```python
import torch

def _softmax(x, axis=-1):
    return torch.softmax(x, dim=axis)
def _gelu(x):
    return torch.nn.functional.gelu(x, approximate="tanh")
def _silu(x):
    return torch.nn.functional.silu(x)
def _sigmoid(x):
    return torch.sigmoid(x)
def _layernorm(x, axis=-1, eps=1e-5):
    m = x.mean(dim=axis, keepdim=True)
    v = x.var(dim=axis, keepdim=True, unbiased=False)
    return (x - m) / torch.sqrt(v + eps)
def _scatter_add(tgt, idx, src, axis=0):
    return tgt.clone().index_add_(axis, idx, src)
def _segment_sum(src, seg, n):
    out = torch.zeros((n,) + src.shape[1:], dtype=src.dtype)
    return out.index_add_(0, seg, src)
def _pad(x, pw):
    flat = tuple(v for pair in reversed(pw) for v in pair)
    return torch.nn.functional.pad(x, flat)

kernel_name = 'sequential_preLN__sliding_local_dilated__glu_gated_geglu__prompt'

def setup_inputs():

    _w = (lambda a: (lambda t: t.to(torch.bfloat16) if t.is_floating_point() else t)(torch.as_tensor(a)))
    def _A_setup():
        B, S, D = 1, 2048, 1024
        return {
            "x": _w((lambda *s: torch.randn(*s, dtype=torch.bfloat16) * 0.05)(B, S, D)),
            "wqkv": _w((lambda *s: torch.randn(*s, dtype=torch.bfloat16) * 0.05)(D, 3 * D)),
            "wo": _w((lambda *s: torch.randn(*s, dtype=torch.bfloat16) * 0.05)(D, D)),
        }
    _A_in = _A_setup()

    def _B_setup():
        B, S, Dm, Df = 1, 2048, 1024, 3584
        return {
            "x": _w((lambda *s: torch.randn(*s, dtype=torch.bfloat16) * 0.05)(B, S, Dm)),
            "w_gate": _w((lambda *s: torch.randn(*s, dtype=torch.bfloat16) * 0.8)(Dm, Df) * (Dm ** -0.5)),
            "w_up": _w((lambda *s: torch.randn(*s, dtype=torch.bfloat16) * 0.8)(Dm, Df) * (Dm ** -0.5)),
            "w_down": _w((lambda *s: torch.randn(*s, dtype=torch.bfloat16) * 0.8)(Df, Dm) * (Df ** -0.5)),
        }
    _B_in = _B_setup()

    return {
        "A_x": _A_in["x"],
        "A_wqkv": _A_in["wqkv"],
        "A_wo": _A_in["wo"],
        "B_x": _B_in["x"],
        "B_w_gate": _B_in["w_gate"],
        "B_w_up": _B_in["w_up"],
        "B_w_down": _B_in["w_down"],
    }

def reference(A_x, A_wqkv, A_wo, B_x, B_w_gate, B_w_up, B_w_down):
    def _A_ref(x, wqkv, wo):
        B, S, D = x.shape
        H = 32; Dh = D // H
        W, dil = 8, 2
        qkv = (lambda x, *d: x.permute(*d))((x @ wqkv).reshape(B, S, 3, H, Dh), 2, 0, 3, 1, 4)
        q, k, v = qkv[0], qkv[1], qkv[2]
        scale = Dh ** -0.5
        pos = torch.arange(S)
        off = torch.arange(W) * dil
        idx = pos[:, None] - off[None, :]
        mask = idx >= 0
        idx_c = torch.where(mask, idx, 0).reshape(-1)
        kg = k[:, :, idx_c, :].reshape(B, H, S, W, Dh)
        vg = v[:, :, idx_c, :].reshape(B, H, S, W, Dh)
        logits = torch.einsum("bhsd,bhswd->bhsw", q, kg) * scale
        logits = torch.where(mask[None, None, :, :], logits, -1e9)
        attn = _softmax(logits, axis=-1)
        o = torch.einsum("bhsw,bhswd->bhsd", attn, vg)
        return (lambda x, *d: x.permute(*d))(o, 0, 2, 1, 3).reshape(B, S, D) @ wo

    def _B_ref(x, w_gate, w_up, w_down):
        g = torch.einsum("bsd,df->bsf", x, w_gate)
        u = torch.einsum("bsd,df->bsf", x, w_up)
        h = _gelu(g) * u
        return torch.einsum("bsf,fd->bsd", h, w_down)

    x = A_x
    h = x + _A_ref(_layernorm(x, axis=-1), A_wqkv, A_wo)
    h2 = h + _B_ref(_layernorm(h, axis=-1), B_w_gate, B_w_up, B_w_down)
    return h2
```

```asm
; @launch grid=(256,1,1) block=(512,1,1) lds=151552
.amdgcn_target "amdgcn-amd-amdhsa--gfx950"
.text
.globl sequential_preLN__sliding_local_dilated__glu_gated_geglu__prompt_kernel
.p2align 8
.type sequential_preLN__sliding_local_dilated__glu_gated_geglu__prompt_kernel,@function
sequential_preLN__sliding_local_dilated__glu_gated_geglu__prompt_kernel:
s_cmp_ge_u32 s2, 256
s_cbranch_scc1 Ldone_1
s_load_dwordx4 s[4:7], s[0:1], 0
s_load_dwordx2 s[32:33], s[0:1], 72
s_and_b32 s3, s2, 7
s_lshr_b32 s42, s2, 3
s_and_b32 s48, s42, 3
s_lshr_b32 s49, s42, 2
s_and_b32 s34, s3, 3
s_lshl_b32 s34, s34, 2
s_add_u32 s34, s34, s48
s_lshr_b32 s35, s3, 2
s_lshl_b32 s35, s35, 3
s_add_u32 s35, s35, s49
v_lshrrev_b32 v12, 6, v0
v_and_b32 v1, 63, v0
v_readfirstlane_b32 s36, v12
s_nop 3
s_lshl_b32 s43, s35, 7
s_lshl_b32 s44, s34, 18
s_lshl_b32 s45, s35, 14
s_add_u32 s45, s45, s44
s_lshl_b32 s50, s34, 7
s_sub_u32 s50, s50, 16
s_waitcnt lgkmcnt(0)
s_mov_b32 s8, s4
s_mov_b32 s9, s5
s_mov_b32 s10, 4194304
s_mov_b32 s11, 0x20000
s_add_u32 s12, s6, s43
s_addc_u32 s13, s7, 0
s_mov_b32 s14, 6289536
s_mov_b32 s15, 0x20000
s_add_u32 s16, s32, s45
s_addc_u32 s17, s33, 0
s_mov_b32 s18, 16384
s_mov_b32 s19, 0x20000
v_and_b32 v12, 15, v1
v_lshrrev_b32 v13, 4, v1
s_cmp_ge_u32 s36, 4
s_cbranch_scc1 Lprod_2
v_lshrrev_b32 v16, 1, v12
v_xor_b32 v15, v13, v16
v_lshlrev_b32 v15, 4, v15
v_lshl_add_u32 v2, v12, 7, v15
v_xor_b32 v3, 64, v2
v_add_u32 v4, 86016, v2
v_add_u32 v5, 86016, v3
v_lshrrev_b32 v15, 2, v12
v_and_b32 v16, 3, v1
v_lshl_add_u32 v19, v13, 3, v15
v_lshlrev_b32 v19, 7, v19
v_and_b32 v15, 2, v15
v_and_b32 v17, 1, v13
v_lshl_add_u32 v15, v17, 2, v15
v_lshrrev_b32 v17, 1, v16
s_lshl_b32 s43, s36, 1
v_add_u32 v17, s43, v17
v_xor_b32 v15, v15, v17
v_lshl_add_u32 v19, v15, 4, v19
v_and_b32 v16, 1, v16
v_lshl_add_u32 v19, v16, 3, v19
v_add_u32 v6, 18432, v19
v_add_u32 v7, 61440, v19
v_add_u32 v8, 104448, v19
v_mov_b32 v128, 0
v_mov_b32 v129, 0
v_mov_b32 v130, 0
v_mov_b32 v131, 0
v_mov_b32 v132, 0
v_mov_b32 v133, 0
v_mov_b32 v134, 0
v_mov_b32 v135, 0
v_mov_b32 v136, 0
v_mov_b32 v137, 0
v_mov_b32 v138, 0
v_mov_b32 v139, 0
v_mov_b32 v140, 0
v_mov_b32 v141, 0
v_mov_b32 v142, 0
v_mov_b32 v143, 0
v_mov_b32 v144, 0
v_mov_b32 v145, 0
v_mov_b32 v146, 0
v_mov_b32 v147, 0
v_mov_b32 v148, 0
v_mov_b32 v149, 0
v_mov_b32 v150, 0
v_mov_b32 v151, 0
v_mov_b32 v152, 0
v_mov_b32 v153, 0
v_mov_b32 v154, 0
v_mov_b32 v155, 0
v_mov_b32 v156, 0
v_mov_b32 v157, 0
v_mov_b32 v158, 0
v_mov_b32 v159, 0
v_mov_b32 v160, 0
v_mov_b32 v161, 0
v_mov_b32 v162, 0
v_mov_b32 v163, 0
v_mov_b32 v164, 0
v_mov_b32 v165, 0
v_mov_b32 v166, 0
v_mov_b32 v167, 0
v_mov_b32 v168, 0
v_mov_b32 v169, 0
v_mov_b32 v170, 0
v_mov_b32 v171, 0
v_mov_b32 v172, 0
v_mov_b32 v173, 0
v_mov_b32 v174, 0
v_mov_b32 v175, 0
v_mov_b32 v176, 0
v_mov_b32 v177, 0
v_mov_b32 v178, 0
v_mov_b32 v179, 0
v_mov_b32 v180, 0
v_mov_b32 v181, 0
v_mov_b32 v182, 0
v_mov_b32 v183, 0
v_mov_b32 v184, 0
v_mov_b32 v185, 0
v_mov_b32 v186, 0
v_mov_b32 v187, 0
v_mov_b32 v188, 0
v_mov_b32 v189, 0
v_mov_b32 v190, 0
v_mov_b32 v191, 0
v_mov_b32 v192, 0
v_mov_b32 v193, 0
v_mov_b32 v194, 0
v_mov_b32 v195, 0
v_mov_b32 v196, 0
v_mov_b32 v197, 0
v_mov_b32 v198, 0
v_mov_b32 v199, 0
v_mov_b32 v200, 0
v_mov_b32 v201, 0
v_mov_b32 v202, 0
v_mov_b32 v203, 0
v_mov_b32 v204, 0
v_mov_b32 v205, 0
v_mov_b32 v206, 0
v_mov_b32 v207, 0
v_mov_b32 v208, 0
v_mov_b32 v209, 0
v_mov_b32 v210, 0
v_mov_b32 v211, 0
v_mov_b32 v212, 0
v_mov_b32 v213, 0
v_mov_b32 v214, 0
v_mov_b32 v215, 0
v_mov_b32 v216, 0
v_mov_b32 v217, 0
v_mov_b32 v218, 0
v_mov_b32 v219, 0
v_mov_b32 v220, 0
v_mov_b32 v221, 0
v_mov_b32 v222, 0
v_mov_b32 v223, 0
v_mov_b32 v224, 0
v_mov_b32 v225, 0
v_mov_b32 v226, 0
v_mov_b32 v227, 0
v_mov_b32 v228, 0
v_mov_b32 v229, 0
v_mov_b32 v230, 0
v_mov_b32 v231, 0
v_mov_b32 v232, 0
v_mov_b32 v233, 0
v_mov_b32 v234, 0
v_mov_b32 v235, 0
s_barrier
ds_read_b128 v[32:35], v2 offset:0
ds_read_b64_tr_b16 v[72:73], v6 offset:8192
ds_read_b64_tr_b16 v[74:75], v6 offset:8704
ds_read_b64_tr_b16 v[76:77], v6 offset:16384
ds_read_b64_tr_b16 v[78:79], v6 offset:16896
ds_read_b64_tr_b16 v[68:69], v6 offset:0
ds_read_b64_tr_b16 v[70:71], v6 offset:512
ds_read_b128 v[36:39], v2 offset:2048
ds_read_b128 v[40:43], v2 offset:4096
ds_read_b128 v[44:47], v2 offset:6144
ds_read_b128 v[48:51], v2 offset:8192
ds_read_b128 v[52:55], v2 offset:10240
ds_read_b128 v[56:59], v2 offset:12288
ds_read_b128 v[60:63], v2 offset:14336
ds_read_b128 v[64:67], v2 offset:16384
s_mov_b32 s41, 5
Lcl_5:
s_waitcnt lgkmcnt(0)
v_mfma_f32_16x16x32_bf16 v[164:167], v[72:75], v[32:35], v[164:167]
ds_read_b128 v[80:83], v3 offset:0
v_mfma_f32_16x16x32_bf16 v[200:203], v[76:79], v[32:35], v[200:203]
ds_read_b64_tr_b16 v[120:121], v6 offset:12288
v_mfma_f32_16x16x32_bf16 v[128:131], v[68:71], v[32:35], v[128:131]
ds_read_b64_tr_b16 v[122:123], v6 offset:12800
v_mfma_f32_16x16x32_bf16 v[168:171], v[72:75], v[36:39], v[168:171]
ds_read_b64_tr_b16 v[124:125], v6 offset:20480
v_mfma_f32_16x16x32_bf16 v[204:207], v[76:79], v[36:39], v[204:207]
ds_read_b64_tr_b16 v[126:127], v6 offset:20992
v_mfma_f32_16x16x32_bf16 v[132:135], v[68:71], v[36:39], v[132:135]
ds_read_b64_tr_b16 v[116:117], v6 offset:4096
v_mfma_f32_16x16x32_bf16 v[172:175], v[72:75], v[40:43], v[172:175]
ds_read_b64_tr_b16 v[118:119], v6 offset:4608
v_mfma_f32_16x16x32_bf16 v[208:211], v[76:79], v[40:43], v[208:211]
ds_read_b128 v[84:87], v3 offset:2048
v_mfma_f32_16x16x32_bf16 v[136:139], v[68:71], v[40:43], v[136:139]
ds_read_b128 v[88:91], v3 offset:4096
v_mfma_f32_16x16x32_bf16 v[176:179], v[72:75], v[44:47], v[176:179]
ds_read_b128 v[92:95], v3 offset:6144
v_mfma_f32_16x16x32_bf16 v[212:215], v[76:79], v[44:47], v[212:215]
ds_read_b128 v[96:99], v3 offset:8192
v_mfma_f32_16x16x32_bf16 v[140:143], v[68:71], v[44:47], v[140:143]
ds_read_b128 v[100:103], v3 offset:10240
v_mfma_f32_16x16x32_bf16 v[180:183], v[72:75], v[48:51], v[180:183]
ds_read_b128 v[104:107], v3 offset:12288
v_mfma_f32_16x16x32_bf16 v[216:219], v[76:79], v[48:51], v[216:219]
ds_read_b128 v[108:111], v3 offset:14336
v_mfma_f32_16x16x32_bf16 v[144:147], v[68:71], v[48:51], v[144:147]
ds_read_b128 v[112:115], v3 offset:16384
v_mfma_f32_16x16x32_bf16 v[184:187], v[72:75], v[52:55], v[184:187]
v_mfma_f32_16x16x32_bf16 v[220:223], v[76:79], v[52:55], v[220:223]
v_mfma_f32_16x16x32_bf16 v[148:151], v[68:71], v[52:55], v[148:151]
v_mfma_f32_16x16x32_bf16 v[188:191], v[72:75], v[56:59], v[188:191]
v_mfma_f32_16x16x32_bf16 v[224:227], v[76:79], v[56:59], v[224:227]
v_mfma_f32_16x16x32_bf16 v[152:155], v[68:71], v[56:59], v[152:155]
v_mfma_f32_16x16x32_bf16 v[192:195], v[72:75], v[60:63], v[192:195]
v_mfma_f32_16x16x32_bf16 v[228:231], v[76:79], v[60:63], v[228:231]
v_mfma_f32_16x16x32_bf16 v[156:159], v[68:71], v[60:63], v[156:159]
v_mfma_f32_16x16x32_bf16 v[196:199], v[72:75], v[64:67], v[196:199]
v_mfma_f32_16x16x32_bf16 v[232:235], v[76:79], v[64:67], v[232:235]
v_mfma_f32_16x16x32_bf16 v[160:163], v[68:71], v[64:67], v[160:163]
s_waitcnt lgkmcnt(0)
s_barrier
v_mfma_f32_16x16x32_bf16 v[164:167], v[120:123], v[80:83], v[164:167]
ds_read_b128 v[32:35], v2 offset:43008
v_mfma_f32_16x16x32_bf16 v[200:203], v[124:127], v[80:83], v[200:203]
ds_read_b64_tr_b16 v[72:73], v7 offset:8192
v_mfma_f32_16x16x32_bf16 v[128:131], v[116:119], v[80:83], v[128:131]
ds_read_b64_tr_b16 v[74:75], v7 offset:8704
v_mfma_f32_16x16x32_bf16 v[168:171], v[120:123], v[84:87], v[168:171]
ds_read_b64_tr_b16 v[76:77], v7 offset:16384
v_mfma_f32_16x16x32_bf16 v[204:207], v[124:127], v[84:87], v[204:207]
ds_read_b64_tr_b16 v[78:79], v7 offset:16896
v_mfma_f32_16x16x32_bf16 v[132:135], v[116:119], v[84:87], v[132:135]
ds_read_b64_tr_b16 v[68:69], v7 offset:0
v_mfma_f32_16x16x32_bf16 v[172:175], v[120:123], v[88:91], v[172:175]
ds_read_b64_tr_b16 v[70:71], v7 offset:512
v_mfma_f32_16x16x32_bf16 v[208:211], v[124:127], v[88:91], v[208:211]
ds_read_b128 v[36:39], v2 offset:45056
v_mfma_f32_16x16x32_bf16 v[136:139], v[116:119], v[88:91], v[136:139]
ds_read_b128 v[40:43], v2 offset:47104
v_mfma_f32_16x16x32_bf16 v[176:179], v[120:123], v[92:95], v[176:179]
ds_read_b128 v[44:47], v2 offset:49152
v_mfma_f32_16x16x32_bf16 v[212:215], v[124:127], v[92:95], v[212:215]
ds_read_b128 v[48:51], v2 offset:51200
v_mfma_f32_16x16x32_bf16 v[140:143], v[116:119], v[92:95], v[140:143]
ds_read_b128 v[52:55], v2 offset:53248
v_mfma_f32_16x16x32_bf16 v[180:183], v[120:123], v[96:99], v[180:183]
ds_read_b128 v[56:59], v2 offset:55296
v_mfma_f32_16x16x32_bf16 v[216:219], v[124:127], v[96:99], v[216:219]
ds_read_b128 v[60:63], v2 offset:57344
v_mfma_f32_16x16x32_bf16 v[144:147], v[116:119], v[96:99], v[144:147]
ds_read_b128 v[64:67], v2 offset:59392
v_mfma_f32_16x16x32_bf16 v[184:187], v[120:123], v[100:103], v[184:187]
v_mfma_f32_16x16x32_bf16 v[220:223], v[124:127], v[100:103], v[220:223]
v_mfma_f32_16x16x32_bf16 v[148:151], v[116:119], v[100:103], v[148:151]
v_mfma_f32_16x16x32_bf16 v[188:191], v[120:123], v[104:107], v[188:191]
v_mfma_f32_16x16x32_bf16 v[224:227], v[124:127], v[104:107], v[224:227]
v_mfma_f32_16x16x32_bf16 v[152:155], v[116:119], v[104:107], v[152:155]
v_mfma_f32_16x16x32_bf16 v[192:195], v[120:123], v[108:111], v[192:195]
v_mfma_f32_16x16x32_bf16 v[228:231], v[124:127], v[108:111], v[228:231]
v_mfma_f32_16x16x32_bf16 v[156:159], v[116:119], v[108:111], v[156:159]
v_mfma_f32_16x16x32_bf16 v[196:199], v[120:123], v[112:115], v[196:199]
v_mfma_f32_16x16x32_bf16 v[232:235], v[124:127], v[112:115], v[232:235]
v_mfma_f32_16x16x32_bf16 v[160:163], v[116:119], v[112:115], v[160:163]
s_waitcnt lgkmcnt(0)
v_mfma_f32_16x16x32_bf16 v[164:167], v[72:75], v[32:35], v[164:167]
ds_read_b128 v[80:83], v3 offset:43008
v_mfma_f32_16x16x32_bf16 v[200:203], v[76:79], v[32:35], v[200:203]
ds_read_b64_tr_b16 v[120:121], v7 offset:12288
v_mfma_f32_16x16x32_bf16 v[128:131], v[68:71], v[32:35], v[128:131]
ds_read_b64_tr_b16 v[122:123], v7 offset:12800
v_mfma_f32_16x16x32_bf16 v[168:171], v[72:75], v[36:39], v[168:171]
ds_read_b64_tr_b16 v[124:125], v7 offset:20480
v_mfma_f32_16x16x32_bf16 v[204:207], v[76:79], v[36:39], v[204:207]
ds_read_b64_tr_b16 v[126:127], v7 offset:20992
v_mfma_f32_16x16x32_bf16 v[132:135], v[68:71], v[36:39], v[132:135]
ds_read_b64_tr_b16 v[116:117], v7 offset:4096
v_mfma_f32_16x16x32_bf16 v[172:175], v[72:75], v[40:43], v[172:175]
ds_read_b64_tr_b16 v[118:119], v7 offset:4608
v_mfma_f32_16x16x32_bf16 v[208:211], v[76:79], v[40:43], v[208:211]
ds_read_b128 v[84:87], v3 offset:45056
v_mfma_f32_16x16x32_bf16 v[136:139], v[68:71], v[40:43], v[136:139]
ds_read_b128 v[88:91], v3 offset:47104
v_mfma_f32_16x16x32_bf16 v[176:179], v[72:75], v[44:47], v[176:179]
ds_read_b128 v[92:95], v3 offset:49152
v_mfma_f32_16x16x32_bf16 v[212:215], v[76:79], v[44:47], v[212:215]
ds_read_b128 v[96:99], v3 offset:51200
v_mfma_f32_16x16x32_bf16 v[140:143], v[68:71], v[44:47], v[140:143]
ds_read_b128 v[100:103], v3 offset:53248
v_mfma_f32_16x16x32_bf16 v[180:183], v[72:75], v[48:51], v[180:183]
ds_read_b128 v[104:107], v3 offset:55296
v_mfma_f32_16x16x32_bf16 v[216:219], v[76:79], v[48:51], v[216:219]
ds_read_b128 v[108:111], v3 offset:57344
v_mfma_f32_16x16x32_bf16 v[144:147], v[68:71], v[48:51], v[144:147]
ds_read_b128 v[112:115], v3 offset:59392
v_mfma_f32_16x16x32_bf16 v[184:187], v[72:75], v[52:55], v[184:187]
v_mfma_f32_16x16x32_bf16 v[220:223], v[76:79], v[52:55], v[220:223]
v_mfma_f32_16x16x32_bf16 v[148:151], v[68:71], v[52:55], v[148:151]
v_mfma_f32_16x16x32_bf16 v[188:191], v[72:75], v[56:59], v[188:191]
v_mfma_f32_16x16x32_bf16 v[224:227], v[76:79], v[56:59], v[224:227]
v_mfma_f32_16x16x32_bf16 v[152:155], v[68:71], v[56:59], v[152:155]
v_mfma_f32_16x16x32_bf16 v[192:195], v[72:75], v[60:63], v[192:195]
v_mfma_f32_16x16x32_bf16 v[228:231], v[76:79], v[60:63], v[228:231]
v_mfma_f32_16x16x32_bf16 v[156:159], v[68:71], v[60:63], v[156:159]
v_mfma_f32_16x16x32_bf16 v[196:199], v[72:75], v[64:67], v[196:199]
v_mfma_f32_16x16x32_bf16 v[232:235], v[76:79], v[64:67], v[232:235]
v_mfma_f32_16x16x32_bf16 v[160:163], v[68:71], v[64:67], v[160:163]
s_waitcnt lgkmcnt(0)
s_barrier
v_mfma_f32_16x16x32_bf16 v[164:167], v[120:123], v[80:83], v[164:167]
ds_read_b128 v[32:35], v4 offset:0
v_mfma_f32_16x16x32_bf16 v[200:203], v[124:127], v[80:83], v[200:203]
ds_read_b64_tr_b16 v[72:73], v8 offset:8192
v_mfma_f32_16x16x32_bf16 v[128:131], v[116:119], v[80:83], v[128:131]
ds_read_b64_tr_b16 v[74:75], v8 offset:8704
v_mfma_f32_16x16x32_bf16 v[168:171], v[120:123], v[84:87], v[168:171]
ds_read_b64_tr_b16 v[76:77], v8 offset:16384
v_mfma_f32_16x16x32_bf16 v[204:207], v[124:127], v[84:87], v[204:207]
ds_read_b64_tr_b16 v[78:79], v8 offset:16896
v_mfma_f32_16x16x32_bf16 v[132:135], v[116:119], v[84:87], v[132:135]
ds_read_b64_tr_b16 v[68:69], v8 offset:0
v_mfma_f32_16x16x32_bf16 v[172:175], v[120:123], v[88:91], v[172:175]
ds_read_b64_tr_b16 v[70:71], v8 offset:512
v_mfma_f32_16x16x32_bf16 v[208:211], v[124:127], v[88:91], v[208:211]
ds_read_b128 v[36:39], v4 offset:2048
v_mfma_f32_16x16x32_bf16 v[136:139], v[116:119], v[88:91], v[136:139]
ds_read_b128 v[40:43], v4 offset:4096
v_mfma_f32_16x16x32_bf16 v[176:179], v[120:123], v[92:95], v[176:179]
ds_read_b128 v[44:47], v4 offset:6144
v_mfma_f32_16x16x32_bf16 v[212:215], v[124:127], v[92:95], v[212:215]
ds_read_b128 v[48:51], v4 offset:8192
v_mfma_f32_16x16x32_bf16 v[140:143], v[116:119], v[92:95], v[140:143]
ds_read_b128 v[52:55], v4 offset:10240
v_mfma_f32_16x16x32_bf16 v[180:183], v[120:123], v[96:99], v[180:183]
ds_read_b128 v[56:59], v4 offset:12288
v_mfma_f32_16x16x32_bf16 v[216:219], v[124:127], v[96:99], v[216:219]
ds_read_b128 v[60:63], v4 offset:14336
v_mfma_f32_16x16x32_bf16 v[144:147], v[116:119], v[96:99], v[144:147]
ds_read_b128 v[64:67], v4 offset:16384
v_mfma_f32_16x16x32_bf16 v[184:187], v[120:123], v[100:103], v[184:187]
v_mfma_f32_16x16x32_bf16 v[220:223], v[124:127], v[100:103], v[220:223]
v_mfma_f32_16x16x32_bf16 v[148:151], v[116:119], v[100:103], v[148:151]
v_mfma_f32_16x16x32_bf16 v[188:191], v[120:123], v[104:107], v[188:191]
v_mfma_f32_16x16x32_bf16 v[224:227], v[124:127], v[104:107], v[224:227]
v_mfma_f32_16x16x32_bf16 v[152:155], v[116:119], v[104:107], v[152:155]
v_mfma_f32_16x16x32_bf16 v[192:195], v[120:123], v[108:111], v[192:195]
v_mfma_f32_16x16x32_bf16 v[228:231], v[124:127], v[108:111], v[228:231]
v_mfma_f32_16x16x32_bf16 v[156:159], v[116:119], v[108:111], v[156:159]
v_mfma_f32_16x16x32_bf16 v[196:199], v[120:123], v[112:115], v[196:199]
v_mfma_f32_16x16x32_bf16 v[232:235], v[124:127], v[112:115], v[232:235]
v_mfma_f32_16x16x32_bf16 v[160:163], v[116:119], v[112:115], v[160:163]
s_waitcnt lgkmcnt(0)
v_mfma_f32_16x16x32_bf16 v[164:167], v[72:75], v[32:35], v[164:167]
ds_read_b128 v[80:83], v5 offset:0
v_mfma_f32_16x16x32_bf16 v[200:203], v[76:79], v[32:35], v[200:203]
ds_read_b64_tr_b16 v[120:121], v8 offset:12288
v_mfma_f32_16x16x32_bf16 v[128:131], v[68:71], v[32:35], v[128:131]
ds_read_b64_tr_b16 v[122:123], v8 offset:12800
v_mfma_f32_16x16x32_bf16 v[168:171], v[72:75], v[36:39], v[168:171]
ds_read_b64_tr_b16 v[124:125], v8 offset:20480
v_mfma_f32_16x16x32_bf16 v[204:207], v[76:79], v[36:39], v[204:207]
ds_read_b64_tr_b16 v[126:127], v8 offset:20992
v_mfma_f32_16x16x32_bf16 v[132:135], v[68:71], v[36:39], v[132:135]
ds_read_b64_tr_b16 v[116:117], v8 offset:4096
v_mfma_f32_16x16x32_bf16 v[172:175], v[72:75], v[40:43], v[172:175]
ds_read_b64_tr_b16 v[118:119], v8 offset:4608
v_mfma_f32_16x16x32_bf16 v[208:211], v[76:79], v[40:43], v[208:211]
ds_read_b128 v[84:87], v5 offset:2048
v_mfma_f32_16x16x32_bf16 v[136:139], v[68:71], v[40:43], v[136:139]
ds_read_b128 v[88:91], v5 offset:4096
v_mfma_f32_16x16x32_bf16 v[176:179], v[72:75], v[44:47], v[176:179]
ds_read_b128 v[92:95], v5 offset:6144
v_mfma_f32_16x16x32_bf16 v[212:215], v[76:79], v[44:47], v[212:215]
ds_read_b128 v[96:99], v5 offset:8192
v_mfma_f32_16x16x32_bf16 v[140:143], v[68:71], v[44:47], v[140:143]
ds_read_b128 v[100:103], v5 offset:10240
v_mfma_f32_16x16x32_bf16 v[180:183], v[72:75], v[48:51], v[180:183]
ds_read_b128 v[104:107], v5 offset:12288
v_mfma_f32_16x16x32_bf16 v[216:219], v[76:79], v[48:51], v[216:219]
ds_read_b128 v[108:111], v5 offset:14336
v_mfma_f32_16x16x32_bf16 v[144:147], v[68:71], v[48:51], v[144:147]
ds_read_b128 v[112:115], v5 offset:16384
v_mfma_f32_16x16x32_bf16 v[184:187], v[72:75], v[52:55], v[184:187]
v_mfma_f32_16x16x32_bf16 v[220:223], v[76:79], v[52:55], v[220:223]
v_mfma_f32_16x16x32_bf16 v[148:151], v[68:71], v[52:55], v[148:151]
v_mfma_f32_16x16x32_bf16 v[188:191], v[72:75], v[56:59], v[188:191]
v_mfma_f32_16x16x32_bf16 v[224:227], v[76:79], v[56:59], v[224:227]
v_mfma_f32_16x16x32_bf16 v[152:155], v[68:71], v[56:59], v[152:155]
v_mfma_f32_16x16x32_bf16 v[192:195], v[72:75], v[60:63], v[192:195]
v_mfma_f32_16x16x32_bf16 v[228:231], v[76:79], v[60:63], v[228:231]
v_mfma_f32_16x16x32_bf16 v[156:159], v[68:71], v[60:63], v[156:159]
v_mfma_f32_16x16x32_bf16 v[196:199], v[72:75], v[64:67], v[196:199]
v_mfma_f32_16x16x32_bf16 v[232:235], v[76:79], v[64:67], v[232:235]
v_mfma_f32_16x16x32_bf16 v[160:163], v[68:71], v[64:67], v[160:163]
s_waitcnt lgkmcnt(0)
s_barrier
v_mfma_f32_16x16x32_bf16 v[164:167], v[120:123], v[80:83], v[164:167]
ds_read_b128 v[32:35], v2 offset:0
v_mfma_f32_16x16x32_bf16 v[200:203], v[124:127], v[80:83], v[200:203]
ds_read_b64_tr_b16 v[72:73], v6 offset:8192
v_mfma_f32_16x16x32_bf16 v[128:131], v[116:119], v[80:83], v[128:131]
ds_read_b64_tr_b16 v[74:75], v6 offset:8704
v_mfma_f32_16x16x32_bf16 v[168:171], v[120:123], v[84:87], v[168:171]
ds_read_b64_tr_b16 v[76:77], v6 offset:16384
v_mfma_f32_16x16x32_bf16 v[204:207], v[124:127], v[84:87], v[204:207]
ds_read_b64_tr_b16 v[78:79], v6 offset:16896
v_mfma_f32_16x16x32_bf16 v[132:135], v[116:119], v[84:87], v[132:135]
ds_read_b64_tr_b16 v[68:69], v6 offset:0
v_mfma_f32_16x16x32_bf16 v[172:175], v[120:123], v[88:91], v[172:175]
ds_read_b64_tr_b16 v[70:71], v6 offset:512
v_mfma_f32_16x16x32_bf16 v[208:211], v[124:127], v[88:91], v[208:211]
ds_read_b128 v[36:39], v2 offset:2048
v_mfma_f32_16x16x32_bf16 v[136:139], v[116:119], v[88:91], v[136:139]
ds_read_b128 v[40:43], v2 offset:4096
v_mfma_f32_16x16x32_bf16 v[176:179], v[120:123], v[92:95], v[176:179]
ds_read_b128 v[44:47], v2 offset:6144
v_mfma_f32_16x16x32_bf16 v[212:215], v[124:127], v[92:95], v[212:215]
ds_read_b128 v[48:51], v2 offset:8192
v_mfma_f32_16x16x32_bf16 v[140:143], v[116:119], v[92:95], v[140:143]
ds_read_b128 v[52:55], v2 offset:10240
v_mfma_f32_16x16x32_bf16 v[180:183], v[120:123], v[96:99], v[180:183]
ds_read_b128 v[56:59], v2 offset:12288
v_mfma_f32_16x16x32_bf16 v[216:219], v[124:127], v[96:99], v[216:219]
ds_read_b128 v[60:63], v2 offset:14336
v_mfma_f32_16x16x32_bf16 v[144:147], v[116:119], v[96:99], v[144:147]
ds_read_b128 v[64:67], v2 offset:16384
v_mfma_f32_16x16x32_bf16 v[184:187], v[120:123], v[100:103], v[184:187]
v_mfma_f32_16x16x32_bf16 v[220:223], v[124:127], v[100:103], v[220:223]
v_mfma_f32_16x16x32_bf16 v[148:151], v[116:119], v[100:103], v[148:151]
v_mfma_f32_16x16x32_bf16 v[188:191], v[120:123], v[104:107], v[188:191]
v_mfma_f32_16x16x32_bf16 v[224:227], v[124:127], v[104:107], v[224:227]
v_mfma_f32_16x16x32_bf16 v[152:155], v[116:119], v[104:107], v[152:155]
v_mfma_f32_16x16x32_bf16 v[192:195], v[120:123], v[108:111], v[192:195]
v_mfma_f32_16x16x32_bf16 v[228:231], v[124:127], v[108:111], v[228:231]
v_mfma_f32_16x16x32_bf16 v[156:159], v[116:119], v[108:111], v[156:159]
v_mfma_f32_16x16x32_bf16 v[196:199], v[120:123], v[112:115], v[196:199]
v_mfma_f32_16x16x32_bf16 v[232:235], v[124:127], v[112:115], v[232:235]
v_mfma_f32_16x16x32_bf16 v[160:163], v[116:119], v[112:115], v[160:163]
s_sub_u32 s41, s41, 1
s_cmp_lg_u32 s41, 0
s_cbranch_scc1 Lcl_5
s_waitcnt lgkmcnt(0)
v_mfma_f32_16x16x32_bf16 v[164:167], v[72:75], v[32:35], v[164:167]
ds_read_b128 v[80:83], v3 offset:0
v_mfma_f32_16x16x32_bf16 v[200:203], v[76:79], v[32:35], v[200:203]
ds_read_b64_tr_b16 v[120:121], v6 offset:12288
v_mfma_f32_16x16x32_bf16 v[128:131], v[68:71], v[32:35], v[128:131]
ds_read_b64_tr_b16 v[122:123], v6 offset:12800
v_mfma_f32_16x16x32_bf16 v[168:171], v[72:75], v[36:39], v[168:171]
ds_read_b64_tr_b16 v[124:125], v6 offset:20480
v_mfma_f32_16x16x32_bf16 v[204:207], v[76:79], v[36:39], v[204:207]
ds_read_b64_tr_b16 v[126:127], v6 offset:20992
v_mfma_f32_16x16x32_bf16 v[132:135], v[68:71], v[36:39], v[132:135]
ds_read_b64_tr_b16 v[116:117], v6 offset:4096
v_mfma_f32_16x16x32_bf16 v[172:175], v[72:75], v[40:43], v[172:175]
ds_read_b64_tr_b16 v[118:119], v6 offset:4608
v_mfma_f32_16x16x32_bf16 v[208:211], v[76:79], v[40:43], v[208:211]
ds_read_b128 v[84:87], v3 offset:2048
v_mfma_f32_16x16x32_bf16 v[136:139], v[68:71], v[40:43], v[136:139]
ds_read_b128 v[88:91], v3 offset:4096
v_mfma_f32_16x16x32_bf16 v[176:179], v[72:75], v[44:47], v[176:179]
ds_read_b128 v[92:95], v3 offset:6144
v_mfma_f32_16x16x32_bf16 v[212:215], v[76:79], v[44:47], v[212:215]
ds_read_b128 v[96:99], v3 offset:8192
v_mfma_f32_16x16x32_bf16 v[140:143], v[68:71], v[44:47], v[140:143]
ds_read_b128 v[100:103], v3 offset:10240
v_mfma_f32_16x16x32_bf16 v[180:183], v[72:75], v[48:51], v[180:183]
ds_read_b128 v[104:107], v3 offset:12288
v_mfma_f32_16x16x32_bf16 v[216:219], v[76:79], v[48:51], v[216:219]
ds_read_b128 v[108:111], v3 offset:14336
v_mfma_f32_16x16x32_bf16 v[144:147], v[68:71], v[48:51], v[144:147]
ds_read_b128 v[112:115], v3 offset:16384
v_mfma_f32_16x16x32_bf16 v[184:187], v[72:75], v[52:55], v[184:187]
v_mfma_f32_16x16x32_bf16 v[220:223], v[76:79], v[52:55], v[220:223]
v_mfma_f32_16x16x32_bf16 v[148:151], v[68:71], v[52:55], v[148:151]
v_mfma_f32_16x16x32_bf16 v[188:191], v[72:75], v[56:59], v[188:191]
v_mfma_f32_16x16x32_bf16 v[224:227], v[76:79], v[56:59], v[224:227]
v_mfma_f32_16x16x32_bf16 v[152:155], v[68:71], v[56:59], v[152:155]
v_mfma_f32_16x16x32_bf16 v[192:195], v[72:75], v[60:63], v[192:195]
v_mfma_f32_16x16x32_bf16 v[228:231], v[76:79], v[60:63], v[228:231]
v_mfma_f32_16x16x32_bf16 v[156:159], v[68:71], v[60:63], v[156:159]
v_mfma_f32_16x16x32_bf16 v[196:199], v[72:75], v[64:67], v[196:199]
v_mfma_f32_16x16x32_bf16 v[232:235], v[76:79], v[64:67], v[232:235]
v_mfma_f32_16x16x32_bf16 v[160:163], v[68:71], v[64:67], v[160:163]
s_waitcnt lgkmcnt(0)
s_barrier
v_mfma_f32_16x16x32_bf16 v[164:167], v[120:123], v[80:83], v[164:167]
v_mfma_f32_16x16x32_bf16 v[200:203], v[124:127], v[80:83], v[200:203]
v_mfma_f32_16x16x32_bf16 v[128:131], v[116:119], v[80:83], v[128:131]
v_mfma_f32_16x16x32_bf16 v[168:171], v[120:123], v[84:87], v[168:171]
v_mfma_f32_16x16x32_bf16 v[204:207], v[124:127], v[84:87], v[204:207]
v_mfma_f32_16x16x32_bf16 v[132:135], v[116:119], v[84:87], v[132:135]
v_mfma_f32_16x16x32_bf16 v[172:175], v[120:123], v[88:91], v[172:175]
v_mfma_f32_16x16x32_bf16 v[208:211], v[124:127], v[88:91], v[208:211]
v_mfma_f32_16x16x32_bf16 v[136:139], v[116:119], v[88:91], v[136:139]
v_mfma_f32_16x16x32_bf16 v[176:179], v[120:123], v[92:95], v[176:179]
v_mfma_f32_16x16x32_bf16 v[212:215], v[124:127], v[92:95], v[212:215]
v_mfma_f32_16x16x32_bf16 v[140:143], v[116:119], v[92:95], v[140:143]
v_mfma_f32_16x16x32_bf16 v[180:183], v[120:123], v[96:99], v[180:183]
v_mfma_f32_16x16x32_bf16 v[216:219], v[124:127], v[96:99], v[216:219]
v_mfma_f32_16x16x32_bf16 v[144:147], v[116:119], v[96:99], v[144:147]
v_mfma_f32_16x16x32_bf16 v[184:187], v[120:123], v[100:103], v[184:187]
v_mfma_f32_16x16x32_bf16 v[220:223], v[124:127], v[100:103], v[220:223]
v_mfma_f32_16x16x32_bf16 v[148:151], v[116:119], v[100:103], v[148:151]
v_mfma_f32_16x16x32_bf16 v[188:191], v[120:123], v[104:107], v[188:191]
v_mfma_f32_16x16x32_bf16 v[224:227], v[124:127], v[104:107], v[224:227]
v_mfma_f32_16x16x32_bf16 v[152:155], v[116:119], v[104:107], v[152:155]
v_mfma_f32_16x16x32_bf16 v[192:195], v[120:123], v[108:111], v[192:195]
v_mfma_f32_16x16x32_bf16 v[228:231], v[124:127], v[108:111], v[228:231]
v_mfma_f32_16x16x32_bf16 v[156:159], v[116:119], v[108:111], v[156:159]
v_mfma_f32_16x16x32_bf16 v[196:199], v[120:123], v[112:115], v[196:199]
v_mfma_f32_16x16x32_bf16 v[232:235], v[124:127], v[112:115], v[232:235]
v_mfma_f32_16x16x32_bf16 v[160:163], v[116:119], v[112:115], v[160:163]
s_barrier
v_lshlrev_b32 v14, 3, v12
v_add_u32 v14, 129024, v14
ds_read_b64 v[32:33], v14 offset:0
ds_read_b64 v[34:35], v14 offset:128
ds_read_b64 v[36:37], v14 offset:256
ds_read_b64 v[38:39], v14 offset:384
ds_read_b64 v[40:41], v14 offset:512
ds_read_b64 v[42:43], v14 offset:640
ds_read_b64 v[44:45], v14 offset:768
ds_read_b64 v[46:47], v14 offset:896
ds_read_b64 v[48:49], v14 offset:1024
v_mov_b32_dpp v52, v128 row_newbcast:0 row_mask:0xf bank_mask:0xf
v_mov_b32_dpp v53, v129 row_newbcast:0 row_mask:0xf bank_mask:0xf
v_mov_b32_dpp v54, v130 row_newbcast:0 row_mask:0xf bank_mask:0xf
v_mov_b32_dpp v55, v131 row_newbcast:0 row_mask:0xf bank_mask:0xf
v_mov_b32_dpp v56, v164 row_newbcast:0 row_mask:0xf bank_mask:0xf
v_mov_b32_dpp v57, v165 row_newbcast:0 row_mask:0xf bank_mask:0xf
v_mov_b32_dpp v58, v166 row_newbcast:0 row_mask:0xf bank_mask:0xf
v_mov_b32_dpp v59, v167 row_newbcast:0 row_mask:0xf bank_mask:0xf
v_mov_b32_dpp v60, v200 row_newbcast:0 row_mask:0xf bank_mask:0xf
v_mov_b32_dpp v61, v201 row_newbcast:0 row_mask:0xf bank_mask:0xf
v_mov_b32_dpp v62, v202 row_newbcast:0 row_mask:0xf bank_mask:0xf
v_mov_b32_dpp v63, v203 row_newbcast:0 row_mask:0xf bank_mask:0xf
v_mul_u32_u24 v14, 400, v12
v_lshl_add_u32 v14, v13, 3, v14
s_lshl_b32 s43, s36, 5
v_add_u32 v14, s43, v14
s_waitcnt lgkmcnt(0)
v_pk_fma_f32 v[164:165], v[32:33], v[56:57], v[164:165] op_sel_hi:[0,1,1] neg_lo:[1,0,0] neg_hi:[1,0,0]
v_pk_fma_f32 v[166:167], v[32:33], v[58:59], v[166:167] op_sel_hi:[0,1,1] neg_lo:[1,0,0] neg_hi:[1,0,0]
v_pk_mul_f32 v[164:165], v[32:33], v[164:165] op_sel:[1,0] op_sel_hi:[1,1]
v_pk_mul_f32 v[166:167], v[32:33], v[166:167] op_sel:[1,0] op_sel_hi:[1,1]
v_cvt_pk_bf16_f32 v164, v164, v165
v_cvt_pk_bf16_f32 v165, v166, v167
ds_write_b64 v14, v[164:165] offset:128
v_pk_fma_f32 v[200:201], v[32:33], v[60:61], v[200:201] op_sel_hi:[0,1,1] neg_lo:[1,0,0] neg_hi:[1,0,0]
v_pk_fma_f32 v[202:203], v[32:33], v[62:63], v[202:203] op_sel_hi:[0,1,1] neg_lo:[1,0,0] neg_hi:[1,0,0]
v_pk_mul_f32 v[200:201], v[32:33], v[200:201] op_sel:[1,0] op_sel_hi:[1,1]
v_pk_mul_f32 v[202:203], v[32:33], v[202:203] op_sel:[1,0] op_sel_hi:[1,1]
v_cvt_pk_bf16_f32 v200, v200, v201
v_cvt_pk_bf16_f32 v201, v202, v203
ds_write_b64 v14, v[200:201] offset:256
v_pk_fma_f32 v[132:133], v[34:35], v[52:53], v[132:133] op_sel_hi:[0,1,1] neg_lo:[1,0,0] neg_hi:[1,0,0]
v_pk_fma_f32 v[134:135], v[34:35], v[54:55], v[134:135] op_sel_hi:[0,1,1] neg_lo:[1,0,0] neg_hi:[1,0,0]
v_pk_mul_f32 v[132:133], v[34:35], v[132:133] op_sel:[1,0] op_sel_hi:[1,1]
v_pk_mul_f32 v[134:135], v[34:35], v[134:135] op_sel:[1,0] op_sel_hi:[1,1]
v_cvt_pk_bf16_f32 v132, v132, v133
v_cvt_pk_bf16_f32 v133, v134, v135
ds_write_b64 v14, v[132:133] offset:6400
v_pk_fma_f32 v[168:169], v[34:35], v[56:57], v[168:169] op_sel_hi:[0,1,1] neg_lo:[1,0,0] neg_hi:[1,0,0]
v_pk_fma_f32 v[170:171], v[34:35], v[58:59], v[170:171] op_sel_hi:[0,1,1] neg_lo:[1,0,0] neg_hi:[1,0,0]
v_pk_mul_f32 v[168:169], v[34:35], v[168:169] op_sel:[1,0] op_sel_hi:[1,1]
v_pk_mul_f32 v[170:171], v[34:35], v[170:171] op_sel:[1,0] op_sel_hi:[1,1]
v_cvt_pk_bf16_f32 v168, v168, v169
v_cvt_pk_bf16_f32 v169, v170, v171
ds_write_b64 v14, v[168:169] offset:6528
v_pk_fma_f32 v[204:205], v[34:35], v[60:61], v[204:205] op_sel_hi:[0,1,1] neg_lo:[1,0,0] neg_hi:[1,0,0]
v_pk_fma_f32 v[206:207], v[34:35], v[62:63], v[206:207] op_sel_hi:[0,1,1] neg_lo:[1,0,0] neg_hi:[1,0,0]
v_pk_mul_f32 v[204:205], v[34:35], v[204:205] op_sel:[1,0] op_sel_hi:[1,1]
v_pk_mul_f32 v[206:207], v[34:35], v[206:207] op_sel:[1,0] op_sel_hi:[1,1]
v_cvt_pk_bf16_f32 v204, v204, v205
v_cvt_pk_bf16_f32 v205, v206, v207
ds_write_b64 v14, v[204:205] offset:6656
v_pk_fma_f32 v[136:137], v[36:37], v[52:53], v[136:137] op_sel_hi:[0,1,1] neg_lo:[1,0,0] neg_hi:[1,0,0]
v_pk_fma_f32 v[138:139], v[36:37], v[54:55], v[138:139] op_sel_hi:[0,1,1] neg_lo:[1,0,0] neg_hi:[1,0,0]
v_pk_mul_f32 v[136:137], v[36:37], v[136:137] op_sel:[1,0] op_sel_hi:[1,1]
v_pk_mul_f32 v[138:139], v[36:37], v[138:139] op_sel:[1,0] op_sel_hi:[1,1]
v_cvt_pk_bf16_f32 v136, v136, v137
v_cvt_pk_bf16_f32 v137, v138, v139
ds_write_b64 v14, v[136:137] offset:12800
v_pk_fma_f32 v[172:173], v[36:37], v[56:57], v[172:173] op_sel_hi:[0,1,1] neg_lo:[1,0,0] neg_hi:[1,0,0]
v_pk_fma_f32 v[174:175], v[36:37], v[58:59], v[174:175] op_sel_hi:[0,1,1] neg_lo:[1,0,0] neg_hi:[1,0,0]
v_pk_mul_f32 v[172:173], v[36:37], v[172:173] op_sel:[1,0] op_sel_hi:[1,1]
v_pk_mul_f32 v[174:175], v[36:37], v[174:175] op_sel:[1,0] op_sel_hi:[1,1]
v_cvt_pk_bf16_f32 v172, v172, v173
v_cvt_pk_bf16_f32 v173, v174, v175
ds_write_b64 v14, v[172:173] offset:12928
v_pk_fma_f32 v[208:209], v[36:37], v[60:61], v[208:209] op_sel_hi:[0,1,1] neg_lo:[1,0,0] neg_hi:[1,0,0]
v_pk_fma_f32 v[210:211], v[36:37], v[62:63], v[210:211] op_sel_hi:[0,1,1] neg_lo:[1,0,0] neg_hi:[1,0,0]
v_pk_mul_f32 v[208:209], v[36:37], v[208:209] op_sel:[1,0] op_sel_hi:[1,1]
v_pk_mul_f32 v[210:211], v[36:37], v[210:211] op_sel:[1,0] op_sel_hi:[1,1]
v_cvt_pk_bf16_f32 v208, v208, v209
v_cvt_pk_bf16_f32 v209, v210, v211
ds_write_b64 v14, v[208:209] offset:13056
v_pk_fma_f32 v[140:141], v[38:39], v[52:53], v[140:141] op_sel_hi:[0,1,1] neg_lo:[1,0,0] neg_hi:[1,0,0]
v_pk_fma_f32 v[142:143], v[38:39], v[54:55], v[142:143] op_sel_hi:[0,1,1] neg_lo:[1,0,0] neg_hi:[1,0,0]
v_pk_mul_f32 v[140:141], v[38:39], v[140:141] op_sel:[1,0] op_sel_hi:[1,1]
v_pk_mul_f32 v[142:143], v[38:39], v[142:143] op_sel:[1,0] op_sel_hi:[1,1]
v_cvt_pk_bf16_f32 v140, v140, v141
v_cvt_pk_bf16_f32 v141, v142, v143
ds_write_b64 v14, v[140:141] offset:19200
v_pk_fma_f32 v[176:177], v[38:39], v[56:57], v[176:177] op_sel_hi:[0,1,1] neg_lo:[1,0,0] neg_hi:[1,0,0]
v_pk_fma_f32 v[178:179], v[38:39], v[58:59], v[178:179] op_sel_hi:[0,1,1] neg_lo:[1,0,0] neg_hi:[1,0,0]
v_pk_mul_f32 v[176:177], v[38:39], v[176:177] op_sel:[1,0] op_sel_hi:[1,1]
v_pk_mul_f32 v[178:179], v[38:39], v[178:179] op_sel:[1,0] op_sel_hi:[1,1]
v_cvt_pk_bf16_f32 v176, v176, v177
v_cvt_pk_bf16_f32 v177, v178, v179
ds_write_b64 v14, v[176:177] offset:19328
v_pk_fma_f32 v[212:213], v[38:39], v[60:61], v[212:213] op_sel_hi:[0,1,1] neg_lo:[1,0,0] neg_hi:[1,0,0]
v_pk_fma_f32 v[214:215], v[38:39], v[62:63], v[214:215] op_sel_hi:[0,1,1] neg_lo:[1,0,0] neg_hi:[1,0,0]
v_pk_mul_f32 v[212:213], v[38:39], v[212:213] op_sel:[1,0] op_sel_hi:[1,1]
v_pk_mul_f32 v[214:215], v[38:39], v[214:215] op_sel:[1,0] op_sel_hi:[1,1]
v_cvt_pk_bf16_f32 v212, v212, v213
v_cvt_pk_bf16_f32 v213, v214, v215
ds_write_b64 v14, v[212:213] offset:19456
v_pk_fma_f32 v[144:145], v[40:41], v[52:53], v[144:145] op_sel_hi:[0,1,1] neg_lo:[1,0,0] neg_hi:[1,0,0]
v_pk_fma_f32 v[146:147], v[40:41], v[54:55], v[146:147] op_sel_hi:[0,1,1] neg_lo:[1,0,0] neg_hi:[1,0,0]
v_pk_mul_f32 v[144:145], v[40:41], v[144:145] op_sel:[1,0] op_sel_hi:[1,1]
v_pk_mul_f32 v[146:147], v[40:41], v[146:147] op_sel:[1,0] op_sel_hi:[1,1]
v_cvt_pk_bf16_f32 v144, v144, v145
v_cvt_pk_bf16_f32 v145, v146, v147
ds_write_b64 v14, v[144:145] offset:25600
v_pk_fma_f32 v[180:181], v[40:41], v[56:57], v[180:181] op_sel_hi:[0,1,1] neg_lo:[1,0,0] neg_hi:[1,0,0]
v_pk_fma_f32 v[182:183], v[40:41], v[58:59], v[182:183] op_sel_hi:[0,1,1] neg_lo:[1,0,0] neg_hi:[1,0,0]
v_pk_mul_f32 v[180:181], v[40:41], v[180:181] op_sel:[1,0] op_sel_hi:[1,1]
v_pk_mul_f32 v[182:183], v[40:41], v[182:183] op_sel:[1,0] op_sel_hi:[1,1]
v_cvt_pk_bf16_f32 v180, v180, v181
v_cvt_pk_bf16_f32 v181, v182, v183
ds_write_b64 v14, v[180:181] offset:25728
v_pk_fma_f32 v[216:217], v[40:41], v[60:61], v[216:217] op_sel_hi:[0,1,1] neg_lo:[1,0,0] neg_hi:[1,0,0]
v_pk_fma_f32 v[218:219], v[40:41], v[62:63], v[218:219] op_sel_hi:[0,1,1] neg_lo:[1,0,0] neg_hi:[1,0,0]
v_pk_mul_f32 v[216:217], v[40:41], v[216:217] op_sel:[1,0] op_sel_hi:[1,1]
v_pk_mul_f32 v[218:219], v[40:41], v[218:219] op_sel:[1,0] op_sel_hi:[1,1]
v_cvt_pk_bf16_f32 v216, v216, v217
v_cvt_pk_bf16_f32 v217, v218, v219
ds_write_b64 v14, v[216:217] offset:25856
v_pk_fma_f32 v[148:149], v[42:43], v[52:53], v[148:149] op_sel_hi:[0,1,1] neg_lo:[1,0,0] neg_hi:[1,0,0]
v_pk_fma_f32 v[150:151], v[42:43], v[54:55], v[150:151] op_sel_hi:[0,1,1] neg_lo:[1,0,0] neg_hi:[1,0,0]
v_pk_mul_f32 v[148:149], v[42:43], v[148:149] op_sel:[1,0] op_sel_hi:[1,1]
v_pk_mul_f32 v[150:151], v[42:43], v[150:151] op_sel:[1,0] op_sel_hi:[1,1]
v_cvt_pk_bf16_f32 v148, v148, v149
v_cvt_pk_bf16_f32 v149, v150, v151
ds_write_b64 v14, v[148:149] offset:32000
v_pk_fma_f32 v[184:185], v[42:43], v[56:57], v[184:185] op_sel_hi:[0,1,1] neg_lo:[1,0,0] neg_hi:[1,0,0]
v_pk_fma_f32 v[186:187], v[42:43], v[58:59], v[186:187] op_sel_hi:[0,1,1] neg_lo:[1,0,0] neg_hi:[1,0,0]
v_pk_mul_f32 v[184:185], v[42:43], v[184:185] op_sel:[1,0] op_sel_hi:[1,1]
v_pk_mul_f32 v[186:187], v[42:43], v[186:187] op_sel:[1,0] op_sel_hi:[1,1]
v_cvt_pk_bf16_f32 v184, v184, v185
v_cvt_pk_bf16_f32 v185, v186, v187
ds_write_b64 v14, v[184:185] offset:32128
v_pk_fma_f32 v[220:221], v[42:43], v[60:61], v[220:221] op_sel_hi:[0,1,1] neg_lo:[1,0,0] neg_hi:[1,0,0]
v_pk_fma_f32 v[222:223], v[42:43], v[62:63], v[222:223] op_sel_hi:[0,1,1] neg_lo:[1,0,0] neg_hi:[1,0,0]
v_pk_mul_f32 v[220:221], v[42:43], v[220:221] op_sel:[1,0] op_sel_hi:[1,1]
v_pk_mul_f32 v[222:223], v[42:43], v[222:223] op_sel:[1,0] op_sel_hi:[1,1]
v_cvt_pk_bf16_f32 v220, v220, v221
v_cvt_pk_bf16_f32 v221, v222, v223
ds_write_b64 v14, v[220:221] offset:32256
v_pk_fma_f32 v[152:153], v[44:45], v[52:53], v[152:153] op_sel_hi:[0,1,1] neg_lo:[1,0,0] neg_hi:[1,0,0]
v_pk_fma_f32 v[154:155], v[44:45], v[54:55], v[154:155] op_sel_hi:[0,1,1] neg_lo:[1,0,0] neg_hi:[1,0,0]
v_pk_mul_f32 v[152:153], v[44:45], v[152:153] op_sel:[1,0] op_sel_hi:[1,1]
v_pk_mul_f32 v[154:155], v[44:45], v[154:155] op_sel:[1,0] op_sel_hi:[1,1]
v_cvt_pk_bf16_f32 v152, v152, v153
v_cvt_pk_bf16_f32 v153, v154, v155
ds_write_b64 v14, v[152:153] offset:38400
v_pk_fma_f32 v[188:189], v[44:45], v[56:57], v[188:189] op_sel_hi:[0,1,1] neg_lo:[1,0,0] neg_hi:[1,0,0]
v_pk_fma_f32 v[190:191], v[44:45], v[58:59], v[190:191] op_sel_hi:[0,1,1] neg_lo:[1,0,0] neg_hi:[1,0,0]
v_pk_mul_f32 v[188:189], v[44:45], v[188:189] op_sel:[1,0] op_sel_hi:[1,1]
v_pk_mul_f32 v[190:191], v[44:45], v[190:191] op_sel:[1,0] op_sel_hi:[1,1]
v_cvt_pk_bf16_f32 v188, v188, v189
v_cvt_pk_bf16_f32 v189, v190, v191
ds_write_b64 v14, v[188:189] offset:38528
v_pk_fma_f32 v[224:225], v[44:45], v[60:61], v[224:225] op_sel_hi:[0,1,1] neg_lo:[1,0,0] neg_hi:[1,0,0]
v_pk_fma_f32 v[226:227], v[44:45], v[62:63], v[226:227] op_sel_hi:[0,1,1] neg_lo:[1,0,0] neg_hi:[1,0,0]
v_pk_mul_f32 v[224:225], v[44:45], v[224:225] op_sel:[1,0] op_sel_hi:[1,1]
v_pk_mul_f32 v[226:227], v[44:45], v[226:227] op_sel:[1,0] op_sel_hi:[1,1]
v_cvt_pk_bf16_f32 v224, v224, v225
v_cvt_pk_bf16_f32 v225, v226, v227
ds_write_b64 v14, v[224:225] offset:38656
v_pk_fma_f32 v[156:157], v[46:47], v[52:53], v[156:157] op_sel_hi:[0,1,1] neg_lo:[1,0,0] neg_hi:[1,0,0]
v_pk_fma_f32 v[158:159], v[46:47], v[54:55], v[158:159] op_sel_hi:[0,1,1] neg_lo:[1,0,0] neg_hi:[1,0,0]
v_pk_mul_f32 v[156:157], v[46:47], v[156:157] op_sel:[1,0] op_sel_hi:[1,1]
v_pk_mul_f32 v[158:159], v[46:47], v[158:159] op_sel:[1,0] op_sel_hi:[1,1]
v_cvt_pk_bf16_f32 v156, v156, v157
v_cvt_pk_bf16_f32 v157, v158, v159
ds_write_b64 v14, v[156:157] offset:44800
v_pk_fma_f32 v[192:193], v[46:47], v[56:57], v[192:193] op_sel_hi:[0,1,1] neg_lo:[1,0,0] neg_hi:[1,0,0]
v_pk_fma_f32 v[194:195], v[46:47], v[58:59], v[194:195] op_sel_hi:[0,1,1] neg_lo:[1,0,0] neg_hi:[1,0,0]
v_pk_mul_f32 v[192:193], v[46:47], v[192:193] op_sel:[1,0] op_sel_hi:[1,1]
v_pk_mul_f32 v[194:195], v[46:47], v[194:195] op_sel:[1,0] op_sel_hi:[1,1]
v_cvt_pk_bf16_f32 v192, v192, v193
v_cvt_pk_bf16_f32 v193, v194, v195
ds_write_b64 v14, v[192:193] offset:44928
v_pk_fma_f32 v[228:229], v[46:47], v[60:61], v[228:229] op_sel_hi:[0,1,1] neg_lo:[1,0,0] neg_hi:[1,0,0]
v_pk_fma_f32 v[230:231], v[46:47], v[62:63], v[230:231] op_sel_hi:[0,1,1] neg_lo:[1,0,0] neg_hi:[1,0,0]
v_pk_mul_f32 v[228:229], v[46:47], v[228:229] op_sel:[1,0] op_sel_hi:[1,1]
v_pk_mul_f32 v[230:231], v[46:47], v[230:231] op_sel:[1,0] op_sel_hi:[1,1]
v_cvt_pk_bf16_f32 v228, v228, v229
v_cvt_pk_bf16_f32 v229, v230, v231
ds_write_b64 v14, v[228:229] offset:45056
v_pk_fma_f32 v[160:161], v[48:49], v[52:53], v[160:161] op_sel_hi:[0,1,1] neg_lo:[1,0,0] neg_hi:[1,0,0]
v_pk_fma_f32 v[162:163], v[48:49], v[54:55], v[162:163] op_sel_hi:[0,1,1] neg_lo:[1,0,0] neg_hi:[1,0,0]
v_pk_mul_f32 v[160:161], v[48:49], v[160:161] op_sel:[1,0] op_sel_hi:[1,1]
v_pk_mul_f32 v[162:163], v[48:49], v[162:163] op_sel:[1,0] op_sel_hi:[1,1]
v_cvt_pk_bf16_f32 v160, v160, v161
v_cvt_pk_bf16_f32 v161, v162, v163
ds_write_b64 v14, v[160:161] offset:51200
v_pk_fma_f32 v[196:197], v[48:49], v[56:57], v[196:197] op_sel_hi:[0,1,1] neg_lo:[1,0,0] neg_hi:[1,0,0]
v_pk_fma_f32 v[198:199], v[48:49], v[58:59], v[198:199] op_sel_hi:[0,1,1] neg_lo:[1,0,0] neg_hi:[1,0,0]
v_pk_mul_f32 v[196:197], v[48:49], v[196:197] op_sel:[1,0] op_sel_hi:[1,1]
v_pk_mul_f32 v[198:199], v[48:49], v[198:199] op_sel:[1,0] op_sel_hi:[1,1]
v_cvt_pk_bf16_f32 v196, v196, v197
v_cvt_pk_bf16_f32 v197, v198, v199
ds_write_b64 v14, v[196:197] offset:51328
v_pk_fma_f32 v[232:233], v[48:49], v[60:61], v[232:233] op_sel_hi:[0,1,1] neg_lo:[1,0,0] neg_hi:[1,0,0]
v_pk_fma_f32 v[234:235], v[48:49], v[62:63], v[234:235] op_sel_hi:[0,1,1] neg_lo:[1,0,0] neg_hi:[1,0,0]
v_pk_mul_f32 v[232:233], v[48:49], v[232:233] op_sel:[1,0] op_sel_hi:[1,1]
v_pk_mul_f32 v[234:235], v[48:49], v[234:235] op_sel:[1,0] op_sel_hi:[1,1]
v_cvt_pk_bf16_f32 v232, v232, v233
v_cvt_pk_bf16_f32 v233, v234, v235
ds_write_b64 v14, v[232:233] offset:51456
s_waitcnt lgkmcnt(0)
s_branch Latt_4
Lprod_2:
s_sub_u32 s47, s36, 4
s_lshl_b32 s43, s34, 7
s_lshl_b32 s44, s35, 3
s_add_u32 s43, s43, s44
s_mov_b32 s63, s43
s_lshl_b32 s44, s47, 1
s_add_u32 s51, s43, s44
v_lshlrev_b32 v10, 4, v1
s_add_u32 s20, s32, 26214400
s_addc_u32 s21, s33, 0
s_mov_b32 s22, 16384
s_mov_b32 s23, 0x20000
s_cmp_eq_u32 s47, 3
s_cbranch_scc1 Lpf_3
v_lshrrev_b32 v14, 3, v1
v_and_b32 v15, 7, v1
v_and_b32 v16, 2, v14
v_xor_b32 v16, v15, v16
v_lshlrev_b32 v16, 4, v16
v_mul_u32_u24 v17, 6144, v14
s_lshl_b32 s43, s47, 11
v_add3_u32 v2, v17, v16, s43
v_xor_b32 v3, 64, v2
v_lshrrev_b32 v16, 1, v14
v_xor_b32 v16, v15, v16
v_lshlrev_b32 v16, 4, v16
s_lshl_b32 s43, s47, 3
s_add_u32 s43, s43, s50
v_add_u32 v17, s43, v14
s_and_b32 s44, s47, 1
s_lshl_b32 s44, s44, 6
v_add_u32 v18, 0, v17
v_max_i32 v18, 0, v18
v_lshl_add_u32 v18, v18, 11, v16
v_xor_b32 v18, s44, v18
v_mov_b32 v4, v18
v_add_u32 v18, 24, v17
v_max_i32 v18, 0, v18
v_lshl_add_u32 v18, v18, 11, v16
v_xor_b32 v18, s44, v18
v_xor_b32 v5, 64, v18
v_add_u32 v18, 48, v17
v_max_i32 v18, 0, v18
v_lshl_add_u32 v18, v18, 11, v16
v_xor_b32 v18, s44, v18
v_mov_b32 v6, v18
v_add_u32 v18, 72, v17
v_max_i32 v18, 0, v18
v_lshl_add_u32 v18, v18, 11, v16
v_xor_b32 v18, s44, v18
v_xor_b32 v7, 64, v18
v_add_u32 v18, 96, v17
v_max_i32 v18, 0, v18
v_lshl_add_u32 v18, v18, 11, v16
v_xor_b32 v18, s44, v18
v_mov_b32 v8, v18
v_add_u32 v18, 120, v17
v_max_i32 v18, 0, v18
v_lshl_add_u32 v18, v18, 11, v16
v_xor_b32 v18, s44, v18
v_xor_b32 v9, 64, v18
s_lshl_b32 s39, s47, 10
s_lshl_b32 s40, s47, 13
s_add_u32 s40, s40, 18432
s_mov_b32 s37, 0
s_mov_b32 s38, 0
s_bfm_b64 s[60:61], 56, 8
s_cmp_eq_u32 s47, 0
s_cselect_b64 s[60:61], s[60:61], -1
s_add_u32 m0, s39, 0
s_mov_b64 exec, s[60:61]
buffer_load_dwordx4 v4, s[8:11], s37 offen lds
s_mov_b64 exec, -1
s_add_u32 m0, s39, 3072
s_nop 0
buffer_load_dwordx4 v5, s[8:11], s37 offen lds
s_add_u32 m0, s39, 6144
s_nop 0
buffer_load_dwordx4 v6, s[8:11], s37 offen lds
s_add_u32 m0, s39, 9216
s_nop 0
buffer_load_dwordx4 v7, s[8:11], s37 offen lds
s_add_u32 m0, s39, 12288
s_nop 0
buffer_load_dwordx4 v8, s[8:11], s37 offen lds
s_add_u32 m0, s39, 15360
s_nop 0
buffer_load_dwordx4 v9, s[8:11], s37 offen lds
s_add_u32 m0, s40, 0
s_add_u32 s43, s38, 0
buffer_load_dwordx4 v2, s[12:15], s43 offen lds
s_add_u32 m0, s40, 1024
s_add_u32 s43, s38, 49152
buffer_load_dwordx4 v3, s[12:15], s43 offen lds
s_add_u32 m0, s40, 2048
s_add_u32 s43, s38, 98304
buffer_load_dwordx4 v2, s[12:15], s43 offen lds
s_add_u32 m0, s40, 3072
s_add_u32 s43, s38, 147456
buffer_load_dwordx4 v3, s[12:15], s43 offen lds
s_add_u32 m0, s40, 4096
s_add_u32 s43, s38, 196608
buffer_load_dwordx4 v2, s[12:15], s43 offen lds
s_add_u32 m0, s40, 5120
s_add_u32 s43, s38, 245760
buffer_load_dwordx4 v3, s[12:15], s43 offen lds
s_add_u32 m0, s40, 6144
s_add_u32 s43, s38, 294912
buffer_load_dwordx4 v2, s[12:15], s43 offen lds
s_add_u32 m0, s40, 7168
s_add_u32 s43, s38, 344064
buffer_load_dwordx4 v3, s[12:15], s43 offen lds
s_add_u32 s37, s37, 128
s_add_u32 s38, s38, 393216
s_add_u32 m0, s39, 43008
s_mov_b64 exec, s[60:61]
buffer_load_dwordx4 v4, s[8:11], s37 offen lds
s_mov_b64 exec, -1
s_add_u32 m0, s39, 46080
s_nop 0
buffer_load_dwordx4 v5, s[8:11], s37 offen lds
s_add_u32 m0, s39, 49152
s_nop 0
buffer_load_dwordx4 v6, s[8:11], s37 offen lds
s_add_u32 m0, s39, 52224
s_nop 0
buffer_load_dwordx4 v7, s[8:11], s37 offen lds
s_add_u32 m0, s39, 55296
s_nop 0
buffer_load_dwordx4 v8, s[8:11], s37 offen lds
s_add_u32 m0, s39, 58368
s_nop 0
buffer_load_dwordx4 v9, s[8:11], s37 offen lds
s_add_u32 m0, s40, 43008
s_add_u32 s43, s38, 0
buffer_load_dwordx4 v2, s[12:15], s43 offen lds
s_add_u32 m0, s40, 44032
s_add_u32 s43, s38, 49152
buffer_load_dwordx4 v3, s[12:15], s43 offen lds
s_add_u32 m0, s40, 45056
s_add_u32 s43, s38, 98304
buffer_load_dwordx4 v2, s[12:15], s43 offen lds
s_add_u32 m0, s40, 46080
s_add_u32 s43, s38, 147456
buffer_load_dwordx4 v3, s[12:15], s43 offen lds
s_add_u32 m0, s40, 47104
s_add_u32 s43, s38, 196608
buffer_load_dwordx4 v2, s[12:15], s43 offen lds
s_add_u32 m0, s40, 48128
s_add_u32 s43, s38, 245760
buffer_load_dwordx4 v3, s[12:15], s43 offen lds
s_add_u32 m0, s40, 49152
s_add_u32 s43, s38, 294912
buffer_load_dwordx4 v2, s[12:15], s43 offen lds
s_add_u32 m0, s40, 50176
s_add_u32 s43, s38, 344064
buffer_load_dwordx4 v3, s[12:15], s43 offen lds
s_add_u32 s37, s37, 128
s_add_u32 s38, s38, 393216
s_add_u32 m0, s39, 86016
s_mov_b64 exec, s[60:61]
buffer_load_dwordx4 v4, s[8:11], s37 offen lds
s_mov_b64 exec, -1
s_add_u32 m0, s39, 89088
s_nop 0
buffer_load_dwordx4 v5, s[8:11], s37 offen lds
s_add_u32 m0, s39, 92160
s_nop 0
buffer_load_dwordx4 v6, s[8:11], s37 offen lds
s_add_u32 m0, s39, 95232
s_nop 0
buffer_load_dwordx4 v7, s[8:11], s37 offen lds
s_add_u32 m0, s39, 98304
s_nop 0
buffer_load_dwordx4 v8, s[8:11], s37 offen lds
s_add_u32 m0, s39, 101376
s_nop 0
buffer_load_dwordx4 v9, s[8:11], s37 offen lds
s_add_u32 m0, s40, 86016
s_add_u32 s43, s38, 0
buffer_load_dwordx4 v2, s[12:15], s43 offen lds
s_add_u32 m0, s40, 87040
s_add_u32 s43, s38, 49152
buffer_load_dwordx4 v3, s[12:15], s43 offen lds
s_add_u32 m0, s40, 88064
s_add_u32 s43, s38, 98304
buffer_load_dwordx4 v2, s[12:15], s43 offen lds
s_add_u32 m0, s40, 89088
s_add_u32 s43, s38, 147456
buffer_load_dwordx4 v3, s[12:15], s43 offen lds
s_add_u32 m0, s40, 90112
s_add_u32 s43, s38, 196608
buffer_load_dwordx4 v2, s[12:15], s43 offen lds
s_add_u32 m0, s40, 91136
s_add_u32 s43, s38, 245760
buffer_load_dwordx4 v3, s[12:15], s43 offen lds
s_add_u32 m0, s40, 92160
s_add_u32 s43, s38, 294912
buffer_load_dwordx4 v2, s[12:15], s43 offen lds
s_add_u32 m0, s40, 93184
s_add_u32 s43, s38, 344064
buffer_load_dwordx4 v3, s[12:15], s43 offen lds
s_add_u32 s37, s37, 128
s_add_u32 s38, s38, 393216
s_lshl_b32 s43, s51, 11
buffer_load_dwordx4 v[96:99], v10, s[8:11], s43 offen offset:0
buffer_load_dwordx4 v[100:103], v10, s[8:11], s43 offen offset:1024
buffer_load_dwordx4 v[104:107], v10, s[8:11], s43 offen offset:2048
buffer_load_dwordx4 v[108:111], v10, s[8:11], s43 offen offset:3072
s_waitcnt vmcnt(32)
s_barrier
s_waitcnt vmcnt(18)
s_barrier
s_add_u32 m0, s39, 0
s_mov_b64 exec, s[60:61]
buffer_load_dwordx4 v4, s[8:11], s37 offen lds
s_mov_b64 exec, -1
s_add_u32 m0, s39, 3072
s_nop 0
buffer_load_dwordx4 v5, s[8:11], s37 offen lds
s_add_u32 m0, s39, 6144
s_nop 0
buffer_load_dwordx4 v6, s[8:11], s37 offen lds
s_add_u32 m0, s39, 9216
s_nop 0
buffer_load_dwordx4 v7, s[8:11], s37 offen lds
s_add_u32 m0, s39, 12288
s_nop 0
buffer_load_dwordx4 v8, s[8:11], s37 offen lds
s_add_u32 m0, s39, 15360
s_nop 0
buffer_load_dwordx4 v9, s[8:11], s37 offen lds
s_add_u32 m0, s40, 0
s_add_u32 s43, s38, 0
buffer_load_dwordx4 v2, s[12:15], s43 offen lds
s_add_u32 m0, s40, 1024
s_add_u32 s43, s38, 49152
buffer_load_dwordx4 v3, s[12:15], s43 offen lds
s_add_u32 m0, s40, 2048
s_add_u32 s43, s38, 98304
buffer_load_dwordx4 v2, s[12:15], s43 offen lds
s_add_u32 m0, s40, 3072
s_add_u32 s43, s38, 147456
buffer_load_dwordx4 v3, s[12:15], s43 offen lds
s_add_u32 m0, s40, 4096
s_add_u32 s43, s38, 196608
buffer_load_dwordx4 v2, s[12:15], s43 offen lds
s_add_u32 m0, s40, 5120
s_add_u32 s43, s38, 245760
buffer_load_dwordx4 v3, s[12:15], s43 offen lds
s_add_u32 m0, s40, 6144
s_add_u32 s43, s38, 294912
buffer_load_dwordx4 v2, s[12:15], s43 offen lds
s_add_u32 m0, s40, 7168
s_add_u32 s43, s38, 344064
buffer_load_dwordx4 v3, s[12:15], s43 offen lds
s_add_u32 s37, s37, 128
s_add_u32 s38, s38, 393216
s_waitcnt vmcnt(14)
s_barrier
s_add_u32 m0, s39, 43008
s_mov_b64 exec, s[60:61]
buffer_load_dwordx4 v4, s[8:11], s37 offen lds
s_mov_b64 exec, -1
s_add_u32 m0, s39, 46080
s_nop 0
buffer_load_dwordx4 v5, s[8:11], s37 offen lds
s_add_u32 m0, s39, 49152
s_nop 0
buffer_load_dwordx4 v6, s[8:11], s37 offen lds
s_add_u32 m0, s39, 52224
s_nop 0
buffer_load_dwordx4 v7, s[8:11], s37 offen lds
s_add_u32 m0, s39, 55296
s_nop 0
buffer_load_dwordx4 v8, s[8:11], s37 offen lds
s_add_u32 m0, s39, 58368
s_nop 0
buffer_load_dwordx4 v9, s[8:11], s37 offen lds
s_add_u32 m0, s40, 43008
s_add_u32 s43, s38, 0
buffer_load_dwordx4 v2, s[12:15], s43 offen lds
s_add_u32 m0, s40, 44032
s_add_u32 s43, s38, 49152
buffer_load_dwordx4 v3, s[12:15], s43 offen lds
s_add_u32 m0, s40, 45056
s_add_u32 s43, s38, 98304
buffer_load_dwordx4 v2, s[12:15], s43 offen lds
s_add_u32 m0, s40, 46080
s_add_u32 s43, s38, 147456
buffer_load_dwordx4 v3, s[12:15], s43 offen lds
s_add_u32 m0, s40, 47104
s_add_u32 s43, s38, 196608
buffer_load_dwordx4 v2, s[12:15], s43 offen lds
s_add_u32 m0, s40, 48128
s_add_u32 s43, s38, 245760
buffer_load_dwordx4 v3, s[12:15], s43 offen lds
s_add_u32 m0, s40, 49152
s_add_u32 s43, s38, 294912
buffer_load_dwordx4 v2, s[12:15], s43 offen lds
s_add_u32 m0, s40, 50176
s_add_u32 s43, s38, 344064
buffer_load_dwordx4 v3, s[12:15], s43 offen lds
s_add_u32 s37, s37, 128
s_add_u32 s38, s38, 393216
v_lshlrev_b32 v124, 16, v96
v_and_b32 v125, 0xffff0000, v96
v_mov_b32 v116, v124
v_mov_b32 v117, v125
v_mul_f32 v118, v124, v124
v_mul_f32 v119, v125, v125
v_lshlrev_b32 v126, 16, v97
v_and_b32 v127, 0xffff0000, v97
v_add_f32 v116, v116, v126
v_add_f32 v117, v117, v127
v_fmac_f32 v118, v126, v126
v_fmac_f32 v119, v127, v127
v_lshlrev_b32 v124, 16, v98
v_and_b32 v125, 0xffff0000, v98
v_add_f32 v116, v116, v124
v_add_f32 v117, v117, v125
v_fmac_f32 v118, v124, v124
v_fmac_f32 v119, v125, v125
v_lshlrev_b32 v126, 16, v99
v_and_b32 v127, 0xffff0000, v99
v_add_f32 v116, v116, v126
v_add_f32 v117, v117, v127
v_fmac_f32 v118, v126, v126
v_fmac_f32 v119, v127, v127
v_lshlrev_b32 v124, 16, v100
v_and_b32 v125, 0xffff0000, v100
v_add_f32 v116, v116, v124
v_add_f32 v117, v117, v125
v_fmac_f32 v118, v124, v124
v_fmac_f32 v119, v125, v125
v_lshlrev_b32 v126, 16, v101
v_and_b32 v127, 0xffff0000, v101
v_add_f32 v116, v116, v126
v_add_f32 v117, v117, v127
v_fmac_f32 v118, v126, v126
v_fmac_f32 v119, v127, v127
v_lshlrev_b32 v124, 16, v102
v_and_b32 v125, 0xffff0000, v102
v_add_f32 v116, v116, v124
v_add_f32 v117, v117, v125
v_fmac_f32 v118, v124, v124
v_fmac_f32 v119, v125, v125
v_lshlrev_b32 v126, 16, v103
v_and_b32 v127, 0xffff0000, v103
v_add_f32 v116, v116, v126
v_add_f32 v117, v117, v127
v_fmac_f32 v118, v126, v126
v_fmac_f32 v119, v127, v127
v_lshlrev_b32 v124, 16, v104
v_and_b32 v125, 0xffff0000, v104
v_mov_b32 v120, v124
v_mov_b32 v121, v125
v_mul_f32 v122, v124, v124
v_mul_f32 v123, v125, v125
v_lshlrev_b32 v126, 16, v105
v_and_b32 v127, 0xffff0000, v105
v_add_f32 v120, v120, v126
v_add_f32 v121, v121, v127
v_fmac_f32 v122, v126, v126
v_fmac_f32 v123, v127, v127
v_lshlrev_b32 v124, 16, v106
v_and_b32 v125, 0xffff0000, v106
v_add_f32 v120, v120, v124
v_add_f32 v121, v121, v125
v_fmac_f32 v122, v124, v124
v_fmac_f32 v123, v125, v125
v_lshlrev_b32 v126, 16, v107
v_and_b32 v127, 0xffff0000, v107
v_add_f32 v120, v120, v126
v_add_f32 v121, v121, v127
v_fmac_f32 v122, v126, v126
v_fmac_f32 v123, v127, v127
v_lshlrev_b32 v124, 16, v108
v_and_b32 v125, 0xffff0000, v108
v_add_f32 v120, v120, v124
v_add_f32 v121, v121, v125
v_fmac_f32 v122, v124, v124
v_fmac_f32 v123, v125, v125
v_lshlrev_b32 v126, 16, v109
v_and_b32 v127, 0xffff0000, v109
v_add_f32 v120, v120, v126
v_add_f32 v121, v121, v127
v_fmac_f32 v122, v126, v126
v_fmac_f32 v123, v127, v127
v_lshlrev_b32 v124, 16, v110
v_and_b32 v125, 0xffff0000, v110
v_add_f32 v120, v120, v124
v_add_f32 v121, v121, v125
v_fmac_f32 v122, v124, v124
v_fmac_f32 v123, v125, v125
v_lshlrev_b32 v126, 16, v111
v_and_b32 v127, 0xffff0000, v111
v_add_f32 v120, v120, v126
v_add_f32 v121, v121, v127
v_fmac_f32 v122, v126, v126
v_fmac_f32 v123, v127, v127
v_add_f32 v116, v116, v117
v_add_f32 v118, v118, v119
v_add_f32 v120, v120, v121
v_add_f32 v122, v122, v123
s_nop 0
v_add_f32_dpp v116, v116, v116 row_ror:8 row_mask:0xf bank_mask:0xf
v_add_f32_dpp v118, v118, v118 row_ror:8 row_mask:0xf bank_mask:0xf
v_add_f32_dpp v120, v120, v120 row_ror:8 row_mask:0xf bank_mask:0xf
v_add_f32_dpp v122, v122, v122 row_ror:8 row_mask:0xf bank_mask:0xf
v_add_f32_dpp v116, v116, v116 row_ror:4 row_mask:0xf bank_mask:0xf
v_add_f32_dpp v118, v118, v118 row_ror:4 row_mask:0xf bank_mask:0xf
v_add_f32_dpp v120, v120, v120 row_ror:4 row_mask:0xf bank_mask:0xf
v_add_f32_dpp v122, v122, v122 row_ror:4 row_mask:0xf bank_mask:0xf
v_add_f32_dpp v116, v116, v116 row_ror:2 row_mask:0xf bank_mask:0xf
v_add_f32_dpp v118, v118, v118 row_ror:2 row_mask:0xf bank_mask:0xf
v_add_f32_dpp v120, v120, v120 row_ror:2 row_mask:0xf bank_mask:0xf
v_add_f32_dpp v122, v122, v122 row_ror:2 row_mask:0xf bank_mask:0xf
v_add_f32_dpp v116, v116, v116 row_ror:1 row_mask:0xf bank_mask:0xf
v_add_f32_dpp v118, v118, v118 row_ror:1 row_mask:0xf bank_mask:0xf
v_add_f32_dpp v120, v120, v120 row_ror:1 row_mask:0xf bank_mask:0xf
v_add_f32_dpp v122, v122, v122 row_ror:1 row_mask:0xf bank_mask:0xf
v_mov_b32 v117, v116
v_mov_b32 v119, v118
v_mov_b32 v121, v120
v_mov_b32 v123, v122
s_nop 0
v_permlane16_swap_b32 v116, v117
v_permlane16_swap_b32 v118, v119
v_permlane16_swap_b32 v120, v121
v_permlane16_swap_b32 v122, v123
v_add_f32 v116, v116, v117
v_add_f32 v118, v118, v119
v_add_f32 v120, v120, v121
v_add_f32 v122, v122, v123
v_mov_b32 v117, v116
v_mov_b32 v119, v118
v_mov_b32 v121, v120
v_mov_b32 v123, v122
s_nop 0
v_permlane32_swap_b32 v116, v117
v_permlane32_swap_b32 v118, v119
v_permlane32_swap_b32 v120, v121
v_permlane32_swap_b32 v122, v123
v_add_f32 v116, v116, v117
v_add_f32 v118, v118, v119
v_add_f32 v120, v120, v121
v_add_f32 v122, v122, v123
v_mul_f32 v112, 0x3a800000, v116
v_mul_f32 v113, 0x3a800000, v118
v_fma_f32 v113, -v112, v112, v113
v_max_f32 v113, 0, v113
v_add_f32 v113, 0x3727c5ac, v113
v_rsq_f32 v113, v113
v_mul_f32 v114, 0x3a800000, v120
v_mul_f32 v115, 0x3a800000, v122
v_fma_f32 v115, -v114, v114, v115
v_max_f32 v115, 0, v115
v_add_f32 v115, 0x3727c5ac, v115
v_rsq_f32 v115, v115
s_nop 0
s_lshl_b32 s43, s47, 4
s_add_u32 s43, s43, 130176
v_mov_b32 v11, s43
ds_write_b128 v11, v[112:115]
s_waitcnt lgkmcnt(0)
s_waitcnt vmcnt(14)
s_barrier
s_add_u32 m0, s39, 86016
s_mov_b64 exec, s[60:61]
buffer_load_dwordx4 v4, s[8:11], s37 offen lds
s_mov_b64 exec, -1
s_add_u32 m0, s39, 89088
s_nop 0
buffer_load_dwordx4 v5, s[8:11], s37 offen lds
s_add_u32 m0, s39, 92160
s_nop 0
buffer_load_dwordx4 v6, s[8:11], s37 offen lds
s_add_u32 m0, s39, 95232
s_nop 0
buffer_load_dwordx4 v7, s[8:11], s37 offen lds
s_add_u32 m0, s39, 98304
s_nop 0
buffer_load_dwordx4 v8, s[8:11], s37 offen lds
s_add_u32 m0, s39, 101376
s_nop 0
buffer_load_dwordx4 v9, s[8:11], s37 offen lds
s_add_u32 m0, s40, 86016
s_add_u32 s43, s38, 0
buffer_load_dwordx4 v2, s[12:15], s43 offen lds
s_add_u32 m0, s40, 87040
s_add_u32 s43, s38, 49152
buffer_load_dwordx4 v3, s[12:15], s43 offen lds
s_add_u32 m0, s40, 88064
s_add_u32 s43, s38, 98304
buffer_load_dwordx4 v2, s[12:15], s43 offen lds
s_add_u32 m0, s40, 89088
s_add_u32 s43, s38, 147456
buffer_load_dwordx4 v3, s[12:15], s43 offen lds
s_add_u32 m0, s40, 90112
s_add_u32 s43, s38, 196608
buffer_load_dwordx4 v2, s[12:15], s43 offen lds
s_add_u32 m0, s40, 91136
s_add_u32 s43, s38, 245760
buffer_load_dwordx4 v3, s[12:15], s43 offen lds
s_add_u32 m0, s40, 92160
s_add_u32 s43, s38, 294912
buffer_load_dwordx4 v2, s[12:15], s43 offen lds
s_add_u32 m0, s40, 93184
s_add_u32 s43, s38, 344064
buffer_load_dwordx4 v3, s[12:15], s43 offen lds
s_add_u32 s37, s37, 128
s_add_u32 s38, s38, 393216
s_waitcnt vmcnt(14)
s_barrier
s_mov_b32 s41, 3
Lpl_6:
s_add_u32 m0, s39, 0
s_mov_b64 exec, s[60:61]
buffer_load_dwordx4 v4, s[8:11], s37 offen lds
s_mov_b64 exec, -1
s_add_u32 m0, s39, 3072
s_nop 0
buffer_load_dwordx4 v5, s[8:11], s37 offen lds
s_add_u32 m0, s39, 6144
s_nop 0
buffer_load_dwordx4 v6, s[8:11], s37 offen lds
s_add_u32 m0, s39, 9216
s_nop 0
buffer_load_dwordx4 v7, s[8:11], s37 offen lds
s_add_u32 m0, s39, 12288
s_nop 0
buffer_load_dwordx4 v8, s[8:11], s37 offen lds
s_add_u32 m0, s39, 15360
s_nop 0
buffer_load_dwordx4 v9, s[8:11], s37 offen lds
s_add_u32 m0, s40, 0
s_add_u32 s43, s38, 0
buffer_load_dwordx4 v2, s[12:15], s43 offen lds
s_add_u32 m0, s40, 1024
s_add_u32 s43, s38, 49152
buffer_load_dwordx4 v3, s[12:15], s43 offen lds
s_add_u32 m0, s40, 2048
s_add_u32 s43, s38, 98304
buffer_load_dwordx4 v2, s[12:15], s43 offen lds
s_add_u32 m0, s40, 3072
s_add_u32 s43, s38, 147456
buffer_load_dwordx4 v3, s[12:15], s43 offen lds
s_add_u32 m0, s40, 4096
s_add_u32 s43, s38, 196608
buffer_load_dwordx4 v2, s[12:15], s43 offen lds
s_add_u32 m0, s40, 5120
s_add_u32 s43, s38, 245760
buffer_load_dwordx4 v3, s[12:15], s43 offen lds
s_add_u32 m0, s40, 6144
s_add_u32 s43, s38, 294912
buffer_load_dwordx4 v2, s[12:15], s43 offen lds
s_add_u32 m0, s40, 7168
s_add_u32 s43, s38, 344064
buffer_load_dwordx4 v3, s[12:15], s43 offen lds
s_add_u32 s37, s37, 128
s_add_u32 s38, s38, 393216
s_waitcnt vmcnt(14)
s_barrier
s_add_u32 m0, s39, 43008
s_mov_b64 exec, s[60:61]
buffer_load_dwordx4 v4, s[8:11], s37 offen lds
s_mov_b64 exec, -1
s_add_u32 m0, s39, 46080
s_nop 0
buffer_load_dwordx4 v5, s[8:11], s37 offen lds
s_add_u32 m0, s39, 49152
s_nop 0
buffer_load_dwordx4 v6, s[8:11], s37 offen lds
s_add_u32 m0, s39, 52224
s_nop 0
buffer_load_dwordx4 v7, s[8:11], s37 offen lds
s_add_u32 m0, s39, 55296
s_nop 0
buffer_load_dwordx4 v8, s[8:11], s37 offen lds
s_add_u32 m0, s39, 58368
s_nop 0
buffer_load_dwordx4 v9, s[8:11], s37 offen lds
s_add_u32 m0, s40, 43008
s_add_u32 s43, s38, 0
buffer_load_dwordx4 v2, s[12:15], s43 offen lds
s_add_u32 m0, s40, 44032
s_add_u32 s43, s38, 49152
buffer_load_dwordx4 v3, s[12:15], s43 offen lds
s_add_u32 m0, s40, 45056
s_add_u32 s43, s38, 98304
buffer_load_dwordx4 v2, s[12:15], s43 offen lds
s_add_u32 m0, s40, 46080
s_add_u32 s43, s38, 147456
buffer_load_dwordx4 v3, s[12:15], s43 offen lds
s_add_u32 m0, s40, 47104
s_add_u32 s43, s38, 196608
buffer_load_dwordx4 v2, s[12:15], s43 offen lds
s_add_u32 m0, s40, 48128
s_add_u32 s43, s38, 245760
buffer_load_dwordx4 v3, s[12:15], s43 offen lds
s_add_u32 m0, s40, 49152
s_add_u32 s43, s38, 294912
buffer_load_dwordx4 v2, s[12:15], s43 offen lds
s_add_u32 m0, s40, 50176
s_add_u32 s43, s38, 344064
buffer_load_dwordx4 v3, s[12:15], s43 offen lds
s_add_u32 s37, s37, 128
s_add_u32 s38, s38, 393216
s_waitcnt vmcnt(14)
s_barrier
s_add_u32 m0, s39, 86016
s_mov_b64 exec, s[60:61]
buffer_load_dwordx4 v4, s[8:11], s37 offen lds
s_mov_b64 exec, -1
s_add_u32 m0, s39, 89088
s_nop 0
buffer_load_dwordx4 v5, s[8:11], s37 offen lds
s_add_u32 m0, s39, 92160
s_nop 0
buffer_load_dwordx4 v6, s[8:11], s37 offen lds
s_add_u32 m0, s39, 95232
s_nop 0
buffer_load_dwordx4 v7, s[8:11], s37 offen lds
s_add_u32 m0, s39, 98304
s_nop 0
buffer_load_dwordx4 v8, s[8:11], s37 offen lds
s_add_u32 m0, s39, 101376
s_nop 0
buffer_load_dwordx4 v9, s[8:11], s37 offen lds
s_add_u32 m0, s40, 86016
s_add_u32 s43, s38, 0
buffer_load_dwordx4 v2, s[12:15], s43 offen lds
s_add_u32 m0, s40, 87040
s_add_u32 s43, s38, 49152
buffer_load_dwordx4 v3, s[12:15], s43 offen lds
s_add_u32 m0, s40, 88064
s_add_u32 s43, s38, 98304
buffer_load_dwordx4 v2, s[12:15], s43 offen lds
s_add_u32 m0, s40, 89088
s_add_u32 s43, s38, 147456
buffer_load_dwordx4 v3, s[12:15], s43 offen lds
s_add_u32 m0, s40, 90112
s_add_u32 s43, s38, 196608
buffer_load_dwordx4 v2, s[12:15], s43 offen lds
s_add_u32 m0, s40, 91136
s_add_u32 s43, s38, 245760
buffer_load_dwordx4 v3, s[12:15], s43 offen lds
s_add_u32 m0, s40, 92160
s_add_u32 s43, s38, 294912
buffer_load_dwordx4 v2, s[12:15], s43 offen lds
s_add_u32 m0, s40, 93184
s_add_u32 s43, s38, 344064
buffer_load_dwordx4 v3, s[12:15], s43 offen lds
s_add_u32 s37, s37, 128
s_add_u32 s38, s38, 393216
s_waitcnt vmcnt(14)
s_barrier
s_sub_u32 s41, s41, 1
s_cmp_lg_u32 s41, 0
s_cbranch_scc1 Lpl_6
s_add_u32 m0, s39, 0
s_mov_b64 exec, s[60:61]
buffer_load_dwordx4 v4, s[8:11], s37 offen lds
s_mov_b64 exec, -1
s_add_u32 m0, s39, 3072
s_nop 0
buffer_load_dwordx4 v5, s[8:11], s37 offen lds
s_add_u32 m0, s39, 6144
s_nop 0
buffer_load_dwordx4 v6, s[8:11], s37 offen lds
s_add_u32 m0, s39, 9216
s_nop 0
buffer_load_dwordx4 v7, s[8:11], s37 offen lds
s_add_u32 m0, s39, 12288
s_nop 0
buffer_load_dwordx4 v8, s[8:11], s37 offen lds
s_add_u32 m0, s39, 15360
s_nop 0
buffer_load_dwordx4 v9, s[8:11], s37 offen lds
s_add_u32 m0, s40, 0
s_add_u32 s43, s38, 0
buffer_load_dwordx4 v2, s[12:15], s43 offen lds
s_add_u32 m0, s40, 1024
s_add_u32 s43, s38, 49152
buffer_load_dwordx4 v3, s[12:15], s43 offen lds
s_add_u32 m0, s40, 2048
s_add_u32 s43, s38, 98304
buffer_load_dwordx4 v2, s[12:15], s43 offen lds
s_add_u32 m0, s40, 3072
s_add_u32 s43, s38, 147456
buffer_load_dwordx4 v3, s[12:15], s43 offen lds
s_add_u32 m0, s40, 4096
s_add_u32 s43, s38, 196608
buffer_load_dwordx4 v2, s[12:15], s43 offen lds
s_add_u32 m0, s40, 5120
s_add_u32 s43, s38, 245760
buffer_load_dwordx4 v3, s[12:15], s43 offen lds
s_add_u32 m0, s40, 6144
s_add_u32 s43, s38, 294912
buffer_load_dwordx4 v2, s[12:15], s43 offen lds
s_add_u32 m0, s40, 7168
s_add_u32 s43, s38, 344064
buffer_load_dwordx4 v3, s[12:15], s43 offen lds
s_add_u32 s37, s37, 128
s_add_u32 s38, s38, 393216
s_waitcnt vmcnt(14)
s_barrier
s_waitcnt vmcnt(0)
s_barrier
s_barrier
s_barrier
s_branch Latt_4
Lpf_3:
s_load_dwordx2 s[26:27], s[0:1], 64
s_lshl_b32 s43, s51, 11
buffer_load_dwordx4 v[96:99], v10, s[8:11], s43 offen offset:0
buffer_load_dwordx4 v[100:103], v10, s[8:11], s43 offen offset:1024
buffer_load_dwordx4 v[104:107], v10, s[8:11], s43 offen offset:2048
buffer_load_dwordx4 v[108:111], v10, s[8:11], s43 offen offset:3072
v_min_u32 v14, 23, v1
v_lshrrev_b32 v15, 3, v14
v_mul_u32_u24 v15, 43008, v15
v_and_b32 v14, 7, v14
v_lshl_add_u32 v15, v14, 4, v15
v_mov_b32 v32, 0x3f803f80
v_mov_b32 v33, 0x3f803f80
v_mov_b32 v34, 0x3f803f80
v_mov_b32 v35, 0x3f803f80
ds_write_b128 v15, v[32:35]
v_add_u32 v14, 0, v1
v_min_u32 v14, 47, v14
v_mul_u32_u24 v15, 21846, v14
v_lshrrev_b32 v15, 16, v15
v_mul_u32_u24 v16, 3, v15
v_sub_u32 v16, v14, v16
s_mul_i32 s43, s48, 16
v_add_u32 v15, s43, v15
v_mul_u32_u24 v15, 6144, v15
v_lshl_add_u32 v2, v16, 11, v15
s_waitcnt lgkmcnt(0)
s_mov_b32 s56, s26
s_mov_b32 s57, s27
s_mov_b32 s58, 256
s_mov_b32 s59, 0x20000
v_lshlrev_b32 v14, 7, v1
s_or_b32 s43, s34, s35
s_cmp_lg_u32 s43, 0
s_cbranch_scc1 Lz_7
s_add_u32 s84, s32, 28311552
s_addc_u32 s85, s33, 0
s_mov_b32 s86, 16384
s_mov_b32 s87, 0x20000
v_mov_b32 v5, 0
buffer_store_dword v5, v14, s[84:87], 0 offen sc1
s_movk_i32 s43, 0x2000
buffer_store_dword v5, v14, s[84:87], s43 offen sc1
s_waitcnt vmcnt(0)
Lz_7:
s_mov_b32 s84, s6
s_mov_b32 s85, s7
s_mov_b32 s86, 6291456
s_mov_b32 s87, 0x20000
s_mul_i32 s43, s2, 24576
buffer_load_dword v31, v14, s[84:87], s43 offen
s_add_u32 s43, s43, 8192
buffer_load_dword v31, v14, s[84:87], s43 offen
s_add_u32 s43, s43, 8192
buffer_load_dword v31, v14, s[84:87], s43 offen
s_barrier
s_barrier
s_barrier
s_waitcnt vmcnt(3)
v_lshlrev_b32 v124, 16, v96
v_and_b32 v125, 0xffff0000, v96
v_mov_b32 v116, v124
v_mov_b32 v117, v125
v_mul_f32 v118, v124, v124
v_mul_f32 v119, v125, v125
v_lshlrev_b32 v126, 16, v97
v_and_b32 v127, 0xffff0000, v97
v_add_f32 v116, v116, v126
v_add_f32 v117, v117, v127
v_fmac_f32 v118, v126, v126
v_fmac_f32 v119, v127, v127
v_lshlrev_b32 v124, 16, v98
v_and_b32 v125, 0xffff0000, v98
v_add_f32 v116, v116, v124
v_add_f32 v117, v117, v125
v_fmac_f32 v118, v124, v124
v_fmac_f32 v119, v125, v125
v_lshlrev_b32 v126, 16, v99
v_and_b32 v127, 0xffff0000, v99
v_add_f32 v116, v116, v126
v_add_f32 v117, v117, v127
v_fmac_f32 v118, v126, v126
v_fmac_f32 v119, v127, v127
v_lshlrev_b32 v124, 16, v100
v_and_b32 v125, 0xffff0000, v100
v_add_f32 v116, v116, v124
v_add_f32 v117, v117, v125
v_fmac_f32 v118, v124, v124
v_fmac_f32 v119, v125, v125
v_lshlrev_b32 v126, 16, v101
v_and_b32 v127, 0xffff0000, v101
v_add_f32 v116, v116, v126
v_add_f32 v117, v117, v127
v_fmac_f32 v118, v126, v126
v_fmac_f32 v119, v127, v127
v_lshlrev_b32 v124, 16, v102
v_and_b32 v125, 0xffff0000, v102
v_add_f32 v116, v116, v124
v_add_f32 v117, v117, v125
v_fmac_f32 v118, v124, v124
v_fmac_f32 v119, v125, v125
v_lshlrev_b32 v126, 16, v103
v_and_b32 v127, 0xffff0000, v103
v_add_f32 v116, v116, v126
v_add_f32 v117, v117, v127
v_fmac_f32 v118, v126, v126
v_fmac_f32 v119, v127, v127
v_lshlrev_b32 v124, 16, v104
v_and_b32 v125, 0xffff0000, v104
v_mov_b32 v120, v124
v_mov_b32 v121, v125
v_mul_f32 v122, v124, v124
v_mul_f32 v123, v125, v125
v_lshlrev_b32 v126, 16, v105
v_and_b32 v127, 0xffff0000, v105
v_add_f32 v120, v120, v126
v_add_f32 v121, v121, v127
v_fmac_f32 v122, v126, v126
v_fmac_f32 v123, v127, v127
v_lshlrev_b32 v124, 16, v106
v_and_b32 v125, 0xffff0000, v106
v_add_f32 v120, v120, v124
v_add_f32 v121, v121, v125
v_fmac_f32 v122, v124, v124
v_fmac_f32 v123, v125, v125
v_lshlrev_b32 v126, 16, v107
v_and_b32 v127, 0xffff0000, v107
v_add_f32 v120, v120, v126
v_add_f32 v121, v121, v127
v_fmac_f32 v122, v126, v126
v_fmac_f32 v123, v127, v127
v_lshlrev_b32 v124, 16, v108
v_and_b32 v125, 0xffff0000, v108
v_add_f32 v120, v120, v124
v_add_f32 v121, v121, v125
v_fmac_f32 v122, v124, v124
v_fmac_f32 v123, v125, v125
v_lshlrev_b32 v126, 16, v109
v_and_b32 v127, 0xffff0000, v109
v_add_f32 v120, v120, v126
v_add_f32 v121, v121, v127
v_fmac_f32 v122, v126, v126
v_fmac_f32 v123, v127, v127
v_lshlrev_b32 v124, 16, v110
v_and_b32 v125, 0xffff0000, v110
v_add_f32 v120, v120, v124
v_add_f32 v121, v121, v125
v_fmac_f32 v122, v124, v124
v_fmac_f32 v123, v125, v125
v_lshlrev_b32 v126, 16, v111
v_and_b32 v127, 0xffff0000, v111
v_add_f32 v120, v120, v126
v_add_f32 v121, v121, v127
v_fmac_f32 v122, v126, v126
v_fmac_f32 v123, v127, v127
v_add_f32 v116, v116, v117
v_add_f32 v118, v118, v119
v_add_f32 v120, v120, v121
v_add_f32 v122, v122, v123
s_nop 0
v_add_f32_dpp v116, v116, v116 row_ror:8 row_mask:0xf bank_mask:0xf
v_add_f32_dpp v118, v118, v118 row_ror:8 row_mask:0xf bank_mask:0xf
v_add_f32_dpp v120, v120, v120 row_ror:8 row_mask:0xf bank_mask:0xf
v_add_f32_dpp v122, v122, v122 row_ror:8 row_mask:0xf bank_mask:0xf
v_add_f32_dpp v116, v116, v116 row_ror:4 row_mask:0xf bank_mask:0xf
v_add_f32_dpp v118, v118, v118 row_ror:4 row_mask:0xf bank_mask:0xf
v_add_f32_dpp v120, v120, v120 row_ror:4 row_mask:0xf bank_mask:0xf
v_add_f32_dpp v122, v122, v122 row_ror:4 row_mask:0xf bank_mask:0xf
v_add_f32_dpp v116, v116, v116 row_ror:2 row_mask:0xf bank_mask:0xf
v_add_f32_dpp v118, v118, v118 row_ror:2 row_mask:0xf bank_mask:0xf
v_add_f32_dpp v120, v120, v120 row_ror:2 row_mask:0xf bank_mask:0xf
v_add_f32_dpp v122, v122, v122 row_ror:2 row_mask:0xf bank_mask:0xf
v_add_f32_dpp v116, v116, v116 row_ror:1 row_mask:0xf bank_mask:0xf
v_add_f32_dpp v118, v118, v118 row_ror:1 row_mask:0xf bank_mask:0xf
v_add_f32_dpp v120, v120, v120 row_ror:1 row_mask:0xf bank_mask:0xf
v_add_f32_dpp v122, v122, v122 row_ror:1 row_mask:0xf bank_mask:0xf
v_mov_b32 v117, v116
v_mov_b32 v119, v118
v_mov_b32 v121, v120
v_mov_b32 v123, v122
s_nop 0
v_permlane16_swap_b32 v116, v117
v_permlane16_swap_b32 v118, v119
v_permlane16_swap_b32 v120, v121
v_permlane16_swap_b32 v122, v123
v_add_f32 v116, v116, v117
v_add_f32 v118, v118, v119
v_add_f32 v120, v120, v121
v_add_f32 v122, v122, v123
v_mov_b32 v117, v116
v_mov_b32 v119, v118
v_mov_b32 v121, v120
v_mov_b32 v123, v122
s_nop 0
v_permlane32_swap_b32 v116, v117
v_permlane32_swap_b32 v118, v119
v_permlane32_swap_b32 v120, v121
v_permlane32_swap_b32 v122, v123
v_add_f32 v116, v116, v117
v_add_f32 v118, v118, v119
v_add_f32 v120, v120, v121
v_add_f32 v122, v122, v123
v_mul_f32 v112, 0x3a800000, v116
v_mul_f32 v113, 0x3a800000, v118
v_fma_f32 v113, -v112, v112, v113
v_max_f32 v113, 0, v113
v_add_f32 v113, 0x3727c5ac, v113
v_rsq_f32 v113, v113
v_mul_f32 v114, 0x3a800000, v120
v_mul_f32 v115, 0x3a800000, v122
v_fma_f32 v115, -v114, v114, v115
v_max_f32 v115, 0, v115
v_add_f32 v115, 0x3727c5ac, v115
v_rsq_f32 v115, v115
s_nop 0
s_lshl_b32 s43, s47, 4
s_add_u32 s43, s43, 130176
v_mov_b32 v11, s43
ds_write_b128 v11, v[112:115]
s_waitcnt lgkmcnt(0)
s_barrier
v_lshlrev_b32 v5, 4, v1
v_and_b32 v5, 63, v5
v_add_u32 v6, 130176, v5
ds_read_b128 v[112:115], v6
s_lshl_b32 s43, s63, 3
v_add_u32 v5, s43, v5
s_waitcnt lgkmcnt(0)
s_mov_b64 exec, 15
buffer_store_dwordx4 v[112:115], v5, s[20:23], 0 offen sc1
s_mov_b64 exec, -1
s_barrier
s_barrier
s_barrier
s_barrier
s_waitcnt vmcnt(0)
s_lshl_b32 s43, s34, 4
s_add_u32 s43, s43, s35
v_mov_b32 v5, s43
v_mov_b32 v6, 1
s_mov_b64 exec, 1
buffer_store_byte v6, v5, s[56:59], 0 offen sc1
s_mov_b64 exec, -1
s_barrier
s_barrier
s_barrier
s_lshl_b32 s43, s34, 4
s_sub_u32 s44, s43, 4
s_max_i32 s44, s44, 0
v_lshl_add_u32 v5, v1, 2, s43
v_mov_b32 v6, s44
v_cmp_gt_u32 vcc, 4, v1
s_nop 1
v_cndmask_b32 v5, v6, v5, vcc
v_cmp_eq_u32 vcc, 5, v1
s_nop 1
v_cndmask_b32 v5, v5, 0, vcc
buffer_load_dword v6, v5, s[56:59], 0 offen sc1
s_barrier
s_barrier
s_mov_b32 s41, 200
s_mov_b32 s62, 0
s_waitcnt vmcnt(0)
Lpoll_9:
v_and_b32 v6, 0x01010101, v6
v_cmp_ne_u32 vcc, 0x01010101, v6
s_nop 4
s_cbranch_vccz Lok_10
buffer_load_dword v6, v5, s[56:59], 0 offen sc1
s_waitcnt vmcnt(0)
s_sub_u32 s41, s41, 1
s_cmp_lg_u32 s41, 0
s_cbranch_scc1 Lpoll_9
s_mov_b32 s41, 0
Lfb_11:
s_add_u32 s62, s50, s41
s_max_i32 s62, s62, 0
s_lshl_b32 s43, s62, 11
buffer_load_dwordx4 v[96:99], v10, s[8:11], s43 offen offset:0
buffer_load_dwordx4 v[100:103], v10, s[8:11], s43 offen offset:1024
buffer_load_dwordx4 v[104:107], v10, s[8:11], s43 offen offset:2048
buffer_load_dwordx4 v[108:111], v10, s[8:11], s43 offen offset:3072
s_waitcnt vmcnt(0)
v_lshlrev_b32 v124, 16, v96
v_and_b32 v125, 0xffff0000, v96
v_mov_b32 v116, v124
v_mov_b32 v117, v125
v_mul_f32 v118, v124, v124
v_mul_f32 v119, v125, v125
v_lshlrev_b32 v126, 16, v97
v_and_b32 v127, 0xffff0000, v97
v_add_f32 v116, v116, v126
v_add_f32 v117, v117, v127
v_fmac_f32 v118, v126, v126
v_fmac_f32 v119, v127, v127
v_lshlrev_b32 v124, 16, v98
v_and_b32 v125, 0xffff0000, v98
v_add_f32 v116, v116, v124
v_add_f32 v117, v117, v125
v_fmac_f32 v118, v124, v124
v_fmac_f32 v119, v125, v125
v_lshlrev_b32 v126, 16, v99
v_and_b32 v127, 0xffff0000, v99
v_add_f32 v116, v116, v126
v_add_f32 v117, v117, v127
v_fmac_f32 v118, v126, v126
v_fmac_f32 v119, v127, v127
v_lshlrev_b32 v124, 16, v100
v_and_b32 v125, 0xffff0000, v100
v_add_f32 v116, v116, v124
v_add_f32 v117, v117, v125
v_fmac_f32 v118, v124, v124
v_fmac_f32 v119, v125, v125
v_lshlrev_b32 v126, 16, v101
v_and_b32 v127, 0xffff0000, v101
v_add_f32 v116, v116, v126
v_add_f32 v117, v117, v127
v_fmac_f32 v118, v126, v126
v_fmac_f32 v119, v127, v127
v_lshlrev_b32 v124, 16, v102
v_and_b32 v125, 0xffff0000, v102
v_add_f32 v116, v116, v124
v_add_f32 v117, v117, v125
v_fmac_f32 v118, v124, v124
v_fmac_f32 v119, v125, v125
v_lshlrev_b32 v126, 16, v103
v_and_b32 v127, 0xffff0000, v103
v_add_f32 v116, v116, v126
v_add_f32 v117, v117, v127
v_fmac_f32 v118, v126, v126
v_fmac_f32 v119, v127, v127
v_lshlrev_b32 v124, 16, v104
v_and_b32 v125, 0xffff0000, v104
v_mov_b32 v120, v124
v_mov_b32 v121, v125
v_mul_f32 v122, v124, v124
v_mul_f32 v123, v125, v125
v_lshlrev_b32 v126, 16, v105
v_and_b32 v127, 0xffff0000, v105
v_add_f32 v120, v120, v126
v_add_f32 v121, v121, v127
v_fmac_f32 v122, v126, v126
v_fmac_f32 v123, v127, v127
v_lshlrev_b32 v124, 16, v106
v_and_b32 v125, 0xffff0000, v106
v_add_f32 v120, v120, v124
v_add_f32 v121, v121, v125
v_fmac_f32 v122, v124, v124
v_fmac_f32 v123, v125, v125
v_lshlrev_b32 v126, 16, v107
v_and_b32 v127, 0xffff0000, v107
v_add_f32 v120, v120, v126
v_add_f32 v121, v121, v127
v_fmac_f32 v122, v126, v126
v_fmac_f32 v123, v127, v127
v_lshlrev_b32 v124, 16, v108
v_and_b32 v125, 0xffff0000, v108
v_add_f32 v120, v120, v124
v_add_f32 v121, v121, v125
v_fmac_f32 v122, v124, v124
v_fmac_f32 v123, v125, v125
v_lshlrev_b32 v126, 16, v109
v_and_b32 v127, 0xffff0000, v109
v_add_f32 v120, v120, v126
v_add_f32 v121, v121, v127
v_fmac_f32 v122, v126, v126
v_fmac_f32 v123, v127, v127
v_lshlrev_b32 v124, 16, v110
v_and_b32 v125, 0xffff0000, v110
v_add_f32 v120, v120, v124
v_add_f32 v121, v121, v125
v_fmac_f32 v122, v124, v124
v_fmac_f32 v123, v125, v125
v_lshlrev_b32 v126, 16, v111
v_and_b32 v127, 0xffff0000, v111
v_add_f32 v120, v120, v126
v_add_f32 v121, v121, v127
v_fmac_f32 v122, v126, v126
v_fmac_f32 v123, v127, v127
v_add_f32 v116, v116, v117
v_add_f32 v118, v118, v119
v_add_f32 v120, v120, v121
v_add_f32 v122, v122, v123
s_nop 0
v_add_f32_dpp v116, v116, v116 row_ror:8 row_mask:0xf bank_mask:0xf
v_add_f32_dpp v118, v118, v118 row_ror:8 row_mask:0xf bank_mask:0xf
v_add_f32_dpp v120, v120, v120 row_ror:8 row_mask:0xf bank_mask:0xf
v_add_f32_dpp v122, v122, v122 row_ror:8 row_mask:0xf bank_mask:0xf
v_add_f32_dpp v116, v116, v116 row_ror:4 row_mask:0xf bank_mask:0xf
v_add_f32_dpp v118, v118, v118 row_ror:4 row_mask:0xf bank_mask:0xf
v_add_f32_dpp v120, v120, v120 row_ror:4 row_mask:0xf bank_mask:0xf
v_add_f32_dpp v122, v122, v122 row_ror:4 row_mask:0xf bank_mask:0xf
v_add_f32_dpp v116, v116, v116 row_ror:2 row_mask:0xf bank_mask:0xf
v_add_f32_dpp v118, v118, v118 row_ror:2 row_mask:0xf bank_mask:0xf
v_add_f32_dpp v120, v120, v120 row_ror:2 row_mask:0xf bank_mask:0xf
v_add_f32_dpp v122, v122, v122 row_ror:2 row_mask:0xf bank_mask:0xf
v_add_f32_dpp v116, v116, v116 row_ror:1 row_mask:0xf bank_mask:0xf
v_add_f32_dpp v118, v118, v118 row_ror:1 row_mask:0xf bank_mask:0xf
v_add_f32_dpp v120, v120, v120 row_ror:1 row_mask:0xf bank_mask:0xf
v_add_f32_dpp v122, v122, v122 row_ror:1 row_mask:0xf bank_mask:0xf
v_mov_b32 v117, v116
v_mov_b32 v119, v118
v_mov_b32 v121, v120
v_mov_b32 v123, v122
s_nop 0
v_permlane16_swap_b32 v116, v117
v_permlane16_swap_b32 v118, v119
v_permlane16_swap_b32 v120, v121
v_permlane16_swap_b32 v122, v123
v_add_f32 v116, v116, v117
v_add_f32 v118, v118, v119
v_add_f32 v120, v120, v121
v_add_f32 v122, v122, v123
v_mov_b32 v117, v116
v_mov_b32 v119, v118
v_mov_b32 v121, v120
v_mov_b32 v123, v122
s_nop 0
v_permlane32_swap_b32 v116, v117
v_permlane32_swap_b32 v118, v119
v_permlane32_swap_b32 v120, v121
v_permlane32_swap_b32 v122, v123
v_add_f32 v116, v116, v117
v_add_f32 v118, v118, v119
v_add_f32 v120, v120, v121
v_add_f32 v122, v122, v123
v_mul_f32 v112, 0x3a800000, v116
v_mul_f32 v113, 0x3a800000, v118
v_fma_f32 v113, -v112, v112, v113
v_max_f32 v113, 0, v113
v_add_f32 v113, 0x3727c5ac, v113
v_rsq_f32 v113, v113
v_mul_f32 v114, 0x3a800000, v120
v_mul_f32 v115, 0x3a800000, v122
v_fma_f32 v115, -v114, v114, v115
v_max_f32 v115, 0, v115
v_add_f32 v115, 0x3727c5ac, v115
v_rsq_f32 v115, v115
s_nop 0
s_lshl_b32 s43, s41, 3
s_add_u32 s43, s43, 129024
v_mov_b32 v5, s43
ds_write_b128 v5, v[112:115]
s_add_u32 s41, s41, 2
s_cmp_lt_u32 s41, 144
s_cbranch_scc1 Lfb_11
s_mov_b32 s62, 1
v_mov_b32 v5, 0
s_mov_b32 s41, 0x10000
Lz0_12:
buffer_load_ubyte v6, v5, s[56:59], 0 offen sc1
s_waitcnt vmcnt(0)
v_cmp_eq_u32 vcc, 0, v6
s_nop 4
s_cbranch_vccz Lok_10
s_sub_u32 s41, s41, 1
s_cmp_lg_u32 s41, 0
s_cbranch_scc1 Lz0_12
Lok_10:
v_add_u32 v5, 0, v1
v_min_u32 v5, 143, v5
v_lshlrev_b32 v20, 3, v5
v_add_u32 v5, s50, v5
v_max_i32 v5, 0, v5
v_lshlrev_b32 v5, 3, v5
buffer_load_dwordx2 v[32:33], v5, s[20:23], 0 offen sc1
v_add_u32 v5, 64, v1
v_min_u32 v5, 143, v5
v_lshlrev_b32 v21, 3, v5
v_add_u32 v5, s50, v5
v_max_i32 v5, 0, v5
v_lshlrev_b32 v5, 3, v5
buffer_load_dwordx2 v[34:35], v5, s[20:23], 0 offen sc1
v_add_u32 v5, 128, v1
v_min_u32 v5, 143, v5
v_lshlrev_b32 v22, 3, v5
v_add_u32 v5, s50, v5
v_max_i32 v5, 0, v5
v_lshlrev_b32 v5, 3, v5
buffer_load_dwordx2 v[36:37], v5, s[20:23], 0 offen sc1
s_barrier
s_load_dwordx2 s[88:89], s[0:1], 16
v_lshlrev_b32 v29, 7, v1
s_lshl_b32 s43, s2, 13
s_waitcnt lgkmcnt(0)
s_mov_b32 s84, s88
s_mov_b32 s85, s89
s_mov_b32 s86, 2097152
s_mov_b32 s87, 0x20000
buffer_load_dword v30, v29, s[84:87], s43 offen
s_barrier
s_waitcnt vmcnt(1)
s_cmp_eq_u32 s62, 1
s_cbranch_scc1 Lgd_8
v_add_u32 v20, 129024, v20
ds_write_b64 v20, v[32:33]
v_add_u32 v21, 129024, v21
ds_write_b64 v21, v[34:35]
v_add_u32 v22, 129024, v22
ds_write_b64 v22, v[36:37]
Lgd_8:
s_waitcnt lgkmcnt(0)
s_lshr_b32 s43, s2, 1
s_cmp_ge_u32 s43, 112
s_cbranch_scc1 Lnj_13
s_and_b32 s44, s2, 1
s_lshl_b32 s45, s44, 3
s_add_u32 s45, s45, 32
s_load_dwordx2 s[88:89], s[0:1], s45
s_mul_i32 s45, s43, 2341
s_lshr_b32 s45, s45, 16
s_mul_i32 s46, s45, 28
s_sub_u32 s46, s43, s46
v_lshrrev_b32 v28, 4, v1
s_lshl_b32 s43, s45, 8
v_add_u32 v28, s43, v28
v_mul_u32_u24 v28, 7168, v28
v_and_b32 v29, 15, v1
v_lshl_add_u32 v28, v29, 4, v28
s_lshl_b32 s43, s46, 8
v_add_u32 v28, s43, v28
s_waitcnt lgkmcnt(0)
s_mov_b32 s84, s88
s_mov_b32 s85, s89
s_mov_b32 s86, 7340032
s_mov_b32 s87, 0x20000
s_mov_b32 s43, 0
buffer_load_dwordx4 v[128:131], v28, s[84:87], s43 offen
s_mov_b32 s43, 28672
buffer_load_dwordx4 v[132:135], v28, s[84:87], s43 offen
s_mov_b32 s43, 57344
buffer_load_dwordx4 v[136:139], v28, s[84:87], s43 offen
s_mov_b32 s43, 86016
buffer_load_dwordx4 v[140:143], v28, s[84:87], s43 offen
s_mov_b32 s43, 114688
buffer_load_dwordx4 v[144:147], v28, s[84:87], s43 offen
s_mov_b32 s43, 143360
buffer_load_dwordx4 v[148:151], v28, s[84:87], s43 offen
s_mov_b32 s43, 172032
buffer_load_dwordx4 v[152:155], v28, s[84:87], s43 offen
s_mov_b32 s43, 200704
buffer_load_dwordx4 v[156:159], v28, s[84:87], s43 offen
s_mov_b32 s43, 229376
buffer_load_dwordx4 v[160:163], v28, s[84:87], s43 offen
s_mov_b32 s43, 258048
buffer_load_dwordx4 v[164:167], v28, s[84:87], s43 offen
s_mov_b32 s43, 286720
buffer_load_dwordx4 v[168:171], v28, s[84:87], s43 offen
s_mov_b32 s43, 315392
buffer_load_dwordx4 v[172:175], v28, s[84:87], s43 offen
s_mov_b32 s43, 344064
buffer_load_dwordx4 v[176:179], v28, s[84:87], s43 offen
s_mov_b32 s43, 372736
buffer_load_dwordx4 v[180:183], v28, s[84:87], s43 offen
s_mov_b32 s43, 401408
buffer_load_dwordx4 v[184:187], v28, s[84:87], s43 offen
s_mov_b32 s43, 430080
buffer_load_dwordx4 v[188:191], v28, s[84:87], s43 offen
Lnj_13:
s_barrier
s_lshr_b32 s43, s2, 1
s_cmp_ge_u32 s43, 112
s_cbranch_scc1 Lnj_14
s_and_b32 s44, s2, 1
s_lshl_b32 s45, s44, 3
s_add_u32 s45, s45, 32
s_load_dwordx2 s[88:89], s[0:1], s45
s_mul_i32 s45, s43, 2341
s_lshr_b32 s45, s45, 16
s_mul_i32 s46, s45, 28
s_sub_u32 s46, s43, s46
v_lshrrev_b32 v28, 4, v1
s_lshl_b32 s43, s45, 8
v_add_u32 v28, s43, v28
v_mul_u32_u24 v28, 7168, v28
v_and_b32 v29, 15, v1
v_lshl_add_u32 v28, v29, 4, v28
s_lshl_b32 s43, s46, 8
v_add_u32 v28, s43, v28
s_waitcnt lgkmcnt(0)
s_mov_b32 s84, s88
s_mov_b32 s85, s89
s_mov_b32 s86, 7340032
s_mov_b32 s87, 0x20000
s_mov_b32 s43, 458752
buffer_load_dwordx4 v[192:195], v28, s[84:87], s43 offen
s_mov_b32 s43, 487424
buffer_load_dwordx4 v[196:199], v28, s[84:87], s43 offen
s_mov_b32 s43, 516096
buffer_load_dwordx4 v[200:203], v28, s[84:87], s43 offen
s_mov_b32 s43, 544768
buffer_load_dwordx4 v[204:207], v28, s[84:87], s43 offen
s_mov_b32 s43, 573440
buffer_load_dwordx4 v[208:211], v28, s[84:87], s43 offen
s_mov_b32 s43, 602112
buffer_load_dwordx4 v[212:215], v28, s[84:87], s43 offen
s_mov_b32 s43, 630784
buffer_load_dwordx4 v[216:219], v28, s[84:87], s43 offen
s_mov_b32 s43, 659456
buffer_load_dwordx4 v[220:223], v28, s[84:87], s43 offen
s_mov_b32 s43, 688128
buffer_load_dwordx4 v[224:227], v28, s[84:87], s43 offen
s_mov_b32 s43, 716800
buffer_load_dwordx4 v[228:231], v28, s[84:87], s43 offen
s_mov_b32 s43, 745472
buffer_load_dwordx4 v[232:235], v28, s[84:87], s43 offen
s_mov_b32 s43, 774144
buffer_load_dwordx4 v[236:239], v28, s[84:87], s43 offen
s_mov_b32 s43, 802816
buffer_load_dwordx4 v[240:243], v28, s[84:87], s43 offen
s_mov_b32 s43, 831488
buffer_load_dwordx4 v[244:247], v28, s[84:87], s43 offen
s_mov_b32 s43, 860160
buffer_load_dwordx4 v[248:251], v28, s[84:87], s43 offen
s_mov_b32 s43, 888832
buffer_load_dwordx4 v[252:255], v28, s[84:87], s43 offen
Lnj_14:
s_barrier
s_barrier
Latt_4:
s_barrier
s_and_b32 s43, s36, 1
s_lshr_b32 s44, s36, 1
s_and_b32 s44, s44, 1
s_lshr_b32 s45, s36, 2
v_lshlrev_b32 v14, 2, v13
v_sub_u32 v14, v12, v14
v_subrev_u32 v15, 0, v14
v_cmp_ge_u32 s[52:53], 7, v15
v_add_u32 v15, 16, v15
v_cmp_ge_u32 s[84:85], 7, v15
v_subrev_u32 v15, 1, v14
v_cmp_ge_u32 s[54:55], 7, v15
v_add_u32 v15, 16, v15
v_cmp_ge_u32 s[86:87], 7, v15
v_subrev_u32 v15, 2, v14
v_cmp_ge_u32 s[56:57], 7, v15
v_add_u32 v15, 16, v15
v_cmp_ge_u32 s[88:89], 7, v15
v_subrev_u32 v15, 3, v14
v_cmp_ge_u32 s[58:59], 7, v15
v_add_u32 v15, 16, v15
v_cmp_ge_u32 s[90:91], 7, v15
s_lshl_b32 s46, s45, 6
s_add_u32 s46, s46, s44
s_add_u32 s46, s46, 16
v_lshl_add_u32 v14, v12, 1, s46
s_lshl_b32 s47, s43, 6
v_lshl_add_u32 v15, v13, 4, s47
v_mul_u32_u24 v2, 400, v14
v_add_u32 v2, v2, v15
v_subrev_u32 v16, 32, v14
v_max_i32 v16, 0, v16
v_mul_u32_u24 v3, 400, v16
v_add_u32 v3, v3, v15
v_lshrrev_b32 v16, 2, v12
v_lshl_add_u32 v16, v13, 2, v16
v_lshl_add_u32 v16, v16, 1, s46
v_and_b32 v17, 3, v1
v_lshl_add_u32 v17, v17, 3, s47
v_mul_u32_u24 v4, 400, v16
v_add_u32 v4, v4, v17
v_subrev_u32 v16, 32, v16
v_max_i32 v16, 0, v16
v_mul_u32_u24 v5, 400, v16
v_add_u32 v5, v5, v17
s_lshl_b32 s60, s43, 13
s_lshl_b32 s61, s45, 10
s_add_u32 s60, s60, s61
s_lshl_b32 s61, s44, 8
s_add_u32 s60, s60, s61
v_lshlrev_b32 v6, 11, v13
v_lshl_add_u32 v6, v12, 4, v6
v_add_u32 v6, s60, v6
v_mov_b32 v8, 0xff800000
s_mov_b32 s61, 0x3e8293ee
s_or_b32 s62, s34, s45
ds_read_b128 v[32:35], v2 offset:0
ds_read_b128 v[36:39], v2 offset:128
ds_read_b128 v[40:43], v3 offset:128
ds_read_b64_tr_b16 v[44:45], v5 offset:256
ds_read_b64_tr_b16 v[46:47], v4 offset:256
ds_read_b64_tr_b16 v[48:49], v5 offset:288
ds_read_b64_tr_b16 v[50:51], v4 offset:288
ds_read_b128 v[80:83], v2 offset:12800
ds_read_b128 v[84:87], v2 offset:12928
ds_read_b128 v[88:91], v2 offset:128
ds_read_b64_tr_b16 v[92:93], v4 offset:256
ds_read_b64_tr_b16 v[94:95], v4 offset:13056
ds_read_b64_tr_b16 v[96:97], v4 offset:288
ds_read_b64_tr_b16 v[98:99], v4 offset:13088
s_waitcnt lgkmcnt(11)
v_mfma_f32_16x16x32_bf16 v[52:55], v[40:43], v[32:35], 0
v_mfma_f32_16x16x32_bf16 v[56:59], v[36:39], v[32:35], 0
s_waitcnt lgkmcnt(4)
v_mfma_f32_16x16x32_bf16 v[100:103], v[88:91], v[80:83], 0
v_mfma_f32_16x16x32_bf16 v[104:107], v[84:87], v[80:83], 0
s_nop 4
s_cmp_lg_u32 s62, 0
s_cselect_b64 s[92:93], s[84:85], 0
v_cndmask_b32 v52, v8, v52, s[92:93]
s_cselect_b64 s[92:93], s[86:87], 0
v_cndmask_b32 v53, v8, v53, s[92:93]
s_cselect_b64 s[92:93], s[88:89], 0
v_cndmask_b32 v54, v8, v54, s[92:93]
s_cselect_b64 s[92:93], s[90:91], 0
v_cndmask_b32 v55, v8, v55, s[92:93]
v_cndmask_b32 v56, v8, v56, s[52:53]
v_cndmask_b32 v57, v8, v57, s[54:55]
v_cndmask_b32 v58, v8, v58, s[56:57]
v_cndmask_b32 v59, v8, v59, s[58:59]
v_max3_f32 v60, v52, v53, v54
v_max3_f32 v60, v60, v55, v56
v_max3_f32 v60, v60, v57, v58
v_max_f32 v60, v60, v59
v_mov_b32 v61, v60
s_nop 1
v_permlane32_swap_b32 v60, v61
v_max_f32 v60, v60, v61
v_mov_b32 v61, v60
s_nop 1
v_permlane16_swap_b32 v60, v61
v_max_f32 v60, v60, v61
v_mul_f32 v60, s61, v60
v_fma_f32 v52, v52, s61, -v60
v_fma_f32 v53, v53, s61, -v60
v_fma_f32 v54, v54, s61, -v60
v_fma_f32 v55, v55, s61, -v60
v_fma_f32 v56, v56, s61, -v60
v_fma_f32 v57, v57, s61, -v60
v_fma_f32 v58, v58, s61, -v60
v_fma_f32 v59, v59, s61, -v60
v_exp_f32 v52, v52
v_exp_f32 v53, v53
v_exp_f32 v54, v54
v_exp_f32 v55, v55
v_exp_f32 v56, v56
v_exp_f32 v57, v57
v_exp_f32 v58, v58
v_exp_f32 v59, v59
s_nop 0
v_add_f32 v60, v52, v53
v_add_f32 v60, v60, v54
v_add_f32 v60, v60, v55
v_add_f32 v60, v60, v56
v_add_f32 v60, v60, v57
v_add_f32 v60, v60, v58
v_add_f32 v60, v60, v59
v_cvt_pk_bf16_f32 v64, v52, v53
v_cvt_pk_bf16_f32 v65, v54, v55
v_cvt_pk_bf16_f32 v66, v56, v57
v_cvt_pk_bf16_f32 v67, v58, v59
v_mov_b32 v61, v60
s_nop 1
v_permlane32_swap_b32 v60, v61
v_add_f32 v60, v60, v61
v_mov_b32 v61, v60
s_nop 1
v_permlane16_swap_b32 v60, v61
v_add_f32 v60, v60, v61
v_rcp_f32 v60, v60
s_waitcnt lgkmcnt(0)
v_mfma_f32_16x16x32_bf16 v[68:71], v[44:47], v[64:67], 0
v_mfma_f32_16x16x32_bf16 v[72:75], v[48:51], v[64:67], 0
v_cndmask_b32 v100, v8, v100, s[84:85]
v_cndmask_b32 v101, v8, v101, s[86:87]
v_cndmask_b32 v102, v8, v102, s[88:89]
v_cndmask_b32 v103, v8, v103, s[90:91]
v_cndmask_b32 v104, v8, v104, s[52:53]
v_cndmask_b32 v105, v8, v105, s[54:55]
v_cndmask_b32 v106, v8, v106, s[56:57]
v_cndmask_b32 v107, v8, v107, s[58:59]
v_max3_f32 v108, v100, v101, v102
v_max3_f32 v108, v108, v103, v104
v_max3_f32 v108, v108, v105, v106
v_max_f32 v108, v108, v107
v_mov_b32 v109, v108
s_nop 1
v_permlane32_swap_b32 v108, v109
v_max_f32 v108, v108, v109
v_mov_b32 v109, v108
s_nop 1
v_permlane16_swap_b32 v108, v109
v_max_f32 v108, v108, v109
v_mul_f32 v108, s61, v108
v_fma_f32 v100, v100, s61, -v108
v_fma_f32 v101, v101, s61, -v108
v_fma_f32 v102, v102, s61, -v108
v_fma_f32 v103, v103, s61, -v108
v_fma_f32 v104, v104, s61, -v108
v_fma_f32 v105, v105, s61, -v108
v_fma_f32 v106, v106, s61, -v108
v_fma_f32 v107, v107, s61, -v108
v_exp_f32 v100, v100
v_exp_f32 v101, v101
v_exp_f32 v102, v102
v_exp_f32 v103, v103
v_exp_f32 v104, v104
v_exp_f32 v105, v105
v_exp_f32 v106, v106
v_exp_f32 v107, v107
s_nop 0
v_add_f32 v108, v100, v101
v_add_f32 v108, v108, v102
v_add_f32 v108, v108, v103
v_add_f32 v108, v108, v104
v_add_f32 v108, v108, v105
v_add_f32 v108, v108, v106
v_add_f32 v108, v108, v107
v_cvt_pk_bf16_f32 v112, v100, v101
v_cvt_pk_bf16_f32 v113, v102, v103
v_cvt_pk_bf16_f32 v114, v104, v105
v_cvt_pk_bf16_f32 v115, v106, v107
v_mov_b32 v109, v108
s_nop 1
v_permlane32_swap_b32 v108, v109
v_add_f32 v108, v108, v109
v_mov_b32 v109, v108
s_nop 1
v_permlane16_swap_b32 v108, v109
v_add_f32 v108, v108, v109
v_rcp_f32 v108, v108
s_waitcnt lgkmcnt(0)
v_mfma_f32_16x16x32_bf16 v[116:119], v[92:95], v[112:115], 0
v_mfma_f32_16x16x32_bf16 v[120:123], v[96:99], v[112:115], 0
s_nop 4
v_mul_f32 v68, v60, v68
v_mul_f32 v69, v60, v69
v_mul_f32 v70, v60, v70
v_mul_f32 v71, v60, v71
v_mul_f32 v72, v60, v72
v_mul_f32 v73, v60, v73
v_mul_f32 v74, v60, v74
v_mul_f32 v75, v60, v75
v_cvt_pk_bf16_f32 v68, v68, v69
v_cvt_pk_bf16_f32 v69, v70, v71
v_cvt_pk_bf16_f32 v70, v72, v73
v_cvt_pk_bf16_f32 v71, v74, v75
buffer_store_dwordx4 v[68:71], v6, s[16:19], 0 offen offset:0 sc1
v_mul_f32 v116, v108, v116
v_mul_f32 v117, v108, v117
v_mul_f32 v118, v108, v118
v_mul_f32 v119, v108, v119
v_mul_f32 v120, v108, v120
v_mul_f32 v121, v108, v121
v_mul_f32 v122, v108, v122
v_mul_f32 v123, v108, v123
v_cvt_pk_bf16_f32 v116, v116, v117
v_cvt_pk_bf16_f32 v117, v118, v119
v_cvt_pk_bf16_f32 v118, v120, v121
v_cvt_pk_bf16_f32 v119, v122, v123
buffer_store_dwordx4 v[116:119], v6, s[16:19], 0 offen offset:512 sc1
s_waitcnt vmcnt(0)
s_barrier
s_add_u32 s56, s32, 28311552
s_addc_u32 s57, s33, 0
s_mov_b32 s58, 16384
s_mov_b32 s59, 0x20000
s_cmp_lg_u32 s36, 0
s_cbranch_scc1 Lsig_15
s_add_u32 s43, s34, 0
s_lshl_b32 s43, s43, 7
v_mov_b32 v5, s43
v_mov_b32 v6, 1
s_mov_b64 exec, 1
buffer_atomic_add v6, v5, s[56:59], 0 offen sc1
s_mov_b64 exec, -1
Lsig_15:
s_load_dwordx4 s[4:7], s[0:1], 32
s_load_dwordx2 s[28:29], s[0:1], 16
s_load_dwordx4 s[60:63], s[0:1], 48
s_load_dwordx2 s[30:31], s[0:1], 0
v_and_b32 v17, 15, v1
v_lshrrev_b32 v18, 4, v1
s_lshr_b32 s46, s36, 1
s_and_b32 s46, s46, 1
s_and_b32 s47, s36, 1
s_and_b32 s51, s36, 3
s_waitcnt lgkmcnt(0)
s_cmp_ge_u32 s36, 4
s_cbranch_scc1 LG1_16
s_lshl_b32 s43, s34, 18
s_lshl_b32 s44, s35, 7
s_add_u32 s43, s43, s44
s_add_u32 s16, s30, s43
s_addc_u32 s17, s31, 0
s_mov_b32 s18, 260224
s_mov_b32 s19, 0x20000
s_lshl_b32 s43, s36, 5
v_lshl_add_u32 v19, v17, 1, s43
v_lshlrev_b32 v19, 11, v19
v_lshl_add_u32 v23, v18, 3, v19
buffer_load_dwordx2 v[160:161], v23, s[16:19], 0 offen offset:0
buffer_load_dwordx2 v[162:163], v23, s[16:19], 0 offen offset:32
buffer_load_dwordx2 v[164:165], v23, s[16:19], 0 offen offset:64
buffer_load_dwordx2 v[166:167], v23, s[16:19], 0 offen offset:96
buffer_load_dwordx2 v[168:169], v23, s[16:19], 0 offen offset:2048
buffer_load_dwordx2 v[170:171], v23, s[16:19], 0 offen offset:2080
buffer_load_dwordx2 v[172:173], v23, s[16:19], 0 offen offset:2112
buffer_load_dwordx2 v[174:175], v23, s[16:19], 0 offen offset:2144
v_lshlrev_b32 v19, 11, v18
v_lshl_add_u32 v19, v17, 4, v19
s_lshl_b32 s43, s36, 9
v_add_u32 v2, s43, v19
v_add_u32 v3, 49152, v2
v_add_u32 v4, 98304, v2
v_lshrrev_b32 v19, 2, v17
v_lshl_add_u32 v20, v18, 2, v19
v_bfe_u32 v21, v20, 1, 2
v_lshlrev_b32 v20, 7, v20
v_lshl_add_u32 v20, v21, 5, v20
v_and_b32 v19, 3, v1
v_lshl_add_u32 v20, v19, 3, v20
v_add_u32 v5, 16384, v20
v_xor_b32 v6, 32, v5
v_xor_b32 v7, 64, v5
v_xor_b32 v8, 96, v5
v_add_u32 v9, 49152, v5
v_add_u32 v10, 49152, v6
v_add_u32 v11, 49152, v7
v_add_u32 v12, 49152, v8
v_add_u32 v13, 98304, v5
v_add_u32 v14, 98304, v6
v_add_u32 v15, 98304, v7
v_add_u32 v16, 98304, v8
s_lshl_b32 s43, s34, 18
s_lshl_b32 s44, s35, 14
s_add_u32 s43, s43, s44
s_add_u32 s20, s32, s43
s_addc_u32 s21, s33, 0
s_add_u32 s20, s20, 4194304
s_addc_u32 s21, s21, 0
s_mov_b32 s22, 16384
s_mov_b32 s23, 0x20000
s_lshl_b32 s43, s34, 14
s_lshl_b32 s44, s35, 10
s_add_u32 s43, s43, s44
s_add_u32 s24, s32, s43
s_addc_u32 s25, s33, 0
s_add_u32 s24, s24, 25165824
s_addc_u32 s25, s25, 0
s_mov_b32 s26, 1024
s_mov_b32 s27, 0x20000
s_movk_i32 s50, 0x2000
s_mov_b32 s52, 0x3f803f80
v_lshrrev_b32 v19, 1, v18
v_lshl_add_u32 v19, v19, 4, v17
s_lshl_b32 s43, s36, 5
v_add_u32 v19, s43, v19
v_and_b32 v20, 1, v18
v_lshlrev_b32 v20, 2, v20
v_lshl_add_u32 v22, v19, 3, v20
s_waitcnt vmcnt(0)
v_lshlrev_b32 v128, 16, v160
v_and_b32 v129, 0xffff0000, v160
v_lshlrev_b32 v130, 16, v161
v_and_b32 v131, 0xffff0000, v161
v_lshlrev_b32 v132, 16, v162
v_and_b32 v133, 0xffff0000, v162
v_lshlrev_b32 v134, 16, v163
v_and_b32 v135, 0xffff0000, v163
v_lshlrev_b32 v136, 16, v164
v_and_b32 v137, 0xffff0000, v164
v_lshlrev_b32 v138, 16, v165
v_and_b32 v139, 0xffff0000, v165
v_lshlrev_b32 v140, 16, v166
v_and_b32 v141, 0xffff0000, v166
v_lshlrev_b32 v142, 16, v167
v_and_b32 v143, 0xffff0000, v167
v_lshlrev_b32 v144, 16, v168
v_and_b32 v145, 0xffff0000, v168
v_lshlrev_b32 v146, 16, v169
v_and_b32 v147, 0xffff0000, v169
v_lshlrev_b32 v148, 16, v170
v_and_b32 v149, 0xffff0000, v170
v_lshlrev_b32 v150, 16, v171
v_and_b32 v151, 0xffff0000, v171
v_lshlrev_b32 v152, 16, v172
v_and_b32 v153, 0xffff0000, v172
v_lshlrev_b32 v154, 16, v173
v_and_b32 v155, 0xffff0000, v173
v_lshlrev_b32 v156, 16, v174
v_and_b32 v157, 0xffff0000, v174
v_lshlrev_b32 v158, 16, v175
v_and_b32 v159, 0xffff0000, v175
s_lshl_b32 s43, s34, 18
s_add_u32 s12, s32, s43
s_addc_u32 s13, s33, 0
s_mov_b32 s14, 262144
s_mov_b32 s15, 0x20000
v_lshlrev_b32 v21, 4, v1
s_lshl_b32 s54, s36, 11
s_barrier
s_add_u32 m0, s54, 0
s_add_u32 s43, s54, 0
buffer_load_dwordx4 v21, s[12:15], s43 offen sc1 lds
s_add_u32 m0, s54, 1024
s_add_u32 s43, s54, 1024
buffer_load_dwordx4 v21, s[12:15], s43 offen sc1 lds
s_add_u32 m0, s54, 24576
s_add_u32 s43, s54, 16384
buffer_load_dwordx4 v21, s[12:15], s43 offen sc1 lds
s_add_u32 m0, s54, 25600
s_add_u32 s43, s54, 17408
buffer_load_dwordx4 v21, s[12:15], s43 offen sc1 lds
s_waitcnt vmcnt(2)
s_barrier
ds_read_b128 v[32:35], v2 offset:0
ds_read_b64_tr_b16 v[48:49], v5 offset:0
ds_read_b64_tr_b16 v[50:51], v5 offset:2048
ds_read_b64_tr_b16 v[52:53], v6 offset:0
ds_read_b64_tr_b16 v[54:55], v6 offset:2048
ds_read_b128 v[36:39], v2 offset:256
ds_read_b64_tr_b16 v[56:57], v7 offset:0
ds_read_b64_tr_b16 v[58:59], v7 offset:2048
ds_read_b64_tr_b16 v[60:61], v8 offset:0
ds_read_b64_tr_b16 v[62:63], v8 offset:2048
ds_read_b128 v[40:43], v2 offset:8192
ds_read_b64_tr_b16 v[64:65], v5 offset:4096
ds_read_b64_tr_b16 v[66:67], v5 offset:6144
ds_read_b64_tr_b16 v[68:69], v6 offset:4096
ds_read_b64_tr_b16 v[70:71], v6 offset:6144
ds_read_b128 v[44:47], v2 offset:8448
ds_read_b64_tr_b16 v[72:73], v7 offset:4096
ds_read_b64_tr_b16 v[74:75], v7 offset:6144
ds_read_b64_tr_b16 v[76:77], v8 offset:4096
ds_read_b64_tr_b16 v[78:79], v8 offset:6144
s_waitcnt vmcnt(0) lgkmcnt(0)
s_barrier
v_mfma_f32_16x16x32_bf16 v[128:131], v[48:51], v[32:35], v[128:131]
ds_read_b128 v[80:83], v2 offset:24576
ds_read_b64_tr_b16 v[96:97], v5 offset:24576
v_mfma_f32_16x16x32_bf16 v[132:135], v[52:55], v[32:35], v[132:135]
ds_read_b64_tr_b16 v[98:99], v5 offset:26624
ds_read_b64_tr_b16 v[100:101], v6 offset:24576
v_mfma_f32_16x16x32_bf16 v[136:139], v[56:59], v[32:35], v[136:139]
ds_read_b64_tr_b16 v[102:103], v6 offset:26624
ds_read_b128 v[84:87], v2 offset:24832
v_mfma_f32_16x16x32_bf16 v[140:143], v[60:63], v[32:35], v[140:143]
ds_read_b64_tr_b16 v[104:105], v7 offset:24576
ds_read_b64_tr_b16 v[106:107], v7 offset:26624
v_mfma_f32_16x16x32_bf16 v[144:147], v[48:51], v[36:39], v[144:147]
ds_read_b64_tr_b16 v[108:109], v8 offset:24576
ds_read_b64_tr_b16 v[110:111], v8 offset:26624
v_mfma_f32_16x16x32_bf16 v[148:151], v[52:55], v[36:39], v[148:151]
ds_read_b128 v[88:91], v2 offset:32768
ds_read_b64_tr_b16 v[112:113], v5 offset:28672
v_mfma_f32_16x16x32_bf16 v[152:155], v[56:59], v[36:39], v[152:155]
ds_read_b64_tr_b16 v[114:115], v5 offset:30720
v_mfma_f32_16x16x32_bf16 v[156:159], v[60:63], v[36:39], v[156:159]
ds_read_b64_tr_b16 v[116:117], v6 offset:28672
v_mfma_f32_16x16x32_bf16 v[128:131], v[64:67], v[40:43], v[128:131]
ds_read_b64_tr_b16 v[118:119], v6 offset:30720
v_mfma_f32_16x16x32_bf16 v[132:135], v[68:71], v[40:43], v[132:135]
ds_read_b128 v[92:95], v2 offset:33024
v_mfma_f32_16x16x32_bf16 v[136:139], v[72:75], v[40:43], v[136:139]
ds_read_b64_tr_b16 v[120:121], v7 offset:28672
v_mfma_f32_16x16x32_bf16 v[140:143], v[76:79], v[40:43], v[140:143]
ds_read_b64_tr_b16 v[122:123], v7 offset:30720
v_mfma_f32_16x16x32_bf16 v[144:147], v[64:67], v[44:47], v[144:147]
ds_read_b64_tr_b16 v[124:125], v8 offset:28672
v_mfma_f32_16x16x32_bf16 v[148:151], v[68:71], v[44:47], v[148:151]
ds_read_b64_tr_b16 v[126:127], v8 offset:30720
v_mfma_f32_16x16x32_bf16 v[152:155], v[72:75], v[44:47], v[152:155]
v_mfma_f32_16x16x32_bf16 v[156:159], v[76:79], v[44:47], v[156:159]
s_waitcnt lgkmcnt(0)
s_barrier
v_mfma_f32_16x16x32_bf16 v[128:131], v[96:99], v[80:83], v[128:131]
ds_read_b128 v[32:35], v3 offset:0
ds_read_b64_tr_b16 v[48:49], v9 offset:0
v_mfma_f32_16x16x32_bf16 v[132:135], v[100:103], v[80:83], v[132:135]
ds_read_b64_tr_b16 v[50:51], v9 offset:2048
ds_read_b64_tr_b16 v[52:53], v10 offset:0
v_mfma_f32_16x16x32_bf16 v[136:139], v[104:107], v[80:83], v[136:139]
ds_read_b64_tr_b16 v[54:55], v10 offset:2048
ds_read_b128 v[36:39], v3 offset:256
v_mfma_f32_16x16x32_bf16 v[140:143], v[108:111], v[80:83], v[140:143]
ds_read_b64_tr_b16 v[56:57], v11 offset:0
ds_read_b64_tr_b16 v[58:59], v11 offset:2048
v_mfma_f32_16x16x32_bf16 v[144:147], v[96:99], v[84:87], v[144:147]
ds_read_b64_tr_b16 v[60:61], v12 offset:0
ds_read_b64_tr_b16 v[62:63], v12 offset:2048
v_mfma_f32_16x16x32_bf16 v[148:151], v[100:103], v[84:87], v[148:151]
ds_read_b128 v[40:43], v3 offset:8192
ds_read_b64_tr_b16 v[64:65], v9 offset:4096
v_mfma_f32_16x16x32_bf16 v[152:155], v[104:107], v[84:87], v[152:155]
ds_read_b64_tr_b16 v[66:67], v9 offset:6144
v_mfma_f32_16x16x32_bf16 v[156:159], v[108:111], v[84:87], v[156:159]
ds_read_b64_tr_b16 v[68:69], v10 offset:4096
v_mfma_f32_16x16x32_bf16 v[128:131], v[112:115], v[88:91], v[128:131]
ds_read_b64_tr_b16 v[70:71], v10 offset:6144
v_mfma_f32_16x16x32_bf16 v[132:135], v[116:119], v[88:91], v[132:135]
ds_read_b128 v[44:47], v3 offset:8448
v_mfma_f32_16x16x32_bf16 v[136:139], v[120:123], v[88:91], v[136:139]
ds_read_b64_tr_b16 v[72:73], v11 offset:4096
v_mfma_f32_16x16x32_bf16 v[140:143], v[124:127], v[88:91], v[140:143]
ds_read_b64_tr_b16 v[74:75], v11 offset:6144
v_mfma_f32_16x16x32_bf16 v[144:147], v[112:115], v[92:95], v[144:147]
ds_read_b64_tr_b16 v[76:77], v12 offset:4096
v_mfma_f32_16x16x32_bf16 v[148:151], v[116:119], v[92:95], v[148:151]
ds_read_b64_tr_b16 v[78:79], v12 offset:6144
v_mfma_f32_16x16x32_bf16 v[152:155], v[120:123], v[92:95], v[152:155]
v_mfma_f32_16x16x32_bf16 v[156:159], v[124:127], v[92:95], v[156:159]
s_mov_b32 s41, 2
Lg2_17:
s_waitcnt lgkmcnt(0)
s_barrier
v_mfma_f32_16x16x32_bf16 v[128:131], v[48:51], v[32:35], v[128:131]
ds_read_b128 v[80:83], v3 offset:24576
ds_read_b64_tr_b16 v[96:97], v9 offset:24576
v_mfma_f32_16x16x32_bf16 v[132:135], v[52:55], v[32:35], v[132:135]
ds_read_b64_tr_b16 v[98:99], v9 offset:26624
ds_read_b64_tr_b16 v[100:101], v10 offset:24576
v_mfma_f32_16x16x32_bf16 v[136:139], v[56:59], v[32:35], v[136:139]
ds_read_b64_tr_b16 v[102:103], v10 offset:26624
ds_read_b128 v[84:87], v3 offset:24832
v_mfma_f32_16x16x32_bf16 v[140:143], v[60:63], v[32:35], v[140:143]
ds_read_b64_tr_b16 v[104:105], v11 offset:24576
ds_read_b64_tr_b16 v[106:107], v11 offset:26624
v_mfma_f32_16x16x32_bf16 v[144:147], v[48:51], v[36:39], v[144:147]
ds_read_b64_tr_b16 v[108:109], v12 offset:24576
ds_read_b64_tr_b16 v[110:111], v12 offset:26624
v_mfma_f32_16x16x32_bf16 v[148:151], v[52:55], v[36:39], v[148:151]
ds_read_b128 v[88:91], v3 offset:32768
ds_read_b64_tr_b16 v[112:113], v9 offset:28672
v_mfma_f32_16x16x32_bf16 v[152:155], v[56:59], v[36:39], v[152:155]
ds_read_b64_tr_b16 v[114:115], v9 offset:30720
v_mfma_f32_16x16x32_bf16 v[156:159], v[60:63], v[36:39], v[156:159]
ds_read_b64_tr_b16 v[116:117], v10 offset:28672
v_mfma_f32_16x16x32_bf16 v[128:131], v[64:67], v[40:43], v[128:131]
ds_read_b64_tr_b16 v[118:119], v10 offset:30720
v_mfma_f32_16x16x32_bf16 v[132:135], v[68:71], v[40:43], v[132:135]
ds_read_b128 v[92:95], v3 offset:33024
v_mfma_f32_16x16x32_bf16 v[136:139], v[72:75], v[40:43], v[136:139]
ds_read_b64_tr_b16 v[120:121], v11 offset:28672
v_mfma_f32_16x16x32_bf16 v[140:143], v[76:79], v[40:43], v[140:143]
ds_read_b64_tr_b16 v[122:123], v11 offset:30720
v_mfma_f32_16x16x32_bf16 v[144:147], v[64:67], v[44:47], v[144:147]
ds_read_b64_tr_b16 v[124:125], v12 offset:28672
v_mfma_f32_16x16x32_bf16 v[148:151], v[68:71], v[44:47], v[148:151]
ds_read_b64_tr_b16 v[126:127], v12 offset:30720
v_mfma_f32_16x16x32_bf16 v[152:155], v[72:75], v[44:47], v[152:155]
v_mfma_f32_16x16x32_bf16 v[156:159], v[76:79], v[44:47], v[156:159]
s_waitcnt lgkmcnt(0)
s_barrier
v_mfma_f32_16x16x32_bf16 v[128:131], v[96:99], v[80:83], v[128:131]
ds_read_b128 v[32:35], v4 offset:0
ds_read_b64_tr_b16 v[48:49], v13 offset:0
v_mfma_f32_16x16x32_bf16 v[132:135], v[100:103], v[80:83], v[132:135]
ds_read_b64_tr_b16 v[50:51], v13 offset:2048
ds_read_b64_tr_b16 v[52:53], v14 offset:0
v_mfma_f32_16x16x32_bf16 v[136:139], v[104:107], v[80:83], v[136:139]
ds_read_b64_tr_b16 v[54:55], v14 offset:2048
ds_read_b128 v[36:39], v4 offset:256
v_mfma_f32_16x16x32_bf16 v[140:143], v[108:111], v[80:83], v[140:143]
ds_read_b64_tr_b16 v[56:57], v15 offset:0
ds_read_b64_tr_b16 v[58:59], v15 offset:2048
v_mfma_f32_16x16x32_bf16 v[144:147], v[96:99], v[84:87], v[144:147]
ds_read_b64_tr_b16 v[60:61], v16 offset:0
ds_read_b64_tr_b16 v[62:63], v16 offset:2048
v_mfma_f32_16x16x32_bf16 v[148:151], v[100:103], v[84:87], v[148:151]
ds_read_b128 v[40:43], v4 offset:8192
ds_read_b64_tr_b16 v[64:65], v13 offset:4096
v_mfma_f32_16x16x32_bf16 v[152:155], v[104:107], v[84:87], v[152:155]
ds_read_b64_tr_b16 v[66:67], v13 offset:6144
v_mfma_f32_16x16x32_bf16 v[156:159], v[108:111], v[84:87], v[156:159]
ds_read_b64_tr_b16 v[68:69], v14 offset:4096
v_mfma_f32_16x16x32_bf16 v[128:131], v[112:115], v[88:91], v[128:131]
ds_read_b64_tr_b16 v[70:71], v14 offset:6144
v_mfma_f32_16x16x32_bf16 v[132:135], v[116:119], v[88:91], v[132:135]
ds_read_b128 v[44:47], v4 offset:8448
v_mfma_f32_16x16x32_bf16 v[136:139], v[120:123], v[88:91], v[136:139]
ds_read_b64_tr_b16 v[72:73], v15 offset:4096
v_mfma_f32_16x16x32_bf16 v[140:143], v[124:127], v[88:91], v[140:143]
ds_read_b64_tr_b16 v[74:75], v15 offset:6144
v_mfma_f32_16x16x32_bf16 v[144:147], v[112:115], v[92:95], v[144:147]
ds_read_b64_tr_b16 v[76:77], v16 offset:4096
v_mfma_f32_16x16x32_bf16 v[148:151], v[116:119], v[92:95], v[148:151]
ds_read_b64_tr_b16 v[78:79], v16 offset:6144
v_mfma_f32_16x16x32_bf16 v[152:155], v[120:123], v[92:95], v[152:155]
v_mfma_f32_16x16x32_bf16 v[156:159], v[124:127], v[92:95], v[156:159]
s_waitcnt lgkmcnt(0)
s_barrier
v_mfma_f32_16x16x32_bf16 v[128:131], v[48:51], v[32:35], v[128:131]
ds_read_b128 v[80:83], v4 offset:24576
ds_read_b64_tr_b16 v[96:97], v13 offset:24576
v_mfma_f32_16x16x32_bf16 v[132:135], v[52:55], v[32:35], v[132:135]
ds_read_b64_tr_b16 v[98:99], v13 offset:26624
ds_read_b64_tr_b16 v[100:101], v14 offset:24576
v_mfma_f32_16x16x32_bf16 v[136:139], v[56:59], v[32:35], v[136:139]
ds_read_b64_tr_b16 v[102:103], v14 offset:26624
ds_read_b128 v[84:87], v4 offset:24832
v_mfma_f32_16x16x32_bf16 v[140:143], v[60:63], v[32:35], v[140:143]
ds_read_b64_tr_b16 v[104:105], v15 offset:24576
ds_read_b64_tr_b16 v[106:107], v15 offset:26624
v_mfma_f32_16x16x32_bf16 v[144:147], v[48:51], v[36:39], v[144:147]
ds_read_b64_tr_b16 v[108:109], v16 offset:24576
ds_read_b64_tr_b16 v[110:111], v16 offset:26624
v_mfma_f32_16x16x32_bf16 v[148:151], v[52:55], v[36:39], v[148:151]
ds_read_b128 v[88:91], v4 offset:32768
ds_read_b64_tr_b16 v[112:113], v13 offset:28672
v_mfma_f32_16x16x32_bf16 v[152:155], v[56:59], v[36:39], v[152:155]
ds_read_b64_tr_b16 v[114:115], v13 offset:30720
v_mfma_f32_16x16x32_bf16 v[156:159], v[60:63], v[36:39], v[156:159]
ds_read_b64_tr_b16 v[116:117], v14 offset:28672
v_mfma_f32_16x16x32_bf16 v[128:131], v[64:67], v[40:43], v[128:131]
ds_read_b64_tr_b16 v[118:119], v14 offset:30720
v_mfma_f32_16x16x32_bf16 v[132:135], v[68:71], v[40:43], v[132:135]
ds_read_b128 v[92:95], v4 offset:33024
v_mfma_f32_16x16x32_bf16 v[136:139], v[72:75], v[40:43], v[136:139]
ds_read_b64_tr_b16 v[120:121], v15 offset:28672
v_mfma_f32_16x16x32_bf16 v[140:143], v[76:79], v[40:43], v[140:143]
ds_read_b64_tr_b16 v[122:123], v15 offset:30720
v_mfma_f32_16x16x32_bf16 v[144:147], v[64:67], v[44:47], v[144:147]
ds_read_b64_tr_b16 v[124:125], v16 offset:28672
v_mfma_f32_16x16x32_bf16 v[148:151], v[68:71], v[44:47], v[148:151]
ds_read_b64_tr_b16 v[126:127], v16 offset:30720
v_mfma_f32_16x16x32_bf16 v[152:155], v[72:75], v[44:47], v[152:155]
v_mfma_f32_16x16x32_bf16 v[156:159], v[76:79], v[44:47], v[156:159]
s_waitcnt lgkmcnt(0)
s_barrier
v_mfma_f32_16x16x32_bf16 v[128:131], v[96:99], v[80:83], v[128:131]
ds_read_b128 v[32:35], v2 offset:0
ds_read_b64_tr_b16 v[48:49], v5 offset:0
v_mfma_f32_16x16x32_bf16 v[132:135], v[100:103], v[80:83], v[132:135]
ds_read_b64_tr_b16 v[50:51], v5 offset:2048
ds_read_b64_tr_b16 v[52:53], v6 offset:0
v_mfma_f32_16x16x32_bf16 v[136:139], v[104:107], v[80:83], v[136:139]
ds_read_b64_tr_b16 v[54:55], v6 offset:2048
ds_read_b128 v[36:39], v2 offset:256
v_mfma_f32_16x16x32_bf16 v[140:143], v[108:111], v[80:83], v[140:143]
ds_read_b64_tr_b16 v[56:57], v7 offset:0
ds_read_b64_tr_b16 v[58:59], v7 offset:2048
v_mfma_f32_16x16x32_bf16 v[144:147], v[96:99], v[84:87], v[144:147]
ds_read_b64_tr_b16 v[60:61], v8 offset:0
ds_read_b64_tr_b16 v[62:63], v8 offset:2048
v_mfma_f32_16x16x32_bf16 v[148:151], v[100:103], v[84:87], v[148:151]
ds_read_b128 v[40:43], v2 offset:8192
ds_read_b64_tr_b16 v[64:65], v5 offset:4096
v_mfma_f32_16x16x32_bf16 v[152:155], v[104:107], v[84:87], v[152:155]
ds_read_b64_tr_b16 v[66:67], v5 offset:6144
v_mfma_f32_16x16x32_bf16 v[156:159], v[108:111], v[84:87], v[156:159]
ds_read_b64_tr_b16 v[68:69], v6 offset:4096
v_mfma_f32_16x16x32_bf16 v[128:131], v[112:115], v[88:91], v[128:131]
ds_read_b64_tr_b16 v[70:71], v6 offset:6144
v_mfma_f32_16x16x32_bf16 v[132:135], v[116:119], v[88:91], v[132:135]
ds_read_b128 v[44:47], v2 offset:8448
v_mfma_f32_16x16x32_bf16 v[136:139], v[120:123], v[88:91], v[136:139]
ds_read_b64_tr_b16 v[72:73], v7 offset:4096
v_mfma_f32_16x16x32_bf16 v[140:143], v[124:127], v[88:91], v[140:143]
ds_read_b64_tr_b16 v[74:75], v7 offset:6144
v_mfma_f32_16x16x32_bf16 v[144:147], v[112:115], v[92:95], v[144:147]
ds_read_b64_tr_b16 v[76:77], v8 offset:4096
v_mfma_f32_16x16x32_bf16 v[148:151], v[116:119], v[92:95], v[148:151]
ds_read_b64_tr_b16 v[78:79], v8 offset:6144
v_mfma_f32_16x16x32_bf16 v[152:155], v[120:123], v[92:95], v[152:155]
v_mfma_f32_16x16x32_bf16 v[156:159], v[124:127], v[92:95], v[156:159]
s_waitcnt lgkmcnt(0)
s_barrier
v_mfma_f32_16x16x32_bf16 v[128:131], v[48:51], v[32:35], v[128:131]
ds_read_b128 v[80:83], v2 offset:24576
ds_read_b64_tr_b16 v[96:97], v5 offset:24576
v_mfma_f32_16x16x32_bf16 v[132:135], v[52:55], v[32:35], v[132:135]
ds_read_b64_tr_b16 v[98:99], v5 offset:26624
ds_read_b64_tr_b16 v[100:101], v6 offset:24576
v_mfma_f32_16x16x32_bf16 v[136:139], v[56:59], v[32:35], v[136:139]
ds_read_b64_tr_b16 v[102:103], v6 offset:26624
ds_read_b128 v[84:87], v2 offset:24832
v_mfma_f32_16x16x32_bf16 v[140:143], v[60:63], v[32:35], v[140:143]
ds_read_b64_tr_b16 v[104:105], v7 offset:24576
ds_read_b64_tr_b16 v[106:107], v7 offset:26624
v_mfma_f32_16x16x32_bf16 v[144:147], v[48:51], v[36:39], v[144:147]
ds_read_b64_tr_b16 v[108:109], v8 offset:24576
ds_read_b64_tr_b16 v[110:111], v8 offset:26624
v_mfma_f32_16x16x32_bf16 v[148:151], v[52:55], v[36:39], v[148:151]
ds_read_b128 v[88:91], v2 offset:32768
ds_read_b64_tr_b16 v[112:113], v5 offset:28672
v_mfma_f32_16x16x32_bf16 v[152:155], v[56:59], v[36:39], v[152:155]
ds_read_b64_tr_b16 v[114:115], v5 offset:30720
v_mfma_f32_16x16x32_bf16 v[156:159], v[60:63], v[36:39], v[156:159]
ds_read_b64_tr_b16 v[116:117], v6 offset:28672
v_mfma_f32_16x16x32_bf16 v[128:131], v[64:67], v[40:43], v[128:131]
ds_read_b64_tr_b16 v[118:119], v6 offset:30720
v_mfma_f32_16x16x32_bf16 v[132:135], v[68:71], v[40:43], v[132:135]
ds_read_b128 v[92:95], v2 offset:33024
v_mfma_f32_16x16x32_bf16 v[136:139], v[72:75], v[40:43], v[136:139]
ds_read_b64_tr_b16 v[120:121], v7 offset:28672
v_mfma_f32_16x16x32_bf16 v[140:143], v[76:79], v[40:43], v[140:143]
ds_read_b64_tr_b16 v[122:123], v7 offset:30720
v_mfma_f32_16x16x32_bf16 v[144:147], v[64:67], v[44:47], v[144:147]
ds_read_b64_tr_b16 v[124:125], v8 offset:28672
v_mfma_f32_16x16x32_bf16 v[148:151], v[68:71], v[44:47], v[148:151]
ds_read_b64_tr_b16 v[126:127], v8 offset:30720
v_mfma_f32_16x16x32_bf16 v[152:155], v[72:75], v[44:47], v[152:155]
v_mfma_f32_16x16x32_bf16 v[156:159], v[76:79], v[44:47], v[156:159]
s_waitcnt lgkmcnt(0)
s_barrier
v_mfma_f32_16x16x32_bf16 v[128:131], v[96:99], v[80:83], v[128:131]
ds_read_b128 v[32:35], v3 offset:0
ds_read_b64_tr_b16 v[48:49], v9 offset:0
v_mfma_f32_16x16x32_bf16 v[132:135], v[100:103], v[80:83], v[132:135]
ds_read_b64_tr_b16 v[50:51], v9 offset:2048
ds_read_b64_tr_b16 v[52:53], v10 offset:0
v_mfma_f32_16x16x32_bf16 v[136:139], v[104:107], v[80:83], v[136:139]
ds_read_b64_tr_b16 v[54:55], v10 offset:2048
ds_read_b128 v[36:39], v3 offset:256
v_mfma_f32_16x16x32_bf16 v[140:143], v[108:111], v[80:83], v[140:143]
ds_read_b64_tr_b16 v[56:57], v11 offset:0
ds_read_b64_tr_b16 v[58:59], v11 offset:2048
v_mfma_f32_16x16x32_bf16 v[144:147], v[96:99], v[84:87], v[144:147]
ds_read_b64_tr_b16 v[60:61], v12 offset:0
ds_read_b64_tr_b16 v[62:63], v12 offset:2048
v_mfma_f32_16x16x32_bf16 v[148:151], v[100:103], v[84:87], v[148:151]
ds_read_b128 v[40:43], v3 offset:8192
ds_read_b64_tr_b16 v[64:65], v9 offset:4096
v_mfma_f32_16x16x32_bf16 v[152:155], v[104:107], v[84:87], v[152:155]
ds_read_b64_tr_b16 v[66:67], v9 offset:6144
v_mfma_f32_16x16x32_bf16 v[156:159], v[108:111], v[84:87], v[156:159]
ds_read_b64_tr_b16 v[68:69], v10 offset:4096
v_mfma_f32_16x16x32_bf16 v[128:131], v[112:115], v[88:91], v[128:131]
ds_read_b64_tr_b16 v[70:71], v10 offset:6144
v_mfma_f32_16x16x32_bf16 v[132:135], v[116:119], v[88:91], v[132:135]
ds_read_b128 v[44:47], v3 offset:8448
v_mfma_f32_16x16x32_bf16 v[136:139], v[120:123], v[88:91], v[136:139]
ds_read_b64_tr_b16 v[72:73], v11 offset:4096
v_mfma_f32_16x16x32_bf16 v[140:143], v[124:127], v[88:91], v[140:143]
ds_read_b64_tr_b16 v[74:75], v11 offset:6144
v_mfma_f32_16x16x32_bf16 v[144:147], v[112:115], v[92:95], v[144:147]
ds_read_b64_tr_b16 v[76:77], v12 offset:4096
v_mfma_f32_16x16x32_bf16 v[148:151], v[116:119], v[92:95], v[148:151]
ds_read_b64_tr_b16 v[78:79], v12 offset:6144
v_mfma_f32_16x16x32_bf16 v[152:155], v[120:123], v[92:95], v[152:155]
v_mfma_f32_16x16x32_bf16 v[156:159], v[124:127], v[92:95], v[156:159]
s_sub_u32 s41, s41, 1
s_cmp_lg_u32 s41, 0
s_cbranch_scc1 Lg2_17
s_waitcnt lgkmcnt(0)
s_barrier
v_mfma_f32_16x16x32_bf16 v[128:131], v[48:51], v[32:35], v[128:131]
ds_read_b128 v[80:83], v3 offset:24576
ds_read_b64_tr_b16 v[96:97], v9 offset:24576
v_mfma_f32_16x16x32_bf16 v[132:135], v[52:55], v[32:35], v[132:135]
ds_read_b64_tr_b16 v[98:99], v9 offset:26624
ds_read_b64_tr_b16 v[100:101], v10 offset:24576
v_mfma_f32_16x16x32_bf16 v[136:139], v[56:59], v[32:35], v[136:139]
ds_read_b64_tr_b16 v[102:103], v10 offset:26624
ds_read_b128 v[84:87], v3 offset:24832
v_mfma_f32_16x16x32_bf16 v[140:143], v[60:63], v[32:35], v[140:143]
ds_read_b64_tr_b16 v[104:105], v11 offset:24576
ds_read_b64_tr_b16 v[106:107], v11 offset:26624
v_mfma_f32_16x16x32_bf16 v[144:147], v[48:51], v[36:39], v[144:147]
ds_read_b64_tr_b16 v[108:109], v12 offset:24576
ds_read_b64_tr_b16 v[110:111], v12 offset:26624
v_mfma_f32_16x16x32_bf16 v[148:151], v[52:55], v[36:39], v[148:151]
ds_read_b128 v[88:91], v3 offset:32768
ds_read_b64_tr_b16 v[112:113], v9 offset:28672
v_mfma_f32_16x16x32_bf16 v[152:155], v[56:59], v[36:39], v[152:155]
ds_read_b64_tr_b16 v[114:115], v9 offset:30720
v_mfma_f32_16x16x32_bf16 v[156:159], v[60:63], v[36:39], v[156:159]
ds_read_b64_tr_b16 v[116:117], v10 offset:28672
v_mfma_f32_16x16x32_bf16 v[128:131], v[64:67], v[40:43], v[128:131]
ds_read_b64_tr_b16 v[118:119], v10 offset:30720
v_mfma_f32_16x16x32_bf16 v[132:135], v[68:71], v[40:43], v[132:135]
ds_read_b128 v[92:95], v3 offset:33024
v_mfma_f32_16x16x32_bf16 v[136:139], v[72:75], v[40:43], v[136:139]
ds_read_b64_tr_b16 v[120:121], v11 offset:28672
v_mfma_f32_16x16x32_bf16 v[140:143], v[76:79], v[40:43], v[140:143]
ds_read_b64_tr_b16 v[122:123], v11 offset:30720
v_mfma_f32_16x16x32_bf16 v[144:147], v[64:67], v[44:47], v[144:147]
ds_read_b64_tr_b16 v[124:125], v12 offset:28672
v_mfma_f32_16x16x32_bf16 v[148:151], v[68:71], v[44:47], v[148:151]
ds_read_b64_tr_b16 v[126:127], v12 offset:30720
v_mfma_f32_16x16x32_bf16 v[152:155], v[72:75], v[44:47], v[152:155]
v_mfma_f32_16x16x32_bf16 v[156:159], v[76:79], v[44:47], v[156:159]
s_waitcnt lgkmcnt(0)
s_barrier
v_mfma_f32_16x16x32_bf16 v[128:131], v[96:99], v[80:83], v[128:131]
v_mfma_f32_16x16x32_bf16 v[132:135], v[100:103], v[80:83], v[132:135]
v_mfma_f32_16x16x32_bf16 v[136:139], v[104:107], v[80:83], v[136:139]
v_mfma_f32_16x16x32_bf16 v[140:143], v[108:111], v[80:83], v[140:143]
v_mfma_f32_16x16x32_bf16 v[144:147], v[96:99], v[84:87], v[144:147]
v_mfma_f32_16x16x32_bf16 v[148:151], v[100:103], v[84:87], v[148:151]
v_mfma_f32_16x16x32_bf16 v[152:155], v[104:107], v[84:87], v[152:155]
v_mfma_f32_16x16x32_bf16 v[156:159], v[108:111], v[84:87], v[156:159]
v_mfma_f32_16x16x32_bf16 v[128:131], v[112:115], v[88:91], v[128:131]
v_mfma_f32_16x16x32_bf16 v[132:135], v[116:119], v[88:91], v[132:135]
v_mfma_f32_16x16x32_bf16 v[136:139], v[120:123], v[88:91], v[136:139]
v_mfma_f32_16x16x32_bf16 v[140:143], v[124:127], v[88:91], v[140:143]
v_mfma_f32_16x16x32_bf16 v[144:147], v[112:115], v[92:95], v[144:147]
v_mfma_f32_16x16x32_bf16 v[148:151], v[116:119], v[92:95], v[148:151]
v_mfma_f32_16x16x32_bf16 v[152:155], v[120:123], v[92:95], v[152:155]
v_mfma_f32_16x16x32_bf16 v[156:159], v[124:127], v[92:95], v[156:159]
s_nop 4
v_cvt_pk_bf16_f32 v96, v128, v129
v_cvt_pk_bf16_f32 v97, v130, v131
v_cvt_pk_bf16_f32 v98, v132, v133
v_cvt_pk_bf16_f32 v99, v134, v135
buffer_store_dwordx4 v[96:99], v2, s[20:23], 0 offen offset:0 sc1
v_cvt_pk_bf16_f32 v100, v136, v137
v_cvt_pk_bf16_f32 v101, v138, v139
v_cvt_pk_bf16_f32 v102, v140, v141
v_cvt_pk_bf16_f32 v103, v142, v143
buffer_store_dwordx4 v[100:103], v2, s[20:23], s50 offen offset:0 sc1
v_cvt_pk_bf16_f32 v104, v144, v145
v_cvt_pk_bf16_f32 v105, v146, v147
v_cvt_pk_bf16_f32 v106, v148, v149
v_cvt_pk_bf16_f32 v107, v150, v151
buffer_store_dwordx4 v[104:107], v2, s[20:23], 0 offen offset:256 sc1
v_cvt_pk_bf16_f32 v108, v152, v153
v_cvt_pk_bf16_f32 v109, v154, v155
v_cvt_pk_bf16_f32 v110, v156, v157
v_cvt_pk_bf16_f32 v111, v158, v159
buffer_store_dwordx4 v[108:111], v2, s[20:23], s50 offen offset:256 sc1
v_dot2_f32_bf16 v112, v96, s52, 0
v_dot2_f32_bf16 v113, v96, v96, 0
v_dot2_f32_bf16 v114, v104, s52, 0
v_dot2_f32_bf16 v115, v104, v104, 0
v_dot2_f32_bf16 v112, v97, s52, v112
v_dot2_f32_bf16 v113, v97, v97, v113
v_dot2_f32_bf16 v114, v105, s52, v114
v_dot2_f32_bf16 v115, v105, v105, v115
v_dot2_f32_bf16 v112, v98, s52, v112
v_dot2_f32_bf16 v113, v98, v98, v113
v_dot2_f32_bf16 v114, v106, s52, v114
v_dot2_f32_bf16 v115, v106, v106, v115
v_dot2_f32_bf16 v112, v99, s52, v112
v_dot2_f32_bf16 v113, v99, v99, v113
v_dot2_f32_bf16 v114, v107, s52, v114
v_dot2_f32_bf16 v115, v107, v107, v115
v_dot2_f32_bf16 v112, v100, s52, v112
v_dot2_f32_bf16 v113, v100, v100, v113
v_dot2_f32_bf16 v114, v108, s52, v114
v_dot2_f32_bf16 v115, v108, v108, v115
v_dot2_f32_bf16 v112, v101, s52, v112
v_dot2_f32_bf16 v113, v101, v101, v113
v_dot2_f32_bf16 v114, v109, s52, v114
v_dot2_f32_bf16 v115, v109, v109, v115
v_dot2_f32_bf16 v112, v102, s52, v112
v_dot2_f32_bf16 v113, v102, v102, v113
v_dot2_f32_bf16 v114, v110, s52, v114
v_dot2_f32_bf16 v115, v110, v110, v115
v_dot2_f32_bf16 v112, v103, s52, v112
v_dot2_f32_bf16 v113, v103, v103, v113
v_dot2_f32_bf16 v114, v111, s52, v114
v_dot2_f32_bf16 v115, v111, v111, v115
s_nop 2
v_permlane32_swap_b32 v112, v114
v_permlane32_swap_b32 v113, v115
v_add_f32 v112, v112, v114
v_add_f32 v113, v113, v115
s_nop 1
v_permlane16_swap_b32 v112, v113
v_add_f32 v112, v112, v113
buffer_store_dword v112, v22, s[24:27], 0 offen sc1
s_waitcnt vmcnt(0)
s_barrier
s_cmp_lg_u32 s36, 0
s_cbranch_scc1 Lsig_18
s_add_u32 s43, s34, 16
s_lshl_b32 s43, s43, 7
v_mov_b32 v19, s43
v_mov_b32 v20, 1
s_mov_b64 exec, 1
buffer_atomic_add v20, v19, s[56:59], 0 offen sc1
s_mov_b64 exec, -1
Lsig_18:
s_lshl_b32 s53, s47, 2
v_lshlrev_b32 v19, 11, v18
v_lshl_add_u32 v19, v17, 4, v19
s_lshl_b32 s43, s46, 10
v_add_u32 v2, s43, v19
v_add_u32 v3, 49152, v2
v_add_u32 v4, 98304, v2
v_lshrrev_b32 v19, 2, v17
v_lshl_add_u32 v20, v18, 2, v19
v_and_b32 v21, 7, v20
v_lshlrev_b32 v20, 8, v20
v_and_b32 v19, 3, v1
v_lshl_add_u32 v20, v19, 3, v20
s_add_u32 s43, s53, 0
v_xor_b32 v19, s43, v21
v_lshl_add_u32 v5, v19, 5, v20
s_add_u32 s43, s53, 1
v_xor_b32 v19, s43, v21
v_lshl_add_u32 v6, v19, 5, v20
s_add_u32 s43, s53, 2
v_xor_b32 v19, s43, v21
v_lshl_add_u32 v7, v19, 5, v20
s_add_u32 s43, s53, 3
v_xor_b32 v19, s43, v21
v_lshl_add_u32 v8, v19, 5, v20
v_add_u32 v9, 49152, v5
v_add_u32 v10, 49152, v6
v_add_u32 v11, 49152, v7
v_add_u32 v12, 49152, v8
v_add_u32 v13, 98304, v5
v_add_u32 v14, 98304, v6
v_add_u32 v15, 98304, v7
v_add_u32 v16, 98304, v8
v_mov_b32 v128, 0
v_mov_b32 v129, 0
v_mov_b32 v130, 0
v_mov_b32 v131, 0
v_mov_b32 v132, 0
v_mov_b32 v133, 0
v_mov_b32 v134, 0
v_mov_b32 v135, 0
v_mov_b32 v136, 0
v_mov_b32 v137, 0
v_mov_b32 v138, 0
v_mov_b32 v139, 0
v_mov_b32 v140, 0
v_mov_b32 v141, 0
v_mov_b32 v142, 0
v_mov_b32 v143, 0
v_mov_b32 v144, 0
v_mov_b32 v145, 0
v_mov_b32 v146, 0
v_mov_b32 v147, 0
v_mov_b32 v148, 0
v_mov_b32 v149, 0
v_mov_b32 v150, 0
v_mov_b32 v151, 0
v_mov_b32 v152, 0
v_mov_b32 v153, 0
v_mov_b32 v154, 0
v_mov_b32 v155, 0
v_mov_b32 v156, 0
v_mov_b32 v157, 0
v_mov_b32 v158, 0
v_mov_b32 v159, 0
v_mov_b32 v160, 0
v_mov_b32 v161, 0
v_mov_b32 v162, 0
v_mov_b32 v163, 0
v_mov_b32 v164, 0
v_mov_b32 v165, 0
v_mov_b32 v166, 0
v_mov_b32 v167, 0
v_mov_b32 v168, 0
v_mov_b32 v169, 0
v_mov_b32 v170, 0
v_mov_b32 v171, 0
v_mov_b32 v172, 0
v_mov_b32 v173, 0
v_mov_b32 v174, 0
v_mov_b32 v175, 0
v_mov_b32 v176, 0
v_mov_b32 v177, 0
v_mov_b32 v178, 0
v_mov_b32 v179, 0
v_mov_b32 v180, 0
v_mov_b32 v181, 0
v_mov_b32 v182, 0
v_mov_b32 v183, 0
v_mov_b32 v184, 0
v_mov_b32 v185, 0
v_mov_b32 v186, 0
v_mov_b32 v187, 0
v_mov_b32 v188, 0
v_mov_b32 v189, 0
v_mov_b32 v190, 0
v_mov_b32 v191, 0
v_mov_b32 v192, 0
v_mov_b32 v193, 0
v_mov_b32 v194, 0
v_mov_b32 v195, 0
v_mov_b32 v196, 0
v_mov_b32 v197, 0
v_mov_b32 v198, 0
v_mov_b32 v199, 0
v_mov_b32 v200, 0
v_mov_b32 v201, 0
v_mov_b32 v202, 0
v_mov_b32 v203, 0
v_mov_b32 v204, 0
v_mov_b32 v205, 0
v_mov_b32 v206, 0
v_mov_b32 v207, 0
v_mov_b32 v208, 0
v_mov_b32 v209, 0
v_mov_b32 v210, 0
v_mov_b32 v211, 0
v_mov_b32 v212, 0
v_mov_b32 v213, 0
v_mov_b32 v214, 0
v_mov_b32 v215, 0
v_mov_b32 v216, 0
v_mov_b32 v217, 0
v_mov_b32 v218, 0
v_mov_b32 v219, 0
v_mov_b32 v220, 0
v_mov_b32 v221, 0
v_mov_b32 v222, 0
v_mov_b32 v223, 0
v_mov_b32 v224, 0
v_mov_b32 v225, 0
v_mov_b32 v226, 0
v_mov_b32 v227, 0
v_mov_b32 v228, 0
v_mov_b32 v229, 0
v_mov_b32 v230, 0
v_mov_b32 v231, 0
v_mov_b32 v232, 0
v_mov_b32 v233, 0
v_mov_b32 v234, 0
v_mov_b32 v235, 0
v_mov_b32 v236, 0
v_mov_b32 v237, 0
v_mov_b32 v238, 0
v_mov_b32 v239, 0
v_mov_b32 v240, 0
v_mov_b32 v241, 0
v_mov_b32 v242, 0
v_mov_b32 v243, 0
v_mov_b32 v244, 0
v_mov_b32 v245, 0
v_mov_b32 v246, 0
v_mov_b32 v247, 0
v_mov_b32 v248, 0
v_mov_b32 v249, 0
v_mov_b32 v250, 0
v_mov_b32 v251, 0
v_mov_b32 v252, 0
v_mov_b32 v253, 0
v_mov_b32 v254, 0
v_mov_b32 v255, 0
s_mul_i32 s43, s35, 192
s_and_b32 s43, s43, 0xffffff80
s_add_u32 s43, s43, 4096
s_cmp_eq_u32 s51, 1
s_cselect_b32 s8, s4, s6
s_cselect_b32 s9, s5, s7
s_sub_u32 s10, 7340032, s43
s_lshl_b32 s44, s34, 18
s_add_u32 s44, s44, 4194304
s_movk_i32 s38, 28672
s_cmp_eq_u32 s51, 0
s_cselect_b32 s8, s32, s8
s_cselect_b32 s9, s33, s9
s_cselect_b32 s10, 262144, s10
s_cselect_b32 s43, s44, s43
s_cselect_b32 s38, 1024, s38
s_cselect_b32 s45, 0, -1
s_add_u32 s8, s8, s43
s_addc_u32 s9, s9, 0
s_mov_b32 s11, 0x20000
s_sub_u32 s37, 0, s38
s_lshl_b32 s39, s51, 14
v_lshrrev_b32 v19, 4, v1
v_lshlrev_b32 v20, 5, v19
v_mul_u32_u24 v19, 6912, v19
v_and_b32 v19, s45, v19
v_and_b32 v20, s45, v20
v_lshlrev_b32 v21, 4, v1
v_xor_b32 v21, v21, v20
v_add_u32 v22, v21, v19
s_and_b32 s45, s45, 128
v_xor_b32 v23, s45, v22
s_mul_i32 s43, s38, 32
s_add_u32 s37, s37, s43
s_mul_i32 s43, s34, 917504
s_mul_i32 s44, s35, 16384
s_add_u32 s43, s43, s44
s_add_u32 s43, s43, 8388608
s_add_u32 s24, s32, s43
s_addc_u32 s25, s33, 0
s_mov_b32 s26, 278528
s_mov_b32 s27, 0x20000
s_mov_b32 s53, 262144
s_lshl_b32 s43, s47, 13
s_lshl_b32 s44, s46, 10
s_add_u32 s43, s43, s44
v_lshlrev_b32 v19, 11, v18
v_lshl_add_u32 v19, v17, 4, v19
v_add_u32 v27, s43, v19
s_lshl_b32 s43, s34, 18
s_lshl_b32 s44, s35, 7
s_add_u32 s43, s43, s44
s_add_u32 s16, s62, s43
s_addc_u32 s17, s63, 0
s_mov_b32 s18, 260224
s_mov_b32 s19, 0x20000
s_lshl_b32 s43, s36, 5
v_lshl_add_u32 v19, v17, 1, s43
v_lshlrev_b32 v19, 11, v19
v_and_b32 v20, 1, v18
v_lshl_add_u32 v19, v20, 5, v19
v_lshrrev_b32 v20, 1, v18
v_lshl_add_u32 v28, v20, 4, v19
s_lshl_b32 s43, s34, 18
s_add_u32 s12, s32, s43
s_addc_u32 s13, s33, 0
s_add_u32 s12, s12, 4194304
s_addc_u32 s13, s13, 0
s_mov_b32 s14, 262144
s_mov_b32 s15, 0x20000
v_lshlrev_b32 v21, 4, v1
s_lshl_b32 s54, s36, 11
s_barrier
s_add_u32 m0, s54, 98304
s_add_u32 s43, s54, 0
buffer_load_dwordx4 v21, s[12:15], s43 offen sc1 lds
s_add_u32 m0, s54, 99328
s_add_u32 s43, s54, 1024
buffer_load_dwordx4 v21, s[12:15], s43 offen sc1 lds
s_add_u32 m0, s54, 0
s_add_u32 s43, s54, 16384
buffer_load_dwordx4 v21, s[12:15], s43 offen sc1 lds
s_add_u32 m0, s54, 1024
s_add_u32 s43, s54, 17408
buffer_load_dwordx4 v21, s[12:15], s43 offen sc1 lds
s_add_u32 m0, s54, 49152
s_add_u32 s43, s54, 32768
buffer_load_dwordx4 v21, s[12:15], s43 offen sc1 lds
s_add_u32 m0, s54, 50176
s_add_u32 s43, s54, 33792
buffer_load_dwordx4 v21, s[12:15], s43 offen sc1 lds
s_waitcnt vmcnt(4)
s_barrier
s_setprio 1
ds_read_b128 v[32:35], v4 offset:0
ds_read_b64_tr_b16 v[48:49], v13 offset:16384
ds_read_b64_tr_b16 v[50:51], v13 offset:20480
ds_read_b128 v[36:39], v4 offset:256
ds_read_b128 v[40:43], v4 offset:512
ds_read_b128 v[44:47], v4 offset:768
ds_read_b64_tr_b16 v[64:65], v13 offset:32768
ds_read_b64_tr_b16 v[66:67], v13 offset:36864
ds_read_b64_tr_b16 v[52:53], v14 offset:16384
ds_read_b64_tr_b16 v[54:55], v14 offset:20480
ds_read_b64_tr_b16 v[68:69], v14 offset:32768
ds_read_b64_tr_b16 v[70:71], v14 offset:36864
ds_read_b64_tr_b16 v[56:57], v15 offset:16384
ds_read_b64_tr_b16 v[58:59], v15 offset:20480
ds_read_b64_tr_b16 v[72:73], v15 offset:32768
ds_read_b64_tr_b16 v[74:75], v15 offset:36864
ds_read_b64_tr_b16 v[60:61], v16 offset:16384
ds_read_b64_tr_b16 v[62:63], v16 offset:20480
ds_read_b64_tr_b16 v[76:77], v16 offset:32768
ds_read_b64_tr_b16 v[78:79], v16 offset:36864
s_mov_b32 s41, 5
Lk3_19:
s_waitcnt lgkmcnt(0)
v_mfma_f32_16x16x32_bf16 v[128:131], v[48:51], v[32:35], v[128:131]
ds_read_b128 v[80:83], v4 offset:8192
v_mfma_f32_16x16x32_bf16 v[132:135], v[48:51], v[36:39], v[132:135]
ds_read_b64_tr_b16 v[96:97], v13 offset:24576
v_mfma_f32_16x16x32_bf16 v[136:139], v[48:51], v[40:43], v[136:139]
ds_read_b64_tr_b16 v[98:99], v13 offset:28672
v_mfma_f32_16x16x32_bf16 v[140:143], v[48:51], v[44:47], v[140:143]
ds_read_b128 v[84:87], v4 offset:8448
v_mfma_f32_16x16x32_bf16 v[192:195], v[64:67], v[32:35], v[192:195]
ds_read_b128 v[88:91], v4 offset:8704
v_mfma_f32_16x16x32_bf16 v[196:199], v[64:67], v[36:39], v[196:199]
ds_read_b128 v[92:95], v4 offset:8960
v_mfma_f32_16x16x32_bf16 v[200:203], v[64:67], v[40:43], v[200:203]
ds_read_b64_tr_b16 v[112:113], v13 offset:40960
v_mfma_f32_16x16x32_bf16 v[204:207], v[64:67], v[44:47], v[204:207]
ds_read_b64_tr_b16 v[114:115], v13 offset:45056
v_mfma_f32_16x16x32_bf16 v[144:147], v[52:55], v[32:35], v[144:147]
ds_read_b64_tr_b16 v[100:101], v14 offset:24576
v_mfma_f32_16x16x32_bf16 v[148:151], v[52:55], v[36:39], v[148:151]
ds_read_b64_tr_b16 v[102:103], v14 offset:28672
v_mfma_f32_16x16x32_bf16 v[152:155], v[52:55], v[40:43], v[152:155]
ds_read_b64_tr_b16 v[116:117], v14 offset:40960
v_mfma_f32_16x16x32_bf16 v[156:159], v[52:55], v[44:47], v[156:159]
ds_read_b64_tr_b16 v[118:119], v14 offset:45056
v_mfma_f32_16x16x32_bf16 v[208:211], v[68:71], v[32:35], v[208:211]
ds_read_b64_tr_b16 v[104:105], v15 offset:24576
v_mfma_f32_16x16x32_bf16 v[212:215], v[68:71], v[36:39], v[212:215]
ds_read_b64_tr_b16 v[106:107], v15 offset:28672
v_mfma_f32_16x16x32_bf16 v[216:219], v[68:71], v[40:43], v[216:219]
ds_read_b64_tr_b16 v[120:121], v15 offset:40960
v_mfma_f32_16x16x32_bf16 v[220:223], v[68:71], v[44:47], v[220:223]
ds_read_b64_tr_b16 v[122:123], v15 offset:45056
v_mfma_f32_16x16x32_bf16 v[160:163], v[56:59], v[32:35], v[160:163]
ds_read_b64_tr_b16 v[108:109], v16 offset:24576
v_mfma_f32_16x16x32_bf16 v[164:167], v[56:59], v[36:39], v[164:167]
ds_read_b64_tr_b16 v[110:111], v16 offset:28672
v_mfma_f32_16x16x32_bf16 v[168:171], v[56:59], v[40:43], v[168:171]
ds_read_b64_tr_b16 v[124:125], v16 offset:40960
v_mfma_f32_16x16x32_bf16 v[172:175], v[56:59], v[44:47], v[172:175]
ds_read_b64_tr_b16 v[126:127], v16 offset:45056
v_mfma_f32_16x16x32_bf16 v[224:227], v[72:75], v[32:35], v[224:227]
v_mfma_f32_16x16x32_bf16 v[228:231], v[72:75], v[36:39], v[228:231]
v_mfma_f32_16x16x32_bf16 v[232:235], v[72:75], v[40:43], v[232:235]
v_mfma_f32_16x16x32_bf16 v[236:239], v[72:75], v[44:47], v[236:239]
v_mfma_f32_16x16x32_bf16 v[176:179], v[60:63], v[32:35], v[176:179]
v_mfma_f32_16x16x32_bf16 v[180:183], v[60:63], v[36:39], v[180:183]
v_mfma_f32_16x16x32_bf16 v[184:187], v[60:63], v[40:43], v[184:187]
v_mfma_f32_16x16x32_bf16 v[188:191], v[60:63], v[44:47], v[188:191]
v_mfma_f32_16x16x32_bf16 v[240:243], v[76:79], v[32:35], v[240:243]
v_mfma_f32_16x16x32_bf16 v[244:247], v[76:79], v[36:39], v[244:247]
v_mfma_f32_16x16x32_bf16 v[248:251], v[76:79], v[40:43], v[248:251]
v_mfma_f32_16x16x32_bf16 v[252:255], v[76:79], v[44:47], v[252:255]
s_waitcnt vmcnt(2) lgkmcnt(0)
s_barrier
v_mfma_f32_16x16x32_bf16 v[128:131], v[96:99], v[80:83], v[128:131]
ds_read_b128 v[32:35], v2 offset:0
v_mfma_f32_16x16x32_bf16 v[132:135], v[96:99], v[84:87], v[132:135]
ds_read_b64_tr_b16 v[48:49], v5 offset:16384
v_mfma_f32_16x16x32_bf16 v[136:139], v[96:99], v[88:91], v[136:139]
ds_read_b64_tr_b16 v[50:51], v5 offset:20480
v_mfma_f32_16x16x32_bf16 v[140:143], v[96:99], v[92:95], v[140:143]
ds_read_b128 v[36:39], v2 offset:256
v_mfma_f32_16x16x32_bf16 v[192:195], v[112:115], v[80:83], v[192:195]
ds_read_b128 v[40:43], v2 offset:512
v_mfma_f32_16x16x32_bf16 v[196:199], v[112:115], v[84:87], v[196:199]
ds_read_b128 v[44:47], v2 offset:768
v_mfma_f32_16x16x32_bf16 v[200:203], v[112:115], v[88:91], v[200:203]
ds_read_b64_tr_b16 v[64:65], v5 offset:32768
v_mfma_f32_16x16x32_bf16 v[204:207], v[112:115], v[92:95], v[204:207]
ds_read_b64_tr_b16 v[66:67], v5 offset:36864
v_mfma_f32_16x16x32_bf16 v[144:147], v[100:103], v[80:83], v[144:147]
ds_read_b64_tr_b16 v[52:53], v6 offset:16384
v_mfma_f32_16x16x32_bf16 v[148:151], v[100:103], v[84:87], v[148:151]
ds_read_b64_tr_b16 v[54:55], v6 offset:20480
v_mfma_f32_16x16x32_bf16 v[152:155], v[100:103], v[88:91], v[152:155]
ds_read_b64_tr_b16 v[68:69], v6 offset:32768
v_mfma_f32_16x16x32_bf16 v[156:159], v[100:103], v[92:95], v[156:159]
ds_read_b64_tr_b16 v[70:71], v6 offset:36864
v_mfma_f32_16x16x32_bf16 v[208:211], v[116:119], v[80:83], v[208:211]
ds_read_b64_tr_b16 v[56:57], v7 offset:16384
v_mfma_f32_16x16x32_bf16 v[212:215], v[116:119], v[84:87], v[212:215]
ds_read_b64_tr_b16 v[58:59], v7 offset:20480
v_mfma_f32_16x16x32_bf16 v[216:219], v[116:119], v[88:91], v[216:219]
ds_read_b64_tr_b16 v[72:73], v7 offset:32768
v_mfma_f32_16x16x32_bf16 v[220:223], v[116:119], v[92:95], v[220:223]
ds_read_b64_tr_b16 v[74:75], v7 offset:36864
v_mfma_f32_16x16x32_bf16 v[160:163], v[104:107], v[80:83], v[160:163]
ds_read_b64_tr_b16 v[60:61], v8 offset:16384
v_mfma_f32_16x16x32_bf16 v[164:167], v[104:107], v[84:87], v[164:167]
ds_read_b64_tr_b16 v[62:63], v8 offset:20480
v_mfma_f32_16x16x32_bf16 v[168:171], v[104:107], v[88:91], v[168:171]
ds_read_b64_tr_b16 v[76:77], v8 offset:32768
v_mfma_f32_16x16x32_bf16 v[172:175], v[104:107], v[92:95], v[172:175]
ds_read_b64_tr_b16 v[78:79], v8 offset:36864
v_mfma_f32_16x16x32_bf16 v[224:227], v[120:123], v[80:83], v[224:227]
v_mfma_f32_16x16x32_bf16 v[228:231], v[120:123], v[84:87], v[228:231]
v_mfma_f32_16x16x32_bf16 v[232:235], v[120:123], v[88:91], v[232:235]
v_mfma_f32_16x16x32_bf16 v[236:239], v[120:123], v[92:95], v[236:239]
v_mfma_f32_16x16x32_bf16 v[176:179], v[108:111], v[80:83], v[176:179]
v_mfma_f32_16x16x32_bf16 v[180:183], v[108:111], v[84:87], v[180:183]
v_mfma_f32_16x16x32_bf16 v[184:187], v[108:111], v[88:91], v[184:187]
v_mfma_f32_16x16x32_bf16 v[188:191], v[108:111], v[92:95], v[188:191]
v_mfma_f32_16x16x32_bf16 v[240:243], v[124:127], v[80:83], v[240:243]
v_mfma_f32_16x16x32_bf16 v[244:247], v[124:127], v[84:87], v[244:247]
v_mfma_f32_16x16x32_bf16 v[248:251], v[124:127], v[88:91], v[248:251]
v_mfma_f32_16x16x32_bf16 v[252:255], v[124:127], v[92:95], v[252:255]
s_waitcnt lgkmcnt(0)
v_mfma_f32_16x16x32_bf16 v[128:131], v[48:51], v[32:35], v[128:131]
ds_read_b128 v[80:83], v2 offset:8192
v_mfma_f32_16x16x32_bf16 v[132:135], v[48:51], v[36:39], v[132:135]
ds_read_b64_tr_b16 v[96:97], v5 offset:24576
v_mfma_f32_16x16x32_bf16 v[136:139], v[48:51], v[40:43], v[136:139]
ds_read_b64_tr_b16 v[98:99], v5 offset:28672
v_mfma_f32_16x16x32_bf16 v[140:143], v[48:51], v[44:47], v[140:143]
ds_read_b128 v[84:87], v2 offset:8448
v_mfma_f32_16x16x32_bf16 v[192:195], v[64:67], v[32:35], v[192:195]
ds_read_b128 v[88:91], v2 offset:8704
v_mfma_f32_16x16x32_bf16 v[196:199], v[64:67], v[36:39], v[196:199]
ds_read_b128 v[92:95], v2 offset:8960
v_mfma_f32_16x16x32_bf16 v[200:203], v[64:67], v[40:43], v[200:203]
ds_read_b64_tr_b16 v[112:113], v5 offset:40960
v_mfma_f32_16x16x32_bf16 v[204:207], v[64:67], v[44:47], v[204:207]
ds_read_b64_tr_b16 v[114:115], v5 offset:45056
v_mfma_f32_16x16x32_bf16 v[144:147], v[52:55], v[32:35], v[144:147]
ds_read_b64_tr_b16 v[100:101], v6 offset:24576
v_mfma_f32_16x16x32_bf16 v[148:151], v[52:55], v[36:39], v[148:151]
ds_read_b64_tr_b16 v[102:103], v6 offset:28672
v_mfma_f32_16x16x32_bf16 v[152:155], v[52:55], v[40:43], v[152:155]
ds_read_b64_tr_b16 v[116:117], v6 offset:40960
v_mfma_f32_16x16x32_bf16 v[156:159], v[52:55], v[44:47], v[156:159]
ds_read_b64_tr_b16 v[118:119], v6 offset:45056
v_mfma_f32_16x16x32_bf16 v[208:211], v[68:71], v[32:35], v[208:211]
ds_read_b64_tr_b16 v[104:105], v7 offset:24576
v_mfma_f32_16x16x32_bf16 v[212:215], v[68:71], v[36:39], v[212:215]
ds_read_b64_tr_b16 v[106:107], v7 offset:28672
v_mfma_f32_16x16x32_bf16 v[216:219], v[68:71], v[40:43], v[216:219]
ds_read_b64_tr_b16 v[120:121], v7 offset:40960
v_mfma_f32_16x16x32_bf16 v[220:223], v[68:71], v[44:47], v[220:223]
ds_read_b64_tr_b16 v[122:123], v7 offset:45056
v_mfma_f32_16x16x32_bf16 v[160:163], v[56:59], v[32:35], v[160:163]
ds_read_b64_tr_b16 v[108:109], v8 offset:24576
v_mfma_f32_16x16x32_bf16 v[164:167], v[56:59], v[36:39], v[164:167]
ds_read_b64_tr_b16 v[110:111], v8 offset:28672
v_mfma_f32_16x16x32_bf16 v[168:171], v[56:59], v[40:43], v[168:171]
ds_read_b64_tr_b16 v[124:125], v8 offset:40960
v_mfma_f32_16x16x32_bf16 v[172:175], v[56:59], v[44:47], v[172:175]
ds_read_b64_tr_b16 v[126:127], v8 offset:45056
v_mfma_f32_16x16x32_bf16 v[224:227], v[72:75], v[32:35], v[224:227]
v_mfma_f32_16x16x32_bf16 v[228:231], v[72:75], v[36:39], v[228:231]
v_mfma_f32_16x16x32_bf16 v[232:235], v[72:75], v[40:43], v[232:235]
v_mfma_f32_16x16x32_bf16 v[236:239], v[72:75], v[44:47], v[236:239]
v_mfma_f32_16x16x32_bf16 v[176:179], v[60:63], v[32:35], v[176:179]
v_mfma_f32_16x16x32_bf16 v[180:183], v[60:63], v[36:39], v[180:183]
v_mfma_f32_16x16x32_bf16 v[184:187], v[60:63], v[40:43], v[184:187]
v_mfma_f32_16x16x32_bf16 v[188:191], v[60:63], v[44:47], v[188:191]
v_mfma_f32_16x16x32_bf16 v[240:243], v[76:79], v[32:35], v[240:243]
v_mfma_f32_16x16x32_bf16 v[244:247], v[76:79], v[36:39], v[244:247]
v_mfma_f32_16x16x32_bf16 v[248:251], v[76:79], v[40:43], v[248:251]
v_mfma_f32_16x16x32_bf16 v[252:255], v[76:79], v[44:47], v[252:255]
s_waitcnt vmcnt(0) lgkmcnt(0)
s_barrier
v_mfma_f32_16x16x32_bf16 v[128:131], v[96:99], v[80:83], v[128:131]
ds_read_b128 v[32:35], v3 offset:0
v_mfma_f32_16x16x32_bf16 v[132:135], v[96:99], v[84:87], v[132:135]
ds_read_b64_tr_b16 v[48:49], v9 offset:16384
v_mfma_f32_16x16x32_bf16 v[136:139], v[96:99], v[88:91], v[136:139]
ds_read_b64_tr_b16 v[50:51], v9 offset:20480
v_mfma_f32_16x16x32_bf16 v[140:143], v[96:99], v[92:95], v[140:143]
ds_read_b128 v[36:39], v3 offset:256
v_mfma_f32_16x16x32_bf16 v[192:195], v[112:115], v[80:83], v[192:195]
ds_read_b128 v[40:43], v3 offset:512
v_mfma_f32_16x16x32_bf16 v[196:199], v[112:115], v[84:87], v[196:199]
ds_read_b128 v[44:47], v3 offset:768
v_mfma_f32_16x16x32_bf16 v[200:203], v[112:115], v[88:91], v[200:203]
ds_read_b64_tr_b16 v[64:65], v9 offset:32768
v_mfma_f32_16x16x32_bf16 v[204:207], v[112:115], v[92:95], v[204:207]
ds_read_b64_tr_b16 v[66:67], v9 offset:36864
v_mfma_f32_16x16x32_bf16 v[144:147], v[100:103], v[80:83], v[144:147]
ds_read_b64_tr_b16 v[52:53], v10 offset:16384
v_mfma_f32_16x16x32_bf16 v[148:151], v[100:103], v[84:87], v[148:151]
ds_read_b64_tr_b16 v[54:55], v10 offset:20480
v_mfma_f32_16x16x32_bf16 v[152:155], v[100:103], v[88:91], v[152:155]
ds_read_b64_tr_b16 v[68:69], v10 offset:32768
v_mfma_f32_16x16x32_bf16 v[156:159], v[100:103], v[92:95], v[156:159]
ds_read_b64_tr_b16 v[70:71], v10 offset:36864
v_mfma_f32_16x16x32_bf16 v[208:211], v[116:119], v[80:83], v[208:211]
ds_read_b64_tr_b16 v[56:57], v11 offset:16384
v_mfma_f32_16x16x32_bf16 v[212:215], v[116:119], v[84:87], v[212:215]
ds_read_b64_tr_b16 v[58:59], v11 offset:20480
v_mfma_f32_16x16x32_bf16 v[216:219], v[116:119], v[88:91], v[216:219]
ds_read_b64_tr_b16 v[72:73], v11 offset:32768
v_mfma_f32_16x16x32_bf16 v[220:223], v[116:119], v[92:95], v[220:223]
ds_read_b64_tr_b16 v[74:75], v11 offset:36864
v_mfma_f32_16x16x32_bf16 v[160:163], v[104:107], v[80:83], v[160:163]
ds_read_b64_tr_b16 v[60:61], v12 offset:16384
v_mfma_f32_16x16x32_bf16 v[164:167], v[104:107], v[84:87], v[164:167]
ds_read_b64_tr_b16 v[62:63], v12 offset:20480
v_mfma_f32_16x16x32_bf16 v[168:171], v[104:107], v[88:91], v[168:171]
ds_read_b64_tr_b16 v[76:77], v12 offset:32768
v_mfma_f32_16x16x32_bf16 v[172:175], v[104:107], v[92:95], v[172:175]
ds_read_b64_tr_b16 v[78:79], v12 offset:36864
v_mfma_f32_16x16x32_bf16 v[224:227], v[120:123], v[80:83], v[224:227]
v_mfma_f32_16x16x32_bf16 v[228:231], v[120:123], v[84:87], v[228:231]
v_mfma_f32_16x16x32_bf16 v[232:235], v[120:123], v[88:91], v[232:235]
v_mfma_f32_16x16x32_bf16 v[236:239], v[120:123], v[92:95], v[236:239]
v_mfma_f32_16x16x32_bf16 v[176:179], v[108:111], v[80:83], v[176:179]
v_mfma_f32_16x16x32_bf16 v[180:183], v[108:111], v[84:87], v[180:183]
v_mfma_f32_16x16x32_bf16 v[184:187], v[108:111], v[88:91], v[184:187]
v_mfma_f32_16x16x32_bf16 v[188:191], v[108:111], v[92:95], v[188:191]
v_mfma_f32_16x16x32_bf16 v[240:243], v[124:127], v[80:83], v[240:243]
v_mfma_f32_16x16x32_bf16 v[244:247], v[124:127], v[84:87], v[244:247]
v_mfma_f32_16x16x32_bf16 v[248:251], v[124:127], v[88:91], v[248:251]
v_mfma_f32_16x16x32_bf16 v[252:255], v[124:127], v[92:95], v[252:255]
s_waitcnt lgkmcnt(0)
v_mfma_f32_16x16x32_bf16 v[128:131], v[48:51], v[32:35], v[128:131]
ds_read_b128 v[80:83], v3 offset:8192
v_mfma_f32_16x16x32_bf16 v[132:135], v[48:51], v[36:39], v[132:135]
ds_read_b64_tr_b16 v[96:97], v9 offset:24576
v_mfma_f32_16x16x32_bf16 v[136:139], v[48:51], v[40:43], v[136:139]
ds_read_b64_tr_b16 v[98:99], v9 offset:28672
v_mfma_f32_16x16x32_bf16 v[140:143], v[48:51], v[44:47], v[140:143]
ds_read_b128 v[84:87], v3 offset:8448
v_mfma_f32_16x16x32_bf16 v[192:195], v[64:67], v[32:35], v[192:195]
ds_read_b128 v[88:91], v3 offset:8704
v_mfma_f32_16x16x32_bf16 v[196:199], v[64:67], v[36:39], v[196:199]
ds_read_b128 v[92:95], v3 offset:8960
v_mfma_f32_16x16x32_bf16 v[200:203], v[64:67], v[40:43], v[200:203]
ds_read_b64_tr_b16 v[112:113], v9 offset:40960
v_mfma_f32_16x16x32_bf16 v[204:207], v[64:67], v[44:47], v[204:207]
ds_read_b64_tr_b16 v[114:115], v9 offset:45056
v_mfma_f32_16x16x32_bf16 v[144:147], v[52:55], v[32:35], v[144:147]
ds_read_b64_tr_b16 v[100:101], v10 offset:24576
v_mfma_f32_16x16x32_bf16 v[148:151], v[52:55], v[36:39], v[148:151]
ds_read_b64_tr_b16 v[102:103], v10 offset:28672
v_mfma_f32_16x16x32_bf16 v[152:155], v[52:55], v[40:43], v[152:155]
ds_read_b64_tr_b16 v[116:117], v10 offset:40960
v_mfma_f32_16x16x32_bf16 v[156:159], v[52:55], v[44:47], v[156:159]
ds_read_b64_tr_b16 v[118:119], v10 offset:45056
v_mfma_f32_16x16x32_bf16 v[208:211], v[68:71], v[32:35], v[208:211]
ds_read_b64_tr_b16 v[104:105], v11 offset:24576
v_mfma_f32_16x16x32_bf16 v[212:215], v[68:71], v[36:39], v[212:215]
ds_read_b64_tr_b16 v[106:107], v11 offset:28672
v_mfma_f32_16x16x32_bf16 v[216:219], v[68:71], v[40:43], v[216:219]
ds_read_b64_tr_b16 v[120:121], v11 offset:40960
v_mfma_f32_16x16x32_bf16 v[220:223], v[68:71], v[44:47], v[220:223]
ds_read_b64_tr_b16 v[122:123], v11 offset:45056
v_mfma_f32_16x16x32_bf16 v[160:163], v[56:59], v[32:35], v[160:163]
ds_read_b64_tr_b16 v[108:109], v12 offset:24576
v_mfma_f32_16x16x32_bf16 v[164:167], v[56:59], v[36:39], v[164:167]
ds_read_b64_tr_b16 v[110:111], v12 offset:28672
v_mfma_f32_16x16x32_bf16 v[168:171], v[56:59], v[40:43], v[168:171]
ds_read_b64_tr_b16 v[124:125], v12 offset:40960
v_mfma_f32_16x16x32_bf16 v[172:175], v[56:59], v[44:47], v[172:175]
ds_read_b64_tr_b16 v[126:127], v12 offset:45056
v_mfma_f32_16x16x32_bf16 v[224:227], v[72:75], v[32:35], v[224:227]
v_mfma_f32_16x16x32_bf16 v[228:231], v[72:75], v[36:39], v[228:231]
v_mfma_f32_16x16x32_bf16 v[232:235], v[72:75], v[40:43], v[232:235]
v_mfma_f32_16x16x32_bf16 v[236:239], v[72:75], v[44:47], v[236:239]
v_mfma_f32_16x16x32_bf16 v[176:179], v[60:63], v[32:35], v[176:179]
v_mfma_f32_16x16x32_bf16 v[180:183], v[60:63], v[36:39], v[180:183]
v_mfma_f32_16x16x32_bf16 v[184:187], v[60:63], v[40:43], v[184:187]
v_mfma_f32_16x16x32_bf16 v[188:191], v[60:63], v[44:47], v[188:191]
v_mfma_f32_16x16x32_bf16 v[240:243], v[76:79], v[32:35], v[240:243]
v_mfma_f32_16x16x32_bf16 v[244:247], v[76:79], v[36:39], v[244:247]
v_mfma_f32_16x16x32_bf16 v[248:251], v[76:79], v[40:43], v[248:251]
v_mfma_f32_16x16x32_bf16 v[252:255], v[76:79], v[44:47], v[252:255]
s_waitcnt lgkmcnt(0)
s_barrier
v_mfma_f32_16x16x32_bf16 v[128:131], v[96:99], v[80:83], v[128:131]
ds_read_b128 v[32:35], v4 offset:0
v_mfma_f32_16x16x32_bf16 v[132:135], v[96:99], v[84:87], v[132:135]
ds_read_b64_tr_b16 v[48:49], v13 offset:16384
v_mfma_f32_16x16x32_bf16 v[136:139], v[96:99], v[88:91], v[136:139]
ds_read_b64_tr_b16 v[50:51], v13 offset:20480
v_mfma_f32_16x16x32_bf16 v[140:143], v[96:99], v[92:95], v[140:143]
ds_read_b128 v[36:39], v4 offset:256
v_mfma_f32_16x16x32_bf16 v[192:195], v[112:115], v[80:83], v[192:195]
ds_read_b128 v[40:43], v4 offset:512
v_mfma_f32_16x16x32_bf16 v[196:199], v[112:115], v[84:87], v[196:199]
ds_read_b128 v[44:47], v4 offset:768
v_mfma_f32_16x16x32_bf16 v[200:203], v[112:115], v[88:91], v[200:203]
ds_read_b64_tr_b16 v[64:65], v13 offset:32768
v_mfma_f32_16x16x32_bf16 v[204:207], v[112:115], v[92:95], v[204:207]
ds_read_b64_tr_b16 v[66:67], v13 offset:36864
v_mfma_f32_16x16x32_bf16 v[144:147], v[100:103], v[80:83], v[144:147]
ds_read_b64_tr_b16 v[52:53], v14 offset:16384
v_mfma_f32_16x16x32_bf16 v[148:151], v[100:103], v[84:87], v[148:151]
ds_read_b64_tr_b16 v[54:55], v14 offset:20480
v_mfma_f32_16x16x32_bf16 v[152:155], v[100:103], v[88:91], v[152:155]
ds_read_b64_tr_b16 v[68:69], v14 offset:32768
v_mfma_f32_16x16x32_bf16 v[156:159], v[100:103], v[92:95], v[156:159]
ds_read_b64_tr_b16 v[70:71], v14 offset:36864
v_mfma_f32_16x16x32_bf16 v[208:211], v[116:119], v[80:83], v[208:211]
ds_read_b64_tr_b16 v[56:57], v15 offset:16384
v_mfma_f32_16x16x32_bf16 v[212:215], v[116:119], v[84:87], v[212:215]
ds_read_b64_tr_b16 v[58:59], v15 offset:20480
v_mfma_f32_16x16x32_bf16 v[216:219], v[116:119], v[88:91], v[216:219]
ds_read_b64_tr_b16 v[72:73], v15 offset:32768
v_mfma_f32_16x16x32_bf16 v[220:223], v[116:119], v[92:95], v[220:223]
ds_read_b64_tr_b16 v[74:75], v15 offset:36864
v_mfma_f32_16x16x32_bf16 v[160:163], v[104:107], v[80:83], v[160:163]
ds_read_b64_tr_b16 v[60:61], v16 offset:16384
v_mfma_f32_16x16x32_bf16 v[164:167], v[104:107], v[84:87], v[164:167]
ds_read_b64_tr_b16 v[62:63], v16 offset:20480
v_mfma_f32_16x16x32_bf16 v[168:171], v[104:107], v[88:91], v[168:171]
ds_read_b64_tr_b16 v[76:77], v16 offset:32768
v_mfma_f32_16x16x32_bf16 v[172:175], v[104:107], v[92:95], v[172:175]
ds_read_b64_tr_b16 v[78:79], v16 offset:36864
v_mfma_f32_16x16x32_bf16 v[224:227], v[120:123], v[80:83], v[224:227]
v_mfma_f32_16x16x32_bf16 v[228:231], v[120:123], v[84:87], v[228:231]
v_mfma_f32_16x16x32_bf16 v[232:235], v[120:123], v[88:91], v[232:235]
v_mfma_f32_16x16x32_bf16 v[236:239], v[120:123], v[92:95], v[236:239]
v_mfma_f32_16x16x32_bf16 v[176:179], v[108:111], v[80:83], v[176:179]
v_mfma_f32_16x16x32_bf16 v[180:183], v[108:111], v[84:87], v[180:183]
v_mfma_f32_16x16x32_bf16 v[184:187], v[108:111], v[88:91], v[184:187]
v_mfma_f32_16x16x32_bf16 v[188:191], v[108:111], v[92:95], v[188:191]
v_mfma_f32_16x16x32_bf16 v[240:243], v[124:127], v[80:83], v[240:243]
v_mfma_f32_16x16x32_bf16 v[244:247], v[124:127], v[84:87], v[244:247]
v_mfma_f32_16x16x32_bf16 v[248:251], v[124:127], v[88:91], v[248:251]
v_mfma_f32_16x16x32_bf16 v[252:255], v[124:127], v[92:95], v[252:255]
s_sub_u32 s41, s41, 1
s_cmp_lg_u32 s41, 0
s_cbranch_scc1 Lk3_19
s_waitcnt lgkmcnt(0)
v_mfma_f32_16x16x32_bf16 v[128:131], v[48:51], v[32:35], v[128:131]
ds_read_b128 v[80:83], v4 offset:8192
v_mfma_f32_16x16x32_bf16 v[132:135], v[48:51], v[36:39], v[132:135]
ds_read_b64_tr_b16 v[96:97], v13 offset:24576
v_mfma_f32_16x16x32_bf16 v[136:139], v[48:51], v[40:43], v[136:139]
ds_read_b64_tr_b16 v[98:99], v13 offset:28672
v_mfma_f32_16x16x32_bf16 v[140:143], v[48:51], v[44:47], v[140:143]
ds_read_b128 v[84:87], v4 offset:8448
v_mfma_f32_16x16x32_bf16 v[192:195], v[64:67], v[32:35], v[192:195]
ds_read_b128 v[88:91], v4 offset:8704
v_mfma_f32_16x16x32_bf16 v[196:199], v[64:67], v[36:39], v[196:199]
ds_read_b128 v[92:95], v4 offset:8960
v_mfma_f32_16x16x32_bf16 v[200:203], v[64:67], v[40:43], v[200:203]
ds_read_b64_tr_b16 v[112:113], v13 offset:40960
v_mfma_f32_16x16x32_bf16 v[204:207], v[64:67], v[44:47], v[204:207]
ds_read_b64_tr_b16 v[114:115], v13 offset:45056
v_mfma_f32_16x16x32_bf16 v[144:147], v[52:55], v[32:35], v[144:147]
ds_read_b64_tr_b16 v[100:101], v14 offset:24576
v_mfma_f32_16x16x32_bf16 v[148:151], v[52:55], v[36:39], v[148:151]
ds_read_b64_tr_b16 v[102:103], v14 offset:28672
v_mfma_f32_16x16x32_bf16 v[152:155], v[52:55], v[40:43], v[152:155]
ds_read_b64_tr_b16 v[116:117], v14 offset:40960
v_mfma_f32_16x16x32_bf16 v[156:159], v[52:55], v[44:47], v[156:159]
ds_read_b64_tr_b16 v[118:119], v14 offset:45056
v_mfma_f32_16x16x32_bf16 v[208:211], v[68:71], v[32:35], v[208:211]
ds_read_b64_tr_b16 v[104:105], v15 offset:24576
v_mfma_f32_16x16x32_bf16 v[212:215], v[68:71], v[36:39], v[212:215]
ds_read_b64_tr_b16 v[106:107], v15 offset:28672
v_mfma_f32_16x16x32_bf16 v[216:219], v[68:71], v[40:43], v[216:219]
ds_read_b64_tr_b16 v[120:121], v15 offset:40960
v_mfma_f32_16x16x32_bf16 v[220:223], v[68:71], v[44:47], v[220:223]
ds_read_b64_tr_b16 v[122:123], v15 offset:45056
v_mfma_f32_16x16x32_bf16 v[160:163], v[56:59], v[32:35], v[160:163]
ds_read_b64_tr_b16 v[108:109], v16 offset:24576
v_mfma_f32_16x16x32_bf16 v[164:167], v[56:59], v[36:39], v[164:167]
ds_read_b64_tr_b16 v[110:111], v16 offset:28672
v_mfma_f32_16x16x32_bf16 v[168:171], v[56:59], v[40:43], v[168:171]
ds_read_b64_tr_b16 v[124:125], v16 offset:40960
v_mfma_f32_16x16x32_bf16 v[172:175], v[56:59], v[44:47], v[172:175]
ds_read_b64_tr_b16 v[126:127], v16 offset:45056
v_mfma_f32_16x16x32_bf16 v[224:227], v[72:75], v[32:35], v[224:227]
v_mfma_f32_16x16x32_bf16 v[228:231], v[72:75], v[36:39], v[228:231]
v_mfma_f32_16x16x32_bf16 v[232:235], v[72:75], v[40:43], v[232:235]
v_mfma_f32_16x16x32_bf16 v[236:239], v[72:75], v[44:47], v[236:239]
v_mfma_f32_16x16x32_bf16 v[176:179], v[60:63], v[32:35], v[176:179]
v_mfma_f32_16x16x32_bf16 v[180:183], v[60:63], v[36:39], v[180:183]
v_mfma_f32_16x16x32_bf16 v[184:187], v[60:63], v[40:43], v[184:187]
v_mfma_f32_16x16x32_bf16 v[188:191], v[60:63], v[44:47], v[188:191]
v_mfma_f32_16x16x32_bf16 v[240:243], v[76:79], v[32:35], v[240:243]
v_mfma_f32_16x16x32_bf16 v[244:247], v[76:79], v[36:39], v[244:247]
v_mfma_f32_16x16x32_bf16 v[248:251], v[76:79], v[40:43], v[248:251]
v_mfma_f32_16x16x32_bf16 v[252:255], v[76:79], v[44:47], v[252:255]
s_waitcnt lgkmcnt(0)
s_barrier
s_cmp_eq_u32 s36, 3
s_cbranch_scc1 L3h_20
s_add_u32 m0, s39, 98304
s_add_u32 s37, s37, s38
buffer_load_dwordx4 v22, s[8:11], s37 offen sc1 lds
v_mfma_f32_16x16x32_bf16 v[128:131], v[96:99], v[80:83], v[128:131]
v_mfma_f32_16x16x32_bf16 v[132:135], v[96:99], v[84:87], v[132:135]
s_add_u32 m0, s39, 99328
s_add_u32 s37, s37, s38
buffer_load_dwordx4 v23, s[8:11], s37 offen sc1 lds
v_mfma_f32_16x16x32_bf16 v[136:139], v[96:99], v[88:91], v[136:139]
v_mfma_f32_16x16x32_bf16 v[140:143], v[96:99], v[92:95], v[140:143]
s_add_u32 m0, s39, 100352
s_add_u32 s37, s37, s38
buffer_load_dwordx4 v22, s[8:11], s37 offen sc1 lds
v_mfma_f32_16x16x32_bf16 v[192:195], v[112:115], v[80:83], v[192:195]
v_mfma_f32_16x16x32_bf16 v[196:199], v[112:115], v[84:87], v[196:199]
s_add_u32 m0, s39, 101376
s_add_u32 s37, s37, s38
buffer_load_dwordx4 v23, s[8:11], s37 offen sc1 lds
v_mfma_f32_16x16x32_bf16 v[200:203], v[112:115], v[88:91], v[200:203]
v_mfma_f32_16x16x32_bf16 v[204:207], v[112:115], v[92:95], v[204:207]
s_add_u32 m0, s39, 102400
s_add_u32 s37, s37, s38
buffer_load_dwordx4 v22, s[8:11], s37 offen sc1 lds
v_mfma_f32_16x16x32_bf16 v[144:147], v[100:103], v[80:83], v[144:147]
v_mfma_f32_16x16x32_bf16 v[148:151], v[100:103], v[84:87], v[148:151]
s_add_u32 m0, s39, 103424
s_add_u32 s37, s37, s38
buffer_load_dwordx4 v23, s[8:11], s37 offen sc1 lds
v_mfma_f32_16x16x32_bf16 v[152:155], v[100:103], v[88:91], v[152:155]
v_mfma_f32_16x16x32_bf16 v[156:159], v[100:103], v[92:95], v[156:159]
s_add_u32 m0, s39, 104448
s_add_u32 s37, s37, s38
buffer_load_dwordx4 v22, s[8:11], s37 offen sc1 lds
v_mfma_f32_16x16x32_bf16 v[208:211], v[116:119], v[80:83], v[208:211]
v_mfma_f32_16x16x32_bf16 v[212:215], v[116:119], v[84:87], v[212:215]
s_add_u32 m0, s39, 105472
s_add_u32 s37, s37, s38
buffer_load_dwordx4 v23, s[8:11], s37 offen sc1 lds
v_mfma_f32_16x16x32_bf16 v[216:219], v[116:119], v[88:91], v[216:219]
v_mfma_f32_16x16x32_bf16 v[220:223], v[116:119], v[92:95], v[220:223]
s_add_u32 m0, s39, 106496
s_add_u32 s37, s37, s38
buffer_load_dwordx4 v22, s[8:11], s37 offen sc1 lds
v_mfma_f32_16x16x32_bf16 v[160:163], v[104:107], v[80:83], v[160:163]
v_mfma_f32_16x16x32_bf16 v[164:167], v[104:107], v[84:87], v[164:167]
s_add_u32 m0, s39, 107520
s_add_u32 s37, s37, s38
buffer_load_dwordx4 v23, s[8:11], s37 offen sc1 lds
v_mfma_f32_16x16x32_bf16 v[168:171], v[104:107], v[88:91], v[168:171]
v_mfma_f32_16x16x32_bf16 v[172:175], v[104:107], v[92:95], v[172:175]
s_add_u32 m0, s39, 108544
s_add_u32 s37, s37, s38
buffer_load_dwordx4 v22, s[8:11], s37 offen sc1 lds
v_mfma_f32_16x16x32_bf16 v[224:227], v[120:123], v[80:83], v[224:227]
v_mfma_f32_16x16x32_bf16 v[228:231], v[120:123], v[84:87], v[228:231]
s_add_u32 m0, s39, 109568
s_add_u32 s37, s37, s38
buffer_load_dwordx4 v23, s[8:11], s37 offen sc1 lds
v_mfma_f32_16x16x32_bf16 v[232:235], v[120:123], v[88:91], v[232:235]
v_mfma_f32_16x16x32_bf16 v[236:239], v[120:123], v[92:95], v[236:239]
s_add_u32 m0, s39, 110592
s_add_u32 s37, s37, s38
buffer_load_dwordx4 v22, s[8:11], s37 offen sc1 lds
v_mfma_f32_16x16x32_bf16 v[176:179], v[108:111], v[80:83], v[176:179]
v_mfma_f32_16x16x32_bf16 v[180:183], v[108:111], v[84:87], v[180:183]
s_add_u32 m0, s39, 111616
s_add_u32 s37, s37, s38
buffer_load_dwordx4 v23, s[8:11], s37 offen sc1 lds
v_mfma_f32_16x16x32_bf16 v[184:187], v[108:111], v[88:91], v[184:187]
v_mfma_f32_16x16x32_bf16 v[188:191], v[108:111], v[92:95], v[188:191]
s_add_u32 m0, s39, 112640
s_add_u32 s37, s37, s38
buffer_load_dwordx4 v22, s[8:11], s37 offen sc1 lds
v_mfma_f32_16x16x32_bf16 v[240:243], v[124:127], v[80:83], v[240:243]
v_mfma_f32_16x16x32_bf16 v[244:247], v[124:127], v[84:87], v[244:247]
s_add_u32 m0, s39, 113664
s_add_u32 s37, s37, s38
buffer_load_dwordx4 v23, s[8:11], s37 offen sc1 lds
v_mfma_f32_16x16x32_bf16 v[248:251], v[124:127], v[88:91], v[248:251]
v_mfma_f32_16x16x32_bf16 v[252:255], v[124:127], v[92:95], v[252:255]
s_setprio 0
s_lshl_b32 s43, s46, 9
s_add_u32 s43, s43, 147456
v_lshl_add_u32 v19, v17, 3, s43
ds_read_b64 v[80:81], v19 offset:0
ds_read_b64 v[82:83], v19 offset:128
ds_read_b64 v[84:85], v19 offset:256
ds_read_b64 v[86:87], v19 offset:384
s_mul_i32 s43, s47, 256
s_add_u32 s43, s43, 148480
v_lshl_add_u32 v19, v18, 4, s43
ds_read_b128 v[48:51], v19 offset:0
ds_read_b128 v[52:55], v19 offset:64
ds_read_b128 v[56:59], v19 offset:128
ds_read_b128 v[60:63], v19 offset:192
ds_read_b128 v[64:67], v19 offset:896
ds_read_b128 v[68:71], v19 offset:960
ds_read_b128 v[72:75], v19 offset:1024
ds_read_b128 v[76:79], v19 offset:1088
s_waitcnt lgkmcnt(0)
v_mov_b32 v32, v80
v_mul_f32 v88, v81, v81
v_mul_f32 v36, 0xc0135761, v81
v_mul_f32 v89, 0xbdd2d3e8, v81
v_rcp_f32 v44, v88
v_mul_f32 v40, v89, v88
v_mov_b32 v33, v82
v_mul_f32 v88, v83, v83
v_mul_f32 v37, 0xc0135761, v83
v_mul_f32 v89, 0xbdd2d3e8, v83
v_rcp_f32 v45, v88
v_mul_f32 v41, v89, v88
v_mov_b32 v34, v84
v_mul_f32 v88, v85, v85
v_mul_f32 v38, 0xc0135761, v85
v_mul_f32 v89, 0xbdd2d3e8, v85
v_rcp_f32 v46, v88
v_mul_f32 v42, v89, v88
v_mov_b32 v35, v86
v_mul_f32 v88, v87, v87
v_mul_f32 v39, 0xc0135761, v87
v_mul_f32 v89, 0xbdd2d3e8, v87
v_rcp_f32 v47, v88
v_mul_f32 v43, v89, v88
s_barrier
s_add_u32 m0, s39, 0
s_add_u32 s37, s37, s38
buffer_load_dwordx4 v22, s[8:11], s37 offen sc1 lds
v_fma_f32 v128, -v32, v48, v128
v_fma_f32 v129, -v32, v49, v129
v_fma_f32 v130, -v32, v50, v130
s_add_u32 m0, s39, 1024
s_add_u32 s37, s37, s38
buffer_load_dwordx4 v23, s[8:11], s37 offen sc1 lds
v_fma_f32 v131, -v32, v51, v131
v_fma_f32 v192, -v32, v64, v192
v_fma_f32 v193, -v32, v65, v193
s_add_u32 m0, s39, 2048
s_add_u32 s37, s37, s38
buffer_load_dwordx4 v22, s[8:11], s37 offen sc1 lds
v_fma_f32 v194, -v32, v66, v194
v_fma_f32 v195, -v32, v67, v195
v_mul_f32 v80, v128, v128
s_add_u32 m0, s39, 3072
s_add_u32 s37, s37, s38
buffer_load_dwordx4 v23, s[8:11], s37 offen sc1 lds
v_mul_f32 v81, v129, v129
v_mul_f32 v82, v130, v130
v_mul_f32 v83, v131, v131
s_add_u32 m0, s39, 4096
s_add_u32 s37, s37, s38
buffer_load_dwordx4 v22, s[8:11], s37 offen sc1 lds
v_fma_f32 v80, v80, v40, v36
v_fma_f32 v81, v81, v40, v36
v_fma_f32 v82, v82, v40, v36
s_add_u32 m0, s39, 5120
s_add_u32 s37, s37, s38
buffer_load_dwordx4 v23, s[8:11], s37 offen sc1 lds
v_fma_f32 v83, v83, v40, v36
v_mul_f32 v80, v80, v128
v_mul_f32 v81, v81, v129
s_add_u32 m0, s39, 6144
s_add_u32 s37, s37, s38
buffer_load_dwordx4 v22, s[8:11], s37 offen sc1 lds
v_mul_f32 v82, v82, v130
v_mul_f32 v83, v83, v131
v_exp_f32 v80, v80
s_add_u32 m0, s39, 7168
s_add_u32 s37, s37, s38
buffer_load_dwordx4 v23, s[8:11], s37 offen sc1 lds
v_exp_f32 v81, v81
v_exp_f32 v82, v82
v_exp_f32 v83, v83
s_add_u32 m0, s39, 8192
s_add_u32 s37, s37, s38
buffer_load_dwordx4 v22, s[8:11], s37 offen sc1 lds
v_mul_f32 v192, v128, v192
v_mul_f32 v193, v129, v193
v_mul_f32 v194, v130, v194
s_add_u32 m0, s39, 9216
s_add_u32 s37, s37, s38
buffer_load_dwordx4 v23, s[8:11], s37 offen sc1 lds
v_mul_f32 v195, v131, v195
v_fma_f32 v80, v80, v44, v44
v_fma_f32 v81, v81, v44, v44
s_add_u32 m0, s39, 10240
s_add_u32 s37, s37, s38
buffer_load_dwordx4 v22, s[8:11], s37 offen sc1 lds
v_fma_f32 v82, v82, v44, v44
v_fma_f32 v83, v83, v44, v44
v_rcp_f32 v80, v80
s_add_u32 m0, s39, 11264
s_add_u32 s37, s37, s38
buffer_load_dwordx4 v23, s[8:11], s37 offen sc1 lds
v_rcp_f32 v81, v81
v_rcp_f32 v82, v82
v_rcp_f32 v83, v83
s_add_u32 m0, s39, 12288
s_add_u32 s37, s37, s38
buffer_load_dwordx4 v22, s[8:11], s37 offen sc1 lds
v_mul_f32 v192, v192, v80
v_mul_f32 v193, v193, v81
v_mul_f32 v194, v194, v82
s_add_u32 m0, s39, 13312
s_add_u32 s37, s37, s38
buffer_load_dwordx4 v23, s[8:11], s37 offen sc1 lds
v_mul_f32 v195, v195, v83
v_cvt_pk_bf16_f32 v96, v192, v193
v_cvt_pk_bf16_f32 v97, v194, v195
s_add_u32 m0, s39, 14336
s_add_u32 s37, s37, s38
buffer_load_dwordx4 v22, s[8:11], s37 offen sc1 lds
v_fma_f32 v144, -v32, v52, v144
v_fma_f32 v145, -v32, v53, v145
v_fma_f32 v146, -v32, v54, v146
s_add_u32 m0, s39, 15360
s_add_u32 s37, s37, s38
buffer_load_dwordx4 v23, s[8:11], s37 offen sc1 lds
v_fma_f32 v147, -v32, v55, v147
v_fma_f32 v208, -v32, v68, v208
v_fma_f32 v209, -v32, v69, v209
s_waitcnt vmcnt(16)
s_barrier
s_add_u32 m0, s39, 49152
s_add_u32 s37, s37, s38
buffer_load_dwordx4 v22, s[8:11], s37 offen sc1 lds
v_fma_f32 v210, -v32, v70, v210
v_fma_f32 v211, -v32, v71, v211
v_mul_f32 v84, v144, v144
v_mul_f32 v85, v145, v145
s_add_u32 m0, s39, 50176
s_add_u32 s37, s37, s38
buffer_load_dwordx4 v23, s[8:11], s37 offen sc1 lds
v_mul_f32 v86, v146, v146
v_mul_f32 v87, v147, v147
v_fma_f32 v84, v84, v40, v36
v_fma_f32 v85, v85, v40, v36
s_add_u32 m0, s39, 51200
s_add_u32 s37, s37, s38
buffer_load_dwordx4 v22, s[8:11], s37 offen sc1 lds
v_fma_f32 v86, v86, v40, v36
v_fma_f32 v87, v87, v40, v36
v_mul_f32 v84, v84, v144
v_mul_f32 v85, v85, v145
s_add_u32 m0, s39, 52224
s_add_u32 s37, s37, s38
buffer_load_dwordx4 v23, s[8:11], s37 offen sc1 lds
v_mul_f32 v86, v86, v146
v_mul_f32 v87, v87, v147
v_exp_f32 v84, v84
v_exp_f32 v85, v85
s_add_u32 m0, s39, 53248
s_add_u32 s37, s37, s38
buffer_load_dwordx4 v22, s[8:11], s37 offen sc1 lds
v_exp_f32 v86, v86
v_exp_f32 v87, v87
v_mul_f32 v208, v144, v208
v_mul_f32 v209, v145, v209
s_add_u32 m0, s39, 54272
s_add_u32 s37, s37, s38
buffer_load_dwordx4 v23, s[8:11], s37 offen sc1 lds
v_mul_f32 v210, v146, v210
v_mul_f32 v211, v147, v211
v_fma_f32 v84, v84, v44, v44
v_fma_f32 v85, v85, v44, v44
s_add_u32 m0, s39, 55296
s_add_u32 s37, s37, s38
buffer_load_dwordx4 v22, s[8:11], s37 offen sc1 lds
v_fma_f32 v86, v86, v44, v44
v_fma_f32 v87, v87, v44, v44
v_rcp_f32 v84, v84
v_rcp_f32 v85, v85
s_add_u32 m0, s39, 56320
s_add_u32 s37, s37, s38
buffer_load_dwordx4 v23, s[8:11], s37 offen sc1 lds
v_rcp_f32 v86, v86
v_rcp_f32 v87, v87
v_mul_f32 v208, v208, v84
v_mul_f32 v209, v209, v85
s_add_u32 m0, s39, 57344
s_add_u32 s37, s37, s38
buffer_load_dwordx4 v22, s[8:11], s37 offen sc1 lds
v_mul_f32 v210, v210, v86
v_mul_f32 v211, v211, v87
v_cvt_pk_bf16_f32 v98, v208, v209
v_cvt_pk_bf16_f32 v99, v210, v211
s_add_u32 m0, s39, 58368
s_add_u32 s37, s37, s38
buffer_load_dwordx4 v23, s[8:11], s37 offen sc1 lds
v_fma_f32 v132, -v33, v48, v132
v_fma_f32 v133, -v33, v49, v133
v_fma_f32 v134, -v33, v50, v134
s_add_u32 m0, s39, 59392
s_add_u32 s37, s37, s38
buffer_load_dwordx4 v22, s[8:11], s37 offen sc1 lds
v_fma_f32 v135, -v33, v51, v135
v_fma_f32 v196, -v33, v64, v196
v_fma_f32 v197, -v33, v65, v197
v_fma_f32 v198, -v33, v66, v198
s_add_u32 m0, s39, 60416
s_add_u32 s37, s37, s38
buffer_load_dwordx4 v23, s[8:11], s37 offen sc1 lds
v_fma_f32 v199, -v33, v67, v199
v_mul_f32 v80, v132, v132
v_mul_f32 v81, v133, v133
v_mul_f32 v82, v134, v134
s_add_u32 m0, s39, 61440
s_add_u32 s37, s37, s38
buffer_load_dwordx4 v22, s[8:11], s37 offen sc1 lds
v_mul_f32 v83, v135, v135
v_lshlrev_b32 v19, 11, v18
v_lshl_add_u32 v19, v17, 4, v19
s_lshl_b32 s43, s36, 9
s_add_u32 m0, s39, 62464
s_add_u32 s37, s37, s38
buffer_load_dwordx4 v23, s[8:11], s37 offen sc1 lds
v_add_u32 v2, s43, v19
v_add_u32 v3, 49152, v2
v_add_u32 v4, 98304, v2
v_lshrrev_b32 v19, 2, v17
s_add_u32 m0, s39, 63488
s_add_u32 s37, s37, s38
buffer_load_dwordx4 v22, s[8:11], s37 offen sc1 lds
v_lshl_add_u32 v20, v18, 2, v19
v_bfe_u32 v21, v20, 1, 2
v_lshlrev_b32 v20, 7, v20
v_lshl_add_u32 v20, v21, 5, v20
s_add_u32 m0, s39, 64512
s_add_u32 s37, s37, s38
buffer_load_dwordx4 v23, s[8:11], s37 offen sc1 lds
v_and_b32 v19, 3, v1
v_lshl_add_u32 v20, v19, 3, v20
v_add_u32 v5, 16384, v20
buffer_store_dwordx4 v[96:99], v27, s[24:27], 0 offen offset:0 sc1
s_waitcnt vmcnt(17)
s_barrier
s_add_u32 m0, s39, 98304
s_add_u32 s37, s37, s38
buffer_load_dwordx4 v22, s[8:11], s37 offen sc1 lds
v_fma_f32 v80, v80, v41, v37
v_fma_f32 v81, v81, v41, v37
v_fma_f32 v82, v82, v41, v37
v_fma_f32 v83, v83, v41, v37
s_add_u32 m0, s39, 99328
s_add_u32 s37, s37, s38
buffer_load_dwordx4 v23, s[8:11], s37 offen sc1 lds
v_mul_f32 v80, v80, v132
v_mul_f32 v81, v81, v133
v_mul_f32 v82, v82, v134
v_mul_f32 v83, v83, v135
s_add_u32 m0, s39, 100352
s_add_u32 s37, s37, s38
buffer_load_dwordx4 v22, s[8:11], s37 offen sc1 lds
v_exp_f32 v80, v80
v_exp_f32 v81, v81
v_exp_f32 v82, v82
v_exp_f32 v83, v83
s_add_u32 m0, s39, 101376
s_add_u32 s37, s37, s38
buffer_load_dwordx4 v23, s[8:11], s37 offen sc1 lds
v_mul_f32 v196, v132, v196
v_mul_f32 v197, v133, v197
v_mul_f32 v198, v134, v198
s_add_u32 m0, s39, 102400
s_add_u32 s37, s37, s38
buffer_load_dwordx4 v22, s[8:11], s37 offen sc1 lds
v_mul_f32 v199, v135, v199
v_fma_f32 v80, v80, v45, v45
v_fma_f32 v81, v81, v45, v45
v_fma_f32 v82, v82, v45, v45
s_add_u32 m0, s39, 103424
s_add_u32 s37, s37, s38
buffer_load_dwordx4 v23, s[8:11], s37 offen sc1 lds
v_fma_f32 v83, v83, v45, v45
v_rcp_f32 v80, v80
v_rcp_f32 v81, v81
v_rcp_f32 v82, v82
s_add_u32 m0, s39, 104448
s_add_u32 s37, s37, s38
buffer_load_dwordx4 v22, s[8:11], s37 offen sc1 lds
v_rcp_f32 v83, v83
v_mul_f32 v196, v196, v80
v_mul_f32 v197, v197, v81
s_add_u32 m0, s39, 105472
s_add_u32 s37, s37, s38
buffer_load_dwordx4 v23, s[8:11], s37 offen sc1 lds
v_mul_f32 v198, v198, v82
v_mul_f32 v199, v199, v83
v_cvt_pk_bf16_f32 v100, v196, v197
v_cvt_pk_bf16_f32 v101, v198, v199
s_add_u32 m0, s39, 106496
s_add_u32 s37, s37, s38
buffer_load_dwordx4 v22, s[8:11], s37 offen sc1 lds
v_fma_f32 v148, -v33, v52, v148
v_fma_f32 v149, -v33, v53, v149
v_fma_f32 v150, -v33, v54, v150
v_fma_f32 v151, -v33, v55, v151
s_add_u32 m0, s39, 107520
s_add_u32 s37, s37, s38
buffer_load_dwordx4 v23, s[8:11], s37 offen sc1 lds
v_fma_f32 v212, -v33, v68, v212
v_fma_f32 v213, -v33, v69, v213
v_fma_f32 v214, -v33, v70, v214
s_add_u32 m0, s39, 108544
s_add_u32 s37, s37, s38
buffer_load_dwordx4 v22, s[8:11], s37 offen sc1 lds
v_fma_f32 v215, -v33, v71, v215
v_mul_f32 v84, v148, v148
v_mul_f32 v85, v149, v149
v_mul_f32 v86, v150, v150
s_add_u32 m0, s39, 109568
s_add_u32 s37, s37, s38
buffer_load_dwordx4 v23, s[8:11], s37 offen sc1 lds
v_mul_f32 v87, v151, v151
v_fma_f32 v84, v84, v41, v37
v_fma_f32 v85, v85, v41, v37
v_fma_f32 v86, v86, v41, v37
s_add_u32 m0, s39, 110592
s_add_u32 s37, s37, s38
buffer_load_dwordx4 v22, s[8:11], s37 offen sc1 lds
v_fma_f32 v87, v87, v41, v37
v_mul_f32 v84, v84, v148
v_mul_f32 v85, v85, v149
s_add_u32 m0, s39, 111616
s_add_u32 s37, s37, s38
buffer_load_dwordx4 v23, s[8:11], s37 offen sc1 lds
v_xor_b32 v6, 32, v5
v_xor_b32 v7, 64, v5
v_xor_b32 v8, 96, v5
v_add_u32 v9, 49152, v5
s_add_u32 m0, s39, 112640
s_add_u32 s37, s37, s38
buffer_load_dwordx4 v22, s[8:11], s37 offen sc1 lds
v_add_u32 v10, 49152, v6
v_add_u32 v11, 49152, v7
v_add_u32 v12, 49152, v8
v_add_u32 v13, 98304, v5
s_add_u32 m0, s39, 113664
s_add_u32 s37, s37, s38
buffer_load_dwordx4 v23, s[8:11], s37 offen sc1 lds
v_add_u32 v14, 98304, v6
v_add_u32 v15, 98304, v7
v_add_u32 v16, 98304, v8
s_waitcnt vmcnt(17)
s_barrier
s_add_u32 m0, s39, 0
s_add_u32 s37, s37, s38
buffer_load_dwordx4 v22, s[8:11], s37 offen sc1 lds
v_mul_f32 v86, v86, v150
v_mul_f32 v87, v87, v151
v_exp_f32 v84, v84
v_exp_f32 v85, v85
s_add_u32 m0, s39, 1024
s_add_u32 s37, s37, s38
buffer_load_dwordx4 v23, s[8:11], s37 offen sc1 lds
v_exp_f32 v86, v86
v_exp_f32 v87, v87
v_mul_f32 v212, v148, v212
s_add_u32 m0, s39, 2048
s_add_u32 s37, s37, s38
buffer_load_dwordx4 v22, s[8:11], s37 offen sc1 lds
v_mul_f32 v213, v149, v213
v_mul_f32 v214, v150, v214
v_mul_f32 v215, v151, v215
s_add_u32 m0, s39, 3072
s_add_u32 s37, s37, s38
buffer_load_dwordx4 v23, s[8:11], s37 offen sc1 lds
v_fma_f32 v84, v84, v45, v45
v_fma_f32 v85, v85, v45, v45
v_fma_f32 v86, v86, v45, v45
s_add_u32 m0, s39, 4096
s_add_u32 s37, s37, s38
buffer_load_dwordx4 v22, s[8:11], s37 offen sc1 lds
v_fma_f32 v87, v87, v45, v45
v_rcp_f32 v84, v84
v_rcp_f32 v85, v85
s_add_u32 m0, s39, 5120
s_add_u32 s37, s37, s38
buffer_load_dwordx4 v23, s[8:11], s37 offen sc1 lds
v_rcp_f32 v86, v86
v_rcp_f32 v87, v87
v_mul_f32 v212, v212, v84
s_add_u32 m0, s39, 6144
s_add_u32 s37, s37, s38
buffer_load_dwordx4 v22, s[8:11], s37 offen sc1 lds
v_mul_f32 v213, v213, v85
v_mul_f32 v214, v214, v86
v_mul_f32 v215, v215, v87
s_add_u32 m0, s39, 7168
s_add_u32 s37, s37, s38
buffer_load_dwordx4 v23, s[8:11], s37 offen sc1 lds
v_cvt_pk_bf16_f32 v102, v212, v213
v_cvt_pk_bf16_f32 v103, v214, v215
s_add_u32 m0, s39, 8192
s_add_u32 s37, s37, s38
buffer_load_dwordx4 v22, s[8:11], s37 offen sc1 lds
v_fma_f32 v136, -v34, v48, v136
v_fma_f32 v137, -v34, v49, v137
v_fma_f32 v138, -v34, v50, v138
s_add_u32 m0, s39, 9216
s_add_u32 s37, s37, s38
buffer_load_dwordx4 v23, s[8:11], s37 offen sc1 lds
v_fma_f32 v139, -v34, v51, v139
v_fma_f32 v200, -v34, v64, v200
v_fma_f32 v201, -v34, v65, v201
s_add_u32 m0, s39, 10240
s_add_u32 s37, s37, s38
buffer_load_dwordx4 v22, s[8:11], s37 offen sc1 lds
v_fma_f32 v202, -v34, v66, v202
v_fma_f32 v203, -v34, v67, v203
v_mul_f32 v80, v136, v136
s_add_u32 m0, s39, 11264
s_add_u32 s37, s37, s38
buffer_load_dwordx4 v23, s[8:11], s37 offen sc1 lds
v_mul_f32 v81, v137, v137
v_mul_f32 v82, v138, v138
v_mul_f32 v83, v139, v139
s_add_u32 m0, s39, 12288
s_add_u32 s37, s37, s38
buffer_load_dwordx4 v22, s[8:11], s37 offen sc1 lds
v_fma_f32 v80, v80, v42, v38
v_fma_f32 v81, v81, v42, v38
v_fma_f32 v82, v82, v42, v38
s_add_u32 m0, s39, 13312
s_add_u32 s37, s37, s38
buffer_load_dwordx4 v23, s[8:11], s37 offen sc1 lds
v_fma_f32 v83, v83, v42, v38
v_mul_f32 v80, v80, v136
v_mul_f32 v81, v81, v137
s_add_u32 m0, s39, 14336
s_add_u32 s37, s37, s38
buffer_load_dwordx4 v22, s[8:11], s37 offen sc1 lds
v_mul_f32 v82, v82, v138
v_mul_f32 v83, v83, v139
v_exp_f32 v80, v80
s_add_u32 m0, s39, 15360
s_add_u32 s37, s37, s38
buffer_load_dwordx4 v23, s[8:11], s37 offen sc1 lds
v_exp_f32 v81, v81
v_exp_f32 v82, v82
v_exp_f32 v83, v83
buffer_store_dwordx4 v[100:103], v27, s[24:27], 0 offen offset:256 sc1
s_waitcnt vmcnt(17)
s_barrier
s_add_u32 m0, s39, 49152
s_add_u32 s37, s37, s38
buffer_load_dwordx4 v22, s[8:11], s37 offen sc1 lds
v_mul_f32 v200, v136, v200
v_mul_f32 v201, v137, v201
v_mul_f32 v202, v138, v202
s_add_u32 m0, s39, 50176
s_add_u32 s37, s37, s38
buffer_load_dwordx4 v23, s[8:11], s37 offen sc1 lds
v_mul_f32 v203, v139, v203
v_fma_f32 v80, v80, v46, v46
v_fma_f32 v81, v81, v46, v46
s_add_u32 m0, s39, 51200
s_add_u32 s37, s37, s38
buffer_load_dwordx4 v22, s[8:11], s37 offen sc1 lds
v_fma_f32 v82, v82, v46, v46
v_fma_f32 v83, v83, v46, v46
v_rcp_f32 v80, v80
s_add_u32 m0, s39, 52224
s_add_u32 s37, s37, s38
buffer_load_dwordx4 v23, s[8:11], s37 offen sc1 lds
v_rcp_f32 v81, v81
v_rcp_f32 v82, v82
v_rcp_f32 v83, v83
s_add_u32 m0, s39, 53248
s_add_u32 s37, s37, s38
buffer_load_dwordx4 v22, s[8:11], s37 offen sc1 lds
v_mul_f32 v200, v200, v80
v_mul_f32 v201, v201, v81
v_mul_f32 v202, v202, v82
s_add_u32 m0, s39, 54272
s_add_u32 s37, s37, s38
buffer_load_dwordx4 v23, s[8:11], s37 offen sc1 lds
v_mul_f32 v203, v203, v83
v_cvt_pk_bf16_f32 v104, v200, v201
v_cvt_pk_bf16_f32 v105, v202, v203
s_add_u32 m0, s39, 55296
s_add_u32 s37, s37, s38
buffer_load_dwordx4 v22, s[8:11], s37 offen sc1 lds
v_fma_f32 v152, -v34, v52, v152
v_fma_f32 v153, -v34, v53, v153
v_fma_f32 v154, -v34, v54, v154
s_add_u32 m0, s39, 56320
s_add_u32 s37, s37, s38
buffer_load_dwordx4 v23, s[8:11], s37 offen sc1 lds
v_fma_f32 v155, -v34, v55, v155
v_fma_f32 v216, -v34, v68, v216
v_fma_f32 v217, -v34, v69, v217
s_add_u32 m0, s39, 57344
s_add_u32 s37, s37, s38
buffer_load_dwordx4 v22, s[8:11], s37 offen sc1 lds
v_fma_f32 v218, -v34, v70, v218
v_fma_f32 v219, -v34, v71, v219
v_mul_f32 v84, v152, v152
s_add_u32 m0, s39, 58368
s_add_u32 s37, s37, s38
buffer_load_dwordx4 v23, s[8:11], s37 offen sc1 lds
v_mul_f32 v85, v153, v153
v_mul_f32 v86, v154, v154
v_mul_f32 v87, v155, v155
s_add_u32 m0, s39, 59392
s_add_u32 s37, s37, s38
buffer_load_dwordx4 v22, s[8:11], s37 offen sc1 lds
v_fma_f32 v84, v84, v42, v38
v_fma_f32 v85, v85, v42, v38
v_fma_f32 v86, v86, v42, v38
s_add_u32 m0, s39, 60416
s_add_u32 s37, s37, s38
buffer_load_dwordx4 v23, s[8:11], s37 offen sc1 lds
v_fma_f32 v87, v87, v42, v38
v_mul_f32 v84, v84, v152
v_mul_f32 v85, v85, v153
s_add_u32 m0, s39, 61440
s_add_u32 s37, s37, s38
buffer_load_dwordx4 v22, s[8:11], s37 offen sc1 lds
v_mul_f32 v86, v86, v154
v_mul_f32 v87, v87, v155
v_exp_f32 v84, v84
s_add_u32 m0, s39, 62464
s_add_u32 s37, s37, s38
buffer_load_dwordx4 v23, s[8:11], s37 offen sc1 lds
v_exp_f32 v85, v85
v_exp_f32 v86, v86
v_exp_f32 v87, v87
s_add_u32 m0, s39, 63488
s_add_u32 s37, s37, s38
buffer_load_dwordx4 v22, s[8:11], s37 offen sc1 lds
v_mul_f32 v216, v152, v216
v_mul_f32 v217, v153, v217
v_mul_f32 v218, v154, v218
s_add_u32 m0, s39, 64512
s_add_u32 s37, s37, s38
buffer_load_dwordx4 v23, s[8:11], s37 offen sc1 lds
v_mul_f32 v219, v155, v219
v_fma_f32 v84, v84, v46, v46
v_fma_f32 v85, v85, v46, v46
s_waitcnt vmcnt(17)
s_barrier
s_add_u32 m0, s39, 98304
s_add_u32 s37, s37, s38
buffer_load_dwordx4 v22, s[8:11], s37 offen sc1 lds
v_fma_f32 v86, v86, v46, v46
v_fma_f32 v87, v87, v46, v46
v_rcp_f32 v84, v84
v_rcp_f32 v85, v85
s_add_u32 m0, s39, 99328
s_add_u32 s37, s37, s38
buffer_load_dwordx4 v23, s[8:11], s37 offen sc1 lds
v_rcp_f32 v86, v86
v_rcp_f32 v87, v87
v_mul_f32 v216, v216, v84
s_add_u32 m0, s39, 100352
s_add_u32 s37, s37, s38
buffer_load_dwordx4 v22, s[8:11], s37 offen sc1 lds
v_mul_f32 v217, v217, v85
v_mul_f32 v218, v218, v86
v_mul_f32 v219, v219, v87
s_add_u32 m0, s39, 101376
s_add_u32 s37, s37, s38
buffer_load_dwordx4 v23, s[8:11], s37 offen sc1 lds
v_cvt_pk_bf16_f32 v106, v216, v217
v_cvt_pk_bf16_f32 v107, v218, v219
s_add_u32 m0, s39, 102400
s_add_u32 s37, s37, s38
buffer_load_dwordx4 v22, s[8:11], s37 offen sc1 lds
v_fma_f32 v140, -v35, v48, v140
v_fma_f32 v141, -v35, v49, v141
v_fma_f32 v142, -v35, v50, v142
s_add_u32 m0, s39, 103424
s_add_u32 s37, s37, s38
buffer_load_dwordx4 v23, s[8:11], s37 offen sc1 lds
v_fma_f32 v143, -v35, v51, v143
v_fma_f32 v204, -v35, v64, v204
v_fma_f32 v205, -v35, v65, v205
s_add_u32 m0, s39, 104448
s_add_u32 s37, s37, s38
buffer_load_dwordx4 v22, s[8:11], s37 offen sc1 lds
v_fma_f32 v206, -v35, v66, v206
v_fma_f32 v207, -v35, v67, v207
v_mul_f32 v80, v140, v140
s_add_u32 m0, s39, 105472
s_add_u32 s37, s37, s38
buffer_load_dwordx4 v23, s[8:11], s37 offen sc1 lds
v_mul_f32 v81, v141, v141
v_mul_f32 v82, v142, v142
v_mul_f32 v83, v143, v143
s_add_u32 m0, s39, 106496
s_add_u32 s37, s37, s38
buffer_load_dwordx4 v22, s[8:11], s37 offen sc1 lds
v_fma_f32 v80, v80, v43, v39
v_fma_f32 v81, v81, v43, v39
v_fma_f32 v82, v82, v43, v39
s_add_u32 m0, s39, 107520
s_add_u32 s37, s37, s38
buffer_load_dwordx4 v23, s[8:11], s37 offen sc1 lds
v_fma_f32 v83, v83, v43, v39
v_mul_f32 v80, v80, v140
v_mul_f32 v81, v81, v141
s_add_u32 m0, s39, 108544
s_add_u32 s37, s37, s38
buffer_load_dwordx4 v22, s[8:11], s37 offen sc1 lds
v_mul_f32 v82, v82, v142
v_mul_f32 v83, v83, v143
v_exp_f32 v80, v80
s_add_u32 m0, s39, 109568
s_add_u32 s37, s37, s38
buffer_load_dwordx4 v23, s[8:11], s37 offen sc1 lds
v_exp_f32 v81, v81
v_exp_f32 v82, v82
v_exp_f32 v83, v83
s_add_u32 m0, s39, 110592
s_add_u32 s37, s37, s38
buffer_load_dwordx4 v22, s[8:11], s37 offen sc1 lds
v_mul_f32 v204, v140, v204
v_mul_f32 v205, v141, v205
v_mul_f32 v206, v142, v206
s_add_u32 m0, s39, 111616
s_add_u32 s37, s37, s38
buffer_load_dwordx4 v23, s[8:11], s37 offen sc1 lds
v_mul_f32 v207, v143, v207
v_fma_f32 v80, v80, v47, v47
v_fma_f32 v81, v81, v47, v47
s_add_u32 m0, s39, 112640
s_add_u32 s37, s37, s38
buffer_load_dwordx4 v22, s[8:11], s37 offen sc1 lds
v_fma_f32 v82, v82, v47, v47
v_fma_f32 v83, v83, v47, v47
v_rcp_f32 v80, v80
s_add_u32 m0, s39, 113664
s_add_u32 s37, s37, s38
buffer_load_dwordx4 v23, s[8:11], s37 offen sc1 lds
v_rcp_f32 v81, v81
v_rcp_f32 v82, v82
v_rcp_f32 v83, v83
buffer_store_dwordx4 v[104:107], v27, s[24:27], 0 offen offset:512 sc1
s_waitcnt vmcnt(17)
s_barrier
s_add_u32 m0, s39, 0
s_add_u32 s37, s37, s38
buffer_load_dwordx4 v22, s[8:11], s37 offen sc1 lds
v_mul_f32 v204, v204, v80
v_mul_f32 v205, v205, v81
v_mul_f32 v206, v206, v82
v_mul_f32 v207, v207, v83
s_add_u32 m0, s39, 1024
s_add_u32 s37, s37, s38
buffer_load_dwordx4 v23, s[8:11], s37 offen sc1 lds
v_cvt_pk_bf16_f32 v108, v204, v205
v_cvt_pk_bf16_f32 v109, v206, v207
v_fma_f32 v156, -v35, v52, v156
s_add_u32 m0, s39, 2048
s_add_u32 s37, s37, s38
buffer_load_dwordx4 v22, s[8:11], s37 offen sc1 lds
v_fma_f32 v157, -v35, v53, v157
v_fma_f32 v158, -v35, v54, v158
v_fma_f32 v159, -v35, v55, v159
s_add_u32 m0, s39, 3072
s_add_u32 s37, s37, s38
buffer_load_dwordx4 v23, s[8:11], s37 offen sc1 lds
v_fma_f32 v220, -v35, v68, v220
v_fma_f32 v221, -v35, v69, v221
v_fma_f32 v222, -v35, v70, v222
s_add_u32 m0, s39, 4096
s_add_u32 s37, s37, s38
buffer_load_dwordx4 v22, s[8:11], s37 offen sc1 lds
v_fma_f32 v223, -v35, v71, v223
v_mul_f32 v84, v156, v156
v_mul_f32 v85, v157, v157
s_add_u32 m0, s39, 5120
s_add_u32 s37, s37, s38
buffer_load_dwordx4 v23, s[8:11], s37 offen sc1 lds
v_mul_f32 v86, v158, v158
v_mul_f32 v87, v159, v159
v_fma_f32 v84, v84, v43, v39
s_add_u32 m0, s39, 6144
s_add_u32 s37, s37, s38
buffer_load_dwordx4 v22, s[8:11], s37 offen sc1 lds
v_fma_f32 v85, v85, v43, v39
v_fma_f32 v86, v86, v43, v39
v_fma_f32 v87, v87, v43, v39
s_add_u32 m0, s39, 7168
s_add_u32 s37, s37, s38
buffer_load_dwordx4 v23, s[8:11], s37 offen sc1 lds
v_mul_f32 v84, v84, v156
v_mul_f32 v85, v85, v157
v_mul_f32 v86, v86, v158
s_add_u32 m0, s39, 8192
s_add_u32 s37, s37, s38
buffer_load_dwordx4 v22, s[8:11], s37 offen sc1 lds
v_mul_f32 v87, v87, v159
v_exp_f32 v84, v84
v_exp_f32 v85, v85
s_add_u32 m0, s39, 9216
s_add_u32 s37, s37, s38
buffer_load_dwordx4 v23, s[8:11], s37 offen sc1 lds
v_exp_f32 v86, v86
v_exp_f32 v87, v87
v_mul_f32 v220, v156, v220
s_add_u32 m0, s39, 10240
s_add_u32 s37, s37, s38
buffer_load_dwordx4 v22, s[8:11], s37 offen sc1 lds
v_mul_f32 v221, v157, v221
v_mul_f32 v222, v158, v222
v_mul_f32 v223, v159, v223
s_add_u32 m0, s39, 11264
s_add_u32 s37, s37, s38
buffer_load_dwordx4 v23, s[8:11], s37 offen sc1 lds
v_fma_f32 v84, v84, v47, v47
v_fma_f32 v85, v85, v47, v47
v_fma_f32 v86, v86, v47, v47
s_add_u32 m0, s39, 12288
s_add_u32 s37, s37, s38
buffer_load_dwordx4 v22, s[8:11], s37 offen sc1 lds
v_fma_f32 v87, v87, v47, v47
v_rcp_f32 v84, v84
v_rcp_f32 v85, v85
s_add_u32 m0, s39, 13312
s_add_u32 s37, s37, s38
buffer_load_dwordx4 v23, s[8:11], s37 offen sc1 lds
v_rcp_f32 v86, v86
v_rcp_f32 v87, v87
v_mul_f32 v220, v220, v84
s_add_u32 m0, s39, 14336
s_add_u32 s37, s37, s38
buffer_load_dwordx4 v22, s[8:11], s37 offen sc1 lds
v_mul_f32 v221, v221, v85
v_mul_f32 v222, v222, v86
v_mul_f32 v223, v223, v87
s_add_u32 m0, s39, 15360
s_add_u32 s37, s37, s38
buffer_load_dwordx4 v23, s[8:11], s37 offen sc1 lds
v_cvt_pk_bf16_f32 v110, v220, v221
v_cvt_pk_bf16_f32 v111, v222, v223
buffer_store_dwordx4 v[108:111], v27, s[24:27], 0 offen offset:768 sc1
s_waitcnt vmcnt(18)
s_barrier
s_add_u32 m0, s39, 49152
s_add_u32 s37, s37, s38
buffer_load_dwordx4 v22, s[8:11], s37 offen sc1 lds
v_fma_f32 v160, -v32, v56, v160
v_fma_f32 v161, -v32, v57, v161
v_fma_f32 v162, -v32, v58, v162
v_fma_f32 v163, -v32, v59, v163
s_add_u32 m0, s39, 50176
s_add_u32 s37, s37, s38
buffer_load_dwordx4 v23, s[8:11], s37 offen sc1 lds
v_fma_f32 v224, -v32, v72, v224
v_fma_f32 v225, -v32, v73, v225
v_fma_f32 v226, -v32, v74, v226
s_add_u32 m0, s39, 51200
s_add_u32 s37, s37, s38
buffer_load_dwordx4 v22, s[8:11], s37 offen sc1 lds
v_fma_f32 v227, -v32, v75, v227
v_mul_f32 v80, v160, v160
v_mul_f32 v81, v161, v161
v_mul_f32 v82, v162, v162
s_add_u32 m0, s39, 52224
s_add_u32 s37, s37, s38
buffer_load_dwordx4 v23, s[8:11], s37 offen sc1 lds
v_mul_f32 v83, v163, v163
v_fma_f32 v80, v80, v40, v36
v_fma_f32 v81, v81, v40, v36
s_add_u32 m0, s39, 53248
s_add_u32 s37, s37, s38
buffer_load_dwordx4 v22, s[8:11], s37 offen sc1 lds
v_fma_f32 v82, v82, v40, v36
v_fma_f32 v83, v83, v40, v36
v_mul_f32 v80, v80, v160
v_mul_f32 v81, v81, v161
s_add_u32 m0, s39, 54272
s_add_u32 s37, s37, s38
buffer_load_dwordx4 v23, s[8:11], s37 offen sc1 lds
v_mul_f32 v82, v82, v162
v_mul_f32 v83, v83, v163
v_exp_f32 v80, v80
s_add_u32 m0, s39, 55296
s_add_u32 s37, s37, s38
buffer_load_dwordx4 v22, s[8:11], s37 offen sc1 lds
v_exp_f32 v81, v81
v_exp_f32 v82, v82
v_exp_f32 v83, v83
v_mul_f32 v224, v160, v224
s_add_u32 m0, s39, 56320
s_add_u32 s37, s37, s38
buffer_load_dwordx4 v23, s[8:11], s37 offen sc1 lds
v_mul_f32 v225, v161, v225
v_mul_f32 v226, v162, v226
v_mul_f32 v227, v163, v227
s_add_u32 m0, s39, 57344
s_add_u32 s37, s37, s38
buffer_load_dwordx4 v22, s[8:11], s37 offen sc1 lds
v_fma_f32 v80, v80, v44, v44
v_fma_f32 v81, v81, v44, v44
v_fma_f32 v82, v82, v44, v44
v_fma_f32 v83, v83, v44, v44
s_add_u32 m0, s39, 58368
s_add_u32 s37, s37, s38
buffer_load_dwordx4 v23, s[8:11], s37 offen sc1 lds
v_rcp_f32 v80, v80
v_rcp_f32 v81, v81
v_rcp_f32 v82, v82
s_add_u32 m0, s39, 59392
s_add_u32 s37, s37, s38
buffer_load_dwordx4 v22, s[8:11], s37 offen sc1 lds
v_rcp_f32 v83, v83
v_mul_f32 v224, v224, v80
v_mul_f32 v225, v225, v81
v_mul_f32 v226, v226, v82
s_add_u32 m0, s39, 60416
s_add_u32 s37, s37, s38
buffer_load_dwordx4 v23, s[8:11], s37 offen sc1 lds
v_mul_f32 v227, v227, v83
v_cvt_pk_bf16_f32 v96, v224, v225
v_cvt_pk_bf16_f32 v97, v226, v227
s_add_u32 m0, s39, 61440
s_add_u32 s37, s37, s38
buffer_load_dwordx4 v22, s[8:11], s37 offen sc1 lds
v_fma_f32 v176, -v32, v60, v176
v_fma_f32 v177, -v32, v61, v177
v_fma_f32 v178, -v32, v62, v178
v_fma_f32 v179, -v32, v63, v179
s_add_u32 m0, s39, 62464
s_add_u32 s37, s37, s38
buffer_load_dwordx4 v23, s[8:11], s37 offen sc1 lds
v_fma_f32 v240, -v32, v76, v240
v_fma_f32 v241, -v32, v77, v241
v_lshlrev_b32 v19, 11, v18
s_add_u32 m0, s39, 63488
s_add_u32 s37, s37, s38
buffer_load_dwordx4 v22, s[8:11], s37 offen sc1 lds
v_lshl_add_u32 v19, v17, 4, v19
s_lshl_b32 s43, s36, 9
v_add_u32 v208, s43, v19
buffer_load_dwordx4 v[192:195], v208, s[20:23], 0 offen offset:0 sc1
s_add_u32 m0, s39, 64512
s_add_u32 s37, s37, s38
buffer_load_dwordx4 v23, s[8:11], s37 offen sc1 lds
buffer_load_dwordx4 v[196:199], v208, s[20:23], s50 offen offset:0 sc1
buffer_load_dwordx4 v[200:203], v208, s[20:23], 0 offen offset:256 sc1
buffer_load_dwordx4 v[204:207], v208, s[20:23], s50 offen offset:256 sc1
s_waitcnt vmcnt(20)
s_barrier
s_add_u32 m0, s39, 98304
s_add_u32 s37, s37, s38
buffer_load_dwordx4 v22, s[8:11], s37 offen sc1 lds
v_fma_f32 v242, -v32, v78, v242
v_fma_f32 v243, -v32, v79, v243
v_mul_f32 v84, v176, v176
v_mul_f32 v85, v177, v177
s_add_u32 m0, s39, 99328
s_add_u32 s37, s37, s38
buffer_load_dwordx4 v23, s[8:11], s37 offen sc1 lds
v_mul_f32 v86, v178, v178
v_mul_f32 v87, v179, v179
v_fma_f32 v84, v84, v40, v36
s_add_u32 m0, s39, 100352
s_add_u32 s37, s37, s38
buffer_load_dwordx4 v22, s[8:11], s37 offen sc1 lds
v_fma_f32 v85, v85, v40, v36
v_fma_f32 v86, v86, v40, v36
v_fma_f32 v87, v87, v40, v36
s_add_u32 m0, s39, 101376
s_add_u32 s37, s37, s38
buffer_load_dwordx4 v23, s[8:11], s37 offen sc1 lds
v_mul_f32 v84, v84, v176
v_mul_f32 v85, v85, v177
v_mul_f32 v86, v86, v178
s_add_u32 m0, s39, 102400
s_add_u32 s37, s37, s38
buffer_load_dwordx4 v22, s[8:11], s37 offen sc1 lds
v_mul_f32 v87, v87, v179
v_exp_f32 v84, v84
v_exp_f32 v85, v85
s_add_u32 m0, s39, 103424
s_add_u32 s37, s37, s38
buffer_load_dwordx4 v23, s[8:11], s37 offen sc1 lds
v_exp_f32 v86, v86
v_exp_f32 v87, v87
v_mul_f32 v240, v176, v240
s_add_u32 m0, s39, 104448
s_add_u32 s37, s37, s38
buffer_load_dwordx4 v22, s[8:11], s37 offen sc1 lds
v_mul_f32 v241, v177, v241
v_mul_f32 v242, v178, v242
v_mul_f32 v243, v179, v243
s_add_u32 m0, s39, 105472
s_add_u32 s37, s37, s38
buffer_load_dwordx4 v23, s[8:11], s37 offen sc1 lds
v_fma_f32 v84, v84, v44, v44
v_fma_f32 v85, v85, v44, v44
v_fma_f32 v86, v86, v44, v44
s_add_u32 m0, s39, 106496
s_add_u32 s37, s37, s38
buffer_load_dwordx4 v22, s[8:11], s37 offen sc1 lds
v_fma_f32 v87, v87, v44, v44
v_rcp_f32 v84, v84
v_rcp_f32 v85, v85
s_add_u32 m0, s39, 107520
s_add_u32 s37, s37, s38
buffer_load_dwordx4 v23, s[8:11], s37 offen sc1 lds
v_rcp_f32 v86, v86
v_rcp_f32 v87, v87
v_mul_f32 v240, v240, v84
s_add_u32 m0, s39, 108544
s_add_u32 s37, s37, s38
buffer_load_dwordx4 v22, s[8:11], s37 offen sc1 lds
v_mul_f32 v241, v241, v85
v_mul_f32 v242, v242, v86
v_mul_f32 v243, v243, v87
s_add_u32 m0, s39, 109568
s_add_u32 s37, s37, s38
buffer_load_dwordx4 v23, s[8:11], s37 offen sc1 lds
v_cvt_pk_bf16_f32 v98, v240, v241
v_cvt_pk_bf16_f32 v99, v242, v243
s_add_u32 m0, s39, 110592
s_add_u32 s37, s37, s38
buffer_load_dwordx4 v22, s[8:11], s37 offen sc1 lds
v_fma_f32 v164, -v33, v56, v164
v_fma_f32 v165, -v33, v57, v165
v_fma_f32 v166, -v33, v58, v166
s_add_u32 m0, s39, 111616
s_add_u32 s37, s37, s38
buffer_load_dwordx4 v23, s[8:11], s37 offen sc1 lds
v_fma_f32 v167, -v33, v59, v167
v_fma_f32 v228, -v33, v72, v228
v_fma_f32 v229, -v33, v73, v229
s_add_u32 m0, s39, 112640
s_add_u32 s37, s37, s38
buffer_load_dwordx4 v22, s[8:11], s37 offen sc1 lds
v_fma_f32 v230, -v33, v74, v230
v_fma_f32 v231, -v33, v75, v231
v_mul_f32 v80, v164, v164
s_add_u32 m0, s39, 113664
s_add_u32 s37, s37, s38
buffer_load_dwordx4 v23, s[8:11], s37 offen sc1 lds
v_mul_f32 v81, v165, v165
v_mul_f32 v82, v166, v166
v_mul_f32 v83, v167, v167
buffer_store_dwordx4 v[96:99], v27, s[24:27], s53 offen offset:0 sc1
s_waitcnt vmcnt(20)
s_barrier
s_add_u32 m0, s39, 0
s_add_u32 s37, s37, s38
buffer_load_dwordx4 v22, s[8:11], s37 offen sc1 lds
v_fma_f32 v80, v80, v41, v37
v_fma_f32 v81, v81, v41, v37
v_fma_f32 v82, v82, v41, v37
s_add_u32 m0, s39, 1024
s_add_u32 s37, s37, s38
buffer_load_dwordx4 v23, s[8:11], s37 offen sc1 lds
v_fma_f32 v83, v83, v41, v37
v_mul_f32 v80, v80, v164
v_mul_f32 v81, v81, v165
s_add_u32 m0, s39, 2048
s_add_u32 s37, s37, s38
buffer_load_dwordx4 v22, s[8:11], s37 offen sc1 lds
v_mul_f32 v82, v82, v166
v_mul_f32 v83, v83, v167
v_exp_f32 v80, v80
s_add_u32 m0, s39, 3072
s_add_u32 s37, s37, s38
buffer_load_dwordx4 v23, s[8:11], s37 offen sc1 lds
v_exp_f32 v81, v81
v_exp_f32 v82, v82
v_exp_f32 v83, v83
s_add_u32 m0, s39, 4096
s_add_u32 s37, s37, s38
buffer_load_dwordx4 v22, s[8:11], s37 offen sc1 lds
v_mul_f32 v228, v164, v228
v_mul_f32 v229, v165, v229
v_mul_f32 v230, v166, v230
s_add_u32 m0, s39, 5120
s_add_u32 s37, s37, s38
buffer_load_dwordx4 v23, s[8:11], s37 offen sc1 lds
v_mul_f32 v231, v167, v231
v_fma_f32 v80, v80, v45, v45
v_fma_f32 v81, v81, v45, v45
s_add_u32 m0, s39, 6144
s_add_u32 s37, s37, s38
buffer_load_dwordx4 v22, s[8:11], s37 offen sc1 lds
v_fma_f32 v82, v82, v45, v45
v_fma_f32 v83, v83, v45, v45
v_rcp_f32 v80, v80
s_add_u32 m0, s39, 7168
s_add_u32 s37, s37, s38
buffer_load_dwordx4 v23, s[8:11], s37 offen sc1 lds
v_rcp_f32 v81, v81
v_rcp_f32 v82, v82
v_rcp_f32 v83, v83
s_add_u32 m0, s39, 8192
s_add_u32 s37, s37, s38
buffer_load_dwordx4 v22, s[8:11], s37 offen sc1 lds
v_mul_f32 v228, v228, v80
v_mul_f32 v229, v229, v81
v_mul_f32 v230, v230, v82
s_add_u32 m0, s39, 9216
s_add_u32 s37, s37, s38
buffer_load_dwordx4 v23, s[8:11], s37 offen sc1 lds
v_mul_f32 v231, v231, v83
v_cvt_pk_bf16_f32 v100, v228, v229
v_cvt_pk_bf16_f32 v101, v230, v231
s_add_u32 m0, s39, 10240
s_add_u32 s37, s37, s38
buffer_load_dwordx4 v22, s[8:11], s37 offen sc1 lds
v_fma_f32 v180, -v33, v60, v180
v_fma_f32 v181, -v33, v61, v181
v_fma_f32 v182, -v33, v62, v182
s_add_u32 m0, s39, 11264
s_add_u32 s37, s37, s38
buffer_load_dwordx4 v23, s[8:11], s37 offen sc1 lds
v_fma_f32 v183, -v33, v63, v183
v_fma_f32 v244, -v33, v76, v244
v_fma_f32 v245, -v33, v77, v245
s_add_u32 m0, s39, 12288
s_add_u32 s37, s37, s38
buffer_load_dwordx4 v22, s[8:11], s37 offen sc1 lds
v_fma_f32 v246, -v33, v78, v246
v_fma_f32 v247, -v33, v79, v247
v_mul_f32 v84, v180, v180
s_add_u32 m0, s39, 13312
s_add_u32 s37, s37, s38
buffer_load_dwordx4 v23, s[8:11], s37 offen sc1 lds
v_mul_f32 v85, v181, v181
v_mul_f32 v86, v182, v182
v_mul_f32 v87, v183, v183
s_add_u32 m0, s39, 14336
s_add_u32 s37, s37, s38
buffer_load_dwordx4 v22, s[8:11], s37 offen sc1 lds
v_fma_f32 v84, v84, v41, v37
v_fma_f32 v85, v85, v41, v37
v_fma_f32 v86, v86, v41, v37
s_add_u32 m0, s39, 15360
s_add_u32 s37, s37, s38
buffer_load_dwordx4 v23, s[8:11], s37 offen sc1 lds
v_fma_f32 v87, v87, v41, v37
v_mul_f32 v84, v84, v180
v_mul_f32 v85, v85, v181
s_waitcnt vmcnt(17)
s_barrier
s_add_u32 m0, s39, 49152
s_add_u32 s37, s37, s38
buffer_load_dwordx4 v22, s[8:11], s37 offen sc1 lds
v_mul_f32 v86, v86, v182
v_mul_f32 v87, v87, v183
v_exp_f32 v84, v84
v_exp_f32 v85, v85
v_exp_f32 v86, v86
s_add_u32 m0, s39, 50176
s_add_u32 s37, s37, s38
buffer_load_dwordx4 v23, s[8:11], s37 offen sc1 lds
v_exp_f32 v87, v87
v_mul_f32 v244, v180, v244
v_mul_f32 v245, v181, v245
v_mul_f32 v246, v182, v246
s_add_u32 m0, s39, 51200
s_add_u32 s37, s37, s38
buffer_load_dwordx4 v22, s[8:11], s37 offen sc1 lds
v_mul_f32 v247, v183, v247
v_fma_f32 v84, v84, v45, v45
v_fma_f32 v85, v85, v45, v45
v_fma_f32 v86, v86, v45, v45
s_add_u32 m0, s39, 52224
s_add_u32 s37, s37, s38
buffer_load_dwordx4 v23, s[8:11], s37 offen sc1 lds
v_fma_f32 v87, v87, v45, v45
v_rcp_f32 v84, v84
v_rcp_f32 v85, v85
v_rcp_f32 v86, v86
s_add_u32 m0, s39, 53248
s_add_u32 s37, s37, s38
buffer_load_dwordx4 v22, s[8:11], s37 offen sc1 lds
v_rcp_f32 v87, v87
v_mul_f32 v244, v244, v84
v_mul_f32 v245, v245, v85
v_mul_f32 v246, v246, v86
s_add_u32 m0, s39, 54272
s_add_u32 s37, s37, s38
buffer_load_dwordx4 v23, s[8:11], s37 offen sc1 lds
v_mul_f32 v247, v247, v87
v_cvt_pk_bf16_f32 v102, v244, v245
v_cvt_pk_bf16_f32 v103, v246, v247
s_add_u32 m0, s39, 55296
s_add_u32 s37, s37, s38
buffer_load_dwordx4 v22, s[8:11], s37 offen sc1 lds
v_fma_f32 v168, -v34, v56, v168
v_fma_f32 v169, -v34, v57, v169
v_fma_f32 v170, -v34, v58, v170
v_fma_f32 v171, -v34, v59, v171
s_add_u32 m0, s39, 56320
s_add_u32 s37, s37, s38
buffer_load_dwordx4 v23, s[8:11], s37 offen sc1 lds
v_fma_f32 v232, -v34, v72, v232
v_fma_f32 v233, -v34, v73, v233
v_fma_f32 v234, -v34, v74, v234
v_fma_f32 v235, -v34, v75, v235
s_add_u32 m0, s39, 57344
s_add_u32 s37, s37, s38
buffer_load_dwordx4 v22, s[8:11], s37 offen sc1 lds
v_mul_f32 v80, v168, v168
v_mul_f32 v81, v169, v169
v_mul_f32 v82, v170, v170
v_mul_f32 v83, v171, v171
s_add_u32 m0, s39, 58368
s_add_u32 s37, s37, s38
buffer_load_dwordx4 v23, s[8:11], s37 offen sc1 lds
v_fma_f32 v80, v80, v42, v38
v_fma_f32 v81, v81, v42, v38
v_fma_f32 v82, v82, v42, v38
v_fma_f32 v83, v83, v42, v38
s_add_u32 m0, s39, 59392
s_add_u32 s37, s37, s38
buffer_load_dwordx4 v22, s[8:11], s37 offen sc1 lds
v_mul_f32 v80, v80, v168
v_mul_f32 v81, v81, v169
v_mul_f32 v82, v82, v170
v_mul_f32 v83, v83, v171
s_add_u32 m0, s39, 60416
s_add_u32 s37, s37, s38
buffer_load_dwordx4 v23, s[8:11], s37 offen sc1 lds
v_exp_f32 v80, v80
v_exp_f32 v81, v81
v_exp_f32 v82, v82
v_exp_f32 v83, v83
s_add_u32 m0, s39, 61440
s_add_u32 s37, s37, s38
buffer_load_dwordx4 v22, s[8:11], s37 offen sc1 lds
v_lshlrev_b32 v128, 16, v192
v_and_b32 v129, 0xffff0000, v192
v_lshlrev_b32 v130, 16, v193
v_and_b32 v131, 0xffff0000, v193
s_add_u32 m0, s39, 62464
s_add_u32 s37, s37, s38
buffer_load_dwordx4 v23, s[8:11], s37 offen sc1 lds
v_lshlrev_b32 v132, 16, v194
v_and_b32 v133, 0xffff0000, v194
v_lshlrev_b32 v134, 16, v195
v_and_b32 v135, 0xffff0000, v195
s_add_u32 m0, s39, 63488
s_add_u32 s37, s37, s38
buffer_load_dwordx4 v22, s[8:11], s37 offen sc1 lds
v_lshlrev_b32 v136, 16, v196
v_and_b32 v137, 0xffff0000, v196
v_lshlrev_b32 v138, 16, v197
v_and_b32 v139, 0xffff0000, v197
s_add_u32 m0, s39, 64512
s_add_u32 s37, s37, s38
buffer_load_dwordx4 v23, s[8:11], s37 offen sc1 lds
v_lshlrev_b32 v140, 16, v198
v_and_b32 v141, 0xffff0000, v198
v_lshlrev_b32 v142, 16, v199
v_and_b32 v143, 0xffff0000, v199
buffer_store_dwordx4 v[100:103], v27, s[24:27], s53 offen offset:256 sc1
s_waitcnt vmcnt(17)
s_barrier
s_add_u32 m0, s39, 98304
s_add_u32 s37, s37, s38
buffer_load_dwordx4 v22, s[8:11], s37 offen sc1 lds
v_mul_f32 v232, v168, v232
v_mul_f32 v233, v169, v233
v_mul_f32 v234, v170, v234
v_mul_f32 v235, v171, v235
s_add_u32 m0, s39, 99328
s_add_u32 s37, s37, s38
buffer_load_dwordx4 v23, s[8:11], s37 offen sc1 lds
v_fma_f32 v80, v80, v46, v46
v_fma_f32 v81, v81, v46, v46
v_fma_f32 v82, v82, v46, v46
v_fma_f32 v83, v83, v46, v46
s_add_u32 m0, s39, 100352
s_add_u32 s37, s37, s38
buffer_load_dwordx4 v22, s[8:11], s37 offen sc1 lds
v_rcp_f32 v80, v80
v_rcp_f32 v81, v81
v_rcp_f32 v82, v82
v_rcp_f32 v83, v83
s_add_u32 m0, s39, 101376
s_add_u32 s37, s37, s38
buffer_load_dwordx4 v23, s[8:11], s37 offen sc1 lds
v_mul_f32 v232, v232, v80
v_mul_f32 v233, v233, v81
v_mul_f32 v234, v234, v82
v_mul_f32 v235, v235, v83
s_add_u32 m0, s39, 102400
s_add_u32 s37, s37, s38
buffer_load_dwordx4 v22, s[8:11], s37 offen sc1 lds
v_cvt_pk_bf16_f32 v104, v232, v233
v_cvt_pk_bf16_f32 v105, v234, v235
v_fma_f32 v184, -v34, v60, v184
v_fma_f32 v185, -v34, v61, v185
s_add_u32 m0, s39, 103424
s_add_u32 s37, s37, s38
buffer_load_dwordx4 v23, s[8:11], s37 offen sc1 lds
v_fma_f32 v186, -v34, v62, v186
v_fma_f32 v187, -v34, v63, v187
v_fma_f32 v248, -v34, v76, v248
v_fma_f32 v249, -v34, v77, v249
s_add_u32 m0, s39, 104448
s_add_u32 s37, s37, s38
buffer_load_dwordx4 v22, s[8:11], s37 offen sc1 lds
v_fma_f32 v250, -v34, v78, v250
v_fma_f32 v251, -v34, v79, v251
v_mul_f32 v84, v184, v184
v_mul_f32 v85, v185, v185
s_add_u32 m0, s39, 105472
s_add_u32 s37, s37, s38
buffer_load_dwordx4 v23, s[8:11], s37 offen sc1 lds
v_mul_f32 v86, v186, v186
v_mul_f32 v87, v187, v187
v_fma_f32 v84, v84, v42, v38
v_fma_f32 v85, v85, v42, v38
s_add_u32 m0, s39, 106496
s_add_u32 s37, s37, s38
buffer_load_dwordx4 v22, s[8:11], s37 offen sc1 lds
v_fma_f32 v86, v86, v42, v38
v_fma_f32 v87, v87, v42, v38
v_mul_f32 v84, v84, v184
v_mul_f32 v85, v85, v185
s_add_u32 m0, s39, 107520
s_add_u32 s37, s37, s38
buffer_load_dwordx4 v23, s[8:11], s37 offen sc1 lds
v_mul_f32 v86, v86, v186
v_mul_f32 v87, v87, v187
v_exp_f32 v84, v84
v_exp_f32 v85, v85
s_add_u32 m0, s39, 108544
s_add_u32 s37, s37, s38
buffer_load_dwordx4 v22, s[8:11], s37 offen sc1 lds
v_exp_f32 v86, v86
v_exp_f32 v87, v87
v_mul_f32 v248, v184, v248
v_mul_f32 v249, v185, v249
s_add_u32 m0, s39, 109568
s_add_u32 s37, s37, s38
buffer_load_dwordx4 v23, s[8:11], s37 offen sc1 lds
v_mul_f32 v250, v186, v250
v_mul_f32 v251, v187, v251
v_fma_f32 v84, v84, v46, v46
v_fma_f32 v85, v85, v46, v46
s_add_u32 m0, s39, 110592
s_add_u32 s37, s37, s38
buffer_load_dwordx4 v22, s[8:11], s37 offen sc1 lds
v_lshlrev_b32 v144, 16, v200
v_and_b32 v145, 0xffff0000, v200
v_lshlrev_b32 v146, 16, v201
v_and_b32 v147, 0xffff0000, v201
s_add_u32 m0, s39, 111616
s_add_u32 s37, s37, s38
buffer_load_dwordx4 v23, s[8:11], s37 offen sc1 lds
v_lshlrev_b32 v148, 16, v202
v_and_b32 v149, 0xffff0000, v202
v_lshlrev_b32 v150, 16, v203
v_and_b32 v151, 0xffff0000, v203
s_add_u32 m0, s39, 112640
s_add_u32 s37, s37, s38
buffer_load_dwordx4 v22, s[8:11], s37 offen sc1 lds
v_lshlrev_b32 v152, 16, v204
v_and_b32 v153, 0xffff0000, v204
v_lshlrev_b32 v154, 16, v205
v_and_b32 v155, 0xffff0000, v205
s_add_u32 m0, s39, 113664
s_add_u32 s37, s37, s38
buffer_load_dwordx4 v23, s[8:11], s37 offen sc1 lds
v_lshlrev_b32 v156, 16, v206
v_and_b32 v157, 0xffff0000, v206
v_lshlrev_b32 v158, 16, v207
v_and_b32 v159, 0xffff0000, v207
s_waitcnt vmcnt(17)
s_barrier
s_add_u32 m0, s39, 0
s_add_u32 s37, s37, s38
buffer_load_dwordx4 v22, s[8:11], s37 offen sc1 lds
v_fma_f32 v86, v86, v46, v46
v_fma_f32 v87, v87, v46, v46
v_rcp_f32 v84, v84
v_rcp_f32 v85, v85
s_add_u32 m0, s39, 1024
s_add_u32 s37, s37, s38
buffer_load_dwordx4 v23, s[8:11], s37 offen sc1 lds
v_rcp_f32 v86, v86
v_rcp_f32 v87, v87
v_mul_f32 v248, v248, v84
s_add_u32 m0, s39, 2048
s_add_u32 s37, s37, s38
buffer_load_dwordx4 v22, s[8:11], s37 offen sc1 lds
v_mul_f32 v249, v249, v85
v_mul_f32 v250, v250, v86
v_mul_f32 v251, v251, v87
s_add_u32 m0, s39, 3072
s_add_u32 s37, s37, s38
buffer_load_dwordx4 v23, s[8:11], s37 offen sc1 lds
v_cvt_pk_bf16_f32 v106, v248, v249
v_cvt_pk_bf16_f32 v107, v250, v251
s_add_u32 m0, s39, 4096
s_add_u32 s37, s37, s38
buffer_load_dwordx4 v22, s[8:11], s37 offen sc1 lds
v_fma_f32 v172, -v35, v56, v172
v_fma_f32 v173, -v35, v57, v173
v_fma_f32 v174, -v35, v58, v174
s_add_u32 m0, s39, 5120
s_add_u32 s37, s37, s38
buffer_load_dwordx4 v23, s[8:11], s37 offen sc1 lds
v_fma_f32 v175, -v35, v59, v175
v_fma_f32 v236, -v35, v72, v236
v_fma_f32 v237, -v35, v73, v237
s_add_u32 m0, s39, 6144
s_add_u32 s37, s37, s38
buffer_load_dwordx4 v22, s[8:11], s37 offen sc1 lds
v_fma_f32 v238, -v35, v74, v238
v_fma_f32 v239, -v35, v75, v239
v_mul_f32 v80, v172, v172
s_add_u32 m0, s39, 7168
s_add_u32 s37, s37, s38
buffer_load_dwordx4 v23, s[8:11], s37 offen sc1 lds
v_mul_f32 v81, v173, v173
v_mul_f32 v82, v174, v174
v_mul_f32 v83, v175, v175
s_add_u32 m0, s39, 8192
s_add_u32 s37, s37, s38
buffer_load_dwordx4 v22, s[8:11], s37 offen sc1 lds
v_fma_f32 v80, v80, v43, v39
v_fma_f32 v81, v81, v43, v39
v_fma_f32 v82, v82, v43, v39
s_add_u32 m0, s39, 9216
s_add_u32 s37, s37, s38
buffer_load_dwordx4 v23, s[8:11], s37 offen sc1 lds
v_fma_f32 v83, v83, v43, v39
v_mul_f32 v80, v80, v172
v_mul_f32 v81, v81, v173
s_add_u32 m0, s39, 10240
s_add_u32 s37, s37, s38
buffer_load_dwordx4 v22, s[8:11], s37 offen sc1 lds
v_mul_f32 v82, v82, v174
v_mul_f32 v83, v83, v175
v_exp_f32 v80, v80
s_add_u32 m0, s39, 11264
s_add_u32 s37, s37, s38
buffer_load_dwordx4 v23, s[8:11], s37 offen sc1 lds
v_exp_f32 v81, v81
v_exp_f32 v82, v82
v_exp_f32 v83, v83
s_add_u32 m0, s39, 12288
s_add_u32 s37, s37, s38
buffer_load_dwordx4 v22, s[8:11], s37 offen sc1 lds
v_mul_f32 v236, v172, v236
v_mul_f32 v237, v173, v237
v_mul_f32 v238, v174, v238
s_add_u32 m0, s39, 13312
s_add_u32 s37, s37, s38
buffer_load_dwordx4 v23, s[8:11], s37 offen sc1 lds
v_mul_f32 v239, v175, v239
v_fma_f32 v80, v80, v47, v47
v_fma_f32 v81, v81, v47, v47
s_add_u32 m0, s39, 14336
s_add_u32 s37, s37, s38
buffer_load_dwordx4 v22, s[8:11], s37 offen sc1 lds
v_fma_f32 v82, v82, v47, v47
v_fma_f32 v83, v83, v47, v47
v_rcp_f32 v80, v80
s_add_u32 m0, s39, 15360
s_add_u32 s37, s37, s38
buffer_load_dwordx4 v23, s[8:11], s37 offen sc1 lds
v_rcp_f32 v81, v81
v_rcp_f32 v82, v82
v_rcp_f32 v83, v83
buffer_store_dwordx4 v[104:107], v27, s[24:27], s53 offen offset:512 sc1
s_waitcnt vmcnt(17)
s_barrier
s_mul_i32 s44, s34, 917504
s_lshl_b32 s39, s51, 13
s_add_u32 s44, s44, s39
s_add_u32 s44, s44, 8388608
s_lshl_b32 s43, s35, 7
s_mov_b32 s10, 909312
s_movk_i32 s38, 1024
s_movk_i32 s40, 9216
s_cmp_eq_u32 s51, 2
s_cselect_b32 s8, s60, s32
s_cselect_b32 s9, s61, s33
s_cselect_b32 s10, 7338112, s10
s_cselect_b32 s43, s43, s44
s_cselect_b32 s38, 16384, s38
s_cselect_b32 s40, 81920, s40
s_cselect_b32 s55, 81920, s38
s_cselect_b32 s45, -1, 0
s_add_u32 s8, s8, s43
s_addc_u32 s9, s9, 0
s_mov_b32 s11, 0x20000
s_sub_u32 s37, 0, s40
v_lshrrev_b32 v19, 3, v1
v_mul_u32_u24 v19, 1920, v19
v_lshrrev_b32 v20, 4, v1
v_lshlrev_b32 v20, 5, v20
v_and_b32 v19, s45, v19
v_and_b32 v20, s45, v20
v_lshlrev_b32 v21, 4, v1
v_xor_b32 v21, v21, v20
v_add_u32 v21, v21, v19
s_add_u32 m0, s39, 49152
s_add_u32 s37, s37, s40
buffer_load_dwordx4 v21, s[8:11], s37 offen sc1 lds
v_mul_f32 v236, v236, v80
v_mul_f32 v237, v237, v81
v_mul_f32 v238, v238, v82
s_add_u32 m0, s39, 50176
s_add_u32 s37, s37, s38
buffer_load_dwordx4 v21, s[8:11], s37 offen sc1 lds
v_mul_f32 v239, v239, v83
v_cvt_pk_bf16_f32 v108, v236, v237
v_cvt_pk_bf16_f32 v109, v238, v239
s_add_u32 m0, s39, 51200
s_add_u32 s37, s37, s38
buffer_load_dwordx4 v21, s[8:11], s37 offen sc1 lds
v_fma_f32 v188, -v35, v60, v188
v_fma_f32 v189, -v35, v61, v189
v_fma_f32 v190, -v35, v62, v190
s_add_u32 m0, s39, 52224
s_add_u32 s37, s37, s38
buffer_load_dwordx4 v21, s[8:11], s37 offen sc1 lds
v_fma_f32 v191, -v35, v63, v191
v_fma_f32 v252, -v35, v76, v252
v_fma_f32 v253, -v35, v77, v253
s_add_u32 m0, s39, 53248
s_add_u32 s37, s37, s55
buffer_load_dwordx4 v21, s[8:11], s37 offen sc1 lds
v_fma_f32 v254, -v35, v78, v254
v_fma_f32 v255, -v35, v79, v255
v_mul_f32 v84, v188, v188
s_add_u32 m0, s39, 54272
s_add_u32 s37, s37, s38
buffer_load_dwordx4 v21, s[8:11], s37 offen sc1 lds
v_mul_f32 v85, v189, v189
v_mul_f32 v86, v190, v190
v_mul_f32 v87, v191, v191
s_add_u32 m0, s39, 55296
s_add_u32 s37, s37, s38
buffer_load_dwordx4 v21, s[8:11], s37 offen sc1 lds
v_fma_f32 v84, v84, v43, v39
v_fma_f32 v85, v85, v43, v39
v_fma_f32 v86, v86, v43, v39
s_add_u32 m0, s39, 56320
s_add_u32 s37, s37, s38
buffer_load_dwordx4 v21, s[8:11], s37 offen sc1 lds
v_fma_f32 v87, v87, v43, v39
v_mul_f32 v84, v84, v188
v_mul_f32 v85, v85, v189
s_add_u32 m0, s39, 73728
s_add_u32 s37, s37, s40
buffer_load_dwordx4 v21, s[8:11], s37 offen sc1 lds
v_mul_f32 v86, v86, v190
v_mul_f32 v87, v87, v191
v_exp_f32 v84, v84
v_exp_f32 v85, v85
s_add_u32 m0, s39, 74752
s_add_u32 s37, s37, s38
buffer_load_dwordx4 v21, s[8:11], s37 offen sc1 lds
v_exp_f32 v86, v86
v_exp_f32 v87, v87
v_mul_f32 v252, v188, v252
s_add_u32 m0, s39, 75776
s_add_u32 s37, s37, s38
buffer_load_dwordx4 v21, s[8:11], s37 offen sc1 lds
v_mul_f32 v253, v189, v253
v_mul_f32 v254, v190, v254
v_mul_f32 v255, v191, v255
s_add_u32 m0, s39, 76800
s_add_u32 s37, s37, s38
buffer_load_dwordx4 v21, s[8:11], s37 offen sc1 lds
v_fma_f32 v84, v84, v47, v47
v_fma_f32 v85, v85, v47, v47
v_fma_f32 v86, v86, v47, v47
s_add_u32 m0, s39, 77824
s_add_u32 s37, s37, s55
buffer_load_dwordx4 v21, s[8:11], s37 offen sc1 lds
v_fma_f32 v87, v87, v47, v47
v_rcp_f32 v84, v84
v_rcp_f32 v85, v85
s_add_u32 m0, s39, 78848
s_add_u32 s37, s37, s38
buffer_load_dwordx4 v21, s[8:11], s37 offen sc1 lds
v_rcp_f32 v86, v86
v_rcp_f32 v87, v87
v_mul_f32 v252, v252, v84
s_add_u32 m0, s39, 79872
s_add_u32 s37, s37, s38
buffer_load_dwordx4 v21, s[8:11], s37 offen sc1 lds
v_mul_f32 v253, v253, v85
v_mul_f32 v254, v254, v86
v_mul_f32 v255, v255, v87
s_add_u32 m0, s39, 80896
s_add_u32 s37, s37, s38
buffer_load_dwordx4 v21, s[8:11], s37 offen sc1 lds
v_cvt_pk_bf16_f32 v110, v252, v253
v_cvt_pk_bf16_f32 v111, v254, v255
buffer_store_dwordx4 v[108:111], v27, s[24:27], s53 offen offset:768 sc1
s_waitcnt vmcnt(18)
s_barrier
s_add_u32 m0, s39, 98304
s_add_u32 s37, s37, s40
buffer_load_dwordx4 v21, s[8:11], s37 offen sc1 lds
s_add_u32 m0, s39, 99328
s_add_u32 s37, s37, s38
buffer_load_dwordx4 v21, s[8:11], s37 offen sc1 lds
s_add_u32 m0, s39, 100352
s_add_u32 s37, s37, s38
buffer_load_dwordx4 v21, s[8:11], s37 offen sc1 lds
s_add_u32 m0, s39, 101376
s_add_u32 s37, s37, s38
buffer_load_dwordx4 v21, s[8:11], s37 offen sc1 lds
s_add_u32 m0, s39, 102400
s_add_u32 s37, s37, s55
buffer_load_dwordx4 v21, s[8:11], s37 offen sc1 lds
s_add_u32 m0, s39, 103424
s_add_u32 s37, s37, s38
buffer_load_dwordx4 v21, s[8:11], s37 offen sc1 lds
s_add_u32 m0, s39, 104448
s_add_u32 s37, s37, s38
buffer_load_dwordx4 v21, s[8:11], s37 offen sc1 lds
s_add_u32 m0, s39, 105472
s_add_u32 s37, s37, s38
buffer_load_dwordx4 v21, s[8:11], s37 offen sc1 lds
s_add_u32 m0, s39, 122880
s_add_u32 s37, s37, s40
buffer_load_dwordx4 v21, s[8:11], s37 offen sc1 lds
s_add_u32 m0, s39, 123904
s_add_u32 s37, s37, s38
buffer_load_dwordx4 v21, s[8:11], s37 offen sc1 lds
s_add_u32 m0, s39, 124928
s_add_u32 s37, s37, s38
buffer_load_dwordx4 v21, s[8:11], s37 offen sc1 lds
s_add_u32 m0, s39, 125952
s_add_u32 s37, s37, s38
buffer_load_dwordx4 v21, s[8:11], s37 offen sc1 lds
s_add_u32 m0, s39, 126976
s_add_u32 s37, s37, s55
buffer_load_dwordx4 v21, s[8:11], s37 offen sc1 lds
s_add_u32 m0, s39, 128000
s_add_u32 s37, s37, s38
buffer_load_dwordx4 v21, s[8:11], s37 offen sc1 lds
s_add_u32 m0, s39, 129024
s_add_u32 s37, s37, s38
buffer_load_dwordx4 v21, s[8:11], s37 offen sc1 lds
s_add_u32 m0, s39, 130048
s_add_u32 s37, s37, s38
buffer_load_dwordx4 v21, s[8:11], s37 offen sc1 lds
s_waitcnt vmcnt(16)
s_barrier
s_branch LK4_21
L3h_20:
v_mfma_f32_16x16x32_bf16 v[128:131], v[96:99], v[80:83], v[128:131]
v_mfma_f32_16x16x32_bf16 v[132:135], v[96:99], v[84:87], v[132:135]
v_mfma_f32_16x16x32_bf16 v[136:139], v[96:99], v[88:91], v[136:139]
v_mfma_f32_16x16x32_bf16 v[140:143], v[96:99], v[92:95], v[140:143]
v_mfma_f32_16x16x32_bf16 v[192:195], v[112:115], v[80:83], v[192:195]
v_mfma_f32_16x16x32_bf16 v[196:199], v[112:115], v[84:87], v[196:199]
v_mfma_f32_16x16x32_bf16 v[200:203], v[112:115], v[88:91], v[200:203]
v_mfma_f32_16x16x32_bf16 v[204:207], v[112:115], v[92:95], v[204:207]
v_mfma_f32_16x16x32_bf16 v[144:147], v[100:103], v[80:83], v[144:147]
v_mfma_f32_16x16x32_bf16 v[148:151], v[100:103], v[84:87], v[148:151]
v_mfma_f32_16x16x32_bf16 v[152:155], v[100:103], v[88:91], v[152:155]
v_mfma_f32_16x16x32_bf16 v[156:159], v[100:103], v[92:95], v[156:159]
v_mfma_f32_16x16x32_bf16 v[208:211], v[116:119], v[80:83], v[208:211]
v_mfma_f32_16x16x32_bf16 v[212:215], v[116:119], v[84:87], v[212:215]
v_mfma_f32_16x16x32_bf16 v[216:219], v[116:119], v[88:91], v[216:219]
v_mfma_f32_16x16x32_bf16 v[220:223], v[116:119], v[92:95], v[220:223]
v_mfma_f32_16x16x32_bf16 v[160:163], v[104:107], v[80:83], v[160:163]
v_mfma_f32_16x16x32_bf16 v[164:167], v[104:107], v[84:87], v[164:167]
v_mfma_f32_16x16x32_bf16 v[168:171], v[104:107], v[88:91], v[168:171]
v_mfma_f32_16x16x32_bf16 v[172:175], v[104:107], v[92:95], v[172:175]
v_mfma_f32_16x16x32_bf16 v[224:227], v[120:123], v[80:83], v[224:227]
v_mfma_f32_16x16x32_bf16 v[228:231], v[120:123], v[84:87], v[228:231]
v_mfma_f32_16x16x32_bf16 v[232:235], v[120:123], v[88:91], v[232:235]
v_mfma_f32_16x16x32_bf16 v[236:239], v[120:123], v[92:95], v[236:239]
v_mfma_f32_16x16x32_bf16 v[176:179], v[108:111], v[80:83], v[176:179]
v_mfma_f32_16x16x32_bf16 v[180:183], v[108:111], v[84:87], v[180:183]
v_mfma_f32_16x16x32_bf16 v[184:187], v[108:111], v[88:91], v[184:187]
v_mfma_f32_16x16x32_bf16 v[188:191], v[108:111], v[92:95], v[188:191]
v_mfma_f32_16x16x32_bf16 v[240:243], v[124:127], v[80:83], v[240:243]
v_mfma_f32_16x16x32_bf16 v[244:247], v[124:127], v[84:87], v[244:247]
v_mfma_f32_16x16x32_bf16 v[248:251], v[124:127], v[88:91], v[248:251]
v_mfma_f32_16x16x32_bf16 v[252:255], v[124:127], v[92:95], v[252:255]
s_setprio 0
s_lshl_b32 s43, s46, 9
s_add_u32 s43, s43, 147456
v_lshl_add_u32 v19, v17, 3, s43
ds_read_b64 v[80:81], v19 offset:0
ds_read_b64 v[82:83], v19 offset:128
ds_read_b64 v[84:85], v19 offset:256
ds_read_b64 v[86:87], v19 offset:384
s_mul_i32 s43, s47, 256
s_add_u32 s43, s43, 148480
v_lshl_add_u32 v19, v18, 4, s43
ds_read_b128 v[48:51], v19 offset:0
ds_read_b128 v[52:55], v19 offset:64
ds_read_b128 v[56:59], v19 offset:128
ds_read_b128 v[60:63], v19 offset:192
ds_read_b128 v[64:67], v19 offset:896
ds_read_b128 v[68:71], v19 offset:960
ds_read_b128 v[72:75], v19 offset:1024
ds_read_b128 v[76:79], v19 offset:1088
s_waitcnt lgkmcnt(0)
v_mov_b32 v32, v80
v_mul_f32 v88, v81, v81
v_mul_f32 v36, 0xc0135761, v81
v_mul_f32 v89, 0xbdd2d3e8, v81
v_rcp_f32 v44, v88
v_mul_f32 v40, v89, v88
v_mov_b32 v33, v82
v_mul_f32 v88, v83, v83
v_mul_f32 v37, 0xc0135761, v83
v_mul_f32 v89, 0xbdd2d3e8, v83
v_rcp_f32 v45, v88
v_mul_f32 v41, v89, v88
v_mov_b32 v34, v84
v_mul_f32 v88, v85, v85
v_mul_f32 v38, 0xc0135761, v85
v_mul_f32 v89, 0xbdd2d3e8, v85
v_rcp_f32 v46, v88
v_mul_f32 v42, v89, v88
v_mov_b32 v35, v86
v_mul_f32 v88, v87, v87
v_mul_f32 v39, 0xc0135761, v87
v_mul_f32 v89, 0xbdd2d3e8, v87
v_rcp_f32 v47, v88
v_mul_f32 v43, v89, v88
s_barrier
v_fma_f32 v128, -v32, v48, v128
v_fma_f32 v129, -v32, v49, v129
v_fma_f32 v130, -v32, v50, v130
v_fma_f32 v131, -v32, v51, v131
v_fma_f32 v192, -v32, v64, v192
v_fma_f32 v193, -v32, v65, v193
v_fma_f32 v194, -v32, v66, v194
v_fma_f32 v195, -v32, v67, v195
v_mul_f32 v80, v128, v128
v_mul_f32 v81, v129, v129
v_mul_f32 v82, v130, v130
v_mul_f32 v83, v131, v131
v_fma_f32 v80, v80, v40, v36
v_fma_f32 v81, v81, v40, v36
v_fma_f32 v82, v82, v40, v36
v_fma_f32 v83, v83, v40, v36
v_mul_f32 v80, v80, v128
v_mul_f32 v81, v81, v129
v_mul_f32 v82, v82, v130
v_mul_f32 v83, v83, v131
v_exp_f32 v80, v80
v_exp_f32 v81, v81
v_exp_f32 v82, v82
v_exp_f32 v83, v83
v_mul_f32 v192, v128, v192
v_mul_f32 v193, v129, v193
v_mul_f32 v194, v130, v194
v_mul_f32 v195, v131, v195
v_fma_f32 v80, v80, v44, v44
v_fma_f32 v81, v81, v44, v44
v_fma_f32 v82, v82, v44, v44
v_fma_f32 v83, v83, v44, v44
v_rcp_f32 v80, v80
v_rcp_f32 v81, v81
v_rcp_f32 v82, v82
v_rcp_f32 v83, v83
v_mul_f32 v192, v192, v80
v_mul_f32 v193, v193, v81
v_mul_f32 v194, v194, v82
v_mul_f32 v195, v195, v83
v_cvt_pk_bf16_f32 v96, v192, v193
v_cvt_pk_bf16_f32 v97, v194, v195
v_fma_f32 v144, -v32, v52, v144
v_fma_f32 v145, -v32, v53, v145
v_fma_f32 v146, -v32, v54, v146
v_fma_f32 v147, -v32, v55, v147
v_fma_f32 v208, -v32, v68, v208
v_fma_f32 v209, -v32, v69, v209
s_barrier
v_fma_f32 v210, -v32, v70, v210
v_fma_f32 v211, -v32, v71, v211
v_mul_f32 v84, v144, v144
v_mul_f32 v85, v145, v145
v_mul_f32 v86, v146, v146
v_mul_f32 v87, v147, v147
v_fma_f32 v84, v84, v40, v36
v_fma_f32 v85, v85, v40, v36
v_fma_f32 v86, v86, v40, v36
v_fma_f32 v87, v87, v40, v36
v_mul_f32 v84, v84, v144
v_mul_f32 v85, v85, v145
v_mul_f32 v86, v86, v146
v_mul_f32 v87, v87, v147
v_exp_f32 v84, v84
v_exp_f32 v85, v85
v_exp_f32 v86, v86
v_exp_f32 v87, v87
v_mul_f32 v208, v144, v208
v_mul_f32 v209, v145, v209
v_mul_f32 v210, v146, v210
v_mul_f32 v211, v147, v211
v_fma_f32 v84, v84, v44, v44
v_fma_f32 v85, v85, v44, v44
v_fma_f32 v86, v86, v44, v44
v_fma_f32 v87, v87, v44, v44
v_rcp_f32 v84, v84
v_rcp_f32 v85, v85
v_rcp_f32 v86, v86
v_rcp_f32 v87, v87
v_mul_f32 v208, v208, v84
v_mul_f32 v209, v209, v85
v_mul_f32 v210, v210, v86
v_mul_f32 v211, v211, v87
v_cvt_pk_bf16_f32 v98, v208, v209
v_cvt_pk_bf16_f32 v99, v210, v211
buffer_store_dwordx4 v[96:99], v27, s[24:27], 0 offen offset:0 sc1
v_fma_f32 v132, -v33, v48, v132
v_fma_f32 v133, -v33, v49, v133
v_fma_f32 v134, -v33, v50, v134
v_fma_f32 v135, -v33, v51, v135
v_fma_f32 v196, -v33, v64, v196
v_fma_f32 v197, -v33, v65, v197
v_fma_f32 v198, -v33, v66, v198
v_fma_f32 v199, -v33, v67, v199
v_mul_f32 v80, v132, v132
v_mul_f32 v81, v133, v133
v_mul_f32 v82, v134, v134
v_mul_f32 v83, v135, v135
v_lshlrev_b32 v19, 11, v18
v_lshl_add_u32 v19, v17, 4, v19
s_lshl_b32 s43, s36, 9
v_add_u32 v2, s43, v19
v_add_u32 v3, 49152, v2
v_add_u32 v4, 98304, v2
v_lshrrev_b32 v19, 2, v17
v_lshl_add_u32 v20, v18, 2, v19
v_bfe_u32 v21, v20, 1, 2
v_lshlrev_b32 v20, 7, v20
v_lshl_add_u32 v20, v21, 5, v20
v_and_b32 v19, 3, v1
v_lshl_add_u32 v20, v19, 3, v20
v_add_u32 v5, 16384, v20
s_barrier
v_fma_f32 v80, v80, v41, v37
v_fma_f32 v81, v81, v41, v37
v_fma_f32 v82, v82, v41, v37
v_fma_f32 v83, v83, v41, v37
v_mul_f32 v80, v80, v132
v_mul_f32 v81, v81, v133
v_mul_f32 v82, v82, v134
v_mul_f32 v83, v83, v135
v_exp_f32 v80, v80
v_exp_f32 v81, v81
v_exp_f32 v82, v82
v_exp_f32 v83, v83
v_mul_f32 v196, v132, v196
v_mul_f32 v197, v133, v197
v_mul_f32 v198, v134, v198
v_mul_f32 v199, v135, v199
v_fma_f32 v80, v80, v45, v45
v_fma_f32 v81, v81, v45, v45
v_fma_f32 v82, v82, v45, v45
v_fma_f32 v83, v83, v45, v45
v_rcp_f32 v80, v80
v_rcp_f32 v81, v81
v_rcp_f32 v82, v82
v_rcp_f32 v83, v83
v_mul_f32 v196, v196, v80
v_mul_f32 v197, v197, v81
v_mul_f32 v198, v198, v82
v_mul_f32 v199, v199, v83
v_cvt_pk_bf16_f32 v100, v196, v197
v_cvt_pk_bf16_f32 v101, v198, v199
v_fma_f32 v148, -v33, v52, v148
v_fma_f32 v149, -v33, v53, v149
v_fma_f32 v150, -v33, v54, v150
v_fma_f32 v151, -v33, v55, v151
v_fma_f32 v212, -v33, v68, v212
v_fma_f32 v213, -v33, v69, v213
v_fma_f32 v214, -v33, v70, v214
v_fma_f32 v215, -v33, v71, v215
v_mul_f32 v84, v148, v148
v_mul_f32 v85, v149, v149
v_mul_f32 v86, v150, v150
v_mul_f32 v87, v151, v151
v_fma_f32 v84, v84, v41, v37
v_fma_f32 v85, v85, v41, v37
v_fma_f32 v86, v86, v41, v37
v_fma_f32 v87, v87, v41, v37
v_mul_f32 v84, v84, v148
v_mul_f32 v85, v85, v149
v_xor_b32 v6, 32, v5
v_xor_b32 v7, 64, v5
v_xor_b32 v8, 96, v5
v_add_u32 v9, 49152, v5
v_add_u32 v10, 49152, v6
v_add_u32 v11, 49152, v7
v_add_u32 v12, 49152, v8
v_add_u32 v13, 98304, v5
v_add_u32 v14, 98304, v6
v_add_u32 v15, 98304, v7
v_add_u32 v16, 98304, v8
s_barrier
v_mul_f32 v86, v86, v150
v_mul_f32 v87, v87, v151
v_exp_f32 v84, v84
v_exp_f32 v85, v85
v_exp_f32 v86, v86
v_exp_f32 v87, v87
v_mul_f32 v212, v148, v212
v_mul_f32 v213, v149, v213
v_mul_f32 v214, v150, v214
v_mul_f32 v215, v151, v215
v_fma_f32 v84, v84, v45, v45
v_fma_f32 v85, v85, v45, v45
v_fma_f32 v86, v86, v45, v45
v_fma_f32 v87, v87, v45, v45
v_rcp_f32 v84, v84
v_rcp_f32 v85, v85
v_rcp_f32 v86, v86
v_rcp_f32 v87, v87
v_mul_f32 v212, v212, v84
v_mul_f32 v213, v213, v85
v_mul_f32 v214, v214, v86
v_mul_f32 v215, v215, v87
v_cvt_pk_bf16_f32 v102, v212, v213
v_cvt_pk_bf16_f32 v103, v214, v215
buffer_store_dwordx4 v[100:103], v27, s[24:27], 0 offen offset:256 sc1
v_fma_f32 v136, -v34, v48, v136
v_fma_f32 v137, -v34, v49, v137
v_fma_f32 v138, -v34, v50, v138
v_fma_f32 v139, -v34, v51, v139
v_fma_f32 v200, -v34, v64, v200
v_fma_f32 v201, -v34, v65, v201
v_fma_f32 v202, -v34, v66, v202
v_fma_f32 v203, -v34, v67, v203
v_mul_f32 v80, v136, v136
v_mul_f32 v81, v137, v137
v_mul_f32 v82, v138, v138
v_mul_f32 v83, v139, v139
v_fma_f32 v80, v80, v42, v38
v_fma_f32 v81, v81, v42, v38
v_fma_f32 v82, v82, v42, v38
v_fma_f32 v83, v83, v42, v38
v_mul_f32 v80, v80, v136
v_mul_f32 v81, v81, v137
v_mul_f32 v82, v82, v138
v_mul_f32 v83, v83, v139
v_exp_f32 v80, v80
v_exp_f32 v81, v81
v_exp_f32 v82, v82
v_exp_f32 v83, v83
s_barrier
v_mul_f32 v200, v136, v200
v_mul_f32 v201, v137, v201
v_mul_f32 v202, v138, v202
v_mul_f32 v203, v139, v203
v_fma_f32 v80, v80, v46, v46
v_fma_f32 v81, v81, v46, v46
v_fma_f32 v82, v82, v46, v46
v_fma_f32 v83, v83, v46, v46
v_rcp_f32 v80, v80
v_rcp_f32 v81, v81
v_rcp_f32 v82, v82
v_rcp_f32 v83, v83
v_mul_f32 v200, v200, v80
v_mul_f32 v201, v201, v81
v_mul_f32 v202, v202, v82
v_mul_f32 v203, v203, v83
v_cvt_pk_bf16_f32 v104, v200, v201
v_cvt_pk_bf16_f32 v105, v202, v203
v_fma_f32 v152, -v34, v52, v152
v_fma_f32 v153, -v34, v53, v153
v_fma_f32 v154, -v34, v54, v154
v_fma_f32 v155, -v34, v55, v155
v_fma_f32 v216, -v34, v68, v216
v_fma_f32 v217, -v34, v69, v217
v_fma_f32 v218, -v34, v70, v218
v_fma_f32 v219, -v34, v71, v219
v_mul_f32 v84, v152, v152
v_mul_f32 v85, v153, v153
v_mul_f32 v86, v154, v154
v_mul_f32 v87, v155, v155
v_fma_f32 v84, v84, v42, v38
v_fma_f32 v85, v85, v42, v38
v_fma_f32 v86, v86, v42, v38
v_fma_f32 v87, v87, v42, v38
v_mul_f32 v84, v84, v152
v_mul_f32 v85, v85, v153
v_mul_f32 v86, v86, v154
v_mul_f32 v87, v87, v155
v_exp_f32 v84, v84
v_exp_f32 v85, v85
v_exp_f32 v86, v86
v_exp_f32 v87, v87
v_mul_f32 v216, v152, v216
v_mul_f32 v217, v153, v217
v_mul_f32 v218, v154, v218
v_mul_f32 v219, v155, v219
v_fma_f32 v84, v84, v46, v46
v_fma_f32 v85, v85, v46, v46
s_barrier
v_fma_f32 v86, v86, v46, v46
v_fma_f32 v87, v87, v46, v46
v_rcp_f32 v84, v84
v_rcp_f32 v85, v85
v_rcp_f32 v86, v86
v_rcp_f32 v87, v87
v_mul_f32 v216, v216, v84
v_mul_f32 v217, v217, v85
v_mul_f32 v218, v218, v86
v_mul_f32 v219, v219, v87
v_cvt_pk_bf16_f32 v106, v216, v217
v_cvt_pk_bf16_f32 v107, v218, v219
buffer_store_dwordx4 v[104:107], v27, s[24:27], 0 offen offset:512 sc1
v_fma_f32 v140, -v35, v48, v140
v_fma_f32 v141, -v35, v49, v141
v_fma_f32 v142, -v35, v50, v142
v_fma_f32 v143, -v35, v51, v143
v_fma_f32 v204, -v35, v64, v204
v_fma_f32 v205, -v35, v65, v205
v_fma_f32 v206, -v35, v66, v206
v_fma_f32 v207, -v35, v67, v207
v_mul_f32 v80, v140, v140
v_mul_f32 v81, v141, v141
v_mul_f32 v82, v142, v142
v_mul_f32 v83, v143, v143
v_fma_f32 v80, v80, v43, v39
v_fma_f32 v81, v81, v43, v39
v_fma_f32 v82, v82, v43, v39
v_fma_f32 v83, v83, v43, v39
v_mul_f32 v80, v80, v140
v_mul_f32 v81, v81, v141
v_mul_f32 v82, v82, v142
v_mul_f32 v83, v83, v143
v_exp_f32 v80, v80
v_exp_f32 v81, v81
v_exp_f32 v82, v82
v_exp_f32 v83, v83
v_mul_f32 v204, v140, v204
v_mul_f32 v205, v141, v205
v_mul_f32 v206, v142, v206
v_mul_f32 v207, v143, v207
v_fma_f32 v80, v80, v47, v47
v_fma_f32 v81, v81, v47, v47
v_fma_f32 v82, v82, v47, v47
v_fma_f32 v83, v83, v47, v47
v_rcp_f32 v80, v80
v_rcp_f32 v81, v81
v_rcp_f32 v82, v82
v_rcp_f32 v83, v83
s_barrier
v_mul_f32 v204, v204, v80
v_mul_f32 v205, v205, v81
v_mul_f32 v206, v206, v82
v_mul_f32 v207, v207, v83
v_cvt_pk_bf16_f32 v108, v204, v205
v_cvt_pk_bf16_f32 v109, v206, v207
v_fma_f32 v156, -v35, v52, v156
v_fma_f32 v157, -v35, v53, v157
v_fma_f32 v158, -v35, v54, v158
v_fma_f32 v159, -v35, v55, v159
v_fma_f32 v220, -v35, v68, v220
v_fma_f32 v221, -v35, v69, v221
v_fma_f32 v222, -v35, v70, v222
v_fma_f32 v223, -v35, v71, v223
v_mul_f32 v84, v156, v156
v_mul_f32 v85, v157, v157
v_mul_f32 v86, v158, v158
v_mul_f32 v87, v159, v159
v_fma_f32 v84, v84, v43, v39
v_fma_f32 v85, v85, v43, v39
v_fma_f32 v86, v86, v43, v39
v_fma_f32 v87, v87, v43, v39
v_mul_f32 v84, v84, v156
v_mul_f32 v85, v85, v157
v_mul_f32 v86, v86, v158
v_mul_f32 v87, v87, v159
v_exp_f32 v84, v84
v_exp_f32 v85, v85
v_exp_f32 v86, v86
v_exp_f32 v87, v87
v_mul_f32 v220, v156, v220
v_mul_f32 v221, v157, v221
v_mul_f32 v222, v158, v222
v_mul_f32 v223, v159, v223
v_fma_f32 v84, v84, v47, v47
v_fma_f32 v85, v85, v47, v47
v_fma_f32 v86, v86, v47, v47
v_fma_f32 v87, v87, v47, v47
v_rcp_f32 v84, v84
v_rcp_f32 v85, v85
v_rcp_f32 v86, v86
v_rcp_f32 v87, v87
v_mul_f32 v220, v220, v84
v_mul_f32 v221, v221, v85
v_mul_f32 v222, v222, v86
v_mul_f32 v223, v223, v87
v_cvt_pk_bf16_f32 v110, v220, v221
v_cvt_pk_bf16_f32 v111, v222, v223
buffer_store_dwordx4 v[108:111], v27, s[24:27], 0 offen offset:768 sc1
s_barrier
v_fma_f32 v160, -v32, v56, v160
v_fma_f32 v161, -v32, v57, v161
v_fma_f32 v162, -v32, v58, v162
v_fma_f32 v163, -v32, v59, v163
v_fma_f32 v224, -v32, v72, v224
v_fma_f32 v225, -v32, v73, v225
v_fma_f32 v226, -v32, v74, v226
v_fma_f32 v227, -v32, v75, v227
v_mul_f32 v80, v160, v160
v_mul_f32 v81, v161, v161
v_mul_f32 v82, v162, v162
v_mul_f32 v83, v163, v163
v_fma_f32 v80, v80, v40, v36
v_fma_f32 v81, v81, v40, v36
v_fma_f32 v82, v82, v40, v36
v_fma_f32 v83, v83, v40, v36
v_mul_f32 v80, v80, v160
v_mul_f32 v81, v81, v161
v_mul_f32 v82, v82, v162
v_mul_f32 v83, v83, v163
v_exp_f32 v80, v80
v_exp_f32 v81, v81
v_exp_f32 v82, v82
v_exp_f32 v83, v83
v_mul_f32 v224, v160, v224
v_mul_f32 v225, v161, v225
v_mul_f32 v226, v162, v226
v_mul_f32 v227, v163, v227
v_fma_f32 v80, v80, v44, v44
v_fma_f32 v81, v81, v44, v44
v_fma_f32 v82, v82, v44, v44
v_fma_f32 v83, v83, v44, v44
v_rcp_f32 v80, v80
v_rcp_f32 v81, v81
v_rcp_f32 v82, v82
v_rcp_f32 v83, v83
v_mul_f32 v224, v224, v80
v_mul_f32 v225, v225, v81
v_mul_f32 v226, v226, v82
v_mul_f32 v227, v227, v83
v_cvt_pk_bf16_f32 v96, v224, v225
v_cvt_pk_bf16_f32 v97, v226, v227
v_fma_f32 v176, -v32, v60, v176
v_fma_f32 v177, -v32, v61, v177
v_fma_f32 v178, -v32, v62, v178
v_fma_f32 v179, -v32, v63, v179
v_fma_f32 v240, -v32, v76, v240
v_fma_f32 v241, -v32, v77, v241
v_lshlrev_b32 v19, 11, v18
v_lshl_add_u32 v19, v17, 4, v19
s_lshl_b32 s43, s36, 9
v_add_u32 v208, s43, v19
buffer_load_dwordx4 v[192:195], v208, s[20:23], 0 offen offset:0 sc1
buffer_load_dwordx4 v[196:199], v208, s[20:23], s50 offen offset:0 sc1
buffer_load_dwordx4 v[200:203], v208, s[20:23], 0 offen offset:256 sc1
buffer_load_dwordx4 v[204:207], v208, s[20:23], s50 offen offset:256 sc1
s_waitcnt vmcnt(4)
s_barrier
s_add_u32 s43, s34, 32
s_lshl_b32 s43, s43, 7
v_mov_b32 v21, s43
v_mov_b32 v22, 1
s_mov_b64 exec, 1
buffer_atomic_add v22, v21, s[56:59], 0 offen sc1
s_mov_b64 exec, -1
v_fma_f32 v242, -v32, v78, v242
v_fma_f32 v243, -v32, v79, v243
v_mul_f32 v84, v176, v176
v_mul_f32 v85, v177, v177
v_mul_f32 v86, v178, v178
v_mul_f32 v87, v179, v179
v_fma_f32 v84, v84, v40, v36
v_fma_f32 v85, v85, v40, v36
v_fma_f32 v86, v86, v40, v36
v_fma_f32 v87, v87, v40, v36
v_mul_f32 v84, v84, v176
v_mul_f32 v85, v85, v177
v_mul_f32 v86, v86, v178
v_mul_f32 v87, v87, v179
v_exp_f32 v84, v84
v_exp_f32 v85, v85
v_exp_f32 v86, v86
v_exp_f32 v87, v87
v_mul_f32 v240, v176, v240
v_mul_f32 v241, v177, v241
v_mul_f32 v242, v178, v242
v_mul_f32 v243, v179, v243
v_fma_f32 v84, v84, v44, v44
v_fma_f32 v85, v85, v44, v44
v_fma_f32 v86, v86, v44, v44
v_fma_f32 v87, v87, v44, v44
v_rcp_f32 v84, v84
v_rcp_f32 v85, v85
v_rcp_f32 v86, v86
v_rcp_f32 v87, v87
v_mul_f32 v240, v240, v84
v_mul_f32 v241, v241, v85
v_mul_f32 v242, v242, v86
v_mul_f32 v243, v243, v87
v_cvt_pk_bf16_f32 v98, v240, v241
v_cvt_pk_bf16_f32 v99, v242, v243
buffer_store_dwordx4 v[96:99], v27, s[24:27], s53 offen offset:0 sc1
v_fma_f32 v164, -v33, v56, v164
v_fma_f32 v165, -v33, v57, v165
v_fma_f32 v166, -v33, v58, v166
v_fma_f32 v167, -v33, v59, v167
v_fma_f32 v228, -v33, v72, v228
v_fma_f32 v229, -v33, v73, v229
v_fma_f32 v230, -v33, v74, v230
v_fma_f32 v231, -v33, v75, v231
v_mul_f32 v80, v164, v164
v_mul_f32 v81, v165, v165
v_mul_f32 v82, v166, v166
v_mul_f32 v83, v167, v167
s_barrier
v_fma_f32 v80, v80, v41, v37
v_fma_f32 v81, v81, v41, v37
v_fma_f32 v82, v82, v41, v37
v_fma_f32 v83, v83, v41, v37
v_mul_f32 v80, v80, v164
v_mul_f32 v81, v81, v165
v_mul_f32 v82, v82, v166
v_mul_f32 v83, v83, v167
v_exp_f32 v80, v80
v_exp_f32 v81, v81
v_exp_f32 v82, v82
v_exp_f32 v83, v83
v_mul_f32 v228, v164, v228
v_mul_f32 v229, v165, v229
v_mul_f32 v230, v166, v230
v_mul_f32 v231, v167, v231
v_fma_f32 v80, v80, v45, v45
v_fma_f32 v81, v81, v45, v45
v_fma_f32 v82, v82, v45, v45
v_fma_f32 v83, v83, v45, v45
v_rcp_f32 v80, v80
v_rcp_f32 v81, v81
v_rcp_f32 v82, v82
v_rcp_f32 v83, v83
v_mul_f32 v228, v228, v80
v_mul_f32 v229, v229, v81
v_mul_f32 v230, v230, v82
v_mul_f32 v231, v231, v83
v_cvt_pk_bf16_f32 v100, v228, v229
v_cvt_pk_bf16_f32 v101, v230, v231
v_fma_f32 v180, -v33, v60, v180
v_fma_f32 v181, -v33, v61, v181
v_fma_f32 v182, -v33, v62, v182
v_fma_f32 v183, -v33, v63, v183
v_fma_f32 v244, -v33, v76, v244
v_fma_f32 v245, -v33, v77, v245
v_fma_f32 v246, -v33, v78, v246
v_fma_f32 v247, -v33, v79, v247
v_mul_f32 v84, v180, v180
v_mul_f32 v85, v181, v181
v_mul_f32 v86, v182, v182
v_mul_f32 v87, v183, v183
v_fma_f32 v84, v84, v41, v37
v_fma_f32 v85, v85, v41, v37
v_fma_f32 v86, v86, v41, v37
v_fma_f32 v87, v87, v41, v37
v_mul_f32 v84, v84, v180
v_mul_f32 v85, v85, v181
s_waitcnt vmcnt(1)
s_barrier
v_mul_f32 v86, v86, v182
v_mul_f32 v87, v87, v183
v_exp_f32 v84, v84
v_exp_f32 v85, v85
v_exp_f32 v86, v86
v_exp_f32 v87, v87
v_mul_f32 v244, v180, v244
v_mul_f32 v245, v181, v245
v_mul_f32 v246, v182, v246
v_mul_f32 v247, v183, v247
v_fma_f32 v84, v84, v45, v45
v_fma_f32 v85, v85, v45, v45
v_fma_f32 v86, v86, v45, v45
v_fma_f32 v87, v87, v45, v45
v_rcp_f32 v84, v84
v_rcp_f32 v85, v85
v_rcp_f32 v86, v86
v_rcp_f32 v87, v87
v_mul_f32 v244, v244, v84
v_mul_f32 v245, v245, v85
v_mul_f32 v246, v246, v86
v_mul_f32 v247, v247, v87
v_cvt_pk_bf16_f32 v102, v244, v245
v_cvt_pk_bf16_f32 v103, v246, v247
buffer_store_dwordx4 v[100:103], v27, s[24:27], s53 offen offset:256 sc1
v_fma_f32 v168, -v34, v56, v168
v_fma_f32 v169, -v34, v57, v169
v_fma_f32 v170, -v34, v58, v170
v_fma_f32 v171, -v34, v59, v171
v_fma_f32 v232, -v34, v72, v232
v_fma_f32 v233, -v34, v73, v233
v_fma_f32 v234, -v34, v74, v234
v_fma_f32 v235, -v34, v75, v235
v_mul_f32 v80, v168, v168
v_mul_f32 v81, v169, v169
v_mul_f32 v82, v170, v170
v_mul_f32 v83, v171, v171
v_fma_f32 v80, v80, v42, v38
v_fma_f32 v81, v81, v42, v38
v_fma_f32 v82, v82, v42, v38
v_fma_f32 v83, v83, v42, v38
v_mul_f32 v80, v80, v168
v_mul_f32 v81, v81, v169
v_mul_f32 v82, v82, v170
v_mul_f32 v83, v83, v171
v_exp_f32 v80, v80
v_exp_f32 v81, v81
v_exp_f32 v82, v82
v_exp_f32 v83, v83
v_lshlrev_b32 v128, 16, v192
v_and_b32 v129, 0xffff0000, v192
v_lshlrev_b32 v130, 16, v193
v_and_b32 v131, 0xffff0000, v193
v_lshlrev_b32 v132, 16, v194
v_and_b32 v133, 0xffff0000, v194
v_lshlrev_b32 v134, 16, v195
v_and_b32 v135, 0xffff0000, v195
v_lshlrev_b32 v136, 16, v196
v_and_b32 v137, 0xffff0000, v196
v_lshlrev_b32 v138, 16, v197
v_and_b32 v139, 0xffff0000, v197
v_lshlrev_b32 v140, 16, v198
v_and_b32 v141, 0xffff0000, v198
v_lshlrev_b32 v142, 16, v199
v_and_b32 v143, 0xffff0000, v199
s_barrier
v_mul_f32 v232, v168, v232
v_mul_f32 v233, v169, v233
v_mul_f32 v234, v170, v234
v_mul_f32 v235, v171, v235
v_fma_f32 v80, v80, v46, v46
v_fma_f32 v81, v81, v46, v46
v_fma_f32 v82, v82, v46, v46
v_fma_f32 v83, v83, v46, v46
v_rcp_f32 v80, v80
v_rcp_f32 v81, v81
v_rcp_f32 v82, v82
v_rcp_f32 v83, v83
v_mul_f32 v232, v232, v80
v_mul_f32 v233, v233, v81
v_mul_f32 v234, v234, v82
v_mul_f32 v235, v235, v83
v_cvt_pk_bf16_f32 v104, v232, v233
v_cvt_pk_bf16_f32 v105, v234, v235
v_fma_f32 v184, -v34, v60, v184
v_fma_f32 v185, -v34, v61, v185
v_fma_f32 v186, -v34, v62, v186
v_fma_f32 v187, -v34, v63, v187
v_fma_f32 v248, -v34, v76, v248
v_fma_f32 v249, -v34, v77, v249
v_fma_f32 v250, -v34, v78, v250
v_fma_f32 v251, -v34, v79, v251
v_mul_f32 v84, v184, v184
v_mul_f32 v85, v185, v185
v_mul_f32 v86, v186, v186
v_mul_f32 v87, v187, v187
v_fma_f32 v84, v84, v42, v38
v_fma_f32 v85, v85, v42, v38
v_fma_f32 v86, v86, v42, v38
v_fma_f32 v87, v87, v42, v38
v_mul_f32 v84, v84, v184
v_mul_f32 v85, v85, v185
v_mul_f32 v86, v86, v186
v_mul_f32 v87, v87, v187
v_exp_f32 v84, v84
v_exp_f32 v85, v85
v_exp_f32 v86, v86
v_exp_f32 v87, v87
v_mul_f32 v248, v184, v248
v_mul_f32 v249, v185, v249
v_mul_f32 v250, v186, v250
v_mul_f32 v251, v187, v251
v_fma_f32 v84, v84, v46, v46
v_fma_f32 v85, v85, v46, v46
v_lshlrev_b32 v144, 16, v200
v_and_b32 v145, 0xffff0000, v200
v_lshlrev_b32 v146, 16, v201
v_and_b32 v147, 0xffff0000, v201
v_lshlrev_b32 v148, 16, v202
v_and_b32 v149, 0xffff0000, v202
v_lshlrev_b32 v150, 16, v203
v_and_b32 v151, 0xffff0000, v203
v_lshlrev_b32 v152, 16, v204
v_and_b32 v153, 0xffff0000, v204
v_lshlrev_b32 v154, 16, v205
v_and_b32 v155, 0xffff0000, v205
v_lshlrev_b32 v156, 16, v206
v_and_b32 v157, 0xffff0000, v206
v_lshlrev_b32 v158, 16, v207
v_and_b32 v159, 0xffff0000, v207
s_barrier
s_add_u32 s43, s34, 32
s_lshl_b32 s43, s43, 7
v_mov_b32 v21, s43
v_mov_b32 v23, 16
buffer_load_dword v22, v21, s[56:59], 0 offen sc1
v_fma_f32 v86, v86, v46, v46
v_fma_f32 v87, v87, v46, v46
v_rcp_f32 v84, v84
v_rcp_f32 v85, v85
v_rcp_f32 v86, v86
v_rcp_f32 v87, v87
v_mul_f32 v248, v248, v84
v_mul_f32 v249, v249, v85
v_mul_f32 v250, v250, v86
v_mul_f32 v251, v251, v87
v_cvt_pk_bf16_f32 v106, v248, v249
v_cvt_pk_bf16_f32 v107, v250, v251
buffer_store_dwordx4 v[104:107], v27, s[24:27], s53 offen offset:512 sc1
v_fma_f32 v172, -v35, v56, v172
v_fma_f32 v173, -v35, v57, v173
v_fma_f32 v174, -v35, v58, v174
v_fma_f32 v175, -v35, v59, v175
v_fma_f32 v236, -v35, v72, v236
v_fma_f32 v237, -v35, v73, v237
v_fma_f32 v238, -v35, v74, v238
v_fma_f32 v239, -v35, v75, v239
v_mul_f32 v80, v172, v172
v_mul_f32 v81, v173, v173
v_mul_f32 v82, v174, v174
v_mul_f32 v83, v175, v175
v_fma_f32 v80, v80, v43, v39
v_fma_f32 v81, v81, v43, v39
v_fma_f32 v82, v82, v43, v39
v_fma_f32 v83, v83, v43, v39
v_mul_f32 v80, v80, v172
v_mul_f32 v81, v81, v173
v_mul_f32 v82, v82, v174
v_mul_f32 v83, v83, v175
v_exp_f32 v80, v80
v_exp_f32 v81, v81
v_exp_f32 v82, v82
v_exp_f32 v83, v83
v_mul_f32 v236, v172, v236
v_mul_f32 v237, v173, v237
v_mul_f32 v238, v174, v238
v_mul_f32 v239, v175, v239
v_fma_f32 v80, v80, v47, v47
v_fma_f32 v81, v81, v47, v47
v_fma_f32 v82, v82, v47, v47
v_fma_f32 v83, v83, v47, v47
v_rcp_f32 v80, v80
v_rcp_f32 v81, v81
v_rcp_f32 v82, v82
v_rcp_f32 v83, v83
s_mov_b32 s41, 0x10000
Lpoll_22:
s_waitcnt vmcnt(0)
v_cmp_ne_u32 vcc, v23, v22
s_nop 4
s_cbranch_vccz Lpok_23
buffer_load_dword v22, v21, s[56:59], 0 offen sc1
s_sub_u32 s41, s41, 1
s_cmp_lg_u32 s41, 0
s_cbranch_scc1 Lpoll_22
s_waitcnt vmcnt(0)
Lpok_23:
s_barrier
v_mul_f32 v236, v236, v80
v_mul_f32 v237, v237, v81
v_mul_f32 v238, v238, v82
v_mul_f32 v239, v239, v83
v_cvt_pk_bf16_f32 v108, v236, v237
v_cvt_pk_bf16_f32 v109, v238, v239
v_fma_f32 v188, -v35, v60, v188
v_fma_f32 v189, -v35, v61, v189
v_fma_f32 v190, -v35, v62, v190
v_fma_f32 v191, -v35, v63, v191
v_fma_f32 v252, -v35, v76, v252
v_fma_f32 v253, -v35, v77, v253
v_fma_f32 v254, -v35, v78, v254
v_fma_f32 v255, -v35, v79, v255
v_mul_f32 v84, v188, v188
v_mul_f32 v85, v189, v189
v_mul_f32 v86, v190, v190
v_mul_f32 v87, v191, v191
v_fma_f32 v84, v84, v43, v39
v_fma_f32 v85, v85, v43, v39
v_fma_f32 v86, v86, v43, v39
v_fma_f32 v87, v87, v43, v39
v_mul_f32 v84, v84, v188
v_mul_f32 v85, v85, v189
v_mul_f32 v86, v86, v190
v_mul_f32 v87, v87, v191
v_exp_f32 v84, v84
v_exp_f32 v85, v85
v_exp_f32 v86, v86
v_exp_f32 v87, v87
v_mul_f32 v252, v188, v252
v_mul_f32 v253, v189, v253
v_mul_f32 v254, v190, v254
v_mul_f32 v255, v191, v255
v_fma_f32 v84, v84, v47, v47
v_fma_f32 v85, v85, v47, v47
v_fma_f32 v86, v86, v47, v47
v_fma_f32 v87, v87, v47, v47
v_rcp_f32 v84, v84
v_rcp_f32 v85, v85
v_rcp_f32 v86, v86
v_rcp_f32 v87, v87
v_mul_f32 v252, v252, v84
v_mul_f32 v253, v253, v85
v_mul_f32 v254, v254, v86
v_mul_f32 v255, v255, v87
v_cvt_pk_bf16_f32 v110, v252, v253
v_cvt_pk_bf16_f32 v111, v254, v255
buffer_store_dwordx4 v[108:111], v27, s[24:27], s53 offen offset:768 sc1
s_barrier
s_waitcnt vmcnt(0)
s_barrier
LK4_21:
s_setprio 1
ds_read_b128 v[32:35], v3 offset:0
ds_read_b64_tr_b16 v[48:49], v9 offset:0
ds_read_b64_tr_b16 v[50:51], v9 offset:2048
ds_read_b64_tr_b16 v[52:53], v10 offset:0
ds_read_b64_tr_b16 v[54:55], v10 offset:2048
ds_read_b128 v[36:39], v3 offset:256
ds_read_b64_tr_b16 v[56:57], v11 offset:0
ds_read_b64_tr_b16 v[58:59], v11 offset:2048
ds_read_b64_tr_b16 v[60:61], v12 offset:0
ds_read_b64_tr_b16 v[62:63], v12 offset:2048
ds_read_b128 v[40:43], v3 offset:8192
ds_read_b64_tr_b16 v[64:65], v9 offset:4096
ds_read_b64_tr_b16 v[66:67], v9 offset:6144
ds_read_b64_tr_b16 v[68:69], v10 offset:4096
ds_read_b64_tr_b16 v[70:71], v10 offset:6144
ds_read_b128 v[44:47], v3 offset:8448
ds_read_b64_tr_b16 v[72:73], v11 offset:4096
ds_read_b64_tr_b16 v[74:75], v11 offset:6144
ds_read_b64_tr_b16 v[76:77], v12 offset:4096
ds_read_b64_tr_b16 v[78:79], v12 offset:6144
s_waitcnt lgkmcnt(0)
s_barrier
v_mfma_f32_16x16x32_bf16 v[128:131], v[48:51], v[32:35], v[128:131]
ds_read_b128 v[80:83], v3 offset:24576
ds_read_b64_tr_b16 v[96:97], v9 offset:24576
v_mfma_f32_16x16x32_bf16 v[132:135], v[52:55], v[32:35], v[132:135]
ds_read_b64_tr_b16 v[98:99], v9 offset:26624
ds_read_b64_tr_b16 v[100:101], v10 offset:24576
v_mfma_f32_16x16x32_bf16 v[136:139], v[56:59], v[32:35], v[136:139]
ds_read_b64_tr_b16 v[102:103], v10 offset:26624
ds_read_b128 v[84:87], v3 offset:24832
v_mfma_f32_16x16x32_bf16 v[140:143], v[60:63], v[32:35], v[140:143]
ds_read_b64_tr_b16 v[104:105], v11 offset:24576
ds_read_b64_tr_b16 v[106:107], v11 offset:26624
v_mfma_f32_16x16x32_bf16 v[144:147], v[48:51], v[36:39], v[144:147]
ds_read_b64_tr_b16 v[108:109], v12 offset:24576
ds_read_b64_tr_b16 v[110:111], v12 offset:26624
v_mfma_f32_16x16x32_bf16 v[148:151], v[52:55], v[36:39], v[148:151]
ds_read_b128 v[88:91], v3 offset:32768
ds_read_b64_tr_b16 v[112:113], v9 offset:28672
v_mfma_f32_16x16x32_bf16 v[152:155], v[56:59], v[36:39], v[152:155]
ds_read_b64_tr_b16 v[114:115], v9 offset:30720
v_mfma_f32_16x16x32_bf16 v[156:159], v[60:63], v[36:39], v[156:159]
ds_read_b64_tr_b16 v[116:117], v10 offset:28672
v_mfma_f32_16x16x32_bf16 v[128:131], v[64:67], v[40:43], v[128:131]
ds_read_b64_tr_b16 v[118:119], v10 offset:30720
v_mfma_f32_16x16x32_bf16 v[132:135], v[68:71], v[40:43], v[132:135]
ds_read_b128 v[92:95], v3 offset:33024
v_mfma_f32_16x16x32_bf16 v[136:139], v[72:75], v[40:43], v[136:139]
ds_read_b64_tr_b16 v[120:121], v11 offset:28672
v_mfma_f32_16x16x32_bf16 v[140:143], v[76:79], v[40:43], v[140:143]
ds_read_b64_tr_b16 v[122:123], v11 offset:30720
v_mfma_f32_16x16x32_bf16 v[144:147], v[64:67], v[44:47], v[144:147]
ds_read_b64_tr_b16 v[124:125], v12 offset:28672
v_mfma_f32_16x16x32_bf16 v[148:151], v[68:71], v[44:47], v[148:151]
ds_read_b64_tr_b16 v[126:127], v12 offset:30720
v_mfma_f32_16x16x32_bf16 v[152:155], v[72:75], v[44:47], v[152:155]
v_mfma_f32_16x16x32_bf16 v[156:159], v[76:79], v[44:47], v[156:159]
s_waitcnt vmcnt(8) lgkmcnt(0)
s_barrier
v_mfma_f32_16x16x32_bf16 v[128:131], v[96:99], v[80:83], v[128:131]
ds_read_b128 v[32:35], v4 offset:0
ds_read_b64_tr_b16 v[48:49], v13 offset:0
v_mfma_f32_16x16x32_bf16 v[132:135], v[100:103], v[80:83], v[132:135]
ds_read_b64_tr_b16 v[50:51], v13 offset:2048
ds_read_b64_tr_b16 v[52:53], v14 offset:0
v_mfma_f32_16x16x32_bf16 v[136:139], v[104:107], v[80:83], v[136:139]
ds_read_b64_tr_b16 v[54:55], v14 offset:2048
ds_read_b128 v[36:39], v4 offset:256
v_mfma_f32_16x16x32_bf16 v[140:143], v[108:111], v[80:83], v[140:143]
ds_read_b64_tr_b16 v[56:57], v15 offset:0
ds_read_b64_tr_b16 v[58:59], v15 offset:2048
v_mfma_f32_16x16x32_bf16 v[144:147], v[96:99], v[84:87], v[144:147]
ds_read_b64_tr_b16 v[60:61], v16 offset:0
ds_read_b64_tr_b16 v[62:63], v16 offset:2048
v_mfma_f32_16x16x32_bf16 v[148:151], v[100:103], v[84:87], v[148:151]
ds_read_b128 v[40:43], v4 offset:8192
ds_read_b64_tr_b16 v[64:65], v13 offset:4096
v_mfma_f32_16x16x32_bf16 v[152:155], v[104:107], v[84:87], v[152:155]
ds_read_b64_tr_b16 v[66:67], v13 offset:6144
v_mfma_f32_16x16x32_bf16 v[156:159], v[108:111], v[84:87], v[156:159]
ds_read_b64_tr_b16 v[68:69], v14 offset:4096
v_mfma_f32_16x16x32_bf16 v[128:131], v[112:115], v[88:91], v[128:131]
ds_read_b64_tr_b16 v[70:71], v14 offset:6144
v_mfma_f32_16x16x32_bf16 v[132:135], v[116:119], v[88:91], v[132:135]
ds_read_b128 v[44:47], v4 offset:8448
v_mfma_f32_16x16x32_bf16 v[136:139], v[120:123], v[88:91], v[136:139]
ds_read_b64_tr_b16 v[72:73], v15 offset:4096
v_mfma_f32_16x16x32_bf16 v[140:143], v[124:127], v[88:91], v[140:143]
ds_read_b64_tr_b16 v[74:75], v15 offset:6144
v_mfma_f32_16x16x32_bf16 v[144:147], v[112:115], v[92:95], v[144:147]
ds_read_b64_tr_b16 v[76:77], v16 offset:4096
v_mfma_f32_16x16x32_bf16 v[148:151], v[116:119], v[92:95], v[148:151]
ds_read_b64_tr_b16 v[78:79], v16 offset:6144
v_mfma_f32_16x16x32_bf16 v[152:155], v[120:123], v[92:95], v[152:155]
v_mfma_f32_16x16x32_bf16 v[156:159], v[124:127], v[92:95], v[156:159]
s_waitcnt vmcnt(0) lgkmcnt(0)
s_barrier
v_mfma_f32_16x16x32_bf16 v[128:131], v[48:51], v[32:35], v[128:131]
ds_read_b128 v[80:83], v4 offset:24576
ds_read_b64_tr_b16 v[96:97], v13 offset:24576
v_mfma_f32_16x16x32_bf16 v[132:135], v[52:55], v[32:35], v[132:135]
ds_read_b64_tr_b16 v[98:99], v13 offset:26624
ds_read_b64_tr_b16 v[100:101], v14 offset:24576
v_mfma_f32_16x16x32_bf16 v[136:139], v[56:59], v[32:35], v[136:139]
ds_read_b64_tr_b16 v[102:103], v14 offset:26624
ds_read_b128 v[84:87], v4 offset:24832
v_mfma_f32_16x16x32_bf16 v[140:143], v[60:63], v[32:35], v[140:143]
ds_read_b64_tr_b16 v[104:105], v15 offset:24576
ds_read_b64_tr_b16 v[106:107], v15 offset:26624
v_mfma_f32_16x16x32_bf16 v[144:147], v[48:51], v[36:39], v[144:147]
ds_read_b64_tr_b16 v[108:109], v16 offset:24576
ds_read_b64_tr_b16 v[110:111], v16 offset:26624
v_mfma_f32_16x16x32_bf16 v[148:151], v[52:55], v[36:39], v[148:151]
ds_read_b128 v[88:91], v4 offset:32768
ds_read_b64_tr_b16 v[112:113], v13 offset:28672
v_mfma_f32_16x16x32_bf16 v[152:155], v[56:59], v[36:39], v[152:155]
ds_read_b64_tr_b16 v[114:115], v13 offset:30720
v_mfma_f32_16x16x32_bf16 v[156:159], v[60:63], v[36:39], v[156:159]
ds_read_b64_tr_b16 v[116:117], v14 offset:28672
v_mfma_f32_16x16x32_bf16 v[128:131], v[64:67], v[40:43], v[128:131]
ds_read_b64_tr_b16 v[118:119], v14 offset:30720
v_mfma_f32_16x16x32_bf16 v[132:135], v[68:71], v[40:43], v[132:135]
ds_read_b128 v[92:95], v4 offset:33024
v_mfma_f32_16x16x32_bf16 v[136:139], v[72:75], v[40:43], v[136:139]
ds_read_b64_tr_b16 v[120:121], v15 offset:28672
v_mfma_f32_16x16x32_bf16 v[140:143], v[76:79], v[40:43], v[140:143]
ds_read_b64_tr_b16 v[122:123], v15 offset:30720
v_mfma_f32_16x16x32_bf16 v[144:147], v[64:67], v[44:47], v[144:147]
ds_read_b64_tr_b16 v[124:125], v16 offset:28672
v_mfma_f32_16x16x32_bf16 v[148:151], v[68:71], v[44:47], v[148:151]
ds_read_b64_tr_b16 v[126:127], v16 offset:30720
v_mfma_f32_16x16x32_bf16 v[152:155], v[72:75], v[44:47], v[152:155]
v_mfma_f32_16x16x32_bf16 v[156:159], v[76:79], v[44:47], v[156:159]
s_mov_b32 s41, 8
Lg2_24:
s_waitcnt lgkmcnt(0)
s_barrier
v_mfma_f32_16x16x32_bf16 v[128:131], v[96:99], v[80:83], v[128:131]
ds_read_b128 v[32:35], v2 offset:0
ds_read_b64_tr_b16 v[48:49], v5 offset:0
v_mfma_f32_16x16x32_bf16 v[132:135], v[100:103], v[80:83], v[132:135]
ds_read_b64_tr_b16 v[50:51], v5 offset:2048
ds_read_b64_tr_b16 v[52:53], v6 offset:0
v_mfma_f32_16x16x32_bf16 v[136:139], v[104:107], v[80:83], v[136:139]
ds_read_b64_tr_b16 v[54:55], v6 offset:2048
ds_read_b128 v[36:39], v2 offset:256
v_mfma_f32_16x16x32_bf16 v[140:143], v[108:111], v[80:83], v[140:143]
ds_read_b64_tr_b16 v[56:57], v7 offset:0
ds_read_b64_tr_b16 v[58:59], v7 offset:2048
v_mfma_f32_16x16x32_bf16 v[144:147], v[96:99], v[84:87], v[144:147]
ds_read_b64_tr_b16 v[60:61], v8 offset:0
ds_read_b64_tr_b16 v[62:63], v8 offset:2048
v_mfma_f32_16x16x32_bf16 v[148:151], v[100:103], v[84:87], v[148:151]
ds_read_b128 v[40:43], v2 offset:8192
ds_read_b64_tr_b16 v[64:65], v5 offset:4096
v_mfma_f32_16x16x32_bf16 v[152:155], v[104:107], v[84:87], v[152:155]
ds_read_b64_tr_b16 v[66:67], v5 offset:6144
v_mfma_f32_16x16x32_bf16 v[156:159], v[108:111], v[84:87], v[156:159]
ds_read_b64_tr_b16 v[68:69], v6 offset:4096
v_mfma_f32_16x16x32_bf16 v[128:131], v[112:115], v[88:91], v[128:131]
ds_read_b64_tr_b16 v[70:71], v6 offset:6144
v_mfma_f32_16x16x32_bf16 v[132:135], v[116:119], v[88:91], v[132:135]
ds_read_b128 v[44:47], v2 offset:8448
v_mfma_f32_16x16x32_bf16 v[136:139], v[120:123], v[88:91], v[136:139]
ds_read_b64_tr_b16 v[72:73], v7 offset:4096
v_mfma_f32_16x16x32_bf16 v[140:143], v[124:127], v[88:91], v[140:143]
ds_read_b64_tr_b16 v[74:75], v7 offset:6144
v_mfma_f32_16x16x32_bf16 v[144:147], v[112:115], v[92:95], v[144:147]
ds_read_b64_tr_b16 v[76:77], v8 offset:4096
v_mfma_f32_16x16x32_bf16 v[148:151], v[116:119], v[92:95], v[148:151]
ds_read_b64_tr_b16 v[78:79], v8 offset:6144
v_mfma_f32_16x16x32_bf16 v[152:155], v[120:123], v[92:95], v[152:155]
v_mfma_f32_16x16x32_bf16 v[156:159], v[124:127], v[92:95], v[156:159]
s_waitcnt lgkmcnt(0)
s_barrier
v_mfma_f32_16x16x32_bf16 v[128:131], v[48:51], v[32:35], v[128:131]
ds_read_b128 v[80:83], v2 offset:24576
ds_read_b64_tr_b16 v[96:97], v5 offset:24576
v_mfma_f32_16x16x32_bf16 v[132:135], v[52:55], v[32:35], v[132:135]
ds_read_b64_tr_b16 v[98:99], v5 offset:26624
ds_read_b64_tr_b16 v[100:101], v6 offset:24576
v_mfma_f32_16x16x32_bf16 v[136:139], v[56:59], v[32:35], v[136:139]
ds_read_b64_tr_b16 v[102:103], v6 offset:26624
ds_read_b128 v[84:87], v2 offset:24832
v_mfma_f32_16x16x32_bf16 v[140:143], v[60:63], v[32:35], v[140:143]
ds_read_b64_tr_b16 v[104:105], v7 offset:24576
ds_read_b64_tr_b16 v[106:107], v7 offset:26624
v_mfma_f32_16x16x32_bf16 v[144:147], v[48:51], v[36:39], v[144:147]
ds_read_b64_tr_b16 v[108:109], v8 offset:24576
ds_read_b64_tr_b16 v[110:111], v8 offset:26624
v_mfma_f32_16x16x32_bf16 v[148:151], v[52:55], v[36:39], v[148:151]
ds_read_b128 v[88:91], v2 offset:32768
ds_read_b64_tr_b16 v[112:113], v5 offset:28672
v_mfma_f32_16x16x32_bf16 v[152:155], v[56:59], v[36:39], v[152:155]
ds_read_b64_tr_b16 v[114:115], v5 offset:30720
v_mfma_f32_16x16x32_bf16 v[156:159], v[60:63], v[36:39], v[156:159]
ds_read_b64_tr_b16 v[116:117], v6 offset:28672
v_mfma_f32_16x16x32_bf16 v[128:131], v[64:67], v[40:43], v[128:131]
ds_read_b64_tr_b16 v[118:119], v6 offset:30720
v_mfma_f32_16x16x32_bf16 v[132:135], v[68:71], v[40:43], v[132:135]
ds_read_b128 v[92:95], v2 offset:33024
v_mfma_f32_16x16x32_bf16 v[136:139], v[72:75], v[40:43], v[136:139]
ds_read_b64_tr_b16 v[120:121], v7 offset:28672
v_mfma_f32_16x16x32_bf16 v[140:143], v[76:79], v[40:43], v[140:143]
ds_read_b64_tr_b16 v[122:123], v7 offset:30720
v_mfma_f32_16x16x32_bf16 v[144:147], v[64:67], v[44:47], v[144:147]
ds_read_b64_tr_b16 v[124:125], v8 offset:28672
v_mfma_f32_16x16x32_bf16 v[148:151], v[68:71], v[44:47], v[148:151]
ds_read_b64_tr_b16 v[126:127], v8 offset:30720
v_mfma_f32_16x16x32_bf16 v[152:155], v[72:75], v[44:47], v[152:155]
v_mfma_f32_16x16x32_bf16 v[156:159], v[76:79], v[44:47], v[156:159]
s_waitcnt lgkmcnt(0)
s_barrier
v_mfma_f32_16x16x32_bf16 v[128:131], v[96:99], v[80:83], v[128:131]
ds_read_b128 v[32:35], v3 offset:0
ds_read_b64_tr_b16 v[48:49], v9 offset:0
v_mfma_f32_16x16x32_bf16 v[132:135], v[100:103], v[80:83], v[132:135]
ds_read_b64_tr_b16 v[50:51], v9 offset:2048
ds_read_b64_tr_b16 v[52:53], v10 offset:0
v_mfma_f32_16x16x32_bf16 v[136:139], v[104:107], v[80:83], v[136:139]
ds_read_b64_tr_b16 v[54:55], v10 offset:2048
ds_read_b128 v[36:39], v3 offset:256
v_mfma_f32_16x16x32_bf16 v[140:143], v[108:111], v[80:83], v[140:143]
ds_read_b64_tr_b16 v[56:57], v11 offset:0
ds_read_b64_tr_b16 v[58:59], v11 offset:2048
v_mfma_f32_16x16x32_bf16 v[144:147], v[96:99], v[84:87], v[144:147]
ds_read_b64_tr_b16 v[60:61], v12 offset:0
ds_read_b64_tr_b16 v[62:63], v12 offset:2048
v_mfma_f32_16x16x32_bf16 v[148:151], v[100:103], v[84:87], v[148:151]
ds_read_b128 v[40:43], v3 offset:8192
ds_read_b64_tr_b16 v[64:65], v9 offset:4096
v_mfma_f32_16x16x32_bf16 v[152:155], v[104:107], v[84:87], v[152:155]
ds_read_b64_tr_b16 v[66:67], v9 offset:6144
v_mfma_f32_16x16x32_bf16 v[156:159], v[108:111], v[84:87], v[156:159]
ds_read_b64_tr_b16 v[68:69], v10 offset:4096
v_mfma_f32_16x16x32_bf16 v[128:131], v[112:115], v[88:91], v[128:131]
ds_read_b64_tr_b16 v[70:71], v10 offset:6144
v_mfma_f32_16x16x32_bf16 v[132:135], v[116:119], v[88:91], v[132:135]
ds_read_b128 v[44:47], v3 offset:8448
v_mfma_f32_16x16x32_bf16 v[136:139], v[120:123], v[88:91], v[136:139]
ds_read_b64_tr_b16 v[72:73], v11 offset:4096
v_mfma_f32_16x16x32_bf16 v[140:143], v[124:127], v[88:91], v[140:143]
ds_read_b64_tr_b16 v[74:75], v11 offset:6144
v_mfma_f32_16x16x32_bf16 v[144:147], v[112:115], v[92:95], v[144:147]
ds_read_b64_tr_b16 v[76:77], v12 offset:4096
v_mfma_f32_16x16x32_bf16 v[148:151], v[116:119], v[92:95], v[148:151]
ds_read_b64_tr_b16 v[78:79], v12 offset:6144
v_mfma_f32_16x16x32_bf16 v[152:155], v[120:123], v[92:95], v[152:155]
v_mfma_f32_16x16x32_bf16 v[156:159], v[124:127], v[92:95], v[156:159]
s_waitcnt lgkmcnt(0)
s_barrier
v_mfma_f32_16x16x32_bf16 v[128:131], v[48:51], v[32:35], v[128:131]
ds_read_b128 v[80:83], v3 offset:24576
ds_read_b64_tr_b16 v[96:97], v9 offset:24576
v_mfma_f32_16x16x32_bf16 v[132:135], v[52:55], v[32:35], v[132:135]
ds_read_b64_tr_b16 v[98:99], v9 offset:26624
ds_read_b64_tr_b16 v[100:101], v10 offset:24576
v_mfma_f32_16x16x32_bf16 v[136:139], v[56:59], v[32:35], v[136:139]
ds_read_b64_tr_b16 v[102:103], v10 offset:26624
ds_read_b128 v[84:87], v3 offset:24832
v_mfma_f32_16x16x32_bf16 v[140:143], v[60:63], v[32:35], v[140:143]
ds_read_b64_tr_b16 v[104:105], v11 offset:24576
ds_read_b64_tr_b16 v[106:107], v11 offset:26624
v_mfma_f32_16x16x32_bf16 v[144:147], v[48:51], v[36:39], v[144:147]
ds_read_b64_tr_b16 v[108:109], v12 offset:24576
ds_read_b64_tr_b16 v[110:111], v12 offset:26624
v_mfma_f32_16x16x32_bf16 v[148:151], v[52:55], v[36:39], v[148:151]
ds_read_b128 v[88:91], v3 offset:32768
ds_read_b64_tr_b16 v[112:113], v9 offset:28672
v_mfma_f32_16x16x32_bf16 v[152:155], v[56:59], v[36:39], v[152:155]
ds_read_b64_tr_b16 v[114:115], v9 offset:30720
v_mfma_f32_16x16x32_bf16 v[156:159], v[60:63], v[36:39], v[156:159]
ds_read_b64_tr_b16 v[116:117], v10 offset:28672
v_mfma_f32_16x16x32_bf16 v[128:131], v[64:67], v[40:43], v[128:131]
ds_read_b64_tr_b16 v[118:119], v10 offset:30720
v_mfma_f32_16x16x32_bf16 v[132:135], v[68:71], v[40:43], v[132:135]
ds_read_b128 v[92:95], v3 offset:33024
v_mfma_f32_16x16x32_bf16 v[136:139], v[72:75], v[40:43], v[136:139]
ds_read_b64_tr_b16 v[120:121], v11 offset:28672
v_mfma_f32_16x16x32_bf16 v[140:143], v[76:79], v[40:43], v[140:143]
ds_read_b64_tr_b16 v[122:123], v11 offset:30720
v_mfma_f32_16x16x32_bf16 v[144:147], v[64:67], v[44:47], v[144:147]
ds_read_b64_tr_b16 v[124:125], v12 offset:28672
v_mfma_f32_16x16x32_bf16 v[148:151], v[68:71], v[44:47], v[148:151]
ds_read_b64_tr_b16 v[126:127], v12 offset:30720
v_mfma_f32_16x16x32_bf16 v[152:155], v[72:75], v[44:47], v[152:155]
v_mfma_f32_16x16x32_bf16 v[156:159], v[76:79], v[44:47], v[156:159]
s_waitcnt lgkmcnt(0)
s_barrier
v_mfma_f32_16x16x32_bf16 v[128:131], v[96:99], v[80:83], v[128:131]
ds_read_b128 v[32:35], v4 offset:0
ds_read_b64_tr_b16 v[48:49], v13 offset:0
v_mfma_f32_16x16x32_bf16 v[132:135], v[100:103], v[80:83], v[132:135]
ds_read_b64_tr_b16 v[50:51], v13 offset:2048
ds_read_b64_tr_b16 v[52:53], v14 offset:0
v_mfma_f32_16x16x32_bf16 v[136:139], v[104:107], v[80:83], v[136:139]
ds_read_b64_tr_b16 v[54:55], v14 offset:2048
ds_read_b128 v[36:39], v4 offset:256
v_mfma_f32_16x16x32_bf16 v[140:143], v[108:111], v[80:83], v[140:143]
ds_read_b64_tr_b16 v[56:57], v15 offset:0
ds_read_b64_tr_b16 v[58:59], v15 offset:2048
v_mfma_f32_16x16x32_bf16 v[144:147], v[96:99], v[84:87], v[144:147]
ds_read_b64_tr_b16 v[60:61], v16 offset:0
ds_read_b64_tr_b16 v[62:63], v16 offset:2048
v_mfma_f32_16x16x32_bf16 v[148:151], v[100:103], v[84:87], v[148:151]
ds_read_b128 v[40:43], v4 offset:8192
ds_read_b64_tr_b16 v[64:65], v13 offset:4096
v_mfma_f32_16x16x32_bf16 v[152:155], v[104:107], v[84:87], v[152:155]
ds_read_b64_tr_b16 v[66:67], v13 offset:6144
v_mfma_f32_16x16x32_bf16 v[156:159], v[108:111], v[84:87], v[156:159]
ds_read_b64_tr_b16 v[68:69], v14 offset:4096
v_mfma_f32_16x16x32_bf16 v[128:131], v[112:115], v[88:91], v[128:131]
ds_read_b64_tr_b16 v[70:71], v14 offset:6144
v_mfma_f32_16x16x32_bf16 v[132:135], v[116:119], v[88:91], v[132:135]
ds_read_b128 v[44:47], v4 offset:8448
v_mfma_f32_16x16x32_bf16 v[136:139], v[120:123], v[88:91], v[136:139]
ds_read_b64_tr_b16 v[72:73], v15 offset:4096
v_mfma_f32_16x16x32_bf16 v[140:143], v[124:127], v[88:91], v[140:143]
ds_read_b64_tr_b16 v[74:75], v15 offset:6144
v_mfma_f32_16x16x32_bf16 v[144:147], v[112:115], v[92:95], v[144:147]
ds_read_b64_tr_b16 v[76:77], v16 offset:4096
v_mfma_f32_16x16x32_bf16 v[148:151], v[116:119], v[92:95], v[148:151]
ds_read_b64_tr_b16 v[78:79], v16 offset:6144
v_mfma_f32_16x16x32_bf16 v[152:155], v[120:123], v[92:95], v[152:155]
v_mfma_f32_16x16x32_bf16 v[156:159], v[124:127], v[92:95], v[156:159]
s_waitcnt lgkmcnt(0)
s_barrier
v_mfma_f32_16x16x32_bf16 v[128:131], v[48:51], v[32:35], v[128:131]
ds_read_b128 v[80:83], v4 offset:24576
ds_read_b64_tr_b16 v[96:97], v13 offset:24576
v_mfma_f32_16x16x32_bf16 v[132:135], v[52:55], v[32:35], v[132:135]
ds_read_b64_tr_b16 v[98:99], v13 offset:26624
ds_read_b64_tr_b16 v[100:101], v14 offset:24576
v_mfma_f32_16x16x32_bf16 v[136:139], v[56:59], v[32:35], v[136:139]
ds_read_b64_tr_b16 v[102:103], v14 offset:26624
ds_read_b128 v[84:87], v4 offset:24832
v_mfma_f32_16x16x32_bf16 v[140:143], v[60:63], v[32:35], v[140:143]
ds_read_b64_tr_b16 v[104:105], v15 offset:24576
ds_read_b64_tr_b16 v[106:107], v15 offset:26624
v_mfma_f32_16x16x32_bf16 v[144:147], v[48:51], v[36:39], v[144:147]
ds_read_b64_tr_b16 v[108:109], v16 offset:24576
ds_read_b64_tr_b16 v[110:111], v16 offset:26624
v_mfma_f32_16x16x32_bf16 v[148:151], v[52:55], v[36:39], v[148:151]
ds_read_b128 v[88:91], v4 offset:32768
ds_read_b64_tr_b16 v[112:113], v13 offset:28672
v_mfma_f32_16x16x32_bf16 v[152:155], v[56:59], v[36:39], v[152:155]
ds_read_b64_tr_b16 v[114:115], v13 offset:30720
v_mfma_f32_16x16x32_bf16 v[156:159], v[60:63], v[36:39], v[156:159]
ds_read_b64_tr_b16 v[116:117], v14 offset:28672
v_mfma_f32_16x16x32_bf16 v[128:131], v[64:67], v[40:43], v[128:131]
ds_read_b64_tr_b16 v[118:119], v14 offset:30720
v_mfma_f32_16x16x32_bf16 v[132:135], v[68:71], v[40:43], v[132:135]
ds_read_b128 v[92:95], v4 offset:33024
v_mfma_f32_16x16x32_bf16 v[136:139], v[72:75], v[40:43], v[136:139]
ds_read_b64_tr_b16 v[120:121], v15 offset:28672
v_mfma_f32_16x16x32_bf16 v[140:143], v[76:79], v[40:43], v[140:143]
ds_read_b64_tr_b16 v[122:123], v15 offset:30720
v_mfma_f32_16x16x32_bf16 v[144:147], v[64:67], v[44:47], v[144:147]
ds_read_b64_tr_b16 v[124:125], v16 offset:28672
v_mfma_f32_16x16x32_bf16 v[148:151], v[68:71], v[44:47], v[148:151]
ds_read_b64_tr_b16 v[126:127], v16 offset:30720
v_mfma_f32_16x16x32_bf16 v[152:155], v[72:75], v[44:47], v[152:155]
v_mfma_f32_16x16x32_bf16 v[156:159], v[76:79], v[44:47], v[156:159]
s_sub_u32 s41, s41, 1
s_cmp_lg_u32 s41, 0
s_cbranch_scc1 Lg2_24
s_waitcnt lgkmcnt(0)
s_barrier
v_mfma_f32_16x16x32_bf16 v[128:131], v[96:99], v[80:83], v[128:131]
ds_read_b128 v[32:35], v2 offset:0
ds_read_b64_tr_b16 v[48:49], v5 offset:0
v_mfma_f32_16x16x32_bf16 v[132:135], v[100:103], v[80:83], v[132:135]
ds_read_b64_tr_b16 v[50:51], v5 offset:2048
ds_read_b64_tr_b16 v[52:53], v6 offset:0
v_mfma_f32_16x16x32_bf16 v[136:139], v[104:107], v[80:83], v[136:139]
ds_read_b64_tr_b16 v[54:55], v6 offset:2048
ds_read_b128 v[36:39], v2 offset:256
v_mfma_f32_16x16x32_bf16 v[140:143], v[108:111], v[80:83], v[140:143]
ds_read_b64_tr_b16 v[56:57], v7 offset:0
ds_read_b64_tr_b16 v[58:59], v7 offset:2048
v_mfma_f32_16x16x32_bf16 v[144:147], v[96:99], v[84:87], v[144:147]
ds_read_b64_tr_b16 v[60:61], v8 offset:0
ds_read_b64_tr_b16 v[62:63], v8 offset:2048
v_mfma_f32_16x16x32_bf16 v[148:151], v[100:103], v[84:87], v[148:151]
ds_read_b128 v[40:43], v2 offset:8192
ds_read_b64_tr_b16 v[64:65], v5 offset:4096
v_mfma_f32_16x16x32_bf16 v[152:155], v[104:107], v[84:87], v[152:155]
ds_read_b64_tr_b16 v[66:67], v5 offset:6144
v_mfma_f32_16x16x32_bf16 v[156:159], v[108:111], v[84:87], v[156:159]
ds_read_b64_tr_b16 v[68:69], v6 offset:4096
v_mfma_f32_16x16x32_bf16 v[128:131], v[112:115], v[88:91], v[128:131]
ds_read_b64_tr_b16 v[70:71], v6 offset:6144
v_mfma_f32_16x16x32_bf16 v[132:135], v[116:119], v[88:91], v[132:135]
ds_read_b128 v[44:47], v2 offset:8448
v_mfma_f32_16x16x32_bf16 v[136:139], v[120:123], v[88:91], v[136:139]
ds_read_b64_tr_b16 v[72:73], v7 offset:4096
v_mfma_f32_16x16x32_bf16 v[140:143], v[124:127], v[88:91], v[140:143]
ds_read_b64_tr_b16 v[74:75], v7 offset:6144
v_mfma_f32_16x16x32_bf16 v[144:147], v[112:115], v[92:95], v[144:147]
ds_read_b64_tr_b16 v[76:77], v8 offset:4096
v_mfma_f32_16x16x32_bf16 v[148:151], v[116:119], v[92:95], v[148:151]
ds_read_b64_tr_b16 v[78:79], v8 offset:6144
v_mfma_f32_16x16x32_bf16 v[152:155], v[120:123], v[92:95], v[152:155]
v_mfma_f32_16x16x32_bf16 v[156:159], v[124:127], v[92:95], v[156:159]
s_waitcnt lgkmcnt(0)
s_barrier
v_mfma_f32_16x16x32_bf16 v[128:131], v[48:51], v[32:35], v[128:131]
ds_read_b128 v[80:83], v2 offset:24576
ds_read_b64_tr_b16 v[96:97], v5 offset:24576
v_mfma_f32_16x16x32_bf16 v[132:135], v[52:55], v[32:35], v[132:135]
ds_read_b64_tr_b16 v[98:99], v5 offset:26624
ds_read_b64_tr_b16 v[100:101], v6 offset:24576
v_mfma_f32_16x16x32_bf16 v[136:139], v[56:59], v[32:35], v[136:139]
ds_read_b64_tr_b16 v[102:103], v6 offset:26624
ds_read_b128 v[84:87], v2 offset:24832
v_mfma_f32_16x16x32_bf16 v[140:143], v[60:63], v[32:35], v[140:143]
ds_read_b64_tr_b16 v[104:105], v7 offset:24576
ds_read_b64_tr_b16 v[106:107], v7 offset:26624
v_mfma_f32_16x16x32_bf16 v[144:147], v[48:51], v[36:39], v[144:147]
ds_read_b64_tr_b16 v[108:109], v8 offset:24576
ds_read_b64_tr_b16 v[110:111], v8 offset:26624
v_mfma_f32_16x16x32_bf16 v[148:151], v[52:55], v[36:39], v[148:151]
ds_read_b128 v[88:91], v2 offset:32768
ds_read_b64_tr_b16 v[112:113], v5 offset:28672
v_mfma_f32_16x16x32_bf16 v[152:155], v[56:59], v[36:39], v[152:155]
ds_read_b64_tr_b16 v[114:115], v5 offset:30720
v_mfma_f32_16x16x32_bf16 v[156:159], v[60:63], v[36:39], v[156:159]
ds_read_b64_tr_b16 v[116:117], v6 offset:28672
v_mfma_f32_16x16x32_bf16 v[128:131], v[64:67], v[40:43], v[128:131]
ds_read_b64_tr_b16 v[118:119], v6 offset:30720
v_mfma_f32_16x16x32_bf16 v[132:135], v[68:71], v[40:43], v[132:135]
ds_read_b128 v[92:95], v2 offset:33024
v_mfma_f32_16x16x32_bf16 v[136:139], v[72:75], v[40:43], v[136:139]
ds_read_b64_tr_b16 v[120:121], v7 offset:28672
v_mfma_f32_16x16x32_bf16 v[140:143], v[76:79], v[40:43], v[140:143]
ds_read_b64_tr_b16 v[122:123], v7 offset:30720
v_mfma_f32_16x16x32_bf16 v[144:147], v[64:67], v[44:47], v[144:147]
ds_read_b64_tr_b16 v[124:125], v8 offset:28672
v_mfma_f32_16x16x32_bf16 v[148:151], v[68:71], v[44:47], v[148:151]
ds_read_b64_tr_b16 v[126:127], v8 offset:30720
v_mfma_f32_16x16x32_bf16 v[152:155], v[72:75], v[44:47], v[152:155]
v_mfma_f32_16x16x32_bf16 v[156:159], v[76:79], v[44:47], v[156:159]
s_waitcnt lgkmcnt(0)
s_barrier
v_mfma_f32_16x16x32_bf16 v[128:131], v[96:99], v[80:83], v[128:131]
ds_read_b128 v[32:35], v3 offset:0
ds_read_b64_tr_b16 v[48:49], v9 offset:0
v_mfma_f32_16x16x32_bf16 v[132:135], v[100:103], v[80:83], v[132:135]
ds_read_b64_tr_b16 v[50:51], v9 offset:2048
ds_read_b64_tr_b16 v[52:53], v10 offset:0
v_mfma_f32_16x16x32_bf16 v[136:139], v[104:107], v[80:83], v[136:139]
ds_read_b64_tr_b16 v[54:55], v10 offset:2048
ds_read_b128 v[36:39], v3 offset:256
v_mfma_f32_16x16x32_bf16 v[140:143], v[108:111], v[80:83], v[140:143]
ds_read_b64_tr_b16 v[56:57], v11 offset:0
ds_read_b64_tr_b16 v[58:59], v11 offset:2048
v_mfma_f32_16x16x32_bf16 v[144:147], v[96:99], v[84:87], v[144:147]
ds_read_b64_tr_b16 v[60:61], v12 offset:0
ds_read_b64_tr_b16 v[62:63], v12 offset:2048
v_mfma_f32_16x16x32_bf16 v[148:151], v[100:103], v[84:87], v[148:151]
ds_read_b128 v[40:43], v3 offset:8192
ds_read_b64_tr_b16 v[64:65], v9 offset:4096
v_mfma_f32_16x16x32_bf16 v[152:155], v[104:107], v[84:87], v[152:155]
ds_read_b64_tr_b16 v[66:67], v9 offset:6144
v_mfma_f32_16x16x32_bf16 v[156:159], v[108:111], v[84:87], v[156:159]
ds_read_b64_tr_b16 v[68:69], v10 offset:4096
v_mfma_f32_16x16x32_bf16 v[128:131], v[112:115], v[88:91], v[128:131]
ds_read_b64_tr_b16 v[70:71], v10 offset:6144
v_mfma_f32_16x16x32_bf16 v[132:135], v[116:119], v[88:91], v[132:135]
ds_read_b128 v[44:47], v3 offset:8448
v_mfma_f32_16x16x32_bf16 v[136:139], v[120:123], v[88:91], v[136:139]
ds_read_b64_tr_b16 v[72:73], v11 offset:4096
v_mfma_f32_16x16x32_bf16 v[140:143], v[124:127], v[88:91], v[140:143]
ds_read_b64_tr_b16 v[74:75], v11 offset:6144
v_mfma_f32_16x16x32_bf16 v[144:147], v[112:115], v[92:95], v[144:147]
ds_read_b64_tr_b16 v[76:77], v12 offset:4096
v_mfma_f32_16x16x32_bf16 v[148:151], v[116:119], v[92:95], v[148:151]
ds_read_b64_tr_b16 v[78:79], v12 offset:6144
v_mfma_f32_16x16x32_bf16 v[152:155], v[120:123], v[92:95], v[152:155]
v_mfma_f32_16x16x32_bf16 v[156:159], v[124:127], v[92:95], v[156:159]
s_waitcnt lgkmcnt(0)
s_barrier
v_mfma_f32_16x16x32_bf16 v[128:131], v[48:51], v[32:35], v[128:131]
ds_read_b128 v[80:83], v3 offset:24576
ds_read_b64_tr_b16 v[96:97], v9 offset:24576
v_mfma_f32_16x16x32_bf16 v[132:135], v[52:55], v[32:35], v[132:135]
ds_read_b64_tr_b16 v[98:99], v9 offset:26624
ds_read_b64_tr_b16 v[100:101], v10 offset:24576
v_mfma_f32_16x16x32_bf16 v[136:139], v[56:59], v[32:35], v[136:139]
ds_read_b64_tr_b16 v[102:103], v10 offset:26624
ds_read_b128 v[84:87], v3 offset:24832
v_mfma_f32_16x16x32_bf16 v[140:143], v[60:63], v[32:35], v[140:143]
ds_read_b64_tr_b16 v[104:105], v11 offset:24576
ds_read_b64_tr_b16 v[106:107], v11 offset:26624
v_mfma_f32_16x16x32_bf16 v[144:147], v[48:51], v[36:39], v[144:147]
ds_read_b64_tr_b16 v[108:109], v12 offset:24576
ds_read_b64_tr_b16 v[110:111], v12 offset:26624
v_mfma_f32_16x16x32_bf16 v[148:151], v[52:55], v[36:39], v[148:151]
ds_read_b128 v[88:91], v3 offset:32768
ds_read_b64_tr_b16 v[112:113], v9 offset:28672
v_mfma_f32_16x16x32_bf16 v[152:155], v[56:59], v[36:39], v[152:155]
ds_read_b64_tr_b16 v[114:115], v9 offset:30720
v_mfma_f32_16x16x32_bf16 v[156:159], v[60:63], v[36:39], v[156:159]
ds_read_b64_tr_b16 v[116:117], v10 offset:28672
v_mfma_f32_16x16x32_bf16 v[128:131], v[64:67], v[40:43], v[128:131]
ds_read_b64_tr_b16 v[118:119], v10 offset:30720
v_mfma_f32_16x16x32_bf16 v[132:135], v[68:71], v[40:43], v[132:135]
ds_read_b128 v[92:95], v3 offset:33024
v_mfma_f32_16x16x32_bf16 v[136:139], v[72:75], v[40:43], v[136:139]
ds_read_b64_tr_b16 v[120:121], v11 offset:28672
v_mfma_f32_16x16x32_bf16 v[140:143], v[76:79], v[40:43], v[140:143]
ds_read_b64_tr_b16 v[122:123], v11 offset:30720
v_mfma_f32_16x16x32_bf16 v[144:147], v[64:67], v[44:47], v[144:147]
ds_read_b64_tr_b16 v[124:125], v12 offset:28672
v_mfma_f32_16x16x32_bf16 v[148:151], v[68:71], v[44:47], v[148:151]
ds_read_b64_tr_b16 v[126:127], v12 offset:30720
v_mfma_f32_16x16x32_bf16 v[152:155], v[72:75], v[44:47], v[152:155]
v_mfma_f32_16x16x32_bf16 v[156:159], v[76:79], v[44:47], v[156:159]
s_waitcnt lgkmcnt(0)
s_barrier
v_mfma_f32_16x16x32_bf16 v[128:131], v[96:99], v[80:83], v[128:131]
v_mfma_f32_16x16x32_bf16 v[132:135], v[100:103], v[80:83], v[132:135]
v_mfma_f32_16x16x32_bf16 v[136:139], v[104:107], v[80:83], v[136:139]
v_mfma_f32_16x16x32_bf16 v[140:143], v[108:111], v[80:83], v[140:143]
v_mfma_f32_16x16x32_bf16 v[144:147], v[96:99], v[84:87], v[144:147]
v_mfma_f32_16x16x32_bf16 v[148:151], v[100:103], v[84:87], v[148:151]
v_mfma_f32_16x16x32_bf16 v[152:155], v[104:107], v[84:87], v[152:155]
v_mfma_f32_16x16x32_bf16 v[156:159], v[108:111], v[84:87], v[156:159]
v_mfma_f32_16x16x32_bf16 v[128:131], v[112:115], v[88:91], v[128:131]
v_mfma_f32_16x16x32_bf16 v[132:135], v[116:119], v[88:91], v[132:135]
v_mfma_f32_16x16x32_bf16 v[136:139], v[120:123], v[88:91], v[136:139]
v_mfma_f32_16x16x32_bf16 v[140:143], v[124:127], v[88:91], v[140:143]
v_mfma_f32_16x16x32_bf16 v[144:147], v[112:115], v[92:95], v[144:147]
v_mfma_f32_16x16x32_bf16 v[148:151], v[116:119], v[92:95], v[148:151]
v_mfma_f32_16x16x32_bf16 v[152:155], v[120:123], v[92:95], v[152:155]
v_mfma_f32_16x16x32_bf16 v[156:159], v[124:127], v[92:95], v[156:159]
s_nop 4
v_cvt_pk_bf16_f32 v96, v128, v129
v_cvt_pk_bf16_f32 v97, v130, v131
v_cvt_pk_bf16_f32 v98, v132, v133
v_cvt_pk_bf16_f32 v99, v134, v135
v_cvt_pk_bf16_f32 v100, v136, v137
v_cvt_pk_bf16_f32 v101, v138, v139
v_cvt_pk_bf16_f32 v102, v140, v141
v_cvt_pk_bf16_f32 v103, v142, v143
v_cvt_pk_bf16_f32 v104, v144, v145
v_cvt_pk_bf16_f32 v105, v146, v147
v_cvt_pk_bf16_f32 v106, v148, v149
v_cvt_pk_bf16_f32 v107, v150, v151
v_cvt_pk_bf16_f32 v108, v152, v153
v_cvt_pk_bf16_f32 v109, v154, v155
v_cvt_pk_bf16_f32 v110, v156, v157
v_cvt_pk_bf16_f32 v111, v158, v159
v_permlane16_swap_b32 v96, v98
v_permlane16_swap_b32 v97, v99
buffer_store_dwordx4 v[96:99], v28, s[16:19], 0 offen offset:0
v_permlane16_swap_b32 v100, v102
v_permlane16_swap_b32 v101, v103
buffer_store_dwordx4 v[100:103], v28, s[16:19], 0 offen offset:64
v_permlane16_swap_b32 v104, v106
v_permlane16_swap_b32 v105, v107
buffer_store_dwordx4 v[104:107], v28, s[16:19], 0 offen offset:2048
v_permlane16_swap_b32 v108, v110
v_permlane16_swap_b32 v109, v111
buffer_store_dwordx4 v[108:111], v28, s[16:19], 0 offen offset:2112
s_branch Ldone_1
LG1_16:
s_cmp_eq_u32 s36, 7
s_cbranch_scc1 L7_25
s_mul_i32 s44, s34, 262144
s_lshl_b32 s39, s51, 13
s_add_u32 s44, s44, s39
s_add_u32 s44, s44, 0
s_lshl_b32 s43, s35, 7
s_mov_b32 s10, 253952
s_movk_i32 s38, 1024
s_movk_i32 s40, 9216
s_cmp_eq_u32 s51, 2
s_cselect_b32 s8, s28, s32
s_cselect_b32 s9, s29, s33
s_cselect_b32 s10, 2095232, s10
s_cselect_b32 s43, s43, s44
s_cselect_b32 s38, 16384, s38
s_cselect_b32 s40, 16384, s40
s_cselect_b32 s55, 16384, s38
s_cselect_b32 s45, -1, 0
s_add_u32 s8, s8, s43
s_addc_u32 s9, s9, 0
s_mov_b32 s11, 0x20000
s_sub_u32 s37, 0, s40
v_lshrrev_b32 v19, 3, v1
v_mul_u32_u24 v19, 1920, v19
v_lshrrev_b32 v20, 4, v1
v_lshlrev_b32 v20, 5, v20
v_and_b32 v19, s45, v19
v_and_b32 v20, s45, v20
v_lshlrev_b32 v23, 4, v1
v_xor_b32 v23, v23, v20
v_add_u32 v23, v23, v19
s_lshl_b32 s43, s34, 18
s_add_u32 s12, s32, s43
s_addc_u32 s13, s33, 0
s_mov_b32 s14, 262144
s_mov_b32 s15, 0x20000
v_lshlrev_b32 v21, 4, v1
s_lshl_b32 s54, s36, 11
s_cmp_eq_u32 s51, 1
s_cbranch_scc1 Lp_29
s_cmp_eq_u32 s51, 2
s_cbranch_scc1 Lp_30
Lp_28:
s_add_u32 s43, s34, 0
s_lshl_b32 s43, s43, 7
v_mov_b32 v12, s43
v_mov_b32 v14, 16
buffer_load_dword v13, v12, s[56:59], 0 offen sc1
s_mov_b32 s41, 0x10000
Lpoll_31:
s_waitcnt vmcnt(0)
v_cmp_ne_u32 vcc, v14, v13
s_nop 4
s_cbranch_vccz Lpok_32
buffer_load_dword v13, v12, s[56:59], 0 offen sc1
s_sub_u32 s41, s41, 1
s_cmp_lg_u32 s41, 0
s_cbranch_scc1 Lpoll_31
s_waitcnt vmcnt(0)
Lpok_32:
s_barrier
s_add_u32 m0, s54, 0
s_add_u32 s43, s54, 0
buffer_load_dwordx4 v21, s[12:15], s43 offen sc1 lds
s_add_u32 m0, s54, 1024
s_add_u32 s43, s54, 1024
buffer_load_dwordx4 v21, s[12:15], s43 offen sc1 lds
s_add_u32 m0, s54, 24576
s_add_u32 s43, s54, 16384
buffer_load_dwordx4 v21, s[12:15], s43 offen sc1 lds
s_add_u32 m0, s54, 25600
s_add_u32 s43, s54, 17408
buffer_load_dwordx4 v21, s[12:15], s43 offen sc1 lds
s_add_u32 s37, s37, 32768
s_add_u32 m0, s39, 49152
s_add_u32 s37, s37, s40
buffer_load_dwordx4 v23, s[8:11], s37 offen sc1 lds
s_add_u32 m0, s39, 50176
s_add_u32 s37, s37, s38
buffer_load_dwordx4 v23, s[8:11], s37 offen sc1 lds
s_add_u32 m0, s39, 51200
s_add_u32 s37, s37, s38
buffer_load_dwordx4 v23, s[8:11], s37 offen sc1 lds
s_add_u32 m0, s39, 52224
s_add_u32 s37, s37, s38
buffer_load_dwordx4 v23, s[8:11], s37 offen sc1 lds
s_add_u32 m0, s39, 53248
s_add_u32 s37, s37, s55
buffer_load_dwordx4 v23, s[8:11], s37 offen sc1 lds
s_add_u32 m0, s39, 54272
s_add_u32 s37, s37, s38
buffer_load_dwordx4 v23, s[8:11], s37 offen sc1 lds
s_add_u32 m0, s39, 55296
s_add_u32 s37, s37, s38
buffer_load_dwordx4 v23, s[8:11], s37 offen sc1 lds
s_add_u32 m0, s39, 56320
s_add_u32 s37, s37, s38
buffer_load_dwordx4 v23, s[8:11], s37 offen sc1 lds
s_add_u32 m0, s39, 73728
s_add_u32 s37, s37, s40
buffer_load_dwordx4 v23, s[8:11], s37 offen sc1 lds
s_add_u32 m0, s39, 74752
s_add_u32 s37, s37, s38
buffer_load_dwordx4 v23, s[8:11], s37 offen sc1 lds
s_add_u32 m0, s39, 75776
s_add_u32 s37, s37, s38
buffer_load_dwordx4 v23, s[8:11], s37 offen sc1 lds
s_add_u32 m0, s39, 76800
s_add_u32 s37, s37, s38
buffer_load_dwordx4 v23, s[8:11], s37 offen sc1 lds
s_add_u32 m0, s39, 77824
s_add_u32 s37, s37, s55
buffer_load_dwordx4 v23, s[8:11], s37 offen sc1 lds
s_add_u32 m0, s39, 78848
s_add_u32 s37, s37, s38
buffer_load_dwordx4 v23, s[8:11], s37 offen sc1 lds
s_add_u32 m0, s39, 79872
s_add_u32 s37, s37, s38
buffer_load_dwordx4 v23, s[8:11], s37 offen sc1 lds
s_add_u32 m0, s39, 80896
s_add_u32 s37, s37, s38
buffer_load_dwordx4 v23, s[8:11], s37 offen sc1 lds
s_add_u32 m0, s39, 98304
s_add_u32 s37, s37, s40
buffer_load_dwordx4 v23, s[8:11], s37 offen sc1 lds
s_add_u32 m0, s39, 99328
s_add_u32 s37, s37, s38
buffer_load_dwordx4 v23, s[8:11], s37 offen sc1 lds
s_add_u32 m0, s39, 100352
s_add_u32 s37, s37, s38
buffer_load_dwordx4 v23, s[8:11], s37 offen sc1 lds
s_add_u32 m0, s39, 101376
s_add_u32 s37, s37, s38
buffer_load_dwordx4 v23, s[8:11], s37 offen sc1 lds
s_add_u32 m0, s39, 102400
s_add_u32 s37, s37, s55
buffer_load_dwordx4 v23, s[8:11], s37 offen sc1 lds
s_add_u32 m0, s39, 103424
s_add_u32 s37, s37, s38
buffer_load_dwordx4 v23, s[8:11], s37 offen sc1 lds
s_add_u32 m0, s39, 104448
s_add_u32 s37, s37, s38
buffer_load_dwordx4 v23, s[8:11], s37 offen sc1 lds
s_add_u32 m0, s39, 105472
s_add_u32 s37, s37, s38
buffer_load_dwordx4 v23, s[8:11], s37 offen sc1 lds
s_add_u32 m0, s39, 122880
s_add_u32 s37, s37, s40
buffer_load_dwordx4 v23, s[8:11], s37 offen sc1 lds
s_add_u32 m0, s39, 123904
s_add_u32 s37, s37, s38
buffer_load_dwordx4 v23, s[8:11], s37 offen sc1 lds
s_add_u32 m0, s39, 124928
s_add_u32 s37, s37, s38
buffer_load_dwordx4 v23, s[8:11], s37 offen sc1 lds
s_add_u32 m0, s39, 125952
s_add_u32 s37, s37, s38
buffer_load_dwordx4 v23, s[8:11], s37 offen sc1 lds
s_add_u32 m0, s39, 126976
s_add_u32 s37, s37, s55
buffer_load_dwordx4 v23, s[8:11], s37 offen sc1 lds
s_add_u32 m0, s39, 128000
s_add_u32 s37, s37, s38
buffer_load_dwordx4 v23, s[8:11], s37 offen sc1 lds
s_add_u32 m0, s39, 129024
s_add_u32 s37, s37, s38
buffer_load_dwordx4 v23, s[8:11], s37 offen sc1 lds
s_add_u32 m0, s39, 130048
s_add_u32 s37, s37, s38
buffer_load_dwordx4 v23, s[8:11], s37 offen sc1 lds
s_waitcnt vmcnt(34)
s_barrier
s_waitcnt vmcnt(32)
s_barrier
s_add_u32 m0, s39, 0
s_add_u32 s37, s37, s40
buffer_load_dwordx4 v23, s[8:11], s37 offen sc1 lds
s_add_u32 m0, s39, 1024
s_add_u32 s37, s37, s38
buffer_load_dwordx4 v23, s[8:11], s37 offen sc1 lds
s_add_u32 m0, s39, 2048
s_add_u32 s37, s37, s38
buffer_load_dwordx4 v23, s[8:11], s37 offen sc1 lds
s_add_u32 m0, s39, 3072
s_add_u32 s37, s37, s38
buffer_load_dwordx4 v23, s[8:11], s37 offen sc1 lds
s_add_u32 m0, s39, 4096
s_add_u32 s37, s37, s55
buffer_load_dwordx4 v23, s[8:11], s37 offen sc1 lds
s_add_u32 m0, s39, 5120
s_add_u32 s37, s37, s38
buffer_load_dwordx4 v23, s[8:11], s37 offen sc1 lds
s_add_u32 m0, s39, 6144
s_add_u32 s37, s37, s38
buffer_load_dwordx4 v23, s[8:11], s37 offen sc1 lds
s_add_u32 m0, s39, 7168
s_add_u32 s37, s37, s38
buffer_load_dwordx4 v23, s[8:11], s37 offen sc1 lds
s_waitcnt vmcnt(32)
s_barrier
s_add_u32 m0, s39, 24576
s_add_u32 s37, s37, s40
buffer_load_dwordx4 v23, s[8:11], s37 offen sc1 lds
s_add_u32 m0, s39, 25600
s_add_u32 s37, s37, s38
buffer_load_dwordx4 v23, s[8:11], s37 offen sc1 lds
s_add_u32 m0, s39, 26624
s_add_u32 s37, s37, s38
buffer_load_dwordx4 v23, s[8:11], s37 offen sc1 lds
s_add_u32 m0, s39, 27648
s_add_u32 s37, s37, s38
buffer_load_dwordx4 v23, s[8:11], s37 offen sc1 lds
s_add_u32 m0, s39, 28672
s_add_u32 s37, s37, s55
buffer_load_dwordx4 v23, s[8:11], s37 offen sc1 lds
s_add_u32 m0, s39, 29696
s_add_u32 s37, s37, s38
buffer_load_dwordx4 v23, s[8:11], s37 offen sc1 lds
s_add_u32 m0, s39, 30720
s_add_u32 s37, s37, s38
buffer_load_dwordx4 v23, s[8:11], s37 offen sc1 lds
s_add_u32 m0, s39, 31744
s_add_u32 s37, s37, s38
buffer_load_dwordx4 v23, s[8:11], s37 offen sc1 lds
s_waitcnt vmcnt(32)
s_barrier
s_add_u32 m0, s39, 49152
s_add_u32 s37, s37, s40
buffer_load_dwordx4 v23, s[8:11], s37 offen sc1 lds
s_add_u32 m0, s39, 50176
s_add_u32 s37, s37, s38
buffer_load_dwordx4 v23, s[8:11], s37 offen sc1 lds
s_add_u32 m0, s39, 51200
s_add_u32 s37, s37, s38
buffer_load_dwordx4 v23, s[8:11], s37 offen sc1 lds
s_add_u32 m0, s39, 52224
s_add_u32 s37, s37, s38
buffer_load_dwordx4 v23, s[8:11], s37 offen sc1 lds
s_add_u32 m0, s39, 53248
s_add_u32 s37, s37, s55
buffer_load_dwordx4 v23, s[8:11], s37 offen sc1 lds
s_add_u32 m0, s39, 54272
s_add_u32 s37, s37, s38
buffer_load_dwordx4 v23, s[8:11], s37 offen sc1 lds
s_add_u32 m0, s39, 55296
s_add_u32 s37, s37, s38
buffer_load_dwordx4 v23, s[8:11], s37 offen sc1 lds
s_add_u32 m0, s39, 56320
s_add_u32 s37, s37, s38
buffer_load_dwordx4 v23, s[8:11], s37 offen sc1 lds
s_waitcnt vmcnt(32)
s_barrier
s_add_u32 m0, s39, 73728
s_add_u32 s37, s37, s40
buffer_load_dwordx4 v23, s[8:11], s37 offen sc1 lds
s_add_u32 m0, s39, 74752
s_add_u32 s37, s37, s38
buffer_load_dwordx4 v23, s[8:11], s37 offen sc1 lds
s_add_u32 m0, s39, 75776
s_add_u32 s37, s37, s38
buffer_load_dwordx4 v23, s[8:11], s37 offen sc1 lds
s_add_u32 m0, s39, 76800
s_add_u32 s37, s37, s38
buffer_load_dwordx4 v23, s[8:11], s37 offen sc1 lds
s_add_u32 m0, s39, 77824
s_add_u32 s37, s37, s55
buffer_load_dwordx4 v23, s[8:11], s37 offen sc1 lds
s_add_u32 m0, s39, 78848
s_add_u32 s37, s37, s38
buffer_load_dwordx4 v23, s[8:11], s37 offen sc1 lds
s_add_u32 m0, s39, 79872
s_add_u32 s37, s37, s38
buffer_load_dwordx4 v23, s[8:11], s37 offen sc1 lds
s_add_u32 m0, s39, 80896
s_add_u32 s37, s37, s38
buffer_load_dwordx4 v23, s[8:11], s37 offen sc1 lds
s_waitcnt vmcnt(32)
s_barrier
s_add_u32 m0, s39, 98304
s_add_u32 s37, s37, s40
buffer_load_dwordx4 v23, s[8:11], s37 offen sc1 lds
s_add_u32 m0, s39, 99328
s_add_u32 s37, s37, s38
buffer_load_dwordx4 v23, s[8:11], s37 offen sc1 lds
s_add_u32 m0, s39, 100352
s_add_u32 s37, s37, s38
buffer_load_dwordx4 v23, s[8:11], s37 offen sc1 lds
s_add_u32 m0, s39, 101376
s_add_u32 s37, s37, s38
buffer_load_dwordx4 v23, s[8:11], s37 offen sc1 lds
s_add_u32 m0, s39, 102400
s_add_u32 s37, s37, s55
buffer_load_dwordx4 v23, s[8:11], s37 offen sc1 lds
s_add_u32 m0, s39, 103424
s_add_u32 s37, s37, s38
buffer_load_dwordx4 v23, s[8:11], s37 offen sc1 lds
s_add_u32 m0, s39, 104448
s_add_u32 s37, s37, s38
buffer_load_dwordx4 v23, s[8:11], s37 offen sc1 lds
s_add_u32 m0, s39, 105472
s_add_u32 s37, s37, s38
buffer_load_dwordx4 v23, s[8:11], s37 offen sc1 lds
s_waitcnt vmcnt(32)
s_barrier
s_add_u32 m0, s39, 122880
s_add_u32 s37, s37, s40
buffer_load_dwordx4 v23, s[8:11], s37 offen sc1 lds
s_add_u32 m0, s39, 123904
s_add_u32 s37, s37, s38
buffer_load_dwordx4 v23, s[8:11], s37 offen sc1 lds
s_add_u32 m0, s39, 124928
s_add_u32 s37, s37, s38
buffer_load_dwordx4 v23, s[8:11], s37 offen sc1 lds
s_add_u32 m0, s39, 125952
s_add_u32 s37, s37, s38
buffer_load_dwordx4 v23, s[8:11], s37 offen sc1 lds
s_add_u32 m0, s39, 126976
s_add_u32 s37, s37, s55
buffer_load_dwordx4 v23, s[8:11], s37 offen sc1 lds
s_add_u32 m0, s39, 128000
s_add_u32 s37, s37, s38
buffer_load_dwordx4 v23, s[8:11], s37 offen sc1 lds
s_add_u32 m0, s39, 129024
s_add_u32 s37, s37, s38
buffer_load_dwordx4 v23, s[8:11], s37 offen sc1 lds
s_add_u32 m0, s39, 130048
s_add_u32 s37, s37, s38
buffer_load_dwordx4 v23, s[8:11], s37 offen sc1 lds
s_waitcnt vmcnt(32)
s_barrier
s_add_u32 m0, s39, 0
s_add_u32 s37, s37, s40
buffer_load_dwordx4 v23, s[8:11], s37 offen sc1 lds
s_add_u32 m0, s39, 1024
s_add_u32 s37, s37, s38
buffer_load_dwordx4 v23, s[8:11], s37 offen sc1 lds
s_add_u32 m0, s39, 2048
s_add_u32 s37, s37, s38
buffer_load_dwordx4 v23, s[8:11], s37 offen sc1 lds
s_add_u32 m0, s39, 3072
s_add_u32 s37, s37, s38
buffer_load_dwordx4 v23, s[8:11], s37 offen sc1 lds
s_add_u32 m0, s39, 4096
s_add_u32 s37, s37, s55
buffer_load_dwordx4 v23, s[8:11], s37 offen sc1 lds
s_add_u32 m0, s39, 5120
s_add_u32 s37, s37, s38
buffer_load_dwordx4 v23, s[8:11], s37 offen sc1 lds
s_add_u32 m0, s39, 6144
s_add_u32 s37, s37, s38
buffer_load_dwordx4 v23, s[8:11], s37 offen sc1 lds
s_add_u32 m0, s39, 7168
s_add_u32 s37, s37, s38
buffer_load_dwordx4 v23, s[8:11], s37 offen sc1 lds
s_waitcnt vmcnt(32)
s_barrier
s_add_u32 m0, s39, 24576
s_add_u32 s37, s37, s40
buffer_load_dwordx4 v23, s[8:11], s37 offen sc1 lds
s_add_u32 m0, s39, 25600
s_add_u32 s37, s37, s38
buffer_load_dwordx4 v23, s[8:11], s37 offen sc1 lds
s_add_u32 m0, s39, 26624
s_add_u32 s37, s37, s38
buffer_load_dwordx4 v23, s[8:11], s37 offen sc1 lds
s_add_u32 m0, s39, 27648
s_add_u32 s37, s37, s38
buffer_load_dwordx4 v23, s[8:11], s37 offen sc1 lds
s_add_u32 m0, s39, 28672
s_add_u32 s37, s37, s55
buffer_load_dwordx4 v23, s[8:11], s37 offen sc1 lds
s_add_u32 m0, s39, 29696
s_add_u32 s37, s37, s38
buffer_load_dwordx4 v23, s[8:11], s37 offen sc1 lds
s_add_u32 m0, s39, 30720
s_add_u32 s37, s37, s38
buffer_load_dwordx4 v23, s[8:11], s37 offen sc1 lds
s_add_u32 m0, s39, 31744
s_add_u32 s37, s37, s38
buffer_load_dwordx4 v23, s[8:11], s37 offen sc1 lds
s_waitcnt vmcnt(32)
s_barrier
s_add_u32 m0, s39, 49152
s_add_u32 s37, s37, s40
buffer_load_dwordx4 v23, s[8:11], s37 offen sc1 lds
s_add_u32 m0, s39, 50176
s_add_u32 s37, s37, s38
buffer_load_dwordx4 v23, s[8:11], s37 offen sc1 lds
s_add_u32 m0, s39, 51200
s_add_u32 s37, s37, s38
buffer_load_dwordx4 v23, s[8:11], s37 offen sc1 lds
s_add_u32 m0, s39, 52224
s_add_u32 s37, s37, s38
buffer_load_dwordx4 v23, s[8:11], s37 offen sc1 lds
s_add_u32 m0, s39, 53248
s_add_u32 s37, s37, s55
buffer_load_dwordx4 v23, s[8:11], s37 offen sc1 lds
s_add_u32 m0, s39, 54272
s_add_u32 s37, s37, s38
buffer_load_dwordx4 v23, s[8:11], s37 offen sc1 lds
s_add_u32 m0, s39, 55296
s_add_u32 s37, s37, s38
buffer_load_dwordx4 v23, s[8:11], s37 offen sc1 lds
s_add_u32 m0, s39, 56320
s_add_u32 s37, s37, s38
buffer_load_dwordx4 v23, s[8:11], s37 offen sc1 lds
s_waitcnt vmcnt(32)
s_barrier
s_add_u32 m0, s39, 73728
s_add_u32 s37, s37, s40
buffer_load_dwordx4 v23, s[8:11], s37 offen sc1 lds
s_add_u32 m0, s39, 74752
s_add_u32 s37, s37, s38
buffer_load_dwordx4 v23, s[8:11], s37 offen sc1 lds
s_add_u32 m0, s39, 75776
s_add_u32 s37, s37, s38
buffer_load_dwordx4 v23, s[8:11], s37 offen sc1 lds
s_add_u32 m0, s39, 76800
s_add_u32 s37, s37, s38
buffer_load_dwordx4 v23, s[8:11], s37 offen sc1 lds
s_add_u32 m0, s39, 77824
s_add_u32 s37, s37, s55
buffer_load_dwordx4 v23, s[8:11], s37 offen sc1 lds
s_add_u32 m0, s39, 78848
s_add_u32 s37, s37, s38
buffer_load_dwordx4 v23, s[8:11], s37 offen sc1 lds
s_add_u32 m0, s39, 79872
s_add_u32 s37, s37, s38
buffer_load_dwordx4 v23, s[8:11], s37 offen sc1 lds
s_add_u32 m0, s39, 80896
s_add_u32 s37, s37, s38
buffer_load_dwordx4 v23, s[8:11], s37 offen sc1 lds
s_waitcnt vmcnt(32)
s_barrier
s_lshl_b32 s43, s35, 8
s_cmp_eq_u32 s51, 1
s_cselect_b32 s8, s4, s6
s_cselect_b32 s9, s5, s7
s_sub_u32 s10, 7340032, s43
s_lshl_b32 s44, s34, 18
s_add_u32 s44, s44, 4194304
s_movk_i32 s38, 28672
s_cmp_eq_u32 s51, 0
s_cselect_b32 s8, s32, s8
s_cselect_b32 s9, s33, s9
s_cselect_b32 s10, 262144, s10
s_cselect_b32 s43, s44, s43
s_cselect_b32 s38, 1024, s38
s_cselect_b32 s45, 0, -1
s_add_u32 s8, s8, s43
s_addc_u32 s9, s9, 0
s_mov_b32 s11, 0x20000
s_sub_u32 s37, 0, s38
s_lshl_b32 s39, s51, 14
v_lshrrev_b32 v19, 4, v1
v_lshlrev_b32 v20, 5, v19
v_mul_u32_u24 v19, 6912, v19
v_and_b32 v19, s45, v19
v_and_b32 v20, s45, v20
v_lshlrev_b32 v21, 4, v1
v_xor_b32 v21, v21, v20
v_add_u32 v22, v21, v19
s_and_b32 s45, s45, 128
v_xor_b32 v23, s45, v22
s_waitcnt vmcnt(24)
s_barrier
s_waitcnt vmcnt(16)
s_barrier
s_waitcnt vmcnt(8)
s_barrier
s_waitcnt vmcnt(0)
s_barrier
s_barrier
s_barrier
s_mul_i32 s43, s38, 48
s_add_u32 s37, s37, s43
s_add_u32 s43, s34, 16
s_lshl_b32 s43, s43, 7
v_mov_b32 v12, s43
v_mov_b32 v14, 16
buffer_load_dword v13, v12, s[56:59], 0 offen sc1
s_mov_b32 s41, 0x10000
Lpoll_33:
s_waitcnt vmcnt(0)
v_cmp_ne_u32 vcc, v14, v13
s_nop 4
s_cbranch_vccz Lpok_34
buffer_load_dword v13, v12, s[56:59], 0 offen sc1
s_sub_u32 s41, s41, 1
s_cmp_lg_u32 s41, 0
s_cbranch_scc1 Lpoll_33
s_waitcnt vmcnt(0)
Lpok_34:
s_branch LP3_27
Lp_29:
s_barrier
s_add_u32 m0, s54, 0
s_add_u32 s43, s54, 0
buffer_load_dwordx4 v21, s[12:15], s43 offen sc1 lds
s_add_u32 m0, s54, 1024
s_add_u32 s43, s54, 1024
buffer_load_dwordx4 v21, s[12:15], s43 offen sc1 lds
s_add_u32 m0, s54, 24576
s_add_u32 s43, s54, 16384
buffer_load_dwordx4 v21, s[12:15], s43 offen sc1 lds
s_add_u32 m0, s54, 25600
s_add_u32 s43, s54, 17408
buffer_load_dwordx4 v21, s[12:15], s43 offen sc1 lds
s_add_u32 s37, s37, 32768
s_add_u32 m0, s39, 49152
s_add_u32 s37, s37, s40
buffer_load_dwordx4 v23, s[8:11], s37 offen sc1 lds
s_add_u32 m0, s39, 50176
s_add_u32 s37, s37, s38
buffer_load_dwordx4 v23, s[8:11], s37 offen sc1 lds
s_add_u32 m0, s39, 51200
s_add_u32 s37, s37, s38
buffer_load_dwordx4 v23, s[8:11], s37 offen sc1 lds
s_add_u32 m0, s39, 52224
s_add_u32 s37, s37, s38
buffer_load_dwordx4 v23, s[8:11], s37 offen sc1 lds
s_add_u32 m0, s39, 53248
s_add_u32 s37, s37, s55
buffer_load_dwordx4 v23, s[8:11], s37 offen sc1 lds
s_add_u32 m0, s39, 54272
s_add_u32 s37, s37, s38
buffer_load_dwordx4 v23, s[8:11], s37 offen sc1 lds
s_add_u32 m0, s39, 55296
s_add_u32 s37, s37, s38
buffer_load_dwordx4 v23, s[8:11], s37 offen sc1 lds
s_add_u32 m0, s39, 56320
s_add_u32 s37, s37, s38
buffer_load_dwordx4 v23, s[8:11], s37 offen sc1 lds
s_add_u32 m0, s39, 73728
s_add_u32 s37, s37, s40
buffer_load_dwordx4 v23, s[8:11], s37 offen sc1 lds
s_add_u32 m0, s39, 74752
s_add_u32 s37, s37, s38
buffer_load_dwordx4 v23, s[8:11], s37 offen sc1 lds
s_add_u32 m0, s39, 75776
s_add_u32 s37, s37, s38
buffer_load_dwordx4 v23, s[8:11], s37 offen sc1 lds
s_add_u32 m0, s39, 76800
s_add_u32 s37, s37, s38
buffer_load_dwordx4 v23, s[8:11], s37 offen sc1 lds
s_add_u32 m0, s39, 77824
s_add_u32 s37, s37, s55
buffer_load_dwordx4 v23, s[8:11], s37 offen sc1 lds
s_add_u32 m0, s39, 78848
s_add_u32 s37, s37, s38
buffer_load_dwordx4 v23, s[8:11], s37 offen sc1 lds
s_add_u32 m0, s39, 79872
s_add_u32 s37, s37, s38
buffer_load_dwordx4 v23, s[8:11], s37 offen sc1 lds
s_add_u32 m0, s39, 80896
s_add_u32 s37, s37, s38
buffer_load_dwordx4 v23, s[8:11], s37 offen sc1 lds
s_add_u32 m0, s39, 98304
s_add_u32 s37, s37, s40
buffer_load_dwordx4 v23, s[8:11], s37 offen sc1 lds
s_add_u32 m0, s39, 99328
s_add_u32 s37, s37, s38
buffer_load_dwordx4 v23, s[8:11], s37 offen sc1 lds
s_add_u32 m0, s39, 100352
s_add_u32 s37, s37, s38
buffer_load_dwordx4 v23, s[8:11], s37 offen sc1 lds
s_add_u32 m0, s39, 101376
s_add_u32 s37, s37, s38
buffer_load_dwordx4 v23, s[8:11], s37 offen sc1 lds
s_add_u32 m0, s39, 102400
s_add_u32 s37, s37, s55
buffer_load_dwordx4 v23, s[8:11], s37 offen sc1 lds
s_add_u32 m0, s39, 103424
s_add_u32 s37, s37, s38
buffer_load_dwordx4 v23, s[8:11], s37 offen sc1 lds
s_add_u32 m0, s39, 104448
s_add_u32 s37, s37, s38
buffer_load_dwordx4 v23, s[8:11], s37 offen sc1 lds
s_add_u32 m0, s39, 105472
s_add_u32 s37, s37, s38
buffer_load_dwordx4 v23, s[8:11], s37 offen sc1 lds
s_add_u32 m0, s39, 122880
s_add_u32 s37, s37, s40
buffer_load_dwordx4 v23, s[8:11], s37 offen sc1 lds
s_add_u32 m0, s39, 123904
s_add_u32 s37, s37, s38
buffer_load_dwordx4 v23, s[8:11], s37 offen sc1 lds
s_add_u32 m0, s39, 124928
s_add_u32 s37, s37, s38
buffer_load_dwordx4 v23, s[8:11], s37 offen sc1 lds
s_add_u32 m0, s39, 125952
s_add_u32 s37, s37, s38
buffer_load_dwordx4 v23, s[8:11], s37 offen sc1 lds
s_add_u32 m0, s39, 126976
s_add_u32 s37, s37, s55
buffer_load_dwordx4 v23, s[8:11], s37 offen sc1 lds
s_add_u32 m0, s39, 128000
s_add_u32 s37, s37, s38
buffer_load_dwordx4 v23, s[8:11], s37 offen sc1 lds
s_add_u32 m0, s39, 129024
s_add_u32 s37, s37, s38
buffer_load_dwordx4 v23, s[8:11], s37 offen sc1 lds
s_add_u32 m0, s39, 130048
s_add_u32 s37, s37, s38
buffer_load_dwordx4 v23, s[8:11], s37 offen sc1 lds
s_waitcnt vmcnt(34)
s_barrier
s_waitcnt vmcnt(32)
s_barrier
s_add_u32 m0, s39, 0
s_add_u32 s37, s37, s40
buffer_load_dwordx4 v23, s[8:11], s37 offen sc1 lds
s_add_u32 m0, s39, 1024
s_add_u32 s37, s37, s38
buffer_load_dwordx4 v23, s[8:11], s37 offen sc1 lds
s_add_u32 m0, s39, 2048
s_add_u32 s37, s37, s38
buffer_load_dwordx4 v23, s[8:11], s37 offen sc1 lds
s_add_u32 m0, s39, 3072
s_add_u32 s37, s37, s38
buffer_load_dwordx4 v23, s[8:11], s37 offen sc1 lds
s_add_u32 m0, s39, 4096
s_add_u32 s37, s37, s55
buffer_load_dwordx4 v23, s[8:11], s37 offen sc1 lds
s_add_u32 m0, s39, 5120
s_add_u32 s37, s37, s38
buffer_load_dwordx4 v23, s[8:11], s37 offen sc1 lds
s_add_u32 m0, s39, 6144
s_add_u32 s37, s37, s38
buffer_load_dwordx4 v23, s[8:11], s37 offen sc1 lds
s_add_u32 m0, s39, 7168
s_add_u32 s37, s37, s38
buffer_load_dwordx4 v23, s[8:11], s37 offen sc1 lds
s_waitcnt vmcnt(32)
s_barrier
s_add_u32 m0, s39, 24576
s_add_u32 s37, s37, s40
buffer_load_dwordx4 v23, s[8:11], s37 offen sc1 lds
s_add_u32 m0, s39, 25600
s_add_u32 s37, s37, s38
buffer_load_dwordx4 v23, s[8:11], s37 offen sc1 lds
s_add_u32 m0, s39, 26624
s_add_u32 s37, s37, s38
buffer_load_dwordx4 v23, s[8:11], s37 offen sc1 lds
s_add_u32 m0, s39, 27648
s_add_u32 s37, s37, s38
buffer_load_dwordx4 v23, s[8:11], s37 offen sc1 lds
s_add_u32 m0, s39, 28672
s_add_u32 s37, s37, s55
buffer_load_dwordx4 v23, s[8:11], s37 offen sc1 lds
s_add_u32 m0, s39, 29696
s_add_u32 s37, s37, s38
buffer_load_dwordx4 v23, s[8:11], s37 offen sc1 lds
s_add_u32 m0, s39, 30720
s_add_u32 s37, s37, s38
buffer_load_dwordx4 v23, s[8:11], s37 offen sc1 lds
s_add_u32 m0, s39, 31744
s_add_u32 s37, s37, s38
buffer_load_dwordx4 v23, s[8:11], s37 offen sc1 lds
s_waitcnt vmcnt(32)
s_barrier
s_add_u32 m0, s39, 49152
s_add_u32 s37, s37, s40
buffer_load_dwordx4 v23, s[8:11], s37 offen sc1 lds
s_add_u32 m0, s39, 50176
s_add_u32 s37, s37, s38
buffer_load_dwordx4 v23, s[8:11], s37 offen sc1 lds
s_add_u32 m0, s39, 51200
s_add_u32 s37, s37, s38
buffer_load_dwordx4 v23, s[8:11], s37 offen sc1 lds
s_add_u32 m0, s39, 52224
s_add_u32 s37, s37, s38
buffer_load_dwordx4 v23, s[8:11], s37 offen sc1 lds
s_add_u32 m0, s39, 53248
s_add_u32 s37, s37, s55
buffer_load_dwordx4 v23, s[8:11], s37 offen sc1 lds
s_add_u32 m0, s39, 54272
s_add_u32 s37, s37, s38
buffer_load_dwordx4 v23, s[8:11], s37 offen sc1 lds
s_add_u32 m0, s39, 55296
s_add_u32 s37, s37, s38
buffer_load_dwordx4 v23, s[8:11], s37 offen sc1 lds
s_add_u32 m0, s39, 56320
s_add_u32 s37, s37, s38
buffer_load_dwordx4 v23, s[8:11], s37 offen sc1 lds
s_waitcnt vmcnt(32)
s_barrier
s_add_u32 m0, s39, 73728
s_add_u32 s37, s37, s40
buffer_load_dwordx4 v23, s[8:11], s37 offen sc1 lds
s_add_u32 m0, s39, 74752
s_add_u32 s37, s37, s38
buffer_load_dwordx4 v23, s[8:11], s37 offen sc1 lds
s_add_u32 m0, s39, 75776
s_add_u32 s37, s37, s38
buffer_load_dwordx4 v23, s[8:11], s37 offen sc1 lds
s_add_u32 m0, s39, 76800
s_add_u32 s37, s37, s38
buffer_load_dwordx4 v23, s[8:11], s37 offen sc1 lds
s_add_u32 m0, s39, 77824
s_add_u32 s37, s37, s55
buffer_load_dwordx4 v23, s[8:11], s37 offen sc1 lds
s_add_u32 m0, s39, 78848
s_add_u32 s37, s37, s38
buffer_load_dwordx4 v23, s[8:11], s37 offen sc1 lds
s_add_u32 m0, s39, 79872
s_add_u32 s37, s37, s38
buffer_load_dwordx4 v23, s[8:11], s37 offen sc1 lds
s_add_u32 m0, s39, 80896
s_add_u32 s37, s37, s38
buffer_load_dwordx4 v23, s[8:11], s37 offen sc1 lds
s_waitcnt vmcnt(32)
s_barrier
s_add_u32 m0, s39, 98304
s_add_u32 s37, s37, s40
buffer_load_dwordx4 v23, s[8:11], s37 offen sc1 lds
s_add_u32 m0, s39, 99328
s_add_u32 s37, s37, s38
buffer_load_dwordx4 v23, s[8:11], s37 offen sc1 lds
s_add_u32 m0, s39, 100352
s_add_u32 s37, s37, s38
buffer_load_dwordx4 v23, s[8:11], s37 offen sc1 lds
s_add_u32 m0, s39, 101376
s_add_u32 s37, s37, s38
buffer_load_dwordx4 v23, s[8:11], s37 offen sc1 lds
s_add_u32 m0, s39, 102400
s_add_u32 s37, s37, s55
buffer_load_dwordx4 v23, s[8:11], s37 offen sc1 lds
s_add_u32 m0, s39, 103424
s_add_u32 s37, s37, s38
buffer_load_dwordx4 v23, s[8:11], s37 offen sc1 lds
s_add_u32 m0, s39, 104448
s_add_u32 s37, s37, s38
buffer_load_dwordx4 v23, s[8:11], s37 offen sc1 lds
s_add_u32 m0, s39, 105472
s_add_u32 s37, s37, s38
buffer_load_dwordx4 v23, s[8:11], s37 offen sc1 lds
s_waitcnt vmcnt(32)
s_barrier
s_add_u32 m0, s39, 122880
s_add_u32 s37, s37, s40
buffer_load_dwordx4 v23, s[8:11], s37 offen sc1 lds
s_add_u32 m0, s39, 123904
s_add_u32 s37, s37, s38
buffer_load_dwordx4 v23, s[8:11], s37 offen sc1 lds
s_add_u32 m0, s39, 124928
s_add_u32 s37, s37, s38
buffer_load_dwordx4 v23, s[8:11], s37 offen sc1 lds
s_add_u32 m0, s39, 125952
s_add_u32 s37, s37, s38
buffer_load_dwordx4 v23, s[8:11], s37 offen sc1 lds
s_add_u32 m0, s39, 126976
s_add_u32 s37, s37, s55
buffer_load_dwordx4 v23, s[8:11], s37 offen sc1 lds
s_add_u32 m0, s39, 128000
s_add_u32 s37, s37, s38
buffer_load_dwordx4 v23, s[8:11], s37 offen sc1 lds
s_add_u32 m0, s39, 129024
s_add_u32 s37, s37, s38
buffer_load_dwordx4 v23, s[8:11], s37 offen sc1 lds
s_add_u32 m0, s39, 130048
s_add_u32 s37, s37, s38
buffer_load_dwordx4 v23, s[8:11], s37 offen sc1 lds
s_waitcnt vmcnt(32)
s_barrier
s_add_u32 m0, s39, 0
s_add_u32 s37, s37, s40
buffer_load_dwordx4 v23, s[8:11], s37 offen sc1 lds
s_add_u32 m0, s39, 1024
s_add_u32 s37, s37, s38
buffer_load_dwordx4 v23, s[8:11], s37 offen sc1 lds
s_add_u32 m0, s39, 2048
s_add_u32 s37, s37, s38
buffer_load_dwordx4 v23, s[8:11], s37 offen sc1 lds
s_add_u32 m0, s39, 3072
s_add_u32 s37, s37, s38
buffer_load_dwordx4 v23, s[8:11], s37 offen sc1 lds
s_add_u32 m0, s39, 4096
s_add_u32 s37, s37, s55
buffer_load_dwordx4 v23, s[8:11], s37 offen sc1 lds
s_add_u32 m0, s39, 5120
s_add_u32 s37, s37, s38
buffer_load_dwordx4 v23, s[8:11], s37 offen sc1 lds
s_add_u32 m0, s39, 6144
s_add_u32 s37, s37, s38
buffer_load_dwordx4 v23, s[8:11], s37 offen sc1 lds
s_add_u32 m0, s39, 7168
s_add_u32 s37, s37, s38
buffer_load_dwordx4 v23, s[8:11], s37 offen sc1 lds
s_waitcnt vmcnt(32)
s_barrier
s_add_u32 m0, s39, 24576
s_add_u32 s37, s37, s40
buffer_load_dwordx4 v23, s[8:11], s37 offen sc1 lds
s_add_u32 m0, s39, 25600
s_add_u32 s37, s37, s38
buffer_load_dwordx4 v23, s[8:11], s37 offen sc1 lds
s_add_u32 m0, s39, 26624
s_add_u32 s37, s37, s38
buffer_load_dwordx4 v23, s[8:11], s37 offen sc1 lds
s_add_u32 m0, s39, 27648
s_add_u32 s37, s37, s38
buffer_load_dwordx4 v23, s[8:11], s37 offen sc1 lds
s_add_u32 m0, s39, 28672
s_add_u32 s37, s37, s55
buffer_load_dwordx4 v23, s[8:11], s37 offen sc1 lds
s_add_u32 m0, s39, 29696
s_add_u32 s37, s37, s38
buffer_load_dwordx4 v23, s[8:11], s37 offen sc1 lds
s_add_u32 m0, s39, 30720
s_add_u32 s37, s37, s38
buffer_load_dwordx4 v23, s[8:11], s37 offen sc1 lds
s_add_u32 m0, s39, 31744
s_add_u32 s37, s37, s38
buffer_load_dwordx4 v23, s[8:11], s37 offen sc1 lds
s_waitcnt vmcnt(32)
s_barrier
s_add_u32 m0, s39, 49152
s_add_u32 s37, s37, s40
buffer_load_dwordx4 v23, s[8:11], s37 offen sc1 lds
s_add_u32 m0, s39, 50176
s_add_u32 s37, s37, s38
buffer_load_dwordx4 v23, s[8:11], s37 offen sc1 lds
s_add_u32 m0, s39, 51200
s_add_u32 s37, s37, s38
buffer_load_dwordx4 v23, s[8:11], s37 offen sc1 lds
s_add_u32 m0, s39, 52224
s_add_u32 s37, s37, s38
buffer_load_dwordx4 v23, s[8:11], s37 offen sc1 lds
s_add_u32 m0, s39, 53248
s_add_u32 s37, s37, s55
buffer_load_dwordx4 v23, s[8:11], s37 offen sc1 lds
s_add_u32 m0, s39, 54272
s_add_u32 s37, s37, s38
buffer_load_dwordx4 v23, s[8:11], s37 offen sc1 lds
s_add_u32 m0, s39, 55296
s_add_u32 s37, s37, s38
buffer_load_dwordx4 v23, s[8:11], s37 offen sc1 lds
s_add_u32 m0, s39, 56320
s_add_u32 s37, s37, s38
buffer_load_dwordx4 v23, s[8:11], s37 offen sc1 lds
s_waitcnt vmcnt(32)
s_barrier
s_add_u32 m0, s39, 73728
s_add_u32 s37, s37, s40
buffer_load_dwordx4 v23, s[8:11], s37 offen sc1 lds
s_add_u32 m0, s39, 74752
s_add_u32 s37, s37, s38
buffer_load_dwordx4 v23, s[8:11], s37 offen sc1 lds
s_add_u32 m0, s39, 75776
s_add_u32 s37, s37, s38
buffer_load_dwordx4 v23, s[8:11], s37 offen sc1 lds
s_add_u32 m0, s39, 76800
s_add_u32 s37, s37, s38
buffer_load_dwordx4 v23, s[8:11], s37 offen sc1 lds
s_add_u32 m0, s39, 77824
s_add_u32 s37, s37, s55
buffer_load_dwordx4 v23, s[8:11], s37 offen sc1 lds
s_add_u32 m0, s39, 78848
s_add_u32 s37, s37, s38
buffer_load_dwordx4 v23, s[8:11], s37 offen sc1 lds
s_add_u32 m0, s39, 79872
s_add_u32 s37, s37, s38
buffer_load_dwordx4 v23, s[8:11], s37 offen sc1 lds
s_add_u32 m0, s39, 80896
s_add_u32 s37, s37, s38
buffer_load_dwordx4 v23, s[8:11], s37 offen sc1 lds
s_waitcnt vmcnt(32)
s_barrier
s_lshl_b32 s43, s35, 8
s_cmp_eq_u32 s51, 1
s_cselect_b32 s8, s4, s6
s_cselect_b32 s9, s5, s7
s_sub_u32 s10, 7340032, s43
s_lshl_b32 s44, s34, 18
s_add_u32 s44, s44, 4194304
s_movk_i32 s38, 28672
s_cmp_eq_u32 s51, 0
s_cselect_b32 s8, s32, s8
s_cselect_b32 s9, s33, s9
s_cselect_b32 s10, 262144, s10
s_cselect_b32 s43, s44, s43
s_cselect_b32 s38, 1024, s38
s_cselect_b32 s45, 0, -1
s_add_u32 s8, s8, s43
s_addc_u32 s9, s9, 0
s_mov_b32 s11, 0x20000
s_sub_u32 s37, 0, s38
s_lshl_b32 s39, s51, 14
v_lshrrev_b32 v19, 4, v1
v_lshlrev_b32 v20, 5, v19
v_mul_u32_u24 v19, 6912, v19
v_and_b32 v19, s45, v19
v_and_b32 v20, s45, v20
v_lshlrev_b32 v21, 4, v1
v_xor_b32 v21, v21, v20
v_add_u32 v22, v21, v19
s_and_b32 s45, s45, 128
v_xor_b32 v23, s45, v22
s_waitcnt vmcnt(24)
s_barrier
s_add_u32 m0, s39, 98304
s_add_u32 s37, s37, s38
buffer_load_dwordx4 v22, s[8:11], s37 offen sc1 lds
s_add_u32 m0, s39, 99328
s_add_u32 s37, s37, s38
buffer_load_dwordx4 v23, s[8:11], s37 offen sc1 lds
s_add_u32 m0, s39, 100352
s_add_u32 s37, s37, s38
buffer_load_dwordx4 v22, s[8:11], s37 offen sc1 lds
s_add_u32 m0, s39, 101376
s_add_u32 s37, s37, s38
buffer_load_dwordx4 v23, s[8:11], s37 offen sc1 lds
s_add_u32 m0, s39, 102400
s_add_u32 s37, s37, s38
buffer_load_dwordx4 v22, s[8:11], s37 offen sc1 lds
s_add_u32 m0, s39, 103424
s_add_u32 s37, s37, s38
buffer_load_dwordx4 v23, s[8:11], s37 offen sc1 lds
s_add_u32 m0, s39, 104448
s_add_u32 s37, s37, s38
buffer_load_dwordx4 v22, s[8:11], s37 offen sc1 lds
s_add_u32 m0, s39, 105472
s_add_u32 s37, s37, s38
buffer_load_dwordx4 v23, s[8:11], s37 offen sc1 lds
s_add_u32 m0, s39, 106496
s_add_u32 s37, s37, s38
buffer_load_dwordx4 v22, s[8:11], s37 offen sc1 lds
s_add_u32 m0, s39, 107520
s_add_u32 s37, s37, s38
buffer_load_dwordx4 v23, s[8:11], s37 offen sc1 lds
s_add_u32 m0, s39, 108544
s_add_u32 s37, s37, s38
buffer_load_dwordx4 v22, s[8:11], s37 offen sc1 lds
s_add_u32 m0, s39, 109568
s_add_u32 s37, s37, s38
buffer_load_dwordx4 v23, s[8:11], s37 offen sc1 lds
s_add_u32 m0, s39, 110592
s_add_u32 s37, s37, s38
buffer_load_dwordx4 v22, s[8:11], s37 offen sc1 lds
s_add_u32 m0, s39, 111616
s_add_u32 s37, s37, s38
buffer_load_dwordx4 v23, s[8:11], s37 offen sc1 lds
s_add_u32 m0, s39, 112640
s_add_u32 s37, s37, s38
buffer_load_dwordx4 v22, s[8:11], s37 offen sc1 lds
s_add_u32 m0, s39, 113664
s_add_u32 s37, s37, s38
buffer_load_dwordx4 v23, s[8:11], s37 offen sc1 lds
s_waitcnt vmcnt(32)
s_barrier
s_waitcnt vmcnt(24)
s_barrier
s_add_u32 m0, s39, 0
s_add_u32 s37, s37, s38
buffer_load_dwordx4 v22, s[8:11], s37 offen sc1 lds
s_add_u32 m0, s39, 1024
s_add_u32 s37, s37, s38
buffer_load_dwordx4 v23, s[8:11], s37 offen sc1 lds
s_add_u32 m0, s39, 2048
s_add_u32 s37, s37, s38
buffer_load_dwordx4 v22, s[8:11], s37 offen sc1 lds
s_add_u32 m0, s39, 3072
s_add_u32 s37, s37, s38
buffer_load_dwordx4 v23, s[8:11], s37 offen sc1 lds
s_add_u32 m0, s39, 4096
s_add_u32 s37, s37, s38
buffer_load_dwordx4 v22, s[8:11], s37 offen sc1 lds
s_add_u32 m0, s39, 5120
s_add_u32 s37, s37, s38
buffer_load_dwordx4 v23, s[8:11], s37 offen sc1 lds
s_add_u32 m0, s39, 6144
s_add_u32 s37, s37, s38
buffer_load_dwordx4 v22, s[8:11], s37 offen sc1 lds
s_add_u32 m0, s39, 7168
s_add_u32 s37, s37, s38
buffer_load_dwordx4 v23, s[8:11], s37 offen sc1 lds
s_add_u32 m0, s39, 8192
s_add_u32 s37, s37, s38
buffer_load_dwordx4 v22, s[8:11], s37 offen sc1 lds
s_add_u32 m0, s39, 9216
s_add_u32 s37, s37, s38
buffer_load_dwordx4 v23, s[8:11], s37 offen sc1 lds
s_add_u32 m0, s39, 10240
s_add_u32 s37, s37, s38
buffer_load_dwordx4 v22, s[8:11], s37 offen sc1 lds
s_add_u32 m0, s39, 11264
s_add_u32 s37, s37, s38
buffer_load_dwordx4 v23, s[8:11], s37 offen sc1 lds
s_add_u32 m0, s39, 12288
s_add_u32 s37, s37, s38
buffer_load_dwordx4 v22, s[8:11], s37 offen sc1 lds
s_add_u32 m0, s39, 13312
s_add_u32 s37, s37, s38
buffer_load_dwordx4 v23, s[8:11], s37 offen sc1 lds
s_add_u32 m0, s39, 14336
s_add_u32 s37, s37, s38
buffer_load_dwordx4 v22, s[8:11], s37 offen sc1 lds
s_add_u32 m0, s39, 15360
s_add_u32 s37, s37, s38
buffer_load_dwordx4 v23, s[8:11], s37 offen sc1 lds
s_waitcnt vmcnt(32)
s_barrier
s_barrier
s_barrier
s_add_u32 m0, s39, 49152
s_add_u32 s37, s37, s38
buffer_load_dwordx4 v22, s[8:11], s37 offen sc1 lds
s_add_u32 m0, s39, 50176
s_add_u32 s37, s37, s38
buffer_load_dwordx4 v23, s[8:11], s37 offen sc1 lds
s_add_u32 m0, s39, 51200
s_add_u32 s37, s37, s38
buffer_load_dwordx4 v22, s[8:11], s37 offen sc1 lds
s_add_u32 m0, s39, 52224
s_add_u32 s37, s37, s38
buffer_load_dwordx4 v23, s[8:11], s37 offen sc1 lds
s_add_u32 m0, s39, 53248
s_add_u32 s37, s37, s38
buffer_load_dwordx4 v22, s[8:11], s37 offen sc1 lds
s_add_u32 m0, s39, 54272
s_add_u32 s37, s37, s38
buffer_load_dwordx4 v23, s[8:11], s37 offen sc1 lds
s_add_u32 m0, s39, 55296
s_add_u32 s37, s37, s38
buffer_load_dwordx4 v22, s[8:11], s37 offen sc1 lds
s_add_u32 m0, s39, 56320
s_add_u32 s37, s37, s38
buffer_load_dwordx4 v23, s[8:11], s37 offen sc1 lds
s_add_u32 m0, s39, 57344
s_add_u32 s37, s37, s38
buffer_load_dwordx4 v22, s[8:11], s37 offen sc1 lds
s_add_u32 m0, s39, 58368
s_add_u32 s37, s37, s38
buffer_load_dwordx4 v23, s[8:11], s37 offen sc1 lds
s_add_u32 m0, s39, 59392
s_add_u32 s37, s37, s38
buffer_load_dwordx4 v22, s[8:11], s37 offen sc1 lds
s_add_u32 m0, s39, 60416
s_add_u32 s37, s37, s38
buffer_load_dwordx4 v23, s[8:11], s37 offen sc1 lds
s_add_u32 m0, s39, 61440
s_add_u32 s37, s37, s38
buffer_load_dwordx4 v22, s[8:11], s37 offen sc1 lds
s_add_u32 m0, s39, 62464
s_add_u32 s37, s37, s38
buffer_load_dwordx4 v23, s[8:11], s37 offen sc1 lds
s_add_u32 m0, s39, 63488
s_add_u32 s37, s37, s38
buffer_load_dwordx4 v22, s[8:11], s37 offen sc1 lds
s_add_u32 m0, s39, 64512
s_add_u32 s37, s37, s38
buffer_load_dwordx4 v23, s[8:11], s37 offen sc1 lds
s_branch LP3_27
Lp_30:
s_add_u32 m0, s39, 0
s_add_u32 s37, s37, s40
buffer_load_dwordx4 v23, s[8:11], s37 offen sc1 lds
s_add_u32 m0, s39, 1024
s_add_u32 s37, s37, s38
buffer_load_dwordx4 v23, s[8:11], s37 offen sc1 lds
s_add_u32 m0, s39, 2048
s_add_u32 s37, s37, s38
buffer_load_dwordx4 v23, s[8:11], s37 offen sc1 lds
s_add_u32 m0, s39, 3072
s_add_u32 s37, s37, s38
buffer_load_dwordx4 v23, s[8:11], s37 offen sc1 lds
s_add_u32 m0, s39, 4096
s_add_u32 s37, s37, s55
buffer_load_dwordx4 v23, s[8:11], s37 offen sc1 lds
s_add_u32 m0, s39, 5120
s_add_u32 s37, s37, s38
buffer_load_dwordx4 v23, s[8:11], s37 offen sc1 lds
s_add_u32 m0, s39, 6144
s_add_u32 s37, s37, s38
buffer_load_dwordx4 v23, s[8:11], s37 offen sc1 lds
s_add_u32 m0, s39, 7168
s_add_u32 s37, s37, s38
buffer_load_dwordx4 v23, s[8:11], s37 offen sc1 lds
s_add_u32 m0, s39, 24576
s_add_u32 s37, s37, s40
buffer_load_dwordx4 v23, s[8:11], s37 offen sc1 lds
s_add_u32 m0, s39, 25600
s_add_u32 s37, s37, s38
buffer_load_dwordx4 v23, s[8:11], s37 offen sc1 lds
s_add_u32 m0, s39, 26624
s_add_u32 s37, s37, s38
buffer_load_dwordx4 v23, s[8:11], s37 offen sc1 lds
s_add_u32 m0, s39, 27648
s_add_u32 s37, s37, s38
buffer_load_dwordx4 v23, s[8:11], s37 offen sc1 lds
s_add_u32 m0, s39, 28672
s_add_u32 s37, s37, s55
buffer_load_dwordx4 v23, s[8:11], s37 offen sc1 lds
s_add_u32 m0, s39, 29696
s_add_u32 s37, s37, s38
buffer_load_dwordx4 v23, s[8:11], s37 offen sc1 lds
s_add_u32 m0, s39, 30720
s_add_u32 s37, s37, s38
buffer_load_dwordx4 v23, s[8:11], s37 offen sc1 lds
s_add_u32 m0, s39, 31744
s_add_u32 s37, s37, s38
buffer_load_dwordx4 v23, s[8:11], s37 offen sc1 lds
s_add_u32 m0, s39, 49152
s_add_u32 s37, s37, s40
buffer_load_dwordx4 v23, s[8:11], s37 offen sc1 lds
s_add_u32 m0, s39, 50176
s_add_u32 s37, s37, s38
buffer_load_dwordx4 v23, s[8:11], s37 offen sc1 lds
s_add_u32 m0, s39, 51200
s_add_u32 s37, s37, s38
buffer_load_dwordx4 v23, s[8:11], s37 offen sc1 lds
s_add_u32 m0, s39, 52224
s_add_u32 s37, s37, s38
buffer_load_dwordx4 v23, s[8:11], s37 offen sc1 lds
s_add_u32 m0, s39, 53248
s_add_u32 s37, s37, s55
buffer_load_dwordx4 v23, s[8:11], s37 offen sc1 lds
s_add_u32 m0, s39, 54272
s_add_u32 s37, s37, s38
buffer_load_dwordx4 v23, s[8:11], s37 offen sc1 lds
s_add_u32 m0, s39, 55296
s_add_u32 s37, s37, s38
buffer_load_dwordx4 v23, s[8:11], s37 offen sc1 lds
s_add_u32 m0, s39, 56320
s_add_u32 s37, s37, s38
buffer_load_dwordx4 v23, s[8:11], s37 offen sc1 lds
s_add_u32 m0, s39, 73728
s_add_u32 s37, s37, s40
buffer_load_dwordx4 v23, s[8:11], s37 offen sc1 lds
s_add_u32 m0, s39, 74752
s_add_u32 s37, s37, s38
buffer_load_dwordx4 v23, s[8:11], s37 offen sc1 lds
s_add_u32 m0, s39, 75776
s_add_u32 s37, s37, s38
buffer_load_dwordx4 v23, s[8:11], s37 offen sc1 lds
s_add_u32 m0, s39, 76800
s_add_u32 s37, s37, s38
buffer_load_dwordx4 v23, s[8:11], s37 offen sc1 lds
s_add_u32 m0, s39, 77824
s_add_u32 s37, s37, s55
buffer_load_dwordx4 v23, s[8:11], s37 offen sc1 lds
s_add_u32 m0, s39, 78848
s_add_u32 s37, s37, s38
buffer_load_dwordx4 v23, s[8:11], s37 offen sc1 lds
s_add_u32 m0, s39, 79872
s_add_u32 s37, s37, s38
buffer_load_dwordx4 v23, s[8:11], s37 offen sc1 lds
s_add_u32 m0, s39, 80896
s_add_u32 s37, s37, s38
buffer_load_dwordx4 v23, s[8:11], s37 offen sc1 lds
s_add_u32 m0, s39, 98304
s_add_u32 s37, s37, s40
buffer_load_dwordx4 v23, s[8:11], s37 offen sc1 lds
s_add_u32 m0, s39, 99328
s_add_u32 s37, s37, s38
buffer_load_dwordx4 v23, s[8:11], s37 offen sc1 lds
s_add_u32 m0, s39, 100352
s_add_u32 s37, s37, s38
buffer_load_dwordx4 v23, s[8:11], s37 offen sc1 lds
s_add_u32 m0, s39, 101376
s_add_u32 s37, s37, s38
buffer_load_dwordx4 v23, s[8:11], s37 offen sc1 lds
s_add_u32 m0, s39, 102400
s_add_u32 s37, s37, s55
buffer_load_dwordx4 v23, s[8:11], s37 offen sc1 lds
s_add_u32 m0, s39, 103424
s_add_u32 s37, s37, s38
buffer_load_dwordx4 v23, s[8:11], s37 offen sc1 lds
s_add_u32 m0, s39, 104448
s_add_u32 s37, s37, s38
buffer_load_dwordx4 v23, s[8:11], s37 offen sc1 lds
s_add_u32 m0, s39, 105472
s_add_u32 s37, s37, s38
buffer_load_dwordx4 v23, s[8:11], s37 offen sc1 lds
s_add_u32 m0, s39, 122880
s_add_u32 s37, s37, s40
buffer_load_dwordx4 v23, s[8:11], s37 offen sc1 lds
s_add_u32 m0, s39, 123904
s_add_u32 s37, s37, s38
buffer_load_dwordx4 v23, s[8:11], s37 offen sc1 lds
s_add_u32 m0, s39, 124928
s_add_u32 s37, s37, s38
buffer_load_dwordx4 v23, s[8:11], s37 offen sc1 lds
s_add_u32 m0, s39, 125952
s_add_u32 s37, s37, s38
buffer_load_dwordx4 v23, s[8:11], s37 offen sc1 lds
s_add_u32 m0, s39, 126976
s_add_u32 s37, s37, s55
buffer_load_dwordx4 v23, s[8:11], s37 offen sc1 lds
s_add_u32 m0, s39, 128000
s_add_u32 s37, s37, s38
buffer_load_dwordx4 v23, s[8:11], s37 offen sc1 lds
s_add_u32 m0, s39, 129024
s_add_u32 s37, s37, s38
buffer_load_dwordx4 v23, s[8:11], s37 offen sc1 lds
s_add_u32 m0, s39, 130048
s_add_u32 s37, s37, s38
buffer_load_dwordx4 v23, s[8:11], s37 offen sc1 lds
s_barrier
s_add_u32 m0, s54, 0
s_add_u32 s43, s54, 0
buffer_load_dwordx4 v21, s[12:15], s43 offen sc1 lds
s_add_u32 m0, s54, 1024
s_add_u32 s43, s54, 1024
buffer_load_dwordx4 v21, s[12:15], s43 offen sc1 lds
s_add_u32 m0, s54, 24576
s_add_u32 s43, s54, 16384
buffer_load_dwordx4 v21, s[12:15], s43 offen sc1 lds
s_add_u32 m0, s54, 25600
s_add_u32 s43, s54, 17408
buffer_load_dwordx4 v21, s[12:15], s43 offen sc1 lds
s_waitcnt vmcnt(2)
s_barrier
s_waitcnt vmcnt(0)
s_barrier
s_add_u32 m0, s39, 0
s_add_u32 s37, s37, s40
buffer_load_dwordx4 v23, s[8:11], s37 offen sc1 lds
s_add_u32 m0, s39, 1024
s_add_u32 s37, s37, s38
buffer_load_dwordx4 v23, s[8:11], s37 offen sc1 lds
s_add_u32 m0, s39, 2048
s_add_u32 s37, s37, s38
buffer_load_dwordx4 v23, s[8:11], s37 offen sc1 lds
s_add_u32 m0, s39, 3072
s_add_u32 s37, s37, s38
buffer_load_dwordx4 v23, s[8:11], s37 offen sc1 lds
s_add_u32 m0, s39, 4096
s_add_u32 s37, s37, s55
buffer_load_dwordx4 v23, s[8:11], s37 offen sc1 lds
s_add_u32 m0, s39, 5120
s_add_u32 s37, s37, s38
buffer_load_dwordx4 v23, s[8:11], s37 offen sc1 lds
s_add_u32 m0, s39, 6144
s_add_u32 s37, s37, s38
buffer_load_dwordx4 v23, s[8:11], s37 offen sc1 lds
s_add_u32 m0, s39, 7168
s_add_u32 s37, s37, s38
buffer_load_dwordx4 v23, s[8:11], s37 offen sc1 lds
s_waitcnt vmcnt(36)
s_barrier
s_add_u32 m0, s39, 24576
s_add_u32 s37, s37, s40
buffer_load_dwordx4 v23, s[8:11], s37 offen sc1 lds
s_add_u32 m0, s39, 25600
s_add_u32 s37, s37, s38
buffer_load_dwordx4 v23, s[8:11], s37 offen sc1 lds
s_add_u32 m0, s39, 26624
s_add_u32 s37, s37, s38
buffer_load_dwordx4 v23, s[8:11], s37 offen sc1 lds
s_add_u32 m0, s39, 27648
s_add_u32 s37, s37, s38
buffer_load_dwordx4 v23, s[8:11], s37 offen sc1 lds
s_add_u32 m0, s39, 28672
s_add_u32 s37, s37, s55
buffer_load_dwordx4 v23, s[8:11], s37 offen sc1 lds
s_add_u32 m0, s39, 29696
s_add_u32 s37, s37, s38
buffer_load_dwordx4 v23, s[8:11], s37 offen sc1 lds
s_add_u32 m0, s39, 30720
s_add_u32 s37, s37, s38
buffer_load_dwordx4 v23, s[8:11], s37 offen sc1 lds
s_add_u32 m0, s39, 31744
s_add_u32 s37, s37, s38
buffer_load_dwordx4 v23, s[8:11], s37 offen sc1 lds
s_waitcnt vmcnt(36)
s_barrier
s_add_u32 m0, s39, 49152
s_add_u32 s37, s37, s40
buffer_load_dwordx4 v23, s[8:11], s37 offen sc1 lds
s_add_u32 m0, s39, 50176
s_add_u32 s37, s37, s38
buffer_load_dwordx4 v23, s[8:11], s37 offen sc1 lds
s_add_u32 m0, s39, 51200
s_add_u32 s37, s37, s38
buffer_load_dwordx4 v23, s[8:11], s37 offen sc1 lds
s_add_u32 m0, s39, 52224
s_add_u32 s37, s37, s38
buffer_load_dwordx4 v23, s[8:11], s37 offen sc1 lds
s_add_u32 m0, s39, 53248
s_add_u32 s37, s37, s55
buffer_load_dwordx4 v23, s[8:11], s37 offen sc1 lds
s_add_u32 m0, s39, 54272
s_add_u32 s37, s37, s38
buffer_load_dwordx4 v23, s[8:11], s37 offen sc1 lds
s_add_u32 m0, s39, 55296
s_add_u32 s37, s37, s38
buffer_load_dwordx4 v23, s[8:11], s37 offen sc1 lds
s_add_u32 m0, s39, 56320
s_add_u32 s37, s37, s38
buffer_load_dwordx4 v23, s[8:11], s37 offen sc1 lds
s_waitcnt vmcnt(36)
s_barrier
s_add_u32 m0, s39, 73728
s_add_u32 s37, s37, s40
buffer_load_dwordx4 v23, s[8:11], s37 offen sc1 lds
s_add_u32 m0, s39, 74752
s_add_u32 s37, s37, s38
buffer_load_dwordx4 v23, s[8:11], s37 offen sc1 lds
s_add_u32 m0, s39, 75776
s_add_u32 s37, s37, s38
buffer_load_dwordx4 v23, s[8:11], s37 offen sc1 lds
s_add_u32 m0, s39, 76800
s_add_u32 s37, s37, s38
buffer_load_dwordx4 v23, s[8:11], s37 offen sc1 lds
s_add_u32 m0, s39, 77824
s_add_u32 s37, s37, s55
buffer_load_dwordx4 v23, s[8:11], s37 offen sc1 lds
s_add_u32 m0, s39, 78848
s_add_u32 s37, s37, s38
buffer_load_dwordx4 v23, s[8:11], s37 offen sc1 lds
s_add_u32 m0, s39, 79872
s_add_u32 s37, s37, s38
buffer_load_dwordx4 v23, s[8:11], s37 offen sc1 lds
s_add_u32 m0, s39, 80896
s_add_u32 s37, s37, s38
buffer_load_dwordx4 v23, s[8:11], s37 offen sc1 lds
s_waitcnt vmcnt(36)
s_barrier
s_add_u32 m0, s39, 98304
s_add_u32 s37, s37, s40
buffer_load_dwordx4 v23, s[8:11], s37 offen sc1 lds
s_add_u32 m0, s39, 99328
s_add_u32 s37, s37, s38
buffer_load_dwordx4 v23, s[8:11], s37 offen sc1 lds
s_add_u32 m0, s39, 100352
s_add_u32 s37, s37, s38
buffer_load_dwordx4 v23, s[8:11], s37 offen sc1 lds
s_add_u32 m0, s39, 101376
s_add_u32 s37, s37, s38
buffer_load_dwordx4 v23, s[8:11], s37 offen sc1 lds
s_add_u32 m0, s39, 102400
s_add_u32 s37, s37, s55
buffer_load_dwordx4 v23, s[8:11], s37 offen sc1 lds
s_add_u32 m0, s39, 103424
s_add_u32 s37, s37, s38
buffer_load_dwordx4 v23, s[8:11], s37 offen sc1 lds
s_add_u32 m0, s39, 104448
s_add_u32 s37, s37, s38
buffer_load_dwordx4 v23, s[8:11], s37 offen sc1 lds
s_add_u32 m0, s39, 105472
s_add_u32 s37, s37, s38
buffer_load_dwordx4 v23, s[8:11], s37 offen sc1 lds
s_waitcnt vmcnt(32)
s_barrier
s_add_u32 m0, s39, 122880
s_add_u32 s37, s37, s40
buffer_load_dwordx4 v23, s[8:11], s37 offen sc1 lds
s_add_u32 m0, s39, 123904
s_add_u32 s37, s37, s38
buffer_load_dwordx4 v23, s[8:11], s37 offen sc1 lds
s_add_u32 m0, s39, 124928
s_add_u32 s37, s37, s38
buffer_load_dwordx4 v23, s[8:11], s37 offen sc1 lds
s_add_u32 m0, s39, 125952
s_add_u32 s37, s37, s38
buffer_load_dwordx4 v23, s[8:11], s37 offen sc1 lds
s_add_u32 m0, s39, 126976
s_add_u32 s37, s37, s55
buffer_load_dwordx4 v23, s[8:11], s37 offen sc1 lds
s_add_u32 m0, s39, 128000
s_add_u32 s37, s37, s38
buffer_load_dwordx4 v23, s[8:11], s37 offen sc1 lds
s_add_u32 m0, s39, 129024
s_add_u32 s37, s37, s38
buffer_load_dwordx4 v23, s[8:11], s37 offen sc1 lds
s_add_u32 m0, s39, 130048
s_add_u32 s37, s37, s38
buffer_load_dwordx4 v23, s[8:11], s37 offen sc1 lds
s_waitcnt vmcnt(32)
s_barrier
s_add_u32 m0, s39, 0
s_add_u32 s37, s37, s40
buffer_load_dwordx4 v23, s[8:11], s37 offen sc1 lds
s_add_u32 m0, s39, 1024
s_add_u32 s37, s37, s38
buffer_load_dwordx4 v23, s[8:11], s37 offen sc1 lds
s_add_u32 m0, s39, 2048
s_add_u32 s37, s37, s38
buffer_load_dwordx4 v23, s[8:11], s37 offen sc1 lds
s_add_u32 m0, s39, 3072
s_add_u32 s37, s37, s38
buffer_load_dwordx4 v23, s[8:11], s37 offen sc1 lds
s_add_u32 m0, s39, 4096
s_add_u32 s37, s37, s55
buffer_load_dwordx4 v23, s[8:11], s37 offen sc1 lds
s_add_u32 m0, s39, 5120
s_add_u32 s37, s37, s38
buffer_load_dwordx4 v23, s[8:11], s37 offen sc1 lds
s_add_u32 m0, s39, 6144
s_add_u32 s37, s37, s38
buffer_load_dwordx4 v23, s[8:11], s37 offen sc1 lds
s_add_u32 m0, s39, 7168
s_add_u32 s37, s37, s38
buffer_load_dwordx4 v23, s[8:11], s37 offen sc1 lds
s_waitcnt vmcnt(32)
s_barrier
s_add_u32 m0, s39, 24576
s_add_u32 s37, s37, s40
buffer_load_dwordx4 v23, s[8:11], s37 offen sc1 lds
s_add_u32 m0, s39, 25600
s_add_u32 s37, s37, s38
buffer_load_dwordx4 v23, s[8:11], s37 offen sc1 lds
s_add_u32 m0, s39, 26624
s_add_u32 s37, s37, s38
buffer_load_dwordx4 v23, s[8:11], s37 offen sc1 lds
s_add_u32 m0, s39, 27648
s_add_u32 s37, s37, s38
buffer_load_dwordx4 v23, s[8:11], s37 offen sc1 lds
s_add_u32 m0, s39, 28672
s_add_u32 s37, s37, s55
buffer_load_dwordx4 v23, s[8:11], s37 offen sc1 lds
s_add_u32 m0, s39, 29696
s_add_u32 s37, s37, s38
buffer_load_dwordx4 v23, s[8:11], s37 offen sc1 lds
s_add_u32 m0, s39, 30720
s_add_u32 s37, s37, s38
buffer_load_dwordx4 v23, s[8:11], s37 offen sc1 lds
s_add_u32 m0, s39, 31744
s_add_u32 s37, s37, s38
buffer_load_dwordx4 v23, s[8:11], s37 offen sc1 lds
s_waitcnt vmcnt(32)
s_barrier
s_add_u32 m0, s39, 49152
s_add_u32 s37, s37, s40
buffer_load_dwordx4 v23, s[8:11], s37 offen sc1 lds
s_add_u32 m0, s39, 50176
s_add_u32 s37, s37, s38
buffer_load_dwordx4 v23, s[8:11], s37 offen sc1 lds
s_add_u32 m0, s39, 51200
s_add_u32 s37, s37, s38
buffer_load_dwordx4 v23, s[8:11], s37 offen sc1 lds
s_add_u32 m0, s39, 52224
s_add_u32 s37, s37, s38
buffer_load_dwordx4 v23, s[8:11], s37 offen sc1 lds
s_add_u32 m0, s39, 53248
s_add_u32 s37, s37, s55
buffer_load_dwordx4 v23, s[8:11], s37 offen sc1 lds
s_add_u32 m0, s39, 54272
s_add_u32 s37, s37, s38
buffer_load_dwordx4 v23, s[8:11], s37 offen sc1 lds
s_add_u32 m0, s39, 55296
s_add_u32 s37, s37, s38
buffer_load_dwordx4 v23, s[8:11], s37 offen sc1 lds
s_add_u32 m0, s39, 56320
s_add_u32 s37, s37, s38
buffer_load_dwordx4 v23, s[8:11], s37 offen sc1 lds
s_waitcnt vmcnt(32)
s_barrier
s_add_u32 m0, s39, 73728
s_add_u32 s37, s37, s40
buffer_load_dwordx4 v23, s[8:11], s37 offen sc1 lds
s_add_u32 m0, s39, 74752
s_add_u32 s37, s37, s38
buffer_load_dwordx4 v23, s[8:11], s37 offen sc1 lds
s_add_u32 m0, s39, 75776
s_add_u32 s37, s37, s38
buffer_load_dwordx4 v23, s[8:11], s37 offen sc1 lds
s_add_u32 m0, s39, 76800
s_add_u32 s37, s37, s38
buffer_load_dwordx4 v23, s[8:11], s37 offen sc1 lds
s_add_u32 m0, s39, 77824
s_add_u32 s37, s37, s55
buffer_load_dwordx4 v23, s[8:11], s37 offen sc1 lds
s_add_u32 m0, s39, 78848
s_add_u32 s37, s37, s38
buffer_load_dwordx4 v23, s[8:11], s37 offen sc1 lds
s_add_u32 m0, s39, 79872
s_add_u32 s37, s37, s38
buffer_load_dwordx4 v23, s[8:11], s37 offen sc1 lds
s_add_u32 m0, s39, 80896
s_add_u32 s37, s37, s38
buffer_load_dwordx4 v23, s[8:11], s37 offen sc1 lds
s_waitcnt vmcnt(32)
s_barrier
s_lshl_b32 s43, s35, 8
s_cmp_eq_u32 s51, 1
s_cselect_b32 s8, s4, s6
s_cselect_b32 s9, s5, s7
s_sub_u32 s10, 7340032, s43
s_lshl_b32 s44, s34, 18
s_add_u32 s44, s44, 4194304
s_movk_i32 s38, 28672
s_cmp_eq_u32 s51, 0
s_cselect_b32 s8, s32, s8
s_cselect_b32 s9, s33, s9
s_cselect_b32 s10, 262144, s10
s_cselect_b32 s43, s44, s43
s_cselect_b32 s38, 1024, s38
s_cselect_b32 s45, 0, -1
s_add_u32 s8, s8, s43
s_addc_u32 s9, s9, 0
s_mov_b32 s11, 0x20000
s_sub_u32 s37, 0, s38
s_lshl_b32 s39, s51, 14
v_lshrrev_b32 v19, 4, v1
v_lshlrev_b32 v20, 5, v19
v_mul_u32_u24 v19, 6912, v19
v_and_b32 v19, s45, v19
v_and_b32 v20, s45, v20
v_lshlrev_b32 v21, 4, v1
v_xor_b32 v21, v21, v20
v_add_u32 v22, v21, v19
s_and_b32 s45, s45, 128
v_xor_b32 v23, s45, v22
s_waitcnt vmcnt(24)
s_barrier
s_add_u32 m0, s39, 98304
s_add_u32 s37, s37, s38
buffer_load_dwordx4 v22, s[8:11], s37 offen sc1 lds
s_add_u32 m0, s39, 99328
s_add_u32 s37, s37, s38
buffer_load_dwordx4 v23, s[8:11], s37 offen sc1 lds
s_add_u32 m0, s39, 100352
s_add_u32 s37, s37, s38
buffer_load_dwordx4 v22, s[8:11], s37 offen sc1 lds
s_add_u32 m0, s39, 101376
s_add_u32 s37, s37, s38
buffer_load_dwordx4 v23, s[8:11], s37 offen sc1 lds
s_add_u32 m0, s39, 102400
s_add_u32 s37, s37, s38
buffer_load_dwordx4 v22, s[8:11], s37 offen sc1 lds
s_add_u32 m0, s39, 103424
s_add_u32 s37, s37, s38
buffer_load_dwordx4 v23, s[8:11], s37 offen sc1 lds
s_add_u32 m0, s39, 104448
s_add_u32 s37, s37, s38
buffer_load_dwordx4 v22, s[8:11], s37 offen sc1 lds
s_add_u32 m0, s39, 105472
s_add_u32 s37, s37, s38
buffer_load_dwordx4 v23, s[8:11], s37 offen sc1 lds
s_add_u32 m0, s39, 106496
s_add_u32 s37, s37, s38
buffer_load_dwordx4 v22, s[8:11], s37 offen sc1 lds
s_add_u32 m0, s39, 107520
s_add_u32 s37, s37, s38
buffer_load_dwordx4 v23, s[8:11], s37 offen sc1 lds
s_add_u32 m0, s39, 108544
s_add_u32 s37, s37, s38
buffer_load_dwordx4 v22, s[8:11], s37 offen sc1 lds
s_add_u32 m0, s39, 109568
s_add_u32 s37, s37, s38
buffer_load_dwordx4 v23, s[8:11], s37 offen sc1 lds
s_add_u32 m0, s39, 110592
s_add_u32 s37, s37, s38
buffer_load_dwordx4 v22, s[8:11], s37 offen sc1 lds
s_add_u32 m0, s39, 111616
s_add_u32 s37, s37, s38
buffer_load_dwordx4 v23, s[8:11], s37 offen sc1 lds
s_add_u32 m0, s39, 112640
s_add_u32 s37, s37, s38
buffer_load_dwordx4 v22, s[8:11], s37 offen sc1 lds
s_add_u32 m0, s39, 113664
s_add_u32 s37, s37, s38
buffer_load_dwordx4 v23, s[8:11], s37 offen sc1 lds
s_waitcnt vmcnt(32)
s_barrier
s_waitcnt vmcnt(24)
s_barrier
s_add_u32 m0, s39, 0
s_add_u32 s37, s37, s38
buffer_load_dwordx4 v22, s[8:11], s37 offen sc1 lds
s_add_u32 m0, s39, 1024
s_add_u32 s37, s37, s38
buffer_load_dwordx4 v23, s[8:11], s37 offen sc1 lds
s_add_u32 m0, s39, 2048
s_add_u32 s37, s37, s38
buffer_load_dwordx4 v22, s[8:11], s37 offen sc1 lds
s_add_u32 m0, s39, 3072
s_add_u32 s37, s37, s38
buffer_load_dwordx4 v23, s[8:11], s37 offen sc1 lds
s_add_u32 m0, s39, 4096
s_add_u32 s37, s37, s38
buffer_load_dwordx4 v22, s[8:11], s37 offen sc1 lds
s_add_u32 m0, s39, 5120
s_add_u32 s37, s37, s38
buffer_load_dwordx4 v23, s[8:11], s37 offen sc1 lds
s_add_u32 m0, s39, 6144
s_add_u32 s37, s37, s38
buffer_load_dwordx4 v22, s[8:11], s37 offen sc1 lds
s_add_u32 m0, s39, 7168
s_add_u32 s37, s37, s38
buffer_load_dwordx4 v23, s[8:11], s37 offen sc1 lds
s_add_u32 m0, s39, 8192
s_add_u32 s37, s37, s38
buffer_load_dwordx4 v22, s[8:11], s37 offen sc1 lds
s_add_u32 m0, s39, 9216
s_add_u32 s37, s37, s38
buffer_load_dwordx4 v23, s[8:11], s37 offen sc1 lds
s_add_u32 m0, s39, 10240
s_add_u32 s37, s37, s38
buffer_load_dwordx4 v22, s[8:11], s37 offen sc1 lds
s_add_u32 m0, s39, 11264
s_add_u32 s37, s37, s38
buffer_load_dwordx4 v23, s[8:11], s37 offen sc1 lds
s_add_u32 m0, s39, 12288
s_add_u32 s37, s37, s38
buffer_load_dwordx4 v22, s[8:11], s37 offen sc1 lds
s_add_u32 m0, s39, 13312
s_add_u32 s37, s37, s38
buffer_load_dwordx4 v23, s[8:11], s37 offen sc1 lds
s_add_u32 m0, s39, 14336
s_add_u32 s37, s37, s38
buffer_load_dwordx4 v22, s[8:11], s37 offen sc1 lds
s_add_u32 m0, s39, 15360
s_add_u32 s37, s37, s38
buffer_load_dwordx4 v23, s[8:11], s37 offen sc1 lds
s_waitcnt vmcnt(32)
s_barrier
s_barrier
s_barrier
s_add_u32 m0, s39, 49152
s_add_u32 s37, s37, s38
buffer_load_dwordx4 v22, s[8:11], s37 offen sc1 lds
s_add_u32 m0, s39, 50176
s_add_u32 s37, s37, s38
buffer_load_dwordx4 v23, s[8:11], s37 offen sc1 lds
s_add_u32 m0, s39, 51200
s_add_u32 s37, s37, s38
buffer_load_dwordx4 v22, s[8:11], s37 offen sc1 lds
s_add_u32 m0, s39, 52224
s_add_u32 s37, s37, s38
buffer_load_dwordx4 v23, s[8:11], s37 offen sc1 lds
s_add_u32 m0, s39, 53248
s_add_u32 s37, s37, s38
buffer_load_dwordx4 v22, s[8:11], s37 offen sc1 lds
s_add_u32 m0, s39, 54272
s_add_u32 s37, s37, s38
buffer_load_dwordx4 v23, s[8:11], s37 offen sc1 lds
s_add_u32 m0, s39, 55296
s_add_u32 s37, s37, s38
buffer_load_dwordx4 v22, s[8:11], s37 offen sc1 lds
s_add_u32 m0, s39, 56320
s_add_u32 s37, s37, s38
buffer_load_dwordx4 v23, s[8:11], s37 offen sc1 lds
s_add_u32 m0, s39, 57344
s_add_u32 s37, s37, s38
buffer_load_dwordx4 v22, s[8:11], s37 offen sc1 lds
s_add_u32 m0, s39, 58368
s_add_u32 s37, s37, s38
buffer_load_dwordx4 v23, s[8:11], s37 offen sc1 lds
s_add_u32 m0, s39, 59392
s_add_u32 s37, s37, s38
buffer_load_dwordx4 v22, s[8:11], s37 offen sc1 lds
s_add_u32 m0, s39, 60416
s_add_u32 s37, s37, s38
buffer_load_dwordx4 v23, s[8:11], s37 offen sc1 lds
s_add_u32 m0, s39, 61440
s_add_u32 s37, s37, s38
buffer_load_dwordx4 v22, s[8:11], s37 offen sc1 lds
s_add_u32 m0, s39, 62464
s_add_u32 s37, s37, s38
buffer_load_dwordx4 v23, s[8:11], s37 offen sc1 lds
s_add_u32 m0, s39, 63488
s_add_u32 s37, s37, s38
buffer_load_dwordx4 v22, s[8:11], s37 offen sc1 lds
s_add_u32 m0, s39, 64512
s_add_u32 s37, s37, s38
buffer_load_dwordx4 v23, s[8:11], s37 offen sc1 lds
LP3_27:
s_lshl_b32 s43, s34, 18
s_add_u32 s12, s32, s43
s_addc_u32 s13, s33, 0
s_add_u32 s12, s12, 4194304
s_addc_u32 s13, s13, 0
s_mov_b32 s14, 262144
s_mov_b32 s15, 0x20000
v_lshlrev_b32 v21, 4, v1
s_lshl_b32 s54, s36, 11
s_barrier
s_add_u32 m0, s54, 98304
s_add_u32 s43, s54, 0
buffer_load_dwordx4 v21, s[12:15], s43 offen sc1 lds
s_add_u32 m0, s54, 99328
s_add_u32 s43, s54, 1024
buffer_load_dwordx4 v21, s[12:15], s43 offen sc1 lds
s_add_u32 m0, s54, 0
s_add_u32 s43, s54, 16384
buffer_load_dwordx4 v21, s[12:15], s43 offen sc1 lds
s_add_u32 m0, s54, 1024
s_add_u32 s43, s54, 17408
buffer_load_dwordx4 v21, s[12:15], s43 offen sc1 lds
s_add_u32 m0, s54, 49152
s_add_u32 s43, s54, 32768
buffer_load_dwordx4 v21, s[12:15], s43 offen sc1 lds
s_add_u32 m0, s54, 50176
s_add_u32 s43, s54, 33792
buffer_load_dwordx4 v21, s[12:15], s43 offen sc1 lds
s_waitcnt vmcnt(4)
s_barrier
s_waitcnt vmcnt(2)
s_barrier
s_mov_b32 s41, 3
Lp3_35:
s_add_u32 m0, s39, 98304
s_add_u32 s37, s37, s38
buffer_load_dwordx4 v22, s[8:11], s37 offen sc1 lds
s_add_u32 m0, s39, 99328
s_add_u32 s37, s37, s38
buffer_load_dwordx4 v23, s[8:11], s37 offen sc1 lds
s_add_u32 m0, s39, 100352
s_add_u32 s37, s37, s38
buffer_load_dwordx4 v22, s[8:11], s37 offen sc1 lds
s_add_u32 m0, s39, 101376
s_add_u32 s37, s37, s38
buffer_load_dwordx4 v23, s[8:11], s37 offen sc1 lds
s_add_u32 m0, s39, 102400
s_add_u32 s37, s37, s38
buffer_load_dwordx4 v22, s[8:11], s37 offen sc1 lds
s_add_u32 m0, s39, 103424
s_add_u32 s37, s37, s38
buffer_load_dwordx4 v23, s[8:11], s37 offen sc1 lds
s_add_u32 m0, s39, 104448
s_add_u32 s37, s37, s38
buffer_load_dwordx4 v22, s[8:11], s37 offen sc1 lds
s_add_u32 m0, s39, 105472
s_add_u32 s37, s37, s38
buffer_load_dwordx4 v23, s[8:11], s37 offen sc1 lds
s_add_u32 m0, s39, 106496
s_add_u32 s37, s37, s38
buffer_load_dwordx4 v22, s[8:11], s37 offen sc1 lds
s_add_u32 m0, s39, 107520
s_add_u32 s37, s37, s38
buffer_load_dwordx4 v23, s[8:11], s37 offen sc1 lds
s_add_u32 m0, s39, 108544
s_add_u32 s37, s37, s38
buffer_load_dwordx4 v22, s[8:11], s37 offen sc1 lds
s_add_u32 m0, s39, 109568
s_add_u32 s37, s37, s38
buffer_load_dwordx4 v23, s[8:11], s37 offen sc1 lds
s_add_u32 m0, s39, 110592
s_add_u32 s37, s37, s38
buffer_load_dwordx4 v22, s[8:11], s37 offen sc1 lds
s_add_u32 m0, s39, 111616
s_add_u32 s37, s37, s38
buffer_load_dwordx4 v23, s[8:11], s37 offen sc1 lds
s_add_u32 m0, s39, 112640
s_add_u32 s37, s37, s38
buffer_load_dwordx4 v22, s[8:11], s37 offen sc1 lds
s_add_u32 m0, s39, 113664
s_add_u32 s37, s37, s38
buffer_load_dwordx4 v23, s[8:11], s37 offen sc1 lds
s_waitcnt vmcnt(16)
s_barrier
s_add_u32 m0, s39, 0
s_add_u32 s37, s37, s38
buffer_load_dwordx4 v22, s[8:11], s37 offen sc1 lds
s_add_u32 m0, s39, 1024
s_add_u32 s37, s37, s38
buffer_load_dwordx4 v23, s[8:11], s37 offen sc1 lds
s_add_u32 m0, s39, 2048
s_add_u32 s37, s37, s38
buffer_load_dwordx4 v22, s[8:11], s37 offen sc1 lds
s_add_u32 m0, s39, 3072
s_add_u32 s37, s37, s38
buffer_load_dwordx4 v23, s[8:11], s37 offen sc1 lds
s_add_u32 m0, s39, 4096
s_add_u32 s37, s37, s38
buffer_load_dwordx4 v22, s[8:11], s37 offen sc1 lds
s_add_u32 m0, s39, 5120
s_add_u32 s37, s37, s38
buffer_load_dwordx4 v23, s[8:11], s37 offen sc1 lds
s_add_u32 m0, s39, 6144
s_add_u32 s37, s37, s38
buffer_load_dwordx4 v22, s[8:11], s37 offen sc1 lds
s_add_u32 m0, s39, 7168
s_add_u32 s37, s37, s38
buffer_load_dwordx4 v23, s[8:11], s37 offen sc1 lds
s_add_u32 m0, s39, 8192
s_add_u32 s37, s37, s38
buffer_load_dwordx4 v22, s[8:11], s37 offen sc1 lds
s_add_u32 m0, s39, 9216
s_add_u32 s37, s37, s38
buffer_load_dwordx4 v23, s[8:11], s37 offen sc1 lds
s_add_u32 m0, s39, 10240
s_add_u32 s37, s37, s38
buffer_load_dwordx4 v22, s[8:11], s37 offen sc1 lds
s_add_u32 m0, s39, 11264
s_add_u32 s37, s37, s38
buffer_load_dwordx4 v23, s[8:11], s37 offen sc1 lds
s_add_u32 m0, s39, 12288
s_add_u32 s37, s37, s38
buffer_load_dwordx4 v22, s[8:11], s37 offen sc1 lds
s_add_u32 m0, s39, 13312
s_add_u32 s37, s37, s38
buffer_load_dwordx4 v23, s[8:11], s37 offen sc1 lds
s_add_u32 m0, s39, 14336
s_add_u32 s37, s37, s38
buffer_load_dwordx4 v22, s[8:11], s37 offen sc1 lds
s_add_u32 m0, s39, 15360
s_add_u32 s37, s37, s38
buffer_load_dwordx4 v23, s[8:11], s37 offen sc1 lds
s_waitcnt vmcnt(16)
s_barrier
s_add_u32 m0, s39, 49152
s_add_u32 s37, s37, s38
buffer_load_dwordx4 v22, s[8:11], s37 offen sc1 lds
s_add_u32 m0, s39, 50176
s_add_u32 s37, s37, s38
buffer_load_dwordx4 v23, s[8:11], s37 offen sc1 lds
s_add_u32 m0, s39, 51200
s_add_u32 s37, s37, s38
buffer_load_dwordx4 v22, s[8:11], s37 offen sc1 lds
s_add_u32 m0, s39, 52224
s_add_u32 s37, s37, s38
buffer_load_dwordx4 v23, s[8:11], s37 offen sc1 lds
s_add_u32 m0, s39, 53248
s_add_u32 s37, s37, s38
buffer_load_dwordx4 v22, s[8:11], s37 offen sc1 lds
s_add_u32 m0, s39, 54272
s_add_u32 s37, s37, s38
buffer_load_dwordx4 v23, s[8:11], s37 offen sc1 lds
s_add_u32 m0, s39, 55296
s_add_u32 s37, s37, s38
buffer_load_dwordx4 v22, s[8:11], s37 offen sc1 lds
s_add_u32 m0, s39, 56320
s_add_u32 s37, s37, s38
buffer_load_dwordx4 v23, s[8:11], s37 offen sc1 lds
s_add_u32 m0, s39, 57344
s_add_u32 s37, s37, s38
buffer_load_dwordx4 v22, s[8:11], s37 offen sc1 lds
s_add_u32 m0, s39, 58368
s_add_u32 s37, s37, s38
buffer_load_dwordx4 v23, s[8:11], s37 offen sc1 lds
s_add_u32 m0, s39, 59392
s_add_u32 s37, s37, s38
buffer_load_dwordx4 v22, s[8:11], s37 offen sc1 lds
s_add_u32 m0, s39, 60416
s_add_u32 s37, s37, s38
buffer_load_dwordx4 v23, s[8:11], s37 offen sc1 lds
s_add_u32 m0, s39, 61440
s_add_u32 s37, s37, s38
buffer_load_dwordx4 v22, s[8:11], s37 offen sc1 lds
s_add_u32 m0, s39, 62464
s_add_u32 s37, s37, s38
buffer_load_dwordx4 v23, s[8:11], s37 offen sc1 lds
s_add_u32 m0, s39, 63488
s_add_u32 s37, s37, s38
buffer_load_dwordx4 v22, s[8:11], s37 offen sc1 lds
s_add_u32 m0, s39, 64512
s_add_u32 s37, s37, s38
buffer_load_dwordx4 v23, s[8:11], s37 offen sc1 lds
s_waitcnt vmcnt(16)
s_barrier
s_sub_u32 s41, s41, 1
s_cmp_lg_u32 s41, 0
s_cbranch_scc1 Lp3_35
s_add_u32 m0, s39, 98304
s_add_u32 s37, s37, s38
buffer_load_dwordx4 v22, s[8:11], s37 offen sc1 lds
s_and_b32 s53, s35, 1
s_lshl_b32 s53, s53, 1
s_mul_i32 s43, s47, 3
s_add_u32 m0, s39, 99328
s_add_u32 s37, s37, s38
buffer_load_dwordx4 v23, s[8:11], s37 offen sc1 lds
s_add_u32 s53, s53, s43
v_lshlrev_b32 v19, 11, v18
v_lshl_add_u32 v19, v17, 4, v19
s_add_u32 m0, s39, 100352
s_add_u32 s37, s37, s38
buffer_load_dwordx4 v22, s[8:11], s37 offen sc1 lds
s_lshl_b32 s43, s46, 10
v_add_u32 v2, s43, v19
v_add_u32 v3, 49152, v2
s_add_u32 m0, s39, 101376
s_add_u32 s37, s37, s38
buffer_load_dwordx4 v23, s[8:11], s37 offen sc1 lds
v_add_u32 v4, 98304, v2
v_lshrrev_b32 v19, 2, v17
v_lshl_add_u32 v20, v18, 2, v19
s_add_u32 m0, s39, 102400
s_add_u32 s37, s37, s38
buffer_load_dwordx4 v22, s[8:11], s37 offen sc1 lds
v_and_b32 v21, 7, v20
v_lshlrev_b32 v20, 8, v20
v_and_b32 v19, 3, v1
s_add_u32 m0, s39, 103424
s_add_u32 s37, s37, s38
buffer_load_dwordx4 v23, s[8:11], s37 offen sc1 lds
v_lshl_add_u32 v20, v19, 3, v20
s_add_u32 s43, s53, 0
v_xor_b32 v19, s43, v21
s_add_u32 m0, s39, 104448
s_add_u32 s37, s37, s38
buffer_load_dwordx4 v22, s[8:11], s37 offen sc1 lds
v_lshl_add_u32 v5, v19, 5, v20
s_add_u32 s43, s53, 1
v_xor_b32 v19, s43, v21
s_add_u32 m0, s39, 105472
s_add_u32 s37, s37, s38
buffer_load_dwordx4 v23, s[8:11], s37 offen sc1 lds
v_lshl_add_u32 v6, v19, 5, v20
s_add_u32 s43, s53, 2
v_xor_b32 v19, s43, v21
s_add_u32 m0, s39, 106496
s_add_u32 s37, s37, s38
buffer_load_dwordx4 v22, s[8:11], s37 offen sc1 lds
v_lshl_add_u32 v7, v19, 5, v20
v_add_u32 v9, 49152, v5
v_add_u32 v10, 49152, v6
s_add_u32 m0, s39, 107520
s_add_u32 s37, s37, s38
buffer_load_dwordx4 v23, s[8:11], s37 offen sc1 lds
v_add_u32 v11, 49152, v7
v_add_u32 v13, 98304, v5
v_add_u32 v14, 98304, v6
s_add_u32 m0, s39, 108544
s_add_u32 s37, s37, s38
buffer_load_dwordx4 v22, s[8:11], s37 offen sc1 lds
v_add_u32 v15, 98304, v7
s_lshl_b32 s43, s46, 9
s_add_u32 s43, s43, 147456
s_add_u32 m0, s39, 109568
s_add_u32 s37, s37, s38
buffer_load_dwordx4 v23, s[8:11], s37 offen sc1 lds
v_lshl_add_u32 v19, v17, 3, s43
ds_read_b64 v[80:81], v19 offset:0
ds_read_b64 v[82:83], v19 offset:128
s_add_u32 m0, s39, 110592
s_add_u32 s37, s37, s38
buffer_load_dwordx4 v22, s[8:11], s37 offen sc1 lds
ds_read_b64 v[84:85], v19 offset:256
ds_read_b64 v[86:87], v19 offset:384
s_mul_i32 s43, s47, 192
s_add_u32 m0, s39, 111616
s_add_u32 s37, s37, s38
buffer_load_dwordx4 v23, s[8:11], s37 offen sc1 lds
s_add_u32 s43, s43, 148992
v_lshl_add_u32 v19, v18, 4, s43
ds_read_b128 v[48:51], v19 offset:0
s_add_u32 m0, s39, 112640
s_add_u32 s37, s37, s38
buffer_load_dwordx4 v22, s[8:11], s37 offen sc1 lds
ds_read_b128 v[52:55], v19 offset:64
ds_read_b128 v[56:59], v19 offset:128
ds_read_b128 v[60:63], v19 offset:896
s_add_u32 m0, s39, 113664
s_add_u32 s37, s37, s38
buffer_load_dwordx4 v23, s[8:11], s37 offen sc1 lds
ds_read_b128 v[64:67], v19 offset:960
ds_read_b128 v[68:71], v19 offset:1024
s_waitcnt vmcnt(16)
s_barrier
s_add_u32 m0, s39, 0
s_add_u32 s37, s37, s38
buffer_load_dwordx4 v22, s[8:11], s37 offen sc1 lds
s_waitcnt lgkmcnt(0)
v_mul_f32 v88, v81, v81
v_mul_f32 v228, 0xc0135761, v81
s_add_u32 m0, s39, 1024
s_add_u32 s37, s37, s38
buffer_load_dwordx4 v23, s[8:11], s37 offen sc1 lds
v_mul_f32 v89, 0xbdd2d3e8, v81
v_rcp_f32 v236, v88
v_mul_f32 v232, v89, v88
s_add_u32 m0, s39, 2048
s_add_u32 s37, s37, s38
buffer_load_dwordx4 v22, s[8:11], s37 offen sc1 lds
v_mul_f32 v88, v83, v83
v_mul_f32 v229, 0xc0135761, v83
v_mul_f32 v89, 0xbdd2d3e8, v83
s_add_u32 m0, s39, 3072
s_add_u32 s37, s37, s38
buffer_load_dwordx4 v23, s[8:11], s37 offen sc1 lds
v_rcp_f32 v237, v88
v_mul_f32 v233, v89, v88
v_mul_f32 v88, v85, v85
s_add_u32 m0, s39, 4096
s_add_u32 s37, s37, s38
buffer_load_dwordx4 v22, s[8:11], s37 offen sc1 lds
v_mul_f32 v230, 0xc0135761, v85
v_mul_f32 v89, 0xbdd2d3e8, v85
v_rcp_f32 v238, v88
s_add_u32 m0, s39, 5120
s_add_u32 s37, s37, s38
buffer_load_dwordx4 v23, s[8:11], s37 offen sc1 lds
v_mul_f32 v234, v89, v88
v_mul_f32 v88, v87, v87
s_add_u32 m0, s39, 6144
s_add_u32 s37, s37, s38
buffer_load_dwordx4 v22, s[8:11], s37 offen sc1 lds
v_mul_f32 v231, 0xc0135761, v87
v_mul_f32 v89, 0xbdd2d3e8, v87
v_rcp_f32 v239, v88
s_add_u32 m0, s39, 7168
s_add_u32 s37, s37, s38
buffer_load_dwordx4 v23, s[8:11], s37 offen sc1 lds
v_mul_f32 v235, v89, v88
s_mul_i32 s43, s34, 917504
s_mul_i32 s44, s35, 24576
s_add_u32 m0, s39, 8192
s_add_u32 s37, s37, s38
buffer_load_dwordx4 v22, s[8:11], s37 offen sc1 lds
s_add_u32 s43, s43, s44
s_add_u32 s43, s43, 8912896
s_add_u32 s24, s32, s43
s_add_u32 m0, s39, 9216
s_add_u32 s37, s37, s38
buffer_load_dwordx4 v23, s[8:11], s37 offen sc1 lds
s_addc_u32 s25, s33, 0
s_mov_b32 s26, 24576
s_mov_b32 s27, 0x20000
s_add_u32 m0, s39, 10240
s_add_u32 s37, s37, s38
buffer_load_dwordx4 v22, s[8:11], s37 offen sc1 lds
s_mov_b32 s53, 262144
s_lshl_b32 s43, s47, 13
s_add_u32 m0, s39, 11264
s_add_u32 s37, s37, s38
buffer_load_dwordx4 v23, s[8:11], s37 offen sc1 lds
s_lshl_b32 s44, s46, 10
s_add_u32 s43, s43, s44
v_lshlrev_b32 v19, 11, v18
s_add_u32 m0, s39, 12288
s_add_u32 s37, s37, s38
buffer_load_dwordx4 v22, s[8:11], s37 offen sc1 lds
v_lshl_add_u32 v19, v17, 4, v19
v_add_u32 v27, s43, v19
s_lshl_b32 s43, s47, 12
s_add_u32 m0, s39, 13312
s_add_u32 s37, s37, s38
buffer_load_dwordx4 v23, s[8:11], s37 offen sc1 lds
s_add_u32 s43, s43, s44
s_add_u32 s43, s43, 16384
v_and_b32 v19, 1, v18
s_add_u32 m0, s39, 14336
s_add_u32 s37, s37, s38
buffer_load_dwordx4 v22, s[8:11], s37 offen sc1 lds
v_lshlrev_b32 v19, 11, v19
v_lshrrev_b32 v20, 1, v18
v_lshl_add_u32 v19, v20, 8, v19
s_add_u32 m0, s39, 15360
s_add_u32 s37, s37, s38
buffer_load_dwordx4 v23, s[8:11], s37 offen sc1 lds
v_lshl_add_u32 v19, v17, 4, v19
v_add_u32 v28, s43, v19
s_waitcnt vmcnt(16)
s_barrier
s_add_u32 m0, s39, 49152
s_add_u32 s37, s37, s38
buffer_load_dwordx4 v22, s[8:11], s37 offen sc1 lds
v_mul_f32 v128, -v80, v48
v_mul_f32 v129, -v80, v49
s_add_u32 m0, s39, 50176
s_add_u32 s37, s37, s38
buffer_load_dwordx4 v23, s[8:11], s37 offen sc1 lds
v_mul_f32 v130, -v80, v50
v_mul_f32 v131, -v80, v51
s_add_u32 m0, s39, 51200
s_add_u32 s37, s37, s38
buffer_load_dwordx4 v22, s[8:11], s37 offen sc1 lds
v_mul_f32 v132, -v82, v48
v_mul_f32 v133, -v82, v49
s_add_u32 m0, s39, 52224
s_add_u32 s37, s37, s38
buffer_load_dwordx4 v23, s[8:11], s37 offen sc1 lds
v_mul_f32 v134, -v82, v50
v_mul_f32 v135, -v82, v51
s_add_u32 m0, s39, 53248
s_add_u32 s37, s37, s38
buffer_load_dwordx4 v22, s[8:11], s37 offen sc1 lds
v_mul_f32 v136, -v84, v48
v_mul_f32 v137, -v84, v49
s_add_u32 m0, s39, 54272
s_add_u32 s37, s37, s38
buffer_load_dwordx4 v23, s[8:11], s37 offen sc1 lds
v_mul_f32 v138, -v84, v50
v_mul_f32 v139, -v84, v51
s_add_u32 m0, s39, 55296
s_add_u32 s37, s37, s38
buffer_load_dwordx4 v22, s[8:11], s37 offen sc1 lds
v_mul_f32 v140, -v86, v48
v_mul_f32 v141, -v86, v49
s_add_u32 m0, s39, 56320
s_add_u32 s37, s37, s38
buffer_load_dwordx4 v23, s[8:11], s37 offen sc1 lds
v_mul_f32 v142, -v86, v50
v_mul_f32 v143, -v86, v51
s_add_u32 m0, s39, 57344
s_add_u32 s37, s37, s38
buffer_load_dwordx4 v22, s[8:11], s37 offen sc1 lds
v_mul_f32 v144, -v80, v52
v_mul_f32 v145, -v80, v53
s_add_u32 m0, s39, 58368
s_add_u32 s37, s37, s38
buffer_load_dwordx4 v23, s[8:11], s37 offen sc1 lds
v_mul_f32 v146, -v80, v54
v_mul_f32 v147, -v80, v55
s_add_u32 m0, s39, 59392
s_add_u32 s37, s37, s38
buffer_load_dwordx4 v22, s[8:11], s37 offen sc1 lds
v_mul_f32 v148, -v82, v52
v_mul_f32 v149, -v82, v53
s_add_u32 m0, s39, 60416
s_add_u32 s37, s37, s38
buffer_load_dwordx4 v23, s[8:11], s37 offen sc1 lds
v_mul_f32 v150, -v82, v54
v_mul_f32 v151, -v82, v55
s_add_u32 m0, s39, 61440
s_add_u32 s37, s37, s38
buffer_load_dwordx4 v22, s[8:11], s37 offen sc1 lds
v_mul_f32 v152, -v84, v52
v_mul_f32 v153, -v84, v53
s_add_u32 m0, s39, 62464
s_add_u32 s37, s37, s38
buffer_load_dwordx4 v23, s[8:11], s37 offen sc1 lds
v_mul_f32 v154, -v84, v54
v_mul_f32 v155, -v84, v55
s_add_u32 m0, s39, 63488
s_add_u32 s37, s37, s38
buffer_load_dwordx4 v22, s[8:11], s37 offen sc1 lds
v_mul_f32 v156, -v86, v52
v_mul_f32 v157, -v86, v53
s_add_u32 m0, s39, 64512
s_add_u32 s37, s37, s38
buffer_load_dwordx4 v23, s[8:11], s37 offen sc1 lds
v_mul_f32 v158, -v86, v54
v_mul_f32 v159, -v86, v55
s_waitcnt vmcnt(16)
s_barrier
s_add_u32 m0, s39, 98304
s_add_u32 s37, s37, s38
buffer_load_dwordx4 v22, s[8:11], s37 offen sc1 lds
v_mul_f32 v160, -v80, v56
v_mul_f32 v161, -v80, v57
s_add_u32 m0, s39, 99328
s_add_u32 s37, s37, s38
buffer_load_dwordx4 v23, s[8:11], s37 offen sc1 lds
v_mul_f32 v162, -v80, v58
v_mul_f32 v163, -v80, v59
s_add_u32 m0, s39, 100352
s_add_u32 s37, s37, s38
buffer_load_dwordx4 v22, s[8:11], s37 offen sc1 lds
v_mul_f32 v164, -v82, v56
v_mul_f32 v165, -v82, v57
s_add_u32 m0, s39, 101376
s_add_u32 s37, s37, s38
buffer_load_dwordx4 v23, s[8:11], s37 offen sc1 lds
v_mul_f32 v166, -v82, v58
v_mul_f32 v167, -v82, v59
s_add_u32 m0, s39, 102400
s_add_u32 s37, s37, s38
buffer_load_dwordx4 v22, s[8:11], s37 offen sc1 lds
v_mul_f32 v168, -v84, v56
v_mul_f32 v169, -v84, v57
s_add_u32 m0, s39, 103424
s_add_u32 s37, s37, s38
buffer_load_dwordx4 v23, s[8:11], s37 offen sc1 lds
v_mul_f32 v170, -v84, v58
v_mul_f32 v171, -v84, v59
s_add_u32 m0, s39, 104448
s_add_u32 s37, s37, s38
buffer_load_dwordx4 v22, s[8:11], s37 offen sc1 lds
v_mul_f32 v172, -v86, v56
v_mul_f32 v173, -v86, v57
s_add_u32 m0, s39, 105472
s_add_u32 s37, s37, s38
buffer_load_dwordx4 v23, s[8:11], s37 offen sc1 lds
v_mul_f32 v174, -v86, v58
v_mul_f32 v175, -v86, v59
s_add_u32 m0, s39, 106496
s_add_u32 s37, s37, s38
buffer_load_dwordx4 v22, s[8:11], s37 offen sc1 lds
v_mul_f32 v176, -v80, v60
v_mul_f32 v177, -v80, v61
s_add_u32 m0, s39, 107520
s_add_u32 s37, s37, s38
buffer_load_dwordx4 v23, s[8:11], s37 offen sc1 lds
v_mul_f32 v178, -v80, v62
v_mul_f32 v179, -v80, v63
s_add_u32 m0, s39, 108544
s_add_u32 s37, s37, s38
buffer_load_dwordx4 v22, s[8:11], s37 offen sc1 lds
v_mul_f32 v180, -v82, v60
v_mul_f32 v181, -v82, v61
s_add_u32 m0, s39, 109568
s_add_u32 s37, s37, s38
buffer_load_dwordx4 v23, s[8:11], s37 offen sc1 lds
v_mul_f32 v182, -v82, v62
v_mul_f32 v183, -v82, v63
s_add_u32 m0, s39, 110592
s_add_u32 s37, s37, s38
buffer_load_dwordx4 v22, s[8:11], s37 offen sc1 lds
v_mul_f32 v184, -v84, v60
v_mul_f32 v185, -v84, v61
s_add_u32 m0, s39, 111616
s_add_u32 s37, s37, s38
buffer_load_dwordx4 v23, s[8:11], s37 offen sc1 lds
v_mul_f32 v186, -v84, v62
v_mul_f32 v187, -v84, v63
s_add_u32 m0, s39, 112640
s_add_u32 s37, s37, s38
buffer_load_dwordx4 v22, s[8:11], s37 offen sc1 lds
v_mul_f32 v188, -v86, v60
v_mul_f32 v189, -v86, v61
s_add_u32 m0, s39, 113664
s_add_u32 s37, s37, s38
buffer_load_dwordx4 v23, s[8:11], s37 offen sc1 lds
v_mul_f32 v190, -v86, v62
v_mul_f32 v191, -v86, v63
s_waitcnt vmcnt(16)
s_barrier
s_mul_i32 s43, s35, 192
s_and_b32 s43, s43, 0xffffff80
s_add_u32 s43, s43, 4096
s_cmp_eq_u32 s51, 1
s_cselect_b32 s8, s4, s6
s_cselect_b32 s9, s5, s7
s_sub_u32 s10, 7340032, s43
s_lshl_b32 s44, s34, 18
s_add_u32 s44, s44, 4194304
s_movk_i32 s38, 28672
s_cmp_eq_u32 s51, 0
s_cselect_b32 s8, s32, s8
s_cselect_b32 s9, s33, s9
s_cselect_b32 s10, 262144, s10
s_cselect_b32 s43, s44, s43
s_cselect_b32 s38, 1024, s38
s_cselect_b32 s45, 0, -1
s_add_u32 s8, s8, s43
s_addc_u32 s9, s9, 0
s_mov_b32 s11, 0x20000
s_sub_u32 s37, 0, s38
s_lshl_b32 s39, s51, 14
v_lshrrev_b32 v19, 4, v1
v_lshlrev_b32 v20, 5, v19
v_mul_u32_u24 v19, 6912, v19
v_and_b32 v19, s45, v19
v_and_b32 v20, s45, v20
v_lshlrev_b32 v21, 4, v1
v_xor_b32 v21, v21, v20
v_add_u32 v22, v21, v19
s_and_b32 s45, s45, 128
v_xor_b32 v23, s45, v22
s_add_u32 m0, s39, 0
s_add_u32 s37, s37, s38
buffer_load_dwordx4 v22, s[8:11], s37 offen sc1 lds
v_mul_f32 v192, -v80, v64
v_mul_f32 v193, -v80, v65
s_add_u32 m0, s39, 1024
s_add_u32 s37, s37, s38
buffer_load_dwordx4 v23, s[8:11], s37 offen sc1 lds
v_mul_f32 v194, -v80, v66
v_mul_f32 v195, -v80, v67
s_add_u32 m0, s39, 2048
s_add_u32 s37, s37, s38
buffer_load_dwordx4 v22, s[8:11], s37 offen sc1 lds
v_mul_f32 v196, -v82, v64
v_mul_f32 v197, -v82, v65
s_add_u32 m0, s39, 3072
s_add_u32 s37, s37, s38
buffer_load_dwordx4 v23, s[8:11], s37 offen sc1 lds
v_mul_f32 v198, -v82, v66
v_mul_f32 v199, -v82, v67
s_add_u32 m0, s39, 4096
s_add_u32 s37, s37, s38
buffer_load_dwordx4 v22, s[8:11], s37 offen sc1 lds
v_mul_f32 v200, -v84, v64
v_mul_f32 v201, -v84, v65
s_add_u32 m0, s39, 5120
s_add_u32 s37, s37, s38
buffer_load_dwordx4 v23, s[8:11], s37 offen sc1 lds
v_mul_f32 v202, -v84, v66
v_mul_f32 v203, -v84, v67
s_add_u32 m0, s39, 6144
s_add_u32 s37, s37, s38
buffer_load_dwordx4 v22, s[8:11], s37 offen sc1 lds
v_mul_f32 v204, -v86, v64
v_mul_f32 v205, -v86, v65
s_add_u32 m0, s39, 7168
s_add_u32 s37, s37, s38
buffer_load_dwordx4 v23, s[8:11], s37 offen sc1 lds
v_mul_f32 v206, -v86, v66
v_mul_f32 v207, -v86, v67
s_add_u32 m0, s39, 8192
s_add_u32 s37, s37, s38
buffer_load_dwordx4 v22, s[8:11], s37 offen sc1 lds
v_mul_f32 v208, -v80, v68
v_mul_f32 v209, -v80, v69
s_add_u32 m0, s39, 9216
s_add_u32 s37, s37, s38
buffer_load_dwordx4 v23, s[8:11], s37 offen sc1 lds
v_mul_f32 v210, -v80, v70
v_mul_f32 v211, -v80, v71
s_add_u32 m0, s39, 10240
s_add_u32 s37, s37, s38
buffer_load_dwordx4 v22, s[8:11], s37 offen sc1 lds
v_mul_f32 v212, -v82, v68
v_mul_f32 v213, -v82, v69
s_add_u32 m0, s39, 11264
s_add_u32 s37, s37, s38
buffer_load_dwordx4 v23, s[8:11], s37 offen sc1 lds
v_mul_f32 v214, -v82, v70
v_mul_f32 v215, -v82, v71
s_add_u32 m0, s39, 12288
s_add_u32 s37, s37, s38
buffer_load_dwordx4 v22, s[8:11], s37 offen sc1 lds
v_mul_f32 v216, -v84, v68
v_mul_f32 v217, -v84, v69
s_add_u32 m0, s39, 13312
s_add_u32 s37, s37, s38
buffer_load_dwordx4 v23, s[8:11], s37 offen sc1 lds
v_mul_f32 v218, -v84, v70
v_mul_f32 v219, -v84, v71
s_add_u32 m0, s39, 14336
s_add_u32 s37, s37, s38
buffer_load_dwordx4 v22, s[8:11], s37 offen sc1 lds
v_mul_f32 v220, -v86, v68
v_mul_f32 v221, -v86, v69
s_add_u32 m0, s39, 15360
s_add_u32 s37, s37, s38
buffer_load_dwordx4 v23, s[8:11], s37 offen sc1 lds
v_mul_f32 v222, -v86, v70
v_mul_f32 v223, -v86, v71
s_waitcnt vmcnt(16)
s_barrier
s_add_u32 m0, s39, 49152
s_add_u32 s37, s37, s38
buffer_load_dwordx4 v22, s[8:11], s37 offen sc1 lds
s_add_u32 m0, s39, 50176
s_add_u32 s37, s37, s38
buffer_load_dwordx4 v23, s[8:11], s37 offen sc1 lds
s_add_u32 m0, s39, 51200
s_add_u32 s37, s37, s38
buffer_load_dwordx4 v22, s[8:11], s37 offen sc1 lds
s_add_u32 m0, s39, 52224
s_add_u32 s37, s37, s38
buffer_load_dwordx4 v23, s[8:11], s37 offen sc1 lds
s_add_u32 m0, s39, 53248
s_add_u32 s37, s37, s38
buffer_load_dwordx4 v22, s[8:11], s37 offen sc1 lds
s_add_u32 m0, s39, 54272
s_add_u32 s37, s37, s38
buffer_load_dwordx4 v23, s[8:11], s37 offen sc1 lds
s_add_u32 m0, s39, 55296
s_add_u32 s37, s37, s38
buffer_load_dwordx4 v22, s[8:11], s37 offen sc1 lds
s_add_u32 m0, s39, 56320
s_add_u32 s37, s37, s38
buffer_load_dwordx4 v23, s[8:11], s37 offen sc1 lds
s_add_u32 m0, s39, 57344
s_add_u32 s37, s37, s38
buffer_load_dwordx4 v22, s[8:11], s37 offen sc1 lds
s_add_u32 m0, s39, 58368
s_add_u32 s37, s37, s38
buffer_load_dwordx4 v23, s[8:11], s37 offen sc1 lds
s_add_u32 m0, s39, 59392
s_add_u32 s37, s37, s38
buffer_load_dwordx4 v22, s[8:11], s37 offen sc1 lds
s_add_u32 m0, s39, 60416
s_add_u32 s37, s37, s38
buffer_load_dwordx4 v23, s[8:11], s37 offen sc1 lds
s_add_u32 m0, s39, 61440
s_add_u32 s37, s37, s38
buffer_load_dwordx4 v22, s[8:11], s37 offen sc1 lds
s_add_u32 m0, s39, 62464
s_add_u32 s37, s37, s38
buffer_load_dwordx4 v23, s[8:11], s37 offen sc1 lds
s_add_u32 m0, s39, 63488
s_add_u32 s37, s37, s38
buffer_load_dwordx4 v22, s[8:11], s37 offen sc1 lds
s_add_u32 m0, s39, 64512
s_add_u32 s37, s37, s38
buffer_load_dwordx4 v23, s[8:11], s37 offen sc1 lds
s_mul_i32 s44, s34, 917504
s_lshl_b32 s39, s51, 13
s_add_u32 s44, s44, s39
s_add_u32 s44, s44, 8388608
s_lshl_b32 s43, s35, 7
s_mov_b32 s10, 909312
s_movk_i32 s38, 1024
s_movk_i32 s40, 9216
s_cmp_eq_u32 s51, 2
s_cselect_b32 s8, s60, s32
s_cselect_b32 s9, s61, s33
s_cselect_b32 s10, 7338112, s10
s_cselect_b32 s43, s43, s44
s_cselect_b32 s38, 16384, s38
s_cselect_b32 s40, 81920, s40
s_cselect_b32 s55, 81920, s38
s_cselect_b32 s45, -1, 0
s_add_u32 s8, s8, s43
s_addc_u32 s9, s9, 0
s_mov_b32 s11, 0x20000
s_sub_u32 s37, 0, s40
v_lshrrev_b32 v19, 3, v1
v_mul_u32_u24 v19, 1920, v19
v_lshrrev_b32 v20, 4, v1
v_lshlrev_b32 v20, 5, v20
v_and_b32 v19, s45, v19
v_and_b32 v20, s45, v20
v_lshlrev_b32 v21, 4, v1
v_xor_b32 v21, v21, v20
v_add_u32 v21, v21, v19
s_mul_i32 s43, s38, 6
s_add_u32 s43, s43, s40
s_add_u32 s43, s43, s55
s_lshl_b32 s43, s43, 2
s_add_u32 s37, s37, s43
s_and_b32 s54, s45, 4290838528
s_waitcnt vmcnt(16)
s_barrier
s_branch LK3b_26
L7_25:
s_lshr_b32 s43, s2, 1
s_cmp_ge_u32 s43, 112
s_cbranch_scc1 Lnojob_36
s_and_b32 s44, s2, 1
s_lshl_b32 s45, s44, 3
s_add_u32 s45, s45, 32
s_load_dwordx2 s[68:69], s[0:1], s45
s_mul_i32 s45, s43, 2341
s_lshr_b32 s45, s45, 16
s_mul_i32 s46, s45, 28
s_sub_u32 s46, s43, s46
v_lshrrev_b32 v4, 4, v1
s_lshl_b32 s43, s45, 8
v_add_u32 v4, s43, v4
v_mul_u32_u24 v4, 7168, v4
v_and_b32 v5, 15, v1
v_lshl_add_u32 v4, v5, 4, v4
s_lshl_b32 s43, s46, 8
v_add_u32 v4, s43, v4
s_waitcnt lgkmcnt(0)
s_mov_b32 s64, s68
s_mov_b32 s65, s69
s_mov_b32 s66, 7340032
s_mov_b32 s67, 0x20000
s_lshl_b32 s55, s45, 1
s_add_u32 s55, s55, s44
s_mul_i32 s55, s55, 14336
s_lshl_b32 s45, s46, 9
s_add_u32 s55, s55, s45
v_lshl_add_u32 v5, v5, 5, s55
s_add_u32 s72, s32, 27262976
s_addc_u32 s73, s33, 0
s_mov_b32 s74, 114688
s_mov_b32 s75, 0x20000
v_mov_b32 v32, 0
v_mov_b32 v33, 0
v_mov_b32 v34, 0
v_mov_b32 v35, 0
v_mov_b32 v36, 0
v_mov_b32 v37, 0
v_mov_b32 v38, 0
v_mov_b32 v39, 0
v_lshlrev_b32 v40, 16, v128
v_and_b32 v41, 0xffff0000, v128
v_lshlrev_b32 v42, 16, v129
v_and_b32 v43, 0xffff0000, v129
v_lshlrev_b32 v44, 16, v130
v_and_b32 v45, 0xffff0000, v130
v_lshlrev_b32 v46, 16, v131
v_and_b32 v47, 0xffff0000, v131
s_mov_b32 s43, 917504
buffer_load_dwordx4 v[128:131], v4, s[64:67], s43 offen
v_add_f32 v32, v32, v40
v_add_f32 v33, v33, v41
v_add_f32 v34, v34, v42
v_add_f32 v35, v35, v43
v_add_f32 v36, v36, v44
v_add_f32 v37, v37, v45
v_add_f32 v38, v38, v46
v_add_f32 v39, v39, v47
v_lshlrev_b32 v40, 16, v132
v_and_b32 v41, 0xffff0000, v132
v_lshlrev_b32 v42, 16, v133
v_and_b32 v43, 0xffff0000, v133
v_lshlrev_b32 v44, 16, v134
v_and_b32 v45, 0xffff0000, v134
v_lshlrev_b32 v46, 16, v135
v_and_b32 v47, 0xffff0000, v135
s_mov_b32 s43, 946176
buffer_load_dwordx4 v[132:135], v4, s[64:67], s43 offen
v_add_f32 v32, v32, v40
v_add_f32 v33, v33, v41
v_add_f32 v34, v34, v42
v_add_f32 v35, v35, v43
v_add_f32 v36, v36, v44
v_add_f32 v37, v37, v45
v_add_f32 v38, v38, v46
v_add_f32 v39, v39, v47
v_lshlrev_b32 v40, 16, v136
v_and_b32 v41, 0xffff0000, v136
v_lshlrev_b32 v42, 16, v137
v_and_b32 v43, 0xffff0000, v137
v_lshlrev_b32 v44, 16, v138
v_and_b32 v45, 0xffff0000, v138
v_lshlrev_b32 v46, 16, v139
v_and_b32 v47, 0xffff0000, v139
s_mov_b32 s43, 974848
buffer_load_dwordx4 v[136:139], v4, s[64:67], s43 offen
v_add_f32 v32, v32, v40
v_add_f32 v33, v33, v41
v_add_f32 v34, v34, v42
v_add_f32 v35, v35, v43
v_add_f32 v36, v36, v44
v_add_f32 v37, v37, v45
v_add_f32 v38, v38, v46
v_add_f32 v39, v39, v47
v_lshlrev_b32 v40, 16, v140
v_and_b32 v41, 0xffff0000, v140
v_lshlrev_b32 v42, 16, v141
v_and_b32 v43, 0xffff0000, v141
v_lshlrev_b32 v44, 16, v142
v_and_b32 v45, 0xffff0000, v142
v_lshlrev_b32 v46, 16, v143
v_and_b32 v47, 0xffff0000, v143
s_mov_b32 s43, 1003520
buffer_load_dwordx4 v[140:143], v4, s[64:67], s43 offen
v_add_f32 v32, v32, v40
v_add_f32 v33, v33, v41
v_add_f32 v34, v34, v42
v_add_f32 v35, v35, v43
v_add_f32 v36, v36, v44
v_add_f32 v37, v37, v45
v_add_f32 v38, v38, v46
v_add_f32 v39, v39, v47
v_lshlrev_b32 v40, 16, v144
v_and_b32 v41, 0xffff0000, v144
v_lshlrev_b32 v42, 16, v145
v_and_b32 v43, 0xffff0000, v145
v_lshlrev_b32 v44, 16, v146
v_and_b32 v45, 0xffff0000, v146
v_lshlrev_b32 v46, 16, v147
v_and_b32 v47, 0xffff0000, v147
s_mov_b32 s43, 1032192
buffer_load_dwordx4 v[144:147], v4, s[64:67], s43 offen
v_add_f32 v32, v32, v40
v_add_f32 v33, v33, v41
v_add_f32 v34, v34, v42
v_add_f32 v35, v35, v43
v_add_f32 v36, v36, v44
v_add_f32 v37, v37, v45
v_add_f32 v38, v38, v46
v_add_f32 v39, v39, v47
v_lshlrev_b32 v40, 16, v148
v_and_b32 v41, 0xffff0000, v148
v_lshlrev_b32 v42, 16, v149
v_and_b32 v43, 0xffff0000, v149
v_lshlrev_b32 v44, 16, v150
v_and_b32 v45, 0xffff0000, v150
v_lshlrev_b32 v46, 16, v151
v_and_b32 v47, 0xffff0000, v151
s_mov_b32 s43, 1060864
buffer_load_dwordx4 v[148:151], v4, s[64:67], s43 offen
v_add_f32 v32, v32, v40
v_add_f32 v33, v33, v41
v_add_f32 v34, v34, v42
v_add_f32 v35, v35, v43
v_add_f32 v36, v36, v44
v_add_f32 v37, v37, v45
v_add_f32 v38, v38, v46
v_add_f32 v39, v39, v47
v_lshlrev_b32 v40, 16, v152
v_and_b32 v41, 0xffff0000, v152
v_lshlrev_b32 v42, 16, v153
v_and_b32 v43, 0xffff0000, v153
v_lshlrev_b32 v44, 16, v154
v_and_b32 v45, 0xffff0000, v154
v_lshlrev_b32 v46, 16, v155
v_and_b32 v47, 0xffff0000, v155
s_mov_b32 s43, 1089536
buffer_load_dwordx4 v[152:155], v4, s[64:67], s43 offen
v_add_f32 v32, v32, v40
v_add_f32 v33, v33, v41
v_add_f32 v34, v34, v42
v_add_f32 v35, v35, v43
v_add_f32 v36, v36, v44
v_add_f32 v37, v37, v45
v_add_f32 v38, v38, v46
v_add_f32 v39, v39, v47
v_lshlrev_b32 v40, 16, v156
v_and_b32 v41, 0xffff0000, v156
v_lshlrev_b32 v42, 16, v157
v_and_b32 v43, 0xffff0000, v157
v_lshlrev_b32 v44, 16, v158
v_and_b32 v45, 0xffff0000, v158
v_lshlrev_b32 v46, 16, v159
v_and_b32 v47, 0xffff0000, v159
s_mov_b32 s43, 1118208
buffer_load_dwordx4 v[156:159], v4, s[64:67], s43 offen
v_add_f32 v32, v32, v40
v_add_f32 v33, v33, v41
v_add_f32 v34, v34, v42
v_add_f32 v35, v35, v43
v_add_f32 v36, v36, v44
v_add_f32 v37, v37, v45
v_add_f32 v38, v38, v46
v_add_f32 v39, v39, v47
v_lshlrev_b32 v40, 16, v160
v_and_b32 v41, 0xffff0000, v160
v_lshlrev_b32 v42, 16, v161
v_and_b32 v43, 0xffff0000, v161
v_lshlrev_b32 v44, 16, v162
v_and_b32 v45, 0xffff0000, v162
v_lshlrev_b32 v46, 16, v163
v_and_b32 v47, 0xffff0000, v163
s_mov_b32 s43, 1146880
buffer_load_dwordx4 v[160:163], v4, s[64:67], s43 offen
v_add_f32 v32, v32, v40
v_add_f32 v33, v33, v41
v_add_f32 v34, v34, v42
v_add_f32 v35, v35, v43
v_add_f32 v36, v36, v44
v_add_f32 v37, v37, v45
v_add_f32 v38, v38, v46
v_add_f32 v39, v39, v47
v_lshlrev_b32 v40, 16, v164
v_and_b32 v41, 0xffff0000, v164
v_lshlrev_b32 v42, 16, v165
v_and_b32 v43, 0xffff0000, v165
v_lshlrev_b32 v44, 16, v166
v_and_b32 v45, 0xffff0000, v166
v_lshlrev_b32 v46, 16, v167
v_and_b32 v47, 0xffff0000, v167
s_mov_b32 s43, 1175552
buffer_load_dwordx4 v[164:167], v4, s[64:67], s43 offen
v_add_f32 v32, v32, v40
v_add_f32 v33, v33, v41
v_add_f32 v34, v34, v42
v_add_f32 v35, v35, v43
v_add_f32 v36, v36, v44
v_add_f32 v37, v37, v45
v_add_f32 v38, v38, v46
v_add_f32 v39, v39, v47
v_lshlrev_b32 v40, 16, v168
v_and_b32 v41, 0xffff0000, v168
v_lshlrev_b32 v42, 16, v169
v_and_b32 v43, 0xffff0000, v169
v_lshlrev_b32 v44, 16, v170
v_and_b32 v45, 0xffff0000, v170
v_lshlrev_b32 v46, 16, v171
v_and_b32 v47, 0xffff0000, v171
s_mov_b32 s43, 1204224
buffer_load_dwordx4 v[168:171], v4, s[64:67], s43 offen
v_add_f32 v32, v32, v40
v_add_f32 v33, v33, v41
v_add_f32 v34, v34, v42
v_add_f32 v35, v35, v43
v_add_f32 v36, v36, v44
v_add_f32 v37, v37, v45
v_add_f32 v38, v38, v46
v_add_f32 v39, v39, v47
v_lshlrev_b32 v40, 16, v172
v_and_b32 v41, 0xffff0000, v172
v_lshlrev_b32 v42, 16, v173
v_and_b32 v43, 0xffff0000, v173
v_lshlrev_b32 v44, 16, v174
v_and_b32 v45, 0xffff0000, v174
v_lshlrev_b32 v46, 16, v175
v_and_b32 v47, 0xffff0000, v175
s_mov_b32 s43, 1232896
buffer_load_dwordx4 v[172:175], v4, s[64:67], s43 offen
v_add_f32 v32, v32, v40
v_add_f32 v33, v33, v41
v_add_f32 v34, v34, v42
v_add_f32 v35, v35, v43
v_add_f32 v36, v36, v44
v_add_f32 v37, v37, v45
v_add_f32 v38, v38, v46
v_add_f32 v39, v39, v47
v_lshlrev_b32 v40, 16, v176
v_and_b32 v41, 0xffff0000, v176
v_lshlrev_b32 v42, 16, v177
v_and_b32 v43, 0xffff0000, v177
v_lshlrev_b32 v44, 16, v178
v_and_b32 v45, 0xffff0000, v178
v_lshlrev_b32 v46, 16, v179
v_and_b32 v47, 0xffff0000, v179
s_mov_b32 s43, 1261568
buffer_load_dwordx4 v[176:179], v4, s[64:67], s43 offen
v_add_f32 v32, v32, v40
v_add_f32 v33, v33, v41
v_add_f32 v34, v34, v42
v_add_f32 v35, v35, v43
v_add_f32 v36, v36, v44
v_add_f32 v37, v37, v45
v_add_f32 v38, v38, v46
v_add_f32 v39, v39, v47
v_lshlrev_b32 v40, 16, v180
v_and_b32 v41, 0xffff0000, v180
v_lshlrev_b32 v42, 16, v181
v_and_b32 v43, 0xffff0000, v181
v_lshlrev_b32 v44, 16, v182
v_and_b32 v45, 0xffff0000, v182
v_lshlrev_b32 v46, 16, v183
v_and_b32 v47, 0xffff0000, v183
s_mov_b32 s43, 1290240
buffer_load_dwordx4 v[180:183], v4, s[64:67], s43 offen
v_add_f32 v32, v32, v40
v_add_f32 v33, v33, v41
v_add_f32 v34, v34, v42
v_add_f32 v35, v35, v43
v_add_f32 v36, v36, v44
v_add_f32 v37, v37, v45
v_add_f32 v38, v38, v46
v_add_f32 v39, v39, v47
v_lshlrev_b32 v40, 16, v184
v_and_b32 v41, 0xffff0000, v184
v_lshlrev_b32 v42, 16, v185
v_and_b32 v43, 0xffff0000, v185
v_lshlrev_b32 v44, 16, v186
v_and_b32 v45, 0xffff0000, v186
v_lshlrev_b32 v46, 16, v187
v_and_b32 v47, 0xffff0000, v187
s_mov_b32 s43, 1318912
buffer_load_dwordx4 v[184:187], v4, s[64:67], s43 offen
v_add_f32 v32, v32, v40
v_add_f32 v33, v33, v41
v_add_f32 v34, v34, v42
v_add_f32 v35, v35, v43
v_add_f32 v36, v36, v44
v_add_f32 v37, v37, v45
v_add_f32 v38, v38, v46
v_add_f32 v39, v39, v47
v_lshlrev_b32 v40, 16, v188
v_and_b32 v41, 0xffff0000, v188
v_lshlrev_b32 v42, 16, v189
v_and_b32 v43, 0xffff0000, v189
v_lshlrev_b32 v44, 16, v190
v_and_b32 v45, 0xffff0000, v190
v_lshlrev_b32 v46, 16, v191
v_and_b32 v47, 0xffff0000, v191
s_mov_b32 s43, 1347584
buffer_load_dwordx4 v[188:191], v4, s[64:67], s43 offen
v_add_f32 v32, v32, v40
v_add_f32 v33, v33, v41
v_add_f32 v34, v34, v42
v_add_f32 v35, v35, v43
v_add_f32 v36, v36, v44
v_add_f32 v37, v37, v45
v_add_f32 v38, v38, v46
v_add_f32 v39, v39, v47
v_lshlrev_b32 v40, 16, v192
v_and_b32 v41, 0xffff0000, v192
v_lshlrev_b32 v42, 16, v193
v_and_b32 v43, 0xffff0000, v193
v_lshlrev_b32 v44, 16, v194
v_and_b32 v45, 0xffff0000, v194
v_lshlrev_b32 v46, 16, v195
v_and_b32 v47, 0xffff0000, v195
s_mov_b32 s43, 1376256
buffer_load_dwordx4 v[192:195], v4, s[64:67], s43 offen
v_add_f32 v32, v32, v40
v_add_f32 v33, v33, v41
v_add_f32 v34, v34, v42
v_add_f32 v35, v35, v43
v_add_f32 v36, v36, v44
v_add_f32 v37, v37, v45
v_add_f32 v38, v38, v46
v_add_f32 v39, v39, v47
v_lshlrev_b32 v40, 16, v196
v_and_b32 v41, 0xffff0000, v196
v_lshlrev_b32 v42, 16, v197
v_and_b32 v43, 0xffff0000, v197
v_lshlrev_b32 v44, 16, v198
v_and_b32 v45, 0xffff0000, v198
v_lshlrev_b32 v46, 16, v199
v_and_b32 v47, 0xffff0000, v199
s_mov_b32 s43, 1404928
buffer_load_dwordx4 v[196:199], v4, s[64:67], s43 offen
v_add_f32 v32, v32, v40
v_add_f32 v33, v33, v41
v_add_f32 v34, v34, v42
v_add_f32 v35, v35, v43
v_add_f32 v36, v36, v44
v_add_f32 v37, v37, v45
v_add_f32 v38, v38, v46
v_add_f32 v39, v39, v47
v_lshlrev_b32 v40, 16, v200
v_and_b32 v41, 0xffff0000, v200
v_lshlrev_b32 v42, 16, v201
v_and_b32 v43, 0xffff0000, v201
v_lshlrev_b32 v44, 16, v202
v_and_b32 v45, 0xffff0000, v202
v_lshlrev_b32 v46, 16, v203
v_and_b32 v47, 0xffff0000, v203
s_mov_b32 s43, 1433600
buffer_load_dwordx4 v[200:203], v4, s[64:67], s43 offen
v_add_f32 v32, v32, v40
v_add_f32 v33, v33, v41
v_add_f32 v34, v34, v42
v_add_f32 v35, v35, v43
v_add_f32 v36, v36, v44
v_add_f32 v37, v37, v45
v_add_f32 v38, v38, v46
v_add_f32 v39, v39, v47
v_lshlrev_b32 v40, 16, v204
v_and_b32 v41, 0xffff0000, v204
v_lshlrev_b32 v42, 16, v205
v_and_b32 v43, 0xffff0000, v205
v_lshlrev_b32 v44, 16, v206
v_and_b32 v45, 0xffff0000, v206
v_lshlrev_b32 v46, 16, v207
v_and_b32 v47, 0xffff0000, v207
s_mov_b32 s43, 1462272
buffer_load_dwordx4 v[204:207], v4, s[64:67], s43 offen
v_add_f32 v32, v32, v40
v_add_f32 v33, v33, v41
v_add_f32 v34, v34, v42
v_add_f32 v35, v35, v43
v_add_f32 v36, v36, v44
v_add_f32 v37, v37, v45
v_add_f32 v38, v38, v46
v_add_f32 v39, v39, v47
v_lshlrev_b32 v40, 16, v208
v_and_b32 v41, 0xffff0000, v208
v_lshlrev_b32 v42, 16, v209
v_and_b32 v43, 0xffff0000, v209
v_lshlrev_b32 v44, 16, v210
v_and_b32 v45, 0xffff0000, v210
v_lshlrev_b32 v46, 16, v211
v_and_b32 v47, 0xffff0000, v211
s_mov_b32 s43, 1490944
buffer_load_dwordx4 v[208:211], v4, s[64:67], s43 offen
v_add_f32 v32, v32, v40
v_add_f32 v33, v33, v41
v_add_f32 v34, v34, v42
v_add_f32 v35, v35, v43
v_add_f32 v36, v36, v44
v_add_f32 v37, v37, v45
v_add_f32 v38, v38, v46
v_add_f32 v39, v39, v47
v_lshlrev_b32 v40, 16, v212
v_and_b32 v41, 0xffff0000, v212
v_lshlrev_b32 v42, 16, v213
v_and_b32 v43, 0xffff0000, v213
v_lshlrev_b32 v44, 16, v214
v_and_b32 v45, 0xffff0000, v214
v_lshlrev_b32 v46, 16, v215
v_and_b32 v47, 0xffff0000, v215
s_mov_b32 s43, 1519616
buffer_load_dwordx4 v[212:215], v4, s[64:67], s43 offen
v_add_f32 v32, v32, v40
v_add_f32 v33, v33, v41
v_add_f32 v34, v34, v42
v_add_f32 v35, v35, v43
v_add_f32 v36, v36, v44
v_add_f32 v37, v37, v45
v_add_f32 v38, v38, v46
v_add_f32 v39, v39, v47
v_lshlrev_b32 v40, 16, v216
v_and_b32 v41, 0xffff0000, v216
v_lshlrev_b32 v42, 16, v217
v_and_b32 v43, 0xffff0000, v217
v_lshlrev_b32 v44, 16, v218
v_and_b32 v45, 0xffff0000, v218
v_lshlrev_b32 v46, 16, v219
v_and_b32 v47, 0xffff0000, v219
s_mov_b32 s43, 1548288
buffer_load_dwordx4 v[216:219], v4, s[64:67], s43 offen
v_add_f32 v32, v32, v40
v_add_f32 v33, v33, v41
v_add_f32 v34, v34, v42
v_add_f32 v35, v35, v43
v_add_f32 v36, v36, v44
v_add_f32 v37, v37, v45
v_add_f32 v38, v38, v46
v_add_f32 v39, v39, v47
v_lshlrev_b32 v40, 16, v220
v_and_b32 v41, 0xffff0000, v220
v_lshlrev_b32 v42, 16, v221
v_and_b32 v43, 0xffff0000, v221
v_lshlrev_b32 v44, 16, v222
v_and_b32 v45, 0xffff0000, v222
v_lshlrev_b32 v46, 16, v223
v_and_b32 v47, 0xffff0000, v223
s_mov_b32 s43, 1576960
buffer_load_dwordx4 v[220:223], v4, s[64:67], s43 offen
v_add_f32 v32, v32, v40
v_add_f32 v33, v33, v41
v_add_f32 v34, v34, v42
v_add_f32 v35, v35, v43
v_add_f32 v36, v36, v44
v_add_f32 v37, v37, v45
v_add_f32 v38, v38, v46
v_add_f32 v39, v39, v47
v_lshlrev_b32 v40, 16, v224
v_and_b32 v41, 0xffff0000, v224
v_lshlrev_b32 v42, 16, v225
v_and_b32 v43, 0xffff0000, v225
v_lshlrev_b32 v44, 16, v226
v_and_b32 v45, 0xffff0000, v226
v_lshlrev_b32 v46, 16, v227
v_and_b32 v47, 0xffff0000, v227
s_mov_b32 s43, 1605632
buffer_load_dwordx4 v[224:227], v4, s[64:67], s43 offen
v_add_f32 v32, v32, v40
v_add_f32 v33, v33, v41
v_add_f32 v34, v34, v42
v_add_f32 v35, v35, v43
v_add_f32 v36, v36, v44
v_add_f32 v37, v37, v45
v_add_f32 v38, v38, v46
v_add_f32 v39, v39, v47
v_lshlrev_b32 v40, 16, v228
v_and_b32 v41, 0xffff0000, v228
v_lshlrev_b32 v42, 16, v229
v_and_b32 v43, 0xffff0000, v229
v_lshlrev_b32 v44, 16, v230
v_and_b32 v45, 0xffff0000, v230
v_lshlrev_b32 v46, 16, v231
v_and_b32 v47, 0xffff0000, v231
s_mov_b32 s43, 1634304
buffer_load_dwordx4 v[228:231], v4, s[64:67], s43 offen
v_add_f32 v32, v32, v40
v_add_f32 v33, v33, v41
v_add_f32 v34, v34, v42
v_add_f32 v35, v35, v43
v_add_f32 v36, v36, v44
v_add_f32 v37, v37, v45
v_add_f32 v38, v38, v46
v_add_f32 v39, v39, v47
v_lshlrev_b32 v40, 16, v232
v_and_b32 v41, 0xffff0000, v232
v_lshlrev_b32 v42, 16, v233
v_and_b32 v43, 0xffff0000, v233
v_lshlrev_b32 v44, 16, v234
v_and_b32 v45, 0xffff0000, v234
v_lshlrev_b32 v46, 16, v235
v_and_b32 v47, 0xffff0000, v235
s_mov_b32 s43, 1662976
buffer_load_dwordx4 v[232:235], v4, s[64:67], s43 offen
v_add_f32 v32, v32, v40
v_add_f32 v33, v33, v41
v_add_f32 v34, v34, v42
v_add_f32 v35, v35, v43
v_add_f32 v36, v36, v44
v_add_f32 v37, v37, v45
v_add_f32 v38, v38, v46
v_add_f32 v39, v39, v47
v_lshlrev_b32 v40, 16, v236
v_and_b32 v41, 0xffff0000, v236
v_lshlrev_b32 v42, 16, v237
v_and_b32 v43, 0xffff0000, v237
v_lshlrev_b32 v44, 16, v238
v_and_b32 v45, 0xffff0000, v238
v_lshlrev_b32 v46, 16, v239
v_and_b32 v47, 0xffff0000, v239
s_mov_b32 s43, 1691648
buffer_load_dwordx4 v[236:239], v4, s[64:67], s43 offen
v_add_f32 v32, v32, v40
v_add_f32 v33, v33, v41
v_add_f32 v34, v34, v42
v_add_f32 v35, v35, v43
v_add_f32 v36, v36, v44
v_add_f32 v37, v37, v45
v_add_f32 v38, v38, v46
v_add_f32 v39, v39, v47
v_lshlrev_b32 v40, 16, v240
v_and_b32 v41, 0xffff0000, v240
v_lshlrev_b32 v42, 16, v241
v_and_b32 v43, 0xffff0000, v241
v_lshlrev_b32 v44, 16, v242
v_and_b32 v45, 0xffff0000, v242
v_lshlrev_b32 v46, 16, v243
v_and_b32 v47, 0xffff0000, v243
s_mov_b32 s43, 1720320
buffer_load_dwordx4 v[240:243], v4, s[64:67], s43 offen
v_add_f32 v32, v32, v40
v_add_f32 v33, v33, v41
v_add_f32 v34, v34, v42
v_add_f32 v35, v35, v43
v_add_f32 v36, v36, v44
v_add_f32 v37, v37, v45
v_add_f32 v38, v38, v46
v_add_f32 v39, v39, v47
v_lshlrev_b32 v40, 16, v244
v_and_b32 v41, 0xffff0000, v244
v_lshlrev_b32 v42, 16, v245
v_and_b32 v43, 0xffff0000, v245
v_lshlrev_b32 v44, 16, v246
v_and_b32 v45, 0xffff0000, v246
v_lshlrev_b32 v46, 16, v247
v_and_b32 v47, 0xffff0000, v247
s_mov_b32 s43, 1748992
buffer_load_dwordx4 v[244:247], v4, s[64:67], s43 offen
v_add_f32 v32, v32, v40
v_add_f32 v33, v33, v41
v_add_f32 v34, v34, v42
v_add_f32 v35, v35, v43
v_add_f32 v36, v36, v44
v_add_f32 v37, v37, v45
v_add_f32 v38, v38, v46
v_add_f32 v39, v39, v47
v_lshlrev_b32 v40, 16, v248
v_and_b32 v41, 0xffff0000, v248
v_lshlrev_b32 v42, 16, v249
v_and_b32 v43, 0xffff0000, v249
v_lshlrev_b32 v44, 16, v250
v_and_b32 v45, 0xffff0000, v250
v_lshlrev_b32 v46, 16, v251
v_and_b32 v47, 0xffff0000, v251
s_mov_b32 s43, 1777664
buffer_load_dwordx4 v[248:251], v4, s[64:67], s43 offen
v_add_f32 v32, v32, v40
v_add_f32 v33, v33, v41
v_add_f32 v34, v34, v42
v_add_f32 v35, v35, v43
v_add_f32 v36, v36, v44
v_add_f32 v37, v37, v45
v_add_f32 v38, v38, v46
v_add_f32 v39, v39, v47
v_lshlrev_b32 v40, 16, v252
v_and_b32 v41, 0xffff0000, v252
v_lshlrev_b32 v42, 16, v253
v_and_b32 v43, 0xffff0000, v253
v_lshlrev_b32 v44, 16, v254
v_and_b32 v45, 0xffff0000, v254
v_lshlrev_b32 v46, 16, v255
v_and_b32 v47, 0xffff0000, v255
s_mov_b32 s43, 1806336
buffer_load_dwordx4 v[252:255], v4, s[64:67], s43 offen
v_add_f32 v32, v32, v40
v_add_f32 v33, v33, v41
v_add_f32 v34, v34, v42
v_add_f32 v35, v35, v43
v_add_f32 v36, v36, v44
v_add_f32 v37, v37, v45
v_add_f32 v38, v38, v46
v_add_f32 v39, v39, v47
s_lshl_b32 s43, s34, 18
s_add_u32 s12, s32, s43
s_addc_u32 s13, s33, 0
s_mov_b32 s14, 262144
s_mov_b32 s15, 0x20000
v_lshlrev_b32 v21, 4, v1
s_lshl_b32 s54, s36, 11
s_barrier
s_add_u32 m0, s54, 0
s_add_u32 s43, s54, 0
buffer_load_dwordx4 v21, s[12:15], s43 offen sc1 lds
s_add_u32 m0, s54, 1024
s_add_u32 s43, s54, 1024
buffer_load_dwordx4 v21, s[12:15], s43 offen sc1 lds
s_add_u32 m0, s54, 24576
s_add_u32 s43, s54, 16384
buffer_load_dwordx4 v21, s[12:15], s43 offen sc1 lds
s_add_u32 m0, s54, 25600
s_add_u32 s43, s54, 17408
buffer_load_dwordx4 v21, s[12:15], s43 offen sc1 lds
s_waitcnt vmcnt(2)
s_barrier
s_waitcnt vmcnt(0)
s_barrier
s_barrier
s_barrier
s_barrier
s_barrier
s_barrier
s_barrier
s_barrier
s_barrier
s_barrier
s_barrier
s_barrier
s_barrier
s_barrier
s_barrier
s_barrier
s_barrier
s_mul_i32 s43, s2, 28672
s_add_u32 s76, s60, s43
s_addc_u32 s77, s61, 0
s_mov_b32 s78, 28672
s_mov_b32 s79, 0x20000
v_lshlrev_b32 v19, 7, v1
s_mov_b32 s43, 0
buffer_load_dword v30, v19, s[76:79], s43 offen
s_mov_b32 s43, 8192
buffer_load_dword v30, v19, s[76:79], s43 offen
s_mov_b32 s43, 16384
buffer_load_dword v30, v19, s[76:79], s43 offen
s_mov_b32 s43, 24576
buffer_load_dword v30, v19, s[76:79], s43 offen
v_lshlrev_b32 v40, 16, v128
v_and_b32 v41, 0xffff0000, v128
v_lshlrev_b32 v42, 16, v129
v_and_b32 v43, 0xffff0000, v129
v_lshlrev_b32 v44, 16, v130
v_and_b32 v45, 0xffff0000, v130
v_lshlrev_b32 v46, 16, v131
v_and_b32 v47, 0xffff0000, v131
v_add_f32 v32, v32, v40
v_add_f32 v33, v33, v41
v_add_f32 v34, v34, v42
v_add_f32 v35, v35, v43
v_add_f32 v36, v36, v44
v_add_f32 v37, v37, v45
v_add_f32 v38, v38, v46
v_add_f32 v39, v39, v47
v_lshlrev_b32 v40, 16, v132
v_and_b32 v41, 0xffff0000, v132
v_lshlrev_b32 v42, 16, v133
v_and_b32 v43, 0xffff0000, v133
v_lshlrev_b32 v44, 16, v134
v_and_b32 v45, 0xffff0000, v134
v_lshlrev_b32 v46, 16, v135
v_and_b32 v47, 0xffff0000, v135
v_add_f32 v32, v32, v40
v_add_f32 v33, v33, v41
v_add_f32 v34, v34, v42
v_add_f32 v35, v35, v43
v_add_f32 v36, v36, v44
v_add_f32 v37, v37, v45
v_add_f32 v38, v38, v46
v_add_f32 v39, v39, v47
v_lshlrev_b32 v40, 16, v136
v_and_b32 v41, 0xffff0000, v136
v_lshlrev_b32 v42, 16, v137
v_and_b32 v43, 0xffff0000, v137
v_lshlrev_b32 v44, 16, v138
v_and_b32 v45, 0xffff0000, v138
v_lshlrev_b32 v46, 16, v139
v_and_b32 v47, 0xffff0000, v139
v_add_f32 v32, v32, v40
v_add_f32 v33, v33, v41
v_add_f32 v34, v34, v42
v_add_f32 v35, v35, v43
v_add_f32 v36, v36, v44
v_add_f32 v37, v37, v45
v_add_f32 v38, v38, v46
v_add_f32 v39, v39, v47
v_lshlrev_b32 v40, 16, v140
v_and_b32 v41, 0xffff0000, v140
v_lshlrev_b32 v42, 16, v141
v_and_b32 v43, 0xffff0000, v141
v_lshlrev_b32 v44, 16, v142
v_and_b32 v45, 0xffff0000, v142
v_lshlrev_b32 v46, 16, v143
v_and_b32 v47, 0xffff0000, v143
v_add_f32 v32, v32, v40
v_add_f32 v33, v33, v41
v_add_f32 v34, v34, v42
v_add_f32 v35, v35, v43
v_add_f32 v36, v36, v44
v_add_f32 v37, v37, v45
v_add_f32 v38, v38, v46
v_add_f32 v39, v39, v47
v_lshlrev_b32 v40, 16, v144
v_and_b32 v41, 0xffff0000, v144
v_lshlrev_b32 v42, 16, v145
v_and_b32 v43, 0xffff0000, v145
v_lshlrev_b32 v44, 16, v146
v_and_b32 v45, 0xffff0000, v146
v_lshlrev_b32 v46, 16, v147
v_and_b32 v47, 0xffff0000, v147
v_add_f32 v32, v32, v40
v_add_f32 v33, v33, v41
v_add_f32 v34, v34, v42
v_add_f32 v35, v35, v43
v_add_f32 v36, v36, v44
v_add_f32 v37, v37, v45
v_add_f32 v38, v38, v46
v_add_f32 v39, v39, v47
v_lshlrev_b32 v40, 16, v148
v_and_b32 v41, 0xffff0000, v148
v_lshlrev_b32 v42, 16, v149
v_and_b32 v43, 0xffff0000, v149
v_lshlrev_b32 v44, 16, v150
v_and_b32 v45, 0xffff0000, v150
v_lshlrev_b32 v46, 16, v151
v_and_b32 v47, 0xffff0000, v151
v_add_f32 v32, v32, v40
v_add_f32 v33, v33, v41
v_add_f32 v34, v34, v42
v_add_f32 v35, v35, v43
v_add_f32 v36, v36, v44
v_add_f32 v37, v37, v45
v_add_f32 v38, v38, v46
v_add_f32 v39, v39, v47
v_lshlrev_b32 v40, 16, v152
v_and_b32 v41, 0xffff0000, v152
v_lshlrev_b32 v42, 16, v153
v_and_b32 v43, 0xffff0000, v153
v_lshlrev_b32 v44, 16, v154
v_and_b32 v45, 0xffff0000, v154
v_lshlrev_b32 v46, 16, v155
v_and_b32 v47, 0xffff0000, v155
v_add_f32 v32, v32, v40
v_add_f32 v33, v33, v41
v_add_f32 v34, v34, v42
v_add_f32 v35, v35, v43
v_add_f32 v36, v36, v44
v_add_f32 v37, v37, v45
v_add_f32 v38, v38, v46
v_add_f32 v39, v39, v47
v_lshlrev_b32 v40, 16, v156
v_and_b32 v41, 0xffff0000, v156
v_lshlrev_b32 v42, 16, v157
v_and_b32 v43, 0xffff0000, v157
v_lshlrev_b32 v44, 16, v158
v_and_b32 v45, 0xffff0000, v158
v_lshlrev_b32 v46, 16, v159
v_and_b32 v47, 0xffff0000, v159
v_add_f32 v32, v32, v40
v_add_f32 v33, v33, v41
v_add_f32 v34, v34, v42
v_add_f32 v35, v35, v43
v_add_f32 v36, v36, v44
v_add_f32 v37, v37, v45
v_add_f32 v38, v38, v46
v_add_f32 v39, v39, v47
v_lshlrev_b32 v40, 16, v160
v_and_b32 v41, 0xffff0000, v160
v_lshlrev_b32 v42, 16, v161
v_and_b32 v43, 0xffff0000, v161
v_lshlrev_b32 v44, 16, v162
v_and_b32 v45, 0xffff0000, v162
v_lshlrev_b32 v46, 16, v163
v_and_b32 v47, 0xffff0000, v163
v_add_f32 v32, v32, v40
v_add_f32 v33, v33, v41
v_add_f32 v34, v34, v42
v_add_f32 v35, v35, v43
v_add_f32 v36, v36, v44
v_add_f32 v37, v37, v45
v_add_f32 v38, v38, v46
v_add_f32 v39, v39, v47
v_lshlrev_b32 v40, 16, v164
v_and_b32 v41, 0xffff0000, v164
v_lshlrev_b32 v42, 16, v165
v_and_b32 v43, 0xffff0000, v165
v_lshlrev_b32 v44, 16, v166
v_and_b32 v45, 0xffff0000, v166
v_lshlrev_b32 v46, 16, v167
v_and_b32 v47, 0xffff0000, v167
v_add_f32 v32, v32, v40
v_add_f32 v33, v33, v41
v_add_f32 v34, v34, v42
v_add_f32 v35, v35, v43
v_add_f32 v36, v36, v44
v_add_f32 v37, v37, v45
v_add_f32 v38, v38, v46
v_add_f32 v39, v39, v47
v_lshlrev_b32 v40, 16, v168
v_and_b32 v41, 0xffff0000, v168
v_lshlrev_b32 v42, 16, v169
v_and_b32 v43, 0xffff0000, v169
v_lshlrev_b32 v44, 16, v170
v_and_b32 v45, 0xffff0000, v170
v_lshlrev_b32 v46, 16, v171
v_and_b32 v47, 0xffff0000, v171
v_add_f32 v32, v32, v40
v_add_f32 v33, v33, v41
v_add_f32 v34, v34, v42
v_add_f32 v35, v35, v43
v_add_f32 v36, v36, v44
v_add_f32 v37, v37, v45
v_add_f32 v38, v38, v46
v_add_f32 v39, v39, v47
v_lshlrev_b32 v40, 16, v172
v_and_b32 v41, 0xffff0000, v172
v_lshlrev_b32 v42, 16, v173
v_and_b32 v43, 0xffff0000, v173
v_lshlrev_b32 v44, 16, v174
v_and_b32 v45, 0xffff0000, v174
v_lshlrev_b32 v46, 16, v175
v_and_b32 v47, 0xffff0000, v175
v_add_f32 v32, v32, v40
v_add_f32 v33, v33, v41
v_add_f32 v34, v34, v42
v_add_f32 v35, v35, v43
v_add_f32 v36, v36, v44
v_add_f32 v37, v37, v45
v_add_f32 v38, v38, v46
v_add_f32 v39, v39, v47
v_lshlrev_b32 v40, 16, v176
v_and_b32 v41, 0xffff0000, v176
v_lshlrev_b32 v42, 16, v177
v_and_b32 v43, 0xffff0000, v177
v_lshlrev_b32 v44, 16, v178
v_and_b32 v45, 0xffff0000, v178
v_lshlrev_b32 v46, 16, v179
v_and_b32 v47, 0xffff0000, v179
v_add_f32 v32, v32, v40
v_add_f32 v33, v33, v41
v_add_f32 v34, v34, v42
v_add_f32 v35, v35, v43
v_add_f32 v36, v36, v44
v_add_f32 v37, v37, v45
v_add_f32 v38, v38, v46
v_add_f32 v39, v39, v47
v_lshlrev_b32 v40, 16, v180
v_and_b32 v41, 0xffff0000, v180
v_lshlrev_b32 v42, 16, v181
v_and_b32 v43, 0xffff0000, v181
v_lshlrev_b32 v44, 16, v182
v_and_b32 v45, 0xffff0000, v182
v_lshlrev_b32 v46, 16, v183
v_and_b32 v47, 0xffff0000, v183
v_add_f32 v32, v32, v40
v_add_f32 v33, v33, v41
v_add_f32 v34, v34, v42
v_add_f32 v35, v35, v43
v_add_f32 v36, v36, v44
v_add_f32 v37, v37, v45
v_add_f32 v38, v38, v46
v_add_f32 v39, v39, v47
v_lshlrev_b32 v40, 16, v184
v_and_b32 v41, 0xffff0000, v184
v_lshlrev_b32 v42, 16, v185
v_and_b32 v43, 0xffff0000, v185
v_lshlrev_b32 v44, 16, v186
v_and_b32 v45, 0xffff0000, v186
v_lshlrev_b32 v46, 16, v187
v_and_b32 v47, 0xffff0000, v187
v_add_f32 v32, v32, v40
v_add_f32 v33, v33, v41
v_add_f32 v34, v34, v42
v_add_f32 v35, v35, v43
v_add_f32 v36, v36, v44
v_add_f32 v37, v37, v45
v_add_f32 v38, v38, v46
v_add_f32 v39, v39, v47
v_lshlrev_b32 v40, 16, v188
v_and_b32 v41, 0xffff0000, v188
v_lshlrev_b32 v42, 16, v189
v_and_b32 v43, 0xffff0000, v189
v_lshlrev_b32 v44, 16, v190
v_and_b32 v45, 0xffff0000, v190
v_lshlrev_b32 v46, 16, v191
v_and_b32 v47, 0xffff0000, v191
v_add_f32 v32, v32, v40
v_add_f32 v33, v33, v41
v_add_f32 v34, v34, v42
v_add_f32 v35, v35, v43
v_add_f32 v36, v36, v44
v_add_f32 v37, v37, v45
v_add_f32 v38, v38, v46
v_add_f32 v39, v39, v47
v_lshlrev_b32 v40, 16, v192
v_and_b32 v41, 0xffff0000, v192
v_lshlrev_b32 v42, 16, v193
v_and_b32 v43, 0xffff0000, v193
v_lshlrev_b32 v44, 16, v194
v_and_b32 v45, 0xffff0000, v194
v_lshlrev_b32 v46, 16, v195
v_and_b32 v47, 0xffff0000, v195
v_add_f32 v32, v32, v40
v_add_f32 v33, v33, v41
v_add_f32 v34, v34, v42
v_add_f32 v35, v35, v43
v_add_f32 v36, v36, v44
v_add_f32 v37, v37, v45
v_add_f32 v38, v38, v46
v_add_f32 v39, v39, v47
v_lshlrev_b32 v40, 16, v196
v_and_b32 v41, 0xffff0000, v196
v_lshlrev_b32 v42, 16, v197
v_and_b32 v43, 0xffff0000, v197
v_lshlrev_b32 v44, 16, v198
v_and_b32 v45, 0xffff0000, v198
v_lshlrev_b32 v46, 16, v199
v_and_b32 v47, 0xffff0000, v199
v_add_f32 v32, v32, v40
v_add_f32 v33, v33, v41
v_add_f32 v34, v34, v42
v_add_f32 v35, v35, v43
v_add_f32 v36, v36, v44
v_add_f32 v37, v37, v45
v_add_f32 v38, v38, v46
v_add_f32 v39, v39, v47
v_lshlrev_b32 v40, 16, v200
v_and_b32 v41, 0xffff0000, v200
v_lshlrev_b32 v42, 16, v201
v_and_b32 v43, 0xffff0000, v201
v_lshlrev_b32 v44, 16, v202
v_and_b32 v45, 0xffff0000, v202
v_lshlrev_b32 v46, 16, v203
v_and_b32 v47, 0xffff0000, v203
v_add_f32 v32, v32, v40
v_add_f32 v33, v33, v41
v_add_f32 v34, v34, v42
v_add_f32 v35, v35, v43
v_add_f32 v36, v36, v44
v_add_f32 v37, v37, v45
v_add_f32 v38, v38, v46
v_add_f32 v39, v39, v47
v_lshlrev_b32 v40, 16, v204
v_and_b32 v41, 0xffff0000, v204
v_lshlrev_b32 v42, 16, v205
v_and_b32 v43, 0xffff0000, v205
v_lshlrev_b32 v44, 16, v206
v_and_b32 v45, 0xffff0000, v206
v_lshlrev_b32 v46, 16, v207
v_and_b32 v47, 0xffff0000, v207
v_add_f32 v32, v32, v40
v_add_f32 v33, v33, v41
v_add_f32 v34, v34, v42
v_add_f32 v35, v35, v43
v_add_f32 v36, v36, v44
v_add_f32 v37, v37, v45
v_add_f32 v38, v38, v46
v_add_f32 v39, v39, v47
v_lshlrev_b32 v40, 16, v208
v_and_b32 v41, 0xffff0000, v208
v_lshlrev_b32 v42, 16, v209
v_and_b32 v43, 0xffff0000, v209
v_lshlrev_b32 v44, 16, v210
v_and_b32 v45, 0xffff0000, v210
v_lshlrev_b32 v46, 16, v211
v_and_b32 v47, 0xffff0000, v211
v_add_f32 v32, v32, v40
v_add_f32 v33, v33, v41
v_add_f32 v34, v34, v42
v_add_f32 v35, v35, v43
v_add_f32 v36, v36, v44
v_add_f32 v37, v37, v45
v_add_f32 v38, v38, v46
v_add_f32 v39, v39, v47
v_lshlrev_b32 v40, 16, v212
v_and_b32 v41, 0xffff0000, v212
v_lshlrev_b32 v42, 16, v213
v_and_b32 v43, 0xffff0000, v213
v_lshlrev_b32 v44, 16, v214
v_and_b32 v45, 0xffff0000, v214
v_lshlrev_b32 v46, 16, v215
v_and_b32 v47, 0xffff0000, v215
v_add_f32 v32, v32, v40
v_add_f32 v33, v33, v41
v_add_f32 v34, v34, v42
v_add_f32 v35, v35, v43
v_add_f32 v36, v36, v44
v_add_f32 v37, v37, v45
v_add_f32 v38, v38, v46
v_add_f32 v39, v39, v47
v_lshlrev_b32 v40, 16, v216
v_and_b32 v41, 0xffff0000, v216
v_lshlrev_b32 v42, 16, v217
v_and_b32 v43, 0xffff0000, v217
v_lshlrev_b32 v44, 16, v218
v_and_b32 v45, 0xffff0000, v218
v_lshlrev_b32 v46, 16, v219
v_and_b32 v47, 0xffff0000, v219
v_add_f32 v32, v32, v40
v_add_f32 v33, v33, v41
v_add_f32 v34, v34, v42
v_add_f32 v35, v35, v43
v_add_f32 v36, v36, v44
v_add_f32 v37, v37, v45
v_add_f32 v38, v38, v46
v_add_f32 v39, v39, v47
v_lshlrev_b32 v40, 16, v220
v_and_b32 v41, 0xffff0000, v220
v_lshlrev_b32 v42, 16, v221
v_and_b32 v43, 0xffff0000, v221
v_lshlrev_b32 v44, 16, v222
v_and_b32 v45, 0xffff0000, v222
v_lshlrev_b32 v46, 16, v223
v_and_b32 v47, 0xffff0000, v223
v_add_f32 v32, v32, v40
v_add_f32 v33, v33, v41
v_add_f32 v34, v34, v42
v_add_f32 v35, v35, v43
v_add_f32 v36, v36, v44
v_add_f32 v37, v37, v45
v_add_f32 v38, v38, v46
v_add_f32 v39, v39, v47
v_lshlrev_b32 v40, 16, v224
v_and_b32 v41, 0xffff0000, v224
v_lshlrev_b32 v42, 16, v225
v_and_b32 v43, 0xffff0000, v225
v_lshlrev_b32 v44, 16, v226
v_and_b32 v45, 0xffff0000, v226
v_lshlrev_b32 v46, 16, v227
v_and_b32 v47, 0xffff0000, v227
v_add_f32 v32, v32, v40
v_add_f32 v33, v33, v41
v_add_f32 v34, v34, v42
v_add_f32 v35, v35, v43
v_add_f32 v36, v36, v44
v_add_f32 v37, v37, v45
v_add_f32 v38, v38, v46
v_add_f32 v39, v39, v47
v_lshlrev_b32 v40, 16, v228
v_and_b32 v41, 0xffff0000, v228
v_lshlrev_b32 v42, 16, v229
v_and_b32 v43, 0xffff0000, v229
v_lshlrev_b32 v44, 16, v230
v_and_b32 v45, 0xffff0000, v230
v_lshlrev_b32 v46, 16, v231
v_and_b32 v47, 0xffff0000, v231
v_add_f32 v32, v32, v40
v_add_f32 v33, v33, v41
v_add_f32 v34, v34, v42
v_add_f32 v35, v35, v43
v_add_f32 v36, v36, v44
v_add_f32 v37, v37, v45
v_add_f32 v38, v38, v46
v_add_f32 v39, v39, v47
v_lshlrev_b32 v40, 16, v232
v_and_b32 v41, 0xffff0000, v232
v_lshlrev_b32 v42, 16, v233
v_and_b32 v43, 0xffff0000, v233
v_lshlrev_b32 v44, 16, v234
v_and_b32 v45, 0xffff0000, v234
v_lshlrev_b32 v46, 16, v235
v_and_b32 v47, 0xffff0000, v235
v_add_f32 v32, v32, v40
v_add_f32 v33, v33, v41
v_add_f32 v34, v34, v42
v_add_f32 v35, v35, v43
v_add_f32 v36, v36, v44
v_add_f32 v37, v37, v45
v_add_f32 v38, v38, v46
v_add_f32 v39, v39, v47
v_lshlrev_b32 v40, 16, v236
v_and_b32 v41, 0xffff0000, v236
v_lshlrev_b32 v42, 16, v237
v_and_b32 v43, 0xffff0000, v237
v_lshlrev_b32 v44, 16, v238
v_and_b32 v45, 0xffff0000, v238
v_lshlrev_b32 v46, 16, v239
v_and_b32 v47, 0xffff0000, v239
v_add_f32 v32, v32, v40
v_add_f32 v33, v33, v41
v_add_f32 v34, v34, v42
v_add_f32 v35, v35, v43
v_add_f32 v36, v36, v44
v_add_f32 v37, v37, v45
v_add_f32 v38, v38, v46
v_add_f32 v39, v39, v47
v_lshlrev_b32 v40, 16, v240
v_and_b32 v41, 0xffff0000, v240
v_lshlrev_b32 v42, 16, v241
v_and_b32 v43, 0xffff0000, v241
v_lshlrev_b32 v44, 16, v242
v_and_b32 v45, 0xffff0000, v242
v_lshlrev_b32 v46, 16, v243
v_and_b32 v47, 0xffff0000, v243
v_add_f32 v32, v32, v40
v_add_f32 v33, v33, v41
v_add_f32 v34, v34, v42
v_add_f32 v35, v35, v43
v_add_f32 v36, v36, v44
v_add_f32 v37, v37, v45
v_add_f32 v38, v38, v46
v_add_f32 v39, v39, v47
v_lshlrev_b32 v40, 16, v244
v_and_b32 v41, 0xffff0000, v244
v_lshlrev_b32 v42, 16, v245
v_and_b32 v43, 0xffff0000, v245
v_lshlrev_b32 v44, 16, v246
v_and_b32 v45, 0xffff0000, v246
v_lshlrev_b32 v46, 16, v247
v_and_b32 v47, 0xffff0000, v247
v_add_f32 v32, v32, v40
v_add_f32 v33, v33, v41
v_add_f32 v34, v34, v42
v_add_f32 v35, v35, v43
v_add_f32 v36, v36, v44
v_add_f32 v37, v37, v45
v_add_f32 v38, v38, v46
v_add_f32 v39, v39, v47
v_lshlrev_b32 v40, 16, v248
v_and_b32 v41, 0xffff0000, v248
v_lshlrev_b32 v42, 16, v249
v_and_b32 v43, 0xffff0000, v249
v_lshlrev_b32 v44, 16, v250
v_and_b32 v45, 0xffff0000, v250
v_lshlrev_b32 v46, 16, v251
v_and_b32 v47, 0xffff0000, v251
v_add_f32 v32, v32, v40
v_add_f32 v33, v33, v41
v_add_f32 v34, v34, v42
v_add_f32 v35, v35, v43
v_add_f32 v36, v36, v44
v_add_f32 v37, v37, v45
v_add_f32 v38, v38, v46
v_add_f32 v39, v39, v47
v_lshlrev_b32 v40, 16, v252
v_and_b32 v41, 0xffff0000, v252
v_lshlrev_b32 v42, 16, v253
v_and_b32 v43, 0xffff0000, v253
v_lshlrev_b32 v44, 16, v254
v_and_b32 v45, 0xffff0000, v254
v_lshlrev_b32 v46, 16, v255
v_and_b32 v47, 0xffff0000, v255
v_add_f32 v32, v32, v40
v_add_f32 v33, v33, v41
v_add_f32 v34, v34, v42
v_add_f32 v35, v35, v43
v_add_f32 v36, v36, v44
v_add_f32 v37, v37, v45
v_add_f32 v38, v38, v46
v_add_f32 v39, v39, v47
v_mov_b32 v40, v32
v_mov_b32 v41, v33
v_mov_b32 v42, v34
v_mov_b32 v43, v35
v_mov_b32 v44, v36
v_mov_b32 v45, v37
v_mov_b32 v46, v38
v_mov_b32 v47, v39
s_nop 0
v_permlane16_swap_b32 v32, v40
v_permlane16_swap_b32 v33, v41
v_permlane16_swap_b32 v34, v42
v_permlane16_swap_b32 v35, v43
v_permlane16_swap_b32 v36, v44
v_permlane16_swap_b32 v37, v45
v_permlane16_swap_b32 v38, v46
v_permlane16_swap_b32 v39, v47
v_add_f32 v32, v32, v40
v_add_f32 v33, v33, v41
v_add_f32 v34, v34, v42
v_add_f32 v35, v35, v43
v_add_f32 v36, v36, v44
v_add_f32 v37, v37, v45
v_add_f32 v38, v38, v46
v_add_f32 v39, v39, v47
v_mov_b32 v40, v32
v_mov_b32 v41, v33
v_mov_b32 v42, v34
v_mov_b32 v43, v35
v_mov_b32 v44, v36
v_mov_b32 v45, v37
v_mov_b32 v46, v38
v_mov_b32 v47, v39
s_nop 0
v_permlane32_swap_b32 v32, v40
v_permlane32_swap_b32 v33, v41
v_permlane32_swap_b32 v34, v42
v_permlane32_swap_b32 v35, v43
v_permlane32_swap_b32 v36, v44
v_permlane32_swap_b32 v37, v45
v_permlane32_swap_b32 v38, v46
v_permlane32_swap_b32 v39, v47
v_add_f32 v32, v32, v40
v_add_f32 v33, v33, v41
v_add_f32 v34, v34, v42
v_add_f32 v35, v35, v43
v_add_f32 v36, v36, v44
v_add_f32 v37, v37, v45
v_add_f32 v38, v38, v46
v_add_f32 v39, v39, v47
s_mov_b64 exec, 0xffff
buffer_store_dwordx4 v[32:35], v5, s[72:75], 0 offen sc1
buffer_store_dwordx4 v[36:39], v5, s[72:75], 0 offen offset:16 sc1
s_mov_b64 exec, -1
s_waitcnt vmcnt(0)
v_mov_b32 v12, 10240
v_mov_b32 v13, 1
s_mov_b64 exec, 1
buffer_atomic_add v13, v12, s[56:59], 0 offen sc1
s_mov_b64 exec, -1
s_branch Lcsd_37
Lnojob_36:
s_lshl_b32 s43, s34, 18
s_add_u32 s12, s32, s43
s_addc_u32 s13, s33, 0
s_mov_b32 s14, 262144
s_mov_b32 s15, 0x20000
v_lshlrev_b32 v21, 4, v1
s_lshl_b32 s54, s36, 11
s_barrier
s_add_u32 m0, s54, 0
s_add_u32 s43, s54, 0
buffer_load_dwordx4 v21, s[12:15], s43 offen sc1 lds
s_add_u32 m0, s54, 1024
s_add_u32 s43, s54, 1024
buffer_load_dwordx4 v21, s[12:15], s43 offen sc1 lds
s_add_u32 m0, s54, 24576
s_add_u32 s43, s54, 16384
buffer_load_dwordx4 v21, s[12:15], s43 offen sc1 lds
s_add_u32 m0, s54, 25600
s_add_u32 s43, s54, 17408
buffer_load_dwordx4 v21, s[12:15], s43 offen sc1 lds
s_waitcnt vmcnt(2)
s_barrier
s_waitcnt vmcnt(0)
s_barrier
s_barrier
s_barrier
s_barrier
s_barrier
s_barrier
s_barrier
s_barrier
s_barrier
s_barrier
s_barrier
s_barrier
s_barrier
s_barrier
s_barrier
s_barrier
s_barrier
s_mul_i32 s43, s2, 28672
s_add_u32 s76, s60, s43
s_addc_u32 s77, s61, 0
s_mov_b32 s78, 28672
s_mov_b32 s79, 0x20000
v_lshlrev_b32 v19, 7, v1
s_mov_b32 s43, 0
buffer_load_dword v30, v19, s[76:79], s43 offen
s_mov_b32 s43, 8192
buffer_load_dword v30, v19, s[76:79], s43 offen
s_mov_b32 s43, 16384
buffer_load_dword v30, v19, s[76:79], s43 offen
s_mov_b32 s43, 24576
buffer_load_dword v30, v19, s[76:79], s43 offen
Lcsd_37:
s_mov_b32 s46, 1
s_lshl_b32 s43, s34, 18
s_add_u32 s12, s32, s43
s_addc_u32 s13, s33, 0
s_add_u32 s12, s12, 4194304
s_addc_u32 s13, s13, 0
s_mov_b32 s14, 262144
s_mov_b32 s15, 0x20000
v_lshlrev_b32 v21, 4, v1
s_lshl_b32 s54, s36, 11
s_lshl_b32 s43, s34, 14
s_add_u32 s64, s32, s43
s_addc_u32 s65, s33, 0
s_add_u32 s64, s64, 25165824
s_addc_u32 s65, s65, 0
s_mov_b32 s66, 16384
s_mov_b32 s67, 0x20000
s_add_u32 s72, s32, 27262976
s_addc_u32 s73, s33, 0
s_mov_b32 s74, 114688
s_mov_b32 s75, 0x20000
s_barrier
s_add_u32 m0, s54, 98304
s_add_u32 s43, s54, 0
buffer_load_dwordx4 v21, s[12:15], s43 offen sc1 lds
s_add_u32 m0, s54, 99328
s_add_u32 s43, s54, 1024
buffer_load_dwordx4 v21, s[12:15], s43 offen sc1 lds
s_add_u32 m0, s54, 0
s_add_u32 s43, s54, 16384
buffer_load_dwordx4 v21, s[12:15], s43 offen sc1 lds
s_add_u32 m0, s54, 1024
s_add_u32 s43, s54, 17408
buffer_load_dwordx4 v21, s[12:15], s43 offen sc1 lds
s_add_u32 m0, s54, 49152
s_add_u32 s43, s54, 32768
buffer_load_dwordx4 v21, s[12:15], s43 offen sc1 lds
s_add_u32 m0, s54, 50176
s_add_u32 s43, s54, 33792
buffer_load_dwordx4 v21, s[12:15], s43 offen sc1 lds
s_waitcnt vmcnt(4)
s_barrier
s_waitcnt vmcnt(2)
s_barrier
s_waitcnt vmcnt(0)
s_barrier
s_mov_b32 s43, 0
buffer_load_dwordx4 v[128:131], v21, s[64:67], s43 offen sc1
s_mov_b32 s43, 1024
buffer_load_dwordx4 v[132:135], v21, s[64:67], s43 offen sc1
s_mov_b32 s43, 2048
buffer_load_dwordx4 v[136:139], v21, s[64:67], s43 offen sc1
s_mov_b32 s43, 3072
buffer_load_dwordx4 v[140:143], v21, s[64:67], s43 offen sc1
s_mov_b32 s43, 4096
buffer_load_dwordx4 v[144:147], v21, s[64:67], s43 offen sc1
s_mov_b32 s43, 5120
buffer_load_dwordx4 v[148:151], v21, s[64:67], s43 offen sc1
s_mov_b32 s43, 6144
buffer_load_dwordx4 v[152:155], v21, s[64:67], s43 offen sc1
s_mov_b32 s43, 7168
buffer_load_dwordx4 v[156:159], v21, s[64:67], s43 offen sc1
s_mov_b32 s43, 8192
buffer_load_dwordx4 v[160:163], v21, s[64:67], s43 offen sc1
s_mov_b32 s43, 9216
buffer_load_dwordx4 v[164:167], v21, s[64:67], s43 offen sc1
s_mov_b32 s43, 10240
buffer_load_dwordx4 v[168:171], v21, s[64:67], s43 offen sc1
s_mov_b32 s43, 11264
buffer_load_dwordx4 v[172:175], v21, s[64:67], s43 offen sc1
s_mov_b32 s43, 12288
buffer_load_dwordx4 v[176:179], v21, s[64:67], s43 offen sc1
s_mov_b32 s43, 13312
buffer_load_dwordx4 v[180:183], v21, s[64:67], s43 offen sc1
s_mov_b32 s43, 14336
buffer_load_dwordx4 v[184:187], v21, s[64:67], s43 offen sc1
s_mov_b32 s43, 15360
buffer_load_dwordx4 v[188:191], v21, s[64:67], s43 offen sc1
s_barrier
v_mov_b32 v12, 10240
v_mov_b32 v14, 224
buffer_load_dword v13, v12, s[56:59], 0 offen sc1
s_barrier
s_barrier
s_mov_b32 s41, 0x10000
Lpoll_38:
s_waitcnt vmcnt(0)
v_cmp_ne_u32 vcc, v14, v13
s_nop 4
s_cbranch_vccz Lpok_39
buffer_load_dword v13, v12, s[56:59], 0 offen sc1
s_sub_u32 s41, s41, 1
s_cmp_lg_u32 s41, 0
s_cbranch_scc1 Lpoll_38
s_waitcnt vmcnt(0)
Lpok_39:
v_min_u32 v12, 55, v1
v_lshlrev_b32 v13, 4, v12
s_lshl_b32 s43, s35, 9
s_mul_i32 s44, s35, 384
s_add_u32 s44, s44, 7680
v_mov_b32 v14, s44
v_mov_b32 v15, s43
v_cmp_gt_u32 vcc, 32, v12
s_nop 1
v_cndmask_b32 v14, v14, v15, vcc
v_add_u32 v14, v14, v13
v_add_u32 v13, 148480, v13
s_mov_b32 s43, 0
buffer_load_dwordx4 v[192:195], v14, s[72:75], s43 offen sc1
s_mov_b32 s43, 28672
buffer_load_dwordx4 v[196:199], v14, s[72:75], s43 offen sc1
s_mov_b32 s43, 57344
buffer_load_dwordx4 v[200:203], v14, s[72:75], s43 offen sc1
s_mov_b32 s43, 86016
buffer_load_dwordx4 v[204:207], v14, s[72:75], s43 offen sc1
s_mov_b32 s43, 14336
buffer_load_dwordx4 v[208:211], v14, s[72:75], s43 offen sc1
s_mov_b32 s43, 43008
buffer_load_dwordx4 v[212:215], v14, s[72:75], s43 offen sc1
s_mov_b32 s43, 71680
buffer_load_dwordx4 v[216:219], v14, s[72:75], s43 offen sc1
s_mov_b32 s43, 100352
buffer_load_dwordx4 v[220:223], v14, s[72:75], s43 offen sc1
s_barrier
v_add_f32 v128, v128, v132
v_add_f32 v129, v129, v133
v_add_f32 v130, v130, v134
v_add_f32 v131, v131, v135
v_add_f32 v128, v128, v136
v_add_f32 v129, v129, v137
v_add_f32 v130, v130, v138
v_add_f32 v131, v131, v139
v_add_f32 v128, v128, v140
v_add_f32 v129, v129, v141
v_add_f32 v130, v130, v142
v_add_f32 v131, v131, v143
v_add_f32 v128, v128, v144
v_add_f32 v129, v129, v145
v_add_f32 v130, v130, v146
v_add_f32 v131, v131, v147
v_add_f32 v128, v128, v148
v_add_f32 v129, v129, v149
v_add_f32 v130, v130, v150
v_add_f32 v131, v131, v151
v_add_f32 v128, v128, v152
v_add_f32 v129, v129, v153
v_add_f32 v130, v130, v154
v_add_f32 v131, v131, v155
v_add_f32 v128, v128, v156
v_add_f32 v129, v129, v157
v_add_f32 v130, v130, v158
v_add_f32 v131, v131, v159
v_add_f32 v128, v128, v160
v_add_f32 v129, v129, v161
v_add_f32 v130, v130, v162
v_add_f32 v131, v131, v163
v_add_f32 v128, v128, v164
v_add_f32 v129, v129, v165
v_add_f32 v130, v130, v166
v_add_f32 v131, v131, v167
v_add_f32 v128, v128, v168
v_add_f32 v129, v129, v169
v_add_f32 v130, v130, v170
v_add_f32 v131, v131, v171
v_add_f32 v128, v128, v172
v_add_f32 v129, v129, v173
v_add_f32 v130, v130, v174
v_add_f32 v131, v131, v175
v_add_f32 v128, v128, v176
v_add_f32 v129, v129, v177
v_add_f32 v130, v130, v178
v_add_f32 v131, v131, v179
v_add_f32 v128, v128, v180
v_add_f32 v129, v129, v181
v_add_f32 v130, v130, v182
v_add_f32 v131, v131, v183
v_add_f32 v128, v128, v184
v_add_f32 v129, v129, v185
v_add_f32 v130, v130, v186
v_add_f32 v131, v131, v187
v_add_f32 v128, v128, v188
v_add_f32 v129, v129, v189
v_add_f32 v130, v130, v190
v_add_f32 v131, v131, v191
v_mul_f32 v128, 0x3a800000, v128
v_mul_f32 v129, 0x3a800000, v129
v_fma_f32 v129, -v128, v128, v129
v_max_f32 v129, 0, v129
v_add_f32 v129, 0x3727c5ac, v129
v_rsq_f32 v129, v129
v_mul_f32 v130, 0x3a800000, v130
v_mul_f32 v131, 0x3a800000, v131
v_fma_f32 v131, -v130, v130, v131
v_max_f32 v131, 0, v131
v_add_f32 v131, 0x3727c5ac, v131
v_rsq_f32 v131, v131
v_add_u32 v19, 147456, v21
ds_write_b128 v19, v[128:131]
s_barrier
s_barrier
s_waitcnt vmcnt(0)
v_add_f32 v192, v192, v196
v_add_f32 v200, v200, v204
v_add_f32 v193, v193, v197
v_add_f32 v201, v201, v205
v_add_f32 v194, v194, v198
v_add_f32 v202, v202, v206
v_add_f32 v195, v195, v199
v_add_f32 v203, v203, v207
v_add_f32 v192, v192, v200
v_add_f32 v193, v193, v201
v_add_f32 v194, v194, v202
v_add_f32 v195, v195, v203
ds_write_b128 v13, v[192:195] offset:0
v_add_f32 v208, v208, v212
v_add_f32 v216, v216, v220
v_add_f32 v209, v209, v213
v_add_f32 v217, v217, v221
v_add_f32 v210, v210, v214
v_add_f32 v218, v218, v222
v_add_f32 v211, v211, v215
v_add_f32 v219, v219, v223
v_add_f32 v208, v208, v216
v_add_f32 v209, v209, v217
v_add_f32 v210, v210, v218
v_add_f32 v211, v211, v219
ds_write_b128 v13, v[208:211] offset:896
s_waitcnt lgkmcnt(0)
s_barrier
s_barrier
s_and_b32 s53, s35, 1
s_lshl_b32 s53, s53, 1
s_mul_i32 s43, s47, 3
s_add_u32 s53, s53, s43
v_lshlrev_b32 v19, 11, v18
v_lshl_add_u32 v19, v17, 4, v19
s_lshl_b32 s43, s46, 10
v_add_u32 v2, s43, v19
v_add_u32 v3, 49152, v2
v_add_u32 v4, 98304, v2
v_lshrrev_b32 v19, 2, v17
v_lshl_add_u32 v20, v18, 2, v19
v_and_b32 v21, 7, v20
v_lshlrev_b32 v20, 8, v20
v_and_b32 v19, 3, v1
v_lshl_add_u32 v20, v19, 3, v20
s_add_u32 s43, s53, 0
v_xor_b32 v19, s43, v21
v_lshl_add_u32 v5, v19, 5, v20
s_add_u32 s43, s53, 1
v_xor_b32 v19, s43, v21
v_lshl_add_u32 v6, v19, 5, v20
s_add_u32 s43, s53, 2
v_xor_b32 v19, s43, v21
v_lshl_add_u32 v7, v19, 5, v20
v_add_u32 v9, 49152, v5
v_add_u32 v10, 49152, v6
v_add_u32 v11, 49152, v7
v_add_u32 v13, 98304, v5
v_add_u32 v14, 98304, v6
v_add_u32 v15, 98304, v7
s_lshl_b32 s43, s46, 9
s_add_u32 s43, s43, 147456
v_lshl_add_u32 v19, v17, 3, s43
ds_read_b64 v[80:81], v19 offset:0
ds_read_b64 v[82:83], v19 offset:128
ds_read_b64 v[84:85], v19 offset:256
ds_read_b64 v[86:87], v19 offset:384
s_mul_i32 s43, s47, 192
s_add_u32 s43, s43, 148992
v_lshl_add_u32 v19, v18, 4, s43
ds_read_b128 v[48:51], v19 offset:0
ds_read_b128 v[52:55], v19 offset:64
ds_read_b128 v[56:59], v19 offset:128
ds_read_b128 v[60:63], v19 offset:896
ds_read_b128 v[64:67], v19 offset:960
ds_read_b128 v[68:71], v19 offset:1024
s_barrier
s_waitcnt lgkmcnt(0)
v_mul_f32 v88, v81, v81
v_mul_f32 v228, 0xc0135761, v81
v_mul_f32 v89, 0xbdd2d3e8, v81
v_rcp_f32 v236, v88
v_mul_f32 v232, v89, v88
v_mul_f32 v88, v83, v83
v_mul_f32 v229, 0xc0135761, v83
v_mul_f32 v89, 0xbdd2d3e8, v83
v_rcp_f32 v237, v88
v_mul_f32 v233, v89, v88
v_mul_f32 v88, v85, v85
v_mul_f32 v230, 0xc0135761, v85
v_mul_f32 v89, 0xbdd2d3e8, v85
v_rcp_f32 v238, v88
v_mul_f32 v234, v89, v88
v_mul_f32 v88, v87, v87
v_mul_f32 v231, 0xc0135761, v87
v_mul_f32 v89, 0xbdd2d3e8, v87
v_rcp_f32 v239, v88
v_mul_f32 v235, v89, v88
s_mul_i32 s43, s34, 917504
s_mul_i32 s44, s35, 24576
s_add_u32 s43, s43, s44
s_add_u32 s43, s43, 8912896
s_add_u32 s24, s32, s43
s_addc_u32 s25, s33, 0
s_mov_b32 s26, 24576
s_mov_b32 s27, 0x20000
s_mov_b32 s53, 262144
s_lshl_b32 s43, s47, 13
s_lshl_b32 s44, s46, 10
s_add_u32 s43, s43, s44
v_lshlrev_b32 v19, 11, v18
v_lshl_add_u32 v19, v17, 4, v19
v_add_u32 v27, s43, v19
s_lshl_b32 s43, s47, 12
s_add_u32 s43, s43, s44
s_add_u32 s43, s43, 16384
v_and_b32 v19, 1, v18
v_lshlrev_b32 v19, 11, v19
v_lshrrev_b32 v20, 1, v18
v_lshl_add_u32 v19, v20, 8, v19
v_lshl_add_u32 v19, v17, 4, v19
v_add_u32 v28, s43, v19
s_barrier
v_mul_f32 v128, -v80, v48
v_mul_f32 v129, -v80, v49
v_mul_f32 v130, -v80, v50
v_mul_f32 v131, -v80, v51
v_mul_f32 v132, -v82, v48
v_mul_f32 v133, -v82, v49
v_mul_f32 v134, -v82, v50
v_mul_f32 v135, -v82, v51
v_mul_f32 v136, -v84, v48
v_mul_f32 v137, -v84, v49
v_mul_f32 v138, -v84, v50
v_mul_f32 v139, -v84, v51
v_mul_f32 v140, -v86, v48
v_mul_f32 v141, -v86, v49
v_mul_f32 v142, -v86, v50
v_mul_f32 v143, -v86, v51
v_mul_f32 v144, -v80, v52
v_mul_f32 v145, -v80, v53
v_mul_f32 v146, -v80, v54
v_mul_f32 v147, -v80, v55
v_mul_f32 v148, -v82, v52
v_mul_f32 v149, -v82, v53
v_mul_f32 v150, -v82, v54
v_mul_f32 v151, -v82, v55
v_mul_f32 v152, -v84, v52
v_mul_f32 v153, -v84, v53
v_mul_f32 v154, -v84, v54
v_mul_f32 v155, -v84, v55
v_mul_f32 v156, -v86, v52
v_mul_f32 v157, -v86, v53
v_mul_f32 v158, -v86, v54
v_mul_f32 v159, -v86, v55
s_barrier
v_mul_f32 v160, -v80, v56
v_mul_f32 v161, -v80, v57
v_mul_f32 v162, -v80, v58
v_mul_f32 v163, -v80, v59
v_mul_f32 v164, -v82, v56
v_mul_f32 v165, -v82, v57
v_mul_f32 v166, -v82, v58
v_mul_f32 v167, -v82, v59
v_mul_f32 v168, -v84, v56
v_mul_f32 v169, -v84, v57
v_mul_f32 v170, -v84, v58
v_mul_f32 v171, -v84, v59
v_mul_f32 v172, -v86, v56
v_mul_f32 v173, -v86, v57
v_mul_f32 v174, -v86, v58
v_mul_f32 v175, -v86, v59
v_mul_f32 v176, -v80, v60
v_mul_f32 v177, -v80, v61
v_mul_f32 v178, -v80, v62
v_mul_f32 v179, -v80, v63
v_mul_f32 v180, -v82, v60
v_mul_f32 v181, -v82, v61
v_mul_f32 v182, -v82, v62
v_mul_f32 v183, -v82, v63
v_mul_f32 v184, -v84, v60
v_mul_f32 v185, -v84, v61
v_mul_f32 v186, -v84, v62
v_mul_f32 v187, -v84, v63
v_mul_f32 v188, -v86, v60
v_mul_f32 v189, -v86, v61
v_mul_f32 v190, -v86, v62
v_mul_f32 v191, -v86, v63
s_barrier
v_mul_f32 v192, -v80, v64
v_mul_f32 v193, -v80, v65
v_mul_f32 v194, -v80, v66
v_mul_f32 v195, -v80, v67
v_mul_f32 v196, -v82, v64
v_mul_f32 v197, -v82, v65
v_mul_f32 v198, -v82, v66
v_mul_f32 v199, -v82, v67
v_mul_f32 v200, -v84, v64
v_mul_f32 v201, -v84, v65
v_mul_f32 v202, -v84, v66
v_mul_f32 v203, -v84, v67
v_mul_f32 v204, -v86, v64
v_mul_f32 v205, -v86, v65
v_mul_f32 v206, -v86, v66
v_mul_f32 v207, -v86, v67
v_mul_f32 v208, -v80, v68
v_mul_f32 v209, -v80, v69
v_mul_f32 v210, -v80, v70
v_mul_f32 v211, -v80, v71
v_mul_f32 v212, -v82, v68
v_mul_f32 v213, -v82, v69
v_mul_f32 v214, -v82, v70
v_mul_f32 v215, -v82, v71
v_mul_f32 v216, -v84, v68
v_mul_f32 v217, -v84, v69
v_mul_f32 v218, -v84, v70
v_mul_f32 v219, -v84, v71
v_mul_f32 v220, -v86, v68
v_mul_f32 v221, -v86, v69
v_mul_f32 v222, -v86, v70
v_mul_f32 v223, -v86, v71
s_barrier
s_barrier
LK3b_26:
s_setprio 1
ds_read_b128 v[32:35], v2 offset:0
ds_read_b64_tr_b16 v[48:49], v5 offset:16384
ds_read_b64_tr_b16 v[50:51], v5 offset:20480
ds_read_b128 v[36:39], v2 offset:256
ds_read_b128 v[40:43], v2 offset:512
ds_read_b128 v[44:47], v2 offset:768
ds_read_b64_tr_b16 v[60:61], v5 offset:32768
ds_read_b64_tr_b16 v[62:63], v5 offset:36864
ds_read_b64_tr_b16 v[52:53], v6 offset:16384
ds_read_b64_tr_b16 v[54:55], v6 offset:20480
ds_read_b64_tr_b16 v[64:65], v6 offset:32768
ds_read_b64_tr_b16 v[66:67], v6 offset:36864
ds_read_b64_tr_b16 v[56:57], v7 offset:16384
ds_read_b64_tr_b16 v[58:59], v7 offset:20480
ds_read_b64_tr_b16 v[68:69], v7 offset:32768
ds_read_b64_tr_b16 v[70:71], v7 offset:36864
s_mov_b32 s41, 5
Lk3_40:
s_waitcnt lgkmcnt(0)
v_mfma_f32_16x16x32_bf16 v[128:131], v[48:51], v[32:35], v[128:131]
ds_read_b128 v[80:83], v2 offset:8192
v_mfma_f32_16x16x32_bf16 v[132:135], v[48:51], v[36:39], v[132:135]
ds_read_b64_tr_b16 v[96:97], v5 offset:24576
v_mfma_f32_16x16x32_bf16 v[136:139], v[48:51], v[40:43], v[136:139]
ds_read_b64_tr_b16 v[98:99], v5 offset:28672
v_mfma_f32_16x16x32_bf16 v[140:143], v[48:51], v[44:47], v[140:143]
ds_read_b128 v[84:87], v2 offset:8448
v_mfma_f32_16x16x32_bf16 v[176:179], v[60:63], v[32:35], v[176:179]
ds_read_b128 v[88:91], v2 offset:8704
v_mfma_f32_16x16x32_bf16 v[180:183], v[60:63], v[36:39], v[180:183]
ds_read_b128 v[92:95], v2 offset:8960
v_mfma_f32_16x16x32_bf16 v[184:187], v[60:63], v[40:43], v[184:187]
ds_read_b64_tr_b16 v[108:109], v5 offset:40960
v_mfma_f32_16x16x32_bf16 v[188:191], v[60:63], v[44:47], v[188:191]
ds_read_b64_tr_b16 v[110:111], v5 offset:45056
v_mfma_f32_16x16x32_bf16 v[144:147], v[52:55], v[32:35], v[144:147]
ds_read_b64_tr_b16 v[100:101], v6 offset:24576
v_mfma_f32_16x16x32_bf16 v[148:151], v[52:55], v[36:39], v[148:151]
ds_read_b64_tr_b16 v[102:103], v6 offset:28672
v_mfma_f32_16x16x32_bf16 v[152:155], v[52:55], v[40:43], v[152:155]
ds_read_b64_tr_b16 v[112:113], v6 offset:40960
v_mfma_f32_16x16x32_bf16 v[156:159], v[52:55], v[44:47], v[156:159]
ds_read_b64_tr_b16 v[114:115], v6 offset:45056
v_mfma_f32_16x16x32_bf16 v[192:195], v[64:67], v[32:35], v[192:195]
ds_read_b64_tr_b16 v[104:105], v7 offset:24576
v_mfma_f32_16x16x32_bf16 v[196:199], v[64:67], v[36:39], v[196:199]
ds_read_b64_tr_b16 v[106:107], v7 offset:28672
v_mfma_f32_16x16x32_bf16 v[200:203], v[64:67], v[40:43], v[200:203]
ds_read_b64_tr_b16 v[116:117], v7 offset:40960
v_mfma_f32_16x16x32_bf16 v[204:207], v[64:67], v[44:47], v[204:207]
ds_read_b64_tr_b16 v[118:119], v7 offset:45056
v_mfma_f32_16x16x32_bf16 v[160:163], v[56:59], v[32:35], v[160:163]
v_mfma_f32_16x16x32_bf16 v[164:167], v[56:59], v[36:39], v[164:167]
v_mfma_f32_16x16x32_bf16 v[168:171], v[56:59], v[40:43], v[168:171]
v_mfma_f32_16x16x32_bf16 v[172:175], v[56:59], v[44:47], v[172:175]
v_mfma_f32_16x16x32_bf16 v[208:211], v[68:71], v[32:35], v[208:211]
v_mfma_f32_16x16x32_bf16 v[212:215], v[68:71], v[36:39], v[212:215]
v_mfma_f32_16x16x32_bf16 v[216:219], v[68:71], v[40:43], v[216:219]
v_mfma_f32_16x16x32_bf16 v[220:223], v[68:71], v[44:47], v[220:223]
s_waitcnt vmcnt(0) lgkmcnt(0)
s_barrier
v_mfma_f32_16x16x32_bf16 v[128:131], v[96:99], v[80:83], v[128:131]
ds_read_b128 v[32:35], v3 offset:0
v_mfma_f32_16x16x32_bf16 v[132:135], v[96:99], v[84:87], v[132:135]
ds_read_b64_tr_b16 v[48:49], v9 offset:16384
v_mfma_f32_16x16x32_bf16 v[136:139], v[96:99], v[88:91], v[136:139]
ds_read_b64_tr_b16 v[50:51], v9 offset:20480
v_mfma_f32_16x16x32_bf16 v[140:143], v[96:99], v[92:95], v[140:143]
ds_read_b128 v[36:39], v3 offset:256
v_mfma_f32_16x16x32_bf16 v[176:179], v[108:111], v[80:83], v[176:179]
ds_read_b128 v[40:43], v3 offset:512
v_mfma_f32_16x16x32_bf16 v[180:183], v[108:111], v[84:87], v[180:183]
ds_read_b128 v[44:47], v3 offset:768
v_mfma_f32_16x16x32_bf16 v[184:187], v[108:111], v[88:91], v[184:187]
ds_read_b64_tr_b16 v[60:61], v9 offset:32768
v_mfma_f32_16x16x32_bf16 v[188:191], v[108:111], v[92:95], v[188:191]
ds_read_b64_tr_b16 v[62:63], v9 offset:36864
v_mfma_f32_16x16x32_bf16 v[144:147], v[100:103], v[80:83], v[144:147]
ds_read_b64_tr_b16 v[52:53], v10 offset:16384
v_mfma_f32_16x16x32_bf16 v[148:151], v[100:103], v[84:87], v[148:151]
ds_read_b64_tr_b16 v[54:55], v10 offset:20480
v_mfma_f32_16x16x32_bf16 v[152:155], v[100:103], v[88:91], v[152:155]
ds_read_b64_tr_b16 v[64:65], v10 offset:32768
v_mfma_f32_16x16x32_bf16 v[156:159], v[100:103], v[92:95], v[156:159]
ds_read_b64_tr_b16 v[66:67], v10 offset:36864
v_mfma_f32_16x16x32_bf16 v[192:195], v[112:115], v[80:83], v[192:195]
ds_read_b64_tr_b16 v[56:57], v11 offset:16384
v_mfma_f32_16x16x32_bf16 v[196:199], v[112:115], v[84:87], v[196:199]
ds_read_b64_tr_b16 v[58:59], v11 offset:20480
v_mfma_f32_16x16x32_bf16 v[200:203], v[112:115], v[88:91], v[200:203]
ds_read_b64_tr_b16 v[68:69], v11 offset:32768
v_mfma_f32_16x16x32_bf16 v[204:207], v[112:115], v[92:95], v[204:207]
ds_read_b64_tr_b16 v[70:71], v11 offset:36864
v_mfma_f32_16x16x32_bf16 v[160:163], v[104:107], v[80:83], v[160:163]
v_mfma_f32_16x16x32_bf16 v[164:167], v[104:107], v[84:87], v[164:167]
v_mfma_f32_16x16x32_bf16 v[168:171], v[104:107], v[88:91], v[168:171]
v_mfma_f32_16x16x32_bf16 v[172:175], v[104:107], v[92:95], v[172:175]
v_mfma_f32_16x16x32_bf16 v[208:211], v[116:119], v[80:83], v[208:211]
v_mfma_f32_16x16x32_bf16 v[212:215], v[116:119], v[84:87], v[212:215]
v_mfma_f32_16x16x32_bf16 v[216:219], v[116:119], v[88:91], v[216:219]
v_mfma_f32_16x16x32_bf16 v[220:223], v[116:119], v[92:95], v[220:223]
s_waitcnt lgkmcnt(0)
v_mfma_f32_16x16x32_bf16 v[128:131], v[48:51], v[32:35], v[128:131]
ds_read_b128 v[80:83], v3 offset:8192
v_mfma_f32_16x16x32_bf16 v[132:135], v[48:51], v[36:39], v[132:135]
ds_read_b64_tr_b16 v[96:97], v9 offset:24576
v_mfma_f32_16x16x32_bf16 v[136:139], v[48:51], v[40:43], v[136:139]
ds_read_b64_tr_b16 v[98:99], v9 offset:28672
v_mfma_f32_16x16x32_bf16 v[140:143], v[48:51], v[44:47], v[140:143]
ds_read_b128 v[84:87], v3 offset:8448
v_mfma_f32_16x16x32_bf16 v[176:179], v[60:63], v[32:35], v[176:179]
ds_read_b128 v[88:91], v3 offset:8704
v_mfma_f32_16x16x32_bf16 v[180:183], v[60:63], v[36:39], v[180:183]
ds_read_b128 v[92:95], v3 offset:8960
v_mfma_f32_16x16x32_bf16 v[184:187], v[60:63], v[40:43], v[184:187]
ds_read_b64_tr_b16 v[108:109], v9 offset:40960
v_mfma_f32_16x16x32_bf16 v[188:191], v[60:63], v[44:47], v[188:191]
ds_read_b64_tr_b16 v[110:111], v9 offset:45056
v_mfma_f32_16x16x32_bf16 v[144:147], v[52:55], v[32:35], v[144:147]
ds_read_b64_tr_b16 v[100:101], v10 offset:24576
v_mfma_f32_16x16x32_bf16 v[148:151], v[52:55], v[36:39], v[148:151]
ds_read_b64_tr_b16 v[102:103], v10 offset:28672
v_mfma_f32_16x16x32_bf16 v[152:155], v[52:55], v[40:43], v[152:155]
ds_read_b64_tr_b16 v[112:113], v10 offset:40960
v_mfma_f32_16x16x32_bf16 v[156:159], v[52:55], v[44:47], v[156:159]
ds_read_b64_tr_b16 v[114:115], v10 offset:45056
v_mfma_f32_16x16x32_bf16 v[192:195], v[64:67], v[32:35], v[192:195]
ds_read_b64_tr_b16 v[104:105], v11 offset:24576
v_mfma_f32_16x16x32_bf16 v[196:199], v[64:67], v[36:39], v[196:199]
ds_read_b64_tr_b16 v[106:107], v11 offset:28672
v_mfma_f32_16x16x32_bf16 v[200:203], v[64:67], v[40:43], v[200:203]
ds_read_b64_tr_b16 v[116:117], v11 offset:40960
v_mfma_f32_16x16x32_bf16 v[204:207], v[64:67], v[44:47], v[204:207]
ds_read_b64_tr_b16 v[118:119], v11 offset:45056
v_mfma_f32_16x16x32_bf16 v[160:163], v[56:59], v[32:35], v[160:163]
v_mfma_f32_16x16x32_bf16 v[164:167], v[56:59], v[36:39], v[164:167]
v_mfma_f32_16x16x32_bf16 v[168:171], v[56:59], v[40:43], v[168:171]
v_mfma_f32_16x16x32_bf16 v[172:175], v[56:59], v[44:47], v[172:175]
v_mfma_f32_16x16x32_bf16 v[208:211], v[68:71], v[32:35], v[208:211]
v_mfma_f32_16x16x32_bf16 v[212:215], v[68:71], v[36:39], v[212:215]
v_mfma_f32_16x16x32_bf16 v[216:219], v[68:71], v[40:43], v[216:219]
v_mfma_f32_16x16x32_bf16 v[220:223], v[68:71], v[44:47], v[220:223]
s_waitcnt lgkmcnt(0)
s_barrier
v_mfma_f32_16x16x32_bf16 v[128:131], v[96:99], v[80:83], v[128:131]
ds_read_b128 v[32:35], v4 offset:0
v_mfma_f32_16x16x32_bf16 v[132:135], v[96:99], v[84:87], v[132:135]
ds_read_b64_tr_b16 v[48:49], v13 offset:16384
v_mfma_f32_16x16x32_bf16 v[136:139], v[96:99], v[88:91], v[136:139]
ds_read_b64_tr_b16 v[50:51], v13 offset:20480
v_mfma_f32_16x16x32_bf16 v[140:143], v[96:99], v[92:95], v[140:143]
ds_read_b128 v[36:39], v4 offset:256
v_mfma_f32_16x16x32_bf16 v[176:179], v[108:111], v[80:83], v[176:179]
ds_read_b128 v[40:43], v4 offset:512
v_mfma_f32_16x16x32_bf16 v[180:183], v[108:111], v[84:87], v[180:183]
ds_read_b128 v[44:47], v4 offset:768
v_mfma_f32_16x16x32_bf16 v[184:187], v[108:111], v[88:91], v[184:187]
ds_read_b64_tr_b16 v[60:61], v13 offset:32768
v_mfma_f32_16x16x32_bf16 v[188:191], v[108:111], v[92:95], v[188:191]
ds_read_b64_tr_b16 v[62:63], v13 offset:36864
v_mfma_f32_16x16x32_bf16 v[144:147], v[100:103], v[80:83], v[144:147]
ds_read_b64_tr_b16 v[52:53], v14 offset:16384
v_mfma_f32_16x16x32_bf16 v[148:151], v[100:103], v[84:87], v[148:151]
ds_read_b64_tr_b16 v[54:55], v14 offset:20480
v_mfma_f32_16x16x32_bf16 v[152:155], v[100:103], v[88:91], v[152:155]
ds_read_b64_tr_b16 v[64:65], v14 offset:32768
v_mfma_f32_16x16x32_bf16 v[156:159], v[100:103], v[92:95], v[156:159]
ds_read_b64_tr_b16 v[66:67], v14 offset:36864
v_mfma_f32_16x16x32_bf16 v[192:195], v[112:115], v[80:83], v[192:195]
ds_read_b64_tr_b16 v[56:57], v15 offset:16384
v_mfma_f32_16x16x32_bf16 v[196:199], v[112:115], v[84:87], v[196:199]
ds_read_b64_tr_b16 v[58:59], v15 offset:20480
v_mfma_f32_16x16x32_bf16 v[200:203], v[112:115], v[88:91], v[200:203]
ds_read_b64_tr_b16 v[68:69], v15 offset:32768
v_mfma_f32_16x16x32_bf16 v[204:207], v[112:115], v[92:95], v[204:207]
ds_read_b64_tr_b16 v[70:71], v15 offset:36864
v_mfma_f32_16x16x32_bf16 v[160:163], v[104:107], v[80:83], v[160:163]
v_mfma_f32_16x16x32_bf16 v[164:167], v[104:107], v[84:87], v[164:167]
v_mfma_f32_16x16x32_bf16 v[168:171], v[104:107], v[88:91], v[168:171]
v_mfma_f32_16x16x32_bf16 v[172:175], v[104:107], v[92:95], v[172:175]
v_mfma_f32_16x16x32_bf16 v[208:211], v[116:119], v[80:83], v[208:211]
v_mfma_f32_16x16x32_bf16 v[212:215], v[116:119], v[84:87], v[212:215]
v_mfma_f32_16x16x32_bf16 v[216:219], v[116:119], v[88:91], v[216:219]
v_mfma_f32_16x16x32_bf16 v[220:223], v[116:119], v[92:95], v[220:223]
s_waitcnt lgkmcnt(0)
v_mfma_f32_16x16x32_bf16 v[128:131], v[48:51], v[32:35], v[128:131]
ds_read_b128 v[80:83], v4 offset:8192
v_mfma_f32_16x16x32_bf16 v[132:135], v[48:51], v[36:39], v[132:135]
ds_read_b64_tr_b16 v[96:97], v13 offset:24576
v_mfma_f32_16x16x32_bf16 v[136:139], v[48:51], v[40:43], v[136:139]
ds_read_b64_tr_b16 v[98:99], v13 offset:28672
v_mfma_f32_16x16x32_bf16 v[140:143], v[48:51], v[44:47], v[140:143]
ds_read_b128 v[84:87], v4 offset:8448
v_mfma_f32_16x16x32_bf16 v[176:179], v[60:63], v[32:35], v[176:179]
ds_read_b128 v[88:91], v4 offset:8704
v_mfma_f32_16x16x32_bf16 v[180:183], v[60:63], v[36:39], v[180:183]
ds_read_b128 v[92:95], v4 offset:8960
v_mfma_f32_16x16x32_bf16 v[184:187], v[60:63], v[40:43], v[184:187]
ds_read_b64_tr_b16 v[108:109], v13 offset:40960
v_mfma_f32_16x16x32_bf16 v[188:191], v[60:63], v[44:47], v[188:191]
ds_read_b64_tr_b16 v[110:111], v13 offset:45056
v_mfma_f32_16x16x32_bf16 v[144:147], v[52:55], v[32:35], v[144:147]
ds_read_b64_tr_b16 v[100:101], v14 offset:24576
v_mfma_f32_16x16x32_bf16 v[148:151], v[52:55], v[36:39], v[148:151]
ds_read_b64_tr_b16 v[102:103], v14 offset:28672
v_mfma_f32_16x16x32_bf16 v[152:155], v[52:55], v[40:43], v[152:155]
ds_read_b64_tr_b16 v[112:113], v14 offset:40960
v_mfma_f32_16x16x32_bf16 v[156:159], v[52:55], v[44:47], v[156:159]
ds_read_b64_tr_b16 v[114:115], v14 offset:45056
v_mfma_f32_16x16x32_bf16 v[192:195], v[64:67], v[32:35], v[192:195]
ds_read_b64_tr_b16 v[104:105], v15 offset:24576
v_mfma_f32_16x16x32_bf16 v[196:199], v[64:67], v[36:39], v[196:199]
ds_read_b64_tr_b16 v[106:107], v15 offset:28672
v_mfma_f32_16x16x32_bf16 v[200:203], v[64:67], v[40:43], v[200:203]
ds_read_b64_tr_b16 v[116:117], v15 offset:40960
v_mfma_f32_16x16x32_bf16 v[204:207], v[64:67], v[44:47], v[204:207]
ds_read_b64_tr_b16 v[118:119], v15 offset:45056
v_mfma_f32_16x16x32_bf16 v[160:163], v[56:59], v[32:35], v[160:163]
v_mfma_f32_16x16x32_bf16 v[164:167], v[56:59], v[36:39], v[164:167]
v_mfma_f32_16x16x32_bf16 v[168:171], v[56:59], v[40:43], v[168:171]
v_mfma_f32_16x16x32_bf16 v[172:175], v[56:59], v[44:47], v[172:175]
v_mfma_f32_16x16x32_bf16 v[208:211], v[68:71], v[32:35], v[208:211]
v_mfma_f32_16x16x32_bf16 v[212:215], v[68:71], v[36:39], v[212:215]
v_mfma_f32_16x16x32_bf16 v[216:219], v[68:71], v[40:43], v[216:219]
v_mfma_f32_16x16x32_bf16 v[220:223], v[68:71], v[44:47], v[220:223]
s_waitcnt lgkmcnt(0)
s_barrier
v_mfma_f32_16x16x32_bf16 v[128:131], v[96:99], v[80:83], v[128:131]
ds_read_b128 v[32:35], v2 offset:0
v_mfma_f32_16x16x32_bf16 v[132:135], v[96:99], v[84:87], v[132:135]
ds_read_b64_tr_b16 v[48:49], v5 offset:16384
v_mfma_f32_16x16x32_bf16 v[136:139], v[96:99], v[88:91], v[136:139]
ds_read_b64_tr_b16 v[50:51], v5 offset:20480
v_mfma_f32_16x16x32_bf16 v[140:143], v[96:99], v[92:95], v[140:143]
ds_read_b128 v[36:39], v2 offset:256
v_mfma_f32_16x16x32_bf16 v[176:179], v[108:111], v[80:83], v[176:179]
ds_read_b128 v[40:43], v2 offset:512
v_mfma_f32_16x16x32_bf16 v[180:183], v[108:111], v[84:87], v[180:183]
ds_read_b128 v[44:47], v2 offset:768
v_mfma_f32_16x16x32_bf16 v[184:187], v[108:111], v[88:91], v[184:187]
ds_read_b64_tr_b16 v[60:61], v5 offset:32768
v_mfma_f32_16x16x32_bf16 v[188:191], v[108:111], v[92:95], v[188:191]
ds_read_b64_tr_b16 v[62:63], v5 offset:36864
v_mfma_f32_16x16x32_bf16 v[144:147], v[100:103], v[80:83], v[144:147]
ds_read_b64_tr_b16 v[52:53], v6 offset:16384
v_mfma_f32_16x16x32_bf16 v[148:151], v[100:103], v[84:87], v[148:151]
ds_read_b64_tr_b16 v[54:55], v6 offset:20480
v_mfma_f32_16x16x32_bf16 v[152:155], v[100:103], v[88:91], v[152:155]
ds_read_b64_tr_b16 v[64:65], v6 offset:32768
v_mfma_f32_16x16x32_bf16 v[156:159], v[100:103], v[92:95], v[156:159]
ds_read_b64_tr_b16 v[66:67], v6 offset:36864
v_mfma_f32_16x16x32_bf16 v[192:195], v[112:115], v[80:83], v[192:195]
ds_read_b64_tr_b16 v[56:57], v7 offset:16384
v_mfma_f32_16x16x32_bf16 v[196:199], v[112:115], v[84:87], v[196:199]
ds_read_b64_tr_b16 v[58:59], v7 offset:20480
v_mfma_f32_16x16x32_bf16 v[200:203], v[112:115], v[88:91], v[200:203]
ds_read_b64_tr_b16 v[68:69], v7 offset:32768
v_mfma_f32_16x16x32_bf16 v[204:207], v[112:115], v[92:95], v[204:207]
ds_read_b64_tr_b16 v[70:71], v7 offset:36864
v_mfma_f32_16x16x32_bf16 v[160:163], v[104:107], v[80:83], v[160:163]
v_mfma_f32_16x16x32_bf16 v[164:167], v[104:107], v[84:87], v[164:167]
v_mfma_f32_16x16x32_bf16 v[168:171], v[104:107], v[88:91], v[168:171]
v_mfma_f32_16x16x32_bf16 v[172:175], v[104:107], v[92:95], v[172:175]
v_mfma_f32_16x16x32_bf16 v[208:211], v[116:119], v[80:83], v[208:211]
v_mfma_f32_16x16x32_bf16 v[212:215], v[116:119], v[84:87], v[212:215]
v_mfma_f32_16x16x32_bf16 v[216:219], v[116:119], v[88:91], v[216:219]
v_mfma_f32_16x16x32_bf16 v[220:223], v[116:119], v[92:95], v[220:223]
s_sub_u32 s41, s41, 1
s_cmp_lg_u32 s41, 0
s_cbranch_scc1 Lk3_40
s_waitcnt lgkmcnt(0)
v_mfma_f32_16x16x32_bf16 v[128:131], v[48:51], v[32:35], v[128:131]
ds_read_b128 v[80:83], v2 offset:8192
v_mfma_f32_16x16x32_bf16 v[132:135], v[48:51], v[36:39], v[132:135]
ds_read_b64_tr_b16 v[96:97], v5 offset:24576
v_mfma_f32_16x16x32_bf16 v[136:139], v[48:51], v[40:43], v[136:139]
ds_read_b64_tr_b16 v[98:99], v5 offset:28672
v_mfma_f32_16x16x32_bf16 v[140:143], v[48:51], v[44:47], v[140:143]
ds_read_b128 v[84:87], v2 offset:8448
v_mfma_f32_16x16x32_bf16 v[176:179], v[60:63], v[32:35], v[176:179]
ds_read_b128 v[88:91], v2 offset:8704
v_mfma_f32_16x16x32_bf16 v[180:183], v[60:63], v[36:39], v[180:183]
ds_read_b128 v[92:95], v2 offset:8960
v_mfma_f32_16x16x32_bf16 v[184:187], v[60:63], v[40:43], v[184:187]
ds_read_b64_tr_b16 v[108:109], v5 offset:40960
v_mfma_f32_16x16x32_bf16 v[188:191], v[60:63], v[44:47], v[188:191]
ds_read_b64_tr_b16 v[110:111], v5 offset:45056
v_mfma_f32_16x16x32_bf16 v[144:147], v[52:55], v[32:35], v[144:147]
ds_read_b64_tr_b16 v[100:101], v6 offset:24576
v_mfma_f32_16x16x32_bf16 v[148:151], v[52:55], v[36:39], v[148:151]
ds_read_b64_tr_b16 v[102:103], v6 offset:28672
v_mfma_f32_16x16x32_bf16 v[152:155], v[52:55], v[40:43], v[152:155]
ds_read_b64_tr_b16 v[112:113], v6 offset:40960
v_mfma_f32_16x16x32_bf16 v[156:159], v[52:55], v[44:47], v[156:159]
ds_read_b64_tr_b16 v[114:115], v6 offset:45056
v_mfma_f32_16x16x32_bf16 v[192:195], v[64:67], v[32:35], v[192:195]
ds_read_b64_tr_b16 v[104:105], v7 offset:24576
v_mfma_f32_16x16x32_bf16 v[196:199], v[64:67], v[36:39], v[196:199]
ds_read_b64_tr_b16 v[106:107], v7 offset:28672
v_mfma_f32_16x16x32_bf16 v[200:203], v[64:67], v[40:43], v[200:203]
ds_read_b64_tr_b16 v[116:117], v7 offset:40960
v_mfma_f32_16x16x32_bf16 v[204:207], v[64:67], v[44:47], v[204:207]
ds_read_b64_tr_b16 v[118:119], v7 offset:45056
v_mfma_f32_16x16x32_bf16 v[160:163], v[56:59], v[32:35], v[160:163]
v_mfma_f32_16x16x32_bf16 v[164:167], v[56:59], v[36:39], v[164:167]
v_mfma_f32_16x16x32_bf16 v[168:171], v[56:59], v[40:43], v[168:171]
v_mfma_f32_16x16x32_bf16 v[172:175], v[56:59], v[44:47], v[172:175]
v_mfma_f32_16x16x32_bf16 v[208:211], v[68:71], v[32:35], v[208:211]
v_mfma_f32_16x16x32_bf16 v[212:215], v[68:71], v[36:39], v[212:215]
v_mfma_f32_16x16x32_bf16 v[216:219], v[68:71], v[40:43], v[216:219]
v_mfma_f32_16x16x32_bf16 v[220:223], v[68:71], v[44:47], v[220:223]
s_waitcnt lgkmcnt(0)
s_barrier
s_cmp_eq_u32 s36, 7
s_cbranch_scc1 L7b_41
s_add_u32 m0, s39, 0
s_add_u32 s37, s37, s40
buffer_load_dwordx4 v21, s[8:11], s37 offen sc1 lds
v_mfma_f32_16x16x32_bf16 v[128:131], v[96:99], v[80:83], v[128:131]
v_mfma_f32_16x16x32_bf16 v[132:135], v[96:99], v[84:87], v[132:135]
s_add_u32 m0, s39, 1024
s_add_u32 s37, s37, s38
buffer_load_dwordx4 v21, s[8:11], s37 offen sc1 lds
v_mfma_f32_16x16x32_bf16 v[136:139], v[96:99], v[88:91], v[136:139]
s_add_u32 m0, s39, 2048
s_add_u32 s37, s37, s38
buffer_load_dwordx4 v21, s[8:11], s37 offen sc1 lds
v_mfma_f32_16x16x32_bf16 v[140:143], v[96:99], v[92:95], v[140:143]
v_mfma_f32_16x16x32_bf16 v[176:179], v[108:111], v[80:83], v[176:179]
s_add_u32 m0, s39, 3072
s_add_u32 s37, s37, s38
buffer_load_dwordx4 v21, s[8:11], s37 offen sc1 lds
v_mfma_f32_16x16x32_bf16 v[180:183], v[108:111], v[84:87], v[180:183]
s_add_u32 m0, s39, 4096
s_add_u32 s37, s37, s55
buffer_load_dwordx4 v21, s[8:11], s37 offen sc1 lds
v_mfma_f32_16x16x32_bf16 v[184:187], v[108:111], v[88:91], v[184:187]
v_mfma_f32_16x16x32_bf16 v[188:191], v[108:111], v[92:95], v[188:191]
s_add_u32 m0, s39, 5120
s_add_u32 s37, s37, s38
buffer_load_dwordx4 v21, s[8:11], s37 offen sc1 lds
v_mfma_f32_16x16x32_bf16 v[144:147], v[100:103], v[80:83], v[144:147]
s_add_u32 m0, s39, 6144
s_add_u32 s37, s37, s38
buffer_load_dwordx4 v21, s[8:11], s37 offen sc1 lds
v_mfma_f32_16x16x32_bf16 v[148:151], v[100:103], v[84:87], v[148:151]
v_mfma_f32_16x16x32_bf16 v[152:155], v[100:103], v[88:91], v[152:155]
s_add_u32 m0, s39, 7168
s_add_u32 s37, s37, s38
buffer_load_dwordx4 v21, s[8:11], s37 offen sc1 lds
v_mfma_f32_16x16x32_bf16 v[156:159], v[100:103], v[92:95], v[156:159]
s_add_u32 m0, s39, 24576
s_add_u32 s37, s37, s40
buffer_load_dwordx4 v21, s[8:11], s37 offen sc1 lds
v_mfma_f32_16x16x32_bf16 v[192:195], v[112:115], v[80:83], v[192:195]
v_mfma_f32_16x16x32_bf16 v[196:199], v[112:115], v[84:87], v[196:199]
s_add_u32 m0, s39, 25600
s_add_u32 s37, s37, s38
buffer_load_dwordx4 v21, s[8:11], s37 offen sc1 lds
v_mfma_f32_16x16x32_bf16 v[200:203], v[112:115], v[88:91], v[200:203]
s_add_u32 m0, s39, 26624
s_add_u32 s37, s37, s38
buffer_load_dwordx4 v21, s[8:11], s37 offen sc1 lds
v_mfma_f32_16x16x32_bf16 v[204:207], v[112:115], v[92:95], v[204:207]
v_mfma_f32_16x16x32_bf16 v[160:163], v[104:107], v[80:83], v[160:163]
s_add_u32 m0, s39, 27648
s_add_u32 s37, s37, s38
buffer_load_dwordx4 v21, s[8:11], s37 offen sc1 lds
v_mfma_f32_16x16x32_bf16 v[164:167], v[104:107], v[84:87], v[164:167]
s_add_u32 m0, s39, 28672
s_add_u32 s37, s37, s55
buffer_load_dwordx4 v21, s[8:11], s37 offen sc1 lds
v_mfma_f32_16x16x32_bf16 v[168:171], v[104:107], v[88:91], v[168:171]
v_mfma_f32_16x16x32_bf16 v[172:175], v[104:107], v[92:95], v[172:175]
s_add_u32 m0, s39, 29696
s_add_u32 s37, s37, s38
buffer_load_dwordx4 v21, s[8:11], s37 offen sc1 lds
v_mfma_f32_16x16x32_bf16 v[208:211], v[116:119], v[80:83], v[208:211]
s_add_u32 m0, s39, 30720
s_add_u32 s37, s37, s38
buffer_load_dwordx4 v21, s[8:11], s37 offen sc1 lds
v_mfma_f32_16x16x32_bf16 v[212:215], v[116:119], v[84:87], v[212:215]
v_mfma_f32_16x16x32_bf16 v[216:219], v[116:119], v[88:91], v[216:219]
s_add_u32 m0, s39, 31744
s_add_u32 s37, s37, s38
buffer_load_dwordx4 v21, s[8:11], s37 offen sc1 lds
v_mfma_f32_16x16x32_bf16 v[220:223], v[116:119], v[92:95], v[220:223]
s_setprio 0
s_barrier
s_add_u32 m0, s39, 49152
s_add_u32 s37, s37, s40
buffer_load_dwordx4 v21, s[8:11], s37 offen sc1 lds
v_mul_f32 v80, v128, v128
v_mul_f32 v81, v129, v129
v_mul_f32 v82, v130, v130
v_mul_f32 v83, v131, v131
s_add_u32 m0, s39, 50176
s_add_u32 s37, s37, s38
buffer_load_dwordx4 v21, s[8:11], s37 offen sc1 lds
v_fma_f32 v80, v80, v232, v228
v_fma_f32 v81, v81, v232, v228
v_fma_f32 v82, v82, v232, v228
v_fma_f32 v83, v83, v232, v228
s_add_u32 m0, s39, 51200
s_add_u32 s37, s37, s38
buffer_load_dwordx4 v21, s[8:11], s37 offen sc1 lds
v_mul_f32 v80, v80, v128
v_mul_f32 v81, v81, v129
v_mul_f32 v82, v82, v130
v_mul_f32 v83, v83, v131
s_add_u32 m0, s39, 52224
s_add_u32 s37, s37, s38
buffer_load_dwordx4 v21, s[8:11], s37 offen sc1 lds
v_exp_f32 v80, v80
v_exp_f32 v81, v81
v_exp_f32 v82, v82
s_add_u32 m0, s39, 53248
s_add_u32 s37, s37, s55
buffer_load_dwordx4 v21, s[8:11], s37 offen sc1 lds
v_exp_f32 v83, v83
v_mul_f32 v176, v128, v176
v_mul_f32 v177, v129, v177
v_mul_f32 v178, v130, v178
s_add_u32 m0, s39, 54272
s_add_u32 s37, s37, s38
buffer_load_dwordx4 v21, s[8:11], s37 offen sc1 lds
v_mul_f32 v179, v131, v179
v_fma_f32 v80, v80, v236, v236
v_fma_f32 v81, v81, v236, v236
v_fma_f32 v82, v82, v236, v236
s_add_u32 m0, s39, 55296
s_add_u32 s37, s37, s38
buffer_load_dwordx4 v21, s[8:11], s37 offen sc1 lds
v_fma_f32 v83, v83, v236, v236
v_rcp_f32 v80, v80
v_rcp_f32 v81, v81
v_rcp_f32 v82, v82
s_add_u32 m0, s39, 56320
s_add_u32 s37, s37, s38
buffer_load_dwordx4 v21, s[8:11], s37 offen sc1 lds
v_rcp_f32 v83, v83
v_mul_f32 v176, v176, v80
v_mul_f32 v177, v177, v81
s_barrier
s_add_u32 m0, s39, 73728
s_add_u32 s37, s37, s40
buffer_load_dwordx4 v21, s[8:11], s37 offen sc1 lds
v_mul_f32 v178, v178, v82
v_mul_f32 v179, v179, v83
v_cvt_pk_bf16_f32 v96, v176, v177
v_cvt_pk_bf16_f32 v97, v178, v179
s_add_u32 m0, s39, 74752
s_add_u32 s37, s37, s38
buffer_load_dwordx4 v21, s[8:11], s37 offen sc1 lds
v_mul_f32 v84, v144, v144
v_mul_f32 v85, v145, v145
v_mul_f32 v86, v146, v146
v_mul_f32 v87, v147, v147
s_add_u32 m0, s39, 75776
s_add_u32 s37, s37, s38
buffer_load_dwordx4 v21, s[8:11], s37 offen sc1 lds
v_fma_f32 v84, v84, v232, v228
v_fma_f32 v85, v85, v232, v228
v_fma_f32 v86, v86, v232, v228
v_fma_f32 v87, v87, v232, v228
s_add_u32 m0, s39, 76800
s_add_u32 s37, s37, s38
buffer_load_dwordx4 v21, s[8:11], s37 offen sc1 lds
v_mul_f32 v84, v84, v144
v_mul_f32 v85, v85, v145
v_mul_f32 v86, v86, v146
s_add_u32 m0, s39, 77824
s_add_u32 s37, s37, s55
buffer_load_dwordx4 v21, s[8:11], s37 offen sc1 lds
v_mul_f32 v87, v87, v147
v_exp_f32 v84, v84
v_exp_f32 v85, v85
v_exp_f32 v86, v86
s_add_u32 m0, s39, 78848
s_add_u32 s37, s37, s38
buffer_load_dwordx4 v21, s[8:11], s37 offen sc1 lds
v_exp_f32 v87, v87
v_mul_f32 v192, v144, v192
v_mul_f32 v193, v145, v193
v_mul_f32 v194, v146, v194
s_add_u32 m0, s39, 79872
s_add_u32 s37, s37, s38
buffer_load_dwordx4 v21, s[8:11], s37 offen sc1 lds
v_mul_f32 v195, v147, v195
v_fma_f32 v84, v84, v236, v236
v_fma_f32 v85, v85, v236, v236
v_fma_f32 v86, v86, v236, v236
s_add_u32 m0, s39, 80896
s_add_u32 s37, s37, s38
buffer_load_dwordx4 v21, s[8:11], s37 offen sc1 lds
v_fma_f32 v87, v87, v236, v236
v_rcp_f32 v84, v84
v_rcp_f32 v85, v85
s_barrier
s_add_u32 m0, s39, 98304
s_add_u32 s37, s37, s40
buffer_load_dwordx4 v21, s[8:11], s37 offen sc1 lds
v_rcp_f32 v86, v86
v_rcp_f32 v87, v87
v_mul_f32 v192, v192, v84
v_mul_f32 v193, v193, v85
s_add_u32 m0, s39, 99328
s_add_u32 s37, s37, s38
buffer_load_dwordx4 v21, s[8:11], s37 offen sc1 lds
v_mul_f32 v194, v194, v86
v_mul_f32 v195, v195, v87
v_cvt_pk_bf16_f32 v98, v192, v193
v_cvt_pk_bf16_f32 v99, v194, v195
s_add_u32 m0, s39, 100352
s_add_u32 s37, s37, s38
buffer_load_dwordx4 v21, s[8:11], s37 offen sc1 lds
v_mul_f32 v80, v160, v160
v_mul_f32 v81, v161, v161
v_mul_f32 v82, v162, v162
s_add_u32 m0, s39, 101376
s_add_u32 s37, s37, s38
buffer_load_dwordx4 v21, s[8:11], s37 offen sc1 lds
v_mul_f32 v83, v163, v163
v_fma_f32 v80, v80, v232, v228
v_fma_f32 v81, v81, v232, v228
s_add_u32 m0, s39, 102400
s_add_u32 s37, s37, s55
buffer_load_dwordx4 v21, s[8:11], s37 offen sc1 lds
v_fma_f32 v82, v82, v232, v228
v_fma_f32 v83, v83, v232, v228
v_mul_f32 v80, v80, v160
v_mul_f32 v81, v81, v161
s_add_u32 m0, s39, 103424
s_add_u32 s37, s37, s38
buffer_load_dwordx4 v21, s[8:11], s37 offen sc1 lds
v_mul_f32 v82, v82, v162
v_mul_f32 v83, v83, v163
v_exp_f32 v80, v80
v_exp_f32 v81, v81
s_add_u32 m0, s39, 104448
s_add_u32 s37, s37, s38
buffer_load_dwordx4 v21, s[8:11], s37 offen sc1 lds
v_exp_f32 v82, v82
v_exp_f32 v83, v83
v_mul_f32 v208, v160, v208
v_mul_f32 v209, v161, v209
s_add_u32 m0, s39, 105472
s_add_u32 s37, s37, s38
buffer_load_dwordx4 v21, s[8:11], s37 offen sc1 lds
v_mul_f32 v210, v162, v210
v_mul_f32 v211, v163, v211
v_fma_f32 v80, v80, v236, v236
buffer_store_dwordx4 v[96:99], v27, s[24:27], 0 offen offset:0 sc1
s_waitcnt vmcnt(33)
s_barrier
s_add_u32 m0, s39, 122880
s_add_u32 s37, s37, s40
buffer_load_dwordx4 v21, s[8:11], s37 offen sc1 lds
v_fma_f32 v81, v81, v236, v236
v_fma_f32 v82, v82, v236, v236
v_fma_f32 v83, v83, v236, v236
v_rcp_f32 v80, v80
s_add_u32 m0, s39, 123904
s_add_u32 s37, s37, s38
buffer_load_dwordx4 v21, s[8:11], s37 offen sc1 lds
v_rcp_f32 v81, v81
v_rcp_f32 v82, v82
v_rcp_f32 v83, v83
v_mul_f32 v208, v208, v80
s_add_u32 m0, s39, 124928
s_add_u32 s37, s37, s38
buffer_load_dwordx4 v21, s[8:11], s37 offen sc1 lds
v_mul_f32 v209, v209, v81
v_mul_f32 v210, v210, v82
v_mul_f32 v211, v211, v83
v_cvt_pk_bf16_f32 v112, v208, v209
s_add_u32 m0, s39, 125952
s_add_u32 s37, s37, s38
buffer_load_dwordx4 v21, s[8:11], s37 offen sc1 lds
v_cvt_pk_bf16_f32 v113, v210, v211
v_mul_f32 v80, v132, v132
v_mul_f32 v81, v133, v133
s_add_u32 m0, s39, 126976
s_add_u32 s37, s37, s55
buffer_load_dwordx4 v21, s[8:11], s37 offen sc1 lds
v_mul_f32 v82, v134, v134
v_mul_f32 v83, v135, v135
v_fma_f32 v80, v80, v233, v229
v_fma_f32 v81, v81, v233, v229
s_add_u32 m0, s39, 128000
s_add_u32 s37, s37, s38
buffer_load_dwordx4 v21, s[8:11], s37 offen sc1 lds
v_fma_f32 v82, v82, v233, v229
v_fma_f32 v83, v83, v233, v229
v_mul_f32 v80, v80, v132
v_mul_f32 v81, v81, v133
s_add_u32 m0, s39, 129024
s_add_u32 s37, s37, s38
buffer_load_dwordx4 v21, s[8:11], s37 offen sc1 lds
v_mul_f32 v82, v82, v134
v_mul_f32 v83, v83, v135
v_exp_f32 v80, v80
v_exp_f32 v81, v81
s_add_u32 m0, s39, 130048
s_add_u32 s37, s37, s38
buffer_load_dwordx4 v21, s[8:11], s37 offen sc1 lds
v_exp_f32 v82, v82
v_exp_f32 v83, v83
v_mul_f32 v180, v132, v180
s_waitcnt vmcnt(33)
s_barrier
s_add_u32 m0, s39, 0
s_add_u32 s37, s37, s40
buffer_load_dwordx4 v21, s[8:11], s37 offen sc1 lds
v_mul_f32 v181, v133, v181
v_mul_f32 v182, v134, v182
v_mul_f32 v183, v135, v183
v_fma_f32 v80, v80, v237, v237
s_add_u32 m0, s39, 1024
s_add_u32 s37, s37, s38
buffer_load_dwordx4 v21, s[8:11], s37 offen sc1 lds
v_fma_f32 v81, v81, v237, v237
v_fma_f32 v82, v82, v237, v237
v_fma_f32 v83, v83, v237, v237
v_rcp_f32 v80, v80
s_add_u32 m0, s39, 2048
s_add_u32 s37, s37, s38
buffer_load_dwordx4 v21, s[8:11], s37 offen sc1 lds
v_rcp_f32 v81, v81
v_rcp_f32 v82, v82
v_rcp_f32 v83, v83
v_mul_f32 v180, v180, v80
s_add_u32 m0, s39, 3072
s_add_u32 s37, s37, s38
buffer_load_dwordx4 v21, s[8:11], s37 offen sc1 lds
v_mul_f32 v181, v181, v81
v_mul_f32 v182, v182, v82
v_mul_f32 v183, v183, v83
s_add_u32 m0, s39, 4096
s_add_u32 s37, s37, s55
buffer_load_dwordx4 v21, s[8:11], s37 offen sc1 lds
v_cvt_pk_bf16_f32 v100, v180, v181
v_cvt_pk_bf16_f32 v101, v182, v183
v_mul_f32 v84, v148, v148
v_mul_f32 v85, v149, v149
s_add_u32 m0, s39, 5120
s_add_u32 s37, s37, s38
buffer_load_dwordx4 v21, s[8:11], s37 offen sc1 lds
v_mul_f32 v86, v150, v150
v_mul_f32 v87, v151, v151
v_fma_f32 v84, v84, v233, v229
v_fma_f32 v85, v85, v233, v229
s_add_u32 m0, s39, 6144
s_add_u32 s37, s37, s38
buffer_load_dwordx4 v21, s[8:11], s37 offen sc1 lds
v_fma_f32 v86, v86, v233, v229
v_fma_f32 v87, v87, v233, v229
v_mul_f32 v84, v84, v148
v_mul_f32 v85, v85, v149
s_add_u32 m0, s39, 7168
s_add_u32 s37, s37, s38
buffer_load_dwordx4 v21, s[8:11], s37 offen sc1 lds
v_mul_f32 v86, v86, v150
v_mul_f32 v87, v87, v151
v_exp_f32 v84, v84
s_waitcnt vmcnt(33)
s_barrier
s_add_u32 m0, s39, 24576
s_add_u32 s37, s37, s40
buffer_load_dwordx4 v21, s[8:11], s37 offen sc1 lds
v_exp_f32 v85, v85
v_exp_f32 v86, v86
v_exp_f32 v87, v87
v_mul_f32 v196, v148, v196
s_add_u32 m0, s39, 25600
s_add_u32 s37, s37, s38
buffer_load_dwordx4 v21, s[8:11], s37 offen sc1 lds
v_mul_f32 v197, v149, v197
v_mul_f32 v198, v150, v198
v_mul_f32 v199, v151, v199
v_fma_f32 v84, v84, v237, v237
s_add_u32 m0, s39, 26624
s_add_u32 s37, s37, s38
buffer_load_dwordx4 v21, s[8:11], s37 offen sc1 lds
v_fma_f32 v85, v85, v237, v237
v_fma_f32 v86, v86, v237, v237
v_fma_f32 v87, v87, v237, v237
v_rcp_f32 v84, v84
s_add_u32 m0, s39, 27648
s_add_u32 s37, s37, s38
buffer_load_dwordx4 v21, s[8:11], s37 offen sc1 lds
v_rcp_f32 v85, v85
v_rcp_f32 v86, v86
v_rcp_f32 v87, v87
s_add_u32 m0, s39, 28672
s_add_u32 s37, s37, s55
buffer_load_dwordx4 v21, s[8:11], s37 offen sc1 lds
v_mul_f32 v196, v196, v84
v_mul_f32 v197, v197, v85
v_mul_f32 v198, v198, v86
v_mul_f32 v199, v199, v87
s_add_u32 m0, s39, 29696
s_add_u32 s37, s37, s38
buffer_load_dwordx4 v21, s[8:11], s37 offen sc1 lds
v_cvt_pk_bf16_f32 v102, v196, v197
v_cvt_pk_bf16_f32 v103, v198, v199
v_mul_f32 v80, v164, v164
s_add_u32 m0, s39, 30720
s_add_u32 s37, s37, s38
buffer_load_dwordx4 v21, s[8:11], s37 offen sc1 lds
v_mul_f32 v81, v165, v165
v_mul_f32 v82, v166, v166
v_mul_f32 v83, v167, v167
v_fma_f32 v80, v80, v233, v229
s_add_u32 m0, s39, 31744
s_add_u32 s37, s37, s38
buffer_load_dwordx4 v21, s[8:11], s37 offen sc1 lds
v_fma_f32 v81, v81, v233, v229
v_fma_f32 v82, v82, v233, v229
v_fma_f32 v83, v83, v233, v229
buffer_store_dwordx4 v[100:103], v27, s[24:27], 0 offen offset:256 sc1
s_waitcnt vmcnt(34)
s_barrier
s_add_u32 m0, s39, 49152
s_add_u32 s37, s37, s40
buffer_load_dwordx4 v21, s[8:11], s37 offen sc1 lds
v_mul_f32 v80, v80, v164
v_mul_f32 v81, v81, v165
v_mul_f32 v82, v82, v166
v_mul_f32 v83, v83, v167
s_add_u32 m0, s39, 50176
s_add_u32 s37, s37, s38
buffer_load_dwordx4 v21, s[8:11], s37 offen sc1 lds
v_exp_f32 v80, v80
v_exp_f32 v81, v81
v_exp_f32 v82, v82
v_exp_f32 v83, v83
s_add_u32 m0, s39, 51200
s_add_u32 s37, s37, s38
buffer_load_dwordx4 v21, s[8:11], s37 offen sc1 lds
v_mul_f32 v212, v164, v212
v_mul_f32 v213, v165, v213
v_mul_f32 v214, v166, v214
v_mul_f32 v215, v167, v215
s_add_u32 m0, s39, 52224
s_add_u32 s37, s37, s38
buffer_load_dwordx4 v21, s[8:11], s37 offen sc1 lds
v_fma_f32 v80, v80, v237, v237
v_fma_f32 v81, v81, v237, v237
v_fma_f32 v82, v82, v237, v237
s_add_u32 m0, s39, 53248
s_add_u32 s37, s37, s55
buffer_load_dwordx4 v21, s[8:11], s37 offen sc1 lds
v_fma_f32 v83, v83, v237, v237
v_rcp_f32 v80, v80
v_rcp_f32 v81, v81
v_rcp_f32 v82, v82
s_add_u32 m0, s39, 54272
s_add_u32 s37, s37, s38
buffer_load_dwordx4 v21, s[8:11], s37 offen sc1 lds
v_rcp_f32 v83, v83
v_mul_f32 v212, v212, v80
v_mul_f32 v213, v213, v81
v_mul_f32 v214, v214, v82
s_add_u32 m0, s39, 55296
s_add_u32 s37, s37, s38
buffer_load_dwordx4 v21, s[8:11], s37 offen sc1 lds
v_mul_f32 v215, v215, v83
v_cvt_pk_bf16_f32 v114, v212, v213
v_cvt_pk_bf16_f32 v115, v214, v215
s_nop 1
s_add_u32 m0, s39, 56320
s_add_u32 s37, s37, s38
buffer_load_dwordx4 v21, s[8:11], s37 offen sc1 lds
v_permlane32_swap_b32 v112, v114
v_permlane32_swap_b32 v113, v115
buffer_store_dwordx4 v[112:115], v28, s[24:27], 0 offen offset:0 sc1
s_waitcnt vmcnt(35)
s_barrier
s_add_u32 m0, s39, 73728
s_add_u32 s37, s37, s40
buffer_load_dwordx4 v21, s[8:11], s37 offen sc1 lds
v_mul_f32 v80, v136, v136
v_mul_f32 v81, v137, v137
v_mul_f32 v82, v138, v138
v_mul_f32 v83, v139, v139
s_add_u32 m0, s39, 74752
s_add_u32 s37, s37, s38
buffer_load_dwordx4 v21, s[8:11], s37 offen sc1 lds
v_fma_f32 v80, v80, v234, v230
v_fma_f32 v81, v81, v234, v230
v_fma_f32 v82, v82, v234, v230
v_fma_f32 v83, v83, v234, v230
s_add_u32 m0, s39, 75776
s_add_u32 s37, s37, s38
buffer_load_dwordx4 v21, s[8:11], s37 offen sc1 lds
v_mul_f32 v80, v80, v136
v_mul_f32 v81, v81, v137
v_mul_f32 v82, v82, v138
v_mul_f32 v83, v83, v139
s_add_u32 m0, s39, 76800
s_add_u32 s37, s37, s38
buffer_load_dwordx4 v21, s[8:11], s37 offen sc1 lds
v_exp_f32 v80, v80
v_exp_f32 v81, v81
v_exp_f32 v82, v82
s_add_u32 m0, s39, 77824
s_add_u32 s37, s37, s55
buffer_load_dwordx4 v21, s[8:11], s37 offen sc1 lds
v_exp_f32 v83, v83
v_mul_f32 v184, v136, v184
v_mul_f32 v185, v137, v185
v_mul_f32 v186, v138, v186
s_add_u32 m0, s39, 78848
s_add_u32 s37, s37, s38
buffer_load_dwordx4 v21, s[8:11], s37 offen sc1 lds
v_mul_f32 v187, v139, v187
v_fma_f32 v80, v80, v238, v238
v_fma_f32 v81, v81, v238, v238
v_fma_f32 v82, v82, v238, v238
s_add_u32 m0, s39, 79872
s_add_u32 s37, s37, s38
buffer_load_dwordx4 v21, s[8:11], s37 offen sc1 lds
v_fma_f32 v83, v83, v238, v238
v_rcp_f32 v80, v80
v_rcp_f32 v81, v81
v_rcp_f32 v82, v82
s_add_u32 m0, s39, 80896
s_add_u32 s37, s37, s38
buffer_load_dwordx4 v21, s[8:11], s37 offen sc1 lds
v_rcp_f32 v83, v83
v_mul_f32 v184, v184, v80
v_mul_f32 v185, v185, v81
s_waitcnt vmcnt(34)
s_barrier
s_add_u32 m0, s39, 98304
s_add_u32 s37, s37, s40
buffer_load_dwordx4 v21, s[8:11], s37 offen sc1 lds
v_mul_f32 v186, v186, v82
v_mul_f32 v187, v187, v83
v_cvt_pk_bf16_f32 v104, v184, v185
v_cvt_pk_bf16_f32 v105, v186, v187
s_add_u32 m0, s39, 99328
s_add_u32 s37, s37, s38
buffer_load_dwordx4 v21, s[8:11], s37 offen sc1 lds
v_mul_f32 v84, v152, v152
v_mul_f32 v85, v153, v153
v_mul_f32 v86, v154, v154
v_mul_f32 v87, v155, v155
s_add_u32 m0, s39, 100352
s_add_u32 s37, s37, s38
buffer_load_dwordx4 v21, s[8:11], s37 offen sc1 lds
v_fma_f32 v84, v84, v234, v230
v_fma_f32 v85, v85, v234, v230
v_fma_f32 v86, v86, v234, v230
v_fma_f32 v87, v87, v234, v230
s_add_u32 m0, s39, 101376
s_add_u32 s37, s37, s38
buffer_load_dwordx4 v21, s[8:11], s37 offen sc1 lds
v_mul_f32 v84, v84, v152
v_mul_f32 v85, v85, v153
v_mul_f32 v86, v86, v154
s_add_u32 m0, s39, 102400
s_add_u32 s37, s37, s55
buffer_load_dwordx4 v21, s[8:11], s37 offen sc1 lds
v_mul_f32 v87, v87, v155
v_exp_f32 v84, v84
v_exp_f32 v85, v85
v_exp_f32 v86, v86
s_add_u32 m0, s39, 103424
s_add_u32 s37, s37, s38
buffer_load_dwordx4 v21, s[8:11], s37 offen sc1 lds
v_exp_f32 v87, v87
v_mul_f32 v200, v152, v200
v_mul_f32 v201, v153, v201
v_mul_f32 v202, v154, v202
s_add_u32 m0, s39, 104448
s_add_u32 s37, s37, s38
buffer_load_dwordx4 v21, s[8:11], s37 offen sc1 lds
v_mul_f32 v203, v155, v203
v_fma_f32 v84, v84, v238, v238
v_fma_f32 v85, v85, v238, v238
v_fma_f32 v86, v86, v238, v238
s_add_u32 m0, s39, 105472
s_add_u32 s37, s37, s38
buffer_load_dwordx4 v21, s[8:11], s37 offen sc1 lds
v_fma_f32 v87, v87, v238, v238
v_rcp_f32 v84, v84
v_rcp_f32 v85, v85
s_waitcnt vmcnt(34)
s_barrier
s_add_u32 m0, s39, 122880
s_add_u32 s37, s37, s40
buffer_load_dwordx4 v21, s[8:11], s37 offen sc1 lds
v_rcp_f32 v86, v86
v_rcp_f32 v87, v87
v_mul_f32 v200, v200, v84
v_mul_f32 v201, v201, v85
s_add_u32 m0, s39, 123904
s_add_u32 s37, s37, s38
buffer_load_dwordx4 v21, s[8:11], s37 offen sc1 lds
v_mul_f32 v202, v202, v86
v_mul_f32 v203, v203, v87
v_cvt_pk_bf16_f32 v106, v200, v201
v_cvt_pk_bf16_f32 v107, v202, v203
s_add_u32 m0, s39, 124928
s_add_u32 s37, s37, s38
buffer_load_dwordx4 v21, s[8:11], s37 offen sc1 lds
v_mul_f32 v80, v168, v168
v_mul_f32 v81, v169, v169
v_mul_f32 v82, v170, v170
s_add_u32 m0, s39, 125952
s_add_u32 s37, s37, s38
buffer_load_dwordx4 v21, s[8:11], s37 offen sc1 lds
v_mul_f32 v83, v171, v171
v_fma_f32 v80, v80, v234, v230
v_fma_f32 v81, v81, v234, v230
s_add_u32 m0, s39, 126976
s_add_u32 s37, s37, s55
buffer_load_dwordx4 v21, s[8:11], s37 offen sc1 lds
v_fma_f32 v82, v82, v234, v230
v_fma_f32 v83, v83, v234, v230
v_mul_f32 v80, v80, v168
v_mul_f32 v81, v81, v169
s_add_u32 m0, s39, 128000
s_add_u32 s37, s37, s38
buffer_load_dwordx4 v21, s[8:11], s37 offen sc1 lds
v_mul_f32 v82, v82, v170
v_mul_f32 v83, v83, v171
v_exp_f32 v80, v80
v_exp_f32 v81, v81
s_add_u32 m0, s39, 129024
s_add_u32 s37, s37, s38
buffer_load_dwordx4 v21, s[8:11], s37 offen sc1 lds
v_exp_f32 v82, v82
v_exp_f32 v83, v83
v_mul_f32 v216, v168, v216
v_mul_f32 v217, v169, v217
s_add_u32 m0, s39, 130048
s_add_u32 s37, s37, s38
buffer_load_dwordx4 v21, s[8:11], s37 offen sc1 lds
v_mul_f32 v218, v170, v218
v_mul_f32 v219, v171, v219
v_fma_f32 v80, v80, v238, v238
buffer_store_dwordx4 v[104:107], v27, s[24:27], 0 offen offset:512 sc1
s_waitcnt vmcnt(35)
s_barrier
s_add_u32 s37, s37, s54
s_add_u32 m0, s39, 0
s_add_u32 s37, s37, s40
buffer_load_dwordx4 v21, s[8:11], s37 offen sc1 lds
v_fma_f32 v81, v81, v238, v238
v_fma_f32 v82, v82, v238, v238
v_fma_f32 v83, v83, v238, v238
v_rcp_f32 v80, v80
s_add_u32 m0, s39, 1024
s_add_u32 s37, s37, s38
buffer_load_dwordx4 v21, s[8:11], s37 offen sc1 lds
v_rcp_f32 v81, v81
v_rcp_f32 v82, v82
v_rcp_f32 v83, v83
v_mul_f32 v216, v216, v80
s_add_u32 m0, s39, 2048
s_add_u32 s37, s37, s38
buffer_load_dwordx4 v21, s[8:11], s37 offen sc1 lds
v_mul_f32 v217, v217, v81
v_mul_f32 v218, v218, v82
v_mul_f32 v219, v219, v83
v_cvt_pk_bf16_f32 v116, v216, v217
s_add_u32 m0, s39, 3072
s_add_u32 s37, s37, s38
buffer_load_dwordx4 v21, s[8:11], s37 offen sc1 lds
v_cvt_pk_bf16_f32 v117, v218, v219
v_mul_f32 v80, v140, v140
v_mul_f32 v81, v141, v141
s_add_u32 m0, s39, 4096
s_add_u32 s37, s37, s55
buffer_load_dwordx4 v21, s[8:11], s37 offen sc1 lds
v_mul_f32 v82, v142, v142
v_mul_f32 v83, v143, v143
v_fma_f32 v80, v80, v235, v231
v_fma_f32 v81, v81, v235, v231
s_add_u32 m0, s39, 5120
s_add_u32 s37, s37, s38
buffer_load_dwordx4 v21, s[8:11], s37 offen sc1 lds
v_fma_f32 v82, v82, v235, v231
v_fma_f32 v83, v83, v235, v231
v_mul_f32 v80, v80, v140
v_mul_f32 v81, v81, v141
s_add_u32 m0, s39, 6144
s_add_u32 s37, s37, s38
buffer_load_dwordx4 v21, s[8:11], s37 offen sc1 lds
v_mul_f32 v82, v82, v142
v_mul_f32 v83, v83, v143
v_exp_f32 v80, v80
v_exp_f32 v81, v81
s_add_u32 m0, s39, 7168
s_add_u32 s37, s37, s38
buffer_load_dwordx4 v21, s[8:11], s37 offen sc1 lds
v_exp_f32 v82, v82
v_exp_f32 v83, v83
v_mul_f32 v188, v140, v188
s_waitcnt vmcnt(34)
s_barrier
s_add_u32 m0, s39, 24576
s_add_u32 s37, s37, s40
buffer_load_dwordx4 v21, s[8:11], s37 offen sc1 lds
v_mul_f32 v189, v141, v189
v_mul_f32 v190, v142, v190
v_mul_f32 v191, v143, v191
v_fma_f32 v80, v80, v239, v239
s_add_u32 m0, s39, 25600
s_add_u32 s37, s37, s38
buffer_load_dwordx4 v21, s[8:11], s37 offen sc1 lds
v_fma_f32 v81, v81, v239, v239
v_fma_f32 v82, v82, v239, v239
v_fma_f32 v83, v83, v239, v239
v_rcp_f32 v80, v80
s_add_u32 m0, s39, 26624
s_add_u32 s37, s37, s38
buffer_load_dwordx4 v21, s[8:11], s37 offen sc1 lds
v_rcp_f32 v81, v81
v_rcp_f32 v82, v82
v_rcp_f32 v83, v83
v_mul_f32 v188, v188, v80
s_add_u32 m0, s39, 27648
s_add_u32 s37, s37, s38
buffer_load_dwordx4 v21, s[8:11], s37 offen sc1 lds
v_mul_f32 v189, v189, v81
v_mul_f32 v190, v190, v82
v_mul_f32 v191, v191, v83
s_add_u32 m0, s39, 28672
s_add_u32 s37, s37, s55
buffer_load_dwordx4 v21, s[8:11], s37 offen sc1 lds
v_cvt_pk_bf16_f32 v108, v188, v189
v_cvt_pk_bf16_f32 v109, v190, v191
v_mul_f32 v84, v156, v156
v_mul_f32 v85, v157, v157
s_add_u32 m0, s39, 29696
s_add_u32 s37, s37, s38
buffer_load_dwordx4 v21, s[8:11], s37 offen sc1 lds
v_mul_f32 v86, v158, v158
v_mul_f32 v87, v159, v159
v_fma_f32 v84, v84, v235, v231
v_fma_f32 v85, v85, v235, v231
s_add_u32 m0, s39, 30720
s_add_u32 s37, s37, s38
buffer_load_dwordx4 v21, s[8:11], s37 offen sc1 lds
v_fma_f32 v86, v86, v235, v231
v_fma_f32 v87, v87, v235, v231
v_mul_f32 v84, v84, v156
v_mul_f32 v85, v85, v157
s_add_u32 m0, s39, 31744
s_add_u32 s37, s37, s38
buffer_load_dwordx4 v21, s[8:11], s37 offen sc1 lds
v_mul_f32 v86, v86, v158
v_mul_f32 v87, v87, v159
v_exp_f32 v84, v84
s_waitcnt vmcnt(33)
s_barrier
s_add_u32 m0, s39, 49152
s_add_u32 s37, s37, s40
buffer_load_dwordx4 v21, s[8:11], s37 offen sc1 lds
v_exp_f32 v85, v85
v_exp_f32 v86, v86
v_exp_f32 v87, v87
v_mul_f32 v204, v156, v204
s_add_u32 m0, s39, 50176
s_add_u32 s37, s37, s38
buffer_load_dwordx4 v21, s[8:11], s37 offen sc1 lds
v_mul_f32 v205, v157, v205
v_mul_f32 v206, v158, v206
v_mul_f32 v207, v159, v207
v_fma_f32 v84, v84, v239, v239
s_add_u32 m0, s39, 51200
s_add_u32 s37, s37, s38
buffer_load_dwordx4 v21, s[8:11], s37 offen sc1 lds
v_fma_f32 v85, v85, v239, v239
v_fma_f32 v86, v86, v239, v239
v_fma_f32 v87, v87, v239, v239
v_rcp_f32 v84, v84
s_add_u32 m0, s39, 52224
s_add_u32 s37, s37, s38
buffer_load_dwordx4 v21, s[8:11], s37 offen sc1 lds
v_rcp_f32 v85, v85
v_rcp_f32 v86, v86
v_rcp_f32 v87, v87
s_add_u32 m0, s39, 53248
s_add_u32 s37, s37, s55
buffer_load_dwordx4 v21, s[8:11], s37 offen sc1 lds
v_mul_f32 v204, v204, v84
v_mul_f32 v205, v205, v85
v_mul_f32 v206, v206, v86
v_mul_f32 v207, v207, v87
s_add_u32 m0, s39, 54272
s_add_u32 s37, s37, s38
buffer_load_dwordx4 v21, s[8:11], s37 offen sc1 lds
v_cvt_pk_bf16_f32 v110, v204, v205
v_cvt_pk_bf16_f32 v111, v206, v207
v_mul_f32 v80, v172, v172
s_add_u32 m0, s39, 55296
s_add_u32 s37, s37, s38
buffer_load_dwordx4 v21, s[8:11], s37 offen sc1 lds
v_mul_f32 v81, v173, v173
v_mul_f32 v82, v174, v174
v_mul_f32 v83, v175, v175
v_fma_f32 v80, v80, v235, v231
s_add_u32 m0, s39, 56320
s_add_u32 s37, s37, s38
buffer_load_dwordx4 v21, s[8:11], s37 offen sc1 lds
v_fma_f32 v81, v81, v235, v231
v_fma_f32 v82, v82, v235, v231
v_fma_f32 v83, v83, v235, v231
buffer_store_dwordx4 v[108:111], v27, s[24:27], 0 offen offset:768 sc1
s_waitcnt vmcnt(34)
s_barrier
s_add_u32 m0, s39, 73728
s_add_u32 s37, s37, s40
buffer_load_dwordx4 v21, s[8:11], s37 offen sc1 lds
v_mul_f32 v80, v80, v172
v_mul_f32 v81, v81, v173
v_mul_f32 v82, v82, v174
v_mul_f32 v83, v83, v175
s_add_u32 m0, s39, 74752
s_add_u32 s37, s37, s38
buffer_load_dwordx4 v21, s[8:11], s37 offen sc1 lds
v_exp_f32 v80, v80
v_exp_f32 v81, v81
v_exp_f32 v82, v82
v_exp_f32 v83, v83
s_add_u32 m0, s39, 75776
s_add_u32 s37, s37, s38
buffer_load_dwordx4 v21, s[8:11], s37 offen sc1 lds
v_mul_f32 v220, v172, v220
v_mul_f32 v221, v173, v221
v_mul_f32 v222, v174, v222
v_mul_f32 v223, v175, v223
s_add_u32 m0, s39, 76800
s_add_u32 s37, s37, s38
buffer_load_dwordx4 v21, s[8:11], s37 offen sc1 lds
v_fma_f32 v80, v80, v239, v239
v_fma_f32 v81, v81, v239, v239
v_fma_f32 v82, v82, v239, v239
s_add_u32 m0, s39, 77824
s_add_u32 s37, s37, s55
buffer_load_dwordx4 v21, s[8:11], s37 offen sc1 lds
v_fma_f32 v83, v83, v239, v239
v_rcp_f32 v80, v80
v_rcp_f32 v81, v81
v_rcp_f32 v82, v82
s_add_u32 m0, s39, 78848
s_add_u32 s37, s37, s38
buffer_load_dwordx4 v21, s[8:11], s37 offen sc1 lds
v_rcp_f32 v83, v83
v_mul_f32 v220, v220, v80
v_mul_f32 v221, v221, v81
v_mul_f32 v222, v222, v82
s_add_u32 m0, s39, 79872
s_add_u32 s37, s37, s38
buffer_load_dwordx4 v21, s[8:11], s37 offen sc1 lds
v_mul_f32 v223, v223, v83
v_cvt_pk_bf16_f32 v118, v220, v221
v_cvt_pk_bf16_f32 v119, v222, v223
s_nop 1
s_add_u32 m0, s39, 80896
s_add_u32 s37, s37, s38
buffer_load_dwordx4 v21, s[8:11], s37 offen sc1 lds
v_permlane32_swap_b32 v116, v118
v_permlane32_swap_b32 v117, v119
buffer_store_dwordx4 v[116:119], v28, s[24:27], 0 offen offset:512 sc1
s_waitcnt vmcnt(35)
s_barrier
s_add_u32 m0, s39, 98304
s_add_u32 s37, s37, s40
buffer_load_dwordx4 v21, s[8:11], s37 offen sc1 lds
s_add_u32 m0, s39, 99328
s_add_u32 s37, s37, s38
buffer_load_dwordx4 v21, s[8:11], s37 offen sc1 lds
s_add_u32 m0, s39, 100352
s_add_u32 s37, s37, s38
buffer_load_dwordx4 v21, s[8:11], s37 offen sc1 lds
s_add_u32 m0, s39, 101376
s_add_u32 s37, s37, s38
buffer_load_dwordx4 v21, s[8:11], s37 offen sc1 lds
s_add_u32 m0, s39, 102400
s_add_u32 s37, s37, s55
buffer_load_dwordx4 v21, s[8:11], s37 offen sc1 lds
s_add_u32 m0, s39, 103424
s_add_u32 s37, s37, s38
buffer_load_dwordx4 v21, s[8:11], s37 offen sc1 lds
s_add_u32 m0, s39, 104448
s_add_u32 s37, s37, s38
buffer_load_dwordx4 v21, s[8:11], s37 offen sc1 lds
s_add_u32 m0, s39, 105472
s_add_u32 s37, s37, s38
buffer_load_dwordx4 v21, s[8:11], s37 offen sc1 lds
s_waitcnt vmcnt(34)
s_barrier
s_add_u32 m0, s39, 122880
s_add_u32 s37, s37, s40
buffer_load_dwordx4 v21, s[8:11], s37 offen sc1 lds
s_add_u32 m0, s39, 123904
s_add_u32 s37, s37, s38
buffer_load_dwordx4 v21, s[8:11], s37 offen sc1 lds
s_add_u32 m0, s39, 124928
s_add_u32 s37, s37, s38
buffer_load_dwordx4 v21, s[8:11], s37 offen sc1 lds
s_add_u32 m0, s39, 125952
s_add_u32 s37, s37, s38
buffer_load_dwordx4 v21, s[8:11], s37 offen sc1 lds
s_add_u32 m0, s39, 126976
s_add_u32 s37, s37, s55
buffer_load_dwordx4 v21, s[8:11], s37 offen sc1 lds
s_add_u32 m0, s39, 128000
s_add_u32 s37, s37, s38
buffer_load_dwordx4 v21, s[8:11], s37 offen sc1 lds
s_add_u32 m0, s39, 129024
s_add_u32 s37, s37, s38
buffer_load_dwordx4 v21, s[8:11], s37 offen sc1 lds
s_add_u32 m0, s39, 130048
s_add_u32 s37, s37, s38
buffer_load_dwordx4 v21, s[8:11], s37 offen sc1 lds
s_waitcnt vmcnt(16)
s_barrier
s_add_u32 m0, s39, 0
s_add_u32 s37, s37, s40
buffer_load_dwordx4 v21, s[8:11], s37 offen sc1 lds
s_add_u32 m0, s39, 1024
s_add_u32 s37, s37, s38
buffer_load_dwordx4 v21, s[8:11], s37 offen sc1 lds
s_add_u32 m0, s39, 2048
s_add_u32 s37, s37, s38
buffer_load_dwordx4 v21, s[8:11], s37 offen sc1 lds
s_add_u32 m0, s39, 3072
s_add_u32 s37, s37, s38
buffer_load_dwordx4 v21, s[8:11], s37 offen sc1 lds
s_add_u32 m0, s39, 4096
s_add_u32 s37, s37, s55
buffer_load_dwordx4 v21, s[8:11], s37 offen sc1 lds
s_add_u32 m0, s39, 5120
s_add_u32 s37, s37, s38
buffer_load_dwordx4 v21, s[8:11], s37 offen sc1 lds
s_add_u32 m0, s39, 6144
s_add_u32 s37, s37, s38
buffer_load_dwordx4 v21, s[8:11], s37 offen sc1 lds
s_add_u32 m0, s39, 7168
s_add_u32 s37, s37, s38
buffer_load_dwordx4 v21, s[8:11], s37 offen sc1 lds
s_waitcnt vmcnt(34)
s_barrier
s_add_u32 m0, s39, 24576
s_add_u32 s37, s37, s40
buffer_load_dwordx4 v21, s[8:11], s37 offen sc1 lds
s_add_u32 m0, s39, 25600
s_add_u32 s37, s37, s38
buffer_load_dwordx4 v21, s[8:11], s37 offen sc1 lds
s_add_u32 m0, s39, 26624
s_add_u32 s37, s37, s38
buffer_load_dwordx4 v21, s[8:11], s37 offen sc1 lds
s_add_u32 m0, s39, 27648
s_add_u32 s37, s37, s38
buffer_load_dwordx4 v21, s[8:11], s37 offen sc1 lds
s_add_u32 m0, s39, 28672
s_add_u32 s37, s37, s55
buffer_load_dwordx4 v21, s[8:11], s37 offen sc1 lds
s_add_u32 m0, s39, 29696
s_add_u32 s37, s37, s38
buffer_load_dwordx4 v21, s[8:11], s37 offen sc1 lds
s_add_u32 m0, s39, 30720
s_add_u32 s37, s37, s38
buffer_load_dwordx4 v21, s[8:11], s37 offen sc1 lds
s_add_u32 m0, s39, 31744
s_add_u32 s37, s37, s38
buffer_load_dwordx4 v21, s[8:11], s37 offen sc1 lds
s_waitcnt vmcnt(33)
s_barrier
s_add_u32 m0, s39, 49152
s_add_u32 s37, s37, s40
buffer_load_dwordx4 v21, s[8:11], s37 offen sc1 lds
s_add_u32 m0, s39, 50176
s_add_u32 s37, s37, s38
buffer_load_dwordx4 v21, s[8:11], s37 offen sc1 lds
s_add_u32 m0, s39, 51200
s_add_u32 s37, s37, s38
buffer_load_dwordx4 v21, s[8:11], s37 offen sc1 lds
s_add_u32 m0, s39, 52224
s_add_u32 s37, s37, s38
buffer_load_dwordx4 v21, s[8:11], s37 offen sc1 lds
s_add_u32 m0, s39, 53248
s_add_u32 s37, s37, s55
buffer_load_dwordx4 v21, s[8:11], s37 offen sc1 lds
s_add_u32 m0, s39, 54272
s_add_u32 s37, s37, s38
buffer_load_dwordx4 v21, s[8:11], s37 offen sc1 lds
s_add_u32 m0, s39, 55296
s_add_u32 s37, s37, s38
buffer_load_dwordx4 v21, s[8:11], s37 offen sc1 lds
s_add_u32 m0, s39, 56320
s_add_u32 s37, s37, s38
buffer_load_dwordx4 v21, s[8:11], s37 offen sc1 lds
s_waitcnt vmcnt(32)
s_barrier
s_add_u32 m0, s39, 73728
s_add_u32 s37, s37, s40
buffer_load_dwordx4 v21, s[8:11], s37 offen sc1 lds
s_add_u32 m0, s39, 74752
s_add_u32 s37, s37, s38
buffer_load_dwordx4 v21, s[8:11], s37 offen sc1 lds
s_add_u32 m0, s39, 75776
s_add_u32 s37, s37, s38
buffer_load_dwordx4 v21, s[8:11], s37 offen sc1 lds
s_add_u32 m0, s39, 76800
s_add_u32 s37, s37, s38
buffer_load_dwordx4 v21, s[8:11], s37 offen sc1 lds
s_add_u32 m0, s39, 77824
s_add_u32 s37, s37, s55
buffer_load_dwordx4 v21, s[8:11], s37 offen sc1 lds
s_add_u32 m0, s39, 78848
s_add_u32 s37, s37, s38
buffer_load_dwordx4 v21, s[8:11], s37 offen sc1 lds
s_add_u32 m0, s39, 79872
s_add_u32 s37, s37, s38
buffer_load_dwordx4 v21, s[8:11], s37 offen sc1 lds
s_add_u32 m0, s39, 80896
s_add_u32 s37, s37, s38
buffer_load_dwordx4 v21, s[8:11], s37 offen sc1 lds
s_waitcnt vmcnt(32)
s_barrier
s_mov_b32 s41, 1
Lp4_42:
s_add_u32 m0, s39, 98304
s_add_u32 s37, s37, s40
buffer_load_dwordx4 v21, s[8:11], s37 offen sc1 lds
s_add_u32 m0, s39, 99328
s_add_u32 s37, s37, s38
buffer_load_dwordx4 v21, s[8:11], s37 offen sc1 lds
s_add_u32 m0, s39, 100352
s_add_u32 s37, s37, s38
buffer_load_dwordx4 v21, s[8:11], s37 offen sc1 lds
s_add_u32 m0, s39, 101376
s_add_u32 s37, s37, s38
buffer_load_dwordx4 v21, s[8:11], s37 offen sc1 lds
s_add_u32 m0, s39, 102400
s_add_u32 s37, s37, s55
buffer_load_dwordx4 v21, s[8:11], s37 offen sc1 lds
s_add_u32 m0, s39, 103424
s_add_u32 s37, s37, s38
buffer_load_dwordx4 v21, s[8:11], s37 offen sc1 lds
s_add_u32 m0, s39, 104448
s_add_u32 s37, s37, s38
buffer_load_dwordx4 v21, s[8:11], s37 offen sc1 lds
s_add_u32 m0, s39, 105472
s_add_u32 s37, s37, s38
buffer_load_dwordx4 v21, s[8:11], s37 offen sc1 lds
s_waitcnt vmcnt(32)
s_barrier
s_add_u32 m0, s39, 122880
s_add_u32 s37, s37, s40
buffer_load_dwordx4 v21, s[8:11], s37 offen sc1 lds
s_add_u32 m0, s39, 123904
s_add_u32 s37, s37, s38
buffer_load_dwordx4 v21, s[8:11], s37 offen sc1 lds
s_add_u32 m0, s39, 124928
s_add_u32 s37, s37, s38
buffer_load_dwordx4 v21, s[8:11], s37 offen sc1 lds
s_add_u32 m0, s39, 125952
s_add_u32 s37, s37, s38
buffer_load_dwordx4 v21, s[8:11], s37 offen sc1 lds
s_add_u32 m0, s39, 126976
s_add_u32 s37, s37, s55
buffer_load_dwordx4 v21, s[8:11], s37 offen sc1 lds
s_add_u32 m0, s39, 128000
s_add_u32 s37, s37, s38
buffer_load_dwordx4 v21, s[8:11], s37 offen sc1 lds
s_add_u32 m0, s39, 129024
s_add_u32 s37, s37, s38
buffer_load_dwordx4 v21, s[8:11], s37 offen sc1 lds
s_add_u32 m0, s39, 130048
s_add_u32 s37, s37, s38
buffer_load_dwordx4 v21, s[8:11], s37 offen sc1 lds
s_waitcnt vmcnt(32)
s_barrier
s_add_u32 m0, s39, 0
s_add_u32 s37, s37, s40
buffer_load_dwordx4 v21, s[8:11], s37 offen sc1 lds
s_add_u32 m0, s39, 1024
s_add_u32 s37, s37, s38
buffer_load_dwordx4 v21, s[8:11], s37 offen sc1 lds
s_add_u32 m0, s39, 2048
s_add_u32 s37, s37, s38
buffer_load_dwordx4 v21, s[8:11], s37 offen sc1 lds
s_add_u32 m0, s39, 3072
s_add_u32 s37, s37, s38
buffer_load_dwordx4 v21, s[8:11], s37 offen sc1 lds
s_add_u32 m0, s39, 4096
s_add_u32 s37, s37, s55
buffer_load_dwordx4 v21, s[8:11], s37 offen sc1 lds
s_add_u32 m0, s39, 5120
s_add_u32 s37, s37, s38
buffer_load_dwordx4 v21, s[8:11], s37 offen sc1 lds
s_add_u32 m0, s39, 6144
s_add_u32 s37, s37, s38
buffer_load_dwordx4 v21, s[8:11], s37 offen sc1 lds
s_add_u32 m0, s39, 7168
s_add_u32 s37, s37, s38
buffer_load_dwordx4 v21, s[8:11], s37 offen sc1 lds
s_waitcnt vmcnt(32)
s_barrier
s_add_u32 m0, s39, 24576
s_add_u32 s37, s37, s40
buffer_load_dwordx4 v21, s[8:11], s37 offen sc1 lds
s_add_u32 m0, s39, 25600
s_add_u32 s37, s37, s38
buffer_load_dwordx4 v21, s[8:11], s37 offen sc1 lds
s_add_u32 m0, s39, 26624
s_add_u32 s37, s37, s38
buffer_load_dwordx4 v21, s[8:11], s37 offen sc1 lds
s_add_u32 m0, s39, 27648
s_add_u32 s37, s37, s38
buffer_load_dwordx4 v21, s[8:11], s37 offen sc1 lds
s_add_u32 m0, s39, 28672
s_add_u32 s37, s37, s55
buffer_load_dwordx4 v21, s[8:11], s37 offen sc1 lds
s_add_u32 m0, s39, 29696
s_add_u32 s37, s37, s38
buffer_load_dwordx4 v21, s[8:11], s37 offen sc1 lds
s_add_u32 m0, s39, 30720
s_add_u32 s37, s37, s38
buffer_load_dwordx4 v21, s[8:11], s37 offen sc1 lds
s_add_u32 m0, s39, 31744
s_add_u32 s37, s37, s38
buffer_load_dwordx4 v21, s[8:11], s37 offen sc1 lds
s_waitcnt vmcnt(32)
s_barrier
s_add_u32 m0, s39, 49152
s_add_u32 s37, s37, s40
buffer_load_dwordx4 v21, s[8:11], s37 offen sc1 lds
s_add_u32 m0, s39, 50176
s_add_u32 s37, s37, s38
buffer_load_dwordx4 v21, s[8:11], s37 offen sc1 lds
s_add_u32 m0, s39, 51200
s_add_u32 s37, s37, s38
buffer_load_dwordx4 v21, s[8:11], s37 offen sc1 lds
s_add_u32 m0, s39, 52224
s_add_u32 s37, s37, s38
buffer_load_dwordx4 v21, s[8:11], s37 offen sc1 lds
s_add_u32 m0, s39, 53248
s_add_u32 s37, s37, s55
buffer_load_dwordx4 v21, s[8:11], s37 offen sc1 lds
s_add_u32 m0, s39, 54272
s_add_u32 s37, s37, s38
buffer_load_dwordx4 v21, s[8:11], s37 offen sc1 lds
s_add_u32 m0, s39, 55296
s_add_u32 s37, s37, s38
buffer_load_dwordx4 v21, s[8:11], s37 offen sc1 lds
s_add_u32 m0, s39, 56320
s_add_u32 s37, s37, s38
buffer_load_dwordx4 v21, s[8:11], s37 offen sc1 lds
s_waitcnt vmcnt(32)
s_barrier
s_add_u32 m0, s39, 73728
s_add_u32 s37, s37, s40
buffer_load_dwordx4 v21, s[8:11], s37 offen sc1 lds
s_add_u32 m0, s39, 74752
s_add_u32 s37, s37, s38
buffer_load_dwordx4 v21, s[8:11], s37 offen sc1 lds
s_add_u32 m0, s39, 75776
s_add_u32 s37, s37, s38
buffer_load_dwordx4 v21, s[8:11], s37 offen sc1 lds
s_add_u32 m0, s39, 76800
s_add_u32 s37, s37, s38
buffer_load_dwordx4 v21, s[8:11], s37 offen sc1 lds
s_add_u32 m0, s39, 77824
s_add_u32 s37, s37, s55
buffer_load_dwordx4 v21, s[8:11], s37 offen sc1 lds
s_add_u32 m0, s39, 78848
s_add_u32 s37, s37, s38
buffer_load_dwordx4 v21, s[8:11], s37 offen sc1 lds
s_add_u32 m0, s39, 79872
s_add_u32 s37, s37, s38
buffer_load_dwordx4 v21, s[8:11], s37 offen sc1 lds
s_add_u32 m0, s39, 80896
s_add_u32 s37, s37, s38
buffer_load_dwordx4 v21, s[8:11], s37 offen sc1 lds
s_waitcnt vmcnt(32)
s_barrier
s_sub_u32 s41, s41, 1
s_cmp_lg_u32 s41, 0
s_cbranch_scc1 Lp4_42
s_cmp_eq_u32 s51, 2
s_cbranch_scc1 LW4_43
s_mov_b32 s41, 4
Lp4_44:
s_add_u32 m0, s39, 98304
s_add_u32 s37, s37, s40
buffer_load_dwordx4 v21, s[8:11], s37 offen sc1 lds
s_add_u32 m0, s39, 99328
s_add_u32 s37, s37, s38
buffer_load_dwordx4 v21, s[8:11], s37 offen sc1 lds
s_add_u32 m0, s39, 100352
s_add_u32 s37, s37, s38
buffer_load_dwordx4 v21, s[8:11], s37 offen sc1 lds
s_add_u32 m0, s39, 101376
s_add_u32 s37, s37, s38
buffer_load_dwordx4 v21, s[8:11], s37 offen sc1 lds
s_add_u32 m0, s39, 102400
s_add_u32 s37, s37, s55
buffer_load_dwordx4 v21, s[8:11], s37 offen sc1 lds
s_add_u32 m0, s39, 103424
s_add_u32 s37, s37, s38
buffer_load_dwordx4 v21, s[8:11], s37 offen sc1 lds
s_add_u32 m0, s39, 104448
s_add_u32 s37, s37, s38
buffer_load_dwordx4 v21, s[8:11], s37 offen sc1 lds
s_add_u32 m0, s39, 105472
s_add_u32 s37, s37, s38
buffer_load_dwordx4 v21, s[8:11], s37 offen sc1 lds
s_waitcnt vmcnt(32)
s_barrier
s_add_u32 m0, s39, 122880
s_add_u32 s37, s37, s40
buffer_load_dwordx4 v21, s[8:11], s37 offen sc1 lds
s_add_u32 m0, s39, 123904
s_add_u32 s37, s37, s38
buffer_load_dwordx4 v21, s[8:11], s37 offen sc1 lds
s_add_u32 m0, s39, 124928
s_add_u32 s37, s37, s38
buffer_load_dwordx4 v21, s[8:11], s37 offen sc1 lds
s_add_u32 m0, s39, 125952
s_add_u32 s37, s37, s38
buffer_load_dwordx4 v21, s[8:11], s37 offen sc1 lds
s_add_u32 m0, s39, 126976
s_add_u32 s37, s37, s55
buffer_load_dwordx4 v21, s[8:11], s37 offen sc1 lds
s_add_u32 m0, s39, 128000
s_add_u32 s37, s37, s38
buffer_load_dwordx4 v21, s[8:11], s37 offen sc1 lds
s_add_u32 m0, s39, 129024
s_add_u32 s37, s37, s38
buffer_load_dwordx4 v21, s[8:11], s37 offen sc1 lds
s_add_u32 m0, s39, 130048
s_add_u32 s37, s37, s38
buffer_load_dwordx4 v21, s[8:11], s37 offen sc1 lds
s_waitcnt vmcnt(32)
s_barrier
s_add_u32 m0, s39, 0
s_add_u32 s37, s37, s40
buffer_load_dwordx4 v21, s[8:11], s37 offen sc1 lds
s_add_u32 m0, s39, 1024
s_add_u32 s37, s37, s38
buffer_load_dwordx4 v21, s[8:11], s37 offen sc1 lds
s_add_u32 m0, s39, 2048
s_add_u32 s37, s37, s38
buffer_load_dwordx4 v21, s[8:11], s37 offen sc1 lds
s_add_u32 m0, s39, 3072
s_add_u32 s37, s37, s38
buffer_load_dwordx4 v21, s[8:11], s37 offen sc1 lds
s_add_u32 m0, s39, 4096
s_add_u32 s37, s37, s55
buffer_load_dwordx4 v21, s[8:11], s37 offen sc1 lds
s_add_u32 m0, s39, 5120
s_add_u32 s37, s37, s38
buffer_load_dwordx4 v21, s[8:11], s37 offen sc1 lds
s_add_u32 m0, s39, 6144
s_add_u32 s37, s37, s38
buffer_load_dwordx4 v21, s[8:11], s37 offen sc1 lds
s_add_u32 m0, s39, 7168
s_add_u32 s37, s37, s38
buffer_load_dwordx4 v21, s[8:11], s37 offen sc1 lds
s_waitcnt vmcnt(32)
s_barrier
s_add_u32 m0, s39, 24576
s_add_u32 s37, s37, s40
buffer_load_dwordx4 v21, s[8:11], s37 offen sc1 lds
s_add_u32 m0, s39, 25600
s_add_u32 s37, s37, s38
buffer_load_dwordx4 v21, s[8:11], s37 offen sc1 lds
s_add_u32 m0, s39, 26624
s_add_u32 s37, s37, s38
buffer_load_dwordx4 v21, s[8:11], s37 offen sc1 lds
s_add_u32 m0, s39, 27648
s_add_u32 s37, s37, s38
buffer_load_dwordx4 v21, s[8:11], s37 offen sc1 lds
s_add_u32 m0, s39, 28672
s_add_u32 s37, s37, s55
buffer_load_dwordx4 v21, s[8:11], s37 offen sc1 lds
s_add_u32 m0, s39, 29696
s_add_u32 s37, s37, s38
buffer_load_dwordx4 v21, s[8:11], s37 offen sc1 lds
s_add_u32 m0, s39, 30720
s_add_u32 s37, s37, s38
buffer_load_dwordx4 v21, s[8:11], s37 offen sc1 lds
s_add_u32 m0, s39, 31744
s_add_u32 s37, s37, s38
buffer_load_dwordx4 v21, s[8:11], s37 offen sc1 lds
s_waitcnt vmcnt(32)
s_barrier
s_add_u32 m0, s39, 49152
s_add_u32 s37, s37, s40
buffer_load_dwordx4 v21, s[8:11], s37 offen sc1 lds
s_add_u32 m0, s39, 50176
s_add_u32 s37, s37, s38
buffer_load_dwordx4 v21, s[8:11], s37 offen sc1 lds
s_add_u32 m0, s39, 51200
s_add_u32 s37, s37, s38
buffer_load_dwordx4 v21, s[8:11], s37 offen sc1 lds
s_add_u32 m0, s39, 52224
s_add_u32 s37, s37, s38
buffer_load_dwordx4 v21, s[8:11], s37 offen sc1 lds
s_add_u32 m0, s39, 53248
s_add_u32 s37, s37, s55
buffer_load_dwordx4 v21, s[8:11], s37 offen sc1 lds
s_add_u32 m0, s39, 54272
s_add_u32 s37, s37, s38
buffer_load_dwordx4 v21, s[8:11], s37 offen sc1 lds
s_add_u32 m0, s39, 55296
s_add_u32 s37, s37, s38
buffer_load_dwordx4 v21, s[8:11], s37 offen sc1 lds
s_add_u32 m0, s39, 56320
s_add_u32 s37, s37, s38
buffer_load_dwordx4 v21, s[8:11], s37 offen sc1 lds
s_waitcnt vmcnt(32)
s_barrier
s_add_u32 m0, s39, 73728
s_add_u32 s37, s37, s40
buffer_load_dwordx4 v21, s[8:11], s37 offen sc1 lds
s_add_u32 m0, s39, 74752
s_add_u32 s37, s37, s38
buffer_load_dwordx4 v21, s[8:11], s37 offen sc1 lds
s_add_u32 m0, s39, 75776
s_add_u32 s37, s37, s38
buffer_load_dwordx4 v21, s[8:11], s37 offen sc1 lds
s_add_u32 m0, s39, 76800
s_add_u32 s37, s37, s38
buffer_load_dwordx4 v21, s[8:11], s37 offen sc1 lds
s_add_u32 m0, s39, 77824
s_add_u32 s37, s37, s55
buffer_load_dwordx4 v21, s[8:11], s37 offen sc1 lds
s_add_u32 m0, s39, 78848
s_add_u32 s37, s37, s38
buffer_load_dwordx4 v21, s[8:11], s37 offen sc1 lds
s_add_u32 m0, s39, 79872
s_add_u32 s37, s37, s38
buffer_load_dwordx4 v21, s[8:11], s37 offen sc1 lds
s_add_u32 m0, s39, 80896
s_add_u32 s37, s37, s38
buffer_load_dwordx4 v21, s[8:11], s37 offen sc1 lds
s_waitcnt vmcnt(32)
s_barrier
s_sub_u32 s41, s41, 1
s_cmp_lg_u32 s41, 0
s_cbranch_scc1 Lp4_44
s_waitcnt vmcnt(24)
s_barrier
s_waitcnt vmcnt(16)
s_barrier
s_waitcnt vmcnt(8)
s_barrier
s_waitcnt vmcnt(0)
s_barrier
s_branch Ldone_1
LW4_43:
s_mov_b32 s41, 4
Lp4_45:
s_add_u32 m0, s39, 98304
s_add_u32 s37, s37, 16384
buffer_load_dwordx4 v21, s[8:11], s37 offen sc1 lds
s_add_u32 m0, s39, 99328
s_add_u32 s37, s37, 16384
buffer_load_dwordx4 v21, s[8:11], s37 offen sc1 lds
s_add_u32 m0, s39, 100352
s_add_u32 s37, s37, 16384
buffer_load_dwordx4 v21, s[8:11], s37 offen sc1 lds
s_add_u32 m0, s39, 101376
s_add_u32 s37, s37, 16384
buffer_load_dwordx4 v21, s[8:11], s37 offen sc1 lds
s_add_u32 m0, s39, 102400
s_add_u32 s37, s37, 49152
buffer_load_dwordx4 v21, s[8:11], s37 offen sc1 lds
s_add_u32 m0, s39, 103424
s_add_u32 s37, s37, 16384
buffer_load_dwordx4 v21, s[8:11], s37 offen sc1 lds
s_add_u32 m0, s39, 104448
s_add_u32 s37, s37, 16384
buffer_load_dwordx4 v21, s[8:11], s37 offen sc1 lds
s_add_u32 m0, s39, 105472
s_add_u32 s37, s37, 16384
buffer_load_dwordx4 v21, s[8:11], s37 offen sc1 lds
s_waitcnt vmcnt(32)
s_barrier
s_add_u32 m0, s39, 122880
s_add_u32 s37, s37, 4294885376
buffer_load_dwordx4 v21, s[8:11], s37 offen sc1 lds
s_add_u32 m0, s39, 123904
s_add_u32 s37, s37, 98304
buffer_load_dwordx4 v21, s[8:11], s37 offen sc1 lds
s_add_u32 m0, s39, 124928
s_add_u32 s37, s37, 4294885376
buffer_load_dwordx4 v21, s[8:11], s37 offen sc1 lds
s_add_u32 m0, s39, 125952
s_add_u32 s37, s37, 98304
buffer_load_dwordx4 v21, s[8:11], s37 offen sc1 lds
s_add_u32 m0, s39, 126976
s_add_u32 s37, s37, 16384
buffer_load_dwordx4 v21, s[8:11], s37 offen sc1 lds
s_add_u32 m0, s39, 128000
s_add_u32 s37, s37, 16384
buffer_load_dwordx4 v21, s[8:11], s37 offen sc1 lds
s_add_u32 m0, s39, 129024
s_add_u32 s37, s37, 16384
buffer_load_dwordx4 v21, s[8:11], s37 offen sc1 lds
s_add_u32 m0, s39, 130048
s_add_u32 s37, s37, 16384
buffer_load_dwordx4 v21, s[8:11], s37 offen sc1 lds
s_waitcnt vmcnt(32)
s_barrier
s_add_u32 m0, s39, 0
s_add_u32 s37, s37, 49152
buffer_load_dwordx4 v21, s[8:11], s37 offen sc1 lds
s_add_u32 m0, s39, 1024
s_add_u32 s37, s37, 16384
buffer_load_dwordx4 v21, s[8:11], s37 offen sc1 lds
s_add_u32 m0, s39, 2048
s_add_u32 s37, s37, 16384
buffer_load_dwordx4 v21, s[8:11], s37 offen sc1 lds
s_add_u32 m0, s39, 3072
s_add_u32 s37, s37, 16384
buffer_load_dwordx4 v21, s[8:11], s37 offen sc1 lds
s_add_u32 m0, s39, 4096
s_add_u32 s37, s37, 4294885376
buffer_load_dwordx4 v21, s[8:11], s37 offen sc1 lds
s_add_u32 m0, s39, 5120
s_add_u32 s37, s37, 98304
buffer_load_dwordx4 v21, s[8:11], s37 offen sc1 lds
s_add_u32 m0, s39, 6144
s_add_u32 s37, s37, 4294885376
buffer_load_dwordx4 v21, s[8:11], s37 offen sc1 lds
s_add_u32 m0, s39, 7168
s_add_u32 s37, s37, 98304
buffer_load_dwordx4 v21, s[8:11], s37 offen sc1 lds
s_waitcnt vmcnt(32)
s_barrier
s_add_u32 m0, s39, 24576
s_add_u32 s37, s37, 16384
buffer_load_dwordx4 v21, s[8:11], s37 offen sc1 lds
s_add_u32 m0, s39, 25600
s_add_u32 s37, s37, 16384
buffer_load_dwordx4 v21, s[8:11], s37 offen sc1 lds
s_add_u32 m0, s39, 26624
s_add_u32 s37, s37, 16384
buffer_load_dwordx4 v21, s[8:11], s37 offen sc1 lds
s_add_u32 m0, s39, 27648
s_add_u32 s37, s37, 16384
buffer_load_dwordx4 v21, s[8:11], s37 offen sc1 lds
s_add_u32 m0, s39, 28672
s_add_u32 s37, s37, 49152
buffer_load_dwordx4 v21, s[8:11], s37 offen sc1 lds
s_add_u32 m0, s39, 29696
s_add_u32 s37, s37, 16384
buffer_load_dwordx4 v21, s[8:11], s37 offen sc1 lds
s_add_u32 m0, s39, 30720
s_add_u32 s37, s37, 16384
buffer_load_dwordx4 v21, s[8:11], s37 offen sc1 lds
s_add_u32 m0, s39, 31744
s_add_u32 s37, s37, 16384
buffer_load_dwordx4 v21, s[8:11], s37 offen sc1 lds
s_waitcnt vmcnt(32)
s_barrier
s_add_u32 m0, s39, 49152
s_add_u32 s37, s37, 4294885376
buffer_load_dwordx4 v21, s[8:11], s37 offen sc1 lds
s_add_u32 m0, s39, 50176
s_add_u32 s37, s37, 98304
buffer_load_dwordx4 v21, s[8:11], s37 offen sc1 lds
s_add_u32 m0, s39, 51200
s_add_u32 s37, s37, 4294885376
buffer_load_dwordx4 v21, s[8:11], s37 offen sc1 lds
s_add_u32 m0, s39, 52224
s_add_u32 s37, s37, 98304
buffer_load_dwordx4 v21, s[8:11], s37 offen sc1 lds
s_add_u32 m0, s39, 53248
s_add_u32 s37, s37, 16384
buffer_load_dwordx4 v21, s[8:11], s37 offen sc1 lds
s_add_u32 m0, s39, 54272
s_add_u32 s37, s37, 16384
buffer_load_dwordx4 v21, s[8:11], s37 offen sc1 lds
s_add_u32 m0, s39, 55296
s_add_u32 s37, s37, 16384
buffer_load_dwordx4 v21, s[8:11], s37 offen sc1 lds
s_add_u32 m0, s39, 56320
s_add_u32 s37, s37, 16384
buffer_load_dwordx4 v21, s[8:11], s37 offen sc1 lds
s_waitcnt vmcnt(32)
s_barrier
s_add_u32 m0, s39, 73728
s_add_u32 s37, s37, 49152
buffer_load_dwordx4 v21, s[8:11], s37 offen sc1 lds
s_add_u32 m0, s39, 74752
s_add_u32 s37, s37, 16384
buffer_load_dwordx4 v21, s[8:11], s37 offen sc1 lds
s_add_u32 m0, s39, 75776
s_add_u32 s37, s37, 16384
buffer_load_dwordx4 v21, s[8:11], s37 offen sc1 lds
s_add_u32 m0, s39, 76800
s_add_u32 s37, s37, 16384
buffer_load_dwordx4 v21, s[8:11], s37 offen sc1 lds
s_add_u32 m0, s39, 77824
s_add_u32 s37, s37, 4294885376
buffer_load_dwordx4 v21, s[8:11], s37 offen sc1 lds
s_add_u32 m0, s39, 78848
s_add_u32 s37, s37, 98304
buffer_load_dwordx4 v21, s[8:11], s37 offen sc1 lds
s_add_u32 m0, s39, 79872
s_add_u32 s37, s37, 4294885376
buffer_load_dwordx4 v21, s[8:11], s37 offen sc1 lds
s_add_u32 m0, s39, 80896
s_add_u32 s37, s37, 98304
buffer_load_dwordx4 v21, s[8:11], s37 offen sc1 lds
s_waitcnt vmcnt(32)
s_barrier
s_sub_u32 s41, s41, 1
s_cmp_lg_u32 s41, 0
s_cbranch_scc1 Lp4_45
s_waitcnt vmcnt(24)
s_barrier
s_waitcnt vmcnt(16)
s_barrier
s_waitcnt vmcnt(8)
s_barrier
s_waitcnt vmcnt(0)
s_barrier
s_branch Ldone_1
L7b_41:
s_add_u32 s43, s34, 48
s_lshl_b32 s43, s43, 7
v_mov_b32 v21, s43
v_mov_b32 v22, 1
s_mov_b64 exec, 1
buffer_atomic_add v22, v21, s[56:59], 0 offen sc1
s_mov_b64 exec, -1
v_mfma_f32_16x16x32_bf16 v[128:131], v[96:99], v[80:83], v[128:131]
v_mfma_f32_16x16x32_bf16 v[132:135], v[96:99], v[84:87], v[132:135]
v_mfma_f32_16x16x32_bf16 v[136:139], v[96:99], v[88:91], v[136:139]
v_mfma_f32_16x16x32_bf16 v[140:143], v[96:99], v[92:95], v[140:143]
v_mfma_f32_16x16x32_bf16 v[176:179], v[108:111], v[80:83], v[176:179]
v_mfma_f32_16x16x32_bf16 v[180:183], v[108:111], v[84:87], v[180:183]
v_mfma_f32_16x16x32_bf16 v[184:187], v[108:111], v[88:91], v[184:187]
v_mfma_f32_16x16x32_bf16 v[188:191], v[108:111], v[92:95], v[188:191]
v_mfma_f32_16x16x32_bf16 v[144:147], v[100:103], v[80:83], v[144:147]
v_mfma_f32_16x16x32_bf16 v[148:151], v[100:103], v[84:87], v[148:151]
v_mfma_f32_16x16x32_bf16 v[152:155], v[100:103], v[88:91], v[152:155]
v_mfma_f32_16x16x32_bf16 v[156:159], v[100:103], v[92:95], v[156:159]
v_mfma_f32_16x16x32_bf16 v[192:195], v[112:115], v[80:83], v[192:195]
v_mfma_f32_16x16x32_bf16 v[196:199], v[112:115], v[84:87], v[196:199]
v_mfma_f32_16x16x32_bf16 v[200:203], v[112:115], v[88:91], v[200:203]
v_mfma_f32_16x16x32_bf16 v[204:207], v[112:115], v[92:95], v[204:207]
v_mfma_f32_16x16x32_bf16 v[160:163], v[104:107], v[80:83], v[160:163]
v_mfma_f32_16x16x32_bf16 v[164:167], v[104:107], v[84:87], v[164:167]
v_mfma_f32_16x16x32_bf16 v[168:171], v[104:107], v[88:91], v[168:171]
v_mfma_f32_16x16x32_bf16 v[172:175], v[104:107], v[92:95], v[172:175]
v_mfma_f32_16x16x32_bf16 v[208:211], v[116:119], v[80:83], v[208:211]
v_mfma_f32_16x16x32_bf16 v[212:215], v[116:119], v[84:87], v[212:215]
v_mfma_f32_16x16x32_bf16 v[216:219], v[116:119], v[88:91], v[216:219]
v_mfma_f32_16x16x32_bf16 v[220:223], v[116:119], v[92:95], v[220:223]
s_setprio 0
s_barrier
v_mul_f32 v80, v128, v128
v_mul_f32 v81, v129, v129
v_mul_f32 v82, v130, v130
v_mul_f32 v83, v131, v131
v_fma_f32 v80, v80, v232, v228
v_fma_f32 v81, v81, v232, v228
v_fma_f32 v82, v82, v232, v228
v_fma_f32 v83, v83, v232, v228
v_mul_f32 v80, v80, v128
v_mul_f32 v81, v81, v129
v_mul_f32 v82, v82, v130
v_mul_f32 v83, v83, v131
v_exp_f32 v80, v80
v_exp_f32 v81, v81
v_exp_f32 v82, v82
v_exp_f32 v83, v83
v_mul_f32 v176, v128, v176
v_mul_f32 v177, v129, v177
v_mul_f32 v178, v130, v178
v_mul_f32 v179, v131, v179
v_fma_f32 v80, v80, v236, v236
v_fma_f32 v81, v81, v236, v236
v_fma_f32 v82, v82, v236, v236
v_fma_f32 v83, v83, v236, v236
v_rcp_f32 v80, v80
v_rcp_f32 v81, v81
v_rcp_f32 v82, v82
v_rcp_f32 v83, v83
v_mul_f32 v176, v176, v80
v_mul_f32 v177, v177, v81
s_barrier
v_mul_f32 v178, v178, v82
v_mul_f32 v179, v179, v83
v_cvt_pk_bf16_f32 v96, v176, v177
v_cvt_pk_bf16_f32 v97, v178, v179
v_mul_f32 v84, v144, v144
v_mul_f32 v85, v145, v145
v_mul_f32 v86, v146, v146
v_mul_f32 v87, v147, v147
v_fma_f32 v84, v84, v232, v228
v_fma_f32 v85, v85, v232, v228
v_fma_f32 v86, v86, v232, v228
v_fma_f32 v87, v87, v232, v228
v_mul_f32 v84, v84, v144
v_mul_f32 v85, v85, v145
v_mul_f32 v86, v86, v146
v_mul_f32 v87, v87, v147
v_exp_f32 v84, v84
v_exp_f32 v85, v85
v_exp_f32 v86, v86
v_exp_f32 v87, v87
v_mul_f32 v192, v144, v192
v_mul_f32 v193, v145, v193
v_mul_f32 v194, v146, v194
v_mul_f32 v195, v147, v195
v_fma_f32 v84, v84, v236, v236
v_fma_f32 v85, v85, v236, v236
v_fma_f32 v86, v86, v236, v236
v_fma_f32 v87, v87, v236, v236
v_rcp_f32 v84, v84
v_rcp_f32 v85, v85
s_barrier
v_rcp_f32 v86, v86
v_rcp_f32 v87, v87
v_mul_f32 v192, v192, v84
v_mul_f32 v193, v193, v85
v_mul_f32 v194, v194, v86
v_mul_f32 v195, v195, v87
v_cvt_pk_bf16_f32 v98, v192, v193
v_cvt_pk_bf16_f32 v99, v194, v195
buffer_store_dwordx4 v[96:99], v27, s[24:27], 0 offen offset:0 sc1
v_mul_f32 v80, v160, v160
v_mul_f32 v81, v161, v161
v_mul_f32 v82, v162, v162
v_mul_f32 v83, v163, v163
v_fma_f32 v80, v80, v232, v228
v_fma_f32 v81, v81, v232, v228
v_fma_f32 v82, v82, v232, v228
v_fma_f32 v83, v83, v232, v228
v_mul_f32 v80, v80, v160
v_mul_f32 v81, v81, v161
v_mul_f32 v82, v82, v162
v_mul_f32 v83, v83, v163
v_exp_f32 v80, v80
v_exp_f32 v81, v81
v_exp_f32 v82, v82
v_exp_f32 v83, v83
v_mul_f32 v208, v160, v208
v_mul_f32 v209, v161, v209
v_mul_f32 v210, v162, v210
v_mul_f32 v211, v163, v211
v_fma_f32 v80, v80, v236, v236
s_barrier
v_fma_f32 v81, v81, v236, v236
v_fma_f32 v82, v82, v236, v236
v_fma_f32 v83, v83, v236, v236
v_rcp_f32 v80, v80
v_rcp_f32 v81, v81
v_rcp_f32 v82, v82
v_rcp_f32 v83, v83
v_mul_f32 v208, v208, v80
v_mul_f32 v209, v209, v81
v_mul_f32 v210, v210, v82
v_mul_f32 v211, v211, v83
v_cvt_pk_bf16_f32 v112, v208, v209
v_cvt_pk_bf16_f32 v113, v210, v211
v_mul_f32 v80, v132, v132
v_mul_f32 v81, v133, v133
v_mul_f32 v82, v134, v134
v_mul_f32 v83, v135, v135
v_fma_f32 v80, v80, v233, v229
v_fma_f32 v81, v81, v233, v229
v_fma_f32 v82, v82, v233, v229
v_fma_f32 v83, v83, v233, v229
v_mul_f32 v80, v80, v132
v_mul_f32 v81, v81, v133
v_mul_f32 v82, v82, v134
v_mul_f32 v83, v83, v135
v_exp_f32 v80, v80
v_exp_f32 v81, v81
v_exp_f32 v82, v82
v_exp_f32 v83, v83
v_mul_f32 v180, v132, v180
s_barrier
v_mul_f32 v181, v133, v181
v_mul_f32 v182, v134, v182
v_mul_f32 v183, v135, v183
v_fma_f32 v80, v80, v237, v237
v_fma_f32 v81, v81, v237, v237
v_fma_f32 v82, v82, v237, v237
v_fma_f32 v83, v83, v237, v237
v_rcp_f32 v80, v80
v_rcp_f32 v81, v81
v_rcp_f32 v82, v82
v_rcp_f32 v83, v83
v_mul_f32 v180, v180, v80
v_mul_f32 v181, v181, v81
v_mul_f32 v182, v182, v82
v_mul_f32 v183, v183, v83
v_cvt_pk_bf16_f32 v100, v180, v181
v_cvt_pk_bf16_f32 v101, v182, v183
v_mul_f32 v84, v148, v148
v_mul_f32 v85, v149, v149
v_mul_f32 v86, v150, v150
v_mul_f32 v87, v151, v151
v_fma_f32 v84, v84, v233, v229
v_fma_f32 v85, v85, v233, v229
v_fma_f32 v86, v86, v233, v229
v_fma_f32 v87, v87, v233, v229
v_mul_f32 v84, v84, v148
v_mul_f32 v85, v85, v149
v_mul_f32 v86, v86, v150
v_mul_f32 v87, v87, v151
v_exp_f32 v84, v84
s_barrier
v_exp_f32 v85, v85
v_exp_f32 v86, v86
v_exp_f32 v87, v87
v_mul_f32 v196, v148, v196
v_mul_f32 v197, v149, v197
v_mul_f32 v198, v150, v198
v_mul_f32 v199, v151, v199
v_fma_f32 v84, v84, v237, v237
v_fma_f32 v85, v85, v237, v237
v_fma_f32 v86, v86, v237, v237
v_fma_f32 v87, v87, v237, v237
v_rcp_f32 v84, v84
v_rcp_f32 v85, v85
v_rcp_f32 v86, v86
v_rcp_f32 v87, v87
v_mul_f32 v196, v196, v84
v_mul_f32 v197, v197, v85
v_mul_f32 v198, v198, v86
v_mul_f32 v199, v199, v87
v_cvt_pk_bf16_f32 v102, v196, v197
v_cvt_pk_bf16_f32 v103, v198, v199
buffer_store_dwordx4 v[100:103], v27, s[24:27], 0 offen offset:256 sc1
v_mul_f32 v80, v164, v164
v_mul_f32 v81, v165, v165
v_mul_f32 v82, v166, v166
v_mul_f32 v83, v167, v167
v_fma_f32 v80, v80, v233, v229
v_fma_f32 v81, v81, v233, v229
v_fma_f32 v82, v82, v233, v229
v_fma_f32 v83, v83, v233, v229
s_barrier
s_add_u32 s43, s34, 48
s_lshl_b32 s43, s43, 7
v_mov_b32 v21, s43
v_mov_b32 v23, 16
buffer_load_dword v22, v21, s[56:59], 0 offen sc1
v_mul_f32 v80, v80, v164
v_mul_f32 v81, v81, v165
v_mul_f32 v82, v82, v166
v_mul_f32 v83, v83, v167
v_exp_f32 v80, v80
v_exp_f32 v81, v81
v_exp_f32 v82, v82
v_exp_f32 v83, v83
v_mul_f32 v212, v164, v212
v_mul_f32 v213, v165, v213
v_mul_f32 v214, v166, v214
v_mul_f32 v215, v167, v215
v_fma_f32 v80, v80, v237, v237
v_fma_f32 v81, v81, v237, v237
v_fma_f32 v82, v82, v237, v237
v_fma_f32 v83, v83, v237, v237
v_rcp_f32 v80, v80
v_rcp_f32 v81, v81
v_rcp_f32 v82, v82
v_rcp_f32 v83, v83
v_mul_f32 v212, v212, v80
v_mul_f32 v213, v213, v81
v_mul_f32 v214, v214, v82
v_mul_f32 v215, v215, v83
v_cvt_pk_bf16_f32 v114, v212, v213
v_cvt_pk_bf16_f32 v115, v214, v215
s_nop 1
v_permlane32_swap_b32 v112, v114
v_permlane32_swap_b32 v113, v115
buffer_store_dwordx4 v[112:115], v28, s[24:27], 0 offen offset:0 sc1
s_barrier
v_mul_f32 v80, v136, v136
v_mul_f32 v81, v137, v137
v_mul_f32 v82, v138, v138
v_mul_f32 v83, v139, v139
v_fma_f32 v80, v80, v234, v230
v_fma_f32 v81, v81, v234, v230
v_fma_f32 v82, v82, v234, v230
v_fma_f32 v83, v83, v234, v230
v_mul_f32 v80, v80, v136
v_mul_f32 v81, v81, v137
v_mul_f32 v82, v82, v138
v_mul_f32 v83, v83, v139
v_exp_f32 v80, v80
v_exp_f32 v81, v81
v_exp_f32 v82, v82
v_exp_f32 v83, v83
v_mul_f32 v184, v136, v184
v_mul_f32 v185, v137, v185
v_mul_f32 v186, v138, v186
v_mul_f32 v187, v139, v187
v_fma_f32 v80, v80, v238, v238
v_fma_f32 v81, v81, v238, v238
v_fma_f32 v82, v82, v238, v238
v_fma_f32 v83, v83, v238, v238
v_rcp_f32 v80, v80
v_rcp_f32 v81, v81
v_rcp_f32 v82, v82
v_rcp_f32 v83, v83
v_mul_f32 v184, v184, v80
v_mul_f32 v185, v185, v81
s_barrier
v_mul_f32 v186, v186, v82
v_mul_f32 v187, v187, v83
v_cvt_pk_bf16_f32 v104, v184, v185
v_cvt_pk_bf16_f32 v105, v186, v187
v_mul_f32 v84, v152, v152
v_mul_f32 v85, v153, v153
v_mul_f32 v86, v154, v154
v_mul_f32 v87, v155, v155
v_fma_f32 v84, v84, v234, v230
v_fma_f32 v85, v85, v234, v230
v_fma_f32 v86, v86, v234, v230
v_fma_f32 v87, v87, v234, v230
v_mul_f32 v84, v84, v152
v_mul_f32 v85, v85, v153
v_mul_f32 v86, v86, v154
v_mul_f32 v87, v87, v155
v_exp_f32 v84, v84
v_exp_f32 v85, v85
v_exp_f32 v86, v86
v_exp_f32 v87, v87
v_mul_f32 v200, v152, v200
v_mul_f32 v201, v153, v201
v_mul_f32 v202, v154, v202
v_mul_f32 v203, v155, v203
v_fma_f32 v84, v84, v238, v238
v_fma_f32 v85, v85, v238, v238
v_fma_f32 v86, v86, v238, v238
v_fma_f32 v87, v87, v238, v238
v_rcp_f32 v84, v84
v_rcp_f32 v85, v85
s_barrier
v_rcp_f32 v86, v86
v_rcp_f32 v87, v87
v_mul_f32 v200, v200, v84
v_mul_f32 v201, v201, v85
v_mul_f32 v202, v202, v86
v_mul_f32 v203, v203, v87
v_cvt_pk_bf16_f32 v106, v200, v201
v_cvt_pk_bf16_f32 v107, v202, v203
buffer_store_dwordx4 v[104:107], v27, s[24:27], 0 offen offset:512 sc1
v_mul_f32 v80, v168, v168
v_mul_f32 v81, v169, v169
v_mul_f32 v82, v170, v170
v_mul_f32 v83, v171, v171
v_fma_f32 v80, v80, v234, v230
v_fma_f32 v81, v81, v234, v230
v_fma_f32 v82, v82, v234, v230
v_fma_f32 v83, v83, v234, v230
v_mul_f32 v80, v80, v168
v_mul_f32 v81, v81, v169
v_mul_f32 v82, v82, v170
v_mul_f32 v83, v83, v171
v_exp_f32 v80, v80
v_exp_f32 v81, v81
v_exp_f32 v82, v82
v_exp_f32 v83, v83
v_mul_f32 v216, v168, v216
v_mul_f32 v217, v169, v217
v_mul_f32 v218, v170, v218
v_mul_f32 v219, v171, v219
v_fma_f32 v80, v80, v238, v238
s_mov_b32 s41, 0x10000
Lpoll_46:
s_waitcnt vmcnt(0)
v_cmp_ne_u32 vcc, v23, v22
s_nop 4
s_cbranch_vccz Lpok_47
buffer_load_dword v22, v21, s[56:59], 0 offen sc1
s_sub_u32 s41, s41, 1
s_cmp_lg_u32 s41, 0
s_cbranch_scc1 Lpoll_46
s_waitcnt vmcnt(0)
Lpok_47:
s_barrier
v_fma_f32 v81, v81, v238, v238
v_fma_f32 v82, v82, v238, v238
v_fma_f32 v83, v83, v238, v238
v_rcp_f32 v80, v80
v_rcp_f32 v81, v81
v_rcp_f32 v82, v82
v_rcp_f32 v83, v83
v_mul_f32 v216, v216, v80
v_mul_f32 v217, v217, v81
v_mul_f32 v218, v218, v82
v_mul_f32 v219, v219, v83
v_cvt_pk_bf16_f32 v116, v216, v217
v_cvt_pk_bf16_f32 v117, v218, v219
v_mul_f32 v80, v140, v140
v_mul_f32 v81, v141, v141
v_mul_f32 v82, v142, v142
v_mul_f32 v83, v143, v143
v_fma_f32 v80, v80, v235, v231
v_fma_f32 v81, v81, v235, v231
v_fma_f32 v82, v82, v235, v231
v_fma_f32 v83, v83, v235, v231
v_mul_f32 v80, v80, v140
v_mul_f32 v81, v81, v141
v_mul_f32 v82, v82, v142
v_mul_f32 v83, v83, v143
v_exp_f32 v80, v80
v_exp_f32 v81, v81
v_exp_f32 v82, v82
v_exp_f32 v83, v83
v_mul_f32 v188, v140, v188
s_barrier
v_mul_f32 v189, v141, v189
v_mul_f32 v190, v142, v190
v_mul_f32 v191, v143, v191
v_fma_f32 v80, v80, v239, v239
v_fma_f32 v81, v81, v239, v239
v_fma_f32 v82, v82, v239, v239
v_fma_f32 v83, v83, v239, v239
v_rcp_f32 v80, v80
v_rcp_f32 v81, v81
v_rcp_f32 v82, v82
v_rcp_f32 v83, v83
v_mul_f32 v188, v188, v80
v_mul_f32 v189, v189, v81
v_mul_f32 v190, v190, v82
v_mul_f32 v191, v191, v83
v_cvt_pk_bf16_f32 v108, v188, v189
v_cvt_pk_bf16_f32 v109, v190, v191
v_mul_f32 v84, v156, v156
v_mul_f32 v85, v157, v157
v_mul_f32 v86, v158, v158
v_mul_f32 v87, v159, v159
v_fma_f32 v84, v84, v235, v231
v_fma_f32 v85, v85, v235, v231
v_fma_f32 v86, v86, v235, v231
v_fma_f32 v87, v87, v235, v231
v_mul_f32 v84, v84, v156
v_mul_f32 v85, v85, v157
v_mul_f32 v86, v86, v158
v_mul_f32 v87, v87, v159
v_exp_f32 v84, v84
s_barrier
v_exp_f32 v85, v85
v_exp_f32 v86, v86
v_exp_f32 v87, v87
v_mul_f32 v204, v156, v204
v_mul_f32 v205, v157, v205
v_mul_f32 v206, v158, v206
v_mul_f32 v207, v159, v207
v_fma_f32 v84, v84, v239, v239
v_fma_f32 v85, v85, v239, v239
v_fma_f32 v86, v86, v239, v239
v_fma_f32 v87, v87, v239, v239
v_rcp_f32 v84, v84
v_rcp_f32 v85, v85
v_rcp_f32 v86, v86
v_rcp_f32 v87, v87
v_mul_f32 v204, v204, v84
v_mul_f32 v205, v205, v85
v_mul_f32 v206, v206, v86
v_mul_f32 v207, v207, v87
v_cvt_pk_bf16_f32 v110, v204, v205
v_cvt_pk_bf16_f32 v111, v206, v207
buffer_store_dwordx4 v[108:111], v27, s[24:27], 0 offen offset:768 sc1
v_mul_f32 v80, v172, v172
v_mul_f32 v81, v173, v173
v_mul_f32 v82, v174, v174
v_mul_f32 v83, v175, v175
v_fma_f32 v80, v80, v235, v231
v_fma_f32 v81, v81, v235, v231
v_fma_f32 v82, v82, v235, v231
v_fma_f32 v83, v83, v235, v231
s_barrier
v_mul_f32 v80, v80, v172
v_mul_f32 v81, v81, v173
v_mul_f32 v82, v82, v174
v_mul_f32 v83, v83, v175
v_exp_f32 v80, v80
v_exp_f32 v81, v81
v_exp_f32 v82, v82
v_exp_f32 v83, v83
v_mul_f32 v220, v172, v220
v_mul_f32 v221, v173, v221
v_mul_f32 v222, v174, v222
v_mul_f32 v223, v175, v223
v_fma_f32 v80, v80, v239, v239
v_fma_f32 v81, v81, v239, v239
v_fma_f32 v82, v82, v239, v239
v_fma_f32 v83, v83, v239, v239
v_rcp_f32 v80, v80
v_rcp_f32 v81, v81
v_rcp_f32 v82, v82
v_rcp_f32 v83, v83
v_mul_f32 v220, v220, v80
v_mul_f32 v221, v221, v81
v_mul_f32 v222, v222, v82
v_mul_f32 v223, v223, v83
v_cvt_pk_bf16_f32 v118, v220, v221
v_cvt_pk_bf16_f32 v119, v222, v223
s_nop 1
v_permlane32_swap_b32 v116, v118
v_permlane32_swap_b32 v117, v119
buffer_store_dwordx4 v[116:119], v28, s[24:27], 0 offen offset:512 sc1
s_barrier
s_barrier
s_waitcnt vmcnt(0)
s_barrier
s_add_u32 s43, s34, 64
s_lshl_b32 s43, s43, 7
v_mov_b32 v21, s43
v_mov_b32 v22, 1
s_mov_b64 exec, 1
buffer_atomic_add v22, v21, s[56:59], 0 offen sc1
s_mov_b64 exec, -1
s_barrier
s_barrier
s_barrier
s_barrier
s_barrier
s_barrier
s_add_u32 s43, s34, 64
s_lshl_b32 s43, s43, 7
v_mov_b32 v21, s43
v_mov_b32 v23, 16
buffer_load_dword v22, v21, s[56:59], 0 offen sc1
s_barrier
s_barrier
s_barrier
s_mov_b32 s41, 0x10000
Lpoll_48:
s_waitcnt vmcnt(0)
v_cmp_ne_u32 vcc, v23, v22
s_nop 4
s_cbranch_vccz Lpok_49
buffer_load_dword v22, v21, s[56:59], 0 offen sc1
s_sub_u32 s41, s41, 1
s_cmp_lg_u32 s41, 0
s_cbranch_scc1 Lpoll_48
s_waitcnt vmcnt(0)
Lpok_49:
s_barrier
s_branch Ldone_1
Ldone_1:
s_endpgm
.section .rodata,"a"
.p2align 6
.amdhsa_kernel sequential_preLN__sliding_local_dilated__glu_gated_geglu__prompt_kernel
  .amdhsa_next_free_vgpr 256
  .amdhsa_next_free_sgpr 100
  .amdhsa_accum_offset 256
  .amdhsa_group_segment_fixed_size 0
  .amdhsa_kernarg_size 80
  .amdhsa_user_sgpr_count 2
  .amdhsa_user_sgpr_kernarg_segment_ptr 1
  .amdhsa_system_sgpr_workgroup_id_x 1
  .amdhsa_float_denorm_mode_32 3
  .amdhsa_float_denorm_mode_16_64 3
.end_amdhsa_kernel
```

```asm
; @launch grid=(256,1,1) block=(512,1,1) lds=151552
.amdgcn_target "amdgcn-amd-amdhsa--gfx950"
.text
.globl sequential_preLN__sliding_local_dilated__glu_gated_geglu__prompt_kernel
.p2align 8
.type sequential_preLN__sliding_local_dilated__glu_gated_geglu__prompt_kernel,@function
sequential_preLN__sliding_local_dilated__glu_gated_geglu__prompt_kernel:
s_cmp_ge_u32 s2, 256
s_cbranch_scc1 Ldone_1
s_load_dwordx4 s[4:7], s[0:1], 0
s_load_dwordx2 s[32:33], s[0:1], 72
s_and_b32 s3, s2, 7
s_lshr_b32 s42, s2, 3
s_and_b32 s48, s42, 3
s_lshr_b32 s49, s42, 2
s_and_b32 s34, s3, 3
s_lshl_b32 s34, s34, 2
s_add_u32 s34, s34, s48
s_lshr_b32 s35, s3, 2
s_lshl_b32 s35, s35, 3
s_add_u32 s35, s35, s49
v_lshrrev_b32 v12, 6, v0
v_and_b32 v1, 63, v0
v_readfirstlane_b32 s36, v12
s_nop 3
s_lshl_b32 s43, s35, 7
s_lshl_b32 s44, s34, 18
s_lshl_b32 s45, s35, 14
s_add_u32 s45, s45, s44
s_lshl_b32 s50, s34, 7
s_sub_u32 s50, s50, 16
s_waitcnt lgkmcnt(0)
s_mov_b32 s8, s4
s_mov_b32 s9, s5
s_mov_b32 s10, 4194304
s_mov_b32 s11, 0x20000
s_add_u32 s12, s6, s43
s_addc_u32 s13, s7, 0
s_mov_b32 s14, 6289536
s_mov_b32 s15, 0x20000
s_add_u32 s16, s32, s45
s_addc_u32 s17, s33, 0
s_mov_b32 s18, 16384
s_mov_b32 s19, 0x20000
v_and_b32 v12, 15, v1
v_lshrrev_b32 v13, 4, v1
s_cmp_ge_u32 s36, 4
s_cbranch_scc1 Lprod_2
v_lshrrev_b32 v16, 1, v12
v_xor_b32 v15, v13, v16
v_lshlrev_b32 v15, 4, v15
v_lshl_add_u32 v2, v12, 7, v15
v_xor_b32 v3, 64, v2
v_add_u32 v4, 86016, v2
v_add_u32 v5, 86016, v3
v_lshrrev_b32 v15, 2, v12
v_and_b32 v16, 3, v1
v_lshl_add_u32 v19, v13, 3, v15
v_lshlrev_b32 v19, 7, v19
v_and_b32 v15, 2, v15
v_and_b32 v17, 1, v13
v_lshl_add_u32 v15, v17, 2, v15
v_lshrrev_b32 v17, 1, v16
s_lshl_b32 s43, s36, 1
v_add_u32 v17, s43, v17
v_xor_b32 v15, v15, v17
v_lshl_add_u32 v19, v15, 4, v19
v_and_b32 v16, 1, v16
v_lshl_add_u32 v19, v16, 3, v19
v_add_u32 v6, 18432, v19
v_add_u32 v7, 61440, v19
v_add_u32 v8, 104448, v19
v_mov_b32 v128, 0
v_mov_b32 v129, 0
v_mov_b32 v130, 0
v_mov_b32 v131, 0
v_mov_b32 v132, 0
v_mov_b32 v133, 0
v_mov_b32 v134, 0
v_mov_b32 v135, 0
v_mov_b32 v136, 0
v_mov_b32 v137, 0
v_mov_b32 v138, 0
v_mov_b32 v139, 0
v_mov_b32 v140, 0
v_mov_b32 v141, 0
v_mov_b32 v142, 0
v_mov_b32 v143, 0
v_mov_b32 v144, 0
v_mov_b32 v145, 0
v_mov_b32 v146, 0
v_mov_b32 v147, 0
v_mov_b32 v148, 0
v_mov_b32 v149, 0
v_mov_b32 v150, 0
v_mov_b32 v151, 0
v_mov_b32 v152, 0
v_mov_b32 v153, 0
v_mov_b32 v154, 0
v_mov_b32 v155, 0
v_mov_b32 v156, 0
v_mov_b32 v157, 0
v_mov_b32 v158, 0
v_mov_b32 v159, 0
v_mov_b32 v160, 0
v_mov_b32 v161, 0
v_mov_b32 v162, 0
v_mov_b32 v163, 0
v_mov_b32 v164, 0
v_mov_b32 v165, 0
v_mov_b32 v166, 0
v_mov_b32 v167, 0
v_mov_b32 v168, 0
v_mov_b32 v169, 0
v_mov_b32 v170, 0
v_mov_b32 v171, 0
v_mov_b32 v172, 0
v_mov_b32 v173, 0
v_mov_b32 v174, 0
v_mov_b32 v175, 0
v_mov_b32 v176, 0
v_mov_b32 v177, 0
v_mov_b32 v178, 0
v_mov_b32 v179, 0
v_mov_b32 v180, 0
v_mov_b32 v181, 0
v_mov_b32 v182, 0
v_mov_b32 v183, 0
v_mov_b32 v184, 0
v_mov_b32 v185, 0
v_mov_b32 v186, 0
v_mov_b32 v187, 0
v_mov_b32 v188, 0
v_mov_b32 v189, 0
v_mov_b32 v190, 0
v_mov_b32 v191, 0
v_mov_b32 v192, 0
v_mov_b32 v193, 0
v_mov_b32 v194, 0
v_mov_b32 v195, 0
v_mov_b32 v196, 0
v_mov_b32 v197, 0
v_mov_b32 v198, 0
v_mov_b32 v199, 0
v_mov_b32 v200, 0
v_mov_b32 v201, 0
v_mov_b32 v202, 0
v_mov_b32 v203, 0
v_mov_b32 v204, 0
v_mov_b32 v205, 0
v_mov_b32 v206, 0
v_mov_b32 v207, 0
v_mov_b32 v208, 0
v_mov_b32 v209, 0
v_mov_b32 v210, 0
v_mov_b32 v211, 0
v_mov_b32 v212, 0
v_mov_b32 v213, 0
v_mov_b32 v214, 0
v_mov_b32 v215, 0
v_mov_b32 v216, 0
v_mov_b32 v217, 0
v_mov_b32 v218, 0
v_mov_b32 v219, 0
v_mov_b32 v220, 0
v_mov_b32 v221, 0
v_mov_b32 v222, 0
v_mov_b32 v223, 0
v_mov_b32 v224, 0
v_mov_b32 v225, 0
v_mov_b32 v226, 0
v_mov_b32 v227, 0
v_mov_b32 v228, 0
v_mov_b32 v229, 0
v_mov_b32 v230, 0
v_mov_b32 v231, 0
v_mov_b32 v232, 0
v_mov_b32 v233, 0
v_mov_b32 v234, 0
v_mov_b32 v235, 0
s_barrier
ds_read_b128 v[32:35], v2 offset:0
ds_read_b64_tr_b16 v[72:73], v6 offset:8192
ds_read_b64_tr_b16 v[74:75], v6 offset:8704
ds_read_b64_tr_b16 v[76:77], v6 offset:16384
ds_read_b64_tr_b16 v[78:79], v6 offset:16896
ds_read_b64_tr_b16 v[68:69], v6 offset:0
ds_read_b64_tr_b16 v[70:71], v6 offset:512
ds_read_b128 v[36:39], v2 offset:2048
ds_read_b128 v[40:43], v2 offset:4096
ds_read_b128 v[44:47], v2 offset:6144
ds_read_b128 v[48:51], v2 offset:8192
ds_read_b128 v[52:55], v2 offset:10240
ds_read_b128 v[56:59], v2 offset:12288
ds_read_b128 v[60:63], v2 offset:14336
ds_read_b128 v[64:67], v2 offset:16384
s_mov_b32 s41, 5
Lcl_5:
s_waitcnt lgkmcnt(0)
v_mfma_f32_16x16x32_bf16 v[164:167], v[72:75], v[32:35], v[164:167]
ds_read_b128 v[80:83], v3 offset:0
v_mfma_f32_16x16x32_bf16 v[200:203], v[76:79], v[32:35], v[200:203]
ds_read_b64_tr_b16 v[120:121], v6 offset:12288
v_mfma_f32_16x16x32_bf16 v[128:131], v[68:71], v[32:35], v[128:131]
ds_read_b64_tr_b16 v[122:123], v6 offset:12800
v_mfma_f32_16x16x32_bf16 v[168:171], v[72:75], v[36:39], v[168:171]
ds_read_b64_tr_b16 v[124:125], v6 offset:20480
v_mfma_f32_16x16x32_bf16 v[204:207], v[76:79], v[36:39], v[204:207]
ds_read_b64_tr_b16 v[126:127], v6 offset:20992
v_mfma_f32_16x16x32_bf16 v[132:135], v[68:71], v[36:39], v[132:135]
ds_read_b64_tr_b16 v[116:117], v6 offset:4096
v_mfma_f32_16x16x32_bf16 v[172:175], v[72:75], v[40:43], v[172:175]
ds_read_b64_tr_b16 v[118:119], v6 offset:4608
v_mfma_f32_16x16x32_bf16 v[208:211], v[76:79], v[40:43], v[208:211]
ds_read_b128 v[84:87], v3 offset:2048
v_mfma_f32_16x16x32_bf16 v[136:139], v[68:71], v[40:43], v[136:139]
ds_read_b128 v[88:91], v3 offset:4096
v_mfma_f32_16x16x32_bf16 v[176:179], v[72:75], v[44:47], v[176:179]
ds_read_b128 v[92:95], v3 offset:6144
v_mfma_f32_16x16x32_bf16 v[212:215], v[76:79], v[44:47], v[212:215]
ds_read_b128 v[96:99], v3 offset:8192
v_mfma_f32_16x16x32_bf16 v[140:143], v[68:71], v[44:47], v[140:143]
ds_read_b128 v[100:103], v3 offset:10240
v_mfma_f32_16x16x32_bf16 v[180:183], v[72:75], v[48:51], v[180:183]
ds_read_b128 v[104:107], v3 offset:12288
v_mfma_f32_16x16x32_bf16 v[216:219], v[76:79], v[48:51], v[216:219]
ds_read_b128 v[108:111], v3 offset:14336
v_mfma_f32_16x16x32_bf16 v[144:147], v[68:71], v[48:51], v[144:147]
ds_read_b128 v[112:115], v3 offset:16384
v_mfma_f32_16x16x32_bf16 v[184:187], v[72:75], v[52:55], v[184:187]
v_mfma_f32_16x16x32_bf16 v[220:223], v[76:79], v[52:55], v[220:223]
v_mfma_f32_16x16x32_bf16 v[148:151], v[68:71], v[52:55], v[148:151]
v_mfma_f32_16x16x32_bf16 v[188:191], v[72:75], v[56:59], v[188:191]
v_mfma_f32_16x16x32_bf16 v[224:227], v[76:79], v[56:59], v[224:227]
v_mfma_f32_16x16x32_bf16 v[152:155], v[68:71], v[56:59], v[152:155]
v_mfma_f32_16x16x32_bf16 v[192:195], v[72:75], v[60:63], v[192:195]
v_mfma_f32_16x16x32_bf16 v[228:231], v[76:79], v[60:63], v[228:231]
v_mfma_f32_16x16x32_bf16 v[156:159], v[68:71], v[60:63], v[156:159]
v_mfma_f32_16x16x32_bf16 v[196:199], v[72:75], v[64:67], v[196:199]
v_mfma_f32_16x16x32_bf16 v[232:235], v[76:79], v[64:67], v[232:235]
v_mfma_f32_16x16x32_bf16 v[160:163], v[68:71], v[64:67], v[160:163]
s_waitcnt lgkmcnt(0)
s_barrier
v_mfma_f32_16x16x32_bf16 v[164:167], v[120:123], v[80:83], v[164:167]
ds_read_b128 v[32:35], v2 offset:43008
v_mfma_f32_16x16x32_bf16 v[200:203], v[124:127], v[80:83], v[200:203]
ds_read_b64_tr_b16 v[72:73], v7 offset:8192
v_mfma_f32_16x16x32_bf16 v[128:131], v[116:119], v[80:83], v[128:131]
ds_read_b64_tr_b16 v[74:75], v7 offset:8704
v_mfma_f32_16x16x32_bf16 v[168:171], v[120:123], v[84:87], v[168:171]
ds_read_b64_tr_b16 v[76:77], v7 offset:16384
v_mfma_f32_16x16x32_bf16 v[204:207], v[124:127], v[84:87], v[204:207]
ds_read_b64_tr_b16 v[78:79], v7 offset:16896
v_mfma_f32_16x16x32_bf16 v[132:135], v[116:119], v[84:87], v[132:135]
ds_read_b64_tr_b16 v[68:69], v7 offset:0
v_mfma_f32_16x16x32_bf16 v[172:175], v[120:123], v[88:91], v[172:175]
ds_read_b64_tr_b16 v[70:71], v7 offset:512
v_mfma_f32_16x16x32_bf16 v[208:211], v[124:127], v[88:91], v[208:211]
ds_read_b128 v[36:39], v2 offset:45056
v_mfma_f32_16x16x32_bf16 v[136:139], v[116:119], v[88:91], v[136:139]
ds_read_b128 v[40:43], v2 offset:47104
v_mfma_f32_16x16x32_bf16 v[176:179], v[120:123], v[92:95], v[176:179]
ds_read_b128 v[44:47], v2 offset:49152
v_mfma_f32_16x16x32_bf16 v[212:215], v[124:127], v[92:95], v[212:215]
ds_read_b128 v[48:51], v2 offset:51200
v_mfma_f32_16x16x32_bf16 v[140:143], v[116:119], v[92:95], v[140:143]
ds_read_b128 v[52:55], v2 offset:53248
v_mfma_f32_16x16x32_bf16 v[180:183], v[120:123], v[96:99], v[180:183]
ds_read_b128 v[56:59], v2 offset:55296
v_mfma_f32_16x16x32_bf16 v[216:219], v[124:127], v[96:99], v[216:219]
ds_read_b128 v[60:63], v2 offset:57344
v_mfma_f32_16x16x32_bf16 v[144:147], v[116:119], v[96:99], v[144:147]
ds_read_b128 v[64:67], v2 offset:59392
v_mfma_f32_16x16x32_bf16 v[184:187], v[120:123], v[100:103], v[184:187]
v_mfma_f32_16x16x32_bf16 v[220:223], v[124:127], v[100:103], v[220:223]
v_mfma_f32_16x16x32_bf16 v[148:151], v[116:119], v[100:103], v[148:151]
v_mfma_f32_16x16x32_bf16 v[188:191], v[120:123], v[104:107], v[188:191]
v_mfma_f32_16x16x32_bf16 v[224:227], v[124:127], v[104:107], v[224:227]
v_mfma_f32_16x16x32_bf16 v[152:155], v[116:119], v[104:107], v[152:155]
v_mfma_f32_16x16x32_bf16 v[192:195], v[120:123], v[108:111], v[192:195]
v_mfma_f32_16x16x32_bf16 v[228:231], v[124:127], v[108:111], v[228:231]
v_mfma_f32_16x16x32_bf16 v[156:159], v[116:119], v[108:111], v[156:159]
v_mfma_f32_16x16x32_bf16 v[196:199], v[120:123], v[112:115], v[196:199]
v_mfma_f32_16x16x32_bf16 v[232:235], v[124:127], v[112:115], v[232:235]
v_mfma_f32_16x16x32_bf16 v[160:163], v[116:119], v[112:115], v[160:163]
s_waitcnt lgkmcnt(0)
v_mfma_f32_16x16x32_bf16 v[164:167], v[72:75], v[32:35], v[164:167]
ds_read_b128 v[80:83], v3 offset:43008
v_mfma_f32_16x16x32_bf16 v[200:203], v[76:79], v[32:35], v[200:203]
ds_read_b64_tr_b16 v[120:121], v7 offset:12288
v_mfma_f32_16x16x32_bf16 v[128:131], v[68:71], v[32:35], v[128:131]
ds_read_b64_tr_b16 v[122:123], v7 offset:12800
v_mfma_f32_16x16x32_bf16 v[168:171], v[72:75], v[36:39], v[168:171]
ds_read_b64_tr_b16 v[124:125], v7 offset:20480
v_mfma_f32_16x16x32_bf16 v[204:207], v[76:79], v[36:39], v[204:207]
ds_read_b64_tr_b16 v[126:127], v7 offset:20992
v_mfma_f32_16x16x32_bf16 v[132:135], v[68:71], v[36:39], v[132:135]
ds_read_b64_tr_b16 v[116:117], v7 offset:4096
v_mfma_f32_16x16x32_bf16 v[172:175], v[72:75], v[40:43], v[172:175]
ds_read_b64_tr_b16 v[118:119], v7 offset:4608
v_mfma_f32_16x16x32_bf16 v[208:211], v[76:79], v[40:43], v[208:211]
ds_read_b128 v[84:87], v3 offset:45056
v_mfma_f32_16x16x32_bf16 v[136:139], v[68:71], v[40:43], v[136:139]
ds_read_b128 v[88:91], v3 offset:47104
v_mfma_f32_16x16x32_bf16 v[176:179], v[72:75], v[44:47], v[176:179]
ds_read_b128 v[92:95], v3 offset:49152
v_mfma_f32_16x16x32_bf16 v[212:215], v[76:79], v[44:47], v[212:215]
ds_read_b128 v[96:99], v3 offset:51200
v_mfma_f32_16x16x32_bf16 v[140:143], v[68:71], v[44:47], v[140:143]
ds_read_b128 v[100:103], v3 offset:53248
v_mfma_f32_16x16x32_bf16 v[180:183], v[72:75], v[48:51], v[180:183]
ds_read_b128 v[104:107], v3 offset:55296
v_mfma_f32_16x16x32_bf16 v[216:219], v[76:79], v[48:51], v[216:219]
ds_read_b128 v[108:111], v3 offset:57344
v_mfma_f32_16x16x32_bf16 v[144:147], v[68:71], v[48:51], v[144:147]
ds_read_b128 v[112:115], v3 offset:59392
v_mfma_f32_16x16x32_bf16 v[184:187], v[72:75], v[52:55], v[184:187]
v_mfma_f32_16x16x32_bf16 v[220:223], v[76:79], v[52:55], v[220:223]
v_mfma_f32_16x16x32_bf16 v[148:151], v[68:71], v[52:55], v[148:151]
v_mfma_f32_16x16x32_bf16 v[188:191], v[72:75], v[56:59], v[188:191]
v_mfma_f32_16x16x32_bf16 v[224:227], v[76:79], v[56:59], v[224:227]
v_mfma_f32_16x16x32_bf16 v[152:155], v[68:71], v[56:59], v[152:155]
v_mfma_f32_16x16x32_bf16 v[192:195], v[72:75], v[60:63], v[192:195]
v_mfma_f32_16x16x32_bf16 v[228:231], v[76:79], v[60:63], v[228:231]
v_mfma_f32_16x16x32_bf16 v[156:159], v[68:71], v[60:63], v[156:159]
v_mfma_f32_16x16x32_bf16 v[196:199], v[72:75], v[64:67], v[196:199]
v_mfma_f32_16x16x32_bf16 v[232:235], v[76:79], v[64:67], v[232:235]
v_mfma_f32_16x16x32_bf16 v[160:163], v[68:71], v[64:67], v[160:163]
s_waitcnt lgkmcnt(0)
s_barrier
v_mfma_f32_16x16x32_bf16 v[164:167], v[120:123], v[80:83], v[164:167]
ds_read_b128 v[32:35], v4 offset:0
v_mfma_f32_16x16x32_bf16 v[200:203], v[124:127], v[80:83], v[200:203]
ds_read_b64_tr_b16 v[72:73], v8 offset:8192
v_mfma_f32_16x16x32_bf16 v[128:131], v[116:119], v[80:83], v[128:131]
ds_read_b64_tr_b16 v[74:75], v8 offset:8704
v_mfma_f32_16x16x32_bf16 v[168:171], v[120:123], v[84:87], v[168:171]
ds_read_b64_tr_b16 v[76:77], v8 offset:16384
v_mfma_f32_16x16x32_bf16 v[204:207], v[124:127], v[84:87], v[204:207]
ds_read_b64_tr_b16 v[78:79], v8 offset:16896
v_mfma_f32_16x16x32_bf16 v[132:135], v[116:119], v[84:87], v[132:135]
ds_read_b64_tr_b16 v[68:69], v8 offset:0
v_mfma_f32_16x16x32_bf16 v[172:175], v[120:123], v[88:91], v[172:175]
ds_read_b64_tr_b16 v[70:71], v8 offset:512
v_mfma_f32_16x16x32_bf16 v[208:211], v[124:127], v[88:91], v[208:211]
ds_read_b128 v[36:39], v4 offset:2048
v_mfma_f32_16x16x32_bf16 v[136:139], v[116:119], v[88:91], v[136:139]
ds_read_b128 v[40:43], v4 offset:4096
v_mfma_f32_16x16x32_bf16 v[176:179], v[120:123], v[92:95], v[176:179]
ds_read_b128 v[44:47], v4 offset:6144
v_mfma_f32_16x16x32_bf16 v[212:215], v[124:127], v[92:95], v[212:215]
ds_read_b128 v[48:51], v4 offset:8192
v_mfma_f32_16x16x32_bf16 v[140:143], v[116:119], v[92:95], v[140:143]
ds_read_b128 v[52:55], v4 offset:10240
v_mfma_f32_16x16x32_bf16 v[180:183], v[120:123], v[96:99], v[180:183]
ds_read_b128 v[56:59], v4 offset:12288
v_mfma_f32_16x16x32_bf16 v[216:219], v[124:127], v[96:99], v[216:219]
ds_read_b128 v[60:63], v4 offset:14336
v_mfma_f32_16x16x32_bf16 v[144:147], v[116:119], v[96:99], v[144:147]
ds_read_b128 v[64:67], v4 offset:16384
v_mfma_f32_16x16x32_bf16 v[184:187], v[120:123], v[100:103], v[184:187]
v_mfma_f32_16x16x32_bf16 v[220:223], v[124:127], v[100:103], v[220:223]
v_mfma_f32_16x16x32_bf16 v[148:151], v[116:119], v[100:103], v[148:151]
v_mfma_f32_16x16x32_bf16 v[188:191], v[120:123], v[104:107], v[188:191]
v_mfma_f32_16x16x32_bf16 v[224:227], v[124:127], v[104:107], v[224:227]
v_mfma_f32_16x16x32_bf16 v[152:155], v[116:119], v[104:107], v[152:155]
v_mfma_f32_16x16x32_bf16 v[192:195], v[120:123], v[108:111], v[192:195]
v_mfma_f32_16x16x32_bf16 v[228:231], v[124:127], v[108:111], v[228:231]
v_mfma_f32_16x16x32_bf16 v[156:159], v[116:119], v[108:111], v[156:159]
v_mfma_f32_16x16x32_bf16 v[196:199], v[120:123], v[112:115], v[196:199]
v_mfma_f32_16x16x32_bf16 v[232:235], v[124:127], v[112:115], v[232:235]
v_mfma_f32_16x16x32_bf16 v[160:163], v[116:119], v[112:115], v[160:163]
s_waitcnt lgkmcnt(0)
v_mfma_f32_16x16x32_bf16 v[164:167], v[72:75], v[32:35], v[164:167]
ds_read_b128 v[80:83], v5 offset:0
v_mfma_f32_16x16x32_bf16 v[200:203], v[76:79], v[32:35], v[200:203]
ds_read_b64_tr_b16 v[120:121], v8 offset:12288
v_mfma_f32_16x16x32_bf16 v[128:131], v[68:71], v[32:35], v[128:131]
ds_read_b64_tr_b16 v[122:123], v8 offset:12800
v_mfma_f32_16x16x32_bf16 v[168:171], v[72:75], v[36:39], v[168:171]
ds_read_b64_tr_b16 v[124:125], v8 offset:20480
v_mfma_f32_16x16x32_bf16 v[204:207], v[76:79], v[36:39], v[204:207]
ds_read_b64_tr_b16 v[126:127], v8 offset:20992
v_mfma_f32_16x16x32_bf16 v[132:135], v[68:71], v[36:39], v[132:135]
ds_read_b64_tr_b16 v[116:117], v8 offset:4096
v_mfma_f32_16x16x32_bf16 v[172:175], v[72:75], v[40:43], v[172:175]
ds_read_b64_tr_b16 v[118:119], v8 offset:4608
v_mfma_f32_16x16x32_bf16 v[208:211], v[76:79], v[40:43], v[208:211]
ds_read_b128 v[84:87], v5 offset:2048
v_mfma_f32_16x16x32_bf16 v[136:139], v[68:71], v[40:43], v[136:139]
ds_read_b128 v[88:91], v5 offset:4096
v_mfma_f32_16x16x32_bf16 v[176:179], v[72:75], v[44:47], v[176:179]
ds_read_b128 v[92:95], v5 offset:6144
v_mfma_f32_16x16x32_bf16 v[212:215], v[76:79], v[44:47], v[212:215]
ds_read_b128 v[96:99], v5 offset:8192
v_mfma_f32_16x16x32_bf16 v[140:143], v[68:71], v[44:47], v[140:143]
ds_read_b128 v[100:103], v5 offset:10240
v_mfma_f32_16x16x32_bf16 v[180:183], v[72:75], v[48:51], v[180:183]
ds_read_b128 v[104:107], v5 offset:12288
v_mfma_f32_16x16x32_bf16 v[216:219], v[76:79], v[48:51], v[216:219]
ds_read_b128 v[108:111], v5 offset:14336
v_mfma_f32_16x16x32_bf16 v[144:147], v[68:71], v[48:51], v[144:147]
ds_read_b128 v[112:115], v5 offset:16384
v_mfma_f32_16x16x32_bf16 v[184:187], v[72:75], v[52:55], v[184:187]
v_mfma_f32_16x16x32_bf16 v[220:223], v[76:79], v[52:55], v[220:223]
v_mfma_f32_16x16x32_bf16 v[148:151], v[68:71], v[52:55], v[148:151]
v_mfma_f32_16x16x32_bf16 v[188:191], v[72:75], v[56:59], v[188:191]
v_mfma_f32_16x16x32_bf16 v[224:227], v[76:79], v[56:59], v[224:227]
v_mfma_f32_16x16x32_bf16 v[152:155], v[68:71], v[56:59], v[152:155]
v_mfma_f32_16x16x32_bf16 v[192:195], v[72:75], v[60:63], v[192:195]
v_mfma_f32_16x16x32_bf16 v[228:231], v[76:79], v[60:63], v[228:231]
v_mfma_f32_16x16x32_bf16 v[156:159], v[68:71], v[60:63], v[156:159]
v_mfma_f32_16x16x32_bf16 v[196:199], v[72:75], v[64:67], v[196:199]
v_mfma_f32_16x16x32_bf16 v[232:235], v[76:79], v[64:67], v[232:235]
v_mfma_f32_16x16x32_bf16 v[160:163], v[68:71], v[64:67], v[160:163]
s_waitcnt lgkmcnt(0)
s_barrier
v_mfma_f32_16x16x32_bf16 v[164:167], v[120:123], v[80:83], v[164:167]
ds_read_b128 v[32:35], v2 offset:0
v_mfma_f32_16x16x32_bf16 v[200:203], v[124:127], v[80:83], v[200:203]
ds_read_b64_tr_b16 v[72:73], v6 offset:8192
v_mfma_f32_16x16x32_bf16 v[128:131], v[116:119], v[80:83], v[128:131]
ds_read_b64_tr_b16 v[74:75], v6 offset:8704
v_mfma_f32_16x16x32_bf16 v[168:171], v[120:123], v[84:87], v[168:171]
ds_read_b64_tr_b16 v[76:77], v6 offset:16384
v_mfma_f32_16x16x32_bf16 v[204:207], v[124:127], v[84:87], v[204:207]
ds_read_b64_tr_b16 v[78:79], v6 offset:16896
v_mfma_f32_16x16x32_bf16 v[132:135], v[116:119], v[84:87], v[132:135]
ds_read_b64_tr_b16 v[68:69], v6 offset:0
v_mfma_f32_16x16x32_bf16 v[172:175], v[120:123], v[88:91], v[172:175]
ds_read_b64_tr_b16 v[70:71], v6 offset:512
v_mfma_f32_16x16x32_bf16 v[208:211], v[124:127], v[88:91], v[208:211]
ds_read_b128 v[36:39], v2 offset:2048
v_mfma_f32_16x16x32_bf16 v[136:139], v[116:119], v[88:91], v[136:139]
ds_read_b128 v[40:43], v2 offset:4096
v_mfma_f32_16x16x32_bf16 v[176:179], v[120:123], v[92:95], v[176:179]
ds_read_b128 v[44:47], v2 offset:6144
v_mfma_f32_16x16x32_bf16 v[212:215], v[124:127], v[92:95], v[212:215]
ds_read_b128 v[48:51], v2 offset:8192
v_mfma_f32_16x16x32_bf16 v[140:143], v[116:119], v[92:95], v[140:143]
ds_read_b128 v[52:55], v2 offset:10240
v_mfma_f32_16x16x32_bf16 v[180:183], v[120:123], v[96:99], v[180:183]
ds_read_b128 v[56:59], v2 offset:12288
v_mfma_f32_16x16x32_bf16 v[216:219], v[124:127], v[96:99], v[216:219]
ds_read_b128 v[60:63], v2 offset:14336
v_mfma_f32_16x16x32_bf16 v[144:147], v[116:119], v[96:99], v[144:147]
ds_read_b128 v[64:67], v2 offset:16384
v_mfma_f32_16x16x32_bf16 v[184:187], v[120:123], v[100:103], v[184:187]
v_mfma_f32_16x16x32_bf16 v[220:223], v[124:127], v[100:103], v[220:223]
v_mfma_f32_16x16x32_bf16 v[148:151], v[116:119], v[100:103], v[148:151]
v_mfma_f32_16x16x32_bf16 v[188:191], v[120:123], v[104:107], v[188:191]
v_mfma_f32_16x16x32_bf16 v[224:227], v[124:127], v[104:107], v[224:227]
v_mfma_f32_16x16x32_bf16 v[152:155], v[116:119], v[104:107], v[152:155]
v_mfma_f32_16x16x32_bf16 v[192:195], v[120:123], v[108:111], v[192:195]
v_mfma_f32_16x16x32_bf16 v[228:231], v[124:127], v[108:111], v[228:231]
v_mfma_f32_16x16x32_bf16 v[156:159], v[116:119], v[108:111], v[156:159]
v_mfma_f32_16x16x32_bf16 v[196:199], v[120:123], v[112:115], v[196:199]
v_mfma_f32_16x16x32_bf16 v[232:235], v[124:127], v[112:115], v[232:235]
v_mfma_f32_16x16x32_bf16 v[160:163], v[116:119], v[112:115], v[160:163]
s_sub_u32 s41, s41, 1
s_cmp_lg_u32 s41, 0
s_cbranch_scc1 Lcl_5
s_waitcnt lgkmcnt(0)
v_mfma_f32_16x16x32_bf16 v[164:167], v[72:75], v[32:35], v[164:167]
ds_read_b128 v[80:83], v3 offset:0
v_mfma_f32_16x16x32_bf16 v[200:203], v[76:79], v[32:35], v[200:203]
ds_read_b64_tr_b16 v[120:121], v6 offset:12288
v_mfma_f32_16x16x32_bf16 v[128:131], v[68:71], v[32:35], v[128:131]
ds_read_b64_tr_b16 v[122:123], v6 offset:12800
v_mfma_f32_16x16x32_bf16 v[168:171], v[72:75], v[36:39], v[168:171]
ds_read_b64_tr_b16 v[124:125], v6 offset:20480
v_mfma_f32_16x16x32_bf16 v[204:207], v[76:79], v[36:39], v[204:207]
ds_read_b64_tr_b16 v[126:127], v6 offset:20992
v_mfma_f32_16x16x32_bf16 v[132:135], v[68:71], v[36:39], v[132:135]
ds_read_b64_tr_b16 v[116:117], v6 offset:4096
v_mfma_f32_16x16x32_bf16 v[172:175], v[72:75], v[40:43], v[172:175]
ds_read_b64_tr_b16 v[118:119], v6 offset:4608
v_mfma_f32_16x16x32_bf16 v[208:211], v[76:79], v[40:43], v[208:211]
ds_read_b128 v[84:87], v3 offset:2048
v_mfma_f32_16x16x32_bf16 v[136:139], v[68:71], v[40:43], v[136:139]
ds_read_b128 v[88:91], v3 offset:4096
v_mfma_f32_16x16x32_bf16 v[176:179], v[72:75], v[44:47], v[176:179]
ds_read_b128 v[92:95], v3 offset:6144
v_mfma_f32_16x16x32_bf16 v[212:215], v[76:79], v[44:47], v[212:215]
ds_read_b128 v[96:99], v3 offset:8192
v_mfma_f32_16x16x32_bf16 v[140:143], v[68:71], v[44:47], v[140:143]
ds_read_b128 v[100:103], v3 offset:10240
v_mfma_f32_16x16x32_bf16 v[180:183], v[72:75], v[48:51], v[180:183]
ds_read_b128 v[104:107], v3 offset:12288
v_mfma_f32_16x16x32_bf16 v[216:219], v[76:79], v[48:51], v[216:219]
ds_read_b128 v[108:111], v3 offset:14336
v_mfma_f32_16x16x32_bf16 v[144:147], v[68:71], v[48:51], v[144:147]
ds_read_b128 v[112:115], v3 offset:16384
v_mfma_f32_16x16x32_bf16 v[184:187], v[72:75], v[52:55], v[184:187]
v_mfma_f32_16x16x32_bf16 v[220:223], v[76:79], v[52:55], v[220:223]
v_mfma_f32_16x16x32_bf16 v[148:151], v[68:71], v[52:55], v[148:151]
v_mfma_f32_16x16x32_bf16 v[188:191], v[72:75], v[56:59], v[188:191]
v_mfma_f32_16x16x32_bf16 v[224:227], v[76:79], v[56:59], v[224:227]
v_mfma_f32_16x16x32_bf16 v[152:155], v[68:71], v[56:59], v[152:155]
v_mfma_f32_16x16x32_bf16 v[192:195], v[72:75], v[60:63], v[192:195]
v_mfma_f32_16x16x32_bf16 v[228:231], v[76:79], v[60:63], v[228:231]
v_mfma_f32_16x16x32_bf16 v[156:159], v[68:71], v[60:63], v[156:159]
v_mfma_f32_16x16x32_bf16 v[196:199], v[72:75], v[64:67], v[196:199]
v_mfma_f32_16x16x32_bf16 v[232:235], v[76:79], v[64:67], v[232:235]
v_mfma_f32_16x16x32_bf16 v[160:163], v[68:71], v[64:67], v[160:163]
s_waitcnt lgkmcnt(0)
s_barrier
v_mfma_f32_16x16x32_bf16 v[164:167], v[120:123], v[80:83], v[164:167]
v_mfma_f32_16x16x32_bf16 v[200:203], v[124:127], v[80:83], v[200:203]
v_mfma_f32_16x16x32_bf16 v[128:131], v[116:119], v[80:83], v[128:131]
v_mfma_f32_16x16x32_bf16 v[168:171], v[120:123], v[84:87], v[168:171]
v_mfma_f32_16x16x32_bf16 v[204:207], v[124:127], v[84:87], v[204:207]
v_mfma_f32_16x16x32_bf16 v[132:135], v[116:119], v[84:87], v[132:135]
v_mfma_f32_16x16x32_bf16 v[172:175], v[120:123], v[88:91], v[172:175]
v_mfma_f32_16x16x32_bf16 v[208:211], v[124:127], v[88:91], v[208:211]
v_mfma_f32_16x16x32_bf16 v[136:139], v[116:119], v[88:91], v[136:139]
v_mfma_f32_16x16x32_bf16 v[176:179], v[120:123], v[92:95], v[176:179]
v_mfma_f32_16x16x32_bf16 v[212:215], v[124:127], v[92:95], v[212:215]
v_mfma_f32_16x16x32_bf16 v[140:143], v[116:119], v[92:95], v[140:143]
v_mfma_f32_16x16x32_bf16 v[180:183], v[120:123], v[96:99], v[180:183]
v_mfma_f32_16x16x32_bf16 v[216:219], v[124:127], v[96:99], v[216:219]
v_mfma_f32_16x16x32_bf16 v[144:147], v[116:119], v[96:99], v[144:147]
v_mfma_f32_16x16x32_bf16 v[184:187], v[120:123], v[100:103], v[184:187]
v_mfma_f32_16x16x32_bf16 v[220:223], v[124:127], v[100:103], v[220:223]
v_mfma_f32_16x16x32_bf16 v[148:151], v[116:119], v[100:103], v[148:151]
v_mfma_f32_16x16x32_bf16 v[188:191], v[120:123], v[104:107], v[188:191]
v_mfma_f32_16x16x32_bf16 v[224:227], v[124:127], v[104:107], v[224:227]
v_mfma_f32_16x16x32_bf16 v[152:155], v[116:119], v[104:107], v[152:155]
v_mfma_f32_16x16x32_bf16 v[192:195], v[120:123], v[108:111], v[192:195]
v_mfma_f32_16x16x32_bf16 v[228:231], v[124:127], v[108:111], v[228:231]
v_mfma_f32_16x16x32_bf16 v[156:159], v[116:119], v[108:111], v[156:159]
v_mfma_f32_16x16x32_bf16 v[196:199], v[120:123], v[112:115], v[196:199]
v_mfma_f32_16x16x32_bf16 v[232:235], v[124:127], v[112:115], v[232:235]
v_mfma_f32_16x16x32_bf16 v[160:163], v[116:119], v[112:115], v[160:163]
s_barrier
v_lshlrev_b32 v14, 3, v12
v_add_u32 v14, 129024, v14
ds_read_b64 v[32:33], v14 offset:0
ds_read_b64 v[34:35], v14 offset:128
ds_read_b64 v[36:37], v14 offset:256
ds_read_b64 v[38:39], v14 offset:384
ds_read_b64 v[40:41], v14 offset:512
ds_read_b64 v[42:43], v14 offset:640
ds_read_b64 v[44:45], v14 offset:768
ds_read_b64 v[46:47], v14 offset:896
ds_read_b64 v[48:49], v14 offset:1024
v_mov_b32_dpp v52, v128 row_newbcast:0 row_mask:0xf bank_mask:0xf
v_mov_b32_dpp v53, v129 row_newbcast:0 row_mask:0xf bank_mask:0xf
v_mov_b32_dpp v54, v130 row_newbcast:0 row_mask:0xf bank_mask:0xf
v_mov_b32_dpp v55, v131 row_newbcast:0 row_mask:0xf bank_mask:0xf
v_mov_b32_dpp v56, v164 row_newbcast:0 row_mask:0xf bank_mask:0xf
v_mov_b32_dpp v57, v165 row_newbcast:0 row_mask:0xf bank_mask:0xf
v_mov_b32_dpp v58, v166 row_newbcast:0 row_mask:0xf bank_mask:0xf
v_mov_b32_dpp v59, v167 row_newbcast:0 row_mask:0xf bank_mask:0xf
v_mov_b32_dpp v60, v200 row_newbcast:0 row_mask:0xf bank_mask:0xf
v_mov_b32_dpp v61, v201 row_newbcast:0 row_mask:0xf bank_mask:0xf
v_mov_b32_dpp v62, v202 row_newbcast:0 row_mask:0xf bank_mask:0xf
v_mov_b32_dpp v63, v203 row_newbcast:0 row_mask:0xf bank_mask:0xf
v_mul_u32_u24 v14, 400, v12
v_lshl_add_u32 v14, v13, 3, v14
s_lshl_b32 s43, s36, 5
v_add_u32 v14, s43, v14
s_waitcnt lgkmcnt(0)
v_pk_fma_f32 v[164:165], v[32:33], v[56:57], v[164:165] op_sel_hi:[0,1,1] neg_lo:[1,0,0] neg_hi:[1,0,0]
v_pk_fma_f32 v[166:167], v[32:33], v[58:59], v[166:167] op_sel_hi:[0,1,1] neg_lo:[1,0,0] neg_hi:[1,0,0]
v_pk_mul_f32 v[164:165], v[32:33], v[164:165] op_sel:[1,0] op_sel_hi:[1,1]
v_pk_mul_f32 v[166:167], v[32:33], v[166:167] op_sel:[1,0] op_sel_hi:[1,1]
v_cvt_pk_bf16_f32 v164, v164, v165
v_cvt_pk_bf16_f32 v165, v166, v167
ds_write_b64 v14, v[164:165] offset:128
v_pk_fma_f32 v[200:201], v[32:33], v[60:61], v[200:201] op_sel_hi:[0,1,1] neg_lo:[1,0,0] neg_hi:[1,0,0]
v_pk_fma_f32 v[202:203], v[32:33], v[62:63], v[202:203] op_sel_hi:[0,1,1] neg_lo:[1,0,0] neg_hi:[1,0,0]
v_pk_mul_f32 v[200:201], v[32:33], v[200:201] op_sel:[1,0] op_sel_hi:[1,1]
v_pk_mul_f32 v[202:203], v[32:33], v[202:203] op_sel:[1,0] op_sel_hi:[1,1]
v_cvt_pk_bf16_f32 v200, v200, v201
v_cvt_pk_bf16_f32 v201, v202, v203
ds_write_b64 v14, v[200:201] offset:256
v_pk_fma_f32 v[132:133], v[34:35], v[52:53], v[132:133] op_sel_hi:[0,1,1] neg_lo:[1,0,0] neg_hi:[1,0,0]
v_pk_fma_f32 v[134:135], v[34:35], v[54:55], v[134:135] op_sel_hi:[0,1,1] neg_lo:[1,0,0] neg_hi:[1,0,0]
v_pk_mul_f32 v[132:133], v[34:35], v[132:133] op_sel:[1,0] op_sel_hi:[1,1]
v_pk_mul_f32 v[134:135], v[34:35], v[134:135] op_sel:[1,0] op_sel_hi:[1,1]
v_cvt_pk_bf16_f32 v132, v132, v133
v_cvt_pk_bf16_f32 v133, v134, v135
ds_write_b64 v14, v[132:133] offset:6400
v_pk_fma_f32 v[168:169], v[34:35], v[56:57], v[168:169] op_sel_hi:[0,1,1] neg_lo:[1,0,0] neg_hi:[1,0,0]
v_pk_fma_f32 v[170:171], v[34:35], v[58:59], v[170:171] op_sel_hi:[0,1,1] neg_lo:[1,0,0] neg_hi:[1,0,0]
v_pk_mul_f32 v[168:169], v[34:35], v[168:169] op_sel:[1,0] op_sel_hi:[1,1]
v_pk_mul_f32 v[170:171], v[34:35], v[170:171] op_sel:[1,0] op_sel_hi:[1,1]
v_cvt_pk_bf16_f32 v168, v168, v169
v_cvt_pk_bf16_f32 v169, v170, v171
ds_write_b64 v14, v[168:169] offset:6528
v_pk_fma_f32 v[204:205], v[34:35], v[60:61], v[204:205] op_sel_hi:[0,1,1] neg_lo:[1,0,0] neg_hi:[1,0,0]
v_pk_fma_f32 v[206:207], v[34:35], v[62:63], v[206:207] op_sel_hi:[0,1,1] neg_lo:[1,0,0] neg_hi:[1,0,0]
v_pk_mul_f32 v[204:205], v[34:35], v[204:205] op_sel:[1,0] op_sel_hi:[1,1]
v_pk_mul_f32 v[206:207], v[34:35], v[206:207] op_sel:[1,0] op_sel_hi:[1,1]
v_cvt_pk_bf16_f32 v204, v204, v205
v_cvt_pk_bf16_f32 v205, v206, v207
ds_write_b64 v14, v[204:205] offset:6656
v_pk_fma_f32 v[136:137], v[36:37], v[52:53], v[136:137] op_sel_hi:[0,1,1] neg_lo:[1,0,0] neg_hi:[1,0,0]
v_pk_fma_f32 v[138:139], v[36:37], v[54:55], v[138:139] op_sel_hi:[0,1,1] neg_lo:[1,0,0] neg_hi:[1,0,0]
v_pk_mul_f32 v[136:137], v[36:37], v[136:137] op_sel:[1,0] op_sel_hi:[1,1]
v_pk_mul_f32 v[138:139], v[36:37], v[138:139] op_sel:[1,0] op_sel_hi:[1,1]
v_cvt_pk_bf16_f32 v136, v136, v137
v_cvt_pk_bf16_f32 v137, v138, v139
ds_write_b64 v14, v[136:137] offset:12800
v_pk_fma_f32 v[172:173], v[36:37], v[56:57], v[172:173] op_sel_hi:[0,1,1] neg_lo:[1,0,0] neg_hi:[1,0,0]
v_pk_fma_f32 v[174:175], v[36:37], v[58:59], v[174:175] op_sel_hi:[0,1,1] neg_lo:[1,0,0] neg_hi:[1,0,0]
v_pk_mul_f32 v[172:173], v[36:37], v[172:173] op_sel:[1,0] op_sel_hi:[1,1]
v_pk_mul_f32 v[174:175], v[36:37], v[174:175] op_sel:[1,0] op_sel_hi:[1,1]
v_cvt_pk_bf16_f32 v172, v172, v173
v_cvt_pk_bf16_f32 v173, v174, v175
ds_write_b64 v14, v[172:173] offset:12928
v_pk_fma_f32 v[208:209], v[36:37], v[60:61], v[208:209] op_sel_hi:[0,1,1] neg_lo:[1,0,0] neg_hi:[1,0,0]
v_pk_fma_f32 v[210:211], v[36:37], v[62:63], v[210:211] op_sel_hi:[0,1,1] neg_lo:[1,0,0] neg_hi:[1,0,0]
v_pk_mul_f32 v[208:209], v[36:37], v[208:209] op_sel:[1,0] op_sel_hi:[1,1]
v_pk_mul_f32 v[210:211], v[36:37], v[210:211] op_sel:[1,0] op_sel_hi:[1,1]
v_cvt_pk_bf16_f32 v208, v208, v209
v_cvt_pk_bf16_f32 v209, v210, v211
ds_write_b64 v14, v[208:209] offset:13056
v_pk_fma_f32 v[140:141], v[38:39], v[52:53], v[140:141] op_sel_hi:[0,1,1] neg_lo:[1,0,0] neg_hi:[1,0,0]
v_pk_fma_f32 v[142:143], v[38:39], v[54:55], v[142:143] op_sel_hi:[0,1,1] neg_lo:[1,0,0] neg_hi:[1,0,0]
v_pk_mul_f32 v[140:141], v[38:39], v[140:141] op_sel:[1,0] op_sel_hi:[1,1]
v_pk_mul_f32 v[142:143], v[38:39], v[142:143] op_sel:[1,0] op_sel_hi:[1,1]
v_cvt_pk_bf16_f32 v140, v140, v141
v_cvt_pk_bf16_f32 v141, v142, v143
ds_write_b64 v14, v[140:141] offset:19200
v_pk_fma_f32 v[176:177], v[38:39], v[56:57], v[176:177] op_sel_hi:[0,1,1] neg_lo:[1,0,0] neg_hi:[1,0,0]
v_pk_fma_f32 v[178:179], v[38:39], v[58:59], v[178:179] op_sel_hi:[0,1,1] neg_lo:[1,0,0] neg_hi:[1,0,0]
v_pk_mul_f32 v[176:177], v[38:39], v[176:177] op_sel:[1,0] op_sel_hi:[1,1]
v_pk_mul_f32 v[178:179], v[38:39], v[178:179] op_sel:[1,0] op_sel_hi:[1,1]
v_cvt_pk_bf16_f32 v176, v176, v177
v_cvt_pk_bf16_f32 v177, v178, v179
ds_write_b64 v14, v[176:177] offset:19328
v_pk_fma_f32 v[212:213], v[38:39], v[60:61], v[212:213] op_sel_hi:[0,1,1] neg_lo:[1,0,0] neg_hi:[1,0,0]
v_pk_fma_f32 v[214:215], v[38:39], v[62:63], v[214:215] op_sel_hi:[0,1,1] neg_lo:[1,0,0] neg_hi:[1,0,0]
v_pk_mul_f32 v[212:213], v[38:39], v[212:213] op_sel:[1,0] op_sel_hi:[1,1]
v_pk_mul_f32 v[214:215], v[38:39], v[214:215] op_sel:[1,0] op_sel_hi:[1,1]
v_cvt_pk_bf16_f32 v212, v212, v213
v_cvt_pk_bf16_f32 v213, v214, v215
ds_write_b64 v14, v[212:213] offset:19456
v_pk_fma_f32 v[144:145], v[40:41], v[52:53], v[144:145] op_sel_hi:[0,1,1] neg_lo:[1,0,0] neg_hi:[1,0,0]
v_pk_fma_f32 v[146:147], v[40:41], v[54:55], v[146:147] op_sel_hi:[0,1,1] neg_lo:[1,0,0] neg_hi:[1,0,0]
v_pk_mul_f32 v[144:145], v[40:41], v[144:145] op_sel:[1,0] op_sel_hi:[1,1]
v_pk_mul_f32 v[146:147], v[40:41], v[146:147] op_sel:[1,0] op_sel_hi:[1,1]
v_cvt_pk_bf16_f32 v144, v144, v145
v_cvt_pk_bf16_f32 v145, v146, v147
ds_write_b64 v14, v[144:145] offset:25600
v_pk_fma_f32 v[180:181], v[40:41], v[56:57], v[180:181] op_sel_hi:[0,1,1] neg_lo:[1,0,0] neg_hi:[1,0,0]
v_pk_fma_f32 v[182:183], v[40:41], v[58:59], v[182:183] op_sel_hi:[0,1,1] neg_lo:[1,0,0] neg_hi:[1,0,0]
v_pk_mul_f32 v[180:181], v[40:41], v[180:181] op_sel:[1,0] op_sel_hi:[1,1]
v_pk_mul_f32 v[182:183], v[40:41], v[182:183] op_sel:[1,0] op_sel_hi:[1,1]
v_cvt_pk_bf16_f32 v180, v180, v181
v_cvt_pk_bf16_f32 v181, v182, v183
ds_write_b64 v14, v[180:181] offset:25728
v_pk_fma_f32 v[216:217], v[40:41], v[60:61], v[216:217] op_sel_hi:[0,1,1] neg_lo:[1,0,0] neg_hi:[1,0,0]
v_pk_fma_f32 v[218:219], v[40:41], v[62:63], v[218:219] op_sel_hi:[0,1,1] neg_lo:[1,0,0] neg_hi:[1,0,0]
v_pk_mul_f32 v[216:217], v[40:41], v[216:217] op_sel:[1,0] op_sel_hi:[1,1]
v_pk_mul_f32 v[218:219], v[40:41], v[218:219] op_sel:[1,0] op_sel_hi:[1,1]
v_cvt_pk_bf16_f32 v216, v216, v217
v_cvt_pk_bf16_f32 v217, v218, v219
ds_write_b64 v14, v[216:217] offset:25856
v_pk_fma_f32 v[148:149], v[42:43], v[52:53], v[148:149] op_sel_hi:[0,1,1] neg_lo:[1,0,0] neg_hi:[1,0,0]
v_pk_fma_f32 v[150:151], v[42:43], v[54:55], v[150:151] op_sel_hi:[0,1,1] neg_lo:[1,0,0] neg_hi:[1,0,0]
v_pk_mul_f32 v[148:149], v[42:43], v[148:149] op_sel:[1,0] op_sel_hi:[1,1]
v_pk_mul_f32 v[150:151], v[42:43], v[150:151] op_sel:[1,0] op_sel_hi:[1,1]
v_cvt_pk_bf16_f32 v148, v148, v149
v_cvt_pk_bf16_f32 v149, v150, v151
ds_write_b64 v14, v[148:149] offset:32000
v_pk_fma_f32 v[184:185], v[42:43], v[56:57], v[184:185] op_sel_hi:[0,1,1] neg_lo:[1,0,0] neg_hi:[1,0,0]
v_pk_fma_f32 v[186:187], v[42:43], v[58:59], v[186:187] op_sel_hi:[0,1,1] neg_lo:[1,0,0] neg_hi:[1,0,0]
v_pk_mul_f32 v[184:185], v[42:43], v[184:185] op_sel:[1,0] op_sel_hi:[1,1]
v_pk_mul_f32 v[186:187], v[42:43], v[186:187] op_sel:[1,0] op_sel_hi:[1,1]
v_cvt_pk_bf16_f32 v184, v184, v185
v_cvt_pk_bf16_f32 v185, v186, v187
ds_write_b64 v14, v[184:185] offset:32128
v_pk_fma_f32 v[220:221], v[42:43], v[60:61], v[220:221] op_sel_hi:[0,1,1] neg_lo:[1,0,0] neg_hi:[1,0,0]
v_pk_fma_f32 v[222:223], v[42:43], v[62:63], v[222:223] op_sel_hi:[0,1,1] neg_lo:[1,0,0] neg_hi:[1,0,0]
v_pk_mul_f32 v[220:221], v[42:43], v[220:221] op_sel:[1,0] op_sel_hi:[1,1]
v_pk_mul_f32 v[222:223], v[42:43], v[222:223] op_sel:[1,0] op_sel_hi:[1,1]
v_cvt_pk_bf16_f32 v220, v220, v221
v_cvt_pk_bf16_f32 v221, v222, v223
ds_write_b64 v14, v[220:221] offset:32256
v_pk_fma_f32 v[152:153], v[44:45], v[52:53], v[152:153] op_sel_hi:[0,1,1] neg_lo:[1,0,0] neg_hi:[1,0,0]
v_pk_fma_f32 v[154:155], v[44:45], v[54:55], v[154:155] op_sel_hi:[0,1,1] neg_lo:[1,0,0] neg_hi:[1,0,0]
v_pk_mul_f32 v[152:153], v[44:45], v[152:153] op_sel:[1,0] op_sel_hi:[1,1]
v_pk_mul_f32 v[154:155], v[44:45], v[154:155] op_sel:[1,0] op_sel_hi:[1,1]
v_cvt_pk_bf16_f32 v152, v152, v153
v_cvt_pk_bf16_f32 v153, v154, v155
ds_write_b64 v14, v[152:153] offset:38400
v_pk_fma_f32 v[188:189], v[44:45], v[56:57], v[188:189] op_sel_hi:[0,1,1] neg_lo:[1,0,0] neg_hi:[1,0,0]
v_pk_fma_f32 v[190:191], v[44:45], v[58:59], v[190:191] op_sel_hi:[0,1,1] neg_lo:[1,0,0] neg_hi:[1,0,0]
v_pk_mul_f32 v[188:189], v[44:45], v[188:189] op_sel:[1,0] op_sel_hi:[1,1]
v_pk_mul_f32 v[190:191], v[44:45], v[190:191] op_sel:[1,0] op_sel_hi:[1,1]
v_cvt_pk_bf16_f32 v188, v188, v189
v_cvt_pk_bf16_f32 v189, v190, v191
ds_write_b64 v14, v[188:189] offset:38528
v_pk_fma_f32 v[224:225], v[44:45], v[60:61], v[224:225] op_sel_hi:[0,1,1] neg_lo:[1,0,0] neg_hi:[1,0,0]
v_pk_fma_f32 v[226:227], v[44:45], v[62:63], v[226:227] op_sel_hi:[0,1,1] neg_lo:[1,0,0] neg_hi:[1,0,0]
v_pk_mul_f32 v[224:225], v[44:45], v[224:225] op_sel:[1,0] op_sel_hi:[1,1]
v_pk_mul_f32 v[226:227], v[44:45], v[226:227] op_sel:[1,0] op_sel_hi:[1,1]
v_cvt_pk_bf16_f32 v224, v224, v225
v_cvt_pk_bf16_f32 v225, v226, v227
ds_write_b64 v14, v[224:225] offset:38656
v_pk_fma_f32 v[156:157], v[46:47], v[52:53], v[156:157] op_sel_hi:[0,1,1] neg_lo:[1,0,0] neg_hi:[1,0,0]
v_pk_fma_f32 v[158:159], v[46:47], v[54:55], v[158:159] op_sel_hi:[0,1,1] neg_lo:[1,0,0] neg_hi:[1,0,0]
v_pk_mul_f32 v[156:157], v[46:47], v[156:157] op_sel:[1,0] op_sel_hi:[1,1]
v_pk_mul_f32 v[158:159], v[46:47], v[158:159] op_sel:[1,0] op_sel_hi:[1,1]
v_cvt_pk_bf16_f32 v156, v156, v157
v_cvt_pk_bf16_f32 v157, v158, v159
ds_write_b64 v14, v[156:157] offset:44800
v_pk_fma_f32 v[192:193], v[46:47], v[56:57], v[192:193] op_sel_hi:[0,1,1] neg_lo:[1,0,0] neg_hi:[1,0,0]
v_pk_fma_f32 v[194:195], v[46:47], v[58:59], v[194:195] op_sel_hi:[0,1,1] neg_lo:[1,0,0] neg_hi:[1,0,0]
v_pk_mul_f32 v[192:193], v[46:47], v[192:193] op_sel:[1,0] op_sel_hi:[1,1]
v_pk_mul_f32 v[194:195], v[46:47], v[194:195] op_sel:[1,0] op_sel_hi:[1,1]
v_cvt_pk_bf16_f32 v192, v192, v193
v_cvt_pk_bf16_f32 v193, v194, v195
ds_write_b64 v14, v[192:193] offset:44928
v_pk_fma_f32 v[228:229], v[46:47], v[60:61], v[228:229] op_sel_hi:[0,1,1] neg_lo:[1,0,0] neg_hi:[1,0,0]
v_pk_fma_f32 v[230:231], v[46:47], v[62:63], v[230:231] op_sel_hi:[0,1,1] neg_lo:[1,0,0] neg_hi:[1,0,0]
v_pk_mul_f32 v[228:229], v[46:47], v[228:229] op_sel:[1,0] op_sel_hi:[1,1]
v_pk_mul_f32 v[230:231], v[46:47], v[230:231] op_sel:[1,0] op_sel_hi:[1,1]
v_cvt_pk_bf16_f32 v228, v228, v229
v_cvt_pk_bf16_f32 v229, v230, v231
ds_write_b64 v14, v[228:229] offset:45056
v_pk_fma_f32 v[160:161], v[48:49], v[52:53], v[160:161] op_sel_hi:[0,1,1] neg_lo:[1,0,0] neg_hi:[1,0,0]
v_pk_fma_f32 v[162:163], v[48:49], v[54:55], v[162:163] op_sel_hi:[0,1,1] neg_lo:[1,0,0] neg_hi:[1,0,0]
v_pk_mul_f32 v[160:161], v[48:49], v[160:161] op_sel:[1,0] op_sel_hi:[1,1]
v_pk_mul_f32 v[162:163], v[48:49], v[162:163] op_sel:[1,0] op_sel_hi:[1,1]
v_cvt_pk_bf16_f32 v160, v160, v161
v_cvt_pk_bf16_f32 v161, v162, v163
ds_write_b64 v14, v[160:161] offset:51200
v_pk_fma_f32 v[196:197], v[48:49], v[56:57], v[196:197] op_sel_hi:[0,1,1] neg_lo:[1,0,0] neg_hi:[1,0,0]
v_pk_fma_f32 v[198:199], v[48:49], v[58:59], v[198:199] op_sel_hi:[0,1,1] neg_lo:[1,0,0] neg_hi:[1,0,0]
v_pk_mul_f32 v[196:197], v[48:49], v[196:197] op_sel:[1,0] op_sel_hi:[1,1]
v_pk_mul_f32 v[198:199], v[48:49], v[198:199] op_sel:[1,0] op_sel_hi:[1,1]
v_cvt_pk_bf16_f32 v196, v196, v197
v_cvt_pk_bf16_f32 v197, v198, v199
ds_write_b64 v14, v[196:197] offset:51328
v_pk_fma_f32 v[232:233], v[48:49], v[60:61], v[232:233] op_sel_hi:[0,1,1] neg_lo:[1,0,0] neg_hi:[1,0,0]
v_pk_fma_f32 v[234:235], v[48:49], v[62:63], v[234:235] op_sel_hi:[0,1,1] neg_lo:[1,0,0] neg_hi:[1,0,0]
v_pk_mul_f32 v[232:233], v[48:49], v[232:233] op_sel:[1,0] op_sel_hi:[1,1]
v_pk_mul_f32 v[234:235], v[48:49], v[234:235] op_sel:[1,0] op_sel_hi:[1,1]
v_cvt_pk_bf16_f32 v232, v232, v233
v_cvt_pk_bf16_f32 v233, v234, v235
ds_write_b64 v14, v[232:233] offset:51456
s_waitcnt lgkmcnt(0)
s_branch Latt_4
Lprod_2:
s_sub_u32 s47, s36, 4
s_lshl_b32 s43, s34, 7
s_lshl_b32 s44, s35, 3
s_add_u32 s43, s43, s44
s_mov_b32 s63, s43
s_lshl_b32 s44, s47, 1
s_add_u32 s51, s43, s44
v_lshlrev_b32 v10, 4, v1
s_add_u32 s20, s32, 26214400
s_addc_u32 s21, s33, 0
s_mov_b32 s22, 16384
s_mov_b32 s23, 0x20000
s_cmp_eq_u32 s47, 3
s_cbranch_scc1 Lpf_3
v_lshrrev_b32 v14, 3, v1
v_and_b32 v15, 7, v1
v_and_b32 v16, 2, v14
v_xor_b32 v16, v15, v16
v_lshlrev_b32 v16, 4, v16
v_mul_u32_u24 v17, 6144, v14
s_lshl_b32 s43, s47, 11
v_add3_u32 v2, v17, v16, s43
v_xor_b32 v3, 64, v2
v_lshrrev_b32 v16, 1, v14
v_xor_b32 v16, v15, v16
v_lshlrev_b32 v16, 4, v16
s_lshl_b32 s43, s47, 3
s_add_u32 s43, s43, s50
v_add_u32 v17, s43, v14
s_and_b32 s44, s47, 1
s_lshl_b32 s44, s44, 6
v_add_u32 v18, 0, v17
v_max_i32 v18, 0, v18
v_lshl_add_u32 v18, v18, 11, v16
v_xor_b32 v18, s44, v18
v_mov_b32 v4, v18
v_add_u32 v18, 24, v17
v_max_i32 v18, 0, v18
v_lshl_add_u32 v18, v18, 11, v16
v_xor_b32 v18, s44, v18
v_xor_b32 v5, 64, v18
v_add_u32 v18, 48, v17
v_max_i32 v18, 0, v18
v_lshl_add_u32 v18, v18, 11, v16
v_xor_b32 v18, s44, v18
v_mov_b32 v6, v18
v_add_u32 v18, 72, v17
v_max_i32 v18, 0, v18
v_lshl_add_u32 v18, v18, 11, v16
v_xor_b32 v18, s44, v18
v_xor_b32 v7, 64, v18
v_add_u32 v18, 96, v17
v_max_i32 v18, 0, v18
v_lshl_add_u32 v18, v18, 11, v16
v_xor_b32 v18, s44, v18
v_mov_b32 v8, v18
v_add_u32 v18, 120, v17
v_max_i32 v18, 0, v18
v_lshl_add_u32 v18, v18, 11, v16
v_xor_b32 v18, s44, v18
v_xor_b32 v9, 64, v18
s_lshl_b32 s39, s47, 10
s_lshl_b32 s40, s47, 13
s_add_u32 s40, s40, 18432
s_mov_b32 s37, 0
s_mov_b32 s38, 0
s_bfm_b64 s[60:61], 56, 8
s_cmp_eq_u32 s47, 0
s_cselect_b64 s[60:61], s[60:61], -1
s_add_u32 m0, s39, 0
s_mov_b64 exec, s[60:61]
buffer_load_dwordx4 v4, s[8:11], s37 offen lds
s_mov_b64 exec, -1
s_add_u32 m0, s39, 3072
s_nop 0
buffer_load_dwordx4 v5, s[8:11], s37 offen lds
s_add_u32 m0, s39, 6144
s_nop 0
buffer_load_dwordx4 v6, s[8:11], s37 offen lds
s_add_u32 m0, s39, 9216
s_nop 0
buffer_load_dwordx4 v7, s[8:11], s37 offen lds
s_add_u32 m0, s39, 12288
s_nop 0
buffer_load_dwordx4 v8, s[8:11], s37 offen lds
s_add_u32 m0, s39, 15360
s_nop 0
buffer_load_dwordx4 v9, s[8:11], s37 offen lds
s_add_u32 m0, s40, 0
s_add_u32 s43, s38, 0
buffer_load_dwordx4 v2, s[12:15], s43 offen lds
s_add_u32 m0, s40, 1024
s_add_u32 s43, s38, 49152
buffer_load_dwordx4 v3, s[12:15], s43 offen lds
s_add_u32 m0, s40, 2048
s_add_u32 s43, s38, 98304
buffer_load_dwordx4 v2, s[12:15], s43 offen lds
s_add_u32 m0, s40, 3072
s_add_u32 s43, s38, 147456
buffer_load_dwordx4 v3, s[12:15], s43 offen lds
s_add_u32 m0, s40, 4096
s_add_u32 s43, s38, 196608
buffer_load_dwordx4 v2, s[12:15], s43 offen lds
s_add_u32 m0, s40, 5120
s_add_u32 s43, s38, 245760
buffer_load_dwordx4 v3, s[12:15], s43 offen lds
s_add_u32 m0, s40, 6144
s_add_u32 s43, s38, 294912
buffer_load_dwordx4 v2, s[12:15], s43 offen lds
s_add_u32 m0, s40, 7168
s_add_u32 s43, s38, 344064
buffer_load_dwordx4 v3, s[12:15], s43 offen lds
s_add_u32 s37, s37, 128
s_add_u32 s38, s38, 393216
s_add_u32 m0, s39, 43008
s_mov_b64 exec, s[60:61]
buffer_load_dwordx4 v4, s[8:11], s37 offen lds
s_mov_b64 exec, -1
s_add_u32 m0, s39, 46080
s_nop 0
buffer_load_dwordx4 v5, s[8:11], s37 offen lds
s_add_u32 m0, s39, 49152
s_nop 0
buffer_load_dwordx4 v6, s[8:11], s37 offen lds
s_add_u32 m0, s39, 52224
s_nop 0
buffer_load_dwordx4 v7, s[8:11], s37 offen lds
s_add_u32 m0, s39, 55296
s_nop 0
buffer_load_dwordx4 v8, s[8:11], s37 offen lds
s_add_u32 m0, s39, 58368
s_nop 0
buffer_load_dwordx4 v9, s[8:11], s37 offen lds
s_add_u32 m0, s40, 43008
s_add_u32 s43, s38, 0
buffer_load_dwordx4 v2, s[12:15], s43 offen lds
s_add_u32 m0, s40, 44032
s_add_u32 s43, s38, 49152
buffer_load_dwordx4 v3, s[12:15], s43 offen lds
s_add_u32 m0, s40, 45056
s_add_u32 s43, s38, 98304
buffer_load_dwordx4 v2, s[12:15], s43 offen lds
s_add_u32 m0, s40, 46080
s_add_u32 s43, s38, 147456
buffer_load_dwordx4 v3, s[12:15], s43 offen lds
s_add_u32 m0, s40, 47104
s_add_u32 s43, s38, 196608
buffer_load_dwordx4 v2, s[12:15], s43 offen lds
s_add_u32 m0, s40, 48128
s_add_u32 s43, s38, 245760
buffer_load_dwordx4 v3, s[12:15], s43 offen lds
s_add_u32 m0, s40, 49152
s_add_u32 s43, s38, 294912
buffer_load_dwordx4 v2, s[12:15], s43 offen lds
s_add_u32 m0, s40, 50176
s_add_u32 s43, s38, 344064
buffer_load_dwordx4 v3, s[12:15], s43 offen lds
s_add_u32 s37, s37, 128
s_add_u32 s38, s38, 393216
s_add_u32 m0, s39, 86016
s_mov_b64 exec, s[60:61]
buffer_load_dwordx4 v4, s[8:11], s37 offen lds
s_mov_b64 exec, -1
s_add_u32 m0, s39, 89088
s_nop 0
buffer_load_dwordx4 v5, s[8:11], s37 offen lds
s_add_u32 m0, s39, 92160
s_nop 0
buffer_load_dwordx4 v6, s[8:11], s37 offen lds
s_add_u32 m0, s39, 95232
s_nop 0
buffer_load_dwordx4 v7, s[8:11], s37 offen lds
s_add_u32 m0, s39, 98304
s_nop 0
buffer_load_dwordx4 v8, s[8:11], s37 offen lds
s_add_u32 m0, s39, 101376
s_nop 0
buffer_load_dwordx4 v9, s[8:11], s37 offen lds
s_add_u32 m0, s40, 86016
s_add_u32 s43, s38, 0
buffer_load_dwordx4 v2, s[12:15], s43 offen lds
s_add_u32 m0, s40, 87040
s_add_u32 s43, s38, 49152
buffer_load_dwordx4 v3, s[12:15], s43 offen lds
s_add_u32 m0, s40, 88064
s_add_u32 s43, s38, 98304
buffer_load_dwordx4 v2, s[12:15], s43 offen lds
s_add_u32 m0, s40, 89088
s_add_u32 s43, s38, 147456
buffer_load_dwordx4 v3, s[12:15], s43 offen lds
s_add_u32 m0, s40, 90112
s_add_u32 s43, s38, 196608
buffer_load_dwordx4 v2, s[12:15], s43 offen lds
s_add_u32 m0, s40, 91136
s_add_u32 s43, s38, 245760
buffer_load_dwordx4 v3, s[12:15], s43 offen lds
s_add_u32 m0, s40, 92160
s_add_u32 s43, s38, 294912
buffer_load_dwordx4 v2, s[12:15], s43 offen lds
s_add_u32 m0, s40, 93184
s_add_u32 s43, s38, 344064
buffer_load_dwordx4 v3, s[12:15], s43 offen lds
s_add_u32 s37, s37, 128
s_add_u32 s38, s38, 393216
s_lshl_b32 s43, s51, 11
buffer_load_dwordx4 v[96:99], v10, s[8:11], s43 offen offset:0
buffer_load_dwordx4 v[100:103], v10, s[8:11], s43 offen offset:1024
buffer_load_dwordx4 v[104:107], v10, s[8:11], s43 offen offset:2048
buffer_load_dwordx4 v[108:111], v10, s[8:11], s43 offen offset:3072
s_waitcnt vmcnt(32)
s_barrier
s_waitcnt vmcnt(18)
s_barrier
s_add_u32 m0, s39, 0
s_mov_b64 exec, s[60:61]
buffer_load_dwordx4 v4, s[8:11], s37 offen lds
s_mov_b64 exec, -1
s_add_u32 m0, s39, 3072
s_nop 0
buffer_load_dwordx4 v5, s[8:11], s37 offen lds
s_add_u32 m0, s39, 6144
s_nop 0
buffer_load_dwordx4 v6, s[8:11], s37 offen lds
s_add_u32 m0, s39, 9216
s_nop 0
buffer_load_dwordx4 v7, s[8:11], s37 offen lds
s_add_u32 m0, s39, 12288
s_nop 0
buffer_load_dwordx4 v8, s[8:11], s37 offen lds
s_add_u32 m0, s39, 15360
s_nop 0
buffer_load_dwordx4 v9, s[8:11], s37 offen lds
s_add_u32 m0, s40, 0
s_add_u32 s43, s38, 0
buffer_load_dwordx4 v2, s[12:15], s43 offen lds
s_add_u32 m0, s40, 1024
s_add_u32 s43, s38, 49152
buffer_load_dwordx4 v3, s[12:15], s43 offen lds
s_add_u32 m0, s40, 2048
s_add_u32 s43, s38, 98304
buffer_load_dwordx4 v2, s[12:15], s43 offen lds
s_add_u32 m0, s40, 3072
s_add_u32 s43, s38, 147456
buffer_load_dwordx4 v3, s[12:15], s43 offen lds
s_add_u32 m0, s40, 4096
s_add_u32 s43, s38, 196608
buffer_load_dwordx4 v2, s[12:15], s43 offen lds
s_add_u32 m0, s40, 5120
s_add_u32 s43, s38, 245760
buffer_load_dwordx4 v3, s[12:15], s43 offen lds
s_add_u32 m0, s40, 6144
s_add_u32 s43, s38, 294912
buffer_load_dwordx4 v2, s[12:15], s43 offen lds
s_add_u32 m0, s40, 7168
s_add_u32 s43, s38, 344064
buffer_load_dwordx4 v3, s[12:15], s43 offen lds
s_add_u32 s37, s37, 128
s_add_u32 s38, s38, 393216
s_waitcnt vmcnt(14)
s_barrier
s_add_u32 m0, s39, 43008
s_mov_b64 exec, s[60:61]
buffer_load_dwordx4 v4, s[8:11], s37 offen lds
s_mov_b64 exec, -1
s_add_u32 m0, s39, 46080
s_nop 0
buffer_load_dwordx4 v5, s[8:11], s37 offen lds
s_add_u32 m0, s39, 49152
s_nop 0
buffer_load_dwordx4 v6, s[8:11], s37 offen lds
s_add_u32 m0, s39, 52224
s_nop 0
buffer_load_dwordx4 v7, s[8:11], s37 offen lds
s_add_u32 m0, s39, 55296
s_nop 0
buffer_load_dwordx4 v8, s[8:11], s37 offen lds
s_add_u32 m0, s39, 58368
s_nop 0
buffer_load_dwordx4 v9, s[8:11], s37 offen lds
s_add_u32 m0, s40, 43008
s_add_u32 s43, s38, 0
buffer_load_dwordx4 v2, s[12:15], s43 offen lds
s_add_u32 m0, s40, 44032
s_add_u32 s43, s38, 49152
buffer_load_dwordx4 v3, s[12:15], s43 offen lds
s_add_u32 m0, s40, 45056
s_add_u32 s43, s38, 98304
buffer_load_dwordx4 v2, s[12:15], s43 offen lds
s_add_u32 m0, s40, 46080
s_add_u32 s43, s38, 147456
buffer_load_dwordx4 v3, s[12:15], s43 offen lds
s_add_u32 m0, s40, 47104
s_add_u32 s43, s38, 196608
buffer_load_dwordx4 v2, s[12:15], s43 offen lds
s_add_u32 m0, s40, 48128
s_add_u32 s43, s38, 245760
buffer_load_dwordx4 v3, s[12:15], s43 offen lds
s_add_u32 m0, s40, 49152
s_add_u32 s43, s38, 294912
buffer_load_dwordx4 v2, s[12:15], s43 offen lds
s_add_u32 m0, s40, 50176
s_add_u32 s43, s38, 344064
buffer_load_dwordx4 v3, s[12:15], s43 offen lds
s_add_u32 s37, s37, 128
s_add_u32 s38, s38, 393216
v_lshlrev_b32 v124, 16, v96
v_and_b32 v125, 0xffff0000, v96
v_mov_b32 v116, v124
v_mov_b32 v117, v125
v_mul_f32 v118, v124, v124
v_mul_f32 v119, v125, v125
v_lshlrev_b32 v126, 16, v97
v_and_b32 v127, 0xffff0000, v97
v_add_f32 v116, v116, v126
v_add_f32 v117, v117, v127
v_fmac_f32 v118, v126, v126
v_fmac_f32 v119, v127, v127
v_lshlrev_b32 v124, 16, v98
v_and_b32 v125, 0xffff0000, v98
v_add_f32 v116, v116, v124
v_add_f32 v117, v117, v125
v_fmac_f32 v118, v124, v124
v_fmac_f32 v119, v125, v125
v_lshlrev_b32 v126, 16, v99
v_and_b32 v127, 0xffff0000, v99
v_add_f32 v116, v116, v126
v_add_f32 v117, v117, v127
v_fmac_f32 v118, v126, v126
v_fmac_f32 v119, v127, v127
v_lshlrev_b32 v124, 16, v100
v_and_b32 v125, 0xffff0000, v100
v_add_f32 v116, v116, v124
v_add_f32 v117, v117, v125
v_fmac_f32 v118, v124, v124
v_fmac_f32 v119, v125, v125
v_lshlrev_b32 v126, 16, v101
v_and_b32 v127, 0xffff0000, v101
v_add_f32 v116, v116, v126
v_add_f32 v117, v117, v127
v_fmac_f32 v118, v126, v126
v_fmac_f32 v119, v127, v127
v_lshlrev_b32 v124, 16, v102
v_and_b32 v125, 0xffff0000, v102
v_add_f32 v116, v116, v124
v_add_f32 v117, v117, v125
v_fmac_f32 v118, v124, v124
v_fmac_f32 v119, v125, v125
v_lshlrev_b32 v126, 16, v103
v_and_b32 v127, 0xffff0000, v103
v_add_f32 v116, v116, v126
v_add_f32 v117, v117, v127
v_fmac_f32 v118, v126, v126
v_fmac_f32 v119, v127, v127
v_lshlrev_b32 v124, 16, v104
v_and_b32 v125, 0xffff0000, v104
v_mov_b32 v120, v124
v_mov_b32 v121, v125
v_mul_f32 v122, v124, v124
v_mul_f32 v123, v125, v125
v_lshlrev_b32 v126, 16, v105
v_and_b32 v127, 0xffff0000, v105
v_add_f32 v120, v120, v126
v_add_f32 v121, v121, v127
v_fmac_f32 v122, v126, v126
v_fmac_f32 v123, v127, v127
v_lshlrev_b32 v124, 16, v106
v_and_b32 v125, 0xffff0000, v106
v_add_f32 v120, v120, v124
v_add_f32 v121, v121, v125
v_fmac_f32 v122, v124, v124
v_fmac_f32 v123, v125, v125
v_lshlrev_b32 v126, 16, v107
v_and_b32 v127, 0xffff0000, v107
v_add_f32 v120, v120, v126
v_add_f32 v121, v121, v127
v_fmac_f32 v122, v126, v126
v_fmac_f32 v123, v127, v127
v_lshlrev_b32 v124, 16, v108
v_and_b32 v125, 0xffff0000, v108
v_add_f32 v120, v120, v124
v_add_f32 v121, v121, v125
v_fmac_f32 v122, v124, v124
v_fmac_f32 v123, v125, v125
v_lshlrev_b32 v126, 16, v109
v_and_b32 v127, 0xffff0000, v109
v_add_f32 v120, v120, v126
v_add_f32 v121, v121, v127
v_fmac_f32 v122, v126, v126
v_fmac_f32 v123, v127, v127
v_lshlrev_b32 v124, 16, v110
v_and_b32 v125, 0xffff0000, v110
v_add_f32 v120, v120, v124
v_add_f32 v121, v121, v125
v_fmac_f32 v122, v124, v124
v_fmac_f32 v123, v125, v125
v_lshlrev_b32 v126, 16, v111
v_and_b32 v127, 0xffff0000, v111
v_add_f32 v120, v120, v126
v_add_f32 v121, v121, v127
v_fmac_f32 v122, v126, v126
v_fmac_f32 v123, v127, v127
v_add_f32 v116, v116, v117
v_add_f32 v118, v118, v119
v_add_f32 v120, v120, v121
v_add_f32 v122, v122, v123
s_nop 0
v_add_f32_dpp v116, v116, v116 row_ror:8 row_mask:0xf bank_mask:0xf
v_add_f32_dpp v118, v118, v118 row_ror:8 row_mask:0xf bank_mask:0xf
v_add_f32_dpp v120, v120, v120 row_ror:8 row_mask:0xf bank_mask:0xf
v_add_f32_dpp v122, v122, v122 row_ror:8 row_mask:0xf bank_mask:0xf
v_add_f32_dpp v116, v116, v116 row_ror:4 row_mask:0xf bank_mask:0xf
v_add_f32_dpp v118, v118, v118 row_ror:4 row_mask:0xf bank_mask:0xf
v_add_f32_dpp v120, v120, v120 row_ror:4 row_mask:0xf bank_mask:0xf
v_add_f32_dpp v122, v122, v122 row_ror:4 row_mask:0xf bank_mask:0xf
v_add_f32_dpp v116, v116, v116 row_ror:2 row_mask:0xf bank_mask:0xf
v_add_f32_dpp v118, v118, v118 row_ror:2 row_mask:0xf bank_mask:0xf
v_add_f32_dpp v120, v120, v120 row_ror:2 row_mask:0xf bank_mask:0xf
v_add_f32_dpp v122, v122, v122 row_ror:2 row_mask:0xf bank_mask:0xf
v_add_f32_dpp v116, v116, v116 row_ror:1 row_mask:0xf bank_mask:0xf
v_add_f32_dpp v118, v118, v118 row_ror:1 row_mask:0xf bank_mask:0xf
v_add_f32_dpp v120, v120, v120 row_ror:1 row_mask:0xf bank_mask:0xf
v_add_f32_dpp v122, v122, v122 row_ror:1 row_mask:0xf bank_mask:0xf
v_mov_b32 v117, v116
v_mov_b32 v119, v118
v_mov_b32 v121, v120
v_mov_b32 v123, v122
s_nop 0
v_permlane16_swap_b32 v116, v117
v_permlane16_swap_b32 v118, v119
v_permlane16_swap_b32 v120, v121
v_permlane16_swap_b32 v122, v123
v_add_f32 v116, v116, v117
v_add_f32 v118, v118, v119
v_add_f32 v120, v120, v121
v_add_f32 v122, v122, v123
v_mov_b32 v117, v116
v_mov_b32 v119, v118
v_mov_b32 v121, v120
v_mov_b32 v123, v122
s_nop 0
v_permlane32_swap_b32 v116, v117
v_permlane32_swap_b32 v118, v119
v_permlane32_swap_b32 v120, v121
v_permlane32_swap_b32 v122, v123
v_add_f32 v116, v116, v117
v_add_f32 v118, v118, v119
v_add_f32 v120, v120, v121
v_add_f32 v122, v122, v123
v_mul_f32 v112, 0x3a800000, v116
v_mul_f32 v113, 0x3a800000, v118
v_fma_f32 v113, -v112, v112, v113
v_max_f32 v113, 0, v113
v_add_f32 v113, 0x3727c5ac, v113
v_rsq_f32 v113, v113
v_mul_f32 v114, 0x3a800000, v120
v_mul_f32 v115, 0x3a800000, v122
v_fma_f32 v115, -v114, v114, v115
v_max_f32 v115, 0, v115
v_add_f32 v115, 0x3727c5ac, v115
v_rsq_f32 v115, v115
s_nop 0
s_lshl_b32 s43, s47, 4
s_add_u32 s43, s43, 130176
v_mov_b32 v11, s43
ds_write_b128 v11, v[112:115]
s_waitcnt lgkmcnt(0)
s_waitcnt vmcnt(14)
s_barrier
s_add_u32 m0, s39, 86016
s_mov_b64 exec, s[60:61]
buffer_load_dwordx4 v4, s[8:11], s37 offen lds
s_mov_b64 exec, -1
s_add_u32 m0, s39, 89088
s_nop 0
buffer_load_dwordx4 v5, s[8:11], s37 offen lds
s_add_u32 m0, s39, 92160
s_nop 0
buffer_load_dwordx4 v6, s[8:11], s37 offen lds
s_add_u32 m0, s39, 95232
s_nop 0
buffer_load_dwordx4 v7, s[8:11], s37 offen lds
s_add_u32 m0, s39, 98304
s_nop 0
buffer_load_dwordx4 v8, s[8:11], s37 offen lds
s_add_u32 m0, s39, 101376
s_nop 0
buffer_load_dwordx4 v9, s[8:11], s37 offen lds
s_add_u32 m0, s40, 86016
s_add_u32 s43, s38, 0
buffer_load_dwordx4 v2, s[12:15], s43 offen lds
s_add_u32 m0, s40, 87040
s_add_u32 s43, s38, 49152
buffer_load_dwordx4 v3, s[12:15], s43 offen lds
s_add_u32 m0, s40, 88064
s_add_u32 s43, s38, 98304
buffer_load_dwordx4 v2, s[12:15], s43 offen lds
s_add_u32 m0, s40, 89088
s_add_u32 s43, s38, 147456
buffer_load_dwordx4 v3, s[12:15], s43 offen lds
s_add_u32 m0, s40, 90112
s_add_u32 s43, s38, 196608
buffer_load_dwordx4 v2, s[12:15], s43 offen lds
s_add_u32 m0, s40, 91136
s_add_u32 s43, s38, 245760
buffer_load_dwordx4 v3, s[12:15], s43 offen lds
s_add_u32 m0, s40, 92160
s_add_u32 s43, s38, 294912
buffer_load_dwordx4 v2, s[12:15], s43 offen lds
s_add_u32 m0, s40, 93184
s_add_u32 s43, s38, 344064
buffer_load_dwordx4 v3, s[12:15], s43 offen lds
s_add_u32 s37, s37, 128
s_add_u32 s38, s38, 393216
s_waitcnt vmcnt(14)
s_barrier
s_mov_b32 s41, 3
Lpl_6:
s_add_u32 m0, s39, 0
s_mov_b64 exec, s[60:61]
buffer_load_dwordx4 v4, s[8:11], s37 offen lds
s_mov_b64 exec, -1
s_add_u32 m0, s39, 3072
s_nop 0
buffer_load_dwordx4 v5, s[8:11], s37 offen lds
s_add_u32 m0, s39, 6144
s_nop 0
buffer_load_dwordx4 v6, s[8:11], s37 offen lds
s_add_u32 m0, s39, 9216
s_nop 0
buffer_load_dwordx4 v7, s[8:11], s37 offen lds
s_add_u32 m0, s39, 12288
s_nop 0
buffer_load_dwordx4 v8, s[8:11], s37 offen lds
s_add_u32 m0, s39, 15360
s_nop 0
buffer_load_dwordx4 v9, s[8:11], s37 offen lds
s_add_u32 m0, s40, 0
s_add_u32 s43, s38, 0
buffer_load_dwordx4 v2, s[12:15], s43 offen lds
s_add_u32 m0, s40, 1024
s_add_u32 s43, s38, 49152
buffer_load_dwordx4 v3, s[12:15], s43 offen lds
s_add_u32 m0, s40, 2048
s_add_u32 s43, s38, 98304
buffer_load_dwordx4 v2, s[12:15], s43 offen lds
s_add_u32 m0, s40, 3072
s_add_u32 s43, s38, 147456
buffer_load_dwordx4 v3, s[12:15], s43 offen lds
s_add_u32 m0, s40, 4096
s_add_u32 s43, s38, 196608
buffer_load_dwordx4 v2, s[12:15], s43 offen lds
s_add_u32 m0, s40, 5120
s_add_u32 s43, s38, 245760
buffer_load_dwordx4 v3, s[12:15], s43 offen lds
s_add_u32 m0, s40, 6144
s_add_u32 s43, s38, 294912
buffer_load_dwordx4 v2, s[12:15], s43 offen lds
s_add_u32 m0, s40, 7168
s_add_u32 s43, s38, 344064
buffer_load_dwordx4 v3, s[12:15], s43 offen lds
s_add_u32 s37, s37, 128
s_add_u32 s38, s38, 393216
s_waitcnt vmcnt(14)
s_barrier
s_add_u32 m0, s39, 43008
s_mov_b64 exec, s[60:61]
buffer_load_dwordx4 v4, s[8:11], s37 offen lds
s_mov_b64 exec, -1
s_add_u32 m0, s39, 46080
s_nop 0
buffer_load_dwordx4 v5, s[8:11], s37 offen lds
s_add_u32 m0, s39, 49152
s_nop 0
buffer_load_dwordx4 v6, s[8:11], s37 offen lds
s_add_u32 m0, s39, 52224
s_nop 0
buffer_load_dwordx4 v7, s[8:11], s37 offen lds
s_add_u32 m0, s39, 55296
s_nop 0
buffer_load_dwordx4 v8, s[8:11], s37 offen lds
s_add_u32 m0, s39, 58368
s_nop 0
buffer_load_dwordx4 v9, s[8:11], s37 offen lds
s_add_u32 m0, s40, 43008
s_add_u32 s43, s38, 0
buffer_load_dwordx4 v2, s[12:15], s43 offen lds
s_add_u32 m0, s40, 44032
s_add_u32 s43, s38, 49152
buffer_load_dwordx4 v3, s[12:15], s43 offen lds
s_add_u32 m0, s40, 45056
s_add_u32 s43, s38, 98304
buffer_load_dwordx4 v2, s[12:15], s43 offen lds
s_add_u32 m0, s40, 46080
s_add_u32 s43, s38, 147456
buffer_load_dwordx4 v3, s[12:15], s43 offen lds
s_add_u32 m0, s40, 47104
s_add_u32 s43, s38, 196608
buffer_load_dwordx4 v2, s[12:15], s43 offen lds
s_add_u32 m0, s40, 48128
s_add_u32 s43, s38, 245760
buffer_load_dwordx4 v3, s[12:15], s43 offen lds
s_add_u32 m0, s40, 49152
s_add_u32 s43, s38, 294912
buffer_load_dwordx4 v2, s[12:15], s43 offen lds
s_add_u32 m0, s40, 50176
s_add_u32 s43, s38, 344064
buffer_load_dwordx4 v3, s[12:15], s43 offen lds
s_add_u32 s37, s37, 128
s_add_u32 s38, s38, 393216
s_waitcnt vmcnt(14)
s_barrier
s_add_u32 m0, s39, 86016
s_mov_b64 exec, s[60:61]
buffer_load_dwordx4 v4, s[8:11], s37 offen lds
s_mov_b64 exec, -1
s_add_u32 m0, s39, 89088
s_nop 0
buffer_load_dwordx4 v5, s[8:11], s37 offen lds
s_add_u32 m0, s39, 92160
s_nop 0
buffer_load_dwordx4 v6, s[8:11], s37 offen lds
s_add_u32 m0, s39, 95232
s_nop 0
buffer_load_dwordx4 v7, s[8:11], s37 offen lds
s_add_u32 m0, s39, 98304
s_nop 0
buffer_load_dwordx4 v8, s[8:11], s37 offen lds
s_add_u32 m0, s39, 101376
s_nop 0
buffer_load_dwordx4 v9, s[8:11], s37 offen lds
s_add_u32 m0, s40, 86016
s_add_u32 s43, s38, 0
buffer_load_dwordx4 v2, s[12:15], s43 offen lds
s_add_u32 m0, s40, 87040
s_add_u32 s43, s38, 49152
buffer_load_dwordx4 v3, s[12:15], s43 offen lds
s_add_u32 m0, s40, 88064
s_add_u32 s43, s38, 98304
buffer_load_dwordx4 v2, s[12:15], s43 offen lds
s_add_u32 m0, s40, 89088
s_add_u32 s43, s38, 147456
buffer_load_dwordx4 v3, s[12:15], s43 offen lds
s_add_u32 m0, s40, 90112
s_add_u32 s43, s38, 196608
buffer_load_dwordx4 v2, s[12:15], s43 offen lds
s_add_u32 m0, s40, 91136
s_add_u32 s43, s38, 245760
buffer_load_dwordx4 v3, s[12:15], s43 offen lds
s_add_u32 m0, s40, 92160
s_add_u32 s43, s38, 294912
buffer_load_dwordx4 v2, s[12:15], s43 offen lds
s_add_u32 m0, s40, 93184
s_add_u32 s43, s38, 344064
buffer_load_dwordx4 v3, s[12:15], s43 offen lds
s_add_u32 s37, s37, 128
s_add_u32 s38, s38, 393216
s_waitcnt vmcnt(14)
s_barrier
s_sub_u32 s41, s41, 1
s_cmp_lg_u32 s41, 0
s_cbranch_scc1 Lpl_6
s_add_u32 m0, s39, 0
s_mov_b64 exec, s[60:61]
buffer_load_dwordx4 v4, s[8:11], s37 offen lds
s_mov_b64 exec, -1
s_add_u32 m0, s39, 3072
s_nop 0
buffer_load_dwordx4 v5, s[8:11], s37 offen lds
s_add_u32 m0, s39, 6144
s_nop 0
buffer_load_dwordx4 v6, s[8:11], s37 offen lds
s_add_u32 m0, s39, 9216
s_nop 0
buffer_load_dwordx4 v7, s[8:11], s37 offen lds
s_add_u32 m0, s39, 12288
s_nop 0
buffer_load_dwordx4 v8, s[8:11], s37 offen lds
s_add_u32 m0, s39, 15360
s_nop 0
buffer_load_dwordx4 v9, s[8:11], s37 offen lds
s_add_u32 m0, s40, 0
s_add_u32 s43, s38, 0
buffer_load_dwordx4 v2, s[12:15], s43 offen lds
s_add_u32 m0, s40, 1024
s_add_u32 s43, s38, 49152
buffer_load_dwordx4 v3, s[12:15], s43 offen lds
s_add_u32 m0, s40, 2048
s_add_u32 s43, s38, 98304
buffer_load_dwordx4 v2, s[12:15], s43 offen lds
s_add_u32 m0, s40, 3072
s_add_u32 s43, s38, 147456
buffer_load_dwordx4 v3, s[12:15], s43 offen lds
s_add_u32 m0, s40, 4096
s_add_u32 s43, s38, 196608
buffer_load_dwordx4 v2, s[12:15], s43 offen lds
s_add_u32 m0, s40, 5120
s_add_u32 s43, s38, 245760
buffer_load_dwordx4 v3, s[12:15], s43 offen lds
s_add_u32 m0, s40, 6144
s_add_u32 s43, s38, 294912
buffer_load_dwordx4 v2, s[12:15], s43 offen lds
s_add_u32 m0, s40, 7168
s_add_u32 s43, s38, 344064
buffer_load_dwordx4 v3, s[12:15], s43 offen lds
s_add_u32 s37, s37, 128
s_add_u32 s38, s38, 393216
s_waitcnt vmcnt(14)
s_barrier
s_waitcnt vmcnt(0)
s_barrier
s_barrier
s_barrier
s_branch Latt_4
Lpf_3:
s_load_dwordx2 s[26:27], s[0:1], 64
s_lshl_b32 s43, s51, 11
buffer_load_dwordx4 v[96:99], v10, s[8:11], s43 offen offset:0
buffer_load_dwordx4 v[100:103], v10, s[8:11], s43 offen offset:1024
buffer_load_dwordx4 v[104:107], v10, s[8:11], s43 offen offset:2048
buffer_load_dwordx4 v[108:111], v10, s[8:11], s43 offen offset:3072
v_min_u32 v14, 23, v1
v_lshrrev_b32 v15, 3, v14
v_mul_u32_u24 v15, 43008, v15
v_and_b32 v14, 7, v14
v_lshl_add_u32 v15, v14, 4, v15
v_mov_b32 v32, 0x3f803f80
v_mov_b32 v33, 0x3f803f80
v_mov_b32 v34, 0x3f803f80
v_mov_b32 v35, 0x3f803f80
ds_write_b128 v15, v[32:35]
v_add_u32 v14, 0, v1
v_min_u32 v14, 47, v14
v_mul_u32_u24 v15, 21846, v14
v_lshrrev_b32 v15, 16, v15
v_mul_u32_u24 v16, 3, v15
v_sub_u32 v16, v14, v16
s_mul_i32 s43, s48, 16
v_add_u32 v15, s43, v15
v_mul_u32_u24 v15, 6144, v15
v_lshl_add_u32 v2, v16, 11, v15
s_waitcnt lgkmcnt(0)
s_mov_b32 s56, s26
s_mov_b32 s57, s27
s_mov_b32 s58, 256
s_mov_b32 s59, 0x20000
v_lshlrev_b32 v14, 7, v1
s_or_b32 s43, s34, s35
s_cmp_lg_u32 s43, 0
s_cbranch_scc1 Lz_7
s_add_u32 s84, s32, 28311552
s_addc_u32 s85, s33, 0
s_mov_b32 s86, 16384
s_mov_b32 s87, 0x20000
v_mov_b32 v5, 0
buffer_store_dword v5, v14, s[84:87], 0 offen sc1
s_movk_i32 s43, 0x2000
buffer_store_dword v5, v14, s[84:87], s43 offen sc1
s_waitcnt vmcnt(0)
Lz_7:
s_mov_b32 s84, s6
s_mov_b32 s85, s7
s_mov_b32 s86, 6291456
s_mov_b32 s87, 0x20000
s_mul_i32 s43, s2, 24576
buffer_load_dword v31, v14, s[84:87], s43 offen
s_add_u32 s43, s43, 8192
buffer_load_dword v31, v14, s[84:87], s43 offen
s_add_u32 s43, s43, 8192
buffer_load_dword v31, v14, s[84:87], s43 offen
s_barrier
s_barrier
s_barrier
s_waitcnt vmcnt(3)
v_lshlrev_b32 v124, 16, v96
v_and_b32 v125, 0xffff0000, v96
v_mov_b32 v116, v124
v_mov_b32 v117, v125
v_mul_f32 v118, v124, v124
v_mul_f32 v119, v125, v125
v_lshlrev_b32 v126, 16, v97
v_and_b32 v127, 0xffff0000, v97
v_add_f32 v116, v116, v126
v_add_f32 v117, v117, v127
v_fmac_f32 v118, v126, v126
v_fmac_f32 v119, v127, v127
v_lshlrev_b32 v124, 16, v98
v_and_b32 v125, 0xffff0000, v98
v_add_f32 v116, v116, v124
v_add_f32 v117, v117, v125
v_fmac_f32 v118, v124, v124
v_fmac_f32 v119, v125, v125
v_lshlrev_b32 v126, 16, v99
v_and_b32 v127, 0xffff0000, v99
v_add_f32 v116, v116, v126
v_add_f32 v117, v117, v127
v_fmac_f32 v118, v126, v126
v_fmac_f32 v119, v127, v127
v_lshlrev_b32 v124, 16, v100
v_and_b32 v125, 0xffff0000, v100
v_add_f32 v116, v116, v124
v_add_f32 v117, v117, v125
v_fmac_f32 v118, v124, v124
v_fmac_f32 v119, v125, v125
v_lshlrev_b32 v126, 16, v101
v_and_b32 v127, 0xffff0000, v101
v_add_f32 v116, v116, v126
v_add_f32 v117, v117, v127
v_fmac_f32 v118, v126, v126
v_fmac_f32 v119, v127, v127
v_lshlrev_b32 v124, 16, v102
v_and_b32 v125, 0xffff0000, v102
v_add_f32 v116, v116, v124
v_add_f32 v117, v117, v125
v_fmac_f32 v118, v124, v124
v_fmac_f32 v119, v125, v125
v_lshlrev_b32 v126, 16, v103
v_and_b32 v127, 0xffff0000, v103
v_add_f32 v116, v116, v126
v_add_f32 v117, v117, v127
v_fmac_f32 v118, v126, v126
v_fmac_f32 v119, v127, v127
v_lshlrev_b32 v124, 16, v104
v_and_b32 v125, 0xffff0000, v104
v_mov_b32 v120, v124
v_mov_b32 v121, v125
v_mul_f32 v122, v124, v124
v_mul_f32 v123, v125, v125
v_lshlrev_b32 v126, 16, v105
v_and_b32 v127, 0xffff0000, v105
v_add_f32 v120, v120, v126
v_add_f32 v121, v121, v127
v_fmac_f32 v122, v126, v126
v_fmac_f32 v123, v127, v127
v_lshlrev_b32 v124, 16, v106
v_and_b32 v125, 0xffff0000, v106
v_add_f32 v120, v120, v124
v_add_f32 v121, v121, v125
v_fmac_f32 v122, v124, v124
v_fmac_f32 v123, v125, v125
v_lshlrev_b32 v126, 16, v107
v_and_b32 v127, 0xffff0000, v107
v_add_f32 v120, v120, v126
v_add_f32 v121, v121, v127
v_fmac_f32 v122, v126, v126
v_fmac_f32 v123, v127, v127
v_lshlrev_b32 v124, 16, v108
v_and_b32 v125, 0xffff0000, v108
v_add_f32 v120, v120, v124
v_add_f32 v121, v121, v125
v_fmac_f32 v122, v124, v124
v_fmac_f32 v123, v125, v125
v_lshlrev_b32 v126, 16, v109
v_and_b32 v127, 0xffff0000, v109
v_add_f32 v120, v120, v126
v_add_f32 v121, v121, v127
v_fmac_f32 v122, v126, v126
v_fmac_f32 v123, v127, v127
v_lshlrev_b32 v124, 16, v110
v_and_b32 v125, 0xffff0000, v110
v_add_f32 v120, v120, v124
v_add_f32 v121, v121, v125
v_fmac_f32 v122, v124, v124
v_fmac_f32 v123, v125, v125
v_lshlrev_b32 v126, 16, v111
v_and_b32 v127, 0xffff0000, v111
v_add_f32 v120, v120, v126
v_add_f32 v121, v121, v127
v_fmac_f32 v122, v126, v126
v_fmac_f32 v123, v127, v127
v_add_f32 v116, v116, v117
v_add_f32 v118, v118, v119
v_add_f32 v120, v120, v121
v_add_f32 v122, v122, v123
s_nop 0
v_add_f32_dpp v116, v116, v116 row_ror:8 row_mask:0xf bank_mask:0xf
v_add_f32_dpp v118, v118, v118 row_ror:8 row_mask:0xf bank_mask:0xf
v_add_f32_dpp v120, v120, v120 row_ror:8 row_mask:0xf bank_mask:0xf
v_add_f32_dpp v122, v122, v122 row_ror:8 row_mask:0xf bank_mask:0xf
v_add_f32_dpp v116, v116, v116 row_ror:4 row_mask:0xf bank_mask:0xf
v_add_f32_dpp v118, v118, v118 row_ror:4 row_mask:0xf bank_mask:0xf
v_add_f32_dpp v120, v120, v120 row_ror:4 row_mask:0xf bank_mask:0xf
v_add_f32_dpp v122, v122, v122 row_ror:4 row_mask:0xf bank_mask:0xf
v_add_f32_dpp v116, v116, v116 row_ror:2 row_mask:0xf bank_mask:0xf
v_add_f32_dpp v118, v118, v118 row_ror:2 row_mask:0xf bank_mask:0xf
v_add_f32_dpp v120, v120, v120 row_ror:2 row_mask:0xf bank_mask:0xf
v_add_f32_dpp v122, v122, v122 row_ror:2 row_mask:0xf bank_mask:0xf
v_add_f32_dpp v116, v116, v116 row_ror:1 row_mask:0xf bank_mask:0xf
v_add_f32_dpp v118, v118, v118 row_ror:1 row_mask:0xf bank_mask:0xf
v_add_f32_dpp v120, v120, v120 row_ror:1 row_mask:0xf bank_mask:0xf
v_add_f32_dpp v122, v122, v122 row_ror:1 row_mask:0xf bank_mask:0xf
v_mov_b32 v117, v116
v_mov_b32 v119, v118
v_mov_b32 v121, v120
v_mov_b32 v123, v122
s_nop 0
v_permlane16_swap_b32 v116, v117
v_permlane16_swap_b32 v118, v119
v_permlane16_swap_b32 v120, v121
v_permlane16_swap_b32 v122, v123
v_add_f32 v116, v116, v117
v_add_f32 v118, v118, v119
v_add_f32 v120, v120, v121
v_add_f32 v122, v122, v123
v_mov_b32 v117, v116
v_mov_b32 v119, v118
v_mov_b32 v121, v120
v_mov_b32 v123, v122
s_nop 0
v_permlane32_swap_b32 v116, v117
v_permlane32_swap_b32 v118, v119
v_permlane32_swap_b32 v120, v121
v_permlane32_swap_b32 v122, v123
v_add_f32 v116, v116, v117
v_add_f32 v118, v118, v119
v_add_f32 v120, v120, v121
v_add_f32 v122, v122, v123
v_mul_f32 v112, 0x3a800000, v116
v_mul_f32 v113, 0x3a800000, v118
v_fma_f32 v113, -v112, v112, v113
v_max_f32 v113, 0, v113
v_add_f32 v113, 0x3727c5ac, v113
v_rsq_f32 v113, v113
v_mul_f32 v114, 0x3a800000, v120
v_mul_f32 v115, 0x3a800000, v122
v_fma_f32 v115, -v114, v114, v115
v_max_f32 v115, 0, v115
v_add_f32 v115, 0x3727c5ac, v115
v_rsq_f32 v115, v115
s_nop 0
s_lshl_b32 s43, s47, 4
s_add_u32 s43, s43, 130176
v_mov_b32 v11, s43
ds_write_b128 v11, v[112:115]
s_waitcnt lgkmcnt(0)
s_barrier
v_lshlrev_b32 v5, 4, v1
v_and_b32 v5, 63, v5
v_add_u32 v6, 130176, v5
ds_read_b128 v[112:115], v6
s_lshl_b32 s43, s63, 3
v_add_u32 v5, s43, v5
s_waitcnt lgkmcnt(0)
s_mov_b64 exec, 15
buffer_store_dwordx4 v[112:115], v5, s[20:23], 0 offen sc1
s_mov_b64 exec, -1
s_barrier
s_barrier
s_barrier
s_barrier
s_waitcnt vmcnt(0)
s_lshl_b32 s43, s34, 4
s_add_u32 s43, s43, s35
v_mov_b32 v5, s43
v_mov_b32 v6, 1
s_mov_b64 exec, 1
buffer_store_byte v6, v5, s[56:59], 0 offen sc1
s_mov_b64 exec, -1
s_barrier
s_barrier
s_barrier
s_lshl_b32 s43, s34, 4
s_sub_u32 s44, s43, 4
s_max_i32 s44, s44, 0
v_lshl_add_u32 v5, v1, 2, s43
v_mov_b32 v6, s44
v_cmp_gt_u32 vcc, 4, v1
s_nop 1
v_cndmask_b32 v5, v6, v5, vcc
v_cmp_eq_u32 vcc, 5, v1
s_nop 1
v_cndmask_b32 v5, v5, 0, vcc
buffer_load_dword v6, v5, s[56:59], 0 offen sc1
s_barrier
s_barrier
s_mov_b32 s41, 200
s_mov_b32 s62, 0
s_waitcnt vmcnt(0)
Lpoll_9:
v_and_b32 v6, 0x01010101, v6
v_cmp_ne_u32 vcc, 0x01010101, v6
s_nop 4
s_cbranch_vccz Lok_10
buffer_load_dword v6, v5, s[56:59], 0 offen sc1
s_waitcnt vmcnt(0)
s_sub_u32 s41, s41, 1
s_cmp_lg_u32 s41, 0
s_cbranch_scc1 Lpoll_9
s_mov_b32 s41, 0
Lfb_11:
s_add_u32 s62, s50, s41
s_max_i32 s62, s62, 0
s_lshl_b32 s43, s62, 11
buffer_load_dwordx4 v[96:99], v10, s[8:11], s43 offen offset:0
buffer_load_dwordx4 v[100:103], v10, s[8:11], s43 offen offset:1024
buffer_load_dwordx4 v[104:107], v10, s[8:11], s43 offen offset:2048
buffer_load_dwordx4 v[108:111], v10, s[8:11], s43 offen offset:3072
s_waitcnt vmcnt(0)
v_lshlrev_b32 v124, 16, v96
v_and_b32 v125, 0xffff0000, v96
v_mov_b32 v116, v124
v_mov_b32 v117, v125
v_mul_f32 v118, v124, v124
v_mul_f32 v119, v125, v125
v_lshlrev_b32 v126, 16, v97
v_and_b32 v127, 0xffff0000, v97
v_add_f32 v116, v116, v126
v_add_f32 v117, v117, v127
v_fmac_f32 v118, v126, v126
v_fmac_f32 v119, v127, v127
v_lshlrev_b32 v124, 16, v98
v_and_b32 v125, 0xffff0000, v98
v_add_f32 v116, v116, v124
v_add_f32 v117, v117, v125
v_fmac_f32 v118, v124, v124
v_fmac_f32 v119, v125, v125
v_lshlrev_b32 v126, 16, v99
v_and_b32 v127, 0xffff0000, v99
v_add_f32 v116, v116, v126
v_add_f32 v117, v117, v127
v_fmac_f32 v118, v126, v126
v_fmac_f32 v119, v127, v127
v_lshlrev_b32 v124, 16, v100
v_and_b32 v125, 0xffff0000, v100
v_add_f32 v116, v116, v124
v_add_f32 v117, v117, v125
v_fmac_f32 v118, v124, v124
v_fmac_f32 v119, v125, v125
v_lshlrev_b32 v126, 16, v101
v_and_b32 v127, 0xffff0000, v101
v_add_f32 v116, v116, v126
v_add_f32 v117, v117, v127
v_fmac_f32 v118, v126, v126
v_fmac_f32 v119, v127, v127
v_lshlrev_b32 v124, 16, v102
v_and_b32 v125, 0xffff0000, v102
v_add_f32 v116, v116, v124
v_add_f32 v117, v117, v125
v_fmac_f32 v118, v124, v124
v_fmac_f32 v119, v125, v125
v_lshlrev_b32 v126, 16, v103
v_and_b32 v127, 0xffff0000, v103
v_add_f32 v116, v116, v126
v_add_f32 v117, v117, v127
v_fmac_f32 v118, v126, v126
v_fmac_f32 v119, v127, v127
v_lshlrev_b32 v124, 16, v104
v_and_b32 v125, 0xffff0000, v104
v_mov_b32 v120, v124
v_mov_b32 v121, v125
v_mul_f32 v122, v124, v124
v_mul_f32 v123, v125, v125
v_lshlrev_b32 v126, 16, v105
v_and_b32 v127, 0xffff0000, v105
v_add_f32 v120, v120, v126
v_add_f32 v121, v121, v127
v_fmac_f32 v122, v126, v126
v_fmac_f32 v123, v127, v127
v_lshlrev_b32 v124, 16, v106
v_and_b32 v125, 0xffff0000, v106
v_add_f32 v120, v120, v124
v_add_f32 v121, v121, v125
v_fmac_f32 v122, v124, v124
v_fmac_f32 v123, v125, v125
v_lshlrev_b32 v126, 16, v107
v_and_b32 v127, 0xffff0000, v107
v_add_f32 v120, v120, v126
v_add_f32 v121, v121, v127
v_fmac_f32 v122, v126, v126
v_fmac_f32 v123, v127, v127
v_lshlrev_b32 v124, 16, v108
v_and_b32 v125, 0xffff0000, v108
v_add_f32 v120, v120, v124
v_add_f32 v121, v121, v125
v_fmac_f32 v122, v124, v124
v_fmac_f32 v123, v125, v125
v_lshlrev_b32 v126, 16, v109
v_and_b32 v127, 0xffff0000, v109
v_add_f32 v120, v120, v126
v_add_f32 v121, v121, v127
v_fmac_f32 v122, v126, v126
v_fmac_f32 v123, v127, v127
v_lshlrev_b32 v124, 16, v110
v_and_b32 v125, 0xffff0000, v110
v_add_f32 v120, v120, v124
v_add_f32 v121, v121, v125
v_fmac_f32 v122, v124, v124
v_fmac_f32 v123, v125, v125
v_lshlrev_b32 v126, 16, v111
v_and_b32 v127, 0xffff0000, v111
v_add_f32 v120, v120, v126
v_add_f32 v121, v121, v127
v_fmac_f32 v122, v126, v126
v_fmac_f32 v123, v127, v127
v_add_f32 v116, v116, v117
v_add_f32 v118, v118, v119
v_add_f32 v120, v120, v121
v_add_f32 v122, v122, v123
s_nop 0
v_add_f32_dpp v116, v116, v116 row_ror:8 row_mask:0xf bank_mask:0xf
v_add_f32_dpp v118, v118, v118 row_ror:8 row_mask:0xf bank_mask:0xf
v_add_f32_dpp v120, v120, v120 row_ror:8 row_mask:0xf bank_mask:0xf
v_add_f32_dpp v122, v122, v122 row_ror:8 row_mask:0xf bank_mask:0xf
v_add_f32_dpp v116, v116, v116 row_ror:4 row_mask:0xf bank_mask:0xf
v_add_f32_dpp v118, v118, v118 row_ror:4 row_mask:0xf bank_mask:0xf
v_add_f32_dpp v120, v120, v120 row_ror:4 row_mask:0xf bank_mask:0xf
v_add_f32_dpp v122, v122, v122 row_ror:4 row_mask:0xf bank_mask:0xf
v_add_f32_dpp v116, v116, v116 row_ror:2 row_mask:0xf bank_mask:0xf
v_add_f32_dpp v118, v118, v118 row_ror:2 row_mask:0xf bank_mask:0xf
v_add_f32_dpp v120, v120, v120 row_ror:2 row_mask:0xf bank_mask:0xf
v_add_f32_dpp v122, v122, v122 row_ror:2 row_mask:0xf bank_mask:0xf
v_add_f32_dpp v116, v116, v116 row_ror:1 row_mask:0xf bank_mask:0xf
v_add_f32_dpp v118, v118, v118 row_ror:1 row_mask:0xf bank_mask:0xf
v_add_f32_dpp v120, v120, v120 row_ror:1 row_mask:0xf bank_mask:0xf
v_add_f32_dpp v122, v122, v122 row_ror:1 row_mask:0xf bank_mask:0xf
v_mov_b32 v117, v116
v_mov_b32 v119, v118
v_mov_b32 v121, v120
v_mov_b32 v123, v122
s_nop 0
v_permlane16_swap_b32 v116, v117
v_permlane16_swap_b32 v118, v119
v_permlane16_swap_b32 v120, v121
v_permlane16_swap_b32 v122, v123
v_add_f32 v116, v116, v117
v_add_f32 v118, v118, v119
v_add_f32 v120, v120, v121
v_add_f32 v122, v122, v123
v_mov_b32 v117, v116
v_mov_b32 v119, v118
v_mov_b32 v121, v120
v_mov_b32 v123, v122
s_nop 0
v_permlane32_swap_b32 v116, v117
v_permlane32_swap_b32 v118, v119
v_permlane32_swap_b32 v120, v121
v_permlane32_swap_b32 v122, v123
v_add_f32 v116, v116, v117
v_add_f32 v118, v118, v119
v_add_f32 v120, v120, v121
v_add_f32 v122, v122, v123
v_mul_f32 v112, 0x3a800000, v116
v_mul_f32 v113, 0x3a800000, v118
v_fma_f32 v113, -v112, v112, v113
v_max_f32 v113, 0, v113
v_add_f32 v113, 0x3727c5ac, v113
v_rsq_f32 v113, v113
v_mul_f32 v114, 0x3a800000, v120
v_mul_f32 v115, 0x3a800000, v122
v_fma_f32 v115, -v114, v114, v115
v_max_f32 v115, 0, v115
v_add_f32 v115, 0x3727c5ac, v115
v_rsq_f32 v115, v115
s_nop 0
s_lshl_b32 s43, s41, 3
s_add_u32 s43, s43, 129024
v_mov_b32 v5, s43
ds_write_b128 v5, v[112:115]
s_add_u32 s41, s41, 2
s_cmp_lt_u32 s41, 144
s_cbranch_scc1 Lfb_11
s_mov_b32 s62, 1
v_mov_b32 v5, 0
s_mov_b32 s41, 0x10000
Lz0_12:
buffer_load_ubyte v6, v5, s[56:59], 0 offen sc1
s_waitcnt vmcnt(0)
v_cmp_eq_u32 vcc, 0, v6
s_nop 4
s_cbranch_vccz Lok_10
s_sub_u32 s41, s41, 1
s_cmp_lg_u32 s41, 0
s_cbranch_scc1 Lz0_12
Lok_10:
v_add_u32 v5, 0, v1
v_min_u32 v5, 143, v5
v_lshlrev_b32 v20, 3, v5
v_add_u32 v5, s50, v5
v_max_i32 v5, 0, v5
v_lshlrev_b32 v5, 3, v5
buffer_load_dwordx2 v[32:33], v5, s[20:23], 0 offen sc1
v_add_u32 v5, 64, v1
v_min_u32 v5, 143, v5
v_lshlrev_b32 v21, 3, v5
v_add_u32 v5, s50, v5
v_max_i32 v5, 0, v5
v_lshlrev_b32 v5, 3, v5
buffer_load_dwordx2 v[34:35], v5, s[20:23], 0 offen sc1
v_add_u32 v5, 128, v1
v_min_u32 v5, 143, v5
v_lshlrev_b32 v22, 3, v5
v_add_u32 v5, s50, v5
v_max_i32 v5, 0, v5
v_lshlrev_b32 v5, 3, v5
buffer_load_dwordx2 v[36:37], v5, s[20:23], 0 offen sc1
s_barrier
s_load_dwordx2 s[88:89], s[0:1], 16
v_lshlrev_b32 v29, 7, v1
s_lshl_b32 s43, s2, 13
s_waitcnt lgkmcnt(0)
s_mov_b32 s84, s88
s_mov_b32 s85, s89
s_mov_b32 s86, 2097152
s_mov_b32 s87, 0x20000
buffer_load_dword v30, v29, s[84:87], s43 offen
s_barrier
s_waitcnt vmcnt(1)
s_cmp_eq_u32 s62, 1
s_cbranch_scc1 Lgd_8
v_add_u32 v20, 129024, v20
ds_write_b64 v20, v[32:33]
v_add_u32 v21, 129024, v21
ds_write_b64 v21, v[34:35]
v_add_u32 v22, 129024, v22
ds_write_b64 v22, v[36:37]
Lgd_8:
s_waitcnt lgkmcnt(0)
s_lshr_b32 s43, s2, 1
s_cmp_ge_u32 s43, 112
s_cbranch_scc1 Lnj_13
s_and_b32 s44, s2, 1
s_lshl_b32 s45, s44, 3
s_add_u32 s45, s45, 32
s_load_dwordx2 s[88:89], s[0:1], s45
s_mul_i32 s45, s43, 2341
s_lshr_b32 s45, s45, 16
s_mul_i32 s46, s45, 28
s_sub_u32 s46, s43, s46
v_lshrrev_b32 v28, 4, v1
s_lshl_b32 s43, s45, 8
v_add_u32 v28, s43, v28
v_mul_u32_u24 v28, 7168, v28
v_and_b32 v29, 15, v1
v_lshl_add_u32 v28, v29, 4, v28
s_lshl_b32 s43, s46, 8
v_add_u32 v28, s43, v28
s_waitcnt lgkmcnt(0)
s_mov_b32 s84, s88
s_mov_b32 s85, s89
s_mov_b32 s86, 7340032
s_mov_b32 s87, 0x20000
s_mov_b32 s43, 0
buffer_load_dwordx4 v[128:131], v28, s[84:87], s43 offen
s_mov_b32 s43, 28672
buffer_load_dwordx4 v[132:135], v28, s[84:87], s43 offen
s_mov_b32 s43, 57344
buffer_load_dwordx4 v[136:139], v28, s[84:87], s43 offen
s_mov_b32 s43, 86016
buffer_load_dwordx4 v[140:143], v28, s[84:87], s43 offen
s_mov_b32 s43, 114688
buffer_load_dwordx4 v[144:147], v28, s[84:87], s43 offen
s_mov_b32 s43, 143360
buffer_load_dwordx4 v[148:151], v28, s[84:87], s43 offen
s_mov_b32 s43, 172032
buffer_load_dwordx4 v[152:155], v28, s[84:87], s43 offen
s_mov_b32 s43, 200704
buffer_load_dwordx4 v[156:159], v28, s[84:87], s43 offen
s_mov_b32 s43, 229376
buffer_load_dwordx4 v[160:163], v28, s[84:87], s43 offen
s_mov_b32 s43, 258048
buffer_load_dwordx4 v[164:167], v28, s[84:87], s43 offen
s_mov_b32 s43, 286720
buffer_load_dwordx4 v[168:171], v28, s[84:87], s43 offen
s_mov_b32 s43, 315392
buffer_load_dwordx4 v[172:175], v28, s[84:87], s43 offen
s_mov_b32 s43, 344064
buffer_load_dwordx4 v[176:179], v28, s[84:87], s43 offen
s_mov_b32 s43, 372736
buffer_load_dwordx4 v[180:183], v28, s[84:87], s43 offen
s_mov_b32 s43, 401408
buffer_load_dwordx4 v[184:187], v28, s[84:87], s43 offen
s_mov_b32 s43, 430080
buffer_load_dwordx4 v[188:191], v28, s[84:87], s43 offen
Lnj_13:
s_barrier
s_lshr_b32 s43, s2, 1
s_cmp_ge_u32 s43, 112
s_cbranch_scc1 Lnj_14
s_and_b32 s44, s2, 1
s_lshl_b32 s45, s44, 3
s_add_u32 s45, s45, 32
s_load_dwordx2 s[88:89], s[0:1], s45
s_mul_i32 s45, s43, 2341
s_lshr_b32 s45, s45, 16
s_mul_i32 s46, s45, 28
s_sub_u32 s46, s43, s46
v_lshrrev_b32 v28, 4, v1
s_lshl_b32 s43, s45, 8
v_add_u32 v28, s43, v28
v_mul_u32_u24 v28, 7168, v28
v_and_b32 v29, 15, v1
v_lshl_add_u32 v28, v29, 4, v28
s_lshl_b32 s43, s46, 8
v_add_u32 v28, s43, v28
s_waitcnt lgkmcnt(0)
s_mov_b32 s84, s88
s_mov_b32 s85, s89
s_mov_b32 s86, 7340032
s_mov_b32 s87, 0x20000
s_mov_b32 s43, 458752
buffer_load_dwordx4 v[192:195], v28, s[84:87], s43 offen
s_mov_b32 s43, 487424
buffer_load_dwordx4 v[196:199], v28, s[84:87], s43 offen
s_mov_b32 s43, 516096
buffer_load_dwordx4 v[200:203], v28, s[84:87], s43 offen
s_mov_b32 s43, 544768
buffer_load_dwordx4 v[204:207], v28, s[84:87], s43 offen
s_mov_b32 s43, 573440
buffer_load_dwordx4 v[208:211], v28, s[84:87], s43 offen
s_mov_b32 s43, 602112
buffer_load_dwordx4 v[212:215], v28, s[84:87], s43 offen
s_mov_b32 s43, 630784
buffer_load_dwordx4 v[216:219], v28, s[84:87], s43 offen
s_mov_b32 s43, 659456
buffer_load_dwordx4 v[220:223], v28, s[84:87], s43 offen
s_mov_b32 s43, 688128
buffer_load_dwordx4 v[224:227], v28, s[84:87], s43 offen
s_mov_b32 s43, 716800
buffer_load_dwordx4 v[228:231], v28, s[84:87], s43 offen
s_mov_b32 s43, 745472
buffer_load_dwordx4 v[232:235], v28, s[84:87], s43 offen
s_mov_b32 s43, 774144
buffer_load_dwordx4 v[236:239], v28, s[84:87], s43 offen
s_mov_b32 s43, 802816
buffer_load_dwordx4 v[240:243], v28, s[84:87], s43 offen
s_mov_b32 s43, 831488
buffer_load_dwordx4 v[244:247], v28, s[84:87], s43 offen
s_mov_b32 s43, 860160
buffer_load_dwordx4 v[248:251], v28, s[84:87], s43 offen
s_mov_b32 s43, 888832
buffer_load_dwordx4 v[252:255], v28, s[84:87], s43 offen
Lnj_14:
s_barrier
s_barrier
Latt_4:
s_barrier
s_and_b32 s43, s36, 1
s_lshr_b32 s44, s36, 1
s_and_b32 s44, s44, 1
s_lshr_b32 s45, s36, 2
v_lshlrev_b32 v14, 2, v13
v_sub_u32 v14, v12, v14
v_subrev_u32 v15, 0, v14
v_cmp_ge_u32 s[52:53], 7, v15
v_add_u32 v15, 16, v15
v_cmp_ge_u32 s[84:85], 7, v15
v_subrev_u32 v15, 1, v14
v_cmp_ge_u32 s[54:55], 7, v15
v_add_u32 v15, 16, v15
v_cmp_ge_u32 s[86:87], 7, v15
v_subrev_u32 v15, 2, v14
v_cmp_ge_u32 s[56:57], 7, v15
v_add_u32 v15, 16, v15
v_cmp_ge_u32 s[88:89], 7, v15
v_subrev_u32 v15, 3, v14
v_cmp_ge_u32 s[58:59], 7, v15
v_add_u32 v15, 16, v15
v_cmp_ge_u32 s[90:91], 7, v15
s_lshl_b32 s46, s45, 6
s_add_u32 s46, s46, s44
s_add_u32 s46, s46, 16
v_lshl_add_u32 v14, v12, 1, s46
s_lshl_b32 s47, s43, 6
v_lshl_add_u32 v15, v13, 4, s47
v_mul_u32_u24 v2, 400, v14
v_add_u32 v2, v2, v15
v_subrev_u32 v16, 32, v14
v_max_i32 v16, 0, v16
v_mul_u32_u24 v3, 400, v16
v_add_u32 v3, v3, v15
v_lshrrev_b32 v16, 2, v12
v_lshl_add_u32 v16, v13, 2, v16
v_lshl_add_u32 v16, v16, 1, s46
v_and_b32 v17, 3, v1
v_lshl_add_u32 v17, v17, 3, s47
v_mul_u32_u24 v4, 400, v16
v_add_u32 v4, v4, v17
v_subrev_u32 v16, 32, v16
v_max_i32 v16, 0, v16
v_mul_u32_u24 v5, 400, v16
v_add_u32 v5, v5, v17
s_lshl_b32 s60, s43, 13
s_lshl_b32 s61, s45, 10
s_add_u32 s60, s60, s61
s_lshl_b32 s61, s44, 8
s_add_u32 s60, s60, s61
v_lshlrev_b32 v6, 11, v13
v_lshl_add_u32 v6, v12, 4, v6
v_add_u32 v6, s60, v6
v_mov_b32 v8, 0xff800000
s_mov_b32 s61, 0x3e8293ee
s_or_b32 s62, s34, s45
ds_read_b128 v[32:35], v2 offset:0
ds_read_b128 v[36:39], v2 offset:128
ds_read_b128 v[40:43], v3 offset:128
ds_read_b64_tr_b16 v[44:45], v5 offset:256
ds_read_b64_tr_b16 v[46:47], v4 offset:256
ds_read_b64_tr_b16 v[48:49], v5 offset:288
ds_read_b64_tr_b16 v[50:51], v4 offset:288
ds_read_b128 v[80:83], v2 offset:12800
ds_read_b128 v[84:87], v2 offset:12928
ds_read_b128 v[88:91], v2 offset:128
ds_read_b64_tr_b16 v[92:93], v4 offset:256
ds_read_b64_tr_b16 v[94:95], v4 offset:13056
ds_read_b64_tr_b16 v[96:97], v4 offset:288
ds_read_b64_tr_b16 v[98:99], v4 offset:13088
s_waitcnt lgkmcnt(11)
v_mfma_f32_16x16x32_bf16 v[52:55], v[40:43], v[32:35], 0
v_mfma_f32_16x16x32_bf16 v[56:59], v[36:39], v[32:35], 0
s_waitcnt lgkmcnt(4)
v_mfma_f32_16x16x32_bf16 v[100:103], v[88:91], v[80:83], 0
v_mfma_f32_16x16x32_bf16 v[104:107], v[84:87], v[80:83], 0
s_nop 4
s_cmp_lg_u32 s62, 0
s_cselect_b64 s[92:93], s[84:85], 0
v_cndmask_b32 v52, v8, v52, s[92:93]
s_cselect_b64 s[92:93], s[86:87], 0
v_cndmask_b32 v53, v8, v53, s[92:93]
s_cselect_b64 s[92:93], s[88:89], 0
v_cndmask_b32 v54, v8, v54, s[92:93]
s_cselect_b64 s[92:93], s[90:91], 0
v_cndmask_b32 v55, v8, v55, s[92:93]
v_cndmask_b32 v56, v8, v56, s[52:53]
v_cndmask_b32 v57, v8, v57, s[54:55]
v_cndmask_b32 v58, v8, v58, s[56:57]
v_cndmask_b32 v59, v8, v59, s[58:59]
v_max3_f32 v60, v52, v53, v54
v_max3_f32 v60, v60, v55, v56
v_max3_f32 v60, v60, v57, v58
v_max_f32 v60, v60, v59
v_mov_b32 v61, v60
s_nop 1
v_permlane32_swap_b32 v60, v61
v_max_f32 v60, v60, v61
v_mov_b32 v61, v60
s_nop 1
v_permlane16_swap_b32 v60, v61
v_max_f32 v60, v60, v61
v_mul_f32 v60, s61, v60
v_fma_f32 v52, v52, s61, -v60
v_fma_f32 v53, v53, s61, -v60
v_fma_f32 v54, v54, s61, -v60
v_fma_f32 v55, v55, s61, -v60
v_fma_f32 v56, v56, s61, -v60
v_fma_f32 v57, v57, s61, -v60
v_fma_f32 v58, v58, s61, -v60
v_fma_f32 v59, v59, s61, -v60
v_exp_f32 v52, v52
v_exp_f32 v53, v53
v_exp_f32 v54, v54
v_exp_f32 v55, v55
v_exp_f32 v56, v56
v_exp_f32 v57, v57
v_exp_f32 v58, v58
v_exp_f32 v59, v59
s_nop 0
v_add_f32 v60, v52, v53
v_add_f32 v60, v60, v54
v_add_f32 v60, v60, v55
v_add_f32 v60, v60, v56
v_add_f32 v60, v60, v57
v_add_f32 v60, v60, v58
v_add_f32 v60, v60, v59
v_cvt_pk_bf16_f32 v64, v52, v53
v_cvt_pk_bf16_f32 v65, v54, v55
v_cvt_pk_bf16_f32 v66, v56, v57
v_cvt_pk_bf16_f32 v67, v58, v59
v_mov_b32 v61, v60
s_nop 1
v_permlane32_swap_b32 v60, v61
v_add_f32 v60, v60, v61
v_mov_b32 v61, v60
s_nop 1
v_permlane16_swap_b32 v60, v61
v_add_f32 v60, v60, v61
v_rcp_f32 v60, v60
s_waitcnt lgkmcnt(0)
v_mfma_f32_16x16x32_bf16 v[68:71], v[44:47], v[64:67], 0
v_mfma_f32_16x16x32_bf16 v[72:75], v[48:51], v[64:67], 0
v_cndmask_b32 v100, v8, v100, s[84:85]
v_cndmask_b32 v101, v8, v101, s[86:87]
v_cndmask_b32 v102, v8, v102, s[88:89]
v_cndmask_b32 v103, v8, v103, s[90:91]
v_cndmask_b32 v104, v8, v104, s[52:53]
v_cndmask_b32 v105, v8, v105, s[54:55]
v_cndmask_b32 v106, v8, v106, s[56:57]
v_cndmask_b32 v107, v8, v107, s[58:59]
v_max3_f32 v108, v100, v101, v102
v_max3_f32 v108, v108, v103, v104
v_max3_f32 v108, v108, v105, v106
v_max_f32 v108, v108, v107
v_mov_b32 v109, v108
s_nop 1
v_permlane32_swap_b32 v108, v109
v_max_f32 v108, v108, v109
v_mov_b32 v109, v108
s_nop 1
v_permlane16_swap_b32 v108, v109
v_max_f32 v108, v108, v109
v_mul_f32 v108, s61, v108
v_fma_f32 v100, v100, s61, -v108
v_fma_f32 v101, v101, s61, -v108
v_fma_f32 v102, v102, s61, -v108
v_fma_f32 v103, v103, s61, -v108
v_fma_f32 v104, v104, s61, -v108
v_fma_f32 v105, v105, s61, -v108
v_fma_f32 v106, v106, s61, -v108
v_fma_f32 v107, v107, s61, -v108
v_exp_f32 v100, v100
v_exp_f32 v101, v101
v_exp_f32 v102, v102
v_exp_f32 v103, v103
v_exp_f32 v104, v104
v_exp_f32 v105, v105
v_exp_f32 v106, v106
v_exp_f32 v107, v107
s_nop 0
v_add_f32 v108, v100, v101
v_add_f32 v108, v108, v102
v_add_f32 v108, v108, v103
v_add_f32 v108, v108, v104
v_add_f32 v108, v108, v105
v_add_f32 v108, v108, v106
v_add_f32 v108, v108, v107
v_cvt_pk_bf16_f32 v112, v100, v101
v_cvt_pk_bf16_f32 v113, v102, v103
v_cvt_pk_bf16_f32 v114, v104, v105
v_cvt_pk_bf16_f32 v115, v106, v107
v_mov_b32 v109, v108
s_nop 1
v_permlane32_swap_b32 v108, v109
v_add_f32 v108, v108, v109
v_mov_b32 v109, v108
s_nop 1
v_permlane16_swap_b32 v108, v109
v_add_f32 v108, v108, v109
v_rcp_f32 v108, v108
s_waitcnt lgkmcnt(0)
v_mfma_f32_16x16x32_bf16 v[116:119], v[92:95], v[112:115], 0
v_mfma_f32_16x16x32_bf16 v[120:123], v[96:99], v[112:115], 0
s_nop 4
v_mul_f32 v68, v60, v68
v_mul_f32 v69, v60, v69
v_mul_f32 v70, v60, v70
v_mul_f32 v71, v60, v71
v_mul_f32 v72, v60, v72
v_mul_f32 v73, v60, v73
v_mul_f32 v74, v60, v74
v_mul_f32 v75, v60, v75
v_cvt_pk_bf16_f32 v68, v68, v69
v_cvt_pk_bf16_f32 v69, v70, v71
v_cvt_pk_bf16_f32 v70, v72, v73
v_cvt_pk_bf16_f32 v71, v74, v75
buffer_store_dwordx4 v[68:71], v6, s[16:19], 0 offen offset:0 sc1
v_mul_f32 v116, v108, v116
v_mul_f32 v117, v108, v117
v_mul_f32 v118, v108, v118
v_mul_f32 v119, v108, v119
v_mul_f32 v120, v108, v120
v_mul_f32 v121, v108, v121
v_mul_f32 v122, v108, v122
v_mul_f32 v123, v108, v123
v_cvt_pk_bf16_f32 v116, v116, v117
v_cvt_pk_bf16_f32 v117, v118, v119
v_cvt_pk_bf16_f32 v118, v120, v121
v_cvt_pk_bf16_f32 v119, v122, v123
buffer_store_dwordx4 v[116:119], v6, s[16:19], 0 offen offset:512 sc1
s_waitcnt vmcnt(0)
s_barrier
s_add_u32 s56, s32, 28311552
s_addc_u32 s57, s33, 0
s_mov_b32 s58, 16384
s_mov_b32 s59, 0x20000
s_cmp_lg_u32 s36, 0
s_cbranch_scc1 Lsig_15
s_add_u32 s43, s34, 0
s_lshl_b32 s43, s43, 7
v_mov_b32 v5, s43
v_mov_b32 v6, 1
s_mov_b64 exec, 1
buffer_atomic_add v6, v5, s[56:59], 0 offen sc1
s_mov_b64 exec, -1
Lsig_15:
s_load_dwordx4 s[4:7], s[0:1], 32
s_load_dwordx2 s[28:29], s[0:1], 16
s_load_dwordx4 s[60:63], s[0:1], 48
s_load_dwordx2 s[30:31], s[0:1], 0
v_and_b32 v17, 15, v1
v_lshrrev_b32 v18, 4, v1
s_lshr_b32 s46, s36, 1
s_and_b32 s46, s46, 1
s_and_b32 s47, s36, 1
s_and_b32 s51, s36, 3
s_waitcnt lgkmcnt(0)
s_cmp_ge_u32 s36, 4
s_cbranch_scc1 LG1_16
s_lshl_b32 s43, s34, 18
s_lshl_b32 s44, s35, 7
s_add_u32 s43, s43, s44
s_add_u32 s16, s30, s43
s_addc_u32 s17, s31, 0
s_mov_b32 s18, 260224
s_mov_b32 s19, 0x20000
s_lshl_b32 s43, s36, 5
v_lshl_add_u32 v19, v17, 1, s43
v_lshlrev_b32 v19, 11, v19
v_lshl_add_u32 v23, v18, 3, v19
buffer_load_dwordx2 v[160:161], v23, s[16:19], 0 offen offset:0
buffer_load_dwordx2 v[162:163], v23, s[16:19], 0 offen offset:32
buffer_load_dwordx2 v[164:165], v23, s[16:19], 0 offen offset:64
buffer_load_dwordx2 v[166:167], v23, s[16:19], 0 offen offset:96
buffer_load_dwordx2 v[168:169], v23, s[16:19], 0 offen offset:2048
buffer_load_dwordx2 v[170:171], v23, s[16:19], 0 offen offset:2080
buffer_load_dwordx2 v[172:173], v23, s[16:19], 0 offen offset:2112
buffer_load_dwordx2 v[174:175], v23, s[16:19], 0 offen offset:2144
v_lshlrev_b32 v19, 11, v18
v_lshl_add_u32 v19, v17, 4, v19
s_lshl_b32 s43, s36, 9
v_add_u32 v2, s43, v19
v_add_u32 v3, 49152, v2
v_add_u32 v4, 98304, v2
v_lshrrev_b32 v19, 2, v17
v_lshl_add_u32 v20, v18, 2, v19
v_bfe_u32 v21, v20, 1, 2
v_lshlrev_b32 v20, 7, v20
v_lshl_add_u32 v20, v21, 5, v20
v_and_b32 v19, 3, v1
v_lshl_add_u32 v20, v19, 3, v20
v_add_u32 v5, 16384, v20
v_xor_b32 v6, 32, v5
v_xor_b32 v7, 64, v5
v_xor_b32 v8, 96, v5
v_add_u32 v9, 49152, v5
v_add_u32 v10, 49152, v6
v_add_u32 v11, 49152, v7
v_add_u32 v12, 49152, v8
v_add_u32 v13, 98304, v5
v_add_u32 v14, 98304, v6
v_add_u32 v15, 98304, v7
v_add_u32 v16, 98304, v8
s_lshl_b32 s43, s34, 18
s_lshl_b32 s44, s35, 14
s_add_u32 s43, s43, s44
s_add_u32 s20, s32, s43
s_addc_u32 s21, s33, 0
s_add_u32 s20, s20, 4194304
s_addc_u32 s21, s21, 0
s_mov_b32 s22, 16384
s_mov_b32 s23, 0x20000
s_lshl_b32 s43, s34, 14
s_lshl_b32 s44, s35, 10
s_add_u32 s43, s43, s44
s_add_u32 s24, s32, s43
s_addc_u32 s25, s33, 0
s_add_u32 s24, s24, 25165824
s_addc_u32 s25, s25, 0
s_mov_b32 s26, 1024
s_mov_b32 s27, 0x20000
s_movk_i32 s50, 0x2000
s_mov_b32 s52, 0x3f803f80
v_lshrrev_b32 v19, 1, v18
v_lshl_add_u32 v19, v19, 4, v17
s_lshl_b32 s43, s36, 5
v_add_u32 v19, s43, v19
v_and_b32 v20, 1, v18
v_lshlrev_b32 v20, 2, v20
v_lshl_add_u32 v22, v19, 3, v20
s_waitcnt vmcnt(0)
v_lshlrev_b32 v128, 16, v160
v_and_b32 v129, 0xffff0000, v160
v_lshlrev_b32 v130, 16, v161
v_and_b32 v131, 0xffff0000, v161
v_lshlrev_b32 v132, 16, v162
v_and_b32 v133, 0xffff0000, v162
v_lshlrev_b32 v134, 16, v163
v_and_b32 v135, 0xffff0000, v163
v_lshlrev_b32 v136, 16, v164
v_and_b32 v137, 0xffff0000, v164
v_lshlrev_b32 v138, 16, v165
v_and_b32 v139, 0xffff0000, v165
v_lshlrev_b32 v140, 16, v166
v_and_b32 v141, 0xffff0000, v166
v_lshlrev_b32 v142, 16, v167
v_and_b32 v143, 0xffff0000, v167
v_lshlrev_b32 v144, 16, v168
v_and_b32 v145, 0xffff0000, v168
v_lshlrev_b32 v146, 16, v169
v_and_b32 v147, 0xffff0000, v169
v_lshlrev_b32 v148, 16, v170
v_and_b32 v149, 0xffff0000, v170
v_lshlrev_b32 v150, 16, v171
v_and_b32 v151, 0xffff0000, v171
v_lshlrev_b32 v152, 16, v172
v_and_b32 v153, 0xffff0000, v172
v_lshlrev_b32 v154, 16, v173
v_and_b32 v155, 0xffff0000, v173
v_lshlrev_b32 v156, 16, v174
v_and_b32 v157, 0xffff0000, v174
v_lshlrev_b32 v158, 16, v175
v_and_b32 v159, 0xffff0000, v175
s_lshl_b32 s43, s34, 18
s_add_u32 s12, s32, s43
s_addc_u32 s13, s33, 0
s_mov_b32 s14, 262144
s_mov_b32 s15, 0x20000
v_lshlrev_b32 v21, 4, v1
s_lshl_b32 s54, s36, 11
s_barrier
s_add_u32 m0, s54, 0
s_add_u32 s43, s54, 0
buffer_load_dwordx4 v21, s[12:15], s43 offen sc1 lds
s_add_u32 m0, s54, 1024
s_add_u32 s43, s54, 1024
buffer_load_dwordx4 v21, s[12:15], s43 offen sc1 lds
s_add_u32 m0, s54, 24576
s_add_u32 s43, s54, 16384
buffer_load_dwordx4 v21, s[12:15], s43 offen sc1 lds
s_add_u32 m0, s54, 25600
s_add_u32 s43, s54, 17408
buffer_load_dwordx4 v21, s[12:15], s43 offen sc1 lds
s_waitcnt vmcnt(2)
s_barrier
ds_read_b128 v[32:35], v2 offset:0
ds_read_b64_tr_b16 v[48:49], v5 offset:0
ds_read_b64_tr_b16 v[50:51], v5 offset:2048
ds_read_b64_tr_b16 v[52:53], v6 offset:0
ds_read_b64_tr_b16 v[54:55], v6 offset:2048
ds_read_b128 v[36:39], v2 offset:256
ds_read_b64_tr_b16 v[56:57], v7 offset:0
ds_read_b64_tr_b16 v[58:59], v7 offset:2048
ds_read_b64_tr_b16 v[60:61], v8 offset:0
ds_read_b64_tr_b16 v[62:63], v8 offset:2048
ds_read_b128 v[40:43], v2 offset:8192
ds_read_b64_tr_b16 v[64:65], v5 offset:4096
ds_read_b64_tr_b16 v[66:67], v5 offset:6144
ds_read_b64_tr_b16 v[68:69], v6 offset:4096
ds_read_b64_tr_b16 v[70:71], v6 offset:6144
ds_read_b128 v[44:47], v2 offset:8448
ds_read_b64_tr_b16 v[72:73], v7 offset:4096
ds_read_b64_tr_b16 v[74:75], v7 offset:6144
ds_read_b64_tr_b16 v[76:77], v8 offset:4096
ds_read_b64_tr_b16 v[78:79], v8 offset:6144
s_waitcnt vmcnt(0) lgkmcnt(0)
s_barrier
v_mfma_f32_16x16x32_bf16 v[128:131], v[48:51], v[32:35], v[128:131]
ds_read_b128 v[80:83], v2 offset:24576
ds_read_b64_tr_b16 v[96:97], v5 offset:24576
v_mfma_f32_16x16x32_bf16 v[132:135], v[52:55], v[32:35], v[132:135]
ds_read_b64_tr_b16 v[98:99], v5 offset:26624
ds_read_b64_tr_b16 v[100:101], v6 offset:24576
v_mfma_f32_16x16x32_bf16 v[136:139], v[56:59], v[32:35], v[136:139]
ds_read_b64_tr_b16 v[102:103], v6 offset:26624
ds_read_b128 v[84:87], v2 offset:24832
v_mfma_f32_16x16x32_bf16 v[140:143], v[60:63], v[32:35], v[140:143]
ds_read_b64_tr_b16 v[104:105], v7 offset:24576
ds_read_b64_tr_b16 v[106:107], v7 offset:26624
v_mfma_f32_16x16x32_bf16 v[144:147], v[48:51], v[36:39], v[144:147]
ds_read_b64_tr_b16 v[108:109], v8 offset:24576
ds_read_b64_tr_b16 v[110:111], v8 offset:26624
v_mfma_f32_16x16x32_bf16 v[148:151], v[52:55], v[36:39], v[148:151]
ds_read_b128 v[88:91], v2 offset:32768
ds_read_b64_tr_b16 v[112:113], v5 offset:28672
v_mfma_f32_16x16x32_bf16 v[152:155], v[56:59], v[36:39], v[152:155]
ds_read_b64_tr_b16 v[114:115], v5 offset:30720
v_mfma_f32_16x16x32_bf16 v[156:159], v[60:63], v[36:39], v[156:159]
ds_read_b64_tr_b16 v[116:117], v6 offset:28672
v_mfma_f32_16x16x32_bf16 v[128:131], v[64:67], v[40:43], v[128:131]
ds_read_b64_tr_b16 v[118:119], v6 offset:30720
v_mfma_f32_16x16x32_bf16 v[132:135], v[68:71], v[40:43], v[132:135]
ds_read_b128 v[92:95], v2 offset:33024
v_mfma_f32_16x16x32_bf16 v[136:139], v[72:75], v[40:43], v[136:139]
ds_read_b64_tr_b16 v[120:121], v7 offset:28672
v_mfma_f32_16x16x32_bf16 v[140:143], v[76:79], v[40:43], v[140:143]
ds_read_b64_tr_b16 v[122:123], v7 offset:30720
v_mfma_f32_16x16x32_bf16 v[144:147], v[64:67], v[44:47], v[144:147]
ds_read_b64_tr_b16 v[124:125], v8 offset:28672
v_mfma_f32_16x16x32_bf16 v[148:151], v[68:71], v[44:47], v[148:151]
ds_read_b64_tr_b16 v[126:127], v8 offset:30720
v_mfma_f32_16x16x32_bf16 v[152:155], v[72:75], v[44:47], v[152:155]
v_mfma_f32_16x16x32_bf16 v[156:159], v[76:79], v[44:47], v[156:159]
s_waitcnt lgkmcnt(0)
s_barrier
v_mfma_f32_16x16x32_bf16 v[128:131], v[96:99], v[80:83], v[128:131]
ds_read_b128 v[32:35], v3 offset:0
ds_read_b64_tr_b16 v[48:49], v9 offset:0
v_mfma_f32_16x16x32_bf16 v[132:135], v[100:103], v[80:83], v[132:135]
ds_read_b64_tr_b16 v[50:51], v9 offset:2048
ds_read_b64_tr_b16 v[52:53], v10 offset:0
v_mfma_f32_16x16x32_bf16 v[136:139], v[104:107], v[80:83], v[136:139]
ds_read_b64_tr_b16 v[54:55], v10 offset:2048
ds_read_b128 v[36:39], v3 offset:256
v_mfma_f32_16x16x32_bf16 v[140:143], v[108:111], v[80:83], v[140:143]
ds_read_b64_tr_b16 v[56:57], v11 offset:0
ds_read_b64_tr_b16 v[58:59], v11 offset:2048
v_mfma_f32_16x16x32_bf16 v[144:147], v[96:99], v[84:87], v[144:147]
ds_read_b64_tr_b16 v[60:61], v12 offset:0
ds_read_b64_tr_b16 v[62:63], v12 offset:2048
v_mfma_f32_16x16x32_bf16 v[148:151], v[100:103], v[84:87], v[148:151]
ds_read_b128 v[40:43], v3 offset:8192
ds_read_b64_tr_b16 v[64:65], v9 offset:4096
v_mfma_f32_16x16x32_bf16 v[152:155], v[104:107], v[84:87], v[152:155]
ds_read_b64_tr_b16 v[66:67], v9 offset:6144
v_mfma_f32_16x16x32_bf16 v[156:159], v[108:111], v[84:87], v[156:159]
ds_read_b64_tr_b16 v[68:69], v10 offset:4096
v_mfma_f32_16x16x32_bf16 v[128:131], v[112:115], v[88:91], v[128:131]
ds_read_b64_tr_b16 v[70:71], v10 offset:6144
v_mfma_f32_16x16x32_bf16 v[132:135], v[116:119], v[88:91], v[132:135]
ds_read_b128 v[44:47], v3 offset:8448
v_mfma_f32_16x16x32_bf16 v[136:139], v[120:123], v[88:91], v[136:139]
ds_read_b64_tr_b16 v[72:73], v11 offset:4096
v_mfma_f32_16x16x32_bf16 v[140:143], v[124:127], v[88:91], v[140:143]
ds_read_b64_tr_b16 v[74:75], v11 offset:6144
v_mfma_f32_16x16x32_bf16 v[144:147], v[112:115], v[92:95], v[144:147]
ds_read_b64_tr_b16 v[76:77], v12 offset:4096
v_mfma_f32_16x16x32_bf16 v[148:151], v[116:119], v[92:95], v[148:151]
ds_read_b64_tr_b16 v[78:79], v12 offset:6144
v_mfma_f32_16x16x32_bf16 v[152:155], v[120:123], v[92:95], v[152:155]
v_mfma_f32_16x16x32_bf16 v[156:159], v[124:127], v[92:95], v[156:159]
s_mov_b32 s41, 2
Lg2_17:
s_waitcnt lgkmcnt(0)
s_barrier
v_mfma_f32_16x16x32_bf16 v[128:131], v[48:51], v[32:35], v[128:131]
ds_read_b128 v[80:83], v3 offset:24576
ds_read_b64_tr_b16 v[96:97], v9 offset:24576
v_mfma_f32_16x16x32_bf16 v[132:135], v[52:55], v[32:35], v[132:135]
ds_read_b64_tr_b16 v[98:99], v9 offset:26624
ds_read_b64_tr_b16 v[100:101], v10 offset:24576
v_mfma_f32_16x16x32_bf16 v[136:139], v[56:59], v[32:35], v[136:139]
ds_read_b64_tr_b16 v[102:103], v10 offset:26624
ds_read_b128 v[84:87], v3 offset:24832
v_mfma_f32_16x16x32_bf16 v[140:143], v[60:63], v[32:35], v[140:143]
ds_read_b64_tr_b16 v[104:105], v11 offset:24576
ds_read_b64_tr_b16 v[106:107], v11 offset:26624
v_mfma_f32_16x16x32_bf16 v[144:147], v[48:51], v[36:39], v[144:147]
ds_read_b64_tr_b16 v[108:109], v12 offset:24576
ds_read_b64_tr_b16 v[110:111], v12 offset:26624
v_mfma_f32_16x16x32_bf16 v[148:151], v[52:55], v[36:39], v[148:151]
ds_read_b128 v[88:91], v3 offset:32768
ds_read_b64_tr_b16 v[112:113], v9 offset:28672
v_mfma_f32_16x16x32_bf16 v[152:155], v[56:59], v[36:39], v[152:155]
ds_read_b64_tr_b16 v[114:115], v9 offset:30720
v_mfma_f32_16x16x32_bf16 v[156:159], v[60:63], v[36:39], v[156:159]
ds_read_b64_tr_b16 v[116:117], v10 offset:28672
v_mfma_f32_16x16x32_bf16 v[128:131], v[64:67], v[40:43], v[128:131]
ds_read_b64_tr_b16 v[118:119], v10 offset:30720
v_mfma_f32_16x16x32_bf16 v[132:135], v[68:71], v[40:43], v[132:135]
ds_read_b128 v[92:95], v3 offset:33024
v_mfma_f32_16x16x32_bf16 v[136:139], v[72:75], v[40:43], v[136:139]
ds_read_b64_tr_b16 v[120:121], v11 offset:28672
v_mfma_f32_16x16x32_bf16 v[140:143], v[76:79], v[40:43], v[140:143]
ds_read_b64_tr_b16 v[122:123], v11 offset:30720
v_mfma_f32_16x16x32_bf16 v[144:147], v[64:67], v[44:47], v[144:147]
ds_read_b64_tr_b16 v[124:125], v12 offset:28672
v_mfma_f32_16x16x32_bf16 v[148:151], v[68:71], v[44:47], v[148:151]
ds_read_b64_tr_b16 v[126:127], v12 offset:30720
v_mfma_f32_16x16x32_bf16 v[152:155], v[72:75], v[44:47], v[152:155]
v_mfma_f32_16x16x32_bf16 v[156:159], v[76:79], v[44:47], v[156:159]
s_waitcnt lgkmcnt(0)
s_barrier
v_mfma_f32_16x16x32_bf16 v[128:131], v[96:99], v[80:83], v[128:131]
ds_read_b128 v[32:35], v4 offset:0
ds_read_b64_tr_b16 v[48:49], v13 offset:0
v_mfma_f32_16x16x32_bf16 v[132:135], v[100:103], v[80:83], v[132:135]
ds_read_b64_tr_b16 v[50:51], v13 offset:2048
ds_read_b64_tr_b16 v[52:53], v14 offset:0
v_mfma_f32_16x16x32_bf16 v[136:139], v[104:107], v[80:83], v[136:139]
ds_read_b64_tr_b16 v[54:55], v14 offset:2048
ds_read_b128 v[36:39], v4 offset:256
v_mfma_f32_16x16x32_bf16 v[140:143], v[108:111], v[80:83], v[140:143]
ds_read_b64_tr_b16 v[56:57], v15 offset:0
ds_read_b64_tr_b16 v[58:59], v15 offset:2048
v_mfma_f32_16x16x32_bf16 v[144:147], v[96:99], v[84:87], v[144:147]
ds_read_b64_tr_b16 v[60:61], v16 offset:0
ds_read_b64_tr_b16 v[62:63], v16 offset:2048
v_mfma_f32_16x16x32_bf16 v[148:151], v[100:103], v[84:87], v[148:151]
ds_read_b128 v[40:43], v4 offset:8192
ds_read_b64_tr_b16 v[64:65], v13 offset:4096
v_mfma_f32_16x16x32_bf16 v[152:155], v[104:107], v[84:87], v[152:155]
ds_read_b64_tr_b16 v[66:67], v13 offset:6144
v_mfma_f32_16x16x32_bf16 v[156:159], v[108:111], v[84:87], v[156:159]
ds_read_b64_tr_b16 v[68:69], v14 offset:4096
v_mfma_f32_16x16x32_bf16 v[128:131], v[112:115], v[88:91], v[128:131]
ds_read_b64_tr_b16 v[70:71], v14 offset:6144
v_mfma_f32_16x16x32_bf16 v[132:135], v[116:119], v[88:91], v[132:135]
ds_read_b128 v[44:47], v4 offset:8448
v_mfma_f32_16x16x32_bf16 v[136:139], v[120:123], v[88:91], v[136:139]
ds_read_b64_tr_b16 v[72:73], v15 offset:4096
v_mfma_f32_16x16x32_bf16 v[140:143], v[124:127], v[88:91], v[140:143]
ds_read_b64_tr_b16 v[74:75], v15 offset:6144
v_mfma_f32_16x16x32_bf16 v[144:147], v[112:115], v[92:95], v[144:147]
ds_read_b64_tr_b16 v[76:77], v16 offset:4096
v_mfma_f32_16x16x32_bf16 v[148:151], v[116:119], v[92:95], v[148:151]
ds_read_b64_tr_b16 v[78:79], v16 offset:6144
v_mfma_f32_16x16x32_bf16 v[152:155], v[120:123], v[92:95], v[152:155]
v_mfma_f32_16x16x32_bf16 v[156:159], v[124:127], v[92:95], v[156:159]
s_waitcnt lgkmcnt(0)
s_barrier
v_mfma_f32_16x16x32_bf16 v[128:131], v[48:51], v[32:35], v[128:131]
ds_read_b128 v[80:83], v4 offset:24576
ds_read_b64_tr_b16 v[96:97], v13 offset:24576
v_mfma_f32_16x16x32_bf16 v[132:135], v[52:55], v[32:35], v[132:135]
ds_read_b64_tr_b16 v[98:99], v13 offset:26624
ds_read_b64_tr_b16 v[100:101], v14 offset:24576
v_mfma_f32_16x16x32_bf16 v[136:139], v[56:59], v[32:35], v[136:139]
ds_read_b64_tr_b16 v[102:103], v14 offset:26624
ds_read_b128 v[84:87], v4 offset:24832
v_mfma_f32_16x16x32_bf16 v[140:143], v[60:63], v[32:35], v[140:143]
ds_read_b64_tr_b16 v[104:105], v15 offset:24576
ds_read_b64_tr_b16 v[106:107], v15 offset:26624
v_mfma_f32_16x16x32_bf16 v[144:147], v[48:51], v[36:39], v[144:147]
ds_read_b64_tr_b16 v[108:109], v16 offset:24576
ds_read_b64_tr_b16 v[110:111], v16 offset:26624
v_mfma_f32_16x16x32_bf16 v[148:151], v[52:55], v[36:39], v[148:151]
ds_read_b128 v[88:91], v4 offset:32768
ds_read_b64_tr_b16 v[112:113], v13 offset:28672
v_mfma_f32_16x16x32_bf16 v[152:155], v[56:59], v[36:39], v[152:155]
ds_read_b64_tr_b16 v[114:115], v13 offset:30720
v_mfma_f32_16x16x32_bf16 v[156:159], v[60:63], v[36:39], v[156:159]
ds_read_b64_tr_b16 v[116:117], v14 offset:28672
v_mfma_f32_16x16x32_bf16 v[128:131], v[64:67], v[40:43], v[128:131]
ds_read_b64_tr_b16 v[118:119], v14 offset:30720
v_mfma_f32_16x16x32_bf16 v[132:135], v[68:71], v[40:43], v[132:135]
ds_read_b128 v[92:95], v4 offset:33024
v_mfma_f32_16x16x32_bf16 v[136:139], v[72:75], v[40:43], v[136:139]
ds_read_b64_tr_b16 v[120:121], v15 offset:28672
v_mfma_f32_16x16x32_bf16 v[140:143], v[76:79], v[40:43], v[140:143]
ds_read_b64_tr_b16 v[122:123], v15 offset:30720
v_mfma_f32_16x16x32_bf16 v[144:147], v[64:67], v[44:47], v[144:147]
ds_read_b64_tr_b16 v[124:125], v16 offset:28672
v_mfma_f32_16x16x32_bf16 v[148:151], v[68:71], v[44:47], v[148:151]
ds_read_b64_tr_b16 v[126:127], v16 offset:30720
v_mfma_f32_16x16x32_bf16 v[152:155], v[72:75], v[44:47], v[152:155]
v_mfma_f32_16x16x32_bf16 v[156:159], v[76:79], v[44:47], v[156:159]
s_waitcnt lgkmcnt(0)
s_barrier
v_mfma_f32_16x16x32_bf16 v[128:131], v[96:99], v[80:83], v[128:131]
ds_read_b128 v[32:35], v2 offset:0
ds_read_b64_tr_b16 v[48:49], v5 offset:0
v_mfma_f32_16x16x32_bf16 v[132:135], v[100:103], v[80:83], v[132:135]
ds_read_b64_tr_b16 v[50:51], v5 offset:2048
ds_read_b64_tr_b16 v[52:53], v6 offset:0
v_mfma_f32_16x16x32_bf16 v[136:139], v[104:107], v[80:83], v[136:139]
ds_read_b64_tr_b16 v[54:55], v6 offset:2048
ds_read_b128 v[36:39], v2 offset:256
v_mfma_f32_16x16x32_bf16 v[140:143], v[108:111], v[80:83], v[140:143]
ds_read_b64_tr_b16 v[56:57], v7 offset:0
ds_read_b64_tr_b16 v[58:59], v7 offset:2048
v_mfma_f32_16x16x32_bf16 v[144:147], v[96:99], v[84:87], v[144:147]
ds_read_b64_tr_b16 v[60:61], v8 offset:0
ds_read_b64_tr_b16 v[62:63], v8 offset:2048
v_mfma_f32_16x16x32_bf16 v[148:151], v[100:103], v[84:87], v[148:151]
ds_read_b128 v[40:43], v2 offset:8192
ds_read_b64_tr_b16 v[64:65], v5 offset:4096
v_mfma_f32_16x16x32_bf16 v[152:155], v[104:107], v[84:87], v[152:155]
ds_read_b64_tr_b16 v[66:67], v5 offset:6144
v_mfma_f32_16x16x32_bf16 v[156:159], v[108:111], v[84:87], v[156:159]
ds_read_b64_tr_b16 v[68:69], v6 offset:4096
v_mfma_f32_16x16x32_bf16 v[128:131], v[112:115], v[88:91], v[128:131]
ds_read_b64_tr_b16 v[70:71], v6 offset:6144
v_mfma_f32_16x16x32_bf16 v[132:135], v[116:119], v[88:91], v[132:135]
ds_read_b128 v[44:47], v2 offset:8448
v_mfma_f32_16x16x32_bf16 v[136:139], v[120:123], v[88:91], v[136:139]
ds_read_b64_tr_b16 v[72:73], v7 offset:4096
v_mfma_f32_16x16x32_bf16 v[140:143], v[124:127], v[88:91], v[140:143]
ds_read_b64_tr_b16 v[74:75], v7 offset:6144
v_mfma_f32_16x16x32_bf16 v[144:147], v[112:115], v[92:95], v[144:147]
ds_read_b64_tr_b16 v[76:77], v8 offset:4096
v_mfma_f32_16x16x32_bf16 v[148:151], v[116:119], v[92:95], v[148:151]
ds_read_b64_tr_b16 v[78:79], v8 offset:6144
v_mfma_f32_16x16x32_bf16 v[152:155], v[120:123], v[92:95], v[152:155]
v_mfma_f32_16x16x32_bf16 v[156:159], v[124:127], v[92:95], v[156:159]
s_waitcnt lgkmcnt(0)
s_barrier
v_mfma_f32_16x16x32_bf16 v[128:131], v[48:51], v[32:35], v[128:131]
ds_read_b128 v[80:83], v2 offset:24576
ds_read_b64_tr_b16 v[96:97], v5 offset:24576
v_mfma_f32_16x16x32_bf16 v[132:135], v[52:55], v[32:35], v[132:135]
ds_read_b64_tr_b16 v[98:99], v5 offset:26624
ds_read_b64_tr_b16 v[100:101], v6 offset:24576
v_mfma_f32_16x16x32_bf16 v[136:139], v[56:59], v[32:35], v[136:139]
ds_read_b64_tr_b16 v[102:103], v6 offset:26624
ds_read_b128 v[84:87], v2 offset:24832
v_mfma_f32_16x16x32_bf16 v[140:143], v[60:63], v[32:35], v[140:143]
ds_read_b64_tr_b16 v[104:105], v7 offset:24576
ds_read_b64_tr_b16 v[106:107], v7 offset:26624
v_mfma_f32_16x16x32_bf16 v[144:147], v[48:51], v[36:39], v[144:147]
ds_read_b64_tr_b16 v[108:109], v8 offset:24576
ds_read_b64_tr_b16 v[110:111], v8 offset:26624
v_mfma_f32_16x16x32_bf16 v[148:151], v[52:55], v[36:39], v[148:151]
ds_read_b128 v[88:91], v2 offset:32768
ds_read_b64_tr_b16 v[112:113], v5 offset:28672
v_mfma_f32_16x16x32_bf16 v[152:155], v[56:59], v[36:39], v[152:155]
ds_read_b64_tr_b16 v[114:115], v5 offset:30720
v_mfma_f32_16x16x32_bf16 v[156:159], v[60:63], v[36:39], v[156:159]
ds_read_b64_tr_b16 v[116:117], v6 offset:28672
v_mfma_f32_16x16x32_bf16 v[128:131], v[64:67], v[40:43], v[128:131]
ds_read_b64_tr_b16 v[118:119], v6 offset:30720
v_mfma_f32_16x16x32_bf16 v[132:135], v[68:71], v[40:43], v[132:135]
ds_read_b128 v[92:95], v2 offset:33024
v_mfma_f32_16x16x32_bf16 v[136:139], v[72:75], v[40:43], v[136:139]
ds_read_b64_tr_b16 v[120:121], v7 offset:28672
v_mfma_f32_16x16x32_bf16 v[140:143], v[76:79], v[40:43], v[140:143]
ds_read_b64_tr_b16 v[122:123], v7 offset:30720
v_mfma_f32_16x16x32_bf16 v[144:147], v[64:67], v[44:47], v[144:147]
ds_read_b64_tr_b16 v[124:125], v8 offset:28672
v_mfma_f32_16x16x32_bf16 v[148:151], v[68:71], v[44:47], v[148:151]
ds_read_b64_tr_b16 v[126:127], v8 offset:30720
v_mfma_f32_16x16x32_bf16 v[152:155], v[72:75], v[44:47], v[152:155]
v_mfma_f32_16x16x32_bf16 v[156:159], v[76:79], v[44:47], v[156:159]
s_waitcnt lgkmcnt(0)
s_barrier
v_mfma_f32_16x16x32_bf16 v[128:131], v[96:99], v[80:83], v[128:131]
ds_read_b128 v[32:35], v3 offset:0
ds_read_b64_tr_b16 v[48:49], v9 offset:0
v_mfma_f32_16x16x32_bf16 v[132:135], v[100:103], v[80:83], v[132:135]
ds_read_b64_tr_b16 v[50:51], v9 offset:2048
ds_read_b64_tr_b16 v[52:53], v10 offset:0
v_mfma_f32_16x16x32_bf16 v[136:139], v[104:107], v[80:83], v[136:139]
ds_read_b64_tr_b16 v[54:55], v10 offset:2048
ds_read_b128 v[36:39], v3 offset:256
v_mfma_f32_16x16x32_bf16 v[140:143], v[108:111], v[80:83], v[140:143]
ds_read_b64_tr_b16 v[56:57], v11 offset:0
ds_read_b64_tr_b16 v[58:59], v11 offset:2048
v_mfma_f32_16x16x32_bf16 v[144:147], v[96:99], v[84:87], v[144:147]
ds_read_b64_tr_b16 v[60:61], v12 offset:0
ds_read_b64_tr_b16 v[62:63], v12 offset:2048
v_mfma_f32_16x16x32_bf16 v[148:151], v[100:103], v[84:87], v[148:151]
ds_read_b128 v[40:43], v3 offset:8192
ds_read_b64_tr_b16 v[64:65], v9 offset:4096
v_mfma_f32_16x16x32_bf16 v[152:155], v[104:107], v[84:87], v[152:155]
ds_read_b64_tr_b16 v[66:67], v9 offset:6144
v_mfma_f32_16x16x32_bf16 v[156:159], v[108:111], v[84:87], v[156:159]
ds_read_b64_tr_b16 v[68:69], v10 offset:4096
v_mfma_f32_16x16x32_bf16 v[128:131], v[112:115], v[88:91], v[128:131]
ds_read_b64_tr_b16 v[70:71], v10 offset:6144
v_mfma_f32_16x16x32_bf16 v[132:135], v[116:119], v[88:91], v[132:135]
ds_read_b128 v[44:47], v3 offset:8448
v_mfma_f32_16x16x32_bf16 v[136:139], v[120:123], v[88:91], v[136:139]
ds_read_b64_tr_b16 v[72:73], v11 offset:4096
v_mfma_f32_16x16x32_bf16 v[140:143], v[124:127], v[88:91], v[140:143]
ds_read_b64_tr_b16 v[74:75], v11 offset:6144
v_mfma_f32_16x16x32_bf16 v[144:147], v[112:115], v[92:95], v[144:147]
ds_read_b64_tr_b16 v[76:77], v12 offset:4096
v_mfma_f32_16x16x32_bf16 v[148:151], v[116:119], v[92:95], v[148:151]
ds_read_b64_tr_b16 v[78:79], v12 offset:6144
v_mfma_f32_16x16x32_bf16 v[152:155], v[120:123], v[92:95], v[152:155]
v_mfma_f32_16x16x32_bf16 v[156:159], v[124:127], v[92:95], v[156:159]
s_sub_u32 s41, s41, 1
s_cmp_lg_u32 s41, 0
s_cbranch_scc1 Lg2_17
s_waitcnt lgkmcnt(0)
s_barrier
v_mfma_f32_16x16x32_bf16 v[128:131], v[48:51], v[32:35], v[128:131]
ds_read_b128 v[80:83], v3 offset:24576
ds_read_b64_tr_b16 v[96:97], v9 offset:24576
v_mfma_f32_16x16x32_bf16 v[132:135], v[52:55], v[32:35], v[132:135]
ds_read_b64_tr_b16 v[98:99], v9 offset:26624
ds_read_b64_tr_b16 v[100:101], v10 offset:24576
v_mfma_f32_16x16x32_bf16 v[136:139], v[56:59], v[32:35], v[136:139]
ds_read_b64_tr_b16 v[102:103], v10 offset:26624
ds_read_b128 v[84:87], v3 offset:24832
v_mfma_f32_16x16x32_bf16 v[140:143], v[60:63], v[32:35], v[140:143]
ds_read_b64_tr_b16 v[104:105], v11 offset:24576
ds_read_b64_tr_b16 v[106:107], v11 offset:26624
v_mfma_f32_16x16x32_bf16 v[144:147], v[48:51], v[36:39], v[144:147]
ds_read_b64_tr_b16 v[108:109], v12 offset:24576
ds_read_b64_tr_b16 v[110:111], v12 offset:26624
v_mfma_f32_16x16x32_bf16 v[148:151], v[52:55], v[36:39], v[148:151]
ds_read_b128 v[88:91], v3 offset:32768
ds_read_b64_tr_b16 v[112:113], v9 offset:28672
v_mfma_f32_16x16x32_bf16 v[152:155], v[56:59], v[36:39], v[152:155]
ds_read_b64_tr_b16 v[114:115], v9 offset:30720
v_mfma_f32_16x16x32_bf16 v[156:159], v[60:63], v[36:39], v[156:159]
ds_read_b64_tr_b16 v[116:117], v10 offset:28672
v_mfma_f32_16x16x32_bf16 v[128:131], v[64:67], v[40:43], v[128:131]
ds_read_b64_tr_b16 v[118:119], v10 offset:30720
v_mfma_f32_16x16x32_bf16 v[132:135], v[68:71], v[40:43], v[132:135]
ds_read_b128 v[92:95], v3 offset:33024
v_mfma_f32_16x16x32_bf16 v[136:139], v[72:75], v[40:43], v[136:139]
ds_read_b64_tr_b16 v[120:121], v11 offset:28672
v_mfma_f32_16x16x32_bf16 v[140:143], v[76:79], v[40:43], v[140:143]
ds_read_b64_tr_b16 v[122:123], v11 offset:30720
v_mfma_f32_16x16x32_bf16 v[144:147], v[64:67], v[44:47], v[144:147]
ds_read_b64_tr_b16 v[124:125], v12 offset:28672
v_mfma_f32_16x16x32_bf16 v[148:151], v[68:71], v[44:47], v[148:151]
ds_read_b64_tr_b16 v[126:127], v12 offset:30720
v_mfma_f32_16x16x32_bf16 v[152:155], v[72:75], v[44:47], v[152:155]
v_mfma_f32_16x16x32_bf16 v[156:159], v[76:79], v[44:47], v[156:159]
s_waitcnt lgkmcnt(0)
s_barrier
v_mfma_f32_16x16x32_bf16 v[128:131], v[96:99], v[80:83], v[128:131]
v_mfma_f32_16x16x32_bf16 v[132:135], v[100:103], v[80:83], v[132:135]
v_mfma_f32_16x16x32_bf16 v[136:139], v[104:107], v[80:83], v[136:139]
v_mfma_f32_16x16x32_bf16 v[140:143], v[108:111], v[80:83], v[140:143]
v_mfma_f32_16x16x32_bf16 v[144:147], v[96:99], v[84:87], v[144:147]
v_mfma_f32_16x16x32_bf16 v[148:151], v[100:103], v[84:87], v[148:151]
v_mfma_f32_16x16x32_bf16 v[152:155], v[104:107], v[84:87], v[152:155]
v_mfma_f32_16x16x32_bf16 v[156:159], v[108:111], v[84:87], v[156:159]
v_mfma_f32_16x16x32_bf16 v[128:131], v[112:115], v[88:91], v[128:131]
v_mfma_f32_16x16x32_bf16 v[132:135], v[116:119], v[88:91], v[132:135]
v_mfma_f32_16x16x32_bf16 v[136:139], v[120:123], v[88:91], v[136:139]
v_mfma_f32_16x16x32_bf16 v[140:143], v[124:127], v[88:91], v[140:143]
v_mfma_f32_16x16x32_bf16 v[144:147], v[112:115], v[92:95], v[144:147]
v_mfma_f32_16x16x32_bf16 v[148:151], v[116:119], v[92:95], v[148:151]
v_mfma_f32_16x16x32_bf16 v[152:155], v[120:123], v[92:95], v[152:155]
v_mfma_f32_16x16x32_bf16 v[156:159], v[124:127], v[92:95], v[156:159]
s_nop 4
v_cvt_pk_bf16_f32 v96, v128, v129
v_cvt_pk_bf16_f32 v97, v130, v131
v_cvt_pk_bf16_f32 v98, v132, v133
v_cvt_pk_bf16_f32 v99, v134, v135
buffer_store_dwordx4 v[96:99], v2, s[20:23], 0 offen offset:0 sc1
v_cvt_pk_bf16_f32 v100, v136, v137
v_cvt_pk_bf16_f32 v101, v138, v139
v_cvt_pk_bf16_f32 v102, v140, v141
v_cvt_pk_bf16_f32 v103, v142, v143
buffer_store_dwordx4 v[100:103], v2, s[20:23], s50 offen offset:0 sc1
v_cvt_pk_bf16_f32 v104, v144, v145
v_cvt_pk_bf16_f32 v105, v146, v147
v_cvt_pk_bf16_f32 v106, v148, v149
v_cvt_pk_bf16_f32 v107, v150, v151
buffer_store_dwordx4 v[104:107], v2, s[20:23], 0 offen offset:256 sc1
v_cvt_pk_bf16_f32 v108, v152, v153
v_cvt_pk_bf16_f32 v109, v154, v155
v_cvt_pk_bf16_f32 v110, v156, v157
v_cvt_pk_bf16_f32 v111, v158, v159
buffer_store_dwordx4 v[108:111], v2, s[20:23], s50 offen offset:256 sc1
v_dot2_f32_bf16 v112, v96, s52, 0
v_dot2_f32_bf16 v113, v96, v96, 0
v_dot2_f32_bf16 v114, v104, s52, 0
v_dot2_f32_bf16 v115, v104, v104, 0
v_dot2_f32_bf16 v112, v97, s52, v112
v_dot2_f32_bf16 v113, v97, v97, v113
v_dot2_f32_bf16 v114, v105, s52, v114
v_dot2_f32_bf16 v115, v105, v105, v115
v_dot2_f32_bf16 v112, v98, s52, v112
v_dot2_f32_bf16 v113, v98, v98, v113
v_dot2_f32_bf16 v114, v106, s52, v114
v_dot2_f32_bf16 v115, v106, v106, v115
v_dot2_f32_bf16 v112, v99, s52, v112
v_dot2_f32_bf16 v113, v99, v99, v113
v_dot2_f32_bf16 v114, v107, s52, v114
v_dot2_f32_bf16 v115, v107, v107, v115
v_dot2_f32_bf16 v112, v100, s52, v112
v_dot2_f32_bf16 v113, v100, v100, v113
v_dot2_f32_bf16 v114, v108, s52, v114
v_dot2_f32_bf16 v115, v108, v108, v115
v_dot2_f32_bf16 v112, v101, s52, v112
v_dot2_f32_bf16 v113, v101, v101, v113
v_dot2_f32_bf16 v114, v109, s52, v114
v_dot2_f32_bf16 v115, v109, v109, v115
v_dot2_f32_bf16 v112, v102, s52, v112
v_dot2_f32_bf16 v113, v102, v102, v113
v_dot2_f32_bf16 v114, v110, s52, v114
v_dot2_f32_bf16 v115, v110, v110, v115
v_dot2_f32_bf16 v112, v103, s52, v112
v_dot2_f32_bf16 v113, v103, v103, v113
v_dot2_f32_bf16 v114, v111, s52, v114
v_dot2_f32_bf16 v115, v111, v111, v115
s_nop 2
v_permlane32_swap_b32 v112, v114
v_permlane32_swap_b32 v113, v115
v_add_f32 v112, v112, v114
v_add_f32 v113, v113, v115
s_nop 1
v_permlane16_swap_b32 v112, v113
v_add_f32 v112, v112, v113
buffer_store_dword v112, v22, s[24:27], 0 offen sc1
s_waitcnt vmcnt(0)
s_barrier
s_cmp_lg_u32 s36, 0
s_cbranch_scc1 Lsig_18
s_add_u32 s43, s34, 16
s_lshl_b32 s43, s43, 7
v_mov_b32 v19, s43
v_mov_b32 v20, 1
s_mov_b64 exec, 1
buffer_atomic_add v20, v19, s[56:59], 0 offen sc1
s_mov_b64 exec, -1
Lsig_18:
s_lshl_b32 s53, s47, 2
v_lshlrev_b32 v19, 11, v18
v_lshl_add_u32 v19, v17, 4, v19
s_lshl_b32 s43, s46, 10
v_add_u32 v2, s43, v19
v_add_u32 v3, 49152, v2
v_add_u32 v4, 98304, v2
v_lshrrev_b32 v19, 2, v17
v_lshl_add_u32 v20, v18, 2, v19
v_and_b32 v21, 7, v20
v_lshlrev_b32 v20, 8, v20
v_and_b32 v19, 3, v1
v_lshl_add_u32 v20, v19, 3, v20
s_add_u32 s43, s53, 0
v_xor_b32 v19, s43, v21
v_lshl_add_u32 v5, v19, 5, v20
s_add_u32 s43, s53, 1
v_xor_b32 v19, s43, v21
v_lshl_add_u32 v6, v19, 5, v20
s_add_u32 s43, s53, 2
v_xor_b32 v19, s43, v21
v_lshl_add_u32 v7, v19, 5, v20
s_add_u32 s43, s53, 3
v_xor_b32 v19, s43, v21
v_lshl_add_u32 v8, v19, 5, v20
v_add_u32 v9, 49152, v5
v_add_u32 v10, 49152, v6
v_add_u32 v11, 49152, v7
v_add_u32 v12, 49152, v8
v_add_u32 v13, 98304, v5
v_add_u32 v14, 98304, v6
v_add_u32 v15, 98304, v7
v_add_u32 v16, 98304, v8
v_mov_b32 v128, 0
v_mov_b32 v129, 0
v_mov_b32 v130, 0
v_mov_b32 v131, 0
v_mov_b32 v132, 0
v_mov_b32 v133, 0
v_mov_b32 v134, 0
v_mov_b32 v135, 0
v_mov_b32 v136, 0
v_mov_b32 v137, 0
v_mov_b32 v138, 0
v_mov_b32 v139, 0
v_mov_b32 v140, 0
v_mov_b32 v141, 0
v_mov_b32 v142, 0
v_mov_b32 v143, 0
v_mov_b32 v144, 0
v_mov_b32 v145, 0
v_mov_b32 v146, 0
v_mov_b32 v147, 0
v_mov_b32 v148, 0
v_mov_b32 v149, 0
v_mov_b32 v150, 0
v_mov_b32 v151, 0
v_mov_b32 v152, 0
v_mov_b32 v153, 0
v_mov_b32 v154, 0
v_mov_b32 v155, 0
v_mov_b32 v156, 0
v_mov_b32 v157, 0
v_mov_b32 v158, 0
v_mov_b32 v159, 0
v_mov_b32 v160, 0
v_mov_b32 v161, 0
v_mov_b32 v162, 0
v_mov_b32 v163, 0
v_mov_b32 v164, 0
v_mov_b32 v165, 0
v_mov_b32 v166, 0
v_mov_b32 v167, 0
v_mov_b32 v168, 0
v_mov_b32 v169, 0
v_mov_b32 v170, 0
v_mov_b32 v171, 0
v_mov_b32 v172, 0
v_mov_b32 v173, 0
v_mov_b32 v174, 0
v_mov_b32 v175, 0
v_mov_b32 v176, 0
v_mov_b32 v177, 0
v_mov_b32 v178, 0
v_mov_b32 v179, 0
v_mov_b32 v180, 0
v_mov_b32 v181, 0
v_mov_b32 v182, 0
v_mov_b32 v183, 0
v_mov_b32 v184, 0
v_mov_b32 v185, 0
v_mov_b32 v186, 0
v_mov_b32 v187, 0
v_mov_b32 v188, 0
v_mov_b32 v189, 0
v_mov_b32 v190, 0
v_mov_b32 v191, 0
v_mov_b32 v192, 0
v_mov_b32 v193, 0
v_mov_b32 v194, 0
v_mov_b32 v195, 0
v_mov_b32 v196, 0
v_mov_b32 v197, 0
v_mov_b32 v198, 0
v_mov_b32 v199, 0
v_mov_b32 v200, 0
v_mov_b32 v201, 0
v_mov_b32 v202, 0
v_mov_b32 v203, 0
v_mov_b32 v204, 0
v_mov_b32 v205, 0
v_mov_b32 v206, 0
v_mov_b32 v207, 0
v_mov_b32 v208, 0
v_mov_b32 v209, 0
v_mov_b32 v210, 0
v_mov_b32 v211, 0
v_mov_b32 v212, 0
v_mov_b32 v213, 0
v_mov_b32 v214, 0
v_mov_b32 v215, 0
v_mov_b32 v216, 0
v_mov_b32 v217, 0
v_mov_b32 v218, 0
v_mov_b32 v219, 0
v_mov_b32 v220, 0
v_mov_b32 v221, 0
v_mov_b32 v222, 0
v_mov_b32 v223, 0
v_mov_b32 v224, 0
v_mov_b32 v225, 0
v_mov_b32 v226, 0
v_mov_b32 v227, 0
v_mov_b32 v228, 0
v_mov_b32 v229, 0
v_mov_b32 v230, 0
v_mov_b32 v231, 0
v_mov_b32 v232, 0
v_mov_b32 v233, 0
v_mov_b32 v234, 0
v_mov_b32 v235, 0
v_mov_b32 v236, 0
v_mov_b32 v237, 0
v_mov_b32 v238, 0
v_mov_b32 v239, 0
v_mov_b32 v240, 0
v_mov_b32 v241, 0
v_mov_b32 v242, 0
v_mov_b32 v243, 0
v_mov_b32 v244, 0
v_mov_b32 v245, 0
v_mov_b32 v246, 0
v_mov_b32 v247, 0
v_mov_b32 v248, 0
v_mov_b32 v249, 0
v_mov_b32 v250, 0
v_mov_b32 v251, 0
v_mov_b32 v252, 0
v_mov_b32 v253, 0
v_mov_b32 v254, 0
v_mov_b32 v255, 0
s_mul_i32 s43, s35, 192
s_and_b32 s43, s43, 0xffffff80
s_add_u32 s43, s43, 4096
s_cmp_eq_u32 s51, 1
s_cselect_b32 s8, s4, s6
s_cselect_b32 s9, s5, s7
s_sub_u32 s10, 7340032, s43
s_lshl_b32 s44, s34, 18
s_add_u32 s44, s44, 4194304
s_movk_i32 s38, 28672
s_cmp_eq_u32 s51, 0
s_cselect_b32 s8, s32, s8
s_cselect_b32 s9, s33, s9
s_cselect_b32 s10, 262144, s10
s_cselect_b32 s43, s44, s43
s_cselect_b32 s38, 1024, s38
s_cselect_b32 s45, 0, -1
s_add_u32 s8, s8, s43
s_addc_u32 s9, s9, 0
s_mov_b32 s11, 0x20000
s_sub_u32 s37, 0, s38
s_lshl_b32 s39, s51, 14
v_lshrrev_b32 v19, 4, v1
v_lshlrev_b32 v20, 5, v19
v_mul_u32_u24 v19, 6912, v19
v_and_b32 v19, s45, v19
v_and_b32 v20, s45, v20
v_lshlrev_b32 v21, 4, v1
v_xor_b32 v21, v21, v20
v_add_u32 v22, v21, v19
s_and_b32 s45, s45, 128
v_xor_b32 v23, s45, v22
s_mul_i32 s43, s38, 32
s_add_u32 s37, s37, s43
s_mul_i32 s43, s34, 917504
s_mul_i32 s44, s35, 16384
s_add_u32 s43, s43, s44
s_add_u32 s43, s43, 8388608
s_add_u32 s24, s32, s43
s_addc_u32 s25, s33, 0
s_mov_b32 s26, 278528
s_mov_b32 s27, 0x20000
s_mov_b32 s53, 262144
s_lshl_b32 s43, s47, 13
s_lshl_b32 s44, s46, 10
s_add_u32 s43, s43, s44
v_lshlrev_b32 v19, 11, v18
v_lshl_add_u32 v19, v17, 4, v19
v_add_u32 v27, s43, v19
s_lshl_b32 s43, s34, 18
s_lshl_b32 s44, s35, 7
s_add_u32 s43, s43, s44
s_add_u32 s16, s62, s43
s_addc_u32 s17, s63, 0
s_mov_b32 s18, 260224
s_mov_b32 s19, 0x20000
s_lshl_b32 s43, s36, 5
v_lshl_add_u32 v19, v17, 1, s43
v_lshlrev_b32 v19, 11, v19
v_and_b32 v20, 1, v18
v_lshl_add_u32 v19, v20, 5, v19
v_lshrrev_b32 v20, 1, v18
v_lshl_add_u32 v28, v20, 4, v19
s_lshl_b32 s43, s34, 18
s_add_u32 s12, s32, s43
s_addc_u32 s13, s33, 0
s_add_u32 s12, s12, 4194304
s_addc_u32 s13, s13, 0
s_mov_b32 s14, 262144
s_mov_b32 s15, 0x20000
v_lshlrev_b32 v21, 4, v1
s_lshl_b32 s54, s36, 11
s_barrier
s_add_u32 m0, s54, 98304
s_add_u32 s43, s54, 0
buffer_load_dwordx4 v21, s[12:15], s43 offen sc1 lds
s_add_u32 m0, s54, 99328
s_add_u32 s43, s54, 1024
buffer_load_dwordx4 v21, s[12:15], s43 offen sc1 lds
s_add_u32 m0, s54, 0
s_add_u32 s43, s54, 16384
buffer_load_dwordx4 v21, s[12:15], s43 offen sc1 lds
s_add_u32 m0, s54, 1024
s_add_u32 s43, s54, 17408
buffer_load_dwordx4 v21, s[12:15], s43 offen sc1 lds
s_add_u32 m0, s54, 49152
s_add_u32 s43, s54, 32768
buffer_load_dwordx4 v21, s[12:15], s43 offen sc1 lds
s_add_u32 m0, s54, 50176
s_add_u32 s43, s54, 33792
buffer_load_dwordx4 v21, s[12:15], s43 offen sc1 lds
s_waitcnt vmcnt(4)
s_barrier
s_setprio 1
ds_read_b128 v[32:35], v4 offset:0
ds_read_b64_tr_b16 v[48:49], v13 offset:16384
ds_read_b64_tr_b16 v[50:51], v13 offset:20480
ds_read_b128 v[36:39], v4 offset:256
ds_read_b128 v[40:43], v4 offset:512
ds_read_b128 v[44:47], v4 offset:768
ds_read_b64_tr_b16 v[64:65], v13 offset:32768
ds_read_b64_tr_b16 v[66:67], v13 offset:36864
ds_read_b64_tr_b16 v[52:53], v14 offset:16384
ds_read_b64_tr_b16 v[54:55], v14 offset:20480
ds_read_b64_tr_b16 v[68:69], v14 offset:32768
ds_read_b64_tr_b16 v[70:71], v14 offset:36864
ds_read_b64_tr_b16 v[56:57], v15 offset:16384
ds_read_b64_tr_b16 v[58:59], v15 offset:20480
ds_read_b64_tr_b16 v[72:73], v15 offset:32768
ds_read_b64_tr_b16 v[74:75], v15 offset:36864
ds_read_b64_tr_b16 v[60:61], v16 offset:16384
ds_read_b64_tr_b16 v[62:63], v16 offset:20480
ds_read_b64_tr_b16 v[76:77], v16 offset:32768
ds_read_b64_tr_b16 v[78:79], v16 offset:36864
s_mov_b32 s41, 5
Lk3_19:
s_waitcnt lgkmcnt(0)
v_mfma_f32_16x16x32_bf16 v[128:131], v[48:51], v[32:35], v[128:131]
ds_read_b128 v[80:83], v4 offset:8192
v_mfma_f32_16x16x32_bf16 v[132:135], v[48:51], v[36:39], v[132:135]
ds_read_b64_tr_b16 v[96:97], v13 offset:24576
v_mfma_f32_16x16x32_bf16 v[136:139], v[48:51], v[40:43], v[136:139]
ds_read_b64_tr_b16 v[98:99], v13 offset:28672
v_mfma_f32_16x16x32_bf16 v[140:143], v[48:51], v[44:47], v[140:143]
ds_read_b128 v[84:87], v4 offset:8448
v_mfma_f32_16x16x32_bf16 v[192:195], v[64:67], v[32:35], v[192:195]
ds_read_b128 v[88:91], v4 offset:8704
v_mfma_f32_16x16x32_bf16 v[196:199], v[64:67], v[36:39], v[196:199]
ds_read_b128 v[92:95], v4 offset:8960
v_mfma_f32_16x16x32_bf16 v[200:203], v[64:67], v[40:43], v[200:203]
ds_read_b64_tr_b16 v[112:113], v13 offset:40960
v_mfma_f32_16x16x32_bf16 v[204:207], v[64:67], v[44:47], v[204:207]
ds_read_b64_tr_b16 v[114:115], v13 offset:45056
v_mfma_f32_16x16x32_bf16 v[144:147], v[52:55], v[32:35], v[144:147]
ds_read_b64_tr_b16 v[100:101], v14 offset:24576
v_mfma_f32_16x16x32_bf16 v[148:151], v[52:55], v[36:39], v[148:151]
ds_read_b64_tr_b16 v[102:103], v14 offset:28672
v_mfma_f32_16x16x32_bf16 v[152:155], v[52:55], v[40:43], v[152:155]
ds_read_b64_tr_b16 v[116:117], v14 offset:40960
v_mfma_f32_16x16x32_bf16 v[156:159], v[52:55], v[44:47], v[156:159]
ds_read_b64_tr_b16 v[118:119], v14 offset:45056
v_mfma_f32_16x16x32_bf16 v[208:211], v[68:71], v[32:35], v[208:211]
ds_read_b64_tr_b16 v[104:105], v15 offset:24576
v_mfma_f32_16x16x32_bf16 v[212:215], v[68:71], v[36:39], v[212:215]
ds_read_b64_tr_b16 v[106:107], v15 offset:28672
v_mfma_f32_16x16x32_bf16 v[216:219], v[68:71], v[40:43], v[216:219]
ds_read_b64_tr_b16 v[120:121], v15 offset:40960
v_mfma_f32_16x16x32_bf16 v[220:223], v[68:71], v[44:47], v[220:223]
ds_read_b64_tr_b16 v[122:123], v15 offset:45056
v_mfma_f32_16x16x32_bf16 v[160:163], v[56:59], v[32:35], v[160:163]
ds_read_b64_tr_b16 v[108:109], v16 offset:24576
v_mfma_f32_16x16x32_bf16 v[164:167], v[56:59], v[36:39], v[164:167]
ds_read_b64_tr_b16 v[110:111], v16 offset:28672
v_mfma_f32_16x16x32_bf16 v[168:171], v[56:59], v[40:43], v[168:171]
ds_read_b64_tr_b16 v[124:125], v16 offset:40960
v_mfma_f32_16x16x32_bf16 v[172:175], v[56:59], v[44:47], v[172:175]
ds_read_b64_tr_b16 v[126:127], v16 offset:45056
v_mfma_f32_16x16x32_bf16 v[224:227], v[72:75], v[32:35], v[224:227]
v_mfma_f32_16x16x32_bf16 v[228:231], v[72:75], v[36:39], v[228:231]
v_mfma_f32_16x16x32_bf16 v[232:235], v[72:75], v[40:43], v[232:235]
v_mfma_f32_16x16x32_bf16 v[236:239], v[72:75], v[44:47], v[236:239]
v_mfma_f32_16x16x32_bf16 v[176:179], v[60:63], v[32:35], v[176:179]
v_mfma_f32_16x16x32_bf16 v[180:183], v[60:63], v[36:39], v[180:183]
v_mfma_f32_16x16x32_bf16 v[184:187], v[60:63], v[40:43], v[184:187]
v_mfma_f32_16x16x32_bf16 v[188:191], v[60:63], v[44:47], v[188:191]
v_mfma_f32_16x16x32_bf16 v[240:243], v[76:79], v[32:35], v[240:243]
v_mfma_f32_16x16x32_bf16 v[244:247], v[76:79], v[36:39], v[244:247]
v_mfma_f32_16x16x32_bf16 v[248:251], v[76:79], v[40:43], v[248:251]
v_mfma_f32_16x16x32_bf16 v[252:255], v[76:79], v[44:47], v[252:255]
s_waitcnt vmcnt(2) lgkmcnt(0)
s_barrier
v_mfma_f32_16x16x32_bf16 v[128:131], v[96:99], v[80:83], v[128:131]
ds_read_b128 v[32:35], v2 offset:0
v_mfma_f32_16x16x32_bf16 v[132:135], v[96:99], v[84:87], v[132:135]
ds_read_b64_tr_b16 v[48:49], v5 offset:16384
v_mfma_f32_16x16x32_bf16 v[136:139], v[96:99], v[88:91], v[136:139]
ds_read_b64_tr_b16 v[50:51], v5 offset:20480
v_mfma_f32_16x16x32_bf16 v[140:143], v[96:99], v[92:95], v[140:143]
ds_read_b128 v[36:39], v2 offset:256
v_mfma_f32_16x16x32_bf16 v[192:195], v[112:115], v[80:83], v[192:195]
ds_read_b128 v[40:43], v2 offset:512
v_mfma_f32_16x16x32_bf16 v[196:199], v[112:115], v[84:87], v[196:199]
ds_read_b128 v[44:47], v2 offset:768
v_mfma_f32_16x16x32_bf16 v[200:203], v[112:115], v[88:91], v[200:203]
ds_read_b64_tr_b16 v[64:65], v5 offset:32768
v_mfma_f32_16x16x32_bf16 v[204:207], v[112:115], v[92:95], v[204:207]
ds_read_b64_tr_b16 v[66:67], v5 offset:36864
v_mfma_f32_16x16x32_bf16 v[144:147], v[100:103], v[80:83], v[144:147]
ds_read_b64_tr_b16 v[52:53], v6 offset:16384
v_mfma_f32_16x16x32_bf16 v[148:151], v[100:103], v[84:87], v[148:151]
ds_read_b64_tr_b16 v[54:55], v6 offset:20480
v_mfma_f32_16x16x32_bf16 v[152:155], v[100:103], v[88:91], v[152:155]
ds_read_b64_tr_b16 v[68:69], v6 offset:32768
v_mfma_f32_16x16x32_bf16 v[156:159], v[100:103], v[92:95], v[156:159]
ds_read_b64_tr_b16 v[70:71], v6 offset:36864
v_mfma_f32_16x16x32_bf16 v[208:211], v[116:119], v[80:83], v[208:211]
ds_read_b64_tr_b16 v[56:57], v7 offset:16384
v_mfma_f32_16x16x32_bf16 v[212:215], v[116:119], v[84:87], v[212:215]
ds_read_b64_tr_b16 v[58:59], v7 offset:20480
v_mfma_f32_16x16x32_bf16 v[216:219], v[116:119], v[88:91], v[216:219]
ds_read_b64_tr_b16 v[72:73], v7 offset:32768
v_mfma_f32_16x16x32_bf16 v[220:223], v[116:119], v[92:95], v[220:223]
ds_read_b64_tr_b16 v[74:75], v7 offset:36864
v_mfma_f32_16x16x32_bf16 v[160:163], v[104:107], v[80:83], v[160:163]
ds_read_b64_tr_b16 v[60:61], v8 offset:16384
v_mfma_f32_16x16x32_bf16 v[164:167], v[104:107], v[84:87], v[164:167]
ds_read_b64_tr_b16 v[62:63], v8 offset:20480
v_mfma_f32_16x16x32_bf16 v[168:171], v[104:107], v[88:91], v[168:171]
ds_read_b64_tr_b16 v[76:77], v8 offset:32768
v_mfma_f32_16x16x32_bf16 v[172:175], v[104:107], v[92:95], v[172:175]
ds_read_b64_tr_b16 v[78:79], v8 offset:36864
v_mfma_f32_16x16x32_bf16 v[224:227], v[120:123], v[80:83], v[224:227]
v_mfma_f32_16x16x32_bf16 v[228:231], v[120:123], v[84:87], v[228:231]
v_mfma_f32_16x16x32_bf16 v[232:235], v[120:123], v[88:91], v[232:235]
v_mfma_f32_16x16x32_bf16 v[236:239], v[120:123], v[92:95], v[236:239]
v_mfma_f32_16x16x32_bf16 v[176:179], v[108:111], v[80:83], v[176:179]
v_mfma_f32_16x16x32_bf16 v[180:183], v[108:111], v[84:87], v[180:183]
v_mfma_f32_16x16x32_bf16 v[184:187], v[108:111], v[88:91], v[184:187]
v_mfma_f32_16x16x32_bf16 v[188:191], v[108:111], v[92:95], v[188:191]
v_mfma_f32_16x16x32_bf16 v[240:243], v[124:127], v[80:83], v[240:243]
v_mfma_f32_16x16x32_bf16 v[244:247], v[124:127], v[84:87], v[244:247]
v_mfma_f32_16x16x32_bf16 v[248:251], v[124:127], v[88:91], v[248:251]
v_mfma_f32_16x16x32_bf16 v[252:255], v[124:127], v[92:95], v[252:255]
s_waitcnt lgkmcnt(0)
v_mfma_f32_16x16x32_bf16 v[128:131], v[48:51], v[32:35], v[128:131]
ds_read_b128 v[80:83], v2 offset:8192
v_mfma_f32_16x16x32_bf16 v[132:135], v[48:51], v[36:39], v[132:135]
ds_read_b64_tr_b16 v[96:97], v5 offset:24576
v_mfma_f32_16x16x32_bf16 v[136:139], v[48:51], v[40:43], v[136:139]
ds_read_b64_tr_b16 v[98:99], v5 offset:28672
v_mfma_f32_16x16x32_bf16 v[140:143], v[48:51], v[44:47], v[140:143]
ds_read_b128 v[84:87], v2 offset:8448
v_mfma_f32_16x16x32_bf16 v[192:195], v[64:67], v[32:35], v[192:195]
ds_read_b128 v[88:91], v2 offset:8704
v_mfma_f32_16x16x32_bf16 v[196:199], v[64:67], v[36:39], v[196:199]
ds_read_b128 v[92:95], v2 offset:8960
v_mfma_f32_16x16x32_bf16 v[200:203], v[64:67], v[40:43], v[200:203]
ds_read_b64_tr_b16 v[112:113], v5 offset:40960
v_mfma_f32_16x16x32_bf16 v[204:207], v[64:67], v[44:47], v[204:207]
ds_read_b64_tr_b16 v[114:115], v5 offset:45056
v_mfma_f32_16x16x32_bf16 v[144:147], v[52:55], v[32:35], v[144:147]
ds_read_b64_tr_b16 v[100:101], v6 offset:24576
v_mfma_f32_16x16x32_bf16 v[148:151], v[52:55], v[36:39], v[148:151]
ds_read_b64_tr_b16 v[102:103], v6 offset:28672
v_mfma_f32_16x16x32_bf16 v[152:155], v[52:55], v[40:43], v[152:155]
ds_read_b64_tr_b16 v[116:117], v6 offset:40960
v_mfma_f32_16x16x32_bf16 v[156:159], v[52:55], v[44:47], v[156:159]
ds_read_b64_tr_b16 v[118:119], v6 offset:45056
v_mfma_f32_16x16x32_bf16 v[208:211], v[68:71], v[32:35], v[208:211]
ds_read_b64_tr_b16 v[104:105], v7 offset:24576
v_mfma_f32_16x16x32_bf16 v[212:215], v[68:71], v[36:39], v[212:215]
ds_read_b64_tr_b16 v[106:107], v7 offset:28672
v_mfma_f32_16x16x32_bf16 v[216:219], v[68:71], v[40:43], v[216:219]
ds_read_b64_tr_b16 v[120:121], v7 offset:40960
v_mfma_f32_16x16x32_bf16 v[220:223], v[68:71], v[44:47], v[220:223]
ds_read_b64_tr_b16 v[122:123], v7 offset:45056
v_mfma_f32_16x16x32_bf16 v[160:163], v[56:59], v[32:35], v[160:163]
ds_read_b64_tr_b16 v[108:109], v8 offset:24576
v_mfma_f32_16x16x32_bf16 v[164:167], v[56:59], v[36:39], v[164:167]
ds_read_b64_tr_b16 v[110:111], v8 offset:28672
v_mfma_f32_16x16x32_bf16 v[168:171], v[56:59], v[40:43], v[168:171]
ds_read_b64_tr_b16 v[124:125], v8 offset:40960
v_mfma_f32_16x16x32_bf16 v[172:175], v[56:59], v[44:47], v[172:175]
ds_read_b64_tr_b16 v[126:127], v8 offset:45056
v_mfma_f32_16x16x32_bf16 v[224:227], v[72:75], v[32:35], v[224:227]
v_mfma_f32_16x16x32_bf16 v[228:231], v[72:75], v[36:39], v[228:231]
v_mfma_f32_16x16x32_bf16 v[232:235], v[72:75], v[40:43], v[232:235]
v_mfma_f32_16x16x32_bf16 v[236:239], v[72:75], v[44:47], v[236:239]
v_mfma_f32_16x16x32_bf16 v[176:179], v[60:63], v[32:35], v[176:179]
v_mfma_f32_16x16x32_bf16 v[180:183], v[60:63], v[36:39], v[180:183]
v_mfma_f32_16x16x32_bf16 v[184:187], v[60:63], v[40:43], v[184:187]
v_mfma_f32_16x16x32_bf16 v[188:191], v[60:63], v[44:47], v[188:191]
v_mfma_f32_16x16x32_bf16 v[240:243], v[76:79], v[32:35], v[240:243]
v_mfma_f32_16x16x32_bf16 v[244:247], v[76:79], v[36:39], v[244:247]
v_mfma_f32_16x16x32_bf16 v[248:251], v[76:79], v[40:43], v[248:251]
v_mfma_f32_16x16x32_bf16 v[252:255], v[76:79], v[44:47], v[252:255]
s_waitcnt vmcnt(0) lgkmcnt(0)
s_barrier
v_mfma_f32_16x16x32_bf16 v[128:131], v[96:99], v[80:83], v[128:131]
ds_read_b128 v[32:35], v3 offset:0
v_mfma_f32_16x16x32_bf16 v[132:135], v[96:99], v[84:87], v[132:135]
ds_read_b64_tr_b16 v[48:49], v9 offset:16384
v_mfma_f32_16x16x32_bf16 v[136:139], v[96:99], v[88:91], v[136:139]
ds_read_b64_tr_b16 v[50:51], v9 offset:20480
v_mfma_f32_16x16x32_bf16 v[140:143], v[96:99], v[92:95], v[140:143]
ds_read_b128 v[36:39], v3 offset:256
v_mfma_f32_16x16x32_bf16 v[192:195], v[112:115], v[80:83], v[192:195]
ds_read_b128 v[40:43], v3 offset:512
v_mfma_f32_16x16x32_bf16 v[196:199], v[112:115], v[84:87], v[196:199]
ds_read_b128 v[44:47], v3 offset:768
v_mfma_f32_16x16x32_bf16 v[200:203], v[112:115], v[88:91], v[200:203]
ds_read_b64_tr_b16 v[64:65], v9 offset:32768
v_mfma_f32_16x16x32_bf16 v[204:207], v[112:115], v[92:95], v[204:207]
ds_read_b64_tr_b16 v[66:67], v9 offset:36864
v_mfma_f32_16x16x32_bf16 v[144:147], v[100:103], v[80:83], v[144:147]
ds_read_b64_tr_b16 v[52:53], v10 offset:16384
v_mfma_f32_16x16x32_bf16 v[148:151], v[100:103], v[84:87], v[148:151]
ds_read_b64_tr_b16 v[54:55], v10 offset:20480
v_mfma_f32_16x16x32_bf16 v[152:155], v[100:103], v[88:91], v[152:155]
ds_read_b64_tr_b16 v[68:69], v10 offset:32768
v_mfma_f32_16x16x32_bf16 v[156:159], v[100:103], v[92:95], v[156:159]
ds_read_b64_tr_b16 v[70:71], v10 offset:36864
v_mfma_f32_16x16x32_bf16 v[208:211], v[116:119], v[80:83], v[208:211]
ds_read_b64_tr_b16 v[56:57], v11 offset:16384
v_mfma_f32_16x16x32_bf16 v[212:215], v[116:119], v[84:87], v[212:215]
ds_read_b64_tr_b16 v[58:59], v11 offset:20480
v_mfma_f32_16x16x32_bf16 v[216:219], v[116:119], v[88:91], v[216:219]
ds_read_b64_tr_b16 v[72:73], v11 offset:32768
v_mfma_f32_16x16x32_bf16 v[220:223], v[116:119], v[92:95], v[220:223]
ds_read_b64_tr_b16 v[74:75], v11 offset:36864
v_mfma_f32_16x16x32_bf16 v[160:163], v[104:107], v[80:83], v[160:163]
ds_read_b64_tr_b16 v[60:61], v12 offset:16384
v_mfma_f32_16x16x32_bf16 v[164:167], v[104:107], v[84:87], v[164:167]
ds_read_b64_tr_b16 v[62:63], v12 offset:20480
v_mfma_f32_16x16x32_bf16 v[168:171], v[104:107], v[88:91], v[168:171]
ds_read_b64_tr_b16 v[76:77], v12 offset:32768
v_mfma_f32_16x16x32_bf16 v[172:175], v[104:107], v[92:95], v[172:175]
ds_read_b64_tr_b16 v[78:79], v12 offset:36864
v_mfma_f32_16x16x32_bf16 v[224:227], v[120:123], v[80:83], v[224:227]
v_mfma_f32_16x16x32_bf16 v[228:231], v[120:123], v[84:87], v[228:231]
v_mfma_f32_16x16x32_bf16 v[232:235], v[120:123], v[88:91], v[232:235]
v_mfma_f32_16x16x32_bf16 v[236:239], v[120:123], v[92:95], v[236:239]
v_mfma_f32_16x16x32_bf16 v[176:179], v[108:111], v[80:83], v[176:179]
v_mfma_f32_16x16x32_bf16 v[180:183], v[108:111], v[84:87], v[180:183]
v_mfma_f32_16x16x32_bf16 v[184:187], v[108:111], v[88:91], v[184:187]
v_mfma_f32_16x16x32_bf16 v[188:191], v[108:111], v[92:95], v[188:191]
v_mfma_f32_16x16x32_bf16 v[240:243], v[124:127], v[80:83], v[240:243]
v_mfma_f32_16x16x32_bf16 v[244:247], v[124:127], v[84:87], v[244:247]
v_mfma_f32_16x16x32_bf16 v[248:251], v[124:127], v[88:91], v[248:251]
v_mfma_f32_16x16x32_bf16 v[252:255], v[124:127], v[92:95], v[252:255]
s_waitcnt lgkmcnt(0)
v_mfma_f32_16x16x32_bf16 v[128:131], v[48:51], v[32:35], v[128:131]
ds_read_b128 v[80:83], v3 offset:8192
v_mfma_f32_16x16x32_bf16 v[132:135], v[48:51], v[36:39], v[132:135]
ds_read_b64_tr_b16 v[96:97], v9 offset:24576
v_mfma_f32_16x16x32_bf16 v[136:139], v[48:51], v[40:43], v[136:139]
ds_read_b64_tr_b16 v[98:99], v9 offset:28672
v_mfma_f32_16x16x32_bf16 v[140:143], v[48:51], v[44:47], v[140:143]
ds_read_b128 v[84:87], v3 offset:8448
v_mfma_f32_16x16x32_bf16 v[192:195], v[64:67], v[32:35], v[192:195]
ds_read_b128 v[88:91], v3 offset:8704
v_mfma_f32_16x16x32_bf16 v[196:199], v[64:67], v[36:39], v[196:199]
ds_read_b128 v[92:95], v3 offset:8960
v_mfma_f32_16x16x32_bf16 v[200:203], v[64:67], v[40:43], v[200:203]
ds_read_b64_tr_b16 v[112:113], v9 offset:40960
v_mfma_f32_16x16x32_bf16 v[204:207], v[64:67], v[44:47], v[204:207]
ds_read_b64_tr_b16 v[114:115], v9 offset:45056
v_mfma_f32_16x16x32_bf16 v[144:147], v[52:55], v[32:35], v[144:147]
ds_read_b64_tr_b16 v[100:101], v10 offset:24576
v_mfma_f32_16x16x32_bf16 v[148:151], v[52:55], v[36:39], v[148:151]
ds_read_b64_tr_b16 v[102:103], v10 offset:28672
v_mfma_f32_16x16x32_bf16 v[152:155], v[52:55], v[40:43], v[152:155]
ds_read_b64_tr_b16 v[116:117], v10 offset:40960
v_mfma_f32_16x16x32_bf16 v[156:159], v[52:55], v[44:47], v[156:159]
ds_read_b64_tr_b16 v[118:119], v10 offset:45056
v_mfma_f32_16x16x32_bf16 v[208:211], v[68:71], v[32:35], v[208:211]
ds_read_b64_tr_b16 v[104:105], v11 offset:24576
v_mfma_f32_16x16x32_bf16 v[212:215], v[68:71], v[36:39], v[212:215]
ds_read_b64_tr_b16 v[106:107], v11 offset:28672
v_mfma_f32_16x16x32_bf16 v[216:219], v[68:71], v[40:43], v[216:219]
ds_read_b64_tr_b16 v[120:121], v11 offset:40960
v_mfma_f32_16x16x32_bf16 v[220:223], v[68:71], v[44:47], v[220:223]
ds_read_b64_tr_b16 v[122:123], v11 offset:45056
v_mfma_f32_16x16x32_bf16 v[160:163], v[56:59], v[32:35], v[160:163]
ds_read_b64_tr_b16 v[108:109], v12 offset:24576
v_mfma_f32_16x16x32_bf16 v[164:167], v[56:59], v[36:39], v[164:167]
ds_read_b64_tr_b16 v[110:111], v12 offset:28672
v_mfma_f32_16x16x32_bf16 v[168:171], v[56:59], v[40:43], v[168:171]
ds_read_b64_tr_b16 v[124:125], v12 offset:40960
v_mfma_f32_16x16x32_bf16 v[172:175], v[56:59], v[44:47], v[172:175]
ds_read_b64_tr_b16 v[126:127], v12 offset:45056
v_mfma_f32_16x16x32_bf16 v[224:227], v[72:75], v[32:35], v[224:227]
v_mfma_f32_16x16x32_bf16 v[228:231], v[72:75], v[36:39], v[228:231]
v_mfma_f32_16x16x32_bf16 v[232:235], v[72:75], v[40:43], v[232:235]
v_mfma_f32_16x16x32_bf16 v[236:239], v[72:75], v[44:47], v[236:239]
v_mfma_f32_16x16x32_bf16 v[176:179], v[60:63], v[32:35], v[176:179]
v_mfma_f32_16x16x32_bf16 v[180:183], v[60:63], v[36:39], v[180:183]
v_mfma_f32_16x16x32_bf16 v[184:187], v[60:63], v[40:43], v[184:187]
v_mfma_f32_16x16x32_bf16 v[188:191], v[60:63], v[44:47], v[188:191]
v_mfma_f32_16x16x32_bf16 v[240:243], v[76:79], v[32:35], v[240:243]
v_mfma_f32_16x16x32_bf16 v[244:247], v[76:79], v[36:39], v[244:247]
v_mfma_f32_16x16x32_bf16 v[248:251], v[76:79], v[40:43], v[248:251]
v_mfma_f32_16x16x32_bf16 v[252:255], v[76:79], v[44:47], v[252:255]
s_waitcnt lgkmcnt(0)
s_barrier
v_mfma_f32_16x16x32_bf16 v[128:131], v[96:99], v[80:83], v[128:131]
ds_read_b128 v[32:35], v4 offset:0
v_mfma_f32_16x16x32_bf16 v[132:135], v[96:99], v[84:87], v[132:135]
ds_read_b64_tr_b16 v[48:49], v13 offset:16384
v_mfma_f32_16x16x32_bf16 v[136:139], v[96:99], v[88:91], v[136:139]
ds_read_b64_tr_b16 v[50:51], v13 offset:20480
v_mfma_f32_16x16x32_bf16 v[140:143], v[96:99], v[92:95], v[140:143]
ds_read_b128 v[36:39], v4 offset:256
v_mfma_f32_16x16x32_bf16 v[192:195], v[112:115], v[80:83], v[192:195]
ds_read_b128 v[40:43], v4 offset:512
v_mfma_f32_16x16x32_bf16 v[196:199], v[112:115], v[84:87], v[196:199]
ds_read_b128 v[44:47], v4 offset:768
v_mfma_f32_16x16x32_bf16 v[200:203], v[112:115], v[88:91], v[200:203]
ds_read_b64_tr_b16 v[64:65], v13 offset:32768
v_mfma_f32_16x16x32_bf16 v[204:207], v[112:115], v[92:95], v[204:207]
ds_read_b64_tr_b16 v[66:67], v13 offset:36864
v_mfma_f32_16x16x32_bf16 v[144:147], v[100:103], v[80:83], v[144:147]
ds_read_b64_tr_b16 v[52:53], v14 offset:16384
v_mfma_f32_16x16x32_bf16 v[148:151], v[100:103], v[84:87], v[148:151]
ds_read_b64_tr_b16 v[54:55], v14 offset:20480
v_mfma_f32_16x16x32_bf16 v[152:155], v[100:103], v[88:91], v[152:155]
ds_read_b64_tr_b16 v[68:69], v14 offset:32768
v_mfma_f32_16x16x32_bf16 v[156:159], v[100:103], v[92:95], v[156:159]
ds_read_b64_tr_b16 v[70:71], v14 offset:36864
v_mfma_f32_16x16x32_bf16 v[208:211], v[116:119], v[80:83], v[208:211]
ds_read_b64_tr_b16 v[56:57], v15 offset:16384
v_mfma_f32_16x16x32_bf16 v[212:215], v[116:119], v[84:87], v[212:215]
ds_read_b64_tr_b16 v[58:59], v15 offset:20480
v_mfma_f32_16x16x32_bf16 v[216:219], v[116:119], v[88:91], v[216:219]
ds_read_b64_tr_b16 v[72:73], v15 offset:32768
v_mfma_f32_16x16x32_bf16 v[220:223], v[116:119], v[92:95], v[220:223]
ds_read_b64_tr_b16 v[74:75], v15 offset:36864
v_mfma_f32_16x16x32_bf16 v[160:163], v[104:107], v[80:83], v[160:163]
ds_read_b64_tr_b16 v[60:61], v16 offset:16384
v_mfma_f32_16x16x32_bf16 v[164:167], v[104:107], v[84:87], v[164:167]
ds_read_b64_tr_b16 v[62:63], v16 offset:20480
v_mfma_f32_16x16x32_bf16 v[168:171], v[104:107], v[88:91], v[168:171]
ds_read_b64_tr_b16 v[76:77], v16 offset:32768
v_mfma_f32_16x16x32_bf16 v[172:175], v[104:107], v[92:95], v[172:175]
ds_read_b64_tr_b16 v[78:79], v16 offset:36864
v_mfma_f32_16x16x32_bf16 v[224:227], v[120:123], v[80:83], v[224:227]
v_mfma_f32_16x16x32_bf16 v[228:231], v[120:123], v[84:87], v[228:231]
v_mfma_f32_16x16x32_bf16 v[232:235], v[120:123], v[88:91], v[232:235]
v_mfma_f32_16x16x32_bf16 v[236:239], v[120:123], v[92:95], v[236:239]
v_mfma_f32_16x16x32_bf16 v[176:179], v[108:111], v[80:83], v[176:179]
v_mfma_f32_16x16x32_bf16 v[180:183], v[108:111], v[84:87], v[180:183]
v_mfma_f32_16x16x32_bf16 v[184:187], v[108:111], v[88:91], v[184:187]
v_mfma_f32_16x16x32_bf16 v[188:191], v[108:111], v[92:95], v[188:191]
v_mfma_f32_16x16x32_bf16 v[240:243], v[124:127], v[80:83], v[240:243]
v_mfma_f32_16x16x32_bf16 v[244:247], v[124:127], v[84:87], v[244:247]
v_mfma_f32_16x16x32_bf16 v[248:251], v[124:127], v[88:91], v[248:251]
v_mfma_f32_16x16x32_bf16 v[252:255], v[124:127], v[92:95], v[252:255]
s_sub_u32 s41, s41, 1
s_cmp_lg_u32 s41, 0
s_cbranch_scc1 Lk3_19
s_waitcnt lgkmcnt(0)
v_mfma_f32_16x16x32_bf16 v[128:131], v[48:51], v[32:35], v[128:131]
ds_read_b128 v[80:83], v4 offset:8192
v_mfma_f32_16x16x32_bf16 v[132:135], v[48:51], v[36:39], v[132:135]
ds_read_b64_tr_b16 v[96:97], v13 offset:24576
v_mfma_f32_16x16x32_bf16 v[136:139], v[48:51], v[40:43], v[136:139]
ds_read_b64_tr_b16 v[98:99], v13 offset:28672
v_mfma_f32_16x16x32_bf16 v[140:143], v[48:51], v[44:47], v[140:143]
ds_read_b128 v[84:87], v4 offset:8448
v_mfma_f32_16x16x32_bf16 v[192:195], v[64:67], v[32:35], v[192:195]
ds_read_b128 v[88:91], v4 offset:8704
v_mfma_f32_16x16x32_bf16 v[196:199], v[64:67], v[36:39], v[196:199]
ds_read_b128 v[92:95], v4 offset:8960
v_mfma_f32_16x16x32_bf16 v[200:203], v[64:67], v[40:43], v[200:203]
ds_read_b64_tr_b16 v[112:113], v13 offset:40960
v_mfma_f32_16x16x32_bf16 v[204:207], v[64:67], v[44:47], v[204:207]
ds_read_b64_tr_b16 v[114:115], v13 offset:45056
v_mfma_f32_16x16x32_bf16 v[144:147], v[52:55], v[32:35], v[144:147]
ds_read_b64_tr_b16 v[100:101], v14 offset:24576
v_mfma_f32_16x16x32_bf16 v[148:151], v[52:55], v[36:39], v[148:151]
ds_read_b64_tr_b16 v[102:103], v14 offset:28672
v_mfma_f32_16x16x32_bf16 v[152:155], v[52:55], v[40:43], v[152:155]
ds_read_b64_tr_b16 v[116:117], v14 offset:40960
v_mfma_f32_16x16x32_bf16 v[156:159], v[52:55], v[44:47], v[156:159]
ds_read_b64_tr_b16 v[118:119], v14 offset:45056
v_mfma_f32_16x16x32_bf16 v[208:211], v[68:71], v[32:35], v[208:211]
ds_read_b64_tr_b16 v[104:105], v15 offset:24576
v_mfma_f32_16x16x32_bf16 v[212:215], v[68:71], v[36:39], v[212:215]
ds_read_b64_tr_b16 v[106:107], v15 offset:28672
v_mfma_f32_16x16x32_bf16 v[216:219], v[68:71], v[40:43], v[216:219]
ds_read_b64_tr_b16 v[120:121], v15 offset:40960
v_mfma_f32_16x16x32_bf16 v[220:223], v[68:71], v[44:47], v[220:223]
ds_read_b64_tr_b16 v[122:123], v15 offset:45056
v_mfma_f32_16x16x32_bf16 v[160:163], v[56:59], v[32:35], v[160:163]
ds_read_b64_tr_b16 v[108:109], v16 offset:24576
v_mfma_f32_16x16x32_bf16 v[164:167], v[56:59], v[36:39], v[164:167]
ds_read_b64_tr_b16 v[110:111], v16 offset:28672
v_mfma_f32_16x16x32_bf16 v[168:171], v[56:59], v[40:43], v[168:171]
ds_read_b64_tr_b16 v[124:125], v16 offset:40960
v_mfma_f32_16x16x32_bf16 v[172:175], v[56:59], v[44:47], v[172:175]
ds_read_b64_tr_b16 v[126:127], v16 offset:45056
v_mfma_f32_16x16x32_bf16 v[224:227], v[72:75], v[32:35], v[224:227]
v_mfma_f32_16x16x32_bf16 v[228:231], v[72:75], v[36:39], v[228:231]
v_mfma_f32_16x16x32_bf16 v[232:235], v[72:75], v[40:43], v[232:235]
v_mfma_f32_16x16x32_bf16 v[236:239], v[72:75], v[44:47], v[236:239]
v_mfma_f32_16x16x32_bf16 v[176:179], v[60:63], v[32:35], v[176:179]
v_mfma_f32_16x16x32_bf16 v[180:183], v[60:63], v[36:39], v[180:183]
v_mfma_f32_16x16x32_bf16 v[184:187], v[60:63], v[40:43], v[184:187]
v_mfma_f32_16x16x32_bf16 v[188:191], v[60:63], v[44:47], v[188:191]
v_mfma_f32_16x16x32_bf16 v[240:243], v[76:79], v[32:35], v[240:243]
v_mfma_f32_16x16x32_bf16 v[244:247], v[76:79], v[36:39], v[244:247]
v_mfma_f32_16x16x32_bf16 v[248:251], v[76:79], v[40:43], v[248:251]
v_mfma_f32_16x16x32_bf16 v[252:255], v[76:79], v[44:47], v[252:255]
s_waitcnt lgkmcnt(0)
s_barrier
s_cmp_eq_u32 s36, 3
s_cbranch_scc1 L3h_20
s_add_u32 m0, s39, 98304
s_add_u32 s37, s37, s38
buffer_load_dwordx4 v22, s[8:11], s37 offen sc1 lds
v_mfma_f32_16x16x32_bf16 v[128:131], v[96:99], v[80:83], v[128:131]
v_mfma_f32_16x16x32_bf16 v[132:135], v[96:99], v[84:87], v[132:135]
s_add_u32 m0, s39, 99328
s_add_u32 s37, s37, s38
buffer_load_dwordx4 v23, s[8:11], s37 offen sc1 lds
v_mfma_f32_16x16x32_bf16 v[136:139], v[96:99], v[88:91], v[136:139]
v_mfma_f32_16x16x32_bf16 v[140:143], v[96:99], v[92:95], v[140:143]
s_add_u32 m0, s39, 100352
s_add_u32 s37, s37, s38
buffer_load_dwordx4 v22, s[8:11], s37 offen sc1 lds
v_mfma_f32_16x16x32_bf16 v[192:195], v[112:115], v[80:83], v[192:195]
v_mfma_f32_16x16x32_bf16 v[196:199], v[112:115], v[84:87], v[196:199]
s_add_u32 m0, s39, 101376
s_add_u32 s37, s37, s38
buffer_load_dwordx4 v23, s[8:11], s37 offen sc1 lds
v_mfma_f32_16x16x32_bf16 v[200:203], v[112:115], v[88:91], v[200:203]
v_mfma_f32_16x16x32_bf16 v[204:207], v[112:115], v[92:95], v[204:207]
s_add_u32 m0, s39, 102400
s_add_u32 s37, s37, s38
buffer_load_dwordx4 v22, s[8:11], s37 offen sc1 lds
v_mfma_f32_16x16x32_bf16 v[144:147], v[100:103], v[80:83], v[144:147]
v_mfma_f32_16x16x32_bf16 v[148:151], v[100:103], v[84:87], v[148:151]
s_add_u32 m0, s39, 103424
s_add_u32 s37, s37, s38
buffer_load_dwordx4 v23, s[8:11], s37 offen sc1 lds
v_mfma_f32_16x16x32_bf16 v[152:155], v[100:103], v[88:91], v[152:155]
v_mfma_f32_16x16x32_bf16 v[156:159], v[100:103], v[92:95], v[156:159]
s_add_u32 m0, s39, 104448
s_add_u32 s37, s37, s38
buffer_load_dwordx4 v22, s[8:11], s37 offen sc1 lds
v_mfma_f32_16x16x32_bf16 v[208:211], v[116:119], v[80:83], v[208:211]
v_mfma_f32_16x16x32_bf16 v[212:215], v[116:119], v[84:87], v[212:215]
s_add_u32 m0, s39, 105472
s_add_u32 s37, s37, s38
buffer_load_dwordx4 v23, s[8:11], s37 offen sc1 lds
v_mfma_f32_16x16x32_bf16 v[216:219], v[116:119], v[88:91], v[216:219]
v_mfma_f32_16x16x32_bf16 v[220:223], v[116:119], v[92:95], v[220:223]
s_add_u32 m0, s39, 106496
s_add_u32 s37, s37, s38
buffer_load_dwordx4 v22, s[8:11], s37 offen sc1 lds
v_mfma_f32_16x16x32_bf16 v[160:163], v[104:107], v[80:83], v[160:163]
v_mfma_f32_16x16x32_bf16 v[164:167], v[104:107], v[84:87], v[164:167]
s_add_u32 m0, s39, 107520
s_add_u32 s37, s37, s38
buffer_load_dwordx4 v23, s[8:11], s37 offen sc1 lds
v_mfma_f32_16x16x32_bf16 v[168:171], v[104:107], v[88:91], v[168:171]
v_mfma_f32_16x16x32_bf16 v[172:175], v[104:107], v[92:95], v[172:175]
s_add_u32 m0, s39, 108544
s_add_u32 s37, s37, s38
buffer_load_dwordx4 v22, s[8:11], s37 offen sc1 lds
v_mfma_f32_16x16x32_bf16 v[224:227], v[120:123], v[80:83], v[224:227]
v_mfma_f32_16x16x32_bf16 v[228:231], v[120:123], v[84:87], v[228:231]
s_add_u32 m0, s39, 109568
s_add_u32 s37, s37, s38
buffer_load_dwordx4 v23, s[8:11], s37 offen sc1 lds
v_mfma_f32_16x16x32_bf16 v[232:235], v[120:123], v[88:91], v[232:235]
v_mfma_f32_16x16x32_bf16 v[236:239], v[120:123], v[92:95], v[236:239]
s_add_u32 m0, s39, 110592
s_add_u32 s37, s37, s38
buffer_load_dwordx4 v22, s[8:11], s37 offen sc1 lds
v_mfma_f32_16x16x32_bf16 v[176:179], v[108:111], v[80:83], v[176:179]
v_mfma_f32_16x16x32_bf16 v[180:183], v[108:111], v[84:87], v[180:183]
s_add_u32 m0, s39, 111616
s_add_u32 s37, s37, s38
buffer_load_dwordx4 v23, s[8:11], s37 offen sc1 lds
v_mfma_f32_16x16x32_bf16 v[184:187], v[108:111], v[88:91], v[184:187]
v_mfma_f32_16x16x32_bf16 v[188:191], v[108:111], v[92:95], v[188:191]
s_add_u32 m0, s39, 112640
s_add_u32 s37, s37, s38
buffer_load_dwordx4 v22, s[8:11], s37 offen sc1 lds
v_mfma_f32_16x16x32_bf16 v[240:243], v[124:127], v[80:83], v[240:243]
v_mfma_f32_16x16x32_bf16 v[244:247], v[124:127], v[84:87], v[244:247]
s_add_u32 m0, s39, 113664
s_add_u32 s37, s37, s38
buffer_load_dwordx4 v23, s[8:11], s37 offen sc1 lds
v_mfma_f32_16x16x32_bf16 v[248:251], v[124:127], v[88:91], v[248:251]
v_mfma_f32_16x16x32_bf16 v[252:255], v[124:127], v[92:95], v[252:255]
s_setprio 0
s_lshl_b32 s43, s46, 9
s_add_u32 s43, s43, 147456
v_lshl_add_u32 v19, v17, 3, s43
ds_read_b64 v[80:81], v19 offset:0
ds_read_b64 v[82:83], v19 offset:128
ds_read_b64 v[84:85], v19 offset:256
ds_read_b64 v[86:87], v19 offset:384
s_mul_i32 s43, s47, 256
s_add_u32 s43, s43, 148480
v_lshl_add_u32 v19, v18, 4, s43
ds_read_b128 v[48:51], v19 offset:0
ds_read_b128 v[52:55], v19 offset:64
ds_read_b128 v[56:59], v19 offset:128
ds_read_b128 v[60:63], v19 offset:192
ds_read_b128 v[64:67], v19 offset:896
ds_read_b128 v[68:71], v19 offset:960
ds_read_b128 v[72:75], v19 offset:1024
ds_read_b128 v[76:79], v19 offset:1088
s_waitcnt lgkmcnt(0)
v_mov_b32 v32, v80
v_mul_f32 v88, v81, v81
v_mul_f32 v36, 0xc0135761, v81
v_mul_f32 v89, 0xbdd2d3e8, v81
v_rcp_f32 v44, v88
v_mul_f32 v40, v89, v88
v_mov_b32 v33, v82
v_mul_f32 v88, v83, v83
v_mul_f32 v37, 0xc0135761, v83
v_mul_f32 v89, 0xbdd2d3e8, v83
v_rcp_f32 v45, v88
v_mul_f32 v41, v89, v88
v_mov_b32 v34, v84
v_mul_f32 v88, v85, v85
v_mul_f32 v38, 0xc0135761, v85
v_mul_f32 v89, 0xbdd2d3e8, v85
v_rcp_f32 v46, v88
v_mul_f32 v42, v89, v88
v_mov_b32 v35, v86
v_mul_f32 v88, v87, v87
v_mul_f32 v39, 0xc0135761, v87
v_mul_f32 v89, 0xbdd2d3e8, v87
v_rcp_f32 v47, v88
v_mul_f32 v43, v89, v88
s_barrier
s_add_u32 m0, s39, 0
s_add_u32 s37, s37, s38
buffer_load_dwordx4 v22, s[8:11], s37 offen sc1 lds
v_fma_f32 v128, -v32, v48, v128
v_fma_f32 v129, -v32, v49, v129
v_fma_f32 v130, -v32, v50, v130
s_add_u32 m0, s39, 1024
s_add_u32 s37, s37, s38
buffer_load_dwordx4 v23, s[8:11], s37 offen sc1 lds
v_fma_f32 v131, -v32, v51, v131
v_fma_f32 v192, -v32, v64, v192
v_fma_f32 v193, -v32, v65, v193
s_add_u32 m0, s39, 2048
s_add_u32 s37, s37, s38
buffer_load_dwordx4 v22, s[8:11], s37 offen sc1 lds
v_fma_f32 v194, -v32, v66, v194
v_fma_f32 v195, -v32, v67, v195
v_mul_f32 v80, v128, v128
s_add_u32 m0, s39, 3072
s_add_u32 s37, s37, s38
buffer_load_dwordx4 v23, s[8:11], s37 offen sc1 lds
v_mul_f32 v81, v129, v129
v_mul_f32 v82, v130, v130
v_mul_f32 v83, v131, v131
s_add_u32 m0, s39, 4096
s_add_u32 s37, s37, s38
buffer_load_dwordx4 v22, s[8:11], s37 offen sc1 lds
v_fma_f32 v80, v80, v40, v36
v_fma_f32 v81, v81, v40, v36
v_fma_f32 v82, v82, v40, v36
s_add_u32 m0, s39, 5120
s_add_u32 s37, s37, s38
buffer_load_dwordx4 v23, s[8:11], s37 offen sc1 lds
v_fma_f32 v83, v83, v40, v36
v_mul_f32 v80, v80, v128
v_mul_f32 v81, v81, v129
s_add_u32 m0, s39, 6144
s_add_u32 s37, s37, s38
buffer_load_dwordx4 v22, s[8:11], s37 offen sc1 lds
v_mul_f32 v82, v82, v130
v_mul_f32 v83, v83, v131
v_exp_f32 v80, v80
s_add_u32 m0, s39, 7168
s_add_u32 s37, s37, s38
buffer_load_dwordx4 v23, s[8:11], s37 offen sc1 lds
v_exp_f32 v81, v81
v_exp_f32 v82, v82
v_exp_f32 v83, v83
s_add_u32 m0, s39, 8192
s_add_u32 s37, s37, s38
buffer_load_dwordx4 v22, s[8:11], s37 offen sc1 lds
v_mul_f32 v192, v128, v192
v_mul_f32 v193, v129, v193
v_mul_f32 v194, v130, v194
s_add_u32 m0, s39, 9216
s_add_u32 s37, s37, s38
buffer_load_dwordx4 v23, s[8:11], s37 offen sc1 lds
v_mul_f32 v195, v131, v195
v_fma_f32 v80, v80, v44, v44
v_fma_f32 v81, v81, v44, v44
s_add_u32 m0, s39, 10240
s_add_u32 s37, s37, s38
buffer_load_dwordx4 v22, s[8:11], s37 offen sc1 lds
v_fma_f32 v82, v82, v44, v44
v_fma_f32 v83, v83, v44, v44
v_rcp_f32 v80, v80
s_add_u32 m0, s39, 11264
s_add_u32 s37, s37, s38
buffer_load_dwordx4 v23, s[8:11], s37 offen sc1 lds
v_rcp_f32 v81, v81
v_rcp_f32 v82, v82
v_rcp_f32 v83, v83
s_add_u32 m0, s39, 12288
s_add_u32 s37, s37, s38
buffer_load_dwordx4 v22, s[8:11], s37 offen sc1 lds
v_mul_f32 v192, v192, v80
v_mul_f32 v193, v193, v81
v_mul_f32 v194, v194, v82
s_add_u32 m0, s39, 13312
s_add_u32 s37, s37, s38
buffer_load_dwordx4 v23, s[8:11], s37 offen sc1 lds
v_mul_f32 v195, v195, v83
v_cvt_pk_bf16_f32 v96, v192, v193
v_cvt_pk_bf16_f32 v97, v194, v195
s_add_u32 m0, s39, 14336
s_add_u32 s37, s37, s38
buffer_load_dwordx4 v22, s[8:11], s37 offen sc1 lds
v_fma_f32 v144, -v32, v52, v144
v_fma_f32 v145, -v32, v53, v145
v_fma_f32 v146, -v32, v54, v146
s_add_u32 m0, s39, 15360
s_add_u32 s37, s37, s38
buffer_load_dwordx4 v23, s[8:11], s37 offen sc1 lds
v_fma_f32 v147, -v32, v55, v147
v_fma_f32 v208, -v32, v68, v208
v_fma_f32 v209, -v32, v69, v209
s_waitcnt vmcnt(16)
s_barrier
s_add_u32 m0, s39, 49152
s_add_u32 s37, s37, s38
buffer_load_dwordx4 v22, s[8:11], s37 offen sc1 lds
v_fma_f32 v210, -v32, v70, v210
v_fma_f32 v211, -v32, v71, v211
v_mul_f32 v84, v144, v144
v_mul_f32 v85, v145, v145
s_add_u32 m0, s39, 50176
s_add_u32 s37, s37, s38
buffer_load_dwordx4 v23, s[8:11], s37 offen sc1 lds
v_mul_f32 v86, v146, v146
v_mul_f32 v87, v147, v147
v_fma_f32 v84, v84, v40, v36
v_fma_f32 v85, v85, v40, v36
s_add_u32 m0, s39, 51200
s_add_u32 s37, s37, s38
buffer_load_dwordx4 v22, s[8:11], s37 offen sc1 lds
v_fma_f32 v86, v86, v40, v36
v_fma_f32 v87, v87, v40, v36
v_mul_f32 v84, v84, v144
v_mul_f32 v85, v85, v145
s_add_u32 m0, s39, 52224
s_add_u32 s37, s37, s38
buffer_load_dwordx4 v23, s[8:11], s37 offen sc1 lds
v_mul_f32 v86, v86, v146
v_mul_f32 v87, v87, v147
v_exp_f32 v84, v84
v_exp_f32 v85, v85
s_add_u32 m0, s39, 53248
s_add_u32 s37, s37, s38
buffer_load_dwordx4 v22, s[8:11], s37 offen sc1 lds
v_exp_f32 v86, v86
v_exp_f32 v87, v87
v_mul_f32 v208, v144, v208
v_mul_f32 v209, v145, v209
s_add_u32 m0, s39, 54272
s_add_u32 s37, s37, s38
buffer_load_dwordx4 v23, s[8:11], s37 offen sc1 lds
v_mul_f32 v210, v146, v210
v_mul_f32 v211, v147, v211
v_fma_f32 v84, v84, v44, v44
v_fma_f32 v85, v85, v44, v44
s_add_u32 m0, s39, 55296
s_add_u32 s37, s37, s38
buffer_load_dwordx4 v22, s[8:11], s37 offen sc1 lds
v_fma_f32 v86, v86, v44, v44
v_fma_f32 v87, v87, v44, v44
v_rcp_f32 v84, v84
v_rcp_f32 v85, v85
s_add_u32 m0, s39, 56320
s_add_u32 s37, s37, s38
buffer_load_dwordx4 v23, s[8:11], s37 offen sc1 lds
v_rcp_f32 v86, v86
v_rcp_f32 v87, v87
v_mul_f32 v208, v208, v84
v_mul_f32 v209, v209, v85
s_add_u32 m0, s39, 57344
s_add_u32 s37, s37, s38
buffer_load_dwordx4 v22, s[8:11], s37 offen sc1 lds
v_mul_f32 v210, v210, v86
v_mul_f32 v211, v211, v87
v_cvt_pk_bf16_f32 v98, v208, v209
v_cvt_pk_bf16_f32 v99, v210, v211
s_add_u32 m0, s39, 58368
s_add_u32 s37, s37, s38
buffer_load_dwordx4 v23, s[8:11], s37 offen sc1 lds
v_fma_f32 v132, -v33, v48, v132
v_fma_f32 v133, -v33, v49, v133
v_fma_f32 v134, -v33, v50, v134
s_add_u32 m0, s39, 59392
s_add_u32 s37, s37, s38
buffer_load_dwordx4 v22, s[8:11], s37 offen sc1 lds
v_fma_f32 v135, -v33, v51, v135
v_fma_f32 v196, -v33, v64, v196
v_fma_f32 v197, -v33, v65, v197
v_fma_f32 v198, -v33, v66, v198
s_add_u32 m0, s39, 60416
s_add_u32 s37, s37, s38
buffer_load_dwordx4 v23, s[8:11], s37 offen sc1 lds
v_fma_f32 v199, -v33, v67, v199
v_mul_f32 v80, v132, v132
v_mul_f32 v81, v133, v133
v_mul_f32 v82, v134, v134
s_add_u32 m0, s39, 61440
s_add_u32 s37, s37, s38
buffer_load_dwordx4 v22, s[8:11], s37 offen sc1 lds
v_mul_f32 v83, v135, v135
v_lshlrev_b32 v19, 11, v18
v_lshl_add_u32 v19, v17, 4, v19
s_lshl_b32 s43, s36, 9
s_add_u32 m0, s39, 62464
s_add_u32 s37, s37, s38
buffer_load_dwordx4 v23, s[8:11], s37 offen sc1 lds
v_add_u32 v2, s43, v19
v_add_u32 v3, 49152, v2
v_add_u32 v4, 98304, v2
v_lshrrev_b32 v19, 2, v17
s_add_u32 m0, s39, 63488
s_add_u32 s37, s37, s38
buffer_load_dwordx4 v22, s[8:11], s37 offen sc1 lds
v_lshl_add_u32 v20, v18, 2, v19
v_bfe_u32 v21, v20, 1, 2
v_lshlrev_b32 v20, 7, v20
v_lshl_add_u32 v20, v21, 5, v20
s_add_u32 m0, s39, 64512
s_add_u32 s37, s37, s38
buffer_load_dwordx4 v23, s[8:11], s37 offen sc1 lds
v_and_b32 v19, 3, v1
v_lshl_add_u32 v20, v19, 3, v20
v_add_u32 v5, 16384, v20
buffer_store_dwordx4 v[96:99], v27, s[24:27], 0 offen offset:0 sc1
s_waitcnt vmcnt(17)
s_barrier
s_add_u32 m0, s39, 98304
s_add_u32 s37, s37, s38
buffer_load_dwordx4 v22, s[8:11], s37 offen sc1 lds
v_fma_f32 v80, v80, v41, v37
v_fma_f32 v81, v81, v41, v37
v_fma_f32 v82, v82, v41, v37
v_fma_f32 v83, v83, v41, v37
s_add_u32 m0, s39, 99328
s_add_u32 s37, s37, s38
buffer_load_dwordx4 v23, s[8:11], s37 offen sc1 lds
v_mul_f32 v80, v80, v132
v_mul_f32 v81, v81, v133
v_mul_f32 v82, v82, v134
v_mul_f32 v83, v83, v135
s_add_u32 m0, s39, 100352
s_add_u32 s37, s37, s38
buffer_load_dwordx4 v22, s[8:11], s37 offen sc1 lds
v_exp_f32 v80, v80
v_exp_f32 v81, v81
v_exp_f32 v82, v82
v_exp_f32 v83, v83
s_add_u32 m0, s39, 101376
s_add_u32 s37, s37, s38
buffer_load_dwordx4 v23, s[8:11], s37 offen sc1 lds
v_mul_f32 v196, v132, v196
v_mul_f32 v197, v133, v197
v_mul_f32 v198, v134, v198
s_add_u32 m0, s39, 102400
s_add_u32 s37, s37, s38
buffer_load_dwordx4 v22, s[8:11], s37 offen sc1 lds
v_mul_f32 v199, v135, v199
v_fma_f32 v80, v80, v45, v45
v_fma_f32 v81, v81, v45, v45
v_fma_f32 v82, v82, v45, v45
s_add_u32 m0, s39, 103424
s_add_u32 s37, s37, s38
buffer_load_dwordx4 v23, s[8:11], s37 offen sc1 lds
v_fma_f32 v83, v83, v45, v45
v_rcp_f32 v80, v80
v_rcp_f32 v81, v81
v_rcp_f32 v82, v82
s_add_u32 m0, s39, 104448
s_add_u32 s37, s37, s38
buffer_load_dwordx4 v22, s[8:11], s37 offen sc1 lds
v_rcp_f32 v83, v83
v_mul_f32 v196, v196, v80
v_mul_f32 v197, v197, v81
s_add_u32 m0, s39, 105472
s_add_u32 s37, s37, s38
buffer_load_dwordx4 v23, s[8:11], s37 offen sc1 lds
v_mul_f32 v198, v198, v82
v_mul_f32 v199, v199, v83
v_cvt_pk_bf16_f32 v100, v196, v197
v_cvt_pk_bf16_f32 v101, v198, v199
s_add_u32 m0, s39, 106496
s_add_u32 s37, s37, s38
buffer_load_dwordx4 v22, s[8:11], s37 offen sc1 lds
v_fma_f32 v148, -v33, v52, v148
v_fma_f32 v149, -v33, v53, v149
v_fma_f32 v150, -v33, v54, v150
v_fma_f32 v151, -v33, v55, v151
s_add_u32 m0, s39, 107520
s_add_u32 s37, s37, s38
buffer_load_dwordx4 v23, s[8:11], s37 offen sc1 lds
v_fma_f32 v212, -v33, v68, v212
v_fma_f32 v213, -v33, v69, v213
v_fma_f32 v214, -v33, v70, v214
s_add_u32 m0, s39, 108544
s_add_u32 s37, s37, s38
buffer_load_dwordx4 v22, s[8:11], s37 offen sc1 lds
v_fma_f32 v215, -v33, v71, v215
v_mul_f32 v84, v148, v148
v_mul_f32 v85, v149, v149
v_mul_f32 v86, v150, v150
s_add_u32 m0, s39, 109568
s_add_u32 s37, s37, s38
buffer_load_dwordx4 v23, s[8:11], s37 offen sc1 lds
v_mul_f32 v87, v151, v151
v_fma_f32 v84, v84, v41, v37
v_fma_f32 v85, v85, v41, v37
v_fma_f32 v86, v86, v41, v37
s_add_u32 m0, s39, 110592
s_add_u32 s37, s37, s38
buffer_load_dwordx4 v22, s[8:11], s37 offen sc1 lds
v_fma_f32 v87, v87, v41, v37
v_mul_f32 v84, v84, v148
v_mul_f32 v85, v85, v149
s_add_u32 m0, s39, 111616
s_add_u32 s37, s37, s38
buffer_load_dwordx4 v23, s[8:11], s37 offen sc1 lds
v_xor_b32 v6, 32, v5
v_xor_b32 v7, 64, v5
v_xor_b32 v8, 96, v5
v_add_u32 v9, 49152, v5
s_add_u32 m0, s39, 112640
s_add_u32 s37, s37, s38
buffer_load_dwordx4 v22, s[8:11], s37 offen sc1 lds
v_add_u32 v10, 49152, v6
v_add_u32 v11, 49152, v7
v_add_u32 v12, 49152, v8
v_add_u32 v13, 98304, v5
s_add_u32 m0, s39, 113664
s_add_u32 s37, s37, s38
buffer_load_dwordx4 v23, s[8:11], s37 offen sc1 lds
v_add_u32 v14, 98304, v6
v_add_u32 v15, 98304, v7
v_add_u32 v16, 98304, v8
s_waitcnt vmcnt(17)
s_barrier
s_add_u32 m0, s39, 0
s_add_u32 s37, s37, s38
buffer_load_dwordx4 v22, s[8:11], s37 offen sc1 lds
v_mul_f32 v86, v86, v150
v_mul_f32 v87, v87, v151
v_exp_f32 v84, v84
v_exp_f32 v85, v85
s_add_u32 m0, s39, 1024
s_add_u32 s37, s37, s38
buffer_load_dwordx4 v23, s[8:11], s37 offen sc1 lds
v_exp_f32 v86, v86
v_exp_f32 v87, v87
v_mul_f32 v212, v148, v212
s_add_u32 m0, s39, 2048
s_add_u32 s37, s37, s38
buffer_load_dwordx4 v22, s[8:11], s37 offen sc1 lds
v_mul_f32 v213, v149, v213
v_mul_f32 v214, v150, v214
v_mul_f32 v215, v151, v215
s_add_u32 m0, s39, 3072
s_add_u32 s37, s37, s38
buffer_load_dwordx4 v23, s[8:11], s37 offen sc1 lds
v_fma_f32 v84, v84, v45, v45
v_fma_f32 v85, v85, v45, v45
v_fma_f32 v86, v86, v45, v45
s_add_u32 m0, s39, 4096
s_add_u32 s37, s37, s38
buffer_load_dwordx4 v22, s[8:11], s37 offen sc1 lds
v_fma_f32 v87, v87, v45, v45
v_rcp_f32 v84, v84
v_rcp_f32 v85, v85
s_add_u32 m0, s39, 5120
s_add_u32 s37, s37, s38
buffer_load_dwordx4 v23, s[8:11], s37 offen sc1 lds
v_rcp_f32 v86, v86
v_rcp_f32 v87, v87
v_mul_f32 v212, v212, v84
s_add_u32 m0, s39, 6144
s_add_u32 s37, s37, s38
buffer_load_dwordx4 v22, s[8:11], s37 offen sc1 lds
v_mul_f32 v213, v213, v85
v_mul_f32 v214, v214, v86
v_mul_f32 v215, v215, v87
s_add_u32 m0, s39, 7168
s_add_u32 s37, s37, s38
buffer_load_dwordx4 v23, s[8:11], s37 offen sc1 lds
v_cvt_pk_bf16_f32 v102, v212, v213
v_cvt_pk_bf16_f32 v103, v214, v215
s_add_u32 m0, s39, 8192
s_add_u32 s37, s37, s38
buffer_load_dwordx4 v22, s[8:11], s37 offen sc1 lds
v_fma_f32 v136, -v34, v48, v136
v_fma_f32 v137, -v34, v49, v137
v_fma_f32 v138, -v34, v50, v138
s_add_u32 m0, s39, 9216
s_add_u32 s37, s37, s38
buffer_load_dwordx4 v23, s[8:11], s37 offen sc1 lds
v_fma_f32 v139, -v34, v51, v139
v_fma_f32 v200, -v34, v64, v200
v_fma_f32 v201, -v34, v65, v201
s_add_u32 m0, s39, 10240
s_add_u32 s37, s37, s38
buffer_load_dwordx4 v22, s[8:11], s37 offen sc1 lds
v_fma_f32 v202, -v34, v66, v202
v_fma_f32 v203, -v34, v67, v203
v_mul_f32 v80, v136, v136
s_add_u32 m0, s39, 11264
s_add_u32 s37, s37, s38
buffer_load_dwordx4 v23, s[8:11], s37 offen sc1 lds
v_mul_f32 v81, v137, v137
v_mul_f32 v82, v138, v138
v_mul_f32 v83, v139, v139
s_add_u32 m0, s39, 12288
s_add_u32 s37, s37, s38
buffer_load_dwordx4 v22, s[8:11], s37 offen sc1 lds
v_fma_f32 v80, v80, v42, v38
v_fma_f32 v81, v81, v42, v38
v_fma_f32 v82, v82, v42, v38
s_add_u32 m0, s39, 13312
s_add_u32 s37, s37, s38
buffer_load_dwordx4 v23, s[8:11], s37 offen sc1 lds
v_fma_f32 v83, v83, v42, v38
v_mul_f32 v80, v80, v136
v_mul_f32 v81, v81, v137
s_add_u32 m0, s39, 14336
s_add_u32 s37, s37, s38
buffer_load_dwordx4 v22, s[8:11], s37 offen sc1 lds
v_mul_f32 v82, v82, v138
v_mul_f32 v83, v83, v139
v_exp_f32 v80, v80
s_add_u32 m0, s39, 15360
s_add_u32 s37, s37, s38
buffer_load_dwordx4 v23, s[8:11], s37 offen sc1 lds
v_exp_f32 v81, v81
v_exp_f32 v82, v82
v_exp_f32 v83, v83
buffer_store_dwordx4 v[100:103], v27, s[24:27], 0 offen offset:256 sc1
s_waitcnt vmcnt(17)
s_barrier
s_add_u32 m0, s39, 49152
s_add_u32 s37, s37, s38
buffer_load_dwordx4 v22, s[8:11], s37 offen sc1 lds
v_mul_f32 v200, v136, v200
v_mul_f32 v201, v137, v201
v_mul_f32 v202, v138, v202
s_add_u32 m0, s39, 50176
s_add_u32 s37, s37, s38
buffer_load_dwordx4 v23, s[8:11], s37 offen sc1 lds
v_mul_f32 v203, v139, v203
v_fma_f32 v80, v80, v46, v46
v_fma_f32 v81, v81, v46, v46
s_add_u32 m0, s39, 51200
s_add_u32 s37, s37, s38
buffer_load_dwordx4 v22, s[8:11], s37 offen sc1 lds
v_fma_f32 v82, v82, v46, v46
v_fma_f32 v83, v83, v46, v46
v_rcp_f32 v80, v80
s_add_u32 m0, s39, 52224
s_add_u32 s37, s37, s38
buffer_load_dwordx4 v23, s[8:11], s37 offen sc1 lds
v_rcp_f32 v81, v81
v_rcp_f32 v82, v82
v_rcp_f32 v83, v83
s_add_u32 m0, s39, 53248
s_add_u32 s37, s37, s38
buffer_load_dwordx4 v22, s[8:11], s37 offen sc1 lds
v_mul_f32 v200, v200, v80
v_mul_f32 v201, v201, v81
v_mul_f32 v202, v202, v82
s_add_u32 m0, s39, 54272
s_add_u32 s37, s37, s38
buffer_load_dwordx4 v23, s[8:11], s37 offen sc1 lds
v_mul_f32 v203, v203, v83
v_cvt_pk_bf16_f32 v104, v200, v201
v_cvt_pk_bf16_f32 v105, v202, v203
s_add_u32 m0, s39, 55296
s_add_u32 s37, s37, s38
buffer_load_dwordx4 v22, s[8:11], s37 offen sc1 lds
v_fma_f32 v152, -v34, v52, v152
v_fma_f32 v153, -v34, v53, v153
v_fma_f32 v154, -v34, v54, v154
s_add_u32 m0, s39, 56320
s_add_u32 s37, s37, s38
buffer_load_dwordx4 v23, s[8:11], s37 offen sc1 lds
v_fma_f32 v155, -v34, v55, v155
v_fma_f32 v216, -v34, v68, v216
v_fma_f32 v217, -v34, v69, v217
s_add_u32 m0, s39, 57344
s_add_u32 s37, s37, s38
buffer_load_dwordx4 v22, s[8:11], s37 offen sc1 lds
v_fma_f32 v218, -v34, v70, v218
v_fma_f32 v219, -v34, v71, v219
v_mul_f32 v84, v152, v152
s_add_u32 m0, s39, 58368
s_add_u32 s37, s37, s38
buffer_load_dwordx4 v23, s[8:11], s37 offen sc1 lds
v_mul_f32 v85, v153, v153
v_mul_f32 v86, v154, v154
v_mul_f32 v87, v155, v155
s_add_u32 m0, s39, 59392
s_add_u32 s37, s37, s38
buffer_load_dwordx4 v22, s[8:11], s37 offen sc1 lds
v_fma_f32 v84, v84, v42, v38
v_fma_f32 v85, v85, v42, v38
v_fma_f32 v86, v86, v42, v38
s_add_u32 m0, s39, 60416
s_add_u32 s37, s37, s38
buffer_load_dwordx4 v23, s[8:11], s37 offen sc1 lds
v_fma_f32 v87, v87, v42, v38
v_mul_f32 v84, v84, v152
v_mul_f32 v85, v85, v153
s_add_u32 m0, s39, 61440
s_add_u32 s37, s37, s38
buffer_load_dwordx4 v22, s[8:11], s37 offen sc1 lds
v_mul_f32 v86, v86, v154
v_mul_f32 v87, v87, v155
v_exp_f32 v84, v84
s_add_u32 m0, s39, 62464
s_add_u32 s37, s37, s38
buffer_load_dwordx4 v23, s[8:11], s37 offen sc1 lds
v_exp_f32 v85, v85
v_exp_f32 v86, v86
v_exp_f32 v87, v87
s_add_u32 m0, s39, 63488
s_add_u32 s37, s37, s38
buffer_load_dwordx4 v22, s[8:11], s37 offen sc1 lds
v_mul_f32 v216, v152, v216
v_mul_f32 v217, v153, v217
v_mul_f32 v218, v154, v218
s_add_u32 m0, s39, 64512
s_add_u32 s37, s37, s38
buffer_load_dwordx4 v23, s[8:11], s37 offen sc1 lds
v_mul_f32 v219, v155, v219
v_fma_f32 v84, v84, v46, v46
v_fma_f32 v85, v85, v46, v46
s_waitcnt vmcnt(17)
s_barrier
s_add_u32 m0, s39, 98304
s_add_u32 s37, s37, s38
buffer_load_dwordx4 v22, s[8:11], s37 offen sc1 lds
v_fma_f32 v86, v86, v46, v46
v_fma_f32 v87, v87, v46, v46
v_rcp_f32 v84, v84
v_rcp_f32 v85, v85
s_add_u32 m0, s39, 99328
s_add_u32 s37, s37, s38
buffer_load_dwordx4 v23, s[8:11], s37 offen sc1 lds
v_rcp_f32 v86, v86
v_rcp_f32 v87, v87
v_mul_f32 v216, v216, v84
s_add_u32 m0, s39, 100352
s_add_u32 s37, s37, s38
buffer_load_dwordx4 v22, s[8:11], s37 offen sc1 lds
v_mul_f32 v217, v217, v85
v_mul_f32 v218, v218, v86
v_mul_f32 v219, v219, v87
s_add_u32 m0, s39, 101376
s_add_u32 s37, s37, s38
buffer_load_dwordx4 v23, s[8:11], s37 offen sc1 lds
v_cvt_pk_bf16_f32 v106, v216, v217
v_cvt_pk_bf16_f32 v107, v218, v219
s_add_u32 m0, s39, 102400
s_add_u32 s37, s37, s38
buffer_load_dwordx4 v22, s[8:11], s37 offen sc1 lds
v_fma_f32 v140, -v35, v48, v140
v_fma_f32 v141, -v35, v49, v141
v_fma_f32 v142, -v35, v50, v142
s_add_u32 m0, s39, 103424
s_add_u32 s37, s37, s38
buffer_load_dwordx4 v23, s[8:11], s37 offen sc1 lds
v_fma_f32 v143, -v35, v51, v143
v_fma_f32 v204, -v35, v64, v204
v_fma_f32 v205, -v35, v65, v205
s_add_u32 m0, s39, 104448
s_add_u32 s37, s37, s38
buffer_load_dwordx4 v22, s[8:11], s37 offen sc1 lds
v_fma_f32 v206, -v35, v66, v206
v_fma_f32 v207, -v35, v67, v207
v_mul_f32 v80, v140, v140
s_add_u32 m0, s39, 105472
s_add_u32 s37, s37, s38
buffer_load_dwordx4 v23, s[8:11], s37 offen sc1 lds
v_mul_f32 v81, v141, v141
v_mul_f32 v82, v142, v142
v_mul_f32 v83, v143, v143
s_add_u32 m0, s39, 106496
s_add_u32 s37, s37, s38
buffer_load_dwordx4 v22, s[8:11], s37 offen sc1 lds
v_fma_f32 v80, v80, v43, v39
v_fma_f32 v81, v81, v43, v39
v_fma_f32 v82, v82, v43, v39
s_add_u32 m0, s39, 107520
s_add_u32 s37, s37, s38
buffer_load_dwordx4 v23, s[8:11], s37 offen sc1 lds
v_fma_f32 v83, v83, v43, v39
v_mul_f32 v80, v80, v140
v_mul_f32 v81, v81, v141
s_add_u32 m0, s39, 108544
s_add_u32 s37, s37, s38
buffer_load_dwordx4 v22, s[8:11], s37 offen sc1 lds
v_mul_f32 v82, v82, v142
v_mul_f32 v83, v83, v143
v_exp_f32 v80, v80
s_add_u32 m0, s39, 109568
s_add_u32 s37, s37, s38
buffer_load_dwordx4 v23, s[8:11], s37 offen sc1 lds
v_exp_f32 v81, v81
v_exp_f32 v82, v82
v_exp_f32 v83, v83
s_add_u32 m0, s39, 110592
s_add_u32 s37, s37, s38
buffer_load_dwordx4 v22, s[8:11], s37 offen sc1 lds
v_mul_f32 v204, v140, v204
v_mul_f32 v205, v141, v205
v_mul_f32 v206, v142, v206
s_add_u32 m0, s39, 111616
s_add_u32 s37, s37, s38
buffer_load_dwordx4 v23, s[8:11], s37 offen sc1 lds
v_mul_f32 v207, v143, v207
v_fma_f32 v80, v80, v47, v47
v_fma_f32 v81, v81, v47, v47
s_add_u32 m0, s39, 112640
s_add_u32 s37, s37, s38
buffer_load_dwordx4 v22, s[8:11], s37 offen sc1 lds
v_fma_f32 v82, v82, v47, v47
v_fma_f32 v83, v83, v47, v47
v_rcp_f32 v80, v80
s_add_u32 m0, s39, 113664
s_add_u32 s37, s37, s38
buffer_load_dwordx4 v23, s[8:11], s37 offen sc1 lds
v_rcp_f32 v81, v81
v_rcp_f32 v82, v82
v_rcp_f32 v83, v83
buffer_store_dwordx4 v[104:107], v27, s[24:27], 0 offen offset:512 sc1
s_waitcnt vmcnt(17)
s_barrier
s_add_u32 m0, s39, 0
s_add_u32 s37, s37, s38
buffer_load_dwordx4 v22, s[8:11], s37 offen sc1 lds
v_mul_f32 v204, v204, v80
v_mul_f32 v205, v205, v81
v_mul_f32 v206, v206, v82
v_mul_f32 v207, v207, v83
s_add_u32 m0, s39, 1024
s_add_u32 s37, s37, s38
buffer_load_dwordx4 v23, s[8:11], s37 offen sc1 lds
v_cvt_pk_bf16_f32 v108, v204, v205
v_cvt_pk_bf16_f32 v109, v206, v207
v_fma_f32 v156, -v35, v52, v156
s_add_u32 m0, s39, 2048
s_add_u32 s37, s37, s38
buffer_load_dwordx4 v22, s[8:11], s37 offen sc1 lds
v_fma_f32 v157, -v35, v53, v157
v_fma_f32 v158, -v35, v54, v158
v_fma_f32 v159, -v35, v55, v159
s_add_u32 m0, s39, 3072
s_add_u32 s37, s37, s38
buffer_load_dwordx4 v23, s[8:11], s37 offen sc1 lds
v_fma_f32 v220, -v35, v68, v220
v_fma_f32 v221, -v35, v69, v221
v_fma_f32 v222, -v35, v70, v222
s_add_u32 m0, s39, 4096
s_add_u32 s37, s37, s38
buffer_load_dwordx4 v22, s[8:11], s37 offen sc1 lds
v_fma_f32 v223, -v35, v71, v223
v_mul_f32 v84, v156, v156
v_mul_f32 v85, v157, v157
s_add_u32 m0, s39, 5120
s_add_u32 s37, s37, s38
buffer_load_dwordx4 v23, s[8:11], s37 offen sc1 lds
v_mul_f32 v86, v158, v158
v_mul_f32 v87, v159, v159
v_fma_f32 v84, v84, v43, v39
s_add_u32 m0, s39, 6144
s_add_u32 s37, s37, s38
buffer_load_dwordx4 v22, s[8:11], s37 offen sc1 lds
v_fma_f32 v85, v85, v43, v39
v_fma_f32 v86, v86, v43, v39
v_fma_f32 v87, v87, v43, v39
s_add_u32 m0, s39, 7168
s_add_u32 s37, s37, s38
buffer_load_dwordx4 v23, s[8:11], s37 offen sc1 lds
v_mul_f32 v84, v84, v156
v_mul_f32 v85, v85, v157
v_mul_f32 v86, v86, v158
s_add_u32 m0, s39, 8192
s_add_u32 s37, s37, s38
buffer_load_dwordx4 v22, s[8:11], s37 offen sc1 lds
v_mul_f32 v87, v87, v159
v_exp_f32 v84, v84
v_exp_f32 v85, v85
s_add_u32 m0, s39, 9216
s_add_u32 s37, s37, s38
buffer_load_dwordx4 v23, s[8:11], s37 offen sc1 lds
v_exp_f32 v86, v86
v_exp_f32 v87, v87
v_mul_f32 v220, v156, v220
s_add_u32 m0, s39, 10240
s_add_u32 s37, s37, s38
buffer_load_dwordx4 v22, s[8:11], s37 offen sc1 lds
v_mul_f32 v221, v157, v221
v_mul_f32 v222, v158, v222
v_mul_f32 v223, v159, v223
s_add_u32 m0, s39, 11264
s_add_u32 s37, s37, s38
buffer_load_dwordx4 v23, s[8:11], s37 offen sc1 lds
v_fma_f32 v84, v84, v47, v47
v_fma_f32 v85, v85, v47, v47
v_fma_f32 v86, v86, v47, v47
s_add_u32 m0, s39, 12288
s_add_u32 s37, s37, s38
buffer_load_dwordx4 v22, s[8:11], s37 offen sc1 lds
v_fma_f32 v87, v87, v47, v47
v_rcp_f32 v84, v84
v_rcp_f32 v85, v85
s_add_u32 m0, s39, 13312
s_add_u32 s37, s37, s38
buffer_load_dwordx4 v23, s[8:11], s37 offen sc1 lds
v_rcp_f32 v86, v86
v_rcp_f32 v87, v87
v_mul_f32 v220, v220, v84
s_add_u32 m0, s39, 14336
s_add_u32 s37, s37, s38
buffer_load_dwordx4 v22, s[8:11], s37 offen sc1 lds
v_mul_f32 v221, v221, v85
v_mul_f32 v222, v222, v86
v_mul_f32 v223, v223, v87
s_add_u32 m0, s39, 15360
s_add_u32 s37, s37, s38
buffer_load_dwordx4 v23, s[8:11], s37 offen sc1 lds
v_cvt_pk_bf16_f32 v110, v220, v221
v_cvt_pk_bf16_f32 v111, v222, v223
buffer_store_dwordx4 v[108:111], v27, s[24:27], 0 offen offset:768 sc1
s_waitcnt vmcnt(18)
s_barrier
s_add_u32 m0, s39, 49152
s_add_u32 s37, s37, s38
buffer_load_dwordx4 v22, s[8:11], s37 offen sc1 lds
v_fma_f32 v160, -v32, v56, v160
v_fma_f32 v161, -v32, v57, v161
v_fma_f32 v162, -v32, v58, v162
v_fma_f32 v163, -v32, v59, v163
s_add_u32 m0, s39, 50176
s_add_u32 s37, s37, s38
buffer_load_dwordx4 v23, s[8:11], s37 offen sc1 lds
v_fma_f32 v224, -v32, v72, v224
v_fma_f32 v225, -v32, v73, v225
v_fma_f32 v226, -v32, v74, v226
s_add_u32 m0, s39, 51200
s_add_u32 s37, s37, s38
buffer_load_dwordx4 v22, s[8:11], s37 offen sc1 lds
v_fma_f32 v227, -v32, v75, v227
v_mul_f32 v80, v160, v160
v_mul_f32 v81, v161, v161
v_mul_f32 v82, v162, v162
s_add_u32 m0, s39, 52224
s_add_u32 s37, s37, s38
buffer_load_dwordx4 v23, s[8:11], s37 offen sc1 lds
v_mul_f32 v83, v163, v163
v_fma_f32 v80, v80, v40, v36
v_fma_f32 v81, v81, v40, v36
s_add_u32 m0, s39, 53248
s_add_u32 s37, s37, s38
buffer_load_dwordx4 v22, s[8:11], s37 offen sc1 lds
v_fma_f32 v82, v82, v40, v36
v_fma_f32 v83, v83, v40, v36
v_mul_f32 v80, v80, v160
v_mul_f32 v81, v81, v161
s_add_u32 m0, s39, 54272
s_add_u32 s37, s37, s38
buffer_load_dwordx4 v23, s[8:11], s37 offen sc1 lds
v_mul_f32 v82, v82, v162
v_mul_f32 v83, v83, v163
v_exp_f32 v80, v80
s_add_u32 m0, s39, 55296
s_add_u32 s37, s37, s38
buffer_load_dwordx4 v22, s[8:11], s37 offen sc1 lds
v_exp_f32 v81, v81
v_exp_f32 v82, v82
v_exp_f32 v83, v83
v_mul_f32 v224, v160, v224
s_add_u32 m0, s39, 56320
s_add_u32 s37, s37, s38
buffer_load_dwordx4 v23, s[8:11], s37 offen sc1 lds
v_mul_f32 v225, v161, v225
v_mul_f32 v226, v162, v226
v_mul_f32 v227, v163, v227
s_add_u32 m0, s39, 57344
s_add_u32 s37, s37, s38
buffer_load_dwordx4 v22, s[8:11], s37 offen sc1 lds
v_fma_f32 v80, v80, v44, v44
v_fma_f32 v81, v81, v44, v44
v_fma_f32 v82, v82, v44, v44
v_fma_f32 v83, v83, v44, v44
s_add_u32 m0, s39, 58368
s_add_u32 s37, s37, s38
buffer_load_dwordx4 v23, s[8:11], s37 offen sc1 lds
v_rcp_f32 v80, v80
v_rcp_f32 v81, v81
v_rcp_f32 v82, v82
s_add_u32 m0, s39, 59392
s_add_u32 s37, s37, s38
buffer_load_dwordx4 v22, s[8:11], s37 offen sc1 lds
v_rcp_f32 v83, v83
v_mul_f32 v224, v224, v80
v_mul_f32 v225, v225, v81
v_mul_f32 v226, v226, v82
s_add_u32 m0, s39, 60416
s_add_u32 s37, s37, s38
buffer_load_dwordx4 v23, s[8:11], s37 offen sc1 lds
v_mul_f32 v227, v227, v83
v_cvt_pk_bf16_f32 v96, v224, v225
v_cvt_pk_bf16_f32 v97, v226, v227
s_add_u32 m0, s39, 61440
s_add_u32 s37, s37, s38
buffer_load_dwordx4 v22, s[8:11], s37 offen sc1 lds
v_fma_f32 v176, -v32, v60, v176
v_fma_f32 v177, -v32, v61, v177
v_fma_f32 v178, -v32, v62, v178
v_fma_f32 v179, -v32, v63, v179
s_add_u32 m0, s39, 62464
s_add_u32 s37, s37, s38
buffer_load_dwordx4 v23, s[8:11], s37 offen sc1 lds
v_fma_f32 v240, -v32, v76, v240
v_fma_f32 v241, -v32, v77, v241
v_lshlrev_b32 v19, 11, v18
s_add_u32 m0, s39, 63488
s_add_u32 s37, s37, s38
buffer_load_dwordx4 v22, s[8:11], s37 offen sc1 lds
v_lshl_add_u32 v19, v17, 4, v19
s_lshl_b32 s43, s36, 9
v_add_u32 v208, s43, v19
buffer_load_dwordx4 v[192:195], v208, s[20:23], 0 offen offset:0 sc1
s_add_u32 m0, s39, 64512
s_add_u32 s37, s37, s38
buffer_load_dwordx4 v23, s[8:11], s37 offen sc1 lds
buffer_load_dwordx4 v[196:199], v208, s[20:23], s50 offen offset:0 sc1
buffer_load_dwordx4 v[200:203], v208, s[20:23], 0 offen offset:256 sc1
buffer_load_dwordx4 v[204:207], v208, s[20:23], s50 offen offset:256 sc1
s_waitcnt vmcnt(20)
s_barrier
s_add_u32 m0, s39, 98304
s_add_u32 s37, s37, s38
buffer_load_dwordx4 v22, s[8:11], s37 offen sc1 lds
v_fma_f32 v242, -v32, v78, v242
v_fma_f32 v243, -v32, v79, v243
v_mul_f32 v84, v176, v176
v_mul_f32 v85, v177, v177
s_add_u32 m0, s39, 99328
s_add_u32 s37, s37, s38
buffer_load_dwordx4 v23, s[8:11], s37 offen sc1 lds
v_mul_f32 v86, v178, v178
v_mul_f32 v87, v179, v179
v_fma_f32 v84, v84, v40, v36
s_add_u32 m0, s39, 100352
s_add_u32 s37, s37, s38
buffer_load_dwordx4 v22, s[8:11], s37 offen sc1 lds
v_fma_f32 v85, v85, v40, v36
v_fma_f32 v86, v86, v40, v36
v_fma_f32 v87, v87, v40, v36
s_add_u32 m0, s39, 101376
s_add_u32 s37, s37, s38
buffer_load_dwordx4 v23, s[8:11], s37 offen sc1 lds
v_mul_f32 v84, v84, v176
v_mul_f32 v85, v85, v177
v_mul_f32 v86, v86, v178
s_add_u32 m0, s39, 102400
s_add_u32 s37, s37, s38
buffer_load_dwordx4 v22, s[8:11], s37 offen sc1 lds
v_mul_f32 v87, v87, v179
v_exp_f32 v84, v84
v_exp_f32 v85, v85
s_add_u32 m0, s39, 103424
s_add_u32 s37, s37, s38
buffer_load_dwordx4 v23, s[8:11], s37 offen sc1 lds
v_exp_f32 v86, v86
v_exp_f32 v87, v87
v_mul_f32 v240, v176, v240
s_add_u32 m0, s39, 104448
s_add_u32 s37, s37, s38
buffer_load_dwordx4 v22, s[8:11], s37 offen sc1 lds
v_mul_f32 v241, v177, v241
v_mul_f32 v242, v178, v242
v_mul_f32 v243, v179, v243
s_add_u32 m0, s39, 105472
s_add_u32 s37, s37, s38
buffer_load_dwordx4 v23, s[8:11], s37 offen sc1 lds
v_fma_f32 v84, v84, v44, v44
v_fma_f32 v85, v85, v44, v44
v_fma_f32 v86, v86, v44, v44
s_add_u32 m0, s39, 106496
s_add_u32 s37, s37, s38
buffer_load_dwordx4 v22, s[8:11], s37 offen sc1 lds
v_fma_f32 v87, v87, v44, v44
v_rcp_f32 v84, v84
v_rcp_f32 v85, v85
s_add_u32 m0, s39, 107520
s_add_u32 s37, s37, s38
buffer_load_dwordx4 v23, s[8:11], s37 offen sc1 lds
v_rcp_f32 v86, v86
v_rcp_f32 v87, v87
v_mul_f32 v240, v240, v84
s_add_u32 m0, s39, 108544
s_add_u32 s37, s37, s38
buffer_load_dwordx4 v22, s[8:11], s37 offen sc1 lds
v_mul_f32 v241, v241, v85
v_mul_f32 v242, v242, v86
v_mul_f32 v243, v243, v87
s_add_u32 m0, s39, 109568
s_add_u32 s37, s37, s38
buffer_load_dwordx4 v23, s[8:11], s37 offen sc1 lds
v_cvt_pk_bf16_f32 v98, v240, v241
v_cvt_pk_bf16_f32 v99, v242, v243
s_add_u32 m0, s39, 110592
s_add_u32 s37, s37, s38
buffer_load_dwordx4 v22, s[8:11], s37 offen sc1 lds
v_fma_f32 v164, -v33, v56, v164
v_fma_f32 v165, -v33, v57, v165
v_fma_f32 v166, -v33, v58, v166
s_add_u32 m0, s39, 111616
s_add_u32 s37, s37, s38
buffer_load_dwordx4 v23, s[8:11], s37 offen sc1 lds
v_fma_f32 v167, -v33, v59, v167
v_fma_f32 v228, -v33, v72, v228
v_fma_f32 v229, -v33, v73, v229
s_add_u32 m0, s39, 112640
s_add_u32 s37, s37, s38
buffer_load_dwordx4 v22, s[8:11], s37 offen sc1 lds
v_fma_f32 v230, -v33, v74, v230
v_fma_f32 v231, -v33, v75, v231
v_mul_f32 v80, v164, v164
s_add_u32 m0, s39, 113664
s_add_u32 s37, s37, s38
buffer_load_dwordx4 v23, s[8:11], s37 offen sc1 lds
v_mul_f32 v81, v165, v165
v_mul_f32 v82, v166, v166
v_mul_f32 v83, v167, v167
buffer_store_dwordx4 v[96:99], v27, s[24:27], s53 offen offset:0 sc1
s_waitcnt vmcnt(20)
s_barrier
s_add_u32 m0, s39, 0
s_add_u32 s37, s37, s38
buffer_load_dwordx4 v22, s[8:11], s37 offen sc1 lds
v_fma_f32 v80, v80, v41, v37
v_fma_f32 v81, v81, v41, v37
v_fma_f32 v82, v82, v41, v37
s_add_u32 m0, s39, 1024
s_add_u32 s37, s37, s38
buffer_load_dwordx4 v23, s[8:11], s37 offen sc1 lds
v_fma_f32 v83, v83, v41, v37
v_mul_f32 v80, v80, v164
v_mul_f32 v81, v81, v165
s_add_u32 m0, s39, 2048
s_add_u32 s37, s37, s38
buffer_load_dwordx4 v22, s[8:11], s37 offen sc1 lds
v_mul_f32 v82, v82, v166
v_mul_f32 v83, v83, v167
v_exp_f32 v80, v80
s_add_u32 m0, s39, 3072
s_add_u32 s37, s37, s38
buffer_load_dwordx4 v23, s[8:11], s37 offen sc1 lds
v_exp_f32 v81, v81
v_exp_f32 v82, v82
v_exp_f32 v83, v83
s_add_u32 m0, s39, 4096
s_add_u32 s37, s37, s38
buffer_load_dwordx4 v22, s[8:11], s37 offen sc1 lds
v_mul_f32 v228, v164, v228
v_mul_f32 v229, v165, v229
v_mul_f32 v230, v166, v230
s_add_u32 m0, s39, 5120
s_add_u32 s37, s37, s38
buffer_load_dwordx4 v23, s[8:11], s37 offen sc1 lds
v_mul_f32 v231, v167, v231
v_fma_f32 v80, v80, v45, v45
v_fma_f32 v81, v81, v45, v45
s_add_u32 m0, s39, 6144
s_add_u32 s37, s37, s38
buffer_load_dwordx4 v22, s[8:11], s37 offen sc1 lds
v_fma_f32 v82, v82, v45, v45
v_fma_f32 v83, v83, v45, v45
v_rcp_f32 v80, v80
s_add_u32 m0, s39, 7168
s_add_u32 s37, s37, s38
buffer_load_dwordx4 v23, s[8:11], s37 offen sc1 lds
v_rcp_f32 v81, v81
v_rcp_f32 v82, v82
v_rcp_f32 v83, v83
s_add_u32 m0, s39, 8192
s_add_u32 s37, s37, s38
buffer_load_dwordx4 v22, s[8:11], s37 offen sc1 lds
v_mul_f32 v228, v228, v80
v_mul_f32 v229, v229, v81
v_mul_f32 v230, v230, v82
s_add_u32 m0, s39, 9216
s_add_u32 s37, s37, s38
buffer_load_dwordx4 v23, s[8:11], s37 offen sc1 lds
v_mul_f32 v231, v231, v83
v_cvt_pk_bf16_f32 v100, v228, v229
v_cvt_pk_bf16_f32 v101, v230, v231
s_add_u32 m0, s39, 10240
s_add_u32 s37, s37, s38
buffer_load_dwordx4 v22, s[8:11], s37 offen sc1 lds
v_fma_f32 v180, -v33, v60, v180
v_fma_f32 v181, -v33, v61, v181
v_fma_f32 v182, -v33, v62, v182
s_add_u32 m0, s39, 11264
s_add_u32 s37, s37, s38
buffer_load_dwordx4 v23, s[8:11], s37 offen sc1 lds
v_fma_f32 v183, -v33, v63, v183
v_fma_f32 v244, -v33, v76, v244
v_fma_f32 v245, -v33, v77, v245
s_add_u32 m0, s39, 12288
s_add_u32 s37, s37, s38
buffer_load_dwordx4 v22, s[8:11], s37 offen sc1 lds
v_fma_f32 v246, -v33, v78, v246
v_fma_f32 v247, -v33, v79, v247
v_mul_f32 v84, v180, v180
s_add_u32 m0, s39, 13312
s_add_u32 s37, s37, s38
buffer_load_dwordx4 v23, s[8:11], s37 offen sc1 lds
v_mul_f32 v85, v181, v181
v_mul_f32 v86, v182, v182
v_mul_f32 v87, v183, v183
s_add_u32 m0, s39, 14336
s_add_u32 s37, s37, s38
buffer_load_dwordx4 v22, s[8:11], s37 offen sc1 lds
v_fma_f32 v84, v84, v41, v37
v_fma_f32 v85, v85, v41, v37
v_fma_f32 v86, v86, v41, v37
s_add_u32 m0, s39, 15360
s_add_u32 s37, s37, s38
buffer_load_dwordx4 v23, s[8:11], s37 offen sc1 lds
v_fma_f32 v87, v87, v41, v37
v_mul_f32 v84, v84, v180
v_mul_f32 v85, v85, v181
s_waitcnt vmcnt(17)
s_barrier
s_add_u32 m0, s39, 49152
s_add_u32 s37, s37, s38
buffer_load_dwordx4 v22, s[8:11], s37 offen sc1 lds
v_mul_f32 v86, v86, v182
v_mul_f32 v87, v87, v183
v_exp_f32 v84, v84
v_exp_f32 v85, v85
v_exp_f32 v86, v86
s_add_u32 m0, s39, 50176
s_add_u32 s37, s37, s38
buffer_load_dwordx4 v23, s[8:11], s37 offen sc1 lds
v_exp_f32 v87, v87
v_mul_f32 v244, v180, v244
v_mul_f32 v245, v181, v245
v_mul_f32 v246, v182, v246
s_add_u32 m0, s39, 51200
s_add_u32 s37, s37, s38
buffer_load_dwordx4 v22, s[8:11], s37 offen sc1 lds
v_mul_f32 v247, v183, v247
v_fma_f32 v84, v84, v45, v45
v_fma_f32 v85, v85, v45, v45
v_fma_f32 v86, v86, v45, v45
s_add_u32 m0, s39, 52224
s_add_u32 s37, s37, s38
buffer_load_dwordx4 v23, s[8:11], s37 offen sc1 lds
v_fma_f32 v87, v87, v45, v45
v_rcp_f32 v84, v84
v_rcp_f32 v85, v85
v_rcp_f32 v86, v86
s_add_u32 m0, s39, 53248
s_add_u32 s37, s37, s38
buffer_load_dwordx4 v22, s[8:11], s37 offen sc1 lds
v_rcp_f32 v87, v87
v_mul_f32 v244, v244, v84
v_mul_f32 v245, v245, v85
v_mul_f32 v246, v246, v86
s_add_u32 m0, s39, 54272
s_add_u32 s37, s37, s38
buffer_load_dwordx4 v23, s[8:11], s37 offen sc1 lds
v_mul_f32 v247, v247, v87
v_cvt_pk_bf16_f32 v102, v244, v245
v_cvt_pk_bf16_f32 v103, v246, v247
s_add_u32 m0, s39, 55296
s_add_u32 s37, s37, s38
buffer_load_dwordx4 v22, s[8:11], s37 offen sc1 lds
v_fma_f32 v168, -v34, v56, v168
v_fma_f32 v169, -v34, v57, v169
v_fma_f32 v170, -v34, v58, v170
v_fma_f32 v171, -v34, v59, v171
s_add_u32 m0, s39, 56320
s_add_u32 s37, s37, s38
buffer_load_dwordx4 v23, s[8:11], s37 offen sc1 lds
v_fma_f32 v232, -v34, v72, v232
v_fma_f32 v233, -v34, v73, v233
v_fma_f32 v234, -v34, v74, v234
v_fma_f32 v235, -v34, v75, v235
s_add_u32 m0, s39, 57344
s_add_u32 s37, s37, s38
buffer_load_dwordx4 v22, s[8:11], s37 offen sc1 lds
v_mul_f32 v80, v168, v168
v_mul_f32 v81, v169, v169
v_mul_f32 v82, v170, v170
v_mul_f32 v83, v171, v171
s_add_u32 m0, s39, 58368
s_add_u32 s37, s37, s38
buffer_load_dwordx4 v23, s[8:11], s37 offen sc1 lds
v_fma_f32 v80, v80, v42, v38
v_fma_f32 v81, v81, v42, v38
v_fma_f32 v82, v82, v42, v38
v_fma_f32 v83, v83, v42, v38
s_add_u32 m0, s39, 59392
s_add_u32 s37, s37, s38
buffer_load_dwordx4 v22, s[8:11], s37 offen sc1 lds
v_mul_f32 v80, v80, v168
v_mul_f32 v81, v81, v169
v_mul_f32 v82, v82, v170
v_mul_f32 v83, v83, v171
s_add_u32 m0, s39, 60416
s_add_u32 s37, s37, s38
buffer_load_dwordx4 v23, s[8:11], s37 offen sc1 lds
v_exp_f32 v80, v80
v_exp_f32 v81, v81
v_exp_f32 v82, v82
v_exp_f32 v83, v83
s_add_u32 m0, s39, 61440
s_add_u32 s37, s37, s38
buffer_load_dwordx4 v22, s[8:11], s37 offen sc1 lds
v_lshlrev_b32 v128, 16, v192
v_and_b32 v129, 0xffff0000, v192
v_lshlrev_b32 v130, 16, v193
v_and_b32 v131, 0xffff0000, v193
s_add_u32 m0, s39, 62464
s_add_u32 s37, s37, s38
buffer_load_dwordx4 v23, s[8:11], s37 offen sc1 lds
v_lshlrev_b32 v132, 16, v194
v_and_b32 v133, 0xffff0000, v194
v_lshlrev_b32 v134, 16, v195
v_and_b32 v135, 0xffff0000, v195
s_add_u32 m0, s39, 63488
s_add_u32 s37, s37, s38
buffer_load_dwordx4 v22, s[8:11], s37 offen sc1 lds
v_lshlrev_b32 v136, 16, v196
v_and_b32 v137, 0xffff0000, v196
v_lshlrev_b32 v138, 16, v197
v_and_b32 v139, 0xffff0000, v197
s_add_u32 m0, s39, 64512
s_add_u32 s37, s37, s38
buffer_load_dwordx4 v23, s[8:11], s37 offen sc1 lds
v_lshlrev_b32 v140, 16, v198
v_and_b32 v141, 0xffff0000, v198
v_lshlrev_b32 v142, 16, v199
v_and_b32 v143, 0xffff0000, v199
buffer_store_dwordx4 v[100:103], v27, s[24:27], s53 offen offset:256 sc1
s_waitcnt vmcnt(17)
s_barrier
s_add_u32 m0, s39, 98304
s_add_u32 s37, s37, s38
buffer_load_dwordx4 v22, s[8:11], s37 offen sc1 lds
v_mul_f32 v232, v168, v232
v_mul_f32 v233, v169, v233
v_mul_f32 v234, v170, v234
v_mul_f32 v235, v171, v235
s_add_u32 m0, s39, 99328
s_add_u32 s37, s37, s38
buffer_load_dwordx4 v23, s[8:11], s37 offen sc1 lds
v_fma_f32 v80, v80, v46, v46
v_fma_f32 v81, v81, v46, v46
v_fma_f32 v82, v82, v46, v46
v_fma_f32 v83, v83, v46, v46
s_add_u32 m0, s39, 100352
s_add_u32 s37, s37, s38
buffer_load_dwordx4 v22, s[8:11], s37 offen sc1 lds
v_rcp_f32 v80, v80
v_rcp_f32 v81, v81
v_rcp_f32 v82, v82
v_rcp_f32 v83, v83
s_add_u32 m0, s39, 101376
s_add_u32 s37, s37, s38
buffer_load_dwordx4 v23, s[8:11], s37 offen sc1 lds
v_mul_f32 v232, v232, v80
v_mul_f32 v233, v233, v81
v_mul_f32 v234, v234, v82
v_mul_f32 v235, v235, v83
s_add_u32 m0, s39, 102400
s_add_u32 s37, s37, s38
buffer_load_dwordx4 v22, s[8:11], s37 offen sc1 lds
v_cvt_pk_bf16_f32 v104, v232, v233
v_cvt_pk_bf16_f32 v105, v234, v235
v_fma_f32 v184, -v34, v60, v184
v_fma_f32 v185, -v34, v61, v185
s_add_u32 m0, s39, 103424
s_add_u32 s37, s37, s38
buffer_load_dwordx4 v23, s[8:11], s37 offen sc1 lds
v_fma_f32 v186, -v34, v62, v186
v_fma_f32 v187, -v34, v63, v187
v_fma_f32 v248, -v34, v76, v248
v_fma_f32 v249, -v34, v77, v249
s_add_u32 m0, s39, 104448
s_add_u32 s37, s37, s38
buffer_load_dwordx4 v22, s[8:11], s37 offen sc1 lds
v_fma_f32 v250, -v34, v78, v250
v_fma_f32 v251, -v34, v79, v251
v_mul_f32 v84, v184, v184
v_mul_f32 v85, v185, v185
s_add_u32 m0, s39, 105472
s_add_u32 s37, s37, s38
buffer_load_dwordx4 v23, s[8:11], s37 offen sc1 lds
v_mul_f32 v86, v186, v186
v_mul_f32 v87, v187, v187
v_fma_f32 v84, v84, v42, v38
v_fma_f32 v85, v85, v42, v38
s_add_u32 m0, s39, 106496
s_add_u32 s37, s37, s38
buffer_load_dwordx4 v22, s[8:11], s37 offen sc1 lds
v_fma_f32 v86, v86, v42, v38
v_fma_f32 v87, v87, v42, v38
v_mul_f32 v84, v84, v184
v_mul_f32 v85, v85, v185
s_add_u32 m0, s39, 107520
s_add_u32 s37, s37, s38
buffer_load_dwordx4 v23, s[8:11], s37 offen sc1 lds
v_mul_f32 v86, v86, v186
v_mul_f32 v87, v87, v187
v_exp_f32 v84, v84
v_exp_f32 v85, v85
s_add_u32 m0, s39, 108544
s_add_u32 s37, s37, s38
buffer_load_dwordx4 v22, s[8:11], s37 offen sc1 lds
v_exp_f32 v86, v86
v_exp_f32 v87, v87
v_mul_f32 v248, v184, v248
v_mul_f32 v249, v185, v249
s_add_u32 m0, s39, 109568
s_add_u32 s37, s37, s38
buffer_load_dwordx4 v23, s[8:11], s37 offen sc1 lds
v_mul_f32 v250, v186, v250
v_mul_f32 v251, v187, v251
v_fma_f32 v84, v84, v46, v46
v_fma_f32 v85, v85, v46, v46
s_add_u32 m0, s39, 110592
s_add_u32 s37, s37, s38
buffer_load_dwordx4 v22, s[8:11], s37 offen sc1 lds
v_lshlrev_b32 v144, 16, v200
v_and_b32 v145, 0xffff0000, v200
v_lshlrev_b32 v146, 16, v201
v_and_b32 v147, 0xffff0000, v201
s_add_u32 m0, s39, 111616
s_add_u32 s37, s37, s38
buffer_load_dwordx4 v23, s[8:11], s37 offen sc1 lds
v_lshlrev_b32 v148, 16, v202
v_and_b32 v149, 0xffff0000, v202
v_lshlrev_b32 v150, 16, v203
v_and_b32 v151, 0xffff0000, v203
s_add_u32 m0, s39, 112640
s_add_u32 s37, s37, s38
buffer_load_dwordx4 v22, s[8:11], s37 offen sc1 lds
v_lshlrev_b32 v152, 16, v204
v_and_b32 v153, 0xffff0000, v204
v_lshlrev_b32 v154, 16, v205
v_and_b32 v155, 0xffff0000, v205
s_add_u32 m0, s39, 113664
s_add_u32 s37, s37, s38
buffer_load_dwordx4 v23, s[8:11], s37 offen sc1 lds
v_lshlrev_b32 v156, 16, v206
v_and_b32 v157, 0xffff0000, v206
v_lshlrev_b32 v158, 16, v207
v_and_b32 v159, 0xffff0000, v207
s_waitcnt vmcnt(17)
s_barrier
s_add_u32 m0, s39, 0
s_add_u32 s37, s37, s38
buffer_load_dwordx4 v22, s[8:11], s37 offen sc1 lds
v_fma_f32 v86, v86, v46, v46
v_fma_f32 v87, v87, v46, v46
v_rcp_f32 v84, v84
v_rcp_f32 v85, v85
s_add_u32 m0, s39, 1024
s_add_u32 s37, s37, s38
buffer_load_dwordx4 v23, s[8:11], s37 offen sc1 lds
v_rcp_f32 v86, v86
v_rcp_f32 v87, v87
v_mul_f32 v248, v248, v84
s_add_u32 m0, s39, 2048
s_add_u32 s37, s37, s38
buffer_load_dwordx4 v22, s[8:11], s37 offen sc1 lds
v_mul_f32 v249, v249, v85
v_mul_f32 v250, v250, v86
v_mul_f32 v251, v251, v87
s_add_u32 m0, s39, 3072
s_add_u32 s37, s37, s38
buffer_load_dwordx4 v23, s[8:11], s37 offen sc1 lds
v_cvt_pk_bf16_f32 v106, v248, v249
v_cvt_pk_bf16_f32 v107, v250, v251
s_add_u32 m0, s39, 4096
s_add_u32 s37, s37, s38
buffer_load_dwordx4 v22, s[8:11], s37 offen sc1 lds
v_fma_f32 v172, -v35, v56, v172
v_fma_f32 v173, -v35, v57, v173
v_fma_f32 v174, -v35, v58, v174
s_add_u32 m0, s39, 5120
s_add_u32 s37, s37, s38
buffer_load_dwordx4 v23, s[8:11], s37 offen sc1 lds
v_fma_f32 v175, -v35, v59, v175
v_fma_f32 v236, -v35, v72, v236
v_fma_f32 v237, -v35, v73, v237
s_add_u32 m0, s39, 6144
s_add_u32 s37, s37, s38
buffer_load_dwordx4 v22, s[8:11], s37 offen sc1 lds
v_fma_f32 v238, -v35, v74, v238
v_fma_f32 v239, -v35, v75, v239
v_mul_f32 v80, v172, v172
s_add_u32 m0, s39, 7168
s_add_u32 s37, s37, s38
buffer_load_dwordx4 v23, s[8:11], s37 offen sc1 lds
v_mul_f32 v81, v173, v173
v_mul_f32 v82, v174, v174
v_mul_f32 v83, v175, v175
s_add_u32 m0, s39, 8192
s_add_u32 s37, s37, s38
buffer_load_dwordx4 v22, s[8:11], s37 offen sc1 lds
v_fma_f32 v80, v80, v43, v39
v_fma_f32 v81, v81, v43, v39
v_fma_f32 v82, v82, v43, v39
s_add_u32 m0, s39, 9216
s_add_u32 s37, s37, s38
buffer_load_dwordx4 v23, s[8:11], s37 offen sc1 lds
v_fma_f32 v83, v83, v43, v39
v_mul_f32 v80, v80, v172
v_mul_f32 v81, v81, v173
s_add_u32 m0, s39, 10240
s_add_u32 s37, s37, s38
buffer_load_dwordx4 v22, s[8:11], s37 offen sc1 lds
v_mul_f32 v82, v82, v174
v_mul_f32 v83, v83, v175
v_exp_f32 v80, v80
s_add_u32 m0, s39, 11264
s_add_u32 s37, s37, s38
buffer_load_dwordx4 v23, s[8:11], s37 offen sc1 lds
v_exp_f32 v81, v81
v_exp_f32 v82, v82
v_exp_f32 v83, v83
s_add_u32 m0, s39, 12288
s_add_u32 s37, s37, s38
buffer_load_dwordx4 v22, s[8:11], s37 offen sc1 lds
v_mul_f32 v236, v172, v236
v_mul_f32 v237, v173, v237
v_mul_f32 v238, v174, v238
s_add_u32 m0, s39, 13312
s_add_u32 s37, s37, s38
buffer_load_dwordx4 v23, s[8:11], s37 offen sc1 lds
v_mul_f32 v239, v175, v239
v_fma_f32 v80, v80, v47, v47
v_fma_f32 v81, v81, v47, v47
s_add_u32 m0, s39, 14336
s_add_u32 s37, s37, s38
buffer_load_dwordx4 v22, s[8:11], s37 offen sc1 lds
v_fma_f32 v82, v82, v47, v47
v_fma_f32 v83, v83, v47, v47
v_rcp_f32 v80, v80
s_add_u32 m0, s39, 15360
s_add_u32 s37, s37, s38
buffer_load_dwordx4 v23, s[8:11], s37 offen sc1 lds
v_rcp_f32 v81, v81
v_rcp_f32 v82, v82
v_rcp_f32 v83, v83
buffer_store_dwordx4 v[104:107], v27, s[24:27], s53 offen offset:512 sc1
s_waitcnt vmcnt(17)
s_barrier
s_mul_i32 s44, s34, 917504
s_lshl_b32 s39, s51, 13
s_add_u32 s44, s44, s39
s_add_u32 s44, s44, 8388608
s_lshl_b32 s43, s35, 7
s_mov_b32 s10, 909312
s_movk_i32 s38, 1024
s_movk_i32 s40, 9216
s_cmp_eq_u32 s51, 2
s_cselect_b32 s8, s60, s32
s_cselect_b32 s9, s61, s33
s_cselect_b32 s10, 7338112, s10
s_cselect_b32 s43, s43, s44
s_cselect_b32 s38, 16384, s38
s_cselect_b32 s40, 81920, s40
s_cselect_b32 s55, 81920, s38
s_cselect_b32 s45, -1, 0
s_add_u32 s8, s8, s43
s_addc_u32 s9, s9, 0
s_mov_b32 s11, 0x20000
s_sub_u32 s37, 0, s40
v_lshrrev_b32 v19, 3, v1
v_mul_u32_u24 v19, 1920, v19
v_lshrrev_b32 v20, 4, v1
v_lshlrev_b32 v20, 5, v20
v_and_b32 v19, s45, v19
v_and_b32 v20, s45, v20
v_lshlrev_b32 v21, 4, v1
v_xor_b32 v21, v21, v20
v_add_u32 v21, v21, v19
s_add_u32 m0, s39, 49152
s_add_u32 s37, s37, s40
buffer_load_dwordx4 v21, s[8:11], s37 offen sc1 lds
v_mul_f32 v236, v236, v80
v_mul_f32 v237, v237, v81
v_mul_f32 v238, v238, v82
s_add_u32 m0, s39, 50176
s_add_u32 s37, s37, s38
buffer_load_dwordx4 v21, s[8:11], s37 offen sc1 lds
v_mul_f32 v239, v239, v83
v_cvt_pk_bf16_f32 v108, v236, v237
v_cvt_pk_bf16_f32 v109, v238, v239
s_add_u32 m0, s39, 51200
s_add_u32 s37, s37, s38
buffer_load_dwordx4 v21, s[8:11], s37 offen sc1 lds
v_fma_f32 v188, -v35, v60, v188
v_fma_f32 v189, -v35, v61, v189
v_fma_f32 v190, -v35, v62, v190
s_add_u32 m0, s39, 52224
s_add_u32 s37, s37, s38
buffer_load_dwordx4 v21, s[8:11], s37 offen sc1 lds
v_fma_f32 v191, -v35, v63, v191
v_fma_f32 v252, -v35, v76, v252
v_fma_f32 v253, -v35, v77, v253
s_add_u32 m0, s39, 53248
s_add_u32 s37, s37, s55
buffer_load_dwordx4 v21, s[8:11], s37 offen sc1 lds
v_fma_f32 v254, -v35, v78, v254
v_fma_f32 v255, -v35, v79, v255
v_mul_f32 v84, v188, v188
s_add_u32 m0, s39, 54272
s_add_u32 s37, s37, s38
buffer_load_dwordx4 v21, s[8:11], s37 offen sc1 lds
v_mul_f32 v85, v189, v189
v_mul_f32 v86, v190, v190
v_mul_f32 v87, v191, v191
s_add_u32 m0, s39, 55296
s_add_u32 s37, s37, s38
buffer_load_dwordx4 v21, s[8:11], s37 offen sc1 lds
v_fma_f32 v84, v84, v43, v39
v_fma_f32 v85, v85, v43, v39
v_fma_f32 v86, v86, v43, v39
s_add_u32 m0, s39, 56320
s_add_u32 s37, s37, s38
buffer_load_dwordx4 v21, s[8:11], s37 offen sc1 lds
v_fma_f32 v87, v87, v43, v39
v_mul_f32 v84, v84, v188
v_mul_f32 v85, v85, v189
s_add_u32 m0, s39, 73728
s_add_u32 s37, s37, s40
buffer_load_dwordx4 v21, s[8:11], s37 offen sc1 lds
v_mul_f32 v86, v86, v190
v_mul_f32 v87, v87, v191
v_exp_f32 v84, v84
v_exp_f32 v85, v85
s_add_u32 m0, s39, 74752
s_add_u32 s37, s37, s38
buffer_load_dwordx4 v21, s[8:11], s37 offen sc1 lds
v_exp_f32 v86, v86
v_exp_f32 v87, v87
v_mul_f32 v252, v188, v252
s_add_u32 m0, s39, 75776
s_add_u32 s37, s37, s38
buffer_load_dwordx4 v21, s[8:11], s37 offen sc1 lds
v_mul_f32 v253, v189, v253
v_mul_f32 v254, v190, v254
v_mul_f32 v255, v191, v255
s_add_u32 m0, s39, 76800
s_add_u32 s37, s37, s38
buffer_load_dwordx4 v21, s[8:11], s37 offen sc1 lds
v_fma_f32 v84, v84, v47, v47
v_fma_f32 v85, v85, v47, v47
v_fma_f32 v86, v86, v47, v47
s_add_u32 m0, s39, 77824
s_add_u32 s37, s37, s55
buffer_load_dwordx4 v21, s[8:11], s37 offen sc1 lds
v_fma_f32 v87, v87, v47, v47
v_rcp_f32 v84, v84
v_rcp_f32 v85, v85
s_add_u32 m0, s39, 78848
s_add_u32 s37, s37, s38
buffer_load_dwordx4 v21, s[8:11], s37 offen sc1 lds
v_rcp_f32 v86, v86
v_rcp_f32 v87, v87
v_mul_f32 v252, v252, v84
s_add_u32 m0, s39, 79872
s_add_u32 s37, s37, s38
buffer_load_dwordx4 v21, s[8:11], s37 offen sc1 lds
v_mul_f32 v253, v253, v85
v_mul_f32 v254, v254, v86
v_mul_f32 v255, v255, v87
s_add_u32 m0, s39, 80896
s_add_u32 s37, s37, s38
buffer_load_dwordx4 v21, s[8:11], s37 offen sc1 lds
v_cvt_pk_bf16_f32 v110, v252, v253
v_cvt_pk_bf16_f32 v111, v254, v255
buffer_store_dwordx4 v[108:111], v27, s[24:27], s53 offen offset:768 sc1
s_waitcnt vmcnt(18)
s_barrier
s_add_u32 m0, s39, 98304
s_add_u32 s37, s37, s40
buffer_load_dwordx4 v21, s[8:11], s37 offen sc1 lds
s_add_u32 m0, s39, 99328
s_add_u32 s37, s37, s38
buffer_load_dwordx4 v21, s[8:11], s37 offen sc1 lds
s_add_u32 m0, s39, 100352
s_add_u32 s37, s37, s38
buffer_load_dwordx4 v21, s[8:11], s37 offen sc1 lds
s_add_u32 m0, s39, 101376
s_add_u32 s37, s37, s38
buffer_load_dwordx4 v21, s[8:11], s37 offen sc1 lds
s_add_u32 m0, s39, 102400
s_add_u32 s37, s37, s55
buffer_load_dwordx4 v21, s[8:11], s37 offen sc1 lds
s_add_u32 m0, s39, 103424
s_add_u32 s37, s37, s38
buffer_load_dwordx4 v21, s[8:11], s37 offen sc1 lds
s_add_u32 m0, s39, 104448
s_add_u32 s37, s37, s38
buffer_load_dwordx4 v21, s[8:11], s37 offen sc1 lds
s_add_u32 m0, s39, 105472
s_add_u32 s37, s37, s38
buffer_load_dwordx4 v21, s[8:11], s37 offen sc1 lds
s_add_u32 m0, s39, 122880
s_add_u32 s37, s37, s40
buffer_load_dwordx4 v21, s[8:11], s37 offen sc1 lds
s_add_u32 m0, s39, 123904
s_add_u32 s37, s37, s38
buffer_load_dwordx4 v21, s[8:11], s37 offen sc1 lds
s_add_u32 m0, s39, 124928
s_add_u32 s37, s37, s38
buffer_load_dwordx4 v21, s[8:11], s37 offen sc1 lds
s_add_u32 m0, s39, 125952
s_add_u32 s37, s37, s38
buffer_load_dwordx4 v21, s[8:11], s37 offen sc1 lds
s_add_u32 m0, s39, 126976
s_add_u32 s37, s37, s55
buffer_load_dwordx4 v21, s[8:11], s37 offen sc1 lds
s_add_u32 m0, s39, 128000
s_add_u32 s37, s37, s38
buffer_load_dwordx4 v21, s[8:11], s37 offen sc1 lds
s_add_u32 m0, s39, 129024
s_add_u32 s37, s37, s38
buffer_load_dwordx4 v21, s[8:11], s37 offen sc1 lds
s_add_u32 m0, s39, 130048
s_add_u32 s37, s37, s38
buffer_load_dwordx4 v21, s[8:11], s37 offen sc1 lds
s_waitcnt vmcnt(16)
s_barrier
s_branch LK4_21
L3h_20:
v_mfma_f32_16x16x32_bf16 v[128:131], v[96:99], v[80:83], v[128:131]
v_mfma_f32_16x16x32_bf16 v[132:135], v[96:99], v[84:87], v[132:135]
v_mfma_f32_16x16x32_bf16 v[136:139], v[96:99], v[88:91], v[136:139]
v_mfma_f32_16x16x32_bf16 v[140:143], v[96:99], v[92:95], v[140:143]
v_mfma_f32_16x16x32_bf16 v[192:195], v[112:115], v[80:83], v[192:195]
v_mfma_f32_16x16x32_bf16 v[196:199], v[112:115], v[84:87], v[196:199]
v_mfma_f32_16x16x32_bf16 v[200:203], v[112:115], v[88:91], v[200:203]
v_mfma_f32_16x16x32_bf16 v[204:207], v[112:115], v[92:95], v[204:207]
v_mfma_f32_16x16x32_bf16 v[144:147], v[100:103], v[80:83], v[144:147]
v_mfma_f32_16x16x32_bf16 v[148:151], v[100:103], v[84:87], v[148:151]
v_mfma_f32_16x16x32_bf16 v[152:155], v[100:103], v[88:91], v[152:155]
v_mfma_f32_16x16x32_bf16 v[156:159], v[100:103], v[92:95], v[156:159]
v_mfma_f32_16x16x32_bf16 v[208:211], v[116:119], v[80:83], v[208:211]
v_mfma_f32_16x16x32_bf16 v[212:215], v[116:119], v[84:87], v[212:215]
v_mfma_f32_16x16x32_bf16 v[216:219], v[116:119], v[88:91], v[216:219]
v_mfma_f32_16x16x32_bf16 v[220:223], v[116:119], v[92:95], v[220:223]
v_mfma_f32_16x16x32_bf16 v[160:163], v[104:107], v[80:83], v[160:163]
v_mfma_f32_16x16x32_bf16 v[164:167], v[104:107], v[84:87], v[164:167]
v_mfma_f32_16x16x32_bf16 v[168:171], v[104:107], v[88:91], v[168:171]
v_mfma_f32_16x16x32_bf16 v[172:175], v[104:107], v[92:95], v[172:175]
v_mfma_f32_16x16x32_bf16 v[224:227], v[120:123], v[80:83], v[224:227]
v_mfma_f32_16x16x32_bf16 v[228:231], v[120:123], v[84:87], v[228:231]
v_mfma_f32_16x16x32_bf16 v[232:235], v[120:123], v[88:91], v[232:235]
v_mfma_f32_16x16x32_bf16 v[236:239], v[120:123], v[92:95], v[236:239]
v_mfma_f32_16x16x32_bf16 v[176:179], v[108:111], v[80:83], v[176:179]
v_mfma_f32_16x16x32_bf16 v[180:183], v[108:111], v[84:87], v[180:183]
v_mfma_f32_16x16x32_bf16 v[184:187], v[108:111], v[88:91], v[184:187]
v_mfma_f32_16x16x32_bf16 v[188:191], v[108:111], v[92:95], v[188:191]
v_mfma_f32_16x16x32_bf16 v[240:243], v[124:127], v[80:83], v[240:243]
v_mfma_f32_16x16x32_bf16 v[244:247], v[124:127], v[84:87], v[244:247]
v_mfma_f32_16x16x32_bf16 v[248:251], v[124:127], v[88:91], v[248:251]
v_mfma_f32_16x16x32_bf16 v[252:255], v[124:127], v[92:95], v[252:255]
s_setprio 0
s_lshl_b32 s43, s46, 9
s_add_u32 s43, s43, 147456
v_lshl_add_u32 v19, v17, 3, s43
ds_read_b64 v[80:81], v19 offset:0
ds_read_b64 v[82:83], v19 offset:128
ds_read_b64 v[84:85], v19 offset:256
ds_read_b64 v[86:87], v19 offset:384
s_mul_i32 s43, s47, 256
s_add_u32 s43, s43, 148480
v_lshl_add_u32 v19, v18, 4, s43
ds_read_b128 v[48:51], v19 offset:0
ds_read_b128 v[52:55], v19 offset:64
ds_read_b128 v[56:59], v19 offset:128
ds_read_b128 v[60:63], v19 offset:192
ds_read_b128 v[64:67], v19 offset:896
ds_read_b128 v[68:71], v19 offset:960
ds_read_b128 v[72:75], v19 offset:1024
ds_read_b128 v[76:79], v19 offset:1088
s_waitcnt lgkmcnt(0)
v_mov_b32 v32, v80
v_mul_f32 v88, v81, v81
v_mul_f32 v36, 0xc0135761, v81
v_mul_f32 v89, 0xbdd2d3e8, v81
v_rcp_f32 v44, v88
v_mul_f32 v40, v89, v88
v_mov_b32 v33, v82
v_mul_f32 v88, v83, v83
v_mul_f32 v37, 0xc0135761, v83
v_mul_f32 v89, 0xbdd2d3e8, v83
v_rcp_f32 v45, v88
v_mul_f32 v41, v89, v88
v_mov_b32 v34, v84
v_mul_f32 v88, v85, v85
v_mul_f32 v38, 0xc0135761, v85
v_mul_f32 v89, 0xbdd2d3e8, v85
v_rcp_f32 v46, v88
v_mul_f32 v42, v89, v88
v_mov_b32 v35, v86
v_mul_f32 v88, v87, v87
v_mul_f32 v39, 0xc0135761, v87
v_mul_f32 v89, 0xbdd2d3e8, v87
v_rcp_f32 v47, v88
v_mul_f32 v43, v89, v88
s_barrier
v_fma_f32 v128, -v32, v48, v128
v_fma_f32 v129, -v32, v49, v129
v_fma_f32 v130, -v32, v50, v130
v_fma_f32 v131, -v32, v51, v131
v_fma_f32 v192, -v32, v64, v192
v_fma_f32 v193, -v32, v65, v193
v_fma_f32 v194, -v32, v66, v194
v_fma_f32 v195, -v32, v67, v195
v_mul_f32 v80, v128, v128
v_mul_f32 v81, v129, v129
v_mul_f32 v82, v130, v130
v_mul_f32 v83, v131, v131
v_fma_f32 v80, v80, v40, v36
v_fma_f32 v81, v81, v40, v36
v_fma_f32 v82, v82, v40, v36
v_fma_f32 v83, v83, v40, v36
v_mul_f32 v80, v80, v128
v_mul_f32 v81, v81, v129
v_mul_f32 v82, v82, v130
v_mul_f32 v83, v83, v131
v_exp_f32 v80, v80
v_exp_f32 v81, v81
v_exp_f32 v82, v82
v_exp_f32 v83, v83
v_mul_f32 v192, v128, v192
v_mul_f32 v193, v129, v193
v_mul_f32 v194, v130, v194
v_mul_f32 v195, v131, v195
v_fma_f32 v80, v80, v44, v44
v_fma_f32 v81, v81, v44, v44
v_fma_f32 v82, v82, v44, v44
v_fma_f32 v83, v83, v44, v44
v_rcp_f32 v80, v80
v_rcp_f32 v81, v81
v_rcp_f32 v82, v82
v_rcp_f32 v83, v83
v_mul_f32 v192, v192, v80
v_mul_f32 v193, v193, v81
v_mul_f32 v194, v194, v82
v_mul_f32 v195, v195, v83
v_cvt_pk_bf16_f32 v96, v192, v193
v_cvt_pk_bf16_f32 v97, v194, v195
v_fma_f32 v144, -v32, v52, v144
v_fma_f32 v145, -v32, v53, v145
v_fma_f32 v146, -v32, v54, v146
v_fma_f32 v147, -v32, v55, v147
v_fma_f32 v208, -v32, v68, v208
v_fma_f32 v209, -v32, v69, v209
s_barrier
v_fma_f32 v210, -v32, v70, v210
v_fma_f32 v211, -v32, v71, v211
v_mul_f32 v84, v144, v144
v_mul_f32 v85, v145, v145
v_mul_f32 v86, v146, v146
v_mul_f32 v87, v147, v147
v_fma_f32 v84, v84, v40, v36
v_fma_f32 v85, v85, v40, v36
v_fma_f32 v86, v86, v40, v36
v_fma_f32 v87, v87, v40, v36
v_mul_f32 v84, v84, v144
v_mul_f32 v85, v85, v145
v_mul_f32 v86, v86, v146
v_mul_f32 v87, v87, v147
v_exp_f32 v84, v84
v_exp_f32 v85, v85
v_exp_f32 v86, v86
v_exp_f32 v87, v87
v_mul_f32 v208, v144, v208
v_mul_f32 v209, v145, v209
v_mul_f32 v210, v146, v210
v_mul_f32 v211, v147, v211
v_fma_f32 v84, v84, v44, v44
v_fma_f32 v85, v85, v44, v44
v_fma_f32 v86, v86, v44, v44
v_fma_f32 v87, v87, v44, v44
v_rcp_f32 v84, v84
v_rcp_f32 v85, v85
v_rcp_f32 v86, v86
v_rcp_f32 v87, v87
v_mul_f32 v208, v208, v84
v_mul_f32 v209, v209, v85
v_mul_f32 v210, v210, v86
v_mul_f32 v211, v211, v87
v_cvt_pk_bf16_f32 v98, v208, v209
v_cvt_pk_bf16_f32 v99, v210, v211
buffer_store_dwordx4 v[96:99], v27, s[24:27], 0 offen offset:0 sc1
v_fma_f32 v132, -v33, v48, v132
v_fma_f32 v133, -v33, v49, v133
v_fma_f32 v134, -v33, v50, v134
v_fma_f32 v135, -v33, v51, v135
v_fma_f32 v196, -v33, v64, v196
v_fma_f32 v197, -v33, v65, v197
v_fma_f32 v198, -v33, v66, v198
v_fma_f32 v199, -v33, v67, v199
v_mul_f32 v80, v132, v132
v_mul_f32 v81, v133, v133
v_mul_f32 v82, v134, v134
v_mul_f32 v83, v135, v135
v_lshlrev_b32 v19, 11, v18
v_lshl_add_u32 v19, v17, 4, v19
s_lshl_b32 s43, s36, 9
v_add_u32 v2, s43, v19
v_add_u32 v3, 49152, v2
v_add_u32 v4, 98304, v2
v_lshrrev_b32 v19, 2, v17
v_lshl_add_u32 v20, v18, 2, v19
v_bfe_u32 v21, v20, 1, 2
v_lshlrev_b32 v20, 7, v20
v_lshl_add_u32 v20, v21, 5, v20
v_and_b32 v19, 3, v1
v_lshl_add_u32 v20, v19, 3, v20
v_add_u32 v5, 16384, v20
s_barrier
v_fma_f32 v80, v80, v41, v37
v_fma_f32 v81, v81, v41, v37
v_fma_f32 v82, v82, v41, v37
v_fma_f32 v83, v83, v41, v37
v_mul_f32 v80, v80, v132
v_mul_f32 v81, v81, v133
v_mul_f32 v82, v82, v134
v_mul_f32 v83, v83, v135
v_exp_f32 v80, v80
v_exp_f32 v81, v81
v_exp_f32 v82, v82
v_exp_f32 v83, v83
v_mul_f32 v196, v132, v196
v_mul_f32 v197, v133, v197
v_mul_f32 v198, v134, v198
v_mul_f32 v199, v135, v199
v_fma_f32 v80, v80, v45, v45
v_fma_f32 v81, v81, v45, v45
v_fma_f32 v82, v82, v45, v45
v_fma_f32 v83, v83, v45, v45
v_rcp_f32 v80, v80
v_rcp_f32 v81, v81
v_rcp_f32 v82, v82
v_rcp_f32 v83, v83
v_mul_f32 v196, v196, v80
v_mul_f32 v197, v197, v81
v_mul_f32 v198, v198, v82
v_mul_f32 v199, v199, v83
v_cvt_pk_bf16_f32 v100, v196, v197
v_cvt_pk_bf16_f32 v101, v198, v199
v_fma_f32 v148, -v33, v52, v148
v_fma_f32 v149, -v33, v53, v149
v_fma_f32 v150, -v33, v54, v150
v_fma_f32 v151, -v33, v55, v151
v_fma_f32 v212, -v33, v68, v212
v_fma_f32 v213, -v33, v69, v213
v_fma_f32 v214, -v33, v70, v214
v_fma_f32 v215, -v33, v71, v215
v_mul_f32 v84, v148, v148
v_mul_f32 v85, v149, v149
v_mul_f32 v86, v150, v150
v_mul_f32 v87, v151, v151
v_fma_f32 v84, v84, v41, v37
v_fma_f32 v85, v85, v41, v37
v_fma_f32 v86, v86, v41, v37
v_fma_f32 v87, v87, v41, v37
v_mul_f32 v84, v84, v148
v_mul_f32 v85, v85, v149
v_xor_b32 v6, 32, v5
v_xor_b32 v7, 64, v5
v_xor_b32 v8, 96, v5
v_add_u32 v9, 49152, v5
v_add_u32 v10, 49152, v6
v_add_u32 v11, 49152, v7
v_add_u32 v12, 49152, v8
v_add_u32 v13, 98304, v5
v_add_u32 v14, 98304, v6
v_add_u32 v15, 98304, v7
v_add_u32 v16, 98304, v8
s_barrier
v_mul_f32 v86, v86, v150
v_mul_f32 v87, v87, v151
v_exp_f32 v84, v84
v_exp_f32 v85, v85
v_exp_f32 v86, v86
v_exp_f32 v87, v87
v_mul_f32 v212, v148, v212
v_mul_f32 v213, v149, v213
v_mul_f32 v214, v150, v214
v_mul_f32 v215, v151, v215
v_fma_f32 v84, v84, v45, v45
v_fma_f32 v85, v85, v45, v45
v_fma_f32 v86, v86, v45, v45
v_fma_f32 v87, v87, v45, v45
v_rcp_f32 v84, v84
v_rcp_f32 v85, v85
v_rcp_f32 v86, v86
v_rcp_f32 v87, v87
v_mul_f32 v212, v212, v84
v_mul_f32 v213, v213, v85
v_mul_f32 v214, v214, v86
v_mul_f32 v215, v215, v87
v_cvt_pk_bf16_f32 v102, v212, v213
v_cvt_pk_bf16_f32 v103, v214, v215
buffer_store_dwordx4 v[100:103], v27, s[24:27], 0 offen offset:256 sc1
v_fma_f32 v136, -v34, v48, v136
v_fma_f32 v137, -v34, v49, v137
v_fma_f32 v138, -v34, v50, v138
v_fma_f32 v139, -v34, v51, v139
v_fma_f32 v200, -v34, v64, v200
v_fma_f32 v201, -v34, v65, v201
v_fma_f32 v202, -v34, v66, v202
v_fma_f32 v203, -v34, v67, v203
v_mul_f32 v80, v136, v136
v_mul_f32 v81, v137, v137
v_mul_f32 v82, v138, v138
v_mul_f32 v83, v139, v139
v_fma_f32 v80, v80, v42, v38
v_fma_f32 v81, v81, v42, v38
v_fma_f32 v82, v82, v42, v38
v_fma_f32 v83, v83, v42, v38
v_mul_f32 v80, v80, v136
v_mul_f32 v81, v81, v137
v_mul_f32 v82, v82, v138
v_mul_f32 v83, v83, v139
v_exp_f32 v80, v80
v_exp_f32 v81, v81
v_exp_f32 v82, v82
v_exp_f32 v83, v83
s_barrier
v_mul_f32 v200, v136, v200
v_mul_f32 v201, v137, v201
v_mul_f32 v202, v138, v202
v_mul_f32 v203, v139, v203
v_fma_f32 v80, v80, v46, v46
v_fma_f32 v81, v81, v46, v46
v_fma_f32 v82, v82, v46, v46
v_fma_f32 v83, v83, v46, v46
v_rcp_f32 v80, v80
v_rcp_f32 v81, v81
v_rcp_f32 v82, v82
v_rcp_f32 v83, v83
v_mul_f32 v200, v200, v80
v_mul_f32 v201, v201, v81
v_mul_f32 v202, v202, v82
v_mul_f32 v203, v203, v83
v_cvt_pk_bf16_f32 v104, v200, v201
v_cvt_pk_bf16_f32 v105, v202, v203
v_fma_f32 v152, -v34, v52, v152
v_fma_f32 v153, -v34, v53, v153
v_fma_f32 v154, -v34, v54, v154
v_fma_f32 v155, -v34, v55, v155
v_fma_f32 v216, -v34, v68, v216
v_fma_f32 v217, -v34, v69, v217
v_fma_f32 v218, -v34, v70, v218
v_fma_f32 v219, -v34, v71, v219
v_mul_f32 v84, v152, v152
v_mul_f32 v85, v153, v153
v_mul_f32 v86, v154, v154
v_mul_f32 v87, v155, v155
v_fma_f32 v84, v84, v42, v38
v_fma_f32 v85, v85, v42, v38
v_fma_f32 v86, v86, v42, v38
v_fma_f32 v87, v87, v42, v38
v_mul_f32 v84, v84, v152
v_mul_f32 v85, v85, v153
v_mul_f32 v86, v86, v154
v_mul_f32 v87, v87, v155
v_exp_f32 v84, v84
v_exp_f32 v85, v85
v_exp_f32 v86, v86
v_exp_f32 v87, v87
v_mul_f32 v216, v152, v216
v_mul_f32 v217, v153, v217
v_mul_f32 v218, v154, v218
v_mul_f32 v219, v155, v219
v_fma_f32 v84, v84, v46, v46
v_fma_f32 v85, v85, v46, v46
s_barrier
v_fma_f32 v86, v86, v46, v46
v_fma_f32 v87, v87, v46, v46
v_rcp_f32 v84, v84
v_rcp_f32 v85, v85
v_rcp_f32 v86, v86
v_rcp_f32 v87, v87
v_mul_f32 v216, v216, v84
v_mul_f32 v217, v217, v85
v_mul_f32 v218, v218, v86
v_mul_f32 v219, v219, v87
v_cvt_pk_bf16_f32 v106, v216, v217
v_cvt_pk_bf16_f32 v107, v218, v219
buffer_store_dwordx4 v[104:107], v27, s[24:27], 0 offen offset:512 sc1
v_fma_f32 v140, -v35, v48, v140
v_fma_f32 v141, -v35, v49, v141
v_fma_f32 v142, -v35, v50, v142
v_fma_f32 v143, -v35, v51, v143
v_fma_f32 v204, -v35, v64, v204
v_fma_f32 v205, -v35, v65, v205
v_fma_f32 v206, -v35, v66, v206
v_fma_f32 v207, -v35, v67, v207
v_mul_f32 v80, v140, v140
v_mul_f32 v81, v141, v141
v_mul_f32 v82, v142, v142
v_mul_f32 v83, v143, v143
v_fma_f32 v80, v80, v43, v39
v_fma_f32 v81, v81, v43, v39
v_fma_f32 v82, v82, v43, v39
v_fma_f32 v83, v83, v43, v39
v_mul_f32 v80, v80, v140
v_mul_f32 v81, v81, v141
v_mul_f32 v82, v82, v142
v_mul_f32 v83, v83, v143
v_exp_f32 v80, v80
v_exp_f32 v81, v81
v_exp_f32 v82, v82
v_exp_f32 v83, v83
v_mul_f32 v204, v140, v204
v_mul_f32 v205, v141, v205
v_mul_f32 v206, v142, v206
v_mul_f32 v207, v143, v207
v_fma_f32 v80, v80, v47, v47
v_fma_f32 v81, v81, v47, v47
v_fma_f32 v82, v82, v47, v47
v_fma_f32 v83, v83, v47, v47
v_rcp_f32 v80, v80
v_rcp_f32 v81, v81
v_rcp_f32 v82, v82
v_rcp_f32 v83, v83
s_barrier
v_mul_f32 v204, v204, v80
v_mul_f32 v205, v205, v81
v_mul_f32 v206, v206, v82
v_mul_f32 v207, v207, v83
v_cvt_pk_bf16_f32 v108, v204, v205
v_cvt_pk_bf16_f32 v109, v206, v207
v_fma_f32 v156, -v35, v52, v156
v_fma_f32 v157, -v35, v53, v157
v_fma_f32 v158, -v35, v54, v158
v_fma_f32 v159, -v35, v55, v159
v_fma_f32 v220, -v35, v68, v220
v_fma_f32 v221, -v35, v69, v221
v_fma_f32 v222, -v35, v70, v222
v_fma_f32 v223, -v35, v71, v223
v_mul_f32 v84, v156, v156
v_mul_f32 v85, v157, v157
v_mul_f32 v86, v158, v158
v_mul_f32 v87, v159, v159
v_fma_f32 v84, v84, v43, v39
v_fma_f32 v85, v85, v43, v39
v_fma_f32 v86, v86, v43, v39
v_fma_f32 v87, v87, v43, v39
v_mul_f32 v84, v84, v156
v_mul_f32 v85, v85, v157
v_mul_f32 v86, v86, v158
v_mul_f32 v87, v87, v159
v_exp_f32 v84, v84
v_exp_f32 v85, v85
v_exp_f32 v86, v86
v_exp_f32 v87, v87
v_mul_f32 v220, v156, v220
v_mul_f32 v221, v157, v221
v_mul_f32 v222, v158, v222
v_mul_f32 v223, v159, v223
v_fma_f32 v84, v84, v47, v47
v_fma_f32 v85, v85, v47, v47
v_fma_f32 v86, v86, v47, v47
v_fma_f32 v87, v87, v47, v47
v_rcp_f32 v84, v84
v_rcp_f32 v85, v85
v_rcp_f32 v86, v86
v_rcp_f32 v87, v87
v_mul_f32 v220, v220, v84
v_mul_f32 v221, v221, v85
v_mul_f32 v222, v222, v86
v_mul_f32 v223, v223, v87
v_cvt_pk_bf16_f32 v110, v220, v221
v_cvt_pk_bf16_f32 v111, v222, v223
buffer_store_dwordx4 v[108:111], v27, s[24:27], 0 offen offset:768 sc1
s_barrier
v_fma_f32 v160, -v32, v56, v160
v_fma_f32 v161, -v32, v57, v161
v_fma_f32 v162, -v32, v58, v162
v_fma_f32 v163, -v32, v59, v163
v_fma_f32 v224, -v32, v72, v224
v_fma_f32 v225, -v32, v73, v225
v_fma_f32 v226, -v32, v74, v226
v_fma_f32 v227, -v32, v75, v227
v_mul_f32 v80, v160, v160
v_mul_f32 v81, v161, v161
v_mul_f32 v82, v162, v162
v_mul_f32 v83, v163, v163
v_fma_f32 v80, v80, v40, v36
v_fma_f32 v81, v81, v40, v36
v_fma_f32 v82, v82, v40, v36
v_fma_f32 v83, v83, v40, v36
v_mul_f32 v80, v80, v160
v_mul_f32 v81, v81, v161
v_mul_f32 v82, v82, v162
v_mul_f32 v83, v83, v163
v_exp_f32 v80, v80
v_exp_f32 v81, v81
v_exp_f32 v82, v82
v_exp_f32 v83, v83
v_mul_f32 v224, v160, v224
v_mul_f32 v225, v161, v225
v_mul_f32 v226, v162, v226
v_mul_f32 v227, v163, v227
v_fma_f32 v80, v80, v44, v44
v_fma_f32 v81, v81, v44, v44
v_fma_f32 v82, v82, v44, v44
v_fma_f32 v83, v83, v44, v44
v_rcp_f32 v80, v80
v_rcp_f32 v81, v81
v_rcp_f32 v82, v82
v_rcp_f32 v83, v83
v_mul_f32 v224, v224, v80
v_mul_f32 v225, v225, v81
v_mul_f32 v226, v226, v82
v_mul_f32 v227, v227, v83
v_cvt_pk_bf16_f32 v96, v224, v225
v_cvt_pk_bf16_f32 v97, v226, v227
v_fma_f32 v176, -v32, v60, v176
v_fma_f32 v177, -v32, v61, v177
v_fma_f32 v178, -v32, v62, v178
v_fma_f32 v179, -v32, v63, v179
v_fma_f32 v240, -v32, v76, v240
v_fma_f32 v241, -v32, v77, v241
v_lshlrev_b32 v19, 11, v18
v_lshl_add_u32 v19, v17, 4, v19
s_lshl_b32 s43, s36, 9
v_add_u32 v208, s43, v19
buffer_load_dwordx4 v[192:195], v208, s[20:23], 0 offen offset:0 sc1
buffer_load_dwordx4 v[196:199], v208, s[20:23], s50 offen offset:0 sc1
buffer_load_dwordx4 v[200:203], v208, s[20:23], 0 offen offset:256 sc1
buffer_load_dwordx4 v[204:207], v208, s[20:23], s50 offen offset:256 sc1
s_waitcnt vmcnt(4)
s_barrier
s_add_u32 s43, s34, 32
s_lshl_b32 s43, s43, 7
v_mov_b32 v21, s43
v_mov_b32 v22, 1
s_mov_b64 exec, 1
buffer_atomic_add v22, v21, s[56:59], 0 offen sc1
s_mov_b64 exec, -1
v_fma_f32 v242, -v32, v78, v242
v_fma_f32 v243, -v32, v79, v243
v_mul_f32 v84, v176, v176
v_mul_f32 v85, v177, v177
v_mul_f32 v86, v178, v178
v_mul_f32 v87, v179, v179
v_fma_f32 v84, v84, v40, v36
v_fma_f32 v85, v85, v40, v36
v_fma_f32 v86, v86, v40, v36
v_fma_f32 v87, v87, v40, v36
v_mul_f32 v84, v84, v176
v_mul_f32 v85, v85, v177
v_mul_f32 v86, v86, v178
v_mul_f32 v87, v87, v179
v_exp_f32 v84, v84
v_exp_f32 v85, v85
v_exp_f32 v86, v86
v_exp_f32 v87, v87
v_mul_f32 v240, v176, v240
v_mul_f32 v241, v177, v241
v_mul_f32 v242, v178, v242
v_mul_f32 v243, v179, v243
v_fma_f32 v84, v84, v44, v44
v_fma_f32 v85, v85, v44, v44
v_fma_f32 v86, v86, v44, v44
v_fma_f32 v87, v87, v44, v44
v_rcp_f32 v84, v84
v_rcp_f32 v85, v85
v_rcp_f32 v86, v86
v_rcp_f32 v87, v87
v_mul_f32 v240, v240, v84
v_mul_f32 v241, v241, v85
v_mul_f32 v242, v242, v86
v_mul_f32 v243, v243, v87
v_cvt_pk_bf16_f32 v98, v240, v241
v_cvt_pk_bf16_f32 v99, v242, v243
buffer_store_dwordx4 v[96:99], v27, s[24:27], s53 offen offset:0 sc1
v_fma_f32 v164, -v33, v56, v164
v_fma_f32 v165, -v33, v57, v165
v_fma_f32 v166, -v33, v58, v166
v_fma_f32 v167, -v33, v59, v167
v_fma_f32 v228, -v33, v72, v228
v_fma_f32 v229, -v33, v73, v229
v_fma_f32 v230, -v33, v74, v230
v_fma_f32 v231, -v33, v75, v231
v_mul_f32 v80, v164, v164
v_mul_f32 v81, v165, v165
v_mul_f32 v82, v166, v166
v_mul_f32 v83, v167, v167
s_barrier
v_fma_f32 v80, v80, v41, v37
v_fma_f32 v81, v81, v41, v37
v_fma_f32 v82, v82, v41, v37
v_fma_f32 v83, v83, v41, v37
v_mul_f32 v80, v80, v164
v_mul_f32 v81, v81, v165
v_mul_f32 v82, v82, v166
v_mul_f32 v83, v83, v167
v_exp_f32 v80, v80
v_exp_f32 v81, v81
v_exp_f32 v82, v82
v_exp_f32 v83, v83
v_mul_f32 v228, v164, v228
v_mul_f32 v229, v165, v229
v_mul_f32 v230, v166, v230
v_mul_f32 v231, v167, v231
v_fma_f32 v80, v80, v45, v45
v_fma_f32 v81, v81, v45, v45
v_fma_f32 v82, v82, v45, v45
v_fma_f32 v83, v83, v45, v45
v_rcp_f32 v80, v80
v_rcp_f32 v81, v81
v_rcp_f32 v82, v82
v_rcp_f32 v83, v83
v_mul_f32 v228, v228, v80
v_mul_f32 v229, v229, v81
v_mul_f32 v230, v230, v82
v_mul_f32 v231, v231, v83
v_cvt_pk_bf16_f32 v100, v228, v229
v_cvt_pk_bf16_f32 v101, v230, v231
v_fma_f32 v180, -v33, v60, v180
v_fma_f32 v181, -v33, v61, v181
v_fma_f32 v182, -v33, v62, v182
v_fma_f32 v183, -v33, v63, v183
v_fma_f32 v244, -v33, v76, v244
v_fma_f32 v245, -v33, v77, v245
v_fma_f32 v246, -v33, v78, v246
v_fma_f32 v247, -v33, v79, v247
v_mul_f32 v84, v180, v180
v_mul_f32 v85, v181, v181
v_mul_f32 v86, v182, v182
v_mul_f32 v87, v183, v183
v_fma_f32 v84, v84, v41, v37
v_fma_f32 v85, v85, v41, v37
v_fma_f32 v86, v86, v41, v37
v_fma_f32 v87, v87, v41, v37
v_mul_f32 v84, v84, v180
v_mul_f32 v85, v85, v181
s_waitcnt vmcnt(1)
s_barrier
v_mul_f32 v86, v86, v182
v_mul_f32 v87, v87, v183
v_exp_f32 v84, v84
v_exp_f32 v85, v85
v_exp_f32 v86, v86
v_exp_f32 v87, v87
v_mul_f32 v244, v180, v244
v_mul_f32 v245, v181, v245
v_mul_f32 v246, v182, v246
v_mul_f32 v247, v183, v247
v_fma_f32 v84, v84, v45, v45
v_fma_f32 v85, v85, v45, v45
v_fma_f32 v86, v86, v45, v45
v_fma_f32 v87, v87, v45, v45
v_rcp_f32 v84, v84
v_rcp_f32 v85, v85
v_rcp_f32 v86, v86
v_rcp_f32 v87, v87
v_mul_f32 v244, v244, v84
v_mul_f32 v245, v245, v85
v_mul_f32 v246, v246, v86
v_mul_f32 v247, v247, v87
v_cvt_pk_bf16_f32 v102, v244, v245
v_cvt_pk_bf16_f32 v103, v246, v247
buffer_store_dwordx4 v[100:103], v27, s[24:27], s53 offen offset:256 sc1
v_fma_f32 v168, -v34, v56, v168
v_fma_f32 v169, -v34, v57, v169
v_fma_f32 v170, -v34, v58, v170
v_fma_f32 v171, -v34, v59, v171
v_fma_f32 v232, -v34, v72, v232
v_fma_f32 v233, -v34, v73, v233
v_fma_f32 v234, -v34, v74, v234
v_fma_f32 v235, -v34, v75, v235
v_mul_f32 v80, v168, v168
v_mul_f32 v81, v169, v169
v_mul_f32 v82, v170, v170
v_mul_f32 v83, v171, v171
v_fma_f32 v80, v80, v42, v38
v_fma_f32 v81, v81, v42, v38
v_fma_f32 v82, v82, v42, v38
v_fma_f32 v83, v83, v42, v38
v_mul_f32 v80, v80, v168
v_mul_f32 v81, v81, v169
v_mul_f32 v82, v82, v170
v_mul_f32 v83, v83, v171
v_exp_f32 v80, v80
v_exp_f32 v81, v81
v_exp_f32 v82, v82
v_exp_f32 v83, v83
v_lshlrev_b32 v128, 16, v192
v_and_b32 v129, 0xffff0000, v192
v_lshlrev_b32 v130, 16, v193
v_and_b32 v131, 0xffff0000, v193
v_lshlrev_b32 v132, 16, v194
v_and_b32 v133, 0xffff0000, v194
v_lshlrev_b32 v134, 16, v195
v_and_b32 v135, 0xffff0000, v195
v_lshlrev_b32 v136, 16, v196
v_and_b32 v137, 0xffff0000, v196
v_lshlrev_b32 v138, 16, v197
v_and_b32 v139, 0xffff0000, v197
v_lshlrev_b32 v140, 16, v198
v_and_b32 v141, 0xffff0000, v198
v_lshlrev_b32 v142, 16, v199
v_and_b32 v143, 0xffff0000, v199
s_barrier
v_mul_f32 v232, v168, v232
v_mul_f32 v233, v169, v233
v_mul_f32 v234, v170, v234
v_mul_f32 v235, v171, v235
v_fma_f32 v80, v80, v46, v46
v_fma_f32 v81, v81, v46, v46
v_fma_f32 v82, v82, v46, v46
v_fma_f32 v83, v83, v46, v46
v_rcp_f32 v80, v80
v_rcp_f32 v81, v81
v_rcp_f32 v82, v82
v_rcp_f32 v83, v83
v_mul_f32 v232, v232, v80
v_mul_f32 v233, v233, v81
v_mul_f32 v234, v234, v82
v_mul_f32 v235, v235, v83
v_cvt_pk_bf16_f32 v104, v232, v233
v_cvt_pk_bf16_f32 v105, v234, v235
v_fma_f32 v184, -v34, v60, v184
v_fma_f32 v185, -v34, v61, v185
v_fma_f32 v186, -v34, v62, v186
v_fma_f32 v187, -v34, v63, v187
v_fma_f32 v248, -v34, v76, v248
v_fma_f32 v249, -v34, v77, v249
v_fma_f32 v250, -v34, v78, v250
v_fma_f32 v251, -v34, v79, v251
v_mul_f32 v84, v184, v184
v_mul_f32 v85, v185, v185
v_mul_f32 v86, v186, v186
v_mul_f32 v87, v187, v187
v_fma_f32 v84, v84, v42, v38
v_fma_f32 v85, v85, v42, v38
v_fma_f32 v86, v86, v42, v38
v_fma_f32 v87, v87, v42, v38
v_mul_f32 v84, v84, v184
v_mul_f32 v85, v85, v185
v_mul_f32 v86, v86, v186
v_mul_f32 v87, v87, v187
v_exp_f32 v84, v84
v_exp_f32 v85, v85
v_exp_f32 v86, v86
v_exp_f32 v87, v87
v_mul_f32 v248, v184, v248
v_mul_f32 v249, v185, v249
v_mul_f32 v250, v186, v250
v_mul_f32 v251, v187, v251
v_fma_f32 v84, v84, v46, v46
v_fma_f32 v85, v85, v46, v46
v_lshlrev_b32 v144, 16, v200
v_and_b32 v145, 0xffff0000, v200
v_lshlrev_b32 v146, 16, v201
v_and_b32 v147, 0xffff0000, v201
v_lshlrev_b32 v148, 16, v202
v_and_b32 v149, 0xffff0000, v202
v_lshlrev_b32 v150, 16, v203
v_and_b32 v151, 0xffff0000, v203
v_lshlrev_b32 v152, 16, v204
v_and_b32 v153, 0xffff0000, v204
v_lshlrev_b32 v154, 16, v205
v_and_b32 v155, 0xffff0000, v205
v_lshlrev_b32 v156, 16, v206
v_and_b32 v157, 0xffff0000, v206
v_lshlrev_b32 v158, 16, v207
v_and_b32 v159, 0xffff0000, v207
s_barrier
s_add_u32 s43, s34, 32
s_lshl_b32 s43, s43, 7
v_mov_b32 v21, s43
v_mov_b32 v23, 16
buffer_load_dword v22, v21, s[56:59], 0 offen sc1
v_fma_f32 v86, v86, v46, v46
v_fma_f32 v87, v87, v46, v46
v_rcp_f32 v84, v84
v_rcp_f32 v85, v85
v_rcp_f32 v86, v86
v_rcp_f32 v87, v87
v_mul_f32 v248, v248, v84
v_mul_f32 v249, v249, v85
v_mul_f32 v250, v250, v86
v_mul_f32 v251, v251, v87
v_cvt_pk_bf16_f32 v106, v248, v249
v_cvt_pk_bf16_f32 v107, v250, v251
buffer_store_dwordx4 v[104:107], v27, s[24:27], s53 offen offset:512 sc1
v_fma_f32 v172, -v35, v56, v172
v_fma_f32 v173, -v35, v57, v173
v_fma_f32 v174, -v35, v58, v174
v_fma_f32 v175, -v35, v59, v175
v_fma_f32 v236, -v35, v72, v236
v_fma_f32 v237, -v35, v73, v237
v_fma_f32 v238, -v35, v74, v238
v_fma_f32 v239, -v35, v75, v239
v_mul_f32 v80, v172, v172
v_mul_f32 v81, v173, v173
v_mul_f32 v82, v174, v174
v_mul_f32 v83, v175, v175
v_fma_f32 v80, v80, v43, v39
v_fma_f32 v81, v81, v43, v39
v_fma_f32 v82, v82, v43, v39
v_fma_f32 v83, v83, v43, v39
v_mul_f32 v80, v80, v172
v_mul_f32 v81, v81, v173
v_mul_f32 v82, v82, v174
v_mul_f32 v83, v83, v175
v_exp_f32 v80, v80
v_exp_f32 v81, v81
v_exp_f32 v82, v82
v_exp_f32 v83, v83
v_mul_f32 v236, v172, v236
v_mul_f32 v237, v173, v237
v_mul_f32 v238, v174, v238
v_mul_f32 v239, v175, v239
v_fma_f32 v80, v80, v47, v47
v_fma_f32 v81, v81, v47, v47
v_fma_f32 v82, v82, v47, v47
v_fma_f32 v83, v83, v47, v47
v_rcp_f32 v80, v80
v_rcp_f32 v81, v81
v_rcp_f32 v82, v82
v_rcp_f32 v83, v83
s_mov_b32 s41, 0x10000
Lpoll_22:
s_waitcnt vmcnt(0)
v_cmp_ne_u32 vcc, v23, v22
s_nop 4
s_cbranch_vccz Lpok_23
buffer_load_dword v22, v21, s[56:59], 0 offen sc1
s_sub_u32 s41, s41, 1
s_cmp_lg_u32 s41, 0
s_cbranch_scc1 Lpoll_22
s_waitcnt vmcnt(0)
Lpok_23:
s_barrier
v_mul_f32 v236, v236, v80
v_mul_f32 v237, v237, v81
v_mul_f32 v238, v238, v82
v_mul_f32 v239, v239, v83
v_cvt_pk_bf16_f32 v108, v236, v237
v_cvt_pk_bf16_f32 v109, v238, v239
v_fma_f32 v188, -v35, v60, v188
v_fma_f32 v189, -v35, v61, v189
v_fma_f32 v190, -v35, v62, v190
v_fma_f32 v191, -v35, v63, v191
v_fma_f32 v252, -v35, v76, v252
v_fma_f32 v253, -v35, v77, v253
v_fma_f32 v254, -v35, v78, v254
v_fma_f32 v255, -v35, v79, v255
v_mul_f32 v84, v188, v188
v_mul_f32 v85, v189, v189
v_mul_f32 v86, v190, v190
v_mul_f32 v87, v191, v191
v_fma_f32 v84, v84, v43, v39
v_fma_f32 v85, v85, v43, v39
v_fma_f32 v86, v86, v43, v39
v_fma_f32 v87, v87, v43, v39
v_mul_f32 v84, v84, v188
v_mul_f32 v85, v85, v189
v_mul_f32 v86, v86, v190
v_mul_f32 v87, v87, v191
v_exp_f32 v84, v84
v_exp_f32 v85, v85
v_exp_f32 v86, v86
v_exp_f32 v87, v87
v_mul_f32 v252, v188, v252
v_mul_f32 v253, v189, v253
v_mul_f32 v254, v190, v254
v_mul_f32 v255, v191, v255
v_fma_f32 v84, v84, v47, v47
v_fma_f32 v85, v85, v47, v47
v_fma_f32 v86, v86, v47, v47
v_fma_f32 v87, v87, v47, v47
v_rcp_f32 v84, v84
v_rcp_f32 v85, v85
v_rcp_f32 v86, v86
v_rcp_f32 v87, v87
v_mul_f32 v252, v252, v84
v_mul_f32 v253, v253, v85
v_mul_f32 v254, v254, v86
v_mul_f32 v255, v255, v87
v_cvt_pk_bf16_f32 v110, v252, v253
v_cvt_pk_bf16_f32 v111, v254, v255
buffer_store_dwordx4 v[108:111], v27, s[24:27], s53 offen offset:768 sc1
s_barrier
s_waitcnt vmcnt(0)
s_barrier
LK4_21:
s_setprio 1
ds_read_b128 v[32:35], v3 offset:0
ds_read_b64_tr_b16 v[48:49], v9 offset:0
ds_read_b64_tr_b16 v[50:51], v9 offset:2048
ds_read_b64_tr_b16 v[52:53], v10 offset:0
ds_read_b64_tr_b16 v[54:55], v10 offset:2048
ds_read_b128 v[36:39], v3 offset:256
ds_read_b64_tr_b16 v[56:57], v11 offset:0
ds_read_b64_tr_b16 v[58:59], v11 offset:2048
ds_read_b64_tr_b16 v[60:61], v12 offset:0
ds_read_b64_tr_b16 v[62:63], v12 offset:2048
ds_read_b128 v[40:43], v3 offset:8192
ds_read_b64_tr_b16 v[64:65], v9 offset:4096
ds_read_b64_tr_b16 v[66:67], v9 offset:6144
ds_read_b64_tr_b16 v[68:69], v10 offset:4096
ds_read_b64_tr_b16 v[70:71], v10 offset:6144
ds_read_b128 v[44:47], v3 offset:8448
ds_read_b64_tr_b16 v[72:73], v11 offset:4096
ds_read_b64_tr_b16 v[74:75], v11 offset:6144
ds_read_b64_tr_b16 v[76:77], v12 offset:4096
ds_read_b64_tr_b16 v[78:79], v12 offset:6144
s_waitcnt lgkmcnt(0)
s_barrier
v_mfma_f32_16x16x32_bf16 v[128:131], v[48:51], v[32:35], v[128:131]
ds_read_b128 v[80:83], v3 offset:24576
ds_read_b64_tr_b16 v[96:97], v9 offset:24576
v_mfma_f32_16x16x32_bf16 v[132:135], v[52:55], v[32:35], v[132:135]
ds_read_b64_tr_b16 v[98:99], v9 offset:26624
ds_read_b64_tr_b16 v[100:101], v10 offset:24576
v_mfma_f32_16x16x32_bf16 v[136:139], v[56:59], v[32:35], v[136:139]
ds_read_b64_tr_b16 v[102:103], v10 offset:26624
ds_read_b128 v[84:87], v3 offset:24832
v_mfma_f32_16x16x32_bf16 v[140:143], v[60:63], v[32:35], v[140:143]
ds_read_b64_tr_b16 v[104:105], v11 offset:24576
ds_read_b64_tr_b16 v[106:107], v11 offset:26624
v_mfma_f32_16x16x32_bf16 v[144:147], v[48:51], v[36:39], v[144:147]
ds_read_b64_tr_b16 v[108:109], v12 offset:24576
ds_read_b64_tr_b16 v[110:111], v12 offset:26624
v_mfma_f32_16x16x32_bf16 v[148:151], v[52:55], v[36:39], v[148:151]
ds_read_b128 v[88:91], v3 offset:32768
ds_read_b64_tr_b16 v[112:113], v9 offset:28672
v_mfma_f32_16x16x32_bf16 v[152:155], v[56:59], v[36:39], v[152:155]
ds_read_b64_tr_b16 v[114:115], v9 offset:30720
v_mfma_f32_16x16x32_bf16 v[156:159], v[60:63], v[36:39], v[156:159]
ds_read_b64_tr_b16 v[116:117], v10 offset:28672
v_mfma_f32_16x16x32_bf16 v[128:131], v[64:67], v[40:43], v[128:131]
ds_read_b64_tr_b16 v[118:119], v10 offset:30720
v_mfma_f32_16x16x32_bf16 v[132:135], v[68:71], v[40:43], v[132:135]
ds_read_b128 v[92:95], v3 offset:33024
v_mfma_f32_16x16x32_bf16 v[136:139], v[72:75], v[40:43], v[136:139]
ds_read_b64_tr_b16 v[120:121], v11 offset:28672
v_mfma_f32_16x16x32_bf16 v[140:143], v[76:79], v[40:43], v[140:143]
ds_read_b64_tr_b16 v[122:123], v11 offset:30720
v_mfma_f32_16x16x32_bf16 v[144:147], v[64:67], v[44:47], v[144:147]
ds_read_b64_tr_b16 v[124:125], v12 offset:28672
v_mfma_f32_16x16x32_bf16 v[148:151], v[68:71], v[44:47], v[148:151]
ds_read_b64_tr_b16 v[126:127], v12 offset:30720
v_mfma_f32_16x16x32_bf16 v[152:155], v[72:75], v[44:47], v[152:155]
v_mfma_f32_16x16x32_bf16 v[156:159], v[76:79], v[44:47], v[156:159]
s_waitcnt vmcnt(8) lgkmcnt(0)
s_barrier
v_mfma_f32_16x16x32_bf16 v[128:131], v[96:99], v[80:83], v[128:131]
ds_read_b128 v[32:35], v4 offset:0
ds_read_b64_tr_b16 v[48:49], v13 offset:0
v_mfma_f32_16x16x32_bf16 v[132:135], v[100:103], v[80:83], v[132:135]
ds_read_b64_tr_b16 v[50:51], v13 offset:2048
ds_read_b64_tr_b16 v[52:53], v14 offset:0
v_mfma_f32_16x16x32_bf16 v[136:139], v[104:107], v[80:83], v[136:139]
ds_read_b64_tr_b16 v[54:55], v14 offset:2048
ds_read_b128 v[36:39], v4 offset:256
v_mfma_f32_16x16x32_bf16 v[140:143], v[108:111], v[80:83], v[140:143]
ds_read_b64_tr_b16 v[56:57], v15 offset:0
ds_read_b64_tr_b16 v[58:59], v15 offset:2048
v_mfma_f32_16x16x32_bf16 v[144:147], v[96:99], v[84:87], v[144:147]
ds_read_b64_tr_b16 v[60:61], v16 offset:0
ds_read_b64_tr_b16 v[62:63], v16 offset:2048
v_mfma_f32_16x16x32_bf16 v[148:151], v[100:103], v[84:87], v[148:151]
ds_read_b128 v[40:43], v4 offset:8192
ds_read_b64_tr_b16 v[64:65], v13 offset:4096
v_mfma_f32_16x16x32_bf16 v[152:155], v[104:107], v[84:87], v[152:155]
ds_read_b64_tr_b16 v[66:67], v13 offset:6144
v_mfma_f32_16x16x32_bf16 v[156:159], v[108:111], v[84:87], v[156:159]
ds_read_b64_tr_b16 v[68:69], v14 offset:4096
v_mfma_f32_16x16x32_bf16 v[128:131], v[112:115], v[88:91], v[128:131]
ds_read_b64_tr_b16 v[70:71], v14 offset:6144
v_mfma_f32_16x16x32_bf16 v[132:135], v[116:119], v[88:91], v[132:135]
ds_read_b128 v[44:47], v4 offset:8448
v_mfma_f32_16x16x32_bf16 v[136:139], v[120:123], v[88:91], v[136:139]
ds_read_b64_tr_b16 v[72:73], v15 offset:4096
v_mfma_f32_16x16x32_bf16 v[140:143], v[124:127], v[88:91], v[140:143]
ds_read_b64_tr_b16 v[74:75], v15 offset:6144
v_mfma_f32_16x16x32_bf16 v[144:147], v[112:115], v[92:95], v[144:147]
ds_read_b64_tr_b16 v[76:77], v16 offset:4096
v_mfma_f32_16x16x32_bf16 v[148:151], v[116:119], v[92:95], v[148:151]
ds_read_b64_tr_b16 v[78:79], v16 offset:6144
v_mfma_f32_16x16x32_bf16 v[152:155], v[120:123], v[92:95], v[152:155]
v_mfma_f32_16x16x32_bf16 v[156:159], v[124:127], v[92:95], v[156:159]
s_waitcnt vmcnt(0) lgkmcnt(0)
s_barrier
v_mfma_f32_16x16x32_bf16 v[128:131], v[48:51], v[32:35], v[128:131]
ds_read_b128 v[80:83], v4 offset:24576
ds_read_b64_tr_b16 v[96:97], v13 offset:24576
v_mfma_f32_16x16x32_bf16 v[132:135], v[52:55], v[32:35], v[132:135]
ds_read_b64_tr_b16 v[98:99], v13 offset:26624
ds_read_b64_tr_b16 v[100:101], v14 offset:24576
v_mfma_f32_16x16x32_bf16 v[136:139], v[56:59], v[32:35], v[136:139]
ds_read_b64_tr_b16 v[102:103], v14 offset:26624
ds_read_b128 v[84:87], v4 offset:24832
v_mfma_f32_16x16x32_bf16 v[140:143], v[60:63], v[32:35], v[140:143]
ds_read_b64_tr_b16 v[104:105], v15 offset:24576
ds_read_b64_tr_b16 v[106:107], v15 offset:26624
v_mfma_f32_16x16x32_bf16 v[144:147], v[48:51], v[36:39], v[144:147]
ds_read_b64_tr_b16 v[108:109], v16 offset:24576
ds_read_b64_tr_b16 v[110:111], v16 offset:26624
v_mfma_f32_16x16x32_bf16 v[148:151], v[52:55], v[36:39], v[148:151]
ds_read_b128 v[88:91], v4 offset:32768
ds_read_b64_tr_b16 v[112:113], v13 offset:28672
v_mfma_f32_16x16x32_bf16 v[152:155], v[56:59], v[36:39], v[152:155]
ds_read_b64_tr_b16 v[114:115], v13 offset:30720
v_mfma_f32_16x16x32_bf16 v[156:159], v[60:63], v[36:39], v[156:159]
ds_read_b64_tr_b16 v[116:117], v14 offset:28672
v_mfma_f32_16x16x32_bf16 v[128:131], v[64:67], v[40:43], v[128:131]
ds_read_b64_tr_b16 v[118:119], v14 offset:30720
v_mfma_f32_16x16x32_bf16 v[132:135], v[68:71], v[40:43], v[132:135]
ds_read_b128 v[92:95], v4 offset:33024
v_mfma_f32_16x16x32_bf16 v[136:139], v[72:75], v[40:43], v[136:139]
ds_read_b64_tr_b16 v[120:121], v15 offset:28672
v_mfma_f32_16x16x32_bf16 v[140:143], v[76:79], v[40:43], v[140:143]
ds_read_b64_tr_b16 v[122:123], v15 offset:30720
v_mfma_f32_16x16x32_bf16 v[144:147], v[64:67], v[44:47], v[144:147]
ds_read_b64_tr_b16 v[124:125], v16 offset:28672
v_mfma_f32_16x16x32_bf16 v[148:151], v[68:71], v[44:47], v[148:151]
ds_read_b64_tr_b16 v[126:127], v16 offset:30720
v_mfma_f32_16x16x32_bf16 v[152:155], v[72:75], v[44:47], v[152:155]
v_mfma_f32_16x16x32_bf16 v[156:159], v[76:79], v[44:47], v[156:159]
s_mov_b32 s41, 8
Lg2_24:
s_waitcnt lgkmcnt(0)
s_barrier
v_mfma_f32_16x16x32_bf16 v[128:131], v[96:99], v[80:83], v[128:131]
ds_read_b128 v[32:35], v2 offset:0
ds_read_b64_tr_b16 v[48:49], v5 offset:0
v_mfma_f32_16x16x32_bf16 v[132:135], v[100:103], v[80:83], v[132:135]
ds_read_b64_tr_b16 v[50:51], v5 offset:2048
ds_read_b64_tr_b16 v[52:53], v6 offset:0
v_mfma_f32_16x16x32_bf16 v[136:139], v[104:107], v[80:83], v[136:139]
ds_read_b64_tr_b16 v[54:55], v6 offset:2048
ds_read_b128 v[36:39], v2 offset:256
v_mfma_f32_16x16x32_bf16 v[140:143], v[108:111], v[80:83], v[140:143]
ds_read_b64_tr_b16 v[56:57], v7 offset:0
ds_read_b64_tr_b16 v[58:59], v7 offset:2048
v_mfma_f32_16x16x32_bf16 v[144:147], v[96:99], v[84:87], v[144:147]
ds_read_b64_tr_b16 v[60:61], v8 offset:0
ds_read_b64_tr_b16 v[62:63], v8 offset:2048
v_mfma_f32_16x16x32_bf16 v[148:151], v[100:103], v[84:87], v[148:151]
ds_read_b128 v[40:43], v2 offset:8192
ds_read_b64_tr_b16 v[64:65], v5 offset:4096
v_mfma_f32_16x16x32_bf16 v[152:155], v[104:107], v[84:87], v[152:155]
ds_read_b64_tr_b16 v[66:67], v5 offset:6144
v_mfma_f32_16x16x32_bf16 v[156:159], v[108:111], v[84:87], v[156:159]
ds_read_b64_tr_b16 v[68:69], v6 offset:4096
v_mfma_f32_16x16x32_bf16 v[128:131], v[112:115], v[88:91], v[128:131]
ds_read_b64_tr_b16 v[70:71], v6 offset:6144
v_mfma_f32_16x16x32_bf16 v[132:135], v[116:119], v[88:91], v[132:135]
ds_read_b128 v[44:47], v2 offset:8448
v_mfma_f32_16x16x32_bf16 v[136:139], v[120:123], v[88:91], v[136:139]
ds_read_b64_tr_b16 v[72:73], v7 offset:4096
v_mfma_f32_16x16x32_bf16 v[140:143], v[124:127], v[88:91], v[140:143]
ds_read_b64_tr_b16 v[74:75], v7 offset:6144
v_mfma_f32_16x16x32_bf16 v[144:147], v[112:115], v[92:95], v[144:147]
ds_read_b64_tr_b16 v[76:77], v8 offset:4096
v_mfma_f32_16x16x32_bf16 v[148:151], v[116:119], v[92:95], v[148:151]
ds_read_b64_tr_b16 v[78:79], v8 offset:6144
v_mfma_f32_16x16x32_bf16 v[152:155], v[120:123], v[92:95], v[152:155]
v_mfma_f32_16x16x32_bf16 v[156:159], v[124:127], v[92:95], v[156:159]
s_waitcnt lgkmcnt(0)
s_barrier
v_mfma_f32_16x16x32_bf16 v[128:131], v[48:51], v[32:35], v[128:131]
ds_read_b128 v[80:83], v2 offset:24576
ds_read_b64_tr_b16 v[96:97], v5 offset:24576
v_mfma_f32_16x16x32_bf16 v[132:135], v[52:55], v[32:35], v[132:135]
ds_read_b64_tr_b16 v[98:99], v5 offset:26624
ds_read_b64_tr_b16 v[100:101], v6 offset:24576
v_mfma_f32_16x16x32_bf16 v[136:139], v[56:59], v[32:35], v[136:139]
ds_read_b64_tr_b16 v[102:103], v6 offset:26624
ds_read_b128 v[84:87], v2 offset:24832
v_mfma_f32_16x16x32_bf16 v[140:143], v[60:63], v[32:35], v[140:143]
ds_read_b64_tr_b16 v[104:105], v7 offset:24576
ds_read_b64_tr_b16 v[106:107], v7 offset:26624
v_mfma_f32_16x16x32_bf16 v[144:147], v[48:51], v[36:39], v[144:147]
ds_read_b64_tr_b16 v[108:109], v8 offset:24576
ds_read_b64_tr_b16 v[110:111], v8 offset:26624
v_mfma_f32_16x16x32_bf16 v[148:151], v[52:55], v[36:39], v[148:151]
ds_read_b128 v[88:91], v2 offset:32768
ds_read_b64_tr_b16 v[112:113], v5 offset:28672
v_mfma_f32_16x16x32_bf16 v[152:155], v[56:59], v[36:39], v[152:155]
ds_read_b64_tr_b16 v[114:115], v5 offset:30720
v_mfma_f32_16x16x32_bf16 v[156:159], v[60:63], v[36:39], v[156:159]
ds_read_b64_tr_b16 v[116:117], v6 offset:28672
v_mfma_f32_16x16x32_bf16 v[128:131], v[64:67], v[40:43], v[128:131]
ds_read_b64_tr_b16 v[118:119], v6 offset:30720
v_mfma_f32_16x16x32_bf16 v[132:135], v[68:71], v[40:43], v[132:135]
ds_read_b128 v[92:95], v2 offset:33024
v_mfma_f32_16x16x32_bf16 v[136:139], v[72:75], v[40:43], v[136:139]
ds_read_b64_tr_b16 v[120:121], v7 offset:28672
v_mfma_f32_16x16x32_bf16 v[140:143], v[76:79], v[40:43], v[140:143]
ds_read_b64_tr_b16 v[122:123], v7 offset:30720
v_mfma_f32_16x16x32_bf16 v[144:147], v[64:67], v[44:47], v[144:147]
ds_read_b64_tr_b16 v[124:125], v8 offset:28672
v_mfma_f32_16x16x32_bf16 v[148:151], v[68:71], v[44:47], v[148:151]
ds_read_b64_tr_b16 v[126:127], v8 offset:30720
v_mfma_f32_16x16x32_bf16 v[152:155], v[72:75], v[44:47], v[152:155]
v_mfma_f32_16x16x32_bf16 v[156:159], v[76:79], v[44:47], v[156:159]
s_waitcnt lgkmcnt(0)
s_barrier
v_mfma_f32_16x16x32_bf16 v[128:131], v[96:99], v[80:83], v[128:131]
ds_read_b128 v[32:35], v3 offset:0
ds_read_b64_tr_b16 v[48:49], v9 offset:0
v_mfma_f32_16x16x32_bf16 v[132:135], v[100:103], v[80:83], v[132:135]
ds_read_b64_tr_b16 v[50:51], v9 offset:2048
ds_read_b64_tr_b16 v[52:53], v10 offset:0
v_mfma_f32_16x16x32_bf16 v[136:139], v[104:107], v[80:83], v[136:139]
ds_read_b64_tr_b16 v[54:55], v10 offset:2048
ds_read_b128 v[36:39], v3 offset:256
v_mfma_f32_16x16x32_bf16 v[140:143], v[108:111], v[80:83], v[140:143]
ds_read_b64_tr_b16 v[56:57], v11 offset:0
ds_read_b64_tr_b16 v[58:59], v11 offset:2048
v_mfma_f32_16x16x32_bf16 v[144:147], v[96:99], v[84:87], v[144:147]
ds_read_b64_tr_b16 v[60:61], v12 offset:0
ds_read_b64_tr_b16 v[62:63], v12 offset:2048
v_mfma_f32_16x16x32_bf16 v[148:151], v[100:103], v[84:87], v[148:151]
ds_read_b128 v[40:43], v3 offset:8192
ds_read_b64_tr_b16 v[64:65], v9 offset:4096
v_mfma_f32_16x16x32_bf16 v[152:155], v[104:107], v[84:87], v[152:155]
ds_read_b64_tr_b16 v[66:67], v9 offset:6144
v_mfma_f32_16x16x32_bf16 v[156:159], v[108:111], v[84:87], v[156:159]
ds_read_b64_tr_b16 v[68:69], v10 offset:4096
v_mfma_f32_16x16x32_bf16 v[128:131], v[112:115], v[88:91], v[128:131]
ds_read_b64_tr_b16 v[70:71], v10 offset:6144
v_mfma_f32_16x16x32_bf16 v[132:135], v[116:119], v[88:91], v[132:135]
ds_read_b128 v[44:47], v3 offset:8448
v_mfma_f32_16x16x32_bf16 v[136:139], v[120:123], v[88:91], v[136:139]
ds_read_b64_tr_b16 v[72:73], v11 offset:4096
v_mfma_f32_16x16x32_bf16 v[140:143], v[124:127], v[88:91], v[140:143]
ds_read_b64_tr_b16 v[74:75], v11 offset:6144
v_mfma_f32_16x16x32_bf16 v[144:147], v[112:115], v[92:95], v[144:147]
ds_read_b64_tr_b16 v[76:77], v12 offset:4096
v_mfma_f32_16x16x32_bf16 v[148:151], v[116:119], v[92:95], v[148:151]
ds_read_b64_tr_b16 v[78:79], v12 offset:6144
v_mfma_f32_16x16x32_bf16 v[152:155], v[120:123], v[92:95], v[152:155]
v_mfma_f32_16x16x32_bf16 v[156:159], v[124:127], v[92:95], v[156:159]
s_waitcnt lgkmcnt(0)
s_barrier
v_mfma_f32_16x16x32_bf16 v[128:131], v[48:51], v[32:35], v[128:131]
ds_read_b128 v[80:83], v3 offset:24576
ds_read_b64_tr_b16 v[96:97], v9 offset:24576
v_mfma_f32_16x16x32_bf16 v[132:135], v[52:55], v[32:35], v[132:135]
ds_read_b64_tr_b16 v[98:99], v9 offset:26624
ds_read_b64_tr_b16 v[100:101], v10 offset:24576
v_mfma_f32_16x16x32_bf16 v[136:139], v[56:59], v[32:35], v[136:139]
ds_read_b64_tr_b16 v[102:103], v10 offset:26624
ds_read_b128 v[84:87], v3 offset:24832
v_mfma_f32_16x16x32_bf16 v[140:143], v[60:63], v[32:35], v[140:143]
ds_read_b64_tr_b16 v[104:105], v11 offset:24576
ds_read_b64_tr_b16 v[106:107], v11 offset:26624
v_mfma_f32_16x16x32_bf16 v[144:147], v[48:51], v[36:39], v[144:147]
ds_read_b64_tr_b16 v[108:109], v12 offset:24576
ds_read_b64_tr_b16 v[110:111], v12 offset:26624
v_mfma_f32_16x16x32_bf16 v[148:151], v[52:55], v[36:39], v[148:151]
ds_read_b128 v[88:91], v3 offset:32768
ds_read_b64_tr_b16 v[112:113], v9 offset:28672
v_mfma_f32_16x16x32_bf16 v[152:155], v[56:59], v[36:39], v[152:155]
ds_read_b64_tr_b16 v[114:115], v9 offset:30720
v_mfma_f32_16x16x32_bf16 v[156:159], v[60:63], v[36:39], v[156:159]
ds_read_b64_tr_b16 v[116:117], v10 offset:28672
v_mfma_f32_16x16x32_bf16 v[128:131], v[64:67], v[40:43], v[128:131]
ds_read_b64_tr_b16 v[118:119], v10 offset:30720
v_mfma_f32_16x16x32_bf16 v[132:135], v[68:71], v[40:43], v[132:135]
ds_read_b128 v[92:95], v3 offset:33024
v_mfma_f32_16x16x32_bf16 v[136:139], v[72:75], v[40:43], v[136:139]
ds_read_b64_tr_b16 v[120:121], v11 offset:28672
v_mfma_f32_16x16x32_bf16 v[140:143], v[76:79], v[40:43], v[140:143]
ds_read_b64_tr_b16 v[122:123], v11 offset:30720
v_mfma_f32_16x16x32_bf16 v[144:147], v[64:67], v[44:47], v[144:147]
ds_read_b64_tr_b16 v[124:125], v12 offset:28672
v_mfma_f32_16x16x32_bf16 v[148:151], v[68:71], v[44:47], v[148:151]
ds_read_b64_tr_b16 v[126:127], v12 offset:30720
v_mfma_f32_16x16x32_bf16 v[152:155], v[72:75], v[44:47], v[152:155]
v_mfma_f32_16x16x32_bf16 v[156:159], v[76:79], v[44:47], v[156:159]
s_waitcnt lgkmcnt(0)
s_barrier
v_mfma_f32_16x16x32_bf16 v[128:131], v[96:99], v[80:83], v[128:131]
ds_read_b128 v[32:35], v4 offset:0
ds_read_b64_tr_b16 v[48:49], v13 offset:0
v_mfma_f32_16x16x32_bf16 v[132:135], v[100:103], v[80:83], v[132:135]
ds_read_b64_tr_b16 v[50:51], v13 offset:2048
ds_read_b64_tr_b16 v[52:53], v14 offset:0
v_mfma_f32_16x16x32_bf16 v[136:139], v[104:107], v[80:83], v[136:139]
ds_read_b64_tr_b16 v[54:55], v14 offset:2048
ds_read_b128 v[36:39], v4 offset:256
v_mfma_f32_16x16x32_bf16 v[140:143], v[108:111], v[80:83], v[140:143]
ds_read_b64_tr_b16 v[56:57], v15 offset:0
ds_read_b64_tr_b16 v[58:59], v15 offset:2048
v_mfma_f32_16x16x32_bf16 v[144:147], v[96:99], v[84:87], v[144:147]
ds_read_b64_tr_b16 v[60:61], v16 offset:0
ds_read_b64_tr_b16 v[62:63], v16 offset:2048
v_mfma_f32_16x16x32_bf16 v[148:151], v[100:103], v[84:87], v[148:151]
ds_read_b128 v[40:43], v4 offset:8192
ds_read_b64_tr_b16 v[64:65], v13 offset:4096
v_mfma_f32_16x16x32_bf16 v[152:155], v[104:107], v[84:87], v[152:155]
ds_read_b64_tr_b16 v[66:67], v13 offset:6144
v_mfma_f32_16x16x32_bf16 v[156:159], v[108:111], v[84:87], v[156:159]
ds_read_b64_tr_b16 v[68:69], v14 offset:4096
v_mfma_f32_16x16x32_bf16 v[128:131], v[112:115], v[88:91], v[128:131]
ds_read_b64_tr_b16 v[70:71], v14 offset:6144
v_mfma_f32_16x16x32_bf16 v[132:135], v[116:119], v[88:91], v[132:135]
ds_read_b128 v[44:47], v4 offset:8448
v_mfma_f32_16x16x32_bf16 v[136:139], v[120:123], v[88:91], v[136:139]
ds_read_b64_tr_b16 v[72:73], v15 offset:4096
v_mfma_f32_16x16x32_bf16 v[140:143], v[124:127], v[88:91], v[140:143]
ds_read_b64_tr_b16 v[74:75], v15 offset:6144
v_mfma_f32_16x16x32_bf16 v[144:147], v[112:115], v[92:95], v[144:147]
ds_read_b64_tr_b16 v[76:77], v16 offset:4096
v_mfma_f32_16x16x32_bf16 v[148:151], v[116:119], v[92:95], v[148:151]
ds_read_b64_tr_b16 v[78:79], v16 offset:6144
v_mfma_f32_16x16x32_bf16 v[152:155], v[120:123], v[92:95], v[152:155]
v_mfma_f32_16x16x32_bf16 v[156:159], v[124:127], v[92:95], v[156:159]
s_waitcnt lgkmcnt(0)
s_barrier
v_mfma_f32_16x16x32_bf16 v[128:131], v[48:51], v[32:35], v[128:131]
ds_read_b128 v[80:83], v4 offset:24576
ds_read_b64_tr_b16 v[96:97], v13 offset:24576
v_mfma_f32_16x16x32_bf16 v[132:135], v[52:55], v[32:35], v[132:135]
ds_read_b64_tr_b16 v[98:99], v13 offset:26624
ds_read_b64_tr_b16 v[100:101], v14 offset:24576
v_mfma_f32_16x16x32_bf16 v[136:139], v[56:59], v[32:35], v[136:139]
ds_read_b64_tr_b16 v[102:103], v14 offset:26624
ds_read_b128 v[84:87], v4 offset:24832
v_mfma_f32_16x16x32_bf16 v[140:143], v[60:63], v[32:35], v[140:143]
ds_read_b64_tr_b16 v[104:105], v15 offset:24576
ds_read_b64_tr_b16 v[106:107], v15 offset:26624
v_mfma_f32_16x16x32_bf16 v[144:147], v[48:51], v[36:39], v[144:147]
ds_read_b64_tr_b16 v[108:109], v16 offset:24576
ds_read_b64_tr_b16 v[110:111], v16 offset:26624
v_mfma_f32_16x16x32_bf16 v[148:151], v[52:55], v[36:39], v[148:151]
ds_read_b128 v[88:91], v4 offset:32768
ds_read_b64_tr_b16 v[112:113], v13 offset:28672
v_mfma_f32_16x16x32_bf16 v[152:155], v[56:59], v[36:39], v[152:155]
ds_read_b64_tr_b16 v[114:115], v13 offset:30720
v_mfma_f32_16x16x32_bf16 v[156:159], v[60:63], v[36:39], v[156:159]
ds_read_b64_tr_b16 v[116:117], v14 offset:28672
v_mfma_f32_16x16x32_bf16 v[128:131], v[64:67], v[40:43], v[128:131]
ds_read_b64_tr_b16 v[118:119], v14 offset:30720
v_mfma_f32_16x16x32_bf16 v[132:135], v[68:71], v[40:43], v[132:135]
ds_read_b128 v[92:95], v4 offset:33024
v_mfma_f32_16x16x32_bf16 v[136:139], v[72:75], v[40:43], v[136:139]
ds_read_b64_tr_b16 v[120:121], v15 offset:28672
v_mfma_f32_16x16x32_bf16 v[140:143], v[76:79], v[40:43], v[140:143]
ds_read_b64_tr_b16 v[122:123], v15 offset:30720
v_mfma_f32_16x16x32_bf16 v[144:147], v[64:67], v[44:47], v[144:147]
ds_read_b64_tr_b16 v[124:125], v16 offset:28672
v_mfma_f32_16x16x32_bf16 v[148:151], v[68:71], v[44:47], v[148:151]
ds_read_b64_tr_b16 v[126:127], v16 offset:30720
v_mfma_f32_16x16x32_bf16 v[152:155], v[72:75], v[44:47], v[152:155]
v_mfma_f32_16x16x32_bf16 v[156:159], v[76:79], v[44:47], v[156:159]
s_sub_u32 s41, s41, 1
s_cmp_lg_u32 s41, 0
s_cbranch_scc1 Lg2_24
s_waitcnt lgkmcnt(0)
s_barrier
v_mfma_f32_16x16x32_bf16 v[128:131], v[96:99], v[80:83], v[128:131]
ds_read_b128 v[32:35], v2 offset:0
ds_read_b64_tr_b16 v[48:49], v5 offset:0
v_mfma_f32_16x16x32_bf16 v[132:135], v[100:103], v[80:83], v[132:135]
ds_read_b64_tr_b16 v[50:51], v5 offset:2048
ds_read_b64_tr_b16 v[52:53], v6 offset:0
v_mfma_f32_16x16x32_bf16 v[136:139], v[104:107], v[80:83], v[136:139]
ds_read_b64_tr_b16 v[54:55], v6 offset:2048
ds_read_b128 v[36:39], v2 offset:256
v_mfma_f32_16x16x32_bf16 v[140:143], v[108:111], v[80:83], v[140:143]
ds_read_b64_tr_b16 v[56:57], v7 offset:0
ds_read_b64_tr_b16 v[58:59], v7 offset:2048
v_mfma_f32_16x16x32_bf16 v[144:147], v[96:99], v[84:87], v[144:147]
ds_read_b64_tr_b16 v[60:61], v8 offset:0
ds_read_b64_tr_b16 v[62:63], v8 offset:2048
v_mfma_f32_16x16x32_bf16 v[148:151], v[100:103], v[84:87], v[148:151]
ds_read_b128 v[40:43], v2 offset:8192
ds_read_b64_tr_b16 v[64:65], v5 offset:4096
v_mfma_f32_16x16x32_bf16 v[152:155], v[104:107], v[84:87], v[152:155]
ds_read_b64_tr_b16 v[66:67], v5 offset:6144
v_mfma_f32_16x16x32_bf16 v[156:159], v[108:111], v[84:87], v[156:159]
ds_read_b64_tr_b16 v[68:69], v6 offset:4096
v_mfma_f32_16x16x32_bf16 v[128:131], v[112:115], v[88:91], v[128:131]
ds_read_b64_tr_b16 v[70:71], v6 offset:6144
v_mfma_f32_16x16x32_bf16 v[132:135], v[116:119], v[88:91], v[132:135]
ds_read_b128 v[44:47], v2 offset:8448
v_mfma_f32_16x16x32_bf16 v[136:139], v[120:123], v[88:91], v[136:139]
ds_read_b64_tr_b16 v[72:73], v7 offset:4096
v_mfma_f32_16x16x32_bf16 v[140:143], v[124:127], v[88:91], v[140:143]
ds_read_b64_tr_b16 v[74:75], v7 offset:6144
v_mfma_f32_16x16x32_bf16 v[144:147], v[112:115], v[92:95], v[144:147]
ds_read_b64_tr_b16 v[76:77], v8 offset:4096
v_mfma_f32_16x16x32_bf16 v[148:151], v[116:119], v[92:95], v[148:151]
ds_read_b64_tr_b16 v[78:79], v8 offset:6144
v_mfma_f32_16x16x32_bf16 v[152:155], v[120:123], v[92:95], v[152:155]
v_mfma_f32_16x16x32_bf16 v[156:159], v[124:127], v[92:95], v[156:159]
s_waitcnt lgkmcnt(0)
s_barrier
v_mfma_f32_16x16x32_bf16 v[128:131], v[48:51], v[32:35], v[128:131]
ds_read_b128 v[80:83], v2 offset:24576
ds_read_b64_tr_b16 v[96:97], v5 offset:24576
v_mfma_f32_16x16x32_bf16 v[132:135], v[52:55], v[32:35], v[132:135]
ds_read_b64_tr_b16 v[98:99], v5 offset:26624
ds_read_b64_tr_b16 v[100:101], v6 offset:24576
v_mfma_f32_16x16x32_bf16 v[136:139], v[56:59], v[32:35], v[136:139]
ds_read_b64_tr_b16 v[102:103], v6 offset:26624
ds_read_b128 v[84:87], v2 offset:24832
v_mfma_f32_16x16x32_bf16 v[140:143], v[60:63], v[32:35], v[140:143]
ds_read_b64_tr_b16 v[104:105], v7 offset:24576
ds_read_b64_tr_b16 v[106:107], v7 offset:26624
v_mfma_f32_16x16x32_bf16 v[144:147], v[48:51], v[36:39], v[144:147]
ds_read_b64_tr_b16 v[108:109], v8 offset:24576
ds_read_b64_tr_b16 v[110:111], v8 offset:26624
v_mfma_f32_16x16x32_bf16 v[148:151], v[52:55], v[36:39], v[148:151]
ds_read_b128 v[88:91], v2 offset:32768
ds_read_b64_tr_b16 v[112:113], v5 offset:28672
v_mfma_f32_16x16x32_bf16 v[152:155], v[56:59], v[36:39], v[152:155]
ds_read_b64_tr_b16 v[114:115], v5 offset:30720
v_mfma_f32_16x16x32_bf16 v[156:159], v[60:63], v[36:39], v[156:159]
ds_read_b64_tr_b16 v[116:117], v6 offset:28672
v_mfma_f32_16x16x32_bf16 v[128:131], v[64:67], v[40:43], v[128:131]
ds_read_b64_tr_b16 v[118:119], v6 offset:30720
v_mfma_f32_16x16x32_bf16 v[132:135], v[68:71], v[40:43], v[132:135]
ds_read_b128 v[92:95], v2 offset:33024
v_mfma_f32_16x16x32_bf16 v[136:139], v[72:75], v[40:43], v[136:139]
ds_read_b64_tr_b16 v[120:121], v7 offset:28672
v_mfma_f32_16x16x32_bf16 v[140:143], v[76:79], v[40:43], v[140:143]
ds_read_b64_tr_b16 v[122:123], v7 offset:30720
v_mfma_f32_16x16x32_bf16 v[144:147], v[64:67], v[44:47], v[144:147]
ds_read_b64_tr_b16 v[124:125], v8 offset:28672
v_mfma_f32_16x16x32_bf16 v[148:151], v[68:71], v[44:47], v[148:151]
ds_read_b64_tr_b16 v[126:127], v8 offset:30720
v_mfma_f32_16x16x32_bf16 v[152:155], v[72:75], v[44:47], v[152:155]
v_mfma_f32_16x16x32_bf16 v[156:159], v[76:79], v[44:47], v[156:159]
s_waitcnt lgkmcnt(0)
s_barrier
v_mfma_f32_16x16x32_bf16 v[128:131], v[96:99], v[80:83], v[128:131]
ds_read_b128 v[32:35], v3 offset:0
ds_read_b64_tr_b16 v[48:49], v9 offset:0
v_mfma_f32_16x16x32_bf16 v[132:135], v[100:103], v[80:83], v[132:135]
ds_read_b64_tr_b16 v[50:51], v9 offset:2048
ds_read_b64_tr_b16 v[52:53], v10 offset:0
v_mfma_f32_16x16x32_bf16 v[136:139], v[104:107], v[80:83], v[136:139]
ds_read_b64_tr_b16 v[54:55], v10 offset:2048
ds_read_b128 v[36:39], v3 offset:256
v_mfma_f32_16x16x32_bf16 v[140:143], v[108:111], v[80:83], v[140:143]
ds_read_b64_tr_b16 v[56:57], v11 offset:0
ds_read_b64_tr_b16 v[58:59], v11 offset:2048
v_mfma_f32_16x16x32_bf16 v[144:147], v[96:99], v[84:87], v[144:147]
ds_read_b64_tr_b16 v[60:61], v12 offset:0
ds_read_b64_tr_b16 v[62:63], v12 offset:2048
v_mfma_f32_16x16x32_bf16 v[148:151], v[100:103], v[84:87], v[148:151]
ds_read_b128 v[40:43], v3 offset:8192
ds_read_b64_tr_b16 v[64:65], v9 offset:4096
v_mfma_f32_16x16x32_bf16 v[152:155], v[104:107], v[84:87], v[152:155]
ds_read_b64_tr_b16 v[66:67], v9 offset:6144
v_mfma_f32_16x16x32_bf16 v[156:159], v[108:111], v[84:87], v[156:159]
ds_read_b64_tr_b16 v[68:69], v10 offset:4096
v_mfma_f32_16x16x32_bf16 v[128:131], v[112:115], v[88:91], v[128:131]
ds_read_b64_tr_b16 v[70:71], v10 offset:6144
v_mfma_f32_16x16x32_bf16 v[132:135], v[116:119], v[88:91], v[132:135]
ds_read_b128 v[44:47], v3 offset:8448
v_mfma_f32_16x16x32_bf16 v[136:139], v[120:123], v[88:91], v[136:139]
ds_read_b64_tr_b16 v[72:73], v11 offset:4096
v_mfma_f32_16x16x32_bf16 v[140:143], v[124:127], v[88:91], v[140:143]
ds_read_b64_tr_b16 v[74:75], v11 offset:6144
v_mfma_f32_16x16x32_bf16 v[144:147], v[112:115], v[92:95], v[144:147]
ds_read_b64_tr_b16 v[76:77], v12 offset:4096
v_mfma_f32_16x16x32_bf16 v[148:151], v[116:119], v[92:95], v[148:151]
ds_read_b64_tr_b16 v[78:79], v12 offset:6144
v_mfma_f32_16x16x32_bf16 v[152:155], v[120:123], v[92:95], v[152:155]
v_mfma_f32_16x16x32_bf16 v[156:159], v[124:127], v[92:95], v[156:159]
s_waitcnt lgkmcnt(0)
s_barrier
v_mfma_f32_16x16x32_bf16 v[128:131], v[48:51], v[32:35], v[128:131]
ds_read_b128 v[80:83], v3 offset:24576
ds_read_b64_tr_b16 v[96:97], v9 offset:24576
v_mfma_f32_16x16x32_bf16 v[132:135], v[52:55], v[32:35], v[132:135]
ds_read_b64_tr_b16 v[98:99], v9 offset:26624
ds_read_b64_tr_b16 v[100:101], v10 offset:24576
v_mfma_f32_16x16x32_bf16 v[136:139], v[56:59], v[32:35], v[136:139]
ds_read_b64_tr_b16 v[102:103], v10 offset:26624
ds_read_b128 v[84:87], v3 offset:24832
v_mfma_f32_16x16x32_bf16 v[140:143], v[60:63], v[32:35], v[140:143]
ds_read_b64_tr_b16 v[104:105], v11 offset:24576
ds_read_b64_tr_b16 v[106:107], v11 offset:26624
v_mfma_f32_16x16x32_bf16 v[144:147], v[48:51], v[36:39], v[144:147]
ds_read_b64_tr_b16 v[108:109], v12 offset:24576
ds_read_b64_tr_b16 v[110:111], v12 offset:26624
v_mfma_f32_16x16x32_bf16 v[148:151], v[52:55], v[36:39], v[148:151]
ds_read_b128 v[88:91], v3 offset:32768
ds_read_b64_tr_b16 v[112:113], v9 offset:28672
v_mfma_f32_16x16x32_bf16 v[152:155], v[56:59], v[36:39], v[152:155]
ds_read_b64_tr_b16 v[114:115], v9 offset:30720
v_mfma_f32_16x16x32_bf16 v[156:159], v[60:63], v[36:39], v[156:159]
ds_read_b64_tr_b16 v[116:117], v10 offset:28672
v_mfma_f32_16x16x32_bf16 v[128:131], v[64:67], v[40:43], v[128:131]
ds_read_b64_tr_b16 v[118:119], v10 offset:30720
v_mfma_f32_16x16x32_bf16 v[132:135], v[68:71], v[40:43], v[132:135]
ds_read_b128 v[92:95], v3 offset:33024
v_mfma_f32_16x16x32_bf16 v[136:139], v[72:75], v[40:43], v[136:139]
ds_read_b64_tr_b16 v[120:121], v11 offset:28672
v_mfma_f32_16x16x32_bf16 v[140:143], v[76:79], v[40:43], v[140:143]
ds_read_b64_tr_b16 v[122:123], v11 offset:30720
v_mfma_f32_16x16x32_bf16 v[144:147], v[64:67], v[44:47], v[144:147]
ds_read_b64_tr_b16 v[124:125], v12 offset:28672
v_mfma_f32_16x16x32_bf16 v[148:151], v[68:71], v[44:47], v[148:151]
ds_read_b64_tr_b16 v[126:127], v12 offset:30720
v_mfma_f32_16x16x32_bf16 v[152:155], v[72:75], v[44:47], v[152:155]
v_mfma_f32_16x16x32_bf16 v[156:159], v[76:79], v[44:47], v[156:159]
s_waitcnt lgkmcnt(0)
s_barrier
v_mfma_f32_16x16x32_bf16 v[128:131], v[96:99], v[80:83], v[128:131]
v_mfma_f32_16x16x32_bf16 v[132:135], v[100:103], v[80:83], v[132:135]
v_mfma_f32_16x16x32_bf16 v[136:139], v[104:107], v[80:83], v[136:139]
v_mfma_f32_16x16x32_bf16 v[140:143], v[108:111], v[80:83], v[140:143]
v_mfma_f32_16x16x32_bf16 v[144:147], v[96:99], v[84:87], v[144:147]
v_mfma_f32_16x16x32_bf16 v[148:151], v[100:103], v[84:87], v[148:151]
v_mfma_f32_16x16x32_bf16 v[152:155], v[104:107], v[84:87], v[152:155]
v_mfma_f32_16x16x32_bf16 v[156:159], v[108:111], v[84:87], v[156:159]
v_mfma_f32_16x16x32_bf16 v[128:131], v[112:115], v[88:91], v[128:131]
v_mfma_f32_16x16x32_bf16 v[132:135], v[116:119], v[88:91], v[132:135]
v_mfma_f32_16x16x32_bf16 v[136:139], v[120:123], v[88:91], v[136:139]
v_mfma_f32_16x16x32_bf16 v[140:143], v[124:127], v[88:91], v[140:143]
v_mfma_f32_16x16x32_bf16 v[144:147], v[112:115], v[92:95], v[144:147]
v_mfma_f32_16x16x32_bf16 v[148:151], v[116:119], v[92:95], v[148:151]
v_mfma_f32_16x16x32_bf16 v[152:155], v[120:123], v[92:95], v[152:155]
v_mfma_f32_16x16x32_bf16 v[156:159], v[124:127], v[92:95], v[156:159]
s_nop 4
v_cvt_pk_bf16_f32 v96, v128, v129
v_cvt_pk_bf16_f32 v97, v130, v131
v_cvt_pk_bf16_f32 v98, v132, v133
v_cvt_pk_bf16_f32 v99, v134, v135
v_cvt_pk_bf16_f32 v100, v136, v137
v_cvt_pk_bf16_f32 v101, v138, v139
v_cvt_pk_bf16_f32 v102, v140, v141
v_cvt_pk_bf16_f32 v103, v142, v143
v_cvt_pk_bf16_f32 v104, v144, v145
v_cvt_pk_bf16_f32 v105, v146, v147
v_cvt_pk_bf16_f32 v106, v148, v149
v_cvt_pk_bf16_f32 v107, v150, v151
v_cvt_pk_bf16_f32 v108, v152, v153
v_cvt_pk_bf16_f32 v109, v154, v155
v_cvt_pk_bf16_f32 v110, v156, v157
v_cvt_pk_bf16_f32 v111, v158, v159
v_permlane16_swap_b32 v96, v98
v_permlane16_swap_b32 v97, v99
buffer_store_dwordx4 v[96:99], v28, s[16:19], 0 offen offset:0
v_permlane16_swap_b32 v100, v102
v_permlane16_swap_b32 v101, v103
buffer_store_dwordx4 v[100:103], v28, s[16:19], 0 offen offset:64
v_permlane16_swap_b32 v104, v106
v_permlane16_swap_b32 v105, v107
buffer_store_dwordx4 v[104:107], v28, s[16:19], 0 offen offset:2048
v_permlane16_swap_b32 v108, v110
v_permlane16_swap_b32 v109, v111
buffer_store_dwordx4 v[108:111], v28, s[16:19], 0 offen offset:2112
s_branch Ldone_1
LG1_16:
s_cmp_eq_u32 s36, 7
s_cbranch_scc1 L7_25
s_mul_i32 s44, s34, 262144
s_lshl_b32 s39, s51, 13
s_add_u32 s44, s44, s39
s_add_u32 s44, s44, 0
s_lshl_b32 s43, s35, 7
s_mov_b32 s10, 253952
s_movk_i32 s38, 1024
s_movk_i32 s40, 9216
s_cmp_eq_u32 s51, 2
s_cselect_b32 s8, s28, s32
s_cselect_b32 s9, s29, s33
s_cselect_b32 s10, 2095232, s10
s_cselect_b32 s43, s43, s44
s_cselect_b32 s38, 16384, s38
s_cselect_b32 s40, 16384, s40
s_cselect_b32 s55, 16384, s38
s_cselect_b32 s45, -1, 0
s_add_u32 s8, s8, s43
s_addc_u32 s9, s9, 0
s_mov_b32 s11, 0x20000
s_sub_u32 s37, 0, s40
v_lshrrev_b32 v19, 3, v1
v_mul_u32_u24 v19, 1920, v19
v_lshrrev_b32 v20, 4, v1
v_lshlrev_b32 v20, 5, v20
v_and_b32 v19, s45, v19
v_and_b32 v20, s45, v20
v_lshlrev_b32 v23, 4, v1
v_xor_b32 v23, v23, v20
v_add_u32 v23, v23, v19
s_lshl_b32 s43, s34, 18
s_add_u32 s12, s32, s43
s_addc_u32 s13, s33, 0
s_mov_b32 s14, 262144
s_mov_b32 s15, 0x20000
v_lshlrev_b32 v21, 4, v1
s_lshl_b32 s54, s36, 11
s_cmp_eq_u32 s51, 1
s_cbranch_scc1 Lp_29
s_cmp_eq_u32 s51, 2
s_cbranch_scc1 Lp_30
Lp_28:
s_add_u32 s43, s34, 0
s_lshl_b32 s43, s43, 7
v_mov_b32 v12, s43
v_mov_b32 v14, 16
buffer_load_dword v13, v12, s[56:59], 0 offen sc1
s_mov_b32 s41, 0x10000
Lpoll_31:
s_waitcnt vmcnt(0)
v_cmp_ne_u32 vcc, v14, v13
s_nop 4
s_cbranch_vccz Lpok_32
buffer_load_dword v13, v12, s[56:59], 0 offen sc1
s_sub_u32 s41, s41, 1
s_cmp_lg_u32 s41, 0
s_cbranch_scc1 Lpoll_31
s_waitcnt vmcnt(0)
Lpok_32:
s_barrier
s_add_u32 m0, s54, 0
s_add_u32 s43, s54, 0
buffer_load_dwordx4 v21, s[12:15], s43 offen sc1 lds
s_add_u32 m0, s54, 1024
s_add_u32 s43, s54, 1024
buffer_load_dwordx4 v21, s[12:15], s43 offen sc1 lds
s_add_u32 m0, s54, 24576
s_add_u32 s43, s54, 16384
buffer_load_dwordx4 v21, s[12:15], s43 offen sc1 lds
s_add_u32 m0, s54, 25600
s_add_u32 s43, s54, 17408
buffer_load_dwordx4 v21, s[12:15], s43 offen sc1 lds
s_add_u32 s37, s37, 32768
s_add_u32 m0, s39, 49152
s_add_u32 s37, s37, s40
buffer_load_dwordx4 v23, s[8:11], s37 offen sc1 lds
s_add_u32 m0, s39, 50176
s_add_u32 s37, s37, s38
buffer_load_dwordx4 v23, s[8:11], s37 offen sc1 lds
s_add_u32 m0, s39, 51200
s_add_u32 s37, s37, s38
buffer_load_dwordx4 v23, s[8:11], s37 offen sc1 lds
s_add_u32 m0, s39, 52224
s_add_u32 s37, s37, s38
buffer_load_dwordx4 v23, s[8:11], s37 offen sc1 lds
s_add_u32 m0, s39, 53248
s_add_u32 s37, s37, s55
buffer_load_dwordx4 v23, s[8:11], s37 offen sc1 lds
s_add_u32 m0, s39, 54272
s_add_u32 s37, s37, s38
buffer_load_dwordx4 v23, s[8:11], s37 offen sc1 lds
s_add_u32 m0, s39, 55296
s_add_u32 s37, s37, s38
buffer_load_dwordx4 v23, s[8:11], s37 offen sc1 lds
s_add_u32 m0, s39, 56320
s_add_u32 s37, s37, s38
buffer_load_dwordx4 v23, s[8:11], s37 offen sc1 lds
s_add_u32 m0, s39, 73728
s_add_u32 s37, s37, s40
buffer_load_dwordx4 v23, s[8:11], s37 offen sc1 lds
s_add_u32 m0, s39, 74752
s_add_u32 s37, s37, s38
buffer_load_dwordx4 v23, s[8:11], s37 offen sc1 lds
s_add_u32 m0, s39, 75776
s_add_u32 s37, s37, s38
buffer_load_dwordx4 v23, s[8:11], s37 offen sc1 lds
s_add_u32 m0, s39, 76800
s_add_u32 s37, s37, s38
buffer_load_dwordx4 v23, s[8:11], s37 offen sc1 lds
s_add_u32 m0, s39, 77824
s_add_u32 s37, s37, s55
buffer_load_dwordx4 v23, s[8:11], s37 offen sc1 lds
s_add_u32 m0, s39, 78848
s_add_u32 s37, s37, s38
buffer_load_dwordx4 v23, s[8:11], s37 offen sc1 lds
s_add_u32 m0, s39, 79872
s_add_u32 s37, s37, s38
buffer_load_dwordx4 v23, s[8:11], s37 offen sc1 lds
s_add_u32 m0, s39, 80896
s_add_u32 s37, s37, s38
buffer_load_dwordx4 v23, s[8:11], s37 offen sc1 lds
s_add_u32 m0, s39, 98304
s_add_u32 s37, s37, s40
buffer_load_dwordx4 v23, s[8:11], s37 offen sc1 lds
s_add_u32 m0, s39, 99328
s_add_u32 s37, s37, s38
buffer_load_dwordx4 v23, s[8:11], s37 offen sc1 lds
s_add_u32 m0, s39, 100352
s_add_u32 s37, s37, s38
buffer_load_dwordx4 v23, s[8:11], s37 offen sc1 lds
s_add_u32 m0, s39, 101376
s_add_u32 s37, s37, s38
buffer_load_dwordx4 v23, s[8:11], s37 offen sc1 lds
s_add_u32 m0, s39, 102400
s_add_u32 s37, s37, s55
buffer_load_dwordx4 v23, s[8:11], s37 offen sc1 lds
s_add_u32 m0, s39, 103424
s_add_u32 s37, s37, s38
buffer_load_dwordx4 v23, s[8:11], s37 offen sc1 lds
s_add_u32 m0, s39, 104448
s_add_u32 s37, s37, s38
buffer_load_dwordx4 v23, s[8:11], s37 offen sc1 lds
s_add_u32 m0, s39, 105472
s_add_u32 s37, s37, s38
buffer_load_dwordx4 v23, s[8:11], s37 offen sc1 lds
s_add_u32 m0, s39, 122880
s_add_u32 s37, s37, s40
buffer_load_dwordx4 v23, s[8:11], s37 offen sc1 lds
s_add_u32 m0, s39, 123904
s_add_u32 s37, s37, s38
buffer_load_dwordx4 v23, s[8:11], s37 offen sc1 lds
s_add_u32 m0, s39, 124928
s_add_u32 s37, s37, s38
buffer_load_dwordx4 v23, s[8:11], s37 offen sc1 lds
s_add_u32 m0, s39, 125952
s_add_u32 s37, s37, s38
buffer_load_dwordx4 v23, s[8:11], s37 offen sc1 lds
s_add_u32 m0, s39, 126976
s_add_u32 s37, s37, s55
buffer_load_dwordx4 v23, s[8:11], s37 offen sc1 lds
s_add_u32 m0, s39, 128000
s_add_u32 s37, s37, s38
buffer_load_dwordx4 v23, s[8:11], s37 offen sc1 lds
s_add_u32 m0, s39, 129024
s_add_u32 s37, s37, s38
buffer_load_dwordx4 v23, s[8:11], s37 offen sc1 lds
s_add_u32 m0, s39, 130048
s_add_u32 s37, s37, s38
buffer_load_dwordx4 v23, s[8:11], s37 offen sc1 lds
s_waitcnt vmcnt(34)
s_barrier
s_waitcnt vmcnt(32)
s_barrier
s_add_u32 m0, s39, 0
s_add_u32 s37, s37, s40
buffer_load_dwordx4 v23, s[8:11], s37 offen sc1 lds
s_add_u32 m0, s39, 1024
s_add_u32 s37, s37, s38
buffer_load_dwordx4 v23, s[8:11], s37 offen sc1 lds
s_add_u32 m0, s39, 2048
s_add_u32 s37, s37, s38
buffer_load_dwordx4 v23, s[8:11], s37 offen sc1 lds
s_add_u32 m0, s39, 3072
s_add_u32 s37, s37, s38
buffer_load_dwordx4 v23, s[8:11], s37 offen sc1 lds
s_add_u32 m0, s39, 4096
s_add_u32 s37, s37, s55
buffer_load_dwordx4 v23, s[8:11], s37 offen sc1 lds
s_add_u32 m0, s39, 5120
s_add_u32 s37, s37, s38
buffer_load_dwordx4 v23, s[8:11], s37 offen sc1 lds
s_add_u32 m0, s39, 6144
s_add_u32 s37, s37, s38
buffer_load_dwordx4 v23, s[8:11], s37 offen sc1 lds
s_add_u32 m0, s39, 7168
s_add_u32 s37, s37, s38
buffer_load_dwordx4 v23, s[8:11], s37 offen sc1 lds
s_waitcnt vmcnt(32)
s_barrier
s_add_u32 m0, s39, 24576
s_add_u32 s37, s37, s40
buffer_load_dwordx4 v23, s[8:11], s37 offen sc1 lds
s_add_u32 m0, s39, 25600
s_add_u32 s37, s37, s38
buffer_load_dwordx4 v23, s[8:11], s37 offen sc1 lds
s_add_u32 m0, s39, 26624
s_add_u32 s37, s37, s38
buffer_load_dwordx4 v23, s[8:11], s37 offen sc1 lds
s_add_u32 m0, s39, 27648
s_add_u32 s37, s37, s38
buffer_load_dwordx4 v23, s[8:11], s37 offen sc1 lds
s_add_u32 m0, s39, 28672
s_add_u32 s37, s37, s55
buffer_load_dwordx4 v23, s[8:11], s37 offen sc1 lds
s_add_u32 m0, s39, 29696
s_add_u32 s37, s37, s38
buffer_load_dwordx4 v23, s[8:11], s37 offen sc1 lds
s_add_u32 m0, s39, 30720
s_add_u32 s37, s37, s38
buffer_load_dwordx4 v23, s[8:11], s37 offen sc1 lds
s_add_u32 m0, s39, 31744
s_add_u32 s37, s37, s38
buffer_load_dwordx4 v23, s[8:11], s37 offen sc1 lds
s_waitcnt vmcnt(32)
s_barrier
s_add_u32 m0, s39, 49152
s_add_u32 s37, s37, s40
buffer_load_dwordx4 v23, s[8:11], s37 offen sc1 lds
s_add_u32 m0, s39, 50176
s_add_u32 s37, s37, s38
buffer_load_dwordx4 v23, s[8:11], s37 offen sc1 lds
s_add_u32 m0, s39, 51200
s_add_u32 s37, s37, s38
buffer_load_dwordx4 v23, s[8:11], s37 offen sc1 lds
s_add_u32 m0, s39, 52224
s_add_u32 s37, s37, s38
buffer_load_dwordx4 v23, s[8:11], s37 offen sc1 lds
s_add_u32 m0, s39, 53248
s_add_u32 s37, s37, s55
buffer_load_dwordx4 v23, s[8:11], s37 offen sc1 lds
s_add_u32 m0, s39, 54272
s_add_u32 s37, s37, s38
buffer_load_dwordx4 v23, s[8:11], s37 offen sc1 lds
s_add_u32 m0, s39, 55296
s_add_u32 s37, s37, s38
buffer_load_dwordx4 v23, s[8:11], s37 offen sc1 lds
s_add_u32 m0, s39, 56320
s_add_u32 s37, s37, s38
buffer_load_dwordx4 v23, s[8:11], s37 offen sc1 lds
s_waitcnt vmcnt(32)
s_barrier
s_add_u32 m0, s39, 73728
s_add_u32 s37, s37, s40
buffer_load_dwordx4 v23, s[8:11], s37 offen sc1 lds
s_add_u32 m0, s39, 74752
s_add_u32 s37, s37, s38
buffer_load_dwordx4 v23, s[8:11], s37 offen sc1 lds
s_add_u32 m0, s39, 75776
s_add_u32 s37, s37, s38
buffer_load_dwordx4 v23, s[8:11], s37 offen sc1 lds
s_add_u32 m0, s39, 76800
s_add_u32 s37, s37, s38
buffer_load_dwordx4 v23, s[8:11], s37 offen sc1 lds
s_add_u32 m0, s39, 77824
s_add_u32 s37, s37, s55
buffer_load_dwordx4 v23, s[8:11], s37 offen sc1 lds
s_add_u32 m0, s39, 78848
s_add_u32 s37, s37, s38
buffer_load_dwordx4 v23, s[8:11], s37 offen sc1 lds
s_add_u32 m0, s39, 79872
s_add_u32 s37, s37, s38
buffer_load_dwordx4 v23, s[8:11], s37 offen sc1 lds
s_add_u32 m0, s39, 80896
s_add_u32 s37, s37, s38
buffer_load_dwordx4 v23, s[8:11], s37 offen sc1 lds
s_waitcnt vmcnt(32)
s_barrier
s_add_u32 m0, s39, 98304
s_add_u32 s37, s37, s40
buffer_load_dwordx4 v23, s[8:11], s37 offen sc1 lds
s_add_u32 m0, s39, 99328
s_add_u32 s37, s37, s38
buffer_load_dwordx4 v23, s[8:11], s37 offen sc1 lds
s_add_u32 m0, s39, 100352
s_add_u32 s37, s37, s38
buffer_load_dwordx4 v23, s[8:11], s37 offen sc1 lds
s_add_u32 m0, s39, 101376
s_add_u32 s37, s37, s38
buffer_load_dwordx4 v23, s[8:11], s37 offen sc1 lds
s_add_u32 m0, s39, 102400
s_add_u32 s37, s37, s55
buffer_load_dwordx4 v23, s[8:11], s37 offen sc1 lds
s_add_u32 m0, s39, 103424
s_add_u32 s37, s37, s38
buffer_load_dwordx4 v23, s[8:11], s37 offen sc1 lds
s_add_u32 m0, s39, 104448
s_add_u32 s37, s37, s38
buffer_load_dwordx4 v23, s[8:11], s37 offen sc1 lds
s_add_u32 m0, s39, 105472
s_add_u32 s37, s37, s38
buffer_load_dwordx4 v23, s[8:11], s37 offen sc1 lds
s_waitcnt vmcnt(32)
s_barrier
s_add_u32 m0, s39, 122880
s_add_u32 s37, s37, s40
buffer_load_dwordx4 v23, s[8:11], s37 offen sc1 lds
s_add_u32 m0, s39, 123904
s_add_u32 s37, s37, s38
buffer_load_dwordx4 v23, s[8:11], s37 offen sc1 lds
s_add_u32 m0, s39, 124928
s_add_u32 s37, s37, s38
buffer_load_dwordx4 v23, s[8:11], s37 offen sc1 lds
s_add_u32 m0, s39, 125952
s_add_u32 s37, s37, s38
buffer_load_dwordx4 v23, s[8:11], s37 offen sc1 lds
s_add_u32 m0, s39, 126976
s_add_u32 s37, s37, s55
buffer_load_dwordx4 v23, s[8:11], s37 offen sc1 lds
s_add_u32 m0, s39, 128000
s_add_u32 s37, s37, s38
buffer_load_dwordx4 v23, s[8:11], s37 offen sc1 lds
s_add_u32 m0, s39, 129024
s_add_u32 s37, s37, s38
buffer_load_dwordx4 v23, s[8:11], s37 offen sc1 lds
s_add_u32 m0, s39, 130048
s_add_u32 s37, s37, s38
buffer_load_dwordx4 v23, s[8:11], s37 offen sc1 lds
s_waitcnt vmcnt(32)
s_barrier
s_add_u32 m0, s39, 0
s_add_u32 s37, s37, s40
buffer_load_dwordx4 v23, s[8:11], s37 offen sc1 lds
s_add_u32 m0, s39, 1024
s_add_u32 s37, s37, s38
buffer_load_dwordx4 v23, s[8:11], s37 offen sc1 lds
s_add_u32 m0, s39, 2048
s_add_u32 s37, s37, s38
buffer_load_dwordx4 v23, s[8:11], s37 offen sc1 lds
s_add_u32 m0, s39, 3072
s_add_u32 s37, s37, s38
buffer_load_dwordx4 v23, s[8:11], s37 offen sc1 lds
s_add_u32 m0, s39, 4096
s_add_u32 s37, s37, s55
buffer_load_dwordx4 v23, s[8:11], s37 offen sc1 lds
s_add_u32 m0, s39, 5120
s_add_u32 s37, s37, s38
buffer_load_dwordx4 v23, s[8:11], s37 offen sc1 lds
s_add_u32 m0, s39, 6144
s_add_u32 s37, s37, s38
buffer_load_dwordx4 v23, s[8:11], s37 offen sc1 lds
s_add_u32 m0, s39, 7168
s_add_u32 s37, s37, s38
buffer_load_dwordx4 v23, s[8:11], s37 offen sc1 lds
s_waitcnt vmcnt(32)
s_barrier
s_add_u32 m0, s39, 24576
s_add_u32 s37, s37, s40
buffer_load_dwordx4 v23, s[8:11], s37 offen sc1 lds
s_add_u32 m0, s39, 25600
s_add_u32 s37, s37, s38
buffer_load_dwordx4 v23, s[8:11], s37 offen sc1 lds
s_add_u32 m0, s39, 26624
s_add_u32 s37, s37, s38
buffer_load_dwordx4 v23, s[8:11], s37 offen sc1 lds
s_add_u32 m0, s39, 27648
s_add_u32 s37, s37, s38
buffer_load_dwordx4 v23, s[8:11], s37 offen sc1 lds
s_add_u32 m0, s39, 28672
s_add_u32 s37, s37, s55
buffer_load_dwordx4 v23, s[8:11], s37 offen sc1 lds
s_add_u32 m0, s39, 29696
s_add_u32 s37, s37, s38
buffer_load_dwordx4 v23, s[8:11], s37 offen sc1 lds
s_add_u32 m0, s39, 30720
s_add_u32 s37, s37, s38
buffer_load_dwordx4 v23, s[8:11], s37 offen sc1 lds
s_add_u32 m0, s39, 31744
s_add_u32 s37, s37, s38
buffer_load_dwordx4 v23, s[8:11], s37 offen sc1 lds
s_waitcnt vmcnt(32)
s_barrier
s_add_u32 m0, s39, 49152
s_add_u32 s37, s37, s40
buffer_load_dwordx4 v23, s[8:11], s37 offen sc1 lds
s_add_u32 m0, s39, 50176
s_add_u32 s37, s37, s38
buffer_load_dwordx4 v23, s[8:11], s37 offen sc1 lds
s_add_u32 m0, s39, 51200
s_add_u32 s37, s37, s38
buffer_load_dwordx4 v23, s[8:11], s37 offen sc1 lds
s_add_u32 m0, s39, 52224
s_add_u32 s37, s37, s38
buffer_load_dwordx4 v23, s[8:11], s37 offen sc1 lds
s_add_u32 m0, s39, 53248
s_add_u32 s37, s37, s55
buffer_load_dwordx4 v23, s[8:11], s37 offen sc1 lds
s_add_u32 m0, s39, 54272
s_add_u32 s37, s37, s38
buffer_load_dwordx4 v23, s[8:11], s37 offen sc1 lds
s_add_u32 m0, s39, 55296
s_add_u32 s37, s37, s38
buffer_load_dwordx4 v23, s[8:11], s37 offen sc1 lds
s_add_u32 m0, s39, 56320
s_add_u32 s37, s37, s38
buffer_load_dwordx4 v23, s[8:11], s37 offen sc1 lds
s_waitcnt vmcnt(32)
s_barrier
s_add_u32 m0, s39, 73728
s_add_u32 s37, s37, s40
buffer_load_dwordx4 v23, s[8:11], s37 offen sc1 lds
s_add_u32 m0, s39, 74752
s_add_u32 s37, s37, s38
buffer_load_dwordx4 v23, s[8:11], s37 offen sc1 lds
s_add_u32 m0, s39, 75776
s_add_u32 s37, s37, s38
buffer_load_dwordx4 v23, s[8:11], s37 offen sc1 lds
s_add_u32 m0, s39, 76800
s_add_u32 s37, s37, s38
buffer_load_dwordx4 v23, s[8:11], s37 offen sc1 lds
s_add_u32 m0, s39, 77824
s_add_u32 s37, s37, s55
buffer_load_dwordx4 v23, s[8:11], s37 offen sc1 lds
s_add_u32 m0, s39, 78848
s_add_u32 s37, s37, s38
buffer_load_dwordx4 v23, s[8:11], s37 offen sc1 lds
s_add_u32 m0, s39, 79872
s_add_u32 s37, s37, s38
buffer_load_dwordx4 v23, s[8:11], s37 offen sc1 lds
s_add_u32 m0, s39, 80896
s_add_u32 s37, s37, s38
buffer_load_dwordx4 v23, s[8:11], s37 offen sc1 lds
s_waitcnt vmcnt(32)
s_barrier
s_lshl_b32 s43, s35, 8
s_cmp_eq_u32 s51, 1
s_cselect_b32 s8, s4, s6
s_cselect_b32 s9, s5, s7
s_sub_u32 s10, 7340032, s43
s_lshl_b32 s44, s34, 18
s_add_u32 s44, s44, 4194304
s_movk_i32 s38, 28672
s_cmp_eq_u32 s51, 0
s_cselect_b32 s8, s32, s8
s_cselect_b32 s9, s33, s9
s_cselect_b32 s10, 262144, s10
s_cselect_b32 s43, s44, s43
s_cselect_b32 s38, 1024, s38
s_cselect_b32 s45, 0, -1
s_add_u32 s8, s8, s43
s_addc_u32 s9, s9, 0
s_mov_b32 s11, 0x20000
s_sub_u32 s37, 0, s38
s_lshl_b32 s39, s51, 14
v_lshrrev_b32 v19, 4, v1
v_lshlrev_b32 v20, 5, v19
v_mul_u32_u24 v19, 6912, v19
v_and_b32 v19, s45, v19
v_and_b32 v20, s45, v20
v_lshlrev_b32 v21, 4, v1
v_xor_b32 v21, v21, v20
v_add_u32 v22, v21, v19
s_and_b32 s45, s45, 128
v_xor_b32 v23, s45, v22
s_waitcnt vmcnt(24)
s_barrier
s_waitcnt vmcnt(16)
s_barrier
s_waitcnt vmcnt(8)
s_barrier
s_waitcnt vmcnt(0)
s_barrier
s_barrier
s_barrier
s_mul_i32 s43, s38, 48
s_add_u32 s37, s37, s43
s_add_u32 s43, s34, 16
s_lshl_b32 s43, s43, 7
v_mov_b32 v12, s43
v_mov_b32 v14, 16
buffer_load_dword v13, v12, s[56:59], 0 offen sc1
s_mov_b32 s41, 0x10000
Lpoll_33:
s_waitcnt vmcnt(0)
v_cmp_ne_u32 vcc, v14, v13
s_nop 4
s_cbranch_vccz Lpok_34
buffer_load_dword v13, v12, s[56:59], 0 offen sc1
s_sub_u32 s41, s41, 1
s_cmp_lg_u32 s41, 0
s_cbranch_scc1 Lpoll_33
s_waitcnt vmcnt(0)
Lpok_34:
s_branch LP3_27
Lp_29:
s_barrier
s_add_u32 m0, s54, 0
s_add_u32 s43, s54, 0
buffer_load_dwordx4 v21, s[12:15], s43 offen sc1 lds
s_add_u32 m0, s54, 1024
s_add_u32 s43, s54, 1024
buffer_load_dwordx4 v21, s[12:15], s43 offen sc1 lds
s_add_u32 m0, s54, 24576
s_add_u32 s43, s54, 16384
buffer_load_dwordx4 v21, s[12:15], s43 offen sc1 lds
s_add_u32 m0, s54, 25600
s_add_u32 s43, s54, 17408
buffer_load_dwordx4 v21, s[12:15], s43 offen sc1 lds
s_add_u32 s37, s37, 32768
s_add_u32 m0, s39, 49152
s_add_u32 s37, s37, s40
buffer_load_dwordx4 v23, s[8:11], s37 offen sc1 lds
s_add_u32 m0, s39, 50176
s_add_u32 s37, s37, s38
buffer_load_dwordx4 v23, s[8:11], s37 offen sc1 lds
s_add_u32 m0, s39, 51200
s_add_u32 s37, s37, s38
buffer_load_dwordx4 v23, s[8:11], s37 offen sc1 lds
s_add_u32 m0, s39, 52224
s_add_u32 s37, s37, s38
buffer_load_dwordx4 v23, s[8:11], s37 offen sc1 lds
s_add_u32 m0, s39, 53248
s_add_u32 s37, s37, s55
buffer_load_dwordx4 v23, s[8:11], s37 offen sc1 lds
s_add_u32 m0, s39, 54272
s_add_u32 s37, s37, s38
buffer_load_dwordx4 v23, s[8:11], s37 offen sc1 lds
s_add_u32 m0, s39, 55296
s_add_u32 s37, s37, s38
buffer_load_dwordx4 v23, s[8:11], s37 offen sc1 lds
s_add_u32 m0, s39, 56320
s_add_u32 s37, s37, s38
buffer_load_dwordx4 v23, s[8:11], s37 offen sc1 lds
s_add_u32 m0, s39, 73728
s_add_u32 s37, s37, s40
buffer_load_dwordx4 v23, s[8:11], s37 offen sc1 lds
s_add_u32 m0, s39, 74752
s_add_u32 s37, s37, s38
buffer_load_dwordx4 v23, s[8:11], s37 offen sc1 lds
s_add_u32 m0, s39, 75776
s_add_u32 s37, s37, s38
buffer_load_dwordx4 v23, s[8:11], s37 offen sc1 lds
s_add_u32 m0, s39, 76800
s_add_u32 s37, s37, s38
buffer_load_dwordx4 v23, s[8:11], s37 offen sc1 lds
s_add_u32 m0, s39, 77824
s_add_u32 s37, s37, s55
buffer_load_dwordx4 v23, s[8:11], s37 offen sc1 lds
s_add_u32 m0, s39, 78848
s_add_u32 s37, s37, s38
buffer_load_dwordx4 v23, s[8:11], s37 offen sc1 lds
s_add_u32 m0, s39, 79872
s_add_u32 s37, s37, s38
buffer_load_dwordx4 v23, s[8:11], s37 offen sc1 lds
s_add_u32 m0, s39, 80896
s_add_u32 s37, s37, s38
buffer_load_dwordx4 v23, s[8:11], s37 offen sc1 lds
s_add_u32 m0, s39, 98304
s_add_u32 s37, s37, s40
buffer_load_dwordx4 v23, s[8:11], s37 offen sc1 lds
s_add_u32 m0, s39, 99328
s_add_u32 s37, s37, s38
buffer_load_dwordx4 v23, s[8:11], s37 offen sc1 lds
s_add_u32 m0, s39, 100352
s_add_u32 s37, s37, s38
buffer_load_dwordx4 v23, s[8:11], s37 offen sc1 lds
s_add_u32 m0, s39, 101376
s_add_u32 s37, s37, s38
buffer_load_dwordx4 v23, s[8:11], s37 offen sc1 lds
s_add_u32 m0, s39, 102400
s_add_u32 s37, s37, s55
buffer_load_dwordx4 v23, s[8:11], s37 offen sc1 lds
s_add_u32 m0, s39, 103424
s_add_u32 s37, s37, s38
buffer_load_dwordx4 v23, s[8:11], s37 offen sc1 lds
s_add_u32 m0, s39, 104448
s_add_u32 s37, s37, s38
buffer_load_dwordx4 v23, s[8:11], s37 offen sc1 lds
s_add_u32 m0, s39, 105472
s_add_u32 s37, s37, s38
buffer_load_dwordx4 v23, s[8:11], s37 offen sc1 lds
s_add_u32 m0, s39, 122880
s_add_u32 s37, s37, s40
buffer_load_dwordx4 v23, s[8:11], s37 offen sc1 lds
s_add_u32 m0, s39, 123904
s_add_u32 s37, s37, s38
buffer_load_dwordx4 v23, s[8:11], s37 offen sc1 lds
s_add_u32 m0, s39, 124928
s_add_u32 s37, s37, s38
buffer_load_dwordx4 v23, s[8:11], s37 offen sc1 lds
s_add_u32 m0, s39, 125952
s_add_u32 s37, s37, s38
buffer_load_dwordx4 v23, s[8:11], s37 offen sc1 lds
s_add_u32 m0, s39, 126976
s_add_u32 s37, s37, s55
buffer_load_dwordx4 v23, s[8:11], s37 offen sc1 lds
s_add_u32 m0, s39, 128000
s_add_u32 s37, s37, s38
buffer_load_dwordx4 v23, s[8:11], s37 offen sc1 lds
s_add_u32 m0, s39, 129024
s_add_u32 s37, s37, s38
buffer_load_dwordx4 v23, s[8:11], s37 offen sc1 lds
s_add_u32 m0, s39, 130048
s_add_u32 s37, s37, s38
buffer_load_dwordx4 v23, s[8:11], s37 offen sc1 lds
s_waitcnt vmcnt(34)
s_barrier
s_waitcnt vmcnt(32)
s_barrier
s_add_u32 m0, s39, 0
s_add_u32 s37, s37, s40
buffer_load_dwordx4 v23, s[8:11], s37 offen sc1 lds
s_add_u32 m0, s39, 1024
s_add_u32 s37, s37, s38
buffer_load_dwordx4 v23, s[8:11], s37 offen sc1 lds
s_add_u32 m0, s39, 2048
s_add_u32 s37, s37, s38
buffer_load_dwordx4 v23, s[8:11], s37 offen sc1 lds
s_add_u32 m0, s39, 3072
s_add_u32 s37, s37, s38
buffer_load_dwordx4 v23, s[8:11], s37 offen sc1 lds
s_add_u32 m0, s39, 4096
s_add_u32 s37, s37, s55
buffer_load_dwordx4 v23, s[8:11], s37 offen sc1 lds
s_add_u32 m0, s39, 5120
s_add_u32 s37, s37, s38
buffer_load_dwordx4 v23, s[8:11], s37 offen sc1 lds
s_add_u32 m0, s39, 6144
s_add_u32 s37, s37, s38
buffer_load_dwordx4 v23, s[8:11], s37 offen sc1 lds
s_add_u32 m0, s39, 7168
s_add_u32 s37, s37, s38
buffer_load_dwordx4 v23, s[8:11], s37 offen sc1 lds
s_waitcnt vmcnt(32)
s_barrier
s_add_u32 m0, s39, 24576
s_add_u32 s37, s37, s40
buffer_load_dwordx4 v23, s[8:11], s37 offen sc1 lds
s_add_u32 m0, s39, 25600
s_add_u32 s37, s37, s38
buffer_load_dwordx4 v23, s[8:11], s37 offen sc1 lds
s_add_u32 m0, s39, 26624
s_add_u32 s37, s37, s38
buffer_load_dwordx4 v23, s[8:11], s37 offen sc1 lds
s_add_u32 m0, s39, 27648
s_add_u32 s37, s37, s38
buffer_load_dwordx4 v23, s[8:11], s37 offen sc1 lds
s_add_u32 m0, s39, 28672
s_add_u32 s37, s37, s55
buffer_load_dwordx4 v23, s[8:11], s37 offen sc1 lds
s_add_u32 m0, s39, 29696
s_add_u32 s37, s37, s38
buffer_load_dwordx4 v23, s[8:11], s37 offen sc1 lds
s_add_u32 m0, s39, 30720
s_add_u32 s37, s37, s38
buffer_load_dwordx4 v23, s[8:11], s37 offen sc1 lds
s_add_u32 m0, s39, 31744
s_add_u32 s37, s37, s38
buffer_load_dwordx4 v23, s[8:11], s37 offen sc1 lds
s_waitcnt vmcnt(32)
s_barrier
s_add_u32 m0, s39, 49152
s_add_u32 s37, s37, s40
buffer_load_dwordx4 v23, s[8:11], s37 offen sc1 lds
s_add_u32 m0, s39, 50176
s_add_u32 s37, s37, s38
buffer_load_dwordx4 v23, s[8:11], s37 offen sc1 lds
s_add_u32 m0, s39, 51200
s_add_u32 s37, s37, s38
buffer_load_dwordx4 v23, s[8:11], s37 offen sc1 lds
s_add_u32 m0, s39, 52224
s_add_u32 s37, s37, s38
buffer_load_dwordx4 v23, s[8:11], s37 offen sc1 lds
s_add_u32 m0, s39, 53248
s_add_u32 s37, s37, s55
buffer_load_dwordx4 v23, s[8:11], s37 offen sc1 lds
s_add_u32 m0, s39, 54272
s_add_u32 s37, s37, s38
buffer_load_dwordx4 v23, s[8:11], s37 offen sc1 lds
s_add_u32 m0, s39, 55296
s_add_u32 s37, s37, s38
buffer_load_dwordx4 v23, s[8:11], s37 offen sc1 lds
s_add_u32 m0, s39, 56320
s_add_u32 s37, s37, s38
buffer_load_dwordx4 v23, s[8:11], s37 offen sc1 lds
s_waitcnt vmcnt(32)
s_barrier
s_add_u32 m0, s39, 73728
s_add_u32 s37, s37, s40
buffer_load_dwordx4 v23, s[8:11], s37 offen sc1 lds
s_add_u32 m0, s39, 74752
s_add_u32 s37, s37, s38
buffer_load_dwordx4 v23, s[8:11], s37 offen sc1 lds
s_add_u32 m0, s39, 75776
s_add_u32 s37, s37, s38
buffer_load_dwordx4 v23, s[8:11], s37 offen sc1 lds
s_add_u32 m0, s39, 76800
s_add_u32 s37, s37, s38
buffer_load_dwordx4 v23, s[8:11], s37 offen sc1 lds
s_add_u32 m0, s39, 77824
s_add_u32 s37, s37, s55
buffer_load_dwordx4 v23, s[8:11], s37 offen sc1 lds
s_add_u32 m0, s39, 78848
s_add_u32 s37, s37, s38
buffer_load_dwordx4 v23, s[8:11], s37 offen sc1 lds
s_add_u32 m0, s39, 79872
s_add_u32 s37, s37, s38
buffer_load_dwordx4 v23, s[8:11], s37 offen sc1 lds
s_add_u32 m0, s39, 80896
s_add_u32 s37, s37, s38
buffer_load_dwordx4 v23, s[8:11], s37 offen sc1 lds
s_waitcnt vmcnt(32)
s_barrier
s_add_u32 m0, s39, 98304
s_add_u32 s37, s37, s40
buffer_load_dwordx4 v23, s[8:11], s37 offen sc1 lds
s_add_u32 m0, s39, 99328
s_add_u32 s37, s37, s38
buffer_load_dwordx4 v23, s[8:11], s37 offen sc1 lds
s_add_u32 m0, s39, 100352
s_add_u32 s37, s37, s38
buffer_load_dwordx4 v23, s[8:11], s37 offen sc1 lds
s_add_u32 m0, s39, 101376
s_add_u32 s37, s37, s38
buffer_load_dwordx4 v23, s[8:11], s37 offen sc1 lds
s_add_u32 m0, s39, 102400
s_add_u32 s37, s37, s55
buffer_load_dwordx4 v23, s[8:11], s37 offen sc1 lds
s_add_u32 m0, s39, 103424
s_add_u32 s37, s37, s38
buffer_load_dwordx4 v23, s[8:11], s37 offen sc1 lds
s_add_u32 m0, s39, 104448
s_add_u32 s37, s37, s38
buffer_load_dwordx4 v23, s[8:11], s37 offen sc1 lds
s_add_u32 m0, s39, 105472
s_add_u32 s37, s37, s38
buffer_load_dwordx4 v23, s[8:11], s37 offen sc1 lds
s_waitcnt vmcnt(32)
s_barrier
s_add_u32 m0, s39, 122880
s_add_u32 s37, s37, s40
buffer_load_dwordx4 v23, s[8:11], s37 offen sc1 lds
s_add_u32 m0, s39, 123904
s_add_u32 s37, s37, s38
buffer_load_dwordx4 v23, s[8:11], s37 offen sc1 lds
s_add_u32 m0, s39, 124928
s_add_u32 s37, s37, s38
buffer_load_dwordx4 v23, s[8:11], s37 offen sc1 lds
s_add_u32 m0, s39, 125952
s_add_u32 s37, s37, s38
buffer_load_dwordx4 v23, s[8:11], s37 offen sc1 lds
s_add_u32 m0, s39, 126976
s_add_u32 s37, s37, s55
buffer_load_dwordx4 v23, s[8:11], s37 offen sc1 lds
s_add_u32 m0, s39, 128000
s_add_u32 s37, s37, s38
buffer_load_dwordx4 v23, s[8:11], s37 offen sc1 lds
s_add_u32 m0, s39, 129024
s_add_u32 s37, s37, s38
buffer_load_dwordx4 v23, s[8:11], s37 offen sc1 lds
s_add_u32 m0, s39, 130048
s_add_u32 s37, s37, s38
buffer_load_dwordx4 v23, s[8:11], s37 offen sc1 lds
s_waitcnt vmcnt(32)
s_barrier
s_add_u32 m0, s39, 0
s_add_u32 s37, s37, s40
buffer_load_dwordx4 v23, s[8:11], s37 offen sc1 lds
s_add_u32 m0, s39, 1024
s_add_u32 s37, s37, s38
buffer_load_dwordx4 v23, s[8:11], s37 offen sc1 lds
s_add_u32 m0, s39, 2048
s_add_u32 s37, s37, s38
buffer_load_dwordx4 v23, s[8:11], s37 offen sc1 lds
s_add_u32 m0, s39, 3072
s_add_u32 s37, s37, s38
buffer_load_dwordx4 v23, s[8:11], s37 offen sc1 lds
s_add_u32 m0, s39, 4096
s_add_u32 s37, s37, s55
buffer_load_dwordx4 v23, s[8:11], s37 offen sc1 lds
s_add_u32 m0, s39, 5120
s_add_u32 s37, s37, s38
buffer_load_dwordx4 v23, s[8:11], s37 offen sc1 lds
s_add_u32 m0, s39, 6144
s_add_u32 s37, s37, s38
buffer_load_dwordx4 v23, s[8:11], s37 offen sc1 lds
s_add_u32 m0, s39, 7168
s_add_u32 s37, s37, s38
buffer_load_dwordx4 v23, s[8:11], s37 offen sc1 lds
s_waitcnt vmcnt(32)
s_barrier
s_add_u32 m0, s39, 24576
s_add_u32 s37, s37, s40
buffer_load_dwordx4 v23, s[8:11], s37 offen sc1 lds
s_add_u32 m0, s39, 25600
s_add_u32 s37, s37, s38
buffer_load_dwordx4 v23, s[8:11], s37 offen sc1 lds
s_add_u32 m0, s39, 26624
s_add_u32 s37, s37, s38
buffer_load_dwordx4 v23, s[8:11], s37 offen sc1 lds
s_add_u32 m0, s39, 27648
s_add_u32 s37, s37, s38
buffer_load_dwordx4 v23, s[8:11], s37 offen sc1 lds
s_add_u32 m0, s39, 28672
s_add_u32 s37, s37, s55
buffer_load_dwordx4 v23, s[8:11], s37 offen sc1 lds
s_add_u32 m0, s39, 29696
s_add_u32 s37, s37, s38
buffer_load_dwordx4 v23, s[8:11], s37 offen sc1 lds
s_add_u32 m0, s39, 30720
s_add_u32 s37, s37, s38
buffer_load_dwordx4 v23, s[8:11], s37 offen sc1 lds
s_add_u32 m0, s39, 31744
s_add_u32 s37, s37, s38
buffer_load_dwordx4 v23, s[8:11], s37 offen sc1 lds
s_waitcnt vmcnt(32)
s_barrier
s_add_u32 m0, s39, 49152
s_add_u32 s37, s37, s40
buffer_load_dwordx4 v23, s[8:11], s37 offen sc1 lds
s_add_u32 m0, s39, 50176
s_add_u32 s37, s37, s38
buffer_load_dwordx4 v23, s[8:11], s37 offen sc1 lds
s_add_u32 m0, s39, 51200
s_add_u32 s37, s37, s38
buffer_load_dwordx4 v23, s[8:11], s37 offen sc1 lds
s_add_u32 m0, s39, 52224
s_add_u32 s37, s37, s38
buffer_load_dwordx4 v23, s[8:11], s37 offen sc1 lds
s_add_u32 m0, s39, 53248
s_add_u32 s37, s37, s55
buffer_load_dwordx4 v23, s[8:11], s37 offen sc1 lds
s_add_u32 m0, s39, 54272
s_add_u32 s37, s37, s38
buffer_load_dwordx4 v23, s[8:11], s37 offen sc1 lds
s_add_u32 m0, s39, 55296
s_add_u32 s37, s37, s38
buffer_load_dwordx4 v23, s[8:11], s37 offen sc1 lds
s_add_u32 m0, s39, 56320
s_add_u32 s37, s37, s38
buffer_load_dwordx4 v23, s[8:11], s37 offen sc1 lds
s_waitcnt vmcnt(32)
s_barrier
s_add_u32 m0, s39, 73728
s_add_u32 s37, s37, s40
buffer_load_dwordx4 v23, s[8:11], s37 offen sc1 lds
s_add_u32 m0, s39, 74752
s_add_u32 s37, s37, s38
buffer_load_dwordx4 v23, s[8:11], s37 offen sc1 lds
s_add_u32 m0, s39, 75776
s_add_u32 s37, s37, s38
buffer_load_dwordx4 v23, s[8:11], s37 offen sc1 lds
s_add_u32 m0, s39, 76800
s_add_u32 s37, s37, s38
buffer_load_dwordx4 v23, s[8:11], s37 offen sc1 lds
s_add_u32 m0, s39, 77824
s_add_u32 s37, s37, s55
buffer_load_dwordx4 v23, s[8:11], s37 offen sc1 lds
s_add_u32 m0, s39, 78848
s_add_u32 s37, s37, s38
buffer_load_dwordx4 v23, s[8:11], s37 offen sc1 lds
s_add_u32 m0, s39, 79872
s_add_u32 s37, s37, s38
buffer_load_dwordx4 v23, s[8:11], s37 offen sc1 lds
s_add_u32 m0, s39, 80896
s_add_u32 s37, s37, s38
buffer_load_dwordx4 v23, s[8:11], s37 offen sc1 lds
s_waitcnt vmcnt(32)
s_barrier
s_lshl_b32 s43, s35, 8
s_cmp_eq_u32 s51, 1
s_cselect_b32 s8, s4, s6
s_cselect_b32 s9, s5, s7
s_sub_u32 s10, 7340032, s43
s_lshl_b32 s44, s34, 18
s_add_u32 s44, s44, 4194304
s_movk_i32 s38, 28672
s_cmp_eq_u32 s51, 0
s_cselect_b32 s8, s32, s8
s_cselect_b32 s9, s33, s9
s_cselect_b32 s10, 262144, s10
s_cselect_b32 s43, s44, s43
s_cselect_b32 s38, 1024, s38
s_cselect_b32 s45, 0, -1
s_add_u32 s8, s8, s43
s_addc_u32 s9, s9, 0
s_mov_b32 s11, 0x20000
s_sub_u32 s37, 0, s38
s_lshl_b32 s39, s51, 14
v_lshrrev_b32 v19, 4, v1
v_lshlrev_b32 v20, 5, v19
v_mul_u32_u24 v19, 6912, v19
v_and_b32 v19, s45, v19
v_and_b32 v20, s45, v20
v_lshlrev_b32 v21, 4, v1
v_xor_b32 v21, v21, v20
v_add_u32 v22, v21, v19
s_and_b32 s45, s45, 128
v_xor_b32 v23, s45, v22
s_waitcnt vmcnt(24)
s_barrier
s_add_u32 m0, s39, 98304
s_add_u32 s37, s37, s38
buffer_load_dwordx4 v22, s[8:11], s37 offen sc1 lds
s_add_u32 m0, s39, 99328
s_add_u32 s37, s37, s38
buffer_load_dwordx4 v23, s[8:11], s37 offen sc1 lds
s_add_u32 m0, s39, 100352
s_add_u32 s37, s37, s38
buffer_load_dwordx4 v22, s[8:11], s37 offen sc1 lds
s_add_u32 m0, s39, 101376
s_add_u32 s37, s37, s38
buffer_load_dwordx4 v23, s[8:11], s37 offen sc1 lds
s_add_u32 m0, s39, 102400
s_add_u32 s37, s37, s38
buffer_load_dwordx4 v22, s[8:11], s37 offen sc1 lds
s_add_u32 m0, s39, 103424
s_add_u32 s37, s37, s38
buffer_load_dwordx4 v23, s[8:11], s37 offen sc1 lds
s_add_u32 m0, s39, 104448
s_add_u32 s37, s37, s38
buffer_load_dwordx4 v22, s[8:11], s37 offen sc1 lds
s_add_u32 m0, s39, 105472
s_add_u32 s37, s37, s38
buffer_load_dwordx4 v23, s[8:11], s37 offen sc1 lds
s_add_u32 m0, s39, 106496
s_add_u32 s37, s37, s38
buffer_load_dwordx4 v22, s[8:11], s37 offen sc1 lds
s_add_u32 m0, s39, 107520
s_add_u32 s37, s37, s38
buffer_load_dwordx4 v23, s[8:11], s37 offen sc1 lds
s_add_u32 m0, s39, 108544
s_add_u32 s37, s37, s38
buffer_load_dwordx4 v22, s[8:11], s37 offen sc1 lds
s_add_u32 m0, s39, 109568
s_add_u32 s37, s37, s38
buffer_load_dwordx4 v23, s[8:11], s37 offen sc1 lds
s_add_u32 m0, s39, 110592
s_add_u32 s37, s37, s38
buffer_load_dwordx4 v22, s[8:11], s37 offen sc1 lds
s_add_u32 m0, s39, 111616
s_add_u32 s37, s37, s38
buffer_load_dwordx4 v23, s[8:11], s37 offen sc1 lds
s_add_u32 m0, s39, 112640
s_add_u32 s37, s37, s38
buffer_load_dwordx4 v22, s[8:11], s37 offen sc1 lds
s_add_u32 m0, s39, 113664
s_add_u32 s37, s37, s38
buffer_load_dwordx4 v23, s[8:11], s37 offen sc1 lds
s_waitcnt vmcnt(32)
s_barrier
s_waitcnt vmcnt(24)
s_barrier
s_add_u32 m0, s39, 0
s_add_u32 s37, s37, s38
buffer_load_dwordx4 v22, s[8:11], s37 offen sc1 lds
s_add_u32 m0, s39, 1024
s_add_u32 s37, s37, s38
buffer_load_dwordx4 v23, s[8:11], s37 offen sc1 lds
s_add_u32 m0, s39, 2048
s_add_u32 s37, s37, s38
buffer_load_dwordx4 v22, s[8:11], s37 offen sc1 lds
s_add_u32 m0, s39, 3072
s_add_u32 s37, s37, s38
buffer_load_dwordx4 v23, s[8:11], s37 offen sc1 lds
s_add_u32 m0, s39, 4096
s_add_u32 s37, s37, s38
buffer_load_dwordx4 v22, s[8:11], s37 offen sc1 lds
s_add_u32 m0, s39, 5120
s_add_u32 s37, s37, s38
buffer_load_dwordx4 v23, s[8:11], s37 offen sc1 lds
s_add_u32 m0, s39, 6144
s_add_u32 s37, s37, s38
buffer_load_dwordx4 v22, s[8:11], s37 offen sc1 lds
s_add_u32 m0, s39, 7168
s_add_u32 s37, s37, s38
buffer_load_dwordx4 v23, s[8:11], s37 offen sc1 lds
s_add_u32 m0, s39, 8192
s_add_u32 s37, s37, s38
buffer_load_dwordx4 v22, s[8:11], s37 offen sc1 lds
s_add_u32 m0, s39, 9216
s_add_u32 s37, s37, s38
buffer_load_dwordx4 v23, s[8:11], s37 offen sc1 lds
s_add_u32 m0, s39, 10240
s_add_u32 s37, s37, s38
buffer_load_dwordx4 v22, s[8:11], s37 offen sc1 lds
s_add_u32 m0, s39, 11264
s_add_u32 s37, s37, s38
buffer_load_dwordx4 v23, s[8:11], s37 offen sc1 lds
s_add_u32 m0, s39, 12288
s_add_u32 s37, s37, s38
buffer_load_dwordx4 v22, s[8:11], s37 offen sc1 lds
s_add_u32 m0, s39, 13312
s_add_u32 s37, s37, s38
buffer_load_dwordx4 v23, s[8:11], s37 offen sc1 lds
s_add_u32 m0, s39, 14336
s_add_u32 s37, s37, s38
buffer_load_dwordx4 v22, s[8:11], s37 offen sc1 lds
s_add_u32 m0, s39, 15360
s_add_u32 s37, s37, s38
buffer_load_dwordx4 v23, s[8:11], s37 offen sc1 lds
s_waitcnt vmcnt(32)
s_barrier
s_barrier
s_barrier
s_add_u32 m0, s39, 49152
s_add_u32 s37, s37, s38
buffer_load_dwordx4 v22, s[8:11], s37 offen sc1 lds
s_add_u32 m0, s39, 50176
s_add_u32 s37, s37, s38
buffer_load_dwordx4 v23, s[8:11], s37 offen sc1 lds
s_add_u32 m0, s39, 51200
s_add_u32 s37, s37, s38
buffer_load_dwordx4 v22, s[8:11], s37 offen sc1 lds
s_add_u32 m0, s39, 52224
s_add_u32 s37, s37, s38
buffer_load_dwordx4 v23, s[8:11], s37 offen sc1 lds
s_add_u32 m0, s39, 53248
s_add_u32 s37, s37, s38
buffer_load_dwordx4 v22, s[8:11], s37 offen sc1 lds
s_add_u32 m0, s39, 54272
s_add_u32 s37, s37, s38
buffer_load_dwordx4 v23, s[8:11], s37 offen sc1 lds
s_add_u32 m0, s39, 55296
s_add_u32 s37, s37, s38
buffer_load_dwordx4 v22, s[8:11], s37 offen sc1 lds
s_add_u32 m0, s39, 56320
s_add_u32 s37, s37, s38
buffer_load_dwordx4 v23, s[8:11], s37 offen sc1 lds
s_add_u32 m0, s39, 57344
s_add_u32 s37, s37, s38
buffer_load_dwordx4 v22, s[8:11], s37 offen sc1 lds
s_add_u32 m0, s39, 58368
s_add_u32 s37, s37, s38
buffer_load_dwordx4 v23, s[8:11], s37 offen sc1 lds
s_add_u32 m0, s39, 59392
s_add_u32 s37, s37, s38
buffer_load_dwordx4 v22, s[8:11], s37 offen sc1 lds
s_add_u32 m0, s39, 60416
s_add_u32 s37, s37, s38
buffer_load_dwordx4 v23, s[8:11], s37 offen sc1 lds
s_add_u32 m0, s39, 61440
s_add_u32 s37, s37, s38
buffer_load_dwordx4 v22, s[8:11], s37 offen sc1 lds
s_add_u32 m0, s39, 62464
s_add_u32 s37, s37, s38
buffer_load_dwordx4 v23, s[8:11], s37 offen sc1 lds
s_add_u32 m0, s39, 63488
s_add_u32 s37, s37, s38
buffer_load_dwordx4 v22, s[8:11], s37 offen sc1 lds
s_add_u32 m0, s39, 64512
s_add_u32 s37, s37, s38
buffer_load_dwordx4 v23, s[8:11], s37 offen sc1 lds
s_branch LP3_27
Lp_30:
s_add_u32 m0, s39, 0
s_add_u32 s37, s37, s40
buffer_load_dwordx4 v23, s[8:11], s37 offen sc1 lds
s_add_u32 m0, s39, 1024
s_add_u32 s37, s37, s38
buffer_load_dwordx4 v23, s[8:11], s37 offen sc1 lds
s_add_u32 m0, s39, 2048
s_add_u32 s37, s37, s38
buffer_load_dwordx4 v23, s[8:11], s37 offen sc1 lds
s_add_u32 m0, s39, 3072
s_add_u32 s37, s37, s38
buffer_load_dwordx4 v23, s[8:11], s37 offen sc1 lds
s_add_u32 m0, s39, 4096
s_add_u32 s37, s37, s55
buffer_load_dwordx4 v23, s[8:11], s37 offen sc1 lds
s_add_u32 m0, s39, 5120
s_add_u32 s37, s37, s38
buffer_load_dwordx4 v23, s[8:11], s37 offen sc1 lds
s_add_u32 m0, s39, 6144
s_add_u32 s37, s37, s38
buffer_load_dwordx4 v23, s[8:11], s37 offen sc1 lds
s_add_u32 m0, s39, 7168
s_add_u32 s37, s37, s38
buffer_load_dwordx4 v23, s[8:11], s37 offen sc1 lds
s_add_u32 m0, s39, 24576
s_add_u32 s37, s37, s40
buffer_load_dwordx4 v23, s[8:11], s37 offen sc1 lds
s_add_u32 m0, s39, 25600
s_add_u32 s37, s37, s38
buffer_load_dwordx4 v23, s[8:11], s37 offen sc1 lds
s_add_u32 m0, s39, 26624
s_add_u32 s37, s37, s38
buffer_load_dwordx4 v23, s[8:11], s37 offen sc1 lds
s_add_u32 m0, s39, 27648
s_add_u32 s37, s37, s38
buffer_load_dwordx4 v23, s[8:11], s37 offen sc1 lds
s_add_u32 m0, s39, 28672
s_add_u32 s37, s37, s55
buffer_load_dwordx4 v23, s[8:11], s37 offen sc1 lds
s_add_u32 m0, s39, 29696
s_add_u32 s37, s37, s38
buffer_load_dwordx4 v23, s[8:11], s37 offen sc1 lds
s_add_u32 m0, s39, 30720
s_add_u32 s37, s37, s38
buffer_load_dwordx4 v23, s[8:11], s37 offen sc1 lds
s_add_u32 m0, s39, 31744
s_add_u32 s37, s37, s38
buffer_load_dwordx4 v23, s[8:11], s37 offen sc1 lds
s_add_u32 m0, s39, 49152
s_add_u32 s37, s37, s40
buffer_load_dwordx4 v23, s[8:11], s37 offen sc1 lds
s_add_u32 m0, s39, 50176
s_add_u32 s37, s37, s38
buffer_load_dwordx4 v23, s[8:11], s37 offen sc1 lds
s_add_u32 m0, s39, 51200
s_add_u32 s37, s37, s38
buffer_load_dwordx4 v23, s[8:11], s37 offen sc1 lds
s_add_u32 m0, s39, 52224
s_add_u32 s37, s37, s38
buffer_load_dwordx4 v23, s[8:11], s37 offen sc1 lds
s_add_u32 m0, s39, 53248
s_add_u32 s37, s37, s55
buffer_load_dwordx4 v23, s[8:11], s37 offen sc1 lds
s_add_u32 m0, s39, 54272
s_add_u32 s37, s37, s38
buffer_load_dwordx4 v23, s[8:11], s37 offen sc1 lds
s_add_u32 m0, s39, 55296
s_add_u32 s37, s37, s38
buffer_load_dwordx4 v23, s[8:11], s37 offen sc1 lds
s_add_u32 m0, s39, 56320
s_add_u32 s37, s37, s38
buffer_load_dwordx4 v23, s[8:11], s37 offen sc1 lds
s_add_u32 m0, s39, 73728
s_add_u32 s37, s37, s40
buffer_load_dwordx4 v23, s[8:11], s37 offen sc1 lds
s_add_u32 m0, s39, 74752
s_add_u32 s37, s37, s38
buffer_load_dwordx4 v23, s[8:11], s37 offen sc1 lds
s_add_u32 m0, s39, 75776
s_add_u32 s37, s37, s38
buffer_load_dwordx4 v23, s[8:11], s37 offen sc1 lds
s_add_u32 m0, s39, 76800
s_add_u32 s37, s37, s38
buffer_load_dwordx4 v23, s[8:11], s37 offen sc1 lds
s_add_u32 m0, s39, 77824
s_add_u32 s37, s37, s55
buffer_load_dwordx4 v23, s[8:11], s37 offen sc1 lds
s_add_u32 m0, s39, 78848
s_add_u32 s37, s37, s38
buffer_load_dwordx4 v23, s[8:11], s37 offen sc1 lds
s_add_u32 m0, s39, 79872
s_add_u32 s37, s37, s38
buffer_load_dwordx4 v23, s[8:11], s37 offen sc1 lds
s_add_u32 m0, s39, 80896
s_add_u32 s37, s37, s38
buffer_load_dwordx4 v23, s[8:11], s37 offen sc1 lds
s_add_u32 m0, s39, 98304
s_add_u32 s37, s37, s40
buffer_load_dwordx4 v23, s[8:11], s37 offen sc1 lds
s_add_u32 m0, s39, 99328
s_add_u32 s37, s37, s38
buffer_load_dwordx4 v23, s[8:11], s37 offen sc1 lds
s_add_u32 m0, s39, 100352
s_add_u32 s37, s37, s38
buffer_load_dwordx4 v23, s[8:11], s37 offen sc1 lds
s_add_u32 m0, s39, 101376
s_add_u32 s37, s37, s38
buffer_load_dwordx4 v23, s[8:11], s37 offen sc1 lds
s_add_u32 m0, s39, 102400
s_add_u32 s37, s37, s55
buffer_load_dwordx4 v23, s[8:11], s37 offen sc1 lds
s_add_u32 m0, s39, 103424
s_add_u32 s37, s37, s38
buffer_load_dwordx4 v23, s[8:11], s37 offen sc1 lds
s_add_u32 m0, s39, 104448
s_add_u32 s37, s37, s38
buffer_load_dwordx4 v23, s[8:11], s37 offen sc1 lds
s_add_u32 m0, s39, 105472
s_add_u32 s37, s37, s38
buffer_load_dwordx4 v23, s[8:11], s37 offen sc1 lds
s_add_u32 m0, s39, 122880
s_add_u32 s37, s37, s40
buffer_load_dwordx4 v23, s[8:11], s37 offen sc1 lds
s_add_u32 m0, s39, 123904
s_add_u32 s37, s37, s38
buffer_load_dwordx4 v23, s[8:11], s37 offen sc1 lds
s_add_u32 m0, s39, 124928
s_add_u32 s37, s37, s38
buffer_load_dwordx4 v23, s[8:11], s37 offen sc1 lds
s_add_u32 m0, s39, 125952
s_add_u32 s37, s37, s38
buffer_load_dwordx4 v23, s[8:11], s37 offen sc1 lds
s_add_u32 m0, s39, 126976
s_add_u32 s37, s37, s55
buffer_load_dwordx4 v23, s[8:11], s37 offen sc1 lds
s_add_u32 m0, s39, 128000
s_add_u32 s37, s37, s38
buffer_load_dwordx4 v23, s[8:11], s37 offen sc1 lds
s_add_u32 m0, s39, 129024
s_add_u32 s37, s37, s38
buffer_load_dwordx4 v23, s[8:11], s37 offen sc1 lds
s_add_u32 m0, s39, 130048
s_add_u32 s37, s37, s38
buffer_load_dwordx4 v23, s[8:11], s37 offen sc1 lds
s_barrier
s_add_u32 m0, s54, 0
s_add_u32 s43, s54, 0
buffer_load_dwordx4 v21, s[12:15], s43 offen sc1 lds
s_add_u32 m0, s54, 1024
s_add_u32 s43, s54, 1024
buffer_load_dwordx4 v21, s[12:15], s43 offen sc1 lds
s_add_u32 m0, s54, 24576
s_add_u32 s43, s54, 16384
buffer_load_dwordx4 v21, s[12:15], s43 offen sc1 lds
s_add_u32 m0, s54, 25600
s_add_u32 s43, s54, 17408
buffer_load_dwordx4 v21, s[12:15], s43 offen sc1 lds
s_waitcnt vmcnt(2)
s_barrier
s_waitcnt vmcnt(0)
s_barrier
s_add_u32 m0, s39, 0
s_add_u32 s37, s37, s40
buffer_load_dwordx4 v23, s[8:11], s37 offen sc1 lds
s_add_u32 m0, s39, 1024
s_add_u32 s37, s37, s38
buffer_load_dwordx4 v23, s[8:11], s37 offen sc1 lds
s_add_u32 m0, s39, 2048
s_add_u32 s37, s37, s38
buffer_load_dwordx4 v23, s[8:11], s37 offen sc1 lds
s_add_u32 m0, s39, 3072
s_add_u32 s37, s37, s38
buffer_load_dwordx4 v23, s[8:11], s37 offen sc1 lds
s_add_u32 m0, s39, 4096
s_add_u32 s37, s37, s55
buffer_load_dwordx4 v23, s[8:11], s37 offen sc1 lds
s_add_u32 m0, s39, 5120
s_add_u32 s37, s37, s38
buffer_load_dwordx4 v23, s[8:11], s37 offen sc1 lds
s_add_u32 m0, s39, 6144
s_add_u32 s37, s37, s38
buffer_load_dwordx4 v23, s[8:11], s37 offen sc1 lds
s_add_u32 m0, s39, 7168
s_add_u32 s37, s37, s38
buffer_load_dwordx4 v23, s[8:11], s37 offen sc1 lds
s_waitcnt vmcnt(36)
s_barrier
s_add_u32 m0, s39, 24576
s_add_u32 s37, s37, s40
buffer_load_dwordx4 v23, s[8:11], s37 offen sc1 lds
s_add_u32 m0, s39, 25600
s_add_u32 s37, s37, s38
buffer_load_dwordx4 v23, s[8:11], s37 offen sc1 lds
s_add_u32 m0, s39, 26624
s_add_u32 s37, s37, s38
buffer_load_dwordx4 v23, s[8:11], s37 offen sc1 lds
s_add_u32 m0, s39, 27648
s_add_u32 s37, s37, s38
buffer_load_dwordx4 v23, s[8:11], s37 offen sc1 lds
s_add_u32 m0, s39, 28672
s_add_u32 s37, s37, s55
buffer_load_dwordx4 v23, s[8:11], s37 offen sc1 lds
s_add_u32 m0, s39, 29696
s_add_u32 s37, s37, s38
buffer_load_dwordx4 v23, s[8:11], s37 offen sc1 lds
s_add_u32 m0, s39, 30720
s_add_u32 s37, s37, s38
buffer_load_dwordx4 v23, s[8:11], s37 offen sc1 lds
s_add_u32 m0, s39, 31744
s_add_u32 s37, s37, s38
buffer_load_dwordx4 v23, s[8:11], s37 offen sc1 lds
s_waitcnt vmcnt(36)
s_barrier
s_add_u32 m0, s39, 49152
s_add_u32 s37, s37, s40
buffer_load_dwordx4 v23, s[8:11], s37 offen sc1 lds
s_add_u32 m0, s39, 50176
s_add_u32 s37, s37, s38
buffer_load_dwordx4 v23, s[8:11], s37 offen sc1 lds
s_add_u32 m0, s39, 51200
s_add_u32 s37, s37, s38
buffer_load_dwordx4 v23, s[8:11], s37 offen sc1 lds
s_add_u32 m0, s39, 52224
s_add_u32 s37, s37, s38
buffer_load_dwordx4 v23, s[8:11], s37 offen sc1 lds
s_add_u32 m0, s39, 53248
s_add_u32 s37, s37, s55
buffer_load_dwordx4 v23, s[8:11], s37 offen sc1 lds
s_add_u32 m0, s39, 54272
s_add_u32 s37, s37, s38
buffer_load_dwordx4 v23, s[8:11], s37 offen sc1 lds
s_add_u32 m0, s39, 55296
s_add_u32 s37, s37, s38
buffer_load_dwordx4 v23, s[8:11], s37 offen sc1 lds
s_add_u32 m0, s39, 56320
s_add_u32 s37, s37, s38
buffer_load_dwordx4 v23, s[8:11], s37 offen sc1 lds
s_waitcnt vmcnt(36)
s_barrier
s_add_u32 m0, s39, 73728
s_add_u32 s37, s37, s40
buffer_load_dwordx4 v23, s[8:11], s37 offen sc1 lds
s_add_u32 m0, s39, 74752
s_add_u32 s37, s37, s38
buffer_load_dwordx4 v23, s[8:11], s37 offen sc1 lds
s_add_u32 m0, s39, 75776
s_add_u32 s37, s37, s38
buffer_load_dwordx4 v23, s[8:11], s37 offen sc1 lds
s_add_u32 m0, s39, 76800
s_add_u32 s37, s37, s38
buffer_load_dwordx4 v23, s[8:11], s37 offen sc1 lds
s_add_u32 m0, s39, 77824
s_add_u32 s37, s37, s55
buffer_load_dwordx4 v23, s[8:11], s37 offen sc1 lds
s_add_u32 m0, s39, 78848
s_add_u32 s37, s37, s38
buffer_load_dwordx4 v23, s[8:11], s37 offen sc1 lds
s_add_u32 m0, s39, 79872
s_add_u32 s37, s37, s38
buffer_load_dwordx4 v23, s[8:11], s37 offen sc1 lds
s_add_u32 m0, s39, 80896
s_add_u32 s37, s37, s38
buffer_load_dwordx4 v23, s[8:11], s37 offen sc1 lds
s_waitcnt vmcnt(36)
s_barrier
s_add_u32 m0, s39, 98304
s_add_u32 s37, s37, s40
buffer_load_dwordx4 v23, s[8:11], s37 offen sc1 lds
s_add_u32 m0, s39, 99328
s_add_u32 s37, s37, s38
buffer_load_dwordx4 v23, s[8:11], s37 offen sc1 lds
s_add_u32 m0, s39, 100352
s_add_u32 s37, s37, s38
buffer_load_dwordx4 v23, s[8:11], s37 offen sc1 lds
s_add_u32 m0, s39, 101376
s_add_u32 s37, s37, s38
buffer_load_dwordx4 v23, s[8:11], s37 offen sc1 lds
s_add_u32 m0, s39, 102400
s_add_u32 s37, s37, s55
buffer_load_dwordx4 v23, s[8:11], s37 offen sc1 lds
s_add_u32 m0, s39, 103424
s_add_u32 s37, s37, s38
buffer_load_dwordx4 v23, s[8:11], s37 offen sc1 lds
s_add_u32 m0, s39, 104448
s_add_u32 s37, s37, s38
buffer_load_dwordx4 v23, s[8:11], s37 offen sc1 lds
s_add_u32 m0, s39, 105472
s_add_u32 s37, s37, s38
buffer_load_dwordx4 v23, s[8:11], s37 offen sc1 lds
s_waitcnt vmcnt(32)
s_barrier
s_add_u32 m0, s39, 122880
s_add_u32 s37, s37, s40
buffer_load_dwordx4 v23, s[8:11], s37 offen sc1 lds
s_add_u32 m0, s39, 123904
s_add_u32 s37, s37, s38
buffer_load_dwordx4 v23, s[8:11], s37 offen sc1 lds
s_add_u32 m0, s39, 124928
s_add_u32 s37, s37, s38
buffer_load_dwordx4 v23, s[8:11], s37 offen sc1 lds
s_add_u32 m0, s39, 125952
s_add_u32 s37, s37, s38
buffer_load_dwordx4 v23, s[8:11], s37 offen sc1 lds
s_add_u32 m0, s39, 126976
s_add_u32 s37, s37, s55
buffer_load_dwordx4 v23, s[8:11], s37 offen sc1 lds
s_add_u32 m0, s39, 128000
s_add_u32 s37, s37, s38
buffer_load_dwordx4 v23, s[8:11], s37 offen sc1 lds
s_add_u32 m0, s39, 129024
s_add_u32 s37, s37, s38
buffer_load_dwordx4 v23, s[8:11], s37 offen sc1 lds
s_add_u32 m0, s39, 130048
s_add_u32 s37, s37, s38
buffer_load_dwordx4 v23, s[8:11], s37 offen sc1 lds
s_waitcnt vmcnt(32)
s_barrier
s_add_u32 m0, s39, 0
s_add_u32 s37, s37, s40
buffer_load_dwordx4 v23, s[8:11], s37 offen sc1 lds
s_add_u32 m0, s39, 1024
s_add_u32 s37, s37, s38
buffer_load_dwordx4 v23, s[8:11], s37 offen sc1 lds
s_add_u32 m0, s39, 2048
s_add_u32 s37, s37, s38
buffer_load_dwordx4 v23, s[8:11], s37 offen sc1 lds
s_add_u32 m0, s39, 3072
s_add_u32 s37, s37, s38
buffer_load_dwordx4 v23, s[8:11], s37 offen sc1 lds
s_add_u32 m0, s39, 4096
s_add_u32 s37, s37, s55
buffer_load_dwordx4 v23, s[8:11], s37 offen sc1 lds
s_add_u32 m0, s39, 5120
s_add_u32 s37, s37, s38
buffer_load_dwordx4 v23, s[8:11], s37 offen sc1 lds
s_add_u32 m0, s39, 6144
s_add_u32 s37, s37, s38
buffer_load_dwordx4 v23, s[8:11], s37 offen sc1 lds
s_add_u32 m0, s39, 7168
s_add_u32 s37, s37, s38
buffer_load_dwordx4 v23, s[8:11], s37 offen sc1 lds
s_waitcnt vmcnt(32)
s_barrier
s_add_u32 m0, s39, 24576
s_add_u32 s37, s37, s40
buffer_load_dwordx4 v23, s[8:11], s37 offen sc1 lds
s_add_u32 m0, s39, 25600
s_add_u32 s37, s37, s38
buffer_load_dwordx4 v23, s[8:11], s37 offen sc1 lds
s_add_u32 m0, s39, 26624
s_add_u32 s37, s37, s38
buffer_load_dwordx4 v23, s[8:11], s37 offen sc1 lds
s_add_u32 m0, s39, 27648
s_add_u32 s37, s37, s38
buffer_load_dwordx4 v23, s[8:11], s37 offen sc1 lds
s_add_u32 m0, s39, 28672
s_add_u32 s37, s37, s55
buffer_load_dwordx4 v23, s[8:11], s37 offen sc1 lds
s_add_u32 m0, s39, 29696
s_add_u32 s37, s37, s38
buffer_load_dwordx4 v23, s[8:11], s37 offen sc1 lds
s_add_u32 m0, s39, 30720
s_add_u32 s37, s37, s38
buffer_load_dwordx4 v23, s[8:11], s37 offen sc1 lds
s_add_u32 m0, s39, 31744
s_add_u32 s37, s37, s38
buffer_load_dwordx4 v23, s[8:11], s37 offen sc1 lds
s_waitcnt vmcnt(32)
s_barrier
s_add_u32 m0, s39, 49152
s_add_u32 s37, s37, s40
buffer_load_dwordx4 v23, s[8:11], s37 offen sc1 lds
s_add_u32 m0, s39, 50176
s_add_u32 s37, s37, s38
buffer_load_dwordx4 v23, s[8:11], s37 offen sc1 lds
s_add_u32 m0, s39, 51200
s_add_u32 s37, s37, s38
buffer_load_dwordx4 v23, s[8:11], s37 offen sc1 lds
s_add_u32 m0, s39, 52224
s_add_u32 s37, s37, s38
buffer_load_dwordx4 v23, s[8:11], s37 offen sc1 lds
s_add_u32 m0, s39, 53248
s_add_u32 s37, s37, s55
buffer_load_dwordx4 v23, s[8:11], s37 offen sc1 lds
s_add_u32 m0, s39, 54272
s_add_u32 s37, s37, s38
buffer_load_dwordx4 v23, s[8:11], s37 offen sc1 lds
s_add_u32 m0, s39, 55296
s_add_u32 s37, s37, s38
buffer_load_dwordx4 v23, s[8:11], s37 offen sc1 lds
s_add_u32 m0, s39, 56320
s_add_u32 s37, s37, s38
buffer_load_dwordx4 v23, s[8:11], s37 offen sc1 lds
s_waitcnt vmcnt(32)
s_barrier
s_add_u32 m0, s39, 73728
s_add_u32 s37, s37, s40
buffer_load_dwordx4 v23, s[8:11], s37 offen sc1 lds
s_add_u32 m0, s39, 74752
s_add_u32 s37, s37, s38
buffer_load_dwordx4 v23, s[8:11], s37 offen sc1 lds
s_add_u32 m0, s39, 75776
s_add_u32 s37, s37, s38
buffer_load_dwordx4 v23, s[8:11], s37 offen sc1 lds
s_add_u32 m0, s39, 76800
s_add_u32 s37, s37, s38
buffer_load_dwordx4 v23, s[8:11], s37 offen sc1 lds
s_add_u32 m0, s39, 77824
s_add_u32 s37, s37, s55
buffer_load_dwordx4 v23, s[8:11], s37 offen sc1 lds
s_add_u32 m0, s39, 78848
s_add_u32 s37, s37, s38
buffer_load_dwordx4 v23, s[8:11], s37 offen sc1 lds
s_add_u32 m0, s39, 79872
s_add_u32 s37, s37, s38
buffer_load_dwordx4 v23, s[8:11], s37 offen sc1 lds
s_add_u32 m0, s39, 80896
s_add_u32 s37, s37, s38
buffer_load_dwordx4 v23, s[8:11], s37 offen sc1 lds
s_waitcnt vmcnt(32)
s_barrier
s_lshl_b32 s43, s35, 8
s_cmp_eq_u32 s51, 1
s_cselect_b32 s8, s4, s6
s_cselect_b32 s9, s5, s7
s_sub_u32 s10, 7340032, s43
s_lshl_b32 s44, s34, 18
s_add_u32 s44, s44, 4194304
s_movk_i32 s38, 28672
s_cmp_eq_u32 s51, 0
s_cselect_b32 s8, s32, s8
s_cselect_b32 s9, s33, s9
s_cselect_b32 s10, 262144, s10
s_cselect_b32 s43, s44, s43
s_cselect_b32 s38, 1024, s38
s_cselect_b32 s45, 0, -1
s_add_u32 s8, s8, s43
s_addc_u32 s9, s9, 0
s_mov_b32 s11, 0x20000
s_sub_u32 s37, 0, s38
s_lshl_b32 s39, s51, 14
v_lshrrev_b32 v19, 4, v1
v_lshlrev_b32 v20, 5, v19
v_mul_u32_u24 v19, 6912, v19
v_and_b32 v19, s45, v19
v_and_b32 v20, s45, v20
v_lshlrev_b32 v21, 4, v1
v_xor_b32 v21, v21, v20
v_add_u32 v22, v21, v19
s_and_b32 s45, s45, 128
v_xor_b32 v23, s45, v22
s_waitcnt vmcnt(24)
s_barrier
s_add_u32 m0, s39, 98304
s_add_u32 s37, s37, s38
buffer_load_dwordx4 v22, s[8:11], s37 offen sc1 lds
s_add_u32 m0, s39, 99328
s_add_u32 s37, s37, s38
buffer_load_dwordx4 v23, s[8:11], s37 offen sc1 lds
s_add_u32 m0, s39, 100352
s_add_u32 s37, s37, s38
buffer_load_dwordx4 v22, s[8:11], s37 offen sc1 lds
s_add_u32 m0, s39, 101376
s_add_u32 s37, s37, s38
buffer_load_dwordx4 v23, s[8:11], s37 offen sc1 lds
s_add_u32 m0, s39, 102400
s_add_u32 s37, s37, s38
buffer_load_dwordx4 v22, s[8:11], s37 offen sc1 lds
s_add_u32 m0, s39, 103424
s_add_u32 s37, s37, s38
buffer_load_dwordx4 v23, s[8:11], s37 offen sc1 lds
s_add_u32 m0, s39, 104448
s_add_u32 s37, s37, s38
buffer_load_dwordx4 v22, s[8:11], s37 offen sc1 lds
s_add_u32 m0, s39, 105472
s_add_u32 s37, s37, s38
buffer_load_dwordx4 v23, s[8:11], s37 offen sc1 lds
s_add_u32 m0, s39, 106496
s_add_u32 s37, s37, s38
buffer_load_dwordx4 v22, s[8:11], s37 offen sc1 lds
s_add_u32 m0, s39, 107520
s_add_u32 s37, s37, s38
buffer_load_dwordx4 v23, s[8:11], s37 offen sc1 lds
s_add_u32 m0, s39, 108544
s_add_u32 s37, s37, s38
buffer_load_dwordx4 v22, s[8:11], s37 offen sc1 lds
s_add_u32 m0, s39, 109568
s_add_u32 s37, s37, s38
buffer_load_dwordx4 v23, s[8:11], s37 offen sc1 lds
s_add_u32 m0, s39, 110592
s_add_u32 s37, s37, s38
buffer_load_dwordx4 v22, s[8:11], s37 offen sc1 lds
s_add_u32 m0, s39, 111616
s_add_u32 s37, s37, s38
buffer_load_dwordx4 v23, s[8:11], s37 offen sc1 lds
s_add_u32 m0, s39, 112640
s_add_u32 s37, s37, s38
buffer_load_dwordx4 v22, s[8:11], s37 offen sc1 lds
s_add_u32 m0, s39, 113664
s_add_u32 s37, s37, s38
buffer_load_dwordx4 v23, s[8:11], s37 offen sc1 lds
s_waitcnt vmcnt(32)
s_barrier
s_waitcnt vmcnt(24)
s_barrier
s_add_u32 m0, s39, 0
s_add_u32 s37, s37, s38
buffer_load_dwordx4 v22, s[8:11], s37 offen sc1 lds
s_add_u32 m0, s39, 1024
s_add_u32 s37, s37, s38
buffer_load_dwordx4 v23, s[8:11], s37 offen sc1 lds
s_add_u32 m0, s39, 2048
s_add_u32 s37, s37, s38
buffer_load_dwordx4 v22, s[8:11], s37 offen sc1 lds
s_add_u32 m0, s39, 3072
s_add_u32 s37, s37, s38
buffer_load_dwordx4 v23, s[8:11], s37 offen sc1 lds
s_add_u32 m0, s39, 4096
s_add_u32 s37, s37, s38
buffer_load_dwordx4 v22, s[8:11], s37 offen sc1 lds
s_add_u32 m0, s39, 5120
s_add_u32 s37, s37, s38
buffer_load_dwordx4 v23, s[8:11], s37 offen sc1 lds
s_add_u32 m0, s39, 6144
s_add_u32 s37, s37, s38
buffer_load_dwordx4 v22, s[8:11], s37 offen sc1 lds
s_add_u32 m0, s39, 7168
s_add_u32 s37, s37, s38
buffer_load_dwordx4 v23, s[8:11], s37 offen sc1 lds
s_add_u32 m0, s39, 8192
s_add_u32 s37, s37, s38
buffer_load_dwordx4 v22, s[8:11], s37 offen sc1 lds
s_add_u32 m0, s39, 9216
s_add_u32 s37, s37, s38
buffer_load_dwordx4 v23, s[8:11], s37 offen sc1 lds
s_add_u32 m0, s39, 10240
s_add_u32 s37, s37, s38
buffer_load_dwordx4 v22, s[8:11], s37 offen sc1 lds
s_add_u32 m0, s39, 11264
s_add_u32 s37, s37, s38
buffer_load_dwordx4 v23, s[8:11], s37 offen sc1 lds
s_add_u32 m0, s39, 12288
s_add_u32 s37, s37, s38
buffer_load_dwordx4 v22, s[8:11], s37 offen sc1 lds
s_add_u32 m0, s39, 13312
s_add_u32 s37, s37, s38
buffer_load_dwordx4 v23, s[8:11], s37 offen sc1 lds
s_add_u32 m0, s39, 14336
s_add_u32 s37, s37, s38
buffer_load_dwordx4 v22, s[8:11], s37 offen sc1 lds
s_add_u32 m0, s39, 15360
s_add_u32 s37, s37, s38
buffer_load_dwordx4 v23, s[8:11], s37 offen sc1 lds
s_waitcnt vmcnt(32)
s_barrier
s_barrier
s_barrier
s_add_u32 m0, s39, 49152
s_add_u32 s37, s37, s38
buffer_load_dwordx4 v22, s[8:11], s37 offen sc1 lds
s_add_u32 m0, s39, 50176
s_add_u32 s37, s37, s38
buffer_load_dwordx4 v23, s[8:11], s37 offen sc1 lds
s_add_u32 m0, s39, 51200
s_add_u32 s37, s37, s38
buffer_load_dwordx4 v22, s[8:11], s37 offen sc1 lds
s_add_u32 m0, s39, 52224
s_add_u32 s37, s37, s38
buffer_load_dwordx4 v23, s[8:11], s37 offen sc1 lds
s_add_u32 m0, s39, 53248
s_add_u32 s37, s37, s38
buffer_load_dwordx4 v22, s[8:11], s37 offen sc1 lds
s_add_u32 m0, s39, 54272
s_add_u32 s37, s37, s38
buffer_load_dwordx4 v23, s[8:11], s37 offen sc1 lds
s_add_u32 m0, s39, 55296
s_add_u32 s37, s37, s38
buffer_load_dwordx4 v22, s[8:11], s37 offen sc1 lds
s_add_u32 m0, s39, 56320
s_add_u32 s37, s37, s38
buffer_load_dwordx4 v23, s[8:11], s37 offen sc1 lds
s_add_u32 m0, s39, 57344
s_add_u32 s37, s37, s38
buffer_load_dwordx4 v22, s[8:11], s37 offen sc1 lds
s_add_u32 m0, s39, 58368
s_add_u32 s37, s37, s38
buffer_load_dwordx4 v23, s[8:11], s37 offen sc1 lds
s_add_u32 m0, s39, 59392
s_add_u32 s37, s37, s38
buffer_load_dwordx4 v22, s[8:11], s37 offen sc1 lds
s_add_u32 m0, s39, 60416
s_add_u32 s37, s37, s38
buffer_load_dwordx4 v23, s[8:11], s37 offen sc1 lds
s_add_u32 m0, s39, 61440
s_add_u32 s37, s37, s38
buffer_load_dwordx4 v22, s[8:11], s37 offen sc1 lds
s_add_u32 m0, s39, 62464
s_add_u32 s37, s37, s38
buffer_load_dwordx4 v23, s[8:11], s37 offen sc1 lds
s_add_u32 m0, s39, 63488
s_add_u32 s37, s37, s38
buffer_load_dwordx4 v22, s[8:11], s37 offen sc1 lds
s_add_u32 m0, s39, 64512
s_add_u32 s37, s37, s38
buffer_load_dwordx4 v23, s[8:11], s37 offen sc1 lds
LP3_27:
s_lshl_b32 s43, s34, 18
s_add_u32 s12, s32, s43
s_addc_u32 s13, s33, 0
s_add_u32 s12, s12, 4194304
s_addc_u32 s13, s13, 0
s_mov_b32 s14, 262144
s_mov_b32 s15, 0x20000
v_lshlrev_b32 v21, 4, v1
s_lshl_b32 s54, s36, 11
s_barrier
s_add_u32 m0, s54, 98304
s_add_u32 s43, s54, 0
buffer_load_dwordx4 v21, s[12:15], s43 offen sc1 lds
s_add_u32 m0, s54, 99328
s_add_u32 s43, s54, 1024
buffer_load_dwordx4 v21, s[12:15], s43 offen sc1 lds
s_add_u32 m0, s54, 0
s_add_u32 s43, s54, 16384
buffer_load_dwordx4 v21, s[12:15], s43 offen sc1 lds
s_add_u32 m0, s54, 1024
s_add_u32 s43, s54, 17408
buffer_load_dwordx4 v21, s[12:15], s43 offen sc1 lds
s_add_u32 m0, s54, 49152
s_add_u32 s43, s54, 32768
buffer_load_dwordx4 v21, s[12:15], s43 offen sc1 lds
s_add_u32 m0, s54, 50176
s_add_u32 s43, s54, 33792
buffer_load_dwordx4 v21, s[12:15], s43 offen sc1 lds
s_waitcnt vmcnt(4)
s_barrier
s_waitcnt vmcnt(2)
s_barrier
s_mov_b32 s41, 3
Lp3_35:
s_add_u32 m0, s39, 98304
s_add_u32 s37, s37, s38
buffer_load_dwordx4 v22, s[8:11], s37 offen sc1 lds
s_add_u32 m0, s39, 99328
s_add_u32 s37, s37, s38
buffer_load_dwordx4 v23, s[8:11], s37 offen sc1 lds
s_add_u32 m0, s39, 100352
s_add_u32 s37, s37, s38
buffer_load_dwordx4 v22, s[8:11], s37 offen sc1 lds
s_add_u32 m0, s39, 101376
s_add_u32 s37, s37, s38
buffer_load_dwordx4 v23, s[8:11], s37 offen sc1 lds
s_add_u32 m0, s39, 102400
s_add_u32 s37, s37, s38
buffer_load_dwordx4 v22, s[8:11], s37 offen sc1 lds
s_add_u32 m0, s39, 103424
s_add_u32 s37, s37, s38
buffer_load_dwordx4 v23, s[8:11], s37 offen sc1 lds
s_add_u32 m0, s39, 104448
s_add_u32 s37, s37, s38
buffer_load_dwordx4 v22, s[8:11], s37 offen sc1 lds
s_add_u32 m0, s39, 105472
s_add_u32 s37, s37, s38
buffer_load_dwordx4 v23, s[8:11], s37 offen sc1 lds
s_add_u32 m0, s39, 106496
s_add_u32 s37, s37, s38
buffer_load_dwordx4 v22, s[8:11], s37 offen sc1 lds
s_add_u32 m0, s39, 107520
s_add_u32 s37, s37, s38
buffer_load_dwordx4 v23, s[8:11], s37 offen sc1 lds
s_add_u32 m0, s39, 108544
s_add_u32 s37, s37, s38
buffer_load_dwordx4 v22, s[8:11], s37 offen sc1 lds
s_add_u32 m0, s39, 109568
s_add_u32 s37, s37, s38
buffer_load_dwordx4 v23, s[8:11], s37 offen sc1 lds
s_add_u32 m0, s39, 110592
s_add_u32 s37, s37, s38
buffer_load_dwordx4 v22, s[8:11], s37 offen sc1 lds
s_add_u32 m0, s39, 111616
s_add_u32 s37, s37, s38
buffer_load_dwordx4 v23, s[8:11], s37 offen sc1 lds
s_add_u32 m0, s39, 112640
s_add_u32 s37, s37, s38
buffer_load_dwordx4 v22, s[8:11], s37 offen sc1 lds
s_add_u32 m0, s39, 113664
s_add_u32 s37, s37, s38
buffer_load_dwordx4 v23, s[8:11], s37 offen sc1 lds
s_waitcnt vmcnt(16)
s_barrier
s_add_u32 m0, s39, 0
s_add_u32 s37, s37, s38
buffer_load_dwordx4 v22, s[8:11], s37 offen sc1 lds
s_add_u32 m0, s39, 1024
s_add_u32 s37, s37, s38
buffer_load_dwordx4 v23, s[8:11], s37 offen sc1 lds
s_add_u32 m0, s39, 2048
s_add_u32 s37, s37, s38
buffer_load_dwordx4 v22, s[8:11], s37 offen sc1 lds
s_add_u32 m0, s39, 3072
s_add_u32 s37, s37, s38
buffer_load_dwordx4 v23, s[8:11], s37 offen sc1 lds
s_add_u32 m0, s39, 4096
s_add_u32 s37, s37, s38
buffer_load_dwordx4 v22, s[8:11], s37 offen sc1 lds
s_add_u32 m0, s39, 5120
s_add_u32 s37, s37, s38
buffer_load_dwordx4 v23, s[8:11], s37 offen sc1 lds
s_add_u32 m0, s39, 6144
s_add_u32 s37, s37, s38
buffer_load_dwordx4 v22, s[8:11], s37 offen sc1 lds
s_add_u32 m0, s39, 7168
s_add_u32 s37, s37, s38
buffer_load_dwordx4 v23, s[8:11], s37 offen sc1 lds
s_add_u32 m0, s39, 8192
s_add_u32 s37, s37, s38
buffer_load_dwordx4 v22, s[8:11], s37 offen sc1 lds
s_add_u32 m0, s39, 9216
s_add_u32 s37, s37, s38
buffer_load_dwordx4 v23, s[8:11], s37 offen sc1 lds
s_add_u32 m0, s39, 10240
s_add_u32 s37, s37, s38
buffer_load_dwordx4 v22, s[8:11], s37 offen sc1 lds
s_add_u32 m0, s39, 11264
s_add_u32 s37, s37, s38
buffer_load_dwordx4 v23, s[8:11], s37 offen sc1 lds
s_add_u32 m0, s39, 12288
s_add_u32 s37, s37, s38
buffer_load_dwordx4 v22, s[8:11], s37 offen sc1 lds
s_add_u32 m0, s39, 13312
s_add_u32 s37, s37, s38
buffer_load_dwordx4 v23, s[8:11], s37 offen sc1 lds
s_add_u32 m0, s39, 14336
s_add_u32 s37, s37, s38
buffer_load_dwordx4 v22, s[8:11], s37 offen sc1 lds
s_add_u32 m0, s39, 15360
s_add_u32 s37, s37, s38
buffer_load_dwordx4 v23, s[8:11], s37 offen sc1 lds
s_waitcnt vmcnt(16)
s_barrier
s_add_u32 m0, s39, 49152
s_add_u32 s37, s37, s38
buffer_load_dwordx4 v22, s[8:11], s37 offen sc1 lds
s_add_u32 m0, s39, 50176
s_add_u32 s37, s37, s38
buffer_load_dwordx4 v23, s[8:11], s37 offen sc1 lds
s_add_u32 m0, s39, 51200
s_add_u32 s37, s37, s38
buffer_load_dwordx4 v22, s[8:11], s37 offen sc1 lds
s_add_u32 m0, s39, 52224
s_add_u32 s37, s37, s38
buffer_load_dwordx4 v23, s[8:11], s37 offen sc1 lds
s_add_u32 m0, s39, 53248
s_add_u32 s37, s37, s38
buffer_load_dwordx4 v22, s[8:11], s37 offen sc1 lds
s_add_u32 m0, s39, 54272
s_add_u32 s37, s37, s38
buffer_load_dwordx4 v23, s[8:11], s37 offen sc1 lds
s_add_u32 m0, s39, 55296
s_add_u32 s37, s37, s38
buffer_load_dwordx4 v22, s[8:11], s37 offen sc1 lds
s_add_u32 m0, s39, 56320
s_add_u32 s37, s37, s38
buffer_load_dwordx4 v23, s[8:11], s37 offen sc1 lds
s_add_u32 m0, s39, 57344
s_add_u32 s37, s37, s38
buffer_load_dwordx4 v22, s[8:11], s37 offen sc1 lds
s_add_u32 m0, s39, 58368
s_add_u32 s37, s37, s38
buffer_load_dwordx4 v23, s[8:11], s37 offen sc1 lds
s_add_u32 m0, s39, 59392
s_add_u32 s37, s37, s38
buffer_load_dwordx4 v22, s[8:11], s37 offen sc1 lds
s_add_u32 m0, s39, 60416
s_add_u32 s37, s37, s38
buffer_load_dwordx4 v23, s[8:11], s37 offen sc1 lds
s_add_u32 m0, s39, 61440
s_add_u32 s37, s37, s38
buffer_load_dwordx4 v22, s[8:11], s37 offen sc1 lds
s_add_u32 m0, s39, 62464
s_add_u32 s37, s37, s38
buffer_load_dwordx4 v23, s[8:11], s37 offen sc1 lds
s_add_u32 m0, s39, 63488
s_add_u32 s37, s37, s38
buffer_load_dwordx4 v22, s[8:11], s37 offen sc1 lds
s_add_u32 m0, s39, 64512
s_add_u32 s37, s37, s38
buffer_load_dwordx4 v23, s[8:11], s37 offen sc1 lds
s_waitcnt vmcnt(16)
s_barrier
s_sub_u32 s41, s41, 1
s_cmp_lg_u32 s41, 0
s_cbranch_scc1 Lp3_35
s_add_u32 m0, s39, 98304
s_add_u32 s37, s37, s38
buffer_load_dwordx4 v22, s[8:11], s37 offen sc1 lds
s_and_b32 s53, s35, 1
s_lshl_b32 s53, s53, 1
s_mul_i32 s43, s47, 3
s_add_u32 m0, s39, 99328
s_add_u32 s37, s37, s38
buffer_load_dwordx4 v23, s[8:11], s37 offen sc1 lds
s_add_u32 s53, s53, s43
v_lshlrev_b32 v19, 11, v18
v_lshl_add_u32 v19, v17, 4, v19
s_add_u32 m0, s39, 100352
s_add_u32 s37, s37, s38
buffer_load_dwordx4 v22, s[8:11], s37 offen sc1 lds
s_lshl_b32 s43, s46, 10
v_add_u32 v2, s43, v19
v_add_u32 v3, 49152, v2
s_add_u32 m0, s39, 101376
s_add_u32 s37, s37, s38
buffer_load_dwordx4 v23, s[8:11], s37 offen sc1 lds
v_add_u32 v4, 98304, v2
v_lshrrev_b32 v19, 2, v17
v_lshl_add_u32 v20, v18, 2, v19
s_add_u32 m0, s39, 102400
s_add_u32 s37, s37, s38
buffer_load_dwordx4 v22, s[8:11], s37 offen sc1 lds
v_and_b32 v21, 7, v20
v_lshlrev_b32 v20, 8, v20
v_and_b32 v19, 3, v1
s_add_u32 m0, s39, 103424
s_add_u32 s37, s37, s38
buffer_load_dwordx4 v23, s[8:11], s37 offen sc1 lds
v_lshl_add_u32 v20, v19, 3, v20
s_add_u32 s43, s53, 0
v_xor_b32 v19, s43, v21
s_add_u32 m0, s39, 104448
s_add_u32 s37, s37, s38
buffer_load_dwordx4 v22, s[8:11], s37 offen sc1 lds
v_lshl_add_u32 v5, v19, 5, v20
s_add_u32 s43, s53, 1
v_xor_b32 v19, s43, v21
s_add_u32 m0, s39, 105472
s_add_u32 s37, s37, s38
buffer_load_dwordx4 v23, s[8:11], s37 offen sc1 lds
v_lshl_add_u32 v6, v19, 5, v20
s_add_u32 s43, s53, 2
v_xor_b32 v19, s43, v21
s_add_u32 m0, s39, 106496
s_add_u32 s37, s37, s38
buffer_load_dwordx4 v22, s[8:11], s37 offen sc1 lds
v_lshl_add_u32 v7, v19, 5, v20
v_add_u32 v9, 49152, v5
v_add_u32 v10, 49152, v6
s_add_u32 m0, s39, 107520
s_add_u32 s37, s37, s38
buffer_load_dwordx4 v23, s[8:11], s37 offen sc1 lds
v_add_u32 v11, 49152, v7
v_add_u32 v13, 98304, v5
v_add_u32 v14, 98304, v6
s_add_u32 m0, s39, 108544
s_add_u32 s37, s37, s38
buffer_load_dwordx4 v22, s[8:11], s37 offen sc1 lds
v_add_u32 v15, 98304, v7
s_lshl_b32 s43, s46, 9
s_add_u32 s43, s43, 147456
s_add_u32 m0, s39, 109568
s_add_u32 s37, s37, s38
buffer_load_dwordx4 v23, s[8:11], s37 offen sc1 lds
v_lshl_add_u32 v19, v17, 3, s43
ds_read_b64 v[80:81], v19 offset:0
ds_read_b64 v[82:83], v19 offset:128
s_add_u32 m0, s39, 110592
s_add_u32 s37, s37, s38
buffer_load_dwordx4 v22, s[8:11], s37 offen sc1 lds
ds_read_b64 v[84:85], v19 offset:256
ds_read_b64 v[86:87], v19 offset:384
s_mul_i32 s43, s47, 192
s_add_u32 m0, s39, 111616
s_add_u32 s37, s37, s38
buffer_load_dwordx4 v23, s[8:11], s37 offen sc1 lds
s_add_u32 s43, s43, 148992
v_lshl_add_u32 v19, v18, 4, s43
ds_read_b128 v[48:51], v19 offset:0
s_add_u32 m0, s39, 112640
s_add_u32 s37, s37, s38
buffer_load_dwordx4 v22, s[8:11], s37 offen sc1 lds
ds_read_b128 v[52:55], v19 offset:64
ds_read_b128 v[56:59], v19 offset:128
ds_read_b128 v[60:63], v19 offset:896
s_add_u32 m0, s39, 113664
s_add_u32 s37, s37, s38
buffer_load_dwordx4 v23, s[8:11], s37 offen sc1 lds
ds_read_b128 v[64:67], v19 offset:960
ds_read_b128 v[68:71], v19 offset:1024
s_waitcnt vmcnt(16)
s_barrier
s_add_u32 m0, s39, 0
s_add_u32 s37, s37, s38
buffer_load_dwordx4 v22, s[8:11], s37 offen sc1 lds
s_waitcnt lgkmcnt(0)
v_mul_f32 v88, v81, v81
s_add_u32 m0, s39, 1024
s_add_u32 s37, s37, s38
buffer_load_dwordx4 v23, s[8:11], s37 offen sc1 lds
v_mul_f32 v228, 0xc0135761, v81
s_add_u32 m0, s39, 2048
s_add_u32 s37, s37, s38
buffer_load_dwordx4 v22, s[8:11], s37 offen sc1 lds
v_mul_f32 v89, 0xbdd2d3e8, v81
s_add_u32 m0, s39, 3072
s_add_u32 s37, s37, s38
buffer_load_dwordx4 v23, s[8:11], s37 offen sc1 lds
v_rcp_f32 v236, v88
v_mul_f32 v232, v89, v88
s_add_u32 m0, s39, 4096
s_add_u32 s37, s37, s38
buffer_load_dwordx4 v22, s[8:11], s37 offen sc1 lds
v_mul_f32 v88, v83, v83
s_add_u32 m0, s39, 5120
s_add_u32 s37, s37, s38
buffer_load_dwordx4 v23, s[8:11], s37 offen sc1 lds
v_mul_f32 v229, 0xc0135761, v83
s_add_u32 m0, s39, 6144
s_add_u32 s37, s37, s38
buffer_load_dwordx4 v22, s[8:11], s37 offen sc1 lds
v_mul_f32 v89, 0xbdd2d3e8, v83
v_rcp_f32 v237, v88
s_add_u32 m0, s39, 7168
s_add_u32 s37, s37, s38
buffer_load_dwordx4 v23, s[8:11], s37 offen sc1 lds
v_mul_f32 v233, v89, v88
s_add_u32 m0, s39, 8192
s_add_u32 s37, s37, s38
buffer_load_dwordx4 v22, s[8:11], s37 offen sc1 lds
v_mul_f32 v88, v85, v85
s_add_u32 m0, s39, 9216
s_add_u32 s37, s37, s38
buffer_load_dwordx4 v23, s[8:11], s37 offen sc1 lds
v_mul_f32 v230, 0xc0135761, v85
v_mul_f32 v89, 0xbdd2d3e8, v85
s_add_u32 m0, s39, 10240
s_add_u32 s37, s37, s38
buffer_load_dwordx4 v22, s[8:11], s37 offen sc1 lds
v_rcp_f32 v238, v88
s_add_u32 m0, s39, 11264
s_add_u32 s37, s37, s38
buffer_load_dwordx4 v23, s[8:11], s37 offen sc1 lds
v_mul_f32 v234, v89, v88
s_add_u32 m0, s39, 12288
s_add_u32 s37, s37, s38
buffer_load_dwordx4 v22, s[8:11], s37 offen sc1 lds
v_mul_f32 v88, v87, v87
v_mul_f32 v231, 0xc0135761, v87
s_add_u32 m0, s39, 13312
s_add_u32 s37, s37, s38
buffer_load_dwordx4 v23, s[8:11], s37 offen sc1 lds
v_mul_f32 v89, 0xbdd2d3e8, v87
s_add_u32 m0, s39, 14336
s_add_u32 s37, s37, s38
buffer_load_dwordx4 v22, s[8:11], s37 offen sc1 lds
v_rcp_f32 v239, v88
s_add_u32 m0, s39, 15360
s_add_u32 s37, s37, s38
buffer_load_dwordx4 v23, s[8:11], s37 offen sc1 lds
v_mul_f32 v235, v89, v88
s_mul_i32 s43, s34, 917504
s_mul_i32 s44, s35, 24576
s_add_u32 s43, s43, s44
s_add_u32 s43, s43, 8912896
s_add_u32 s24, s32, s43
s_addc_u32 s25, s33, 0
s_mov_b32 s26, 24576
s_mov_b32 s27, 0x20000
s_mov_b32 s53, 262144
s_lshl_b32 s43, s47, 13
s_lshl_b32 s44, s46, 10
s_add_u32 s43, s43, s44
v_lshlrev_b32 v19, 11, v18
v_lshl_add_u32 v19, v17, 4, v19
v_add_u32 v27, s43, v19
s_lshl_b32 s43, s47, 12
s_add_u32 s43, s43, s44
s_add_u32 s43, s43, 16384
v_and_b32 v19, 1, v18
v_lshlrev_b32 v19, 11, v19
v_lshrrev_b32 v20, 1, v18
v_lshl_add_u32 v19, v20, 8, v19
v_lshl_add_u32 v19, v17, 4, v19
v_add_u32 v28, s43, v19
s_waitcnt vmcnt(16)
s_barrier
s_add_u32 m0, s39, 49152
s_add_u32 s37, s37, s38
buffer_load_dwordx4 v22, s[8:11], s37 offen sc1 lds
v_mul_f32 v128, -v80, v48
v_mul_f32 v129, -v80, v49
s_add_u32 m0, s39, 50176
s_add_u32 s37, s37, s38
buffer_load_dwordx4 v23, s[8:11], s37 offen sc1 lds
v_mul_f32 v130, -v80, v50
v_mul_f32 v131, -v80, v51
s_add_u32 m0, s39, 51200
s_add_u32 s37, s37, s38
buffer_load_dwordx4 v22, s[8:11], s37 offen sc1 lds
v_mul_f32 v132, -v82, v48
v_mul_f32 v133, -v82, v49
s_add_u32 m0, s39, 52224
s_add_u32 s37, s37, s38
buffer_load_dwordx4 v23, s[8:11], s37 offen sc1 lds
v_mul_f32 v134, -v82, v50
v_mul_f32 v135, -v82, v51
s_add_u32 m0, s39, 53248
s_add_u32 s37, s37, s38
buffer_load_dwordx4 v22, s[8:11], s37 offen sc1 lds
v_mul_f32 v136, -v84, v48
v_mul_f32 v137, -v84, v49
s_add_u32 m0, s39, 54272
s_add_u32 s37, s37, s38
buffer_load_dwordx4 v23, s[8:11], s37 offen sc1 lds
v_mul_f32 v138, -v84, v50
v_mul_f32 v139, -v84, v51
s_add_u32 m0, s39, 55296
s_add_u32 s37, s37, s38
buffer_load_dwordx4 v22, s[8:11], s37 offen sc1 lds
v_mul_f32 v140, -v86, v48
v_mul_f32 v141, -v86, v49
s_add_u32 m0, s39, 56320
s_add_u32 s37, s37, s38
buffer_load_dwordx4 v23, s[8:11], s37 offen sc1 lds
v_mul_f32 v142, -v86, v50
v_mul_f32 v143, -v86, v51
s_add_u32 m0, s39, 57344
s_add_u32 s37, s37, s38
buffer_load_dwordx4 v22, s[8:11], s37 offen sc1 lds
v_mul_f32 v144, -v80, v52
v_mul_f32 v145, -v80, v53
s_add_u32 m0, s39, 58368
s_add_u32 s37, s37, s38
buffer_load_dwordx4 v23, s[8:11], s37 offen sc1 lds
v_mul_f32 v146, -v80, v54
v_mul_f32 v147, -v80, v55
s_add_u32 m0, s39, 59392
s_add_u32 s37, s37, s38
buffer_load_dwordx4 v22, s[8:11], s37 offen sc1 lds
v_mul_f32 v148, -v82, v52
v_mul_f32 v149, -v82, v53
s_add_u32 m0, s39, 60416
s_add_u32 s37, s37, s38
buffer_load_dwordx4 v23, s[8:11], s37 offen sc1 lds
v_mul_f32 v150, -v82, v54
v_mul_f32 v151, -v82, v55
s_add_u32 m0, s39, 61440
s_add_u32 s37, s37, s38
buffer_load_dwordx4 v22, s[8:11], s37 offen sc1 lds
v_mul_f32 v152, -v84, v52
v_mul_f32 v153, -v84, v53
s_add_u32 m0, s39, 62464
s_add_u32 s37, s37, s38
buffer_load_dwordx4 v23, s[8:11], s37 offen sc1 lds
v_mul_f32 v154, -v84, v54
v_mul_f32 v155, -v84, v55
s_add_u32 m0, s39, 63488
s_add_u32 s37, s37, s38
buffer_load_dwordx4 v22, s[8:11], s37 offen sc1 lds
v_mul_f32 v156, -v86, v52
v_mul_f32 v157, -v86, v53
s_add_u32 m0, s39, 64512
s_add_u32 s37, s37, s38
buffer_load_dwordx4 v23, s[8:11], s37 offen sc1 lds
v_mul_f32 v158, -v86, v54
v_mul_f32 v159, -v86, v55
s_waitcnt vmcnt(16)
s_barrier
s_add_u32 m0, s39, 98304
s_add_u32 s37, s37, s38
buffer_load_dwordx4 v22, s[8:11], s37 offen sc1 lds
v_mul_f32 v160, -v80, v56
v_mul_f32 v161, -v80, v57
s_add_u32 m0, s39, 99328
s_add_u32 s37, s37, s38
buffer_load_dwordx4 v23, s[8:11], s37 offen sc1 lds
v_mul_f32 v162, -v80, v58
v_mul_f32 v163, -v80, v59
s_add_u32 m0, s39, 100352
s_add_u32 s37, s37, s38
buffer_load_dwordx4 v22, s[8:11], s37 offen sc1 lds
v_mul_f32 v164, -v82, v56
v_mul_f32 v165, -v82, v57
s_add_u32 m0, s39, 101376
s_add_u32 s37, s37, s38
buffer_load_dwordx4 v23, s[8:11], s37 offen sc1 lds
v_mul_f32 v166, -v82, v58
v_mul_f32 v167, -v82, v59
s_add_u32 m0, s39, 102400
s_add_u32 s37, s37, s38
buffer_load_dwordx4 v22, s[8:11], s37 offen sc1 lds
v_mul_f32 v168, -v84, v56
v_mul_f32 v169, -v84, v57
s_add_u32 m0, s39, 103424
s_add_u32 s37, s37, s38
buffer_load_dwordx4 v23, s[8:11], s37 offen sc1 lds
v_mul_f32 v170, -v84, v58
v_mul_f32 v171, -v84, v59
s_add_u32 m0, s39, 104448
s_add_u32 s37, s37, s38
buffer_load_dwordx4 v22, s[8:11], s37 offen sc1 lds
v_mul_f32 v172, -v86, v56
v_mul_f32 v173, -v86, v57
s_add_u32 m0, s39, 105472
s_add_u32 s37, s37, s38
buffer_load_dwordx4 v23, s[8:11], s37 offen sc1 lds
v_mul_f32 v174, -v86, v58
v_mul_f32 v175, -v86, v59
s_add_u32 m0, s39, 106496
s_add_u32 s37, s37, s38
buffer_load_dwordx4 v22, s[8:11], s37 offen sc1 lds
v_mul_f32 v176, -v80, v60
v_mul_f32 v177, -v80, v61
s_add_u32 m0, s39, 107520
s_add_u32 s37, s37, s38
buffer_load_dwordx4 v23, s[8:11], s37 offen sc1 lds
v_mul_f32 v178, -v80, v62
v_mul_f32 v179, -v80, v63
s_add_u32 m0, s39, 108544
s_add_u32 s37, s37, s38
buffer_load_dwordx4 v22, s[8:11], s37 offen sc1 lds
v_mul_f32 v180, -v82, v60
v_mul_f32 v181, -v82, v61
s_add_u32 m0, s39, 109568
s_add_u32 s37, s37, s38
buffer_load_dwordx4 v23, s[8:11], s37 offen sc1 lds
v_mul_f32 v182, -v82, v62
v_mul_f32 v183, -v82, v63
s_add_u32 m0, s39, 110592
s_add_u32 s37, s37, s38
buffer_load_dwordx4 v22, s[8:11], s37 offen sc1 lds
v_mul_f32 v184, -v84, v60
v_mul_f32 v185, -v84, v61
s_add_u32 m0, s39, 111616
s_add_u32 s37, s37, s38
buffer_load_dwordx4 v23, s[8:11], s37 offen sc1 lds
v_mul_f32 v186, -v84, v62
v_mul_f32 v187, -v84, v63
s_add_u32 m0, s39, 112640
s_add_u32 s37, s37, s38
buffer_load_dwordx4 v22, s[8:11], s37 offen sc1 lds
v_mul_f32 v188, -v86, v60
v_mul_f32 v189, -v86, v61
s_add_u32 m0, s39, 113664
s_add_u32 s37, s37, s38
buffer_load_dwordx4 v23, s[8:11], s37 offen sc1 lds
v_mul_f32 v190, -v86, v62
v_mul_f32 v191, -v86, v63
s_waitcnt vmcnt(16)
s_barrier
s_mul_i32 s43, s35, 192
s_and_b32 s43, s43, 0xffffff80
s_add_u32 s43, s43, 4096
s_cmp_eq_u32 s51, 1
s_cselect_b32 s8, s4, s6
s_cselect_b32 s9, s5, s7
s_sub_u32 s10, 7340032, s43
s_lshl_b32 s44, s34, 18
s_add_u32 s44, s44, 4194304
s_movk_i32 s38, 28672
s_cmp_eq_u32 s51, 0
s_cselect_b32 s8, s32, s8
s_cselect_b32 s9, s33, s9
s_cselect_b32 s10, 262144, s10
s_cselect_b32 s43, s44, s43
s_cselect_b32 s38, 1024, s38
s_cselect_b32 s45, 0, -1
s_add_u32 s8, s8, s43
s_addc_u32 s9, s9, 0
s_mov_b32 s11, 0x20000
s_sub_u32 s37, 0, s38
s_lshl_b32 s39, s51, 14
v_lshrrev_b32 v19, 4, v1
v_lshlrev_b32 v20, 5, v19
v_mul_u32_u24 v19, 6912, v19
v_and_b32 v19, s45, v19
v_and_b32 v20, s45, v20
v_lshlrev_b32 v21, 4, v1
v_xor_b32 v21, v21, v20
v_add_u32 v22, v21, v19
s_and_b32 s45, s45, 128
v_xor_b32 v23, s45, v22
s_add_u32 m0, s39, 0
s_add_u32 s37, s37, s38
buffer_load_dwordx4 v22, s[8:11], s37 offen sc1 lds
v_mul_f32 v192, -v80, v64
v_mul_f32 v193, -v80, v65
s_add_u32 m0, s39, 1024
s_add_u32 s37, s37, s38
buffer_load_dwordx4 v23, s[8:11], s37 offen sc1 lds
v_mul_f32 v194, -v80, v66
v_mul_f32 v195, -v80, v67
s_add_u32 m0, s39, 2048
s_add_u32 s37, s37, s38
buffer_load_dwordx4 v22, s[8:11], s37 offen sc1 lds
v_mul_f32 v196, -v82, v64
v_mul_f32 v197, -v82, v65
s_add_u32 m0, s39, 3072
s_add_u32 s37, s37, s38
buffer_load_dwordx4 v23, s[8:11], s37 offen sc1 lds
v_mul_f32 v198, -v82, v66
v_mul_f32 v199, -v82, v67
s_add_u32 m0, s39, 4096
s_add_u32 s37, s37, s38
buffer_load_dwordx4 v22, s[8:11], s37 offen sc1 lds
v_mul_f32 v200, -v84, v64
v_mul_f32 v201, -v84, v65
s_add_u32 m0, s39, 5120
s_add_u32 s37, s37, s38
buffer_load_dwordx4 v23, s[8:11], s37 offen sc1 lds
v_mul_f32 v202, -v84, v66
v_mul_f32 v203, -v84, v67
s_add_u32 m0, s39, 6144
s_add_u32 s37, s37, s38
buffer_load_dwordx4 v22, s[8:11], s37 offen sc1 lds
v_mul_f32 v204, -v86, v64
v_mul_f32 v205, -v86, v65
s_add_u32 m0, s39, 7168
s_add_u32 s37, s37, s38
buffer_load_dwordx4 v23, s[8:11], s37 offen sc1 lds
v_mul_f32 v206, -v86, v66
v_mul_f32 v207, -v86, v67
s_add_u32 m0, s39, 8192
s_add_u32 s37, s37, s38
buffer_load_dwordx4 v22, s[8:11], s37 offen sc1 lds
v_mul_f32 v208, -v80, v68
v_mul_f32 v209, -v80, v69
s_add_u32 m0, s39, 9216
s_add_u32 s37, s37, s38
buffer_load_dwordx4 v23, s[8:11], s37 offen sc1 lds
v_mul_f32 v210, -v80, v70
v_mul_f32 v211, -v80, v71
s_add_u32 m0, s39, 10240
s_add_u32 s37, s37, s38
buffer_load_dwordx4 v22, s[8:11], s37 offen sc1 lds
v_mul_f32 v212, -v82, v68
v_mul_f32 v213, -v82, v69
s_add_u32 m0, s39, 11264
s_add_u32 s37, s37, s38
buffer_load_dwordx4 v23, s[8:11], s37 offen sc1 lds
v_mul_f32 v214, -v82, v70
v_mul_f32 v215, -v82, v71
s_add_u32 m0, s39, 12288
s_add_u32 s37, s37, s38
buffer_load_dwordx4 v22, s[8:11], s37 offen sc1 lds
v_mul_f32 v216, -v84, v68
v_mul_f32 v217, -v84, v69
s_add_u32 m0, s39, 13312
s_add_u32 s37, s37, s38
buffer_load_dwordx4 v23, s[8:11], s37 offen sc1 lds
v_mul_f32 v218, -v84, v70
v_mul_f32 v219, -v84, v71
s_add_u32 m0, s39, 14336
s_add_u32 s37, s37, s38
buffer_load_dwordx4 v22, s[8:11], s37 offen sc1 lds
v_mul_f32 v220, -v86, v68
v_mul_f32 v221, -v86, v69
s_add_u32 m0, s39, 15360
s_add_u32 s37, s37, s38
buffer_load_dwordx4 v23, s[8:11], s37 offen sc1 lds
v_mul_f32 v222, -v86, v70
v_mul_f32 v223, -v86, v71
s_waitcnt vmcnt(16)
s_barrier
s_add_u32 m0, s39, 49152
s_add_u32 s37, s37, s38
buffer_load_dwordx4 v22, s[8:11], s37 offen sc1 lds
s_add_u32 m0, s39, 50176
s_add_u32 s37, s37, s38
buffer_load_dwordx4 v23, s[8:11], s37 offen sc1 lds
s_add_u32 m0, s39, 51200
s_add_u32 s37, s37, s38
buffer_load_dwordx4 v22, s[8:11], s37 offen sc1 lds
s_add_u32 m0, s39, 52224
s_add_u32 s37, s37, s38
buffer_load_dwordx4 v23, s[8:11], s37 offen sc1 lds
s_add_u32 m0, s39, 53248
s_add_u32 s37, s37, s38
buffer_load_dwordx4 v22, s[8:11], s37 offen sc1 lds
s_add_u32 m0, s39, 54272
s_add_u32 s37, s37, s38
buffer_load_dwordx4 v23, s[8:11], s37 offen sc1 lds
s_add_u32 m0, s39, 55296
s_add_u32 s37, s37, s38
buffer_load_dwordx4 v22, s[8:11], s37 offen sc1 lds
s_add_u32 m0, s39, 56320
s_add_u32 s37, s37, s38
buffer_load_dwordx4 v23, s[8:11], s37 offen sc1 lds
s_add_u32 m0, s39, 57344
s_add_u32 s37, s37, s38
buffer_load_dwordx4 v22, s[8:11], s37 offen sc1 lds
s_add_u32 m0, s39, 58368
s_add_u32 s37, s37, s38
buffer_load_dwordx4 v23, s[8:11], s37 offen sc1 lds
s_add_u32 m0, s39, 59392
s_add_u32 s37, s37, s38
buffer_load_dwordx4 v22, s[8:11], s37 offen sc1 lds
s_add_u32 m0, s39, 60416
s_add_u32 s37, s37, s38
buffer_load_dwordx4 v23, s[8:11], s37 offen sc1 lds
s_add_u32 m0, s39, 61440
s_add_u32 s37, s37, s38
buffer_load_dwordx4 v22, s[8:11], s37 offen sc1 lds
s_add_u32 m0, s39, 62464
s_add_u32 s37, s37, s38
buffer_load_dwordx4 v23, s[8:11], s37 offen sc1 lds
s_add_u32 m0, s39, 63488
s_add_u32 s37, s37, s38
buffer_load_dwordx4 v22, s[8:11], s37 offen sc1 lds
s_add_u32 m0, s39, 64512
s_add_u32 s37, s37, s38
buffer_load_dwordx4 v23, s[8:11], s37 offen sc1 lds
s_mul_i32 s44, s34, 917504
s_lshl_b32 s39, s51, 13
s_add_u32 s44, s44, s39
s_add_u32 s44, s44, 8388608
s_lshl_b32 s43, s35, 7
s_mov_b32 s10, 909312
s_movk_i32 s38, 1024
s_movk_i32 s40, 9216
s_cmp_eq_u32 s51, 2
s_cselect_b32 s8, s60, s32
s_cselect_b32 s9, s61, s33
s_cselect_b32 s10, 7338112, s10
s_cselect_b32 s43, s43, s44
s_cselect_b32 s38, 16384, s38
s_cselect_b32 s40, 81920, s40
s_cselect_b32 s55, 81920, s38
s_cselect_b32 s45, -1, 0
s_add_u32 s8, s8, s43
s_addc_u32 s9, s9, 0
s_mov_b32 s11, 0x20000
s_sub_u32 s37, 0, s40
v_lshrrev_b32 v19, 3, v1
v_mul_u32_u24 v19, 1920, v19
v_lshrrev_b32 v20, 4, v1
v_lshlrev_b32 v20, 5, v20
v_and_b32 v19, s45, v19
v_and_b32 v20, s45, v20
v_lshlrev_b32 v21, 4, v1
v_xor_b32 v21, v21, v20
v_add_u32 v21, v21, v19
s_mul_i32 s43, s38, 6
s_add_u32 s43, s43, s40
s_add_u32 s43, s43, s55
s_lshl_b32 s43, s43, 2
s_add_u32 s37, s37, s43
s_and_b32 s54, s45, 4290838528
s_waitcnt vmcnt(16)
s_barrier
s_branch LK3b_26
L7_25:
s_lshr_b32 s43, s2, 1
s_cmp_ge_u32 s43, 112
s_cbranch_scc1 Lnojob_36
s_and_b32 s44, s2, 1
s_lshl_b32 s45, s44, 3
s_add_u32 s45, s45, 32
s_load_dwordx2 s[68:69], s[0:1], s45
s_mul_i32 s45, s43, 2341
s_lshr_b32 s45, s45, 16
s_mul_i32 s46, s45, 28
s_sub_u32 s46, s43, s46
v_lshrrev_b32 v4, 4, v1
s_lshl_b32 s43, s45, 8
v_add_u32 v4, s43, v4
v_mul_u32_u24 v4, 7168, v4
v_and_b32 v5, 15, v1
v_lshl_add_u32 v4, v5, 4, v4
s_lshl_b32 s43, s46, 8
v_add_u32 v4, s43, v4
s_waitcnt lgkmcnt(0)
s_mov_b32 s64, s68
s_mov_b32 s65, s69
s_mov_b32 s66, 7340032
s_mov_b32 s67, 0x20000
s_lshl_b32 s55, s45, 1
s_add_u32 s55, s55, s44
s_mul_i32 s55, s55, 14336
s_lshl_b32 s45, s46, 9
s_add_u32 s55, s55, s45
v_lshl_add_u32 v5, v5, 5, s55
s_add_u32 s72, s32, 27262976
s_addc_u32 s73, s33, 0
s_mov_b32 s74, 114688
s_mov_b32 s75, 0x20000
v_mov_b32 v32, 0
v_mov_b32 v33, 0
v_mov_b32 v34, 0
v_mov_b32 v35, 0
v_mov_b32 v36, 0
v_mov_b32 v37, 0
v_mov_b32 v38, 0
v_mov_b32 v39, 0
v_lshlrev_b32 v40, 16, v128
v_and_b32 v41, 0xffff0000, v128
v_lshlrev_b32 v42, 16, v129
v_and_b32 v43, 0xffff0000, v129
v_lshlrev_b32 v44, 16, v130
v_and_b32 v45, 0xffff0000, v130
v_lshlrev_b32 v46, 16, v131
v_and_b32 v47, 0xffff0000, v131
s_mov_b32 s43, 917504
buffer_load_dwordx4 v[128:131], v4, s[64:67], s43 offen
v_add_f32 v32, v32, v40
v_add_f32 v33, v33, v41
v_add_f32 v34, v34, v42
v_add_f32 v35, v35, v43
v_add_f32 v36, v36, v44
v_add_f32 v37, v37, v45
v_add_f32 v38, v38, v46
v_add_f32 v39, v39, v47
v_lshlrev_b32 v40, 16, v132
v_and_b32 v41, 0xffff0000, v132
v_lshlrev_b32 v42, 16, v133
v_and_b32 v43, 0xffff0000, v133
v_lshlrev_b32 v44, 16, v134
v_and_b32 v45, 0xffff0000, v134
v_lshlrev_b32 v46, 16, v135
v_and_b32 v47, 0xffff0000, v135
s_mov_b32 s43, 946176
buffer_load_dwordx4 v[132:135], v4, s[64:67], s43 offen
v_add_f32 v32, v32, v40
v_add_f32 v33, v33, v41
v_add_f32 v34, v34, v42
v_add_f32 v35, v35, v43
v_add_f32 v36, v36, v44
v_add_f32 v37, v37, v45
v_add_f32 v38, v38, v46
v_add_f32 v39, v39, v47
v_lshlrev_b32 v40, 16, v136
v_and_b32 v41, 0xffff0000, v136
v_lshlrev_b32 v42, 16, v137
v_and_b32 v43, 0xffff0000, v137
v_lshlrev_b32 v44, 16, v138
v_and_b32 v45, 0xffff0000, v138
v_lshlrev_b32 v46, 16, v139
v_and_b32 v47, 0xffff0000, v139
s_mov_b32 s43, 974848
buffer_load_dwordx4 v[136:139], v4, s[64:67], s43 offen
v_add_f32 v32, v32, v40
v_add_f32 v33, v33, v41
v_add_f32 v34, v34, v42
v_add_f32 v35, v35, v43
v_add_f32 v36, v36, v44
v_add_f32 v37, v37, v45
v_add_f32 v38, v38, v46
v_add_f32 v39, v39, v47
v_lshlrev_b32 v40, 16, v140
v_and_b32 v41, 0xffff0000, v140
v_lshlrev_b32 v42, 16, v141
v_and_b32 v43, 0xffff0000, v141
v_lshlrev_b32 v44, 16, v142
v_and_b32 v45, 0xffff0000, v142
v_lshlrev_b32 v46, 16, v143
v_and_b32 v47, 0xffff0000, v143
s_mov_b32 s43, 1003520
buffer_load_dwordx4 v[140:143], v4, s[64:67], s43 offen
v_add_f32 v32, v32, v40
v_add_f32 v33, v33, v41
v_add_f32 v34, v34, v42
v_add_f32 v35, v35, v43
v_add_f32 v36, v36, v44
v_add_f32 v37, v37, v45
v_add_f32 v38, v38, v46
v_add_f32 v39, v39, v47
v_lshlrev_b32 v40, 16, v144
v_and_b32 v41, 0xffff0000, v144
v_lshlrev_b32 v42, 16, v145
v_and_b32 v43, 0xffff0000, v145
v_lshlrev_b32 v44, 16, v146
v_and_b32 v45, 0xffff0000, v146
v_lshlrev_b32 v46, 16, v147
v_and_b32 v47, 0xffff0000, v147
s_mov_b32 s43, 1032192
buffer_load_dwordx4 v[144:147], v4, s[64:67], s43 offen
v_add_f32 v32, v32, v40
v_add_f32 v33, v33, v41
v_add_f32 v34, v34, v42
v_add_f32 v35, v35, v43
v_add_f32 v36, v36, v44
v_add_f32 v37, v37, v45
v_add_f32 v38, v38, v46
v_add_f32 v39, v39, v47
v_lshlrev_b32 v40, 16, v148
v_and_b32 v41, 0xffff0000, v148
v_lshlrev_b32 v42, 16, v149
v_and_b32 v43, 0xffff0000, v149
v_lshlrev_b32 v44, 16, v150
v_and_b32 v45, 0xffff0000, v150
v_lshlrev_b32 v46, 16, v151
v_and_b32 v47, 0xffff0000, v151
s_mov_b32 s43, 1060864
buffer_load_dwordx4 v[148:151], v4, s[64:67], s43 offen
v_add_f32 v32, v32, v40
v_add_f32 v33, v33, v41
v_add_f32 v34, v34, v42
v_add_f32 v35, v35, v43
v_add_f32 v36, v36, v44
v_add_f32 v37, v37, v45
v_add_f32 v38, v38, v46
v_add_f32 v39, v39, v47
v_lshlrev_b32 v40, 16, v152
v_and_b32 v41, 0xffff0000, v152
v_lshlrev_b32 v42, 16, v153
v_and_b32 v43, 0xffff0000, v153
v_lshlrev_b32 v44, 16, v154
v_and_b32 v45, 0xffff0000, v154
v_lshlrev_b32 v46, 16, v155
v_and_b32 v47, 0xffff0000, v155
s_mov_b32 s43, 1089536
buffer_load_dwordx4 v[152:155], v4, s[64:67], s43 offen
v_add_f32 v32, v32, v40
v_add_f32 v33, v33, v41
v_add_f32 v34, v34, v42
v_add_f32 v35, v35, v43
v_add_f32 v36, v36, v44
v_add_f32 v37, v37, v45
v_add_f32 v38, v38, v46
v_add_f32 v39, v39, v47
v_lshlrev_b32 v40, 16, v156
v_and_b32 v41, 0xffff0000, v156
v_lshlrev_b32 v42, 16, v157
v_and_b32 v43, 0xffff0000, v157
v_lshlrev_b32 v44, 16, v158
v_and_b32 v45, 0xffff0000, v158
v_lshlrev_b32 v46, 16, v159
v_and_b32 v47, 0xffff0000, v159
s_mov_b32 s43, 1118208
buffer_load_dwordx4 v[156:159], v4, s[64:67], s43 offen
v_add_f32 v32, v32, v40
v_add_f32 v33, v33, v41
v_add_f32 v34, v34, v42
v_add_f32 v35, v35, v43
v_add_f32 v36, v36, v44
v_add_f32 v37, v37, v45
v_add_f32 v38, v38, v46
v_add_f32 v39, v39, v47
v_lshlrev_b32 v40, 16, v160
v_and_b32 v41, 0xffff0000, v160
v_lshlrev_b32 v42, 16, v161
v_and_b32 v43, 0xffff0000, v161
v_lshlrev_b32 v44, 16, v162
v_and_b32 v45, 0xffff0000, v162
v_lshlrev_b32 v46, 16, v163
v_and_b32 v47, 0xffff0000, v163
s_mov_b32 s43, 1146880
buffer_load_dwordx4 v[160:163], v4, s[64:67], s43 offen
v_add_f32 v32, v32, v40
v_add_f32 v33, v33, v41
v_add_f32 v34, v34, v42
v_add_f32 v35, v35, v43
v_add_f32 v36, v36, v44
v_add_f32 v37, v37, v45
v_add_f32 v38, v38, v46
v_add_f32 v39, v39, v47
v_lshlrev_b32 v40, 16, v164
v_and_b32 v41, 0xffff0000, v164
v_lshlrev_b32 v42, 16, v165
v_and_b32 v43, 0xffff0000, v165
v_lshlrev_b32 v44, 16, v166
v_and_b32 v45, 0xffff0000, v166
v_lshlrev_b32 v46, 16, v167
v_and_b32 v47, 0xffff0000, v167
s_mov_b32 s43, 1175552
buffer_load_dwordx4 v[164:167], v4, s[64:67], s43 offen
v_add_f32 v32, v32, v40
v_add_f32 v33, v33, v41
v_add_f32 v34, v34, v42
v_add_f32 v35, v35, v43
v_add_f32 v36, v36, v44
v_add_f32 v37, v37, v45
v_add_f32 v38, v38, v46
v_add_f32 v39, v39, v47
v_lshlrev_b32 v40, 16, v168
v_and_b32 v41, 0xffff0000, v168
v_lshlrev_b32 v42, 16, v169
v_and_b32 v43, 0xffff0000, v169
v_lshlrev_b32 v44, 16, v170
v_and_b32 v45, 0xffff0000, v170
v_lshlrev_b32 v46, 16, v171
v_and_b32 v47, 0xffff0000, v171
s_mov_b32 s43, 1204224
buffer_load_dwordx4 v[168:171], v4, s[64:67], s43 offen
v_add_f32 v32, v32, v40
v_add_f32 v33, v33, v41
v_add_f32 v34, v34, v42
v_add_f32 v35, v35, v43
v_add_f32 v36, v36, v44
v_add_f32 v37, v37, v45
v_add_f32 v38, v38, v46
v_add_f32 v39, v39, v47
v_lshlrev_b32 v40, 16, v172
v_and_b32 v41, 0xffff0000, v172
v_lshlrev_b32 v42, 16, v173
v_and_b32 v43, 0xffff0000, v173
v_lshlrev_b32 v44, 16, v174
v_and_b32 v45, 0xffff0000, v174
v_lshlrev_b32 v46, 16, v175
v_and_b32 v47, 0xffff0000, v175
s_mov_b32 s43, 1232896
buffer_load_dwordx4 v[172:175], v4, s[64:67], s43 offen
v_add_f32 v32, v32, v40
v_add_f32 v33, v33, v41
v_add_f32 v34, v34, v42
v_add_f32 v35, v35, v43
v_add_f32 v36, v36, v44
v_add_f32 v37, v37, v45
v_add_f32 v38, v38, v46
v_add_f32 v39, v39, v47
v_lshlrev_b32 v40, 16, v176
v_and_b32 v41, 0xffff0000, v176
v_lshlrev_b32 v42, 16, v177
v_and_b32 v43, 0xffff0000, v177
v_lshlrev_b32 v44, 16, v178
v_and_b32 v45, 0xffff0000, v178
v_lshlrev_b32 v46, 16, v179
v_and_b32 v47, 0xffff0000, v179
s_mov_b32 s43, 1261568
buffer_load_dwordx4 v[176:179], v4, s[64:67], s43 offen
v_add_f32 v32, v32, v40
v_add_f32 v33, v33, v41
v_add_f32 v34, v34, v42
v_add_f32 v35, v35, v43
v_add_f32 v36, v36, v44
v_add_f32 v37, v37, v45
v_add_f32 v38, v38, v46
v_add_f32 v39, v39, v47
v_lshlrev_b32 v40, 16, v180
v_and_b32 v41, 0xffff0000, v180
v_lshlrev_b32 v42, 16, v181
v_and_b32 v43, 0xffff0000, v181
v_lshlrev_b32 v44, 16, v182
v_and_b32 v45, 0xffff0000, v182
v_lshlrev_b32 v46, 16, v183
v_and_b32 v47, 0xffff0000, v183
s_mov_b32 s43, 1290240
buffer_load_dwordx4 v[180:183], v4, s[64:67], s43 offen
v_add_f32 v32, v32, v40
v_add_f32 v33, v33, v41
v_add_f32 v34, v34, v42
v_add_f32 v35, v35, v43
v_add_f32 v36, v36, v44
v_add_f32 v37, v37, v45
v_add_f32 v38, v38, v46
v_add_f32 v39, v39, v47
v_lshlrev_b32 v40, 16, v184
v_and_b32 v41, 0xffff0000, v184
v_lshlrev_b32 v42, 16, v185
v_and_b32 v43, 0xffff0000, v185
v_lshlrev_b32 v44, 16, v186
v_and_b32 v45, 0xffff0000, v186
v_lshlrev_b32 v46, 16, v187
v_and_b32 v47, 0xffff0000, v187
s_mov_b32 s43, 1318912
buffer_load_dwordx4 v[184:187], v4, s[64:67], s43 offen
v_add_f32 v32, v32, v40
v_add_f32 v33, v33, v41
v_add_f32 v34, v34, v42
v_add_f32 v35, v35, v43
v_add_f32 v36, v36, v44
v_add_f32 v37, v37, v45
v_add_f32 v38, v38, v46
v_add_f32 v39, v39, v47
v_lshlrev_b32 v40, 16, v188
v_and_b32 v41, 0xffff0000, v188
v_lshlrev_b32 v42, 16, v189
v_and_b32 v43, 0xffff0000, v189
v_lshlrev_b32 v44, 16, v190
v_and_b32 v45, 0xffff0000, v190
v_lshlrev_b32 v46, 16, v191
v_and_b32 v47, 0xffff0000, v191
s_mov_b32 s43, 1347584
buffer_load_dwordx4 v[188:191], v4, s[64:67], s43 offen
v_add_f32 v32, v32, v40
v_add_f32 v33, v33, v41
v_add_f32 v34, v34, v42
v_add_f32 v35, v35, v43
v_add_f32 v36, v36, v44
v_add_f32 v37, v37, v45
v_add_f32 v38, v38, v46
v_add_f32 v39, v39, v47
v_lshlrev_b32 v40, 16, v192
v_and_b32 v41, 0xffff0000, v192
v_lshlrev_b32 v42, 16, v193
v_and_b32 v43, 0xffff0000, v193
v_lshlrev_b32 v44, 16, v194
v_and_b32 v45, 0xffff0000, v194
v_lshlrev_b32 v46, 16, v195
v_and_b32 v47, 0xffff0000, v195
s_mov_b32 s43, 1376256
buffer_load_dwordx4 v[192:195], v4, s[64:67], s43 offen
v_add_f32 v32, v32, v40
v_add_f32 v33, v33, v41
v_add_f32 v34, v34, v42
v_add_f32 v35, v35, v43
v_add_f32 v36, v36, v44
v_add_f32 v37, v37, v45
v_add_f32 v38, v38, v46
v_add_f32 v39, v39, v47
v_lshlrev_b32 v40, 16, v196
v_and_b32 v41, 0xffff0000, v196
v_lshlrev_b32 v42, 16, v197
v_and_b32 v43, 0xffff0000, v197
v_lshlrev_b32 v44, 16, v198
v_and_b32 v45, 0xffff0000, v198
v_lshlrev_b32 v46, 16, v199
v_and_b32 v47, 0xffff0000, v199
s_mov_b32 s43, 1404928
buffer_load_dwordx4 v[196:199], v4, s[64:67], s43 offen
v_add_f32 v32, v32, v40
v_add_f32 v33, v33, v41
v_add_f32 v34, v34, v42
v_add_f32 v35, v35, v43
v_add_f32 v36, v36, v44
v_add_f32 v37, v37, v45
v_add_f32 v38, v38, v46
v_add_f32 v39, v39, v47
v_lshlrev_b32 v40, 16, v200
v_and_b32 v41, 0xffff0000, v200
v_lshlrev_b32 v42, 16, v201
v_and_b32 v43, 0xffff0000, v201
v_lshlrev_b32 v44, 16, v202
v_and_b32 v45, 0xffff0000, v202
v_lshlrev_b32 v46, 16, v203
v_and_b32 v47, 0xffff0000, v203
s_mov_b32 s43, 1433600
buffer_load_dwordx4 v[200:203], v4, s[64:67], s43 offen
v_add_f32 v32, v32, v40
v_add_f32 v33, v33, v41
v_add_f32 v34, v34, v42
v_add_f32 v35, v35, v43
v_add_f32 v36, v36, v44
v_add_f32 v37, v37, v45
v_add_f32 v38, v38, v46
v_add_f32 v39, v39, v47
v_lshlrev_b32 v40, 16, v204
v_and_b32 v41, 0xffff0000, v204
v_lshlrev_b32 v42, 16, v205
v_and_b32 v43, 0xffff0000, v205
v_lshlrev_b32 v44, 16, v206
v_and_b32 v45, 0xffff0000, v206
v_lshlrev_b32 v46, 16, v207
v_and_b32 v47, 0xffff0000, v207
s_mov_b32 s43, 1462272
buffer_load_dwordx4 v[204:207], v4, s[64:67], s43 offen
v_add_f32 v32, v32, v40
v_add_f32 v33, v33, v41
v_add_f32 v34, v34, v42
v_add_f32 v35, v35, v43
v_add_f32 v36, v36, v44
v_add_f32 v37, v37, v45
v_add_f32 v38, v38, v46
v_add_f32 v39, v39, v47
v_lshlrev_b32 v40, 16, v208
v_and_b32 v41, 0xffff0000, v208
v_lshlrev_b32 v42, 16, v209
v_and_b32 v43, 0xffff0000, v209
v_lshlrev_b32 v44, 16, v210
v_and_b32 v45, 0xffff0000, v210
v_lshlrev_b32 v46, 16, v211
v_and_b32 v47, 0xffff0000, v211
s_mov_b32 s43, 1490944
buffer_load_dwordx4 v[208:211], v4, s[64:67], s43 offen
v_add_f32 v32, v32, v40
v_add_f32 v33, v33, v41
v_add_f32 v34, v34, v42
v_add_f32 v35, v35, v43
v_add_f32 v36, v36, v44
v_add_f32 v37, v37, v45
v_add_f32 v38, v38, v46
v_add_f32 v39, v39, v47
v_lshlrev_b32 v40, 16, v212
v_and_b32 v41, 0xffff0000, v212
v_lshlrev_b32 v42, 16, v213
v_and_b32 v43, 0xffff0000, v213
v_lshlrev_b32 v44, 16, v214
v_and_b32 v45, 0xffff0000, v214
v_lshlrev_b32 v46, 16, v215
v_and_b32 v47, 0xffff0000, v215
s_mov_b32 s43, 1519616
buffer_load_dwordx4 v[212:215], v4, s[64:67], s43 offen
v_add_f32 v32, v32, v40
v_add_f32 v33, v33, v41
v_add_f32 v34, v34, v42
v_add_f32 v35, v35, v43
v_add_f32 v36, v36, v44
v_add_f32 v37, v37, v45
v_add_f32 v38, v38, v46
v_add_f32 v39, v39, v47
v_lshlrev_b32 v40, 16, v216
v_and_b32 v41, 0xffff0000, v216
v_lshlrev_b32 v42, 16, v217
v_and_b32 v43, 0xffff0000, v217
v_lshlrev_b32 v44, 16, v218
v_and_b32 v45, 0xffff0000, v218
v_lshlrev_b32 v46, 16, v219
v_and_b32 v47, 0xffff0000, v219
s_mov_b32 s43, 1548288
buffer_load_dwordx4 v[216:219], v4, s[64:67], s43 offen
v_add_f32 v32, v32, v40
v_add_f32 v33, v33, v41
v_add_f32 v34, v34, v42
v_add_f32 v35, v35, v43
v_add_f32 v36, v36, v44
v_add_f32 v37, v37, v45
v_add_f32 v38, v38, v46
v_add_f32 v39, v39, v47
v_lshlrev_b32 v40, 16, v220
v_and_b32 v41, 0xffff0000, v220
v_lshlrev_b32 v42, 16, v221
v_and_b32 v43, 0xffff0000, v221
v_lshlrev_b32 v44, 16, v222
v_and_b32 v45, 0xffff0000, v222
v_lshlrev_b32 v46, 16, v223
v_and_b32 v47, 0xffff0000, v223
s_mov_b32 s43, 1576960
buffer_load_dwordx4 v[220:223], v4, s[64:67], s43 offen
v_add_f32 v32, v32, v40
v_add_f32 v33, v33, v41
v_add_f32 v34, v34, v42
v_add_f32 v35, v35, v43
v_add_f32 v36, v36, v44
v_add_f32 v37, v37, v45
v_add_f32 v38, v38, v46
v_add_f32 v39, v39, v47
v_lshlrev_b32 v40, 16, v224
v_and_b32 v41, 0xffff0000, v224
v_lshlrev_b32 v42, 16, v225
v_and_b32 v43, 0xffff0000, v225
v_lshlrev_b32 v44, 16, v226
v_and_b32 v45, 0xffff0000, v226
v_lshlrev_b32 v46, 16, v227
v_and_b32 v47, 0xffff0000, v227
s_mov_b32 s43, 1605632
buffer_load_dwordx4 v[224:227], v4, s[64:67], s43 offen
v_add_f32 v32, v32, v40
v_add_f32 v33, v33, v41
v_add_f32 v34, v34, v42
v_add_f32 v35, v35, v43
v_add_f32 v36, v36, v44
v_add_f32 v37, v37, v45
v_add_f32 v38, v38, v46
v_add_f32 v39, v39, v47
v_lshlrev_b32 v40, 16, v228
v_and_b32 v41, 0xffff0000, v228
v_lshlrev_b32 v42, 16, v229
v_and_b32 v43, 0xffff0000, v229
v_lshlrev_b32 v44, 16, v230
v_and_b32 v45, 0xffff0000, v230
v_lshlrev_b32 v46, 16, v231
v_and_b32 v47, 0xffff0000, v231
s_mov_b32 s43, 1634304
buffer_load_dwordx4 v[228:231], v4, s[64:67], s43 offen
v_add_f32 v32, v32, v40
v_add_f32 v33, v33, v41
v_add_f32 v34, v34, v42
v_add_f32 v35, v35, v43
v_add_f32 v36, v36, v44
v_add_f32 v37, v37, v45
v_add_f32 v38, v38, v46
v_add_f32 v39, v39, v47
v_lshlrev_b32 v40, 16, v232
v_and_b32 v41, 0xffff0000, v232
v_lshlrev_b32 v42, 16, v233
v_and_b32 v43, 0xffff0000, v233
v_lshlrev_b32 v44, 16, v234
v_and_b32 v45, 0xffff0000, v234
v_lshlrev_b32 v46, 16, v235
v_and_b32 v47, 0xffff0000, v235
s_mov_b32 s43, 1662976
buffer_load_dwordx4 v[232:235], v4, s[64:67], s43 offen
v_add_f32 v32, v32, v40
v_add_f32 v33, v33, v41
v_add_f32 v34, v34, v42
v_add_f32 v35, v35, v43
v_add_f32 v36, v36, v44
v_add_f32 v37, v37, v45
v_add_f32 v38, v38, v46
v_add_f32 v39, v39, v47
v_lshlrev_b32 v40, 16, v236
v_and_b32 v41, 0xffff0000, v236
v_lshlrev_b32 v42, 16, v237
v_and_b32 v43, 0xffff0000, v237
v_lshlrev_b32 v44, 16, v238
v_and_b32 v45, 0xffff0000, v238
v_lshlrev_b32 v46, 16, v239
v_and_b32 v47, 0xffff0000, v239
s_mov_b32 s43, 1691648
buffer_load_dwordx4 v[236:239], v4, s[64:67], s43 offen
v_add_f32 v32, v32, v40
v_add_f32 v33, v33, v41
v_add_f32 v34, v34, v42
v_add_f32 v35, v35, v43
v_add_f32 v36, v36, v44
v_add_f32 v37, v37, v45
v_add_f32 v38, v38, v46
v_add_f32 v39, v39, v47
v_lshlrev_b32 v40, 16, v240
v_and_b32 v41, 0xffff0000, v240
v_lshlrev_b32 v42, 16, v241
v_and_b32 v43, 0xffff0000, v241
v_lshlrev_b32 v44, 16, v242
v_and_b32 v45, 0xffff0000, v242
v_lshlrev_b32 v46, 16, v243
v_and_b32 v47, 0xffff0000, v243
s_mov_b32 s43, 1720320
buffer_load_dwordx4 v[240:243], v4, s[64:67], s43 offen
v_add_f32 v32, v32, v40
v_add_f32 v33, v33, v41
v_add_f32 v34, v34, v42
v_add_f32 v35, v35, v43
v_add_f32 v36, v36, v44
v_add_f32 v37, v37, v45
v_add_f32 v38, v38, v46
v_add_f32 v39, v39, v47
v_lshlrev_b32 v40, 16, v244
v_and_b32 v41, 0xffff0000, v244
v_lshlrev_b32 v42, 16, v245
v_and_b32 v43, 0xffff0000, v245
v_lshlrev_b32 v44, 16, v246
v_and_b32 v45, 0xffff0000, v246
v_lshlrev_b32 v46, 16, v247
v_and_b32 v47, 0xffff0000, v247
s_mov_b32 s43, 1748992
buffer_load_dwordx4 v[244:247], v4, s[64:67], s43 offen
v_add_f32 v32, v32, v40
v_add_f32 v33, v33, v41
v_add_f32 v34, v34, v42
v_add_f32 v35, v35, v43
v_add_f32 v36, v36, v44
v_add_f32 v37, v37, v45
v_add_f32 v38, v38, v46
v_add_f32 v39, v39, v47
v_lshlrev_b32 v40, 16, v248
v_and_b32 v41, 0xffff0000, v248
v_lshlrev_b32 v42, 16, v249
v_and_b32 v43, 0xffff0000, v249
v_lshlrev_b32 v44, 16, v250
v_and_b32 v45, 0xffff0000, v250
v_lshlrev_b32 v46, 16, v251
v_and_b32 v47, 0xffff0000, v251
s_mov_b32 s43, 1777664
buffer_load_dwordx4 v[248:251], v4, s[64:67], s43 offen
v_add_f32 v32, v32, v40
v_add_f32 v33, v33, v41
v_add_f32 v34, v34, v42
v_add_f32 v35, v35, v43
v_add_f32 v36, v36, v44
v_add_f32 v37, v37, v45
v_add_f32 v38, v38, v46
v_add_f32 v39, v39, v47
v_lshlrev_b32 v40, 16, v252
v_and_b32 v41, 0xffff0000, v252
v_lshlrev_b32 v42, 16, v253
v_and_b32 v43, 0xffff0000, v253
v_lshlrev_b32 v44, 16, v254
v_and_b32 v45, 0xffff0000, v254
v_lshlrev_b32 v46, 16, v255
v_and_b32 v47, 0xffff0000, v255
s_mov_b32 s43, 1806336
buffer_load_dwordx4 v[252:255], v4, s[64:67], s43 offen
v_add_f32 v32, v32, v40
v_add_f32 v33, v33, v41
v_add_f32 v34, v34, v42
v_add_f32 v35, v35, v43
v_add_f32 v36, v36, v44
v_add_f32 v37, v37, v45
v_add_f32 v38, v38, v46
v_add_f32 v39, v39, v47
s_lshl_b32 s43, s34, 18
s_add_u32 s12, s32, s43
s_addc_u32 s13, s33, 0
s_mov_b32 s14, 262144
s_mov_b32 s15, 0x20000
v_lshlrev_b32 v21, 4, v1
s_lshl_b32 s54, s36, 11
s_barrier
s_add_u32 m0, s54, 0
s_add_u32 s43, s54, 0
buffer_load_dwordx4 v21, s[12:15], s43 offen sc1 lds
s_add_u32 m0, s54, 1024
s_add_u32 s43, s54, 1024
buffer_load_dwordx4 v21, s[12:15], s43 offen sc1 lds
s_add_u32 m0, s54, 24576
s_add_u32 s43, s54, 16384
buffer_load_dwordx4 v21, s[12:15], s43 offen sc1 lds
s_add_u32 m0, s54, 25600
s_add_u32 s43, s54, 17408
buffer_load_dwordx4 v21, s[12:15], s43 offen sc1 lds
s_waitcnt vmcnt(2)
s_barrier
s_waitcnt vmcnt(0)
s_barrier
s_barrier
s_barrier
s_barrier
s_barrier
s_barrier
s_barrier
s_barrier
s_barrier
s_barrier
s_barrier
s_barrier
s_barrier
s_barrier
s_barrier
s_barrier
s_barrier
s_mul_i32 s43, s2, 28672
s_add_u32 s76, s60, s43
s_addc_u32 s77, s61, 0
s_mov_b32 s78, 28672
s_mov_b32 s79, 0x20000
v_lshlrev_b32 v19, 7, v1
s_mov_b32 s43, 0
buffer_load_dword v30, v19, s[76:79], s43 offen
s_mov_b32 s43, 8192
buffer_load_dword v30, v19, s[76:79], s43 offen
s_mov_b32 s43, 16384
buffer_load_dword v30, v19, s[76:79], s43 offen
s_mov_b32 s43, 24576
buffer_load_dword v30, v19, s[76:79], s43 offen
v_lshlrev_b32 v40, 16, v128
v_and_b32 v41, 0xffff0000, v128
v_lshlrev_b32 v42, 16, v129
v_and_b32 v43, 0xffff0000, v129
v_lshlrev_b32 v44, 16, v130
v_and_b32 v45, 0xffff0000, v130
v_lshlrev_b32 v46, 16, v131
v_and_b32 v47, 0xffff0000, v131
v_add_f32 v32, v32, v40
v_add_f32 v33, v33, v41
v_add_f32 v34, v34, v42
v_add_f32 v35, v35, v43
v_add_f32 v36, v36, v44
v_add_f32 v37, v37, v45
v_add_f32 v38, v38, v46
v_add_f32 v39, v39, v47
v_lshlrev_b32 v40, 16, v132
v_and_b32 v41, 0xffff0000, v132
v_lshlrev_b32 v42, 16, v133
v_and_b32 v43, 0xffff0000, v133
v_lshlrev_b32 v44, 16, v134
v_and_b32 v45, 0xffff0000, v134
v_lshlrev_b32 v46, 16, v135
v_and_b32 v47, 0xffff0000, v135
v_add_f32 v32, v32, v40
v_add_f32 v33, v33, v41
v_add_f32 v34, v34, v42
v_add_f32 v35, v35, v43
v_add_f32 v36, v36, v44
v_add_f32 v37, v37, v45
v_add_f32 v38, v38, v46
v_add_f32 v39, v39, v47
v_lshlrev_b32 v40, 16, v136
v_and_b32 v41, 0xffff0000, v136
v_lshlrev_b32 v42, 16, v137
v_and_b32 v43, 0xffff0000, v137
v_lshlrev_b32 v44, 16, v138
v_and_b32 v45, 0xffff0000, v138
v_lshlrev_b32 v46, 16, v139
v_and_b32 v47, 0xffff0000, v139
v_add_f32 v32, v32, v40
v_add_f32 v33, v33, v41
v_add_f32 v34, v34, v42
v_add_f32 v35, v35, v43
v_add_f32 v36, v36, v44
v_add_f32 v37, v37, v45
v_add_f32 v38, v38, v46
v_add_f32 v39, v39, v47
v_lshlrev_b32 v40, 16, v140
v_and_b32 v41, 0xffff0000, v140
v_lshlrev_b32 v42, 16, v141
v_and_b32 v43, 0xffff0000, v141
v_lshlrev_b32 v44, 16, v142
v_and_b32 v45, 0xffff0000, v142
v_lshlrev_b32 v46, 16, v143
v_and_b32 v47, 0xffff0000, v143
v_add_f32 v32, v32, v40
v_add_f32 v33, v33, v41
v_add_f32 v34, v34, v42
v_add_f32 v35, v35, v43
v_add_f32 v36, v36, v44
v_add_f32 v37, v37, v45
v_add_f32 v38, v38, v46
v_add_f32 v39, v39, v47
v_lshlrev_b32 v40, 16, v144
v_and_b32 v41, 0xffff0000, v144
v_lshlrev_b32 v42, 16, v145
v_and_b32 v43, 0xffff0000, v145
v_lshlrev_b32 v44, 16, v146
v_and_b32 v45, 0xffff0000, v146
v_lshlrev_b32 v46, 16, v147
v_and_b32 v47, 0xffff0000, v147
v_add_f32 v32, v32, v40
v_add_f32 v33, v33, v41
v_add_f32 v34, v34, v42
v_add_f32 v35, v35, v43
v_add_f32 v36, v36, v44
v_add_f32 v37, v37, v45
v_add_f32 v38, v38, v46
v_add_f32 v39, v39, v47
v_lshlrev_b32 v40, 16, v148
v_and_b32 v41, 0xffff0000, v148
v_lshlrev_b32 v42, 16, v149
v_and_b32 v43, 0xffff0000, v149
v_lshlrev_b32 v44, 16, v150
v_and_b32 v45, 0xffff0000, v150
v_lshlrev_b32 v46, 16, v151
v_and_b32 v47, 0xffff0000, v151
v_add_f32 v32, v32, v40
v_add_f32 v33, v33, v41
v_add_f32 v34, v34, v42
v_add_f32 v35, v35, v43
v_add_f32 v36, v36, v44
v_add_f32 v37, v37, v45
v_add_f32 v38, v38, v46
v_add_f32 v39, v39, v47
v_lshlrev_b32 v40, 16, v152
v_and_b32 v41, 0xffff0000, v152
v_lshlrev_b32 v42, 16, v153
v_and_b32 v43, 0xffff0000, v153
v_lshlrev_b32 v44, 16, v154
v_and_b32 v45, 0xffff0000, v154
v_lshlrev_b32 v46, 16, v155
v_and_b32 v47, 0xffff0000, v155
v_add_f32 v32, v32, v40
v_add_f32 v33, v33, v41
v_add_f32 v34, v34, v42
v_add_f32 v35, v35, v43
v_add_f32 v36, v36, v44
v_add_f32 v37, v37, v45
v_add_f32 v38, v38, v46
v_add_f32 v39, v39, v47
v_lshlrev_b32 v40, 16, v156
v_and_b32 v41, 0xffff0000, v156
v_lshlrev_b32 v42, 16, v157
v_and_b32 v43, 0xffff0000, v157
v_lshlrev_b32 v44, 16, v158
v_and_b32 v45, 0xffff0000, v158
v_lshlrev_b32 v46, 16, v159
v_and_b32 v47, 0xffff0000, v159
v_add_f32 v32, v32, v40
v_add_f32 v33, v33, v41
v_add_f32 v34, v34, v42
v_add_f32 v35, v35, v43
v_add_f32 v36, v36, v44
v_add_f32 v37, v37, v45
v_add_f32 v38, v38, v46
v_add_f32 v39, v39, v47
v_lshlrev_b32 v40, 16, v160
v_and_b32 v41, 0xffff0000, v160
v_lshlrev_b32 v42, 16, v161
v_and_b32 v43, 0xffff0000, v161
v_lshlrev_b32 v44, 16, v162
v_and_b32 v45, 0xffff0000, v162
v_lshlrev_b32 v46, 16, v163
v_and_b32 v47, 0xffff0000, v163
v_add_f32 v32, v32, v40
v_add_f32 v33, v33, v41
v_add_f32 v34, v34, v42
v_add_f32 v35, v35, v43
v_add_f32 v36, v36, v44
v_add_f32 v37, v37, v45
v_add_f32 v38, v38, v46
v_add_f32 v39, v39, v47
v_lshlrev_b32 v40, 16, v164
v_and_b32 v41, 0xffff0000, v164
v_lshlrev_b32 v42, 16, v165
v_and_b32 v43, 0xffff0000, v165
v_lshlrev_b32 v44, 16, v166
v_and_b32 v45, 0xffff0000, v166
v_lshlrev_b32 v46, 16, v167
v_and_b32 v47, 0xffff0000, v167
v_add_f32 v32, v32, v40
v_add_f32 v33, v33, v41
v_add_f32 v34, v34, v42
v_add_f32 v35, v35, v43
v_add_f32 v36, v36, v44
v_add_f32 v37, v37, v45
v_add_f32 v38, v38, v46
v_add_f32 v39, v39, v47
v_lshlrev_b32 v40, 16, v168
v_and_b32 v41, 0xffff0000, v168
v_lshlrev_b32 v42, 16, v169
v_and_b32 v43, 0xffff0000, v169
v_lshlrev_b32 v44, 16, v170
v_and_b32 v45, 0xffff0000, v170
v_lshlrev_b32 v46, 16, v171
v_and_b32 v47, 0xffff0000, v171
v_add_f32 v32, v32, v40
v_add_f32 v33, v33, v41
v_add_f32 v34, v34, v42
v_add_f32 v35, v35, v43
v_add_f32 v36, v36, v44
v_add_f32 v37, v37, v45
v_add_f32 v38, v38, v46
v_add_f32 v39, v39, v47
v_lshlrev_b32 v40, 16, v172
v_and_b32 v41, 0xffff0000, v172
v_lshlrev_b32 v42, 16, v173
v_and_b32 v43, 0xffff0000, v173
v_lshlrev_b32 v44, 16, v174
v_and_b32 v45, 0xffff0000, v174
v_lshlrev_b32 v46, 16, v175
v_and_b32 v47, 0xffff0000, v175
v_add_f32 v32, v32, v40
v_add_f32 v33, v33, v41
v_add_f32 v34, v34, v42
v_add_f32 v35, v35, v43
v_add_f32 v36, v36, v44
v_add_f32 v37, v37, v45
v_add_f32 v38, v38, v46
v_add_f32 v39, v39, v47
v_lshlrev_b32 v40, 16, v176
v_and_b32 v41, 0xffff0000, v176
v_lshlrev_b32 v42, 16, v177
v_and_b32 v43, 0xffff0000, v177
v_lshlrev_b32 v44, 16, v178
v_and_b32 v45, 0xffff0000, v178
v_lshlrev_b32 v46, 16, v179
v_and_b32 v47, 0xffff0000, v179
v_add_f32 v32, v32, v40
v_add_f32 v33, v33, v41
v_add_f32 v34, v34, v42
v_add_f32 v35, v35, v43
v_add_f32 v36, v36, v44
v_add_f32 v37, v37, v45
v_add_f32 v38, v38, v46
v_add_f32 v39, v39, v47
v_lshlrev_b32 v40, 16, v180
v_and_b32 v41, 0xffff0000, v180
v_lshlrev_b32 v42, 16, v181
v_and_b32 v43, 0xffff0000, v181
v_lshlrev_b32 v44, 16, v182
v_and_b32 v45, 0xffff0000, v182
v_lshlrev_b32 v46, 16, v183
v_and_b32 v47, 0xffff0000, v183
v_add_f32 v32, v32, v40
v_add_f32 v33, v33, v41
v_add_f32 v34, v34, v42
v_add_f32 v35, v35, v43
v_add_f32 v36, v36, v44
v_add_f32 v37, v37, v45
v_add_f32 v38, v38, v46
v_add_f32 v39, v39, v47
v_lshlrev_b32 v40, 16, v184
v_and_b32 v41, 0xffff0000, v184
v_lshlrev_b32 v42, 16, v185
v_and_b32 v43, 0xffff0000, v185
v_lshlrev_b32 v44, 16, v186
v_and_b32 v45, 0xffff0000, v186
v_lshlrev_b32 v46, 16, v187
v_and_b32 v47, 0xffff0000, v187
v_add_f32 v32, v32, v40
v_add_f32 v33, v33, v41
v_add_f32 v34, v34, v42
v_add_f32 v35, v35, v43
v_add_f32 v36, v36, v44
v_add_f32 v37, v37, v45
v_add_f32 v38, v38, v46
v_add_f32 v39, v39, v47
v_lshlrev_b32 v40, 16, v188
v_and_b32 v41, 0xffff0000, v188
v_lshlrev_b32 v42, 16, v189
v_and_b32 v43, 0xffff0000, v189
v_lshlrev_b32 v44, 16, v190
v_and_b32 v45, 0xffff0000, v190
v_lshlrev_b32 v46, 16, v191
v_and_b32 v47, 0xffff0000, v191
v_add_f32 v32, v32, v40
v_add_f32 v33, v33, v41
v_add_f32 v34, v34, v42
v_add_f32 v35, v35, v43
v_add_f32 v36, v36, v44
v_add_f32 v37, v37, v45
v_add_f32 v38, v38, v46
v_add_f32 v39, v39, v47
v_lshlrev_b32 v40, 16, v192
v_and_b32 v41, 0xffff0000, v192
v_lshlrev_b32 v42, 16, v193
v_and_b32 v43, 0xffff0000, v193
v_lshlrev_b32 v44, 16, v194
v_and_b32 v45, 0xffff0000, v194
v_lshlrev_b32 v46, 16, v195
v_and_b32 v47, 0xffff0000, v195
v_add_f32 v32, v32, v40
v_add_f32 v33, v33, v41
v_add_f32 v34, v34, v42
v_add_f32 v35, v35, v43
v_add_f32 v36, v36, v44
v_add_f32 v37, v37, v45
v_add_f32 v38, v38, v46
v_add_f32 v39, v39, v47
v_lshlrev_b32 v40, 16, v196
v_and_b32 v41, 0xffff0000, v196
v_lshlrev_b32 v42, 16, v197
v_and_b32 v43, 0xffff0000, v197
v_lshlrev_b32 v44, 16, v198
v_and_b32 v45, 0xffff0000, v198
v_lshlrev_b32 v46, 16, v199
v_and_b32 v47, 0xffff0000, v199
v_add_f32 v32, v32, v40
v_add_f32 v33, v33, v41
v_add_f32 v34, v34, v42
v_add_f32 v35, v35, v43
v_add_f32 v36, v36, v44
v_add_f32 v37, v37, v45
v_add_f32 v38, v38, v46
v_add_f32 v39, v39, v47
v_lshlrev_b32 v40, 16, v200
v_and_b32 v41, 0xffff0000, v200
v_lshlrev_b32 v42, 16, v201
v_and_b32 v43, 0xffff0000, v201
v_lshlrev_b32 v44, 16, v202
v_and_b32 v45, 0xffff0000, v202
v_lshlrev_b32 v46, 16, v203
v_and_b32 v47, 0xffff0000, v203
v_add_f32 v32, v32, v40
v_add_f32 v33, v33, v41
v_add_f32 v34, v34, v42
v_add_f32 v35, v35, v43
v_add_f32 v36, v36, v44
v_add_f32 v37, v37, v45
v_add_f32 v38, v38, v46
v_add_f32 v39, v39, v47
v_lshlrev_b32 v40, 16, v204
v_and_b32 v41, 0xffff0000, v204
v_lshlrev_b32 v42, 16, v205
v_and_b32 v43, 0xffff0000, v205
v_lshlrev_b32 v44, 16, v206
v_and_b32 v45, 0xffff0000, v206
v_lshlrev_b32 v46, 16, v207
v_and_b32 v47, 0xffff0000, v207
v_add_f32 v32, v32, v40
v_add_f32 v33, v33, v41
v_add_f32 v34, v34, v42
v_add_f32 v35, v35, v43
v_add_f32 v36, v36, v44
v_add_f32 v37, v37, v45
v_add_f32 v38, v38, v46
v_add_f32 v39, v39, v47
v_lshlrev_b32 v40, 16, v208
v_and_b32 v41, 0xffff0000, v208
v_lshlrev_b32 v42, 16, v209
v_and_b32 v43, 0xffff0000, v209
v_lshlrev_b32 v44, 16, v210
v_and_b32 v45, 0xffff0000, v210
v_lshlrev_b32 v46, 16, v211
v_and_b32 v47, 0xffff0000, v211
v_add_f32 v32, v32, v40
v_add_f32 v33, v33, v41
v_add_f32 v34, v34, v42
v_add_f32 v35, v35, v43
v_add_f32 v36, v36, v44
v_add_f32 v37, v37, v45
v_add_f32 v38, v38, v46
v_add_f32 v39, v39, v47
v_lshlrev_b32 v40, 16, v212
v_and_b32 v41, 0xffff0000, v212
v_lshlrev_b32 v42, 16, v213
v_and_b32 v43, 0xffff0000, v213
v_lshlrev_b32 v44, 16, v214
v_and_b32 v45, 0xffff0000, v214
v_lshlrev_b32 v46, 16, v215
v_and_b32 v47, 0xffff0000, v215
v_add_f32 v32, v32, v40
v_add_f32 v33, v33, v41
v_add_f32 v34, v34, v42
v_add_f32 v35, v35, v43
v_add_f32 v36, v36, v44
v_add_f32 v37, v37, v45
v_add_f32 v38, v38, v46
v_add_f32 v39, v39, v47
v_lshlrev_b32 v40, 16, v216
v_and_b32 v41, 0xffff0000, v216
v_lshlrev_b32 v42, 16, v217
v_and_b32 v43, 0xffff0000, v217
v_lshlrev_b32 v44, 16, v218
v_and_b32 v45, 0xffff0000, v218
v_lshlrev_b32 v46, 16, v219
v_and_b32 v47, 0xffff0000, v219
v_add_f32 v32, v32, v40
v_add_f32 v33, v33, v41
v_add_f32 v34, v34, v42
v_add_f32 v35, v35, v43
v_add_f32 v36, v36, v44
v_add_f32 v37, v37, v45
v_add_f32 v38, v38, v46
v_add_f32 v39, v39, v47
v_lshlrev_b32 v40, 16, v220
v_and_b32 v41, 0xffff0000, v220
v_lshlrev_b32 v42, 16, v221
v_and_b32 v43, 0xffff0000, v221
v_lshlrev_b32 v44, 16, v222
v_and_b32 v45, 0xffff0000, v222
v_lshlrev_b32 v46, 16, v223
v_and_b32 v47, 0xffff0000, v223
v_add_f32 v32, v32, v40
v_add_f32 v33, v33, v41
v_add_f32 v34, v34, v42
v_add_f32 v35, v35, v43
v_add_f32 v36, v36, v44
v_add_f32 v37, v37, v45
v_add_f32 v38, v38, v46
v_add_f32 v39, v39, v47
v_lshlrev_b32 v40, 16, v224
v_and_b32 v41, 0xffff0000, v224
v_lshlrev_b32 v42, 16, v225
v_and_b32 v43, 0xffff0000, v225
v_lshlrev_b32 v44, 16, v226
v_and_b32 v45, 0xffff0000, v226
v_lshlrev_b32 v46, 16, v227
v_and_b32 v47, 0xffff0000, v227
v_add_f32 v32, v32, v40
v_add_f32 v33, v33, v41
v_add_f32 v34, v34, v42
v_add_f32 v35, v35, v43
v_add_f32 v36, v36, v44
v_add_f32 v37, v37, v45
v_add_f32 v38, v38, v46
v_add_f32 v39, v39, v47
v_lshlrev_b32 v40, 16, v228
v_and_b32 v41, 0xffff0000, v228
v_lshlrev_b32 v42, 16, v229
v_and_b32 v43, 0xffff0000, v229
v_lshlrev_b32 v44, 16, v230
v_and_b32 v45, 0xffff0000, v230
v_lshlrev_b32 v46, 16, v231
v_and_b32 v47, 0xffff0000, v231
v_add_f32 v32, v32, v40
v_add_f32 v33, v33, v41
v_add_f32 v34, v34, v42
v_add_f32 v35, v35, v43
v_add_f32 v36, v36, v44
v_add_f32 v37, v37, v45
v_add_f32 v38, v38, v46
v_add_f32 v39, v39, v47
v_lshlrev_b32 v40, 16, v232
v_and_b32 v41, 0xffff0000, v232
v_lshlrev_b32 v42, 16, v233
v_and_b32 v43, 0xffff0000, v233
v_lshlrev_b32 v44, 16, v234
v_and_b32 v45, 0xffff0000, v234
v_lshlrev_b32 v46, 16, v235
v_and_b32 v47, 0xffff0000, v235
v_add_f32 v32, v32, v40
v_add_f32 v33, v33, v41
v_add_f32 v34, v34, v42
v_add_f32 v35, v35, v43
v_add_f32 v36, v36, v44
v_add_f32 v37, v37, v45
v_add_f32 v38, v38, v46
v_add_f32 v39, v39, v47
v_lshlrev_b32 v40, 16, v236
v_and_b32 v41, 0xffff0000, v236
v_lshlrev_b32 v42, 16, v237
v_and_b32 v43, 0xffff0000, v237
v_lshlrev_b32 v44, 16, v238
v_and_b32 v45, 0xffff0000, v238
v_lshlrev_b32 v46, 16, v239
v_and_b32 v47, 0xffff0000, v239
v_add_f32 v32, v32, v40
v_add_f32 v33, v33, v41
v_add_f32 v34, v34, v42
v_add_f32 v35, v35, v43
v_add_f32 v36, v36, v44
v_add_f32 v37, v37, v45
v_add_f32 v38, v38, v46
v_add_f32 v39, v39, v47
v_lshlrev_b32 v40, 16, v240
v_and_b32 v41, 0xffff0000, v240
v_lshlrev_b32 v42, 16, v241
v_and_b32 v43, 0xffff0000, v241
v_lshlrev_b32 v44, 16, v242
v_and_b32 v45, 0xffff0000, v242
v_lshlrev_b32 v46, 16, v243
v_and_b32 v47, 0xffff0000, v243
v_add_f32 v32, v32, v40
v_add_f32 v33, v33, v41
v_add_f32 v34, v34, v42
v_add_f32 v35, v35, v43
v_add_f32 v36, v36, v44
v_add_f32 v37, v37, v45
v_add_f32 v38, v38, v46
v_add_f32 v39, v39, v47
v_lshlrev_b32 v40, 16, v244
v_and_b32 v41, 0xffff0000, v244
v_lshlrev_b32 v42, 16, v245
v_and_b32 v43, 0xffff0000, v245
v_lshlrev_b32 v44, 16, v246
v_and_b32 v45, 0xffff0000, v246
v_lshlrev_b32 v46, 16, v247
v_and_b32 v47, 0xffff0000, v247
v_add_f32 v32, v32, v40
v_add_f32 v33, v33, v41
v_add_f32 v34, v34, v42
v_add_f32 v35, v35, v43
v_add_f32 v36, v36, v44
v_add_f32 v37, v37, v45
v_add_f32 v38, v38, v46
v_add_f32 v39, v39, v47
v_lshlrev_b32 v40, 16, v248
v_and_b32 v41, 0xffff0000, v248
v_lshlrev_b32 v42, 16, v249
v_and_b32 v43, 0xffff0000, v249
v_lshlrev_b32 v44, 16, v250
v_and_b32 v45, 0xffff0000, v250
v_lshlrev_b32 v46, 16, v251
v_and_b32 v47, 0xffff0000, v251
v_add_f32 v32, v32, v40
v_add_f32 v33, v33, v41
v_add_f32 v34, v34, v42
v_add_f32 v35, v35, v43
v_add_f32 v36, v36, v44
v_add_f32 v37, v37, v45
v_add_f32 v38, v38, v46
v_add_f32 v39, v39, v47
v_lshlrev_b32 v40, 16, v252
v_and_b32 v41, 0xffff0000, v252
v_lshlrev_b32 v42, 16, v253
v_and_b32 v43, 0xffff0000, v253
v_lshlrev_b32 v44, 16, v254
v_and_b32 v45, 0xffff0000, v254
v_lshlrev_b32 v46, 16, v255
v_and_b32 v47, 0xffff0000, v255
v_add_f32 v32, v32, v40
v_add_f32 v33, v33, v41
v_add_f32 v34, v34, v42
v_add_f32 v35, v35, v43
v_add_f32 v36, v36, v44
v_add_f32 v37, v37, v45
v_add_f32 v38, v38, v46
v_add_f32 v39, v39, v47
v_mov_b32 v40, v32
v_mov_b32 v41, v33
v_mov_b32 v42, v34
v_mov_b32 v43, v35
v_mov_b32 v44, v36
v_mov_b32 v45, v37
v_mov_b32 v46, v38
v_mov_b32 v47, v39
s_nop 0
v_permlane16_swap_b32 v32, v40
v_permlane16_swap_b32 v33, v41
v_permlane16_swap_b32 v34, v42
v_permlane16_swap_b32 v35, v43
v_permlane16_swap_b32 v36, v44
v_permlane16_swap_b32 v37, v45
v_permlane16_swap_b32 v38, v46
v_permlane16_swap_b32 v39, v47
v_add_f32 v32, v32, v40
v_add_f32 v33, v33, v41
v_add_f32 v34, v34, v42
v_add_f32 v35, v35, v43
v_add_f32 v36, v36, v44
v_add_f32 v37, v37, v45
v_add_f32 v38, v38, v46
v_add_f32 v39, v39, v47
v_mov_b32 v40, v32
v_mov_b32 v41, v33
v_mov_b32 v42, v34
v_mov_b32 v43, v35
v_mov_b32 v44, v36
v_mov_b32 v45, v37
v_mov_b32 v46, v38
v_mov_b32 v47, v39
s_nop 0
v_permlane32_swap_b32 v32, v40
v_permlane32_swap_b32 v33, v41
v_permlane32_swap_b32 v34, v42
v_permlane32_swap_b32 v35, v43
v_permlane32_swap_b32 v36, v44
v_permlane32_swap_b32 v37, v45
v_permlane32_swap_b32 v38, v46
v_permlane32_swap_b32 v39, v47
v_add_f32 v32, v32, v40
v_add_f32 v33, v33, v41
v_add_f32 v34, v34, v42
v_add_f32 v35, v35, v43
v_add_f32 v36, v36, v44
v_add_f32 v37, v37, v45
v_add_f32 v38, v38, v46
v_add_f32 v39, v39, v47
s_mov_b64 exec, 0xffff
buffer_store_dwordx4 v[32:35], v5, s[72:75], 0 offen sc1
buffer_store_dwordx4 v[36:39], v5, s[72:75], 0 offen offset:16 sc1
s_mov_b64 exec, -1
s_waitcnt vmcnt(0)
v_mov_b32 v12, 10240
v_mov_b32 v13, 1
s_mov_b64 exec, 1
buffer_atomic_add v13, v12, s[56:59], 0 offen sc1
s_mov_b64 exec, -1
s_branch Lcsd_37
Lnojob_36:
s_lshl_b32 s43, s34, 18
s_add_u32 s12, s32, s43
s_addc_u32 s13, s33, 0
s_mov_b32 s14, 262144
s_mov_b32 s15, 0x20000
v_lshlrev_b32 v21, 4, v1
s_lshl_b32 s54, s36, 11
s_barrier
s_add_u32 m0, s54, 0
s_add_u32 s43, s54, 0
buffer_load_dwordx4 v21, s[12:15], s43 offen sc1 lds
s_add_u32 m0, s54, 1024
s_add_u32 s43, s54, 1024
buffer_load_dwordx4 v21, s[12:15], s43 offen sc1 lds
s_add_u32 m0, s54, 24576
s_add_u32 s43, s54, 16384
buffer_load_dwordx4 v21, s[12:15], s43 offen sc1 lds
s_add_u32 m0, s54, 25600
s_add_u32 s43, s54, 17408
buffer_load_dwordx4 v21, s[12:15], s43 offen sc1 lds
s_waitcnt vmcnt(2)
s_barrier
s_waitcnt vmcnt(0)
s_barrier
s_barrier
s_barrier
s_barrier
s_barrier
s_barrier
s_barrier
s_barrier
s_barrier
s_barrier
s_barrier
s_barrier
s_barrier
s_barrier
s_barrier
s_barrier
s_barrier
s_mul_i32 s43, s2, 28672
s_add_u32 s76, s60, s43
s_addc_u32 s77, s61, 0
s_mov_b32 s78, 28672
s_mov_b32 s79, 0x20000
v_lshlrev_b32 v19, 7, v1
s_mov_b32 s43, 0
buffer_load_dword v30, v19, s[76:79], s43 offen
s_mov_b32 s43, 8192
buffer_load_dword v30, v19, s[76:79], s43 offen
s_mov_b32 s43, 16384
buffer_load_dword v30, v19, s[76:79], s43 offen
s_mov_b32 s43, 24576
buffer_load_dword v30, v19, s[76:79], s43 offen
Lcsd_37:
s_mov_b32 s46, 1
s_lshl_b32 s43, s34, 18
s_add_u32 s12, s32, s43
s_addc_u32 s13, s33, 0
s_add_u32 s12, s12, 4194304
s_addc_u32 s13, s13, 0
s_mov_b32 s14, 262144
s_mov_b32 s15, 0x20000
v_lshlrev_b32 v21, 4, v1
s_lshl_b32 s54, s36, 11
s_lshl_b32 s43, s34, 14
s_add_u32 s64, s32, s43
s_addc_u32 s65, s33, 0
s_add_u32 s64, s64, 25165824
s_addc_u32 s65, s65, 0
s_mov_b32 s66, 16384
s_mov_b32 s67, 0x20000
s_add_u32 s72, s32, 27262976
s_addc_u32 s73, s33, 0
s_mov_b32 s74, 114688
s_mov_b32 s75, 0x20000
s_barrier
s_add_u32 m0, s54, 98304
s_add_u32 s43, s54, 0
buffer_load_dwordx4 v21, s[12:15], s43 offen sc1 lds
s_add_u32 m0, s54, 99328
s_add_u32 s43, s54, 1024
buffer_load_dwordx4 v21, s[12:15], s43 offen sc1 lds
s_add_u32 m0, s54, 0
s_add_u32 s43, s54, 16384
buffer_load_dwordx4 v21, s[12:15], s43 offen sc1 lds
s_add_u32 m0, s54, 1024
s_add_u32 s43, s54, 17408
buffer_load_dwordx4 v21, s[12:15], s43 offen sc1 lds
s_add_u32 m0, s54, 49152
s_add_u32 s43, s54, 32768
buffer_load_dwordx4 v21, s[12:15], s43 offen sc1 lds
s_add_u32 m0, s54, 50176
s_add_u32 s43, s54, 33792
buffer_load_dwordx4 v21, s[12:15], s43 offen sc1 lds
s_waitcnt vmcnt(4)
s_barrier
s_waitcnt vmcnt(2)
s_barrier
s_waitcnt vmcnt(0)
s_barrier
s_mov_b32 s43, 0
buffer_load_dwordx4 v[128:131], v21, s[64:67], s43 offen sc1
s_mov_b32 s43, 1024
buffer_load_dwordx4 v[132:135], v21, s[64:67], s43 offen sc1
s_mov_b32 s43, 2048
buffer_load_dwordx4 v[136:139], v21, s[64:67], s43 offen sc1
s_mov_b32 s43, 3072
buffer_load_dwordx4 v[140:143], v21, s[64:67], s43 offen sc1
s_mov_b32 s43, 4096
buffer_load_dwordx4 v[144:147], v21, s[64:67], s43 offen sc1
s_mov_b32 s43, 5120
buffer_load_dwordx4 v[148:151], v21, s[64:67], s43 offen sc1
s_mov_b32 s43, 6144
buffer_load_dwordx4 v[152:155], v21, s[64:67], s43 offen sc1
s_mov_b32 s43, 7168
buffer_load_dwordx4 v[156:159], v21, s[64:67], s43 offen sc1
s_mov_b32 s43, 8192
buffer_load_dwordx4 v[160:163], v21, s[64:67], s43 offen sc1
s_mov_b32 s43, 9216
buffer_load_dwordx4 v[164:167], v21, s[64:67], s43 offen sc1
s_mov_b32 s43, 10240
buffer_load_dwordx4 v[168:171], v21, s[64:67], s43 offen sc1
s_mov_b32 s43, 11264
buffer_load_dwordx4 v[172:175], v21, s[64:67], s43 offen sc1
s_mov_b32 s43, 12288
buffer_load_dwordx4 v[176:179], v21, s[64:67], s43 offen sc1
s_mov_b32 s43, 13312
buffer_load_dwordx4 v[180:183], v21, s[64:67], s43 offen sc1
s_mov_b32 s43, 14336
buffer_load_dwordx4 v[184:187], v21, s[64:67], s43 offen sc1
s_mov_b32 s43, 15360
buffer_load_dwordx4 v[188:191], v21, s[64:67], s43 offen sc1
s_barrier
v_mov_b32 v12, 10240
v_mov_b32 v14, 224
buffer_load_dword v13, v12, s[56:59], 0 offen sc1
s_barrier
s_barrier
s_mov_b32 s41, 0x10000
Lpoll_38:
s_waitcnt vmcnt(0)
v_cmp_ne_u32 vcc, v14, v13
s_nop 4
s_cbranch_vccz Lpok_39
buffer_load_dword v13, v12, s[56:59], 0 offen sc1
s_sub_u32 s41, s41, 1
s_cmp_lg_u32 s41, 0
s_cbranch_scc1 Lpoll_38
s_waitcnt vmcnt(0)
Lpok_39:
v_min_u32 v12, 55, v1
v_lshlrev_b32 v13, 4, v12
s_lshl_b32 s43, s35, 9
s_mul_i32 s44, s35, 384
s_add_u32 s44, s44, 7680
v_mov_b32 v14, s44
v_mov_b32 v15, s43
v_cmp_gt_u32 vcc, 32, v12
s_nop 1
v_cndmask_b32 v14, v14, v15, vcc
v_add_u32 v14, v14, v13
v_add_u32 v13, 148480, v13
s_mov_b32 s43, 0
buffer_load_dwordx4 v[192:195], v14, s[72:75], s43 offen sc1
s_mov_b32 s43, 28672
buffer_load_dwordx4 v[196:199], v14, s[72:75], s43 offen sc1
s_mov_b32 s43, 57344
buffer_load_dwordx4 v[200:203], v14, s[72:75], s43 offen sc1
s_mov_b32 s43, 86016
buffer_load_dwordx4 v[204:207], v14, s[72:75], s43 offen sc1
s_mov_b32 s43, 14336
buffer_load_dwordx4 v[208:211], v14, s[72:75], s43 offen sc1
s_mov_b32 s43, 43008
buffer_load_dwordx4 v[212:215], v14, s[72:75], s43 offen sc1
s_mov_b32 s43, 71680
buffer_load_dwordx4 v[216:219], v14, s[72:75], s43 offen sc1
s_mov_b32 s43, 100352
buffer_load_dwordx4 v[220:223], v14, s[72:75], s43 offen sc1
s_barrier
v_add_f32 v128, v128, v132
v_add_f32 v129, v129, v133
v_add_f32 v130, v130, v134
v_add_f32 v131, v131, v135
v_add_f32 v128, v128, v136
v_add_f32 v129, v129, v137
v_add_f32 v130, v130, v138
v_add_f32 v131, v131, v139
v_add_f32 v128, v128, v140
v_add_f32 v129, v129, v141
v_add_f32 v130, v130, v142
v_add_f32 v131, v131, v143
v_add_f32 v128, v128, v144
v_add_f32 v129, v129, v145
v_add_f32 v130, v130, v146
v_add_f32 v131, v131, v147
v_add_f32 v128, v128, v148
v_add_f32 v129, v129, v149
v_add_f32 v130, v130, v150
v_add_f32 v131, v131, v151
v_add_f32 v128, v128, v152
v_add_f32 v129, v129, v153
v_add_f32 v130, v130, v154
v_add_f32 v131, v131, v155
v_add_f32 v128, v128, v156
v_add_f32 v129, v129, v157
v_add_f32 v130, v130, v158
v_add_f32 v131, v131, v159
v_add_f32 v128, v128, v160
v_add_f32 v129, v129, v161
v_add_f32 v130, v130, v162
v_add_f32 v131, v131, v163
v_add_f32 v128, v128, v164
v_add_f32 v129, v129, v165
v_add_f32 v130, v130, v166
v_add_f32 v131, v131, v167
v_add_f32 v128, v128, v168
v_add_f32 v129, v129, v169
v_add_f32 v130, v130, v170
v_add_f32 v131, v131, v171
v_add_f32 v128, v128, v172
v_add_f32 v129, v129, v173
v_add_f32 v130, v130, v174
v_add_f32 v131, v131, v175
v_add_f32 v128, v128, v176
v_add_f32 v129, v129, v177
v_add_f32 v130, v130, v178
v_add_f32 v131, v131, v179
v_add_f32 v128, v128, v180
v_add_f32 v129, v129, v181
v_add_f32 v130, v130, v182
v_add_f32 v131, v131, v183
v_add_f32 v128, v128, v184
v_add_f32 v129, v129, v185
v_add_f32 v130, v130, v186
v_add_f32 v131, v131, v187
v_add_f32 v128, v128, v188
v_add_f32 v129, v129, v189
v_add_f32 v130, v130, v190
v_add_f32 v131, v131, v191
v_mul_f32 v128, 0x3a800000, v128
v_mul_f32 v129, 0x3a800000, v129
v_fma_f32 v129, -v128, v128, v129
v_max_f32 v129, 0, v129
v_add_f32 v129, 0x3727c5ac, v129
v_rsq_f32 v129, v129
v_mul_f32 v130, 0x3a800000, v130
v_mul_f32 v131, 0x3a800000, v131
v_fma_f32 v131, -v130, v130, v131
v_max_f32 v131, 0, v131
v_add_f32 v131, 0x3727c5ac, v131
v_rsq_f32 v131, v131
v_add_u32 v19, 147456, v21
ds_write_b128 v19, v[128:131]
s_barrier
s_barrier
s_waitcnt vmcnt(0)
v_add_f32 v192, v192, v196
v_add_f32 v200, v200, v204
v_add_f32 v193, v193, v197
v_add_f32 v201, v201, v205
v_add_f32 v194, v194, v198
v_add_f32 v202, v202, v206
v_add_f32 v195, v195, v199
v_add_f32 v203, v203, v207
v_add_f32 v192, v192, v200
v_add_f32 v193, v193, v201
v_add_f32 v194, v194, v202
v_add_f32 v195, v195, v203
ds_write_b128 v13, v[192:195] offset:0
v_add_f32 v208, v208, v212
v_add_f32 v216, v216, v220
v_add_f32 v209, v209, v213
v_add_f32 v217, v217, v221
v_add_f32 v210, v210, v214
v_add_f32 v218, v218, v222
v_add_f32 v211, v211, v215
v_add_f32 v219, v219, v223
v_add_f32 v208, v208, v216
v_add_f32 v209, v209, v217
v_add_f32 v210, v210, v218
v_add_f32 v211, v211, v219
ds_write_b128 v13, v[208:211] offset:896
s_waitcnt lgkmcnt(0)
s_barrier
s_barrier
s_and_b32 s53, s35, 1
s_lshl_b32 s53, s53, 1
s_mul_i32 s43, s47, 3
s_add_u32 s53, s53, s43
v_lshlrev_b32 v19, 11, v18
v_lshl_add_u32 v19, v17, 4, v19
s_lshl_b32 s43, s46, 10
v_add_u32 v2, s43, v19
v_add_u32 v3, 49152, v2
v_add_u32 v4, 98304, v2
v_lshrrev_b32 v19, 2, v17
v_lshl_add_u32 v20, v18, 2, v19
v_and_b32 v21, 7, v20
v_lshlrev_b32 v20, 8, v20
v_and_b32 v19, 3, v1
v_lshl_add_u32 v20, v19, 3, v20
s_add_u32 s43, s53, 0
v_xor_b32 v19, s43, v21
v_lshl_add_u32 v5, v19, 5, v20
s_add_u32 s43, s53, 1
v_xor_b32 v19, s43, v21
v_lshl_add_u32 v6, v19, 5, v20
s_add_u32 s43, s53, 2
v_xor_b32 v19, s43, v21
v_lshl_add_u32 v7, v19, 5, v20
v_add_u32 v9, 49152, v5
v_add_u32 v10, 49152, v6
v_add_u32 v11, 49152, v7
v_add_u32 v13, 98304, v5
v_add_u32 v14, 98304, v6
v_add_u32 v15, 98304, v7
s_lshl_b32 s43, s46, 9
s_add_u32 s43, s43, 147456
v_lshl_add_u32 v19, v17, 3, s43
ds_read_b64 v[80:81], v19 offset:0
ds_read_b64 v[82:83], v19 offset:128
ds_read_b64 v[84:85], v19 offset:256
ds_read_b64 v[86:87], v19 offset:384
s_mul_i32 s43, s47, 192
s_add_u32 s43, s43, 148992
v_lshl_add_u32 v19, v18, 4, s43
ds_read_b128 v[48:51], v19 offset:0
ds_read_b128 v[52:55], v19 offset:64
ds_read_b128 v[56:59], v19 offset:128
ds_read_b128 v[60:63], v19 offset:896
ds_read_b128 v[64:67], v19 offset:960
ds_read_b128 v[68:71], v19 offset:1024
s_barrier
s_waitcnt lgkmcnt(0)
v_mul_f32 v88, v81, v81
v_mul_f32 v228, 0xc0135761, v81
v_mul_f32 v89, 0xbdd2d3e8, v81
v_rcp_f32 v236, v88
v_mul_f32 v232, v89, v88
v_mul_f32 v88, v83, v83
v_mul_f32 v229, 0xc0135761, v83
v_mul_f32 v89, 0xbdd2d3e8, v83
v_rcp_f32 v237, v88
v_mul_f32 v233, v89, v88
v_mul_f32 v88, v85, v85
v_mul_f32 v230, 0xc0135761, v85
v_mul_f32 v89, 0xbdd2d3e8, v85
v_rcp_f32 v238, v88
v_mul_f32 v234, v89, v88
v_mul_f32 v88, v87, v87
v_mul_f32 v231, 0xc0135761, v87
v_mul_f32 v89, 0xbdd2d3e8, v87
v_rcp_f32 v239, v88
v_mul_f32 v235, v89, v88
s_mul_i32 s43, s34, 917504
s_mul_i32 s44, s35, 24576
s_add_u32 s43, s43, s44
s_add_u32 s43, s43, 8912896
s_add_u32 s24, s32, s43
s_addc_u32 s25, s33, 0
s_mov_b32 s26, 24576
s_mov_b32 s27, 0x20000
s_mov_b32 s53, 262144
s_lshl_b32 s43, s47, 13
s_lshl_b32 s44, s46, 10
s_add_u32 s43, s43, s44
v_lshlrev_b32 v19, 11, v18
v_lshl_add_u32 v19, v17, 4, v19
v_add_u32 v27, s43, v19
s_lshl_b32 s43, s47, 12
s_add_u32 s43, s43, s44
s_add_u32 s43, s43, 16384
v_and_b32 v19, 1, v18
v_lshlrev_b32 v19, 11, v19
v_lshrrev_b32 v20, 1, v18
v_lshl_add_u32 v19, v20, 8, v19
v_lshl_add_u32 v19, v17, 4, v19
v_add_u32 v28, s43, v19
s_barrier
v_mul_f32 v128, -v80, v48
v_mul_f32 v129, -v80, v49
v_mul_f32 v130, -v80, v50
v_mul_f32 v131, -v80, v51
v_mul_f32 v132, -v82, v48
v_mul_f32 v133, -v82, v49
v_mul_f32 v134, -v82, v50
v_mul_f32 v135, -v82, v51
v_mul_f32 v136, -v84, v48
v_mul_f32 v137, -v84, v49
v_mul_f32 v138, -v84, v50
v_mul_f32 v139, -v84, v51
v_mul_f32 v140, -v86, v48
v_mul_f32 v141, -v86, v49
v_mul_f32 v142, -v86, v50
v_mul_f32 v143, -v86, v51
v_mul_f32 v144, -v80, v52
v_mul_f32 v145, -v80, v53
v_mul_f32 v146, -v80, v54
v_mul_f32 v147, -v80, v55
v_mul_f32 v148, -v82, v52
v_mul_f32 v149, -v82, v53
v_mul_f32 v150, -v82, v54
v_mul_f32 v151, -v82, v55
v_mul_f32 v152, -v84, v52
v_mul_f32 v153, -v84, v53
v_mul_f32 v154, -v84, v54
v_mul_f32 v155, -v84, v55
v_mul_f32 v156, -v86, v52
v_mul_f32 v157, -v86, v53
v_mul_f32 v158, -v86, v54
v_mul_f32 v159, -v86, v55
s_barrier
v_mul_f32 v160, -v80, v56
v_mul_f32 v161, -v80, v57
v_mul_f32 v162, -v80, v58
v_mul_f32 v163, -v80, v59
v_mul_f32 v164, -v82, v56
v_mul_f32 v165, -v82, v57
v_mul_f32 v166, -v82, v58
v_mul_f32 v167, -v82, v59
v_mul_f32 v168, -v84, v56
v_mul_f32 v169, -v84, v57
v_mul_f32 v170, -v84, v58
v_mul_f32 v171, -v84, v59
v_mul_f32 v172, -v86, v56
v_mul_f32 v173, -v86, v57
v_mul_f32 v174, -v86, v58
v_mul_f32 v175, -v86, v59
v_mul_f32 v176, -v80, v60
v_mul_f32 v177, -v80, v61
v_mul_f32 v178, -v80, v62
v_mul_f32 v179, -v80, v63
v_mul_f32 v180, -v82, v60
v_mul_f32 v181, -v82, v61
v_mul_f32 v182, -v82, v62
v_mul_f32 v183, -v82, v63
v_mul_f32 v184, -v84, v60
v_mul_f32 v185, -v84, v61
v_mul_f32 v186, -v84, v62
v_mul_f32 v187, -v84, v63
v_mul_f32 v188, -v86, v60
v_mul_f32 v189, -v86, v61
v_mul_f32 v190, -v86, v62
v_mul_f32 v191, -v86, v63
s_barrier
v_mul_f32 v192, -v80, v64
v_mul_f32 v193, -v80, v65
v_mul_f32 v194, -v80, v66
v_mul_f32 v195, -v80, v67
v_mul_f32 v196, -v82, v64
v_mul_f32 v197, -v82, v65
v_mul_f32 v198, -v82, v66
v_mul_f32 v199, -v82, v67
v_mul_f32 v200, -v84, v64
v_mul_f32 v201, -v84, v65
v_mul_f32 v202, -v84, v66
v_mul_f32 v203, -v84, v67
v_mul_f32 v204, -v86, v64
v_mul_f32 v205, -v86, v65
v_mul_f32 v206, -v86, v66
v_mul_f32 v207, -v86, v67
v_mul_f32 v208, -v80, v68
v_mul_f32 v209, -v80, v69
v_mul_f32 v210, -v80, v70
v_mul_f32 v211, -v80, v71
v_mul_f32 v212, -v82, v68
v_mul_f32 v213, -v82, v69
v_mul_f32 v214, -v82, v70
v_mul_f32 v215, -v82, v71
v_mul_f32 v216, -v84, v68
v_mul_f32 v217, -v84, v69
v_mul_f32 v218, -v84, v70
v_mul_f32 v219, -v84, v71
v_mul_f32 v220, -v86, v68
v_mul_f32 v221, -v86, v69
v_mul_f32 v222, -v86, v70
v_mul_f32 v223, -v86, v71
s_barrier
s_barrier
LK3b_26:
s_setprio 1
ds_read_b128 v[32:35], v2 offset:0
ds_read_b64_tr_b16 v[48:49], v5 offset:16384
ds_read_b64_tr_b16 v[50:51], v5 offset:20480
ds_read_b128 v[36:39], v2 offset:256
ds_read_b128 v[40:43], v2 offset:512
ds_read_b128 v[44:47], v2 offset:768
ds_read_b64_tr_b16 v[60:61], v5 offset:32768
ds_read_b64_tr_b16 v[62:63], v5 offset:36864
ds_read_b64_tr_b16 v[52:53], v6 offset:16384
ds_read_b64_tr_b16 v[54:55], v6 offset:20480
ds_read_b64_tr_b16 v[64:65], v6 offset:32768
ds_read_b64_tr_b16 v[66:67], v6 offset:36864
ds_read_b64_tr_b16 v[56:57], v7 offset:16384
ds_read_b64_tr_b16 v[58:59], v7 offset:20480
ds_read_b64_tr_b16 v[68:69], v7 offset:32768
ds_read_b64_tr_b16 v[70:71], v7 offset:36864
s_mov_b32 s41, 5
Lk3_40:
s_waitcnt lgkmcnt(0)
v_mfma_f32_16x16x32_bf16 v[128:131], v[48:51], v[32:35], v[128:131]
ds_read_b128 v[80:83], v2 offset:8192
v_mfma_f32_16x16x32_bf16 v[132:135], v[48:51], v[36:39], v[132:135]
ds_read_b64_tr_b16 v[96:97], v5 offset:24576
v_mfma_f32_16x16x32_bf16 v[136:139], v[48:51], v[40:43], v[136:139]
ds_read_b64_tr_b16 v[98:99], v5 offset:28672
v_mfma_f32_16x16x32_bf16 v[140:143], v[48:51], v[44:47], v[140:143]
ds_read_b128 v[84:87], v2 offset:8448
v_mfma_f32_16x16x32_bf16 v[176:179], v[60:63], v[32:35], v[176:179]
ds_read_b128 v[88:91], v2 offset:8704
v_mfma_f32_16x16x32_bf16 v[180:183], v[60:63], v[36:39], v[180:183]
ds_read_b128 v[92:95], v2 offset:8960
v_mfma_f32_16x16x32_bf16 v[184:187], v[60:63], v[40:43], v[184:187]
ds_read_b64_tr_b16 v[108:109], v5 offset:40960
v_mfma_f32_16x16x32_bf16 v[188:191], v[60:63], v[44:47], v[188:191]
ds_read_b64_tr_b16 v[110:111], v5 offset:45056
v_mfma_f32_16x16x32_bf16 v[144:147], v[52:55], v[32:35], v[144:147]
ds_read_b64_tr_b16 v[100:101], v6 offset:24576
v_mfma_f32_16x16x32_bf16 v[148:151], v[52:55], v[36:39], v[148:151]
ds_read_b64_tr_b16 v[102:103], v6 offset:28672
v_mfma_f32_16x16x32_bf16 v[152:155], v[52:55], v[40:43], v[152:155]
ds_read_b64_tr_b16 v[112:113], v6 offset:40960
v_mfma_f32_16x16x32_bf16 v[156:159], v[52:55], v[44:47], v[156:159]
ds_read_b64_tr_b16 v[114:115], v6 offset:45056
v_mfma_f32_16x16x32_bf16 v[192:195], v[64:67], v[32:35], v[192:195]
ds_read_b64_tr_b16 v[104:105], v7 offset:24576
v_mfma_f32_16x16x32_bf16 v[196:199], v[64:67], v[36:39], v[196:199]
ds_read_b64_tr_b16 v[106:107], v7 offset:28672
v_mfma_f32_16x16x32_bf16 v[200:203], v[64:67], v[40:43], v[200:203]
ds_read_b64_tr_b16 v[116:117], v7 offset:40960
v_mfma_f32_16x16x32_bf16 v[204:207], v[64:67], v[44:47], v[204:207]
ds_read_b64_tr_b16 v[118:119], v7 offset:45056
v_mfma_f32_16x16x32_bf16 v[160:163], v[56:59], v[32:35], v[160:163]
v_mfma_f32_16x16x32_bf16 v[164:167], v[56:59], v[36:39], v[164:167]
v_mfma_f32_16x16x32_bf16 v[168:171], v[56:59], v[40:43], v[168:171]
v_mfma_f32_16x16x32_bf16 v[172:175], v[56:59], v[44:47], v[172:175]
v_mfma_f32_16x16x32_bf16 v[208:211], v[68:71], v[32:35], v[208:211]
v_mfma_f32_16x16x32_bf16 v[212:215], v[68:71], v[36:39], v[212:215]
v_mfma_f32_16x16x32_bf16 v[216:219], v[68:71], v[40:43], v[216:219]
v_mfma_f32_16x16x32_bf16 v[220:223], v[68:71], v[44:47], v[220:223]
s_waitcnt vmcnt(0) lgkmcnt(0)
s_barrier
v_mfma_f32_16x16x32_bf16 v[128:131], v[96:99], v[80:83], v[128:131]
ds_read_b128 v[32:35], v3 offset:0
v_mfma_f32_16x16x32_bf16 v[132:135], v[96:99], v[84:87], v[132:135]
ds_read_b64_tr_b16 v[48:49], v9 offset:16384
v_mfma_f32_16x16x32_bf16 v[136:139], v[96:99], v[88:91], v[136:139]
ds_read_b64_tr_b16 v[50:51], v9 offset:20480
v_mfma_f32_16x16x32_bf16 v[140:143], v[96:99], v[92:95], v[140:143]
ds_read_b128 v[36:39], v3 offset:256
v_mfma_f32_16x16x32_bf16 v[176:179], v[108:111], v[80:83], v[176:179]
ds_read_b128 v[40:43], v3 offset:512
v_mfma_f32_16x16x32_bf16 v[180:183], v[108:111], v[84:87], v[180:183]
ds_read_b128 v[44:47], v3 offset:768
v_mfma_f32_16x16x32_bf16 v[184:187], v[108:111], v[88:91], v[184:187]
ds_read_b64_tr_b16 v[60:61], v9 offset:32768
v_mfma_f32_16x16x32_bf16 v[188:191], v[108:111], v[92:95], v[188:191]
ds_read_b64_tr_b16 v[62:63], v9 offset:36864
v_mfma_f32_16x16x32_bf16 v[144:147], v[100:103], v[80:83], v[144:147]
ds_read_b64_tr_b16 v[52:53], v10 offset:16384
v_mfma_f32_16x16x32_bf16 v[148:151], v[100:103], v[84:87], v[148:151]
ds_read_b64_tr_b16 v[54:55], v10 offset:20480
v_mfma_f32_16x16x32_bf16 v[152:155], v[100:103], v[88:91], v[152:155]
ds_read_b64_tr_b16 v[64:65], v10 offset:32768
v_mfma_f32_16x16x32_bf16 v[156:159], v[100:103], v[92:95], v[156:159]
ds_read_b64_tr_b16 v[66:67], v10 offset:36864
v_mfma_f32_16x16x32_bf16 v[192:195], v[112:115], v[80:83], v[192:195]
ds_read_b64_tr_b16 v[56:57], v11 offset:16384
v_mfma_f32_16x16x32_bf16 v[196:199], v[112:115], v[84:87], v[196:199]
ds_read_b64_tr_b16 v[58:59], v11 offset:20480
v_mfma_f32_16x16x32_bf16 v[200:203], v[112:115], v[88:91], v[200:203]
ds_read_b64_tr_b16 v[68:69], v11 offset:32768
v_mfma_f32_16x16x32_bf16 v[204:207], v[112:115], v[92:95], v[204:207]
ds_read_b64_tr_b16 v[70:71], v11 offset:36864
v_mfma_f32_16x16x32_bf16 v[160:163], v[104:107], v[80:83], v[160:163]
v_mfma_f32_16x16x32_bf16 v[164:167], v[104:107], v[84:87], v[164:167]
v_mfma_f32_16x16x32_bf16 v[168:171], v[104:107], v[88:91], v[168:171]
v_mfma_f32_16x16x32_bf16 v[172:175], v[104:107], v[92:95], v[172:175]
v_mfma_f32_16x16x32_bf16 v[208:211], v[116:119], v[80:83], v[208:211]
v_mfma_f32_16x16x32_bf16 v[212:215], v[116:119], v[84:87], v[212:215]
v_mfma_f32_16x16x32_bf16 v[216:219], v[116:119], v[88:91], v[216:219]
v_mfma_f32_16x16x32_bf16 v[220:223], v[116:119], v[92:95], v[220:223]
s_waitcnt lgkmcnt(0)
v_mfma_f32_16x16x32_bf16 v[128:131], v[48:51], v[32:35], v[128:131]
ds_read_b128 v[80:83], v3 offset:8192
v_mfma_f32_16x16x32_bf16 v[132:135], v[48:51], v[36:39], v[132:135]
ds_read_b64_tr_b16 v[96:97], v9 offset:24576
v_mfma_f32_16x16x32_bf16 v[136:139], v[48:51], v[40:43], v[136:139]
ds_read_b64_tr_b16 v[98:99], v9 offset:28672
v_mfma_f32_16x16x32_bf16 v[140:143], v[48:51], v[44:47], v[140:143]
ds_read_b128 v[84:87], v3 offset:8448
v_mfma_f32_16x16x32_bf16 v[176:179], v[60:63], v[32:35], v[176:179]
ds_read_b128 v[88:91], v3 offset:8704
v_mfma_f32_16x16x32_bf16 v[180:183], v[60:63], v[36:39], v[180:183]
ds_read_b128 v[92:95], v3 offset:8960
v_mfma_f32_16x16x32_bf16 v[184:187], v[60:63], v[40:43], v[184:187]
ds_read_b64_tr_b16 v[108:109], v9 offset:40960
v_mfma_f32_16x16x32_bf16 v[188:191], v[60:63], v[44:47], v[188:191]
ds_read_b64_tr_b16 v[110:111], v9 offset:45056
v_mfma_f32_16x16x32_bf16 v[144:147], v[52:55], v[32:35], v[144:147]
ds_read_b64_tr_b16 v[100:101], v10 offset:24576
v_mfma_f32_16x16x32_bf16 v[148:151], v[52:55], v[36:39], v[148:151]
ds_read_b64_tr_b16 v[102:103], v10 offset:28672
v_mfma_f32_16x16x32_bf16 v[152:155], v[52:55], v[40:43], v[152:155]
ds_read_b64_tr_b16 v[112:113], v10 offset:40960
v_mfma_f32_16x16x32_bf16 v[156:159], v[52:55], v[44:47], v[156:159]
ds_read_b64_tr_b16 v[114:115], v10 offset:45056
v_mfma_f32_16x16x32_bf16 v[192:195], v[64:67], v[32:35], v[192:195]
ds_read_b64_tr_b16 v[104:105], v11 offset:24576
v_mfma_f32_16x16x32_bf16 v[196:199], v[64:67], v[36:39], v[196:199]
ds_read_b64_tr_b16 v[106:107], v11 offset:28672
v_mfma_f32_16x16x32_bf16 v[200:203], v[64:67], v[40:43], v[200:203]
ds_read_b64_tr_b16 v[116:117], v11 offset:40960
v_mfma_f32_16x16x32_bf16 v[204:207], v[64:67], v[44:47], v[204:207]
ds_read_b64_tr_b16 v[118:119], v11 offset:45056
v_mfma_f32_16x16x32_bf16 v[160:163], v[56:59], v[32:35], v[160:163]
v_mfma_f32_16x16x32_bf16 v[164:167], v[56:59], v[36:39], v[164:167]
v_mfma_f32_16x16x32_bf16 v[168:171], v[56:59], v[40:43], v[168:171]
v_mfma_f32_16x16x32_bf16 v[172:175], v[56:59], v[44:47], v[172:175]
v_mfma_f32_16x16x32_bf16 v[208:211], v[68:71], v[32:35], v[208:211]
v_mfma_f32_16x16x32_bf16 v[212:215], v[68:71], v[36:39], v[212:215]
v_mfma_f32_16x16x32_bf16 v[216:219], v[68:71], v[40:43], v[216:219]
v_mfma_f32_16x16x32_bf16 v[220:223], v[68:71], v[44:47], v[220:223]
s_waitcnt lgkmcnt(0)
s_barrier
v_mfma_f32_16x16x32_bf16 v[128:131], v[96:99], v[80:83], v[128:131]
ds_read_b128 v[32:35], v4 offset:0
v_mfma_f32_16x16x32_bf16 v[132:135], v[96:99], v[84:87], v[132:135]
ds_read_b64_tr_b16 v[48:49], v13 offset:16384
v_mfma_f32_16x16x32_bf16 v[136:139], v[96:99], v[88:91], v[136:139]
ds_read_b64_tr_b16 v[50:51], v13 offset:20480
v_mfma_f32_16x16x32_bf16 v[140:143], v[96:99], v[92:95], v[140:143]
ds_read_b128 v[36:39], v4 offset:256
v_mfma_f32_16x16x32_bf16 v[176:179], v[108:111], v[80:83], v[176:179]
ds_read_b128 v[40:43], v4 offset:512
v_mfma_f32_16x16x32_bf16 v[180:183], v[108:111], v[84:87], v[180:183]
ds_read_b128 v[44:47], v4 offset:768
v_mfma_f32_16x16x32_bf16 v[184:187], v[108:111], v[88:91], v[184:187]
ds_read_b64_tr_b16 v[60:61], v13 offset:32768
v_mfma_f32_16x16x32_bf16 v[188:191], v[108:111], v[92:95], v[188:191]
ds_read_b64_tr_b16 v[62:63], v13 offset:36864
v_mfma_f32_16x16x32_bf16 v[144:147], v[100:103], v[80:83], v[144:147]
ds_read_b64_tr_b16 v[52:53], v14 offset:16384
v_mfma_f32_16x16x32_bf16 v[148:151], v[100:103], v[84:87], v[148:151]
ds_read_b64_tr_b16 v[54:55], v14 offset:20480
v_mfma_f32_16x16x32_bf16 v[152:155], v[100:103], v[88:91], v[152:155]
ds_read_b64_tr_b16 v[64:65], v14 offset:32768
v_mfma_f32_16x16x32_bf16 v[156:159], v[100:103], v[92:95], v[156:159]
ds_read_b64_tr_b16 v[66:67], v14 offset:36864
v_mfma_f32_16x16x32_bf16 v[192:195], v[112:115], v[80:83], v[192:195]
ds_read_b64_tr_b16 v[56:57], v15 offset:16384
v_mfma_f32_16x16x32_bf16 v[196:199], v[112:115], v[84:87], v[196:199]
ds_read_b64_tr_b16 v[58:59], v15 offset:20480
v_mfma_f32_16x16x32_bf16 v[200:203], v[112:115], v[88:91], v[200:203]
ds_read_b64_tr_b16 v[68:69], v15 offset:32768
v_mfma_f32_16x16x32_bf16 v[204:207], v[112:115], v[92:95], v[204:207]
ds_read_b64_tr_b16 v[70:71], v15 offset:36864
v_mfma_f32_16x16x32_bf16 v[160:163], v[104:107], v[80:83], v[160:163]
v_mfma_f32_16x16x32_bf16 v[164:167], v[104:107], v[84:87], v[164:167]
v_mfma_f32_16x16x32_bf16 v[168:171], v[104:107], v[88:91], v[168:171]
v_mfma_f32_16x16x32_bf16 v[172:175], v[104:107], v[92:95], v[172:175]
v_mfma_f32_16x16x32_bf16 v[208:211], v[116:119], v[80:83], v[208:211]
v_mfma_f32_16x16x32_bf16 v[212:215], v[116:119], v[84:87], v[212:215]
v_mfma_f32_16x16x32_bf16 v[216:219], v[116:119], v[88:91], v[216:219]
v_mfma_f32_16x16x32_bf16 v[220:223], v[116:119], v[92:95], v[220:223]
s_waitcnt lgkmcnt(0)
v_mfma_f32_16x16x32_bf16 v[128:131], v[48:51], v[32:35], v[128:131]
ds_read_b128 v[80:83], v4 offset:8192
v_mfma_f32_16x16x32_bf16 v[132:135], v[48:51], v[36:39], v[132:135]
ds_read_b64_tr_b16 v[96:97], v13 offset:24576
v_mfma_f32_16x16x32_bf16 v[136:139], v[48:51], v[40:43], v[136:139]
ds_read_b64_tr_b16 v[98:99], v13 offset:28672
v_mfma_f32_16x16x32_bf16 v[140:143], v[48:51], v[44:47], v[140:143]
ds_read_b128 v[84:87], v4 offset:8448
v_mfma_f32_16x16x32_bf16 v[176:179], v[60:63], v[32:35], v[176:179]
ds_read_b128 v[88:91], v4 offset:8704
v_mfma_f32_16x16x32_bf16 v[180:183], v[60:63], v[36:39], v[180:183]
ds_read_b128 v[92:95], v4 offset:8960
v_mfma_f32_16x16x32_bf16 v[184:187], v[60:63], v[40:43], v[184:187]
ds_read_b64_tr_b16 v[108:109], v13 offset:40960
v_mfma_f32_16x16x32_bf16 v[188:191], v[60:63], v[44:47], v[188:191]
ds_read_b64_tr_b16 v[110:111], v13 offset:45056
v_mfma_f32_16x16x32_bf16 v[144:147], v[52:55], v[32:35], v[144:147]
ds_read_b64_tr_b16 v[100:101], v14 offset:24576
v_mfma_f32_16x16x32_bf16 v[148:151], v[52:55], v[36:39], v[148:151]
ds_read_b64_tr_b16 v[102:103], v14 offset:28672
v_mfma_f32_16x16x32_bf16 v[152:155], v[52:55], v[40:43], v[152:155]
ds_read_b64_tr_b16 v[112:113], v14 offset:40960
v_mfma_f32_16x16x32_bf16 v[156:159], v[52:55], v[44:47], v[156:159]
ds_read_b64_tr_b16 v[114:115], v14 offset:45056
v_mfma_f32_16x16x32_bf16 v[192:195], v[64:67], v[32:35], v[192:195]
ds_read_b64_tr_b16 v[104:105], v15 offset:24576
v_mfma_f32_16x16x32_bf16 v[196:199], v[64:67], v[36:39], v[196:199]
ds_read_b64_tr_b16 v[106:107], v15 offset:28672
v_mfma_f32_16x16x32_bf16 v[200:203], v[64:67], v[40:43], v[200:203]
ds_read_b64_tr_b16 v[116:117], v15 offset:40960
v_mfma_f32_16x16x32_bf16 v[204:207], v[64:67], v[44:47], v[204:207]
ds_read_b64_tr_b16 v[118:119], v15 offset:45056
v_mfma_f32_16x16x32_bf16 v[160:163], v[56:59], v[32:35], v[160:163]
v_mfma_f32_16x16x32_bf16 v[164:167], v[56:59], v[36:39], v[164:167]
v_mfma_f32_16x16x32_bf16 v[168:171], v[56:59], v[40:43], v[168:171]
v_mfma_f32_16x16x32_bf16 v[172:175], v[56:59], v[44:47], v[172:175]
v_mfma_f32_16x16x32_bf16 v[208:211], v[68:71], v[32:35], v[208:211]
v_mfma_f32_16x16x32_bf16 v[212:215], v[68:71], v[36:39], v[212:215]
v_mfma_f32_16x16x32_bf16 v[216:219], v[68:71], v[40:43], v[216:219]
v_mfma_f32_16x16x32_bf16 v[220:223], v[68:71], v[44:47], v[220:223]
s_waitcnt lgkmcnt(0)
s_barrier
v_mfma_f32_16x16x32_bf16 v[128:131], v[96:99], v[80:83], v[128:131]
ds_read_b128 v[32:35], v2 offset:0
v_mfma_f32_16x16x32_bf16 v[132:135], v[96:99], v[84:87], v[132:135]
ds_read_b64_tr_b16 v[48:49], v5 offset:16384
v_mfma_f32_16x16x32_bf16 v[136:139], v[96:99], v[88:91], v[136:139]
ds_read_b64_tr_b16 v[50:51], v5 offset:20480
v_mfma_f32_16x16x32_bf16 v[140:143], v[96:99], v[92:95], v[140:143]
ds_read_b128 v[36:39], v2 offset:256
v_mfma_f32_16x16x32_bf16 v[176:179], v[108:111], v[80:83], v[176:179]
ds_read_b128 v[40:43], v2 offset:512
v_mfma_f32_16x16x32_bf16 v[180:183], v[108:111], v[84:87], v[180:183]
ds_read_b128 v[44:47], v2 offset:768
v_mfma_f32_16x16x32_bf16 v[184:187], v[108:111], v[88:91], v[184:187]
ds_read_b64_tr_b16 v[60:61], v5 offset:32768
v_mfma_f32_16x16x32_bf16 v[188:191], v[108:111], v[92:95], v[188:191]
ds_read_b64_tr_b16 v[62:63], v5 offset:36864
v_mfma_f32_16x16x32_bf16 v[144:147], v[100:103], v[80:83], v[144:147]
ds_read_b64_tr_b16 v[52:53], v6 offset:16384
v_mfma_f32_16x16x32_bf16 v[148:151], v[100:103], v[84:87], v[148:151]
ds_read_b64_tr_b16 v[54:55], v6 offset:20480
v_mfma_f32_16x16x32_bf16 v[152:155], v[100:103], v[88:91], v[152:155]
ds_read_b64_tr_b16 v[64:65], v6 offset:32768
v_mfma_f32_16x16x32_bf16 v[156:159], v[100:103], v[92:95], v[156:159]
ds_read_b64_tr_b16 v[66:67], v6 offset:36864
v_mfma_f32_16x16x32_bf16 v[192:195], v[112:115], v[80:83], v[192:195]
ds_read_b64_tr_b16 v[56:57], v7 offset:16384
v_mfma_f32_16x16x32_bf16 v[196:199], v[112:115], v[84:87], v[196:199]
ds_read_b64_tr_b16 v[58:59], v7 offset:20480
v_mfma_f32_16x16x32_bf16 v[200:203], v[112:115], v[88:91], v[200:203]
ds_read_b64_tr_b16 v[68:69], v7 offset:32768
v_mfma_f32_16x16x32_bf16 v[204:207], v[112:115], v[92:95], v[204:207]
ds_read_b64_tr_b16 v[70:71], v7 offset:36864
v_mfma_f32_16x16x32_bf16 v[160:163], v[104:107], v[80:83], v[160:163]
v_mfma_f32_16x16x32_bf16 v[164:167], v[104:107], v[84:87], v[164:167]
v_mfma_f32_16x16x32_bf16 v[168:171], v[104:107], v[88:91], v[168:171]
v_mfma_f32_16x16x32_bf16 v[172:175], v[104:107], v[92:95], v[172:175]
v_mfma_f32_16x16x32_bf16 v[208:211], v[116:119], v[80:83], v[208:211]
v_mfma_f32_16x16x32_bf16 v[212:215], v[116:119], v[84:87], v[212:215]
v_mfma_f32_16x16x32_bf16 v[216:219], v[116:119], v[88:91], v[216:219]
v_mfma_f32_16x16x32_bf16 v[220:223], v[116:119], v[92:95], v[220:223]
s_sub_u32 s41, s41, 1
s_cmp_lg_u32 s41, 0
s_cbranch_scc1 Lk3_40
s_waitcnt lgkmcnt(0)
v_mfma_f32_16x16x32_bf16 v[128:131], v[48:51], v[32:35], v[128:131]
ds_read_b128 v[80:83], v2 offset:8192
v_mfma_f32_16x16x32_bf16 v[132:135], v[48:51], v[36:39], v[132:135]
ds_read_b64_tr_b16 v[96:97], v5 offset:24576
v_mfma_f32_16x16x32_bf16 v[136:139], v[48:51], v[40:43], v[136:139]
ds_read_b64_tr_b16 v[98:99], v5 offset:28672
v_mfma_f32_16x16x32_bf16 v[140:143], v[48:51], v[44:47], v[140:143]
ds_read_b128 v[84:87], v2 offset:8448
v_mfma_f32_16x16x32_bf16 v[176:179], v[60:63], v[32:35], v[176:179]
ds_read_b128 v[88:91], v2 offset:8704
v_mfma_f32_16x16x32_bf16 v[180:183], v[60:63], v[36:39], v[180:183]
ds_read_b128 v[92:95], v2 offset:8960
v_mfma_f32_16x16x32_bf16 v[184:187], v[60:63], v[40:43], v[184:187]
ds_read_b64_tr_b16 v[108:109], v5 offset:40960
v_mfma_f32_16x16x32_bf16 v[188:191], v[60:63], v[44:47], v[188:191]
ds_read_b64_tr_b16 v[110:111], v5 offset:45056
v_mfma_f32_16x16x32_bf16 v[144:147], v[52:55], v[32:35], v[144:147]
ds_read_b64_tr_b16 v[100:101], v6 offset:24576
v_mfma_f32_16x16x32_bf16 v[148:151], v[52:55], v[36:39], v[148:151]
ds_read_b64_tr_b16 v[102:103], v6 offset:28672
v_mfma_f32_16x16x32_bf16 v[152:155], v[52:55], v[40:43], v[152:155]
ds_read_b64_tr_b16 v[112:113], v6 offset:40960
v_mfma_f32_16x16x32_bf16 v[156:159], v[52:55], v[44:47], v[156:159]
ds_read_b64_tr_b16 v[114:115], v6 offset:45056
v_mfma_f32_16x16x32_bf16 v[192:195], v[64:67], v[32:35], v[192:195]
ds_read_b64_tr_b16 v[104:105], v7 offset:24576
v_mfma_f32_16x16x32_bf16 v[196:199], v[64:67], v[36:39], v[196:199]
ds_read_b64_tr_b16 v[106:107], v7 offset:28672
v_mfma_f32_16x16x32_bf16 v[200:203], v[64:67], v[40:43], v[200:203]
ds_read_b64_tr_b16 v[116:117], v7 offset:40960
v_mfma_f32_16x16x32_bf16 v[204:207], v[64:67], v[44:47], v[204:207]
ds_read_b64_tr_b16 v[118:119], v7 offset:45056
v_mfma_f32_16x16x32_bf16 v[160:163], v[56:59], v[32:35], v[160:163]
v_mfma_f32_16x16x32_bf16 v[164:167], v[56:59], v[36:39], v[164:167]
v_mfma_f32_16x16x32_bf16 v[168:171], v[56:59], v[40:43], v[168:171]
v_mfma_f32_16x16x32_bf16 v[172:175], v[56:59], v[44:47], v[172:175]
v_mfma_f32_16x16x32_bf16 v[208:211], v[68:71], v[32:35], v[208:211]
v_mfma_f32_16x16x32_bf16 v[212:215], v[68:71], v[36:39], v[212:215]
v_mfma_f32_16x16x32_bf16 v[216:219], v[68:71], v[40:43], v[216:219]
v_mfma_f32_16x16x32_bf16 v[220:223], v[68:71], v[44:47], v[220:223]
s_waitcnt lgkmcnt(0)
s_barrier
s_cmp_eq_u32 s36, 7
s_cbranch_scc1 L7b_41
s_add_u32 m0, s39, 0
s_add_u32 s37, s37, s40
buffer_load_dwordx4 v21, s[8:11], s37 offen sc1 lds
v_mfma_f32_16x16x32_bf16 v[128:131], v[96:99], v[80:83], v[128:131]
v_mfma_f32_16x16x32_bf16 v[132:135], v[96:99], v[84:87], v[132:135]
s_add_u32 m0, s39, 1024
s_add_u32 s37, s37, s38
buffer_load_dwordx4 v21, s[8:11], s37 offen sc1 lds
v_mfma_f32_16x16x32_bf16 v[136:139], v[96:99], v[88:91], v[136:139]
s_add_u32 m0, s39, 2048
s_add_u32 s37, s37, s38
buffer_load_dwordx4 v21, s[8:11], s37 offen sc1 lds
v_mfma_f32_16x16x32_bf16 v[140:143], v[96:99], v[92:95], v[140:143]
v_mfma_f32_16x16x32_bf16 v[176:179], v[108:111], v[80:83], v[176:179]
s_add_u32 m0, s39, 3072
s_add_u32 s37, s37, s38
buffer_load_dwordx4 v21, s[8:11], s37 offen sc1 lds
v_mfma_f32_16x16x32_bf16 v[180:183], v[108:111], v[84:87], v[180:183]
s_add_u32 m0, s39, 4096
s_add_u32 s37, s37, s55
buffer_load_dwordx4 v21, s[8:11], s37 offen sc1 lds
v_mfma_f32_16x16x32_bf16 v[184:187], v[108:111], v[88:91], v[184:187]
v_mfma_f32_16x16x32_bf16 v[188:191], v[108:111], v[92:95], v[188:191]
s_add_u32 m0, s39, 5120
s_add_u32 s37, s37, s38
buffer_load_dwordx4 v21, s[8:11], s37 offen sc1 lds
v_mfma_f32_16x16x32_bf16 v[144:147], v[100:103], v[80:83], v[144:147]
s_add_u32 m0, s39, 6144
s_add_u32 s37, s37, s38
buffer_load_dwordx4 v21, s[8:11], s37 offen sc1 lds
v_mfma_f32_16x16x32_bf16 v[148:151], v[100:103], v[84:87], v[148:151]
v_mfma_f32_16x16x32_bf16 v[152:155], v[100:103], v[88:91], v[152:155]
s_add_u32 m0, s39, 7168
s_add_u32 s37, s37, s38
buffer_load_dwordx4 v21, s[8:11], s37 offen sc1 lds
v_mfma_f32_16x16x32_bf16 v[156:159], v[100:103], v[92:95], v[156:159]
s_add_u32 m0, s39, 24576
s_add_u32 s37, s37, s40
buffer_load_dwordx4 v21, s[8:11], s37 offen sc1 lds
v_mfma_f32_16x16x32_bf16 v[192:195], v[112:115], v[80:83], v[192:195]
v_mfma_f32_16x16x32_bf16 v[196:199], v[112:115], v[84:87], v[196:199]
s_add_u32 m0, s39, 25600
s_add_u32 s37, s37, s38
buffer_load_dwordx4 v21, s[8:11], s37 offen sc1 lds
v_mfma_f32_16x16x32_bf16 v[200:203], v[112:115], v[88:91], v[200:203]
s_add_u32 m0, s39, 26624
s_add_u32 s37, s37, s38
buffer_load_dwordx4 v21, s[8:11], s37 offen sc1 lds
v_mfma_f32_16x16x32_bf16 v[204:207], v[112:115], v[92:95], v[204:207]
v_mfma_f32_16x16x32_bf16 v[160:163], v[104:107], v[80:83], v[160:163]
s_add_u32 m0, s39, 27648
s_add_u32 s37, s37, s38
buffer_load_dwordx4 v21, s[8:11], s37 offen sc1 lds
v_mfma_f32_16x16x32_bf16 v[164:167], v[104:107], v[84:87], v[164:167]
s_add_u32 m0, s39, 28672
s_add_u32 s37, s37, s55
buffer_load_dwordx4 v21, s[8:11], s37 offen sc1 lds
v_mfma_f32_16x16x32_bf16 v[168:171], v[104:107], v[88:91], v[168:171]
v_mfma_f32_16x16x32_bf16 v[172:175], v[104:107], v[92:95], v[172:175]
s_add_u32 m0, s39, 29696
s_add_u32 s37, s37, s38
buffer_load_dwordx4 v21, s[8:11], s37 offen sc1 lds
v_mfma_f32_16x16x32_bf16 v[208:211], v[116:119], v[80:83], v[208:211]
s_add_u32 m0, s39, 30720
s_add_u32 s37, s37, s38
buffer_load_dwordx4 v21, s[8:11], s37 offen sc1 lds
v_mfma_f32_16x16x32_bf16 v[212:215], v[116:119], v[84:87], v[212:215]
v_mfma_f32_16x16x32_bf16 v[216:219], v[116:119], v[88:91], v[216:219]
s_add_u32 m0, s39, 31744
s_add_u32 s37, s37, s38
buffer_load_dwordx4 v21, s[8:11], s37 offen sc1 lds
v_mfma_f32_16x16x32_bf16 v[220:223], v[116:119], v[92:95], v[220:223]
s_setprio 0
s_barrier
s_add_u32 m0, s39, 49152
s_add_u32 s37, s37, s40
buffer_load_dwordx4 v21, s[8:11], s37 offen sc1 lds
v_mul_f32 v80, v128, v128
v_mul_f32 v81, v129, v129
v_mul_f32 v82, v130, v130
v_mul_f32 v83, v131, v131
s_add_u32 m0, s39, 50176
s_add_u32 s37, s37, s38
buffer_load_dwordx4 v21, s[8:11], s37 offen sc1 lds
v_fma_f32 v80, v80, v232, v228
v_fma_f32 v81, v81, v232, v228
v_fma_f32 v82, v82, v232, v228
v_fma_f32 v83, v83, v232, v228
s_add_u32 m0, s39, 51200
s_add_u32 s37, s37, s38
buffer_load_dwordx4 v21, s[8:11], s37 offen sc1 lds
v_mul_f32 v80, v80, v128
v_mul_f32 v81, v81, v129
v_mul_f32 v82, v82, v130
v_mul_f32 v83, v83, v131
s_add_u32 m0, s39, 52224
s_add_u32 s37, s37, s38
buffer_load_dwordx4 v21, s[8:11], s37 offen sc1 lds
v_exp_f32 v80, v80
v_exp_f32 v81, v81
v_exp_f32 v82, v82
s_add_u32 m0, s39, 53248
s_add_u32 s37, s37, s55
buffer_load_dwordx4 v21, s[8:11], s37 offen sc1 lds
v_exp_f32 v83, v83
v_mul_f32 v176, v128, v176
v_mul_f32 v177, v129, v177
v_mul_f32 v178, v130, v178
s_add_u32 m0, s39, 54272
s_add_u32 s37, s37, s38
buffer_load_dwordx4 v21, s[8:11], s37 offen sc1 lds
v_mul_f32 v179, v131, v179
v_fma_f32 v80, v80, v236, v236
v_fma_f32 v81, v81, v236, v236
v_fma_f32 v82, v82, v236, v236
s_add_u32 m0, s39, 55296
s_add_u32 s37, s37, s38
buffer_load_dwordx4 v21, s[8:11], s37 offen sc1 lds
v_fma_f32 v83, v83, v236, v236
v_rcp_f32 v80, v80
v_rcp_f32 v81, v81
v_rcp_f32 v82, v82
s_add_u32 m0, s39, 56320
s_add_u32 s37, s37, s38
buffer_load_dwordx4 v21, s[8:11], s37 offen sc1 lds
v_rcp_f32 v83, v83
v_mul_f32 v176, v176, v80
v_mul_f32 v177, v177, v81
s_barrier
s_add_u32 m0, s39, 73728
s_add_u32 s37, s37, s40
buffer_load_dwordx4 v21, s[8:11], s37 offen sc1 lds
v_mul_f32 v178, v178, v82
v_mul_f32 v179, v179, v83
v_cvt_pk_bf16_f32 v96, v176, v177
v_cvt_pk_bf16_f32 v97, v178, v179
s_add_u32 m0, s39, 74752
s_add_u32 s37, s37, s38
buffer_load_dwordx4 v21, s[8:11], s37 offen sc1 lds
v_mul_f32 v84, v144, v144
v_mul_f32 v85, v145, v145
v_mul_f32 v86, v146, v146
v_mul_f32 v87, v147, v147
s_add_u32 m0, s39, 75776
s_add_u32 s37, s37, s38
buffer_load_dwordx4 v21, s[8:11], s37 offen sc1 lds
v_fma_f32 v84, v84, v232, v228
v_fma_f32 v85, v85, v232, v228
v_fma_f32 v86, v86, v232, v228
v_fma_f32 v87, v87, v232, v228
s_add_u32 m0, s39, 76800
s_add_u32 s37, s37, s38
buffer_load_dwordx4 v21, s[8:11], s37 offen sc1 lds
v_mul_f32 v84, v84, v144
v_mul_f32 v85, v85, v145
v_mul_f32 v86, v86, v146
s_add_u32 m0, s39, 77824
s_add_u32 s37, s37, s55
buffer_load_dwordx4 v21, s[8:11], s37 offen sc1 lds
v_mul_f32 v87, v87, v147
v_exp_f32 v84, v84
v_exp_f32 v85, v85
v_exp_f32 v86, v86
s_add_u32 m0, s39, 78848
s_add_u32 s37, s37, s38
buffer_load_dwordx4 v21, s[8:11], s37 offen sc1 lds
v_exp_f32 v87, v87
v_mul_f32 v192, v144, v192
v_mul_f32 v193, v145, v193
v_mul_f32 v194, v146, v194
s_add_u32 m0, s39, 79872
s_add_u32 s37, s37, s38
buffer_load_dwordx4 v21, s[8:11], s37 offen sc1 lds
v_mul_f32 v195, v147, v195
v_fma_f32 v84, v84, v236, v236
v_fma_f32 v85, v85, v236, v236
v_fma_f32 v86, v86, v236, v236
s_add_u32 m0, s39, 80896
s_add_u32 s37, s37, s38
buffer_load_dwordx4 v21, s[8:11], s37 offen sc1 lds
v_fma_f32 v87, v87, v236, v236
v_rcp_f32 v84, v84
v_rcp_f32 v85, v85
s_barrier
s_add_u32 m0, s39, 98304
s_add_u32 s37, s37, s40
buffer_load_dwordx4 v21, s[8:11], s37 offen sc1 lds
v_rcp_f32 v86, v86
v_rcp_f32 v87, v87
v_mul_f32 v192, v192, v84
v_mul_f32 v193, v193, v85
s_add_u32 m0, s39, 99328
s_add_u32 s37, s37, s38
buffer_load_dwordx4 v21, s[8:11], s37 offen sc1 lds
v_mul_f32 v194, v194, v86
v_mul_f32 v195, v195, v87
v_cvt_pk_bf16_f32 v98, v192, v193
v_cvt_pk_bf16_f32 v99, v194, v195
s_add_u32 m0, s39, 100352
s_add_u32 s37, s37, s38
buffer_load_dwordx4 v21, s[8:11], s37 offen sc1 lds
v_mul_f32 v80, v160, v160
v_mul_f32 v81, v161, v161
v_mul_f32 v82, v162, v162
s_add_u32 m0, s39, 101376
s_add_u32 s37, s37, s38
buffer_load_dwordx4 v21, s[8:11], s37 offen sc1 lds
v_mul_f32 v83, v163, v163
v_fma_f32 v80, v80, v232, v228
v_fma_f32 v81, v81, v232, v228
s_add_u32 m0, s39, 102400
s_add_u32 s37, s37, s55
buffer_load_dwordx4 v21, s[8:11], s37 offen sc1 lds
v_fma_f32 v82, v82, v232, v228
v_fma_f32 v83, v83, v232, v228
v_mul_f32 v80, v80, v160
v_mul_f32 v81, v81, v161
s_add_u32 m0, s39, 103424
s_add_u32 s37, s37, s38
buffer_load_dwordx4 v21, s[8:11], s37 offen sc1 lds
v_mul_f32 v82, v82, v162
v_mul_f32 v83, v83, v163
v_exp_f32 v80, v80
v_exp_f32 v81, v81
s_add_u32 m0, s39, 104448
s_add_u32 s37, s37, s38
buffer_load_dwordx4 v21, s[8:11], s37 offen sc1 lds
v_exp_f32 v82, v82
v_exp_f32 v83, v83
v_mul_f32 v208, v160, v208
v_mul_f32 v209, v161, v209
s_add_u32 m0, s39, 105472
s_add_u32 s37, s37, s38
buffer_load_dwordx4 v21, s[8:11], s37 offen sc1 lds
v_mul_f32 v210, v162, v210
v_mul_f32 v211, v163, v211
v_fma_f32 v80, v80, v236, v236
buffer_store_dwordx4 v[96:99], v27, s[24:27], 0 offen offset:0 sc1
s_waitcnt vmcnt(33)
s_barrier
s_add_u32 m0, s39, 122880
s_add_u32 s37, s37, s40
buffer_load_dwordx4 v21, s[8:11], s37 offen sc1 lds
v_fma_f32 v81, v81, v236, v236
v_fma_f32 v82, v82, v236, v236
v_fma_f32 v83, v83, v236, v236
v_rcp_f32 v80, v80
s_add_u32 m0, s39, 123904
s_add_u32 s37, s37, s38
buffer_load_dwordx4 v21, s[8:11], s37 offen sc1 lds
v_rcp_f32 v81, v81
v_rcp_f32 v82, v82
v_rcp_f32 v83, v83
v_mul_f32 v208, v208, v80
s_add_u32 m0, s39, 124928
s_add_u32 s37, s37, s38
buffer_load_dwordx4 v21, s[8:11], s37 offen sc1 lds
v_mul_f32 v209, v209, v81
v_mul_f32 v210, v210, v82
v_mul_f32 v211, v211, v83
v_cvt_pk_bf16_f32 v112, v208, v209
s_add_u32 m0, s39, 125952
s_add_u32 s37, s37, s38
buffer_load_dwordx4 v21, s[8:11], s37 offen sc1 lds
v_cvt_pk_bf16_f32 v113, v210, v211
v_mul_f32 v80, v132, v132
v_mul_f32 v81, v133, v133
s_add_u32 m0, s39, 126976
s_add_u32 s37, s37, s55
buffer_load_dwordx4 v21, s[8:11], s37 offen sc1 lds
v_mul_f32 v82, v134, v134
v_mul_f32 v83, v135, v135
v_fma_f32 v80, v80, v233, v229
v_fma_f32 v81, v81, v233, v229
s_add_u32 m0, s39, 128000
s_add_u32 s37, s37, s38
buffer_load_dwordx4 v21, s[8:11], s37 offen sc1 lds
v_fma_f32 v82, v82, v233, v229
v_fma_f32 v83, v83, v233, v229
v_mul_f32 v80, v80, v132
v_mul_f32 v81, v81, v133
s_add_u32 m0, s39, 129024
s_add_u32 s37, s37, s38
buffer_load_dwordx4 v21, s[8:11], s37 offen sc1 lds
v_mul_f32 v82, v82, v134
v_mul_f32 v83, v83, v135
v_exp_f32 v80, v80
v_exp_f32 v81, v81
s_add_u32 m0, s39, 130048
s_add_u32 s37, s37, s38
buffer_load_dwordx4 v21, s[8:11], s37 offen sc1 lds
v_exp_f32 v82, v82
v_exp_f32 v83, v83
v_mul_f32 v180, v132, v180
s_waitcnt vmcnt(33)
s_barrier
s_add_u32 m0, s39, 0
s_add_u32 s37, s37, s40
buffer_load_dwordx4 v21, s[8:11], s37 offen sc1 lds
v_mul_f32 v181, v133, v181
v_mul_f32 v182, v134, v182
v_mul_f32 v183, v135, v183
v_fma_f32 v80, v80, v237, v237
s_add_u32 m0, s39, 1024
s_add_u32 s37, s37, s38
buffer_load_dwordx4 v21, s[8:11], s37 offen sc1 lds
v_fma_f32 v81, v81, v237, v237
v_fma_f32 v82, v82, v237, v237
v_fma_f32 v83, v83, v237, v237
v_rcp_f32 v80, v80
s_add_u32 m0, s39, 2048
s_add_u32 s37, s37, s38
buffer_load_dwordx4 v21, s[8:11], s37 offen sc1 lds
v_rcp_f32 v81, v81
v_rcp_f32 v82, v82
v_rcp_f32 v83, v83
v_mul_f32 v180, v180, v80
s_add_u32 m0, s39, 3072
s_add_u32 s37, s37, s38
buffer_load_dwordx4 v21, s[8:11], s37 offen sc1 lds
v_mul_f32 v181, v181, v81
v_mul_f32 v182, v182, v82
v_mul_f32 v183, v183, v83
s_add_u32 m0, s39, 4096
s_add_u32 s37, s37, s55
buffer_load_dwordx4 v21, s[8:11], s37 offen sc1 lds
v_cvt_pk_bf16_f32 v100, v180, v181
v_cvt_pk_bf16_f32 v101, v182, v183
v_mul_f32 v84, v148, v148
v_mul_f32 v85, v149, v149
s_add_u32 m0, s39, 5120
s_add_u32 s37, s37, s38
buffer_load_dwordx4 v21, s[8:11], s37 offen sc1 lds
v_mul_f32 v86, v150, v150
v_mul_f32 v87, v151, v151
v_fma_f32 v84, v84, v233, v229
v_fma_f32 v85, v85, v233, v229
s_add_u32 m0, s39, 6144
s_add_u32 s37, s37, s38
buffer_load_dwordx4 v21, s[8:11], s37 offen sc1 lds
v_fma_f32 v86, v86, v233, v229
v_fma_f32 v87, v87, v233, v229
v_mul_f32 v84, v84, v148
v_mul_f32 v85, v85, v149
s_add_u32 m0, s39, 7168
s_add_u32 s37, s37, s38
buffer_load_dwordx4 v21, s[8:11], s37 offen sc1 lds
v_mul_f32 v86, v86, v150
v_mul_f32 v87, v87, v151
v_exp_f32 v84, v84
s_waitcnt vmcnt(33)
s_barrier
s_add_u32 m0, s39, 24576
s_add_u32 s37, s37, s40
buffer_load_dwordx4 v21, s[8:11], s37 offen sc1 lds
v_exp_f32 v85, v85
v_exp_f32 v86, v86
v_exp_f32 v87, v87
v_mul_f32 v196, v148, v196
s_add_u32 m0, s39, 25600
s_add_u32 s37, s37, s38
buffer_load_dwordx4 v21, s[8:11], s37 offen sc1 lds
v_mul_f32 v197, v149, v197
v_mul_f32 v198, v150, v198
v_mul_f32 v199, v151, v199
v_fma_f32 v84, v84, v237, v237
s_add_u32 m0, s39, 26624
s_add_u32 s37, s37, s38
buffer_load_dwordx4 v21, s[8:11], s37 offen sc1 lds
v_fma_f32 v85, v85, v237, v237
v_fma_f32 v86, v86, v237, v237
v_fma_f32 v87, v87, v237, v237
v_rcp_f32 v84, v84
s_add_u32 m0, s39, 27648
s_add_u32 s37, s37, s38
buffer_load_dwordx4 v21, s[8:11], s37 offen sc1 lds
v_rcp_f32 v85, v85
v_rcp_f32 v86, v86
v_rcp_f32 v87, v87
s_add_u32 m0, s39, 28672
s_add_u32 s37, s37, s55
buffer_load_dwordx4 v21, s[8:11], s37 offen sc1 lds
v_mul_f32 v196, v196, v84
v_mul_f32 v197, v197, v85
v_mul_f32 v198, v198, v86
v_mul_f32 v199, v199, v87
s_add_u32 m0, s39, 29696
s_add_u32 s37, s37, s38
buffer_load_dwordx4 v21, s[8:11], s37 offen sc1 lds
v_cvt_pk_bf16_f32 v102, v196, v197
v_cvt_pk_bf16_f32 v103, v198, v199
v_mul_f32 v80, v164, v164
s_add_u32 m0, s39, 30720
s_add_u32 s37, s37, s38
buffer_load_dwordx4 v21, s[8:11], s37 offen sc1 lds
v_mul_f32 v81, v165, v165
v_mul_f32 v82, v166, v166
v_mul_f32 v83, v167, v167
v_fma_f32 v80, v80, v233, v229
s_add_u32 m0, s39, 31744
s_add_u32 s37, s37, s38
buffer_load_dwordx4 v21, s[8:11], s37 offen sc1 lds
v_fma_f32 v81, v81, v233, v229
v_fma_f32 v82, v82, v233, v229
v_fma_f32 v83, v83, v233, v229
buffer_store_dwordx4 v[100:103], v27, s[24:27], 0 offen offset:256 sc1
s_waitcnt vmcnt(34)
s_barrier
s_add_u32 m0, s39, 49152
s_add_u32 s37, s37, s40
buffer_load_dwordx4 v21, s[8:11], s37 offen sc1 lds
v_mul_f32 v80, v80, v164
v_mul_f32 v81, v81, v165
v_mul_f32 v82, v82, v166
v_mul_f32 v83, v83, v167
s_add_u32 m0, s39, 50176
s_add_u32 s37, s37, s38
buffer_load_dwordx4 v21, s[8:11], s37 offen sc1 lds
v_exp_f32 v80, v80
v_exp_f32 v81, v81
v_exp_f32 v82, v82
v_exp_f32 v83, v83
s_add_u32 m0, s39, 51200
s_add_u32 s37, s37, s38
buffer_load_dwordx4 v21, s[8:11], s37 offen sc1 lds
v_mul_f32 v212, v164, v212
v_mul_f32 v213, v165, v213
v_mul_f32 v214, v166, v214
v_mul_f32 v215, v167, v215
s_add_u32 m0, s39, 52224
s_add_u32 s37, s37, s38
buffer_load_dwordx4 v21, s[8:11], s37 offen sc1 lds
v_fma_f32 v80, v80, v237, v237
v_fma_f32 v81, v81, v237, v237
v_fma_f32 v82, v82, v237, v237
s_add_u32 m0, s39, 53248
s_add_u32 s37, s37, s55
buffer_load_dwordx4 v21, s[8:11], s37 offen sc1 lds
v_fma_f32 v83, v83, v237, v237
v_rcp_f32 v80, v80
v_rcp_f32 v81, v81
v_rcp_f32 v82, v82
s_add_u32 m0, s39, 54272
s_add_u32 s37, s37, s38
buffer_load_dwordx4 v21, s[8:11], s37 offen sc1 lds
v_rcp_f32 v83, v83
v_mul_f32 v212, v212, v80
v_mul_f32 v213, v213, v81
v_mul_f32 v214, v214, v82
s_add_u32 m0, s39, 55296
s_add_u32 s37, s37, s38
buffer_load_dwordx4 v21, s[8:11], s37 offen sc1 lds
v_mul_f32 v215, v215, v83
v_cvt_pk_bf16_f32 v114, v212, v213
v_cvt_pk_bf16_f32 v115, v214, v215
s_nop 1
s_add_u32 m0, s39, 56320
s_add_u32 s37, s37, s38
buffer_load_dwordx4 v21, s[8:11], s37 offen sc1 lds
v_permlane32_swap_b32 v112, v114
v_permlane32_swap_b32 v113, v115
buffer_store_dwordx4 v[112:115], v28, s[24:27], 0 offen offset:0 sc1
s_waitcnt vmcnt(35)
s_barrier
s_add_u32 m0, s39, 73728
s_add_u32 s37, s37, s40
buffer_load_dwordx4 v21, s[8:11], s37 offen sc1 lds
v_mul_f32 v80, v136, v136
v_mul_f32 v81, v137, v137
v_mul_f32 v82, v138, v138
v_mul_f32 v83, v139, v139
s_add_u32 m0, s39, 74752
s_add_u32 s37, s37, s38
buffer_load_dwordx4 v21, s[8:11], s37 offen sc1 lds
v_fma_f32 v80, v80, v234, v230
v_fma_f32 v81, v81, v234, v230
v_fma_f32 v82, v82, v234, v230
v_fma_f32 v83, v83, v234, v230
s_add_u32 m0, s39, 75776
s_add_u32 s37, s37, s38
buffer_load_dwordx4 v21, s[8:11], s37 offen sc1 lds
v_mul_f32 v80, v80, v136
v_mul_f32 v81, v81, v137
v_mul_f32 v82, v82, v138
v_mul_f32 v83, v83, v139
s_add_u32 m0, s39, 76800
s_add_u32 s37, s37, s38
buffer_load_dwordx4 v21, s[8:11], s37 offen sc1 lds
v_exp_f32 v80, v80
v_exp_f32 v81, v81
v_exp_f32 v82, v82
s_add_u32 m0, s39, 77824
s_add_u32 s37, s37, s55
buffer_load_dwordx4 v21, s[8:11], s37 offen sc1 lds
v_exp_f32 v83, v83
v_mul_f32 v184, v136, v184
v_mul_f32 v185, v137, v185
v_mul_f32 v186, v138, v186
s_add_u32 m0, s39, 78848
s_add_u32 s37, s37, s38
buffer_load_dwordx4 v21, s[8:11], s37 offen sc1 lds
v_mul_f32 v187, v139, v187
v_fma_f32 v80, v80, v238, v238
v_fma_f32 v81, v81, v238, v238
v_fma_f32 v82, v82, v238, v238
s_add_u32 m0, s39, 79872
s_add_u32 s37, s37, s38
buffer_load_dwordx4 v21, s[8:11], s37 offen sc1 lds
v_fma_f32 v83, v83, v238, v238
v_rcp_f32 v80, v80
v_rcp_f32 v81, v81
v_rcp_f32 v82, v82
s_add_u32 m0, s39, 80896
s_add_u32 s37, s37, s38
buffer_load_dwordx4 v21, s[8:11], s37 offen sc1 lds
v_rcp_f32 v83, v83
v_mul_f32 v184, v184, v80
v_mul_f32 v185, v185, v81
s_waitcnt vmcnt(34)
s_barrier
s_add_u32 m0, s39, 98304
s_add_u32 s37, s37, s40
buffer_load_dwordx4 v21, s[8:11], s37 offen sc1 lds
v_mul_f32 v186, v186, v82
v_mul_f32 v187, v187, v83
v_cvt_pk_bf16_f32 v104, v184, v185
v_cvt_pk_bf16_f32 v105, v186, v187
s_add_u32 m0, s39, 99328
s_add_u32 s37, s37, s38
buffer_load_dwordx4 v21, s[8:11], s37 offen sc1 lds
v_mul_f32 v84, v152, v152
v_mul_f32 v85, v153, v153
v_mul_f32 v86, v154, v154
v_mul_f32 v87, v155, v155
s_add_u32 m0, s39, 100352
s_add_u32 s37, s37, s38
buffer_load_dwordx4 v21, s[8:11], s37 offen sc1 lds
v_fma_f32 v84, v84, v234, v230
v_fma_f32 v85, v85, v234, v230
v_fma_f32 v86, v86, v234, v230
v_fma_f32 v87, v87, v234, v230
s_add_u32 m0, s39, 101376
s_add_u32 s37, s37, s38
buffer_load_dwordx4 v21, s[8:11], s37 offen sc1 lds
v_mul_f32 v84, v84, v152
v_mul_f32 v85, v85, v153
v_mul_f32 v86, v86, v154
s_add_u32 m0, s39, 102400
s_add_u32 s37, s37, s55
buffer_load_dwordx4 v21, s[8:11], s37 offen sc1 lds
v_mul_f32 v87, v87, v155
v_exp_f32 v84, v84
v_exp_f32 v85, v85
v_exp_f32 v86, v86
s_add_u32 m0, s39, 103424
s_add_u32 s37, s37, s38
buffer_load_dwordx4 v21, s[8:11], s37 offen sc1 lds
v_exp_f32 v87, v87
v_mul_f32 v200, v152, v200
v_mul_f32 v201, v153, v201
v_mul_f32 v202, v154, v202
s_add_u32 m0, s39, 104448
s_add_u32 s37, s37, s38
buffer_load_dwordx4 v21, s[8:11], s37 offen sc1 lds
v_mul_f32 v203, v155, v203
v_fma_f32 v84, v84, v238, v238
v_fma_f32 v85, v85, v238, v238
v_fma_f32 v86, v86, v238, v238
s_add_u32 m0, s39, 105472
s_add_u32 s37, s37, s38
buffer_load_dwordx4 v21, s[8:11], s37 offen sc1 lds
v_fma_f32 v87, v87, v238, v238
v_rcp_f32 v84, v84
v_rcp_f32 v85, v85
s_waitcnt vmcnt(34)
s_barrier
s_add_u32 m0, s39, 122880
s_add_u32 s37, s37, s40
buffer_load_dwordx4 v21, s[8:11], s37 offen sc1 lds
v_rcp_f32 v86, v86
v_rcp_f32 v87, v87
v_mul_f32 v200, v200, v84
v_mul_f32 v201, v201, v85
s_add_u32 m0, s39, 123904
s_add_u32 s37, s37, s38
buffer_load_dwordx4 v21, s[8:11], s37 offen sc1 lds
v_mul_f32 v202, v202, v86
v_mul_f32 v203, v203, v87
v_cvt_pk_bf16_f32 v106, v200, v201
v_cvt_pk_bf16_f32 v107, v202, v203
s_add_u32 m0, s39, 124928
s_add_u32 s37, s37, s38
buffer_load_dwordx4 v21, s[8:11], s37 offen sc1 lds
v_mul_f32 v80, v168, v168
v_mul_f32 v81, v169, v169
v_mul_f32 v82, v170, v170
s_add_u32 m0, s39, 125952
s_add_u32 s37, s37, s38
buffer_load_dwordx4 v21, s[8:11], s37 offen sc1 lds
v_mul_f32 v83, v171, v171
v_fma_f32 v80, v80, v234, v230
v_fma_f32 v81, v81, v234, v230
s_add_u32 m0, s39, 126976
s_add_u32 s37, s37, s55
buffer_load_dwordx4 v21, s[8:11], s37 offen sc1 lds
v_fma_f32 v82, v82, v234, v230
v_fma_f32 v83, v83, v234, v230
v_mul_f32 v80, v80, v168
v_mul_f32 v81, v81, v169
s_add_u32 m0, s39, 128000
s_add_u32 s37, s37, s38
buffer_load_dwordx4 v21, s[8:11], s37 offen sc1 lds
v_mul_f32 v82, v82, v170
v_mul_f32 v83, v83, v171
v_exp_f32 v80, v80
v_exp_f32 v81, v81
s_add_u32 m0, s39, 129024
s_add_u32 s37, s37, s38
buffer_load_dwordx4 v21, s[8:11], s37 offen sc1 lds
v_exp_f32 v82, v82
v_exp_f32 v83, v83
v_mul_f32 v216, v168, v216
v_mul_f32 v217, v169, v217
s_add_u32 m0, s39, 130048
s_add_u32 s37, s37, s38
buffer_load_dwordx4 v21, s[8:11], s37 offen sc1 lds
v_mul_f32 v218, v170, v218
v_mul_f32 v219, v171, v219
v_fma_f32 v80, v80, v238, v238
buffer_store_dwordx4 v[104:107], v27, s[24:27], 0 offen offset:512 sc1
s_waitcnt vmcnt(35)
s_barrier
s_add_u32 s37, s37, s54
s_add_u32 m0, s39, 0
s_add_u32 s37, s37, s40
buffer_load_dwordx4 v21, s[8:11], s37 offen sc1 lds
v_fma_f32 v81, v81, v238, v238
v_fma_f32 v82, v82, v238, v238
v_fma_f32 v83, v83, v238, v238
v_rcp_f32 v80, v80
s_add_u32 m0, s39, 1024
s_add_u32 s37, s37, s38
buffer_load_dwordx4 v21, s[8:11], s37 offen sc1 lds
v_rcp_f32 v81, v81
v_rcp_f32 v82, v82
v_rcp_f32 v83, v83
v_mul_f32 v216, v216, v80
s_add_u32 m0, s39, 2048
s_add_u32 s37, s37, s38
buffer_load_dwordx4 v21, s[8:11], s37 offen sc1 lds
v_mul_f32 v217, v217, v81
v_mul_f32 v218, v218, v82
v_mul_f32 v219, v219, v83
v_cvt_pk_bf16_f32 v116, v216, v217
s_add_u32 m0, s39, 3072
s_add_u32 s37, s37, s38
buffer_load_dwordx4 v21, s[8:11], s37 offen sc1 lds
v_cvt_pk_bf16_f32 v117, v218, v219
v_mul_f32 v80, v140, v140
v_mul_f32 v81, v141, v141
s_add_u32 m0, s39, 4096
s_add_u32 s37, s37, s55
buffer_load_dwordx4 v21, s[8:11], s37 offen sc1 lds
v_mul_f32 v82, v142, v142
v_mul_f32 v83, v143, v143
v_fma_f32 v80, v80, v235, v231
v_fma_f32 v81, v81, v235, v231
s_add_u32 m0, s39, 5120
s_add_u32 s37, s37, s38
buffer_load_dwordx4 v21, s[8:11], s37 offen sc1 lds
v_fma_f32 v82, v82, v235, v231
v_fma_f32 v83, v83, v235, v231
v_mul_f32 v80, v80, v140
v_mul_f32 v81, v81, v141
s_add_u32 m0, s39, 6144
s_add_u32 s37, s37, s38
buffer_load_dwordx4 v21, s[8:11], s37 offen sc1 lds
v_mul_f32 v82, v82, v142
v_mul_f32 v83, v83, v143
v_exp_f32 v80, v80
v_exp_f32 v81, v81
s_add_u32 m0, s39, 7168
s_add_u32 s37, s37, s38
buffer_load_dwordx4 v21, s[8:11], s37 offen sc1 lds
v_exp_f32 v82, v82
v_exp_f32 v83, v83
v_mul_f32 v188, v140, v188
s_waitcnt vmcnt(34)
s_barrier
s_add_u32 m0, s39, 24576
s_add_u32 s37, s37, s40
buffer_load_dwordx4 v21, s[8:11], s37 offen sc1 lds
v_mul_f32 v189, v141, v189
v_mul_f32 v190, v142, v190
v_mul_f32 v191, v143, v191
v_fma_f32 v80, v80, v239, v239
s_add_u32 m0, s39, 25600
s_add_u32 s37, s37, s38
buffer_load_dwordx4 v21, s[8:11], s37 offen sc1 lds
v_fma_f32 v81, v81, v239, v239
v_fma_f32 v82, v82, v239, v239
v_fma_f32 v83, v83, v239, v239
v_rcp_f32 v80, v80
s_add_u32 m0, s39, 26624
s_add_u32 s37, s37, s38
buffer_load_dwordx4 v21, s[8:11], s37 offen sc1 lds
v_rcp_f32 v81, v81
v_rcp_f32 v82, v82
v_rcp_f32 v83, v83
v_mul_f32 v188, v188, v80
s_add_u32 m0, s39, 27648
s_add_u32 s37, s37, s38
buffer_load_dwordx4 v21, s[8:11], s37 offen sc1 lds
v_mul_f32 v189, v189, v81
v_mul_f32 v190, v190, v82
v_mul_f32 v191, v191, v83
s_add_u32 m0, s39, 28672
s_add_u32 s37, s37, s55
buffer_load_dwordx4 v21, s[8:11], s37 offen sc1 lds
v_cvt_pk_bf16_f32 v108, v188, v189
v_cvt_pk_bf16_f32 v109, v190, v191
v_mul_f32 v84, v156, v156
v_mul_f32 v85, v157, v157
s_add_u32 m0, s39, 29696
s_add_u32 s37, s37, s38
buffer_load_dwordx4 v21, s[8:11], s37 offen sc1 lds
v_mul_f32 v86, v158, v158
v_mul_f32 v87, v159, v159
v_fma_f32 v84, v84, v235, v231
v_fma_f32 v85, v85, v235, v231
s_add_u32 m0, s39, 30720
s_add_u32 s37, s37, s38
buffer_load_dwordx4 v21, s[8:11], s37 offen sc1 lds
v_fma_f32 v86, v86, v235, v231
v_fma_f32 v87, v87, v235, v231
v_mul_f32 v84, v84, v156
v_mul_f32 v85, v85, v157
s_add_u32 m0, s39, 31744
s_add_u32 s37, s37, s38
buffer_load_dwordx4 v21, s[8:11], s37 offen sc1 lds
v_mul_f32 v86, v86, v158
v_mul_f32 v87, v87, v159
v_exp_f32 v84, v84
s_waitcnt vmcnt(33)
s_barrier
s_add_u32 m0, s39, 49152
s_add_u32 s37, s37, s40
buffer_load_dwordx4 v21, s[8:11], s37 offen sc1 lds
v_exp_f32 v85, v85
v_exp_f32 v86, v86
v_exp_f32 v87, v87
v_mul_f32 v204, v156, v204
s_add_u32 m0, s39, 50176
s_add_u32 s37, s37, s38
buffer_load_dwordx4 v21, s[8:11], s37 offen sc1 lds
v_mul_f32 v205, v157, v205
v_mul_f32 v206, v158, v206
v_mul_f32 v207, v159, v207
v_fma_f32 v84, v84, v239, v239
s_add_u32 m0, s39, 51200
s_add_u32 s37, s37, s38
buffer_load_dwordx4 v21, s[8:11], s37 offen sc1 lds
v_fma_f32 v85, v85, v239, v239
v_fma_f32 v86, v86, v239, v239
v_fma_f32 v87, v87, v239, v239
v_rcp_f32 v84, v84
s_add_u32 m0, s39, 52224
s_add_u32 s37, s37, s38
buffer_load_dwordx4 v21, s[8:11], s37 offen sc1 lds
v_rcp_f32 v85, v85
v_rcp_f32 v86, v86
v_rcp_f32 v87, v87
s_add_u32 m0, s39, 53248
s_add_u32 s37, s37, s55
buffer_load_dwordx4 v21, s[8:11], s37 offen sc1 lds
v_mul_f32 v204, v204, v84
v_mul_f32 v205, v205, v85
v_mul_f32 v206, v206, v86
v_mul_f32 v207, v207, v87
s_add_u32 m0, s39, 54272
s_add_u32 s37, s37, s38
buffer_load_dwordx4 v21, s[8:11], s37 offen sc1 lds
v_cvt_pk_bf16_f32 v110, v204, v205
v_cvt_pk_bf16_f32 v111, v206, v207
v_mul_f32 v80, v172, v172
s_add_u32 m0, s39, 55296
s_add_u32 s37, s37, s38
buffer_load_dwordx4 v21, s[8:11], s37 offen sc1 lds
v_mul_f32 v81, v173, v173
v_mul_f32 v82, v174, v174
v_mul_f32 v83, v175, v175
v_fma_f32 v80, v80, v235, v231
s_add_u32 m0, s39, 56320
s_add_u32 s37, s37, s38
buffer_load_dwordx4 v21, s[8:11], s37 offen sc1 lds
v_fma_f32 v81, v81, v235, v231
v_fma_f32 v82, v82, v235, v231
v_fma_f32 v83, v83, v235, v231
buffer_store_dwordx4 v[108:111], v27, s[24:27], 0 offen offset:768 sc1
s_waitcnt vmcnt(34)
s_barrier
s_add_u32 m0, s39, 73728
s_add_u32 s37, s37, s40
buffer_load_dwordx4 v21, s[8:11], s37 offen sc1 lds
v_mul_f32 v80, v80, v172
v_mul_f32 v81, v81, v173
v_mul_f32 v82, v82, v174
v_mul_f32 v83, v83, v175
s_add_u32 m0, s39, 74752
s_add_u32 s37, s37, s38
buffer_load_dwordx4 v21, s[8:11], s37 offen sc1 lds
v_exp_f32 v80, v80
v_exp_f32 v81, v81
v_exp_f32 v82, v82
v_exp_f32 v83, v83
s_add_u32 m0, s39, 75776
s_add_u32 s37, s37, s38
buffer_load_dwordx4 v21, s[8:11], s37 offen sc1 lds
v_mul_f32 v220, v172, v220
v_mul_f32 v221, v173, v221
v_mul_f32 v222, v174, v222
v_mul_f32 v223, v175, v223
s_add_u32 m0, s39, 76800
s_add_u32 s37, s37, s38
buffer_load_dwordx4 v21, s[8:11], s37 offen sc1 lds
v_fma_f32 v80, v80, v239, v239
v_fma_f32 v81, v81, v239, v239
v_fma_f32 v82, v82, v239, v239
s_add_u32 m0, s39, 77824
s_add_u32 s37, s37, s55
buffer_load_dwordx4 v21, s[8:11], s37 offen sc1 lds
v_fma_f32 v83, v83, v239, v239
v_rcp_f32 v80, v80
v_rcp_f32 v81, v81
v_rcp_f32 v82, v82
s_add_u32 m0, s39, 78848
s_add_u32 s37, s37, s38
buffer_load_dwordx4 v21, s[8:11], s37 offen sc1 lds
v_rcp_f32 v83, v83
v_mul_f32 v220, v220, v80
v_mul_f32 v221, v221, v81
v_mul_f32 v222, v222, v82
s_add_u32 m0, s39, 79872
s_add_u32 s37, s37, s38
buffer_load_dwordx4 v21, s[8:11], s37 offen sc1 lds
v_mul_f32 v223, v223, v83
v_cvt_pk_bf16_f32 v118, v220, v221
v_cvt_pk_bf16_f32 v119, v222, v223
s_nop 1
s_add_u32 m0, s39, 80896
s_add_u32 s37, s37, s38
buffer_load_dwordx4 v21, s[8:11], s37 offen sc1 lds
v_permlane32_swap_b32 v116, v118
v_permlane32_swap_b32 v117, v119
buffer_store_dwordx4 v[116:119], v28, s[24:27], 0 offen offset:512 sc1
s_waitcnt vmcnt(35)
s_barrier
s_add_u32 m0, s39, 98304
s_add_u32 s37, s37, s40
buffer_load_dwordx4 v21, s[8:11], s37 offen sc1 lds
s_add_u32 m0, s39, 99328
s_add_u32 s37, s37, s38
buffer_load_dwordx4 v21, s[8:11], s37 offen sc1 lds
s_add_u32 m0, s39, 100352
s_add_u32 s37, s37, s38
buffer_load_dwordx4 v21, s[8:11], s37 offen sc1 lds
s_add_u32 m0, s39, 101376
s_add_u32 s37, s37, s38
buffer_load_dwordx4 v21, s[8:11], s37 offen sc1 lds
s_add_u32 m0, s39, 102400
s_add_u32 s37, s37, s55
buffer_load_dwordx4 v21, s[8:11], s37 offen sc1 lds
s_add_u32 m0, s39, 103424
s_add_u32 s37, s37, s38
buffer_load_dwordx4 v21, s[8:11], s37 offen sc1 lds
s_add_u32 m0, s39, 104448
s_add_u32 s37, s37, s38
buffer_load_dwordx4 v21, s[8:11], s37 offen sc1 lds
s_add_u32 m0, s39, 105472
s_add_u32 s37, s37, s38
buffer_load_dwordx4 v21, s[8:11], s37 offen sc1 lds
s_waitcnt vmcnt(34)
s_barrier
s_add_u32 m0, s39, 122880
s_add_u32 s37, s37, s40
buffer_load_dwordx4 v21, s[8:11], s37 offen sc1 lds
s_add_u32 m0, s39, 123904
s_add_u32 s37, s37, s38
buffer_load_dwordx4 v21, s[8:11], s37 offen sc1 lds
s_add_u32 m0, s39, 124928
s_add_u32 s37, s37, s38
buffer_load_dwordx4 v21, s[8:11], s37 offen sc1 lds
s_add_u32 m0, s39, 125952
s_add_u32 s37, s37, s38
buffer_load_dwordx4 v21, s[8:11], s37 offen sc1 lds
s_add_u32 m0, s39, 126976
s_add_u32 s37, s37, s55
buffer_load_dwordx4 v21, s[8:11], s37 offen sc1 lds
s_add_u32 m0, s39, 128000
s_add_u32 s37, s37, s38
buffer_load_dwordx4 v21, s[8:11], s37 offen sc1 lds
s_add_u32 m0, s39, 129024
s_add_u32 s37, s37, s38
buffer_load_dwordx4 v21, s[8:11], s37 offen sc1 lds
s_add_u32 m0, s39, 130048
s_add_u32 s37, s37, s38
buffer_load_dwordx4 v21, s[8:11], s37 offen sc1 lds
s_waitcnt vmcnt(16)
s_barrier
s_add_u32 m0, s39, 0
s_add_u32 s37, s37, s40
buffer_load_dwordx4 v21, s[8:11], s37 offen sc1 lds
s_add_u32 m0, s39, 1024
s_add_u32 s37, s37, s38
buffer_load_dwordx4 v21, s[8:11], s37 offen sc1 lds
s_add_u32 m0, s39, 2048
s_add_u32 s37, s37, s38
buffer_load_dwordx4 v21, s[8:11], s37 offen sc1 lds
s_add_u32 m0, s39, 3072
s_add_u32 s37, s37, s38
buffer_load_dwordx4 v21, s[8:11], s37 offen sc1 lds
s_add_u32 m0, s39, 4096
s_add_u32 s37, s37, s55
buffer_load_dwordx4 v21, s[8:11], s37 offen sc1 lds
s_add_u32 m0, s39, 5120
s_add_u32 s37, s37, s38
buffer_load_dwordx4 v21, s[8:11], s37 offen sc1 lds
s_add_u32 m0, s39, 6144
s_add_u32 s37, s37, s38
buffer_load_dwordx4 v21, s[8:11], s37 offen sc1 lds
s_add_u32 m0, s39, 7168
s_add_u32 s37, s37, s38
buffer_load_dwordx4 v21, s[8:11], s37 offen sc1 lds
s_waitcnt vmcnt(34)
s_barrier
s_add_u32 m0, s39, 24576
s_add_u32 s37, s37, s40
buffer_load_dwordx4 v21, s[8:11], s37 offen sc1 lds
s_add_u32 m0, s39, 25600
s_add_u32 s37, s37, s38
buffer_load_dwordx4 v21, s[8:11], s37 offen sc1 lds
s_add_u32 m0, s39, 26624
s_add_u32 s37, s37, s38
buffer_load_dwordx4 v21, s[8:11], s37 offen sc1 lds
s_add_u32 m0, s39, 27648
s_add_u32 s37, s37, s38
buffer_load_dwordx4 v21, s[8:11], s37 offen sc1 lds
s_add_u32 m0, s39, 28672
s_add_u32 s37, s37, s55
buffer_load_dwordx4 v21, s[8:11], s37 offen sc1 lds
s_add_u32 m0, s39, 29696
s_add_u32 s37, s37, s38
buffer_load_dwordx4 v21, s[8:11], s37 offen sc1 lds
s_add_u32 m0, s39, 30720
s_add_u32 s37, s37, s38
buffer_load_dwordx4 v21, s[8:11], s37 offen sc1 lds
s_add_u32 m0, s39, 31744
s_add_u32 s37, s37, s38
buffer_load_dwordx4 v21, s[8:11], s37 offen sc1 lds
s_waitcnt vmcnt(33)
s_barrier
s_add_u32 m0, s39, 49152
s_add_u32 s37, s37, s40
buffer_load_dwordx4 v21, s[8:11], s37 offen sc1 lds
s_add_u32 m0, s39, 50176
s_add_u32 s37, s37, s38
buffer_load_dwordx4 v21, s[8:11], s37 offen sc1 lds
s_add_u32 m0, s39, 51200
s_add_u32 s37, s37, s38
buffer_load_dwordx4 v21, s[8:11], s37 offen sc1 lds
s_add_u32 m0, s39, 52224
s_add_u32 s37, s37, s38
buffer_load_dwordx4 v21, s[8:11], s37 offen sc1 lds
s_add_u32 m0, s39, 53248
s_add_u32 s37, s37, s55
buffer_load_dwordx4 v21, s[8:11], s37 offen sc1 lds
s_add_u32 m0, s39, 54272
s_add_u32 s37, s37, s38
buffer_load_dwordx4 v21, s[8:11], s37 offen sc1 lds
s_add_u32 m0, s39, 55296
s_add_u32 s37, s37, s38
buffer_load_dwordx4 v21, s[8:11], s37 offen sc1 lds
s_add_u32 m0, s39, 56320
s_add_u32 s37, s37, s38
buffer_load_dwordx4 v21, s[8:11], s37 offen sc1 lds
s_waitcnt vmcnt(32)
s_barrier
s_add_u32 m0, s39, 73728
s_add_u32 s37, s37, s40
buffer_load_dwordx4 v21, s[8:11], s37 offen sc1 lds
s_add_u32 m0, s39, 74752
s_add_u32 s37, s37, s38
buffer_load_dwordx4 v21, s[8:11], s37 offen sc1 lds
s_add_u32 m0, s39, 75776
s_add_u32 s37, s37, s38
buffer_load_dwordx4 v21, s[8:11], s37 offen sc1 lds
s_add_u32 m0, s39, 76800
s_add_u32 s37, s37, s38
buffer_load_dwordx4 v21, s[8:11], s37 offen sc1 lds
s_add_u32 m0, s39, 77824
s_add_u32 s37, s37, s55
buffer_load_dwordx4 v21, s[8:11], s37 offen sc1 lds
s_add_u32 m0, s39, 78848
s_add_u32 s37, s37, s38
buffer_load_dwordx4 v21, s[8:11], s37 offen sc1 lds
s_add_u32 m0, s39, 79872
s_add_u32 s37, s37, s38
buffer_load_dwordx4 v21, s[8:11], s37 offen sc1 lds
s_add_u32 m0, s39, 80896
s_add_u32 s37, s37, s38
buffer_load_dwordx4 v21, s[8:11], s37 offen sc1 lds
s_waitcnt vmcnt(32)
s_barrier
s_mov_b32 s41, 1
Lp4_42:
s_add_u32 m0, s39, 98304
s_add_u32 s37, s37, s40
buffer_load_dwordx4 v21, s[8:11], s37 offen sc1 lds
s_add_u32 m0, s39, 99328
s_add_u32 s37, s37, s38
buffer_load_dwordx4 v21, s[8:11], s37 offen sc1 lds
s_add_u32 m0, s39, 100352
s_add_u32 s37, s37, s38
buffer_load_dwordx4 v21, s[8:11], s37 offen sc1 lds
s_add_u32 m0, s39, 101376
s_add_u32 s37, s37, s38
buffer_load_dwordx4 v21, s[8:11], s37 offen sc1 lds
s_add_u32 m0, s39, 102400
s_add_u32 s37, s37, s55
buffer_load_dwordx4 v21, s[8:11], s37 offen sc1 lds
s_add_u32 m0, s39, 103424
s_add_u32 s37, s37, s38
buffer_load_dwordx4 v21, s[8:11], s37 offen sc1 lds
s_add_u32 m0, s39, 104448
s_add_u32 s37, s37, s38
buffer_load_dwordx4 v21, s[8:11], s37 offen sc1 lds
s_add_u32 m0, s39, 105472
s_add_u32 s37, s37, s38
buffer_load_dwordx4 v21, s[8:11], s37 offen sc1 lds
s_waitcnt vmcnt(32)
s_barrier
s_add_u32 m0, s39, 122880
s_add_u32 s37, s37, s40
buffer_load_dwordx4 v21, s[8:11], s37 offen sc1 lds
s_add_u32 m0, s39, 123904
s_add_u32 s37, s37, s38
buffer_load_dwordx4 v21, s[8:11], s37 offen sc1 lds
s_add_u32 m0, s39, 124928
s_add_u32 s37, s37, s38
buffer_load_dwordx4 v21, s[8:11], s37 offen sc1 lds
s_add_u32 m0, s39, 125952
s_add_u32 s37, s37, s38
buffer_load_dwordx4 v21, s[8:11], s37 offen sc1 lds
s_add_u32 m0, s39, 126976
s_add_u32 s37, s37, s55
buffer_load_dwordx4 v21, s[8:11], s37 offen sc1 lds
s_add_u32 m0, s39, 128000
s_add_u32 s37, s37, s38
buffer_load_dwordx4 v21, s[8:11], s37 offen sc1 lds
s_add_u32 m0, s39, 129024
s_add_u32 s37, s37, s38
buffer_load_dwordx4 v21, s[8:11], s37 offen sc1 lds
s_add_u32 m0, s39, 130048
s_add_u32 s37, s37, s38
buffer_load_dwordx4 v21, s[8:11], s37 offen sc1 lds
s_waitcnt vmcnt(32)
s_barrier
s_add_u32 m0, s39, 0
s_add_u32 s37, s37, s40
buffer_load_dwordx4 v21, s[8:11], s37 offen sc1 lds
s_add_u32 m0, s39, 1024
s_add_u32 s37, s37, s38
buffer_load_dwordx4 v21, s[8:11], s37 offen sc1 lds
s_add_u32 m0, s39, 2048
s_add_u32 s37, s37, s38
buffer_load_dwordx4 v21, s[8:11], s37 offen sc1 lds
s_add_u32 m0, s39, 3072
s_add_u32 s37, s37, s38
buffer_load_dwordx4 v21, s[8:11], s37 offen sc1 lds
s_add_u32 m0, s39, 4096
s_add_u32 s37, s37, s55
buffer_load_dwordx4 v21, s[8:11], s37 offen sc1 lds
s_add_u32 m0, s39, 5120
s_add_u32 s37, s37, s38
buffer_load_dwordx4 v21, s[8:11], s37 offen sc1 lds
s_add_u32 m0, s39, 6144
s_add_u32 s37, s37, s38
buffer_load_dwordx4 v21, s[8:11], s37 offen sc1 lds
s_add_u32 m0, s39, 7168
s_add_u32 s37, s37, s38
buffer_load_dwordx4 v21, s[8:11], s37 offen sc1 lds
s_waitcnt vmcnt(32)
s_barrier
s_add_u32 m0, s39, 24576
s_add_u32 s37, s37, s40
buffer_load_dwordx4 v21, s[8:11], s37 offen sc1 lds
s_add_u32 m0, s39, 25600
s_add_u32 s37, s37, s38
buffer_load_dwordx4 v21, s[8:11], s37 offen sc1 lds
s_add_u32 m0, s39, 26624
s_add_u32 s37, s37, s38
buffer_load_dwordx4 v21, s[8:11], s37 offen sc1 lds
s_add_u32 m0, s39, 27648
s_add_u32 s37, s37, s38
buffer_load_dwordx4 v21, s[8:11], s37 offen sc1 lds
s_add_u32 m0, s39, 28672
s_add_u32 s37, s37, s55
buffer_load_dwordx4 v21, s[8:11], s37 offen sc1 lds
s_add_u32 m0, s39, 29696
s_add_u32 s37, s37, s38
buffer_load_dwordx4 v21, s[8:11], s37 offen sc1 lds
s_add_u32 m0, s39, 30720
s_add_u32 s37, s37, s38
buffer_load_dwordx4 v21, s[8:11], s37 offen sc1 lds
s_add_u32 m0, s39, 31744
s_add_u32 s37, s37, s38
buffer_load_dwordx4 v21, s[8:11], s37 offen sc1 lds
s_waitcnt vmcnt(32)
s_barrier
s_add_u32 m0, s39, 49152
s_add_u32 s37, s37, s40
buffer_load_dwordx4 v21, s[8:11], s37 offen sc1 lds
s_add_u32 m0, s39, 50176
s_add_u32 s37, s37, s38
buffer_load_dwordx4 v21, s[8:11], s37 offen sc1 lds
s_add_u32 m0, s39, 51200
s_add_u32 s37, s37, s38
buffer_load_dwordx4 v21, s[8:11], s37 offen sc1 lds
s_add_u32 m0, s39, 52224
s_add_u32 s37, s37, s38
buffer_load_dwordx4 v21, s[8:11], s37 offen sc1 lds
s_add_u32 m0, s39, 53248
s_add_u32 s37, s37, s55
buffer_load_dwordx4 v21, s[8:11], s37 offen sc1 lds
s_add_u32 m0, s39, 54272
s_add_u32 s37, s37, s38
buffer_load_dwordx4 v21, s[8:11], s37 offen sc1 lds
s_add_u32 m0, s39, 55296
s_add_u32 s37, s37, s38
buffer_load_dwordx4 v21, s[8:11], s37 offen sc1 lds
s_add_u32 m0, s39, 56320
s_add_u32 s37, s37, s38
buffer_load_dwordx4 v21, s[8:11], s37 offen sc1 lds
s_waitcnt vmcnt(32)
s_barrier
s_add_u32 m0, s39, 73728
s_add_u32 s37, s37, s40
buffer_load_dwordx4 v21, s[8:11], s37 offen sc1 lds
s_add_u32 m0, s39, 74752
s_add_u32 s37, s37, s38
buffer_load_dwordx4 v21, s[8:11], s37 offen sc1 lds
s_add_u32 m0, s39, 75776
s_add_u32 s37, s37, s38
buffer_load_dwordx4 v21, s[8:11], s37 offen sc1 lds
s_add_u32 m0, s39, 76800
s_add_u32 s37, s37, s38
buffer_load_dwordx4 v21, s[8:11], s37 offen sc1 lds
s_add_u32 m0, s39, 77824
s_add_u32 s37, s37, s55
buffer_load_dwordx4 v21, s[8:11], s37 offen sc1 lds
s_add_u32 m0, s39, 78848
s_add_u32 s37, s37, s38
buffer_load_dwordx4 v21, s[8:11], s37 offen sc1 lds
s_add_u32 m0, s39, 79872
s_add_u32 s37, s37, s38
buffer_load_dwordx4 v21, s[8:11], s37 offen sc1 lds
s_add_u32 m0, s39, 80896
s_add_u32 s37, s37, s38
buffer_load_dwordx4 v21, s[8:11], s37 offen sc1 lds
s_waitcnt vmcnt(32)
s_barrier
s_sub_u32 s41, s41, 1
s_cmp_lg_u32 s41, 0
s_cbranch_scc1 Lp4_42
s_cmp_eq_u32 s51, 2
s_cbranch_scc1 LW4_43
s_mov_b32 s41, 4
Lp4_44:
s_add_u32 m0, s39, 98304
s_add_u32 s37, s37, s40
buffer_load_dwordx4 v21, s[8:11], s37 offen sc1 lds
s_add_u32 m0, s39, 99328
s_add_u32 s37, s37, s38
buffer_load_dwordx4 v21, s[8:11], s37 offen sc1 lds
s_add_u32 m0, s39, 100352
s_add_u32 s37, s37, s38
buffer_load_dwordx4 v21, s[8:11], s37 offen sc1 lds
s_add_u32 m0, s39, 101376
s_add_u32 s37, s37, s38
buffer_load_dwordx4 v21, s[8:11], s37 offen sc1 lds
s_add_u32 m0, s39, 102400
s_add_u32 s37, s37, s55
buffer_load_dwordx4 v21, s[8:11], s37 offen sc1 lds
s_add_u32 m0, s39, 103424
s_add_u32 s37, s37, s38
buffer_load_dwordx4 v21, s[8:11], s37 offen sc1 lds
s_add_u32 m0, s39, 104448
s_add_u32 s37, s37, s38
buffer_load_dwordx4 v21, s[8:11], s37 offen sc1 lds
s_add_u32 m0, s39, 105472
s_add_u32 s37, s37, s38
buffer_load_dwordx4 v21, s[8:11], s37 offen sc1 lds
s_waitcnt vmcnt(32)
s_barrier
s_add_u32 m0, s39, 122880
s_add_u32 s37, s37, s40
buffer_load_dwordx4 v21, s[8:11], s37 offen sc1 lds
s_add_u32 m0, s39, 123904
s_add_u32 s37, s37, s38
buffer_load_dwordx4 v21, s[8:11], s37 offen sc1 lds
s_add_u32 m0, s39, 124928
s_add_u32 s37, s37, s38
buffer_load_dwordx4 v21, s[8:11], s37 offen sc1 lds
s_add_u32 m0, s39, 125952
s_add_u32 s37, s37, s38
buffer_load_dwordx4 v21, s[8:11], s37 offen sc1 lds
s_add_u32 m0, s39, 126976
s_add_u32 s37, s37, s55
buffer_load_dwordx4 v21, s[8:11], s37 offen sc1 lds
s_add_u32 m0, s39, 128000
s_add_u32 s37, s37, s38
buffer_load_dwordx4 v21, s[8:11], s37 offen sc1 lds
s_add_u32 m0, s39, 129024
s_add_u32 s37, s37, s38
buffer_load_dwordx4 v21, s[8:11], s37 offen sc1 lds
s_add_u32 m0, s39, 130048
s_add_u32 s37, s37, s38
buffer_load_dwordx4 v21, s[8:11], s37 offen sc1 lds
s_waitcnt vmcnt(32)
s_barrier
s_add_u32 m0, s39, 0
s_add_u32 s37, s37, s40
buffer_load_dwordx4 v21, s[8:11], s37 offen sc1 lds
s_add_u32 m0, s39, 1024
s_add_u32 s37, s37, s38
buffer_load_dwordx4 v21, s[8:11], s37 offen sc1 lds
s_add_u32 m0, s39, 2048
s_add_u32 s37, s37, s38
buffer_load_dwordx4 v21, s[8:11], s37 offen sc1 lds
s_add_u32 m0, s39, 3072
s_add_u32 s37, s37, s38
buffer_load_dwordx4 v21, s[8:11], s37 offen sc1 lds
s_add_u32 m0, s39, 4096
s_add_u32 s37, s37, s55
buffer_load_dwordx4 v21, s[8:11], s37 offen sc1 lds
s_add_u32 m0, s39, 5120
s_add_u32 s37, s37, s38
buffer_load_dwordx4 v21, s[8:11], s37 offen sc1 lds
s_add_u32 m0, s39, 6144
s_add_u32 s37, s37, s38
buffer_load_dwordx4 v21, s[8:11], s37 offen sc1 lds
s_add_u32 m0, s39, 7168
s_add_u32 s37, s37, s38
buffer_load_dwordx4 v21, s[8:11], s37 offen sc1 lds
s_waitcnt vmcnt(32)
s_barrier
s_add_u32 m0, s39, 24576
s_add_u32 s37, s37, s40
buffer_load_dwordx4 v21, s[8:11], s37 offen sc1 lds
s_add_u32 m0, s39, 25600
s_add_u32 s37, s37, s38
buffer_load_dwordx4 v21, s[8:11], s37 offen sc1 lds
s_add_u32 m0, s39, 26624
s_add_u32 s37, s37, s38
buffer_load_dwordx4 v21, s[8:11], s37 offen sc1 lds
s_add_u32 m0, s39, 27648
s_add_u32 s37, s37, s38
buffer_load_dwordx4 v21, s[8:11], s37 offen sc1 lds
s_add_u32 m0, s39, 28672
s_add_u32 s37, s37, s55
buffer_load_dwordx4 v21, s[8:11], s37 offen sc1 lds
s_add_u32 m0, s39, 29696
s_add_u32 s37, s37, s38
buffer_load_dwordx4 v21, s[8:11], s37 offen sc1 lds
s_add_u32 m0, s39, 30720
s_add_u32 s37, s37, s38
buffer_load_dwordx4 v21, s[8:11], s37 offen sc1 lds
s_add_u32 m0, s39, 31744
s_add_u32 s37, s37, s38
buffer_load_dwordx4 v21, s[8:11], s37 offen sc1 lds
s_waitcnt vmcnt(32)
s_barrier
s_add_u32 m0, s39, 49152
s_add_u32 s37, s37, s40
buffer_load_dwordx4 v21, s[8:11], s37 offen sc1 lds
s_add_u32 m0, s39, 50176
s_add_u32 s37, s37, s38
buffer_load_dwordx4 v21, s[8:11], s37 offen sc1 lds
s_add_u32 m0, s39, 51200
s_add_u32 s37, s37, s38
buffer_load_dwordx4 v21, s[8:11], s37 offen sc1 lds
s_add_u32 m0, s39, 52224
s_add_u32 s37, s37, s38
buffer_load_dwordx4 v21, s[8:11], s37 offen sc1 lds
s_add_u32 m0, s39, 53248
s_add_u32 s37, s37, s55
buffer_load_dwordx4 v21, s[8:11], s37 offen sc1 lds
s_add_u32 m0, s39, 54272
s_add_u32 s37, s37, s38
buffer_load_dwordx4 v21, s[8:11], s37 offen sc1 lds
s_add_u32 m0, s39, 55296
s_add_u32 s37, s37, s38
buffer_load_dwordx4 v21, s[8:11], s37 offen sc1 lds
s_add_u32 m0, s39, 56320
s_add_u32 s37, s37, s38
buffer_load_dwordx4 v21, s[8:11], s37 offen sc1 lds
s_waitcnt vmcnt(32)
s_barrier
s_add_u32 m0, s39, 73728
s_add_u32 s37, s37, s40
buffer_load_dwordx4 v21, s[8:11], s37 offen sc1 lds
s_add_u32 m0, s39, 74752
s_add_u32 s37, s37, s38
buffer_load_dwordx4 v21, s[8:11], s37 offen sc1 lds
s_add_u32 m0, s39, 75776
s_add_u32 s37, s37, s38
buffer_load_dwordx4 v21, s[8:11], s37 offen sc1 lds
s_add_u32 m0, s39, 76800
s_add_u32 s37, s37, s38
buffer_load_dwordx4 v21, s[8:11], s37 offen sc1 lds
s_add_u32 m0, s39, 77824
s_add_u32 s37, s37, s55
buffer_load_dwordx4 v21, s[8:11], s37 offen sc1 lds
s_add_u32 m0, s39, 78848
s_add_u32 s37, s37, s38
buffer_load_dwordx4 v21, s[8:11], s37 offen sc1 lds
s_add_u32 m0, s39, 79872
s_add_u32 s37, s37, s38
buffer_load_dwordx4 v21, s[8:11], s37 offen sc1 lds
s_add_u32 m0, s39, 80896
s_add_u32 s37, s37, s38
buffer_load_dwordx4 v21, s[8:11], s37 offen sc1 lds
s_waitcnt vmcnt(32)
s_barrier
s_sub_u32 s41, s41, 1
s_cmp_lg_u32 s41, 0
s_cbranch_scc1 Lp4_44
s_waitcnt vmcnt(24)
s_barrier
s_waitcnt vmcnt(16)
s_barrier
s_waitcnt vmcnt(8)
s_barrier
s_waitcnt vmcnt(0)
s_barrier
s_branch Ldone_1
LW4_43:
s_mov_b32 s41, 4
Lp4_45:
s_add_u32 m0, s39, 98304
s_add_u32 s37, s37, 16384
buffer_load_dwordx4 v21, s[8:11], s37 offen sc1 lds
s_add_u32 m0, s39, 99328
s_add_u32 s37, s37, 16384
buffer_load_dwordx4 v21, s[8:11], s37 offen sc1 lds
s_add_u32 m0, s39, 100352
s_add_u32 s37, s37, 16384
buffer_load_dwordx4 v21, s[8:11], s37 offen sc1 lds
s_add_u32 m0, s39, 101376
s_add_u32 s37, s37, 16384
buffer_load_dwordx4 v21, s[8:11], s37 offen sc1 lds
s_add_u32 m0, s39, 102400
s_add_u32 s37, s37, 49152
buffer_load_dwordx4 v21, s[8:11], s37 offen sc1 lds
s_add_u32 m0, s39, 103424
s_add_u32 s37, s37, 16384
buffer_load_dwordx4 v21, s[8:11], s37 offen sc1 lds
s_add_u32 m0, s39, 104448
s_add_u32 s37, s37, 16384
buffer_load_dwordx4 v21, s[8:11], s37 offen sc1 lds
s_add_u32 m0, s39, 105472
s_add_u32 s37, s37, 16384
buffer_load_dwordx4 v21, s[8:11], s37 offen sc1 lds
s_waitcnt vmcnt(32)
s_barrier
s_add_u32 m0, s39, 122880
s_add_u32 s37, s37, 4294885376
buffer_load_dwordx4 v21, s[8:11], s37 offen sc1 lds
s_add_u32 m0, s39, 123904
s_add_u32 s37, s37, 98304
buffer_load_dwordx4 v21, s[8:11], s37 offen sc1 lds
s_add_u32 m0, s39, 124928
s_add_u32 s37, s37, 4294885376
buffer_load_dwordx4 v21, s[8:11], s37 offen sc1 lds
s_add_u32 m0, s39, 125952
s_add_u32 s37, s37, 98304
buffer_load_dwordx4 v21, s[8:11], s37 offen sc1 lds
s_add_u32 m0, s39, 126976
s_add_u32 s37, s37, 16384
buffer_load_dwordx4 v21, s[8:11], s37 offen sc1 lds
s_add_u32 m0, s39, 128000
s_add_u32 s37, s37, 16384
buffer_load_dwordx4 v21, s[8:11], s37 offen sc1 lds
s_add_u32 m0, s39, 129024
s_add_u32 s37, s37, 16384
buffer_load_dwordx4 v21, s[8:11], s37 offen sc1 lds
s_add_u32 m0, s39, 130048
s_add_u32 s37, s37, 16384
buffer_load_dwordx4 v21, s[8:11], s37 offen sc1 lds
s_waitcnt vmcnt(32)
s_barrier
s_add_u32 m0, s39, 0
s_add_u32 s37, s37, 49152
buffer_load_dwordx4 v21, s[8:11], s37 offen sc1 lds
s_add_u32 m0, s39, 1024
s_add_u32 s37, s37, 16384
buffer_load_dwordx4 v21, s[8:11], s37 offen sc1 lds
s_add_u32 m0, s39, 2048
s_add_u32 s37, s37, 16384
buffer_load_dwordx4 v21, s[8:11], s37 offen sc1 lds
s_add_u32 m0, s39, 3072
s_add_u32 s37, s37, 16384
buffer_load_dwordx4 v21, s[8:11], s37 offen sc1 lds
s_add_u32 m0, s39, 4096
s_add_u32 s37, s37, 4294885376
buffer_load_dwordx4 v21, s[8:11], s37 offen sc1 lds
s_add_u32 m0, s39, 5120
s_add_u32 s37, s37, 98304
buffer_load_dwordx4 v21, s[8:11], s37 offen sc1 lds
s_add_u32 m0, s39, 6144
s_add_u32 s37, s37, 4294885376
buffer_load_dwordx4 v21, s[8:11], s37 offen sc1 lds
s_add_u32 m0, s39, 7168
s_add_u32 s37, s37, 98304
buffer_load_dwordx4 v21, s[8:11], s37 offen sc1 lds
s_waitcnt vmcnt(32)
s_barrier
s_add_u32 m0, s39, 24576
s_add_u32 s37, s37, 16384
buffer_load_dwordx4 v21, s[8:11], s37 offen sc1 lds
s_add_u32 m0, s39, 25600
s_add_u32 s37, s37, 16384
buffer_load_dwordx4 v21, s[8:11], s37 offen sc1 lds
s_add_u32 m0, s39, 26624
s_add_u32 s37, s37, 16384
buffer_load_dwordx4 v21, s[8:11], s37 offen sc1 lds
s_add_u32 m0, s39, 27648
s_add_u32 s37, s37, 16384
buffer_load_dwordx4 v21, s[8:11], s37 offen sc1 lds
s_add_u32 m0, s39, 28672
s_add_u32 s37, s37, 49152
buffer_load_dwordx4 v21, s[8:11], s37 offen sc1 lds
s_add_u32 m0, s39, 29696
s_add_u32 s37, s37, 16384
buffer_load_dwordx4 v21, s[8:11], s37 offen sc1 lds
s_add_u32 m0, s39, 30720
s_add_u32 s37, s37, 16384
buffer_load_dwordx4 v21, s[8:11], s37 offen sc1 lds
s_add_u32 m0, s39, 31744
s_add_u32 s37, s37, 16384
buffer_load_dwordx4 v21, s[8:11], s37 offen sc1 lds
s_waitcnt vmcnt(32)
s_barrier
s_add_u32 m0, s39, 49152
s_add_u32 s37, s37, 4294885376
buffer_load_dwordx4 v21, s[8:11], s37 offen sc1 lds
s_add_u32 m0, s39, 50176
s_add_u32 s37, s37, 98304
buffer_load_dwordx4 v21, s[8:11], s37 offen sc1 lds
s_add_u32 m0, s39, 51200
s_add_u32 s37, s37, 4294885376
buffer_load_dwordx4 v21, s[8:11], s37 offen sc1 lds
s_add_u32 m0, s39, 52224
s_add_u32 s37, s37, 98304
buffer_load_dwordx4 v21, s[8:11], s37 offen sc1 lds
s_add_u32 m0, s39, 53248
s_add_u32 s37, s37, 16384
buffer_load_dwordx4 v21, s[8:11], s37 offen sc1 lds
s_add_u32 m0, s39, 54272
s_add_u32 s37, s37, 16384
buffer_load_dwordx4 v21, s[8:11], s37 offen sc1 lds
s_add_u32 m0, s39, 55296
s_add_u32 s37, s37, 16384
buffer_load_dwordx4 v21, s[8:11], s37 offen sc1 lds
s_add_u32 m0, s39, 56320
s_add_u32 s37, s37, 16384
buffer_load_dwordx4 v21, s[8:11], s37 offen sc1 lds
s_waitcnt vmcnt(32)
s_barrier
s_add_u32 m0, s39, 73728
s_add_u32 s37, s37, 49152
buffer_load_dwordx4 v21, s[8:11], s37 offen sc1 lds
s_add_u32 m0, s39, 74752
s_add_u32 s37, s37, 16384
buffer_load_dwordx4 v21, s[8:11], s37 offen sc1 lds
s_add_u32 m0, s39, 75776
s_add_u32 s37, s37, 16384
buffer_load_dwordx4 v21, s[8:11], s37 offen sc1 lds
s_add_u32 m0, s39, 76800
s_add_u32 s37, s37, 16384
buffer_load_dwordx4 v21, s[8:11], s37 offen sc1 lds
s_add_u32 m0, s39, 77824
s_add_u32 s37, s37, 4294885376
buffer_load_dwordx4 v21, s[8:11], s37 offen sc1 lds
s_add_u32 m0, s39, 78848
s_add_u32 s37, s37, 98304
buffer_load_dwordx4 v21, s[8:11], s37 offen sc1 lds
s_add_u32 m0, s39, 79872
s_add_u32 s37, s37, 4294885376
buffer_load_dwordx4 v21, s[8:11], s37 offen sc1 lds
s_add_u32 m0, s39, 80896
s_add_u32 s37, s37, 98304
buffer_load_dwordx4 v21, s[8:11], s37 offen sc1 lds
s_waitcnt vmcnt(32)
s_barrier
s_sub_u32 s41, s41, 1
s_cmp_lg_u32 s41, 0
s_cbranch_scc1 Lp4_45
s_waitcnt vmcnt(24)
s_barrier
s_waitcnt vmcnt(16)
s_barrier
s_waitcnt vmcnt(8)
s_barrier
s_waitcnt vmcnt(0)
s_barrier
s_branch Ldone_1
L7b_41:
s_add_u32 s43, s34, 48
s_lshl_b32 s43, s43, 7
v_mov_b32 v21, s43
v_mov_b32 v22, 1
s_mov_b64 exec, 1
buffer_atomic_add v22, v21, s[56:59], 0 offen sc1
s_mov_b64 exec, -1
v_mfma_f32_16x16x32_bf16 v[128:131], v[96:99], v[80:83], v[128:131]
v_mfma_f32_16x16x32_bf16 v[132:135], v[96:99], v[84:87], v[132:135]
v_mfma_f32_16x16x32_bf16 v[136:139], v[96:99], v[88:91], v[136:139]
v_mfma_f32_16x16x32_bf16 v[140:143], v[96:99], v[92:95], v[140:143]
v_mfma_f32_16x16x32_bf16 v[176:179], v[108:111], v[80:83], v[176:179]
v_mfma_f32_16x16x32_bf16 v[180:183], v[108:111], v[84:87], v[180:183]
v_mfma_f32_16x16x32_bf16 v[184:187], v[108:111], v[88:91], v[184:187]
v_mfma_f32_16x16x32_bf16 v[188:191], v[108:111], v[92:95], v[188:191]
v_mfma_f32_16x16x32_bf16 v[144:147], v[100:103], v[80:83], v[144:147]
v_mfma_f32_16x16x32_bf16 v[148:151], v[100:103], v[84:87], v[148:151]
v_mfma_f32_16x16x32_bf16 v[152:155], v[100:103], v[88:91], v[152:155]
v_mfma_f32_16x16x32_bf16 v[156:159], v[100:103], v[92:95], v[156:159]
v_mfma_f32_16x16x32_bf16 v[192:195], v[112:115], v[80:83], v[192:195]
v_mfma_f32_16x16x32_bf16 v[196:199], v[112:115], v[84:87], v[196:199]
v_mfma_f32_16x16x32_bf16 v[200:203], v[112:115], v[88:91], v[200:203]
v_mfma_f32_16x16x32_bf16 v[204:207], v[112:115], v[92:95], v[204:207]
v_mfma_f32_16x16x32_bf16 v[160:163], v[104:107], v[80:83], v[160:163]
v_mfma_f32_16x16x32_bf16 v[164:167], v[104:107], v[84:87], v[164:167]
v_mfma_f32_16x16x32_bf16 v[168:171], v[104:107], v[88:91], v[168:171]
v_mfma_f32_16x16x32_bf16 v[172:175], v[104:107], v[92:95], v[172:175]
v_mfma_f32_16x16x32_bf16 v[208:211], v[116:119], v[80:83], v[208:211]
v_mfma_f32_16x16x32_bf16 v[212:215], v[116:119], v[84:87], v[212:215]
v_mfma_f32_16x16x32_bf16 v[216:219], v[116:119], v[88:91], v[216:219]
v_mfma_f32_16x16x32_bf16 v[220:223], v[116:119], v[92:95], v[220:223]
s_setprio 0
s_barrier
v_mul_f32 v80, v128, v128
v_mul_f32 v81, v129, v129
v_mul_f32 v82, v130, v130
v_mul_f32 v83, v131, v131
v_fma_f32 v80, v80, v232, v228
v_fma_f32 v81, v81, v232, v228
v_fma_f32 v82, v82, v232, v228
v_fma_f32 v83, v83, v232, v228
v_mul_f32 v80, v80, v128
v_mul_f32 v81, v81, v129
v_mul_f32 v82, v82, v130
v_mul_f32 v83, v83, v131
v_exp_f32 v80, v80
v_exp_f32 v81, v81
v_exp_f32 v82, v82
v_exp_f32 v83, v83
v_mul_f32 v176, v128, v176
v_mul_f32 v177, v129, v177
v_mul_f32 v178, v130, v178
v_mul_f32 v179, v131, v179
v_fma_f32 v80, v80, v236, v236
v_fma_f32 v81, v81, v236, v236
v_fma_f32 v82, v82, v236, v236
v_fma_f32 v83, v83, v236, v236
v_rcp_f32 v80, v80
v_rcp_f32 v81, v81
v_rcp_f32 v82, v82
v_rcp_f32 v83, v83
v_mul_f32 v176, v176, v80
v_mul_f32 v177, v177, v81
s_barrier
v_mul_f32 v178, v178, v82
v_mul_f32 v179, v179, v83
v_cvt_pk_bf16_f32 v96, v176, v177
v_cvt_pk_bf16_f32 v97, v178, v179
v_mul_f32 v84, v144, v144
v_mul_f32 v85, v145, v145
v_mul_f32 v86, v146, v146
v_mul_f32 v87, v147, v147
v_fma_f32 v84, v84, v232, v228
v_fma_f32 v85, v85, v232, v228
v_fma_f32 v86, v86, v232, v228
v_fma_f32 v87, v87, v232, v228
v_mul_f32 v84, v84, v144
v_mul_f32 v85, v85, v145
v_mul_f32 v86, v86, v146
v_mul_f32 v87, v87, v147
v_exp_f32 v84, v84
v_exp_f32 v85, v85
v_exp_f32 v86, v86
v_exp_f32 v87, v87
v_mul_f32 v192, v144, v192
v_mul_f32 v193, v145, v193
v_mul_f32 v194, v146, v194
v_mul_f32 v195, v147, v195
v_fma_f32 v84, v84, v236, v236
v_fma_f32 v85, v85, v236, v236
v_fma_f32 v86, v86, v236, v236
v_fma_f32 v87, v87, v236, v236
v_rcp_f32 v84, v84
v_rcp_f32 v85, v85
s_barrier
v_rcp_f32 v86, v86
v_rcp_f32 v87, v87
v_mul_f32 v192, v192, v84
v_mul_f32 v193, v193, v85
v_mul_f32 v194, v194, v86
v_mul_f32 v195, v195, v87
v_cvt_pk_bf16_f32 v98, v192, v193
v_cvt_pk_bf16_f32 v99, v194, v195
buffer_store_dwordx4 v[96:99], v27, s[24:27], 0 offen offset:0 sc1
v_mul_f32 v80, v160, v160
v_mul_f32 v81, v161, v161
v_mul_f32 v82, v162, v162
v_mul_f32 v83, v163, v163
v_fma_f32 v80, v80, v232, v228
v_fma_f32 v81, v81, v232, v228
v_fma_f32 v82, v82, v232, v228
v_fma_f32 v83, v83, v232, v228
v_mul_f32 v80, v80, v160
v_mul_f32 v81, v81, v161
v_mul_f32 v82, v82, v162
v_mul_f32 v83, v83, v163
v_exp_f32 v80, v80
v_exp_f32 v81, v81
v_exp_f32 v82, v82
v_exp_f32 v83, v83
v_mul_f32 v208, v160, v208
v_mul_f32 v209, v161, v209
v_mul_f32 v210, v162, v210
v_mul_f32 v211, v163, v211
v_fma_f32 v80, v80, v236, v236
s_barrier
v_fma_f32 v81, v81, v236, v236
v_fma_f32 v82, v82, v236, v236
v_fma_f32 v83, v83, v236, v236
v_rcp_f32 v80, v80
v_rcp_f32 v81, v81
v_rcp_f32 v82, v82
v_rcp_f32 v83, v83
v_mul_f32 v208, v208, v80
v_mul_f32 v209, v209, v81
v_mul_f32 v210, v210, v82
v_mul_f32 v211, v211, v83
v_cvt_pk_bf16_f32 v112, v208, v209
v_cvt_pk_bf16_f32 v113, v210, v211
v_mul_f32 v80, v132, v132
v_mul_f32 v81, v133, v133
v_mul_f32 v82, v134, v134
v_mul_f32 v83, v135, v135
v_fma_f32 v80, v80, v233, v229
v_fma_f32 v81, v81, v233, v229
v_fma_f32 v82, v82, v233, v229
v_fma_f32 v83, v83, v233, v229
v_mul_f32 v80, v80, v132
v_mul_f32 v81, v81, v133
v_mul_f32 v82, v82, v134
v_mul_f32 v83, v83, v135
v_exp_f32 v80, v80
v_exp_f32 v81, v81
v_exp_f32 v82, v82
v_exp_f32 v83, v83
v_mul_f32 v180, v132, v180
s_barrier
v_mul_f32 v181, v133, v181
v_mul_f32 v182, v134, v182
v_mul_f32 v183, v135, v183
v_fma_f32 v80, v80, v237, v237
v_fma_f32 v81, v81, v237, v237
v_fma_f32 v82, v82, v237, v237
v_fma_f32 v83, v83, v237, v237
v_rcp_f32 v80, v80
v_rcp_f32 v81, v81
v_rcp_f32 v82, v82
v_rcp_f32 v83, v83
v_mul_f32 v180, v180, v80
v_mul_f32 v181, v181, v81
v_mul_f32 v182, v182, v82
v_mul_f32 v183, v183, v83
v_cvt_pk_bf16_f32 v100, v180, v181
v_cvt_pk_bf16_f32 v101, v182, v183
v_mul_f32 v84, v148, v148
v_mul_f32 v85, v149, v149
v_mul_f32 v86, v150, v150
v_mul_f32 v87, v151, v151
v_fma_f32 v84, v84, v233, v229
v_fma_f32 v85, v85, v233, v229
v_fma_f32 v86, v86, v233, v229
v_fma_f32 v87, v87, v233, v229
v_mul_f32 v84, v84, v148
v_mul_f32 v85, v85, v149
v_mul_f32 v86, v86, v150
v_mul_f32 v87, v87, v151
v_exp_f32 v84, v84
s_barrier
v_exp_f32 v85, v85
v_exp_f32 v86, v86
v_exp_f32 v87, v87
v_mul_f32 v196, v148, v196
v_mul_f32 v197, v149, v197
v_mul_f32 v198, v150, v198
v_mul_f32 v199, v151, v199
v_fma_f32 v84, v84, v237, v237
v_fma_f32 v85, v85, v237, v237
v_fma_f32 v86, v86, v237, v237
v_fma_f32 v87, v87, v237, v237
v_rcp_f32 v84, v84
v_rcp_f32 v85, v85
v_rcp_f32 v86, v86
v_rcp_f32 v87, v87
v_mul_f32 v196, v196, v84
v_mul_f32 v197, v197, v85
v_mul_f32 v198, v198, v86
v_mul_f32 v199, v199, v87
v_cvt_pk_bf16_f32 v102, v196, v197
v_cvt_pk_bf16_f32 v103, v198, v199
buffer_store_dwordx4 v[100:103], v27, s[24:27], 0 offen offset:256 sc1
v_mul_f32 v80, v164, v164
v_mul_f32 v81, v165, v165
v_mul_f32 v82, v166, v166
v_mul_f32 v83, v167, v167
v_fma_f32 v80, v80, v233, v229
v_fma_f32 v81, v81, v233, v229
v_fma_f32 v82, v82, v233, v229
v_fma_f32 v83, v83, v233, v229
s_barrier
s_add_u32 s43, s34, 48
s_lshl_b32 s43, s43, 7
v_mov_b32 v21, s43
v_mov_b32 v23, 16
buffer_load_dword v22, v21, s[56:59], 0 offen sc1
v_mul_f32 v80, v80, v164
v_mul_f32 v81, v81, v165
v_mul_f32 v82, v82, v166
v_mul_f32 v83, v83, v167
v_exp_f32 v80, v80
v_exp_f32 v81, v81
v_exp_f32 v82, v82
v_exp_f32 v83, v83
v_mul_f32 v212, v164, v212
v_mul_f32 v213, v165, v213
v_mul_f32 v214, v166, v214
v_mul_f32 v215, v167, v215
v_fma_f32 v80, v80, v237, v237
v_fma_f32 v81, v81, v237, v237
v_fma_f32 v82, v82, v237, v237
v_fma_f32 v83, v83, v237, v237
v_rcp_f32 v80, v80
v_rcp_f32 v81, v81
v_rcp_f32 v82, v82
v_rcp_f32 v83, v83
v_mul_f32 v212, v212, v80
v_mul_f32 v213, v213, v81
v_mul_f32 v214, v214, v82
v_mul_f32 v215, v215, v83
v_cvt_pk_bf16_f32 v114, v212, v213
v_cvt_pk_bf16_f32 v115, v214, v215
s_nop 1
v_permlane32_swap_b32 v112, v114
v_permlane32_swap_b32 v113, v115
buffer_store_dwordx4 v[112:115], v28, s[24:27], 0 offen offset:0 sc1
s_barrier
v_mul_f32 v80, v136, v136
v_mul_f32 v81, v137, v137
v_mul_f32 v82, v138, v138
v_mul_f32 v83, v139, v139
v_fma_f32 v80, v80, v234, v230
v_fma_f32 v81, v81, v234, v230
v_fma_f32 v82, v82, v234, v230
v_fma_f32 v83, v83, v234, v230
v_mul_f32 v80, v80, v136
v_mul_f32 v81, v81, v137
v_mul_f32 v82, v82, v138
v_mul_f32 v83, v83, v139
v_exp_f32 v80, v80
v_exp_f32 v81, v81
v_exp_f32 v82, v82
v_exp_f32 v83, v83
v_mul_f32 v184, v136, v184
v_mul_f32 v185, v137, v185
v_mul_f32 v186, v138, v186
v_mul_f32 v187, v139, v187
v_fma_f32 v80, v80, v238, v238
v_fma_f32 v81, v81, v238, v238
v_fma_f32 v82, v82, v238, v238
v_fma_f32 v83, v83, v238, v238
v_rcp_f32 v80, v80
v_rcp_f32 v81, v81
v_rcp_f32 v82, v82
v_rcp_f32 v83, v83
v_mul_f32 v184, v184, v80
v_mul_f32 v185, v185, v81
s_barrier
v_mul_f32 v186, v186, v82
v_mul_f32 v187, v187, v83
v_cvt_pk_bf16_f32 v104, v184, v185
v_cvt_pk_bf16_f32 v105, v186, v187
v_mul_f32 v84, v152, v152
v_mul_f32 v85, v153, v153
v_mul_f32 v86, v154, v154
v_mul_f32 v87, v155, v155
v_fma_f32 v84, v84, v234, v230
v_fma_f32 v85, v85, v234, v230
v_fma_f32 v86, v86, v234, v230
v_fma_f32 v87, v87, v234, v230
v_mul_f32 v84, v84, v152
v_mul_f32 v85, v85, v153
v_mul_f32 v86, v86, v154
v_mul_f32 v87, v87, v155
v_exp_f32 v84, v84
v_exp_f32 v85, v85
v_exp_f32 v86, v86
v_exp_f32 v87, v87
v_mul_f32 v200, v152, v200
v_mul_f32 v201, v153, v201
v_mul_f32 v202, v154, v202
v_mul_f32 v203, v155, v203
v_fma_f32 v84, v84, v238, v238
v_fma_f32 v85, v85, v238, v238
v_fma_f32 v86, v86, v238, v238
v_fma_f32 v87, v87, v238, v238
v_rcp_f32 v84, v84
v_rcp_f32 v85, v85
s_barrier
v_rcp_f32 v86, v86
v_rcp_f32 v87, v87
v_mul_f32 v200, v200, v84
v_mul_f32 v201, v201, v85
v_mul_f32 v202, v202, v86
v_mul_f32 v203, v203, v87
v_cvt_pk_bf16_f32 v106, v200, v201
v_cvt_pk_bf16_f32 v107, v202, v203
buffer_store_dwordx4 v[104:107], v27, s[24:27], 0 offen offset:512 sc1
v_mul_f32 v80, v168, v168
v_mul_f32 v81, v169, v169
v_mul_f32 v82, v170, v170
v_mul_f32 v83, v171, v171
v_fma_f32 v80, v80, v234, v230
v_fma_f32 v81, v81, v234, v230
v_fma_f32 v82, v82, v234, v230
v_fma_f32 v83, v83, v234, v230
v_mul_f32 v80, v80, v168
v_mul_f32 v81, v81, v169
v_mul_f32 v82, v82, v170
v_mul_f32 v83, v83, v171
v_exp_f32 v80, v80
v_exp_f32 v81, v81
v_exp_f32 v82, v82
v_exp_f32 v83, v83
v_mul_f32 v216, v168, v216
v_mul_f32 v217, v169, v217
v_mul_f32 v218, v170, v218
v_mul_f32 v219, v171, v219
v_fma_f32 v80, v80, v238, v238
s_mov_b32 s41, 0x10000
Lpoll_46:
s_waitcnt vmcnt(0)
v_cmp_ne_u32 vcc, v23, v22
s_nop 4
s_cbranch_vccz Lpok_47
buffer_load_dword v22, v21, s[56:59], 0 offen sc1
s_sub_u32 s41, s41, 1
s_cmp_lg_u32 s41, 0
s_cbranch_scc1 Lpoll_46
s_waitcnt vmcnt(0)
Lpok_47:
s_barrier
v_fma_f32 v81, v81, v238, v238
v_fma_f32 v82, v82, v238, v238
v_fma_f32 v83, v83, v238, v238
v_rcp_f32 v80, v80
v_rcp_f32 v81, v81
v_rcp_f32 v82, v82
v_rcp_f32 v83, v83
v_mul_f32 v216, v216, v80
v_mul_f32 v217, v217, v81
v_mul_f32 v218, v218, v82
v_mul_f32 v219, v219, v83
v_cvt_pk_bf16_f32 v116, v216, v217
v_cvt_pk_bf16_f32 v117, v218, v219
v_mul_f32 v80, v140, v140
v_mul_f32 v81, v141, v141
v_mul_f32 v82, v142, v142
v_mul_f32 v83, v143, v143
v_fma_f32 v80, v80, v235, v231
v_fma_f32 v81, v81, v235, v231
v_fma_f32 v82, v82, v235, v231
v_fma_f32 v83, v83, v235, v231
v_mul_f32 v80, v80, v140
v_mul_f32 v81, v81, v141
v_mul_f32 v82, v82, v142
v_mul_f32 v83, v83, v143
v_exp_f32 v80, v80
v_exp_f32 v81, v81
v_exp_f32 v82, v82
v_exp_f32 v83, v83
v_mul_f32 v188, v140, v188
s_barrier
v_mul_f32 v189, v141, v189
v_mul_f32 v190, v142, v190
v_mul_f32 v191, v143, v191
v_fma_f32 v80, v80, v239, v239
v_fma_f32 v81, v81, v239, v239
v_fma_f32 v82, v82, v239, v239
v_fma_f32 v83, v83, v239, v239
v_rcp_f32 v80, v80
v_rcp_f32 v81, v81
v_rcp_f32 v82, v82
v_rcp_f32 v83, v83
v_mul_f32 v188, v188, v80
v_mul_f32 v189, v189, v81
v_mul_f32 v190, v190, v82
v_mul_f32 v191, v191, v83
v_cvt_pk_bf16_f32 v108, v188, v189
v_cvt_pk_bf16_f32 v109, v190, v191
v_mul_f32 v84, v156, v156
v_mul_f32 v85, v157, v157
v_mul_f32 v86, v158, v158
v_mul_f32 v87, v159, v159
v_fma_f32 v84, v84, v235, v231
v_fma_f32 v85, v85, v235, v231
v_fma_f32 v86, v86, v235, v231
v_fma_f32 v87, v87, v235, v231
v_mul_f32 v84, v84, v156
v_mul_f32 v85, v85, v157
v_mul_f32 v86, v86, v158
v_mul_f32 v87, v87, v159
v_exp_f32 v84, v84
s_barrier
v_exp_f32 v85, v85
v_exp_f32 v86, v86
v_exp_f32 v87, v87
v_mul_f32 v204, v156, v204
v_mul_f32 v205, v157, v205
v_mul_f32 v206, v158, v206
v_mul_f32 v207, v159, v207
v_fma_f32 v84, v84, v239, v239
v_fma_f32 v85, v85, v239, v239
v_fma_f32 v86, v86, v239, v239
v_fma_f32 v87, v87, v239, v239
v_rcp_f32 v84, v84
v_rcp_f32 v85, v85
v_rcp_f32 v86, v86
v_rcp_f32 v87, v87
v_mul_f32 v204, v204, v84
v_mul_f32 v205, v205, v85
v_mul_f32 v206, v206, v86
v_mul_f32 v207, v207, v87
v_cvt_pk_bf16_f32 v110, v204, v205
v_cvt_pk_bf16_f32 v111, v206, v207
buffer_store_dwordx4 v[108:111], v27, s[24:27], 0 offen offset:768 sc1
v_mul_f32 v80, v172, v172
v_mul_f32 v81, v173, v173
v_mul_f32 v82, v174, v174
v_mul_f32 v83, v175, v175
v_fma_f32 v80, v80, v235, v231
v_fma_f32 v81, v81, v235, v231
v_fma_f32 v82, v82, v235, v231
v_fma_f32 v83, v83, v235, v231
s_barrier
v_mul_f32 v80, v80, v172
v_mul_f32 v81, v81, v173
v_mul_f32 v82, v82, v174
v_mul_f32 v83, v83, v175
v_exp_f32 v80, v80
v_exp_f32 v81, v81
v_exp_f32 v82, v82
v_exp_f32 v83, v83
v_mul_f32 v220, v172, v220
v_mul_f32 v221, v173, v221
v_mul_f32 v222, v174, v222
v_mul_f32 v223, v175, v223
v_fma_f32 v80, v80, v239, v239
v_fma_f32 v81, v81, v239, v239
v_fma_f32 v82, v82, v239, v239
v_fma_f32 v83, v83, v239, v239
v_rcp_f32 v80, v80
v_rcp_f32 v81, v81
v_rcp_f32 v82, v82
v_rcp_f32 v83, v83
v_mul_f32 v220, v220, v80
v_mul_f32 v221, v221, v81
v_mul_f32 v222, v222, v82
v_mul_f32 v223, v223, v83
v_cvt_pk_bf16_f32 v118, v220, v221
v_cvt_pk_bf16_f32 v119, v222, v223
s_nop 1
v_permlane32_swap_b32 v116, v118
v_permlane32_swap_b32 v117, v119
buffer_store_dwordx4 v[116:119], v28, s[24:27], 0 offen offset:512 sc1
s_barrier
s_barrier
s_waitcnt vmcnt(0)
s_barrier
s_add_u32 s43, s34, 64
s_lshl_b32 s43, s43, 7
v_mov_b32 v21, s43
v_mov_b32 v22, 1
s_mov_b64 exec, 1
buffer_atomic_add v22, v21, s[56:59], 0 offen sc1
s_mov_b64 exec, -1
s_barrier
s_barrier
s_barrier
s_barrier
s_barrier
s_barrier
s_add_u32 s43, s34, 64
s_lshl_b32 s43, s43, 7
v_mov_b32 v21, s43
v_mov_b32 v23, 16
buffer_load_dword v22, v21, s[56:59], 0 offen sc1
s_barrier
s_barrier
s_barrier
s_mov_b32 s41, 0x10000
Lpoll_48:
s_waitcnt vmcnt(0)
v_cmp_ne_u32 vcc, v23, v22
s_nop 4
s_cbranch_vccz Lpok_49
buffer_load_dword v22, v21, s[56:59], 0 offen sc1
s_sub_u32 s41, s41, 1
s_cmp_lg_u32 s41, 0
s_cbranch_scc1 Lpoll_48
s_waitcnt vmcnt(0)
Lpok_49:
s_barrier
s_branch Ldone_1
Ldone_1:
s_endpgm
.section .rodata,"a"
.p2align 6
.amdhsa_kernel sequential_preLN__sliding_local_dilated__glu_gated_geglu__prompt_kernel
  .amdhsa_next_free_vgpr 256
  .amdhsa_next_free_sgpr 100
  .amdhsa_accum_offset 256
  .amdhsa_group_segment_fixed_size 0
  .amdhsa_kernarg_size 80
  .amdhsa_user_sgpr_count 2
  .amdhsa_user_sgpr_kernarg_segment_ptr 1
  .amdhsa_system_sgpr_workgroup_id_x 1
  .amdhsa_float_denorm_mode_32 3
  .amdhsa_float_denorm_mode_16_64 3
.end_amdhsa_kernel
```

```asm
; @launch grid=(256,1,1) block=(512,1,1) lds=151552
.amdgcn_target "amdgcn-amd-amdhsa--gfx950"
.text
.globl sequential_preLN__sliding_local_dilated__glu_gated_geglu__prompt_kernel
.p2align 8
.type sequential_preLN__sliding_local_dilated__glu_gated_geglu__prompt_kernel,@function
sequential_preLN__sliding_local_dilated__glu_gated_geglu__prompt_kernel:
s_cmp_ge_u32 s2, 256
s_cbranch_scc1 Ldone_1
s_load_dwordx4 s[4:7], s[0:1], 0
s_load_dwordx2 s[32:33], s[0:1], 72
s_load_dwordx2 s[80:81], s[0:1], 32
s_and_b32 s3, s2, 7
s_lshr_b32 s42, s2, 3
s_and_b32 s48, s42, 3
s_lshr_b32 s49, s42, 2
s_and_b32 s34, s3, 3
s_lshl_b32 s34, s34, 2
s_add_u32 s34, s34, s48
s_lshr_b32 s35, s3, 2
s_lshl_b32 s35, s35, 3
s_add_u32 s35, s35, s49
v_lshrrev_b32 v12, 6, v0
v_and_b32 v1, 63, v0
v_readfirstlane_b32 s36, v12
s_nop 3
s_lshl_b32 s43, s35, 7
s_lshl_b32 s44, s34, 18
s_lshl_b32 s45, s35, 14
s_add_u32 s45, s45, s44
s_lshl_b32 s50, s34, 7
s_sub_u32 s50, s50, 16
s_waitcnt lgkmcnt(0)
s_mov_b32 s8, s4
s_mov_b32 s9, s5
s_mov_b32 s10, 4194304
s_mov_b32 s11, 0x20000
s_add_u32 s12, s6, s43
s_addc_u32 s13, s7, 0
s_mov_b32 s14, 6289536
s_mov_b32 s15, 0x20000
s_add_u32 s16, s32, s45
s_addc_u32 s17, s33, 0
s_mov_b32 s18, 16384
s_mov_b32 s19, 0x20000
v_and_b32 v12, 15, v1
v_lshrrev_b32 v13, 4, v1
s_cmp_ge_u32 s36, 4
s_cbranch_scc1 Lprod_2
v_lshrrev_b32 v16, 1, v12
v_xor_b32 v15, v13, v16
v_lshlrev_b32 v15, 4, v15
v_lshl_add_u32 v2, v12, 7, v15
v_xor_b32 v3, 64, v2
v_add_u32 v4, 86016, v2
v_add_u32 v5, 86016, v3
v_lshrrev_b32 v15, 2, v12
v_and_b32 v16, 3, v1
v_lshl_add_u32 v19, v13, 3, v15
v_lshlrev_b32 v19, 7, v19
v_and_b32 v15, 2, v15
v_and_b32 v17, 1, v13
v_lshl_add_u32 v15, v17, 2, v15
v_lshrrev_b32 v17, 1, v16
s_lshl_b32 s43, s36, 1
v_add_u32 v17, s43, v17
v_xor_b32 v15, v15, v17
v_lshl_add_u32 v19, v15, 4, v19
v_and_b32 v16, 1, v16
v_lshl_add_u32 v19, v16, 3, v19
v_add_u32 v6, 18432, v19
v_add_u32 v7, 61440, v19
v_add_u32 v8, 104448, v19
v_mov_b32 v128, 0
v_mov_b32 v129, 0
v_mov_b32 v130, 0
v_mov_b32 v131, 0
v_mov_b32 v132, 0
v_mov_b32 v133, 0
v_mov_b32 v134, 0
v_mov_b32 v135, 0
v_mov_b32 v136, 0
v_mov_b32 v137, 0
v_mov_b32 v138, 0
v_mov_b32 v139, 0
v_mov_b32 v140, 0
v_mov_b32 v141, 0
v_mov_b32 v142, 0
v_mov_b32 v143, 0
v_mov_b32 v144, 0
v_mov_b32 v145, 0
v_mov_b32 v146, 0
v_mov_b32 v147, 0
v_mov_b32 v148, 0
v_mov_b32 v149, 0
v_mov_b32 v150, 0
v_mov_b32 v151, 0
v_mov_b32 v152, 0
v_mov_b32 v153, 0
v_mov_b32 v154, 0
v_mov_b32 v155, 0
v_mov_b32 v156, 0
v_mov_b32 v157, 0
v_mov_b32 v158, 0
v_mov_b32 v159, 0
v_mov_b32 v160, 0
v_mov_b32 v161, 0
v_mov_b32 v162, 0
v_mov_b32 v163, 0
v_mov_b32 v164, 0
v_mov_b32 v165, 0
v_mov_b32 v166, 0
v_mov_b32 v167, 0
v_mov_b32 v168, 0
v_mov_b32 v169, 0
v_mov_b32 v170, 0
v_mov_b32 v171, 0
v_mov_b32 v172, 0
v_mov_b32 v173, 0
v_mov_b32 v174, 0
v_mov_b32 v175, 0
v_mov_b32 v176, 0
v_mov_b32 v177, 0
v_mov_b32 v178, 0
v_mov_b32 v179, 0
v_mov_b32 v180, 0
v_mov_b32 v181, 0
v_mov_b32 v182, 0
v_mov_b32 v183, 0
v_mov_b32 v184, 0
v_mov_b32 v185, 0
v_mov_b32 v186, 0
v_mov_b32 v187, 0
v_mov_b32 v188, 0
v_mov_b32 v189, 0
v_mov_b32 v190, 0
v_mov_b32 v191, 0
v_mov_b32 v192, 0
v_mov_b32 v193, 0
v_mov_b32 v194, 0
v_mov_b32 v195, 0
v_mov_b32 v196, 0
v_mov_b32 v197, 0
v_mov_b32 v198, 0
v_mov_b32 v199, 0
v_mov_b32 v200, 0
v_mov_b32 v201, 0
v_mov_b32 v202, 0
v_mov_b32 v203, 0
v_mov_b32 v204, 0
v_mov_b32 v205, 0
v_mov_b32 v206, 0
v_mov_b32 v207, 0
v_mov_b32 v208, 0
v_mov_b32 v209, 0
v_mov_b32 v210, 0
v_mov_b32 v211, 0
v_mov_b32 v212, 0
v_mov_b32 v213, 0
v_mov_b32 v214, 0
v_mov_b32 v215, 0
v_mov_b32 v216, 0
v_mov_b32 v217, 0
v_mov_b32 v218, 0
v_mov_b32 v219, 0
v_mov_b32 v220, 0
v_mov_b32 v221, 0
v_mov_b32 v222, 0
v_mov_b32 v223, 0
v_mov_b32 v224, 0
v_mov_b32 v225, 0
v_mov_b32 v226, 0
v_mov_b32 v227, 0
v_mov_b32 v228, 0
v_mov_b32 v229, 0
v_mov_b32 v230, 0
v_mov_b32 v231, 0
v_mov_b32 v232, 0
v_mov_b32 v233, 0
v_mov_b32 v234, 0
v_mov_b32 v235, 0
s_barrier
ds_read_b128 v[32:35], v2 offset:0
ds_read_b64_tr_b16 v[72:73], v6 offset:8192
ds_read_b64_tr_b16 v[74:75], v6 offset:8704
ds_read_b64_tr_b16 v[76:77], v6 offset:16384
ds_read_b64_tr_b16 v[78:79], v6 offset:16896
ds_read_b64_tr_b16 v[68:69], v6 offset:0
ds_read_b64_tr_b16 v[70:71], v6 offset:512
ds_read_b128 v[36:39], v2 offset:2048
ds_read_b128 v[40:43], v2 offset:4096
ds_read_b128 v[44:47], v2 offset:6144
ds_read_b128 v[48:51], v2 offset:8192
ds_read_b128 v[52:55], v2 offset:10240
ds_read_b128 v[56:59], v2 offset:12288
ds_read_b128 v[60:63], v2 offset:14336
ds_read_b128 v[64:67], v2 offset:16384
s_mov_b32 s41, 5
Lcl_5:
s_waitcnt lgkmcnt(0)
v_mfma_f32_16x16x32_bf16 v[164:167], v[72:75], v[32:35], v[164:167]
ds_read_b128 v[80:83], v3 offset:0
v_mfma_f32_16x16x32_bf16 v[200:203], v[76:79], v[32:35], v[200:203]
ds_read_b64_tr_b16 v[120:121], v6 offset:12288
v_mfma_f32_16x16x32_bf16 v[128:131], v[68:71], v[32:35], v[128:131]
ds_read_b64_tr_b16 v[122:123], v6 offset:12800
v_mfma_f32_16x16x32_bf16 v[168:171], v[72:75], v[36:39], v[168:171]
ds_read_b64_tr_b16 v[124:125], v6 offset:20480
v_mfma_f32_16x16x32_bf16 v[204:207], v[76:79], v[36:39], v[204:207]
ds_read_b64_tr_b16 v[126:127], v6 offset:20992
v_mfma_f32_16x16x32_bf16 v[132:135], v[68:71], v[36:39], v[132:135]
ds_read_b64_tr_b16 v[116:117], v6 offset:4096
v_mfma_f32_16x16x32_bf16 v[172:175], v[72:75], v[40:43], v[172:175]
ds_read_b64_tr_b16 v[118:119], v6 offset:4608
v_mfma_f32_16x16x32_bf16 v[208:211], v[76:79], v[40:43], v[208:211]
ds_read_b128 v[84:87], v3 offset:2048
v_mfma_f32_16x16x32_bf16 v[136:139], v[68:71], v[40:43], v[136:139]
ds_read_b128 v[88:91], v3 offset:4096
v_mfma_f32_16x16x32_bf16 v[176:179], v[72:75], v[44:47], v[176:179]
ds_read_b128 v[92:95], v3 offset:6144
v_mfma_f32_16x16x32_bf16 v[212:215], v[76:79], v[44:47], v[212:215]
ds_read_b128 v[96:99], v3 offset:8192
v_mfma_f32_16x16x32_bf16 v[140:143], v[68:71], v[44:47], v[140:143]
ds_read_b128 v[100:103], v3 offset:10240
v_mfma_f32_16x16x32_bf16 v[180:183], v[72:75], v[48:51], v[180:183]
ds_read_b128 v[104:107], v3 offset:12288
v_mfma_f32_16x16x32_bf16 v[216:219], v[76:79], v[48:51], v[216:219]
ds_read_b128 v[108:111], v3 offset:14336
v_mfma_f32_16x16x32_bf16 v[144:147], v[68:71], v[48:51], v[144:147]
ds_read_b128 v[112:115], v3 offset:16384
v_mfma_f32_16x16x32_bf16 v[184:187], v[72:75], v[52:55], v[184:187]
v_mfma_f32_16x16x32_bf16 v[220:223], v[76:79], v[52:55], v[220:223]
v_mfma_f32_16x16x32_bf16 v[148:151], v[68:71], v[52:55], v[148:151]
v_mfma_f32_16x16x32_bf16 v[188:191], v[72:75], v[56:59], v[188:191]
v_mfma_f32_16x16x32_bf16 v[224:227], v[76:79], v[56:59], v[224:227]
v_mfma_f32_16x16x32_bf16 v[152:155], v[68:71], v[56:59], v[152:155]
v_mfma_f32_16x16x32_bf16 v[192:195], v[72:75], v[60:63], v[192:195]
v_mfma_f32_16x16x32_bf16 v[228:231], v[76:79], v[60:63], v[228:231]
v_mfma_f32_16x16x32_bf16 v[156:159], v[68:71], v[60:63], v[156:159]
v_mfma_f32_16x16x32_bf16 v[196:199], v[72:75], v[64:67], v[196:199]
v_mfma_f32_16x16x32_bf16 v[232:235], v[76:79], v[64:67], v[232:235]
v_mfma_f32_16x16x32_bf16 v[160:163], v[68:71], v[64:67], v[160:163]
s_waitcnt lgkmcnt(0)
s_barrier
v_mfma_f32_16x16x32_bf16 v[164:167], v[120:123], v[80:83], v[164:167]
ds_read_b128 v[32:35], v2 offset:43008
v_mfma_f32_16x16x32_bf16 v[200:203], v[124:127], v[80:83], v[200:203]
ds_read_b64_tr_b16 v[72:73], v7 offset:8192
v_mfma_f32_16x16x32_bf16 v[128:131], v[116:119], v[80:83], v[128:131]
ds_read_b64_tr_b16 v[74:75], v7 offset:8704
v_mfma_f32_16x16x32_bf16 v[168:171], v[120:123], v[84:87], v[168:171]
ds_read_b64_tr_b16 v[76:77], v7 offset:16384
v_mfma_f32_16x16x32_bf16 v[204:207], v[124:127], v[84:87], v[204:207]
ds_read_b64_tr_b16 v[78:79], v7 offset:16896
v_mfma_f32_16x16x32_bf16 v[132:135], v[116:119], v[84:87], v[132:135]
ds_read_b64_tr_b16 v[68:69], v7 offset:0
v_mfma_f32_16x16x32_bf16 v[172:175], v[120:123], v[88:91], v[172:175]
ds_read_b64_tr_b16 v[70:71], v7 offset:512
v_mfma_f32_16x16x32_bf16 v[208:211], v[124:127], v[88:91], v[208:211]
ds_read_b128 v[36:39], v2 offset:45056
v_mfma_f32_16x16x32_bf16 v[136:139], v[116:119], v[88:91], v[136:139]
ds_read_b128 v[40:43], v2 offset:47104
v_mfma_f32_16x16x32_bf16 v[176:179], v[120:123], v[92:95], v[176:179]
ds_read_b128 v[44:47], v2 offset:49152
v_mfma_f32_16x16x32_bf16 v[212:215], v[124:127], v[92:95], v[212:215]
ds_read_b128 v[48:51], v2 offset:51200
v_mfma_f32_16x16x32_bf16 v[140:143], v[116:119], v[92:95], v[140:143]
ds_read_b128 v[52:55], v2 offset:53248
v_mfma_f32_16x16x32_bf16 v[180:183], v[120:123], v[96:99], v[180:183]
ds_read_b128 v[56:59], v2 offset:55296
v_mfma_f32_16x16x32_bf16 v[216:219], v[124:127], v[96:99], v[216:219]
ds_read_b128 v[60:63], v2 offset:57344
v_mfma_f32_16x16x32_bf16 v[144:147], v[116:119], v[96:99], v[144:147]
ds_read_b128 v[64:67], v2 offset:59392
v_mfma_f32_16x16x32_bf16 v[184:187], v[120:123], v[100:103], v[184:187]
v_mfma_f32_16x16x32_bf16 v[220:223], v[124:127], v[100:103], v[220:223]
v_mfma_f32_16x16x32_bf16 v[148:151], v[116:119], v[100:103], v[148:151]
v_mfma_f32_16x16x32_bf16 v[188:191], v[120:123], v[104:107], v[188:191]
v_mfma_f32_16x16x32_bf16 v[224:227], v[124:127], v[104:107], v[224:227]
v_mfma_f32_16x16x32_bf16 v[152:155], v[116:119], v[104:107], v[152:155]
v_mfma_f32_16x16x32_bf16 v[192:195], v[120:123], v[108:111], v[192:195]
v_mfma_f32_16x16x32_bf16 v[228:231], v[124:127], v[108:111], v[228:231]
v_mfma_f32_16x16x32_bf16 v[156:159], v[116:119], v[108:111], v[156:159]
v_mfma_f32_16x16x32_bf16 v[196:199], v[120:123], v[112:115], v[196:199]
v_mfma_f32_16x16x32_bf16 v[232:235], v[124:127], v[112:115], v[232:235]
v_mfma_f32_16x16x32_bf16 v[160:163], v[116:119], v[112:115], v[160:163]
s_waitcnt lgkmcnt(0)
v_mfma_f32_16x16x32_bf16 v[164:167], v[72:75], v[32:35], v[164:167]
ds_read_b128 v[80:83], v3 offset:43008
v_mfma_f32_16x16x32_bf16 v[200:203], v[76:79], v[32:35], v[200:203]
ds_read_b64_tr_b16 v[120:121], v7 offset:12288
v_mfma_f32_16x16x32_bf16 v[128:131], v[68:71], v[32:35], v[128:131]
ds_read_b64_tr_b16 v[122:123], v7 offset:12800
v_mfma_f32_16x16x32_bf16 v[168:171], v[72:75], v[36:39], v[168:171]
ds_read_b64_tr_b16 v[124:125], v7 offset:20480
v_mfma_f32_16x16x32_bf16 v[204:207], v[76:79], v[36:39], v[204:207]
ds_read_b64_tr_b16 v[126:127], v7 offset:20992
v_mfma_f32_16x16x32_bf16 v[132:135], v[68:71], v[36:39], v[132:135]
ds_read_b64_tr_b16 v[116:117], v7 offset:4096
v_mfma_f32_16x16x32_bf16 v[172:175], v[72:75], v[40:43], v[172:175]
ds_read_b64_tr_b16 v[118:119], v7 offset:4608
v_mfma_f32_16x16x32_bf16 v[208:211], v[76:79], v[40:43], v[208:211]
ds_read_b128 v[84:87], v3 offset:45056
v_mfma_f32_16x16x32_bf16 v[136:139], v[68:71], v[40:43], v[136:139]
ds_read_b128 v[88:91], v3 offset:47104
v_mfma_f32_16x16x32_bf16 v[176:179], v[72:75], v[44:47], v[176:179]
ds_read_b128 v[92:95], v3 offset:49152
v_mfma_f32_16x16x32_bf16 v[212:215], v[76:79], v[44:47], v[212:215]
ds_read_b128 v[96:99], v3 offset:51200
v_mfma_f32_16x16x32_bf16 v[140:143], v[68:71], v[44:47], v[140:143]
ds_read_b128 v[100:103], v3 offset:53248
v_mfma_f32_16x16x32_bf16 v[180:183], v[72:75], v[48:51], v[180:183]
ds_read_b128 v[104:107], v3 offset:55296
v_mfma_f32_16x16x32_bf16 v[216:219], v[76:79], v[48:51], v[216:219]
ds_read_b128 v[108:111], v3 offset:57344
v_mfma_f32_16x16x32_bf16 v[144:147], v[68:71], v[48:51], v[144:147]
ds_read_b128 v[112:115], v3 offset:59392
v_mfma_f32_16x16x32_bf16 v[184:187], v[72:75], v[52:55], v[184:187]
v_mfma_f32_16x16x32_bf16 v[220:223], v[76:79], v[52:55], v[220:223]
v_mfma_f32_16x16x32_bf16 v[148:151], v[68:71], v[52:55], v[148:151]
v_mfma_f32_16x16x32_bf16 v[188:191], v[72:75], v[56:59], v[188:191]
v_mfma_f32_16x16x32_bf16 v[224:227], v[76:79], v[56:59], v[224:227]
v_mfma_f32_16x16x32_bf16 v[152:155], v[68:71], v[56:59], v[152:155]
v_mfma_f32_16x16x32_bf16 v[192:195], v[72:75], v[60:63], v[192:195]
v_mfma_f32_16x16x32_bf16 v[228:231], v[76:79], v[60:63], v[228:231]
v_mfma_f32_16x16x32_bf16 v[156:159], v[68:71], v[60:63], v[156:159]
v_mfma_f32_16x16x32_bf16 v[196:199], v[72:75], v[64:67], v[196:199]
v_mfma_f32_16x16x32_bf16 v[232:235], v[76:79], v[64:67], v[232:235]
v_mfma_f32_16x16x32_bf16 v[160:163], v[68:71], v[64:67], v[160:163]
s_waitcnt lgkmcnt(0)
s_barrier
v_mfma_f32_16x16x32_bf16 v[164:167], v[120:123], v[80:83], v[164:167]
ds_read_b128 v[32:35], v4 offset:0
v_mfma_f32_16x16x32_bf16 v[200:203], v[124:127], v[80:83], v[200:203]
ds_read_b64_tr_b16 v[72:73], v8 offset:8192
v_mfma_f32_16x16x32_bf16 v[128:131], v[116:119], v[80:83], v[128:131]
ds_read_b64_tr_b16 v[74:75], v8 offset:8704
v_mfma_f32_16x16x32_bf16 v[168:171], v[120:123], v[84:87], v[168:171]
ds_read_b64_tr_b16 v[76:77], v8 offset:16384
v_mfma_f32_16x16x32_bf16 v[204:207], v[124:127], v[84:87], v[204:207]
ds_read_b64_tr_b16 v[78:79], v8 offset:16896
v_mfma_f32_16x16x32_bf16 v[132:135], v[116:119], v[84:87], v[132:135]
ds_read_b64_tr_b16 v[68:69], v8 offset:0
v_mfma_f32_16x16x32_bf16 v[172:175], v[120:123], v[88:91], v[172:175]
ds_read_b64_tr_b16 v[70:71], v8 offset:512
v_mfma_f32_16x16x32_bf16 v[208:211], v[124:127], v[88:91], v[208:211]
ds_read_b128 v[36:39], v4 offset:2048
v_mfma_f32_16x16x32_bf16 v[136:139], v[116:119], v[88:91], v[136:139]
ds_read_b128 v[40:43], v4 offset:4096
v_mfma_f32_16x16x32_bf16 v[176:179], v[120:123], v[92:95], v[176:179]
ds_read_b128 v[44:47], v4 offset:6144
v_mfma_f32_16x16x32_bf16 v[212:215], v[124:127], v[92:95], v[212:215]
ds_read_b128 v[48:51], v4 offset:8192
v_mfma_f32_16x16x32_bf16 v[140:143], v[116:119], v[92:95], v[140:143]
ds_read_b128 v[52:55], v4 offset:10240
v_mfma_f32_16x16x32_bf16 v[180:183], v[120:123], v[96:99], v[180:183]
ds_read_b128 v[56:59], v4 offset:12288
v_mfma_f32_16x16x32_bf16 v[216:219], v[124:127], v[96:99], v[216:219]
ds_read_b128 v[60:63], v4 offset:14336
v_mfma_f32_16x16x32_bf16 v[144:147], v[116:119], v[96:99], v[144:147]
ds_read_b128 v[64:67], v4 offset:16384
v_mfma_f32_16x16x32_bf16 v[184:187], v[120:123], v[100:103], v[184:187]
v_mfma_f32_16x16x32_bf16 v[220:223], v[124:127], v[100:103], v[220:223]
v_mfma_f32_16x16x32_bf16 v[148:151], v[116:119], v[100:103], v[148:151]
v_mfma_f32_16x16x32_bf16 v[188:191], v[120:123], v[104:107], v[188:191]
v_mfma_f32_16x16x32_bf16 v[224:227], v[124:127], v[104:107], v[224:227]
v_mfma_f32_16x16x32_bf16 v[152:155], v[116:119], v[104:107], v[152:155]
v_mfma_f32_16x16x32_bf16 v[192:195], v[120:123], v[108:111], v[192:195]
v_mfma_f32_16x16x32_bf16 v[228:231], v[124:127], v[108:111], v[228:231]
v_mfma_f32_16x16x32_bf16 v[156:159], v[116:119], v[108:111], v[156:159]
v_mfma_f32_16x16x32_bf16 v[196:199], v[120:123], v[112:115], v[196:199]
v_mfma_f32_16x16x32_bf16 v[232:235], v[124:127], v[112:115], v[232:235]
v_mfma_f32_16x16x32_bf16 v[160:163], v[116:119], v[112:115], v[160:163]
s_waitcnt lgkmcnt(0)
v_mfma_f32_16x16x32_bf16 v[164:167], v[72:75], v[32:35], v[164:167]
ds_read_b128 v[80:83], v5 offset:0
v_mfma_f32_16x16x32_bf16 v[200:203], v[76:79], v[32:35], v[200:203]
ds_read_b64_tr_b16 v[120:121], v8 offset:12288
v_mfma_f32_16x16x32_bf16 v[128:131], v[68:71], v[32:35], v[128:131]
ds_read_b64_tr_b16 v[122:123], v8 offset:12800
v_mfma_f32_16x16x32_bf16 v[168:171], v[72:75], v[36:39], v[168:171]
ds_read_b64_tr_b16 v[124:125], v8 offset:20480
v_mfma_f32_16x16x32_bf16 v[204:207], v[76:79], v[36:39], v[204:207]
ds_read_b64_tr_b16 v[126:127], v8 offset:20992
v_mfma_f32_16x16x32_bf16 v[132:135], v[68:71], v[36:39], v[132:135]
ds_read_b64_tr_b16 v[116:117], v8 offset:4096
v_mfma_f32_16x16x32_bf16 v[172:175], v[72:75], v[40:43], v[172:175]
ds_read_b64_tr_b16 v[118:119], v8 offset:4608
v_mfma_f32_16x16x32_bf16 v[208:211], v[76:79], v[40:43], v[208:211]
ds_read_b128 v[84:87], v5 offset:2048
v_mfma_f32_16x16x32_bf16 v[136:139], v[68:71], v[40:43], v[136:139]
ds_read_b128 v[88:91], v5 offset:4096
v_mfma_f32_16x16x32_bf16 v[176:179], v[72:75], v[44:47], v[176:179]
ds_read_b128 v[92:95], v5 offset:6144
v_mfma_f32_16x16x32_bf16 v[212:215], v[76:79], v[44:47], v[212:215]
ds_read_b128 v[96:99], v5 offset:8192
v_mfma_f32_16x16x32_bf16 v[140:143], v[68:71], v[44:47], v[140:143]
ds_read_b128 v[100:103], v5 offset:10240
v_mfma_f32_16x16x32_bf16 v[180:183], v[72:75], v[48:51], v[180:183]
ds_read_b128 v[104:107], v5 offset:12288
v_mfma_f32_16x16x32_bf16 v[216:219], v[76:79], v[48:51], v[216:219]
ds_read_b128 v[108:111], v5 offset:14336
v_mfma_f32_16x16x32_bf16 v[144:147], v[68:71], v[48:51], v[144:147]
ds_read_b128 v[112:115], v5 offset:16384
v_mfma_f32_16x16x32_bf16 v[184:187], v[72:75], v[52:55], v[184:187]
v_mfma_f32_16x16x32_bf16 v[220:223], v[76:79], v[52:55], v[220:223]
v_mfma_f32_16x16x32_bf16 v[148:151], v[68:71], v[52:55], v[148:151]
v_mfma_f32_16x16x32_bf16 v[188:191], v[72:75], v[56:59], v[188:191]
v_mfma_f32_16x16x32_bf16 v[224:227], v[76:79], v[56:59], v[224:227]
v_mfma_f32_16x16x32_bf16 v[152:155], v[68:71], v[56:59], v[152:155]
v_mfma_f32_16x16x32_bf16 v[192:195], v[72:75], v[60:63], v[192:195]
v_mfma_f32_16x16x32_bf16 v[228:231], v[76:79], v[60:63], v[228:231]
v_mfma_f32_16x16x32_bf16 v[156:159], v[68:71], v[60:63], v[156:159]
v_mfma_f32_16x16x32_bf16 v[196:199], v[72:75], v[64:67], v[196:199]
v_mfma_f32_16x16x32_bf16 v[232:235], v[76:79], v[64:67], v[232:235]
v_mfma_f32_16x16x32_bf16 v[160:163], v[68:71], v[64:67], v[160:163]
s_waitcnt lgkmcnt(0)
s_barrier
v_mfma_f32_16x16x32_bf16 v[164:167], v[120:123], v[80:83], v[164:167]
ds_read_b128 v[32:35], v2 offset:0
v_mfma_f32_16x16x32_bf16 v[200:203], v[124:127], v[80:83], v[200:203]
ds_read_b64_tr_b16 v[72:73], v6 offset:8192
v_mfma_f32_16x16x32_bf16 v[128:131], v[116:119], v[80:83], v[128:131]
ds_read_b64_tr_b16 v[74:75], v6 offset:8704
v_mfma_f32_16x16x32_bf16 v[168:171], v[120:123], v[84:87], v[168:171]
ds_read_b64_tr_b16 v[76:77], v6 offset:16384
v_mfma_f32_16x16x32_bf16 v[204:207], v[124:127], v[84:87], v[204:207]
ds_read_b64_tr_b16 v[78:79], v6 offset:16896
v_mfma_f32_16x16x32_bf16 v[132:135], v[116:119], v[84:87], v[132:135]
ds_read_b64_tr_b16 v[68:69], v6 offset:0
v_mfma_f32_16x16x32_bf16 v[172:175], v[120:123], v[88:91], v[172:175]
ds_read_b64_tr_b16 v[70:71], v6 offset:512
v_mfma_f32_16x16x32_bf16 v[208:211], v[124:127], v[88:91], v[208:211]
ds_read_b128 v[36:39], v2 offset:2048
v_mfma_f32_16x16x32_bf16 v[136:139], v[116:119], v[88:91], v[136:139]
ds_read_b128 v[40:43], v2 offset:4096
v_mfma_f32_16x16x32_bf16 v[176:179], v[120:123], v[92:95], v[176:179]
ds_read_b128 v[44:47], v2 offset:6144
v_mfma_f32_16x16x32_bf16 v[212:215], v[124:127], v[92:95], v[212:215]
ds_read_b128 v[48:51], v2 offset:8192
v_mfma_f32_16x16x32_bf16 v[140:143], v[116:119], v[92:95], v[140:143]
ds_read_b128 v[52:55], v2 offset:10240
v_mfma_f32_16x16x32_bf16 v[180:183], v[120:123], v[96:99], v[180:183]
ds_read_b128 v[56:59], v2 offset:12288
v_mfma_f32_16x16x32_bf16 v[216:219], v[124:127], v[96:99], v[216:219]
ds_read_b128 v[60:63], v2 offset:14336
v_mfma_f32_16x16x32_bf16 v[144:147], v[116:119], v[96:99], v[144:147]
ds_read_b128 v[64:67], v2 offset:16384
v_mfma_f32_16x16x32_bf16 v[184:187], v[120:123], v[100:103], v[184:187]
v_mfma_f32_16x16x32_bf16 v[220:223], v[124:127], v[100:103], v[220:223]
v_mfma_f32_16x16x32_bf16 v[148:151], v[116:119], v[100:103], v[148:151]
v_mfma_f32_16x16x32_bf16 v[188:191], v[120:123], v[104:107], v[188:191]
v_mfma_f32_16x16x32_bf16 v[224:227], v[124:127], v[104:107], v[224:227]
v_mfma_f32_16x16x32_bf16 v[152:155], v[116:119], v[104:107], v[152:155]
v_mfma_f32_16x16x32_bf16 v[192:195], v[120:123], v[108:111], v[192:195]
v_mfma_f32_16x16x32_bf16 v[228:231], v[124:127], v[108:111], v[228:231]
v_mfma_f32_16x16x32_bf16 v[156:159], v[116:119], v[108:111], v[156:159]
v_mfma_f32_16x16x32_bf16 v[196:199], v[120:123], v[112:115], v[196:199]
v_mfma_f32_16x16x32_bf16 v[232:235], v[124:127], v[112:115], v[232:235]
v_mfma_f32_16x16x32_bf16 v[160:163], v[116:119], v[112:115], v[160:163]
s_sub_u32 s41, s41, 1
s_cmp_lg_u32 s41, 0
s_cbranch_scc1 Lcl_5
s_waitcnt lgkmcnt(0)
v_mfma_f32_16x16x32_bf16 v[164:167], v[72:75], v[32:35], v[164:167]
ds_read_b128 v[80:83], v3 offset:0
v_mfma_f32_16x16x32_bf16 v[200:203], v[76:79], v[32:35], v[200:203]
ds_read_b64_tr_b16 v[120:121], v6 offset:12288
v_mfma_f32_16x16x32_bf16 v[128:131], v[68:71], v[32:35], v[128:131]
ds_read_b64_tr_b16 v[122:123], v6 offset:12800
v_mfma_f32_16x16x32_bf16 v[168:171], v[72:75], v[36:39], v[168:171]
ds_read_b64_tr_b16 v[124:125], v6 offset:20480
v_mfma_f32_16x16x32_bf16 v[204:207], v[76:79], v[36:39], v[204:207]
ds_read_b64_tr_b16 v[126:127], v6 offset:20992
v_mfma_f32_16x16x32_bf16 v[132:135], v[68:71], v[36:39], v[132:135]
ds_read_b64_tr_b16 v[116:117], v6 offset:4096
v_mfma_f32_16x16x32_bf16 v[172:175], v[72:75], v[40:43], v[172:175]
ds_read_b64_tr_b16 v[118:119], v6 offset:4608
v_mfma_f32_16x16x32_bf16 v[208:211], v[76:79], v[40:43], v[208:211]
ds_read_b128 v[84:87], v3 offset:2048
v_mfma_f32_16x16x32_bf16 v[136:139], v[68:71], v[40:43], v[136:139]
ds_read_b128 v[88:91], v3 offset:4096
v_mfma_f32_16x16x32_bf16 v[176:179], v[72:75], v[44:47], v[176:179]
ds_read_b128 v[92:95], v3 offset:6144
v_mfma_f32_16x16x32_bf16 v[212:215], v[76:79], v[44:47], v[212:215]
ds_read_b128 v[96:99], v3 offset:8192
v_mfma_f32_16x16x32_bf16 v[140:143], v[68:71], v[44:47], v[140:143]
ds_read_b128 v[100:103], v3 offset:10240
v_mfma_f32_16x16x32_bf16 v[180:183], v[72:75], v[48:51], v[180:183]
ds_read_b128 v[104:107], v3 offset:12288
v_mfma_f32_16x16x32_bf16 v[216:219], v[76:79], v[48:51], v[216:219]
ds_read_b128 v[108:111], v3 offset:14336
v_mfma_f32_16x16x32_bf16 v[144:147], v[68:71], v[48:51], v[144:147]
ds_read_b128 v[112:115], v3 offset:16384
v_mfma_f32_16x16x32_bf16 v[184:187], v[72:75], v[52:55], v[184:187]
v_mfma_f32_16x16x32_bf16 v[220:223], v[76:79], v[52:55], v[220:223]
v_mfma_f32_16x16x32_bf16 v[148:151], v[68:71], v[52:55], v[148:151]
v_mfma_f32_16x16x32_bf16 v[188:191], v[72:75], v[56:59], v[188:191]
v_mfma_f32_16x16x32_bf16 v[224:227], v[76:79], v[56:59], v[224:227]
v_mfma_f32_16x16x32_bf16 v[152:155], v[68:71], v[56:59], v[152:155]
v_mfma_f32_16x16x32_bf16 v[192:195], v[72:75], v[60:63], v[192:195]
v_mfma_f32_16x16x32_bf16 v[228:231], v[76:79], v[60:63], v[228:231]
v_mfma_f32_16x16x32_bf16 v[156:159], v[68:71], v[60:63], v[156:159]
v_mfma_f32_16x16x32_bf16 v[196:199], v[72:75], v[64:67], v[196:199]
v_mfma_f32_16x16x32_bf16 v[232:235], v[76:79], v[64:67], v[232:235]
v_mfma_f32_16x16x32_bf16 v[160:163], v[68:71], v[64:67], v[160:163]
s_waitcnt lgkmcnt(0)
s_barrier
v_mfma_f32_16x16x32_bf16 v[164:167], v[120:123], v[80:83], v[164:167]
v_mfma_f32_16x16x32_bf16 v[200:203], v[124:127], v[80:83], v[200:203]
v_mfma_f32_16x16x32_bf16 v[128:131], v[116:119], v[80:83], v[128:131]
v_mfma_f32_16x16x32_bf16 v[168:171], v[120:123], v[84:87], v[168:171]
v_mfma_f32_16x16x32_bf16 v[204:207], v[124:127], v[84:87], v[204:207]
v_mfma_f32_16x16x32_bf16 v[132:135], v[116:119], v[84:87], v[132:135]
v_mfma_f32_16x16x32_bf16 v[172:175], v[120:123], v[88:91], v[172:175]
v_mfma_f32_16x16x32_bf16 v[208:211], v[124:127], v[88:91], v[208:211]
v_mfma_f32_16x16x32_bf16 v[136:139], v[116:119], v[88:91], v[136:139]
v_mfma_f32_16x16x32_bf16 v[176:179], v[120:123], v[92:95], v[176:179]
v_mfma_f32_16x16x32_bf16 v[212:215], v[124:127], v[92:95], v[212:215]
v_mfma_f32_16x16x32_bf16 v[140:143], v[116:119], v[92:95], v[140:143]
v_mfma_f32_16x16x32_bf16 v[180:183], v[120:123], v[96:99], v[180:183]
v_mfma_f32_16x16x32_bf16 v[216:219], v[124:127], v[96:99], v[216:219]
v_mfma_f32_16x16x32_bf16 v[144:147], v[116:119], v[96:99], v[144:147]
v_mfma_f32_16x16x32_bf16 v[184:187], v[120:123], v[100:103], v[184:187]
v_mfma_f32_16x16x32_bf16 v[220:223], v[124:127], v[100:103], v[220:223]
v_mfma_f32_16x16x32_bf16 v[148:151], v[116:119], v[100:103], v[148:151]
v_mfma_f32_16x16x32_bf16 v[188:191], v[120:123], v[104:107], v[188:191]
v_mfma_f32_16x16x32_bf16 v[224:227], v[124:127], v[104:107], v[224:227]
v_mfma_f32_16x16x32_bf16 v[152:155], v[116:119], v[104:107], v[152:155]
v_mfma_f32_16x16x32_bf16 v[192:195], v[120:123], v[108:111], v[192:195]
v_mfma_f32_16x16x32_bf16 v[228:231], v[124:127], v[108:111], v[228:231]
v_mfma_f32_16x16x32_bf16 v[156:159], v[116:119], v[108:111], v[156:159]
v_mfma_f32_16x16x32_bf16 v[196:199], v[120:123], v[112:115], v[196:199]
v_mfma_f32_16x16x32_bf16 v[232:235], v[124:127], v[112:115], v[232:235]
v_mfma_f32_16x16x32_bf16 v[160:163], v[116:119], v[112:115], v[160:163]
s_barrier
v_lshlrev_b32 v14, 3, v12
v_add_u32 v14, 129024, v14
ds_read_b64 v[32:33], v14 offset:0
ds_read_b64 v[34:35], v14 offset:128
ds_read_b64 v[36:37], v14 offset:256
ds_read_b64 v[38:39], v14 offset:384
ds_read_b64 v[40:41], v14 offset:512
ds_read_b64 v[42:43], v14 offset:640
ds_read_b64 v[44:45], v14 offset:768
ds_read_b64 v[46:47], v14 offset:896
ds_read_b64 v[48:49], v14 offset:1024
v_mov_b32_dpp v52, v128 row_newbcast:0 row_mask:0xf bank_mask:0xf
v_mov_b32_dpp v53, v129 row_newbcast:0 row_mask:0xf bank_mask:0xf
v_mov_b32_dpp v54, v130 row_newbcast:0 row_mask:0xf bank_mask:0xf
v_mov_b32_dpp v55, v131 row_newbcast:0 row_mask:0xf bank_mask:0xf
v_mov_b32_dpp v56, v164 row_newbcast:0 row_mask:0xf bank_mask:0xf
v_mov_b32_dpp v57, v165 row_newbcast:0 row_mask:0xf bank_mask:0xf
v_mov_b32_dpp v58, v166 row_newbcast:0 row_mask:0xf bank_mask:0xf
v_mov_b32_dpp v59, v167 row_newbcast:0 row_mask:0xf bank_mask:0xf
v_mov_b32_dpp v60, v200 row_newbcast:0 row_mask:0xf bank_mask:0xf
v_mov_b32_dpp v61, v201 row_newbcast:0 row_mask:0xf bank_mask:0xf
v_mov_b32_dpp v62, v202 row_newbcast:0 row_mask:0xf bank_mask:0xf
v_mov_b32_dpp v63, v203 row_newbcast:0 row_mask:0xf bank_mask:0xf
v_mul_u32_u24 v14, 400, v12
v_lshl_add_u32 v14, v13, 3, v14
s_lshl_b32 s43, s36, 5
v_add_u32 v14, s43, v14
s_waitcnt lgkmcnt(0)
v_pk_fma_f32 v[164:165], v[32:33], v[56:57], v[164:165] op_sel_hi:[0,1,1] neg_lo:[1,0,0] neg_hi:[1,0,0]
v_pk_fma_f32 v[166:167], v[32:33], v[58:59], v[166:167] op_sel_hi:[0,1,1] neg_lo:[1,0,0] neg_hi:[1,0,0]
v_pk_mul_f32 v[164:165], v[32:33], v[164:165] op_sel:[1,0] op_sel_hi:[1,1]
v_pk_mul_f32 v[166:167], v[32:33], v[166:167] op_sel:[1,0] op_sel_hi:[1,1]
v_cvt_pk_bf16_f32 v164, v164, v165
v_cvt_pk_bf16_f32 v165, v166, v167
ds_write_b64 v14, v[164:165] offset:128
v_pk_fma_f32 v[200:201], v[32:33], v[60:61], v[200:201] op_sel_hi:[0,1,1] neg_lo:[1,0,0] neg_hi:[1,0,0]
v_pk_fma_f32 v[202:203], v[32:33], v[62:63], v[202:203] op_sel_hi:[0,1,1] neg_lo:[1,0,0] neg_hi:[1,0,0]
v_pk_mul_f32 v[200:201], v[32:33], v[200:201] op_sel:[1,0] op_sel_hi:[1,1]
v_pk_mul_f32 v[202:203], v[32:33], v[202:203] op_sel:[1,0] op_sel_hi:[1,1]
v_cvt_pk_bf16_f32 v200, v200, v201
v_cvt_pk_bf16_f32 v201, v202, v203
ds_write_b64 v14, v[200:201] offset:256
v_pk_fma_f32 v[132:133], v[34:35], v[52:53], v[132:133] op_sel_hi:[0,1,1] neg_lo:[1,0,0] neg_hi:[1,0,0]
v_pk_fma_f32 v[134:135], v[34:35], v[54:55], v[134:135] op_sel_hi:[0,1,1] neg_lo:[1,0,0] neg_hi:[1,0,0]
v_pk_mul_f32 v[132:133], v[34:35], v[132:133] op_sel:[1,0] op_sel_hi:[1,1]
v_pk_mul_f32 v[134:135], v[34:35], v[134:135] op_sel:[1,0] op_sel_hi:[1,1]
v_cvt_pk_bf16_f32 v132, v132, v133
v_cvt_pk_bf16_f32 v133, v134, v135
ds_write_b64 v14, v[132:133] offset:6400
v_pk_fma_f32 v[168:169], v[34:35], v[56:57], v[168:169] op_sel_hi:[0,1,1] neg_lo:[1,0,0] neg_hi:[1,0,0]
v_pk_fma_f32 v[170:171], v[34:35], v[58:59], v[170:171] op_sel_hi:[0,1,1] neg_lo:[1,0,0] neg_hi:[1,0,0]
v_pk_mul_f32 v[168:169], v[34:35], v[168:169] op_sel:[1,0] op_sel_hi:[1,1]
v_pk_mul_f32 v[170:171], v[34:35], v[170:171] op_sel:[1,0] op_sel_hi:[1,1]
v_cvt_pk_bf16_f32 v168, v168, v169
v_cvt_pk_bf16_f32 v169, v170, v171
ds_write_b64 v14, v[168:169] offset:6528
v_pk_fma_f32 v[204:205], v[34:35], v[60:61], v[204:205] op_sel_hi:[0,1,1] neg_lo:[1,0,0] neg_hi:[1,0,0]
v_pk_fma_f32 v[206:207], v[34:35], v[62:63], v[206:207] op_sel_hi:[0,1,1] neg_lo:[1,0,0] neg_hi:[1,0,0]
v_pk_mul_f32 v[204:205], v[34:35], v[204:205] op_sel:[1,0] op_sel_hi:[1,1]
v_pk_mul_f32 v[206:207], v[34:35], v[206:207] op_sel:[1,0] op_sel_hi:[1,1]
v_cvt_pk_bf16_f32 v204, v204, v205
v_cvt_pk_bf16_f32 v205, v206, v207
ds_write_b64 v14, v[204:205] offset:6656
v_pk_fma_f32 v[136:137], v[36:37], v[52:53], v[136:137] op_sel_hi:[0,1,1] neg_lo:[1,0,0] neg_hi:[1,0,0]
v_pk_fma_f32 v[138:139], v[36:37], v[54:55], v[138:139] op_sel_hi:[0,1,1] neg_lo:[1,0,0] neg_hi:[1,0,0]
v_pk_mul_f32 v[136:137], v[36:37], v[136:137] op_sel:[1,0] op_sel_hi:[1,1]
v_pk_mul_f32 v[138:139], v[36:37], v[138:139] op_sel:[1,0] op_sel_hi:[1,1]
v_cvt_pk_bf16_f32 v136, v136, v137
v_cvt_pk_bf16_f32 v137, v138, v139
ds_write_b64 v14, v[136:137] offset:12800
v_pk_fma_f32 v[172:173], v[36:37], v[56:57], v[172:173] op_sel_hi:[0,1,1] neg_lo:[1,0,0] neg_hi:[1,0,0]
v_pk_fma_f32 v[174:175], v[36:37], v[58:59], v[174:175] op_sel_hi:[0,1,1] neg_lo:[1,0,0] neg_hi:[1,0,0]
v_pk_mul_f32 v[172:173], v[36:37], v[172:173] op_sel:[1,0] op_sel_hi:[1,1]
v_pk_mul_f32 v[174:175], v[36:37], v[174:175] op_sel:[1,0] op_sel_hi:[1,1]
v_cvt_pk_bf16_f32 v172, v172, v173
v_cvt_pk_bf16_f32 v173, v174, v175
ds_write_b64 v14, v[172:173] offset:12928
v_pk_fma_f32 v[208:209], v[36:37], v[60:61], v[208:209] op_sel_hi:[0,1,1] neg_lo:[1,0,0] neg_hi:[1,0,0]
v_pk_fma_f32 v[210:211], v[36:37], v[62:63], v[210:211] op_sel_hi:[0,1,1] neg_lo:[1,0,0] neg_hi:[1,0,0]
v_pk_mul_f32 v[208:209], v[36:37], v[208:209] op_sel:[1,0] op_sel_hi:[1,1]
v_pk_mul_f32 v[210:211], v[36:37], v[210:211] op_sel:[1,0] op_sel_hi:[1,1]
v_cvt_pk_bf16_f32 v208, v208, v209
v_cvt_pk_bf16_f32 v209, v210, v211
ds_write_b64 v14, v[208:209] offset:13056
v_pk_fma_f32 v[140:141], v[38:39], v[52:53], v[140:141] op_sel_hi:[0,1,1] neg_lo:[1,0,0] neg_hi:[1,0,0]
v_pk_fma_f32 v[142:143], v[38:39], v[54:55], v[142:143] op_sel_hi:[0,1,1] neg_lo:[1,0,0] neg_hi:[1,0,0]
v_pk_mul_f32 v[140:141], v[38:39], v[140:141] op_sel:[1,0] op_sel_hi:[1,1]
v_pk_mul_f32 v[142:143], v[38:39], v[142:143] op_sel:[1,0] op_sel_hi:[1,1]
v_cvt_pk_bf16_f32 v140, v140, v141
v_cvt_pk_bf16_f32 v141, v142, v143
ds_write_b64 v14, v[140:141] offset:19200
v_pk_fma_f32 v[176:177], v[38:39], v[56:57], v[176:177] op_sel_hi:[0,1,1] neg_lo:[1,0,0] neg_hi:[1,0,0]
v_pk_fma_f32 v[178:179], v[38:39], v[58:59], v[178:179] op_sel_hi:[0,1,1] neg_lo:[1,0,0] neg_hi:[1,0,0]
v_pk_mul_f32 v[176:177], v[38:39], v[176:177] op_sel:[1,0] op_sel_hi:[1,1]
v_pk_mul_f32 v[178:179], v[38:39], v[178:179] op_sel:[1,0] op_sel_hi:[1,1]
v_cvt_pk_bf16_f32 v176, v176, v177
v_cvt_pk_bf16_f32 v177, v178, v179
ds_write_b64 v14, v[176:177] offset:19328
v_pk_fma_f32 v[212:213], v[38:39], v[60:61], v[212:213] op_sel_hi:[0,1,1] neg_lo:[1,0,0] neg_hi:[1,0,0]
v_pk_fma_f32 v[214:215], v[38:39], v[62:63], v[214:215] op_sel_hi:[0,1,1] neg_lo:[1,0,0] neg_hi:[1,0,0]
v_pk_mul_f32 v[212:213], v[38:39], v[212:213] op_sel:[1,0] op_sel_hi:[1,1]
v_pk_mul_f32 v[214:215], v[38:39], v[214:215] op_sel:[1,0] op_sel_hi:[1,1]
v_cvt_pk_bf16_f32 v212, v212, v213
v_cvt_pk_bf16_f32 v213, v214, v215
ds_write_b64 v14, v[212:213] offset:19456
v_pk_fma_f32 v[144:145], v[40:41], v[52:53], v[144:145] op_sel_hi:[0,1,1] neg_lo:[1,0,0] neg_hi:[1,0,0]
v_pk_fma_f32 v[146:147], v[40:41], v[54:55], v[146:147] op_sel_hi:[0,1,1] neg_lo:[1,0,0] neg_hi:[1,0,0]
v_pk_mul_f32 v[144:145], v[40:41], v[144:145] op_sel:[1,0] op_sel_hi:[1,1]
v_pk_mul_f32 v[146:147], v[40:41], v[146:147] op_sel:[1,0] op_sel_hi:[1,1]
v_cvt_pk_bf16_f32 v144, v144, v145
v_cvt_pk_bf16_f32 v145, v146, v147
ds_write_b64 v14, v[144:145] offset:25600
v_pk_fma_f32 v[180:181], v[40:41], v[56:57], v[180:181] op_sel_hi:[0,1,1] neg_lo:[1,0,0] neg_hi:[1,0,0]
v_pk_fma_f32 v[182:183], v[40:41], v[58:59], v[182:183] op_sel_hi:[0,1,1] neg_lo:[1,0,0] neg_hi:[1,0,0]
v_pk_mul_f32 v[180:181], v[40:41], v[180:181] op_sel:[1,0] op_sel_hi:[1,1]
v_pk_mul_f32 v[182:183], v[40:41], v[182:183] op_sel:[1,0] op_sel_hi:[1,1]
v_cvt_pk_bf16_f32 v180, v180, v181
v_cvt_pk_bf16_f32 v181, v182, v183
ds_write_b64 v14, v[180:181] offset:25728
v_pk_fma_f32 v[216:217], v[40:41], v[60:61], v[216:217] op_sel_hi:[0,1,1] neg_lo:[1,0,0] neg_hi:[1,0,0]
v_pk_fma_f32 v[218:219], v[40:41], v[62:63], v[218:219] op_sel_hi:[0,1,1] neg_lo:[1,0,0] neg_hi:[1,0,0]
v_pk_mul_f32 v[216:217], v[40:41], v[216:217] op_sel:[1,0] op_sel_hi:[1,1]
v_pk_mul_f32 v[218:219], v[40:41], v[218:219] op_sel:[1,0] op_sel_hi:[1,1]
v_cvt_pk_bf16_f32 v216, v216, v217
v_cvt_pk_bf16_f32 v217, v218, v219
ds_write_b64 v14, v[216:217] offset:25856
v_pk_fma_f32 v[148:149], v[42:43], v[52:53], v[148:149] op_sel_hi:[0,1,1] neg_lo:[1,0,0] neg_hi:[1,0,0]
v_pk_fma_f32 v[150:151], v[42:43], v[54:55], v[150:151] op_sel_hi:[0,1,1] neg_lo:[1,0,0] neg_hi:[1,0,0]
v_pk_mul_f32 v[148:149], v[42:43], v[148:149] op_sel:[1,0] op_sel_hi:[1,1]
v_pk_mul_f32 v[150:151], v[42:43], v[150:151] op_sel:[1,0] op_sel_hi:[1,1]
v_cvt_pk_bf16_f32 v148, v148, v149
v_cvt_pk_bf16_f32 v149, v150, v151
ds_write_b64 v14, v[148:149] offset:32000
v_pk_fma_f32 v[184:185], v[42:43], v[56:57], v[184:185] op_sel_hi:[0,1,1] neg_lo:[1,0,0] neg_hi:[1,0,0]
v_pk_fma_f32 v[186:187], v[42:43], v[58:59], v[186:187] op_sel_hi:[0,1,1] neg_lo:[1,0,0] neg_hi:[1,0,0]
v_pk_mul_f32 v[184:185], v[42:43], v[184:185] op_sel:[1,0] op_sel_hi:[1,1]
v_pk_mul_f32 v[186:187], v[42:43], v[186:187] op_sel:[1,0] op_sel_hi:[1,1]
v_cvt_pk_bf16_f32 v184, v184, v185
v_cvt_pk_bf16_f32 v185, v186, v187
ds_write_b64 v14, v[184:185] offset:32128
v_pk_fma_f32 v[220:221], v[42:43], v[60:61], v[220:221] op_sel_hi:[0,1,1] neg_lo:[1,0,0] neg_hi:[1,0,0]
v_pk_fma_f32 v[222:223], v[42:43], v[62:63], v[222:223] op_sel_hi:[0,1,1] neg_lo:[1,0,0] neg_hi:[1,0,0]
v_pk_mul_f32 v[220:221], v[42:43], v[220:221] op_sel:[1,0] op_sel_hi:[1,1]
v_pk_mul_f32 v[222:223], v[42:43], v[222:223] op_sel:[1,0] op_sel_hi:[1,1]
v_cvt_pk_bf16_f32 v220, v220, v221
v_cvt_pk_bf16_f32 v221, v222, v223
ds_write_b64 v14, v[220:221] offset:32256
v_pk_fma_f32 v[152:153], v[44:45], v[52:53], v[152:153] op_sel_hi:[0,1,1] neg_lo:[1,0,0] neg_hi:[1,0,0]
v_pk_fma_f32 v[154:155], v[44:45], v[54:55], v[154:155] op_sel_hi:[0,1,1] neg_lo:[1,0,0] neg_hi:[1,0,0]
v_pk_mul_f32 v[152:153], v[44:45], v[152:153] op_sel:[1,0] op_sel_hi:[1,1]
v_pk_mul_f32 v[154:155], v[44:45], v[154:155] op_sel:[1,0] op_sel_hi:[1,1]
v_cvt_pk_bf16_f32 v152, v152, v153
v_cvt_pk_bf16_f32 v153, v154, v155
ds_write_b64 v14, v[152:153] offset:38400
v_pk_fma_f32 v[188:189], v[44:45], v[56:57], v[188:189] op_sel_hi:[0,1,1] neg_lo:[1,0,0] neg_hi:[1,0,0]
v_pk_fma_f32 v[190:191], v[44:45], v[58:59], v[190:191] op_sel_hi:[0,1,1] neg_lo:[1,0,0] neg_hi:[1,0,0]
v_pk_mul_f32 v[188:189], v[44:45], v[188:189] op_sel:[1,0] op_sel_hi:[1,1]
v_pk_mul_f32 v[190:191], v[44:45], v[190:191] op_sel:[1,0] op_sel_hi:[1,1]
v_cvt_pk_bf16_f32 v188, v188, v189
v_cvt_pk_bf16_f32 v189, v190, v191
ds_write_b64 v14, v[188:189] offset:38528
v_pk_fma_f32 v[224:225], v[44:45], v[60:61], v[224:225] op_sel_hi:[0,1,1] neg_lo:[1,0,0] neg_hi:[1,0,0]
v_pk_fma_f32 v[226:227], v[44:45], v[62:63], v[226:227] op_sel_hi:[0,1,1] neg_lo:[1,0,0] neg_hi:[1,0,0]
v_pk_mul_f32 v[224:225], v[44:45], v[224:225] op_sel:[1,0] op_sel_hi:[1,1]
v_pk_mul_f32 v[226:227], v[44:45], v[226:227] op_sel:[1,0] op_sel_hi:[1,1]
v_cvt_pk_bf16_f32 v224, v224, v225
v_cvt_pk_bf16_f32 v225, v226, v227
ds_write_b64 v14, v[224:225] offset:38656
v_pk_fma_f32 v[156:157], v[46:47], v[52:53], v[156:157] op_sel_hi:[0,1,1] neg_lo:[1,0,0] neg_hi:[1,0,0]
v_pk_fma_f32 v[158:159], v[46:47], v[54:55], v[158:159] op_sel_hi:[0,1,1] neg_lo:[1,0,0] neg_hi:[1,0,0]
v_pk_mul_f32 v[156:157], v[46:47], v[156:157] op_sel:[1,0] op_sel_hi:[1,1]
v_pk_mul_f32 v[158:159], v[46:47], v[158:159] op_sel:[1,0] op_sel_hi:[1,1]
v_cvt_pk_bf16_f32 v156, v156, v157
v_cvt_pk_bf16_f32 v157, v158, v159
ds_write_b64 v14, v[156:157] offset:44800
v_pk_fma_f32 v[192:193], v[46:47], v[56:57], v[192:193] op_sel_hi:[0,1,1] neg_lo:[1,0,0] neg_hi:[1,0,0]
v_pk_fma_f32 v[194:195], v[46:47], v[58:59], v[194:195] op_sel_hi:[0,1,1] neg_lo:[1,0,0] neg_hi:[1,0,0]
v_pk_mul_f32 v[192:193], v[46:47], v[192:193] op_sel:[1,0] op_sel_hi:[1,1]
v_pk_mul_f32 v[194:195], v[46:47], v[194:195] op_sel:[1,0] op_sel_hi:[1,1]
v_cvt_pk_bf16_f32 v192, v192, v193
v_cvt_pk_bf16_f32 v193, v194, v195
ds_write_b64 v14, v[192:193] offset:44928
v_pk_fma_f32 v[228:229], v[46:47], v[60:61], v[228:229] op_sel_hi:[0,1,1] neg_lo:[1,0,0] neg_hi:[1,0,0]
v_pk_fma_f32 v[230:231], v[46:47], v[62:63], v[230:231] op_sel_hi:[0,1,1] neg_lo:[1,0,0] neg_hi:[1,0,0]
v_pk_mul_f32 v[228:229], v[46:47], v[228:229] op_sel:[1,0] op_sel_hi:[1,1]
v_pk_mul_f32 v[230:231], v[46:47], v[230:231] op_sel:[1,0] op_sel_hi:[1,1]
v_cvt_pk_bf16_f32 v228, v228, v229
v_cvt_pk_bf16_f32 v229, v230, v231
ds_write_b64 v14, v[228:229] offset:45056
v_pk_fma_f32 v[160:161], v[48:49], v[52:53], v[160:161] op_sel_hi:[0,1,1] neg_lo:[1,0,0] neg_hi:[1,0,0]
v_pk_fma_f32 v[162:163], v[48:49], v[54:55], v[162:163] op_sel_hi:[0,1,1] neg_lo:[1,0,0] neg_hi:[1,0,0]
v_pk_mul_f32 v[160:161], v[48:49], v[160:161] op_sel:[1,0] op_sel_hi:[1,1]
v_pk_mul_f32 v[162:163], v[48:49], v[162:163] op_sel:[1,0] op_sel_hi:[1,1]
v_cvt_pk_bf16_f32 v160, v160, v161
v_cvt_pk_bf16_f32 v161, v162, v163
ds_write_b64 v14, v[160:161] offset:51200
v_pk_fma_f32 v[196:197], v[48:49], v[56:57], v[196:197] op_sel_hi:[0,1,1] neg_lo:[1,0,0] neg_hi:[1,0,0]
v_pk_fma_f32 v[198:199], v[48:49], v[58:59], v[198:199] op_sel_hi:[0,1,1] neg_lo:[1,0,0] neg_hi:[1,0,0]
v_pk_mul_f32 v[196:197], v[48:49], v[196:197] op_sel:[1,0] op_sel_hi:[1,1]
v_pk_mul_f32 v[198:199], v[48:49], v[198:199] op_sel:[1,0] op_sel_hi:[1,1]
v_cvt_pk_bf16_f32 v196, v196, v197
v_cvt_pk_bf16_f32 v197, v198, v199
ds_write_b64 v14, v[196:197] offset:51328
v_pk_fma_f32 v[232:233], v[48:49], v[60:61], v[232:233] op_sel_hi:[0,1,1] neg_lo:[1,0,0] neg_hi:[1,0,0]
v_pk_fma_f32 v[234:235], v[48:49], v[62:63], v[234:235] op_sel_hi:[0,1,1] neg_lo:[1,0,0] neg_hi:[1,0,0]
v_pk_mul_f32 v[232:233], v[48:49], v[232:233] op_sel:[1,0] op_sel_hi:[1,1]
v_pk_mul_f32 v[234:235], v[48:49], v[234:235] op_sel:[1,0] op_sel_hi:[1,1]
v_cvt_pk_bf16_f32 v232, v232, v233
v_cvt_pk_bf16_f32 v233, v234, v235
ds_write_b64 v14, v[232:233] offset:51456
s_waitcnt lgkmcnt(0)
s_branch Latt_4
Lprod_2:
s_sub_u32 s47, s36, 4
s_lshl_b32 s43, s34, 7
s_lshl_b32 s44, s35, 3
s_add_u32 s43, s43, s44
s_mov_b32 s63, s43
s_lshl_b32 s44, s47, 1
s_add_u32 s51, s43, s44
v_lshlrev_b32 v10, 4, v1
s_add_u32 s20, s32, 26214400
s_addc_u32 s21, s33, 0
s_mov_b32 s22, 16384
s_mov_b32 s23, 0x20000
s_cmp_eq_u32 s47, 3
s_cbranch_scc1 Lpf_3
v_lshrrev_b32 v14, 3, v1
v_and_b32 v15, 7, v1
v_and_b32 v16, 2, v14
v_xor_b32 v16, v15, v16
v_lshlrev_b32 v16, 4, v16
v_mul_u32_u24 v17, 6144, v14
s_lshl_b32 s43, s47, 11
v_add3_u32 v2, v17, v16, s43
v_xor_b32 v3, 64, v2
v_lshrrev_b32 v16, 1, v14
v_xor_b32 v16, v15, v16
v_lshlrev_b32 v16, 4, v16
s_lshl_b32 s43, s47, 3
s_add_u32 s43, s43, s50
v_add_u32 v17, s43, v14
s_and_b32 s44, s47, 1
s_lshl_b32 s44, s44, 6
v_add_u32 v18, 0, v17
v_max_i32 v18, 0, v18
v_lshl_add_u32 v18, v18, 11, v16
v_xor_b32 v18, s44, v18
v_mov_b32 v4, v18
v_add_u32 v18, 24, v17
v_max_i32 v18, 0, v18
v_lshl_add_u32 v18, v18, 11, v16
v_xor_b32 v18, s44, v18
v_xor_b32 v5, 64, v18
v_add_u32 v18, 48, v17
v_max_i32 v18, 0, v18
v_lshl_add_u32 v18, v18, 11, v16
v_xor_b32 v18, s44, v18
v_mov_b32 v6, v18
v_add_u32 v18, 72, v17
v_max_i32 v18, 0, v18
v_lshl_add_u32 v18, v18, 11, v16
v_xor_b32 v18, s44, v18
v_xor_b32 v7, 64, v18
v_add_u32 v18, 96, v17
v_max_i32 v18, 0, v18
v_lshl_add_u32 v18, v18, 11, v16
v_xor_b32 v18, s44, v18
v_mov_b32 v8, v18
v_add_u32 v18, 120, v17
v_max_i32 v18, 0, v18
v_lshl_add_u32 v18, v18, 11, v16
v_xor_b32 v18, s44, v18
v_xor_b32 v9, 64, v18
s_lshl_b32 s39, s47, 10
s_lshl_b32 s40, s47, 13
s_add_u32 s40, s40, 18432
s_mov_b32 s37, 0
s_mov_b32 s38, 0
s_bfm_b64 s[60:61], 56, 8
s_cmp_eq_u32 s47, 0
s_cselect_b64 s[60:61], s[60:61], -1
s_add_u32 m0, s39, 0
s_mov_b64 exec, s[60:61]
buffer_load_dwordx4 v4, s[8:11], s37 offen lds
s_mov_b64 exec, -1
s_add_u32 m0, s39, 3072
s_nop 0
buffer_load_dwordx4 v5, s[8:11], s37 offen lds
s_add_u32 m0, s39, 6144
s_nop 0
buffer_load_dwordx4 v6, s[8:11], s37 offen lds
s_add_u32 m0, s39, 9216
s_nop 0
buffer_load_dwordx4 v7, s[8:11], s37 offen lds
s_add_u32 m0, s39, 12288
s_nop 0
buffer_load_dwordx4 v8, s[8:11], s37 offen lds
s_add_u32 m0, s39, 15360
s_nop 0
buffer_load_dwordx4 v9, s[8:11], s37 offen lds
s_add_u32 m0, s40, 0
s_add_u32 s43, s38, 0
buffer_load_dwordx4 v2, s[12:15], s43 offen lds
s_add_u32 m0, s40, 1024
s_add_u32 s43, s38, 49152
buffer_load_dwordx4 v3, s[12:15], s43 offen lds
s_add_u32 m0, s40, 2048
s_add_u32 s43, s38, 98304
buffer_load_dwordx4 v2, s[12:15], s43 offen lds
s_add_u32 m0, s40, 3072
s_add_u32 s43, s38, 147456
buffer_load_dwordx4 v3, s[12:15], s43 offen lds
s_add_u32 m0, s40, 4096
s_add_u32 s43, s38, 196608
buffer_load_dwordx4 v2, s[12:15], s43 offen lds
s_add_u32 m0, s40, 5120
s_add_u32 s43, s38, 245760
buffer_load_dwordx4 v3, s[12:15], s43 offen lds
s_add_u32 m0, s40, 6144
s_add_u32 s43, s38, 294912
buffer_load_dwordx4 v2, s[12:15], s43 offen lds
s_add_u32 m0, s40, 7168
s_add_u32 s43, s38, 344064
buffer_load_dwordx4 v3, s[12:15], s43 offen lds
s_add_u32 s37, s37, 128
s_add_u32 s38, s38, 393216
s_add_u32 m0, s39, 43008
s_mov_b64 exec, s[60:61]
buffer_load_dwordx4 v4, s[8:11], s37 offen lds
s_mov_b64 exec, -1
s_add_u32 m0, s39, 46080
s_nop 0
buffer_load_dwordx4 v5, s[8:11], s37 offen lds
s_add_u32 m0, s39, 49152
s_nop 0
buffer_load_dwordx4 v6, s[8:11], s37 offen lds
s_add_u32 m0, s39, 52224
s_nop 0
buffer_load_dwordx4 v7, s[8:11], s37 offen lds
s_add_u32 m0, s39, 55296
s_nop 0
buffer_load_dwordx4 v8, s[8:11], s37 offen lds
s_add_u32 m0, s39, 58368
s_nop 0
buffer_load_dwordx4 v9, s[8:11], s37 offen lds
s_add_u32 m0, s40, 43008
s_add_u32 s43, s38, 0
buffer_load_dwordx4 v2, s[12:15], s43 offen lds
s_add_u32 m0, s40, 44032
s_add_u32 s43, s38, 49152
buffer_load_dwordx4 v3, s[12:15], s43 offen lds
s_add_u32 m0, s40, 45056
s_add_u32 s43, s38, 98304
buffer_load_dwordx4 v2, s[12:15], s43 offen lds
s_add_u32 m0, s40, 46080
s_add_u32 s43, s38, 147456
buffer_load_dwordx4 v3, s[12:15], s43 offen lds
s_add_u32 m0, s40, 47104
s_add_u32 s43, s38, 196608
buffer_load_dwordx4 v2, s[12:15], s43 offen lds
s_add_u32 m0, s40, 48128
s_add_u32 s43, s38, 245760
buffer_load_dwordx4 v3, s[12:15], s43 offen lds
s_add_u32 m0, s40, 49152
s_add_u32 s43, s38, 294912
buffer_load_dwordx4 v2, s[12:15], s43 offen lds
s_add_u32 m0, s40, 50176
s_add_u32 s43, s38, 344064
buffer_load_dwordx4 v3, s[12:15], s43 offen lds
s_add_u32 s37, s37, 128
s_add_u32 s38, s38, 393216
s_add_u32 m0, s39, 86016
s_mov_b64 exec, s[60:61]
buffer_load_dwordx4 v4, s[8:11], s37 offen lds
s_mov_b64 exec, -1
s_add_u32 m0, s39, 89088
s_nop 0
buffer_load_dwordx4 v5, s[8:11], s37 offen lds
s_add_u32 m0, s39, 92160
s_nop 0
buffer_load_dwordx4 v6, s[8:11], s37 offen lds
s_add_u32 m0, s39, 95232
s_nop 0
buffer_load_dwordx4 v7, s[8:11], s37 offen lds
s_add_u32 m0, s39, 98304
s_nop 0
buffer_load_dwordx4 v8, s[8:11], s37 offen lds
s_add_u32 m0, s39, 101376
s_nop 0
buffer_load_dwordx4 v9, s[8:11], s37 offen lds
s_add_u32 m0, s40, 86016
s_add_u32 s43, s38, 0
buffer_load_dwordx4 v2, s[12:15], s43 offen lds
s_add_u32 m0, s40, 87040
s_add_u32 s43, s38, 49152
buffer_load_dwordx4 v3, s[12:15], s43 offen lds
s_add_u32 m0, s40, 88064
s_add_u32 s43, s38, 98304
buffer_load_dwordx4 v2, s[12:15], s43 offen lds
s_add_u32 m0, s40, 89088
s_add_u32 s43, s38, 147456
buffer_load_dwordx4 v3, s[12:15], s43 offen lds
s_add_u32 m0, s40, 90112
s_add_u32 s43, s38, 196608
buffer_load_dwordx4 v2, s[12:15], s43 offen lds
s_add_u32 m0, s40, 91136
s_add_u32 s43, s38, 245760
buffer_load_dwordx4 v3, s[12:15], s43 offen lds
s_add_u32 m0, s40, 92160
s_add_u32 s43, s38, 294912
buffer_load_dwordx4 v2, s[12:15], s43 offen lds
s_add_u32 m0, s40, 93184
s_add_u32 s43, s38, 344064
buffer_load_dwordx4 v3, s[12:15], s43 offen lds
s_add_u32 s37, s37, 128
s_add_u32 s38, s38, 393216
s_lshl_b32 s43, s51, 11
buffer_load_dwordx4 v[96:99], v10, s[8:11], s43 offen offset:0
buffer_load_dwordx4 v[100:103], v10, s[8:11], s43 offen offset:1024
buffer_load_dwordx4 v[104:107], v10, s[8:11], s43 offen offset:2048
buffer_load_dwordx4 v[108:111], v10, s[8:11], s43 offen offset:3072
s_waitcnt vmcnt(32)
s_barrier
s_lshr_b32 s43, s2, 5
s_cmp_eq_u32 s43, 3
s_cbranch_scc1 Lsj_6
s_cmp_gt_u32 s43, 3
s_cselect_b32 s43, 32, 0
s_sub_u32 s43, s2, s43
s_lshr_b32 s43, s43, 1
s_and_b32 s44, s2, 1
s_lshl_b32 s44, s44, 3
s_add_u32 s44, s44, 32
s_load_dwordx2 s[80:81], s[0:1], s44
s_mul_i32 s45, s43, 2341
s_lshr_b32 s45, s45, 16
s_mul_i32 s46, s45, 28
s_sub_u32 s46, s43, s46
s_lshl_b32 s45, s45, 8
s_mul_i32 s44, s47, 36
s_add_u32 s45, s45, s44
s_add_u32 s45, s45, 128
s_mul_i32 s45, s45, 7168
s_lshl_b32 s46, s46, 8
s_add_u32 s45, s45, s46
s_waitcnt lgkmcnt(0)
s_add_u32 s80, s80, s45
s_addc_u32 s81, s81, 0
Lsj_6:
s_waitcnt vmcnt(18)
s_barrier
s_add_u32 m0, s39, 0
s_mov_b64 exec, s[60:61]
buffer_load_dwordx4 v4, s[8:11], s37 offen lds
s_mov_b64 exec, -1
s_add_u32 m0, s39, 3072
s_nop 0
buffer_load_dwordx4 v5, s[8:11], s37 offen lds
s_add_u32 m0, s39, 6144
s_nop 0
buffer_load_dwordx4 v6, s[8:11], s37 offen lds
s_add_u32 m0, s39, 9216
s_nop 0
buffer_load_dwordx4 v7, s[8:11], s37 offen lds
s_add_u32 m0, s39, 12288
s_nop 0
buffer_load_dwordx4 v8, s[8:11], s37 offen lds
s_add_u32 m0, s39, 15360
s_nop 0
buffer_load_dwordx4 v9, s[8:11], s37 offen lds
s_add_u32 m0, s40, 0
s_add_u32 s43, s38, 0
buffer_load_dwordx4 v2, s[12:15], s43 offen lds
s_add_u32 m0, s40, 1024
s_add_u32 s43, s38, 49152
buffer_load_dwordx4 v3, s[12:15], s43 offen lds
s_add_u32 m0, s40, 2048
s_add_u32 s43, s38, 98304
buffer_load_dwordx4 v2, s[12:15], s43 offen lds
s_add_u32 m0, s40, 3072
s_add_u32 s43, s38, 147456
buffer_load_dwordx4 v3, s[12:15], s43 offen lds
s_add_u32 m0, s40, 4096
s_add_u32 s43, s38, 196608
buffer_load_dwordx4 v2, s[12:15], s43 offen lds
s_add_u32 m0, s40, 5120
s_add_u32 s43, s38, 245760
buffer_load_dwordx4 v3, s[12:15], s43 offen lds
s_add_u32 m0, s40, 6144
s_add_u32 s43, s38, 294912
buffer_load_dwordx4 v2, s[12:15], s43 offen lds
s_add_u32 m0, s40, 7168
s_add_u32 s43, s38, 344064
buffer_load_dwordx4 v3, s[12:15], s43 offen lds
s_add_u32 s37, s37, 128
s_add_u32 s38, s38, 393216
s_waitcnt vmcnt(14)
s_barrier
s_add_u32 m0, s39, 43008
s_mov_b64 exec, s[60:61]
buffer_load_dwordx4 v4, s[8:11], s37 offen lds
s_mov_b64 exec, -1
s_add_u32 m0, s39, 46080
s_nop 0
buffer_load_dwordx4 v5, s[8:11], s37 offen lds
s_add_u32 m0, s39, 49152
s_nop 0
buffer_load_dwordx4 v6, s[8:11], s37 offen lds
s_add_u32 m0, s39, 52224
s_nop 0
buffer_load_dwordx4 v7, s[8:11], s37 offen lds
s_add_u32 m0, s39, 55296
s_nop 0
buffer_load_dwordx4 v8, s[8:11], s37 offen lds
s_add_u32 m0, s39, 58368
s_nop 0
buffer_load_dwordx4 v9, s[8:11], s37 offen lds
s_add_u32 m0, s40, 43008
s_add_u32 s43, s38, 0
buffer_load_dwordx4 v2, s[12:15], s43 offen lds
s_add_u32 m0, s40, 44032
s_add_u32 s43, s38, 49152
buffer_load_dwordx4 v3, s[12:15], s43 offen lds
s_add_u32 m0, s40, 45056
s_add_u32 s43, s38, 98304
buffer_load_dwordx4 v2, s[12:15], s43 offen lds
s_add_u32 m0, s40, 46080
s_add_u32 s43, s38, 147456
buffer_load_dwordx4 v3, s[12:15], s43 offen lds
s_add_u32 m0, s40, 47104
s_add_u32 s43, s38, 196608
buffer_load_dwordx4 v2, s[12:15], s43 offen lds
s_add_u32 m0, s40, 48128
s_add_u32 s43, s38, 245760
buffer_load_dwordx4 v3, s[12:15], s43 offen lds
s_add_u32 m0, s40, 49152
s_add_u32 s43, s38, 294912
buffer_load_dwordx4 v2, s[12:15], s43 offen lds
s_add_u32 m0, s40, 50176
s_add_u32 s43, s38, 344064
buffer_load_dwordx4 v3, s[12:15], s43 offen lds
s_add_u32 s37, s37, 128
s_add_u32 s38, s38, 393216
v_lshlrev_b32 v124, 16, v96
v_and_b32 v125, 0xffff0000, v96
v_mov_b32 v116, v124
v_mov_b32 v117, v125
v_mul_f32 v118, v124, v124
v_mul_f32 v119, v125, v125
v_lshlrev_b32 v126, 16, v97
v_and_b32 v127, 0xffff0000, v97
v_add_f32 v116, v116, v126
v_add_f32 v117, v117, v127
v_fmac_f32 v118, v126, v126
v_fmac_f32 v119, v127, v127
v_lshlrev_b32 v124, 16, v98
v_and_b32 v125, 0xffff0000, v98
v_add_f32 v116, v116, v124
v_add_f32 v117, v117, v125
v_fmac_f32 v118, v124, v124
v_fmac_f32 v119, v125, v125
v_lshlrev_b32 v126, 16, v99
v_and_b32 v127, 0xffff0000, v99
v_add_f32 v116, v116, v126
v_add_f32 v117, v117, v127
v_fmac_f32 v118, v126, v126
v_fmac_f32 v119, v127, v127
v_lshlrev_b32 v124, 16, v100
v_and_b32 v125, 0xffff0000, v100
v_add_f32 v116, v116, v124
v_add_f32 v117, v117, v125
v_fmac_f32 v118, v124, v124
v_fmac_f32 v119, v125, v125
v_lshlrev_b32 v126, 16, v101
v_and_b32 v127, 0xffff0000, v101
v_add_f32 v116, v116, v126
v_add_f32 v117, v117, v127
v_fmac_f32 v118, v126, v126
v_fmac_f32 v119, v127, v127
v_lshlrev_b32 v124, 16, v102
v_and_b32 v125, 0xffff0000, v102
v_add_f32 v116, v116, v124
v_add_f32 v117, v117, v125
v_fmac_f32 v118, v124, v124
v_fmac_f32 v119, v125, v125
v_lshlrev_b32 v126, 16, v103
v_and_b32 v127, 0xffff0000, v103
v_add_f32 v116, v116, v126
v_add_f32 v117, v117, v127
v_fmac_f32 v118, v126, v126
v_fmac_f32 v119, v127, v127
v_lshlrev_b32 v124, 16, v104
v_and_b32 v125, 0xffff0000, v104
v_mov_b32 v120, v124
v_mov_b32 v121, v125
v_mul_f32 v122, v124, v124
v_mul_f32 v123, v125, v125
v_lshlrev_b32 v126, 16, v105
v_and_b32 v127, 0xffff0000, v105
v_add_f32 v120, v120, v126
v_add_f32 v121, v121, v127
v_fmac_f32 v122, v126, v126
v_fmac_f32 v123, v127, v127
v_lshlrev_b32 v124, 16, v106
v_and_b32 v125, 0xffff0000, v106
v_add_f32 v120, v120, v124
v_add_f32 v121, v121, v125
v_fmac_f32 v122, v124, v124
v_fmac_f32 v123, v125, v125
v_lshlrev_b32 v126, 16, v107
v_and_b32 v127, 0xffff0000, v107
v_add_f32 v120, v120, v126
v_add_f32 v121, v121, v127
v_fmac_f32 v122, v126, v126
v_fmac_f32 v123, v127, v127
v_lshlrev_b32 v124, 16, v108
v_and_b32 v125, 0xffff0000, v108
v_add_f32 v120, v120, v124
v_add_f32 v121, v121, v125
v_fmac_f32 v122, v124, v124
v_fmac_f32 v123, v125, v125
v_lshlrev_b32 v126, 16, v109
v_and_b32 v127, 0xffff0000, v109
v_add_f32 v120, v120, v126
v_add_f32 v121, v121, v127
v_fmac_f32 v122, v126, v126
v_fmac_f32 v123, v127, v127
v_lshlrev_b32 v124, 16, v110
v_and_b32 v125, 0xffff0000, v110
v_add_f32 v120, v120, v124
v_add_f32 v121, v121, v125
v_fmac_f32 v122, v124, v124
v_fmac_f32 v123, v125, v125
v_lshlrev_b32 v126, 16, v111
v_and_b32 v127, 0xffff0000, v111
v_add_f32 v120, v120, v126
v_add_f32 v121, v121, v127
v_fmac_f32 v122, v126, v126
v_fmac_f32 v123, v127, v127
v_add_f32 v116, v116, v117
v_add_f32 v118, v118, v119
v_add_f32 v120, v120, v121
v_add_f32 v122, v122, v123
s_nop 0
v_add_f32_dpp v116, v116, v116 row_ror:8 row_mask:0xf bank_mask:0xf
v_add_f32_dpp v118, v118, v118 row_ror:8 row_mask:0xf bank_mask:0xf
v_add_f32_dpp v120, v120, v120 row_ror:8 row_mask:0xf bank_mask:0xf
v_add_f32_dpp v122, v122, v122 row_ror:8 row_mask:0xf bank_mask:0xf
v_add_f32_dpp v116, v116, v116 row_ror:4 row_mask:0xf bank_mask:0xf
v_add_f32_dpp v118, v118, v118 row_ror:4 row_mask:0xf bank_mask:0xf
v_add_f32_dpp v120, v120, v120 row_ror:4 row_mask:0xf bank_mask:0xf
v_add_f32_dpp v122, v122, v122 row_ror:4 row_mask:0xf bank_mask:0xf
v_add_f32_dpp v116, v116, v116 row_ror:2 row_mask:0xf bank_mask:0xf
v_add_f32_dpp v118, v118, v118 row_ror:2 row_mask:0xf bank_mask:0xf
v_add_f32_dpp v120, v120, v120 row_ror:2 row_mask:0xf bank_mask:0xf
v_add_f32_dpp v122, v122, v122 row_ror:2 row_mask:0xf bank_mask:0xf
v_add_f32_dpp v116, v116, v116 row_ror:1 row_mask:0xf bank_mask:0xf
v_add_f32_dpp v118, v118, v118 row_ror:1 row_mask:0xf bank_mask:0xf
v_add_f32_dpp v120, v120, v120 row_ror:1 row_mask:0xf bank_mask:0xf
v_add_f32_dpp v122, v122, v122 row_ror:1 row_mask:0xf bank_mask:0xf
v_mov_b32 v117, v116
v_mov_b32 v119, v118
v_mov_b32 v121, v120
v_mov_b32 v123, v122
s_nop 0
v_permlane16_swap_b32 v116, v117
v_permlane16_swap_b32 v118, v119
v_permlane16_swap_b32 v120, v121
v_permlane16_swap_b32 v122, v123
v_add_f32 v116, v116, v117
v_add_f32 v118, v118, v119
v_add_f32 v120, v120, v121
v_add_f32 v122, v122, v123
v_mov_b32 v117, v116
v_mov_b32 v119, v118
v_mov_b32 v121, v120
v_mov_b32 v123, v122
s_nop 0
v_permlane32_swap_b32 v116, v117
v_permlane32_swap_b32 v118, v119
v_permlane32_swap_b32 v120, v121
v_permlane32_swap_b32 v122, v123
v_add_f32 v116, v116, v117
v_add_f32 v118, v118, v119
v_add_f32 v120, v120, v121
v_add_f32 v122, v122, v123
v_mul_f32 v112, 0x3a800000, v116
v_mul_f32 v113, 0x3a800000, v118
v_fma_f32 v113, -v112, v112, v113
v_max_f32 v113, 0, v113
v_add_f32 v113, 0x3727c5ac, v113
v_rsq_f32 v113, v113
v_mul_f32 v114, 0x3a800000, v120
v_mul_f32 v115, 0x3a800000, v122
v_fma_f32 v115, -v114, v114, v115
v_max_f32 v115, 0, v115
v_add_f32 v115, 0x3727c5ac, v115
v_rsq_f32 v115, v115
s_nop 0
s_lshl_b32 s43, s47, 4
s_add_u32 s43, s43, 130176
v_mov_b32 v11, s43
ds_write_b128 v11, v[112:115]
s_waitcnt lgkmcnt(0)
s_waitcnt vmcnt(14)
s_barrier
s_add_u32 m0, s39, 86016
s_mov_b64 exec, s[60:61]
buffer_load_dwordx4 v4, s[8:11], s37 offen lds
s_mov_b64 exec, -1
s_add_u32 m0, s39, 89088
s_nop 0
buffer_load_dwordx4 v5, s[8:11], s37 offen lds
s_add_u32 m0, s39, 92160
s_nop 0
buffer_load_dwordx4 v6, s[8:11], s37 offen lds
s_add_u32 m0, s39, 95232
s_nop 0
buffer_load_dwordx4 v7, s[8:11], s37 offen lds
s_add_u32 m0, s39, 98304
s_nop 0
buffer_load_dwordx4 v8, s[8:11], s37 offen lds
s_add_u32 m0, s39, 101376
s_nop 0
buffer_load_dwordx4 v9, s[8:11], s37 offen lds
s_add_u32 m0, s40, 86016
s_add_u32 s43, s38, 0
buffer_load_dwordx4 v2, s[12:15], s43 offen lds
s_add_u32 m0, s40, 87040
s_add_u32 s43, s38, 49152
buffer_load_dwordx4 v3, s[12:15], s43 offen lds
s_add_u32 m0, s40, 88064
s_add_u32 s43, s38, 98304
buffer_load_dwordx4 v2, s[12:15], s43 offen lds
s_add_u32 m0, s40, 89088
s_add_u32 s43, s38, 147456
buffer_load_dwordx4 v3, s[12:15], s43 offen lds
s_add_u32 m0, s40, 90112
s_add_u32 s43, s38, 196608
buffer_load_dwordx4 v2, s[12:15], s43 offen lds
s_add_u32 m0, s40, 91136
s_add_u32 s43, s38, 245760
buffer_load_dwordx4 v3, s[12:15], s43 offen lds
s_add_u32 m0, s40, 92160
s_add_u32 s43, s38, 294912
buffer_load_dwordx4 v2, s[12:15], s43 offen lds
s_add_u32 m0, s40, 93184
s_add_u32 s43, s38, 344064
buffer_load_dwordx4 v3, s[12:15], s43 offen lds
s_add_u32 s37, s37, 128
s_add_u32 s38, s38, 393216
s_load_dword s64, s[80:81], 0
s_load_dword s65, s[80:81], 64
s_load_dword s66, s[80:81], 128
s_load_dword s67, s[80:81], 192
s_load_dword s68, s[80:81], 7168
s_load_dword s69, s[80:81], 7232
s_load_dword s70, s[80:81], 7296
s_load_dword s71, s[80:81], 7360
s_add_u32 s80, s80, 14336
s_addc_u32 s81, s81, 0
s_waitcnt vmcnt(14)
s_barrier
s_mov_b32 s41, 3
Lpl_7:
s_add_u32 m0, s39, 0
s_mov_b64 exec, s[60:61]
buffer_load_dwordx4 v4, s[8:11], s37 offen lds
s_mov_b64 exec, -1
s_add_u32 m0, s39, 3072
s_nop 0
buffer_load_dwordx4 v5, s[8:11], s37 offen lds
s_add_u32 m0, s39, 6144
s_nop 0
buffer_load_dwordx4 v6, s[8:11], s37 offen lds
s_add_u32 m0, s39, 9216
s_nop 0
buffer_load_dwordx4 v7, s[8:11], s37 offen lds
s_add_u32 m0, s39, 12288
s_nop 0
buffer_load_dwordx4 v8, s[8:11], s37 offen lds
s_add_u32 m0, s39, 15360
s_nop 0
buffer_load_dwordx4 v9, s[8:11], s37 offen lds
s_add_u32 m0, s40, 0
s_add_u32 s43, s38, 0
buffer_load_dwordx4 v2, s[12:15], s43 offen lds
s_add_u32 m0, s40, 1024
s_add_u32 s43, s38, 49152
buffer_load_dwordx4 v3, s[12:15], s43 offen lds
s_add_u32 m0, s40, 2048
s_add_u32 s43, s38, 98304
buffer_load_dwordx4 v2, s[12:15], s43 offen lds
s_add_u32 m0, s40, 3072
s_add_u32 s43, s38, 147456
buffer_load_dwordx4 v3, s[12:15], s43 offen lds
s_add_u32 m0, s40, 4096
s_add_u32 s43, s38, 196608
buffer_load_dwordx4 v2, s[12:15], s43 offen lds
s_add_u32 m0, s40, 5120
s_add_u32 s43, s38, 245760
buffer_load_dwordx4 v3, s[12:15], s43 offen lds
s_add_u32 m0, s40, 6144
s_add_u32 s43, s38, 294912
buffer_load_dwordx4 v2, s[12:15], s43 offen lds
s_add_u32 m0, s40, 7168
s_add_u32 s43, s38, 344064
buffer_load_dwordx4 v3, s[12:15], s43 offen lds
s_add_u32 s37, s37, 128
s_add_u32 s38, s38, 393216
s_load_dword s64, s[80:81], 0
s_load_dword s65, s[80:81], 64
s_load_dword s66, s[80:81], 128
s_load_dword s67, s[80:81], 192
s_load_dword s68, s[80:81], 7168
s_load_dword s69, s[80:81], 7232
s_load_dword s70, s[80:81], 7296
s_load_dword s71, s[80:81], 7360
s_add_u32 s80, s80, 14336
s_addc_u32 s81, s81, 0
s_waitcnt vmcnt(14)
s_barrier
s_add_u32 m0, s39, 43008
s_mov_b64 exec, s[60:61]
buffer_load_dwordx4 v4, s[8:11], s37 offen lds
s_mov_b64 exec, -1
s_add_u32 m0, s39, 46080
s_nop 0
buffer_load_dwordx4 v5, s[8:11], s37 offen lds
s_add_u32 m0, s39, 49152
s_nop 0
buffer_load_dwordx4 v6, s[8:11], s37 offen lds
s_add_u32 m0, s39, 52224
s_nop 0
buffer_load_dwordx4 v7, s[8:11], s37 offen lds
s_add_u32 m0, s39, 55296
s_nop 0
buffer_load_dwordx4 v8, s[8:11], s37 offen lds
s_add_u32 m0, s39, 58368
s_nop 0
buffer_load_dwordx4 v9, s[8:11], s37 offen lds
s_add_u32 m0, s40, 43008
s_add_u32 s43, s38, 0
buffer_load_dwordx4 v2, s[12:15], s43 offen lds
s_add_u32 m0, s40, 44032
s_add_u32 s43, s38, 49152
buffer_load_dwordx4 v3, s[12:15], s43 offen lds
s_add_u32 m0, s40, 45056
s_add_u32 s43, s38, 98304
buffer_load_dwordx4 v2, s[12:15], s43 offen lds
s_add_u32 m0, s40, 46080
s_add_u32 s43, s38, 147456
buffer_load_dwordx4 v3, s[12:15], s43 offen lds
s_add_u32 m0, s40, 47104
s_add_u32 s43, s38, 196608
buffer_load_dwordx4 v2, s[12:15], s43 offen lds
s_add_u32 m0, s40, 48128
s_add_u32 s43, s38, 245760
buffer_load_dwordx4 v3, s[12:15], s43 offen lds
s_add_u32 m0, s40, 49152
s_add_u32 s43, s38, 294912
buffer_load_dwordx4 v2, s[12:15], s43 offen lds
s_add_u32 m0, s40, 50176
s_add_u32 s43, s38, 344064
buffer_load_dwordx4 v3, s[12:15], s43 offen lds
s_add_u32 s37, s37, 128
s_add_u32 s38, s38, 393216
s_load_dword s64, s[80:81], 0
s_load_dword s65, s[80:81], 64
s_load_dword s66, s[80:81], 128
s_load_dword s67, s[80:81], 192
s_load_dword s68, s[80:81], 7168
s_load_dword s69, s[80:81], 7232
s_load_dword s70, s[80:81], 7296
s_load_dword s71, s[80:81], 7360
s_add_u32 s80, s80, 14336
s_addc_u32 s81, s81, 0
s_waitcnt vmcnt(14)
s_barrier
s_add_u32 m0, s39, 86016
s_mov_b64 exec, s[60:61]
buffer_load_dwordx4 v4, s[8:11], s37 offen lds
s_mov_b64 exec, -1
s_add_u32 m0, s39, 89088
s_nop 0
buffer_load_dwordx4 v5, s[8:11], s37 offen lds
s_add_u32 m0, s39, 92160
s_nop 0
buffer_load_dwordx4 v6, s[8:11], s37 offen lds
s_add_u32 m0, s39, 95232
s_nop 0
buffer_load_dwordx4 v7, s[8:11], s37 offen lds
s_add_u32 m0, s39, 98304
s_nop 0
buffer_load_dwordx4 v8, s[8:11], s37 offen lds
s_add_u32 m0, s39, 101376
s_nop 0
buffer_load_dwordx4 v9, s[8:11], s37 offen lds
s_add_u32 m0, s40, 86016
s_add_u32 s43, s38, 0
buffer_load_dwordx4 v2, s[12:15], s43 offen lds
s_add_u32 m0, s40, 87040
s_add_u32 s43, s38, 49152
buffer_load_dwordx4 v3, s[12:15], s43 offen lds
s_add_u32 m0, s40, 88064
s_add_u32 s43, s38, 98304
buffer_load_dwordx4 v2, s[12:15], s43 offen lds
s_add_u32 m0, s40, 89088
s_add_u32 s43, s38, 147456
buffer_load_dwordx4 v3, s[12:15], s43 offen lds
s_add_u32 m0, s40, 90112
s_add_u32 s43, s38, 196608
buffer_load_dwordx4 v2, s[12:15], s43 offen lds
s_add_u32 m0, s40, 91136
s_add_u32 s43, s38, 245760
buffer_load_dwordx4 v3, s[12:15], s43 offen lds
s_add_u32 m0, s40, 92160
s_add_u32 s43, s38, 294912
buffer_load_dwordx4 v2, s[12:15], s43 offen lds
s_add_u32 m0, s40, 93184
s_add_u32 s43, s38, 344064
buffer_load_dwordx4 v3, s[12:15], s43 offen lds
s_add_u32 s37, s37, 128
s_add_u32 s38, s38, 393216
s_load_dword s64, s[80:81], 0
s_load_dword s65, s[80:81], 64
s_load_dword s66, s[80:81], 128
s_load_dword s67, s[80:81], 192
s_load_dword s68, s[80:81], 7168
s_load_dword s69, s[80:81], 7232
s_load_dword s70, s[80:81], 7296
s_load_dword s71, s[80:81], 7360
s_add_u32 s80, s80, 14336
s_addc_u32 s81, s81, 0
s_waitcnt vmcnt(14)
s_barrier
s_sub_u32 s41, s41, 1
s_cmp_lg_u32 s41, 0
s_cbranch_scc1 Lpl_7
s_add_u32 m0, s39, 0
s_mov_b64 exec, s[60:61]
buffer_load_dwordx4 v4, s[8:11], s37 offen lds
s_mov_b64 exec, -1
s_add_u32 m0, s39, 3072
s_nop 0
buffer_load_dwordx4 v5, s[8:11], s37 offen lds
s_add_u32 m0, s39, 6144
s_nop 0
buffer_load_dwordx4 v6, s[8:11], s37 offen lds
s_add_u32 m0, s39, 9216
s_nop 0
buffer_load_dwordx4 v7, s[8:11], s37 offen lds
s_add_u32 m0, s39, 12288
s_nop 0
buffer_load_dwordx4 v8, s[8:11], s37 offen lds
s_add_u32 m0, s39, 15360
s_nop 0
buffer_load_dwordx4 v9, s[8:11], s37 offen lds
s_add_u32 m0, s40, 0
s_add_u32 s43, s38, 0
buffer_load_dwordx4 v2, s[12:15], s43 offen lds
s_add_u32 m0, s40, 1024
s_add_u32 s43, s38, 49152
buffer_load_dwordx4 v3, s[12:15], s43 offen lds
s_add_u32 m0, s40, 2048
s_add_u32 s43, s38, 98304
buffer_load_dwordx4 v2, s[12:15], s43 offen lds
s_add_u32 m0, s40, 3072
s_add_u32 s43, s38, 147456
buffer_load_dwordx4 v3, s[12:15], s43 offen lds
s_add_u32 m0, s40, 4096
s_add_u32 s43, s38, 196608
buffer_load_dwordx4 v2, s[12:15], s43 offen lds
s_add_u32 m0, s40, 5120
s_add_u32 s43, s38, 245760
buffer_load_dwordx4 v3, s[12:15], s43 offen lds
s_add_u32 m0, s40, 6144
s_add_u32 s43, s38, 294912
buffer_load_dwordx4 v2, s[12:15], s43 offen lds
s_add_u32 m0, s40, 7168
s_add_u32 s43, s38, 344064
buffer_load_dwordx4 v3, s[12:15], s43 offen lds
s_add_u32 s37, s37, 128
s_add_u32 s38, s38, 393216
s_load_dword s64, s[80:81], 0
s_load_dword s65, s[80:81], 64
s_load_dword s66, s[80:81], 128
s_load_dword s67, s[80:81], 192
s_load_dword s68, s[80:81], 7168
s_load_dword s69, s[80:81], 7232
s_load_dword s70, s[80:81], 7296
s_load_dword s71, s[80:81], 7360
s_add_u32 s80, s80, 14336
s_addc_u32 s81, s81, 0
s_waitcnt vmcnt(14)
s_barrier
s_load_dword s64, s[80:81], 0
s_load_dword s65, s[80:81], 64
s_load_dword s66, s[80:81], 128
s_load_dword s67, s[80:81], 192
s_load_dword s68, s[80:81], 7168
s_load_dword s69, s[80:81], 7232
s_load_dword s70, s[80:81], 7296
s_load_dword s71, s[80:81], 7360
s_add_u32 s80, s80, 14336
s_addc_u32 s81, s81, 0
s_waitcnt vmcnt(0)
s_barrier
s_barrier
s_barrier
s_waitcnt lgkmcnt(0)
s_branch Latt_4
Lpf_3:
s_load_dwordx2 s[26:27], s[0:1], 64
s_lshl_b32 s43, s51, 11
buffer_load_dwordx4 v[96:99], v10, s[8:11], s43 offen offset:0
buffer_load_dwordx4 v[100:103], v10, s[8:11], s43 offen offset:1024
buffer_load_dwordx4 v[104:107], v10, s[8:11], s43 offen offset:2048
buffer_load_dwordx4 v[108:111], v10, s[8:11], s43 offen offset:3072
v_min_u32 v14, 23, v1
v_lshrrev_b32 v15, 3, v14
v_mul_u32_u24 v15, 43008, v15
v_and_b32 v14, 7, v14
v_lshl_add_u32 v15, v14, 4, v15
v_mov_b32 v32, 0x3f803f80
v_mov_b32 v33, 0x3f803f80
v_mov_b32 v34, 0x3f803f80
v_mov_b32 v35, 0x3f803f80
ds_write_b128 v15, v[32:35]
v_add_u32 v14, 0, v1
v_min_u32 v14, 47, v14
v_mul_u32_u24 v15, 21846, v14
v_lshrrev_b32 v15, 16, v15
v_mul_u32_u24 v16, 3, v15
v_sub_u32 v16, v14, v16
s_mul_i32 s43, s48, 16
v_add_u32 v15, s43, v15
v_mul_u32_u24 v15, 6144, v15
v_lshl_add_u32 v2, v16, 11, v15
s_waitcnt lgkmcnt(0)
s_mov_b32 s56, s26
s_mov_b32 s57, s27
s_mov_b32 s58, 256
s_mov_b32 s59, 0x20000
v_lshlrev_b32 v14, 7, v1
s_or_b32 s43, s34, s35
s_cmp_lg_u32 s43, 0
s_cbranch_scc1 Lz_8
s_add_u32 s84, s32, 28311552
s_addc_u32 s85, s33, 0
s_mov_b32 s86, 16384
s_mov_b32 s87, 0x20000
v_mov_b32 v5, 0
buffer_store_dword v5, v14, s[84:87], 0 offen sc1
s_movk_i32 s43, 0x2000
buffer_store_dword v5, v14, s[84:87], s43 offen sc1
s_waitcnt vmcnt(0)
Lz_8:
s_mov_b32 s84, s6
s_mov_b32 s85, s7
s_mov_b32 s86, 6291456
s_mov_b32 s87, 0x20000
s_lshr_b32 s44, s2, 3
s_and_b32 s43, s35, 8
s_or_b32 s43, s43, 3
s_lshl_b32 s43, s43, 7
s_mul_i32 s45, s44, 196608
s_add_u32 s43, s43, s45
v_add_u32 v15, 0, v1
v_min_u32 v15, 95, v15
v_mul_u32_u24 v16, 21846, v15
v_lshrrev_b32 v16, 16, v16
v_mul_u32_u24 v17, 3, v16
v_sub_u32 v15, v15, v17
v_mul_u32_u24 v16, 6144, v16
v_lshl_add_u32 v15, v15, 11, v16
buffer_load_dword v31, v15, s[84:87], s43 offen
v_add_u32 v15, 64, v1
v_min_u32 v15, 95, v15
v_mul_u32_u24 v16, 21846, v15
v_lshrrev_b32 v16, 16, v16
v_mul_u32_u24 v17, 3, v16
v_sub_u32 v15, v15, v17
v_mul_u32_u24 v16, 6144, v16
v_lshl_add_u32 v15, v15, 11, v16
buffer_load_dword v31, v15, s[84:87], s43 offen
s_xor_b32 s43, s63, 64
s_lshl_b32 s43, s43, 11
buffer_load_dword v31, v14, s[8:11], s43 offen
s_add_u32 s43, s43, 8192
buffer_load_dword v31, v14, s[8:11], s43 offen
s_barrier
s_mov_b32 s84, s6
s_mov_b32 s85, s7
s_mov_b32 s86, 6291456
s_mov_b32 s87, 0x20000
s_mul_i32 s43, s2, 24576
buffer_load_dword v31, v14, s[84:87], s43 offen
s_add_u32 s43, s43, 8192
buffer_load_dword v31, v14, s[84:87], s43 offen
s_add_u32 s43, s43, 8192
buffer_load_dword v31, v14, s[84:87], s43 offen
s_lshr_b32 s43, s2, 5
s_cmp_eq_u32 s43, 3
s_cbranch_scc1 Lsj_10
s_cmp_gt_u32 s43, 3
s_cselect_b32 s43, 32, 0
s_sub_u32 s43, s2, s43
s_lshr_b32 s43, s43, 1
s_and_b32 s44, s2, 1
s_lshl_b32 s44, s44, 3
s_add_u32 s44, s44, 32
s_load_dwordx2 s[80:81], s[0:1], s44
s_mul_i32 s45, s43, 2341
s_lshr_b32 s45, s45, 16
s_mul_i32 s46, s45, 28
s_sub_u32 s46, s43, s46
s_lshl_b32 s45, s45, 8
s_mul_i32 s44, s47, 36
s_add_u32 s45, s45, s44
s_add_u32 s45, s45, 128
s_mul_i32 s45, s45, 7168
s_lshl_b32 s46, s46, 8
s_add_u32 s45, s45, s46
s_waitcnt lgkmcnt(0)
s_add_u32 s80, s80, s45
s_addc_u32 s81, s81, 0
Lsj_10:
s_barrier
s_barrier
s_waitcnt vmcnt(7)
v_lshlrev_b32 v124, 16, v96
v_and_b32 v125, 0xffff0000, v96
v_mov_b32 v116, v124
v_mov_b32 v117, v125
v_mul_f32 v118, v124, v124
v_mul_f32 v119, v125, v125
v_lshlrev_b32 v126, 16, v97
v_and_b32 v127, 0xffff0000, v97
v_add_f32 v116, v116, v126
v_add_f32 v117, v117, v127
v_fmac_f32 v118, v126, v126
v_fmac_f32 v119, v127, v127
v_lshlrev_b32 v124, 16, v98
v_and_b32 v125, 0xffff0000, v98
v_add_f32 v116, v116, v124
v_add_f32 v117, v117, v125
v_fmac_f32 v118, v124, v124
v_fmac_f32 v119, v125, v125
v_lshlrev_b32 v126, 16, v99
v_and_b32 v127, 0xffff0000, v99
v_add_f32 v116, v116, v126
v_add_f32 v117, v117, v127
v_fmac_f32 v118, v126, v126
v_fmac_f32 v119, v127, v127
v_lshlrev_b32 v124, 16, v100
v_and_b32 v125, 0xffff0000, v100
v_add_f32 v116, v116, v124
v_add_f32 v117, v117, v125
v_fmac_f32 v118, v124, v124
v_fmac_f32 v119, v125, v125
v_lshlrev_b32 v126, 16, v101
v_and_b32 v127, 0xffff0000, v101
v_add_f32 v116, v116, v126
v_add_f32 v117, v117, v127
v_fmac_f32 v118, v126, v126
v_fmac_f32 v119, v127, v127
v_lshlrev_b32 v124, 16, v102
v_and_b32 v125, 0xffff0000, v102
v_add_f32 v116, v116, v124
v_add_f32 v117, v117, v125
v_fmac_f32 v118, v124, v124
v_fmac_f32 v119, v125, v125
v_lshlrev_b32 v126, 16, v103
v_and_b32 v127, 0xffff0000, v103
v_add_f32 v116, v116, v126
v_add_f32 v117, v117, v127
v_fmac_f32 v118, v126, v126
v_fmac_f32 v119, v127, v127
v_lshlrev_b32 v124, 16, v104
v_and_b32 v125, 0xffff0000, v104
v_mov_b32 v120, v124
v_mov_b32 v121, v125
v_mul_f32 v122, v124, v124
v_mul_f32 v123, v125, v125
v_lshlrev_b32 v126, 16, v105
v_and_b32 v127, 0xffff0000, v105
v_add_f32 v120, v120, v126
v_add_f32 v121, v121, v127
v_fmac_f32 v122, v126, v126
v_fmac_f32 v123, v127, v127
v_lshlrev_b32 v124, 16, v106
v_and_b32 v125, 0xffff0000, v106
v_add_f32 v120, v120, v124
v_add_f32 v121, v121, v125
v_fmac_f32 v122, v124, v124
v_fmac_f32 v123, v125, v125
v_lshlrev_b32 v126, 16, v107
v_and_b32 v127, 0xffff0000, v107
v_add_f32 v120, v120, v126
v_add_f32 v121, v121, v127
v_fmac_f32 v122, v126, v126
v_fmac_f32 v123, v127, v127
v_lshlrev_b32 v124, 16, v108
v_and_b32 v125, 0xffff0000, v108
v_add_f32 v120, v120, v124
v_add_f32 v121, v121, v125
v_fmac_f32 v122, v124, v124
v_fmac_f32 v123, v125, v125
v_lshlrev_b32 v126, 16, v109
v_and_b32 v127, 0xffff0000, v109
v_add_f32 v120, v120, v126
v_add_f32 v121, v121, v127
v_fmac_f32 v122, v126, v126
v_fmac_f32 v123, v127, v127
v_lshlrev_b32 v124, 16, v110
v_and_b32 v125, 0xffff0000, v110
v_add_f32 v120, v120, v124
v_add_f32 v121, v121, v125
v_fmac_f32 v122, v124, v124
v_fmac_f32 v123, v125, v125
v_lshlrev_b32 v126, 16, v111
v_and_b32 v127, 0xffff0000, v111
v_add_f32 v120, v120, v126
v_add_f32 v121, v121, v127
v_fmac_f32 v122, v126, v126
v_fmac_f32 v123, v127, v127
v_add_f32 v116, v116, v117
v_add_f32 v118, v118, v119
v_add_f32 v120, v120, v121
v_add_f32 v122, v122, v123
s_nop 0
v_add_f32_dpp v116, v116, v116 row_ror:8 row_mask:0xf bank_mask:0xf
v_add_f32_dpp v118, v118, v118 row_ror:8 row_mask:0xf bank_mask:0xf
v_add_f32_dpp v120, v120, v120 row_ror:8 row_mask:0xf bank_mask:0xf
v_add_f32_dpp v122, v122, v122 row_ror:8 row_mask:0xf bank_mask:0xf
v_add_f32_dpp v116, v116, v116 row_ror:4 row_mask:0xf bank_mask:0xf
v_add_f32_dpp v118, v118, v118 row_ror:4 row_mask:0xf bank_mask:0xf
v_add_f32_dpp v120, v120, v120 row_ror:4 row_mask:0xf bank_mask:0xf
v_add_f32_dpp v122, v122, v122 row_ror:4 row_mask:0xf bank_mask:0xf
v_add_f32_dpp v116, v116, v116 row_ror:2 row_mask:0xf bank_mask:0xf
v_add_f32_dpp v118, v118, v118 row_ror:2 row_mask:0xf bank_mask:0xf
v_add_f32_dpp v120, v120, v120 row_ror:2 row_mask:0xf bank_mask:0xf
v_add_f32_dpp v122, v122, v122 row_ror:2 row_mask:0xf bank_mask:0xf
v_add_f32_dpp v116, v116, v116 row_ror:1 row_mask:0xf bank_mask:0xf
v_add_f32_dpp v118, v118, v118 row_ror:1 row_mask:0xf bank_mask:0xf
v_add_f32_dpp v120, v120, v120 row_ror:1 row_mask:0xf bank_mask:0xf
v_add_f32_dpp v122, v122, v122 row_ror:1 row_mask:0xf bank_mask:0xf
v_mov_b32 v117, v116
v_mov_b32 v119, v118
v_mov_b32 v121, v120
v_mov_b32 v123, v122
s_nop 0
v_permlane16_swap_b32 v116, v117
v_permlane16_swap_b32 v118, v119
v_permlane16_swap_b32 v120, v121
v_permlane16_swap_b32 v122, v123
v_add_f32 v116, v116, v117
v_add_f32 v118, v118, v119
v_add_f32 v120, v120, v121
v_add_f32 v122, v122, v123
v_mov_b32 v117, v116
v_mov_b32 v119, v118
v_mov_b32 v121, v120
v_mov_b32 v123, v122
s_nop 0
v_permlane32_swap_b32 v116, v117
v_permlane32_swap_b32 v118, v119
v_permlane32_swap_b32 v120, v121
v_permlane32_swap_b32 v122, v123
v_add_f32 v116, v116, v117
v_add_f32 v118, v118, v119
v_add_f32 v120, v120, v121
v_add_f32 v122, v122, v123
v_mul_f32 v112, 0x3a800000, v116
v_mul_f32 v113, 0x3a800000, v118
v_fma_f32 v113, -v112, v112, v113
v_max_f32 v113, 0, v113
v_add_f32 v113, 0x3727c5ac, v113
v_rsq_f32 v113, v113
v_mul_f32 v114, 0x3a800000, v120
v_mul_f32 v115, 0x3a800000, v122
v_fma_f32 v115, -v114, v114, v115
v_max_f32 v115, 0, v115
v_add_f32 v115, 0x3727c5ac, v115
v_rsq_f32 v115, v115
s_nop 0
s_lshl_b32 s43, s47, 4
s_add_u32 s43, s43, 130176
v_mov_b32 v11, s43
ds_write_b128 v11, v[112:115]
s_waitcnt lgkmcnt(0)
s_barrier
v_lshlrev_b32 v5, 4, v1
v_and_b32 v5, 63, v5
v_add_u32 v6, 130176, v5
ds_read_b128 v[112:115], v6
s_lshl_b32 s43, s63, 3
v_add_u32 v5, s43, v5
s_waitcnt lgkmcnt(0)
s_mov_b64 exec, 15
buffer_store_dwordx4 v[112:115], v5, s[20:23], 0 offen sc1
s_mov_b64 exec, -1
s_load_dword s64, s[80:81], 0
s_load_dword s65, s[80:81], 64
s_load_dword s66, s[80:81], 128
s_load_dword s67, s[80:81], 192
s_load_dword s68, s[80:81], 7168
s_load_dword s69, s[80:81], 7232
s_load_dword s70, s[80:81], 7296
s_load_dword s71, s[80:81], 7360
s_add_u32 s80, s80, 14336
s_addc_u32 s81, s81, 0
s_barrier
s_load_dword s64, s[80:81], 0
s_load_dword s65, s[80:81], 64
s_load_dword s66, s[80:81], 128
s_load_dword s67, s[80:81], 192
s_load_dword s68, s[80:81], 7168
s_load_dword s69, s[80:81], 7232
s_load_dword s70, s[80:81], 7296
s_load_dword s71, s[80:81], 7360
s_add_u32 s80, s80, 14336
s_addc_u32 s81, s81, 0
s_barrier
s_load_dword s64, s[80:81], 0
s_load_dword s65, s[80:81], 64
s_load_dword s66, s[80:81], 128
s_load_dword s67, s[80:81], 192
s_load_dword s68, s[80:81], 7168
s_load_dword s69, s[80:81], 7232
s_load_dword s70, s[80:81], 7296
s_load_dword s71, s[80:81], 7360
s_add_u32 s80, s80, 14336
s_addc_u32 s81, s81, 0
s_barrier
s_load_dword s64, s[80:81], 0
s_load_dword s65, s[80:81], 64
s_load_dword s66, s[80:81], 128
s_load_dword s67, s[80:81], 192
s_load_dword s68, s[80:81], 7168
s_load_dword s69, s[80:81], 7232
s_load_dword s70, s[80:81], 7296
s_load_dword s71, s[80:81], 7360
s_add_u32 s80, s80, 14336
s_addc_u32 s81, s81, 0
s_barrier
s_waitcnt vmcnt(0)
s_lshl_b32 s43, s34, 4
s_add_u32 s43, s43, s35
v_mov_b32 v5, s43
v_mov_b32 v6, 1
s_mov_b64 exec, 1
buffer_store_byte v6, v5, s[56:59], 0 offen sc1
s_mov_b64 exec, -1
s_load_dword s64, s[80:81], 0
s_load_dword s65, s[80:81], 64
s_load_dword s66, s[80:81], 128
s_load_dword s67, s[80:81], 192
s_load_dword s68, s[80:81], 7168
s_load_dword s69, s[80:81], 7232
s_load_dword s70, s[80:81], 7296
s_load_dword s71, s[80:81], 7360
s_add_u32 s80, s80, 14336
s_addc_u32 s81, s81, 0
s_barrier
s_load_dword s64, s[80:81], 0
s_load_dword s65, s[80:81], 64
s_load_dword s66, s[80:81], 128
s_load_dword s67, s[80:81], 192
s_load_dword s68, s[80:81], 7168
s_load_dword s69, s[80:81], 7232
s_load_dword s70, s[80:81], 7296
s_load_dword s71, s[80:81], 7360
s_add_u32 s80, s80, 14336
s_addc_u32 s81, s81, 0
s_barrier
s_load_dword s64, s[80:81], 0
s_load_dword s65, s[80:81], 64
s_load_dword s66, s[80:81], 128
s_load_dword s67, s[80:81], 192
s_load_dword s68, s[80:81], 7168
s_load_dword s69, s[80:81], 7232
s_load_dword s70, s[80:81], 7296
s_load_dword s71, s[80:81], 7360
s_add_u32 s80, s80, 14336
s_addc_u32 s81, s81, 0
s_barrier
s_lshl_b32 s43, s34, 4
s_sub_u32 s44, s43, 4
s_max_i32 s44, s44, 0
v_lshl_add_u32 v5, v1, 2, s43
v_mov_b32 v6, s44
v_cmp_gt_u32 vcc, 4, v1
s_nop 1
v_cndmask_b32 v5, v6, v5, vcc
v_cmp_eq_u32 vcc, 5, v1
s_nop 1
v_cndmask_b32 v5, v5, 0, vcc
buffer_load_dword v6, v5, s[56:59], 0 offen sc1
s_load_dword s64, s[80:81], 0
s_load_dword s65, s[80:81], 64
s_load_dword s66, s[80:81], 128
s_load_dword s67, s[80:81], 192
s_load_dword s68, s[80:81], 7168
s_load_dword s69, s[80:81], 7232
s_load_dword s70, s[80:81], 7296
s_load_dword s71, s[80:81], 7360
s_add_u32 s80, s80, 14336
s_addc_u32 s81, s81, 0
s_barrier
s_load_dword s64, s[80:81], 0
s_load_dword s65, s[80:81], 64
s_load_dword s66, s[80:81], 128
s_load_dword s67, s[80:81], 192
s_load_dword s68, s[80:81], 7168
s_load_dword s69, s[80:81], 7232
s_load_dword s70, s[80:81], 7296
s_load_dword s71, s[80:81], 7360
s_add_u32 s80, s80, 14336
s_addc_u32 s81, s81, 0
s_barrier
s_mov_b32 s41, 200
s_mov_b32 s62, 0
s_waitcnt vmcnt(0)
Lpoll_11:
v_and_b32 v6, 0x01010101, v6
v_cmp_ne_u32 vcc, 0x01010101, v6
s_nop 4
s_cbranch_vccz Lok_12
buffer_load_dword v6, v5, s[56:59], 0 offen sc1
s_waitcnt vmcnt(0)
s_sub_u32 s41, s41, 1
s_cmp_lg_u32 s41, 0
s_cbranch_scc1 Lpoll_11
s_mov_b32 s41, 0
Lfb_13:
s_add_u32 s62, s50, s41
s_max_i32 s62, s62, 0
s_lshl_b32 s43, s62, 11
buffer_load_dwordx4 v[96:99], v10, s[8:11], s43 offen offset:0
buffer_load_dwordx4 v[100:103], v10, s[8:11], s43 offen offset:1024
buffer_load_dwordx4 v[104:107], v10, s[8:11], s43 offen offset:2048
buffer_load_dwordx4 v[108:111], v10, s[8:11], s43 offen offset:3072
s_waitcnt vmcnt(0)
v_lshlrev_b32 v124, 16, v96
v_and_b32 v125, 0xffff0000, v96
v_mov_b32 v116, v124
v_mov_b32 v117, v125
v_mul_f32 v118, v124, v124
v_mul_f32 v119, v125, v125
v_lshlrev_b32 v126, 16, v97
v_and_b32 v127, 0xffff0000, v97
v_add_f32 v116, v116, v126
v_add_f32 v117, v117, v127
v_fmac_f32 v118, v126, v126
v_fmac_f32 v119, v127, v127
v_lshlrev_b32 v124, 16, v98
v_and_b32 v125, 0xffff0000, v98
v_add_f32 v116, v116, v124
v_add_f32 v117, v117, v125
v_fmac_f32 v118, v124, v124
v_fmac_f32 v119, v125, v125
v_lshlrev_b32 v126, 16, v99
v_and_b32 v127, 0xffff0000, v99
v_add_f32 v116, v116, v126
v_add_f32 v117, v117, v127
v_fmac_f32 v118, v126, v126
v_fmac_f32 v119, v127, v127
v_lshlrev_b32 v124, 16, v100
v_and_b32 v125, 0xffff0000, v100
v_add_f32 v116, v116, v124
v_add_f32 v117, v117, v125
v_fmac_f32 v118, v124, v124
v_fmac_f32 v119, v125, v125
v_lshlrev_b32 v126, 16, v101
v_and_b32 v127, 0xffff0000, v101
v_add_f32 v116, v116, v126
v_add_f32 v117, v117, v127
v_fmac_f32 v118, v126, v126
v_fmac_f32 v119, v127, v127
v_lshlrev_b32 v124, 16, v102
v_and_b32 v125, 0xffff0000, v102
v_add_f32 v116, v116, v124
v_add_f32 v117, v117, v125
v_fmac_f32 v118, v124, v124
v_fmac_f32 v119, v125, v125
v_lshlrev_b32 v126, 16, v103
v_and_b32 v127, 0xffff0000, v103
v_add_f32 v116, v116, v126
v_add_f32 v117, v117, v127
v_fmac_f32 v118, v126, v126
v_fmac_f32 v119, v127, v127
v_lshlrev_b32 v124, 16, v104
v_and_b32 v125, 0xffff0000, v104
v_mov_b32 v120, v124
v_mov_b32 v121, v125
v_mul_f32 v122, v124, v124
v_mul_f32 v123, v125, v125
v_lshlrev_b32 v126, 16, v105
v_and_b32 v127, 0xffff0000, v105
v_add_f32 v120, v120, v126
v_add_f32 v121, v121, v127
v_fmac_f32 v122, v126, v126
v_fmac_f32 v123, v127, v127
v_lshlrev_b32 v124, 16, v106
v_and_b32 v125, 0xffff0000, v106
v_add_f32 v120, v120, v124
v_add_f32 v121, v121, v125
v_fmac_f32 v122, v124, v124
v_fmac_f32 v123, v125, v125
v_lshlrev_b32 v126, 16, v107
v_and_b32 v127, 0xffff0000, v107
v_add_f32 v120, v120, v126
v_add_f32 v121, v121, v127
v_fmac_f32 v122, v126, v126
v_fmac_f32 v123, v127, v127
v_lshlrev_b32 v124, 16, v108
v_and_b32 v125, 0xffff0000, v108
v_add_f32 v120, v120, v124
v_add_f32 v121, v121, v125
v_fmac_f32 v122, v124, v124
v_fmac_f32 v123, v125, v125
v_lshlrev_b32 v126, 16, v109
v_and_b32 v127, 0xffff0000, v109
v_add_f32 v120, v120, v126
v_add_f32 v121, v121, v127
v_fmac_f32 v122, v126, v126
v_fmac_f32 v123, v127, v127
v_lshlrev_b32 v124, 16, v110
v_and_b32 v125, 0xffff0000, v110
v_add_f32 v120, v120, v124
v_add_f32 v121, v121, v125
v_fmac_f32 v122, v124, v124
v_fmac_f32 v123, v125, v125
v_lshlrev_b32 v126, 16, v111
v_and_b32 v127, 0xffff0000, v111
v_add_f32 v120, v120, v126
v_add_f32 v121, v121, v127
v_fmac_f32 v122, v126, v126
v_fmac_f32 v123, v127, v127
v_add_f32 v116, v116, v117
v_add_f32 v118, v118, v119
v_add_f32 v120, v120, v121
v_add_f32 v122, v122, v123
s_nop 0
v_add_f32_dpp v116, v116, v116 row_ror:8 row_mask:0xf bank_mask:0xf
v_add_f32_dpp v118, v118, v118 row_ror:8 row_mask:0xf bank_mask:0xf
v_add_f32_dpp v120, v120, v120 row_ror:8 row_mask:0xf bank_mask:0xf
v_add_f32_dpp v122, v122, v122 row_ror:8 row_mask:0xf bank_mask:0xf
v_add_f32_dpp v116, v116, v116 row_ror:4 row_mask:0xf bank_mask:0xf
v_add_f32_dpp v118, v118, v118 row_ror:4 row_mask:0xf bank_mask:0xf
v_add_f32_dpp v120, v120, v120 row_ror:4 row_mask:0xf bank_mask:0xf
v_add_f32_dpp v122, v122, v122 row_ror:4 row_mask:0xf bank_mask:0xf
v_add_f32_dpp v116, v116, v116 row_ror:2 row_mask:0xf bank_mask:0xf
v_add_f32_dpp v118, v118, v118 row_ror:2 row_mask:0xf bank_mask:0xf
v_add_f32_dpp v120, v120, v120 row_ror:2 row_mask:0xf bank_mask:0xf
v_add_f32_dpp v122, v122, v122 row_ror:2 row_mask:0xf bank_mask:0xf
v_add_f32_dpp v116, v116, v116 row_ror:1 row_mask:0xf bank_mask:0xf
v_add_f32_dpp v118, v118, v118 row_ror:1 row_mask:0xf bank_mask:0xf
v_add_f32_dpp v120, v120, v120 row_ror:1 row_mask:0xf bank_mask:0xf
v_add_f32_dpp v122, v122, v122 row_ror:1 row_mask:0xf bank_mask:0xf
v_mov_b32 v117, v116
v_mov_b32 v119, v118
v_mov_b32 v121, v120
v_mov_b32 v123, v122
s_nop 0
v_permlane16_swap_b32 v116, v117
v_permlane16_swap_b32 v118, v119
v_permlane16_swap_b32 v120, v121
v_permlane16_swap_b32 v122, v123
v_add_f32 v116, v116, v117
v_add_f32 v118, v118, v119
v_add_f32 v120, v120, v121
v_add_f32 v122, v122, v123
v_mov_b32 v117, v116
v_mov_b32 v119, v118
v_mov_b32 v121, v120
v_mov_b32 v123, v122
s_nop 0
v_permlane32_swap_b32 v116, v117
v_permlane32_swap_b32 v118, v119
v_permlane32_swap_b32 v120, v121
v_permlane32_swap_b32 v122, v123
v_add_f32 v116, v116, v117
v_add_f32 v118, v118, v119
v_add_f32 v120, v120, v121
v_add_f32 v122, v122, v123
v_mul_f32 v112, 0x3a800000, v116
v_mul_f32 v113, 0x3a800000, v118
v_fma_f32 v113, -v112, v112, v113
v_max_f32 v113, 0, v113
v_add_f32 v113, 0x3727c5ac, v113
v_rsq_f32 v113, v113
v_mul_f32 v114, 0x3a800000, v120
v_mul_f32 v115, 0x3a800000, v122
v_fma_f32 v115, -v114, v114, v115
v_max_f32 v115, 0, v115
v_add_f32 v115, 0x3727c5ac, v115
v_rsq_f32 v115, v115
s_nop 0
s_lshl_b32 s43, s41, 3
s_add_u32 s43, s43, 129024
v_mov_b32 v5, s43
ds_write_b128 v5, v[112:115]
s_add_u32 s41, s41, 2
s_cmp_lt_u32 s41, 144
s_cbranch_scc1 Lfb_13
s_mov_b32 s62, 1
v_mov_b32 v5, 0
s_mov_b32 s41, 0x10000
Lz0_14:
buffer_load_ubyte v6, v5, s[56:59], 0 offen sc1
s_waitcnt vmcnt(0)
v_cmp_eq_u32 vcc, 0, v6
s_nop 4
s_cbranch_vccz Lok_12
s_sub_u32 s41, s41, 1
s_cmp_lg_u32 s41, 0
s_cbranch_scc1 Lz0_14
Lok_12:
v_add_u32 v5, 0, v1
v_min_u32 v5, 143, v5
v_lshlrev_b32 v20, 3, v5
v_add_u32 v5, s50, v5
v_max_i32 v5, 0, v5
v_lshlrev_b32 v5, 3, v5
buffer_load_dwordx2 v[32:33], v5, s[20:23], 0 offen sc1
v_add_u32 v5, 64, v1
v_min_u32 v5, 143, v5
v_lshlrev_b32 v21, 3, v5
v_add_u32 v5, s50, v5
v_max_i32 v5, 0, v5
v_lshlrev_b32 v5, 3, v5
buffer_load_dwordx2 v[34:35], v5, s[20:23], 0 offen sc1
v_add_u32 v5, 128, v1
v_min_u32 v5, 143, v5
v_lshlrev_b32 v22, 3, v5
v_add_u32 v5, s50, v5
v_max_i32 v5, 0, v5
v_lshlrev_b32 v5, 3, v5
buffer_load_dwordx2 v[36:37], v5, s[20:23], 0 offen sc1
s_barrier
s_load_dwordx2 s[88:89], s[0:1], 16
v_lshlrev_b32 v29, 7, v1
s_lshl_b32 s43, s2, 13
s_waitcnt lgkmcnt(0)
s_mov_b32 s84, s88
s_mov_b32 s85, s89
s_mov_b32 s86, 2097152
s_mov_b32 s87, 0x20000
buffer_load_dword v30, v29, s[84:87], s43 offen
v_and_b32 v29, 31, v1
v_lshlrev_b32 v29, 11, v29
s_and_b32 s43, s35, 8
s_or_b32 s43, s43, 3
s_lshl_b32 s43, s43, 7
s_lshr_b32 s44, s2, 3
s_lshl_b32 s44, s44, 16
s_add_u32 s43, s43, s44
buffer_load_dword v30, v29, s[84:87], s43 offen
s_barrier
s_waitcnt vmcnt(2)
s_cmp_eq_u32 s62, 1
s_cbranch_scc1 Lgd_9
v_add_u32 v20, 129024, v20
ds_write_b64 v20, v[32:33]
v_add_u32 v21, 129024, v21
ds_write_b64 v21, v[34:35]
v_add_u32 v22, 129024, v22
ds_write_b64 v22, v[36:37]
Lgd_9:
s_waitcnt lgkmcnt(0)
s_lshr_b32 s43, s2, 5
s_cmp_eq_u32 s43, 3
s_cbranch_scc1 Lnj_15
s_cmp_gt_u32 s43, 3
s_cselect_b32 s43, 32, 0
s_sub_u32 s43, s2, s43
s_lshr_b32 s43, s43, 1
s_and_b32 s44, s2, 1
s_lshl_b32 s45, s44, 3
s_add_u32 s45, s45, 32
s_load_dwordx2 s[88:89], s[0:1], s45
s_mul_i32 s45, s43, 2341
s_lshr_b32 s45, s45, 16
s_mul_i32 s46, s45, 28
s_sub_u32 s46, s43, s46
v_lshrrev_b32 v28, 4, v1
s_lshl_b32 s43, s45, 8
v_add_u32 v28, s43, v28
v_mul_u32_u24 v28, 7168, v28
v_and_b32 v29, 15, v1
v_lshl_add_u32 v28, v29, 4, v28
s_lshl_b32 s43, s46, 8
v_add_u32 v28, s43, v28
s_waitcnt lgkmcnt(0)
s_mov_b32 s84, s88
s_mov_b32 s85, s89
s_mov_b32 s86, 7340032
s_mov_b32 s87, 0x20000
s_mov_b32 s43, 0
buffer_load_dwordx4 v[128:131], v28, s[84:87], s43 offen
s_mov_b32 s43, 28672
buffer_load_dwordx4 v[132:135], v28, s[84:87], s43 offen
s_mov_b32 s43, 57344
buffer_load_dwordx4 v[136:139], v28, s[84:87], s43 offen
s_mov_b32 s43, 86016
buffer_load_dwordx4 v[140:143], v28, s[84:87], s43 offen
s_mov_b32 s43, 114688
buffer_load_dwordx4 v[144:147], v28, s[84:87], s43 offen
s_mov_b32 s43, 143360
buffer_load_dwordx4 v[148:151], v28, s[84:87], s43 offen
s_mov_b32 s43, 172032
buffer_load_dwordx4 v[152:155], v28, s[84:87], s43 offen
s_mov_b32 s43, 200704
buffer_load_dwordx4 v[156:159], v28, s[84:87], s43 offen
s_mov_b32 s43, 229376
buffer_load_dwordx4 v[160:163], v28, s[84:87], s43 offen
s_mov_b32 s43, 258048
buffer_load_dwordx4 v[164:167], v28, s[84:87], s43 offen
s_mov_b32 s43, 286720
buffer_load_dwordx4 v[168:171], v28, s[84:87], s43 offen
s_mov_b32 s43, 315392
buffer_load_dwordx4 v[172:175], v28, s[84:87], s43 offen
s_mov_b32 s43, 344064
buffer_load_dwordx4 v[176:179], v28, s[84:87], s43 offen
s_mov_b32 s43, 372736
buffer_load_dwordx4 v[180:183], v28, s[84:87], s43 offen
s_mov_b32 s43, 401408
buffer_load_dwordx4 v[184:187], v28, s[84:87], s43 offen
s_mov_b32 s43, 430080
buffer_load_dwordx4 v[188:191], v28, s[84:87], s43 offen
Lnj_15:
s_barrier
s_lshr_b32 s43, s2, 5
s_cmp_eq_u32 s43, 3
s_cbranch_scc1 Lnj_16
s_cmp_gt_u32 s43, 3
s_cselect_b32 s43, 32, 0
s_sub_u32 s43, s2, s43
s_lshr_b32 s43, s43, 1
s_and_b32 s44, s2, 1
s_lshl_b32 s45, s44, 3
s_add_u32 s45, s45, 32
s_load_dwordx2 s[88:89], s[0:1], s45
s_mul_i32 s45, s43, 2341
s_lshr_b32 s45, s45, 16
s_mul_i32 s46, s45, 28
s_sub_u32 s46, s43, s46
v_lshrrev_b32 v28, 4, v1
s_lshl_b32 s43, s45, 8
v_add_u32 v28, s43, v28
v_mul_u32_u24 v28, 7168, v28
v_and_b32 v29, 15, v1
v_lshl_add_u32 v28, v29, 4, v28
s_lshl_b32 s43, s46, 8
v_add_u32 v28, s43, v28
s_waitcnt lgkmcnt(0)
s_mov_b32 s84, s88
s_mov_b32 s85, s89
s_mov_b32 s86, 7340032
s_mov_b32 s87, 0x20000
s_mov_b32 s43, 458752
buffer_load_dwordx4 v[192:195], v28, s[84:87], s43 offen
s_mov_b32 s43, 487424
buffer_load_dwordx4 v[196:199], v28, s[84:87], s43 offen
s_mov_b32 s43, 516096
buffer_load_dwordx4 v[200:203], v28, s[84:87], s43 offen
s_mov_b32 s43, 544768
buffer_load_dwordx4 v[204:207], v28, s[84:87], s43 offen
s_mov_b32 s43, 573440
buffer_load_dwordx4 v[208:211], v28, s[84:87], s43 offen
s_mov_b32 s43, 602112
buffer_load_dwordx4 v[212:215], v28, s[84:87], s43 offen
s_mov_b32 s43, 630784
buffer_load_dwordx4 v[216:219], v28, s[84:87], s43 offen
s_mov_b32 s43, 659456
buffer_load_dwordx4 v[220:223], v28, s[84:87], s43 offen
s_mov_b32 s43, 688128
buffer_load_dwordx4 v[224:227], v28, s[84:87], s43 offen
s_mov_b32 s43, 716800
buffer_load_dwordx4 v[228:231], v28, s[84:87], s43 offen
s_mov_b32 s43, 745472
buffer_load_dwordx4 v[232:235], v28, s[84:87], s43 offen
s_mov_b32 s43, 774144
buffer_load_dwordx4 v[236:239], v28, s[84:87], s43 offen
s_mov_b32 s43, 802816
buffer_load_dwordx4 v[240:243], v28, s[84:87], s43 offen
s_mov_b32 s43, 831488
buffer_load_dwordx4 v[244:247], v28, s[84:87], s43 offen
s_mov_b32 s43, 860160
buffer_load_dwordx4 v[248:251], v28, s[84:87], s43 offen
s_mov_b32 s43, 888832
buffer_load_dwordx4 v[252:255], v28, s[84:87], s43 offen
Lnj_16:
s_barrier
s_barrier
s_waitcnt lgkmcnt(0)
Latt_4:
s_barrier
s_and_b32 s43, s36, 1
s_lshr_b32 s44, s36, 1
s_and_b32 s44, s44, 1
s_lshr_b32 s45, s36, 2
v_lshlrev_b32 v14, 2, v13
v_sub_u32 v14, v12, v14
v_subrev_u32 v15, 0, v14
v_cmp_ge_u32 s[52:53], 7, v15
v_add_u32 v15, 16, v15
v_cmp_ge_u32 s[84:85], 7, v15
v_subrev_u32 v15, 1, v14
v_cmp_ge_u32 s[54:55], 7, v15
v_add_u32 v15, 16, v15
v_cmp_ge_u32 s[86:87], 7, v15
v_subrev_u32 v15, 2, v14
v_cmp_ge_u32 s[56:57], 7, v15
v_add_u32 v15, 16, v15
v_cmp_ge_u32 s[88:89], 7, v15
v_subrev_u32 v15, 3, v14
v_cmp_ge_u32 s[58:59], 7, v15
v_add_u32 v15, 16, v15
v_cmp_ge_u32 s[90:91], 7, v15
s_lshl_b32 s46, s45, 6
s_add_u32 s46, s46, s44
s_add_u32 s46, s46, 16
v_lshl_add_u32 v14, v12, 1, s46
s_lshl_b32 s47, s43, 6
v_lshl_add_u32 v15, v13, 4, s47
v_mul_u32_u24 v2, 400, v14
v_add_u32 v2, v2, v15
v_subrev_u32 v16, 32, v14
v_max_i32 v16, 0, v16
v_mul_u32_u24 v3, 400, v16
v_add_u32 v3, v3, v15
v_lshrrev_b32 v16, 2, v12
v_lshl_add_u32 v16, v13, 2, v16
v_lshl_add_u32 v16, v16, 1, s46
v_and_b32 v17, 3, v1
v_lshl_add_u32 v17, v17, 3, s47
v_mul_u32_u24 v4, 400, v16
v_add_u32 v4, v4, v17
v_subrev_u32 v16, 32, v16
v_max_i32 v16, 0, v16
v_mul_u32_u24 v5, 400, v16
v_add_u32 v5, v5, v17
s_lshl_b32 s60, s43, 13
s_lshl_b32 s61, s45, 10
s_add_u32 s60, s60, s61
s_lshl_b32 s61, s44, 8
s_add_u32 s60, s60, s61
v_lshlrev_b32 v6, 11, v13
v_lshl_add_u32 v6, v12, 4, v6
v_add_u32 v6, s60, v6
v_mov_b32 v8, 0xff800000
s_mov_b32 s61, 0x3e8293ee
s_or_b32 s62, s34, s45
ds_read_b128 v[32:35], v2 offset:0
ds_read_b128 v[36:39], v2 offset:128
ds_read_b128 v[40:43], v3 offset:128
ds_read_b64_tr_b16 v[44:45], v5 offset:256
ds_read_b64_tr_b16 v[46:47], v4 offset:256
ds_read_b64_tr_b16 v[48:49], v5 offset:288
ds_read_b64_tr_b16 v[50:51], v4 offset:288
ds_read_b128 v[80:83], v2 offset:12800
ds_read_b128 v[84:87], v2 offset:12928
ds_read_b128 v[88:91], v2 offset:128
ds_read_b64_tr_b16 v[92:93], v4 offset:256
ds_read_b64_tr_b16 v[94:95], v4 offset:13056
ds_read_b64_tr_b16 v[96:97], v4 offset:288
ds_read_b64_tr_b16 v[98:99], v4 offset:13088
s_waitcnt lgkmcnt(11)
v_mfma_f32_16x16x32_bf16 v[52:55], v[40:43], v[32:35], 0
v_mfma_f32_16x16x32_bf16 v[56:59], v[36:39], v[32:35], 0
s_waitcnt lgkmcnt(4)
v_mfma_f32_16x16x32_bf16 v[100:103], v[88:91], v[80:83], 0
v_mfma_f32_16x16x32_bf16 v[104:107], v[84:87], v[80:83], 0
s_nop 4
s_cmp_lg_u32 s62, 0
s_cselect_b64 s[92:93], s[84:85], 0
v_cndmask_b32 v52, v8, v52, s[92:93]
s_cselect_b64 s[92:93], s[86:87], 0
v_cndmask_b32 v53, v8, v53, s[92:93]
s_cselect_b64 s[92:93], s[88:89], 0
v_cndmask_b32 v54, v8, v54, s[92:93]
s_cselect_b64 s[92:93], s[90:91], 0
v_cndmask_b32 v55, v8, v55, s[92:93]
v_cndmask_b32 v56, v8, v56, s[52:53]
v_cndmask_b32 v57, v8, v57, s[54:55]
v_cndmask_b32 v58, v8, v58, s[56:57]
v_cndmask_b32 v59, v8, v59, s[58:59]
v_max3_f32 v60, v52, v53, v54
v_max3_f32 v60, v60, v55, v56
v_max3_f32 v60, v60, v57, v58
v_max_f32 v60, v60, v59
v_mov_b32 v61, v60
s_nop 1
v_permlane32_swap_b32 v60, v61
v_max_f32 v60, v60, v61
v_mov_b32 v61, v60
s_nop 1
v_permlane16_swap_b32 v60, v61
v_max_f32 v60, v60, v61
v_mul_f32 v60, s61, v60
v_fma_f32 v52, v52, s61, -v60
v_fma_f32 v53, v53, s61, -v60
v_fma_f32 v54, v54, s61, -v60
v_fma_f32 v55, v55, s61, -v60
v_fma_f32 v56, v56, s61, -v60
v_fma_f32 v57, v57, s61, -v60
v_fma_f32 v58, v58, s61, -v60
v_fma_f32 v59, v59, s61, -v60
v_exp_f32 v52, v52
v_exp_f32 v53, v53
v_exp_f32 v54, v54
v_exp_f32 v55, v55
v_exp_f32 v56, v56
v_exp_f32 v57, v57
v_exp_f32 v58, v58
v_exp_f32 v59, v59
s_nop 0
v_add_f32 v60, v52, v53
v_add_f32 v60, v60, v54
v_add_f32 v60, v60, v55
v_add_f32 v60, v60, v56
v_add_f32 v60, v60, v57
v_add_f32 v60, v60, v58
v_add_f32 v60, v60, v59
v_cvt_pk_bf16_f32 v64, v52, v53
v_cvt_pk_bf16_f32 v65, v54, v55
v_cvt_pk_bf16_f32 v66, v56, v57
v_cvt_pk_bf16_f32 v67, v58, v59
v_mov_b32 v61, v60
s_nop 1
v_permlane32_swap_b32 v60, v61
v_add_f32 v60, v60, v61
v_mov_b32 v61, v60
s_nop 1
v_permlane16_swap_b32 v60, v61
v_add_f32 v60, v60, v61
v_rcp_f32 v60, v60
s_waitcnt lgkmcnt(0)
v_mfma_f32_16x16x32_bf16 v[68:71], v[44:47], v[64:67], 0
v_mfma_f32_16x16x32_bf16 v[72:75], v[48:51], v[64:67], 0
v_cndmask_b32 v100, v8, v100, s[84:85]
v_cndmask_b32 v101, v8, v101, s[86:87]
v_cndmask_b32 v102, v8, v102, s[88:89]
v_cndmask_b32 v103, v8, v103, s[90:91]
v_cndmask_b32 v104, v8, v104, s[52:53]
v_cndmask_b32 v105, v8, v105, s[54:55]
v_cndmask_b32 v106, v8, v106, s[56:57]
v_cndmask_b32 v107, v8, v107, s[58:59]
v_max3_f32 v108, v100, v101, v102
v_max3_f32 v108, v108, v103, v104
v_max3_f32 v108, v108, v105, v106
v_max_f32 v108, v108, v107
v_mov_b32 v109, v108
s_nop 1
v_permlane32_swap_b32 v108, v109
v_max_f32 v108, v108, v109
v_mov_b32 v109, v108
s_nop 1
v_permlane16_swap_b32 v108, v109
v_max_f32 v108, v108, v109
v_mul_f32 v108, s61, v108
v_fma_f32 v100, v100, s61, -v108
v_fma_f32 v101, v101, s61, -v108
v_fma_f32 v102, v102, s61, -v108
v_fma_f32 v103, v103, s61, -v108
v_fma_f32 v104, v104, s61, -v108
v_fma_f32 v105, v105, s61, -v108
v_fma_f32 v106, v106, s61, -v108
v_fma_f32 v107, v107, s61, -v108
v_exp_f32 v100, v100
v_exp_f32 v101, v101
v_exp_f32 v102, v102
v_exp_f32 v103, v103
v_exp_f32 v104, v104
v_exp_f32 v105, v105
v_exp_f32 v106, v106
v_exp_f32 v107, v107
s_nop 0
v_add_f32 v108, v100, v101
v_add_f32 v108, v108, v102
v_add_f32 v108, v108, v103
v_add_f32 v108, v108, v104
v_add_f32 v108, v108, v105
v_add_f32 v108, v108, v106
v_add_f32 v108, v108, v107
v_cvt_pk_bf16_f32 v112, v100, v101
v_cvt_pk_bf16_f32 v113, v102, v103
v_cvt_pk_bf16_f32 v114, v104, v105
v_cvt_pk_bf16_f32 v115, v106, v107
v_mov_b32 v109, v108
s_nop 1
v_permlane32_swap_b32 v108, v109
v_add_f32 v108, v108, v109
v_mov_b32 v109, v108
s_nop 1
v_permlane16_swap_b32 v108, v109
v_add_f32 v108, v108, v109
v_rcp_f32 v108, v108
s_waitcnt lgkmcnt(0)
v_mfma_f32_16x16x32_bf16 v[116:119], v[92:95], v[112:115], 0
v_mfma_f32_16x16x32_bf16 v[120:123], v[96:99], v[112:115], 0
s_nop 4
v_mul_f32 v68, v60, v68
v_mul_f32 v69, v60, v69
v_mul_f32 v70, v60, v70
v_mul_f32 v71, v60, v71
v_mul_f32 v72, v60, v72
v_mul_f32 v73, v60, v73
v_mul_f32 v74, v60, v74
v_mul_f32 v75, v60, v75
v_cvt_pk_bf16_f32 v68, v68, v69
v_cvt_pk_bf16_f32 v69, v70, v71
v_cvt_pk_bf16_f32 v70, v72, v73
v_cvt_pk_bf16_f32 v71, v74, v75
buffer_store_dwordx4 v[68:71], v6, s[16:19], 0 offen offset:0 sc1
v_mul_f32 v116, v108, v116
v_mul_f32 v117, v108, v117
v_mul_f32 v118, v108, v118
v_mul_f32 v119, v108, v119
v_mul_f32 v120, v108, v120
v_mul_f32 v121, v108, v121
v_mul_f32 v122, v108, v122
v_mul_f32 v123, v108, v123
v_cvt_pk_bf16_f32 v116, v116, v117
v_cvt_pk_bf16_f32 v117, v118, v119
v_cvt_pk_bf16_f32 v118, v120, v121
v_cvt_pk_bf16_f32 v119, v122, v123
buffer_store_dwordx4 v[116:119], v6, s[16:19], 0 offen offset:512 sc1
s_waitcnt vmcnt(0)
s_barrier
s_add_u32 s56, s32, 28311552
s_addc_u32 s57, s33, 0
s_mov_b32 s58, 16384
s_mov_b32 s59, 0x20000
s_cmp_lg_u32 s36, 0
s_cbranch_scc1 Lsig_17
s_add_u32 s43, s34, 0
s_lshl_b32 s43, s43, 7
v_mov_b32 v5, s43
v_mov_b32 v6, 1
s_mov_b64 exec, 1
buffer_atomic_add v6, v5, s[56:59], 0 offen sc1
s_mov_b64 exec, -1
Lsig_17:
s_load_dwordx4 s[4:7], s[0:1], 32
s_load_dwordx2 s[28:29], s[0:1], 16
s_load_dwordx4 s[60:63], s[0:1], 48
s_load_dwordx2 s[30:31], s[0:1], 0
v_and_b32 v17, 15, v1
v_lshrrev_b32 v18, 4, v1
s_lshr_b32 s46, s36, 1
s_and_b32 s46, s46, 1
s_and_b32 s47, s36, 1
s_and_b32 s51, s36, 3
s_waitcnt lgkmcnt(0)
s_cmp_ge_u32 s36, 4
s_cbranch_scc1 LG1_18
s_lshl_b32 s43, s34, 18
s_lshl_b32 s44, s35, 7
s_add_u32 s43, s43, s44
s_add_u32 s16, s30, s43
s_addc_u32 s17, s31, 0
s_mov_b32 s18, 260224
s_mov_b32 s19, 0x20000
s_lshl_b32 s43, s36, 5
v_lshl_add_u32 v19, v17, 1, s43
v_lshlrev_b32 v19, 11, v19
v_lshl_add_u32 v23, v18, 3, v19
buffer_load_dwordx2 v[160:161], v23, s[16:19], 0 offen offset:0
buffer_load_dwordx2 v[162:163], v23, s[16:19], 0 offen offset:32
buffer_load_dwordx2 v[164:165], v23, s[16:19], 0 offen offset:64
buffer_load_dwordx2 v[166:167], v23, s[16:19], 0 offen offset:96
buffer_load_dwordx2 v[168:169], v23, s[16:19], 0 offen offset:2048
buffer_load_dwordx2 v[170:171], v23, s[16:19], 0 offen offset:2080
buffer_load_dwordx2 v[172:173], v23, s[16:19], 0 offen offset:2112
buffer_load_dwordx2 v[174:175], v23, s[16:19], 0 offen offset:2144
v_lshlrev_b32 v19, 11, v18
v_lshl_add_u32 v19, v17, 4, v19
s_lshl_b32 s43, s36, 9
v_add_u32 v2, s43, v19
v_add_u32 v3, 49152, v2
v_add_u32 v4, 98304, v2
v_lshrrev_b32 v19, 2, v17
v_lshl_add_u32 v20, v18, 2, v19
v_bfe_u32 v21, v20, 1, 2
v_lshlrev_b32 v20, 7, v20
v_lshl_add_u32 v20, v21, 5, v20
v_and_b32 v19, 3, v1
v_lshl_add_u32 v20, v19, 3, v20
v_add_u32 v5, 16384, v20
v_xor_b32 v6, 32, v5
v_xor_b32 v7, 64, v5
v_xor_b32 v8, 96, v5
v_add_u32 v9, 49152, v5
v_add_u32 v10, 49152, v6
v_add_u32 v11, 49152, v7
v_add_u32 v12, 49152, v8
v_add_u32 v13, 98304, v5
v_add_u32 v14, 98304, v6
v_add_u32 v15, 98304, v7
v_add_u32 v16, 98304, v8
s_lshl_b32 s43, s34, 18
s_lshl_b32 s44, s35, 14
s_add_u32 s43, s43, s44
s_add_u32 s20, s32, s43
s_addc_u32 s21, s33, 0
s_add_u32 s20, s20, 4194304
s_addc_u32 s21, s21, 0
s_mov_b32 s22, 16384
s_mov_b32 s23, 0x20000
s_lshl_b32 s43, s34, 14
s_lshl_b32 s44, s35, 10
s_add_u32 s43, s43, s44
s_add_u32 s24, s32, s43
s_addc_u32 s25, s33, 0
s_add_u32 s24, s24, 25165824
s_addc_u32 s25, s25, 0
s_mov_b32 s26, 1024
s_mov_b32 s27, 0x20000
s_movk_i32 s50, 0x2000
s_mov_b32 s52, 0x3f803f80
v_lshrrev_b32 v19, 1, v18
v_lshl_add_u32 v19, v19, 4, v17
s_lshl_b32 s43, s36, 5
v_add_u32 v19, s43, v19
v_and_b32 v20, 1, v18
v_lshlrev_b32 v20, 2, v20
v_lshl_add_u32 v22, v19, 3, v20
s_waitcnt vmcnt(0)
v_lshlrev_b32 v128, 16, v160
v_and_b32 v129, 0xffff0000, v160
v_lshlrev_b32 v130, 16, v161
v_and_b32 v131, 0xffff0000, v161
v_lshlrev_b32 v132, 16, v162
v_and_b32 v133, 0xffff0000, v162
v_lshlrev_b32 v134, 16, v163
v_and_b32 v135, 0xffff0000, v163
v_lshlrev_b32 v136, 16, v164
v_and_b32 v137, 0xffff0000, v164
v_lshlrev_b32 v138, 16, v165
v_and_b32 v139, 0xffff0000, v165
v_lshlrev_b32 v140, 16, v166
v_and_b32 v141, 0xffff0000, v166
v_lshlrev_b32 v142, 16, v167
v_and_b32 v143, 0xffff0000, v167
v_lshlrev_b32 v144, 16, v168
v_and_b32 v145, 0xffff0000, v168
v_lshlrev_b32 v146, 16, v169
v_and_b32 v147, 0xffff0000, v169
v_lshlrev_b32 v148, 16, v170
v_and_b32 v149, 0xffff0000, v170
v_lshlrev_b32 v150, 16, v171
v_and_b32 v151, 0xffff0000, v171
v_lshlrev_b32 v152, 16, v172
v_and_b32 v153, 0xffff0000, v172
v_lshlrev_b32 v154, 16, v173
v_and_b32 v155, 0xffff0000, v173
v_lshlrev_b32 v156, 16, v174
v_and_b32 v157, 0xffff0000, v174
v_lshlrev_b32 v158, 16, v175
v_and_b32 v159, 0xffff0000, v175
s_lshl_b32 s43, s34, 18
s_add_u32 s12, s32, s43
s_addc_u32 s13, s33, 0
s_mov_b32 s14, 262144
s_mov_b32 s15, 0x20000
v_lshlrev_b32 v21, 4, v1
s_lshl_b32 s54, s36, 11
s_barrier
s_add_u32 m0, s54, 0
s_add_u32 s43, s54, 0
buffer_load_dwordx4 v21, s[12:15], s43 offen sc1 lds
s_add_u32 m0, s54, 1024
s_add_u32 s43, s54, 1024
buffer_load_dwordx4 v21, s[12:15], s43 offen sc1 lds
s_add_u32 m0, s54, 24576
s_add_u32 s43, s54, 16384
buffer_load_dwordx4 v21, s[12:15], s43 offen sc1 lds
s_add_u32 m0, s54, 25600
s_add_u32 s43, s54, 17408
buffer_load_dwordx4 v21, s[12:15], s43 offen sc1 lds
s_waitcnt vmcnt(2)
s_barrier
ds_read_b128 v[32:35], v2 offset:0
ds_read_b64_tr_b16 v[48:49], v5 offset:0
ds_read_b64_tr_b16 v[50:51], v5 offset:2048
ds_read_b64_tr_b16 v[52:53], v6 offset:0
ds_read_b64_tr_b16 v[54:55], v6 offset:2048
ds_read_b128 v[36:39], v2 offset:256
ds_read_b64_tr_b16 v[56:57], v7 offset:0
ds_read_b64_tr_b16 v[58:59], v7 offset:2048
ds_read_b64_tr_b16 v[60:61], v8 offset:0
ds_read_b64_tr_b16 v[62:63], v8 offset:2048
ds_read_b128 v[40:43], v2 offset:8192
ds_read_b64_tr_b16 v[64:65], v5 offset:4096
ds_read_b64_tr_b16 v[66:67], v5 offset:6144
ds_read_b64_tr_b16 v[68:69], v6 offset:4096
ds_read_b64_tr_b16 v[70:71], v6 offset:6144
ds_read_b128 v[44:47], v2 offset:8448
ds_read_b64_tr_b16 v[72:73], v7 offset:4096
ds_read_b64_tr_b16 v[74:75], v7 offset:6144
ds_read_b64_tr_b16 v[76:77], v8 offset:4096
ds_read_b64_tr_b16 v[78:79], v8 offset:6144
s_waitcnt vmcnt(0) lgkmcnt(0)
s_barrier
v_mfma_f32_16x16x32_bf16 v[128:131], v[48:51], v[32:35], v[128:131]
ds_read_b128 v[80:83], v2 offset:24576
ds_read_b64_tr_b16 v[96:97], v5 offset:24576
v_mfma_f32_16x16x32_bf16 v[132:135], v[52:55], v[32:35], v[132:135]
ds_read_b64_tr_b16 v[98:99], v5 offset:26624
ds_read_b64_tr_b16 v[100:101], v6 offset:24576
v_mfma_f32_16x16x32_bf16 v[136:139], v[56:59], v[32:35], v[136:139]
ds_read_b64_tr_b16 v[102:103], v6 offset:26624
ds_read_b128 v[84:87], v2 offset:24832
v_mfma_f32_16x16x32_bf16 v[140:143], v[60:63], v[32:35], v[140:143]
ds_read_b64_tr_b16 v[104:105], v7 offset:24576
ds_read_b64_tr_b16 v[106:107], v7 offset:26624
v_mfma_f32_16x16x32_bf16 v[144:147], v[48:51], v[36:39], v[144:147]
ds_read_b64_tr_b16 v[108:109], v8 offset:24576
ds_read_b64_tr_b16 v[110:111], v8 offset:26624
v_mfma_f32_16x16x32_bf16 v[148:151], v[52:55], v[36:39], v[148:151]
ds_read_b128 v[88:91], v2 offset:32768
ds_read_b64_tr_b16 v[112:113], v5 offset:28672
v_mfma_f32_16x16x32_bf16 v[152:155], v[56:59], v[36:39], v[152:155]
ds_read_b64_tr_b16 v[114:115], v5 offset:30720
v_mfma_f32_16x16x32_bf16 v[156:159], v[60:63], v[36:39], v[156:159]
ds_read_b64_tr_b16 v[116:117], v6 offset:28672
v_mfma_f32_16x16x32_bf16 v[128:131], v[64:67], v[40:43], v[128:131]
ds_read_b64_tr_b16 v[118:119], v6 offset:30720
v_mfma_f32_16x16x32_bf16 v[132:135], v[68:71], v[40:43], v[132:135]
ds_read_b128 v[92:95], v2 offset:33024
v_mfma_f32_16x16x32_bf16 v[136:139], v[72:75], v[40:43], v[136:139]
ds_read_b64_tr_b16 v[120:121], v7 offset:28672
v_mfma_f32_16x16x32_bf16 v[140:143], v[76:79], v[40:43], v[140:143]
ds_read_b64_tr_b16 v[122:123], v7 offset:30720
v_mfma_f32_16x16x32_bf16 v[144:147], v[64:67], v[44:47], v[144:147]
ds_read_b64_tr_b16 v[124:125], v8 offset:28672
v_mfma_f32_16x16x32_bf16 v[148:151], v[68:71], v[44:47], v[148:151]
ds_read_b64_tr_b16 v[126:127], v8 offset:30720
v_mfma_f32_16x16x32_bf16 v[152:155], v[72:75], v[44:47], v[152:155]
v_mfma_f32_16x16x32_bf16 v[156:159], v[76:79], v[44:47], v[156:159]
s_waitcnt lgkmcnt(0)
s_barrier
v_mfma_f32_16x16x32_bf16 v[128:131], v[96:99], v[80:83], v[128:131]
ds_read_b128 v[32:35], v3 offset:0
ds_read_b64_tr_b16 v[48:49], v9 offset:0
v_mfma_f32_16x16x32_bf16 v[132:135], v[100:103], v[80:83], v[132:135]
ds_read_b64_tr_b16 v[50:51], v9 offset:2048
ds_read_b64_tr_b16 v[52:53], v10 offset:0
v_mfma_f32_16x16x32_bf16 v[136:139], v[104:107], v[80:83], v[136:139]
ds_read_b64_tr_b16 v[54:55], v10 offset:2048
ds_read_b128 v[36:39], v3 offset:256
v_mfma_f32_16x16x32_bf16 v[140:143], v[108:111], v[80:83], v[140:143]
ds_read_b64_tr_b16 v[56:57], v11 offset:0
ds_read_b64_tr_b16 v[58:59], v11 offset:2048
v_mfma_f32_16x16x32_bf16 v[144:147], v[96:99], v[84:87], v[144:147]
ds_read_b64_tr_b16 v[60:61], v12 offset:0
ds_read_b64_tr_b16 v[62:63], v12 offset:2048
v_mfma_f32_16x16x32_bf16 v[148:151], v[100:103], v[84:87], v[148:151]
ds_read_b128 v[40:43], v3 offset:8192
ds_read_b64_tr_b16 v[64:65], v9 offset:4096
v_mfma_f32_16x16x32_bf16 v[152:155], v[104:107], v[84:87], v[152:155]
ds_read_b64_tr_b16 v[66:67], v9 offset:6144
v_mfma_f32_16x16x32_bf16 v[156:159], v[108:111], v[84:87], v[156:159]
ds_read_b64_tr_b16 v[68:69], v10 offset:4096
v_mfma_f32_16x16x32_bf16 v[128:131], v[112:115], v[88:91], v[128:131]
ds_read_b64_tr_b16 v[70:71], v10 offset:6144
v_mfma_f32_16x16x32_bf16 v[132:135], v[116:119], v[88:91], v[132:135]
ds_read_b128 v[44:47], v3 offset:8448
v_mfma_f32_16x16x32_bf16 v[136:139], v[120:123], v[88:91], v[136:139]
ds_read_b64_tr_b16 v[72:73], v11 offset:4096
v_mfma_f32_16x16x32_bf16 v[140:143], v[124:127], v[88:91], v[140:143]
ds_read_b64_tr_b16 v[74:75], v11 offset:6144
v_mfma_f32_16x16x32_bf16 v[144:147], v[112:115], v[92:95], v[144:147]
ds_read_b64_tr_b16 v[76:77], v12 offset:4096
v_mfma_f32_16x16x32_bf16 v[148:151], v[116:119], v[92:95], v[148:151]
ds_read_b64_tr_b16 v[78:79], v12 offset:6144
v_mfma_f32_16x16x32_bf16 v[152:155], v[120:123], v[92:95], v[152:155]
v_mfma_f32_16x16x32_bf16 v[156:159], v[124:127], v[92:95], v[156:159]
s_mov_b32 s41, 2
Lg2_19:
s_waitcnt lgkmcnt(0)
s_barrier
v_mfma_f32_16x16x32_bf16 v[128:131], v[48:51], v[32:35], v[128:131]
ds_read_b128 v[80:83], v3 offset:24576
ds_read_b64_tr_b16 v[96:97], v9 offset:24576
v_mfma_f32_16x16x32_bf16 v[132:135], v[52:55], v[32:35], v[132:135]
ds_read_b64_tr_b16 v[98:99], v9 offset:26624
ds_read_b64_tr_b16 v[100:101], v10 offset:24576
v_mfma_f32_16x16x32_bf16 v[136:139], v[56:59], v[32:35], v[136:139]
ds_read_b64_tr_b16 v[102:103], v10 offset:26624
ds_read_b128 v[84:87], v3 offset:24832
v_mfma_f32_16x16x32_bf16 v[140:143], v[60:63], v[32:35], v[140:143]
ds_read_b64_tr_b16 v[104:105], v11 offset:24576
ds_read_b64_tr_b16 v[106:107], v11 offset:26624
v_mfma_f32_16x16x32_bf16 v[144:147], v[48:51], v[36:39], v[144:147]
ds_read_b64_tr_b16 v[108:109], v12 offset:24576
ds_read_b64_tr_b16 v[110:111], v12 offset:26624
v_mfma_f32_16x16x32_bf16 v[148:151], v[52:55], v[36:39], v[148:151]
ds_read_b128 v[88:91], v3 offset:32768
ds_read_b64_tr_b16 v[112:113], v9 offset:28672
v_mfma_f32_16x16x32_bf16 v[152:155], v[56:59], v[36:39], v[152:155]
ds_read_b64_tr_b16 v[114:115], v9 offset:30720
v_mfma_f32_16x16x32_bf16 v[156:159], v[60:63], v[36:39], v[156:159]
ds_read_b64_tr_b16 v[116:117], v10 offset:28672
v_mfma_f32_16x16x32_bf16 v[128:131], v[64:67], v[40:43], v[128:131]
ds_read_b64_tr_b16 v[118:119], v10 offset:30720
v_mfma_f32_16x16x32_bf16 v[132:135], v[68:71], v[40:43], v[132:135]
ds_read_b128 v[92:95], v3 offset:33024
v_mfma_f32_16x16x32_bf16 v[136:139], v[72:75], v[40:43], v[136:139]
ds_read_b64_tr_b16 v[120:121], v11 offset:28672
v_mfma_f32_16x16x32_bf16 v[140:143], v[76:79], v[40:43], v[140:143]
ds_read_b64_tr_b16 v[122:123], v11 offset:30720
v_mfma_f32_16x16x32_bf16 v[144:147], v[64:67], v[44:47], v[144:147]
ds_read_b64_tr_b16 v[124:125], v12 offset:28672
v_mfma_f32_16x16x32_bf16 v[148:151], v[68:71], v[44:47], v[148:151]
ds_read_b64_tr_b16 v[126:127], v12 offset:30720
v_mfma_f32_16x16x32_bf16 v[152:155], v[72:75], v[44:47], v[152:155]
v_mfma_f32_16x16x32_bf16 v[156:159], v[76:79], v[44:47], v[156:159]
s_waitcnt lgkmcnt(0)
s_barrier
v_mfma_f32_16x16x32_bf16 v[128:131], v[96:99], v[80:83], v[128:131]
ds_read_b128 v[32:35], v4 offset:0
ds_read_b64_tr_b16 v[48:49], v13 offset:0
v_mfma_f32_16x16x32_bf16 v[132:135], v[100:103], v[80:83], v[132:135]
ds_read_b64_tr_b16 v[50:51], v13 offset:2048
ds_read_b64_tr_b16 v[52:53], v14 offset:0
v_mfma_f32_16x16x32_bf16 v[136:139], v[104:107], v[80:83], v[136:139]
ds_read_b64_tr_b16 v[54:55], v14 offset:2048
ds_read_b128 v[36:39], v4 offset:256
v_mfma_f32_16x16x32_bf16 v[140:143], v[108:111], v[80:83], v[140:143]
ds_read_b64_tr_b16 v[56:57], v15 offset:0
ds_read_b64_tr_b16 v[58:59], v15 offset:2048
v_mfma_f32_16x16x32_bf16 v[144:147], v[96:99], v[84:87], v[144:147]
ds_read_b64_tr_b16 v[60:61], v16 offset:0
ds_read_b64_tr_b16 v[62:63], v16 offset:2048
v_mfma_f32_16x16x32_bf16 v[148:151], v[100:103], v[84:87], v[148:151]
ds_read_b128 v[40:43], v4 offset:8192
ds_read_b64_tr_b16 v[64:65], v13 offset:4096
v_mfma_f32_16x16x32_bf16 v[152:155], v[104:107], v[84:87], v[152:155]
ds_read_b64_tr_b16 v[66:67], v13 offset:6144
v_mfma_f32_16x16x32_bf16 v[156:159], v[108:111], v[84:87], v[156:159]
ds_read_b64_tr_b16 v[68:69], v14 offset:4096
v_mfma_f32_16x16x32_bf16 v[128:131], v[112:115], v[88:91], v[128:131]
ds_read_b64_tr_b16 v[70:71], v14 offset:6144
v_mfma_f32_16x16x32_bf16 v[132:135], v[116:119], v[88:91], v[132:135]
ds_read_b128 v[44:47], v4 offset:8448
v_mfma_f32_16x16x32_bf16 v[136:139], v[120:123], v[88:91], v[136:139]
ds_read_b64_tr_b16 v[72:73], v15 offset:4096
v_mfma_f32_16x16x32_bf16 v[140:143], v[124:127], v[88:91], v[140:143]
ds_read_b64_tr_b16 v[74:75], v15 offset:6144
v_mfma_f32_16x16x32_bf16 v[144:147], v[112:115], v[92:95], v[144:147]
ds_read_b64_tr_b16 v[76:77], v16 offset:4096
v_mfma_f32_16x16x32_bf16 v[148:151], v[116:119], v[92:95], v[148:151]
ds_read_b64_tr_b16 v[78:79], v16 offset:6144
v_mfma_f32_16x16x32_bf16 v[152:155], v[120:123], v[92:95], v[152:155]
v_mfma_f32_16x16x32_bf16 v[156:159], v[124:127], v[92:95], v[156:159]
s_waitcnt lgkmcnt(0)
s_barrier
v_mfma_f32_16x16x32_bf16 v[128:131], v[48:51], v[32:35], v[128:131]
ds_read_b128 v[80:83], v4 offset:24576
ds_read_b64_tr_b16 v[96:97], v13 offset:24576
v_mfma_f32_16x16x32_bf16 v[132:135], v[52:55], v[32:35], v[132:135]
ds_read_b64_tr_b16 v[98:99], v13 offset:26624
ds_read_b64_tr_b16 v[100:101], v14 offset:24576
v_mfma_f32_16x16x32_bf16 v[136:139], v[56:59], v[32:35], v[136:139]
ds_read_b64_tr_b16 v[102:103], v14 offset:26624
ds_read_b128 v[84:87], v4 offset:24832
v_mfma_f32_16x16x32_bf16 v[140:143], v[60:63], v[32:35], v[140:143]
ds_read_b64_tr_b16 v[104:105], v15 offset:24576
ds_read_b64_tr_b16 v[106:107], v15 offset:26624
v_mfma_f32_16x16x32_bf16 v[144:147], v[48:51], v[36:39], v[144:147]
ds_read_b64_tr_b16 v[108:109], v16 offset:24576
ds_read_b64_tr_b16 v[110:111], v16 offset:26624
v_mfma_f32_16x16x32_bf16 v[148:151], v[52:55], v[36:39], v[148:151]
ds_read_b128 v[88:91], v4 offset:32768
ds_read_b64_tr_b16 v[112:113], v13 offset:28672
v_mfma_f32_16x16x32_bf16 v[152:155], v[56:59], v[36:39], v[152:155]
ds_read_b64_tr_b16 v[114:115], v13 offset:30720
v_mfma_f32_16x16x32_bf16 v[156:159], v[60:63], v[36:39], v[156:159]
ds_read_b64_tr_b16 v[116:117], v14 offset:28672
v_mfma_f32_16x16x32_bf16 v[128:131], v[64:67], v[40:43], v[128:131]
ds_read_b64_tr_b16 v[118:119], v14 offset:30720
v_mfma_f32_16x16x32_bf16 v[132:135], v[68:71], v[40:43], v[132:135]
ds_read_b128 v[92:95], v4 offset:33024
v_mfma_f32_16x16x32_bf16 v[136:139], v[72:75], v[40:43], v[136:139]
ds_read_b64_tr_b16 v[120:121], v15 offset:28672
v_mfma_f32_16x16x32_bf16 v[140:143], v[76:79], v[40:43], v[140:143]
ds_read_b64_tr_b16 v[122:123], v15 offset:30720
v_mfma_f32_16x16x32_bf16 v[144:147], v[64:67], v[44:47], v[144:147]
ds_read_b64_tr_b16 v[124:125], v16 offset:28672
v_mfma_f32_16x16x32_bf16 v[148:151], v[68:71], v[44:47], v[148:151]
ds_read_b64_tr_b16 v[126:127], v16 offset:30720
v_mfma_f32_16x16x32_bf16 v[152:155], v[72:75], v[44:47], v[152:155]
v_mfma_f32_16x16x32_bf16 v[156:159], v[76:79], v[44:47], v[156:159]
s_waitcnt lgkmcnt(0)
s_barrier
v_mfma_f32_16x16x32_bf16 v[128:131], v[96:99], v[80:83], v[128:131]
ds_read_b128 v[32:35], v2 offset:0
ds_read_b64_tr_b16 v[48:49], v5 offset:0
v_mfma_f32_16x16x32_bf16 v[132:135], v[100:103], v[80:83], v[132:135]
ds_read_b64_tr_b16 v[50:51], v5 offset:2048
ds_read_b64_tr_b16 v[52:53], v6 offset:0
v_mfma_f32_16x16x32_bf16 v[136:139], v[104:107], v[80:83], v[136:139]
ds_read_b64_tr_b16 v[54:55], v6 offset:2048
ds_read_b128 v[36:39], v2 offset:256
v_mfma_f32_16x16x32_bf16 v[140:143], v[108:111], v[80:83], v[140:143]
ds_read_b64_tr_b16 v[56:57], v7 offset:0
ds_read_b64_tr_b16 v[58:59], v7 offset:2048
v_mfma_f32_16x16x32_bf16 v[144:147], v[96:99], v[84:87], v[144:147]
ds_read_b64_tr_b16 v[60:61], v8 offset:0
ds_read_b64_tr_b16 v[62:63], v8 offset:2048
v_mfma_f32_16x16x32_bf16 v[148:151], v[100:103], v[84:87], v[148:151]
ds_read_b128 v[40:43], v2 offset:8192
ds_read_b64_tr_b16 v[64:65], v5 offset:4096
v_mfma_f32_16x16x32_bf16 v[152:155], v[104:107], v[84:87], v[152:155]
ds_read_b64_tr_b16 v[66:67], v5 offset:6144
v_mfma_f32_16x16x32_bf16 v[156:159], v[108:111], v[84:87], v[156:159]
ds_read_b64_tr_b16 v[68:69], v6 offset:4096
v_mfma_f32_16x16x32_bf16 v[128:131], v[112:115], v[88:91], v[128:131]
ds_read_b64_tr_b16 v[70:71], v6 offset:6144
v_mfma_f32_16x16x32_bf16 v[132:135], v[116:119], v[88:91], v[132:135]
ds_read_b128 v[44:47], v2 offset:8448
v_mfma_f32_16x16x32_bf16 v[136:139], v[120:123], v[88:91], v[136:139]
ds_read_b64_tr_b16 v[72:73], v7 offset:4096
v_mfma_f32_16x16x32_bf16 v[140:143], v[124:127], v[88:91], v[140:143]
ds_read_b64_tr_b16 v[74:75], v7 offset:6144
v_mfma_f32_16x16x32_bf16 v[144:147], v[112:115], v[92:95], v[144:147]
ds_read_b64_tr_b16 v[76:77], v8 offset:4096
v_mfma_f32_16x16x32_bf16 v[148:151], v[116:119], v[92:95], v[148:151]
ds_read_b64_tr_b16 v[78:79], v8 offset:6144
v_mfma_f32_16x16x32_bf16 v[152:155], v[120:123], v[92:95], v[152:155]
v_mfma_f32_16x16x32_bf16 v[156:159], v[124:127], v[92:95], v[156:159]
s_waitcnt lgkmcnt(0)
s_barrier
v_mfma_f32_16x16x32_bf16 v[128:131], v[48:51], v[32:35], v[128:131]
ds_read_b128 v[80:83], v2 offset:24576
ds_read_b64_tr_b16 v[96:97], v5 offset:24576
v_mfma_f32_16x16x32_bf16 v[132:135], v[52:55], v[32:35], v[132:135]
ds_read_b64_tr_b16 v[98:99], v5 offset:26624
ds_read_b64_tr_b16 v[100:101], v6 offset:24576
v_mfma_f32_16x16x32_bf16 v[136:139], v[56:59], v[32:35], v[136:139]
ds_read_b64_tr_b16 v[102:103], v6 offset:26624
ds_read_b128 v[84:87], v2 offset:24832
v_mfma_f32_16x16x32_bf16 v[140:143], v[60:63], v[32:35], v[140:143]
ds_read_b64_tr_b16 v[104:105], v7 offset:24576
ds_read_b64_tr_b16 v[106:107], v7 offset:26624
v_mfma_f32_16x16x32_bf16 v[144:147], v[48:51], v[36:39], v[144:147]
ds_read_b64_tr_b16 v[108:109], v8 offset:24576
ds_read_b64_tr_b16 v[110:111], v8 offset:26624
v_mfma_f32_16x16x32_bf16 v[148:151], v[52:55], v[36:39], v[148:151]
ds_read_b128 v[88:91], v2 offset:32768
ds_read_b64_tr_b16 v[112:113], v5 offset:28672
v_mfma_f32_16x16x32_bf16 v[152:155], v[56:59], v[36:39], v[152:155]
ds_read_b64_tr_b16 v[114:115], v5 offset:30720
v_mfma_f32_16x16x32_bf16 v[156:159], v[60:63], v[36:39], v[156:159]
ds_read_b64_tr_b16 v[116:117], v6 offset:28672
v_mfma_f32_16x16x32_bf16 v[128:131], v[64:67], v[40:43], v[128:131]
ds_read_b64_tr_b16 v[118:119], v6 offset:30720
v_mfma_f32_16x16x32_bf16 v[132:135], v[68:71], v[40:43], v[132:135]
ds_read_b128 v[92:95], v2 offset:33024
v_mfma_f32_16x16x32_bf16 v[136:139], v[72:75], v[40:43], v[136:139]
ds_read_b64_tr_b16 v[120:121], v7 offset:28672
v_mfma_f32_16x16x32_bf16 v[140:143], v[76:79], v[40:43], v[140:143]
ds_read_b64_tr_b16 v[122:123], v7 offset:30720
v_mfma_f32_16x16x32_bf16 v[144:147], v[64:67], v[44:47], v[144:147]
ds_read_b64_tr_b16 v[124:125], v8 offset:28672
v_mfma_f32_16x16x32_bf16 v[148:151], v[68:71], v[44:47], v[148:151]
ds_read_b64_tr_b16 v[126:127], v8 offset:30720
v_mfma_f32_16x16x32_bf16 v[152:155], v[72:75], v[44:47], v[152:155]
v_mfma_f32_16x16x32_bf16 v[156:159], v[76:79], v[44:47], v[156:159]
s_waitcnt lgkmcnt(0)
s_barrier
v_mfma_f32_16x16x32_bf16 v[128:131], v[96:99], v[80:83], v[128:131]
ds_read_b128 v[32:35], v3 offset:0
ds_read_b64_tr_b16 v[48:49], v9 offset:0
v_mfma_f32_16x16x32_bf16 v[132:135], v[100:103], v[80:83], v[132:135]
ds_read_b64_tr_b16 v[50:51], v9 offset:2048
ds_read_b64_tr_b16 v[52:53], v10 offset:0
v_mfma_f32_16x16x32_bf16 v[136:139], v[104:107], v[80:83], v[136:139]
ds_read_b64_tr_b16 v[54:55], v10 offset:2048
ds_read_b128 v[36:39], v3 offset:256
v_mfma_f32_16x16x32_bf16 v[140:143], v[108:111], v[80:83], v[140:143]
ds_read_b64_tr_b16 v[56:57], v11 offset:0
ds_read_b64_tr_b16 v[58:59], v11 offset:2048
v_mfma_f32_16x16x32_bf16 v[144:147], v[96:99], v[84:87], v[144:147]
ds_read_b64_tr_b16 v[60:61], v12 offset:0
ds_read_b64_tr_b16 v[62:63], v12 offset:2048
v_mfma_f32_16x16x32_bf16 v[148:151], v[100:103], v[84:87], v[148:151]
ds_read_b128 v[40:43], v3 offset:8192
ds_read_b64_tr_b16 v[64:65], v9 offset:4096
v_mfma_f32_16x16x32_bf16 v[152:155], v[104:107], v[84:87], v[152:155]
ds_read_b64_tr_b16 v[66:67], v9 offset:6144
v_mfma_f32_16x16x32_bf16 v[156:159], v[108:111], v[84:87], v[156:159]
ds_read_b64_tr_b16 v[68:69], v10 offset:4096
v_mfma_f32_16x16x32_bf16 v[128:131], v[112:115], v[88:91], v[128:131]
ds_read_b64_tr_b16 v[70:71], v10 offset:6144
v_mfma_f32_16x16x32_bf16 v[132:135], v[116:119], v[88:91], v[132:135]
ds_read_b128 v[44:47], v3 offset:8448
v_mfma_f32_16x16x32_bf16 v[136:139], v[120:123], v[88:91], v[136:139]
ds_read_b64_tr_b16 v[72:73], v11 offset:4096
v_mfma_f32_16x16x32_bf16 v[140:143], v[124:127], v[88:91], v[140:143]
ds_read_b64_tr_b16 v[74:75], v11 offset:6144
v_mfma_f32_16x16x32_bf16 v[144:147], v[112:115], v[92:95], v[144:147]
ds_read_b64_tr_b16 v[76:77], v12 offset:4096
v_mfma_f32_16x16x32_bf16 v[148:151], v[116:119], v[92:95], v[148:151]
ds_read_b64_tr_b16 v[78:79], v12 offset:6144
v_mfma_f32_16x16x32_bf16 v[152:155], v[120:123], v[92:95], v[152:155]
v_mfma_f32_16x16x32_bf16 v[156:159], v[124:127], v[92:95], v[156:159]
s_sub_u32 s41, s41, 1
s_cmp_lg_u32 s41, 0
s_cbranch_scc1 Lg2_19
s_waitcnt lgkmcnt(0)
s_barrier
v_mfma_f32_16x16x32_bf16 v[128:131], v[48:51], v[32:35], v[128:131]
ds_read_b128 v[80:83], v3 offset:24576
ds_read_b64_tr_b16 v[96:97], v9 offset:24576
v_mfma_f32_16x16x32_bf16 v[132:135], v[52:55], v[32:35], v[132:135]
ds_read_b64_tr_b16 v[98:99], v9 offset:26624
ds_read_b64_tr_b16 v[100:101], v10 offset:24576
v_mfma_f32_16x16x32_bf16 v[136:139], v[56:59], v[32:35], v[136:139]
ds_read_b64_tr_b16 v[102:103], v10 offset:26624
ds_read_b128 v[84:87], v3 offset:24832
v_mfma_f32_16x16x32_bf16 v[140:143], v[60:63], v[32:35], v[140:143]
ds_read_b64_tr_b16 v[104:105], v11 offset:24576
ds_read_b64_tr_b16 v[106:107], v11 offset:26624
v_mfma_f32_16x16x32_bf16 v[144:147], v[48:51], v[36:39], v[144:147]
ds_read_b64_tr_b16 v[108:109], v12 offset:24576
ds_read_b64_tr_b16 v[110:111], v12 offset:26624
v_mfma_f32_16x16x32_bf16 v[148:151], v[52:55], v[36:39], v[148:151]
ds_read_b128 v[88:91], v3 offset:32768
ds_read_b64_tr_b16 v[112:113], v9 offset:28672
v_mfma_f32_16x16x32_bf16 v[152:155], v[56:59], v[36:39], v[152:155]
ds_read_b64_tr_b16 v[114:115], v9 offset:30720
v_mfma_f32_16x16x32_bf16 v[156:159], v[60:63], v[36:39], v[156:159]
ds_read_b64_tr_b16 v[116:117], v10 offset:28672
v_mfma_f32_16x16x32_bf16 v[128:131], v[64:67], v[40:43], v[128:131]
ds_read_b64_tr_b16 v[118:119], v10 offset:30720
v_mfma_f32_16x16x32_bf16 v[132:135], v[68:71], v[40:43], v[132:135]
ds_read_b128 v[92:95], v3 offset:33024
v_mfma_f32_16x16x32_bf16 v[136:139], v[72:75], v[40:43], v[136:139]
ds_read_b64_tr_b16 v[120:121], v11 offset:28672
v_mfma_f32_16x16x32_bf16 v[140:143], v[76:79], v[40:43], v[140:143]
ds_read_b64_tr_b16 v[122:123], v11 offset:30720
v_mfma_f32_16x16x32_bf16 v[144:147], v[64:67], v[44:47], v[144:147]
ds_read_b64_tr_b16 v[124:125], v12 offset:28672
v_mfma_f32_16x16x32_bf16 v[148:151], v[68:71], v[44:47], v[148:151]
ds_read_b64_tr_b16 v[126:127], v12 offset:30720
v_mfma_f32_16x16x32_bf16 v[152:155], v[72:75], v[44:47], v[152:155]
v_mfma_f32_16x16x32_bf16 v[156:159], v[76:79], v[44:47], v[156:159]
s_waitcnt lgkmcnt(0)
s_barrier
v_mfma_f32_16x16x32_bf16 v[128:131], v[96:99], v[80:83], v[128:131]
v_mfma_f32_16x16x32_bf16 v[132:135], v[100:103], v[80:83], v[132:135]
v_mfma_f32_16x16x32_bf16 v[136:139], v[104:107], v[80:83], v[136:139]
v_mfma_f32_16x16x32_bf16 v[140:143], v[108:111], v[80:83], v[140:143]
v_mfma_f32_16x16x32_bf16 v[144:147], v[96:99], v[84:87], v[144:147]
v_mfma_f32_16x16x32_bf16 v[148:151], v[100:103], v[84:87], v[148:151]
v_mfma_f32_16x16x32_bf16 v[152:155], v[104:107], v[84:87], v[152:155]
v_mfma_f32_16x16x32_bf16 v[156:159], v[108:111], v[84:87], v[156:159]
v_mfma_f32_16x16x32_bf16 v[128:131], v[112:115], v[88:91], v[128:131]
v_mfma_f32_16x16x32_bf16 v[132:135], v[116:119], v[88:91], v[132:135]
v_mfma_f32_16x16x32_bf16 v[136:139], v[120:123], v[88:91], v[136:139]
v_mfma_f32_16x16x32_bf16 v[140:143], v[124:127], v[88:91], v[140:143]
v_mfma_f32_16x16x32_bf16 v[144:147], v[112:115], v[92:95], v[144:147]
v_mfma_f32_16x16x32_bf16 v[148:151], v[116:119], v[92:95], v[148:151]
v_mfma_f32_16x16x32_bf16 v[152:155], v[120:123], v[92:95], v[152:155]
v_mfma_f32_16x16x32_bf16 v[156:159], v[124:127], v[92:95], v[156:159]
s_nop 4
v_cvt_pk_bf16_f32 v96, v128, v129
v_cvt_pk_bf16_f32 v97, v130, v131
v_cvt_pk_bf16_f32 v98, v132, v133
v_cvt_pk_bf16_f32 v99, v134, v135
buffer_store_dwordx4 v[96:99], v2, s[20:23], 0 offen offset:0 sc1
v_cvt_pk_bf16_f32 v100, v136, v137
v_cvt_pk_bf16_f32 v101, v138, v139
v_cvt_pk_bf16_f32 v102, v140, v141
v_cvt_pk_bf16_f32 v103, v142, v143
buffer_store_dwordx4 v[100:103], v2, s[20:23], s50 offen offset:0 sc1
v_cvt_pk_bf16_f32 v104, v144, v145
v_cvt_pk_bf16_f32 v105, v146, v147
v_cvt_pk_bf16_f32 v106, v148, v149
v_cvt_pk_bf16_f32 v107, v150, v151
buffer_store_dwordx4 v[104:107], v2, s[20:23], 0 offen offset:256 sc1
v_cvt_pk_bf16_f32 v108, v152, v153
v_cvt_pk_bf16_f32 v109, v154, v155
v_cvt_pk_bf16_f32 v110, v156, v157
v_cvt_pk_bf16_f32 v111, v158, v159
buffer_store_dwordx4 v[108:111], v2, s[20:23], s50 offen offset:256 sc1
v_dot2_f32_bf16 v112, v96, s52, 0
v_dot2_f32_bf16 v113, v96, v96, 0
v_dot2_f32_bf16 v114, v104, s52, 0
v_dot2_f32_bf16 v115, v104, v104, 0
v_dot2_f32_bf16 v112, v97, s52, v112
v_dot2_f32_bf16 v113, v97, v97, v113
v_dot2_f32_bf16 v114, v105, s52, v114
v_dot2_f32_bf16 v115, v105, v105, v115
v_dot2_f32_bf16 v112, v98, s52, v112
v_dot2_f32_bf16 v113, v98, v98, v113
v_dot2_f32_bf16 v114, v106, s52, v114
v_dot2_f32_bf16 v115, v106, v106, v115
v_dot2_f32_bf16 v112, v99, s52, v112
v_dot2_f32_bf16 v113, v99, v99, v113
v_dot2_f32_bf16 v114, v107, s52, v114
v_dot2_f32_bf16 v115, v107, v107, v115
v_dot2_f32_bf16 v112, v100, s52, v112
v_dot2_f32_bf16 v113, v100, v100, v113
v_dot2_f32_bf16 v114, v108, s52, v114
v_dot2_f32_bf16 v115, v108, v108, v115
v_dot2_f32_bf16 v112, v101, s52, v112
v_dot2_f32_bf16 v113, v101, v101, v113
v_dot2_f32_bf16 v114, v109, s52, v114
v_dot2_f32_bf16 v115, v109, v109, v115
v_dot2_f32_bf16 v112, v102, s52, v112
v_dot2_f32_bf16 v113, v102, v102, v113
v_dot2_f32_bf16 v114, v110, s52, v114
v_dot2_f32_bf16 v115, v110, v110, v115
v_dot2_f32_bf16 v112, v103, s52, v112
v_dot2_f32_bf16 v113, v103, v103, v113
v_dot2_f32_bf16 v114, v111, s52, v114
v_dot2_f32_bf16 v115, v111, v111, v115
s_nop 2
v_permlane32_swap_b32 v112, v114
v_permlane32_swap_b32 v113, v115
v_add_f32 v112, v112, v114
v_add_f32 v113, v113, v115
s_nop 1
v_permlane16_swap_b32 v112, v113
v_add_f32 v112, v112, v113
buffer_store_dword v112, v22, s[24:27], 0 offen sc1
s_waitcnt vmcnt(0)
s_barrier
s_cmp_lg_u32 s36, 0
s_cbranch_scc1 Lsig_20
s_add_u32 s43, s34, 16
s_lshl_b32 s43, s43, 7
v_mov_b32 v19, s43
v_mov_b32 v20, 1
s_mov_b64 exec, 1
buffer_atomic_add v20, v19, s[56:59], 0 offen sc1
s_mov_b64 exec, -1
Lsig_20:
s_lshl_b32 s53, s47, 2
v_lshlrev_b32 v19, 11, v18
v_lshl_add_u32 v19, v17, 4, v19
s_lshl_b32 s43, s46, 10
v_add_u32 v2, s43, v19
v_add_u32 v3, 49152, v2
v_add_u32 v4, 98304, v2
v_lshrrev_b32 v19, 2, v17
v_lshl_add_u32 v20, v18, 2, v19
v_and_b32 v21, 7, v20
v_lshlrev_b32 v20, 8, v20
v_and_b32 v19, 3, v1
v_lshl_add_u32 v20, v19, 3, v20
s_add_u32 s43, s53, 0
v_xor_b32 v19, s43, v21
v_lshl_add_u32 v5, v19, 5, v20
s_add_u32 s43, s53, 1
v_xor_b32 v19, s43, v21
v_lshl_add_u32 v6, v19, 5, v20
s_add_u32 s43, s53, 2
v_xor_b32 v19, s43, v21
v_lshl_add_u32 v7, v19, 5, v20
s_add_u32 s43, s53, 3
v_xor_b32 v19, s43, v21
v_lshl_add_u32 v8, v19, 5, v20
v_add_u32 v9, 49152, v5
v_add_u32 v10, 49152, v6
v_add_u32 v11, 49152, v7
v_add_u32 v12, 49152, v8
v_add_u32 v13, 98304, v5
v_add_u32 v14, 98304, v6
v_add_u32 v15, 98304, v7
v_add_u32 v16, 98304, v8
v_mov_b32 v128, 0
v_mov_b32 v129, 0
v_mov_b32 v130, 0
v_mov_b32 v131, 0
v_mov_b32 v132, 0
v_mov_b32 v133, 0
v_mov_b32 v134, 0
v_mov_b32 v135, 0
v_mov_b32 v136, 0
v_mov_b32 v137, 0
v_mov_b32 v138, 0
v_mov_b32 v139, 0
v_mov_b32 v140, 0
v_mov_b32 v141, 0
v_mov_b32 v142, 0
v_mov_b32 v143, 0
v_mov_b32 v144, 0
v_mov_b32 v145, 0
v_mov_b32 v146, 0
v_mov_b32 v147, 0
v_mov_b32 v148, 0
v_mov_b32 v149, 0
v_mov_b32 v150, 0
v_mov_b32 v151, 0
v_mov_b32 v152, 0
v_mov_b32 v153, 0
v_mov_b32 v154, 0
v_mov_b32 v155, 0
v_mov_b32 v156, 0
v_mov_b32 v157, 0
v_mov_b32 v158, 0
v_mov_b32 v159, 0
v_mov_b32 v160, 0
v_mov_b32 v161, 0
v_mov_b32 v162, 0
v_mov_b32 v163, 0
v_mov_b32 v164, 0
v_mov_b32 v165, 0
v_mov_b32 v166, 0
v_mov_b32 v167, 0
v_mov_b32 v168, 0
v_mov_b32 v169, 0
v_mov_b32 v170, 0
v_mov_b32 v171, 0
v_mov_b32 v172, 0
v_mov_b32 v173, 0
v_mov_b32 v174, 0
v_mov_b32 v175, 0
v_mov_b32 v176, 0
v_mov_b32 v177, 0
v_mov_b32 v178, 0
v_mov_b32 v179, 0
v_mov_b32 v180, 0
v_mov_b32 v181, 0
v_mov_b32 v182, 0
v_mov_b32 v183, 0
v_mov_b32 v184, 0
v_mov_b32 v185, 0
v_mov_b32 v186, 0
v_mov_b32 v187, 0
v_mov_b32 v188, 0
v_mov_b32 v189, 0
v_mov_b32 v190, 0
v_mov_b32 v191, 0
v_mov_b32 v192, 0
v_mov_b32 v193, 0
v_mov_b32 v194, 0
v_mov_b32 v195, 0
v_mov_b32 v196, 0
v_mov_b32 v197, 0
v_mov_b32 v198, 0
v_mov_b32 v199, 0
v_mov_b32 v200, 0
v_mov_b32 v201, 0
v_mov_b32 v202, 0
v_mov_b32 v203, 0
v_mov_b32 v204, 0
v_mov_b32 v205, 0
v_mov_b32 v206, 0
v_mov_b32 v207, 0
v_mov_b32 v208, 0
v_mov_b32 v209, 0
v_mov_b32 v210, 0
v_mov_b32 v211, 0
v_mov_b32 v212, 0
v_mov_b32 v213, 0
v_mov_b32 v214, 0
v_mov_b32 v215, 0
v_mov_b32 v216, 0
v_mov_b32 v217, 0
v_mov_b32 v218, 0
v_mov_b32 v219, 0
v_mov_b32 v220, 0
v_mov_b32 v221, 0
v_mov_b32 v222, 0
v_mov_b32 v223, 0
v_mov_b32 v224, 0
v_mov_b32 v225, 0
v_mov_b32 v226, 0
v_mov_b32 v227, 0
v_mov_b32 v228, 0
v_mov_b32 v229, 0
v_mov_b32 v230, 0
v_mov_b32 v231, 0
v_mov_b32 v232, 0
v_mov_b32 v233, 0
v_mov_b32 v234, 0
v_mov_b32 v235, 0
v_mov_b32 v236, 0
v_mov_b32 v237, 0
v_mov_b32 v238, 0
v_mov_b32 v239, 0
v_mov_b32 v240, 0
v_mov_b32 v241, 0
v_mov_b32 v242, 0
v_mov_b32 v243, 0
v_mov_b32 v244, 0
v_mov_b32 v245, 0
v_mov_b32 v246, 0
v_mov_b32 v247, 0
v_mov_b32 v248, 0
v_mov_b32 v249, 0
v_mov_b32 v250, 0
v_mov_b32 v251, 0
v_mov_b32 v252, 0
v_mov_b32 v253, 0
v_mov_b32 v254, 0
v_mov_b32 v255, 0
s_mul_i32 s43, s35, 192
s_and_b32 s43, s43, 0xffffff80
s_add_u32 s43, s43, 4096
s_cmp_eq_u32 s51, 1
s_cselect_b32 s8, s4, s6
s_cselect_b32 s9, s5, s7
s_sub_u32 s10, 7340032, s43
s_lshl_b32 s44, s34, 18
s_add_u32 s44, s44, 4194304
s_movk_i32 s38, 28672
s_cmp_eq_u32 s51, 0
s_cselect_b32 s8, s32, s8
s_cselect_b32 s9, s33, s9
s_cselect_b32 s10, 262144, s10
s_cselect_b32 s43, s44, s43
s_cselect_b32 s38, 1024, s38
s_cselect_b32 s45, 0, -1
s_add_u32 s8, s8, s43
s_addc_u32 s9, s9, 0
s_mov_b32 s11, 0x20000
s_sub_u32 s37, 0, s38
s_lshl_b32 s39, s51, 14
v_lshrrev_b32 v19, 4, v1
v_lshlrev_b32 v20, 5, v19
v_mul_u32_u24 v19, 6912, v19
v_and_b32 v19, s45, v19
v_and_b32 v20, s45, v20
v_lshlrev_b32 v21, 4, v1
v_xor_b32 v21, v21, v20
v_add_u32 v22, v21, v19
s_and_b32 s45, s45, 128
v_xor_b32 v23, s45, v22
s_mul_i32 s43, s38, 32
s_add_u32 s37, s37, s43
s_mul_i32 s43, s34, 917504
s_mul_i32 s44, s35, 16384
s_add_u32 s43, s43, s44
s_add_u32 s43, s43, 8388608
s_add_u32 s24, s32, s43
s_addc_u32 s25, s33, 0
s_mov_b32 s26, 278528
s_mov_b32 s27, 0x20000
s_mov_b32 s53, 262144
s_lshl_b32 s43, s47, 13
s_lshl_b32 s44, s46, 10
s_add_u32 s43, s43, s44
v_lshlrev_b32 v19, 11, v18
v_lshl_add_u32 v19, v17, 4, v19
v_add_u32 v27, s43, v19
s_lshl_b32 s43, s34, 18
s_lshl_b32 s44, s35, 7
s_add_u32 s43, s43, s44
s_add_u32 s16, s62, s43
s_addc_u32 s17, s63, 0
s_mov_b32 s18, 260224
s_mov_b32 s19, 0x20000
s_lshl_b32 s43, s36, 5
v_lshl_add_u32 v19, v17, 1, s43
v_lshlrev_b32 v19, 11, v19
v_and_b32 v20, 1, v18
v_lshl_add_u32 v19, v20, 5, v19
v_lshrrev_b32 v20, 1, v18
v_lshl_add_u32 v28, v20, 4, v19
s_lshl_b32 s43, s34, 18
s_add_u32 s12, s32, s43
s_addc_u32 s13, s33, 0
s_add_u32 s12, s12, 4194304
s_addc_u32 s13, s13, 0
s_mov_b32 s14, 262144
s_mov_b32 s15, 0x20000
v_lshlrev_b32 v21, 4, v1
s_lshl_b32 s54, s36, 11
s_barrier
s_add_u32 m0, s54, 98304
s_add_u32 s43, s54, 0
buffer_load_dwordx4 v21, s[12:15], s43 offen sc1 lds
s_add_u32 m0, s54, 99328
s_add_u32 s43, s54, 1024
buffer_load_dwordx4 v21, s[12:15], s43 offen sc1 lds
s_add_u32 m0, s54, 0
s_add_u32 s43, s54, 16384
buffer_load_dwordx4 v21, s[12:15], s43 offen sc1 lds
s_add_u32 m0, s54, 1024
s_add_u32 s43, s54, 17408
buffer_load_dwordx4 v21, s[12:15], s43 offen sc1 lds
s_add_u32 m0, s54, 49152
s_add_u32 s43, s54, 32768
buffer_load_dwordx4 v21, s[12:15], s43 offen sc1 lds
s_add_u32 m0, s54, 50176
s_add_u32 s43, s54, 33792
buffer_load_dwordx4 v21, s[12:15], s43 offen sc1 lds
s_waitcnt vmcnt(4)
s_barrier
s_setprio 1
ds_read_b128 v[32:35], v4 offset:0
ds_read_b64_tr_b16 v[48:49], v13 offset:16384
ds_read_b64_tr_b16 v[50:51], v13 offset:20480
ds_read_b128 v[36:39], v4 offset:256
ds_read_b128 v[40:43], v4 offset:512
ds_read_b128 v[44:47], v4 offset:768
ds_read_b64_tr_b16 v[64:65], v13 offset:32768
ds_read_b64_tr_b16 v[66:67], v13 offset:36864
ds_read_b64_tr_b16 v[52:53], v14 offset:16384
ds_read_b64_tr_b16 v[54:55], v14 offset:20480
ds_read_b64_tr_b16 v[68:69], v14 offset:32768
ds_read_b64_tr_b16 v[70:71], v14 offset:36864
ds_read_b64_tr_b16 v[56:57], v15 offset:16384
ds_read_b64_tr_b16 v[58:59], v15 offset:20480
ds_read_b64_tr_b16 v[72:73], v15 offset:32768
ds_read_b64_tr_b16 v[74:75], v15 offset:36864
ds_read_b64_tr_b16 v[60:61], v16 offset:16384
ds_read_b64_tr_b16 v[62:63], v16 offset:20480
ds_read_b64_tr_b16 v[76:77], v16 offset:32768
ds_read_b64_tr_b16 v[78:79], v16 offset:36864
s_mov_b32 s41, 5
Lk3_21:
s_waitcnt lgkmcnt(0)
v_mfma_f32_16x16x32_bf16 v[128:131], v[48:51], v[32:35], v[128:131]
ds_read_b128 v[80:83], v4 offset:8192
v_mfma_f32_16x16x32_bf16 v[132:135], v[48:51], v[36:39], v[132:135]
ds_read_b64_tr_b16 v[96:97], v13 offset:24576
v_mfma_f32_16x16x32_bf16 v[136:139], v[48:51], v[40:43], v[136:139]
ds_read_b64_tr_b16 v[98:99], v13 offset:28672
v_mfma_f32_16x16x32_bf16 v[140:143], v[48:51], v[44:47], v[140:143]
ds_read_b128 v[84:87], v4 offset:8448
v_mfma_f32_16x16x32_bf16 v[192:195], v[64:67], v[32:35], v[192:195]
ds_read_b128 v[88:91], v4 offset:8704
v_mfma_f32_16x16x32_bf16 v[196:199], v[64:67], v[36:39], v[196:199]
ds_read_b128 v[92:95], v4 offset:8960
v_mfma_f32_16x16x32_bf16 v[200:203], v[64:67], v[40:43], v[200:203]
ds_read_b64_tr_b16 v[112:113], v13 offset:40960
v_mfma_f32_16x16x32_bf16 v[204:207], v[64:67], v[44:47], v[204:207]
ds_read_b64_tr_b16 v[114:115], v13 offset:45056
v_mfma_f32_16x16x32_bf16 v[144:147], v[52:55], v[32:35], v[144:147]
ds_read_b64_tr_b16 v[100:101], v14 offset:24576
v_mfma_f32_16x16x32_bf16 v[148:151], v[52:55], v[36:39], v[148:151]
ds_read_b64_tr_b16 v[102:103], v14 offset:28672
v_mfma_f32_16x16x32_bf16 v[152:155], v[52:55], v[40:43], v[152:155]
ds_read_b64_tr_b16 v[116:117], v14 offset:40960
v_mfma_f32_16x16x32_bf16 v[156:159], v[52:55], v[44:47], v[156:159]
ds_read_b64_tr_b16 v[118:119], v14 offset:45056
v_mfma_f32_16x16x32_bf16 v[208:211], v[68:71], v[32:35], v[208:211]
ds_read_b64_tr_b16 v[104:105], v15 offset:24576
v_mfma_f32_16x16x32_bf16 v[212:215], v[68:71], v[36:39], v[212:215]
ds_read_b64_tr_b16 v[106:107], v15 offset:28672
v_mfma_f32_16x16x32_bf16 v[216:219], v[68:71], v[40:43], v[216:219]
ds_read_b64_tr_b16 v[120:121], v15 offset:40960
v_mfma_f32_16x16x32_bf16 v[220:223], v[68:71], v[44:47], v[220:223]
ds_read_b64_tr_b16 v[122:123], v15 offset:45056
v_mfma_f32_16x16x32_bf16 v[160:163], v[56:59], v[32:35], v[160:163]
ds_read_b64_tr_b16 v[108:109], v16 offset:24576
v_mfma_f32_16x16x32_bf16 v[164:167], v[56:59], v[36:39], v[164:167]
ds_read_b64_tr_b16 v[110:111], v16 offset:28672
v_mfma_f32_16x16x32_bf16 v[168:171], v[56:59], v[40:43], v[168:171]
ds_read_b64_tr_b16 v[124:125], v16 offset:40960
v_mfma_f32_16x16x32_bf16 v[172:175], v[56:59], v[44:47], v[172:175]
ds_read_b64_tr_b16 v[126:127], v16 offset:45056
v_mfma_f32_16x16x32_bf16 v[224:227], v[72:75], v[32:35], v[224:227]
v_mfma_f32_16x16x32_bf16 v[228:231], v[72:75], v[36:39], v[228:231]
v_mfma_f32_16x16x32_bf16 v[232:235], v[72:75], v[40:43], v[232:235]
v_mfma_f32_16x16x32_bf16 v[236:239], v[72:75], v[44:47], v[236:239]
v_mfma_f32_16x16x32_bf16 v[176:179], v[60:63], v[32:35], v[176:179]
v_mfma_f32_16x16x32_bf16 v[180:183], v[60:63], v[36:39], v[180:183]
v_mfma_f32_16x16x32_bf16 v[184:187], v[60:63], v[40:43], v[184:187]
v_mfma_f32_16x16x32_bf16 v[188:191], v[60:63], v[44:47], v[188:191]
v_mfma_f32_16x16x32_bf16 v[240:243], v[76:79], v[32:35], v[240:243]
v_mfma_f32_16x16x32_bf16 v[244:247], v[76:79], v[36:39], v[244:247]
v_mfma_f32_16x16x32_bf16 v[248:251], v[76:79], v[40:43], v[248:251]
v_mfma_f32_16x16x32_bf16 v[252:255], v[76:79], v[44:47], v[252:255]
s_waitcnt vmcnt(2) lgkmcnt(0)
s_barrier
v_mfma_f32_16x16x32_bf16 v[128:131], v[96:99], v[80:83], v[128:131]
ds_read_b128 v[32:35], v2 offset:0
v_mfma_f32_16x16x32_bf16 v[132:135], v[96:99], v[84:87], v[132:135]
ds_read_b64_tr_b16 v[48:49], v5 offset:16384
v_mfma_f32_16x16x32_bf16 v[136:139], v[96:99], v[88:91], v[136:139]
ds_read_b64_tr_b16 v[50:51], v5 offset:20480
v_mfma_f32_16x16x32_bf16 v[140:143], v[96:99], v[92:95], v[140:143]
ds_read_b128 v[36:39], v2 offset:256
v_mfma_f32_16x16x32_bf16 v[192:195], v[112:115], v[80:83], v[192:195]
ds_read_b128 v[40:43], v2 offset:512
v_mfma_f32_16x16x32_bf16 v[196:199], v[112:115], v[84:87], v[196:199]
ds_read_b128 v[44:47], v2 offset:768
v_mfma_f32_16x16x32_bf16 v[200:203], v[112:115], v[88:91], v[200:203]
ds_read_b64_tr_b16 v[64:65], v5 offset:32768
v_mfma_f32_16x16x32_bf16 v[204:207], v[112:115], v[92:95], v[204:207]
ds_read_b64_tr_b16 v[66:67], v5 offset:36864
v_mfma_f32_16x16x32_bf16 v[144:147], v[100:103], v[80:83], v[144:147]
ds_read_b64_tr_b16 v[52:53], v6 offset:16384
v_mfma_f32_16x16x32_bf16 v[148:151], v[100:103], v[84:87], v[148:151]
ds_read_b64_tr_b16 v[54:55], v6 offset:20480
v_mfma_f32_16x16x32_bf16 v[152:155], v[100:103], v[88:91], v[152:155]
ds_read_b64_tr_b16 v[68:69], v6 offset:32768
v_mfma_f32_16x16x32_bf16 v[156:159], v[100:103], v[92:95], v[156:159]
ds_read_b64_tr_b16 v[70:71], v6 offset:36864
v_mfma_f32_16x16x32_bf16 v[208:211], v[116:119], v[80:83], v[208:211]
ds_read_b64_tr_b16 v[56:57], v7 offset:16384
v_mfma_f32_16x16x32_bf16 v[212:215], v[116:119], v[84:87], v[212:215]
ds_read_b64_tr_b16 v[58:59], v7 offset:20480
v_mfma_f32_16x16x32_bf16 v[216:219], v[116:119], v[88:91], v[216:219]
ds_read_b64_tr_b16 v[72:73], v7 offset:32768
v_mfma_f32_16x16x32_bf16 v[220:223], v[116:119], v[92:95], v[220:223]
ds_read_b64_tr_b16 v[74:75], v7 offset:36864
v_mfma_f32_16x16x32_bf16 v[160:163], v[104:107], v[80:83], v[160:163]
ds_read_b64_tr_b16 v[60:61], v8 offset:16384
v_mfma_f32_16x16x32_bf16 v[164:167], v[104:107], v[84:87], v[164:167]
ds_read_b64_tr_b16 v[62:63], v8 offset:20480
v_mfma_f32_16x16x32_bf16 v[168:171], v[104:107], v[88:91], v[168:171]
ds_read_b64_tr_b16 v[76:77], v8 offset:32768
v_mfma_f32_16x16x32_bf16 v[172:175], v[104:107], v[92:95], v[172:175]
ds_read_b64_tr_b16 v[78:79], v8 offset:36864
v_mfma_f32_16x16x32_bf16 v[224:227], v[120:123], v[80:83], v[224:227]
v_mfma_f32_16x16x32_bf16 v[228:231], v[120:123], v[84:87], v[228:231]
v_mfma_f32_16x16x32_bf16 v[232:235], v[120:123], v[88:91], v[232:235]
v_mfma_f32_16x16x32_bf16 v[236:239], v[120:123], v[92:95], v[236:239]
v_mfma_f32_16x16x32_bf16 v[176:179], v[108:111], v[80:83], v[176:179]
v_mfma_f32_16x16x32_bf16 v[180:183], v[108:111], v[84:87], v[180:183]
v_mfma_f32_16x16x32_bf16 v[184:187], v[108:111], v[88:91], v[184:187]
v_mfma_f32_16x16x32_bf16 v[188:191], v[108:111], v[92:95], v[188:191]
v_mfma_f32_16x16x32_bf16 v[240:243], v[124:127], v[80:83], v[240:243]
v_mfma_f32_16x16x32_bf16 v[244:247], v[124:127], v[84:87], v[244:247]
v_mfma_f32_16x16x32_bf16 v[248:251], v[124:127], v[88:91], v[248:251]
v_mfma_f32_16x16x32_bf16 v[252:255], v[124:127], v[92:95], v[252:255]
s_waitcnt lgkmcnt(0)
v_mfma_f32_16x16x32_bf16 v[128:131], v[48:51], v[32:35], v[128:131]
ds_read_b128 v[80:83], v2 offset:8192
v_mfma_f32_16x16x32_bf16 v[132:135], v[48:51], v[36:39], v[132:135]
ds_read_b64_tr_b16 v[96:97], v5 offset:24576
v_mfma_f32_16x16x32_bf16 v[136:139], v[48:51], v[40:43], v[136:139]
ds_read_b64_tr_b16 v[98:99], v5 offset:28672
v_mfma_f32_16x16x32_bf16 v[140:143], v[48:51], v[44:47], v[140:143]
ds_read_b128 v[84:87], v2 offset:8448
v_mfma_f32_16x16x32_bf16 v[192:195], v[64:67], v[32:35], v[192:195]
ds_read_b128 v[88:91], v2 offset:8704
v_mfma_f32_16x16x32_bf16 v[196:199], v[64:67], v[36:39], v[196:199]
ds_read_b128 v[92:95], v2 offset:8960
v_mfma_f32_16x16x32_bf16 v[200:203], v[64:67], v[40:43], v[200:203]
ds_read_b64_tr_b16 v[112:113], v5 offset:40960
v_mfma_f32_16x16x32_bf16 v[204:207], v[64:67], v[44:47], v[204:207]
ds_read_b64_tr_b16 v[114:115], v5 offset:45056
v_mfma_f32_16x16x32_bf16 v[144:147], v[52:55], v[32:35], v[144:147]
ds_read_b64_tr_b16 v[100:101], v6 offset:24576
v_mfma_f32_16x16x32_bf16 v[148:151], v[52:55], v[36:39], v[148:151]
ds_read_b64_tr_b16 v[102:103], v6 offset:28672
v_mfma_f32_16x16x32_bf16 v[152:155], v[52:55], v[40:43], v[152:155]
ds_read_b64_tr_b16 v[116:117], v6 offset:40960
v_mfma_f32_16x16x32_bf16 v[156:159], v[52:55], v[44:47], v[156:159]
ds_read_b64_tr_b16 v[118:119], v6 offset:45056
v_mfma_f32_16x16x32_bf16 v[208:211], v[68:71], v[32:35], v[208:211]
ds_read_b64_tr_b16 v[104:105], v7 offset:24576
v_mfma_f32_16x16x32_bf16 v[212:215], v[68:71], v[36:39], v[212:215]
ds_read_b64_tr_b16 v[106:107], v7 offset:28672
v_mfma_f32_16x16x32_bf16 v[216:219], v[68:71], v[40:43], v[216:219]
ds_read_b64_tr_b16 v[120:121], v7 offset:40960
v_mfma_f32_16x16x32_bf16 v[220:223], v[68:71], v[44:47], v[220:223]
ds_read_b64_tr_b16 v[122:123], v7 offset:45056
v_mfma_f32_16x16x32_bf16 v[160:163], v[56:59], v[32:35], v[160:163]
ds_read_b64_tr_b16 v[108:109], v8 offset:24576
v_mfma_f32_16x16x32_bf16 v[164:167], v[56:59], v[36:39], v[164:167]
ds_read_b64_tr_b16 v[110:111], v8 offset:28672
v_mfma_f32_16x16x32_bf16 v[168:171], v[56:59], v[40:43], v[168:171]
ds_read_b64_tr_b16 v[124:125], v8 offset:40960
v_mfma_f32_16x16x32_bf16 v[172:175], v[56:59], v[44:47], v[172:175]
ds_read_b64_tr_b16 v[126:127], v8 offset:45056
v_mfma_f32_16x16x32_bf16 v[224:227], v[72:75], v[32:35], v[224:227]
v_mfma_f32_16x16x32_bf16 v[228:231], v[72:75], v[36:39], v[228:231]
v_mfma_f32_16x16x32_bf16 v[232:235], v[72:75], v[40:43], v[232:235]
v_mfma_f32_16x16x32_bf16 v[236:239], v[72:75], v[44:47], v[236:239]
v_mfma_f32_16x16x32_bf16 v[176:179], v[60:63], v[32:35], v[176:179]
v_mfma_f32_16x16x32_bf16 v[180:183], v[60:63], v[36:39], v[180:183]
v_mfma_f32_16x16x32_bf16 v[184:187], v[60:63], v[40:43], v[184:187]
v_mfma_f32_16x16x32_bf16 v[188:191], v[60:63], v[44:47], v[188:191]
v_mfma_f32_16x16x32_bf16 v[240:243], v[76:79], v[32:35], v[240:243]
v_mfma_f32_16x16x32_bf16 v[244:247], v[76:79], v[36:39], v[244:247]
v_mfma_f32_16x16x32_bf16 v[248:251], v[76:79], v[40:43], v[248:251]
v_mfma_f32_16x16x32_bf16 v[252:255], v[76:79], v[44:47], v[252:255]
s_waitcnt vmcnt(0) lgkmcnt(0)
s_barrier
v_mfma_f32_16x16x32_bf16 v[128:131], v[96:99], v[80:83], v[128:131]
ds_read_b128 v[32:35], v3 offset:0
v_mfma_f32_16x16x32_bf16 v[132:135], v[96:99], v[84:87], v[132:135]
ds_read_b64_tr_b16 v[48:49], v9 offset:16384
v_mfma_f32_16x16x32_bf16 v[136:139], v[96:99], v[88:91], v[136:139]
ds_read_b64_tr_b16 v[50:51], v9 offset:20480
v_mfma_f32_16x16x32_bf16 v[140:143], v[96:99], v[92:95], v[140:143]
ds_read_b128 v[36:39], v3 offset:256
v_mfma_f32_16x16x32_bf16 v[192:195], v[112:115], v[80:83], v[192:195]
ds_read_b128 v[40:43], v3 offset:512
v_mfma_f32_16x16x32_bf16 v[196:199], v[112:115], v[84:87], v[196:199]
ds_read_b128 v[44:47], v3 offset:768
v_mfma_f32_16x16x32_bf16 v[200:203], v[112:115], v[88:91], v[200:203]
ds_read_b64_tr_b16 v[64:65], v9 offset:32768
v_mfma_f32_16x16x32_bf16 v[204:207], v[112:115], v[92:95], v[204:207]
ds_read_b64_tr_b16 v[66:67], v9 offset:36864
v_mfma_f32_16x16x32_bf16 v[144:147], v[100:103], v[80:83], v[144:147]
ds_read_b64_tr_b16 v[52:53], v10 offset:16384
v_mfma_f32_16x16x32_bf16 v[148:151], v[100:103], v[84:87], v[148:151]
ds_read_b64_tr_b16 v[54:55], v10 offset:20480
v_mfma_f32_16x16x32_bf16 v[152:155], v[100:103], v[88:91], v[152:155]
ds_read_b64_tr_b16 v[68:69], v10 offset:32768
v_mfma_f32_16x16x32_bf16 v[156:159], v[100:103], v[92:95], v[156:159]
ds_read_b64_tr_b16 v[70:71], v10 offset:36864
v_mfma_f32_16x16x32_bf16 v[208:211], v[116:119], v[80:83], v[208:211]
ds_read_b64_tr_b16 v[56:57], v11 offset:16384
v_mfma_f32_16x16x32_bf16 v[212:215], v[116:119], v[84:87], v[212:215]
ds_read_b64_tr_b16 v[58:59], v11 offset:20480
v_mfma_f32_16x16x32_bf16 v[216:219], v[116:119], v[88:91], v[216:219]
ds_read_b64_tr_b16 v[72:73], v11 offset:32768
v_mfma_f32_16x16x32_bf16 v[220:223], v[116:119], v[92:95], v[220:223]
ds_read_b64_tr_b16 v[74:75], v11 offset:36864
v_mfma_f32_16x16x32_bf16 v[160:163], v[104:107], v[80:83], v[160:163]
ds_read_b64_tr_b16 v[60:61], v12 offset:16384
v_mfma_f32_16x16x32_bf16 v[164:167], v[104:107], v[84:87], v[164:167]
ds_read_b64_tr_b16 v[62:63], v12 offset:20480
v_mfma_f32_16x16x32_bf16 v[168:171], v[104:107], v[88:91], v[168:171]
ds_read_b64_tr_b16 v[76:77], v12 offset:32768
v_mfma_f32_16x16x32_bf16 v[172:175], v[104:107], v[92:95], v[172:175]
ds_read_b64_tr_b16 v[78:79], v12 offset:36864
v_mfma_f32_16x16x32_bf16 v[224:227], v[120:123], v[80:83], v[224:227]
v_mfma_f32_16x16x32_bf16 v[228:231], v[120:123], v[84:87], v[228:231]
v_mfma_f32_16x16x32_bf16 v[232:235], v[120:123], v[88:91], v[232:235]
v_mfma_f32_16x16x32_bf16 v[236:239], v[120:123], v[92:95], v[236:239]
v_mfma_f32_16x16x32_bf16 v[176:179], v[108:111], v[80:83], v[176:179]
v_mfma_f32_16x16x32_bf16 v[180:183], v[108:111], v[84:87], v[180:183]
v_mfma_f32_16x16x32_bf16 v[184:187], v[108:111], v[88:91], v[184:187]
v_mfma_f32_16x16x32_bf16 v[188:191], v[108:111], v[92:95], v[188:191]
v_mfma_f32_16x16x32_bf16 v[240:243], v[124:127], v[80:83], v[240:243]
v_mfma_f32_16x16x32_bf16 v[244:247], v[124:127], v[84:87], v[244:247]
v_mfma_f32_16x16x32_bf16 v[248:251], v[124:127], v[88:91], v[248:251]
v_mfma_f32_16x16x32_bf16 v[252:255], v[124:127], v[92:95], v[252:255]
s_waitcnt lgkmcnt(0)
v_mfma_f32_16x16x32_bf16 v[128:131], v[48:51], v[32:35], v[128:131]
ds_read_b128 v[80:83], v3 offset:8192
v_mfma_f32_16x16x32_bf16 v[132:135], v[48:51], v[36:39], v[132:135]
ds_read_b64_tr_b16 v[96:97], v9 offset:24576
v_mfma_f32_16x16x32_bf16 v[136:139], v[48:51], v[40:43], v[136:139]
ds_read_b64_tr_b16 v[98:99], v9 offset:28672
v_mfma_f32_16x16x32_bf16 v[140:143], v[48:51], v[44:47], v[140:143]
ds_read_b128 v[84:87], v3 offset:8448
v_mfma_f32_16x16x32_bf16 v[192:195], v[64:67], v[32:35], v[192:195]
ds_read_b128 v[88:91], v3 offset:8704
v_mfma_f32_16x16x32_bf16 v[196:199], v[64:67], v[36:39], v[196:199]
ds_read_b128 v[92:95], v3 offset:8960
v_mfma_f32_16x16x32_bf16 v[200:203], v[64:67], v[40:43], v[200:203]
ds_read_b64_tr_b16 v[112:113], v9 offset:40960
v_mfma_f32_16x16x32_bf16 v[204:207], v[64:67], v[44:47], v[204:207]
ds_read_b64_tr_b16 v[114:115], v9 offset:45056
v_mfma_f32_16x16x32_bf16 v[144:147], v[52:55], v[32:35], v[144:147]
ds_read_b64_tr_b16 v[100:101], v10 offset:24576
v_mfma_f32_16x16x32_bf16 v[148:151], v[52:55], v[36:39], v[148:151]
ds_read_b64_tr_b16 v[102:103], v10 offset:28672
v_mfma_f32_16x16x32_bf16 v[152:155], v[52:55], v[40:43], v[152:155]
ds_read_b64_tr_b16 v[116:117], v10 offset:40960
v_mfma_f32_16x16x32_bf16 v[156:159], v[52:55], v[44:47], v[156:159]
ds_read_b64_tr_b16 v[118:119], v10 offset:45056
v_mfma_f32_16x16x32_bf16 v[208:211], v[68:71], v[32:35], v[208:211]
ds_read_b64_tr_b16 v[104:105], v11 offset:24576
v_mfma_f32_16x16x32_bf16 v[212:215], v[68:71], v[36:39], v[212:215]
ds_read_b64_tr_b16 v[106:107], v11 offset:28672
v_mfma_f32_16x16x32_bf16 v[216:219], v[68:71], v[40:43], v[216:219]
ds_read_b64_tr_b16 v[120:121], v11 offset:40960
v_mfma_f32_16x16x32_bf16 v[220:223], v[68:71], v[44:47], v[220:223]
ds_read_b64_tr_b16 v[122:123], v11 offset:45056
v_mfma_f32_16x16x32_bf16 v[160:163], v[56:59], v[32:35], v[160:163]
ds_read_b64_tr_b16 v[108:109], v12 offset:24576
v_mfma_f32_16x16x32_bf16 v[164:167], v[56:59], v[36:39], v[164:167]
ds_read_b64_tr_b16 v[110:111], v12 offset:28672
v_mfma_f32_16x16x32_bf16 v[168:171], v[56:59], v[40:43], v[168:171]
ds_read_b64_tr_b16 v[124:125], v12 offset:40960
v_mfma_f32_16x16x32_bf16 v[172:175], v[56:59], v[44:47], v[172:175]
ds_read_b64_tr_b16 v[126:127], v12 offset:45056
v_mfma_f32_16x16x32_bf16 v[224:227], v[72:75], v[32:35], v[224:227]
v_mfma_f32_16x16x32_bf16 v[228:231], v[72:75], v[36:39], v[228:231]
v_mfma_f32_16x16x32_bf16 v[232:235], v[72:75], v[40:43], v[232:235]
v_mfma_f32_16x16x32_bf16 v[236:239], v[72:75], v[44:47], v[236:239]
v_mfma_f32_16x16x32_bf16 v[176:179], v[60:63], v[32:35], v[176:179]
v_mfma_f32_16x16x32_bf16 v[180:183], v[60:63], v[36:39], v[180:183]
v_mfma_f32_16x16x32_bf16 v[184:187], v[60:63], v[40:43], v[184:187]
v_mfma_f32_16x16x32_bf16 v[188:191], v[60:63], v[44:47], v[188:191]
v_mfma_f32_16x16x32_bf16 v[240:243], v[76:79], v[32:35], v[240:243]
v_mfma_f32_16x16x32_bf16 v[244:247], v[76:79], v[36:39], v[244:247]
v_mfma_f32_16x16x32_bf16 v[248:251], v[76:79], v[40:43], v[248:251]
v_mfma_f32_16x16x32_bf16 v[252:255], v[76:79], v[44:47], v[252:255]
s_waitcnt lgkmcnt(0)
s_barrier
v_mfma_f32_16x16x32_bf16 v[128:131], v[96:99], v[80:83], v[128:131]
ds_read_b128 v[32:35], v4 offset:0
v_mfma_f32_16x16x32_bf16 v[132:135], v[96:99], v[84:87], v[132:135]
ds_read_b64_tr_b16 v[48:49], v13 offset:16384
v_mfma_f32_16x16x32_bf16 v[136:139], v[96:99], v[88:91], v[136:139]
ds_read_b64_tr_b16 v[50:51], v13 offset:20480
v_mfma_f32_16x16x32_bf16 v[140:143], v[96:99], v[92:95], v[140:143]
ds_read_b128 v[36:39], v4 offset:256
v_mfma_f32_16x16x32_bf16 v[192:195], v[112:115], v[80:83], v[192:195]
ds_read_b128 v[40:43], v4 offset:512
v_mfma_f32_16x16x32_bf16 v[196:199], v[112:115], v[84:87], v[196:199]
ds_read_b128 v[44:47], v4 offset:768
v_mfma_f32_16x16x32_bf16 v[200:203], v[112:115], v[88:91], v[200:203]
ds_read_b64_tr_b16 v[64:65], v13 offset:32768
v_mfma_f32_16x16x32_bf16 v[204:207], v[112:115], v[92:95], v[204:207]
ds_read_b64_tr_b16 v[66:67], v13 offset:36864
v_mfma_f32_16x16x32_bf16 v[144:147], v[100:103], v[80:83], v[144:147]
ds_read_b64_tr_b16 v[52:53], v14 offset:16384
v_mfma_f32_16x16x32_bf16 v[148:151], v[100:103], v[84:87], v[148:151]
ds_read_b64_tr_b16 v[54:55], v14 offset:20480
v_mfma_f32_16x16x32_bf16 v[152:155], v[100:103], v[88:91], v[152:155]
ds_read_b64_tr_b16 v[68:69], v14 offset:32768
v_mfma_f32_16x16x32_bf16 v[156:159], v[100:103], v[92:95], v[156:159]
ds_read_b64_tr_b16 v[70:71], v14 offset:36864
v_mfma_f32_16x16x32_bf16 v[208:211], v[116:119], v[80:83], v[208:211]
ds_read_b64_tr_b16 v[56:57], v15 offset:16384
v_mfma_f32_16x16x32_bf16 v[212:215], v[116:119], v[84:87], v[212:215]
ds_read_b64_tr_b16 v[58:59], v15 offset:20480
v_mfma_f32_16x16x32_bf16 v[216:219], v[116:119], v[88:91], v[216:219]
ds_read_b64_tr_b16 v[72:73], v15 offset:32768
v_mfma_f32_16x16x32_bf16 v[220:223], v[116:119], v[92:95], v[220:223]
ds_read_b64_tr_b16 v[74:75], v15 offset:36864
v_mfma_f32_16x16x32_bf16 v[160:163], v[104:107], v[80:83], v[160:163]
ds_read_b64_tr_b16 v[60:61], v16 offset:16384
v_mfma_f32_16x16x32_bf16 v[164:167], v[104:107], v[84:87], v[164:167]
ds_read_b64_tr_b16 v[62:63], v16 offset:20480
v_mfma_f32_16x16x32_bf16 v[168:171], v[104:107], v[88:91], v[168:171]
ds_read_b64_tr_b16 v[76:77], v16 offset:32768
v_mfma_f32_16x16x32_bf16 v[172:175], v[104:107], v[92:95], v[172:175]
ds_read_b64_tr_b16 v[78:79], v16 offset:36864
v_mfma_f32_16x16x32_bf16 v[224:227], v[120:123], v[80:83], v[224:227]
v_mfma_f32_16x16x32_bf16 v[228:231], v[120:123], v[84:87], v[228:231]
v_mfma_f32_16x16x32_bf16 v[232:235], v[120:123], v[88:91], v[232:235]
v_mfma_f32_16x16x32_bf16 v[236:239], v[120:123], v[92:95], v[236:239]
v_mfma_f32_16x16x32_bf16 v[176:179], v[108:111], v[80:83], v[176:179]
v_mfma_f32_16x16x32_bf16 v[180:183], v[108:111], v[84:87], v[180:183]
v_mfma_f32_16x16x32_bf16 v[184:187], v[108:111], v[88:91], v[184:187]
v_mfma_f32_16x16x32_bf16 v[188:191], v[108:111], v[92:95], v[188:191]
v_mfma_f32_16x16x32_bf16 v[240:243], v[124:127], v[80:83], v[240:243]
v_mfma_f32_16x16x32_bf16 v[244:247], v[124:127], v[84:87], v[244:247]
v_mfma_f32_16x16x32_bf16 v[248:251], v[124:127], v[88:91], v[248:251]
v_mfma_f32_16x16x32_bf16 v[252:255], v[124:127], v[92:95], v[252:255]
s_sub_u32 s41, s41, 1
s_cmp_lg_u32 s41, 0
s_cbranch_scc1 Lk3_21
s_waitcnt lgkmcnt(0)
v_mfma_f32_16x16x32_bf16 v[128:131], v[48:51], v[32:35], v[128:131]
ds_read_b128 v[80:83], v4 offset:8192
v_mfma_f32_16x16x32_bf16 v[132:135], v[48:51], v[36:39], v[132:135]
ds_read_b64_tr_b16 v[96:97], v13 offset:24576
v_mfma_f32_16x16x32_bf16 v[136:139], v[48:51], v[40:43], v[136:139]
ds_read_b64_tr_b16 v[98:99], v13 offset:28672
v_mfma_f32_16x16x32_bf16 v[140:143], v[48:51], v[44:47], v[140:143]
ds_read_b128 v[84:87], v4 offset:8448
v_mfma_f32_16x16x32_bf16 v[192:195], v[64:67], v[32:35], v[192:195]
ds_read_b128 v[88:91], v4 offset:8704
v_mfma_f32_16x16x32_bf16 v[196:199], v[64:67], v[36:39], v[196:199]
ds_read_b128 v[92:95], v4 offset:8960
v_mfma_f32_16x16x32_bf16 v[200:203], v[64:67], v[40:43], v[200:203]
ds_read_b64_tr_b16 v[112:113], v13 offset:40960
v_mfma_f32_16x16x32_bf16 v[204:207], v[64:67], v[44:47], v[204:207]
ds_read_b64_tr_b16 v[114:115], v13 offset:45056
v_mfma_f32_16x16x32_bf16 v[144:147], v[52:55], v[32:35], v[144:147]
ds_read_b64_tr_b16 v[100:101], v14 offset:24576
v_mfma_f32_16x16x32_bf16 v[148:151], v[52:55], v[36:39], v[148:151]
ds_read_b64_tr_b16 v[102:103], v14 offset:28672
v_mfma_f32_16x16x32_bf16 v[152:155], v[52:55], v[40:43], v[152:155]
ds_read_b64_tr_b16 v[116:117], v14 offset:40960
v_mfma_f32_16x16x32_bf16 v[156:159], v[52:55], v[44:47], v[156:159]
ds_read_b64_tr_b16 v[118:119], v14 offset:45056
v_mfma_f32_16x16x32_bf16 v[208:211], v[68:71], v[32:35], v[208:211]
ds_read_b64_tr_b16 v[104:105], v15 offset:24576
v_mfma_f32_16x16x32_bf16 v[212:215], v[68:71], v[36:39], v[212:215]
ds_read_b64_tr_b16 v[106:107], v15 offset:28672
v_mfma_f32_16x16x32_bf16 v[216:219], v[68:71], v[40:43], v[216:219]
ds_read_b64_tr_b16 v[120:121], v15 offset:40960
v_mfma_f32_16x16x32_bf16 v[220:223], v[68:71], v[44:47], v[220:223]
ds_read_b64_tr_b16 v[122:123], v15 offset:45056
v_mfma_f32_16x16x32_bf16 v[160:163], v[56:59], v[32:35], v[160:163]
ds_read_b64_tr_b16 v[108:109], v16 offset:24576
v_mfma_f32_16x16x32_bf16 v[164:167], v[56:59], v[36:39], v[164:167]
ds_read_b64_tr_b16 v[110:111], v16 offset:28672
v_mfma_f32_16x16x32_bf16 v[168:171], v[56:59], v[40:43], v[168:171]
ds_read_b64_tr_b16 v[124:125], v16 offset:40960
v_mfma_f32_16x16x32_bf16 v[172:175], v[56:59], v[44:47], v[172:175]
ds_read_b64_tr_b16 v[126:127], v16 offset:45056
v_mfma_f32_16x16x32_bf16 v[224:227], v[72:75], v[32:35], v[224:227]
v_mfma_f32_16x16x32_bf16 v[228:231], v[72:75], v[36:39], v[228:231]
v_mfma_f32_16x16x32_bf16 v[232:235], v[72:75], v[40:43], v[232:235]
v_mfma_f32_16x16x32_bf16 v[236:239], v[72:75], v[44:47], v[236:239]
v_mfma_f32_16x16x32_bf16 v[176:179], v[60:63], v[32:35], v[176:179]
v_mfma_f32_16x16x32_bf16 v[180:183], v[60:63], v[36:39], v[180:183]
v_mfma_f32_16x16x32_bf16 v[184:187], v[60:63], v[40:43], v[184:187]
v_mfma_f32_16x16x32_bf16 v[188:191], v[60:63], v[44:47], v[188:191]
v_mfma_f32_16x16x32_bf16 v[240:243], v[76:79], v[32:35], v[240:243]
v_mfma_f32_16x16x32_bf16 v[244:247], v[76:79], v[36:39], v[244:247]
v_mfma_f32_16x16x32_bf16 v[248:251], v[76:79], v[40:43], v[248:251]
v_mfma_f32_16x16x32_bf16 v[252:255], v[76:79], v[44:47], v[252:255]
s_waitcnt lgkmcnt(0)
s_barrier
s_cmp_eq_u32 s36, 3
s_cbranch_scc1 L3h_22
s_add_u32 m0, s39, 98304
s_add_u32 s37, s37, s38
buffer_load_dwordx4 v22, s[8:11], s37 offen sc1 lds
v_mfma_f32_16x16x32_bf16 v[128:131], v[96:99], v[80:83], v[128:131]
v_mfma_f32_16x16x32_bf16 v[132:135], v[96:99], v[84:87], v[132:135]
s_add_u32 m0, s39, 99328
s_add_u32 s37, s37, s38
buffer_load_dwordx4 v23, s[8:11], s37 offen sc1 lds
v_mfma_f32_16x16x32_bf16 v[136:139], v[96:99], v[88:91], v[136:139]
v_mfma_f32_16x16x32_bf16 v[140:143], v[96:99], v[92:95], v[140:143]
s_add_u32 m0, s39, 100352
s_add_u32 s37, s37, s38
buffer_load_dwordx4 v22, s[8:11], s37 offen sc1 lds
v_mfma_f32_16x16x32_bf16 v[192:195], v[112:115], v[80:83], v[192:195]
v_mfma_f32_16x16x32_bf16 v[196:199], v[112:115], v[84:87], v[196:199]
s_add_u32 m0, s39, 101376
s_add_u32 s37, s37, s38
buffer_load_dwordx4 v23, s[8:11], s37 offen sc1 lds
v_mfma_f32_16x16x32_bf16 v[200:203], v[112:115], v[88:91], v[200:203]
v_mfma_f32_16x16x32_bf16 v[204:207], v[112:115], v[92:95], v[204:207]
s_add_u32 m0, s39, 102400
s_add_u32 s37, s37, s38
buffer_load_dwordx4 v22, s[8:11], s37 offen sc1 lds
v_mfma_f32_16x16x32_bf16 v[144:147], v[100:103], v[80:83], v[144:147]
v_mfma_f32_16x16x32_bf16 v[148:151], v[100:103], v[84:87], v[148:151]
s_add_u32 m0, s39, 103424
s_add_u32 s37, s37, s38
buffer_load_dwordx4 v23, s[8:11], s37 offen sc1 lds
v_mfma_f32_16x16x32_bf16 v[152:155], v[100:103], v[88:91], v[152:155]
v_mfma_f32_16x16x32_bf16 v[156:159], v[100:103], v[92:95], v[156:159]
s_add_u32 m0, s39, 104448
s_add_u32 s37, s37, s38
buffer_load_dwordx4 v22, s[8:11], s37 offen sc1 lds
v_mfma_f32_16x16x32_bf16 v[208:211], v[116:119], v[80:83], v[208:211]
v_mfma_f32_16x16x32_bf16 v[212:215], v[116:119], v[84:87], v[212:215]
s_add_u32 m0, s39, 105472
s_add_u32 s37, s37, s38
buffer_load_dwordx4 v23, s[8:11], s37 offen sc1 lds
v_mfma_f32_16x16x32_bf16 v[216:219], v[116:119], v[88:91], v[216:219]
v_mfma_f32_16x16x32_bf16 v[220:223], v[116:119], v[92:95], v[220:223]
s_add_u32 m0, s39, 106496
s_add_u32 s37, s37, s38
buffer_load_dwordx4 v22, s[8:11], s37 offen sc1 lds
v_mfma_f32_16x16x32_bf16 v[160:163], v[104:107], v[80:83], v[160:163]
v_mfma_f32_16x16x32_bf16 v[164:167], v[104:107], v[84:87], v[164:167]
s_add_u32 m0, s39, 107520
s_add_u32 s37, s37, s38
buffer_load_dwordx4 v23, s[8:11], s37 offen sc1 lds
v_mfma_f32_16x16x32_bf16 v[168:171], v[104:107], v[88:91], v[168:171]
v_mfma_f32_16x16x32_bf16 v[172:175], v[104:107], v[92:95], v[172:175]
s_add_u32 m0, s39, 108544
s_add_u32 s37, s37, s38
buffer_load_dwordx4 v22, s[8:11], s37 offen sc1 lds
v_mfma_f32_16x16x32_bf16 v[224:227], v[120:123], v[80:83], v[224:227]
v_mfma_f32_16x16x32_bf16 v[228:231], v[120:123], v[84:87], v[228:231]
s_add_u32 m0, s39, 109568
s_add_u32 s37, s37, s38
buffer_load_dwordx4 v23, s[8:11], s37 offen sc1 lds
v_mfma_f32_16x16x32_bf16 v[232:235], v[120:123], v[88:91], v[232:235]
v_mfma_f32_16x16x32_bf16 v[236:239], v[120:123], v[92:95], v[236:239]
s_add_u32 m0, s39, 110592
s_add_u32 s37, s37, s38
buffer_load_dwordx4 v22, s[8:11], s37 offen sc1 lds
v_mfma_f32_16x16x32_bf16 v[176:179], v[108:111], v[80:83], v[176:179]
v_mfma_f32_16x16x32_bf16 v[180:183], v[108:111], v[84:87], v[180:183]
s_add_u32 m0, s39, 111616
s_add_u32 s37, s37, s38
buffer_load_dwordx4 v23, s[8:11], s37 offen sc1 lds
v_mfma_f32_16x16x32_bf16 v[184:187], v[108:111], v[88:91], v[184:187]
v_mfma_f32_16x16x32_bf16 v[188:191], v[108:111], v[92:95], v[188:191]
s_add_u32 m0, s39, 112640
s_add_u32 s37, s37, s38
buffer_load_dwordx4 v22, s[8:11], s37 offen sc1 lds
v_mfma_f32_16x16x32_bf16 v[240:243], v[124:127], v[80:83], v[240:243]
v_mfma_f32_16x16x32_bf16 v[244:247], v[124:127], v[84:87], v[244:247]
s_add_u32 m0, s39, 113664
s_add_u32 s37, s37, s38
buffer_load_dwordx4 v23, s[8:11], s37 offen sc1 lds
v_mfma_f32_16x16x32_bf16 v[248:251], v[124:127], v[88:91], v[248:251]
v_mfma_f32_16x16x32_bf16 v[252:255], v[124:127], v[92:95], v[252:255]
s_setprio 0
s_lshl_b32 s43, s46, 9
s_add_u32 s43, s43, 147456
v_lshl_add_u32 v19, v17, 3, s43
ds_read_b64 v[80:81], v19 offset:0
ds_read_b64 v[82:83], v19 offset:128
ds_read_b64 v[84:85], v19 offset:256
ds_read_b64 v[86:87], v19 offset:384
s_mul_i32 s43, s47, 256
s_add_u32 s43, s43, 148480
v_lshl_add_u32 v19, v18, 4, s43
ds_read_b128 v[48:51], v19 offset:0
ds_read_b128 v[52:55], v19 offset:64
ds_read_b128 v[56:59], v19 offset:128
ds_read_b128 v[60:63], v19 offset:192
ds_read_b128 v[64:67], v19 offset:896
ds_read_b128 v[68:71], v19 offset:960
ds_read_b128 v[72:75], v19 offset:1024
ds_read_b128 v[76:79], v19 offset:1088
s_waitcnt lgkmcnt(0)
v_mov_b32 v32, v80
v_mul_f32 v88, v81, v81
v_mul_f32 v36, 0xc0135761, v81
v_mul_f32 v89, 0xbdd2d3e8, v81
v_rcp_f32 v44, v88
v_mul_f32 v40, v89, v88
v_mov_b32 v33, v82
v_mul_f32 v88, v83, v83
v_mul_f32 v37, 0xc0135761, v83
v_mul_f32 v89, 0xbdd2d3e8, v83
v_rcp_f32 v45, v88
v_mul_f32 v41, v89, v88
v_mov_b32 v34, v84
v_mul_f32 v88, v85, v85
v_mul_f32 v38, 0xc0135761, v85
v_mul_f32 v89, 0xbdd2d3e8, v85
v_rcp_f32 v46, v88
v_mul_f32 v42, v89, v88
v_mov_b32 v35, v86
v_mul_f32 v88, v87, v87
v_mul_f32 v39, 0xc0135761, v87
v_mul_f32 v89, 0xbdd2d3e8, v87
v_rcp_f32 v47, v88
v_mul_f32 v43, v89, v88
s_barrier
s_add_u32 m0, s39, 0
s_add_u32 s37, s37, s38
buffer_load_dwordx4 v22, s[8:11], s37 offen sc1 lds
v_fma_f32 v128, -v32, v48, v128
v_fma_f32 v129, -v32, v49, v129
v_fma_f32 v130, -v32, v50, v130
s_add_u32 m0, s39, 1024
s_add_u32 s37, s37, s38
buffer_load_dwordx4 v23, s[8:11], s37 offen sc1 lds
v_fma_f32 v131, -v32, v51, v131
v_fma_f32 v192, -v32, v64, v192
v_fma_f32 v193, -v32, v65, v193
s_add_u32 m0, s39, 2048
s_add_u32 s37, s37, s38
buffer_load_dwordx4 v22, s[8:11], s37 offen sc1 lds
v_fma_f32 v194, -v32, v66, v194
v_fma_f32 v195, -v32, v67, v195
v_mul_f32 v80, v128, v128
s_add_u32 m0, s39, 3072
s_add_u32 s37, s37, s38
buffer_load_dwordx4 v23, s[8:11], s37 offen sc1 lds
v_mul_f32 v81, v129, v129
v_mul_f32 v82, v130, v130
v_mul_f32 v83, v131, v131
s_add_u32 m0, s39, 4096
s_add_u32 s37, s37, s38
buffer_load_dwordx4 v22, s[8:11], s37 offen sc1 lds
v_fma_f32 v80, v80, v40, v36
v_fma_f32 v81, v81, v40, v36
v_fma_f32 v82, v82, v40, v36
s_add_u32 m0, s39, 5120
s_add_u32 s37, s37, s38
buffer_load_dwordx4 v23, s[8:11], s37 offen sc1 lds
v_fma_f32 v83, v83, v40, v36
v_mul_f32 v80, v80, v128
v_mul_f32 v81, v81, v129
s_add_u32 m0, s39, 6144
s_add_u32 s37, s37, s38
buffer_load_dwordx4 v22, s[8:11], s37 offen sc1 lds
v_mul_f32 v82, v82, v130
v_mul_f32 v83, v83, v131
v_exp_f32 v80, v80
s_add_u32 m0, s39, 7168
s_add_u32 s37, s37, s38
buffer_load_dwordx4 v23, s[8:11], s37 offen sc1 lds
v_exp_f32 v81, v81
v_exp_f32 v82, v82
v_exp_f32 v83, v83
s_add_u32 m0, s39, 8192
s_add_u32 s37, s37, s38
buffer_load_dwordx4 v22, s[8:11], s37 offen sc1 lds
v_mul_f32 v192, v128, v192
v_mul_f32 v193, v129, v193
v_mul_f32 v194, v130, v194
s_add_u32 m0, s39, 9216
s_add_u32 s37, s37, s38
buffer_load_dwordx4 v23, s[8:11], s37 offen sc1 lds
v_mul_f32 v195, v131, v195
v_fma_f32 v80, v80, v44, v44
v_fma_f32 v81, v81, v44, v44
s_add_u32 m0, s39, 10240
s_add_u32 s37, s37, s38
buffer_load_dwordx4 v22, s[8:11], s37 offen sc1 lds
v_fma_f32 v82, v82, v44, v44
v_fma_f32 v83, v83, v44, v44
v_rcp_f32 v80, v80
s_add_u32 m0, s39, 11264
s_add_u32 s37, s37, s38
buffer_load_dwordx4 v23, s[8:11], s37 offen sc1 lds
v_rcp_f32 v81, v81
v_rcp_f32 v82, v82
v_rcp_f32 v83, v83
s_add_u32 m0, s39, 12288
s_add_u32 s37, s37, s38
buffer_load_dwordx4 v22, s[8:11], s37 offen sc1 lds
v_mul_f32 v192, v192, v80
v_mul_f32 v193, v193, v81
v_mul_f32 v194, v194, v82
s_add_u32 m0, s39, 13312
s_add_u32 s37, s37, s38
buffer_load_dwordx4 v23, s[8:11], s37 offen sc1 lds
v_mul_f32 v195, v195, v83
v_cvt_pk_bf16_f32 v96, v192, v193
v_cvt_pk_bf16_f32 v97, v194, v195
s_add_u32 m0, s39, 14336
s_add_u32 s37, s37, s38
buffer_load_dwordx4 v22, s[8:11], s37 offen sc1 lds
v_fma_f32 v144, -v32, v52, v144
v_fma_f32 v145, -v32, v53, v145
v_fma_f32 v146, -v32, v54, v146
s_add_u32 m0, s39, 15360
s_add_u32 s37, s37, s38
buffer_load_dwordx4 v23, s[8:11], s37 offen sc1 lds
v_fma_f32 v147, -v32, v55, v147
v_fma_f32 v208, -v32, v68, v208
v_fma_f32 v209, -v32, v69, v209
s_waitcnt vmcnt(16)
s_barrier
s_add_u32 m0, s39, 49152
s_add_u32 s37, s37, s38
buffer_load_dwordx4 v22, s[8:11], s37 offen sc1 lds
v_fma_f32 v210, -v32, v70, v210
v_fma_f32 v211, -v32, v71, v211
v_mul_f32 v84, v144, v144
v_mul_f32 v85, v145, v145
s_add_u32 m0, s39, 50176
s_add_u32 s37, s37, s38
buffer_load_dwordx4 v23, s[8:11], s37 offen sc1 lds
v_mul_f32 v86, v146, v146
v_mul_f32 v87, v147, v147
v_fma_f32 v84, v84, v40, v36
v_fma_f32 v85, v85, v40, v36
s_add_u32 m0, s39, 51200
s_add_u32 s37, s37, s38
buffer_load_dwordx4 v22, s[8:11], s37 offen sc1 lds
v_fma_f32 v86, v86, v40, v36
v_fma_f32 v87, v87, v40, v36
v_mul_f32 v84, v84, v144
v_mul_f32 v85, v85, v145
s_add_u32 m0, s39, 52224
s_add_u32 s37, s37, s38
buffer_load_dwordx4 v23, s[8:11], s37 offen sc1 lds
v_mul_f32 v86, v86, v146
v_mul_f32 v87, v87, v147
v_exp_f32 v84, v84
v_exp_f32 v85, v85
s_add_u32 m0, s39, 53248
s_add_u32 s37, s37, s38
buffer_load_dwordx4 v22, s[8:11], s37 offen sc1 lds
v_exp_f32 v86, v86
v_exp_f32 v87, v87
v_mul_f32 v208, v144, v208
v_mul_f32 v209, v145, v209
s_add_u32 m0, s39, 54272
s_add_u32 s37, s37, s38
buffer_load_dwordx4 v23, s[8:11], s37 offen sc1 lds
v_mul_f32 v210, v146, v210
v_mul_f32 v211, v147, v211
v_fma_f32 v84, v84, v44, v44
v_fma_f32 v85, v85, v44, v44
s_add_u32 m0, s39, 55296
s_add_u32 s37, s37, s38
buffer_load_dwordx4 v22, s[8:11], s37 offen sc1 lds
v_fma_f32 v86, v86, v44, v44
v_fma_f32 v87, v87, v44, v44
v_rcp_f32 v84, v84
v_rcp_f32 v85, v85
s_add_u32 m0, s39, 56320
s_add_u32 s37, s37, s38
buffer_load_dwordx4 v23, s[8:11], s37 offen sc1 lds
v_rcp_f32 v86, v86
v_rcp_f32 v87, v87
v_mul_f32 v208, v208, v84
v_mul_f32 v209, v209, v85
s_add_u32 m0, s39, 57344
s_add_u32 s37, s37, s38
buffer_load_dwordx4 v22, s[8:11], s37 offen sc1 lds
v_mul_f32 v210, v210, v86
v_mul_f32 v211, v211, v87
v_cvt_pk_bf16_f32 v98, v208, v209
v_cvt_pk_bf16_f32 v99, v210, v211
s_add_u32 m0, s39, 58368
s_add_u32 s37, s37, s38
buffer_load_dwordx4 v23, s[8:11], s37 offen sc1 lds
v_fma_f32 v132, -v33, v48, v132
v_fma_f32 v133, -v33, v49, v133
v_fma_f32 v134, -v33, v50, v134
s_add_u32 m0, s39, 59392
s_add_u32 s37, s37, s38
buffer_load_dwordx4 v22, s[8:11], s37 offen sc1 lds
v_fma_f32 v135, -v33, v51, v135
v_fma_f32 v196, -v33, v64, v196
v_fma_f32 v197, -v33, v65, v197
v_fma_f32 v198, -v33, v66, v198
s_add_u32 m0, s39, 60416
s_add_u32 s37, s37, s38
buffer_load_dwordx4 v23, s[8:11], s37 offen sc1 lds
v_fma_f32 v199, -v33, v67, v199
v_mul_f32 v80, v132, v132
v_mul_f32 v81, v133, v133
v_mul_f32 v82, v134, v134
s_add_u32 m0, s39, 61440
s_add_u32 s37, s37, s38
buffer_load_dwordx4 v22, s[8:11], s37 offen sc1 lds
v_mul_f32 v83, v135, v135
v_lshlrev_b32 v19, 11, v18
v_lshl_add_u32 v19, v17, 4, v19
s_lshl_b32 s43, s36, 9
s_add_u32 m0, s39, 62464
s_add_u32 s37, s37, s38
buffer_load_dwordx4 v23, s[8:11], s37 offen sc1 lds
v_add_u32 v2, s43, v19
v_add_u32 v3, 49152, v2
v_add_u32 v4, 98304, v2
v_lshrrev_b32 v19, 2, v17
s_add_u32 m0, s39, 63488
s_add_u32 s37, s37, s38
buffer_load_dwordx4 v22, s[8:11], s37 offen sc1 lds
v_lshl_add_u32 v20, v18, 2, v19
v_bfe_u32 v21, v20, 1, 2
v_lshlrev_b32 v20, 7, v20
v_lshl_add_u32 v20, v21, 5, v20
s_add_u32 m0, s39, 64512
s_add_u32 s37, s37, s38
buffer_load_dwordx4 v23, s[8:11], s37 offen sc1 lds
v_and_b32 v19, 3, v1
v_lshl_add_u32 v20, v19, 3, v20
v_add_u32 v5, 16384, v20
buffer_store_dwordx4 v[96:99], v27, s[24:27], 0 offen offset:0 sc1
s_waitcnt vmcnt(17)
s_barrier
s_add_u32 m0, s39, 98304
s_add_u32 s37, s37, s38
buffer_load_dwordx4 v22, s[8:11], s37 offen sc1 lds
v_fma_f32 v80, v80, v41, v37
v_fma_f32 v81, v81, v41, v37
v_fma_f32 v82, v82, v41, v37
v_fma_f32 v83, v83, v41, v37
s_add_u32 m0, s39, 99328
s_add_u32 s37, s37, s38
buffer_load_dwordx4 v23, s[8:11], s37 offen sc1 lds
v_mul_f32 v80, v80, v132
v_mul_f32 v81, v81, v133
v_mul_f32 v82, v82, v134
v_mul_f32 v83, v83, v135
s_add_u32 m0, s39, 100352
s_add_u32 s37, s37, s38
buffer_load_dwordx4 v22, s[8:11], s37 offen sc1 lds
v_exp_f32 v80, v80
v_exp_f32 v81, v81
v_exp_f32 v82, v82
v_exp_f32 v83, v83
s_add_u32 m0, s39, 101376
s_add_u32 s37, s37, s38
buffer_load_dwordx4 v23, s[8:11], s37 offen sc1 lds
v_mul_f32 v196, v132, v196
v_mul_f32 v197, v133, v197
v_mul_f32 v198, v134, v198
s_add_u32 m0, s39, 102400
s_add_u32 s37, s37, s38
buffer_load_dwordx4 v22, s[8:11], s37 offen sc1 lds
v_mul_f32 v199, v135, v199
v_fma_f32 v80, v80, v45, v45
v_fma_f32 v81, v81, v45, v45
v_fma_f32 v82, v82, v45, v45
s_add_u32 m0, s39, 103424
s_add_u32 s37, s37, s38
buffer_load_dwordx4 v23, s[8:11], s37 offen sc1 lds
v_fma_f32 v83, v83, v45, v45
v_rcp_f32 v80, v80
v_rcp_f32 v81, v81
v_rcp_f32 v82, v82
s_add_u32 m0, s39, 104448
s_add_u32 s37, s37, s38
buffer_load_dwordx4 v22, s[8:11], s37 offen sc1 lds
v_rcp_f32 v83, v83
v_mul_f32 v196, v196, v80
v_mul_f32 v197, v197, v81
s_add_u32 m0, s39, 105472
s_add_u32 s37, s37, s38
buffer_load_dwordx4 v23, s[8:11], s37 offen sc1 lds
v_mul_f32 v198, v198, v82
v_mul_f32 v199, v199, v83
v_cvt_pk_bf16_f32 v100, v196, v197
v_cvt_pk_bf16_f32 v101, v198, v199
s_add_u32 m0, s39, 106496
s_add_u32 s37, s37, s38
buffer_load_dwordx4 v22, s[8:11], s37 offen sc1 lds
v_fma_f32 v148, -v33, v52, v148
v_fma_f32 v149, -v33, v53, v149
v_fma_f32 v150, -v33, v54, v150
v_fma_f32 v151, -v33, v55, v151
s_add_u32 m0, s39, 107520
s_add_u32 s37, s37, s38
buffer_load_dwordx4 v23, s[8:11], s37 offen sc1 lds
v_fma_f32 v212, -v33, v68, v212
v_fma_f32 v213, -v33, v69, v213
v_fma_f32 v214, -v33, v70, v214
s_add_u32 m0, s39, 108544
s_add_u32 s37, s37, s38
buffer_load_dwordx4 v22, s[8:11], s37 offen sc1 lds
v_fma_f32 v215, -v33, v71, v215
v_mul_f32 v84, v148, v148
v_mul_f32 v85, v149, v149
v_mul_f32 v86, v150, v150
s_add_u32 m0, s39, 109568
s_add_u32 s37, s37, s38
buffer_load_dwordx4 v23, s[8:11], s37 offen sc1 lds
v_mul_f32 v87, v151, v151
v_fma_f32 v84, v84, v41, v37
v_fma_f32 v85, v85, v41, v37
v_fma_f32 v86, v86, v41, v37
s_add_u32 m0, s39, 110592
s_add_u32 s37, s37, s38
buffer_load_dwordx4 v22, s[8:11], s37 offen sc1 lds
v_fma_f32 v87, v87, v41, v37
v_mul_f32 v84, v84, v148
v_mul_f32 v85, v85, v149
s_add_u32 m0, s39, 111616
s_add_u32 s37, s37, s38
buffer_load_dwordx4 v23, s[8:11], s37 offen sc1 lds
v_xor_b32 v6, 32, v5
v_xor_b32 v7, 64, v5
v_xor_b32 v8, 96, v5
v_add_u32 v9, 49152, v5
s_add_u32 m0, s39, 112640
s_add_u32 s37, s37, s38
buffer_load_dwordx4 v22, s[8:11], s37 offen sc1 lds
v_add_u32 v10, 49152, v6
v_add_u32 v11, 49152, v7
v_add_u32 v12, 49152, v8
v_add_u32 v13, 98304, v5
s_add_u32 m0, s39, 113664
s_add_u32 s37, s37, s38
buffer_load_dwordx4 v23, s[8:11], s37 offen sc1 lds
v_add_u32 v14, 98304, v6
v_add_u32 v15, 98304, v7
v_add_u32 v16, 98304, v8
s_waitcnt vmcnt(17)
s_barrier
s_add_u32 m0, s39, 0
s_add_u32 s37, s37, s38
buffer_load_dwordx4 v22, s[8:11], s37 offen sc1 lds
v_mul_f32 v86, v86, v150
v_mul_f32 v87, v87, v151
v_exp_f32 v84, v84
v_exp_f32 v85, v85
s_add_u32 m0, s39, 1024
s_add_u32 s37, s37, s38
buffer_load_dwordx4 v23, s[8:11], s37 offen sc1 lds
v_exp_f32 v86, v86
v_exp_f32 v87, v87
v_mul_f32 v212, v148, v212
s_add_u32 m0, s39, 2048
s_add_u32 s37, s37, s38
buffer_load_dwordx4 v22, s[8:11], s37 offen sc1 lds
v_mul_f32 v213, v149, v213
v_mul_f32 v214, v150, v214
v_mul_f32 v215, v151, v215
s_add_u32 m0, s39, 3072
s_add_u32 s37, s37, s38
buffer_load_dwordx4 v23, s[8:11], s37 offen sc1 lds
v_fma_f32 v84, v84, v45, v45
v_fma_f32 v85, v85, v45, v45
v_fma_f32 v86, v86, v45, v45
s_add_u32 m0, s39, 4096
s_add_u32 s37, s37, s38
buffer_load_dwordx4 v22, s[8:11], s37 offen sc1 lds
v_fma_f32 v87, v87, v45, v45
v_rcp_f32 v84, v84
v_rcp_f32 v85, v85
s_add_u32 m0, s39, 5120
s_add_u32 s37, s37, s38
buffer_load_dwordx4 v23, s[8:11], s37 offen sc1 lds
v_rcp_f32 v86, v86
v_rcp_f32 v87, v87
v_mul_f32 v212, v212, v84
s_add_u32 m0, s39, 6144
s_add_u32 s37, s37, s38
buffer_load_dwordx4 v22, s[8:11], s37 offen sc1 lds
v_mul_f32 v213, v213, v85
v_mul_f32 v214, v214, v86
v_mul_f32 v215, v215, v87
s_add_u32 m0, s39, 7168
s_add_u32 s37, s37, s38
buffer_load_dwordx4 v23, s[8:11], s37 offen sc1 lds
v_cvt_pk_bf16_f32 v102, v212, v213
v_cvt_pk_bf16_f32 v103, v214, v215
s_add_u32 m0, s39, 8192
s_add_u32 s37, s37, s38
buffer_load_dwordx4 v22, s[8:11], s37 offen sc1 lds
v_fma_f32 v136, -v34, v48, v136
v_fma_f32 v137, -v34, v49, v137
v_fma_f32 v138, -v34, v50, v138
s_add_u32 m0, s39, 9216
s_add_u32 s37, s37, s38
buffer_load_dwordx4 v23, s[8:11], s37 offen sc1 lds
v_fma_f32 v139, -v34, v51, v139
v_fma_f32 v200, -v34, v64, v200
v_fma_f32 v201, -v34, v65, v201
s_add_u32 m0, s39, 10240
s_add_u32 s37, s37, s38
buffer_load_dwordx4 v22, s[8:11], s37 offen sc1 lds
v_fma_f32 v202, -v34, v66, v202
v_fma_f32 v203, -v34, v67, v203
v_mul_f32 v80, v136, v136
s_add_u32 m0, s39, 11264
s_add_u32 s37, s37, s38
buffer_load_dwordx4 v23, s[8:11], s37 offen sc1 lds
v_mul_f32 v81, v137, v137
v_mul_f32 v82, v138, v138
v_mul_f32 v83, v139, v139
s_add_u32 m0, s39, 12288
s_add_u32 s37, s37, s38
buffer_load_dwordx4 v22, s[8:11], s37 offen sc1 lds
v_fma_f32 v80, v80, v42, v38
v_fma_f32 v81, v81, v42, v38
v_fma_f32 v82, v82, v42, v38
s_add_u32 m0, s39, 13312
s_add_u32 s37, s37, s38
buffer_load_dwordx4 v23, s[8:11], s37 offen sc1 lds
v_fma_f32 v83, v83, v42, v38
v_mul_f32 v80, v80, v136
v_mul_f32 v81, v81, v137
s_add_u32 m0, s39, 14336
s_add_u32 s37, s37, s38
buffer_load_dwordx4 v22, s[8:11], s37 offen sc1 lds
v_mul_f32 v82, v82, v138
v_mul_f32 v83, v83, v139
v_exp_f32 v80, v80
s_add_u32 m0, s39, 15360
s_add_u32 s37, s37, s38
buffer_load_dwordx4 v23, s[8:11], s37 offen sc1 lds
v_exp_f32 v81, v81
v_exp_f32 v82, v82
v_exp_f32 v83, v83
buffer_store_dwordx4 v[100:103], v27, s[24:27], 0 offen offset:256 sc1
s_waitcnt vmcnt(17)
s_barrier
s_add_u32 m0, s39, 49152
s_add_u32 s37, s37, s38
buffer_load_dwordx4 v22, s[8:11], s37 offen sc1 lds
v_mul_f32 v200, v136, v200
v_mul_f32 v201, v137, v201
v_mul_f32 v202, v138, v202
s_add_u32 m0, s39, 50176
s_add_u32 s37, s37, s38
buffer_load_dwordx4 v23, s[8:11], s37 offen sc1 lds
v_mul_f32 v203, v139, v203
v_fma_f32 v80, v80, v46, v46
v_fma_f32 v81, v81, v46, v46
s_add_u32 m0, s39, 51200
s_add_u32 s37, s37, s38
buffer_load_dwordx4 v22, s[8:11], s37 offen sc1 lds
v_fma_f32 v82, v82, v46, v46
v_fma_f32 v83, v83, v46, v46
v_rcp_f32 v80, v80
s_add_u32 m0, s39, 52224
s_add_u32 s37, s37, s38
buffer_load_dwordx4 v23, s[8:11], s37 offen sc1 lds
v_rcp_f32 v81, v81
v_rcp_f32 v82, v82
v_rcp_f32 v83, v83
s_add_u32 m0, s39, 53248
s_add_u32 s37, s37, s38
buffer_load_dwordx4 v22, s[8:11], s37 offen sc1 lds
v_mul_f32 v200, v200, v80
v_mul_f32 v201, v201, v81
v_mul_f32 v202, v202, v82
s_add_u32 m0, s39, 54272
s_add_u32 s37, s37, s38
buffer_load_dwordx4 v23, s[8:11], s37 offen sc1 lds
v_mul_f32 v203, v203, v83
v_cvt_pk_bf16_f32 v104, v200, v201
v_cvt_pk_bf16_f32 v105, v202, v203
s_add_u32 m0, s39, 55296
s_add_u32 s37, s37, s38
buffer_load_dwordx4 v22, s[8:11], s37 offen sc1 lds
v_fma_f32 v152, -v34, v52, v152
v_fma_f32 v153, -v34, v53, v153
v_fma_f32 v154, -v34, v54, v154
s_add_u32 m0, s39, 56320
s_add_u32 s37, s37, s38
buffer_load_dwordx4 v23, s[8:11], s37 offen sc1 lds
v_fma_f32 v155, -v34, v55, v155
v_fma_f32 v216, -v34, v68, v216
v_fma_f32 v217, -v34, v69, v217
s_add_u32 m0, s39, 57344
s_add_u32 s37, s37, s38
buffer_load_dwordx4 v22, s[8:11], s37 offen sc1 lds
v_fma_f32 v218, -v34, v70, v218
v_fma_f32 v219, -v34, v71, v219
v_mul_f32 v84, v152, v152
s_add_u32 m0, s39, 58368
s_add_u32 s37, s37, s38
buffer_load_dwordx4 v23, s[8:11], s37 offen sc1 lds
v_mul_f32 v85, v153, v153
v_mul_f32 v86, v154, v154
v_mul_f32 v87, v155, v155
s_add_u32 m0, s39, 59392
s_add_u32 s37, s37, s38
buffer_load_dwordx4 v22, s[8:11], s37 offen sc1 lds
v_fma_f32 v84, v84, v42, v38
v_fma_f32 v85, v85, v42, v38
v_fma_f32 v86, v86, v42, v38
s_add_u32 m0, s39, 60416
s_add_u32 s37, s37, s38
buffer_load_dwordx4 v23, s[8:11], s37 offen sc1 lds
v_fma_f32 v87, v87, v42, v38
v_mul_f32 v84, v84, v152
v_mul_f32 v85, v85, v153
s_add_u32 m0, s39, 61440
s_add_u32 s37, s37, s38
buffer_load_dwordx4 v22, s[8:11], s37 offen sc1 lds
v_mul_f32 v86, v86, v154
v_mul_f32 v87, v87, v155
v_exp_f32 v84, v84
s_add_u32 m0, s39, 62464
s_add_u32 s37, s37, s38
buffer_load_dwordx4 v23, s[8:11], s37 offen sc1 lds
v_exp_f32 v85, v85
v_exp_f32 v86, v86
v_exp_f32 v87, v87
s_add_u32 m0, s39, 63488
s_add_u32 s37, s37, s38
buffer_load_dwordx4 v22, s[8:11], s37 offen sc1 lds
v_mul_f32 v216, v152, v216
v_mul_f32 v217, v153, v217
v_mul_f32 v218, v154, v218
s_add_u32 m0, s39, 64512
s_add_u32 s37, s37, s38
buffer_load_dwordx4 v23, s[8:11], s37 offen sc1 lds
v_mul_f32 v219, v155, v219
v_fma_f32 v84, v84, v46, v46
v_fma_f32 v85, v85, v46, v46
s_waitcnt vmcnt(17)
s_barrier
s_add_u32 m0, s39, 98304
s_add_u32 s37, s37, s38
buffer_load_dwordx4 v22, s[8:11], s37 offen sc1 lds
v_fma_f32 v86, v86, v46, v46
v_fma_f32 v87, v87, v46, v46
v_rcp_f32 v84, v84
v_rcp_f32 v85, v85
s_add_u32 m0, s39, 99328
s_add_u32 s37, s37, s38
buffer_load_dwordx4 v23, s[8:11], s37 offen sc1 lds
v_rcp_f32 v86, v86
v_rcp_f32 v87, v87
v_mul_f32 v216, v216, v84
s_add_u32 m0, s39, 100352
s_add_u32 s37, s37, s38
buffer_load_dwordx4 v22, s[8:11], s37 offen sc1 lds
v_mul_f32 v217, v217, v85
v_mul_f32 v218, v218, v86
v_mul_f32 v219, v219, v87
s_add_u32 m0, s39, 101376
s_add_u32 s37, s37, s38
buffer_load_dwordx4 v23, s[8:11], s37 offen sc1 lds
v_cvt_pk_bf16_f32 v106, v216, v217
v_cvt_pk_bf16_f32 v107, v218, v219
s_add_u32 m0, s39, 102400
s_add_u32 s37, s37, s38
buffer_load_dwordx4 v22, s[8:11], s37 offen sc1 lds
v_fma_f32 v140, -v35, v48, v140
v_fma_f32 v141, -v35, v49, v141
v_fma_f32 v142, -v35, v50, v142
s_add_u32 m0, s39, 103424
s_add_u32 s37, s37, s38
buffer_load_dwordx4 v23, s[8:11], s37 offen sc1 lds
v_fma_f32 v143, -v35, v51, v143
v_fma_f32 v204, -v35, v64, v204
v_fma_f32 v205, -v35, v65, v205
s_add_u32 m0, s39, 104448
s_add_u32 s37, s37, s38
buffer_load_dwordx4 v22, s[8:11], s37 offen sc1 lds
v_fma_f32 v206, -v35, v66, v206
v_fma_f32 v207, -v35, v67, v207
v_mul_f32 v80, v140, v140
s_add_u32 m0, s39, 105472
s_add_u32 s37, s37, s38
buffer_load_dwordx4 v23, s[8:11], s37 offen sc1 lds
v_mul_f32 v81, v141, v141
v_mul_f32 v82, v142, v142
v_mul_f32 v83, v143, v143
s_add_u32 m0, s39, 106496
s_add_u32 s37, s37, s38
buffer_load_dwordx4 v22, s[8:11], s37 offen sc1 lds
v_fma_f32 v80, v80, v43, v39
v_fma_f32 v81, v81, v43, v39
v_fma_f32 v82, v82, v43, v39
s_add_u32 m0, s39, 107520
s_add_u32 s37, s37, s38
buffer_load_dwordx4 v23, s[8:11], s37 offen sc1 lds
v_fma_f32 v83, v83, v43, v39
v_mul_f32 v80, v80, v140
v_mul_f32 v81, v81, v141
s_add_u32 m0, s39, 108544
s_add_u32 s37, s37, s38
buffer_load_dwordx4 v22, s[8:11], s37 offen sc1 lds
v_mul_f32 v82, v82, v142
v_mul_f32 v83, v83, v143
v_exp_f32 v80, v80
s_add_u32 m0, s39, 109568
s_add_u32 s37, s37, s38
buffer_load_dwordx4 v23, s[8:11], s37 offen sc1 lds
v_exp_f32 v81, v81
v_exp_f32 v82, v82
v_exp_f32 v83, v83
s_add_u32 m0, s39, 110592
s_add_u32 s37, s37, s38
buffer_load_dwordx4 v22, s[8:11], s37 offen sc1 lds
v_mul_f32 v204, v140, v204
v_mul_f32 v205, v141, v205
v_mul_f32 v206, v142, v206
s_add_u32 m0, s39, 111616
s_add_u32 s37, s37, s38
buffer_load_dwordx4 v23, s[8:11], s37 offen sc1 lds
v_mul_f32 v207, v143, v207
v_fma_f32 v80, v80, v47, v47
v_fma_f32 v81, v81, v47, v47
s_add_u32 m0, s39, 112640
s_add_u32 s37, s37, s38
buffer_load_dwordx4 v22, s[8:11], s37 offen sc1 lds
v_fma_f32 v82, v82, v47, v47
v_fma_f32 v83, v83, v47, v47
v_rcp_f32 v80, v80
s_add_u32 m0, s39, 113664
s_add_u32 s37, s37, s38
buffer_load_dwordx4 v23, s[8:11], s37 offen sc1 lds
v_rcp_f32 v81, v81
v_rcp_f32 v82, v82
v_rcp_f32 v83, v83
buffer_store_dwordx4 v[104:107], v27, s[24:27], 0 offen offset:512 sc1
s_waitcnt vmcnt(17)
s_barrier
s_add_u32 m0, s39, 0
s_add_u32 s37, s37, s38
buffer_load_dwordx4 v22, s[8:11], s37 offen sc1 lds
v_mul_f32 v204, v204, v80
v_mul_f32 v205, v205, v81
v_mul_f32 v206, v206, v82
v_mul_f32 v207, v207, v83
s_add_u32 m0, s39, 1024
s_add_u32 s37, s37, s38
buffer_load_dwordx4 v23, s[8:11], s37 offen sc1 lds
v_cvt_pk_bf16_f32 v108, v204, v205
v_cvt_pk_bf16_f32 v109, v206, v207
v_fma_f32 v156, -v35, v52, v156
s_add_u32 m0, s39, 2048
s_add_u32 s37, s37, s38
buffer_load_dwordx4 v22, s[8:11], s37 offen sc1 lds
v_fma_f32 v157, -v35, v53, v157
v_fma_f32 v158, -v35, v54, v158
v_fma_f32 v159, -v35, v55, v159
s_add_u32 m0, s39, 3072
s_add_u32 s37, s37, s38
buffer_load_dwordx4 v23, s[8:11], s37 offen sc1 lds
v_fma_f32 v220, -v35, v68, v220
v_fma_f32 v221, -v35, v69, v221
v_fma_f32 v222, -v35, v70, v222
s_add_u32 m0, s39, 4096
s_add_u32 s37, s37, s38
buffer_load_dwordx4 v22, s[8:11], s37 offen sc1 lds
v_fma_f32 v223, -v35, v71, v223
v_mul_f32 v84, v156, v156
v_mul_f32 v85, v157, v157
s_add_u32 m0, s39, 5120
s_add_u32 s37, s37, s38
buffer_load_dwordx4 v23, s[8:11], s37 offen sc1 lds
v_mul_f32 v86, v158, v158
v_mul_f32 v87, v159, v159
v_fma_f32 v84, v84, v43, v39
s_add_u32 m0, s39, 6144
s_add_u32 s37, s37, s38
buffer_load_dwordx4 v22, s[8:11], s37 offen sc1 lds
v_fma_f32 v85, v85, v43, v39
v_fma_f32 v86, v86, v43, v39
v_fma_f32 v87, v87, v43, v39
s_add_u32 m0, s39, 7168
s_add_u32 s37, s37, s38
buffer_load_dwordx4 v23, s[8:11], s37 offen sc1 lds
v_mul_f32 v84, v84, v156
v_mul_f32 v85, v85, v157
v_mul_f32 v86, v86, v158
s_add_u32 m0, s39, 8192
s_add_u32 s37, s37, s38
buffer_load_dwordx4 v22, s[8:11], s37 offen sc1 lds
v_mul_f32 v87, v87, v159
v_exp_f32 v84, v84
v_exp_f32 v85, v85
s_add_u32 m0, s39, 9216
s_add_u32 s37, s37, s38
buffer_load_dwordx4 v23, s[8:11], s37 offen sc1 lds
v_exp_f32 v86, v86
v_exp_f32 v87, v87
v_mul_f32 v220, v156, v220
s_add_u32 m0, s39, 10240
s_add_u32 s37, s37, s38
buffer_load_dwordx4 v22, s[8:11], s37 offen sc1 lds
v_mul_f32 v221, v157, v221
v_mul_f32 v222, v158, v222
v_mul_f32 v223, v159, v223
s_add_u32 m0, s39, 11264
s_add_u32 s37, s37, s38
buffer_load_dwordx4 v23, s[8:11], s37 offen sc1 lds
v_fma_f32 v84, v84, v47, v47
v_fma_f32 v85, v85, v47, v47
v_fma_f32 v86, v86, v47, v47
s_add_u32 m0, s39, 12288
s_add_u32 s37, s37, s38
buffer_load_dwordx4 v22, s[8:11], s37 offen sc1 lds
v_fma_f32 v87, v87, v47, v47
v_rcp_f32 v84, v84
v_rcp_f32 v85, v85
s_add_u32 m0, s39, 13312
s_add_u32 s37, s37, s38
buffer_load_dwordx4 v23, s[8:11], s37 offen sc1 lds
v_rcp_f32 v86, v86
v_rcp_f32 v87, v87
v_mul_f32 v220, v220, v84
s_add_u32 m0, s39, 14336
s_add_u32 s37, s37, s38
buffer_load_dwordx4 v22, s[8:11], s37 offen sc1 lds
v_mul_f32 v221, v221, v85
v_mul_f32 v222, v222, v86
v_mul_f32 v223, v223, v87
s_add_u32 m0, s39, 15360
s_add_u32 s37, s37, s38
buffer_load_dwordx4 v23, s[8:11], s37 offen sc1 lds
v_cvt_pk_bf16_f32 v110, v220, v221
v_cvt_pk_bf16_f32 v111, v222, v223
buffer_store_dwordx4 v[108:111], v27, s[24:27], 0 offen offset:768 sc1
s_waitcnt vmcnt(18)
s_barrier
s_add_u32 m0, s39, 49152
s_add_u32 s37, s37, s38
buffer_load_dwordx4 v22, s[8:11], s37 offen sc1 lds
v_fma_f32 v160, -v32, v56, v160
v_fma_f32 v161, -v32, v57, v161
v_fma_f32 v162, -v32, v58, v162
v_fma_f32 v163, -v32, v59, v163
s_add_u32 m0, s39, 50176
s_add_u32 s37, s37, s38
buffer_load_dwordx4 v23, s[8:11], s37 offen sc1 lds
v_fma_f32 v224, -v32, v72, v224
v_fma_f32 v225, -v32, v73, v225
v_fma_f32 v226, -v32, v74, v226
s_add_u32 m0, s39, 51200
s_add_u32 s37, s37, s38
buffer_load_dwordx4 v22, s[8:11], s37 offen sc1 lds
v_fma_f32 v227, -v32, v75, v227
v_mul_f32 v80, v160, v160
v_mul_f32 v81, v161, v161
v_mul_f32 v82, v162, v162
s_add_u32 m0, s39, 52224
s_add_u32 s37, s37, s38
buffer_load_dwordx4 v23, s[8:11], s37 offen sc1 lds
v_mul_f32 v83, v163, v163
v_fma_f32 v80, v80, v40, v36
v_fma_f32 v81, v81, v40, v36
s_add_u32 m0, s39, 53248
s_add_u32 s37, s37, s38
buffer_load_dwordx4 v22, s[8:11], s37 offen sc1 lds
v_fma_f32 v82, v82, v40, v36
v_fma_f32 v83, v83, v40, v36
v_mul_f32 v80, v80, v160
v_mul_f32 v81, v81, v161
s_add_u32 m0, s39, 54272
s_add_u32 s37, s37, s38
buffer_load_dwordx4 v23, s[8:11], s37 offen sc1 lds
v_mul_f32 v82, v82, v162
v_mul_f32 v83, v83, v163
v_exp_f32 v80, v80
s_add_u32 m0, s39, 55296
s_add_u32 s37, s37, s38
buffer_load_dwordx4 v22, s[8:11], s37 offen sc1 lds
v_exp_f32 v81, v81
v_exp_f32 v82, v82
v_exp_f32 v83, v83
v_mul_f32 v224, v160, v224
s_add_u32 m0, s39, 56320
s_add_u32 s37, s37, s38
buffer_load_dwordx4 v23, s[8:11], s37 offen sc1 lds
v_mul_f32 v225, v161, v225
v_mul_f32 v226, v162, v226
v_mul_f32 v227, v163, v227
s_add_u32 m0, s39, 57344
s_add_u32 s37, s37, s38
buffer_load_dwordx4 v22, s[8:11], s37 offen sc1 lds
v_fma_f32 v80, v80, v44, v44
v_fma_f32 v81, v81, v44, v44
v_fma_f32 v82, v82, v44, v44
v_fma_f32 v83, v83, v44, v44
s_add_u32 m0, s39, 58368
s_add_u32 s37, s37, s38
buffer_load_dwordx4 v23, s[8:11], s37 offen sc1 lds
v_rcp_f32 v80, v80
v_rcp_f32 v81, v81
v_rcp_f32 v82, v82
s_add_u32 m0, s39, 59392
s_add_u32 s37, s37, s38
buffer_load_dwordx4 v22, s[8:11], s37 offen sc1 lds
v_rcp_f32 v83, v83
v_mul_f32 v224, v224, v80
v_mul_f32 v225, v225, v81
v_mul_f32 v226, v226, v82
s_add_u32 m0, s39, 60416
s_add_u32 s37, s37, s38
buffer_load_dwordx4 v23, s[8:11], s37 offen sc1 lds
v_mul_f32 v227, v227, v83
v_cvt_pk_bf16_f32 v96, v224, v225
v_cvt_pk_bf16_f32 v97, v226, v227
s_add_u32 m0, s39, 61440
s_add_u32 s37, s37, s38
buffer_load_dwordx4 v22, s[8:11], s37 offen sc1 lds
v_fma_f32 v176, -v32, v60, v176
v_fma_f32 v177, -v32, v61, v177
v_fma_f32 v178, -v32, v62, v178
v_fma_f32 v179, -v32, v63, v179
s_add_u32 m0, s39, 62464
s_add_u32 s37, s37, s38
buffer_load_dwordx4 v23, s[8:11], s37 offen sc1 lds
v_fma_f32 v240, -v32, v76, v240
v_fma_f32 v241, -v32, v77, v241
v_lshlrev_b32 v19, 11, v18
s_add_u32 m0, s39, 63488
s_add_u32 s37, s37, s38
buffer_load_dwordx4 v22, s[8:11], s37 offen sc1 lds
v_lshl_add_u32 v19, v17, 4, v19
s_lshl_b32 s43, s36, 9
v_add_u32 v208, s43, v19
buffer_load_dwordx4 v[192:195], v208, s[20:23], 0 offen offset:0 sc1
s_add_u32 m0, s39, 64512
s_add_u32 s37, s37, s38
buffer_load_dwordx4 v23, s[8:11], s37 offen sc1 lds
buffer_load_dwordx4 v[196:199], v208, s[20:23], s50 offen offset:0 sc1
buffer_load_dwordx4 v[200:203], v208, s[20:23], 0 offen offset:256 sc1
buffer_load_dwordx4 v[204:207], v208, s[20:23], s50 offen offset:256 sc1
s_waitcnt vmcnt(20)
s_barrier
s_add_u32 m0, s39, 98304
s_add_u32 s37, s37, s38
buffer_load_dwordx4 v22, s[8:11], s37 offen sc1 lds
v_fma_f32 v242, -v32, v78, v242
v_fma_f32 v243, -v32, v79, v243
v_mul_f32 v84, v176, v176
v_mul_f32 v85, v177, v177
s_add_u32 m0, s39, 99328
s_add_u32 s37, s37, s38
buffer_load_dwordx4 v23, s[8:11], s37 offen sc1 lds
v_mul_f32 v86, v178, v178
v_mul_f32 v87, v179, v179
v_fma_f32 v84, v84, v40, v36
s_add_u32 m0, s39, 100352
s_add_u32 s37, s37, s38
buffer_load_dwordx4 v22, s[8:11], s37 offen sc1 lds
v_fma_f32 v85, v85, v40, v36
v_fma_f32 v86, v86, v40, v36
v_fma_f32 v87, v87, v40, v36
s_add_u32 m0, s39, 101376
s_add_u32 s37, s37, s38
buffer_load_dwordx4 v23, s[8:11], s37 offen sc1 lds
v_mul_f32 v84, v84, v176
v_mul_f32 v85, v85, v177
v_mul_f32 v86, v86, v178
s_add_u32 m0, s39, 102400
s_add_u32 s37, s37, s38
buffer_load_dwordx4 v22, s[8:11], s37 offen sc1 lds
v_mul_f32 v87, v87, v179
v_exp_f32 v84, v84
v_exp_f32 v85, v85
s_add_u32 m0, s39, 103424
s_add_u32 s37, s37, s38
buffer_load_dwordx4 v23, s[8:11], s37 offen sc1 lds
v_exp_f32 v86, v86
v_exp_f32 v87, v87
v_mul_f32 v240, v176, v240
s_add_u32 m0, s39, 104448
s_add_u32 s37, s37, s38
buffer_load_dwordx4 v22, s[8:11], s37 offen sc1 lds
v_mul_f32 v241, v177, v241
v_mul_f32 v242, v178, v242
v_mul_f32 v243, v179, v243
s_add_u32 m0, s39, 105472
s_add_u32 s37, s37, s38
buffer_load_dwordx4 v23, s[8:11], s37 offen sc1 lds
v_fma_f32 v84, v84, v44, v44
v_fma_f32 v85, v85, v44, v44
v_fma_f32 v86, v86, v44, v44
s_add_u32 m0, s39, 106496
s_add_u32 s37, s37, s38
buffer_load_dwordx4 v22, s[8:11], s37 offen sc1 lds
v_fma_f32 v87, v87, v44, v44
v_rcp_f32 v84, v84
v_rcp_f32 v85, v85
s_add_u32 m0, s39, 107520
s_add_u32 s37, s37, s38
buffer_load_dwordx4 v23, s[8:11], s37 offen sc1 lds
v_rcp_f32 v86, v86
v_rcp_f32 v87, v87
v_mul_f32 v240, v240, v84
s_add_u32 m0, s39, 108544
s_add_u32 s37, s37, s38
buffer_load_dwordx4 v22, s[8:11], s37 offen sc1 lds
v_mul_f32 v241, v241, v85
v_mul_f32 v242, v242, v86
v_mul_f32 v243, v243, v87
s_add_u32 m0, s39, 109568
s_add_u32 s37, s37, s38
buffer_load_dwordx4 v23, s[8:11], s37 offen sc1 lds
v_cvt_pk_bf16_f32 v98, v240, v241
v_cvt_pk_bf16_f32 v99, v242, v243
s_add_u32 m0, s39, 110592
s_add_u32 s37, s37, s38
buffer_load_dwordx4 v22, s[8:11], s37 offen sc1 lds
v_fma_f32 v164, -v33, v56, v164
v_fma_f32 v165, -v33, v57, v165
v_fma_f32 v166, -v33, v58, v166
s_add_u32 m0, s39, 111616
s_add_u32 s37, s37, s38
buffer_load_dwordx4 v23, s[8:11], s37 offen sc1 lds
v_fma_f32 v167, -v33, v59, v167
v_fma_f32 v228, -v33, v72, v228
v_fma_f32 v229, -v33, v73, v229
s_add_u32 m0, s39, 112640
s_add_u32 s37, s37, s38
buffer_load_dwordx4 v22, s[8:11], s37 offen sc1 lds
v_fma_f32 v230, -v33, v74, v230
v_fma_f32 v231, -v33, v75, v231
v_mul_f32 v80, v164, v164
s_add_u32 m0, s39, 113664
s_add_u32 s37, s37, s38
buffer_load_dwordx4 v23, s[8:11], s37 offen sc1 lds
v_mul_f32 v81, v165, v165
v_mul_f32 v82, v166, v166
v_mul_f32 v83, v167, v167
buffer_store_dwordx4 v[96:99], v27, s[24:27], s53 offen offset:0 sc1
s_waitcnt vmcnt(20)
s_barrier
s_add_u32 m0, s39, 0
s_add_u32 s37, s37, s38
buffer_load_dwordx4 v22, s[8:11], s37 offen sc1 lds
v_fma_f32 v80, v80, v41, v37
v_fma_f32 v81, v81, v41, v37
v_fma_f32 v82, v82, v41, v37
s_add_u32 m0, s39, 1024
s_add_u32 s37, s37, s38
buffer_load_dwordx4 v23, s[8:11], s37 offen sc1 lds
v_fma_f32 v83, v83, v41, v37
v_mul_f32 v80, v80, v164
v_mul_f32 v81, v81, v165
s_add_u32 m0, s39, 2048
s_add_u32 s37, s37, s38
buffer_load_dwordx4 v22, s[8:11], s37 offen sc1 lds
v_mul_f32 v82, v82, v166
v_mul_f32 v83, v83, v167
v_exp_f32 v80, v80
s_add_u32 m0, s39, 3072
s_add_u32 s37, s37, s38
buffer_load_dwordx4 v23, s[8:11], s37 offen sc1 lds
v_exp_f32 v81, v81
v_exp_f32 v82, v82
v_exp_f32 v83, v83
s_add_u32 m0, s39, 4096
s_add_u32 s37, s37, s38
buffer_load_dwordx4 v22, s[8:11], s37 offen sc1 lds
v_mul_f32 v228, v164, v228
v_mul_f32 v229, v165, v229
v_mul_f32 v230, v166, v230
s_add_u32 m0, s39, 5120
s_add_u32 s37, s37, s38
buffer_load_dwordx4 v23, s[8:11], s37 offen sc1 lds
v_mul_f32 v231, v167, v231
v_fma_f32 v80, v80, v45, v45
v_fma_f32 v81, v81, v45, v45
s_add_u32 m0, s39, 6144
s_add_u32 s37, s37, s38
buffer_load_dwordx4 v22, s[8:11], s37 offen sc1 lds
v_fma_f32 v82, v82, v45, v45
v_fma_f32 v83, v83, v45, v45
v_rcp_f32 v80, v80
s_add_u32 m0, s39, 7168
s_add_u32 s37, s37, s38
buffer_load_dwordx4 v23, s[8:11], s37 offen sc1 lds
v_rcp_f32 v81, v81
v_rcp_f32 v82, v82
v_rcp_f32 v83, v83
s_add_u32 m0, s39, 8192
s_add_u32 s37, s37, s38
buffer_load_dwordx4 v22, s[8:11], s37 offen sc1 lds
v_mul_f32 v228, v228, v80
v_mul_f32 v229, v229, v81
v_mul_f32 v230, v230, v82
s_add_u32 m0, s39, 9216
s_add_u32 s37, s37, s38
buffer_load_dwordx4 v23, s[8:11], s37 offen sc1 lds
v_mul_f32 v231, v231, v83
v_cvt_pk_bf16_f32 v100, v228, v229
v_cvt_pk_bf16_f32 v101, v230, v231
s_add_u32 m0, s39, 10240
s_add_u32 s37, s37, s38
buffer_load_dwordx4 v22, s[8:11], s37 offen sc1 lds
v_fma_f32 v180, -v33, v60, v180
v_fma_f32 v181, -v33, v61, v181
v_fma_f32 v182, -v33, v62, v182
s_add_u32 m0, s39, 11264
s_add_u32 s37, s37, s38
buffer_load_dwordx4 v23, s[8:11], s37 offen sc1 lds
v_fma_f32 v183, -v33, v63, v183
v_fma_f32 v244, -v33, v76, v244
v_fma_f32 v245, -v33, v77, v245
s_add_u32 m0, s39, 12288
s_add_u32 s37, s37, s38
buffer_load_dwordx4 v22, s[8:11], s37 offen sc1 lds
v_fma_f32 v246, -v33, v78, v246
v_fma_f32 v247, -v33, v79, v247
v_mul_f32 v84, v180, v180
s_add_u32 m0, s39, 13312
s_add_u32 s37, s37, s38
buffer_load_dwordx4 v23, s[8:11], s37 offen sc1 lds
v_mul_f32 v85, v181, v181
v_mul_f32 v86, v182, v182
v_mul_f32 v87, v183, v183
s_add_u32 m0, s39, 14336
s_add_u32 s37, s37, s38
buffer_load_dwordx4 v22, s[8:11], s37 offen sc1 lds
v_fma_f32 v84, v84, v41, v37
v_fma_f32 v85, v85, v41, v37
v_fma_f32 v86, v86, v41, v37
s_add_u32 m0, s39, 15360
s_add_u32 s37, s37, s38
buffer_load_dwordx4 v23, s[8:11], s37 offen sc1 lds
v_fma_f32 v87, v87, v41, v37
v_mul_f32 v84, v84, v180
v_mul_f32 v85, v85, v181
s_waitcnt vmcnt(17)
s_barrier
s_add_u32 m0, s39, 49152
s_add_u32 s37, s37, s38
buffer_load_dwordx4 v22, s[8:11], s37 offen sc1 lds
v_mul_f32 v86, v86, v182
v_mul_f32 v87, v87, v183
v_exp_f32 v84, v84
v_exp_f32 v85, v85
v_exp_f32 v86, v86
s_add_u32 m0, s39, 50176
s_add_u32 s37, s37, s38
buffer_load_dwordx4 v23, s[8:11], s37 offen sc1 lds
v_exp_f32 v87, v87
v_mul_f32 v244, v180, v244
v_mul_f32 v245, v181, v245
v_mul_f32 v246, v182, v246
s_add_u32 m0, s39, 51200
s_add_u32 s37, s37, s38
buffer_load_dwordx4 v22, s[8:11], s37 offen sc1 lds
v_mul_f32 v247, v183, v247
v_fma_f32 v84, v84, v45, v45
v_fma_f32 v85, v85, v45, v45
v_fma_f32 v86, v86, v45, v45
s_add_u32 m0, s39, 52224
s_add_u32 s37, s37, s38
buffer_load_dwordx4 v23, s[8:11], s37 offen sc1 lds
v_fma_f32 v87, v87, v45, v45
v_rcp_f32 v84, v84
v_rcp_f32 v85, v85
v_rcp_f32 v86, v86
s_add_u32 m0, s39, 53248
s_add_u32 s37, s37, s38
buffer_load_dwordx4 v22, s[8:11], s37 offen sc1 lds
v_rcp_f32 v87, v87
v_mul_f32 v244, v244, v84
v_mul_f32 v245, v245, v85
v_mul_f32 v246, v246, v86
s_add_u32 m0, s39, 54272
s_add_u32 s37, s37, s38
buffer_load_dwordx4 v23, s[8:11], s37 offen sc1 lds
v_mul_f32 v247, v247, v87
v_cvt_pk_bf16_f32 v102, v244, v245
v_cvt_pk_bf16_f32 v103, v246, v247
s_add_u32 m0, s39, 55296
s_add_u32 s37, s37, s38
buffer_load_dwordx4 v22, s[8:11], s37 offen sc1 lds
v_fma_f32 v168, -v34, v56, v168
v_fma_f32 v169, -v34, v57, v169
v_fma_f32 v170, -v34, v58, v170
v_fma_f32 v171, -v34, v59, v171
s_add_u32 m0, s39, 56320
s_add_u32 s37, s37, s38
buffer_load_dwordx4 v23, s[8:11], s37 offen sc1 lds
v_fma_f32 v232, -v34, v72, v232
v_fma_f32 v233, -v34, v73, v233
v_fma_f32 v234, -v34, v74, v234
v_fma_f32 v235, -v34, v75, v235
s_add_u32 m0, s39, 57344
s_add_u32 s37, s37, s38
buffer_load_dwordx4 v22, s[8:11], s37 offen sc1 lds
v_mul_f32 v80, v168, v168
v_mul_f32 v81, v169, v169
v_mul_f32 v82, v170, v170
v_mul_f32 v83, v171, v171
s_add_u32 m0, s39, 58368
s_add_u32 s37, s37, s38
buffer_load_dwordx4 v23, s[8:11], s37 offen sc1 lds
v_fma_f32 v80, v80, v42, v38
v_fma_f32 v81, v81, v42, v38
v_fma_f32 v82, v82, v42, v38
v_fma_f32 v83, v83, v42, v38
s_add_u32 m0, s39, 59392
s_add_u32 s37, s37, s38
buffer_load_dwordx4 v22, s[8:11], s37 offen sc1 lds
v_mul_f32 v80, v80, v168
v_mul_f32 v81, v81, v169
v_mul_f32 v82, v82, v170
v_mul_f32 v83, v83, v171
s_add_u32 m0, s39, 60416
s_add_u32 s37, s37, s38
buffer_load_dwordx4 v23, s[8:11], s37 offen sc1 lds
v_exp_f32 v80, v80
v_exp_f32 v81, v81
v_exp_f32 v82, v82
v_exp_f32 v83, v83
s_add_u32 m0, s39, 61440
s_add_u32 s37, s37, s38
buffer_load_dwordx4 v22, s[8:11], s37 offen sc1 lds
v_lshlrev_b32 v128, 16, v192
v_and_b32 v129, 0xffff0000, v192
v_lshlrev_b32 v130, 16, v193
v_and_b32 v131, 0xffff0000, v193
s_add_u32 m0, s39, 62464
s_add_u32 s37, s37, s38
buffer_load_dwordx4 v23, s[8:11], s37 offen sc1 lds
v_lshlrev_b32 v132, 16, v194
v_and_b32 v133, 0xffff0000, v194
v_lshlrev_b32 v134, 16, v195
v_and_b32 v135, 0xffff0000, v195
s_add_u32 m0, s39, 63488
s_add_u32 s37, s37, s38
buffer_load_dwordx4 v22, s[8:11], s37 offen sc1 lds
v_lshlrev_b32 v136, 16, v196
v_and_b32 v137, 0xffff0000, v196
v_lshlrev_b32 v138, 16, v197
v_and_b32 v139, 0xffff0000, v197
s_add_u32 m0, s39, 64512
s_add_u32 s37, s37, s38
buffer_load_dwordx4 v23, s[8:11], s37 offen sc1 lds
v_lshlrev_b32 v140, 16, v198
v_and_b32 v141, 0xffff0000, v198
v_lshlrev_b32 v142, 16, v199
v_and_b32 v143, 0xffff0000, v199
buffer_store_dwordx4 v[100:103], v27, s[24:27], s53 offen offset:256 sc1
s_waitcnt vmcnt(17)
s_barrier
s_add_u32 m0, s39, 98304
s_add_u32 s37, s37, s38
buffer_load_dwordx4 v22, s[8:11], s37 offen sc1 lds
v_mul_f32 v232, v168, v232
v_mul_f32 v233, v169, v233
v_mul_f32 v234, v170, v234
v_mul_f32 v235, v171, v235
s_add_u32 m0, s39, 99328
s_add_u32 s37, s37, s38
buffer_load_dwordx4 v23, s[8:11], s37 offen sc1 lds
v_fma_f32 v80, v80, v46, v46
v_fma_f32 v81, v81, v46, v46
v_fma_f32 v82, v82, v46, v46
v_fma_f32 v83, v83, v46, v46
s_add_u32 m0, s39, 100352
s_add_u32 s37, s37, s38
buffer_load_dwordx4 v22, s[8:11], s37 offen sc1 lds
v_rcp_f32 v80, v80
v_rcp_f32 v81, v81
v_rcp_f32 v82, v82
v_rcp_f32 v83, v83
s_add_u32 m0, s39, 101376
s_add_u32 s37, s37, s38
buffer_load_dwordx4 v23, s[8:11], s37 offen sc1 lds
v_mul_f32 v232, v232, v80
v_mul_f32 v233, v233, v81
v_mul_f32 v234, v234, v82
v_mul_f32 v235, v235, v83
s_add_u32 m0, s39, 102400
s_add_u32 s37, s37, s38
buffer_load_dwordx4 v22, s[8:11], s37 offen sc1 lds
v_cvt_pk_bf16_f32 v104, v232, v233
v_cvt_pk_bf16_f32 v105, v234, v235
v_fma_f32 v184, -v34, v60, v184
v_fma_f32 v185, -v34, v61, v185
s_add_u32 m0, s39, 103424
s_add_u32 s37, s37, s38
buffer_load_dwordx4 v23, s[8:11], s37 offen sc1 lds
v_fma_f32 v186, -v34, v62, v186
v_fma_f32 v187, -v34, v63, v187
v_fma_f32 v248, -v34, v76, v248
v_fma_f32 v249, -v34, v77, v249
s_add_u32 m0, s39, 104448
s_add_u32 s37, s37, s38
buffer_load_dwordx4 v22, s[8:11], s37 offen sc1 lds
v_fma_f32 v250, -v34, v78, v250
v_fma_f32 v251, -v34, v79, v251
v_mul_f32 v84, v184, v184
v_mul_f32 v85, v185, v185
s_add_u32 m0, s39, 105472
s_add_u32 s37, s37, s38
buffer_load_dwordx4 v23, s[8:11], s37 offen sc1 lds
v_mul_f32 v86, v186, v186
v_mul_f32 v87, v187, v187
v_fma_f32 v84, v84, v42, v38
v_fma_f32 v85, v85, v42, v38
s_add_u32 m0, s39, 106496
s_add_u32 s37, s37, s38
buffer_load_dwordx4 v22, s[8:11], s37 offen sc1 lds
v_fma_f32 v86, v86, v42, v38
v_fma_f32 v87, v87, v42, v38
v_mul_f32 v84, v84, v184
v_mul_f32 v85, v85, v185
s_add_u32 m0, s39, 107520
s_add_u32 s37, s37, s38
buffer_load_dwordx4 v23, s[8:11], s37 offen sc1 lds
v_mul_f32 v86, v86, v186
v_mul_f32 v87, v87, v187
v_exp_f32 v84, v84
v_exp_f32 v85, v85
s_add_u32 m0, s39, 108544
s_add_u32 s37, s37, s38
buffer_load_dwordx4 v22, s[8:11], s37 offen sc1 lds
v_exp_f32 v86, v86
v_exp_f32 v87, v87
v_mul_f32 v248, v184, v248
v_mul_f32 v249, v185, v249
s_add_u32 m0, s39, 109568
s_add_u32 s37, s37, s38
buffer_load_dwordx4 v23, s[8:11], s37 offen sc1 lds
v_mul_f32 v250, v186, v250
v_mul_f32 v251, v187, v251
v_fma_f32 v84, v84, v46, v46
v_fma_f32 v85, v85, v46, v46
s_add_u32 m0, s39, 110592
s_add_u32 s37, s37, s38
buffer_load_dwordx4 v22, s[8:11], s37 offen sc1 lds
v_lshlrev_b32 v144, 16, v200
v_and_b32 v145, 0xffff0000, v200
v_lshlrev_b32 v146, 16, v201
v_and_b32 v147, 0xffff0000, v201
s_add_u32 m0, s39, 111616
s_add_u32 s37, s37, s38
buffer_load_dwordx4 v23, s[8:11], s37 offen sc1 lds
v_lshlrev_b32 v148, 16, v202
v_and_b32 v149, 0xffff0000, v202
v_lshlrev_b32 v150, 16, v203
v_and_b32 v151, 0xffff0000, v203
s_add_u32 m0, s39, 112640
s_add_u32 s37, s37, s38
buffer_load_dwordx4 v22, s[8:11], s37 offen sc1 lds
v_lshlrev_b32 v152, 16, v204
v_and_b32 v153, 0xffff0000, v204
v_lshlrev_b32 v154, 16, v205
v_and_b32 v155, 0xffff0000, v205
s_add_u32 m0, s39, 113664
s_add_u32 s37, s37, s38
buffer_load_dwordx4 v23, s[8:11], s37 offen sc1 lds
v_lshlrev_b32 v156, 16, v206
v_and_b32 v157, 0xffff0000, v206
v_lshlrev_b32 v158, 16, v207
v_and_b32 v159, 0xffff0000, v207
s_waitcnt vmcnt(17)
s_barrier
s_add_u32 m0, s39, 0
s_add_u32 s37, s37, s38
buffer_load_dwordx4 v22, s[8:11], s37 offen sc1 lds
v_fma_f32 v86, v86, v46, v46
v_fma_f32 v87, v87, v46, v46
v_rcp_f32 v84, v84
v_rcp_f32 v85, v85
s_add_u32 m0, s39, 1024
s_add_u32 s37, s37, s38
buffer_load_dwordx4 v23, s[8:11], s37 offen sc1 lds
v_rcp_f32 v86, v86
v_rcp_f32 v87, v87
v_mul_f32 v248, v248, v84
s_add_u32 m0, s39, 2048
s_add_u32 s37, s37, s38
buffer_load_dwordx4 v22, s[8:11], s37 offen sc1 lds
v_mul_f32 v249, v249, v85
v_mul_f32 v250, v250, v86
v_mul_f32 v251, v251, v87
s_add_u32 m0, s39, 3072
s_add_u32 s37, s37, s38
buffer_load_dwordx4 v23, s[8:11], s37 offen sc1 lds
v_cvt_pk_bf16_f32 v106, v248, v249
v_cvt_pk_bf16_f32 v107, v250, v251
s_add_u32 m0, s39, 4096
s_add_u32 s37, s37, s38
buffer_load_dwordx4 v22, s[8:11], s37 offen sc1 lds
v_fma_f32 v172, -v35, v56, v172
v_fma_f32 v173, -v35, v57, v173
v_fma_f32 v174, -v35, v58, v174
s_add_u32 m0, s39, 5120
s_add_u32 s37, s37, s38
buffer_load_dwordx4 v23, s[8:11], s37 offen sc1 lds
v_fma_f32 v175, -v35, v59, v175
v_fma_f32 v236, -v35, v72, v236
v_fma_f32 v237, -v35, v73, v237
s_add_u32 m0, s39, 6144
s_add_u32 s37, s37, s38
buffer_load_dwordx4 v22, s[8:11], s37 offen sc1 lds
v_fma_f32 v238, -v35, v74, v238
v_fma_f32 v239, -v35, v75, v239
v_mul_f32 v80, v172, v172
s_add_u32 m0, s39, 7168
s_add_u32 s37, s37, s38
buffer_load_dwordx4 v23, s[8:11], s37 offen sc1 lds
v_mul_f32 v81, v173, v173
v_mul_f32 v82, v174, v174
v_mul_f32 v83, v175, v175
s_add_u32 m0, s39, 8192
s_add_u32 s37, s37, s38
buffer_load_dwordx4 v22, s[8:11], s37 offen sc1 lds
v_fma_f32 v80, v80, v43, v39
v_fma_f32 v81, v81, v43, v39
v_fma_f32 v82, v82, v43, v39
s_add_u32 m0, s39, 9216
s_add_u32 s37, s37, s38
buffer_load_dwordx4 v23, s[8:11], s37 offen sc1 lds
v_fma_f32 v83, v83, v43, v39
v_mul_f32 v80, v80, v172
v_mul_f32 v81, v81, v173
s_add_u32 m0, s39, 10240
s_add_u32 s37, s37, s38
buffer_load_dwordx4 v22, s[8:11], s37 offen sc1 lds
v_mul_f32 v82, v82, v174
v_mul_f32 v83, v83, v175
v_exp_f32 v80, v80
s_add_u32 m0, s39, 11264
s_add_u32 s37, s37, s38
buffer_load_dwordx4 v23, s[8:11], s37 offen sc1 lds
v_exp_f32 v81, v81
v_exp_f32 v82, v82
v_exp_f32 v83, v83
s_add_u32 m0, s39, 12288
s_add_u32 s37, s37, s38
buffer_load_dwordx4 v22, s[8:11], s37 offen sc1 lds
v_mul_f32 v236, v172, v236
v_mul_f32 v237, v173, v237
v_mul_f32 v238, v174, v238
s_add_u32 m0, s39, 13312
s_add_u32 s37, s37, s38
buffer_load_dwordx4 v23, s[8:11], s37 offen sc1 lds
v_mul_f32 v239, v175, v239
v_fma_f32 v80, v80, v47, v47
v_fma_f32 v81, v81, v47, v47
s_add_u32 m0, s39, 14336
s_add_u32 s37, s37, s38
buffer_load_dwordx4 v22, s[8:11], s37 offen sc1 lds
v_fma_f32 v82, v82, v47, v47
v_fma_f32 v83, v83, v47, v47
v_rcp_f32 v80, v80
s_add_u32 m0, s39, 15360
s_add_u32 s37, s37, s38
buffer_load_dwordx4 v23, s[8:11], s37 offen sc1 lds
v_rcp_f32 v81, v81
v_rcp_f32 v82, v82
v_rcp_f32 v83, v83
buffer_store_dwordx4 v[104:107], v27, s[24:27], s53 offen offset:512 sc1
s_waitcnt vmcnt(17)
s_barrier
s_mul_i32 s44, s34, 917504
s_lshl_b32 s39, s51, 13
s_add_u32 s44, s44, s39
s_add_u32 s44, s44, 8388608
s_lshl_b32 s43, s35, 7
s_mov_b32 s10, 909312
s_movk_i32 s38, 1024
s_movk_i32 s40, 9216
s_cmp_eq_u32 s51, 2
s_cselect_b32 s8, s60, s32
s_cselect_b32 s9, s61, s33
s_cselect_b32 s10, 7338112, s10
s_cselect_b32 s43, s43, s44
s_cselect_b32 s38, 16384, s38
s_cselect_b32 s40, 81920, s40
s_cselect_b32 s55, 81920, s38
s_cselect_b32 s45, -1, 0
s_add_u32 s8, s8, s43
s_addc_u32 s9, s9, 0
s_mov_b32 s11, 0x20000
s_sub_u32 s37, 0, s40
v_lshrrev_b32 v19, 3, v1
v_mul_u32_u24 v19, 1920, v19
v_lshrrev_b32 v20, 4, v1
v_lshlrev_b32 v20, 5, v20
v_and_b32 v19, s45, v19
v_and_b32 v20, s45, v20
v_lshlrev_b32 v21, 4, v1
v_xor_b32 v21, v21, v20
v_add_u32 v21, v21, v19
s_add_u32 m0, s39, 49152
s_add_u32 s37, s37, s40
buffer_load_dwordx4 v21, s[8:11], s37 offen sc1 lds
v_mul_f32 v236, v236, v80
v_mul_f32 v237, v237, v81
v_mul_f32 v238, v238, v82
s_add_u32 m0, s39, 50176
s_add_u32 s37, s37, s38
buffer_load_dwordx4 v21, s[8:11], s37 offen sc1 lds
v_mul_f32 v239, v239, v83
v_cvt_pk_bf16_f32 v108, v236, v237
v_cvt_pk_bf16_f32 v109, v238, v239
s_add_u32 m0, s39, 51200
s_add_u32 s37, s37, s38
buffer_load_dwordx4 v21, s[8:11], s37 offen sc1 lds
v_fma_f32 v188, -v35, v60, v188
v_fma_f32 v189, -v35, v61, v189
v_fma_f32 v190, -v35, v62, v190
s_add_u32 m0, s39, 52224
s_add_u32 s37, s37, s38
buffer_load_dwordx4 v21, s[8:11], s37 offen sc1 lds
v_fma_f32 v191, -v35, v63, v191
v_fma_f32 v252, -v35, v76, v252
v_fma_f32 v253, -v35, v77, v253
s_add_u32 m0, s39, 53248
s_add_u32 s37, s37, s55
buffer_load_dwordx4 v21, s[8:11], s37 offen sc1 lds
v_fma_f32 v254, -v35, v78, v254
v_fma_f32 v255, -v35, v79, v255
v_mul_f32 v84, v188, v188
s_add_u32 m0, s39, 54272
s_add_u32 s37, s37, s38
buffer_load_dwordx4 v21, s[8:11], s37 offen sc1 lds
v_mul_f32 v85, v189, v189
v_mul_f32 v86, v190, v190
v_mul_f32 v87, v191, v191
s_add_u32 m0, s39, 55296
s_add_u32 s37, s37, s38
buffer_load_dwordx4 v21, s[8:11], s37 offen sc1 lds
v_fma_f32 v84, v84, v43, v39
v_fma_f32 v85, v85, v43, v39
v_fma_f32 v86, v86, v43, v39
s_add_u32 m0, s39, 56320
s_add_u32 s37, s37, s38
buffer_load_dwordx4 v21, s[8:11], s37 offen sc1 lds
v_fma_f32 v87, v87, v43, v39
v_mul_f32 v84, v84, v188
v_mul_f32 v85, v85, v189
s_add_u32 m0, s39, 73728
s_add_u32 s37, s37, s40
buffer_load_dwordx4 v21, s[8:11], s37 offen sc1 lds
v_mul_f32 v86, v86, v190
v_mul_f32 v87, v87, v191
v_exp_f32 v84, v84
v_exp_f32 v85, v85
s_add_u32 m0, s39, 74752
s_add_u32 s37, s37, s38
buffer_load_dwordx4 v21, s[8:11], s37 offen sc1 lds
v_exp_f32 v86, v86
v_exp_f32 v87, v87
v_mul_f32 v252, v188, v252
s_add_u32 m0, s39, 75776
s_add_u32 s37, s37, s38
buffer_load_dwordx4 v21, s[8:11], s37 offen sc1 lds
v_mul_f32 v253, v189, v253
v_mul_f32 v254, v190, v254
v_mul_f32 v255, v191, v255
s_add_u32 m0, s39, 76800
s_add_u32 s37, s37, s38
buffer_load_dwordx4 v21, s[8:11], s37 offen sc1 lds
v_fma_f32 v84, v84, v47, v47
v_fma_f32 v85, v85, v47, v47
v_fma_f32 v86, v86, v47, v47
s_add_u32 m0, s39, 77824
s_add_u32 s37, s37, s55
buffer_load_dwordx4 v21, s[8:11], s37 offen sc1 lds
v_fma_f32 v87, v87, v47, v47
v_rcp_f32 v84, v84
v_rcp_f32 v85, v85
s_add_u32 m0, s39, 78848
s_add_u32 s37, s37, s38
buffer_load_dwordx4 v21, s[8:11], s37 offen sc1 lds
v_rcp_f32 v86, v86
v_rcp_f32 v87, v87
v_mul_f32 v252, v252, v84
s_add_u32 m0, s39, 79872
s_add_u32 s37, s37, s38
buffer_load_dwordx4 v21, s[8:11], s37 offen sc1 lds
v_mul_f32 v253, v253, v85
v_mul_f32 v254, v254, v86
v_mul_f32 v255, v255, v87
s_add_u32 m0, s39, 80896
s_add_u32 s37, s37, s38
buffer_load_dwordx4 v21, s[8:11], s37 offen sc1 lds
v_cvt_pk_bf16_f32 v110, v252, v253
v_cvt_pk_bf16_f32 v111, v254, v255
buffer_store_dwordx4 v[108:111], v27, s[24:27], s53 offen offset:768 sc1
s_waitcnt vmcnt(18)
s_barrier
s_add_u32 m0, s39, 98304
s_add_u32 s37, s37, s40
buffer_load_dwordx4 v21, s[8:11], s37 offen sc1 lds
s_add_u32 m0, s39, 99328
s_add_u32 s37, s37, s38
buffer_load_dwordx4 v21, s[8:11], s37 offen sc1 lds
s_add_u32 m0, s39, 100352
s_add_u32 s37, s37, s38
buffer_load_dwordx4 v21, s[8:11], s37 offen sc1 lds
s_add_u32 m0, s39, 101376
s_add_u32 s37, s37, s38
buffer_load_dwordx4 v21, s[8:11], s37 offen sc1 lds
s_add_u32 m0, s39, 102400
s_add_u32 s37, s37, s55
buffer_load_dwordx4 v21, s[8:11], s37 offen sc1 lds
s_add_u32 m0, s39, 103424
s_add_u32 s37, s37, s38
buffer_load_dwordx4 v21, s[8:11], s37 offen sc1 lds
s_add_u32 m0, s39, 104448
s_add_u32 s37, s37, s38
buffer_load_dwordx4 v21, s[8:11], s37 offen sc1 lds
s_add_u32 m0, s39, 105472
s_add_u32 s37, s37, s38
buffer_load_dwordx4 v21, s[8:11], s37 offen sc1 lds
s_add_u32 m0, s39, 122880
s_add_u32 s37, s37, s40
buffer_load_dwordx4 v21, s[8:11], s37 offen sc1 lds
s_add_u32 m0, s39, 123904
s_add_u32 s37, s37, s38
buffer_load_dwordx4 v21, s[8:11], s37 offen sc1 lds
s_add_u32 m0, s39, 124928
s_add_u32 s37, s37, s38
buffer_load_dwordx4 v21, s[8:11], s37 offen sc1 lds
s_add_u32 m0, s39, 125952
s_add_u32 s37, s37, s38
buffer_load_dwordx4 v21, s[8:11], s37 offen sc1 lds
s_add_u32 m0, s39, 126976
s_add_u32 s37, s37, s55
buffer_load_dwordx4 v21, s[8:11], s37 offen sc1 lds
s_add_u32 m0, s39, 128000
s_add_u32 s37, s37, s38
buffer_load_dwordx4 v21, s[8:11], s37 offen sc1 lds
s_add_u32 m0, s39, 129024
s_add_u32 s37, s37, s38
buffer_load_dwordx4 v21, s[8:11], s37 offen sc1 lds
s_add_u32 m0, s39, 130048
s_add_u32 s37, s37, s38
buffer_load_dwordx4 v21, s[8:11], s37 offen sc1 lds
s_waitcnt vmcnt(16)
s_barrier
s_branch LK4_23
L3h_22:
v_mfma_f32_16x16x32_bf16 v[128:131], v[96:99], v[80:83], v[128:131]
v_mfma_f32_16x16x32_bf16 v[132:135], v[96:99], v[84:87], v[132:135]
v_mfma_f32_16x16x32_bf16 v[136:139], v[96:99], v[88:91], v[136:139]
v_mfma_f32_16x16x32_bf16 v[140:143], v[96:99], v[92:95], v[140:143]
v_mfma_f32_16x16x32_bf16 v[192:195], v[112:115], v[80:83], v[192:195]
v_mfma_f32_16x16x32_bf16 v[196:199], v[112:115], v[84:87], v[196:199]
v_mfma_f32_16x16x32_bf16 v[200:203], v[112:115], v[88:91], v[200:203]
v_mfma_f32_16x16x32_bf16 v[204:207], v[112:115], v[92:95], v[204:207]
v_mfma_f32_16x16x32_bf16 v[144:147], v[100:103], v[80:83], v[144:147]
v_mfma_f32_16x16x32_bf16 v[148:151], v[100:103], v[84:87], v[148:151]
v_mfma_f32_16x16x32_bf16 v[152:155], v[100:103], v[88:91], v[152:155]
v_mfma_f32_16x16x32_bf16 v[156:159], v[100:103], v[92:95], v[156:159]
v_mfma_f32_16x16x32_bf16 v[208:211], v[116:119], v[80:83], v[208:211]
v_mfma_f32_16x16x32_bf16 v[212:215], v[116:119], v[84:87], v[212:215]
v_mfma_f32_16x16x32_bf16 v[216:219], v[116:119], v[88:91], v[216:219]
v_mfma_f32_16x16x32_bf16 v[220:223], v[116:119], v[92:95], v[220:223]
v_mfma_f32_16x16x32_bf16 v[160:163], v[104:107], v[80:83], v[160:163]
v_mfma_f32_16x16x32_bf16 v[164:167], v[104:107], v[84:87], v[164:167]
v_mfma_f32_16x16x32_bf16 v[168:171], v[104:107], v[88:91], v[168:171]
v_mfma_f32_16x16x32_bf16 v[172:175], v[104:107], v[92:95], v[172:175]
v_mfma_f32_16x16x32_bf16 v[224:227], v[120:123], v[80:83], v[224:227]
v_mfma_f32_16x16x32_bf16 v[228:231], v[120:123], v[84:87], v[228:231]
v_mfma_f32_16x16x32_bf16 v[232:235], v[120:123], v[88:91], v[232:235]
v_mfma_f32_16x16x32_bf16 v[236:239], v[120:123], v[92:95], v[236:239]
v_mfma_f32_16x16x32_bf16 v[176:179], v[108:111], v[80:83], v[176:179]
v_mfma_f32_16x16x32_bf16 v[180:183], v[108:111], v[84:87], v[180:183]
v_mfma_f32_16x16x32_bf16 v[184:187], v[108:111], v[88:91], v[184:187]
v_mfma_f32_16x16x32_bf16 v[188:191], v[108:111], v[92:95], v[188:191]
v_mfma_f32_16x16x32_bf16 v[240:243], v[124:127], v[80:83], v[240:243]
v_mfma_f32_16x16x32_bf16 v[244:247], v[124:127], v[84:87], v[244:247]
v_mfma_f32_16x16x32_bf16 v[248:251], v[124:127], v[88:91], v[248:251]
v_mfma_f32_16x16x32_bf16 v[252:255], v[124:127], v[92:95], v[252:255]
s_setprio 0
s_lshl_b32 s43, s46, 9
s_add_u32 s43, s43, 147456
v_lshl_add_u32 v19, v17, 3, s43
ds_read_b64 v[80:81], v19 offset:0
ds_read_b64 v[82:83], v19 offset:128
ds_read_b64 v[84:85], v19 offset:256
ds_read_b64 v[86:87], v19 offset:384
s_mul_i32 s43, s47, 256
s_add_u32 s43, s43, 148480
v_lshl_add_u32 v19, v18, 4, s43
ds_read_b128 v[48:51], v19 offset:0
ds_read_b128 v[52:55], v19 offset:64
ds_read_b128 v[56:59], v19 offset:128
ds_read_b128 v[60:63], v19 offset:192
ds_read_b128 v[64:67], v19 offset:896
ds_read_b128 v[68:71], v19 offset:960
ds_read_b128 v[72:75], v19 offset:1024
ds_read_b128 v[76:79], v19 offset:1088
s_waitcnt lgkmcnt(0)
v_mov_b32 v32, v80
v_mul_f32 v88, v81, v81
v_mul_f32 v36, 0xc0135761, v81
v_mul_f32 v89, 0xbdd2d3e8, v81
v_rcp_f32 v44, v88
v_mul_f32 v40, v89, v88
v_mov_b32 v33, v82
v_mul_f32 v88, v83, v83
v_mul_f32 v37, 0xc0135761, v83
v_mul_f32 v89, 0xbdd2d3e8, v83
v_rcp_f32 v45, v88
v_mul_f32 v41, v89, v88
v_mov_b32 v34, v84
v_mul_f32 v88, v85, v85
v_mul_f32 v38, 0xc0135761, v85
v_mul_f32 v89, 0xbdd2d3e8, v85
v_rcp_f32 v46, v88
v_mul_f32 v42, v89, v88
v_mov_b32 v35, v86
v_mul_f32 v88, v87, v87
v_mul_f32 v39, 0xc0135761, v87
v_mul_f32 v89, 0xbdd2d3e8, v87
v_rcp_f32 v47, v88
v_mul_f32 v43, v89, v88
s_barrier
v_fma_f32 v128, -v32, v48, v128
v_fma_f32 v129, -v32, v49, v129
v_fma_f32 v130, -v32, v50, v130
v_fma_f32 v131, -v32, v51, v131
v_fma_f32 v192, -v32, v64, v192
v_fma_f32 v193, -v32, v65, v193
v_fma_f32 v194, -v32, v66, v194
v_fma_f32 v195, -v32, v67, v195
v_mul_f32 v80, v128, v128
v_mul_f32 v81, v129, v129
v_mul_f32 v82, v130, v130
v_mul_f32 v83, v131, v131
v_fma_f32 v80, v80, v40, v36
v_fma_f32 v81, v81, v40, v36
v_fma_f32 v82, v82, v40, v36
v_fma_f32 v83, v83, v40, v36
v_mul_f32 v80, v80, v128
v_mul_f32 v81, v81, v129
v_mul_f32 v82, v82, v130
v_mul_f32 v83, v83, v131
v_exp_f32 v80, v80
v_exp_f32 v81, v81
v_exp_f32 v82, v82
v_exp_f32 v83, v83
v_mul_f32 v192, v128, v192
v_mul_f32 v193, v129, v193
v_mul_f32 v194, v130, v194
v_mul_f32 v195, v131, v195
v_fma_f32 v80, v80, v44, v44
v_fma_f32 v81, v81, v44, v44
v_fma_f32 v82, v82, v44, v44
v_fma_f32 v83, v83, v44, v44
v_rcp_f32 v80, v80
v_rcp_f32 v81, v81
v_rcp_f32 v82, v82
v_rcp_f32 v83, v83
v_mul_f32 v192, v192, v80
v_mul_f32 v193, v193, v81
v_mul_f32 v194, v194, v82
v_mul_f32 v195, v195, v83
v_cvt_pk_bf16_f32 v96, v192, v193
v_cvt_pk_bf16_f32 v97, v194, v195
v_fma_f32 v144, -v32, v52, v144
v_fma_f32 v145, -v32, v53, v145
v_fma_f32 v146, -v32, v54, v146
v_fma_f32 v147, -v32, v55, v147
v_fma_f32 v208, -v32, v68, v208
v_fma_f32 v209, -v32, v69, v209
s_barrier
v_fma_f32 v210, -v32, v70, v210
v_fma_f32 v211, -v32, v71, v211
v_mul_f32 v84, v144, v144
v_mul_f32 v85, v145, v145
v_mul_f32 v86, v146, v146
v_mul_f32 v87, v147, v147
v_fma_f32 v84, v84, v40, v36
v_fma_f32 v85, v85, v40, v36
v_fma_f32 v86, v86, v40, v36
v_fma_f32 v87, v87, v40, v36
v_mul_f32 v84, v84, v144
v_mul_f32 v85, v85, v145
v_mul_f32 v86, v86, v146
v_mul_f32 v87, v87, v147
v_exp_f32 v84, v84
v_exp_f32 v85, v85
v_exp_f32 v86, v86
v_exp_f32 v87, v87
v_mul_f32 v208, v144, v208
v_mul_f32 v209, v145, v209
v_mul_f32 v210, v146, v210
v_mul_f32 v211, v147, v211
v_fma_f32 v84, v84, v44, v44
v_fma_f32 v85, v85, v44, v44
v_fma_f32 v86, v86, v44, v44
v_fma_f32 v87, v87, v44, v44
v_rcp_f32 v84, v84
v_rcp_f32 v85, v85
v_rcp_f32 v86, v86
v_rcp_f32 v87, v87
v_mul_f32 v208, v208, v84
v_mul_f32 v209, v209, v85
v_mul_f32 v210, v210, v86
v_mul_f32 v211, v211, v87
v_cvt_pk_bf16_f32 v98, v208, v209
v_cvt_pk_bf16_f32 v99, v210, v211
buffer_store_dwordx4 v[96:99], v27, s[24:27], 0 offen offset:0 sc1
v_fma_f32 v132, -v33, v48, v132
v_fma_f32 v133, -v33, v49, v133
v_fma_f32 v134, -v33, v50, v134
v_fma_f32 v135, -v33, v51, v135
v_fma_f32 v196, -v33, v64, v196
v_fma_f32 v197, -v33, v65, v197
v_fma_f32 v198, -v33, v66, v198
v_fma_f32 v199, -v33, v67, v199
v_mul_f32 v80, v132, v132
v_mul_f32 v81, v133, v133
v_mul_f32 v82, v134, v134
v_mul_f32 v83, v135, v135
v_lshlrev_b32 v19, 11, v18
v_lshl_add_u32 v19, v17, 4, v19
s_lshl_b32 s43, s36, 9
v_add_u32 v2, s43, v19
v_add_u32 v3, 49152, v2
v_add_u32 v4, 98304, v2
v_lshrrev_b32 v19, 2, v17
v_lshl_add_u32 v20, v18, 2, v19
v_bfe_u32 v21, v20, 1, 2
v_lshlrev_b32 v20, 7, v20
v_lshl_add_u32 v20, v21, 5, v20
v_and_b32 v19, 3, v1
v_lshl_add_u32 v20, v19, 3, v20
v_add_u32 v5, 16384, v20
s_barrier
s_mov_b32 s88, s4
s_mov_b32 s89, s5
s_mov_b32 s90, 7340032
s_mov_b32 s91, 0x20000
s_mov_b32 s92, s6
s_mov_b32 s93, s7
s_mov_b32 s94, 7340032
s_mov_b32 s95, 0x20000
s_lshr_b32 s43, s35, 3
s_lshl_b32 s44, s43, 10
s_xor_b32 s44, s44, 1024
s_lshl_b32 s43, s43, 11
s_add_u32 s43, s43, 4480
s_lshr_b32 s45, s2, 3
s_mul_i32 s45, s45, 14336
s_add_u32 s43, s43, s45
v_and_b32 v19, 1, v1
v_mul_lo_u32 v31, v19, s44
v_bfe_u32 v19, v1, 1, 1
v_mul_u32_u24 v19, 7168, v19
v_add3_u32 v31, v31, v19, s43
v_bfe_u32 v19, v1, 2, 3
v_mul_u32_u24 v19, 458752, v19
v_add_u32 v31, v31, v19
s_mov_b32 s43, 3670016
buffer_load_dword v30, v31, s[88:91], s43 offen
buffer_load_dword v30, v31, s[92:95], s43 offen
v_fma_f32 v80, v80, v41, v37
v_fma_f32 v81, v81, v41, v37
v_fma_f32 v82, v82, v41, v37
v_fma_f32 v83, v83, v41, v37
v_mul_f32 v80, v80, v132
v_mul_f32 v81, v81, v133
v_mul_f32 v82, v82, v134
v_mul_f32 v83, v83, v135
v_exp_f32 v80, v80
v_exp_f32 v81, v81
v_exp_f32 v82, v82
v_exp_f32 v83, v83
v_mul_f32 v196, v132, v196
v_mul_f32 v197, v133, v197
v_mul_f32 v198, v134, v198
v_mul_f32 v199, v135, v199
v_fma_f32 v80, v80, v45, v45
v_fma_f32 v81, v81, v45, v45
v_fma_f32 v82, v82, v45, v45
v_fma_f32 v83, v83, v45, v45
v_rcp_f32 v80, v80
v_rcp_f32 v81, v81
v_rcp_f32 v82, v82
v_rcp_f32 v83, v83
v_mul_f32 v196, v196, v80
v_mul_f32 v197, v197, v81
v_mul_f32 v198, v198, v82
v_mul_f32 v199, v199, v83
v_cvt_pk_bf16_f32 v100, v196, v197
v_cvt_pk_bf16_f32 v101, v198, v199
v_fma_f32 v148, -v33, v52, v148
v_fma_f32 v149, -v33, v53, v149
v_fma_f32 v150, -v33, v54, v150
v_fma_f32 v151, -v33, v55, v151
v_fma_f32 v212, -v33, v68, v212
v_fma_f32 v213, -v33, v69, v213
v_fma_f32 v214, -v33, v70, v214
v_fma_f32 v215, -v33, v71, v215
v_mul_f32 v84, v148, v148
v_mul_f32 v85, v149, v149
v_mul_f32 v86, v150, v150
v_mul_f32 v87, v151, v151
v_fma_f32 v84, v84, v41, v37
v_fma_f32 v85, v85, v41, v37
v_fma_f32 v86, v86, v41, v37
v_fma_f32 v87, v87, v41, v37
v_mul_f32 v84, v84, v148
v_mul_f32 v85, v85, v149
v_xor_b32 v6, 32, v5
v_xor_b32 v7, 64, v5
v_xor_b32 v8, 96, v5
v_add_u32 v9, 49152, v5
v_add_u32 v10, 49152, v6
v_add_u32 v11, 49152, v7
v_add_u32 v12, 49152, v8
v_add_u32 v13, 98304, v5
v_add_u32 v14, 98304, v6
v_add_u32 v15, 98304, v7
v_add_u32 v16, 98304, v8
s_barrier
v_mul_f32 v86, v86, v150
v_mul_f32 v87, v87, v151
v_exp_f32 v84, v84
v_exp_f32 v85, v85
v_exp_f32 v86, v86
v_exp_f32 v87, v87
v_mul_f32 v212, v148, v212
v_mul_f32 v213, v149, v213
v_mul_f32 v214, v150, v214
v_mul_f32 v215, v151, v215
v_fma_f32 v84, v84, v45, v45
v_fma_f32 v85, v85, v45, v45
v_fma_f32 v86, v86, v45, v45
v_fma_f32 v87, v87, v45, v45
v_rcp_f32 v84, v84
v_rcp_f32 v85, v85
v_rcp_f32 v86, v86
v_rcp_f32 v87, v87
v_mul_f32 v212, v212, v84
v_mul_f32 v213, v213, v85
v_mul_f32 v214, v214, v86
v_mul_f32 v215, v215, v87
v_cvt_pk_bf16_f32 v102, v212, v213
v_cvt_pk_bf16_f32 v103, v214, v215
buffer_store_dwordx4 v[100:103], v27, s[24:27], 0 offen offset:256 sc1
v_fma_f32 v136, -v34, v48, v136
v_fma_f32 v137, -v34, v49, v137
v_fma_f32 v138, -v34, v50, v138
v_fma_f32 v139, -v34, v51, v139
v_fma_f32 v200, -v34, v64, v200
v_fma_f32 v201, -v34, v65, v201
v_fma_f32 v202, -v34, v66, v202
v_fma_f32 v203, -v34, v67, v203
v_mul_f32 v80, v136, v136
v_mul_f32 v81, v137, v137
v_mul_f32 v82, v138, v138
v_mul_f32 v83, v139, v139
v_fma_f32 v80, v80, v42, v38
v_fma_f32 v81, v81, v42, v38
v_fma_f32 v82, v82, v42, v38
v_fma_f32 v83, v83, v42, v38
v_mul_f32 v80, v80, v136
v_mul_f32 v81, v81, v137
v_mul_f32 v82, v82, v138
v_mul_f32 v83, v83, v139
v_exp_f32 v80, v80
v_exp_f32 v81, v81
v_exp_f32 v82, v82
v_exp_f32 v83, v83
s_barrier
v_mul_f32 v200, v136, v200
v_mul_f32 v201, v137, v201
v_mul_f32 v202, v138, v202
v_mul_f32 v203, v139, v203
v_fma_f32 v80, v80, v46, v46
v_fma_f32 v81, v81, v46, v46
v_fma_f32 v82, v82, v46, v46
v_fma_f32 v83, v83, v46, v46
v_rcp_f32 v80, v80
v_rcp_f32 v81, v81
v_rcp_f32 v82, v82
v_rcp_f32 v83, v83
v_mul_f32 v200, v200, v80
v_mul_f32 v201, v201, v81
v_mul_f32 v202, v202, v82
v_mul_f32 v203, v203, v83
v_cvt_pk_bf16_f32 v104, v200, v201
v_cvt_pk_bf16_f32 v105, v202, v203
v_fma_f32 v152, -v34, v52, v152
v_fma_f32 v153, -v34, v53, v153
v_fma_f32 v154, -v34, v54, v154
v_fma_f32 v155, -v34, v55, v155
v_fma_f32 v216, -v34, v68, v216
v_fma_f32 v217, -v34, v69, v217
v_fma_f32 v218, -v34, v70, v218
v_fma_f32 v219, -v34, v71, v219
v_mul_f32 v84, v152, v152
v_mul_f32 v85, v153, v153
v_mul_f32 v86, v154, v154
v_mul_f32 v87, v155, v155
v_fma_f32 v84, v84, v42, v38
v_fma_f32 v85, v85, v42, v38
v_fma_f32 v86, v86, v42, v38
v_fma_f32 v87, v87, v42, v38
v_mul_f32 v84, v84, v152
v_mul_f32 v85, v85, v153
v_mul_f32 v86, v86, v154
v_mul_f32 v87, v87, v155
v_exp_f32 v84, v84
v_exp_f32 v85, v85
v_exp_f32 v86, v86
v_exp_f32 v87, v87
v_mul_f32 v216, v152, v216
v_mul_f32 v217, v153, v217
v_mul_f32 v218, v154, v218
v_mul_f32 v219, v155, v219
v_fma_f32 v84, v84, v46, v46
v_fma_f32 v85, v85, v46, v46
s_barrier
v_fma_f32 v86, v86, v46, v46
v_fma_f32 v87, v87, v46, v46
v_rcp_f32 v84, v84
v_rcp_f32 v85, v85
v_rcp_f32 v86, v86
v_rcp_f32 v87, v87
v_mul_f32 v216, v216, v84
v_mul_f32 v217, v217, v85
v_mul_f32 v218, v218, v86
v_mul_f32 v219, v219, v87
v_cvt_pk_bf16_f32 v106, v216, v217
v_cvt_pk_bf16_f32 v107, v218, v219
buffer_store_dwordx4 v[104:107], v27, s[24:27], 0 offen offset:512 sc1
v_fma_f32 v140, -v35, v48, v140
v_fma_f32 v141, -v35, v49, v141
v_fma_f32 v142, -v35, v50, v142
v_fma_f32 v143, -v35, v51, v143
v_fma_f32 v204, -v35, v64, v204
v_fma_f32 v205, -v35, v65, v205
v_fma_f32 v206, -v35, v66, v206
v_fma_f32 v207, -v35, v67, v207
v_mul_f32 v80, v140, v140
v_mul_f32 v81, v141, v141
v_mul_f32 v82, v142, v142
v_mul_f32 v83, v143, v143
v_fma_f32 v80, v80, v43, v39
v_fma_f32 v81, v81, v43, v39
v_fma_f32 v82, v82, v43, v39
v_fma_f32 v83, v83, v43, v39
v_mul_f32 v80, v80, v140
v_mul_f32 v81, v81, v141
v_mul_f32 v82, v82, v142
v_mul_f32 v83, v83, v143
v_exp_f32 v80, v80
v_exp_f32 v81, v81
v_exp_f32 v82, v82
v_exp_f32 v83, v83
v_mul_f32 v204, v140, v204
v_mul_f32 v205, v141, v205
v_mul_f32 v206, v142, v206
v_mul_f32 v207, v143, v207
v_fma_f32 v80, v80, v47, v47
v_fma_f32 v81, v81, v47, v47
v_fma_f32 v82, v82, v47, v47
v_fma_f32 v83, v83, v47, v47
v_rcp_f32 v80, v80
v_rcp_f32 v81, v81
v_rcp_f32 v82, v82
v_rcp_f32 v83, v83
s_barrier
v_mul_f32 v204, v204, v80
v_mul_f32 v205, v205, v81
v_mul_f32 v206, v206, v82
v_mul_f32 v207, v207, v83
v_cvt_pk_bf16_f32 v108, v204, v205
v_cvt_pk_bf16_f32 v109, v206, v207
v_fma_f32 v156, -v35, v52, v156
v_fma_f32 v157, -v35, v53, v157
v_fma_f32 v158, -v35, v54, v158
v_fma_f32 v159, -v35, v55, v159
v_fma_f32 v220, -v35, v68, v220
v_fma_f32 v221, -v35, v69, v221
v_fma_f32 v222, -v35, v70, v222
v_fma_f32 v223, -v35, v71, v223
v_mul_f32 v84, v156, v156
v_mul_f32 v85, v157, v157
v_mul_f32 v86, v158, v158
v_mul_f32 v87, v159, v159
v_fma_f32 v84, v84, v43, v39
v_fma_f32 v85, v85, v43, v39
v_fma_f32 v86, v86, v43, v39
v_fma_f32 v87, v87, v43, v39
v_mul_f32 v84, v84, v156
v_mul_f32 v85, v85, v157
v_mul_f32 v86, v86, v158
v_mul_f32 v87, v87, v159
v_exp_f32 v84, v84
v_exp_f32 v85, v85
v_exp_f32 v86, v86
v_exp_f32 v87, v87
v_mul_f32 v220, v156, v220
v_mul_f32 v221, v157, v221
v_mul_f32 v222, v158, v222
v_mul_f32 v223, v159, v223
v_fma_f32 v84, v84, v47, v47
v_fma_f32 v85, v85, v47, v47
v_fma_f32 v86, v86, v47, v47
v_fma_f32 v87, v87, v47, v47
v_rcp_f32 v84, v84
v_rcp_f32 v85, v85
v_rcp_f32 v86, v86
v_rcp_f32 v87, v87
v_mul_f32 v220, v220, v84
v_mul_f32 v221, v221, v85
v_mul_f32 v222, v222, v86
v_mul_f32 v223, v223, v87
v_cvt_pk_bf16_f32 v110, v220, v221
v_cvt_pk_bf16_f32 v111, v222, v223
buffer_store_dwordx4 v[108:111], v27, s[24:27], 0 offen offset:768 sc1
s_barrier
v_fma_f32 v160, -v32, v56, v160
v_fma_f32 v161, -v32, v57, v161
v_fma_f32 v162, -v32, v58, v162
v_fma_f32 v163, -v32, v59, v163
v_fma_f32 v224, -v32, v72, v224
v_fma_f32 v225, -v32, v73, v225
v_fma_f32 v226, -v32, v74, v226
v_fma_f32 v227, -v32, v75, v227
v_mul_f32 v80, v160, v160
v_mul_f32 v81, v161, v161
v_mul_f32 v82, v162, v162
v_mul_f32 v83, v163, v163
v_fma_f32 v80, v80, v40, v36
v_fma_f32 v81, v81, v40, v36
v_fma_f32 v82, v82, v40, v36
v_fma_f32 v83, v83, v40, v36
v_mul_f32 v80, v80, v160
v_mul_f32 v81, v81, v161
v_mul_f32 v82, v82, v162
v_mul_f32 v83, v83, v163
v_exp_f32 v80, v80
v_exp_f32 v81, v81
v_exp_f32 v82, v82
v_exp_f32 v83, v83
v_mul_f32 v224, v160, v224
v_mul_f32 v225, v161, v225
v_mul_f32 v226, v162, v226
v_mul_f32 v227, v163, v227
v_fma_f32 v80, v80, v44, v44
v_fma_f32 v81, v81, v44, v44
v_fma_f32 v82, v82, v44, v44
v_fma_f32 v83, v83, v44, v44
v_rcp_f32 v80, v80
v_rcp_f32 v81, v81
v_rcp_f32 v82, v82
v_rcp_f32 v83, v83
v_mul_f32 v224, v224, v80
v_mul_f32 v225, v225, v81
v_mul_f32 v226, v226, v82
v_mul_f32 v227, v227, v83
v_cvt_pk_bf16_f32 v96, v224, v225
v_cvt_pk_bf16_f32 v97, v226, v227
v_fma_f32 v176, -v32, v60, v176
v_fma_f32 v177, -v32, v61, v177
v_fma_f32 v178, -v32, v62, v178
v_fma_f32 v179, -v32, v63, v179
v_fma_f32 v240, -v32, v76, v240
v_fma_f32 v241, -v32, v77, v241
v_lshlrev_b32 v19, 11, v18
v_lshl_add_u32 v19, v17, 4, v19
s_lshl_b32 s43, s36, 9
v_add_u32 v208, s43, v19
buffer_load_dwordx4 v[192:195], v208, s[20:23], 0 offen offset:0 sc1
buffer_load_dwordx4 v[196:199], v208, s[20:23], s50 offen offset:0 sc1
buffer_load_dwordx4 v[200:203], v208, s[20:23], 0 offen offset:256 sc1
buffer_load_dwordx4 v[204:207], v208, s[20:23], s50 offen offset:256 sc1
s_waitcnt vmcnt(4)
s_barrier
s_add_u32 s43, s34, 32
s_lshl_b32 s43, s43, 7
v_mov_b32 v21, s43
v_mov_b32 v22, 1
s_mov_b64 exec, 1
buffer_atomic_add v22, v21, s[56:59], 0 offen sc1
s_mov_b64 exec, -1
v_fma_f32 v242, -v32, v78, v242
v_fma_f32 v243, -v32, v79, v243
v_mul_f32 v84, v176, v176
v_mul_f32 v85, v177, v177
v_mul_f32 v86, v178, v178
v_mul_f32 v87, v179, v179
v_fma_f32 v84, v84, v40, v36
v_fma_f32 v85, v85, v40, v36
v_fma_f32 v86, v86, v40, v36
v_fma_f32 v87, v87, v40, v36
v_mul_f32 v84, v84, v176
v_mul_f32 v85, v85, v177
v_mul_f32 v86, v86, v178
v_mul_f32 v87, v87, v179
v_exp_f32 v84, v84
v_exp_f32 v85, v85
v_exp_f32 v86, v86
v_exp_f32 v87, v87
v_mul_f32 v240, v176, v240
v_mul_f32 v241, v177, v241
v_mul_f32 v242, v178, v242
v_mul_f32 v243, v179, v243
v_fma_f32 v84, v84, v44, v44
v_fma_f32 v85, v85, v44, v44
v_fma_f32 v86, v86, v44, v44
v_fma_f32 v87, v87, v44, v44
v_rcp_f32 v84, v84
v_rcp_f32 v85, v85
v_rcp_f32 v86, v86
v_rcp_f32 v87, v87
v_mul_f32 v240, v240, v84
v_mul_f32 v241, v241, v85
v_mul_f32 v242, v242, v86
v_mul_f32 v243, v243, v87
v_cvt_pk_bf16_f32 v98, v240, v241
v_cvt_pk_bf16_f32 v99, v242, v243
buffer_store_dwordx4 v[96:99], v27, s[24:27], s53 offen offset:0 sc1
v_fma_f32 v164, -v33, v56, v164
v_fma_f32 v165, -v33, v57, v165
v_fma_f32 v166, -v33, v58, v166
v_fma_f32 v167, -v33, v59, v167
v_fma_f32 v228, -v33, v72, v228
v_fma_f32 v229, -v33, v73, v229
v_fma_f32 v230, -v33, v74, v230
v_fma_f32 v231, -v33, v75, v231
v_mul_f32 v80, v164, v164
v_mul_f32 v81, v165, v165
v_mul_f32 v82, v166, v166
v_mul_f32 v83, v167, v167
s_barrier
s_mov_b32 s80, s60
s_mov_b32 s81, s61
s_mov_b32 s82, 7340032
s_mov_b32 s83, 0x20000
v_and_b32 v29, 31, v1
v_lshlrev_b32 v29, 11, v29
s_and_b32 s43, s35, 8
s_or_b32 s43, s43, 3
s_lshl_b32 s43, s43, 7
v_add_u32 v29, s43, v29
s_lshr_b32 s44, s2, 3
s_lshl_b32 s44, s44, 17
s_add_u32 s43, s44, 0
buffer_load_dword v30, v29, s[80:83], s43 offen
v_fma_f32 v80, v80, v41, v37
v_fma_f32 v81, v81, v41, v37
v_fma_f32 v82, v82, v41, v37
v_fma_f32 v83, v83, v41, v37
v_mul_f32 v80, v80, v164
v_mul_f32 v81, v81, v165
v_mul_f32 v82, v82, v166
v_mul_f32 v83, v83, v167
v_exp_f32 v80, v80
v_exp_f32 v81, v81
v_exp_f32 v82, v82
v_exp_f32 v83, v83
v_mul_f32 v228, v164, v228
v_mul_f32 v229, v165, v229
v_mul_f32 v230, v166, v230
v_mul_f32 v231, v167, v231
v_fma_f32 v80, v80, v45, v45
v_fma_f32 v81, v81, v45, v45
v_fma_f32 v82, v82, v45, v45
v_fma_f32 v83, v83, v45, v45
v_rcp_f32 v80, v80
v_rcp_f32 v81, v81
v_rcp_f32 v82, v82
v_rcp_f32 v83, v83
v_mul_f32 v228, v228, v80
v_mul_f32 v229, v229, v81
v_mul_f32 v230, v230, v82
v_mul_f32 v231, v231, v83
v_cvt_pk_bf16_f32 v100, v228, v229
v_cvt_pk_bf16_f32 v101, v230, v231
v_fma_f32 v180, -v33, v60, v180
v_fma_f32 v181, -v33, v61, v181
v_fma_f32 v182, -v33, v62, v182
v_fma_f32 v183, -v33, v63, v183
v_fma_f32 v244, -v33, v76, v244
v_fma_f32 v245, -v33, v77, v245
v_fma_f32 v246, -v33, v78, v246
v_fma_f32 v247, -v33, v79, v247
v_mul_f32 v84, v180, v180
v_mul_f32 v85, v181, v181
v_mul_f32 v86, v182, v182
v_mul_f32 v87, v183, v183
v_fma_f32 v84, v84, v41, v37
v_fma_f32 v85, v85, v41, v37
v_fma_f32 v86, v86, v41, v37
v_fma_f32 v87, v87, v41, v37
v_mul_f32 v84, v84, v180
v_mul_f32 v85, v85, v181
s_waitcnt vmcnt(1)
s_barrier
v_mul_f32 v86, v86, v182
v_mul_f32 v87, v87, v183
v_exp_f32 v84, v84
v_exp_f32 v85, v85
v_exp_f32 v86, v86
v_exp_f32 v87, v87
v_mul_f32 v244, v180, v244
v_mul_f32 v245, v181, v245
v_mul_f32 v246, v182, v246
v_mul_f32 v247, v183, v247
v_fma_f32 v84, v84, v45, v45
v_fma_f32 v85, v85, v45, v45
v_fma_f32 v86, v86, v45, v45
v_fma_f32 v87, v87, v45, v45
v_rcp_f32 v84, v84
v_rcp_f32 v85, v85
v_rcp_f32 v86, v86
v_rcp_f32 v87, v87
v_mul_f32 v244, v244, v84
v_mul_f32 v245, v245, v85
v_mul_f32 v246, v246, v86
v_mul_f32 v247, v247, v87
v_cvt_pk_bf16_f32 v102, v244, v245
v_cvt_pk_bf16_f32 v103, v246, v247
buffer_store_dwordx4 v[100:103], v27, s[24:27], s53 offen offset:256 sc1
v_fma_f32 v168, -v34, v56, v168
v_fma_f32 v169, -v34, v57, v169
v_fma_f32 v170, -v34, v58, v170
v_fma_f32 v171, -v34, v59, v171
v_fma_f32 v232, -v34, v72, v232
v_fma_f32 v233, -v34, v73, v233
v_fma_f32 v234, -v34, v74, v234
v_fma_f32 v235, -v34, v75, v235
v_mul_f32 v80, v168, v168
v_mul_f32 v81, v169, v169
v_mul_f32 v82, v170, v170
v_mul_f32 v83, v171, v171
v_fma_f32 v80, v80, v42, v38
v_fma_f32 v81, v81, v42, v38
v_fma_f32 v82, v82, v42, v38
v_fma_f32 v83, v83, v42, v38
v_mul_f32 v80, v80, v168
v_mul_f32 v81, v81, v169
v_mul_f32 v82, v82, v170
v_mul_f32 v83, v83, v171
v_exp_f32 v80, v80
v_exp_f32 v81, v81
v_exp_f32 v82, v82
v_exp_f32 v83, v83
v_lshlrev_b32 v128, 16, v192
v_and_b32 v129, 0xffff0000, v192
v_lshlrev_b32 v130, 16, v193
v_and_b32 v131, 0xffff0000, v193
v_lshlrev_b32 v132, 16, v194
v_and_b32 v133, 0xffff0000, v194
v_lshlrev_b32 v134, 16, v195
v_and_b32 v135, 0xffff0000, v195
v_lshlrev_b32 v136, 16, v196
v_and_b32 v137, 0xffff0000, v196
v_lshlrev_b32 v138, 16, v197
v_and_b32 v139, 0xffff0000, v197
v_lshlrev_b32 v140, 16, v198
v_and_b32 v141, 0xffff0000, v198
v_lshlrev_b32 v142, 16, v199
v_and_b32 v143, 0xffff0000, v199
s_barrier
v_mul_f32 v232, v168, v232
v_mul_f32 v233, v169, v233
v_mul_f32 v234, v170, v234
v_mul_f32 v235, v171, v235
v_fma_f32 v80, v80, v46, v46
v_fma_f32 v81, v81, v46, v46
v_fma_f32 v82, v82, v46, v46
v_fma_f32 v83, v83, v46, v46
v_rcp_f32 v80, v80
v_rcp_f32 v81, v81
v_rcp_f32 v82, v82
v_rcp_f32 v83, v83
v_mul_f32 v232, v232, v80
v_mul_f32 v233, v233, v81
v_mul_f32 v234, v234, v82
v_mul_f32 v235, v235, v83
v_cvt_pk_bf16_f32 v104, v232, v233
v_cvt_pk_bf16_f32 v105, v234, v235
v_fma_f32 v184, -v34, v60, v184
v_fma_f32 v185, -v34, v61, v185
v_fma_f32 v186, -v34, v62, v186
v_fma_f32 v187, -v34, v63, v187
v_fma_f32 v248, -v34, v76, v248
v_fma_f32 v249, -v34, v77, v249
v_fma_f32 v250, -v34, v78, v250
v_fma_f32 v251, -v34, v79, v251
v_mul_f32 v84, v184, v184
v_mul_f32 v85, v185, v185
v_mul_f32 v86, v186, v186
v_mul_f32 v87, v187, v187
v_fma_f32 v84, v84, v42, v38
v_fma_f32 v85, v85, v42, v38
v_fma_f32 v86, v86, v42, v38
v_fma_f32 v87, v87, v42, v38
v_mul_f32 v84, v84, v184
v_mul_f32 v85, v85, v185
v_mul_f32 v86, v86, v186
v_mul_f32 v87, v87, v187
v_exp_f32 v84, v84
v_exp_f32 v85, v85
v_exp_f32 v86, v86
v_exp_f32 v87, v87
v_mul_f32 v248, v184, v248
v_mul_f32 v249, v185, v249
v_mul_f32 v250, v186, v250
v_mul_f32 v251, v187, v251
v_fma_f32 v84, v84, v46, v46
v_fma_f32 v85, v85, v46, v46
v_lshlrev_b32 v144, 16, v200
v_and_b32 v145, 0xffff0000, v200
v_lshlrev_b32 v146, 16, v201
v_and_b32 v147, 0xffff0000, v201
v_lshlrev_b32 v148, 16, v202
v_and_b32 v149, 0xffff0000, v202
v_lshlrev_b32 v150, 16, v203
v_and_b32 v151, 0xffff0000, v203
v_lshlrev_b32 v152, 16, v204
v_and_b32 v153, 0xffff0000, v204
v_lshlrev_b32 v154, 16, v205
v_and_b32 v155, 0xffff0000, v205
v_lshlrev_b32 v156, 16, v206
v_and_b32 v157, 0xffff0000, v206
v_lshlrev_b32 v158, 16, v207
v_and_b32 v159, 0xffff0000, v207
s_barrier
s_add_u32 s43, s34, 32
s_lshl_b32 s43, s43, 7
v_mov_b32 v21, s43
v_mov_b32 v23, 16
buffer_load_dword v22, v21, s[56:59], 0 offen sc1
v_fma_f32 v86, v86, v46, v46
v_fma_f32 v87, v87, v46, v46
v_rcp_f32 v84, v84
v_rcp_f32 v85, v85
v_rcp_f32 v86, v86
v_rcp_f32 v87, v87
v_mul_f32 v248, v248, v84
v_mul_f32 v249, v249, v85
v_mul_f32 v250, v250, v86
v_mul_f32 v251, v251, v87
v_cvt_pk_bf16_f32 v106, v248, v249
v_cvt_pk_bf16_f32 v107, v250, v251
buffer_store_dwordx4 v[104:107], v27, s[24:27], s53 offen offset:512 sc1
v_fma_f32 v172, -v35, v56, v172
v_fma_f32 v173, -v35, v57, v173
v_fma_f32 v174, -v35, v58, v174
v_fma_f32 v175, -v35, v59, v175
v_fma_f32 v236, -v35, v72, v236
v_fma_f32 v237, -v35, v73, v237
v_fma_f32 v238, -v35, v74, v238
v_fma_f32 v239, -v35, v75, v239
v_mul_f32 v80, v172, v172
v_mul_f32 v81, v173, v173
v_mul_f32 v82, v174, v174
v_mul_f32 v83, v175, v175
v_fma_f32 v80, v80, v43, v39
v_fma_f32 v81, v81, v43, v39
v_fma_f32 v82, v82, v43, v39
v_fma_f32 v83, v83, v43, v39
v_mul_f32 v80, v80, v172
v_mul_f32 v81, v81, v173
v_mul_f32 v82, v82, v174
v_mul_f32 v83, v83, v175
v_exp_f32 v80, v80
v_exp_f32 v81, v81
v_exp_f32 v82, v82
v_exp_f32 v83, v83
v_mul_f32 v236, v172, v236
v_mul_f32 v237, v173, v237
v_mul_f32 v238, v174, v238
v_mul_f32 v239, v175, v239
v_fma_f32 v80, v80, v47, v47
v_fma_f32 v81, v81, v47, v47
v_fma_f32 v82, v82, v47, v47
v_fma_f32 v83, v83, v47, v47
v_rcp_f32 v80, v80
v_rcp_f32 v81, v81
v_rcp_f32 v82, v82
v_rcp_f32 v83, v83
s_mov_b32 s41, 0x10000
Lpoll_24:
s_waitcnt vmcnt(0)
v_cmp_ne_u32 vcc, v23, v22
s_nop 4
s_cbranch_vccz Lpok_25
buffer_load_dword v22, v21, s[56:59], 0 offen sc1
s_sub_u32 s41, s41, 1
s_cmp_lg_u32 s41, 0
s_cbranch_scc1 Lpoll_24
s_waitcnt vmcnt(0)
Lpok_25:
s_barrier
v_mul_f32 v236, v236, v80
v_mul_f32 v237, v237, v81
v_mul_f32 v238, v238, v82
v_mul_f32 v239, v239, v83
v_cvt_pk_bf16_f32 v108, v236, v237
v_cvt_pk_bf16_f32 v109, v238, v239
v_fma_f32 v188, -v35, v60, v188
v_fma_f32 v189, -v35, v61, v189
v_fma_f32 v190, -v35, v62, v190
v_fma_f32 v191, -v35, v63, v191
v_fma_f32 v252, -v35, v76, v252
v_fma_f32 v253, -v35, v77, v253
v_fma_f32 v254, -v35, v78, v254
v_fma_f32 v255, -v35, v79, v255
v_mul_f32 v84, v188, v188
v_mul_f32 v85, v189, v189
v_mul_f32 v86, v190, v190
v_mul_f32 v87, v191, v191
v_fma_f32 v84, v84, v43, v39
v_fma_f32 v85, v85, v43, v39
v_fma_f32 v86, v86, v43, v39
v_fma_f32 v87, v87, v43, v39
v_mul_f32 v84, v84, v188
v_mul_f32 v85, v85, v189
v_mul_f32 v86, v86, v190
v_mul_f32 v87, v87, v191
v_exp_f32 v84, v84
v_exp_f32 v85, v85
v_exp_f32 v86, v86
v_exp_f32 v87, v87
v_mul_f32 v252, v188, v252
v_mul_f32 v253, v189, v253
v_mul_f32 v254, v190, v254
v_mul_f32 v255, v191, v255
v_fma_f32 v84, v84, v47, v47
v_fma_f32 v85, v85, v47, v47
v_fma_f32 v86, v86, v47, v47
v_fma_f32 v87, v87, v47, v47
v_rcp_f32 v84, v84
v_rcp_f32 v85, v85
v_rcp_f32 v86, v86
v_rcp_f32 v87, v87
v_mul_f32 v252, v252, v84
v_mul_f32 v253, v253, v85
v_mul_f32 v254, v254, v86
v_mul_f32 v255, v255, v87
v_cvt_pk_bf16_f32 v110, v252, v253
v_cvt_pk_bf16_f32 v111, v254, v255
buffer_store_dwordx4 v[108:111], v27, s[24:27], s53 offen offset:768 sc1
s_barrier
s_waitcnt vmcnt(0)
s_barrier
LK4_23:
s_setprio 1
ds_read_b128 v[32:35], v3 offset:0
ds_read_b64_tr_b16 v[48:49], v9 offset:0
ds_read_b64_tr_b16 v[50:51], v9 offset:2048
ds_read_b64_tr_b16 v[52:53], v10 offset:0
ds_read_b64_tr_b16 v[54:55], v10 offset:2048
ds_read_b128 v[36:39], v3 offset:256
ds_read_b64_tr_b16 v[56:57], v11 offset:0
ds_read_b64_tr_b16 v[58:59], v11 offset:2048
ds_read_b64_tr_b16 v[60:61], v12 offset:0
ds_read_b64_tr_b16 v[62:63], v12 offset:2048
ds_read_b128 v[40:43], v3 offset:8192
ds_read_b64_tr_b16 v[64:65], v9 offset:4096
ds_read_b64_tr_b16 v[66:67], v9 offset:6144
ds_read_b64_tr_b16 v[68:69], v10 offset:4096
ds_read_b64_tr_b16 v[70:71], v10 offset:6144
ds_read_b128 v[44:47], v3 offset:8448
ds_read_b64_tr_b16 v[72:73], v11 offset:4096
ds_read_b64_tr_b16 v[74:75], v11 offset:6144
ds_read_b64_tr_b16 v[76:77], v12 offset:4096
ds_read_b64_tr_b16 v[78:79], v12 offset:6144
s_waitcnt lgkmcnt(0)
s_barrier
v_mfma_f32_16x16x32_bf16 v[128:131], v[48:51], v[32:35], v[128:131]
ds_read_b128 v[80:83], v3 offset:24576
ds_read_b64_tr_b16 v[96:97], v9 offset:24576
v_mfma_f32_16x16x32_bf16 v[132:135], v[52:55], v[32:35], v[132:135]
ds_read_b64_tr_b16 v[98:99], v9 offset:26624
ds_read_b64_tr_b16 v[100:101], v10 offset:24576
v_mfma_f32_16x16x32_bf16 v[136:139], v[56:59], v[32:35], v[136:139]
ds_read_b64_tr_b16 v[102:103], v10 offset:26624
ds_read_b128 v[84:87], v3 offset:24832
v_mfma_f32_16x16x32_bf16 v[140:143], v[60:63], v[32:35], v[140:143]
ds_read_b64_tr_b16 v[104:105], v11 offset:24576
ds_read_b64_tr_b16 v[106:107], v11 offset:26624
v_mfma_f32_16x16x32_bf16 v[144:147], v[48:51], v[36:39], v[144:147]
ds_read_b64_tr_b16 v[108:109], v12 offset:24576
ds_read_b64_tr_b16 v[110:111], v12 offset:26624
v_mfma_f32_16x16x32_bf16 v[148:151], v[52:55], v[36:39], v[148:151]
ds_read_b128 v[88:91], v3 offset:32768
ds_read_b64_tr_b16 v[112:113], v9 offset:28672
v_mfma_f32_16x16x32_bf16 v[152:155], v[56:59], v[36:39], v[152:155]
ds_read_b64_tr_b16 v[114:115], v9 offset:30720
v_mfma_f32_16x16x32_bf16 v[156:159], v[60:63], v[36:39], v[156:159]
ds_read_b64_tr_b16 v[116:117], v10 offset:28672
v_mfma_f32_16x16x32_bf16 v[128:131], v[64:67], v[40:43], v[128:131]
ds_read_b64_tr_b16 v[118:119], v10 offset:30720
v_mfma_f32_16x16x32_bf16 v[132:135], v[68:71], v[40:43], v[132:135]
ds_read_b128 v[92:95], v3 offset:33024
v_mfma_f32_16x16x32_bf16 v[136:139], v[72:75], v[40:43], v[136:139]
ds_read_b64_tr_b16 v[120:121], v11 offset:28672
v_mfma_f32_16x16x32_bf16 v[140:143], v[76:79], v[40:43], v[140:143]
ds_read_b64_tr_b16 v[122:123], v11 offset:30720
v_mfma_f32_16x16x32_bf16 v[144:147], v[64:67], v[44:47], v[144:147]
ds_read_b64_tr_b16 v[124:125], v12 offset:28672
v_mfma_f32_16x16x32_bf16 v[148:151], v[68:71], v[44:47], v[148:151]
ds_read_b64_tr_b16 v[126:127], v12 offset:30720
v_mfma_f32_16x16x32_bf16 v[152:155], v[72:75], v[44:47], v[152:155]
v_mfma_f32_16x16x32_bf16 v[156:159], v[76:79], v[44:47], v[156:159]
s_waitcnt vmcnt(8) lgkmcnt(0)
s_barrier
v_mfma_f32_16x16x32_bf16 v[128:131], v[96:99], v[80:83], v[128:131]
ds_read_b128 v[32:35], v4 offset:0
ds_read_b64_tr_b16 v[48:49], v13 offset:0
v_mfma_f32_16x16x32_bf16 v[132:135], v[100:103], v[80:83], v[132:135]
ds_read_b64_tr_b16 v[50:51], v13 offset:2048
ds_read_b64_tr_b16 v[52:53], v14 offset:0
v_mfma_f32_16x16x32_bf16 v[136:139], v[104:107], v[80:83], v[136:139]
ds_read_b64_tr_b16 v[54:55], v14 offset:2048
ds_read_b128 v[36:39], v4 offset:256
v_mfma_f32_16x16x32_bf16 v[140:143], v[108:111], v[80:83], v[140:143]
ds_read_b64_tr_b16 v[56:57], v15 offset:0
ds_read_b64_tr_b16 v[58:59], v15 offset:2048
v_mfma_f32_16x16x32_bf16 v[144:147], v[96:99], v[84:87], v[144:147]
ds_read_b64_tr_b16 v[60:61], v16 offset:0
ds_read_b64_tr_b16 v[62:63], v16 offset:2048
v_mfma_f32_16x16x32_bf16 v[148:151], v[100:103], v[84:87], v[148:151]
ds_read_b128 v[40:43], v4 offset:8192
ds_read_b64_tr_b16 v[64:65], v13 offset:4096
v_mfma_f32_16x16x32_bf16 v[152:155], v[104:107], v[84:87], v[152:155]
ds_read_b64_tr_b16 v[66:67], v13 offset:6144
v_mfma_f32_16x16x32_bf16 v[156:159], v[108:111], v[84:87], v[156:159]
ds_read_b64_tr_b16 v[68:69], v14 offset:4096
v_mfma_f32_16x16x32_bf16 v[128:131], v[112:115], v[88:91], v[128:131]
ds_read_b64_tr_b16 v[70:71], v14 offset:6144
v_mfma_f32_16x16x32_bf16 v[132:135], v[116:119], v[88:91], v[132:135]
ds_read_b128 v[44:47], v4 offset:8448
v_mfma_f32_16x16x32_bf16 v[136:139], v[120:123], v[88:91], v[136:139]
ds_read_b64_tr_b16 v[72:73], v15 offset:4096
v_mfma_f32_16x16x32_bf16 v[140:143], v[124:127], v[88:91], v[140:143]
ds_read_b64_tr_b16 v[74:75], v15 offset:6144
v_mfma_f32_16x16x32_bf16 v[144:147], v[112:115], v[92:95], v[144:147]
ds_read_b64_tr_b16 v[76:77], v16 offset:4096
v_mfma_f32_16x16x32_bf16 v[148:151], v[116:119], v[92:95], v[148:151]
ds_read_b64_tr_b16 v[78:79], v16 offset:6144
v_mfma_f32_16x16x32_bf16 v[152:155], v[120:123], v[92:95], v[152:155]
v_mfma_f32_16x16x32_bf16 v[156:159], v[124:127], v[92:95], v[156:159]
s_waitcnt vmcnt(0) lgkmcnt(0)
s_barrier
v_mfma_f32_16x16x32_bf16 v[128:131], v[48:51], v[32:35], v[128:131]
ds_read_b128 v[80:83], v4 offset:24576
ds_read_b64_tr_b16 v[96:97], v13 offset:24576
v_mfma_f32_16x16x32_bf16 v[132:135], v[52:55], v[32:35], v[132:135]
ds_read_b64_tr_b16 v[98:99], v13 offset:26624
ds_read_b64_tr_b16 v[100:101], v14 offset:24576
v_mfma_f32_16x16x32_bf16 v[136:139], v[56:59], v[32:35], v[136:139]
ds_read_b64_tr_b16 v[102:103], v14 offset:26624
ds_read_b128 v[84:87], v4 offset:24832
v_mfma_f32_16x16x32_bf16 v[140:143], v[60:63], v[32:35], v[140:143]
ds_read_b64_tr_b16 v[104:105], v15 offset:24576
ds_read_b64_tr_b16 v[106:107], v15 offset:26624
v_mfma_f32_16x16x32_bf16 v[144:147], v[48:51], v[36:39], v[144:147]
ds_read_b64_tr_b16 v[108:109], v16 offset:24576
ds_read_b64_tr_b16 v[110:111], v16 offset:26624
v_mfma_f32_16x16x32_bf16 v[148:151], v[52:55], v[36:39], v[148:151]
ds_read_b128 v[88:91], v4 offset:32768
ds_read_b64_tr_b16 v[112:113], v13 offset:28672
v_mfma_f32_16x16x32_bf16 v[152:155], v[56:59], v[36:39], v[152:155]
ds_read_b64_tr_b16 v[114:115], v13 offset:30720
v_mfma_f32_16x16x32_bf16 v[156:159], v[60:63], v[36:39], v[156:159]
ds_read_b64_tr_b16 v[116:117], v14 offset:28672
v_mfma_f32_16x16x32_bf16 v[128:131], v[64:67], v[40:43], v[128:131]
ds_read_b64_tr_b16 v[118:119], v14 offset:30720
v_mfma_f32_16x16x32_bf16 v[132:135], v[68:71], v[40:43], v[132:135]
ds_read_b128 v[92:95], v4 offset:33024
v_mfma_f32_16x16x32_bf16 v[136:139], v[72:75], v[40:43], v[136:139]
ds_read_b64_tr_b16 v[120:121], v15 offset:28672
v_mfma_f32_16x16x32_bf16 v[140:143], v[76:79], v[40:43], v[140:143]
ds_read_b64_tr_b16 v[122:123], v15 offset:30720
v_mfma_f32_16x16x32_bf16 v[144:147], v[64:67], v[44:47], v[144:147]
ds_read_b64_tr_b16 v[124:125], v16 offset:28672
v_mfma_f32_16x16x32_bf16 v[148:151], v[68:71], v[44:47], v[148:151]
ds_read_b64_tr_b16 v[126:127], v16 offset:30720
v_mfma_f32_16x16x32_bf16 v[152:155], v[72:75], v[44:47], v[152:155]
v_mfma_f32_16x16x32_bf16 v[156:159], v[76:79], v[44:47], v[156:159]
s_mov_b32 s41, 8
Lg2_26:
s_waitcnt lgkmcnt(0)
s_barrier
v_mfma_f32_16x16x32_bf16 v[128:131], v[96:99], v[80:83], v[128:131]
ds_read_b128 v[32:35], v2 offset:0
ds_read_b64_tr_b16 v[48:49], v5 offset:0
v_mfma_f32_16x16x32_bf16 v[132:135], v[100:103], v[80:83], v[132:135]
ds_read_b64_tr_b16 v[50:51], v5 offset:2048
ds_read_b64_tr_b16 v[52:53], v6 offset:0
v_mfma_f32_16x16x32_bf16 v[136:139], v[104:107], v[80:83], v[136:139]
ds_read_b64_tr_b16 v[54:55], v6 offset:2048
ds_read_b128 v[36:39], v2 offset:256
v_mfma_f32_16x16x32_bf16 v[140:143], v[108:111], v[80:83], v[140:143]
ds_read_b64_tr_b16 v[56:57], v7 offset:0
ds_read_b64_tr_b16 v[58:59], v7 offset:2048
v_mfma_f32_16x16x32_bf16 v[144:147], v[96:99], v[84:87], v[144:147]
ds_read_b64_tr_b16 v[60:61], v8 offset:0
ds_read_b64_tr_b16 v[62:63], v8 offset:2048
v_mfma_f32_16x16x32_bf16 v[148:151], v[100:103], v[84:87], v[148:151]
ds_read_b128 v[40:43], v2 offset:8192
ds_read_b64_tr_b16 v[64:65], v5 offset:4096
v_mfma_f32_16x16x32_bf16 v[152:155], v[104:107], v[84:87], v[152:155]
ds_read_b64_tr_b16 v[66:67], v5 offset:6144
v_mfma_f32_16x16x32_bf16 v[156:159], v[108:111], v[84:87], v[156:159]
ds_read_b64_tr_b16 v[68:69], v6 offset:4096
v_mfma_f32_16x16x32_bf16 v[128:131], v[112:115], v[88:91], v[128:131]
ds_read_b64_tr_b16 v[70:71], v6 offset:6144
v_mfma_f32_16x16x32_bf16 v[132:135], v[116:119], v[88:91], v[132:135]
ds_read_b128 v[44:47], v2 offset:8448
v_mfma_f32_16x16x32_bf16 v[136:139], v[120:123], v[88:91], v[136:139]
ds_read_b64_tr_b16 v[72:73], v7 offset:4096
v_mfma_f32_16x16x32_bf16 v[140:143], v[124:127], v[88:91], v[140:143]
ds_read_b64_tr_b16 v[74:75], v7 offset:6144
v_mfma_f32_16x16x32_bf16 v[144:147], v[112:115], v[92:95], v[144:147]
ds_read_b64_tr_b16 v[76:77], v8 offset:4096
v_mfma_f32_16x16x32_bf16 v[148:151], v[116:119], v[92:95], v[148:151]
ds_read_b64_tr_b16 v[78:79], v8 offset:6144
v_mfma_f32_16x16x32_bf16 v[152:155], v[120:123], v[92:95], v[152:155]
v_mfma_f32_16x16x32_bf16 v[156:159], v[124:127], v[92:95], v[156:159]
s_waitcnt lgkmcnt(0)
s_barrier
v_mfma_f32_16x16x32_bf16 v[128:131], v[48:51], v[32:35], v[128:131]
ds_read_b128 v[80:83], v2 offset:24576
ds_read_b64_tr_b16 v[96:97], v5 offset:24576
v_mfma_f32_16x16x32_bf16 v[132:135], v[52:55], v[32:35], v[132:135]
ds_read_b64_tr_b16 v[98:99], v5 offset:26624
ds_read_b64_tr_b16 v[100:101], v6 offset:24576
v_mfma_f32_16x16x32_bf16 v[136:139], v[56:59], v[32:35], v[136:139]
ds_read_b64_tr_b16 v[102:103], v6 offset:26624
ds_read_b128 v[84:87], v2 offset:24832
v_mfma_f32_16x16x32_bf16 v[140:143], v[60:63], v[32:35], v[140:143]
ds_read_b64_tr_b16 v[104:105], v7 offset:24576
ds_read_b64_tr_b16 v[106:107], v7 offset:26624
v_mfma_f32_16x16x32_bf16 v[144:147], v[48:51], v[36:39], v[144:147]
ds_read_b64_tr_b16 v[108:109], v8 offset:24576
ds_read_b64_tr_b16 v[110:111], v8 offset:26624
v_mfma_f32_16x16x32_bf16 v[148:151], v[52:55], v[36:39], v[148:151]
ds_read_b128 v[88:91], v2 offset:32768
ds_read_b64_tr_b16 v[112:113], v5 offset:28672
v_mfma_f32_16x16x32_bf16 v[152:155], v[56:59], v[36:39], v[152:155]
ds_read_b64_tr_b16 v[114:115], v5 offset:30720
v_mfma_f32_16x16x32_bf16 v[156:159], v[60:63], v[36:39], v[156:159]
ds_read_b64_tr_b16 v[116:117], v6 offset:28672
v_mfma_f32_16x16x32_bf16 v[128:131], v[64:67], v[40:43], v[128:131]
ds_read_b64_tr_b16 v[118:119], v6 offset:30720
v_mfma_f32_16x16x32_bf16 v[132:135], v[68:71], v[40:43], v[132:135]
ds_read_b128 v[92:95], v2 offset:33024
v_mfma_f32_16x16x32_bf16 v[136:139], v[72:75], v[40:43], v[136:139]
ds_read_b64_tr_b16 v[120:121], v7 offset:28672
v_mfma_f32_16x16x32_bf16 v[140:143], v[76:79], v[40:43], v[140:143]
ds_read_b64_tr_b16 v[122:123], v7 offset:30720
v_mfma_f32_16x16x32_bf16 v[144:147], v[64:67], v[44:47], v[144:147]
ds_read_b64_tr_b16 v[124:125], v8 offset:28672
v_mfma_f32_16x16x32_bf16 v[148:151], v[68:71], v[44:47], v[148:151]
ds_read_b64_tr_b16 v[126:127], v8 offset:30720
v_mfma_f32_16x16x32_bf16 v[152:155], v[72:75], v[44:47], v[152:155]
v_mfma_f32_16x16x32_bf16 v[156:159], v[76:79], v[44:47], v[156:159]
s_waitcnt lgkmcnt(0)
s_barrier
v_mfma_f32_16x16x32_bf16 v[128:131], v[96:99], v[80:83], v[128:131]
ds_read_b128 v[32:35], v3 offset:0
ds_read_b64_tr_b16 v[48:49], v9 offset:0
v_mfma_f32_16x16x32_bf16 v[132:135], v[100:103], v[80:83], v[132:135]
ds_read_b64_tr_b16 v[50:51], v9 offset:2048
ds_read_b64_tr_b16 v[52:53], v10 offset:0
v_mfma_f32_16x16x32_bf16 v[136:139], v[104:107], v[80:83], v[136:139]
ds_read_b64_tr_b16 v[54:55], v10 offset:2048
ds_read_b128 v[36:39], v3 offset:256
v_mfma_f32_16x16x32_bf16 v[140:143], v[108:111], v[80:83], v[140:143]
ds_read_b64_tr_b16 v[56:57], v11 offset:0
ds_read_b64_tr_b16 v[58:59], v11 offset:2048
v_mfma_f32_16x16x32_bf16 v[144:147], v[96:99], v[84:87], v[144:147]
ds_read_b64_tr_b16 v[60:61], v12 offset:0
ds_read_b64_tr_b16 v[62:63], v12 offset:2048
v_mfma_f32_16x16x32_bf16 v[148:151], v[100:103], v[84:87], v[148:151]
ds_read_b128 v[40:43], v3 offset:8192
ds_read_b64_tr_b16 v[64:65], v9 offset:4096
v_mfma_f32_16x16x32_bf16 v[152:155], v[104:107], v[84:87], v[152:155]
ds_read_b64_tr_b16 v[66:67], v9 offset:6144
v_mfma_f32_16x16x32_bf16 v[156:159], v[108:111], v[84:87], v[156:159]
ds_read_b64_tr_b16 v[68:69], v10 offset:4096
v_mfma_f32_16x16x32_bf16 v[128:131], v[112:115], v[88:91], v[128:131]
ds_read_b64_tr_b16 v[70:71], v10 offset:6144
v_mfma_f32_16x16x32_bf16 v[132:135], v[116:119], v[88:91], v[132:135]
ds_read_b128 v[44:47], v3 offset:8448
v_mfma_f32_16x16x32_bf16 v[136:139], v[120:123], v[88:91], v[136:139]
ds_read_b64_tr_b16 v[72:73], v11 offset:4096
v_mfma_f32_16x16x32_bf16 v[140:143], v[124:127], v[88:91], v[140:143]
ds_read_b64_tr_b16 v[74:75], v11 offset:6144
v_mfma_f32_16x16x32_bf16 v[144:147], v[112:115], v[92:95], v[144:147]
ds_read_b64_tr_b16 v[76:77], v12 offset:4096
v_mfma_f32_16x16x32_bf16 v[148:151], v[116:119], v[92:95], v[148:151]
ds_read_b64_tr_b16 v[78:79], v12 offset:6144
v_mfma_f32_16x16x32_bf16 v[152:155], v[120:123], v[92:95], v[152:155]
v_mfma_f32_16x16x32_bf16 v[156:159], v[124:127], v[92:95], v[156:159]
s_waitcnt lgkmcnt(0)
s_barrier
v_mfma_f32_16x16x32_bf16 v[128:131], v[48:51], v[32:35], v[128:131]
ds_read_b128 v[80:83], v3 offset:24576
ds_read_b64_tr_b16 v[96:97], v9 offset:24576
v_mfma_f32_16x16x32_bf16 v[132:135], v[52:55], v[32:35], v[132:135]
ds_read_b64_tr_b16 v[98:99], v9 offset:26624
ds_read_b64_tr_b16 v[100:101], v10 offset:24576
v_mfma_f32_16x16x32_bf16 v[136:139], v[56:59], v[32:35], v[136:139]
ds_read_b64_tr_b16 v[102:103], v10 offset:26624
ds_read_b128 v[84:87], v3 offset:24832
v_mfma_f32_16x16x32_bf16 v[140:143], v[60:63], v[32:35], v[140:143]
ds_read_b64_tr_b16 v[104:105], v11 offset:24576
ds_read_b64_tr_b16 v[106:107], v11 offset:26624
v_mfma_f32_16x16x32_bf16 v[144:147], v[48:51], v[36:39], v[144:147]
ds_read_b64_tr_b16 v[108:109], v12 offset:24576
ds_read_b64_tr_b16 v[110:111], v12 offset:26624
v_mfma_f32_16x16x32_bf16 v[148:151], v[52:55], v[36:39], v[148:151]
ds_read_b128 v[88:91], v3 offset:32768
ds_read_b64_tr_b16 v[112:113], v9 offset:28672
v_mfma_f32_16x16x32_bf16 v[152:155], v[56:59], v[36:39], v[152:155]
ds_read_b64_tr_b16 v[114:115], v9 offset:30720
v_mfma_f32_16x16x32_bf16 v[156:159], v[60:63], v[36:39], v[156:159]
ds_read_b64_tr_b16 v[116:117], v10 offset:28672
v_mfma_f32_16x16x32_bf16 v[128:131], v[64:67], v[40:43], v[128:131]
ds_read_b64_tr_b16 v[118:119], v10 offset:30720
v_mfma_f32_16x16x32_bf16 v[132:135], v[68:71], v[40:43], v[132:135]
ds_read_b128 v[92:95], v3 offset:33024
v_mfma_f32_16x16x32_bf16 v[136:139], v[72:75], v[40:43], v[136:139]
ds_read_b64_tr_b16 v[120:121], v11 offset:28672
v_mfma_f32_16x16x32_bf16 v[140:143], v[76:79], v[40:43], v[140:143]
ds_read_b64_tr_b16 v[122:123], v11 offset:30720
v_mfma_f32_16x16x32_bf16 v[144:147], v[64:67], v[44:47], v[144:147]
ds_read_b64_tr_b16 v[124:125], v12 offset:28672
v_mfma_f32_16x16x32_bf16 v[148:151], v[68:71], v[44:47], v[148:151]
ds_read_b64_tr_b16 v[126:127], v12 offset:30720
v_mfma_f32_16x16x32_bf16 v[152:155], v[72:75], v[44:47], v[152:155]
v_mfma_f32_16x16x32_bf16 v[156:159], v[76:79], v[44:47], v[156:159]
s_waitcnt lgkmcnt(0)
s_barrier
v_mfma_f32_16x16x32_bf16 v[128:131], v[96:99], v[80:83], v[128:131]
ds_read_b128 v[32:35], v4 offset:0
ds_read_b64_tr_b16 v[48:49], v13 offset:0
v_mfma_f32_16x16x32_bf16 v[132:135], v[100:103], v[80:83], v[132:135]
ds_read_b64_tr_b16 v[50:51], v13 offset:2048
ds_read_b64_tr_b16 v[52:53], v14 offset:0
v_mfma_f32_16x16x32_bf16 v[136:139], v[104:107], v[80:83], v[136:139]
ds_read_b64_tr_b16 v[54:55], v14 offset:2048
ds_read_b128 v[36:39], v4 offset:256
v_mfma_f32_16x16x32_bf16 v[140:143], v[108:111], v[80:83], v[140:143]
ds_read_b64_tr_b16 v[56:57], v15 offset:0
ds_read_b64_tr_b16 v[58:59], v15 offset:2048
v_mfma_f32_16x16x32_bf16 v[144:147], v[96:99], v[84:87], v[144:147]
ds_read_b64_tr_b16 v[60:61], v16 offset:0
ds_read_b64_tr_b16 v[62:63], v16 offset:2048
v_mfma_f32_16x16x32_bf16 v[148:151], v[100:103], v[84:87], v[148:151]
ds_read_b128 v[40:43], v4 offset:8192
ds_read_b64_tr_b16 v[64:65], v13 offset:4096
v_mfma_f32_16x16x32_bf16 v[152:155], v[104:107], v[84:87], v[152:155]
ds_read_b64_tr_b16 v[66:67], v13 offset:6144
v_mfma_f32_16x16x32_bf16 v[156:159], v[108:111], v[84:87], v[156:159]
ds_read_b64_tr_b16 v[68:69], v14 offset:4096
v_mfma_f32_16x16x32_bf16 v[128:131], v[112:115], v[88:91], v[128:131]
ds_read_b64_tr_b16 v[70:71], v14 offset:6144
v_mfma_f32_16x16x32_bf16 v[132:135], v[116:119], v[88:91], v[132:135]
ds_read_b128 v[44:47], v4 offset:8448
v_mfma_f32_16x16x32_bf16 v[136:139], v[120:123], v[88:91], v[136:139]
ds_read_b64_tr_b16 v[72:73], v15 offset:4096
v_mfma_f32_16x16x32_bf16 v[140:143], v[124:127], v[88:91], v[140:143]
ds_read_b64_tr_b16 v[74:75], v15 offset:6144
v_mfma_f32_16x16x32_bf16 v[144:147], v[112:115], v[92:95], v[144:147]
ds_read_b64_tr_b16 v[76:77], v16 offset:4096
v_mfma_f32_16x16x32_bf16 v[148:151], v[116:119], v[92:95], v[148:151]
ds_read_b64_tr_b16 v[78:79], v16 offset:6144
v_mfma_f32_16x16x32_bf16 v[152:155], v[120:123], v[92:95], v[152:155]
v_mfma_f32_16x16x32_bf16 v[156:159], v[124:127], v[92:95], v[156:159]
s_waitcnt lgkmcnt(0)
s_barrier
v_mfma_f32_16x16x32_bf16 v[128:131], v[48:51], v[32:35], v[128:131]
ds_read_b128 v[80:83], v4 offset:24576
ds_read_b64_tr_b16 v[96:97], v13 offset:24576
v_mfma_f32_16x16x32_bf16 v[132:135], v[52:55], v[32:35], v[132:135]
ds_read_b64_tr_b16 v[98:99], v13 offset:26624
ds_read_b64_tr_b16 v[100:101], v14 offset:24576
v_mfma_f32_16x16x32_bf16 v[136:139], v[56:59], v[32:35], v[136:139]
ds_read_b64_tr_b16 v[102:103], v14 offset:26624
ds_read_b128 v[84:87], v4 offset:24832
v_mfma_f32_16x16x32_bf16 v[140:143], v[60:63], v[32:35], v[140:143]
ds_read_b64_tr_b16 v[104:105], v15 offset:24576
ds_read_b64_tr_b16 v[106:107], v15 offset:26624
v_mfma_f32_16x16x32_bf16 v[144:147], v[48:51], v[36:39], v[144:147]
ds_read_b64_tr_b16 v[108:109], v16 offset:24576
ds_read_b64_tr_b16 v[110:111], v16 offset:26624
v_mfma_f32_16x16x32_bf16 v[148:151], v[52:55], v[36:39], v[148:151]
ds_read_b128 v[88:91], v4 offset:32768
ds_read_b64_tr_b16 v[112:113], v13 offset:28672
v_mfma_f32_16x16x32_bf16 v[152:155], v[56:59], v[36:39], v[152:155]
ds_read_b64_tr_b16 v[114:115], v13 offset:30720
v_mfma_f32_16x16x32_bf16 v[156:159], v[60:63], v[36:39], v[156:159]
ds_read_b64_tr_b16 v[116:117], v14 offset:28672
v_mfma_f32_16x16x32_bf16 v[128:131], v[64:67], v[40:43], v[128:131]
ds_read_b64_tr_b16 v[118:119], v14 offset:30720
v_mfma_f32_16x16x32_bf16 v[132:135], v[68:71], v[40:43], v[132:135]
ds_read_b128 v[92:95], v4 offset:33024
v_mfma_f32_16x16x32_bf16 v[136:139], v[72:75], v[40:43], v[136:139]
ds_read_b64_tr_b16 v[120:121], v15 offset:28672
v_mfma_f32_16x16x32_bf16 v[140:143], v[76:79], v[40:43], v[140:143]
ds_read_b64_tr_b16 v[122:123], v15 offset:30720
v_mfma_f32_16x16x32_bf16 v[144:147], v[64:67], v[44:47], v[144:147]
ds_read_b64_tr_b16 v[124:125], v16 offset:28672
v_mfma_f32_16x16x32_bf16 v[148:151], v[68:71], v[44:47], v[148:151]
ds_read_b64_tr_b16 v[126:127], v16 offset:30720
v_mfma_f32_16x16x32_bf16 v[152:155], v[72:75], v[44:47], v[152:155]
v_mfma_f32_16x16x32_bf16 v[156:159], v[76:79], v[44:47], v[156:159]
s_sub_u32 s41, s41, 1
s_cmp_lg_u32 s41, 0
s_cbranch_scc1 Lg2_26
s_waitcnt lgkmcnt(0)
s_barrier
v_mfma_f32_16x16x32_bf16 v[128:131], v[96:99], v[80:83], v[128:131]
ds_read_b128 v[32:35], v2 offset:0
ds_read_b64_tr_b16 v[48:49], v5 offset:0
v_mfma_f32_16x16x32_bf16 v[132:135], v[100:103], v[80:83], v[132:135]
ds_read_b64_tr_b16 v[50:51], v5 offset:2048
ds_read_b64_tr_b16 v[52:53], v6 offset:0
v_mfma_f32_16x16x32_bf16 v[136:139], v[104:107], v[80:83], v[136:139]
ds_read_b64_tr_b16 v[54:55], v6 offset:2048
ds_read_b128 v[36:39], v2 offset:256
v_mfma_f32_16x16x32_bf16 v[140:143], v[108:111], v[80:83], v[140:143]
ds_read_b64_tr_b16 v[56:57], v7 offset:0
ds_read_b64_tr_b16 v[58:59], v7 offset:2048
v_mfma_f32_16x16x32_bf16 v[144:147], v[96:99], v[84:87], v[144:147]
ds_read_b64_tr_b16 v[60:61], v8 offset:0
ds_read_b64_tr_b16 v[62:63], v8 offset:2048
v_mfma_f32_16x16x32_bf16 v[148:151], v[100:103], v[84:87], v[148:151]
ds_read_b128 v[40:43], v2 offset:8192
ds_read_b64_tr_b16 v[64:65], v5 offset:4096
v_mfma_f32_16x16x32_bf16 v[152:155], v[104:107], v[84:87], v[152:155]
ds_read_b64_tr_b16 v[66:67], v5 offset:6144
v_mfma_f32_16x16x32_bf16 v[156:159], v[108:111], v[84:87], v[156:159]
ds_read_b64_tr_b16 v[68:69], v6 offset:4096
v_mfma_f32_16x16x32_bf16 v[128:131], v[112:115], v[88:91], v[128:131]
ds_read_b64_tr_b16 v[70:71], v6 offset:6144
v_mfma_f32_16x16x32_bf16 v[132:135], v[116:119], v[88:91], v[132:135]
ds_read_b128 v[44:47], v2 offset:8448
v_mfma_f32_16x16x32_bf16 v[136:139], v[120:123], v[88:91], v[136:139]
ds_read_b64_tr_b16 v[72:73], v7 offset:4096
v_mfma_f32_16x16x32_bf16 v[140:143], v[124:127], v[88:91], v[140:143]
ds_read_b64_tr_b16 v[74:75], v7 offset:6144
v_mfma_f32_16x16x32_bf16 v[144:147], v[112:115], v[92:95], v[144:147]
ds_read_b64_tr_b16 v[76:77], v8 offset:4096
v_mfma_f32_16x16x32_bf16 v[148:151], v[116:119], v[92:95], v[148:151]
ds_read_b64_tr_b16 v[78:79], v8 offset:6144
v_mfma_f32_16x16x32_bf16 v[152:155], v[120:123], v[92:95], v[152:155]
v_mfma_f32_16x16x32_bf16 v[156:159], v[124:127], v[92:95], v[156:159]
s_waitcnt lgkmcnt(0)
s_barrier
v_mfma_f32_16x16x32_bf16 v[128:131], v[48:51], v[32:35], v[128:131]
ds_read_b128 v[80:83], v2 offset:24576
ds_read_b64_tr_b16 v[96:97], v5 offset:24576
v_mfma_f32_16x16x32_bf16 v[132:135], v[52:55], v[32:35], v[132:135]
ds_read_b64_tr_b16 v[98:99], v5 offset:26624
ds_read_b64_tr_b16 v[100:101], v6 offset:24576
v_mfma_f32_16x16x32_bf16 v[136:139], v[56:59], v[32:35], v[136:139]
ds_read_b64_tr_b16 v[102:103], v6 offset:26624
ds_read_b128 v[84:87], v2 offset:24832
v_mfma_f32_16x16x32_bf16 v[140:143], v[60:63], v[32:35], v[140:143]
ds_read_b64_tr_b16 v[104:105], v7 offset:24576
ds_read_b64_tr_b16 v[106:107], v7 offset:26624
v_mfma_f32_16x16x32_bf16 v[144:147], v[48:51], v[36:39], v[144:147]
ds_read_b64_tr_b16 v[108:109], v8 offset:24576
ds_read_b64_tr_b16 v[110:111], v8 offset:26624
v_mfma_f32_16x16x32_bf16 v[148:151], v[52:55], v[36:39], v[148:151]
ds_read_b128 v[88:91], v2 offset:32768
ds_read_b64_tr_b16 v[112:113], v5 offset:28672
v_mfma_f32_16x16x32_bf16 v[152:155], v[56:59], v[36:39], v[152:155]
ds_read_b64_tr_b16 v[114:115], v5 offset:30720
v_mfma_f32_16x16x32_bf16 v[156:159], v[60:63], v[36:39], v[156:159]
ds_read_b64_tr_b16 v[116:117], v6 offset:28672
v_mfma_f32_16x16x32_bf16 v[128:131], v[64:67], v[40:43], v[128:131]
ds_read_b64_tr_b16 v[118:119], v6 offset:30720
v_mfma_f32_16x16x32_bf16 v[132:135], v[68:71], v[40:43], v[132:135]
ds_read_b128 v[92:95], v2 offset:33024
v_mfma_f32_16x16x32_bf16 v[136:139], v[72:75], v[40:43], v[136:139]
ds_read_b64_tr_b16 v[120:121], v7 offset:28672
v_mfma_f32_16x16x32_bf16 v[140:143], v[76:79], v[40:43], v[140:143]
ds_read_b64_tr_b16 v[122:123], v7 offset:30720
v_mfma_f32_16x16x32_bf16 v[144:147], v[64:67], v[44:47], v[144:147]
ds_read_b64_tr_b16 v[124:125], v8 offset:28672
v_mfma_f32_16x16x32_bf16 v[148:151], v[68:71], v[44:47], v[148:151]
ds_read_b64_tr_b16 v[126:127], v8 offset:30720
v_mfma_f32_16x16x32_bf16 v[152:155], v[72:75], v[44:47], v[152:155]
v_mfma_f32_16x16x32_bf16 v[156:159], v[76:79], v[44:47], v[156:159]
s_waitcnt lgkmcnt(0)
s_barrier
v_mfma_f32_16x16x32_bf16 v[128:131], v[96:99], v[80:83], v[128:131]
ds_read_b128 v[32:35], v3 offset:0
ds_read_b64_tr_b16 v[48:49], v9 offset:0
v_mfma_f32_16x16x32_bf16 v[132:135], v[100:103], v[80:83], v[132:135]
ds_read_b64_tr_b16 v[50:51], v9 offset:2048
ds_read_b64_tr_b16 v[52:53], v10 offset:0
v_mfma_f32_16x16x32_bf16 v[136:139], v[104:107], v[80:83], v[136:139]
ds_read_b64_tr_b16 v[54:55], v10 offset:2048
ds_read_b128 v[36:39], v3 offset:256
v_mfma_f32_16x16x32_bf16 v[140:143], v[108:111], v[80:83], v[140:143]
ds_read_b64_tr_b16 v[56:57], v11 offset:0
ds_read_b64_tr_b16 v[58:59], v11 offset:2048
v_mfma_f32_16x16x32_bf16 v[144:147], v[96:99], v[84:87], v[144:147]
ds_read_b64_tr_b16 v[60:61], v12 offset:0
ds_read_b64_tr_b16 v[62:63], v12 offset:2048
v_mfma_f32_16x16x32_bf16 v[148:151], v[100:103], v[84:87], v[148:151]
ds_read_b128 v[40:43], v3 offset:8192
ds_read_b64_tr_b16 v[64:65], v9 offset:4096
v_mfma_f32_16x16x32_bf16 v[152:155], v[104:107], v[84:87], v[152:155]
ds_read_b64_tr_b16 v[66:67], v9 offset:6144
v_mfma_f32_16x16x32_bf16 v[156:159], v[108:111], v[84:87], v[156:159]
ds_read_b64_tr_b16 v[68:69], v10 offset:4096
v_mfma_f32_16x16x32_bf16 v[128:131], v[112:115], v[88:91], v[128:131]
ds_read_b64_tr_b16 v[70:71], v10 offset:6144
v_mfma_f32_16x16x32_bf16 v[132:135], v[116:119], v[88:91], v[132:135]
ds_read_b128 v[44:47], v3 offset:8448
v_mfma_f32_16x16x32_bf16 v[136:139], v[120:123], v[88:91], v[136:139]
ds_read_b64_tr_b16 v[72:73], v11 offset:4096
v_mfma_f32_16x16x32_bf16 v[140:143], v[124:127], v[88:91], v[140:143]
ds_read_b64_tr_b16 v[74:75], v11 offset:6144
v_mfma_f32_16x16x32_bf16 v[144:147], v[112:115], v[92:95], v[144:147]
ds_read_b64_tr_b16 v[76:77], v12 offset:4096
v_mfma_f32_16x16x32_bf16 v[148:151], v[116:119], v[92:95], v[148:151]
ds_read_b64_tr_b16 v[78:79], v12 offset:6144
v_mfma_f32_16x16x32_bf16 v[152:155], v[120:123], v[92:95], v[152:155]
v_mfma_f32_16x16x32_bf16 v[156:159], v[124:127], v[92:95], v[156:159]
s_waitcnt lgkmcnt(0)
s_barrier
v_mfma_f32_16x16x32_bf16 v[128:131], v[48:51], v[32:35], v[128:131]
ds_read_b128 v[80:83], v3 offset:24576
ds_read_b64_tr_b16 v[96:97], v9 offset:24576
v_mfma_f32_16x16x32_bf16 v[132:135], v[52:55], v[32:35], v[132:135]
ds_read_b64_tr_b16 v[98:99], v9 offset:26624
ds_read_b64_tr_b16 v[100:101], v10 offset:24576
v_mfma_f32_16x16x32_bf16 v[136:139], v[56:59], v[32:35], v[136:139]
ds_read_b64_tr_b16 v[102:103], v10 offset:26624
ds_read_b128 v[84:87], v3 offset:24832
v_mfma_f32_16x16x32_bf16 v[140:143], v[60:63], v[32:35], v[140:143]
ds_read_b64_tr_b16 v[104:105], v11 offset:24576
ds_read_b64_tr_b16 v[106:107], v11 offset:26624
v_mfma_f32_16x16x32_bf16 v[144:147], v[48:51], v[36:39], v[144:147]
ds_read_b64_tr_b16 v[108:109], v12 offset:24576
ds_read_b64_tr_b16 v[110:111], v12 offset:26624
v_mfma_f32_16x16x32_bf16 v[148:151], v[52:55], v[36:39], v[148:151]
ds_read_b128 v[88:91], v3 offset:32768
ds_read_b64_tr_b16 v[112:113], v9 offset:28672
v_mfma_f32_16x16x32_bf16 v[152:155], v[56:59], v[36:39], v[152:155]
ds_read_b64_tr_b16 v[114:115], v9 offset:30720
v_mfma_f32_16x16x32_bf16 v[156:159], v[60:63], v[36:39], v[156:159]
ds_read_b64_tr_b16 v[116:117], v10 offset:28672
v_mfma_f32_16x16x32_bf16 v[128:131], v[64:67], v[40:43], v[128:131]
ds_read_b64_tr_b16 v[118:119], v10 offset:30720
v_mfma_f32_16x16x32_bf16 v[132:135], v[68:71], v[40:43], v[132:135]
ds_read_b128 v[92:95], v3 offset:33024
v_mfma_f32_16x16x32_bf16 v[136:139], v[72:75], v[40:43], v[136:139]
ds_read_b64_tr_b16 v[120:121], v11 offset:28672
v_mfma_f32_16x16x32_bf16 v[140:143], v[76:79], v[40:43], v[140:143]
ds_read_b64_tr_b16 v[122:123], v11 offset:30720
v_mfma_f32_16x16x32_bf16 v[144:147], v[64:67], v[44:47], v[144:147]
ds_read_b64_tr_b16 v[124:125], v12 offset:28672
v_mfma_f32_16x16x32_bf16 v[148:151], v[68:71], v[44:47], v[148:151]
ds_read_b64_tr_b16 v[126:127], v12 offset:30720
v_mfma_f32_16x16x32_bf16 v[152:155], v[72:75], v[44:47], v[152:155]
v_mfma_f32_16x16x32_bf16 v[156:159], v[76:79], v[44:47], v[156:159]
s_waitcnt lgkmcnt(0)
s_barrier
v_mfma_f32_16x16x32_bf16 v[128:131], v[96:99], v[80:83], v[128:131]
v_mfma_f32_16x16x32_bf16 v[132:135], v[100:103], v[80:83], v[132:135]
v_mfma_f32_16x16x32_bf16 v[136:139], v[104:107], v[80:83], v[136:139]
v_mfma_f32_16x16x32_bf16 v[140:143], v[108:111], v[80:83], v[140:143]
v_mfma_f32_16x16x32_bf16 v[144:147], v[96:99], v[84:87], v[144:147]
v_mfma_f32_16x16x32_bf16 v[148:151], v[100:103], v[84:87], v[148:151]
v_mfma_f32_16x16x32_bf16 v[152:155], v[104:107], v[84:87], v[152:155]
v_mfma_f32_16x16x32_bf16 v[156:159], v[108:111], v[84:87], v[156:159]
v_mfma_f32_16x16x32_bf16 v[128:131], v[112:115], v[88:91], v[128:131]
v_mfma_f32_16x16x32_bf16 v[132:135], v[116:119], v[88:91], v[132:135]
v_mfma_f32_16x16x32_bf16 v[136:139], v[120:123], v[88:91], v[136:139]
v_mfma_f32_16x16x32_bf16 v[140:143], v[124:127], v[88:91], v[140:143]
v_mfma_f32_16x16x32_bf16 v[144:147], v[112:115], v[92:95], v[144:147]
v_mfma_f32_16x16x32_bf16 v[148:151], v[116:119], v[92:95], v[148:151]
v_mfma_f32_16x16x32_bf16 v[152:155], v[120:123], v[92:95], v[152:155]
v_mfma_f32_16x16x32_bf16 v[156:159], v[124:127], v[92:95], v[156:159]
s_nop 4
v_cvt_pk_bf16_f32 v96, v128, v129
v_cvt_pk_bf16_f32 v97, v130, v131
v_cvt_pk_bf16_f32 v98, v132, v133
v_cvt_pk_bf16_f32 v99, v134, v135
v_cvt_pk_bf16_f32 v100, v136, v137
v_cvt_pk_bf16_f32 v101, v138, v139
v_cvt_pk_bf16_f32 v102, v140, v141
v_cvt_pk_bf16_f32 v103, v142, v143
v_cvt_pk_bf16_f32 v104, v144, v145
v_cvt_pk_bf16_f32 v105, v146, v147
v_cvt_pk_bf16_f32 v106, v148, v149
v_cvt_pk_bf16_f32 v107, v150, v151
v_cvt_pk_bf16_f32 v108, v152, v153
v_cvt_pk_bf16_f32 v109, v154, v155
v_cvt_pk_bf16_f32 v110, v156, v157
v_cvt_pk_bf16_f32 v111, v158, v159
v_permlane16_swap_b32 v96, v98
v_permlane16_swap_b32 v97, v99
buffer_store_dwordx4 v[96:99], v28, s[16:19], 0 offen offset:0
v_permlane16_swap_b32 v100, v102
v_permlane16_swap_b32 v101, v103
buffer_store_dwordx4 v[100:103], v28, s[16:19], 0 offen offset:64
v_permlane16_swap_b32 v104, v106
v_permlane16_swap_b32 v105, v107
buffer_store_dwordx4 v[104:107], v28, s[16:19], 0 offen offset:2048
v_permlane16_swap_b32 v108, v110
v_permlane16_swap_b32 v109, v111
buffer_store_dwordx4 v[108:111], v28, s[16:19], 0 offen offset:2112
s_branch Ldone_1
LG1_18:
s_cmp_eq_u32 s36, 7
s_cbranch_scc1 L7_27
s_mul_i32 s44, s34, 262144
s_lshl_b32 s39, s51, 13
s_add_u32 s44, s44, s39
s_add_u32 s44, s44, 0
s_lshl_b32 s43, s35, 7
s_mov_b32 s10, 253952
s_movk_i32 s38, 1024
s_movk_i32 s40, 9216
s_cmp_eq_u32 s51, 2
s_cselect_b32 s8, s28, s32
s_cselect_b32 s9, s29, s33
s_cselect_b32 s10, 2095232, s10
s_cselect_b32 s43, s43, s44
s_cselect_b32 s38, 16384, s38
s_cselect_b32 s40, 16384, s40
s_cselect_b32 s55, 16384, s38
s_cselect_b32 s45, -1, 0
s_add_u32 s8, s8, s43
s_addc_u32 s9, s9, 0
s_mov_b32 s11, 0x20000
s_sub_u32 s37, 0, s40
v_lshrrev_b32 v19, 3, v1
v_mul_u32_u24 v19, 1920, v19
v_lshrrev_b32 v20, 4, v1
v_lshlrev_b32 v20, 5, v20
v_and_b32 v19, s45, v19
v_and_b32 v20, s45, v20
v_lshlrev_b32 v23, 4, v1
v_xor_b32 v23, v23, v20
v_add_u32 v23, v23, v19
s_lshl_b32 s43, s34, 18
s_add_u32 s12, s32, s43
s_addc_u32 s13, s33, 0
s_mov_b32 s14, 262144
s_mov_b32 s15, 0x20000
v_lshlrev_b32 v21, 4, v1
s_lshl_b32 s54, s36, 11
s_cmp_eq_u32 s51, 1
s_cbranch_scc1 Lp_31
s_cmp_eq_u32 s51, 2
s_cbranch_scc1 Lp_32
Lp_30:
s_load_dword s64, s[80:81], 0
s_load_dword s65, s[80:81], 64
s_load_dword s66, s[80:81], 128
s_load_dword s67, s[80:81], 192
s_load_dword s68, s[80:81], 7168
s_load_dword s69, s[80:81], 7232
s_load_dword s70, s[80:81], 7296
s_load_dword s71, s[80:81], 7360
s_load_dword s72, s[80:81], 14336
s_load_dword s73, s[80:81], 14400
s_load_dword s74, s[80:81], 14464
s_load_dword s75, s[80:81], 14528
s_load_dword s76, s[80:81], 21504
s_load_dword s77, s[80:81], 21568
s_load_dword s78, s[80:81], 21632
s_load_dword s79, s[80:81], 21696
s_load_dword s64, s[80:81], 28672
s_load_dword s65, s[80:81], 28736
s_load_dword s66, s[80:81], 28800
s_load_dword s67, s[80:81], 28864
s_load_dword s68, s[80:81], 35840
s_load_dword s69, s[80:81], 35904
s_load_dword s70, s[80:81], 35968
s_load_dword s71, s[80:81], 36032
s_load_dword s72, s[80:81], 43008
s_load_dword s73, s[80:81], 43072
s_load_dword s74, s[80:81], 43136
s_load_dword s75, s[80:81], 43200
s_load_dword s76, s[80:81], 50176
s_load_dword s77, s[80:81], 50240
s_load_dword s78, s[80:81], 50304
s_load_dword s79, s[80:81], 50368
s_load_dword s64, s[80:81], 57344
s_load_dword s65, s[80:81], 57408
s_load_dword s66, s[80:81], 57472
s_load_dword s67, s[80:81], 57536
s_load_dword s68, s[80:81], 64512
s_load_dword s69, s[80:81], 64576
s_load_dword s70, s[80:81], 64640
s_load_dword s71, s[80:81], 64704
s_load_dword s72, s[80:81], 71680
s_load_dword s73, s[80:81], 71744
s_load_dword s74, s[80:81], 71808
s_load_dword s75, s[80:81], 71872
s_load_dword s76, s[80:81], 78848
s_load_dword s77, s[80:81], 78912
s_load_dword s78, s[80:81], 78976
s_load_dword s79, s[80:81], 79040
s_add_u32 s80, s80, 86016
s_addc_u32 s81, s81, 0
s_add_u32 s43, s34, 0
s_lshl_b32 s43, s43, 7
v_mov_b32 v12, s43
v_mov_b32 v14, 16
buffer_load_dword v13, v12, s[56:59], 0 offen sc1
s_mov_b32 s41, 0x10000
Lpoll_33:
s_waitcnt vmcnt(0)
v_cmp_ne_u32 vcc, v14, v13
s_nop 4
s_cbranch_vccz Lpok_34
buffer_load_dword v13, v12, s[56:59], 0 offen sc1
s_sub_u32 s41, s41, 1
s_cmp_lg_u32 s41, 0
s_cbranch_scc1 Lpoll_33
s_waitcnt vmcnt(0)
Lpok_34:
s_barrier
s_add_u32 m0, s54, 0
s_add_u32 s43, s54, 0
buffer_load_dwordx4 v21, s[12:15], s43 offen sc1 lds
s_add_u32 m0, s54, 1024
s_add_u32 s43, s54, 1024
buffer_load_dwordx4 v21, s[12:15], s43 offen sc1 lds
s_add_u32 m0, s54, 24576
s_add_u32 s43, s54, 16384
buffer_load_dwordx4 v21, s[12:15], s43 offen sc1 lds
s_add_u32 m0, s54, 25600
s_add_u32 s43, s54, 17408
buffer_load_dwordx4 v21, s[12:15], s43 offen sc1 lds
s_add_u32 s37, s37, 32768
s_add_u32 m0, s39, 49152
s_add_u32 s37, s37, s40
buffer_load_dwordx4 v23, s[8:11], s37 offen sc1 lds
s_add_u32 m0, s39, 50176
s_add_u32 s37, s37, s38
buffer_load_dwordx4 v23, s[8:11], s37 offen sc1 lds
s_add_u32 m0, s39, 51200
s_add_u32 s37, s37, s38
buffer_load_dwordx4 v23, s[8:11], s37 offen sc1 lds
s_add_u32 m0, s39, 52224
s_add_u32 s37, s37, s38
buffer_load_dwordx4 v23, s[8:11], s37 offen sc1 lds
s_add_u32 m0, s39, 53248
s_add_u32 s37, s37, s55
buffer_load_dwordx4 v23, s[8:11], s37 offen sc1 lds
s_add_u32 m0, s39, 54272
s_add_u32 s37, s37, s38
buffer_load_dwordx4 v23, s[8:11], s37 offen sc1 lds
s_add_u32 m0, s39, 55296
s_add_u32 s37, s37, s38
buffer_load_dwordx4 v23, s[8:11], s37 offen sc1 lds
s_add_u32 m0, s39, 56320
s_add_u32 s37, s37, s38
buffer_load_dwordx4 v23, s[8:11], s37 offen sc1 lds
s_add_u32 m0, s39, 73728
s_add_u32 s37, s37, s40
buffer_load_dwordx4 v23, s[8:11], s37 offen sc1 lds
s_add_u32 m0, s39, 74752
s_add_u32 s37, s37, s38
buffer_load_dwordx4 v23, s[8:11], s37 offen sc1 lds
s_add_u32 m0, s39, 75776
s_add_u32 s37, s37, s38
buffer_load_dwordx4 v23, s[8:11], s37 offen sc1 lds
s_add_u32 m0, s39, 76800
s_add_u32 s37, s37, s38
buffer_load_dwordx4 v23, s[8:11], s37 offen sc1 lds
s_add_u32 m0, s39, 77824
s_add_u32 s37, s37, s55
buffer_load_dwordx4 v23, s[8:11], s37 offen sc1 lds
s_add_u32 m0, s39, 78848
s_add_u32 s37, s37, s38
buffer_load_dwordx4 v23, s[8:11], s37 offen sc1 lds
s_add_u32 m0, s39, 79872
s_add_u32 s37, s37, s38
buffer_load_dwordx4 v23, s[8:11], s37 offen sc1 lds
s_add_u32 m0, s39, 80896
s_add_u32 s37, s37, s38
buffer_load_dwordx4 v23, s[8:11], s37 offen sc1 lds
s_add_u32 m0, s39, 98304
s_add_u32 s37, s37, s40
buffer_load_dwordx4 v23, s[8:11], s37 offen sc1 lds
s_add_u32 m0, s39, 99328
s_add_u32 s37, s37, s38
buffer_load_dwordx4 v23, s[8:11], s37 offen sc1 lds
s_add_u32 m0, s39, 100352
s_add_u32 s37, s37, s38
buffer_load_dwordx4 v23, s[8:11], s37 offen sc1 lds
s_add_u32 m0, s39, 101376
s_add_u32 s37, s37, s38
buffer_load_dwordx4 v23, s[8:11], s37 offen sc1 lds
s_add_u32 m0, s39, 102400
s_add_u32 s37, s37, s55
buffer_load_dwordx4 v23, s[8:11], s37 offen sc1 lds
s_add_u32 m0, s39, 103424
s_add_u32 s37, s37, s38
buffer_load_dwordx4 v23, s[8:11], s37 offen sc1 lds
s_add_u32 m0, s39, 104448
s_add_u32 s37, s37, s38
buffer_load_dwordx4 v23, s[8:11], s37 offen sc1 lds
s_add_u32 m0, s39, 105472
s_add_u32 s37, s37, s38
buffer_load_dwordx4 v23, s[8:11], s37 offen sc1 lds
s_add_u32 m0, s39, 122880
s_add_u32 s37, s37, s40
buffer_load_dwordx4 v23, s[8:11], s37 offen sc1 lds
s_add_u32 m0, s39, 123904
s_add_u32 s37, s37, s38
buffer_load_dwordx4 v23, s[8:11], s37 offen sc1 lds
s_add_u32 m0, s39, 124928
s_add_u32 s37, s37, s38
buffer_load_dwordx4 v23, s[8:11], s37 offen sc1 lds
s_add_u32 m0, s39, 125952
s_add_u32 s37, s37, s38
buffer_load_dwordx4 v23, s[8:11], s37 offen sc1 lds
s_add_u32 m0, s39, 126976
s_add_u32 s37, s37, s55
buffer_load_dwordx4 v23, s[8:11], s37 offen sc1 lds
s_add_u32 m0, s39, 128000
s_add_u32 s37, s37, s38
buffer_load_dwordx4 v23, s[8:11], s37 offen sc1 lds
s_add_u32 m0, s39, 129024
s_add_u32 s37, s37, s38
buffer_load_dwordx4 v23, s[8:11], s37 offen sc1 lds
s_add_u32 m0, s39, 130048
s_add_u32 s37, s37, s38
buffer_load_dwordx4 v23, s[8:11], s37 offen sc1 lds
s_waitcnt vmcnt(34)
s_barrier
s_waitcnt vmcnt(32)
s_barrier
s_add_u32 m0, s39, 0
s_add_u32 s37, s37, s40
buffer_load_dwordx4 v23, s[8:11], s37 offen sc1 lds
s_add_u32 m0, s39, 1024
s_add_u32 s37, s37, s38
buffer_load_dwordx4 v23, s[8:11], s37 offen sc1 lds
s_add_u32 m0, s39, 2048
s_add_u32 s37, s37, s38
buffer_load_dwordx4 v23, s[8:11], s37 offen sc1 lds
s_add_u32 m0, s39, 3072
s_add_u32 s37, s37, s38
buffer_load_dwordx4 v23, s[8:11], s37 offen sc1 lds
s_add_u32 m0, s39, 4096
s_add_u32 s37, s37, s55
buffer_load_dwordx4 v23, s[8:11], s37 offen sc1 lds
s_add_u32 m0, s39, 5120
s_add_u32 s37, s37, s38
buffer_load_dwordx4 v23, s[8:11], s37 offen sc1 lds
s_add_u32 m0, s39, 6144
s_add_u32 s37, s37, s38
buffer_load_dwordx4 v23, s[8:11], s37 offen sc1 lds
s_add_u32 m0, s39, 7168
s_add_u32 s37, s37, s38
buffer_load_dwordx4 v23, s[8:11], s37 offen sc1 lds
s_waitcnt vmcnt(32)
s_barrier
s_add_u32 m0, s39, 24576
s_add_u32 s37, s37, s40
buffer_load_dwordx4 v23, s[8:11], s37 offen sc1 lds
s_add_u32 m0, s39, 25600
s_add_u32 s37, s37, s38
buffer_load_dwordx4 v23, s[8:11], s37 offen sc1 lds
s_add_u32 m0, s39, 26624
s_add_u32 s37, s37, s38
buffer_load_dwordx4 v23, s[8:11], s37 offen sc1 lds
s_add_u32 m0, s39, 27648
s_add_u32 s37, s37, s38
buffer_load_dwordx4 v23, s[8:11], s37 offen sc1 lds
s_add_u32 m0, s39, 28672
s_add_u32 s37, s37, s55
buffer_load_dwordx4 v23, s[8:11], s37 offen sc1 lds
s_add_u32 m0, s39, 29696
s_add_u32 s37, s37, s38
buffer_load_dwordx4 v23, s[8:11], s37 offen sc1 lds
s_add_u32 m0, s39, 30720
s_add_u32 s37, s37, s38
buffer_load_dwordx4 v23, s[8:11], s37 offen sc1 lds
s_add_u32 m0, s39, 31744
s_add_u32 s37, s37, s38
buffer_load_dwordx4 v23, s[8:11], s37 offen sc1 lds
s_waitcnt vmcnt(32)
s_barrier
s_add_u32 m0, s39, 49152
s_add_u32 s37, s37, s40
buffer_load_dwordx4 v23, s[8:11], s37 offen sc1 lds
s_add_u32 m0, s39, 50176
s_add_u32 s37, s37, s38
buffer_load_dwordx4 v23, s[8:11], s37 offen sc1 lds
s_add_u32 m0, s39, 51200
s_add_u32 s37, s37, s38
buffer_load_dwordx4 v23, s[8:11], s37 offen sc1 lds
s_add_u32 m0, s39, 52224
s_add_u32 s37, s37, s38
buffer_load_dwordx4 v23, s[8:11], s37 offen sc1 lds
s_add_u32 m0, s39, 53248
s_add_u32 s37, s37, s55
buffer_load_dwordx4 v23, s[8:11], s37 offen sc1 lds
s_add_u32 m0, s39, 54272
s_add_u32 s37, s37, s38
buffer_load_dwordx4 v23, s[8:11], s37 offen sc1 lds
s_add_u32 m0, s39, 55296
s_add_u32 s37, s37, s38
buffer_load_dwordx4 v23, s[8:11], s37 offen sc1 lds
s_add_u32 m0, s39, 56320
s_add_u32 s37, s37, s38
buffer_load_dwordx4 v23, s[8:11], s37 offen sc1 lds
s_waitcnt vmcnt(32)
s_barrier
s_add_u32 m0, s39, 73728
s_add_u32 s37, s37, s40
buffer_load_dwordx4 v23, s[8:11], s37 offen sc1 lds
s_add_u32 m0, s39, 74752
s_add_u32 s37, s37, s38
buffer_load_dwordx4 v23, s[8:11], s37 offen sc1 lds
s_add_u32 m0, s39, 75776
s_add_u32 s37, s37, s38
buffer_load_dwordx4 v23, s[8:11], s37 offen sc1 lds
s_add_u32 m0, s39, 76800
s_add_u32 s37, s37, s38
buffer_load_dwordx4 v23, s[8:11], s37 offen sc1 lds
s_add_u32 m0, s39, 77824
s_add_u32 s37, s37, s55
buffer_load_dwordx4 v23, s[8:11], s37 offen sc1 lds
s_add_u32 m0, s39, 78848
s_add_u32 s37, s37, s38
buffer_load_dwordx4 v23, s[8:11], s37 offen sc1 lds
s_add_u32 m0, s39, 79872
s_add_u32 s37, s37, s38
buffer_load_dwordx4 v23, s[8:11], s37 offen sc1 lds
s_add_u32 m0, s39, 80896
s_add_u32 s37, s37, s38
buffer_load_dwordx4 v23, s[8:11], s37 offen sc1 lds
s_waitcnt vmcnt(32)
s_barrier
s_add_u32 m0, s39, 98304
s_add_u32 s37, s37, s40
buffer_load_dwordx4 v23, s[8:11], s37 offen sc1 lds
s_add_u32 m0, s39, 99328
s_add_u32 s37, s37, s38
buffer_load_dwordx4 v23, s[8:11], s37 offen sc1 lds
s_add_u32 m0, s39, 100352
s_add_u32 s37, s37, s38
buffer_load_dwordx4 v23, s[8:11], s37 offen sc1 lds
s_add_u32 m0, s39, 101376
s_add_u32 s37, s37, s38
buffer_load_dwordx4 v23, s[8:11], s37 offen sc1 lds
s_add_u32 m0, s39, 102400
s_add_u32 s37, s37, s55
buffer_load_dwordx4 v23, s[8:11], s37 offen sc1 lds
s_add_u32 m0, s39, 103424
s_add_u32 s37, s37, s38
buffer_load_dwordx4 v23, s[8:11], s37 offen sc1 lds
s_add_u32 m0, s39, 104448
s_add_u32 s37, s37, s38
buffer_load_dwordx4 v23, s[8:11], s37 offen sc1 lds
s_add_u32 m0, s39, 105472
s_add_u32 s37, s37, s38
buffer_load_dwordx4 v23, s[8:11], s37 offen sc1 lds
s_waitcnt vmcnt(32)
s_barrier
s_add_u32 m0, s39, 122880
s_add_u32 s37, s37, s40
buffer_load_dwordx4 v23, s[8:11], s37 offen sc1 lds
s_add_u32 m0, s39, 123904
s_add_u32 s37, s37, s38
buffer_load_dwordx4 v23, s[8:11], s37 offen sc1 lds
s_add_u32 m0, s39, 124928
s_add_u32 s37, s37, s38
buffer_load_dwordx4 v23, s[8:11], s37 offen sc1 lds
s_add_u32 m0, s39, 125952
s_add_u32 s37, s37, s38
buffer_load_dwordx4 v23, s[8:11], s37 offen sc1 lds
s_add_u32 m0, s39, 126976
s_add_u32 s37, s37, s55
buffer_load_dwordx4 v23, s[8:11], s37 offen sc1 lds
s_add_u32 m0, s39, 128000
s_add_u32 s37, s37, s38
buffer_load_dwordx4 v23, s[8:11], s37 offen sc1 lds
s_add_u32 m0, s39, 129024
s_add_u32 s37, s37, s38
buffer_load_dwordx4 v23, s[8:11], s37 offen sc1 lds
s_add_u32 m0, s39, 130048
s_add_u32 s37, s37, s38
buffer_load_dwordx4 v23, s[8:11], s37 offen sc1 lds
s_waitcnt vmcnt(32)
s_barrier
s_add_u32 m0, s39, 0
s_add_u32 s37, s37, s40
buffer_load_dwordx4 v23, s[8:11], s37 offen sc1 lds
s_add_u32 m0, s39, 1024
s_add_u32 s37, s37, s38
buffer_load_dwordx4 v23, s[8:11], s37 offen sc1 lds
s_add_u32 m0, s39, 2048
s_add_u32 s37, s37, s38
buffer_load_dwordx4 v23, s[8:11], s37 offen sc1 lds
s_add_u32 m0, s39, 3072
s_add_u32 s37, s37, s38
buffer_load_dwordx4 v23, s[8:11], s37 offen sc1 lds
s_add_u32 m0, s39, 4096
s_add_u32 s37, s37, s55
buffer_load_dwordx4 v23, s[8:11], s37 offen sc1 lds
s_add_u32 m0, s39, 5120
s_add_u32 s37, s37, s38
buffer_load_dwordx4 v23, s[8:11], s37 offen sc1 lds
s_add_u32 m0, s39, 6144
s_add_u32 s37, s37, s38
buffer_load_dwordx4 v23, s[8:11], s37 offen sc1 lds
s_add_u32 m0, s39, 7168
s_add_u32 s37, s37, s38
buffer_load_dwordx4 v23, s[8:11], s37 offen sc1 lds
s_waitcnt vmcnt(32)
s_barrier
s_add_u32 m0, s39, 24576
s_add_u32 s37, s37, s40
buffer_load_dwordx4 v23, s[8:11], s37 offen sc1 lds
s_add_u32 m0, s39, 25600
s_add_u32 s37, s37, s38
buffer_load_dwordx4 v23, s[8:11], s37 offen sc1 lds
s_add_u32 m0, s39, 26624
s_add_u32 s37, s37, s38
buffer_load_dwordx4 v23, s[8:11], s37 offen sc1 lds
s_add_u32 m0, s39, 27648
s_add_u32 s37, s37, s38
buffer_load_dwordx4 v23, s[8:11], s37 offen sc1 lds
s_add_u32 m0, s39, 28672
s_add_u32 s37, s37, s55
buffer_load_dwordx4 v23, s[8:11], s37 offen sc1 lds
s_add_u32 m0, s39, 29696
s_add_u32 s37, s37, s38
buffer_load_dwordx4 v23, s[8:11], s37 offen sc1 lds
s_add_u32 m0, s39, 30720
s_add_u32 s37, s37, s38
buffer_load_dwordx4 v23, s[8:11], s37 offen sc1 lds
s_add_u32 m0, s39, 31744
s_add_u32 s37, s37, s38
buffer_load_dwordx4 v23, s[8:11], s37 offen sc1 lds
s_waitcnt vmcnt(32)
s_barrier
s_add_u32 m0, s39, 49152
s_add_u32 s37, s37, s40
buffer_load_dwordx4 v23, s[8:11], s37 offen sc1 lds
s_add_u32 m0, s39, 50176
s_add_u32 s37, s37, s38
buffer_load_dwordx4 v23, s[8:11], s37 offen sc1 lds
s_add_u32 m0, s39, 51200
s_add_u32 s37, s37, s38
buffer_load_dwordx4 v23, s[8:11], s37 offen sc1 lds
s_add_u32 m0, s39, 52224
s_add_u32 s37, s37, s38
buffer_load_dwordx4 v23, s[8:11], s37 offen sc1 lds
s_add_u32 m0, s39, 53248
s_add_u32 s37, s37, s55
buffer_load_dwordx4 v23, s[8:11], s37 offen sc1 lds
s_add_u32 m0, s39, 54272
s_add_u32 s37, s37, s38
buffer_load_dwordx4 v23, s[8:11], s37 offen sc1 lds
s_add_u32 m0, s39, 55296
s_add_u32 s37, s37, s38
buffer_load_dwordx4 v23, s[8:11], s37 offen sc1 lds
s_add_u32 m0, s39, 56320
s_add_u32 s37, s37, s38
buffer_load_dwordx4 v23, s[8:11], s37 offen sc1 lds
s_waitcnt vmcnt(32)
s_barrier
s_add_u32 m0, s39, 73728
s_add_u32 s37, s37, s40
buffer_load_dwordx4 v23, s[8:11], s37 offen sc1 lds
s_add_u32 m0, s39, 74752
s_add_u32 s37, s37, s38
buffer_load_dwordx4 v23, s[8:11], s37 offen sc1 lds
s_add_u32 m0, s39, 75776
s_add_u32 s37, s37, s38
buffer_load_dwordx4 v23, s[8:11], s37 offen sc1 lds
s_add_u32 m0, s39, 76800
s_add_u32 s37, s37, s38
buffer_load_dwordx4 v23, s[8:11], s37 offen sc1 lds
s_add_u32 m0, s39, 77824
s_add_u32 s37, s37, s55
buffer_load_dwordx4 v23, s[8:11], s37 offen sc1 lds
s_add_u32 m0, s39, 78848
s_add_u32 s37, s37, s38
buffer_load_dwordx4 v23, s[8:11], s37 offen sc1 lds
s_add_u32 m0, s39, 79872
s_add_u32 s37, s37, s38
buffer_load_dwordx4 v23, s[8:11], s37 offen sc1 lds
s_add_u32 m0, s39, 80896
s_add_u32 s37, s37, s38
buffer_load_dwordx4 v23, s[8:11], s37 offen sc1 lds
s_waitcnt vmcnt(32)
s_barrier
s_lshl_b32 s43, s35, 8
s_cmp_eq_u32 s51, 1
s_cselect_b32 s8, s4, s6
s_cselect_b32 s9, s5, s7
s_sub_u32 s10, 7340032, s43
s_lshl_b32 s44, s34, 18
s_add_u32 s44, s44, 4194304
s_movk_i32 s38, 28672
s_cmp_eq_u32 s51, 0
s_cselect_b32 s8, s32, s8
s_cselect_b32 s9, s33, s9
s_cselect_b32 s10, 262144, s10
s_cselect_b32 s43, s44, s43
s_cselect_b32 s38, 1024, s38
s_cselect_b32 s45, 0, -1
s_add_u32 s8, s8, s43
s_addc_u32 s9, s9, 0
s_mov_b32 s11, 0x20000
s_sub_u32 s37, 0, s38
s_lshl_b32 s39, s51, 14
v_lshrrev_b32 v19, 4, v1
v_lshlrev_b32 v20, 5, v19
v_mul_u32_u24 v19, 6912, v19
v_and_b32 v19, s45, v19
v_and_b32 v20, s45, v20
v_lshlrev_b32 v21, 4, v1
v_xor_b32 v21, v21, v20
v_add_u32 v22, v21, v19
s_and_b32 s45, s45, 128
v_xor_b32 v23, s45, v22
s_waitcnt vmcnt(24)
s_barrier
s_waitcnt vmcnt(16)
s_barrier
s_waitcnt vmcnt(8)
s_barrier
s_waitcnt vmcnt(0)
s_barrier
s_barrier
s_barrier
s_mul_i32 s43, s38, 48
s_add_u32 s37, s37, s43
s_add_u32 s43, s34, 16
s_lshl_b32 s43, s43, 7
v_mov_b32 v12, s43
v_mov_b32 v14, 16
buffer_load_dword v13, v12, s[56:59], 0 offen sc1
s_mov_b32 s41, 0x10000
Lpoll_35:
s_waitcnt vmcnt(0)
v_cmp_ne_u32 vcc, v14, v13
s_nop 4
s_cbranch_vccz Lpok_36
buffer_load_dword v13, v12, s[56:59], 0 offen sc1
s_sub_u32 s41, s41, 1
s_cmp_lg_u32 s41, 0
s_cbranch_scc1 Lpoll_35
s_waitcnt vmcnt(0)
Lpok_36:
s_branch LP3_29
Lp_31:
s_load_dword s64, s[80:81], 0
s_load_dword s65, s[80:81], 64
s_load_dword s66, s[80:81], 128
s_load_dword s67, s[80:81], 192
s_load_dword s68, s[80:81], 7168
s_load_dword s69, s[80:81], 7232
s_load_dword s70, s[80:81], 7296
s_load_dword s71, s[80:81], 7360
s_load_dword s72, s[80:81], 14336
s_load_dword s73, s[80:81], 14400
s_load_dword s74, s[80:81], 14464
s_load_dword s75, s[80:81], 14528
s_load_dword s76, s[80:81], 21504
s_load_dword s77, s[80:81], 21568
s_load_dword s78, s[80:81], 21632
s_load_dword s79, s[80:81], 21696
s_load_dword s64, s[80:81], 28672
s_load_dword s65, s[80:81], 28736
s_load_dword s66, s[80:81], 28800
s_load_dword s67, s[80:81], 28864
s_load_dword s68, s[80:81], 35840
s_load_dword s69, s[80:81], 35904
s_load_dword s70, s[80:81], 35968
s_load_dword s71, s[80:81], 36032
s_load_dword s72, s[80:81], 43008
s_load_dword s73, s[80:81], 43072
s_load_dword s74, s[80:81], 43136
s_load_dword s75, s[80:81], 43200
s_load_dword s76, s[80:81], 50176
s_load_dword s77, s[80:81], 50240
s_load_dword s78, s[80:81], 50304
s_load_dword s79, s[80:81], 50368
s_load_dword s64, s[80:81], 57344
s_load_dword s65, s[80:81], 57408
s_load_dword s66, s[80:81], 57472
s_load_dword s67, s[80:81], 57536
s_load_dword s68, s[80:81], 64512
s_load_dword s69, s[80:81], 64576
s_load_dword s70, s[80:81], 64640
s_load_dword s71, s[80:81], 64704
s_load_dword s72, s[80:81], 71680
s_load_dword s73, s[80:81], 71744
s_load_dword s74, s[80:81], 71808
s_load_dword s75, s[80:81], 71872
s_load_dword s76, s[80:81], 78848
s_load_dword s77, s[80:81], 78912
s_load_dword s78, s[80:81], 78976
s_load_dword s79, s[80:81], 79040
s_add_u32 s80, s80, 86016
s_addc_u32 s81, s81, 0
s_barrier
s_add_u32 m0, s54, 0
s_add_u32 s43, s54, 0
buffer_load_dwordx4 v21, s[12:15], s43 offen sc1 lds
s_add_u32 m0, s54, 1024
s_add_u32 s43, s54, 1024
buffer_load_dwordx4 v21, s[12:15], s43 offen sc1 lds
s_add_u32 m0, s54, 24576
s_add_u32 s43, s54, 16384
buffer_load_dwordx4 v21, s[12:15], s43 offen sc1 lds
s_add_u32 m0, s54, 25600
s_add_u32 s43, s54, 17408
buffer_load_dwordx4 v21, s[12:15], s43 offen sc1 lds
s_add_u32 s37, s37, 32768
s_add_u32 m0, s39, 49152
s_add_u32 s37, s37, s40
buffer_load_dwordx4 v23, s[8:11], s37 offen sc1 lds
s_add_u32 m0, s39, 50176
s_add_u32 s37, s37, s38
buffer_load_dwordx4 v23, s[8:11], s37 offen sc1 lds
s_add_u32 m0, s39, 51200
s_add_u32 s37, s37, s38
buffer_load_dwordx4 v23, s[8:11], s37 offen sc1 lds
s_add_u32 m0, s39, 52224
s_add_u32 s37, s37, s38
buffer_load_dwordx4 v23, s[8:11], s37 offen sc1 lds
s_add_u32 m0, s39, 53248
s_add_u32 s37, s37, s55
buffer_load_dwordx4 v23, s[8:11], s37 offen sc1 lds
s_add_u32 m0, s39, 54272
s_add_u32 s37, s37, s38
buffer_load_dwordx4 v23, s[8:11], s37 offen sc1 lds
s_add_u32 m0, s39, 55296
s_add_u32 s37, s37, s38
buffer_load_dwordx4 v23, s[8:11], s37 offen sc1 lds
s_add_u32 m0, s39, 56320
s_add_u32 s37, s37, s38
buffer_load_dwordx4 v23, s[8:11], s37 offen sc1 lds
s_add_u32 m0, s39, 73728
s_add_u32 s37, s37, s40
buffer_load_dwordx4 v23, s[8:11], s37 offen sc1 lds
s_add_u32 m0, s39, 74752
s_add_u32 s37, s37, s38
buffer_load_dwordx4 v23, s[8:11], s37 offen sc1 lds
s_add_u32 m0, s39, 75776
s_add_u32 s37, s37, s38
buffer_load_dwordx4 v23, s[8:11], s37 offen sc1 lds
s_add_u32 m0, s39, 76800
s_add_u32 s37, s37, s38
buffer_load_dwordx4 v23, s[8:11], s37 offen sc1 lds
s_add_u32 m0, s39, 77824
s_add_u32 s37, s37, s55
buffer_load_dwordx4 v23, s[8:11], s37 offen sc1 lds
s_add_u32 m0, s39, 78848
s_add_u32 s37, s37, s38
buffer_load_dwordx4 v23, s[8:11], s37 offen sc1 lds
s_add_u32 m0, s39, 79872
s_add_u32 s37, s37, s38
buffer_load_dwordx4 v23, s[8:11], s37 offen sc1 lds
s_add_u32 m0, s39, 80896
s_add_u32 s37, s37, s38
buffer_load_dwordx4 v23, s[8:11], s37 offen sc1 lds
s_add_u32 m0, s39, 98304
s_add_u32 s37, s37, s40
buffer_load_dwordx4 v23, s[8:11], s37 offen sc1 lds
s_add_u32 m0, s39, 99328
s_add_u32 s37, s37, s38
buffer_load_dwordx4 v23, s[8:11], s37 offen sc1 lds
s_add_u32 m0, s39, 100352
s_add_u32 s37, s37, s38
buffer_load_dwordx4 v23, s[8:11], s37 offen sc1 lds
s_add_u32 m0, s39, 101376
s_add_u32 s37, s37, s38
buffer_load_dwordx4 v23, s[8:11], s37 offen sc1 lds
s_add_u32 m0, s39, 102400
s_add_u32 s37, s37, s55
buffer_load_dwordx4 v23, s[8:11], s37 offen sc1 lds
s_add_u32 m0, s39, 103424
s_add_u32 s37, s37, s38
buffer_load_dwordx4 v23, s[8:11], s37 offen sc1 lds
s_add_u32 m0, s39, 104448
s_add_u32 s37, s37, s38
buffer_load_dwordx4 v23, s[8:11], s37 offen sc1 lds
s_add_u32 m0, s39, 105472
s_add_u32 s37, s37, s38
buffer_load_dwordx4 v23, s[8:11], s37 offen sc1 lds
s_add_u32 m0, s39, 122880
s_add_u32 s37, s37, s40
buffer_load_dwordx4 v23, s[8:11], s37 offen sc1 lds
s_add_u32 m0, s39, 123904
s_add_u32 s37, s37, s38
buffer_load_dwordx4 v23, s[8:11], s37 offen sc1 lds
s_add_u32 m0, s39, 124928
s_add_u32 s37, s37, s38
buffer_load_dwordx4 v23, s[8:11], s37 offen sc1 lds
s_add_u32 m0, s39, 125952
s_add_u32 s37, s37, s38
buffer_load_dwordx4 v23, s[8:11], s37 offen sc1 lds
s_add_u32 m0, s39, 126976
s_add_u32 s37, s37, s55
buffer_load_dwordx4 v23, s[8:11], s37 offen sc1 lds
s_add_u32 m0, s39, 128000
s_add_u32 s37, s37, s38
buffer_load_dwordx4 v23, s[8:11], s37 offen sc1 lds
s_add_u32 m0, s39, 129024
s_add_u32 s37, s37, s38
buffer_load_dwordx4 v23, s[8:11], s37 offen sc1 lds
s_add_u32 m0, s39, 130048
s_add_u32 s37, s37, s38
buffer_load_dwordx4 v23, s[8:11], s37 offen sc1 lds
s_waitcnt vmcnt(34)
s_barrier
s_waitcnt vmcnt(32)
s_barrier
s_add_u32 m0, s39, 0
s_add_u32 s37, s37, s40
buffer_load_dwordx4 v23, s[8:11], s37 offen sc1 lds
s_add_u32 m0, s39, 1024
s_add_u32 s37, s37, s38
buffer_load_dwordx4 v23, s[8:11], s37 offen sc1 lds
s_add_u32 m0, s39, 2048
s_add_u32 s37, s37, s38
buffer_load_dwordx4 v23, s[8:11], s37 offen sc1 lds
s_add_u32 m0, s39, 3072
s_add_u32 s37, s37, s38
buffer_load_dwordx4 v23, s[8:11], s37 offen sc1 lds
s_add_u32 m0, s39, 4096
s_add_u32 s37, s37, s55
buffer_load_dwordx4 v23, s[8:11], s37 offen sc1 lds
s_add_u32 m0, s39, 5120
s_add_u32 s37, s37, s38
buffer_load_dwordx4 v23, s[8:11], s37 offen sc1 lds
s_add_u32 m0, s39, 6144
s_add_u32 s37, s37, s38
buffer_load_dwordx4 v23, s[8:11], s37 offen sc1 lds
s_add_u32 m0, s39, 7168
s_add_u32 s37, s37, s38
buffer_load_dwordx4 v23, s[8:11], s37 offen sc1 lds
s_waitcnt vmcnt(32)
s_barrier
s_add_u32 m0, s39, 24576
s_add_u32 s37, s37, s40
buffer_load_dwordx4 v23, s[8:11], s37 offen sc1 lds
s_add_u32 m0, s39, 25600
s_add_u32 s37, s37, s38
buffer_load_dwordx4 v23, s[8:11], s37 offen sc1 lds
s_add_u32 m0, s39, 26624
s_add_u32 s37, s37, s38
buffer_load_dwordx4 v23, s[8:11], s37 offen sc1 lds
s_add_u32 m0, s39, 27648
s_add_u32 s37, s37, s38
buffer_load_dwordx4 v23, s[8:11], s37 offen sc1 lds
s_add_u32 m0, s39, 28672
s_add_u32 s37, s37, s55
buffer_load_dwordx4 v23, s[8:11], s37 offen sc1 lds
s_add_u32 m0, s39, 29696
s_add_u32 s37, s37, s38
buffer_load_dwordx4 v23, s[8:11], s37 offen sc1 lds
s_add_u32 m0, s39, 30720
s_add_u32 s37, s37, s38
buffer_load_dwordx4 v23, s[8:11], s37 offen sc1 lds
s_add_u32 m0, s39, 31744
s_add_u32 s37, s37, s38
buffer_load_dwordx4 v23, s[8:11], s37 offen sc1 lds
s_waitcnt vmcnt(32)
s_barrier
s_add_u32 m0, s39, 49152
s_add_u32 s37, s37, s40
buffer_load_dwordx4 v23, s[8:11], s37 offen sc1 lds
s_add_u32 m0, s39, 50176
s_add_u32 s37, s37, s38
buffer_load_dwordx4 v23, s[8:11], s37 offen sc1 lds
s_add_u32 m0, s39, 51200
s_add_u32 s37, s37, s38
buffer_load_dwordx4 v23, s[8:11], s37 offen sc1 lds
s_add_u32 m0, s39, 52224
s_add_u32 s37, s37, s38
buffer_load_dwordx4 v23, s[8:11], s37 offen sc1 lds
s_add_u32 m0, s39, 53248
s_add_u32 s37, s37, s55
buffer_load_dwordx4 v23, s[8:11], s37 offen sc1 lds
s_add_u32 m0, s39, 54272
s_add_u32 s37, s37, s38
buffer_load_dwordx4 v23, s[8:11], s37 offen sc1 lds
s_add_u32 m0, s39, 55296
s_add_u32 s37, s37, s38
buffer_load_dwordx4 v23, s[8:11], s37 offen sc1 lds
s_add_u32 m0, s39, 56320
s_add_u32 s37, s37, s38
buffer_load_dwordx4 v23, s[8:11], s37 offen sc1 lds
s_waitcnt vmcnt(32)
s_barrier
s_add_u32 m0, s39, 73728
s_add_u32 s37, s37, s40
buffer_load_dwordx4 v23, s[8:11], s37 offen sc1 lds
s_add_u32 m0, s39, 74752
s_add_u32 s37, s37, s38
buffer_load_dwordx4 v23, s[8:11], s37 offen sc1 lds
s_add_u32 m0, s39, 75776
s_add_u32 s37, s37, s38
buffer_load_dwordx4 v23, s[8:11], s37 offen sc1 lds
s_add_u32 m0, s39, 76800
s_add_u32 s37, s37, s38
buffer_load_dwordx4 v23, s[8:11], s37 offen sc1 lds
s_add_u32 m0, s39, 77824
s_add_u32 s37, s37, s55
buffer_load_dwordx4 v23, s[8:11], s37 offen sc1 lds
s_add_u32 m0, s39, 78848
s_add_u32 s37, s37, s38
buffer_load_dwordx4 v23, s[8:11], s37 offen sc1 lds
s_add_u32 m0, s39, 79872
s_add_u32 s37, s37, s38
buffer_load_dwordx4 v23, s[8:11], s37 offen sc1 lds
s_add_u32 m0, s39, 80896
s_add_u32 s37, s37, s38
buffer_load_dwordx4 v23, s[8:11], s37 offen sc1 lds
s_waitcnt vmcnt(32)
s_barrier
s_add_u32 m0, s39, 98304
s_add_u32 s37, s37, s40
buffer_load_dwordx4 v23, s[8:11], s37 offen sc1 lds
s_add_u32 m0, s39, 99328
s_add_u32 s37, s37, s38
buffer_load_dwordx4 v23, s[8:11], s37 offen sc1 lds
s_add_u32 m0, s39, 100352
s_add_u32 s37, s37, s38
buffer_load_dwordx4 v23, s[8:11], s37 offen sc1 lds
s_add_u32 m0, s39, 101376
s_add_u32 s37, s37, s38
buffer_load_dwordx4 v23, s[8:11], s37 offen sc1 lds
s_add_u32 m0, s39, 102400
s_add_u32 s37, s37, s55
buffer_load_dwordx4 v23, s[8:11], s37 offen sc1 lds
s_add_u32 m0, s39, 103424
s_add_u32 s37, s37, s38
buffer_load_dwordx4 v23, s[8:11], s37 offen sc1 lds
s_add_u32 m0, s39, 104448
s_add_u32 s37, s37, s38
buffer_load_dwordx4 v23, s[8:11], s37 offen sc1 lds
s_add_u32 m0, s39, 105472
s_add_u32 s37, s37, s38
buffer_load_dwordx4 v23, s[8:11], s37 offen sc1 lds
s_waitcnt vmcnt(32)
s_barrier
s_add_u32 m0, s39, 122880
s_add_u32 s37, s37, s40
buffer_load_dwordx4 v23, s[8:11], s37 offen sc1 lds
s_add_u32 m0, s39, 123904
s_add_u32 s37, s37, s38
buffer_load_dwordx4 v23, s[8:11], s37 offen sc1 lds
s_add_u32 m0, s39, 124928
s_add_u32 s37, s37, s38
buffer_load_dwordx4 v23, s[8:11], s37 offen sc1 lds
s_add_u32 m0, s39, 125952
s_add_u32 s37, s37, s38
buffer_load_dwordx4 v23, s[8:11], s37 offen sc1 lds
s_add_u32 m0, s39, 126976
s_add_u32 s37, s37, s55
buffer_load_dwordx4 v23, s[8:11], s37 offen sc1 lds
s_add_u32 m0, s39, 128000
s_add_u32 s37, s37, s38
buffer_load_dwordx4 v23, s[8:11], s37 offen sc1 lds
s_add_u32 m0, s39, 129024
s_add_u32 s37, s37, s38
buffer_load_dwordx4 v23, s[8:11], s37 offen sc1 lds
s_add_u32 m0, s39, 130048
s_add_u32 s37, s37, s38
buffer_load_dwordx4 v23, s[8:11], s37 offen sc1 lds
s_waitcnt vmcnt(32)
s_barrier
s_add_u32 m0, s39, 0
s_add_u32 s37, s37, s40
buffer_load_dwordx4 v23, s[8:11], s37 offen sc1 lds
s_add_u32 m0, s39, 1024
s_add_u32 s37, s37, s38
buffer_load_dwordx4 v23, s[8:11], s37 offen sc1 lds
s_add_u32 m0, s39, 2048
s_add_u32 s37, s37, s38
buffer_load_dwordx4 v23, s[8:11], s37 offen sc1 lds
s_add_u32 m0, s39, 3072
s_add_u32 s37, s37, s38
buffer_load_dwordx4 v23, s[8:11], s37 offen sc1 lds
s_add_u32 m0, s39, 4096
s_add_u32 s37, s37, s55
buffer_load_dwordx4 v23, s[8:11], s37 offen sc1 lds
s_add_u32 m0, s39, 5120
s_add_u32 s37, s37, s38
buffer_load_dwordx4 v23, s[8:11], s37 offen sc1 lds
s_add_u32 m0, s39, 6144
s_add_u32 s37, s37, s38
buffer_load_dwordx4 v23, s[8:11], s37 offen sc1 lds
s_add_u32 m0, s39, 7168
s_add_u32 s37, s37, s38
buffer_load_dwordx4 v23, s[8:11], s37 offen sc1 lds
s_waitcnt vmcnt(32)
s_barrier
s_add_u32 m0, s39, 24576
s_add_u32 s37, s37, s40
buffer_load_dwordx4 v23, s[8:11], s37 offen sc1 lds
s_add_u32 m0, s39, 25600
s_add_u32 s37, s37, s38
buffer_load_dwordx4 v23, s[8:11], s37 offen sc1 lds
s_add_u32 m0, s39, 26624
s_add_u32 s37, s37, s38
buffer_load_dwordx4 v23, s[8:11], s37 offen sc1 lds
s_add_u32 m0, s39, 27648
s_add_u32 s37, s37, s38
buffer_load_dwordx4 v23, s[8:11], s37 offen sc1 lds
s_add_u32 m0, s39, 28672
s_add_u32 s37, s37, s55
buffer_load_dwordx4 v23, s[8:11], s37 offen sc1 lds
s_add_u32 m0, s39, 29696
s_add_u32 s37, s37, s38
buffer_load_dwordx4 v23, s[8:11], s37 offen sc1 lds
s_add_u32 m0, s39, 30720
s_add_u32 s37, s37, s38
buffer_load_dwordx4 v23, s[8:11], s37 offen sc1 lds
s_add_u32 m0, s39, 31744
s_add_u32 s37, s37, s38
buffer_load_dwordx4 v23, s[8:11], s37 offen sc1 lds
s_waitcnt vmcnt(32)
s_barrier
s_add_u32 m0, s39, 49152
s_add_u32 s37, s37, s40
buffer_load_dwordx4 v23, s[8:11], s37 offen sc1 lds
s_add_u32 m0, s39, 50176
s_add_u32 s37, s37, s38
buffer_load_dwordx4 v23, s[8:11], s37 offen sc1 lds
s_add_u32 m0, s39, 51200
s_add_u32 s37, s37, s38
buffer_load_dwordx4 v23, s[8:11], s37 offen sc1 lds
s_add_u32 m0, s39, 52224
s_add_u32 s37, s37, s38
buffer_load_dwordx4 v23, s[8:11], s37 offen sc1 lds
s_add_u32 m0, s39, 53248
s_add_u32 s37, s37, s55
buffer_load_dwordx4 v23, s[8:11], s37 offen sc1 lds
s_add_u32 m0, s39, 54272
s_add_u32 s37, s37, s38
buffer_load_dwordx4 v23, s[8:11], s37 offen sc1 lds
s_add_u32 m0, s39, 55296
s_add_u32 s37, s37, s38
buffer_load_dwordx4 v23, s[8:11], s37 offen sc1 lds
s_add_u32 m0, s39, 56320
s_add_u32 s37, s37, s38
buffer_load_dwordx4 v23, s[8:11], s37 offen sc1 lds
s_waitcnt vmcnt(32)
s_barrier
s_add_u32 m0, s39, 73728
s_add_u32 s37, s37, s40
buffer_load_dwordx4 v23, s[8:11], s37 offen sc1 lds
s_add_u32 m0, s39, 74752
s_add_u32 s37, s37, s38
buffer_load_dwordx4 v23, s[8:11], s37 offen sc1 lds
s_add_u32 m0, s39, 75776
s_add_u32 s37, s37, s38
buffer_load_dwordx4 v23, s[8:11], s37 offen sc1 lds
s_add_u32 m0, s39, 76800
s_add_u32 s37, s37, s38
buffer_load_dwordx4 v23, s[8:11], s37 offen sc1 lds
s_add_u32 m0, s39, 77824
s_add_u32 s37, s37, s55
buffer_load_dwordx4 v23, s[8:11], s37 offen sc1 lds
s_add_u32 m0, s39, 78848
s_add_u32 s37, s37, s38
buffer_load_dwordx4 v23, s[8:11], s37 offen sc1 lds
s_add_u32 m0, s39, 79872
s_add_u32 s37, s37, s38
buffer_load_dwordx4 v23, s[8:11], s37 offen sc1 lds
s_add_u32 m0, s39, 80896
s_add_u32 s37, s37, s38
buffer_load_dwordx4 v23, s[8:11], s37 offen sc1 lds
s_waitcnt vmcnt(32)
s_barrier
s_lshl_b32 s43, s35, 8
s_cmp_eq_u32 s51, 1
s_cselect_b32 s8, s4, s6
s_cselect_b32 s9, s5, s7
s_sub_u32 s10, 7340032, s43
s_lshl_b32 s44, s34, 18
s_add_u32 s44, s44, 4194304
s_movk_i32 s38, 28672
s_cmp_eq_u32 s51, 0
s_cselect_b32 s8, s32, s8
s_cselect_b32 s9, s33, s9
s_cselect_b32 s10, 262144, s10
s_cselect_b32 s43, s44, s43
s_cselect_b32 s38, 1024, s38
s_cselect_b32 s45, 0, -1
s_add_u32 s8, s8, s43
s_addc_u32 s9, s9, 0
s_mov_b32 s11, 0x20000
s_sub_u32 s37, 0, s38
s_lshl_b32 s39, s51, 14
v_lshrrev_b32 v19, 4, v1
v_lshlrev_b32 v20, 5, v19
v_mul_u32_u24 v19, 6912, v19
v_and_b32 v19, s45, v19
v_and_b32 v20, s45, v20
v_lshlrev_b32 v21, 4, v1
v_xor_b32 v21, v21, v20
v_add_u32 v22, v21, v19
s_and_b32 s45, s45, 128
v_xor_b32 v23, s45, v22
s_waitcnt vmcnt(24)
s_barrier
s_add_u32 m0, s39, 98304
s_add_u32 s37, s37, s38
buffer_load_dwordx4 v22, s[8:11], s37 offen sc1 lds
s_add_u32 m0, s39, 99328
s_add_u32 s37, s37, s38
buffer_load_dwordx4 v23, s[8:11], s37 offen sc1 lds
s_add_u32 m0, s39, 100352
s_add_u32 s37, s37, s38
buffer_load_dwordx4 v22, s[8:11], s37 offen sc1 lds
s_add_u32 m0, s39, 101376
s_add_u32 s37, s37, s38
buffer_load_dwordx4 v23, s[8:11], s37 offen sc1 lds
s_add_u32 m0, s39, 102400
s_add_u32 s37, s37, s38
buffer_load_dwordx4 v22, s[8:11], s37 offen sc1 lds
s_add_u32 m0, s39, 103424
s_add_u32 s37, s37, s38
buffer_load_dwordx4 v23, s[8:11], s37 offen sc1 lds
s_add_u32 m0, s39, 104448
s_add_u32 s37, s37, s38
buffer_load_dwordx4 v22, s[8:11], s37 offen sc1 lds
s_add_u32 m0, s39, 105472
s_add_u32 s37, s37, s38
buffer_load_dwordx4 v23, s[8:11], s37 offen sc1 lds
s_add_u32 m0, s39, 106496
s_add_u32 s37, s37, s38
buffer_load_dwordx4 v22, s[8:11], s37 offen sc1 lds
s_add_u32 m0, s39, 107520
s_add_u32 s37, s37, s38
buffer_load_dwordx4 v23, s[8:11], s37 offen sc1 lds
s_add_u32 m0, s39, 108544
s_add_u32 s37, s37, s38
buffer_load_dwordx4 v22, s[8:11], s37 offen sc1 lds
s_add_u32 m0, s39, 109568
s_add_u32 s37, s37, s38
buffer_load_dwordx4 v23, s[8:11], s37 offen sc1 lds
s_add_u32 m0, s39, 110592
s_add_u32 s37, s37, s38
buffer_load_dwordx4 v22, s[8:11], s37 offen sc1 lds
s_add_u32 m0, s39, 111616
s_add_u32 s37, s37, s38
buffer_load_dwordx4 v23, s[8:11], s37 offen sc1 lds
s_add_u32 m0, s39, 112640
s_add_u32 s37, s37, s38
buffer_load_dwordx4 v22, s[8:11], s37 offen sc1 lds
s_add_u32 m0, s39, 113664
s_add_u32 s37, s37, s38
buffer_load_dwordx4 v23, s[8:11], s37 offen sc1 lds
s_waitcnt vmcnt(32)
s_barrier
s_waitcnt vmcnt(24)
s_barrier
s_add_u32 m0, s39, 0
s_add_u32 s37, s37, s38
buffer_load_dwordx4 v22, s[8:11], s37 offen sc1 lds
s_add_u32 m0, s39, 1024
s_add_u32 s37, s37, s38
buffer_load_dwordx4 v23, s[8:11], s37 offen sc1 lds
s_add_u32 m0, s39, 2048
s_add_u32 s37, s37, s38
buffer_load_dwordx4 v22, s[8:11], s37 offen sc1 lds
s_add_u32 m0, s39, 3072
s_add_u32 s37, s37, s38
buffer_load_dwordx4 v23, s[8:11], s37 offen sc1 lds
s_add_u32 m0, s39, 4096
s_add_u32 s37, s37, s38
buffer_load_dwordx4 v22, s[8:11], s37 offen sc1 lds
s_add_u32 m0, s39, 5120
s_add_u32 s37, s37, s38
buffer_load_dwordx4 v23, s[8:11], s37 offen sc1 lds
s_add_u32 m0, s39, 6144
s_add_u32 s37, s37, s38
buffer_load_dwordx4 v22, s[8:11], s37 offen sc1 lds
s_add_u32 m0, s39, 7168
s_add_u32 s37, s37, s38
buffer_load_dwordx4 v23, s[8:11], s37 offen sc1 lds
s_add_u32 m0, s39, 8192
s_add_u32 s37, s37, s38
buffer_load_dwordx4 v22, s[8:11], s37 offen sc1 lds
s_add_u32 m0, s39, 9216
s_add_u32 s37, s37, s38
buffer_load_dwordx4 v23, s[8:11], s37 offen sc1 lds
s_add_u32 m0, s39, 10240
s_add_u32 s37, s37, s38
buffer_load_dwordx4 v22, s[8:11], s37 offen sc1 lds
s_add_u32 m0, s39, 11264
s_add_u32 s37, s37, s38
buffer_load_dwordx4 v23, s[8:11], s37 offen sc1 lds
s_add_u32 m0, s39, 12288
s_add_u32 s37, s37, s38
buffer_load_dwordx4 v22, s[8:11], s37 offen sc1 lds
s_add_u32 m0, s39, 13312
s_add_u32 s37, s37, s38
buffer_load_dwordx4 v23, s[8:11], s37 offen sc1 lds
s_add_u32 m0, s39, 14336
s_add_u32 s37, s37, s38
buffer_load_dwordx4 v22, s[8:11], s37 offen sc1 lds
s_add_u32 m0, s39, 15360
s_add_u32 s37, s37, s38
buffer_load_dwordx4 v23, s[8:11], s37 offen sc1 lds
s_waitcnt vmcnt(32)
s_barrier
s_barrier
s_barrier
s_add_u32 m0, s39, 49152
s_add_u32 s37, s37, s38
buffer_load_dwordx4 v22, s[8:11], s37 offen sc1 lds
s_add_u32 m0, s39, 50176
s_add_u32 s37, s37, s38
buffer_load_dwordx4 v23, s[8:11], s37 offen sc1 lds
s_add_u32 m0, s39, 51200
s_add_u32 s37, s37, s38
buffer_load_dwordx4 v22, s[8:11], s37 offen sc1 lds
s_add_u32 m0, s39, 52224
s_add_u32 s37, s37, s38
buffer_load_dwordx4 v23, s[8:11], s37 offen sc1 lds
s_add_u32 m0, s39, 53248
s_add_u32 s37, s37, s38
buffer_load_dwordx4 v22, s[8:11], s37 offen sc1 lds
s_add_u32 m0, s39, 54272
s_add_u32 s37, s37, s38
buffer_load_dwordx4 v23, s[8:11], s37 offen sc1 lds
s_add_u32 m0, s39, 55296
s_add_u32 s37, s37, s38
buffer_load_dwordx4 v22, s[8:11], s37 offen sc1 lds
s_add_u32 m0, s39, 56320
s_add_u32 s37, s37, s38
buffer_load_dwordx4 v23, s[8:11], s37 offen sc1 lds
s_add_u32 m0, s39, 57344
s_add_u32 s37, s37, s38
buffer_load_dwordx4 v22, s[8:11], s37 offen sc1 lds
s_add_u32 m0, s39, 58368
s_add_u32 s37, s37, s38
buffer_load_dwordx4 v23, s[8:11], s37 offen sc1 lds
s_add_u32 m0, s39, 59392
s_add_u32 s37, s37, s38
buffer_load_dwordx4 v22, s[8:11], s37 offen sc1 lds
s_add_u32 m0, s39, 60416
s_add_u32 s37, s37, s38
buffer_load_dwordx4 v23, s[8:11], s37 offen sc1 lds
s_add_u32 m0, s39, 61440
s_add_u32 s37, s37, s38
buffer_load_dwordx4 v22, s[8:11], s37 offen sc1 lds
s_add_u32 m0, s39, 62464
s_add_u32 s37, s37, s38
buffer_load_dwordx4 v23, s[8:11], s37 offen sc1 lds
s_add_u32 m0, s39, 63488
s_add_u32 s37, s37, s38
buffer_load_dwordx4 v22, s[8:11], s37 offen sc1 lds
s_add_u32 m0, s39, 64512
s_add_u32 s37, s37, s38
buffer_load_dwordx4 v23, s[8:11], s37 offen sc1 lds
s_branch LP3_29
Lp_32:
s_add_u32 m0, s39, 0
s_add_u32 s37, s37, s40
buffer_load_dwordx4 v23, s[8:11], s37 offen sc1 lds
s_add_u32 m0, s39, 1024
s_add_u32 s37, s37, s38
buffer_load_dwordx4 v23, s[8:11], s37 offen sc1 lds
s_add_u32 m0, s39, 2048
s_add_u32 s37, s37, s38
buffer_load_dwordx4 v23, s[8:11], s37 offen sc1 lds
s_add_u32 m0, s39, 3072
s_add_u32 s37, s37, s38
buffer_load_dwordx4 v23, s[8:11], s37 offen sc1 lds
s_add_u32 m0, s39, 4096
s_add_u32 s37, s37, s55
buffer_load_dwordx4 v23, s[8:11], s37 offen sc1 lds
s_add_u32 m0, s39, 5120
s_add_u32 s37, s37, s38
buffer_load_dwordx4 v23, s[8:11], s37 offen sc1 lds
s_add_u32 m0, s39, 6144
s_add_u32 s37, s37, s38
buffer_load_dwordx4 v23, s[8:11], s37 offen sc1 lds
s_add_u32 m0, s39, 7168
s_add_u32 s37, s37, s38
buffer_load_dwordx4 v23, s[8:11], s37 offen sc1 lds
s_add_u32 m0, s39, 24576
s_add_u32 s37, s37, s40
buffer_load_dwordx4 v23, s[8:11], s37 offen sc1 lds
s_add_u32 m0, s39, 25600
s_add_u32 s37, s37, s38
buffer_load_dwordx4 v23, s[8:11], s37 offen sc1 lds
s_add_u32 m0, s39, 26624
s_add_u32 s37, s37, s38
buffer_load_dwordx4 v23, s[8:11], s37 offen sc1 lds
s_add_u32 m0, s39, 27648
s_add_u32 s37, s37, s38
buffer_load_dwordx4 v23, s[8:11], s37 offen sc1 lds
s_add_u32 m0, s39, 28672
s_add_u32 s37, s37, s55
buffer_load_dwordx4 v23, s[8:11], s37 offen sc1 lds
s_add_u32 m0, s39, 29696
s_add_u32 s37, s37, s38
buffer_load_dwordx4 v23, s[8:11], s37 offen sc1 lds
s_add_u32 m0, s39, 30720
s_add_u32 s37, s37, s38
buffer_load_dwordx4 v23, s[8:11], s37 offen sc1 lds
s_add_u32 m0, s39, 31744
s_add_u32 s37, s37, s38
buffer_load_dwordx4 v23, s[8:11], s37 offen sc1 lds
s_add_u32 m0, s39, 49152
s_add_u32 s37, s37, s40
buffer_load_dwordx4 v23, s[8:11], s37 offen sc1 lds
s_add_u32 m0, s39, 50176
s_add_u32 s37, s37, s38
buffer_load_dwordx4 v23, s[8:11], s37 offen sc1 lds
s_add_u32 m0, s39, 51200
s_add_u32 s37, s37, s38
buffer_load_dwordx4 v23, s[8:11], s37 offen sc1 lds
s_add_u32 m0, s39, 52224
s_add_u32 s37, s37, s38
buffer_load_dwordx4 v23, s[8:11], s37 offen sc1 lds
s_add_u32 m0, s39, 53248
s_add_u32 s37, s37, s55
buffer_load_dwordx4 v23, s[8:11], s37 offen sc1 lds
s_add_u32 m0, s39, 54272
s_add_u32 s37, s37, s38
buffer_load_dwordx4 v23, s[8:11], s37 offen sc1 lds
s_add_u32 m0, s39, 55296
s_add_u32 s37, s37, s38
buffer_load_dwordx4 v23, s[8:11], s37 offen sc1 lds
s_add_u32 m0, s39, 56320
s_add_u32 s37, s37, s38
buffer_load_dwordx4 v23, s[8:11], s37 offen sc1 lds
s_add_u32 m0, s39, 73728
s_add_u32 s37, s37, s40
buffer_load_dwordx4 v23, s[8:11], s37 offen sc1 lds
s_add_u32 m0, s39, 74752
s_add_u32 s37, s37, s38
buffer_load_dwordx4 v23, s[8:11], s37 offen sc1 lds
s_add_u32 m0, s39, 75776
s_add_u32 s37, s37, s38
buffer_load_dwordx4 v23, s[8:11], s37 offen sc1 lds
s_add_u32 m0, s39, 76800
s_add_u32 s37, s37, s38
buffer_load_dwordx4 v23, s[8:11], s37 offen sc1 lds
s_add_u32 m0, s39, 77824
s_add_u32 s37, s37, s55
buffer_load_dwordx4 v23, s[8:11], s37 offen sc1 lds
s_add_u32 m0, s39, 78848
s_add_u32 s37, s37, s38
buffer_load_dwordx4 v23, s[8:11], s37 offen sc1 lds
s_add_u32 m0, s39, 79872
s_add_u32 s37, s37, s38
buffer_load_dwordx4 v23, s[8:11], s37 offen sc1 lds
s_add_u32 m0, s39, 80896
s_add_u32 s37, s37, s38
buffer_load_dwordx4 v23, s[8:11], s37 offen sc1 lds
s_add_u32 m0, s39, 98304
s_add_u32 s37, s37, s40
buffer_load_dwordx4 v23, s[8:11], s37 offen sc1 lds
s_add_u32 m0, s39, 99328
s_add_u32 s37, s37, s38
buffer_load_dwordx4 v23, s[8:11], s37 offen sc1 lds
s_add_u32 m0, s39, 100352
s_add_u32 s37, s37, s38
buffer_load_dwordx4 v23, s[8:11], s37 offen sc1 lds
s_add_u32 m0, s39, 101376
s_add_u32 s37, s37, s38
buffer_load_dwordx4 v23, s[8:11], s37 offen sc1 lds
s_add_u32 m0, s39, 102400
s_add_u32 s37, s37, s55
buffer_load_dwordx4 v23, s[8:11], s37 offen sc1 lds
s_add_u32 m0, s39, 103424
s_add_u32 s37, s37, s38
buffer_load_dwordx4 v23, s[8:11], s37 offen sc1 lds
s_add_u32 m0, s39, 104448
s_add_u32 s37, s37, s38
buffer_load_dwordx4 v23, s[8:11], s37 offen sc1 lds
s_add_u32 m0, s39, 105472
s_add_u32 s37, s37, s38
buffer_load_dwordx4 v23, s[8:11], s37 offen sc1 lds
s_add_u32 m0, s39, 122880
s_add_u32 s37, s37, s40
buffer_load_dwordx4 v23, s[8:11], s37 offen sc1 lds
s_add_u32 m0, s39, 123904
s_add_u32 s37, s37, s38
buffer_load_dwordx4 v23, s[8:11], s37 offen sc1 lds
s_add_u32 m0, s39, 124928
s_add_u32 s37, s37, s38
buffer_load_dwordx4 v23, s[8:11], s37 offen sc1 lds
s_add_u32 m0, s39, 125952
s_add_u32 s37, s37, s38
buffer_load_dwordx4 v23, s[8:11], s37 offen sc1 lds
s_add_u32 m0, s39, 126976
s_add_u32 s37, s37, s55
buffer_load_dwordx4 v23, s[8:11], s37 offen sc1 lds
s_add_u32 m0, s39, 128000
s_add_u32 s37, s37, s38
buffer_load_dwordx4 v23, s[8:11], s37 offen sc1 lds
s_add_u32 m0, s39, 129024
s_add_u32 s37, s37, s38
buffer_load_dwordx4 v23, s[8:11], s37 offen sc1 lds
s_add_u32 m0, s39, 130048
s_add_u32 s37, s37, s38
buffer_load_dwordx4 v23, s[8:11], s37 offen sc1 lds
s_load_dword s64, s[80:81], 0
s_load_dword s65, s[80:81], 64
s_load_dword s66, s[80:81], 128
s_load_dword s67, s[80:81], 192
s_load_dword s68, s[80:81], 7168
s_load_dword s69, s[80:81], 7232
s_load_dword s70, s[80:81], 7296
s_load_dword s71, s[80:81], 7360
s_load_dword s72, s[80:81], 14336
s_load_dword s73, s[80:81], 14400
s_load_dword s74, s[80:81], 14464
s_load_dword s75, s[80:81], 14528
s_load_dword s76, s[80:81], 21504
s_load_dword s77, s[80:81], 21568
s_load_dword s78, s[80:81], 21632
s_load_dword s79, s[80:81], 21696
s_load_dword s64, s[80:81], 28672
s_load_dword s65, s[80:81], 28736
s_load_dword s66, s[80:81], 28800
s_load_dword s67, s[80:81], 28864
s_load_dword s68, s[80:81], 35840
s_load_dword s69, s[80:81], 35904
s_load_dword s70, s[80:81], 35968
s_load_dword s71, s[80:81], 36032
s_load_dword s72, s[80:81], 43008
s_load_dword s73, s[80:81], 43072
s_load_dword s74, s[80:81], 43136
s_load_dword s75, s[80:81], 43200
s_load_dword s76, s[80:81], 50176
s_load_dword s77, s[80:81], 50240
s_load_dword s78, s[80:81], 50304
s_load_dword s79, s[80:81], 50368
s_load_dword s64, s[80:81], 57344
s_load_dword s65, s[80:81], 57408
s_load_dword s66, s[80:81], 57472
s_load_dword s67, s[80:81], 57536
s_load_dword s68, s[80:81], 64512
s_load_dword s69, s[80:81], 64576
s_load_dword s70, s[80:81], 64640
s_load_dword s71, s[80:81], 64704
s_load_dword s72, s[80:81], 71680
s_load_dword s73, s[80:81], 71744
s_load_dword s74, s[80:81], 71808
s_load_dword s75, s[80:81], 71872
s_load_dword s76, s[80:81], 78848
s_load_dword s77, s[80:81], 78912
s_load_dword s78, s[80:81], 78976
s_load_dword s79, s[80:81], 79040
s_add_u32 s80, s80, 86016
s_addc_u32 s81, s81, 0
s_barrier
s_add_u32 m0, s54, 0
s_add_u32 s43, s54, 0
buffer_load_dwordx4 v21, s[12:15], s43 offen sc1 lds
s_add_u32 m0, s54, 1024
s_add_u32 s43, s54, 1024
buffer_load_dwordx4 v21, s[12:15], s43 offen sc1 lds
s_add_u32 m0, s54, 24576
s_add_u32 s43, s54, 16384
buffer_load_dwordx4 v21, s[12:15], s43 offen sc1 lds
s_add_u32 m0, s54, 25600
s_add_u32 s43, s54, 17408
buffer_load_dwordx4 v21, s[12:15], s43 offen sc1 lds
s_waitcnt vmcnt(2)
s_barrier
s_waitcnt vmcnt(0)
s_barrier
s_add_u32 m0, s39, 0
s_add_u32 s37, s37, s40
buffer_load_dwordx4 v23, s[8:11], s37 offen sc1 lds
s_add_u32 m0, s39, 1024
s_add_u32 s37, s37, s38
buffer_load_dwordx4 v23, s[8:11], s37 offen sc1 lds
s_add_u32 m0, s39, 2048
s_add_u32 s37, s37, s38
buffer_load_dwordx4 v23, s[8:11], s37 offen sc1 lds
s_add_u32 m0, s39, 3072
s_add_u32 s37, s37, s38
buffer_load_dwordx4 v23, s[8:11], s37 offen sc1 lds
s_add_u32 m0, s39, 4096
s_add_u32 s37, s37, s55
buffer_load_dwordx4 v23, s[8:11], s37 offen sc1 lds
s_add_u32 m0, s39, 5120
s_add_u32 s37, s37, s38
buffer_load_dwordx4 v23, s[8:11], s37 offen sc1 lds
s_add_u32 m0, s39, 6144
s_add_u32 s37, s37, s38
buffer_load_dwordx4 v23, s[8:11], s37 offen sc1 lds
s_add_u32 m0, s39, 7168
s_add_u32 s37, s37, s38
buffer_load_dwordx4 v23, s[8:11], s37 offen sc1 lds
s_waitcnt vmcnt(36)
s_barrier
s_add_u32 m0, s39, 24576
s_add_u32 s37, s37, s40
buffer_load_dwordx4 v23, s[8:11], s37 offen sc1 lds
s_add_u32 m0, s39, 25600
s_add_u32 s37, s37, s38
buffer_load_dwordx4 v23, s[8:11], s37 offen sc1 lds
s_add_u32 m0, s39, 26624
s_add_u32 s37, s37, s38
buffer_load_dwordx4 v23, s[8:11], s37 offen sc1 lds
s_add_u32 m0, s39, 27648
s_add_u32 s37, s37, s38
buffer_load_dwordx4 v23, s[8:11], s37 offen sc1 lds
s_add_u32 m0, s39, 28672
s_add_u32 s37, s37, s55
buffer_load_dwordx4 v23, s[8:11], s37 offen sc1 lds
s_add_u32 m0, s39, 29696
s_add_u32 s37, s37, s38
buffer_load_dwordx4 v23, s[8:11], s37 offen sc1 lds
s_add_u32 m0, s39, 30720
s_add_u32 s37, s37, s38
buffer_load_dwordx4 v23, s[8:11], s37 offen sc1 lds
s_add_u32 m0, s39, 31744
s_add_u32 s37, s37, s38
buffer_load_dwordx4 v23, s[8:11], s37 offen sc1 lds
s_waitcnt vmcnt(36)
s_barrier
s_add_u32 m0, s39, 49152
s_add_u32 s37, s37, s40
buffer_load_dwordx4 v23, s[8:11], s37 offen sc1 lds
s_add_u32 m0, s39, 50176
s_add_u32 s37, s37, s38
buffer_load_dwordx4 v23, s[8:11], s37 offen sc1 lds
s_add_u32 m0, s39, 51200
s_add_u32 s37, s37, s38
buffer_load_dwordx4 v23, s[8:11], s37 offen sc1 lds
s_add_u32 m0, s39, 52224
s_add_u32 s37, s37, s38
buffer_load_dwordx4 v23, s[8:11], s37 offen sc1 lds
s_add_u32 m0, s39, 53248
s_add_u32 s37, s37, s55
buffer_load_dwordx4 v23, s[8:11], s37 offen sc1 lds
s_add_u32 m0, s39, 54272
s_add_u32 s37, s37, s38
buffer_load_dwordx4 v23, s[8:11], s37 offen sc1 lds
s_add_u32 m0, s39, 55296
s_add_u32 s37, s37, s38
buffer_load_dwordx4 v23, s[8:11], s37 offen sc1 lds
s_add_u32 m0, s39, 56320
s_add_u32 s37, s37, s38
buffer_load_dwordx4 v23, s[8:11], s37 offen sc1 lds
s_waitcnt vmcnt(36)
s_barrier
s_add_u32 m0, s39, 73728
s_add_u32 s37, s37, s40
buffer_load_dwordx4 v23, s[8:11], s37 offen sc1 lds
s_add_u32 m0, s39, 74752
s_add_u32 s37, s37, s38
buffer_load_dwordx4 v23, s[8:11], s37 offen sc1 lds
s_add_u32 m0, s39, 75776
s_add_u32 s37, s37, s38
buffer_load_dwordx4 v23, s[8:11], s37 offen sc1 lds
s_add_u32 m0, s39, 76800
s_add_u32 s37, s37, s38
buffer_load_dwordx4 v23, s[8:11], s37 offen sc1 lds
s_add_u32 m0, s39, 77824
s_add_u32 s37, s37, s55
buffer_load_dwordx4 v23, s[8:11], s37 offen sc1 lds
s_add_u32 m0, s39, 78848
s_add_u32 s37, s37, s38
buffer_load_dwordx4 v23, s[8:11], s37 offen sc1 lds
s_add_u32 m0, s39, 79872
s_add_u32 s37, s37, s38
buffer_load_dwordx4 v23, s[8:11], s37 offen sc1 lds
s_add_u32 m0, s39, 80896
s_add_u32 s37, s37, s38
buffer_load_dwordx4 v23, s[8:11], s37 offen sc1 lds
s_waitcnt vmcnt(36)
s_barrier
s_add_u32 m0, s39, 98304
s_add_u32 s37, s37, s40
buffer_load_dwordx4 v23, s[8:11], s37 offen sc1 lds
s_add_u32 m0, s39, 99328
s_add_u32 s37, s37, s38
buffer_load_dwordx4 v23, s[8:11], s37 offen sc1 lds
s_add_u32 m0, s39, 100352
s_add_u32 s37, s37, s38
buffer_load_dwordx4 v23, s[8:11], s37 offen sc1 lds
s_add_u32 m0, s39, 101376
s_add_u32 s37, s37, s38
buffer_load_dwordx4 v23, s[8:11], s37 offen sc1 lds
s_add_u32 m0, s39, 102400
s_add_u32 s37, s37, s55
buffer_load_dwordx4 v23, s[8:11], s37 offen sc1 lds
s_add_u32 m0, s39, 103424
s_add_u32 s37, s37, s38
buffer_load_dwordx4 v23, s[8:11], s37 offen sc1 lds
s_add_u32 m0, s39, 104448
s_add_u32 s37, s37, s38
buffer_load_dwordx4 v23, s[8:11], s37 offen sc1 lds
s_add_u32 m0, s39, 105472
s_add_u32 s37, s37, s38
buffer_load_dwordx4 v23, s[8:11], s37 offen sc1 lds
s_waitcnt vmcnt(32)
s_barrier
s_add_u32 m0, s39, 122880
s_add_u32 s37, s37, s40
buffer_load_dwordx4 v23, s[8:11], s37 offen sc1 lds
s_add_u32 m0, s39, 123904
s_add_u32 s37, s37, s38
buffer_load_dwordx4 v23, s[8:11], s37 offen sc1 lds
s_add_u32 m0, s39, 124928
s_add_u32 s37, s37, s38
buffer_load_dwordx4 v23, s[8:11], s37 offen sc1 lds
s_add_u32 m0, s39, 125952
s_add_u32 s37, s37, s38
buffer_load_dwordx4 v23, s[8:11], s37 offen sc1 lds
s_add_u32 m0, s39, 126976
s_add_u32 s37, s37, s55
buffer_load_dwordx4 v23, s[8:11], s37 offen sc1 lds
s_add_u32 m0, s39, 128000
s_add_u32 s37, s37, s38
buffer_load_dwordx4 v23, s[8:11], s37 offen sc1 lds
s_add_u32 m0, s39, 129024
s_add_u32 s37, s37, s38
buffer_load_dwordx4 v23, s[8:11], s37 offen sc1 lds
s_add_u32 m0, s39, 130048
s_add_u32 s37, s37, s38
buffer_load_dwordx4 v23, s[8:11], s37 offen sc1 lds
s_waitcnt vmcnt(32)
s_barrier
s_add_u32 m0, s39, 0
s_add_u32 s37, s37, s40
buffer_load_dwordx4 v23, s[8:11], s37 offen sc1 lds
s_add_u32 m0, s39, 1024
s_add_u32 s37, s37, s38
buffer_load_dwordx4 v23, s[8:11], s37 offen sc1 lds
s_add_u32 m0, s39, 2048
s_add_u32 s37, s37, s38
buffer_load_dwordx4 v23, s[8:11], s37 offen sc1 lds
s_add_u32 m0, s39, 3072
s_add_u32 s37, s37, s38
buffer_load_dwordx4 v23, s[8:11], s37 offen sc1 lds
s_add_u32 m0, s39, 4096
s_add_u32 s37, s37, s55
buffer_load_dwordx4 v23, s[8:11], s37 offen sc1 lds
s_add_u32 m0, s39, 5120
s_add_u32 s37, s37, s38
buffer_load_dwordx4 v23, s[8:11], s37 offen sc1 lds
s_add_u32 m0, s39, 6144
s_add_u32 s37, s37, s38
buffer_load_dwordx4 v23, s[8:11], s37 offen sc1 lds
s_add_u32 m0, s39, 7168
s_add_u32 s37, s37, s38
buffer_load_dwordx4 v23, s[8:11], s37 offen sc1 lds
s_waitcnt vmcnt(32)
s_barrier
s_add_u32 m0, s39, 24576
s_add_u32 s37, s37, s40
buffer_load_dwordx4 v23, s[8:11], s37 offen sc1 lds
s_add_u32 m0, s39, 25600
s_add_u32 s37, s37, s38
buffer_load_dwordx4 v23, s[8:11], s37 offen sc1 lds
s_add_u32 m0, s39, 26624
s_add_u32 s37, s37, s38
buffer_load_dwordx4 v23, s[8:11], s37 offen sc1 lds
s_add_u32 m0, s39, 27648
s_add_u32 s37, s37, s38
buffer_load_dwordx4 v23, s[8:11], s37 offen sc1 lds
s_add_u32 m0, s39, 28672
s_add_u32 s37, s37, s55
buffer_load_dwordx4 v23, s[8:11], s37 offen sc1 lds
s_add_u32 m0, s39, 29696
s_add_u32 s37, s37, s38
buffer_load_dwordx4 v23, s[8:11], s37 offen sc1 lds
s_add_u32 m0, s39, 30720
s_add_u32 s37, s37, s38
buffer_load_dwordx4 v23, s[8:11], s37 offen sc1 lds
s_add_u32 m0, s39, 31744
s_add_u32 s37, s37, s38
buffer_load_dwordx4 v23, s[8:11], s37 offen sc1 lds
s_waitcnt vmcnt(32)
s_barrier
s_add_u32 m0, s39, 49152
s_add_u32 s37, s37, s40
buffer_load_dwordx4 v23, s[8:11], s37 offen sc1 lds
s_add_u32 m0, s39, 50176
s_add_u32 s37, s37, s38
buffer_load_dwordx4 v23, s[8:11], s37 offen sc1 lds
s_add_u32 m0, s39, 51200
s_add_u32 s37, s37, s38
buffer_load_dwordx4 v23, s[8:11], s37 offen sc1 lds
s_add_u32 m0, s39, 52224
s_add_u32 s37, s37, s38
buffer_load_dwordx4 v23, s[8:11], s37 offen sc1 lds
s_add_u32 m0, s39, 53248
s_add_u32 s37, s37, s55
buffer_load_dwordx4 v23, s[8:11], s37 offen sc1 lds
s_add_u32 m0, s39, 54272
s_add_u32 s37, s37, s38
buffer_load_dwordx4 v23, s[8:11], s37 offen sc1 lds
s_add_u32 m0, s39, 55296
s_add_u32 s37, s37, s38
buffer_load_dwordx4 v23, s[8:11], s37 offen sc1 lds
s_add_u32 m0, s39, 56320
s_add_u32 s37, s37, s38
buffer_load_dwordx4 v23, s[8:11], s37 offen sc1 lds
s_waitcnt vmcnt(32)
s_barrier
s_add_u32 m0, s39, 73728
s_add_u32 s37, s37, s40
buffer_load_dwordx4 v23, s[8:11], s37 offen sc1 lds
s_add_u32 m0, s39, 74752
s_add_u32 s37, s37, s38
buffer_load_dwordx4 v23, s[8:11], s37 offen sc1 lds
s_add_u32 m0, s39, 75776
s_add_u32 s37, s37, s38
buffer_load_dwordx4 v23, s[8:11], s37 offen sc1 lds
s_add_u32 m0, s39, 76800
s_add_u32 s37, s37, s38
buffer_load_dwordx4 v23, s[8:11], s37 offen sc1 lds
s_add_u32 m0, s39, 77824
s_add_u32 s37, s37, s55
buffer_load_dwordx4 v23, s[8:11], s37 offen sc1 lds
s_add_u32 m0, s39, 78848
s_add_u32 s37, s37, s38
buffer_load_dwordx4 v23, s[8:11], s37 offen sc1 lds
s_add_u32 m0, s39, 79872
s_add_u32 s37, s37, s38
buffer_load_dwordx4 v23, s[8:11], s37 offen sc1 lds
s_add_u32 m0, s39, 80896
s_add_u32 s37, s37, s38
buffer_load_dwordx4 v23, s[8:11], s37 offen sc1 lds
s_waitcnt vmcnt(32)
s_barrier
s_lshl_b32 s43, s35, 8
s_cmp_eq_u32 s51, 1
s_cselect_b32 s8, s4, s6
s_cselect_b32 s9, s5, s7
s_sub_u32 s10, 7340032, s43
s_lshl_b32 s44, s34, 18
s_add_u32 s44, s44, 4194304
s_movk_i32 s38, 28672
s_cmp_eq_u32 s51, 0
s_cselect_b32 s8, s32, s8
s_cselect_b32 s9, s33, s9
s_cselect_b32 s10, 262144, s10
s_cselect_b32 s43, s44, s43
s_cselect_b32 s38, 1024, s38
s_cselect_b32 s45, 0, -1
s_add_u32 s8, s8, s43
s_addc_u32 s9, s9, 0
s_mov_b32 s11, 0x20000
s_sub_u32 s37, 0, s38
s_lshl_b32 s39, s51, 14
v_lshrrev_b32 v19, 4, v1
v_lshlrev_b32 v20, 5, v19
v_mul_u32_u24 v19, 6912, v19
v_and_b32 v19, s45, v19
v_and_b32 v20, s45, v20
v_lshlrev_b32 v21, 4, v1
v_xor_b32 v21, v21, v20
v_add_u32 v22, v21, v19
s_and_b32 s45, s45, 128
v_xor_b32 v23, s45, v22
s_waitcnt vmcnt(24)
s_barrier
s_add_u32 m0, s39, 98304
s_add_u32 s37, s37, s38
buffer_load_dwordx4 v22, s[8:11], s37 offen sc1 lds
s_add_u32 m0, s39, 99328
s_add_u32 s37, s37, s38
buffer_load_dwordx4 v23, s[8:11], s37 offen sc1 lds
s_add_u32 m0, s39, 100352
s_add_u32 s37, s37, s38
buffer_load_dwordx4 v22, s[8:11], s37 offen sc1 lds
s_add_u32 m0, s39, 101376
s_add_u32 s37, s37, s38
buffer_load_dwordx4 v23, s[8:11], s37 offen sc1 lds
s_add_u32 m0, s39, 102400
s_add_u32 s37, s37, s38
buffer_load_dwordx4 v22, s[8:11], s37 offen sc1 lds
s_add_u32 m0, s39, 103424
s_add_u32 s37, s37, s38
buffer_load_dwordx4 v23, s[8:11], s37 offen sc1 lds
s_add_u32 m0, s39, 104448
s_add_u32 s37, s37, s38
buffer_load_dwordx4 v22, s[8:11], s37 offen sc1 lds
s_add_u32 m0, s39, 105472
s_add_u32 s37, s37, s38
buffer_load_dwordx4 v23, s[8:11], s37 offen sc1 lds
s_add_u32 m0, s39, 106496
s_add_u32 s37, s37, s38
buffer_load_dwordx4 v22, s[8:11], s37 offen sc1 lds
s_add_u32 m0, s39, 107520
s_add_u32 s37, s37, s38
buffer_load_dwordx4 v23, s[8:11], s37 offen sc1 lds
s_add_u32 m0, s39, 108544
s_add_u32 s37, s37, s38
buffer_load_dwordx4 v22, s[8:11], s37 offen sc1 lds
s_add_u32 m0, s39, 109568
s_add_u32 s37, s37, s38
buffer_load_dwordx4 v23, s[8:11], s37 offen sc1 lds
s_add_u32 m0, s39, 110592
s_add_u32 s37, s37, s38
buffer_load_dwordx4 v22, s[8:11], s37 offen sc1 lds
s_add_u32 m0, s39, 111616
s_add_u32 s37, s37, s38
buffer_load_dwordx4 v23, s[8:11], s37 offen sc1 lds
s_add_u32 m0, s39, 112640
s_add_u32 s37, s37, s38
buffer_load_dwordx4 v22, s[8:11], s37 offen sc1 lds
s_add_u32 m0, s39, 113664
s_add_u32 s37, s37, s38
buffer_load_dwordx4 v23, s[8:11], s37 offen sc1 lds
s_waitcnt vmcnt(32)
s_barrier
s_waitcnt vmcnt(24)
s_barrier
s_add_u32 m0, s39, 0
s_add_u32 s37, s37, s38
buffer_load_dwordx4 v22, s[8:11], s37 offen sc1 lds
s_add_u32 m0, s39, 1024
s_add_u32 s37, s37, s38
buffer_load_dwordx4 v23, s[8:11], s37 offen sc1 lds
s_add_u32 m0, s39, 2048
s_add_u32 s37, s37, s38
buffer_load_dwordx4 v22, s[8:11], s37 offen sc1 lds
s_add_u32 m0, s39, 3072
s_add_u32 s37, s37, s38
buffer_load_dwordx4 v23, s[8:11], s37 offen sc1 lds
s_add_u32 m0, s39, 4096
s_add_u32 s37, s37, s38
buffer_load_dwordx4 v22, s[8:11], s37 offen sc1 lds
s_add_u32 m0, s39, 5120
s_add_u32 s37, s37, s38
buffer_load_dwordx4 v23, s[8:11], s37 offen sc1 lds
s_add_u32 m0, s39, 6144
s_add_u32 s37, s37, s38
buffer_load_dwordx4 v22, s[8:11], s37 offen sc1 lds
s_add_u32 m0, s39, 7168
s_add_u32 s37, s37, s38
buffer_load_dwordx4 v23, s[8:11], s37 offen sc1 lds
s_add_u32 m0, s39, 8192
s_add_u32 s37, s37, s38
buffer_load_dwordx4 v22, s[8:11], s37 offen sc1 lds
s_add_u32 m0, s39, 9216
s_add_u32 s37, s37, s38
buffer_load_dwordx4 v23, s[8:11], s37 offen sc1 lds
s_add_u32 m0, s39, 10240
s_add_u32 s37, s37, s38
buffer_load_dwordx4 v22, s[8:11], s37 offen sc1 lds
s_add_u32 m0, s39, 11264
s_add_u32 s37, s37, s38
buffer_load_dwordx4 v23, s[8:11], s37 offen sc1 lds
s_add_u32 m0, s39, 12288
s_add_u32 s37, s37, s38
buffer_load_dwordx4 v22, s[8:11], s37 offen sc1 lds
s_add_u32 m0, s39, 13312
s_add_u32 s37, s37, s38
buffer_load_dwordx4 v23, s[8:11], s37 offen sc1 lds
s_add_u32 m0, s39, 14336
s_add_u32 s37, s37, s38
buffer_load_dwordx4 v22, s[8:11], s37 offen sc1 lds
s_add_u32 m0, s39, 15360
s_add_u32 s37, s37, s38
buffer_load_dwordx4 v23, s[8:11], s37 offen sc1 lds
s_waitcnt vmcnt(32)
s_barrier
s_barrier
s_barrier
s_add_u32 m0, s39, 49152
s_add_u32 s37, s37, s38
buffer_load_dwordx4 v22, s[8:11], s37 offen sc1 lds
s_add_u32 m0, s39, 50176
s_add_u32 s37, s37, s38
buffer_load_dwordx4 v23, s[8:11], s37 offen sc1 lds
s_add_u32 m0, s39, 51200
s_add_u32 s37, s37, s38
buffer_load_dwordx4 v22, s[8:11], s37 offen sc1 lds
s_add_u32 m0, s39, 52224
s_add_u32 s37, s37, s38
buffer_load_dwordx4 v23, s[8:11], s37 offen sc1 lds
s_add_u32 m0, s39, 53248
s_add_u32 s37, s37, s38
buffer_load_dwordx4 v22, s[8:11], s37 offen sc1 lds
s_add_u32 m0, s39, 54272
s_add_u32 s37, s37, s38
buffer_load_dwordx4 v23, s[8:11], s37 offen sc1 lds
s_add_u32 m0, s39, 55296
s_add_u32 s37, s37, s38
buffer_load_dwordx4 v22, s[8:11], s37 offen sc1 lds
s_add_u32 m0, s39, 56320
s_add_u32 s37, s37, s38
buffer_load_dwordx4 v23, s[8:11], s37 offen sc1 lds
s_add_u32 m0, s39, 57344
s_add_u32 s37, s37, s38
buffer_load_dwordx4 v22, s[8:11], s37 offen sc1 lds
s_add_u32 m0, s39, 58368
s_add_u32 s37, s37, s38
buffer_load_dwordx4 v23, s[8:11], s37 offen sc1 lds
s_add_u32 m0, s39, 59392
s_add_u32 s37, s37, s38
buffer_load_dwordx4 v22, s[8:11], s37 offen sc1 lds
s_add_u32 m0, s39, 60416
s_add_u32 s37, s37, s38
buffer_load_dwordx4 v23, s[8:11], s37 offen sc1 lds
s_add_u32 m0, s39, 61440
s_add_u32 s37, s37, s38
buffer_load_dwordx4 v22, s[8:11], s37 offen sc1 lds
s_add_u32 m0, s39, 62464
s_add_u32 s37, s37, s38
buffer_load_dwordx4 v23, s[8:11], s37 offen sc1 lds
s_add_u32 m0, s39, 63488
s_add_u32 s37, s37, s38
buffer_load_dwordx4 v22, s[8:11], s37 offen sc1 lds
s_add_u32 m0, s39, 64512
s_add_u32 s37, s37, s38
buffer_load_dwordx4 v23, s[8:11], s37 offen sc1 lds
LP3_29:
s_lshl_b32 s43, s34, 18
s_add_u32 s12, s32, s43
s_addc_u32 s13, s33, 0
s_add_u32 s12, s12, 4194304
s_addc_u32 s13, s13, 0
s_mov_b32 s14, 262144
s_mov_b32 s15, 0x20000
v_lshlrev_b32 v21, 4, v1
s_lshl_b32 s54, s36, 11
s_barrier
s_add_u32 m0, s54, 98304
s_add_u32 s43, s54, 0
buffer_load_dwordx4 v21, s[12:15], s43 offen sc1 lds
s_add_u32 m0, s54, 99328
s_add_u32 s43, s54, 1024
buffer_load_dwordx4 v21, s[12:15], s43 offen sc1 lds
s_add_u32 m0, s54, 0
s_add_u32 s43, s54, 16384
buffer_load_dwordx4 v21, s[12:15], s43 offen sc1 lds
s_add_u32 m0, s54, 1024
s_add_u32 s43, s54, 17408
buffer_load_dwordx4 v21, s[12:15], s43 offen sc1 lds
s_add_u32 m0, s54, 49152
s_add_u32 s43, s54, 32768
buffer_load_dwordx4 v21, s[12:15], s43 offen sc1 lds
s_add_u32 m0, s54, 50176
s_add_u32 s43, s54, 33792
buffer_load_dwordx4 v21, s[12:15], s43 offen sc1 lds
s_waitcnt vmcnt(4)
s_barrier
s_waitcnt vmcnt(2)
s_barrier
s_mul_i32 s43, s2, 28672
s_mul_i32 s44, s51, 7168
s_add_u32 s43, s43, s44
s_add_u32 s80, s60, s43
s_addc_u32 s81, s61, 0
s_mov_b32 s41, 3
Lp3_37:
s_add_u32 m0, s39, 98304
s_add_u32 s37, s37, s38
buffer_load_dwordx4 v22, s[8:11], s37 offen sc1 lds
s_add_u32 m0, s39, 99328
s_add_u32 s37, s37, s38
buffer_load_dwordx4 v23, s[8:11], s37 offen sc1 lds
s_add_u32 m0, s39, 100352
s_add_u32 s37, s37, s38
buffer_load_dwordx4 v22, s[8:11], s37 offen sc1 lds
s_add_u32 m0, s39, 101376
s_add_u32 s37, s37, s38
buffer_load_dwordx4 v23, s[8:11], s37 offen sc1 lds
s_add_u32 m0, s39, 102400
s_add_u32 s37, s37, s38
buffer_load_dwordx4 v22, s[8:11], s37 offen sc1 lds
s_add_u32 m0, s39, 103424
s_add_u32 s37, s37, s38
buffer_load_dwordx4 v23, s[8:11], s37 offen sc1 lds
s_add_u32 m0, s39, 104448
s_add_u32 s37, s37, s38
buffer_load_dwordx4 v22, s[8:11], s37 offen sc1 lds
s_add_u32 m0, s39, 105472
s_add_u32 s37, s37, s38
buffer_load_dwordx4 v23, s[8:11], s37 offen sc1 lds
s_add_u32 m0, s39, 106496
s_add_u32 s37, s37, s38
buffer_load_dwordx4 v22, s[8:11], s37 offen sc1 lds
s_add_u32 m0, s39, 107520
s_add_u32 s37, s37, s38
buffer_load_dwordx4 v23, s[8:11], s37 offen sc1 lds
s_add_u32 m0, s39, 108544
s_add_u32 s37, s37, s38
buffer_load_dwordx4 v22, s[8:11], s37 offen sc1 lds
s_add_u32 m0, s39, 109568
s_add_u32 s37, s37, s38
buffer_load_dwordx4 v23, s[8:11], s37 offen sc1 lds
s_add_u32 m0, s39, 110592
s_add_u32 s37, s37, s38
buffer_load_dwordx4 v22, s[8:11], s37 offen sc1 lds
s_add_u32 m0, s39, 111616
s_add_u32 s37, s37, s38
buffer_load_dwordx4 v23, s[8:11], s37 offen sc1 lds
s_add_u32 m0, s39, 112640
s_add_u32 s37, s37, s38
buffer_load_dwordx4 v22, s[8:11], s37 offen sc1 lds
s_add_u32 m0, s39, 113664
s_add_u32 s37, s37, s38
buffer_load_dwordx4 v23, s[8:11], s37 offen sc1 lds
s_load_dword s64, s[80:81], 0
s_load_dword s65, s[80:81], 64
s_load_dword s66, s[80:81], 128
s_load_dword s67, s[80:81], 192
s_load_dword s68, s[80:81], 256
s_load_dword s69, s[80:81], 320
s_load_dword s70, s[80:81], 384
s_load_dword s71, s[80:81], 448
s_load_dword s72, s[80:81], 512
s_add_u32 s80, s80, 576
s_addc_u32 s81, s81, 0
s_waitcnt vmcnt(16)
s_barrier
s_add_u32 m0, s39, 0
s_add_u32 s37, s37, s38
buffer_load_dwordx4 v22, s[8:11], s37 offen sc1 lds
s_add_u32 m0, s39, 1024
s_add_u32 s37, s37, s38
buffer_load_dwordx4 v23, s[8:11], s37 offen sc1 lds
s_add_u32 m0, s39, 2048
s_add_u32 s37, s37, s38
buffer_load_dwordx4 v22, s[8:11], s37 offen sc1 lds
s_add_u32 m0, s39, 3072
s_add_u32 s37, s37, s38
buffer_load_dwordx4 v23, s[8:11], s37 offen sc1 lds
s_add_u32 m0, s39, 4096
s_add_u32 s37, s37, s38
buffer_load_dwordx4 v22, s[8:11], s37 offen sc1 lds
s_add_u32 m0, s39, 5120
s_add_u32 s37, s37, s38
buffer_load_dwordx4 v23, s[8:11], s37 offen sc1 lds
s_add_u32 m0, s39, 6144
s_add_u32 s37, s37, s38
buffer_load_dwordx4 v22, s[8:11], s37 offen sc1 lds
s_add_u32 m0, s39, 7168
s_add_u32 s37, s37, s38
buffer_load_dwordx4 v23, s[8:11], s37 offen sc1 lds
s_add_u32 m0, s39, 8192
s_add_u32 s37, s37, s38
buffer_load_dwordx4 v22, s[8:11], s37 offen sc1 lds
s_add_u32 m0, s39, 9216
s_add_u32 s37, s37, s38
buffer_load_dwordx4 v23, s[8:11], s37 offen sc1 lds
s_add_u32 m0, s39, 10240
s_add_u32 s37, s37, s38
buffer_load_dwordx4 v22, s[8:11], s37 offen sc1 lds
s_add_u32 m0, s39, 11264
s_add_u32 s37, s37, s38
buffer_load_dwordx4 v23, s[8:11], s37 offen sc1 lds
s_add_u32 m0, s39, 12288
s_add_u32 s37, s37, s38
buffer_load_dwordx4 v22, s[8:11], s37 offen sc1 lds
s_add_u32 m0, s39, 13312
s_add_u32 s37, s37, s38
buffer_load_dwordx4 v23, s[8:11], s37 offen sc1 lds
s_add_u32 m0, s39, 14336
s_add_u32 s37, s37, s38
buffer_load_dwordx4 v22, s[8:11], s37 offen sc1 lds
s_add_u32 m0, s39, 15360
s_add_u32 s37, s37, s38
buffer_load_dwordx4 v23, s[8:11], s37 offen sc1 lds
s_load_dword s64, s[80:81], 0
s_load_dword s65, s[80:81], 64
s_load_dword s66, s[80:81], 128
s_load_dword s67, s[80:81], 192
s_load_dword s68, s[80:81], 256
s_load_dword s69, s[80:81], 320
s_load_dword s70, s[80:81], 384
s_load_dword s71, s[80:81], 448
s_load_dword s72, s[80:81], 512
s_add_u32 s80, s80, 576
s_addc_u32 s81, s81, 0
s_waitcnt vmcnt(16)
s_barrier
s_add_u32 m0, s39, 49152
s_add_u32 s37, s37, s38
buffer_load_dwordx4 v22, s[8:11], s37 offen sc1 lds
s_add_u32 m0, s39, 50176
s_add_u32 s37, s37, s38
buffer_load_dwordx4 v23, s[8:11], s37 offen sc1 lds
s_add_u32 m0, s39, 51200
s_add_u32 s37, s37, s38
buffer_load_dwordx4 v22, s[8:11], s37 offen sc1 lds
s_add_u32 m0, s39, 52224
s_add_u32 s37, s37, s38
buffer_load_dwordx4 v23, s[8:11], s37 offen sc1 lds
s_add_u32 m0, s39, 53248
s_add_u32 s37, s37, s38
buffer_load_dwordx4 v22, s[8:11], s37 offen sc1 lds
s_add_u32 m0, s39, 54272
s_add_u32 s37, s37, s38
buffer_load_dwordx4 v23, s[8:11], s37 offen sc1 lds
s_add_u32 m0, s39, 55296
s_add_u32 s37, s37, s38
buffer_load_dwordx4 v22, s[8:11], s37 offen sc1 lds
s_add_u32 m0, s39, 56320
s_add_u32 s37, s37, s38
buffer_load_dwordx4 v23, s[8:11], s37 offen sc1 lds
s_add_u32 m0, s39, 57344
s_add_u32 s37, s37, s38
buffer_load_dwordx4 v22, s[8:11], s37 offen sc1 lds
s_add_u32 m0, s39, 58368
s_add_u32 s37, s37, s38
buffer_load_dwordx4 v23, s[8:11], s37 offen sc1 lds
s_add_u32 m0, s39, 59392
s_add_u32 s37, s37, s38
buffer_load_dwordx4 v22, s[8:11], s37 offen sc1 lds
s_add_u32 m0, s39, 60416
s_add_u32 s37, s37, s38
buffer_load_dwordx4 v23, s[8:11], s37 offen sc1 lds
s_add_u32 m0, s39, 61440
s_add_u32 s37, s37, s38
buffer_load_dwordx4 v22, s[8:11], s37 offen sc1 lds
s_add_u32 m0, s39, 62464
s_add_u32 s37, s37, s38
buffer_load_dwordx4 v23, s[8:11], s37 offen sc1 lds
s_add_u32 m0, s39, 63488
s_add_u32 s37, s37, s38
buffer_load_dwordx4 v22, s[8:11], s37 offen sc1 lds
s_add_u32 m0, s39, 64512
s_add_u32 s37, s37, s38
buffer_load_dwordx4 v23, s[8:11], s37 offen sc1 lds
s_load_dword s64, s[80:81], 0
s_load_dword s65, s[80:81], 64
s_load_dword s66, s[80:81], 128
s_load_dword s67, s[80:81], 192
s_load_dword s68, s[80:81], 256
s_load_dword s69, s[80:81], 320
s_load_dword s70, s[80:81], 384
s_load_dword s71, s[80:81], 448
s_load_dword s72, s[80:81], 512
s_add_u32 s80, s80, 576
s_addc_u32 s81, s81, 0
s_waitcnt vmcnt(16)
s_barrier
s_sub_u32 s41, s41, 1
s_cmp_lg_u32 s41, 0
s_cbranch_scc1 Lp3_37
s_add_u32 m0, s39, 98304
s_add_u32 s37, s37, s38
buffer_load_dwordx4 v22, s[8:11], s37 offen sc1 lds
s_and_b32 s53, s35, 1
s_lshl_b32 s53, s53, 1
s_mul_i32 s43, s47, 3
s_add_u32 m0, s39, 99328
s_add_u32 s37, s37, s38
buffer_load_dwordx4 v23, s[8:11], s37 offen sc1 lds
s_add_u32 s53, s53, s43
v_lshlrev_b32 v19, 11, v18
v_lshl_add_u32 v19, v17, 4, v19
s_add_u32 m0, s39, 100352
s_add_u32 s37, s37, s38
buffer_load_dwordx4 v22, s[8:11], s37 offen sc1 lds
s_lshl_b32 s43, s46, 10
v_add_u32 v2, s43, v19
v_add_u32 v3, 49152, v2
s_add_u32 m0, s39, 101376
s_add_u32 s37, s37, s38
buffer_load_dwordx4 v23, s[8:11], s37 offen sc1 lds
v_add_u32 v4, 98304, v2
v_lshrrev_b32 v19, 2, v17
v_lshl_add_u32 v20, v18, 2, v19
s_add_u32 m0, s39, 102400
s_add_u32 s37, s37, s38
buffer_load_dwordx4 v22, s[8:11], s37 offen sc1 lds
v_and_b32 v21, 7, v20
v_lshlrev_b32 v20, 8, v20
v_and_b32 v19, 3, v1
s_add_u32 m0, s39, 103424
s_add_u32 s37, s37, s38
buffer_load_dwordx4 v23, s[8:11], s37 offen sc1 lds
v_lshl_add_u32 v20, v19, 3, v20
s_add_u32 s43, s53, 0
v_xor_b32 v19, s43, v21
s_add_u32 m0, s39, 104448
s_add_u32 s37, s37, s38
buffer_load_dwordx4 v22, s[8:11], s37 offen sc1 lds
v_lshl_add_u32 v5, v19, 5, v20
s_add_u32 s43, s53, 1
v_xor_b32 v19, s43, v21
s_add_u32 m0, s39, 105472
s_add_u32 s37, s37, s38
buffer_load_dwordx4 v23, s[8:11], s37 offen sc1 lds
v_lshl_add_u32 v6, v19, 5, v20
s_add_u32 s43, s53, 2
v_xor_b32 v19, s43, v21
s_add_u32 m0, s39, 106496
s_add_u32 s37, s37, s38
buffer_load_dwordx4 v22, s[8:11], s37 offen sc1 lds
v_lshl_add_u32 v7, v19, 5, v20
v_add_u32 v9, 49152, v5
v_add_u32 v10, 49152, v6
s_add_u32 m0, s39, 107520
s_add_u32 s37, s37, s38
buffer_load_dwordx4 v23, s[8:11], s37 offen sc1 lds
v_add_u32 v11, 49152, v7
v_add_u32 v13, 98304, v5
v_add_u32 v14, 98304, v6
s_add_u32 m0, s39, 108544
s_add_u32 s37, s37, s38
buffer_load_dwordx4 v22, s[8:11], s37 offen sc1 lds
v_add_u32 v15, 98304, v7
s_lshl_b32 s43, s46, 9
s_add_u32 s43, s43, 147456
s_add_u32 m0, s39, 109568
s_add_u32 s37, s37, s38
buffer_load_dwordx4 v23, s[8:11], s37 offen sc1 lds
v_lshl_add_u32 v19, v17, 3, s43
ds_read_b64 v[80:81], v19 offset:0
ds_read_b64 v[82:83], v19 offset:128
s_add_u32 m0, s39, 110592
s_add_u32 s37, s37, s38
buffer_load_dwordx4 v22, s[8:11], s37 offen sc1 lds
ds_read_b64 v[84:85], v19 offset:256
ds_read_b64 v[86:87], v19 offset:384
s_mul_i32 s43, s47, 192
s_add_u32 m0, s39, 111616
s_add_u32 s37, s37, s38
buffer_load_dwordx4 v23, s[8:11], s37 offen sc1 lds
s_add_u32 s43, s43, 148992
v_lshl_add_u32 v19, v18, 4, s43
ds_read_b128 v[48:51], v19 offset:0
s_add_u32 m0, s39, 112640
s_add_u32 s37, s37, s38
buffer_load_dwordx4 v22, s[8:11], s37 offen sc1 lds
ds_read_b128 v[52:55], v19 offset:64
ds_read_b128 v[56:59], v19 offset:128
ds_read_b128 v[60:63], v19 offset:896
s_add_u32 m0, s39, 113664
s_add_u32 s37, s37, s38
buffer_load_dwordx4 v23, s[8:11], s37 offen sc1 lds
ds_read_b128 v[64:67], v19 offset:960
ds_read_b128 v[68:71], v19 offset:1024
s_waitcnt vmcnt(16)
s_barrier
s_add_u32 m0, s39, 0
s_add_u32 s37, s37, s38
buffer_load_dwordx4 v22, s[8:11], s37 offen sc1 lds
s_waitcnt lgkmcnt(0)
v_mul_f32 v88, v81, v81
s_add_u32 m0, s39, 1024
s_add_u32 s37, s37, s38
buffer_load_dwordx4 v23, s[8:11], s37 offen sc1 lds
v_mul_f32 v228, 0xc0135761, v81
s_add_u32 m0, s39, 2048
s_add_u32 s37, s37, s38
buffer_load_dwordx4 v22, s[8:11], s37 offen sc1 lds
v_mul_f32 v89, 0xbdd2d3e8, v81
s_add_u32 m0, s39, 3072
s_add_u32 s37, s37, s38
buffer_load_dwordx4 v23, s[8:11], s37 offen sc1 lds
v_rcp_f32 v236, v88
v_mul_f32 v232, v89, v88
s_add_u32 m0, s39, 4096
s_add_u32 s37, s37, s38
buffer_load_dwordx4 v22, s[8:11], s37 offen sc1 lds
v_mul_f32 v88, v83, v83
s_add_u32 m0, s39, 5120
s_add_u32 s37, s37, s38
buffer_load_dwordx4 v23, s[8:11], s37 offen sc1 lds
v_mul_f32 v229, 0xc0135761, v83
s_add_u32 m0, s39, 6144
s_add_u32 s37, s37, s38
buffer_load_dwordx4 v22, s[8:11], s37 offen sc1 lds
v_mul_f32 v89, 0xbdd2d3e8, v83
v_rcp_f32 v237, v88
s_add_u32 m0, s39, 7168
s_add_u32 s37, s37, s38
buffer_load_dwordx4 v23, s[8:11], s37 offen sc1 lds
v_mul_f32 v233, v89, v88
s_add_u32 m0, s39, 8192
s_add_u32 s37, s37, s38
buffer_load_dwordx4 v22, s[8:11], s37 offen sc1 lds
v_mul_f32 v88, v85, v85
s_add_u32 m0, s39, 9216
s_add_u32 s37, s37, s38
buffer_load_dwordx4 v23, s[8:11], s37 offen sc1 lds
v_mul_f32 v230, 0xc0135761, v85
v_mul_f32 v89, 0xbdd2d3e8, v85
s_add_u32 m0, s39, 10240
s_add_u32 s37, s37, s38
buffer_load_dwordx4 v22, s[8:11], s37 offen sc1 lds
v_rcp_f32 v238, v88
s_add_u32 m0, s39, 11264
s_add_u32 s37, s37, s38
buffer_load_dwordx4 v23, s[8:11], s37 offen sc1 lds
v_mul_f32 v234, v89, v88
s_add_u32 m0, s39, 12288
s_add_u32 s37, s37, s38
buffer_load_dwordx4 v22, s[8:11], s37 offen sc1 lds
v_mul_f32 v88, v87, v87
v_mul_f32 v231, 0xc0135761, v87
s_add_u32 m0, s39, 13312
s_add_u32 s37, s37, s38
buffer_load_dwordx4 v23, s[8:11], s37 offen sc1 lds
v_mul_f32 v89, 0xbdd2d3e8, v87
s_add_u32 m0, s39, 14336
s_add_u32 s37, s37, s38
buffer_load_dwordx4 v22, s[8:11], s37 offen sc1 lds
v_rcp_f32 v239, v88
s_add_u32 m0, s39, 15360
s_add_u32 s37, s37, s38
buffer_load_dwordx4 v23, s[8:11], s37 offen sc1 lds
v_mul_f32 v235, v89, v88
s_mul_i32 s43, s34, 917504
s_mul_i32 s44, s35, 24576
s_add_u32 s43, s43, s44
s_add_u32 s43, s43, 8912896
s_add_u32 s24, s32, s43
s_addc_u32 s25, s33, 0
s_mov_b32 s26, 24576
s_mov_b32 s27, 0x20000
s_mov_b32 s53, 262144
s_lshl_b32 s43, s47, 13
s_lshl_b32 s44, s46, 10
s_add_u32 s43, s43, s44
v_lshlrev_b32 v19, 11, v18
v_lshl_add_u32 v19, v17, 4, v19
v_add_u32 v27, s43, v19
s_lshl_b32 s43, s47, 12
s_add_u32 s43, s43, s44
s_add_u32 s43, s43, 16384
v_and_b32 v19, 1, v18
v_lshlrev_b32 v19, 11, v19
v_lshrrev_b32 v20, 1, v18
v_lshl_add_u32 v19, v20, 8, v19
v_lshl_add_u32 v19, v17, 4, v19
v_add_u32 v28, s43, v19
s_load_dword s64, s[80:81], 0
s_load_dword s65, s[80:81], 64
s_load_dword s66, s[80:81], 128
s_load_dword s67, s[80:81], 192
s_load_dword s68, s[80:81], 256
s_load_dword s69, s[80:81], 320
s_load_dword s70, s[80:81], 384
s_load_dword s71, s[80:81], 448
s_add_u32 s80, s80, 512
s_addc_u32 s81, s81, 0
s_waitcnt vmcnt(16)
s_barrier
s_add_u32 m0, s39, 49152
s_add_u32 s37, s37, s38
buffer_load_dwordx4 v22, s[8:11], s37 offen sc1 lds
v_mul_f32 v128, -v80, v48
v_mul_f32 v129, -v80, v49
s_add_u32 m0, s39, 50176
s_add_u32 s37, s37, s38
buffer_load_dwordx4 v23, s[8:11], s37 offen sc1 lds
v_mul_f32 v130, -v80, v50
v_mul_f32 v131, -v80, v51
s_add_u32 m0, s39, 51200
s_add_u32 s37, s37, s38
buffer_load_dwordx4 v22, s[8:11], s37 offen sc1 lds
v_mul_f32 v132, -v82, v48
v_mul_f32 v133, -v82, v49
s_add_u32 m0, s39, 52224
s_add_u32 s37, s37, s38
buffer_load_dwordx4 v23, s[8:11], s37 offen sc1 lds
v_mul_f32 v134, -v82, v50
v_mul_f32 v135, -v82, v51
s_add_u32 m0, s39, 53248
s_add_u32 s37, s37, s38
buffer_load_dwordx4 v22, s[8:11], s37 offen sc1 lds
v_mul_f32 v136, -v84, v48
v_mul_f32 v137, -v84, v49
s_add_u32 m0, s39, 54272
s_add_u32 s37, s37, s38
buffer_load_dwordx4 v23, s[8:11], s37 offen sc1 lds
v_mul_f32 v138, -v84, v50
v_mul_f32 v139, -v84, v51
s_add_u32 m0, s39, 55296
s_add_u32 s37, s37, s38
buffer_load_dwordx4 v22, s[8:11], s37 offen sc1 lds
v_mul_f32 v140, -v86, v48
v_mul_f32 v141, -v86, v49
s_add_u32 m0, s39, 56320
s_add_u32 s37, s37, s38
buffer_load_dwordx4 v23, s[8:11], s37 offen sc1 lds
v_mul_f32 v142, -v86, v50
v_mul_f32 v143, -v86, v51
s_add_u32 m0, s39, 57344
s_add_u32 s37, s37, s38
buffer_load_dwordx4 v22, s[8:11], s37 offen sc1 lds
v_mul_f32 v144, -v80, v52
v_mul_f32 v145, -v80, v53
s_add_u32 m0, s39, 58368
s_add_u32 s37, s37, s38
buffer_load_dwordx4 v23, s[8:11], s37 offen sc1 lds
v_mul_f32 v146, -v80, v54
v_mul_f32 v147, -v80, v55
s_add_u32 m0, s39, 59392
s_add_u32 s37, s37, s38
buffer_load_dwordx4 v22, s[8:11], s37 offen sc1 lds
v_mul_f32 v148, -v82, v52
v_mul_f32 v149, -v82, v53
s_add_u32 m0, s39, 60416
s_add_u32 s37, s37, s38
buffer_load_dwordx4 v23, s[8:11], s37 offen sc1 lds
v_mul_f32 v150, -v82, v54
v_mul_f32 v151, -v82, v55
s_add_u32 m0, s39, 61440
s_add_u32 s37, s37, s38
buffer_load_dwordx4 v22, s[8:11], s37 offen sc1 lds
v_mul_f32 v152, -v84, v52
v_mul_f32 v153, -v84, v53
s_add_u32 m0, s39, 62464
s_add_u32 s37, s37, s38
buffer_load_dwordx4 v23, s[8:11], s37 offen sc1 lds
v_mul_f32 v154, -v84, v54
v_mul_f32 v155, -v84, v55
s_add_u32 m0, s39, 63488
s_add_u32 s37, s37, s38
buffer_load_dwordx4 v22, s[8:11], s37 offen sc1 lds
v_mul_f32 v156, -v86, v52
v_mul_f32 v157, -v86, v53
s_add_u32 m0, s39, 64512
s_add_u32 s37, s37, s38
buffer_load_dwordx4 v23, s[8:11], s37 offen sc1 lds
v_mul_f32 v158, -v86, v54
v_mul_f32 v159, -v86, v55
s_load_dword s64, s[80:81], 0
s_load_dword s65, s[80:81], 64
s_load_dword s66, s[80:81], 128
s_load_dword s67, s[80:81], 192
s_load_dword s68, s[80:81], 256
s_load_dword s69, s[80:81], 320
s_load_dword s70, s[80:81], 384
s_load_dword s71, s[80:81], 448
s_add_u32 s80, s80, 512
s_addc_u32 s81, s81, 0
s_waitcnt vmcnt(16)
s_barrier
s_add_u32 m0, s39, 98304
s_add_u32 s37, s37, s38
buffer_load_dwordx4 v22, s[8:11], s37 offen sc1 lds
v_mul_f32 v160, -v80, v56
v_mul_f32 v161, -v80, v57
s_add_u32 m0, s39, 99328
s_add_u32 s37, s37, s38
buffer_load_dwordx4 v23, s[8:11], s37 offen sc1 lds
v_mul_f32 v162, -v80, v58
v_mul_f32 v163, -v80, v59
s_add_u32 m0, s39, 100352
s_add_u32 s37, s37, s38
buffer_load_dwordx4 v22, s[8:11], s37 offen sc1 lds
v_mul_f32 v164, -v82, v56
v_mul_f32 v165, -v82, v57
s_add_u32 m0, s39, 101376
s_add_u32 s37, s37, s38
buffer_load_dwordx4 v23, s[8:11], s37 offen sc1 lds
v_mul_f32 v166, -v82, v58
v_mul_f32 v167, -v82, v59
s_add_u32 m0, s39, 102400
s_add_u32 s37, s37, s38
buffer_load_dwordx4 v22, s[8:11], s37 offen sc1 lds
v_mul_f32 v168, -v84, v56
v_mul_f32 v169, -v84, v57
s_add_u32 m0, s39, 103424
s_add_u32 s37, s37, s38
buffer_load_dwordx4 v23, s[8:11], s37 offen sc1 lds
v_mul_f32 v170, -v84, v58
v_mul_f32 v171, -v84, v59
s_add_u32 m0, s39, 104448
s_add_u32 s37, s37, s38
buffer_load_dwordx4 v22, s[8:11], s37 offen sc1 lds
v_mul_f32 v172, -v86, v56
v_mul_f32 v173, -v86, v57
s_add_u32 m0, s39, 105472
s_add_u32 s37, s37, s38
buffer_load_dwordx4 v23, s[8:11], s37 offen sc1 lds
v_mul_f32 v174, -v86, v58
v_mul_f32 v175, -v86, v59
s_add_u32 m0, s39, 106496
s_add_u32 s37, s37, s38
buffer_load_dwordx4 v22, s[8:11], s37 offen sc1 lds
v_mul_f32 v176, -v80, v60
v_mul_f32 v177, -v80, v61
s_add_u32 m0, s39, 107520
s_add_u32 s37, s37, s38
buffer_load_dwordx4 v23, s[8:11], s37 offen sc1 lds
v_mul_f32 v178, -v80, v62
v_mul_f32 v179, -v80, v63
s_add_u32 m0, s39, 108544
s_add_u32 s37, s37, s38
buffer_load_dwordx4 v22, s[8:11], s37 offen sc1 lds
v_mul_f32 v180, -v82, v60
v_mul_f32 v181, -v82, v61
s_add_u32 m0, s39, 109568
s_add_u32 s37, s37, s38
buffer_load_dwordx4 v23, s[8:11], s37 offen sc1 lds
v_mul_f32 v182, -v82, v62
v_mul_f32 v183, -v82, v63
s_add_u32 m0, s39, 110592
s_add_u32 s37, s37, s38
buffer_load_dwordx4 v22, s[8:11], s37 offen sc1 lds
v_mul_f32 v184, -v84, v60
v_mul_f32 v185, -v84, v61
s_add_u32 m0, s39, 111616
s_add_u32 s37, s37, s38
buffer_load_dwordx4 v23, s[8:11], s37 offen sc1 lds
v_mul_f32 v186, -v84, v62
v_mul_f32 v187, -v84, v63
s_add_u32 m0, s39, 112640
s_add_u32 s37, s37, s38
buffer_load_dwordx4 v22, s[8:11], s37 offen sc1 lds
v_mul_f32 v188, -v86, v60
v_mul_f32 v189, -v86, v61
s_add_u32 m0, s39, 113664
s_add_u32 s37, s37, s38
buffer_load_dwordx4 v23, s[8:11], s37 offen sc1 lds
v_mul_f32 v190, -v86, v62
v_mul_f32 v191, -v86, v63
s_load_dword s64, s[80:81], 0
s_load_dword s65, s[80:81], 64
s_load_dword s66, s[80:81], 128
s_load_dword s67, s[80:81], 192
s_load_dword s68, s[80:81], 256
s_load_dword s69, s[80:81], 320
s_load_dword s70, s[80:81], 384
s_load_dword s71, s[80:81], 448
s_add_u32 s80, s80, 512
s_addc_u32 s81, s81, 0
s_waitcnt vmcnt(16)
s_barrier
s_mul_i32 s43, s35, 192
s_and_b32 s43, s43, 0xffffff80
s_add_u32 s43, s43, 4096
s_cmp_eq_u32 s51, 1
s_cselect_b32 s8, s4, s6
s_cselect_b32 s9, s5, s7
s_sub_u32 s10, 7340032, s43
s_lshl_b32 s44, s34, 18
s_add_u32 s44, s44, 4194304
s_movk_i32 s38, 28672
s_cmp_eq_u32 s51, 0
s_cselect_b32 s8, s32, s8
s_cselect_b32 s9, s33, s9
s_cselect_b32 s10, 262144, s10
s_cselect_b32 s43, s44, s43
s_cselect_b32 s38, 1024, s38
s_cselect_b32 s45, 0, -1
s_add_u32 s8, s8, s43
s_addc_u32 s9, s9, 0
s_mov_b32 s11, 0x20000
s_sub_u32 s37, 0, s38
s_lshl_b32 s39, s51, 14
v_lshrrev_b32 v19, 4, v1
v_lshlrev_b32 v20, 5, v19
v_mul_u32_u24 v19, 6912, v19
v_and_b32 v19, s45, v19
v_and_b32 v20, s45, v20
v_lshlrev_b32 v21, 4, v1
v_xor_b32 v21, v21, v20
v_add_u32 v22, v21, v19
s_and_b32 s45, s45, 128
v_xor_b32 v23, s45, v22
s_add_u32 m0, s39, 0
s_add_u32 s37, s37, s38
buffer_load_dwordx4 v22, s[8:11], s37 offen sc1 lds
v_mul_f32 v192, -v80, v64
v_mul_f32 v193, -v80, v65
s_add_u32 m0, s39, 1024
s_add_u32 s37, s37, s38
buffer_load_dwordx4 v23, s[8:11], s37 offen sc1 lds
v_mul_f32 v194, -v80, v66
v_mul_f32 v195, -v80, v67
s_add_u32 m0, s39, 2048
s_add_u32 s37, s37, s38
buffer_load_dwordx4 v22, s[8:11], s37 offen sc1 lds
v_mul_f32 v196, -v82, v64
v_mul_f32 v197, -v82, v65
s_add_u32 m0, s39, 3072
s_add_u32 s37, s37, s38
buffer_load_dwordx4 v23, s[8:11], s37 offen sc1 lds
v_mul_f32 v198, -v82, v66
v_mul_f32 v199, -v82, v67
s_add_u32 m0, s39, 4096
s_add_u32 s37, s37, s38
buffer_load_dwordx4 v22, s[8:11], s37 offen sc1 lds
v_mul_f32 v200, -v84, v64
v_mul_f32 v201, -v84, v65
s_add_u32 m0, s39, 5120
s_add_u32 s37, s37, s38
buffer_load_dwordx4 v23, s[8:11], s37 offen sc1 lds
v_mul_f32 v202, -v84, v66
v_mul_f32 v203, -v84, v67
s_add_u32 m0, s39, 6144
s_add_u32 s37, s37, s38
buffer_load_dwordx4 v22, s[8:11], s37 offen sc1 lds
v_mul_f32 v204, -v86, v64
v_mul_f32 v205, -v86, v65
s_add_u32 m0, s39, 7168
s_add_u32 s37, s37, s38
buffer_load_dwordx4 v23, s[8:11], s37 offen sc1 lds
v_mul_f32 v206, -v86, v66
v_mul_f32 v207, -v86, v67
s_add_u32 m0, s39, 8192
s_add_u32 s37, s37, s38
buffer_load_dwordx4 v22, s[8:11], s37 offen sc1 lds
v_mul_f32 v208, -v80, v68
v_mul_f32 v209, -v80, v69
s_add_u32 m0, s39, 9216
s_add_u32 s37, s37, s38
buffer_load_dwordx4 v23, s[8:11], s37 offen sc1 lds
v_mul_f32 v210, -v80, v70
v_mul_f32 v211, -v80, v71
s_add_u32 m0, s39, 10240
s_add_u32 s37, s37, s38
buffer_load_dwordx4 v22, s[8:11], s37 offen sc1 lds
v_mul_f32 v212, -v82, v68
v_mul_f32 v213, -v82, v69
s_add_u32 m0, s39, 11264
s_add_u32 s37, s37, s38
buffer_load_dwordx4 v23, s[8:11], s37 offen sc1 lds
v_mul_f32 v214, -v82, v70
v_mul_f32 v215, -v82, v71
s_add_u32 m0, s39, 12288
s_add_u32 s37, s37, s38
buffer_load_dwordx4 v22, s[8:11], s37 offen sc1 lds
v_mul_f32 v216, -v84, v68
v_mul_f32 v217, -v84, v69
s_add_u32 m0, s39, 13312
s_add_u32 s37, s37, s38
buffer_load_dwordx4 v23, s[8:11], s37 offen sc1 lds
v_mul_f32 v218, -v84, v70
v_mul_f32 v219, -v84, v71
s_add_u32 m0, s39, 14336
s_add_u32 s37, s37, s38
buffer_load_dwordx4 v22, s[8:11], s37 offen sc1 lds
v_mul_f32 v220, -v86, v68
v_mul_f32 v221, -v86, v69
s_add_u32 m0, s39, 15360
s_add_u32 s37, s37, s38
buffer_load_dwordx4 v23, s[8:11], s37 offen sc1 lds
v_mul_f32 v222, -v86, v70
v_mul_f32 v223, -v86, v71
s_load_dword s64, s[80:81], 0
s_load_dword s65, s[80:81], 64
s_load_dword s66, s[80:81], 128
s_load_dword s67, s[80:81], 192
s_load_dword s68, s[80:81], 256
s_load_dword s69, s[80:81], 320
s_load_dword s70, s[80:81], 384
s_add_u32 s80, s80, 448
s_addc_u32 s81, s81, 0
s_waitcnt vmcnt(16)
s_barrier
s_add_u32 m0, s39, 49152
s_add_u32 s37, s37, s38
buffer_load_dwordx4 v22, s[8:11], s37 offen sc1 lds
s_add_u32 m0, s39, 50176
s_add_u32 s37, s37, s38
buffer_load_dwordx4 v23, s[8:11], s37 offen sc1 lds
s_add_u32 m0, s39, 51200
s_add_u32 s37, s37, s38
buffer_load_dwordx4 v22, s[8:11], s37 offen sc1 lds
s_add_u32 m0, s39, 52224
s_add_u32 s37, s37, s38
buffer_load_dwordx4 v23, s[8:11], s37 offen sc1 lds
s_add_u32 m0, s39, 53248
s_add_u32 s37, s37, s38
buffer_load_dwordx4 v22, s[8:11], s37 offen sc1 lds
s_add_u32 m0, s39, 54272
s_add_u32 s37, s37, s38
buffer_load_dwordx4 v23, s[8:11], s37 offen sc1 lds
s_add_u32 m0, s39, 55296
s_add_u32 s37, s37, s38
buffer_load_dwordx4 v22, s[8:11], s37 offen sc1 lds
s_add_u32 m0, s39, 56320
s_add_u32 s37, s37, s38
buffer_load_dwordx4 v23, s[8:11], s37 offen sc1 lds
s_add_u32 m0, s39, 57344
s_add_u32 s37, s37, s38
buffer_load_dwordx4 v22, s[8:11], s37 offen sc1 lds
s_add_u32 m0, s39, 58368
s_add_u32 s37, s37, s38
buffer_load_dwordx4 v23, s[8:11], s37 offen sc1 lds
s_add_u32 m0, s39, 59392
s_add_u32 s37, s37, s38
buffer_load_dwordx4 v22, s[8:11], s37 offen sc1 lds
s_add_u32 m0, s39, 60416
s_add_u32 s37, s37, s38
buffer_load_dwordx4 v23, s[8:11], s37 offen sc1 lds
s_add_u32 m0, s39, 61440
s_add_u32 s37, s37, s38
buffer_load_dwordx4 v22, s[8:11], s37 offen sc1 lds
s_add_u32 m0, s39, 62464
s_add_u32 s37, s37, s38
buffer_load_dwordx4 v23, s[8:11], s37 offen sc1 lds
s_add_u32 m0, s39, 63488
s_add_u32 s37, s37, s38
buffer_load_dwordx4 v22, s[8:11], s37 offen sc1 lds
s_add_u32 m0, s39, 64512
s_add_u32 s37, s37, s38
buffer_load_dwordx4 v23, s[8:11], s37 offen sc1 lds
s_mul_i32 s44, s34, 917504
s_lshl_b32 s39, s51, 13
s_add_u32 s44, s44, s39
s_add_u32 s44, s44, 8388608
s_lshl_b32 s43, s35, 7
s_mov_b32 s10, 909312
s_movk_i32 s38, 1024
s_movk_i32 s40, 9216
s_cmp_eq_u32 s51, 2
s_cselect_b32 s8, s60, s32
s_cselect_b32 s9, s61, s33
s_cselect_b32 s10, 7338112, s10
s_cselect_b32 s43, s43, s44
s_cselect_b32 s38, 16384, s38
s_cselect_b32 s40, 81920, s40
s_cselect_b32 s55, 81920, s38
s_cselect_b32 s45, -1, 0
s_add_u32 s8, s8, s43
s_addc_u32 s9, s9, 0
s_mov_b32 s11, 0x20000
s_sub_u32 s37, 0, s40
v_lshrrev_b32 v19, 3, v1
v_mul_u32_u24 v19, 1920, v19
v_lshrrev_b32 v20, 4, v1
v_lshlrev_b32 v20, 5, v20
v_and_b32 v19, s45, v19
v_and_b32 v20, s45, v20
v_lshlrev_b32 v21, 4, v1
v_xor_b32 v21, v21, v20
v_add_u32 v21, v21, v19
s_mul_i32 s43, s38, 6
s_add_u32 s43, s43, s40
s_add_u32 s43, s43, s55
s_lshl_b32 s43, s43, 2
s_add_u32 s37, s37, s43
s_and_b32 s54, s45, 4290838528
s_waitcnt vmcnt(16)
s_barrier
s_branch LK3b_28
L7_27:
s_lshr_b32 s43, s2, 5
s_cmp_eq_u32 s43, 3
s_cbranch_scc1 Lnojob_38
s_cmp_gt_u32 s43, 3
s_cselect_b32 s43, 32, 0
s_sub_u32 s43, s2, s43
s_lshr_b32 s43, s43, 1
s_and_b32 s44, s2, 1
s_lshl_b32 s45, s44, 3
s_add_u32 s45, s45, 32
s_load_dwordx2 s[68:69], s[0:1], s45
s_mul_i32 s45, s43, 2341
s_lshr_b32 s45, s45, 16
s_mul_i32 s46, s45, 28
s_sub_u32 s46, s43, s46
v_lshrrev_b32 v4, 4, v1
s_lshl_b32 s43, s45, 8
v_add_u32 v4, s43, v4
v_mul_u32_u24 v4, 7168, v4
v_and_b32 v5, 15, v1
v_lshl_add_u32 v4, v5, 4, v4
s_lshl_b32 s43, s46, 8
v_add_u32 v4, s43, v4
s_waitcnt lgkmcnt(0)
s_mov_b32 s64, s68
s_mov_b32 s65, s69
s_mov_b32 s66, 7340032
s_mov_b32 s67, 0x20000
s_lshl_b32 s55, s45, 1
s_add_u32 s55, s55, s44
s_mul_i32 s55, s55, 14336
s_lshl_b32 s45, s46, 9
s_add_u32 s55, s55, s45
v_lshl_add_u32 v5, v5, 5, s55
s_add_u32 s72, s32, 27262976
s_addc_u32 s73, s33, 0
s_mov_b32 s74, 114688
s_mov_b32 s75, 0x20000
v_mov_b32 v32, 0
v_mov_b32 v33, 0
v_mov_b32 v34, 0
v_mov_b32 v35, 0
v_mov_b32 v36, 0
v_mov_b32 v37, 0
v_mov_b32 v38, 0
v_mov_b32 v39, 0
s_mov_b32 s52, 0x00003f80
s_mov_b32 s53, 0x3f800000
s_load_dword s82, s[80:81], 0
s_load_dword s83, s[80:81], 64
s_load_dword s84, s[80:81], 128
s_load_dword s85, s[80:81], 192
s_load_dword s86, s[80:81], 7168
s_load_dword s87, s[80:81], 7232
s_load_dword s82, s[80:81], 7296
s_load_dword s83, s[80:81], 7360
s_add_u32 s80, s80, 14336
s_addc_u32 s81, s81, 0
v_dot2_f32_bf16 v32, v128, s52, v32
v_dot2_f32_bf16 v33, v128, s53, v33
v_dot2_f32_bf16 v34, v129, s52, v34
v_dot2_f32_bf16 v35, v129, s53, v35
v_dot2_f32_bf16 v36, v130, s52, v36
v_dot2_f32_bf16 v37, v130, s53, v37
v_dot2_f32_bf16 v38, v131, s52, v38
v_dot2_f32_bf16 v39, v131, s53, v39
v_dot2_f32_bf16 v32, v132, s52, v32
v_dot2_f32_bf16 v33, v132, s53, v33
v_dot2_f32_bf16 v34, v133, s52, v34
v_dot2_f32_bf16 v35, v133, s53, v35
v_dot2_f32_bf16 v36, v134, s52, v36
v_dot2_f32_bf16 v37, v134, s53, v37
v_dot2_f32_bf16 v38, v135, s52, v38
v_dot2_f32_bf16 v39, v135, s53, v39
v_dot2_f32_bf16 v32, v136, s52, v32
v_dot2_f32_bf16 v33, v136, s53, v33
v_dot2_f32_bf16 v34, v137, s52, v34
v_dot2_f32_bf16 v35, v137, s53, v35
v_dot2_f32_bf16 v36, v138, s52, v36
v_dot2_f32_bf16 v37, v138, s53, v37
v_dot2_f32_bf16 v38, v139, s52, v38
v_dot2_f32_bf16 v39, v139, s53, v39
v_dot2_f32_bf16 v32, v140, s52, v32
v_dot2_f32_bf16 v33, v140, s53, v33
v_dot2_f32_bf16 v34, v141, s52, v34
v_dot2_f32_bf16 v35, v141, s53, v35
v_dot2_f32_bf16 v36, v142, s52, v36
v_dot2_f32_bf16 v37, v142, s53, v37
v_dot2_f32_bf16 v38, v143, s52, v38
v_dot2_f32_bf16 v39, v143, s53, v39
v_dot2_f32_bf16 v32, v144, s52, v32
v_dot2_f32_bf16 v33, v144, s53, v33
v_dot2_f32_bf16 v34, v145, s52, v34
v_dot2_f32_bf16 v35, v145, s53, v35
v_dot2_f32_bf16 v36, v146, s52, v36
v_dot2_f32_bf16 v37, v146, s53, v37
v_dot2_f32_bf16 v38, v147, s52, v38
v_dot2_f32_bf16 v39, v147, s53, v39
v_dot2_f32_bf16 v32, v148, s52, v32
v_dot2_f32_bf16 v33, v148, s53, v33
v_dot2_f32_bf16 v34, v149, s52, v34
v_dot2_f32_bf16 v35, v149, s53, v35
v_dot2_f32_bf16 v36, v150, s52, v36
v_dot2_f32_bf16 v37, v150, s53, v37
v_dot2_f32_bf16 v38, v151, s52, v38
v_dot2_f32_bf16 v39, v151, s53, v39
v_dot2_f32_bf16 v32, v152, s52, v32
v_dot2_f32_bf16 v33, v152, s53, v33
v_dot2_f32_bf16 v34, v153, s52, v34
v_dot2_f32_bf16 v35, v153, s53, v35
v_dot2_f32_bf16 v36, v154, s52, v36
v_dot2_f32_bf16 v37, v154, s53, v37
v_dot2_f32_bf16 v38, v155, s52, v38
v_dot2_f32_bf16 v39, v155, s53, v39
v_dot2_f32_bf16 v32, v156, s52, v32
v_dot2_f32_bf16 v33, v156, s53, v33
v_dot2_f32_bf16 v34, v157, s52, v34
v_dot2_f32_bf16 v35, v157, s53, v35
v_dot2_f32_bf16 v36, v158, s52, v36
v_dot2_f32_bf16 v37, v158, s53, v37
v_dot2_f32_bf16 v38, v159, s52, v38
v_dot2_f32_bf16 v39, v159, s53, v39
v_dot2_f32_bf16 v32, v160, s52, v32
v_dot2_f32_bf16 v33, v160, s53, v33
v_dot2_f32_bf16 v34, v161, s52, v34
v_dot2_f32_bf16 v35, v161, s53, v35
v_dot2_f32_bf16 v36, v162, s52, v36
v_dot2_f32_bf16 v37, v162, s53, v37
v_dot2_f32_bf16 v38, v163, s52, v38
v_dot2_f32_bf16 v39, v163, s53, v39
v_dot2_f32_bf16 v32, v164, s52, v32
v_dot2_f32_bf16 v33, v164, s53, v33
v_dot2_f32_bf16 v34, v165, s52, v34
v_dot2_f32_bf16 v35, v165, s53, v35
v_dot2_f32_bf16 v36, v166, s52, v36
v_dot2_f32_bf16 v37, v166, s53, v37
v_dot2_f32_bf16 v38, v167, s52, v38
v_dot2_f32_bf16 v39, v167, s53, v39
v_dot2_f32_bf16 v32, v168, s52, v32
v_dot2_f32_bf16 v33, v168, s53, v33
v_dot2_f32_bf16 v34, v169, s52, v34
v_dot2_f32_bf16 v35, v169, s53, v35
v_dot2_f32_bf16 v36, v170, s52, v36
v_dot2_f32_bf16 v37, v170, s53, v37
v_dot2_f32_bf16 v38, v171, s52, v38
v_dot2_f32_bf16 v39, v171, s53, v39
v_dot2_f32_bf16 v32, v172, s52, v32
v_dot2_f32_bf16 v33, v172, s53, v33
v_dot2_f32_bf16 v34, v173, s52, v34
v_dot2_f32_bf16 v35, v173, s53, v35
v_dot2_f32_bf16 v36, v174, s52, v36
v_dot2_f32_bf16 v37, v174, s53, v37
v_dot2_f32_bf16 v38, v175, s52, v38
v_dot2_f32_bf16 v39, v175, s53, v39
v_dot2_f32_bf16 v32, v176, s52, v32
v_dot2_f32_bf16 v33, v176, s53, v33
v_dot2_f32_bf16 v34, v177, s52, v34
v_dot2_f32_bf16 v35, v177, s53, v35
v_dot2_f32_bf16 v36, v178, s52, v36
v_dot2_f32_bf16 v37, v178, s53, v37
v_dot2_f32_bf16 v38, v179, s52, v38
v_dot2_f32_bf16 v39, v179, s53, v39
v_dot2_f32_bf16 v32, v180, s52, v32
v_dot2_f32_bf16 v33, v180, s53, v33
v_dot2_f32_bf16 v34, v181, s52, v34
v_dot2_f32_bf16 v35, v181, s53, v35
v_dot2_f32_bf16 v36, v182, s52, v36
v_dot2_f32_bf16 v37, v182, s53, v37
v_dot2_f32_bf16 v38, v183, s52, v38
v_dot2_f32_bf16 v39, v183, s53, v39
v_dot2_f32_bf16 v32, v184, s52, v32
v_dot2_f32_bf16 v33, v184, s53, v33
v_dot2_f32_bf16 v34, v185, s52, v34
v_dot2_f32_bf16 v35, v185, s53, v35
v_dot2_f32_bf16 v36, v186, s52, v36
v_dot2_f32_bf16 v37, v186, s53, v37
v_dot2_f32_bf16 v38, v187, s52, v38
v_dot2_f32_bf16 v39, v187, s53, v39
v_dot2_f32_bf16 v32, v188, s52, v32
v_dot2_f32_bf16 v33, v188, s53, v33
v_dot2_f32_bf16 v34, v189, s52, v34
v_dot2_f32_bf16 v35, v189, s53, v35
v_dot2_f32_bf16 v36, v190, s52, v36
v_dot2_f32_bf16 v37, v190, s53, v37
v_dot2_f32_bf16 v38, v191, s52, v38
v_dot2_f32_bf16 v39, v191, s53, v39
v_dot2_f32_bf16 v32, v192, s52, v32
v_dot2_f32_bf16 v33, v192, s53, v33
v_dot2_f32_bf16 v34, v193, s52, v34
v_dot2_f32_bf16 v35, v193, s53, v35
v_dot2_f32_bf16 v36, v194, s52, v36
v_dot2_f32_bf16 v37, v194, s53, v37
v_dot2_f32_bf16 v38, v195, s52, v38
v_dot2_f32_bf16 v39, v195, s53, v39
v_dot2_f32_bf16 v32, v196, s52, v32
v_dot2_f32_bf16 v33, v196, s53, v33
v_dot2_f32_bf16 v34, v197, s52, v34
v_dot2_f32_bf16 v35, v197, s53, v35
v_dot2_f32_bf16 v36, v198, s52, v36
v_dot2_f32_bf16 v37, v198, s53, v37
v_dot2_f32_bf16 v38, v199, s52, v38
v_dot2_f32_bf16 v39, v199, s53, v39
v_dot2_f32_bf16 v32, v200, s52, v32
v_dot2_f32_bf16 v33, v200, s53, v33
v_dot2_f32_bf16 v34, v201, s52, v34
v_dot2_f32_bf16 v35, v201, s53, v35
v_dot2_f32_bf16 v36, v202, s52, v36
v_dot2_f32_bf16 v37, v202, s53, v37
v_dot2_f32_bf16 v38, v203, s52, v38
v_dot2_f32_bf16 v39, v203, s53, v39
v_dot2_f32_bf16 v32, v204, s52, v32
v_dot2_f32_bf16 v33, v204, s53, v33
v_dot2_f32_bf16 v34, v205, s52, v34
v_dot2_f32_bf16 v35, v205, s53, v35
v_dot2_f32_bf16 v36, v206, s52, v36
v_dot2_f32_bf16 v37, v206, s53, v37
v_dot2_f32_bf16 v38, v207, s52, v38
v_dot2_f32_bf16 v39, v207, s53, v39
v_dot2_f32_bf16 v32, v208, s52, v32
v_dot2_f32_bf16 v33, v208, s53, v33
v_dot2_f32_bf16 v34, v209, s52, v34
v_dot2_f32_bf16 v35, v209, s53, v35
v_dot2_f32_bf16 v36, v210, s52, v36
v_dot2_f32_bf16 v37, v210, s53, v37
v_dot2_f32_bf16 v38, v211, s52, v38
v_dot2_f32_bf16 v39, v211, s53, v39
v_dot2_f32_bf16 v32, v212, s52, v32
v_dot2_f32_bf16 v33, v212, s53, v33
v_dot2_f32_bf16 v34, v213, s52, v34
v_dot2_f32_bf16 v35, v213, s53, v35
v_dot2_f32_bf16 v36, v214, s52, v36
v_dot2_f32_bf16 v37, v214, s53, v37
v_dot2_f32_bf16 v38, v215, s52, v38
v_dot2_f32_bf16 v39, v215, s53, v39
v_dot2_f32_bf16 v32, v216, s52, v32
v_dot2_f32_bf16 v33, v216, s53, v33
v_dot2_f32_bf16 v34, v217, s52, v34
v_dot2_f32_bf16 v35, v217, s53, v35
v_dot2_f32_bf16 v36, v218, s52, v36
v_dot2_f32_bf16 v37, v218, s53, v37
v_dot2_f32_bf16 v38, v219, s52, v38
v_dot2_f32_bf16 v39, v219, s53, v39
v_dot2_f32_bf16 v32, v220, s52, v32
v_dot2_f32_bf16 v33, v220, s53, v33
v_dot2_f32_bf16 v34, v221, s52, v34
v_dot2_f32_bf16 v35, v221, s53, v35
v_dot2_f32_bf16 v36, v222, s52, v36
v_dot2_f32_bf16 v37, v222, s53, v37
v_dot2_f32_bf16 v38, v223, s52, v38
v_dot2_f32_bf16 v39, v223, s53, v39
v_dot2_f32_bf16 v32, v224, s52, v32
v_dot2_f32_bf16 v33, v224, s53, v33
v_dot2_f32_bf16 v34, v225, s52, v34
v_dot2_f32_bf16 v35, v225, s53, v35
v_dot2_f32_bf16 v36, v226, s52, v36
v_dot2_f32_bf16 v37, v226, s53, v37
v_dot2_f32_bf16 v38, v227, s52, v38
v_dot2_f32_bf16 v39, v227, s53, v39
v_dot2_f32_bf16 v32, v228, s52, v32
v_dot2_f32_bf16 v33, v228, s53, v33
v_dot2_f32_bf16 v34, v229, s52, v34
v_dot2_f32_bf16 v35, v229, s53, v35
v_dot2_f32_bf16 v36, v230, s52, v36
v_dot2_f32_bf16 v37, v230, s53, v37
v_dot2_f32_bf16 v38, v231, s52, v38
v_dot2_f32_bf16 v39, v231, s53, v39
v_dot2_f32_bf16 v32, v232, s52, v32
v_dot2_f32_bf16 v33, v232, s53, v33
v_dot2_f32_bf16 v34, v233, s52, v34
v_dot2_f32_bf16 v35, v233, s53, v35
v_dot2_f32_bf16 v36, v234, s52, v36
v_dot2_f32_bf16 v37, v234, s53, v37
v_dot2_f32_bf16 v38, v235, s52, v38
v_dot2_f32_bf16 v39, v235, s53, v39
v_dot2_f32_bf16 v32, v236, s52, v32
v_dot2_f32_bf16 v33, v236, s53, v33
v_dot2_f32_bf16 v34, v237, s52, v34
v_dot2_f32_bf16 v35, v237, s53, v35
v_dot2_f32_bf16 v36, v238, s52, v36
v_dot2_f32_bf16 v37, v238, s53, v37
v_dot2_f32_bf16 v38, v239, s52, v38
v_dot2_f32_bf16 v39, v239, s53, v39
v_dot2_f32_bf16 v32, v240, s52, v32
v_dot2_f32_bf16 v33, v240, s53, v33
v_dot2_f32_bf16 v34, v241, s52, v34
v_dot2_f32_bf16 v35, v241, s53, v35
v_dot2_f32_bf16 v36, v242, s52, v36
v_dot2_f32_bf16 v37, v242, s53, v37
v_dot2_f32_bf16 v38, v243, s52, v38
v_dot2_f32_bf16 v39, v243, s53, v39
v_dot2_f32_bf16 v32, v244, s52, v32
v_dot2_f32_bf16 v33, v244, s53, v33
v_dot2_f32_bf16 v34, v245, s52, v34
v_dot2_f32_bf16 v35, v245, s53, v35
v_dot2_f32_bf16 v36, v246, s52, v36
v_dot2_f32_bf16 v37, v246, s53, v37
v_dot2_f32_bf16 v38, v247, s52, v38
v_dot2_f32_bf16 v39, v247, s53, v39
v_dot2_f32_bf16 v32, v248, s52, v32
v_dot2_f32_bf16 v33, v248, s53, v33
v_dot2_f32_bf16 v34, v249, s52, v34
v_dot2_f32_bf16 v35, v249, s53, v35
v_dot2_f32_bf16 v36, v250, s52, v36
v_dot2_f32_bf16 v37, v250, s53, v37
v_dot2_f32_bf16 v38, v251, s52, v38
v_dot2_f32_bf16 v39, v251, s53, v39
v_dot2_f32_bf16 v32, v252, s52, v32
v_dot2_f32_bf16 v33, v252, s53, v33
v_dot2_f32_bf16 v34, v253, s52, v34
v_dot2_f32_bf16 v35, v253, s53, v35
v_dot2_f32_bf16 v36, v254, s52, v36
v_dot2_f32_bf16 v37, v254, s53, v37
v_dot2_f32_bf16 v38, v255, s52, v38
v_dot2_f32_bf16 v39, v255, s53, v39
s_lshl_b32 s43, s34, 18
s_add_u32 s12, s32, s43
s_addc_u32 s13, s33, 0
s_mov_b32 s14, 262144
s_mov_b32 s15, 0x20000
v_lshlrev_b32 v21, 4, v1
s_lshl_b32 s54, s36, 11
s_barrier
s_add_u32 m0, s54, 0
s_add_u32 s43, s54, 0
buffer_load_dwordx4 v21, s[12:15], s43 offen sc1 lds
s_add_u32 m0, s54, 1024
s_add_u32 s43, s54, 1024
buffer_load_dwordx4 v21, s[12:15], s43 offen sc1 lds
s_add_u32 m0, s54, 24576
s_add_u32 s43, s54, 16384
buffer_load_dwordx4 v21, s[12:15], s43 offen sc1 lds
s_add_u32 m0, s54, 25600
s_add_u32 s43, s54, 17408
buffer_load_dwordx4 v21, s[12:15], s43 offen sc1 lds
s_waitcnt vmcnt(2)
s_barrier
s_waitcnt vmcnt(0)
s_barrier
s_barrier
s_mov_b32 s43, 917504
buffer_load_dwordx4 v[128:131], v4, s[64:67], s43 offen
s_mov_b32 s43, 946176
buffer_load_dwordx4 v[132:135], v4, s[64:67], s43 offen
s_mov_b32 s43, 974848
buffer_load_dwordx4 v[136:139], v4, s[64:67], s43 offen
s_mov_b32 s43, 1003520
buffer_load_dwordx4 v[140:143], v4, s[64:67], s43 offen
s_barrier
s_mov_b32 s43, 1032192
buffer_load_dwordx4 v[144:147], v4, s[64:67], s43 offen
s_mov_b32 s43, 1060864
buffer_load_dwordx4 v[148:151], v4, s[64:67], s43 offen
s_mov_b32 s43, 1089536
buffer_load_dwordx4 v[152:155], v4, s[64:67], s43 offen
s_mov_b32 s43, 1118208
buffer_load_dwordx4 v[156:159], v4, s[64:67], s43 offen
s_barrier
s_mov_b32 s43, 1146880
buffer_load_dwordx4 v[160:163], v4, s[64:67], s43 offen
s_mov_b32 s43, 1175552
buffer_load_dwordx4 v[164:167], v4, s[64:67], s43 offen
s_mov_b32 s43, 1204224
buffer_load_dwordx4 v[168:171], v4, s[64:67], s43 offen
s_mov_b32 s43, 1232896
buffer_load_dwordx4 v[172:175], v4, s[64:67], s43 offen
s_barrier
s_mov_b32 s43, 1261568
buffer_load_dwordx4 v[176:179], v4, s[64:67], s43 offen
s_mov_b32 s43, 1290240
buffer_load_dwordx4 v[180:183], v4, s[64:67], s43 offen
s_mov_b32 s43, 1318912
buffer_load_dwordx4 v[184:187], v4, s[64:67], s43 offen
s_mov_b32 s43, 1347584
buffer_load_dwordx4 v[188:191], v4, s[64:67], s43 offen
s_barrier
s_mov_b32 s43, 1376256
buffer_load_dwordx4 v[192:195], v4, s[64:67], s43 offen
s_mov_b32 s43, 1404928
buffer_load_dwordx4 v[196:199], v4, s[64:67], s43 offen
s_mov_b32 s43, 1433600
buffer_load_dwordx4 v[200:203], v4, s[64:67], s43 offen
s_mov_b32 s43, 1462272
buffer_load_dwordx4 v[204:207], v4, s[64:67], s43 offen
s_barrier
s_mov_b32 s43, 1490944
buffer_load_dwordx4 v[208:211], v4, s[64:67], s43 offen
s_mov_b32 s43, 1519616
buffer_load_dwordx4 v[212:215], v4, s[64:67], s43 offen
s_mov_b32 s43, 1548288
buffer_load_dwordx4 v[216:219], v4, s[64:67], s43 offen
s_mov_b32 s43, 1576960
buffer_load_dwordx4 v[220:223], v4, s[64:67], s43 offen
s_waitcnt vmcnt(20)
v_dot2_f32_bf16 v32, v128, s52, v32
v_dot2_f32_bf16 v33, v128, s53, v33
v_dot2_f32_bf16 v34, v129, s52, v34
v_dot2_f32_bf16 v35, v129, s53, v35
v_dot2_f32_bf16 v36, v130, s52, v36
v_dot2_f32_bf16 v37, v130, s53, v37
v_dot2_f32_bf16 v38, v131, s52, v38
v_dot2_f32_bf16 v39, v131, s53, v39
v_dot2_f32_bf16 v32, v132, s52, v32
v_dot2_f32_bf16 v33, v132, s53, v33
v_dot2_f32_bf16 v34, v133, s52, v34
v_dot2_f32_bf16 v35, v133, s53, v35
v_dot2_f32_bf16 v36, v134, s52, v36
v_dot2_f32_bf16 v37, v134, s53, v37
v_dot2_f32_bf16 v38, v135, s52, v38
v_dot2_f32_bf16 v39, v135, s53, v39
v_dot2_f32_bf16 v32, v136, s52, v32
v_dot2_f32_bf16 v33, v136, s53, v33
v_dot2_f32_bf16 v34, v137, s52, v34
v_dot2_f32_bf16 v35, v137, s53, v35
v_dot2_f32_bf16 v36, v138, s52, v36
v_dot2_f32_bf16 v37, v138, s53, v37
v_dot2_f32_bf16 v38, v139, s52, v38
v_dot2_f32_bf16 v39, v139, s53, v39
v_dot2_f32_bf16 v32, v140, s52, v32
v_dot2_f32_bf16 v33, v140, s53, v33
v_dot2_f32_bf16 v34, v141, s52, v34
v_dot2_f32_bf16 v35, v141, s53, v35
v_dot2_f32_bf16 v36, v142, s52, v36
v_dot2_f32_bf16 v37, v142, s53, v37
v_dot2_f32_bf16 v38, v143, s52, v38
v_dot2_f32_bf16 v39, v143, s53, v39
s_barrier
s_mov_b32 s43, 1605632
buffer_load_dwordx4 v[224:227], v4, s[64:67], s43 offen
s_mov_b32 s43, 1634304
buffer_load_dwordx4 v[228:231], v4, s[64:67], s43 offen
s_mov_b32 s43, 1662976
buffer_load_dwordx4 v[232:235], v4, s[64:67], s43 offen
s_mov_b32 s43, 1691648
buffer_load_dwordx4 v[236:239], v4, s[64:67], s43 offen
s_waitcnt vmcnt(20)
v_dot2_f32_bf16 v32, v144, s52, v32
v_dot2_f32_bf16 v33, v144, s53, v33
v_dot2_f32_bf16 v34, v145, s52, v34
v_dot2_f32_bf16 v35, v145, s53, v35
v_dot2_f32_bf16 v36, v146, s52, v36
v_dot2_f32_bf16 v37, v146, s53, v37
v_dot2_f32_bf16 v38, v147, s52, v38
v_dot2_f32_bf16 v39, v147, s53, v39
v_dot2_f32_bf16 v32, v148, s52, v32
v_dot2_f32_bf16 v33, v148, s53, v33
v_dot2_f32_bf16 v34, v149, s52, v34
v_dot2_f32_bf16 v35, v149, s53, v35
v_dot2_f32_bf16 v36, v150, s52, v36
v_dot2_f32_bf16 v37, v150, s53, v37
v_dot2_f32_bf16 v38, v151, s52, v38
v_dot2_f32_bf16 v39, v151, s53, v39
v_dot2_f32_bf16 v32, v152, s52, v32
v_dot2_f32_bf16 v33, v152, s53, v33
v_dot2_f32_bf16 v34, v153, s52, v34
v_dot2_f32_bf16 v35, v153, s53, v35
v_dot2_f32_bf16 v36, v154, s52, v36
v_dot2_f32_bf16 v37, v154, s53, v37
v_dot2_f32_bf16 v38, v155, s52, v38
v_dot2_f32_bf16 v39, v155, s53, v39
v_dot2_f32_bf16 v32, v156, s52, v32
v_dot2_f32_bf16 v33, v156, s53, v33
v_dot2_f32_bf16 v34, v157, s52, v34
v_dot2_f32_bf16 v35, v157, s53, v35
v_dot2_f32_bf16 v36, v158, s52, v36
v_dot2_f32_bf16 v37, v158, s53, v37
v_dot2_f32_bf16 v38, v159, s52, v38
v_dot2_f32_bf16 v39, v159, s53, v39
s_barrier
s_mov_b32 s43, 1720320
buffer_load_dwordx4 v[240:243], v4, s[64:67], s43 offen
s_mov_b32 s43, 1748992
buffer_load_dwordx4 v[244:247], v4, s[64:67], s43 offen
s_mov_b32 s43, 1777664
buffer_load_dwordx4 v[248:251], v4, s[64:67], s43 offen
s_mov_b32 s43, 1806336
buffer_load_dwordx4 v[252:255], v4, s[64:67], s43 offen
s_waitcnt vmcnt(20)
v_dot2_f32_bf16 v32, v160, s52, v32
v_dot2_f32_bf16 v33, v160, s53, v33
v_dot2_f32_bf16 v34, v161, s52, v34
v_dot2_f32_bf16 v35, v161, s53, v35
v_dot2_f32_bf16 v36, v162, s52, v36
v_dot2_f32_bf16 v37, v162, s53, v37
v_dot2_f32_bf16 v38, v163, s52, v38
v_dot2_f32_bf16 v39, v163, s53, v39
v_dot2_f32_bf16 v32, v164, s52, v32
v_dot2_f32_bf16 v33, v164, s53, v33
v_dot2_f32_bf16 v34, v165, s52, v34
v_dot2_f32_bf16 v35, v165, s53, v35
v_dot2_f32_bf16 v36, v166, s52, v36
v_dot2_f32_bf16 v37, v166, s53, v37
v_dot2_f32_bf16 v38, v167, s52, v38
v_dot2_f32_bf16 v39, v167, s53, v39
v_dot2_f32_bf16 v32, v168, s52, v32
v_dot2_f32_bf16 v33, v168, s53, v33
v_dot2_f32_bf16 v34, v169, s52, v34
v_dot2_f32_bf16 v35, v169, s53, v35
v_dot2_f32_bf16 v36, v170, s52, v36
v_dot2_f32_bf16 v37, v170, s53, v37
v_dot2_f32_bf16 v38, v171, s52, v38
v_dot2_f32_bf16 v39, v171, s53, v39
v_dot2_f32_bf16 v32, v172, s52, v32
v_dot2_f32_bf16 v33, v172, s53, v33
v_dot2_f32_bf16 v34, v173, s52, v34
v_dot2_f32_bf16 v35, v173, s53, v35
v_dot2_f32_bf16 v36, v174, s52, v36
v_dot2_f32_bf16 v37, v174, s53, v37
v_dot2_f32_bf16 v38, v175, s52, v38
v_dot2_f32_bf16 v39, v175, s53, v39
s_barrier
s_waitcnt vmcnt(16)
v_dot2_f32_bf16 v32, v176, s52, v32
v_dot2_f32_bf16 v33, v176, s53, v33
v_dot2_f32_bf16 v34, v177, s52, v34
v_dot2_f32_bf16 v35, v177, s53, v35
v_dot2_f32_bf16 v36, v178, s52, v36
v_dot2_f32_bf16 v37, v178, s53, v37
v_dot2_f32_bf16 v38, v179, s52, v38
v_dot2_f32_bf16 v39, v179, s53, v39
v_dot2_f32_bf16 v32, v180, s52, v32
v_dot2_f32_bf16 v33, v180, s53, v33
v_dot2_f32_bf16 v34, v181, s52, v34
v_dot2_f32_bf16 v35, v181, s53, v35
v_dot2_f32_bf16 v36, v182, s52, v36
v_dot2_f32_bf16 v37, v182, s53, v37
v_dot2_f32_bf16 v38, v183, s52, v38
v_dot2_f32_bf16 v39, v183, s53, v39
v_dot2_f32_bf16 v32, v184, s52, v32
v_dot2_f32_bf16 v33, v184, s53, v33
v_dot2_f32_bf16 v34, v185, s52, v34
v_dot2_f32_bf16 v35, v185, s53, v35
v_dot2_f32_bf16 v36, v186, s52, v36
v_dot2_f32_bf16 v37, v186, s53, v37
v_dot2_f32_bf16 v38, v187, s52, v38
v_dot2_f32_bf16 v39, v187, s53, v39
v_dot2_f32_bf16 v32, v188, s52, v32
v_dot2_f32_bf16 v33, v188, s53, v33
v_dot2_f32_bf16 v34, v189, s52, v34
v_dot2_f32_bf16 v35, v189, s53, v35
v_dot2_f32_bf16 v36, v190, s52, v36
v_dot2_f32_bf16 v37, v190, s53, v37
v_dot2_f32_bf16 v38, v191, s52, v38
v_dot2_f32_bf16 v39, v191, s53, v39
s_barrier
s_waitcnt vmcnt(12)
v_dot2_f32_bf16 v32, v192, s52, v32
v_dot2_f32_bf16 v33, v192, s53, v33
v_dot2_f32_bf16 v34, v193, s52, v34
v_dot2_f32_bf16 v35, v193, s53, v35
v_dot2_f32_bf16 v36, v194, s52, v36
v_dot2_f32_bf16 v37, v194, s53, v37
v_dot2_f32_bf16 v38, v195, s52, v38
v_dot2_f32_bf16 v39, v195, s53, v39
v_dot2_f32_bf16 v32, v196, s52, v32
v_dot2_f32_bf16 v33, v196, s53, v33
v_dot2_f32_bf16 v34, v197, s52, v34
v_dot2_f32_bf16 v35, v197, s53, v35
v_dot2_f32_bf16 v36, v198, s52, v36
v_dot2_f32_bf16 v37, v198, s53, v37
v_dot2_f32_bf16 v38, v199, s52, v38
v_dot2_f32_bf16 v39, v199, s53, v39
v_dot2_f32_bf16 v32, v200, s52, v32
v_dot2_f32_bf16 v33, v200, s53, v33
v_dot2_f32_bf16 v34, v201, s52, v34
v_dot2_f32_bf16 v35, v201, s53, v35
v_dot2_f32_bf16 v36, v202, s52, v36
v_dot2_f32_bf16 v37, v202, s53, v37
v_dot2_f32_bf16 v38, v203, s52, v38
v_dot2_f32_bf16 v39, v203, s53, v39
v_dot2_f32_bf16 v32, v204, s52, v32
v_dot2_f32_bf16 v33, v204, s53, v33
v_dot2_f32_bf16 v34, v205, s52, v34
v_dot2_f32_bf16 v35, v205, s53, v35
v_dot2_f32_bf16 v36, v206, s52, v36
v_dot2_f32_bf16 v37, v206, s53, v37
v_dot2_f32_bf16 v38, v207, s52, v38
v_dot2_f32_bf16 v39, v207, s53, v39
s_barrier
s_waitcnt vmcnt(8)
v_dot2_f32_bf16 v32, v208, s52, v32
v_dot2_f32_bf16 v33, v208, s53, v33
v_dot2_f32_bf16 v34, v209, s52, v34
v_dot2_f32_bf16 v35, v209, s53, v35
v_dot2_f32_bf16 v36, v210, s52, v36
v_dot2_f32_bf16 v37, v210, s53, v37
v_dot2_f32_bf16 v38, v211, s52, v38
v_dot2_f32_bf16 v39, v211, s53, v39
v_dot2_f32_bf16 v32, v212, s52, v32
v_dot2_f32_bf16 v33, v212, s53, v33
v_dot2_f32_bf16 v34, v213, s52, v34
v_dot2_f32_bf16 v35, v213, s53, v35
v_dot2_f32_bf16 v36, v214, s52, v36
v_dot2_f32_bf16 v37, v214, s53, v37
v_dot2_f32_bf16 v38, v215, s52, v38
v_dot2_f32_bf16 v39, v215, s53, v39
v_dot2_f32_bf16 v32, v216, s52, v32
v_dot2_f32_bf16 v33, v216, s53, v33
v_dot2_f32_bf16 v34, v217, s52, v34
v_dot2_f32_bf16 v35, v217, s53, v35
v_dot2_f32_bf16 v36, v218, s52, v36
v_dot2_f32_bf16 v37, v218, s53, v37
v_dot2_f32_bf16 v38, v219, s52, v38
v_dot2_f32_bf16 v39, v219, s53, v39
v_dot2_f32_bf16 v32, v220, s52, v32
v_dot2_f32_bf16 v33, v220, s53, v33
v_dot2_f32_bf16 v34, v221, s52, v34
v_dot2_f32_bf16 v35, v221, s53, v35
v_dot2_f32_bf16 v36, v222, s52, v36
v_dot2_f32_bf16 v37, v222, s53, v37
v_dot2_f32_bf16 v38, v223, s52, v38
v_dot2_f32_bf16 v39, v223, s53, v39
s_barrier
s_waitcnt vmcnt(4)
v_dot2_f32_bf16 v32, v224, s52, v32
v_dot2_f32_bf16 v33, v224, s53, v33
v_dot2_f32_bf16 v34, v225, s52, v34
v_dot2_f32_bf16 v35, v225, s53, v35
v_dot2_f32_bf16 v36, v226, s52, v36
v_dot2_f32_bf16 v37, v226, s53, v37
v_dot2_f32_bf16 v38, v227, s52, v38
v_dot2_f32_bf16 v39, v227, s53, v39
v_dot2_f32_bf16 v32, v228, s52, v32
v_dot2_f32_bf16 v33, v228, s53, v33
v_dot2_f32_bf16 v34, v229, s52, v34
v_dot2_f32_bf16 v35, v229, s53, v35
v_dot2_f32_bf16 v36, v230, s52, v36
v_dot2_f32_bf16 v37, v230, s53, v37
v_dot2_f32_bf16 v38, v231, s52, v38
v_dot2_f32_bf16 v39, v231, s53, v39
v_dot2_f32_bf16 v32, v232, s52, v32
v_dot2_f32_bf16 v33, v232, s53, v33
v_dot2_f32_bf16 v34, v233, s52, v34
v_dot2_f32_bf16 v35, v233, s53, v35
v_dot2_f32_bf16 v36, v234, s52, v36
v_dot2_f32_bf16 v37, v234, s53, v37
v_dot2_f32_bf16 v38, v235, s52, v38
v_dot2_f32_bf16 v39, v235, s53, v39
v_dot2_f32_bf16 v32, v236, s52, v32
v_dot2_f32_bf16 v33, v236, s53, v33
v_dot2_f32_bf16 v34, v237, s52, v34
v_dot2_f32_bf16 v35, v237, s53, v35
v_dot2_f32_bf16 v36, v238, s52, v36
v_dot2_f32_bf16 v37, v238, s53, v37
v_dot2_f32_bf16 v38, v239, s52, v38
v_dot2_f32_bf16 v39, v239, s53, v39
s_barrier
s_waitcnt vmcnt(0)
v_dot2_f32_bf16 v32, v240, s52, v32
v_dot2_f32_bf16 v33, v240, s53, v33
v_dot2_f32_bf16 v34, v241, s52, v34
v_dot2_f32_bf16 v35, v241, s53, v35
v_dot2_f32_bf16 v36, v242, s52, v36
v_dot2_f32_bf16 v37, v242, s53, v37
v_dot2_f32_bf16 v38, v243, s52, v38
v_dot2_f32_bf16 v39, v243, s53, v39
v_dot2_f32_bf16 v32, v244, s52, v32
v_dot2_f32_bf16 v33, v244, s53, v33
v_dot2_f32_bf16 v34, v245, s52, v34
v_dot2_f32_bf16 v35, v245, s53, v35
v_dot2_f32_bf16 v36, v246, s52, v36
v_dot2_f32_bf16 v37, v246, s53, v37
v_dot2_f32_bf16 v38, v247, s52, v38
v_dot2_f32_bf16 v39, v247, s53, v39
v_dot2_f32_bf16 v32, v248, s52, v32
v_dot2_f32_bf16 v33, v248, s53, v33
v_dot2_f32_bf16 v34, v249, s52, v34
v_dot2_f32_bf16 v35, v249, s53, v35
v_dot2_f32_bf16 v36, v250, s52, v36
v_dot2_f32_bf16 v37, v250, s53, v37
v_dot2_f32_bf16 v38, v251, s52, v38
v_dot2_f32_bf16 v39, v251, s53, v39
v_dot2_f32_bf16 v32, v252, s52, v32
v_dot2_f32_bf16 v33, v252, s53, v33
v_dot2_f32_bf16 v34, v253, s52, v34
v_dot2_f32_bf16 v35, v253, s53, v35
v_dot2_f32_bf16 v36, v254, s52, v36
v_dot2_f32_bf16 v37, v254, s53, v37
v_dot2_f32_bf16 v38, v255, s52, v38
v_dot2_f32_bf16 v39, v255, s53, v39
s_nop 2
v_mov_b32 v40, v32
v_mov_b32 v41, v33
v_mov_b32 v42, v34
v_mov_b32 v43, v35
v_mov_b32 v44, v36
v_mov_b32 v45, v37
v_mov_b32 v46, v38
v_mov_b32 v47, v39
s_nop 0
v_permlane16_swap_b32 v32, v40
v_permlane16_swap_b32 v33, v41
v_permlane16_swap_b32 v34, v42
v_permlane16_swap_b32 v35, v43
v_permlane16_swap_b32 v36, v44
v_permlane16_swap_b32 v37, v45
v_permlane16_swap_b32 v38, v46
v_permlane16_swap_b32 v39, v47
v_add_f32 v32, v32, v40
v_add_f32 v33, v33, v41
v_add_f32 v34, v34, v42
v_add_f32 v35, v35, v43
v_add_f32 v36, v36, v44
v_add_f32 v37, v37, v45
v_add_f32 v38, v38, v46
v_add_f32 v39, v39, v47
v_mov_b32 v40, v32
v_mov_b32 v41, v33
v_mov_b32 v42, v34
v_mov_b32 v43, v35
v_mov_b32 v44, v36
v_mov_b32 v45, v37
v_mov_b32 v46, v38
v_mov_b32 v47, v39
s_nop 0
v_permlane32_swap_b32 v32, v40
v_permlane32_swap_b32 v33, v41
v_permlane32_swap_b32 v34, v42
v_permlane32_swap_b32 v35, v43
v_permlane32_swap_b32 v36, v44
v_permlane32_swap_b32 v37, v45
v_permlane32_swap_b32 v38, v46
v_permlane32_swap_b32 v39, v47
v_add_f32 v32, v32, v40
v_add_f32 v33, v33, v41
v_add_f32 v34, v34, v42
v_add_f32 v35, v35, v43
v_add_f32 v36, v36, v44
v_add_f32 v37, v37, v45
v_add_f32 v38, v38, v46
v_add_f32 v39, v39, v47
s_mov_b64 exec, 0xffff
buffer_store_dwordx4 v[32:35], v5, s[72:75], 0 offen sc1
buffer_store_dwordx4 v[36:39], v5, s[72:75], 0 offen offset:16 sc1
s_mov_b64 exec, -1
s_barrier
s_barrier
s_barrier
s_waitcnt vmcnt(0)
v_mov_b32 v12, 10240
v_mov_b32 v13, 1
s_mov_b64 exec, 1
buffer_atomic_add v13, v12, s[56:59], 0 offen sc1
s_mov_b64 exec, -1
s_branch Lcsd_39
Lnojob_38:
s_lshl_b32 s43, s34, 18
s_add_u32 s12, s32, s43
s_addc_u32 s13, s33, 0
s_mov_b32 s14, 262144
s_mov_b32 s15, 0x20000
v_lshlrev_b32 v21, 4, v1
s_lshl_b32 s54, s36, 11
s_barrier
s_add_u32 m0, s54, 0
s_add_u32 s43, s54, 0
buffer_load_dwordx4 v21, s[12:15], s43 offen sc1 lds
s_add_u32 m0, s54, 1024
s_add_u32 s43, s54, 1024
buffer_load_dwordx4 v21, s[12:15], s43 offen sc1 lds
s_add_u32 m0, s54, 24576
s_add_u32 s43, s54, 16384
buffer_load_dwordx4 v21, s[12:15], s43 offen sc1 lds
s_add_u32 m0, s54, 25600
s_add_u32 s43, s54, 17408
buffer_load_dwordx4 v21, s[12:15], s43 offen sc1 lds
s_waitcnt vmcnt(2)
s_barrier
s_waitcnt vmcnt(0)
s_barrier
s_barrier
s_barrier
s_barrier
s_barrier
s_barrier
s_barrier
s_barrier
s_barrier
s_barrier
s_barrier
s_barrier
s_barrier
s_barrier
s_barrier
s_barrier
s_barrier
Lcsd_39:
s_mov_b32 s46, 1
s_lshl_b32 s43, s34, 18
s_add_u32 s12, s32, s43
s_addc_u32 s13, s33, 0
s_add_u32 s12, s12, 4194304
s_addc_u32 s13, s13, 0
s_mov_b32 s14, 262144
s_mov_b32 s15, 0x20000
v_lshlrev_b32 v21, 4, v1
s_lshl_b32 s54, s36, 11
s_mov_b32 s88, s4
s_mov_b32 s89, s5
s_mov_b32 s90, 7340032
s_mov_b32 s91, 0x20000
s_mov_b32 s92, s6
s_mov_b32 s93, s7
s_mov_b32 s94, 7340032
s_mov_b32 s95, 0x20000
s_lshr_b32 s43, s35, 3
s_lshl_b32 s43, s43, 11
s_add_u32 s43, s43, 384
s_movk_i32 s44, 1024
s_lshr_b32 s45, s2, 3
s_mul_i32 s45, s45, 14336
s_add_u32 s43, s43, s45
v_and_b32 v19, 1, v1
v_mul_lo_u32 v31, v19, s44
v_bfe_u32 v19, v1, 1, 1
v_mul_u32_u24 v19, 7168, v19
v_add3_u32 v31, v31, v19, s43
v_bfe_u32 v19, v1, 2, 3
v_mul_u32_u24 v19, 458752, v19
v_add_u32 v31, v31, v19
s_mov_b32 s43, 1376256
buffer_load_dword v30, v31, s[88:91], s43 offen
buffer_load_dword v30, v31, s[92:95], s43 offen
s_lshl_b32 s43, s34, 14
s_add_u32 s64, s32, s43
s_addc_u32 s65, s33, 0
s_add_u32 s64, s64, 25165824
s_addc_u32 s65, s65, 0
s_mov_b32 s66, 16384
s_mov_b32 s67, 0x20000
s_add_u32 s72, s32, 27262976
s_addc_u32 s73, s33, 0
s_mov_b32 s74, 114688
s_mov_b32 s75, 0x20000
s_barrier
s_add_u32 m0, s54, 98304
s_add_u32 s43, s54, 0
buffer_load_dwordx4 v21, s[12:15], s43 offen sc1 lds
s_add_u32 m0, s54, 99328
s_add_u32 s43, s54, 1024
buffer_load_dwordx4 v21, s[12:15], s43 offen sc1 lds
s_add_u32 m0, s54, 0
s_add_u32 s43, s54, 16384
buffer_load_dwordx4 v21, s[12:15], s43 offen sc1 lds
s_add_u32 m0, s54, 1024
s_add_u32 s43, s54, 17408
buffer_load_dwordx4 v21, s[12:15], s43 offen sc1 lds
s_add_u32 m0, s54, 49152
s_add_u32 s43, s54, 32768
buffer_load_dwordx4 v21, s[12:15], s43 offen sc1 lds
s_add_u32 m0, s54, 50176
s_add_u32 s43, s54, 33792
buffer_load_dwordx4 v21, s[12:15], s43 offen sc1 lds
s_waitcnt vmcnt(4)
s_barrier
s_waitcnt vmcnt(2)
s_barrier
s_waitcnt vmcnt(0)
s_mul_i32 s43, s2, 28672
s_mul_i32 s44, s51, 7168
s_add_u32 s43, s43, s44
s_add_u32 s80, s60, s43
s_addc_u32 s81, s61, 0
s_load_dword s82, s[80:81], 0
s_load_dword s83, s[80:81], 64
s_load_dword s84, s[80:81], 128
s_load_dword s85, s[80:81], 192
s_load_dword s86, s[80:81], 256
s_load_dword s87, s[80:81], 320
s_load_dword s82, s[80:81], 384
s_load_dword s83, s[80:81], 448
s_load_dword s84, s[80:81], 512
s_load_dword s85, s[80:81], 576
s_load_dword s86, s[80:81], 640
s_add_u32 s80, s80, 704
s_addc_u32 s81, s81, 0
s_barrier
s_mov_b32 s43, 0
buffer_load_dwordx4 v[128:131], v21, s[64:67], s43 offen sc1
s_mov_b32 s43, 1024
buffer_load_dwordx4 v[132:135], v21, s[64:67], s43 offen sc1
s_mov_b32 s43, 2048
buffer_load_dwordx4 v[136:139], v21, s[64:67], s43 offen sc1
s_mov_b32 s43, 3072
buffer_load_dwordx4 v[140:143], v21, s[64:67], s43 offen sc1
s_mov_b32 s43, 4096
buffer_load_dwordx4 v[144:147], v21, s[64:67], s43 offen sc1
s_mov_b32 s43, 5120
buffer_load_dwordx4 v[148:151], v21, s[64:67], s43 offen sc1
s_mov_b32 s43, 6144
buffer_load_dwordx4 v[152:155], v21, s[64:67], s43 offen sc1
s_mov_b32 s43, 7168
buffer_load_dwordx4 v[156:159], v21, s[64:67], s43 offen sc1
s_mov_b32 s43, 8192
buffer_load_dwordx4 v[160:163], v21, s[64:67], s43 offen sc1
s_mov_b32 s43, 9216
buffer_load_dwordx4 v[164:167], v21, s[64:67], s43 offen sc1
s_mov_b32 s43, 10240
buffer_load_dwordx4 v[168:171], v21, s[64:67], s43 offen sc1
s_mov_b32 s43, 11264
buffer_load_dwordx4 v[172:175], v21, s[64:67], s43 offen sc1
s_mov_b32 s43, 12288
buffer_load_dwordx4 v[176:179], v21, s[64:67], s43 offen sc1
s_mov_b32 s43, 13312
buffer_load_dwordx4 v[180:183], v21, s[64:67], s43 offen sc1
s_mov_b32 s43, 14336
buffer_load_dwordx4 v[184:187], v21, s[64:67], s43 offen sc1
s_mov_b32 s43, 15360
buffer_load_dwordx4 v[188:191], v21, s[64:67], s43 offen sc1
s_load_dword s82, s[80:81], 0
s_load_dword s83, s[80:81], 64
s_load_dword s84, s[80:81], 128
s_load_dword s85, s[80:81], 192
s_load_dword s86, s[80:81], 256
s_load_dword s87, s[80:81], 320
s_load_dword s82, s[80:81], 384
s_load_dword s83, s[80:81], 448
s_load_dword s84, s[80:81], 512
s_load_dword s85, s[80:81], 576
s_load_dword s86, s[80:81], 640
s_add_u32 s80, s80, 704
s_addc_u32 s81, s81, 0
s_barrier
v_mov_b32 v12, 10240
v_mov_b32 v14, 224
buffer_load_dword v13, v12, s[56:59], 0 offen sc1
s_load_dword s82, s[80:81], 0
s_load_dword s83, s[80:81], 64
s_load_dword s84, s[80:81], 128
s_load_dword s85, s[80:81], 192
s_load_dword s86, s[80:81], 256
s_load_dword s87, s[80:81], 320
s_load_dword s82, s[80:81], 384
s_load_dword s83, s[80:81], 448
s_load_dword s84, s[80:81], 512
s_load_dword s85, s[80:81], 576
s_load_dword s86, s[80:81], 640
s_add_u32 s80, s80, 704
s_addc_u32 s81, s81, 0
s_barrier
s_load_dword s82, s[80:81], 0
s_load_dword s83, s[80:81], 64
s_load_dword s84, s[80:81], 128
s_load_dword s85, s[80:81], 192
s_load_dword s86, s[80:81], 256
s_load_dword s87, s[80:81], 320
s_load_dword s82, s[80:81], 384
s_load_dword s83, s[80:81], 448
s_load_dword s84, s[80:81], 512
s_load_dword s85, s[80:81], 576
s_load_dword s86, s[80:81], 640
s_add_u32 s80, s80, 704
s_addc_u32 s81, s81, 0
s_barrier
s_mov_b32 s41, 0x10000
Lpoll_40:
s_waitcnt vmcnt(0)
v_cmp_ne_u32 vcc, v14, v13
s_nop 4
s_cbranch_vccz Lpok_41
buffer_load_dword v13, v12, s[56:59], 0 offen sc1
s_sub_u32 s41, s41, 1
s_cmp_lg_u32 s41, 0
s_cbranch_scc1 Lpoll_40
s_waitcnt vmcnt(0)
Lpok_41:
v_min_u32 v12, 55, v1
v_lshlrev_b32 v13, 4, v12
s_lshl_b32 s43, s35, 9
s_mul_i32 s44, s35, 384
s_add_u32 s44, s44, 7680
v_mov_b32 v14, s44
v_mov_b32 v15, s43
v_cmp_gt_u32 vcc, 32, v12
s_nop 1
v_cndmask_b32 v14, v14, v15, vcc
v_add_u32 v14, v14, v13
v_add_u32 v13, 148480, v13
s_mov_b32 s43, 0
buffer_load_dwordx4 v[192:195], v14, s[72:75], s43 offen sc1
s_mov_b32 s43, 28672
buffer_load_dwordx4 v[196:199], v14, s[72:75], s43 offen sc1
s_mov_b32 s43, 57344
buffer_load_dwordx4 v[200:203], v14, s[72:75], s43 offen sc1
s_mov_b32 s43, 86016
buffer_load_dwordx4 v[204:207], v14, s[72:75], s43 offen sc1
s_mov_b32 s43, 14336
buffer_load_dwordx4 v[208:211], v14, s[72:75], s43 offen sc1
s_mov_b32 s43, 43008
buffer_load_dwordx4 v[212:215], v14, s[72:75], s43 offen sc1
s_mov_b32 s43, 71680
buffer_load_dwordx4 v[216:219], v14, s[72:75], s43 offen sc1
s_mov_b32 s43, 100352
buffer_load_dwordx4 v[220:223], v14, s[72:75], s43 offen sc1
s_load_dword s82, s[80:81], 0
s_load_dword s83, s[80:81], 64
s_load_dword s84, s[80:81], 128
s_load_dword s85, s[80:81], 192
s_load_dword s86, s[80:81], 256
s_load_dword s87, s[80:81], 320
s_load_dword s82, s[80:81], 384
s_load_dword s83, s[80:81], 448
s_load_dword s84, s[80:81], 512
s_load_dword s85, s[80:81], 576
s_load_dword s86, s[80:81], 640
s_add_u32 s80, s80, 704
s_addc_u32 s81, s81, 0
s_barrier
s_mov_b32 s43, 5046272
buffer_load_dword v30, v31, s[88:91], s43 offen
buffer_load_dword v30, v31, s[92:95], s43 offen
v_add_f32 v128, v128, v132
v_add_f32 v129, v129, v133
v_add_f32 v130, v130, v134
v_add_f32 v131, v131, v135
v_add_f32 v128, v128, v136
v_add_f32 v129, v129, v137
v_add_f32 v130, v130, v138
v_add_f32 v131, v131, v139
v_add_f32 v128, v128, v140
v_add_f32 v129, v129, v141
v_add_f32 v130, v130, v142
v_add_f32 v131, v131, v143
v_add_f32 v128, v128, v144
v_add_f32 v129, v129, v145
v_add_f32 v130, v130, v146
v_add_f32 v131, v131, v147
v_add_f32 v128, v128, v148
v_add_f32 v129, v129, v149
v_add_f32 v130, v130, v150
v_add_f32 v131, v131, v151
v_add_f32 v128, v128, v152
v_add_f32 v129, v129, v153
v_add_f32 v130, v130, v154
v_add_f32 v131, v131, v155
v_add_f32 v128, v128, v156
v_add_f32 v129, v129, v157
v_add_f32 v130, v130, v158
v_add_f32 v131, v131, v159
v_add_f32 v128, v128, v160
v_add_f32 v129, v129, v161
v_add_f32 v130, v130, v162
v_add_f32 v131, v131, v163
v_add_f32 v128, v128, v164
v_add_f32 v129, v129, v165
v_add_f32 v130, v130, v166
v_add_f32 v131, v131, v167
v_add_f32 v128, v128, v168
v_add_f32 v129, v129, v169
v_add_f32 v130, v130, v170
v_add_f32 v131, v131, v171
v_add_f32 v128, v128, v172
v_add_f32 v129, v129, v173
v_add_f32 v130, v130, v174
v_add_f32 v131, v131, v175
v_add_f32 v128, v128, v176
v_add_f32 v129, v129, v177
v_add_f32 v130, v130, v178
v_add_f32 v131, v131, v179
v_add_f32 v128, v128, v180
v_add_f32 v129, v129, v181
v_add_f32 v130, v130, v182
v_add_f32 v131, v131, v183
v_add_f32 v128, v128, v184
v_add_f32 v129, v129, v185
v_add_f32 v130, v130, v186
v_add_f32 v131, v131, v187
v_add_f32 v128, v128, v188
v_add_f32 v129, v129, v189
v_add_f32 v130, v130, v190
v_add_f32 v131, v131, v191
v_mul_f32 v128, 0x3a800000, v128
v_mul_f32 v129, 0x3a800000, v129
v_fma_f32 v129, -v128, v128, v129
v_max_f32 v129, 0, v129
v_add_f32 v129, 0x3727c5ac, v129
v_rsq_f32 v129, v129
v_mul_f32 v130, 0x3a800000, v130
v_mul_f32 v131, 0x3a800000, v131
v_fma_f32 v131, -v130, v130, v131
v_max_f32 v131, 0, v131
v_add_f32 v131, 0x3727c5ac, v131
v_rsq_f32 v131, v131
v_add_u32 v19, 147456, v21
ds_write_b128 v19, v[128:131]
s_load_dword s82, s[80:81], 0
s_load_dword s83, s[80:81], 64
s_load_dword s84, s[80:81], 128
s_load_dword s85, s[80:81], 192
s_load_dword s86, s[80:81], 256
s_load_dword s87, s[80:81], 320
s_load_dword s82, s[80:81], 384
s_load_dword s83, s[80:81], 448
s_load_dword s84, s[80:81], 512
s_load_dword s85, s[80:81], 576
s_load_dword s86, s[80:81], 640
s_add_u32 s80, s80, 704
s_addc_u32 s81, s81, 0
s_barrier
s_barrier
s_waitcnt vmcnt(0)
v_add_f32 v192, v192, v196
v_add_f32 v200, v200, v204
v_add_f32 v193, v193, v197
v_add_f32 v201, v201, v205
v_add_f32 v194, v194, v198
v_add_f32 v202, v202, v206
v_add_f32 v195, v195, v199
v_add_f32 v203, v203, v207
v_add_f32 v192, v192, v200
v_add_f32 v193, v193, v201
v_add_f32 v194, v194, v202
v_add_f32 v195, v195, v203
ds_write_b128 v13, v[192:195] offset:0
v_add_f32 v208, v208, v212
v_add_f32 v216, v216, v220
v_add_f32 v209, v209, v213
v_add_f32 v217, v217, v221
v_add_f32 v210, v210, v214
v_add_f32 v218, v218, v222
v_add_f32 v211, v211, v215
v_add_f32 v219, v219, v223
v_add_f32 v208, v208, v216
v_add_f32 v209, v209, v217
v_add_f32 v210, v210, v218
v_add_f32 v211, v211, v219
ds_write_b128 v13, v[208:211] offset:896
s_waitcnt lgkmcnt(0)
s_load_dword s82, s[80:81], 0
s_load_dword s83, s[80:81], 64
s_load_dword s84, s[80:81], 128
s_load_dword s85, s[80:81], 192
s_load_dword s86, s[80:81], 256
s_load_dword s87, s[80:81], 320
s_load_dword s82, s[80:81], 384
s_load_dword s83, s[80:81], 448
s_load_dword s84, s[80:81], 512
s_load_dword s85, s[80:81], 576
s_load_dword s86, s[80:81], 640
s_add_u32 s80, s80, 704
s_addc_u32 s81, s81, 0
s_barrier
s_load_dword s82, s[80:81], 0
s_load_dword s83, s[80:81], 64
s_load_dword s84, s[80:81], 128
s_load_dword s85, s[80:81], 192
s_load_dword s86, s[80:81], 256
s_load_dword s87, s[80:81], 320
s_load_dword s82, s[80:81], 384
s_load_dword s83, s[80:81], 448
s_load_dword s84, s[80:81], 512
s_load_dword s85, s[80:81], 576
s_load_dword s86, s[80:81], 640
s_add_u32 s80, s80, 704
s_addc_u32 s81, s81, 0
s_barrier
s_and_b32 s53, s35, 1
s_lshl_b32 s53, s53, 1
s_mul_i32 s43, s47, 3
s_add_u32 s53, s53, s43
v_lshlrev_b32 v19, 11, v18
v_lshl_add_u32 v19, v17, 4, v19
s_lshl_b32 s43, s46, 10
v_add_u32 v2, s43, v19
v_add_u32 v3, 49152, v2
v_add_u32 v4, 98304, v2
v_lshrrev_b32 v19, 2, v17
v_lshl_add_u32 v20, v18, 2, v19
v_and_b32 v21, 7, v20
v_lshlrev_b32 v20, 8, v20
v_and_b32 v19, 3, v1
v_lshl_add_u32 v20, v19, 3, v20
s_add_u32 s43, s53, 0
v_xor_b32 v19, s43, v21
v_lshl_add_u32 v5, v19, 5, v20
s_add_u32 s43, s53, 1
v_xor_b32 v19, s43, v21
v_lshl_add_u32 v6, v19, 5, v20
s_add_u32 s43, s53, 2
v_xor_b32 v19, s43, v21
v_lshl_add_u32 v7, v19, 5, v20
v_add_u32 v9, 49152, v5
v_add_u32 v10, 49152, v6
v_add_u32 v11, 49152, v7
v_add_u32 v13, 98304, v5
v_add_u32 v14, 98304, v6
v_add_u32 v15, 98304, v7
s_lshl_b32 s43, s46, 9
s_add_u32 s43, s43, 147456
v_lshl_add_u32 v19, v17, 3, s43
ds_read_b64 v[80:81], v19 offset:0
ds_read_b64 v[82:83], v19 offset:128
ds_read_b64 v[84:85], v19 offset:256
ds_read_b64 v[86:87], v19 offset:384
s_mul_i32 s43, s47, 192
s_add_u32 s43, s43, 148992
v_lshl_add_u32 v19, v18, 4, s43
ds_read_b128 v[48:51], v19 offset:0
ds_read_b128 v[52:55], v19 offset:64
ds_read_b128 v[56:59], v19 offset:128
ds_read_b128 v[60:63], v19 offset:896
ds_read_b128 v[64:67], v19 offset:960
ds_read_b128 v[68:71], v19 offset:1024
s_barrier
s_mov_b32 s88, s4
s_mov_b32 s89, s5
s_mov_b32 s90, 7340032
s_mov_b32 s91, 0x20000
s_mov_b32 s92, s6
s_mov_b32 s93, s7
s_mov_b32 s94, 7340032
s_mov_b32 s95, 0x20000
s_lshr_b32 s43, s35, 3
s_lshl_b32 s44, s43, 10
s_xor_b32 s44, s44, 1024
s_lshl_b32 s43, s43, 11
s_add_u32 s43, s43, 4480
s_lshr_b32 s45, s2, 3
s_mul_i32 s45, s45, 14336
s_add_u32 s43, s43, s45
v_and_b32 v19, 1, v1
v_mul_lo_u32 v31, v19, s44
v_bfe_u32 v19, v1, 1, 1
v_mul_u32_u24 v19, 7168, v19
v_add3_u32 v31, v31, v19, s43
v_bfe_u32 v19, v1, 2, 3
v_mul_u32_u24 v19, 458752, v19
v_add_u32 v31, v31, v19
s_mov_b32 s43, 0
buffer_load_dword v30, v31, s[88:91], s43 offen
buffer_load_dword v30, v31, s[92:95], s43 offen
s_waitcnt lgkmcnt(0)
v_mul_f32 v88, v81, v81
v_mul_f32 v228, 0xc0135761, v81
v_mul_f32 v89, 0xbdd2d3e8, v81
v_rcp_f32 v236, v88
v_mul_f32 v232, v89, v88
v_mul_f32 v88, v83, v83
v_mul_f32 v229, 0xc0135761, v83
v_mul_f32 v89, 0xbdd2d3e8, v83
v_rcp_f32 v237, v88
v_mul_f32 v233, v89, v88
v_mul_f32 v88, v85, v85
v_mul_f32 v230, 0xc0135761, v85
v_mul_f32 v89, 0xbdd2d3e8, v85
v_rcp_f32 v238, v88
v_mul_f32 v234, v89, v88
v_mul_f32 v88, v87, v87
v_mul_f32 v231, 0xc0135761, v87
v_mul_f32 v89, 0xbdd2d3e8, v87
v_rcp_f32 v239, v88
v_mul_f32 v235, v89, v88
s_mul_i32 s43, s34, 917504
s_mul_i32 s44, s35, 24576
s_add_u32 s43, s43, s44
s_add_u32 s43, s43, 8912896
s_add_u32 s24, s32, s43
s_addc_u32 s25, s33, 0
s_mov_b32 s26, 24576
s_mov_b32 s27, 0x20000
s_mov_b32 s53, 262144
s_lshl_b32 s43, s47, 13
s_lshl_b32 s44, s46, 10
s_add_u32 s43, s43, s44
v_lshlrev_b32 v19, 11, v18
v_lshl_add_u32 v19, v17, 4, v19
v_add_u32 v27, s43, v19
s_lshl_b32 s43, s47, 12
s_add_u32 s43, s43, s44
s_add_u32 s43, s43, 16384
v_and_b32 v19, 1, v18
v_lshlrev_b32 v19, 11, v19
v_lshrrev_b32 v20, 1, v18
v_lshl_add_u32 v19, v20, 8, v19
v_lshl_add_u32 v19, v17, 4, v19
v_add_u32 v28, s43, v19
s_load_dword s82, s[80:81], 0
s_load_dword s83, s[80:81], 64
s_load_dword s84, s[80:81], 128
s_load_dword s85, s[80:81], 192
s_load_dword s86, s[80:81], 256
s_load_dword s87, s[80:81], 320
s_load_dword s82, s[80:81], 384
s_load_dword s83, s[80:81], 448
s_add_u32 s80, s80, 512
s_addc_u32 s81, s81, 0
s_barrier
v_mul_f32 v128, -v80, v48
v_mul_f32 v129, -v80, v49
v_mul_f32 v130, -v80, v50
v_mul_f32 v131, -v80, v51
v_mul_f32 v132, -v82, v48
v_mul_f32 v133, -v82, v49
v_mul_f32 v134, -v82, v50
v_mul_f32 v135, -v82, v51
v_mul_f32 v136, -v84, v48
v_mul_f32 v137, -v84, v49
v_mul_f32 v138, -v84, v50
v_mul_f32 v139, -v84, v51
v_mul_f32 v140, -v86, v48
v_mul_f32 v141, -v86, v49
v_mul_f32 v142, -v86, v50
v_mul_f32 v143, -v86, v51
v_mul_f32 v144, -v80, v52
v_mul_f32 v145, -v80, v53
v_mul_f32 v146, -v80, v54
v_mul_f32 v147, -v80, v55
v_mul_f32 v148, -v82, v52
v_mul_f32 v149, -v82, v53
v_mul_f32 v150, -v82, v54
v_mul_f32 v151, -v82, v55
v_mul_f32 v152, -v84, v52
v_mul_f32 v153, -v84, v53
v_mul_f32 v154, -v84, v54
v_mul_f32 v155, -v84, v55
v_mul_f32 v156, -v86, v52
v_mul_f32 v157, -v86, v53
v_mul_f32 v158, -v86, v54
v_mul_f32 v159, -v86, v55
s_load_dword s82, s[80:81], 0
s_load_dword s83, s[80:81], 64
s_load_dword s84, s[80:81], 128
s_load_dword s85, s[80:81], 192
s_load_dword s86, s[80:81], 256
s_load_dword s87, s[80:81], 320
s_load_dword s82, s[80:81], 384
s_load_dword s83, s[80:81], 448
s_add_u32 s80, s80, 512
s_addc_u32 s81, s81, 0
s_barrier
v_mul_f32 v160, -v80, v56
v_mul_f32 v161, -v80, v57
v_mul_f32 v162, -v80, v58
v_mul_f32 v163, -v80, v59
v_mul_f32 v164, -v82, v56
v_mul_f32 v165, -v82, v57
v_mul_f32 v166, -v82, v58
v_mul_f32 v167, -v82, v59
v_mul_f32 v168, -v84, v56
v_mul_f32 v169, -v84, v57
v_mul_f32 v170, -v84, v58
v_mul_f32 v171, -v84, v59
v_mul_f32 v172, -v86, v56
v_mul_f32 v173, -v86, v57
v_mul_f32 v174, -v86, v58
v_mul_f32 v175, -v86, v59
v_mul_f32 v176, -v80, v60
v_mul_f32 v177, -v80, v61
v_mul_f32 v178, -v80, v62
v_mul_f32 v179, -v80, v63
v_mul_f32 v180, -v82, v60
v_mul_f32 v181, -v82, v61
v_mul_f32 v182, -v82, v62
v_mul_f32 v183, -v82, v63
v_mul_f32 v184, -v84, v60
v_mul_f32 v185, -v84, v61
v_mul_f32 v186, -v84, v62
v_mul_f32 v187, -v84, v63
v_mul_f32 v188, -v86, v60
v_mul_f32 v189, -v86, v61
v_mul_f32 v190, -v86, v62
v_mul_f32 v191, -v86, v63
s_load_dword s82, s[80:81], 0
s_load_dword s83, s[80:81], 64
s_load_dword s84, s[80:81], 128
s_load_dword s85, s[80:81], 192
s_load_dword s86, s[80:81], 256
s_load_dword s87, s[80:81], 320
s_load_dword s82, s[80:81], 384
s_load_dword s83, s[80:81], 448
s_add_u32 s80, s80, 512
s_addc_u32 s81, s81, 0
s_barrier
v_mul_f32 v192, -v80, v64
v_mul_f32 v193, -v80, v65
v_mul_f32 v194, -v80, v66
v_mul_f32 v195, -v80, v67
v_mul_f32 v196, -v82, v64
v_mul_f32 v197, -v82, v65
v_mul_f32 v198, -v82, v66
v_mul_f32 v199, -v82, v67
v_mul_f32 v200, -v84, v64
v_mul_f32 v201, -v84, v65
v_mul_f32 v202, -v84, v66
v_mul_f32 v203, -v84, v67
v_mul_f32 v204, -v86, v64
v_mul_f32 v205, -v86, v65
v_mul_f32 v206, -v86, v66
v_mul_f32 v207, -v86, v67
v_mul_f32 v208, -v80, v68
v_mul_f32 v209, -v80, v69
v_mul_f32 v210, -v80, v70
v_mul_f32 v211, -v80, v71
v_mul_f32 v212, -v82, v68
v_mul_f32 v213, -v82, v69
v_mul_f32 v214, -v82, v70
v_mul_f32 v215, -v82, v71
v_mul_f32 v216, -v84, v68
v_mul_f32 v217, -v84, v69
v_mul_f32 v218, -v84, v70
v_mul_f32 v219, -v84, v71
v_mul_f32 v220, -v86, v68
v_mul_f32 v221, -v86, v69
v_mul_f32 v222, -v86, v70
v_mul_f32 v223, -v86, v71
s_barrier
s_barrier
LK3b_28:
s_setprio 1
ds_read_b128 v[32:35], v2 offset:0
ds_read_b64_tr_b16 v[48:49], v5 offset:16384
ds_read_b64_tr_b16 v[50:51], v5 offset:20480
ds_read_b128 v[36:39], v2 offset:256
ds_read_b128 v[40:43], v2 offset:512
ds_read_b128 v[44:47], v2 offset:768
ds_read_b64_tr_b16 v[60:61], v5 offset:32768
ds_read_b64_tr_b16 v[62:63], v5 offset:36864
ds_read_b64_tr_b16 v[52:53], v6 offset:16384
ds_read_b64_tr_b16 v[54:55], v6 offset:20480
ds_read_b64_tr_b16 v[64:65], v6 offset:32768
ds_read_b64_tr_b16 v[66:67], v6 offset:36864
ds_read_b64_tr_b16 v[56:57], v7 offset:16384
ds_read_b64_tr_b16 v[58:59], v7 offset:20480
ds_read_b64_tr_b16 v[68:69], v7 offset:32768
ds_read_b64_tr_b16 v[70:71], v7 offset:36864
s_mov_b32 s41, 5
Lk3_42:
s_waitcnt lgkmcnt(0)
v_mfma_f32_16x16x32_bf16 v[128:131], v[48:51], v[32:35], v[128:131]
ds_read_b128 v[80:83], v2 offset:8192
v_mfma_f32_16x16x32_bf16 v[132:135], v[48:51], v[36:39], v[132:135]
ds_read_b64_tr_b16 v[96:97], v5 offset:24576
v_mfma_f32_16x16x32_bf16 v[136:139], v[48:51], v[40:43], v[136:139]
ds_read_b64_tr_b16 v[98:99], v5 offset:28672
v_mfma_f32_16x16x32_bf16 v[140:143], v[48:51], v[44:47], v[140:143]
ds_read_b128 v[84:87], v2 offset:8448
v_mfma_f32_16x16x32_bf16 v[176:179], v[60:63], v[32:35], v[176:179]
ds_read_b128 v[88:91], v2 offset:8704
v_mfma_f32_16x16x32_bf16 v[180:183], v[60:63], v[36:39], v[180:183]
ds_read_b128 v[92:95], v2 offset:8960
v_mfma_f32_16x16x32_bf16 v[184:187], v[60:63], v[40:43], v[184:187]
ds_read_b64_tr_b16 v[108:109], v5 offset:40960
v_mfma_f32_16x16x32_bf16 v[188:191], v[60:63], v[44:47], v[188:191]
ds_read_b64_tr_b16 v[110:111], v5 offset:45056
v_mfma_f32_16x16x32_bf16 v[144:147], v[52:55], v[32:35], v[144:147]
ds_read_b64_tr_b16 v[100:101], v6 offset:24576
v_mfma_f32_16x16x32_bf16 v[148:151], v[52:55], v[36:39], v[148:151]
ds_read_b64_tr_b16 v[102:103], v6 offset:28672
v_mfma_f32_16x16x32_bf16 v[152:155], v[52:55], v[40:43], v[152:155]
ds_read_b64_tr_b16 v[112:113], v6 offset:40960
v_mfma_f32_16x16x32_bf16 v[156:159], v[52:55], v[44:47], v[156:159]
ds_read_b64_tr_b16 v[114:115], v6 offset:45056
v_mfma_f32_16x16x32_bf16 v[192:195], v[64:67], v[32:35], v[192:195]
ds_read_b64_tr_b16 v[104:105], v7 offset:24576
v_mfma_f32_16x16x32_bf16 v[196:199], v[64:67], v[36:39], v[196:199]
ds_read_b64_tr_b16 v[106:107], v7 offset:28672
v_mfma_f32_16x16x32_bf16 v[200:203], v[64:67], v[40:43], v[200:203]
ds_read_b64_tr_b16 v[116:117], v7 offset:40960
v_mfma_f32_16x16x32_bf16 v[204:207], v[64:67], v[44:47], v[204:207]
ds_read_b64_tr_b16 v[118:119], v7 offset:45056
v_mfma_f32_16x16x32_bf16 v[160:163], v[56:59], v[32:35], v[160:163]
v_mfma_f32_16x16x32_bf16 v[164:167], v[56:59], v[36:39], v[164:167]
v_mfma_f32_16x16x32_bf16 v[168:171], v[56:59], v[40:43], v[168:171]
v_mfma_f32_16x16x32_bf16 v[172:175], v[56:59], v[44:47], v[172:175]
v_mfma_f32_16x16x32_bf16 v[208:211], v[68:71], v[32:35], v[208:211]
v_mfma_f32_16x16x32_bf16 v[212:215], v[68:71], v[36:39], v[212:215]
v_mfma_f32_16x16x32_bf16 v[216:219], v[68:71], v[40:43], v[216:219]
v_mfma_f32_16x16x32_bf16 v[220:223], v[68:71], v[44:47], v[220:223]
s_waitcnt vmcnt(0) lgkmcnt(0)
s_barrier
v_mfma_f32_16x16x32_bf16 v[128:131], v[96:99], v[80:83], v[128:131]
ds_read_b128 v[32:35], v3 offset:0
v_mfma_f32_16x16x32_bf16 v[132:135], v[96:99], v[84:87], v[132:135]
ds_read_b64_tr_b16 v[48:49], v9 offset:16384
v_mfma_f32_16x16x32_bf16 v[136:139], v[96:99], v[88:91], v[136:139]
ds_read_b64_tr_b16 v[50:51], v9 offset:20480
v_mfma_f32_16x16x32_bf16 v[140:143], v[96:99], v[92:95], v[140:143]
ds_read_b128 v[36:39], v3 offset:256
v_mfma_f32_16x16x32_bf16 v[176:179], v[108:111], v[80:83], v[176:179]
ds_read_b128 v[40:43], v3 offset:512
v_mfma_f32_16x16x32_bf16 v[180:183], v[108:111], v[84:87], v[180:183]
ds_read_b128 v[44:47], v3 offset:768
v_mfma_f32_16x16x32_bf16 v[184:187], v[108:111], v[88:91], v[184:187]
ds_read_b64_tr_b16 v[60:61], v9 offset:32768
v_mfma_f32_16x16x32_bf16 v[188:191], v[108:111], v[92:95], v[188:191]
ds_read_b64_tr_b16 v[62:63], v9 offset:36864
v_mfma_f32_16x16x32_bf16 v[144:147], v[100:103], v[80:83], v[144:147]
ds_read_b64_tr_b16 v[52:53], v10 offset:16384
v_mfma_f32_16x16x32_bf16 v[148:151], v[100:103], v[84:87], v[148:151]
ds_read_b64_tr_b16 v[54:55], v10 offset:20480
v_mfma_f32_16x16x32_bf16 v[152:155], v[100:103], v[88:91], v[152:155]
ds_read_b64_tr_b16 v[64:65], v10 offset:32768
v_mfma_f32_16x16x32_bf16 v[156:159], v[100:103], v[92:95], v[156:159]
ds_read_b64_tr_b16 v[66:67], v10 offset:36864
v_mfma_f32_16x16x32_bf16 v[192:195], v[112:115], v[80:83], v[192:195]
ds_read_b64_tr_b16 v[56:57], v11 offset:16384
v_mfma_f32_16x16x32_bf16 v[196:199], v[112:115], v[84:87], v[196:199]
ds_read_b64_tr_b16 v[58:59], v11 offset:20480
v_mfma_f32_16x16x32_bf16 v[200:203], v[112:115], v[88:91], v[200:203]
ds_read_b64_tr_b16 v[68:69], v11 offset:32768
v_mfma_f32_16x16x32_bf16 v[204:207], v[112:115], v[92:95], v[204:207]
ds_read_b64_tr_b16 v[70:71], v11 offset:36864
v_mfma_f32_16x16x32_bf16 v[160:163], v[104:107], v[80:83], v[160:163]
v_mfma_f32_16x16x32_bf16 v[164:167], v[104:107], v[84:87], v[164:167]
v_mfma_f32_16x16x32_bf16 v[168:171], v[104:107], v[88:91], v[168:171]
v_mfma_f32_16x16x32_bf16 v[172:175], v[104:107], v[92:95], v[172:175]
v_mfma_f32_16x16x32_bf16 v[208:211], v[116:119], v[80:83], v[208:211]
v_mfma_f32_16x16x32_bf16 v[212:215], v[116:119], v[84:87], v[212:215]
v_mfma_f32_16x16x32_bf16 v[216:219], v[116:119], v[88:91], v[216:219]
v_mfma_f32_16x16x32_bf16 v[220:223], v[116:119], v[92:95], v[220:223]
s_waitcnt lgkmcnt(0)
v_mfma_f32_16x16x32_bf16 v[128:131], v[48:51], v[32:35], v[128:131]
ds_read_b128 v[80:83], v3 offset:8192
v_mfma_f32_16x16x32_bf16 v[132:135], v[48:51], v[36:39], v[132:135]
ds_read_b64_tr_b16 v[96:97], v9 offset:24576
v_mfma_f32_16x16x32_bf16 v[136:139], v[48:51], v[40:43], v[136:139]
ds_read_b64_tr_b16 v[98:99], v9 offset:28672
v_mfma_f32_16x16x32_bf16 v[140:143], v[48:51], v[44:47], v[140:143]
ds_read_b128 v[84:87], v3 offset:8448
v_mfma_f32_16x16x32_bf16 v[176:179], v[60:63], v[32:35], v[176:179]
ds_read_b128 v[88:91], v3 offset:8704
v_mfma_f32_16x16x32_bf16 v[180:183], v[60:63], v[36:39], v[180:183]
ds_read_b128 v[92:95], v3 offset:8960
v_mfma_f32_16x16x32_bf16 v[184:187], v[60:63], v[40:43], v[184:187]
ds_read_b64_tr_b16 v[108:109], v9 offset:40960
v_mfma_f32_16x16x32_bf16 v[188:191], v[60:63], v[44:47], v[188:191]
ds_read_b64_tr_b16 v[110:111], v9 offset:45056
v_mfma_f32_16x16x32_bf16 v[144:147], v[52:55], v[32:35], v[144:147]
ds_read_b64_tr_b16 v[100:101], v10 offset:24576
v_mfma_f32_16x16x32_bf16 v[148:151], v[52:55], v[36:39], v[148:151]
ds_read_b64_tr_b16 v[102:103], v10 offset:28672
v_mfma_f32_16x16x32_bf16 v[152:155], v[52:55], v[40:43], v[152:155]
ds_read_b64_tr_b16 v[112:113], v10 offset:40960
v_mfma_f32_16x16x32_bf16 v[156:159], v[52:55], v[44:47], v[156:159]
ds_read_b64_tr_b16 v[114:115], v10 offset:45056
v_mfma_f32_16x16x32_bf16 v[192:195], v[64:67], v[32:35], v[192:195]
ds_read_b64_tr_b16 v[104:105], v11 offset:24576
v_mfma_f32_16x16x32_bf16 v[196:199], v[64:67], v[36:39], v[196:199]
ds_read_b64_tr_b16 v[106:107], v11 offset:28672
v_mfma_f32_16x16x32_bf16 v[200:203], v[64:67], v[40:43], v[200:203]
ds_read_b64_tr_b16 v[116:117], v11 offset:40960
v_mfma_f32_16x16x32_bf16 v[204:207], v[64:67], v[44:47], v[204:207]
ds_read_b64_tr_b16 v[118:119], v11 offset:45056
v_mfma_f32_16x16x32_bf16 v[160:163], v[56:59], v[32:35], v[160:163]
v_mfma_f32_16x16x32_bf16 v[164:167], v[56:59], v[36:39], v[164:167]
v_mfma_f32_16x16x32_bf16 v[168:171], v[56:59], v[40:43], v[168:171]
v_mfma_f32_16x16x32_bf16 v[172:175], v[56:59], v[44:47], v[172:175]
v_mfma_f32_16x16x32_bf16 v[208:211], v[68:71], v[32:35], v[208:211]
v_mfma_f32_16x16x32_bf16 v[212:215], v[68:71], v[36:39], v[212:215]
v_mfma_f32_16x16x32_bf16 v[216:219], v[68:71], v[40:43], v[216:219]
v_mfma_f32_16x16x32_bf16 v[220:223], v[68:71], v[44:47], v[220:223]
s_waitcnt lgkmcnt(0)
s_barrier
v_mfma_f32_16x16x32_bf16 v[128:131], v[96:99], v[80:83], v[128:131]
ds_read_b128 v[32:35], v4 offset:0
v_mfma_f32_16x16x32_bf16 v[132:135], v[96:99], v[84:87], v[132:135]
ds_read_b64_tr_b16 v[48:49], v13 offset:16384
v_mfma_f32_16x16x32_bf16 v[136:139], v[96:99], v[88:91], v[136:139]
ds_read_b64_tr_b16 v[50:51], v13 offset:20480
v_mfma_f32_16x16x32_bf16 v[140:143], v[96:99], v[92:95], v[140:143]
ds_read_b128 v[36:39], v4 offset:256
v_mfma_f32_16x16x32_bf16 v[176:179], v[108:111], v[80:83], v[176:179]
ds_read_b128 v[40:43], v4 offset:512
v_mfma_f32_16x16x32_bf16 v[180:183], v[108:111], v[84:87], v[180:183]
ds_read_b128 v[44:47], v4 offset:768
v_mfma_f32_16x16x32_bf16 v[184:187], v[108:111], v[88:91], v[184:187]
ds_read_b64_tr_b16 v[60:61], v13 offset:32768
v_mfma_f32_16x16x32_bf16 v[188:191], v[108:111], v[92:95], v[188:191]
ds_read_b64_tr_b16 v[62:63], v13 offset:36864
v_mfma_f32_16x16x32_bf16 v[144:147], v[100:103], v[80:83], v[144:147]
ds_read_b64_tr_b16 v[52:53], v14 offset:16384
v_mfma_f32_16x16x32_bf16 v[148:151], v[100:103], v[84:87], v[148:151]
ds_read_b64_tr_b16 v[54:55], v14 offset:20480
v_mfma_f32_16x16x32_bf16 v[152:155], v[100:103], v[88:91], v[152:155]
ds_read_b64_tr_b16 v[64:65], v14 offset:32768
v_mfma_f32_16x16x32_bf16 v[156:159], v[100:103], v[92:95], v[156:159]
ds_read_b64_tr_b16 v[66:67], v14 offset:36864
v_mfma_f32_16x16x32_bf16 v[192:195], v[112:115], v[80:83], v[192:195]
ds_read_b64_tr_b16 v[56:57], v15 offset:16384
v_mfma_f32_16x16x32_bf16 v[196:199], v[112:115], v[84:87], v[196:199]
ds_read_b64_tr_b16 v[58:59], v15 offset:20480
v_mfma_f32_16x16x32_bf16 v[200:203], v[112:115], v[88:91], v[200:203]
ds_read_b64_tr_b16 v[68:69], v15 offset:32768
v_mfma_f32_16x16x32_bf16 v[204:207], v[112:115], v[92:95], v[204:207]
ds_read_b64_tr_b16 v[70:71], v15 offset:36864
v_mfma_f32_16x16x32_bf16 v[160:163], v[104:107], v[80:83], v[160:163]
v_mfma_f32_16x16x32_bf16 v[164:167], v[104:107], v[84:87], v[164:167]
v_mfma_f32_16x16x32_bf16 v[168:171], v[104:107], v[88:91], v[168:171]
v_mfma_f32_16x16x32_bf16 v[172:175], v[104:107], v[92:95], v[172:175]
v_mfma_f32_16x16x32_bf16 v[208:211], v[116:119], v[80:83], v[208:211]
v_mfma_f32_16x16x32_bf16 v[212:215], v[116:119], v[84:87], v[212:215]
v_mfma_f32_16x16x32_bf16 v[216:219], v[116:119], v[88:91], v[216:219]
v_mfma_f32_16x16x32_bf16 v[220:223], v[116:119], v[92:95], v[220:223]
s_waitcnt lgkmcnt(0)
v_mfma_f32_16x16x32_bf16 v[128:131], v[48:51], v[32:35], v[128:131]
ds_read_b128 v[80:83], v4 offset:8192
v_mfma_f32_16x16x32_bf16 v[132:135], v[48:51], v[36:39], v[132:135]
ds_read_b64_tr_b16 v[96:97], v13 offset:24576
v_mfma_f32_16x16x32_bf16 v[136:139], v[48:51], v[40:43], v[136:139]
ds_read_b64_tr_b16 v[98:99], v13 offset:28672
v_mfma_f32_16x16x32_bf16 v[140:143], v[48:51], v[44:47], v[140:143]
ds_read_b128 v[84:87], v4 offset:8448
v_mfma_f32_16x16x32_bf16 v[176:179], v[60:63], v[32:35], v[176:179]
ds_read_b128 v[88:91], v4 offset:8704
v_mfma_f32_16x16x32_bf16 v[180:183], v[60:63], v[36:39], v[180:183]
ds_read_b128 v[92:95], v4 offset:8960
v_mfma_f32_16x16x32_bf16 v[184:187], v[60:63], v[40:43], v[184:187]
ds_read_b64_tr_b16 v[108:109], v13 offset:40960
v_mfma_f32_16x16x32_bf16 v[188:191], v[60:63], v[44:47], v[188:191]
ds_read_b64_tr_b16 v[110:111], v13 offset:45056
v_mfma_f32_16x16x32_bf16 v[144:147], v[52:55], v[32:35], v[144:147]
ds_read_b64_tr_b16 v[100:101], v14 offset:24576
v_mfma_f32_16x16x32_bf16 v[148:151], v[52:55], v[36:39], v[148:151]
ds_read_b64_tr_b16 v[102:103], v14 offset:28672
v_mfma_f32_16x16x32_bf16 v[152:155], v[52:55], v[40:43], v[152:155]
ds_read_b64_tr_b16 v[112:113], v14 offset:40960
v_mfma_f32_16x16x32_bf16 v[156:159], v[52:55], v[44:47], v[156:159]
ds_read_b64_tr_b16 v[114:115], v14 offset:45056
v_mfma_f32_16x16x32_bf16 v[192:195], v[64:67], v[32:35], v[192:195]
ds_read_b64_tr_b16 v[104:105], v15 offset:24576
v_mfma_f32_16x16x32_bf16 v[196:199], v[64:67], v[36:39], v[196:199]
ds_read_b64_tr_b16 v[106:107], v15 offset:28672
v_mfma_f32_16x16x32_bf16 v[200:203], v[64:67], v[40:43], v[200:203]
ds_read_b64_tr_b16 v[116:117], v15 offset:40960
v_mfma_f32_16x16x32_bf16 v[204:207], v[64:67], v[44:47], v[204:207]
ds_read_b64_tr_b16 v[118:119], v15 offset:45056
v_mfma_f32_16x16x32_bf16 v[160:163], v[56:59], v[32:35], v[160:163]
v_mfma_f32_16x16x32_bf16 v[164:167], v[56:59], v[36:39], v[164:167]
v_mfma_f32_16x16x32_bf16 v[168:171], v[56:59], v[40:43], v[168:171]
v_mfma_f32_16x16x32_bf16 v[172:175], v[56:59], v[44:47], v[172:175]
v_mfma_f32_16x16x32_bf16 v[208:211], v[68:71], v[32:35], v[208:211]
v_mfma_f32_16x16x32_bf16 v[212:215], v[68:71], v[36:39], v[212:215]
v_mfma_f32_16x16x32_bf16 v[216:219], v[68:71], v[40:43], v[216:219]
v_mfma_f32_16x16x32_bf16 v[220:223], v[68:71], v[44:47], v[220:223]
s_waitcnt lgkmcnt(0)
s_barrier
v_mfma_f32_16x16x32_bf16 v[128:131], v[96:99], v[80:83], v[128:131]
ds_read_b128 v[32:35], v2 offset:0
v_mfma_f32_16x16x32_bf16 v[132:135], v[96:99], v[84:87], v[132:135]
ds_read_b64_tr_b16 v[48:49], v5 offset:16384
v_mfma_f32_16x16x32_bf16 v[136:139], v[96:99], v[88:91], v[136:139]
ds_read_b64_tr_b16 v[50:51], v5 offset:20480
v_mfma_f32_16x16x32_bf16 v[140:143], v[96:99], v[92:95], v[140:143]
ds_read_b128 v[36:39], v2 offset:256
v_mfma_f32_16x16x32_bf16 v[176:179], v[108:111], v[80:83], v[176:179]
ds_read_b128 v[40:43], v2 offset:512
v_mfma_f32_16x16x32_bf16 v[180:183], v[108:111], v[84:87], v[180:183]
ds_read_b128 v[44:47], v2 offset:768
v_mfma_f32_16x16x32_bf16 v[184:187], v[108:111], v[88:91], v[184:187]
ds_read_b64_tr_b16 v[60:61], v5 offset:32768
v_mfma_f32_16x16x32_bf16 v[188:191], v[108:111], v[92:95], v[188:191]
ds_read_b64_tr_b16 v[62:63], v5 offset:36864
v_mfma_f32_16x16x32_bf16 v[144:147], v[100:103], v[80:83], v[144:147]
ds_read_b64_tr_b16 v[52:53], v6 offset:16384
v_mfma_f32_16x16x32_bf16 v[148:151], v[100:103], v[84:87], v[148:151]
ds_read_b64_tr_b16 v[54:55], v6 offset:20480
v_mfma_f32_16x16x32_bf16 v[152:155], v[100:103], v[88:91], v[152:155]
ds_read_b64_tr_b16 v[64:65], v6 offset:32768
v_mfma_f32_16x16x32_bf16 v[156:159], v[100:103], v[92:95], v[156:159]
ds_read_b64_tr_b16 v[66:67], v6 offset:36864
v_mfma_f32_16x16x32_bf16 v[192:195], v[112:115], v[80:83], v[192:195]
ds_read_b64_tr_b16 v[56:57], v7 offset:16384
v_mfma_f32_16x16x32_bf16 v[196:199], v[112:115], v[84:87], v[196:199]
ds_read_b64_tr_b16 v[58:59], v7 offset:20480
v_mfma_f32_16x16x32_bf16 v[200:203], v[112:115], v[88:91], v[200:203]
ds_read_b64_tr_b16 v[68:69], v7 offset:32768
v_mfma_f32_16x16x32_bf16 v[204:207], v[112:115], v[92:95], v[204:207]
ds_read_b64_tr_b16 v[70:71], v7 offset:36864
v_mfma_f32_16x16x32_bf16 v[160:163], v[104:107], v[80:83], v[160:163]
v_mfma_f32_16x16x32_bf16 v[164:167], v[104:107], v[84:87], v[164:167]
v_mfma_f32_16x16x32_bf16 v[168:171], v[104:107], v[88:91], v[168:171]
v_mfma_f32_16x16x32_bf16 v[172:175], v[104:107], v[92:95], v[172:175]
v_mfma_f32_16x16x32_bf16 v[208:211], v[116:119], v[80:83], v[208:211]
v_mfma_f32_16x16x32_bf16 v[212:215], v[116:119], v[84:87], v[212:215]
v_mfma_f32_16x16x32_bf16 v[216:219], v[116:119], v[88:91], v[216:219]
v_mfma_f32_16x16x32_bf16 v[220:223], v[116:119], v[92:95], v[220:223]
s_sub_u32 s41, s41, 1
s_cmp_lg_u32 s41, 0
s_cbranch_scc1 Lk3_42
s_waitcnt lgkmcnt(0)
v_mfma_f32_16x16x32_bf16 v[128:131], v[48:51], v[32:35], v[128:131]
ds_read_b128 v[80:83], v2 offset:8192
v_mfma_f32_16x16x32_bf16 v[132:135], v[48:51], v[36:39], v[132:135]
ds_read_b64_tr_b16 v[96:97], v5 offset:24576
v_mfma_f32_16x16x32_bf16 v[136:139], v[48:51], v[40:43], v[136:139]
ds_read_b64_tr_b16 v[98:99], v5 offset:28672
v_mfma_f32_16x16x32_bf16 v[140:143], v[48:51], v[44:47], v[140:143]
ds_read_b128 v[84:87], v2 offset:8448
v_mfma_f32_16x16x32_bf16 v[176:179], v[60:63], v[32:35], v[176:179]
ds_read_b128 v[88:91], v2 offset:8704
v_mfma_f32_16x16x32_bf16 v[180:183], v[60:63], v[36:39], v[180:183]
ds_read_b128 v[92:95], v2 offset:8960
v_mfma_f32_16x16x32_bf16 v[184:187], v[60:63], v[40:43], v[184:187]
ds_read_b64_tr_b16 v[108:109], v5 offset:40960
v_mfma_f32_16x16x32_bf16 v[188:191], v[60:63], v[44:47], v[188:191]
ds_read_b64_tr_b16 v[110:111], v5 offset:45056
v_mfma_f32_16x16x32_bf16 v[144:147], v[52:55], v[32:35], v[144:147]
ds_read_b64_tr_b16 v[100:101], v6 offset:24576
v_mfma_f32_16x16x32_bf16 v[148:151], v[52:55], v[36:39], v[148:151]
ds_read_b64_tr_b16 v[102:103], v6 offset:28672
v_mfma_f32_16x16x32_bf16 v[152:155], v[52:55], v[40:43], v[152:155]
ds_read_b64_tr_b16 v[112:113], v6 offset:40960
v_mfma_f32_16x16x32_bf16 v[156:159], v[52:55], v[44:47], v[156:159]
ds_read_b64_tr_b16 v[114:115], v6 offset:45056
v_mfma_f32_16x16x32_bf16 v[192:195], v[64:67], v[32:35], v[192:195]
ds_read_b64_tr_b16 v[104:105], v7 offset:24576
v_mfma_f32_16x16x32_bf16 v[196:199], v[64:67], v[36:39], v[196:199]
ds_read_b64_tr_b16 v[106:107], v7 offset:28672
v_mfma_f32_16x16x32_bf16 v[200:203], v[64:67], v[40:43], v[200:203]
ds_read_b64_tr_b16 v[116:117], v7 offset:40960
v_mfma_f32_16x16x32_bf16 v[204:207], v[64:67], v[44:47], v[204:207]
ds_read_b64_tr_b16 v[118:119], v7 offset:45056
v_mfma_f32_16x16x32_bf16 v[160:163], v[56:59], v[32:35], v[160:163]
v_mfma_f32_16x16x32_bf16 v[164:167], v[56:59], v[36:39], v[164:167]
v_mfma_f32_16x16x32_bf16 v[168:171], v[56:59], v[40:43], v[168:171]
v_mfma_f32_16x16x32_bf16 v[172:175], v[56:59], v[44:47], v[172:175]
v_mfma_f32_16x16x32_bf16 v[208:211], v[68:71], v[32:35], v[208:211]
v_mfma_f32_16x16x32_bf16 v[212:215], v[68:71], v[36:39], v[212:215]
v_mfma_f32_16x16x32_bf16 v[216:219], v[68:71], v[40:43], v[216:219]
v_mfma_f32_16x16x32_bf16 v[220:223], v[68:71], v[44:47], v[220:223]
s_waitcnt lgkmcnt(0)
s_barrier
s_cmp_eq_u32 s36, 7
s_cbranch_scc1 L7b_43
s_add_u32 m0, s39, 0
s_add_u32 s37, s37, s40
buffer_load_dwordx4 v21, s[8:11], s37 offen sc1 lds
v_mfma_f32_16x16x32_bf16 v[128:131], v[96:99], v[80:83], v[128:131]
v_mfma_f32_16x16x32_bf16 v[132:135], v[96:99], v[84:87], v[132:135]
s_add_u32 m0, s39, 1024
s_add_u32 s37, s37, s38
buffer_load_dwordx4 v21, s[8:11], s37 offen sc1 lds
v_mfma_f32_16x16x32_bf16 v[136:139], v[96:99], v[88:91], v[136:139]
s_add_u32 m0, s39, 2048
s_add_u32 s37, s37, s38
buffer_load_dwordx4 v21, s[8:11], s37 offen sc1 lds
v_mfma_f32_16x16x32_bf16 v[140:143], v[96:99], v[92:95], v[140:143]
v_mfma_f32_16x16x32_bf16 v[176:179], v[108:111], v[80:83], v[176:179]
s_add_u32 m0, s39, 3072
s_add_u32 s37, s37, s38
buffer_load_dwordx4 v21, s[8:11], s37 offen sc1 lds
v_mfma_f32_16x16x32_bf16 v[180:183], v[108:111], v[84:87], v[180:183]
s_add_u32 m0, s39, 4096
s_add_u32 s37, s37, s55
buffer_load_dwordx4 v21, s[8:11], s37 offen sc1 lds
v_mfma_f32_16x16x32_bf16 v[184:187], v[108:111], v[88:91], v[184:187]
v_mfma_f32_16x16x32_bf16 v[188:191], v[108:111], v[92:95], v[188:191]
s_add_u32 m0, s39, 5120
s_add_u32 s37, s37, s38
buffer_load_dwordx4 v21, s[8:11], s37 offen sc1 lds
v_mfma_f32_16x16x32_bf16 v[144:147], v[100:103], v[80:83], v[144:147]
s_add_u32 m0, s39, 6144
s_add_u32 s37, s37, s38
buffer_load_dwordx4 v21, s[8:11], s37 offen sc1 lds
v_mfma_f32_16x16x32_bf16 v[148:151], v[100:103], v[84:87], v[148:151]
v_mfma_f32_16x16x32_bf16 v[152:155], v[100:103], v[88:91], v[152:155]
s_add_u32 m0, s39, 7168
s_add_u32 s37, s37, s38
buffer_load_dwordx4 v21, s[8:11], s37 offen sc1 lds
v_mfma_f32_16x16x32_bf16 v[156:159], v[100:103], v[92:95], v[156:159]
s_add_u32 m0, s39, 24576
s_add_u32 s37, s37, s40
buffer_load_dwordx4 v21, s[8:11], s37 offen sc1 lds
v_mfma_f32_16x16x32_bf16 v[192:195], v[112:115], v[80:83], v[192:195]
v_mfma_f32_16x16x32_bf16 v[196:199], v[112:115], v[84:87], v[196:199]
s_add_u32 m0, s39, 25600
s_add_u32 s37, s37, s38
buffer_load_dwordx4 v21, s[8:11], s37 offen sc1 lds
v_mfma_f32_16x16x32_bf16 v[200:203], v[112:115], v[88:91], v[200:203]
s_add_u32 m0, s39, 26624
s_add_u32 s37, s37, s38
buffer_load_dwordx4 v21, s[8:11], s37 offen sc1 lds
v_mfma_f32_16x16x32_bf16 v[204:207], v[112:115], v[92:95], v[204:207]
v_mfma_f32_16x16x32_bf16 v[160:163], v[104:107], v[80:83], v[160:163]
s_add_u32 m0, s39, 27648
s_add_u32 s37, s37, s38
buffer_load_dwordx4 v21, s[8:11], s37 offen sc1 lds
v_mfma_f32_16x16x32_bf16 v[164:167], v[104:107], v[84:87], v[164:167]
s_add_u32 m0, s39, 28672
s_add_u32 s37, s37, s55
buffer_load_dwordx4 v21, s[8:11], s37 offen sc1 lds
v_mfma_f32_16x16x32_bf16 v[168:171], v[104:107], v[88:91], v[168:171]
v_mfma_f32_16x16x32_bf16 v[172:175], v[104:107], v[92:95], v[172:175]
s_add_u32 m0, s39, 29696
s_add_u32 s37, s37, s38
buffer_load_dwordx4 v21, s[8:11], s37 offen sc1 lds
v_mfma_f32_16x16x32_bf16 v[208:211], v[116:119], v[80:83], v[208:211]
s_add_u32 m0, s39, 30720
s_add_u32 s37, s37, s38
buffer_load_dwordx4 v21, s[8:11], s37 offen sc1 lds
v_mfma_f32_16x16x32_bf16 v[212:215], v[116:119], v[84:87], v[212:215]
v_mfma_f32_16x16x32_bf16 v[216:219], v[116:119], v[88:91], v[216:219]
s_add_u32 m0, s39, 31744
s_add_u32 s37, s37, s38
buffer_load_dwordx4 v21, s[8:11], s37 offen sc1 lds
v_mfma_f32_16x16x32_bf16 v[220:223], v[116:119], v[92:95], v[220:223]
s_setprio 0
s_barrier
s_add_u32 m0, s39, 49152
s_add_u32 s37, s37, s40
buffer_load_dwordx4 v21, s[8:11], s37 offen sc1 lds
v_mul_f32 v80, v128, v128
v_mul_f32 v81, v129, v129
v_mul_f32 v82, v130, v130
v_mul_f32 v83, v131, v131
s_add_u32 m0, s39, 50176
s_add_u32 s37, s37, s38
buffer_load_dwordx4 v21, s[8:11], s37 offen sc1 lds
v_fma_f32 v80, v80, v232, v228
v_fma_f32 v81, v81, v232, v228
v_fma_f32 v82, v82, v232, v228
v_fma_f32 v83, v83, v232, v228
s_add_u32 m0, s39, 51200
s_add_u32 s37, s37, s38
buffer_load_dwordx4 v21, s[8:11], s37 offen sc1 lds
v_mul_f32 v80, v80, v128
v_mul_f32 v81, v81, v129
v_mul_f32 v82, v82, v130
v_mul_f32 v83, v83, v131
s_add_u32 m0, s39, 52224
s_add_u32 s37, s37, s38
buffer_load_dwordx4 v21, s[8:11], s37 offen sc1 lds
v_exp_f32 v80, v80
v_exp_f32 v81, v81
v_exp_f32 v82, v82
s_add_u32 m0, s39, 53248
s_add_u32 s37, s37, s55
buffer_load_dwordx4 v21, s[8:11], s37 offen sc1 lds
v_exp_f32 v83, v83
v_mul_f32 v176, v128, v176
v_mul_f32 v177, v129, v177
v_mul_f32 v178, v130, v178
s_add_u32 m0, s39, 54272
s_add_u32 s37, s37, s38
buffer_load_dwordx4 v21, s[8:11], s37 offen sc1 lds
v_mul_f32 v179, v131, v179
v_fma_f32 v80, v80, v236, v236
v_fma_f32 v81, v81, v236, v236
v_fma_f32 v82, v82, v236, v236
s_add_u32 m0, s39, 55296
s_add_u32 s37, s37, s38
buffer_load_dwordx4 v21, s[8:11], s37 offen sc1 lds
v_fma_f32 v83, v83, v236, v236
v_rcp_f32 v80, v80
v_rcp_f32 v81, v81
v_rcp_f32 v82, v82
s_add_u32 m0, s39, 56320
s_add_u32 s37, s37, s38
buffer_load_dwordx4 v21, s[8:11], s37 offen sc1 lds
v_rcp_f32 v83, v83
v_mul_f32 v176, v176, v80
v_mul_f32 v177, v177, v81
s_barrier
s_add_u32 m0, s39, 73728
s_add_u32 s37, s37, s40
buffer_load_dwordx4 v21, s[8:11], s37 offen sc1 lds
v_mul_f32 v178, v178, v82
v_mul_f32 v179, v179, v83
v_cvt_pk_bf16_f32 v96, v176, v177
v_cvt_pk_bf16_f32 v97, v178, v179
s_add_u32 m0, s39, 74752
s_add_u32 s37, s37, s38
buffer_load_dwordx4 v21, s[8:11], s37 offen sc1 lds
v_mul_f32 v84, v144, v144
v_mul_f32 v85, v145, v145
v_mul_f32 v86, v146, v146
v_mul_f32 v87, v147, v147
s_add_u32 m0, s39, 75776
s_add_u32 s37, s37, s38
buffer_load_dwordx4 v21, s[8:11], s37 offen sc1 lds
v_fma_f32 v84, v84, v232, v228
v_fma_f32 v85, v85, v232, v228
v_fma_f32 v86, v86, v232, v228
v_fma_f32 v87, v87, v232, v228
s_add_u32 m0, s39, 76800
s_add_u32 s37, s37, s38
buffer_load_dwordx4 v21, s[8:11], s37 offen sc1 lds
v_mul_f32 v84, v84, v144
v_mul_f32 v85, v85, v145
v_mul_f32 v86, v86, v146
s_add_u32 m0, s39, 77824
s_add_u32 s37, s37, s55
buffer_load_dwordx4 v21, s[8:11], s37 offen sc1 lds
v_mul_f32 v87, v87, v147
v_exp_f32 v84, v84
v_exp_f32 v85, v85
v_exp_f32 v86, v86
s_add_u32 m0, s39, 78848
s_add_u32 s37, s37, s38
buffer_load_dwordx4 v21, s[8:11], s37 offen sc1 lds
v_exp_f32 v87, v87
v_mul_f32 v192, v144, v192
v_mul_f32 v193, v145, v193
v_mul_f32 v194, v146, v194
s_add_u32 m0, s39, 79872
s_add_u32 s37, s37, s38
buffer_load_dwordx4 v21, s[8:11], s37 offen sc1 lds
v_mul_f32 v195, v147, v195
v_fma_f32 v84, v84, v236, v236
v_fma_f32 v85, v85, v236, v236
v_fma_f32 v86, v86, v236, v236
s_add_u32 m0, s39, 80896
s_add_u32 s37, s37, s38
buffer_load_dwordx4 v21, s[8:11], s37 offen sc1 lds
v_fma_f32 v87, v87, v236, v236
v_rcp_f32 v84, v84
v_rcp_f32 v85, v85
s_barrier
s_add_u32 m0, s39, 98304
s_add_u32 s37, s37, s40
buffer_load_dwordx4 v21, s[8:11], s37 offen sc1 lds
v_rcp_f32 v86, v86
v_rcp_f32 v87, v87
v_mul_f32 v192, v192, v84
v_mul_f32 v193, v193, v85
s_add_u32 m0, s39, 99328
s_add_u32 s37, s37, s38
buffer_load_dwordx4 v21, s[8:11], s37 offen sc1 lds
v_mul_f32 v194, v194, v86
v_mul_f32 v195, v195, v87
v_cvt_pk_bf16_f32 v98, v192, v193
v_cvt_pk_bf16_f32 v99, v194, v195
s_add_u32 m0, s39, 100352
s_add_u32 s37, s37, s38
buffer_load_dwordx4 v21, s[8:11], s37 offen sc1 lds
v_mul_f32 v80, v160, v160
v_mul_f32 v81, v161, v161
v_mul_f32 v82, v162, v162
s_add_u32 m0, s39, 101376
s_add_u32 s37, s37, s38
buffer_load_dwordx4 v21, s[8:11], s37 offen sc1 lds
v_mul_f32 v83, v163, v163
v_fma_f32 v80, v80, v232, v228
v_fma_f32 v81, v81, v232, v228
s_add_u32 m0, s39, 102400
s_add_u32 s37, s37, s55
buffer_load_dwordx4 v21, s[8:11], s37 offen sc1 lds
v_fma_f32 v82, v82, v232, v228
v_fma_f32 v83, v83, v232, v228
v_mul_f32 v80, v80, v160
v_mul_f32 v81, v81, v161
s_add_u32 m0, s39, 103424
s_add_u32 s37, s37, s38
buffer_load_dwordx4 v21, s[8:11], s37 offen sc1 lds
v_mul_f32 v82, v82, v162
v_mul_f32 v83, v83, v163
v_exp_f32 v80, v80
v_exp_f32 v81, v81
s_add_u32 m0, s39, 104448
s_add_u32 s37, s37, s38
buffer_load_dwordx4 v21, s[8:11], s37 offen sc1 lds
v_exp_f32 v82, v82
v_exp_f32 v83, v83
v_mul_f32 v208, v160, v208
v_mul_f32 v209, v161, v209
s_add_u32 m0, s39, 105472
s_add_u32 s37, s37, s38
buffer_load_dwordx4 v21, s[8:11], s37 offen sc1 lds
v_mul_f32 v210, v162, v210
v_mul_f32 v211, v163, v211
v_fma_f32 v80, v80, v236, v236
buffer_store_dwordx4 v[96:99], v27, s[24:27], 0 offen offset:0 sc1
s_waitcnt vmcnt(33)
s_barrier
s_add_u32 m0, s39, 122880
s_add_u32 s37, s37, s40
buffer_load_dwordx4 v21, s[8:11], s37 offen sc1 lds
v_fma_f32 v81, v81, v236, v236
v_fma_f32 v82, v82, v236, v236
v_fma_f32 v83, v83, v236, v236
v_rcp_f32 v80, v80
s_add_u32 m0, s39, 123904
s_add_u32 s37, s37, s38
buffer_load_dwordx4 v21, s[8:11], s37 offen sc1 lds
v_rcp_f32 v81, v81
v_rcp_f32 v82, v82
v_rcp_f32 v83, v83
v_mul_f32 v208, v208, v80
s_add_u32 m0, s39, 124928
s_add_u32 s37, s37, s38
buffer_load_dwordx4 v21, s[8:11], s37 offen sc1 lds
v_mul_f32 v209, v209, v81
v_mul_f32 v210, v210, v82
v_mul_f32 v211, v211, v83
v_cvt_pk_bf16_f32 v112, v208, v209
s_add_u32 m0, s39, 125952
s_add_u32 s37, s37, s38
buffer_load_dwordx4 v21, s[8:11], s37 offen sc1 lds
v_cvt_pk_bf16_f32 v113, v210, v211
v_mul_f32 v80, v132, v132
v_mul_f32 v81, v133, v133
s_add_u32 m0, s39, 126976
s_add_u32 s37, s37, s55
buffer_load_dwordx4 v21, s[8:11], s37 offen sc1 lds
v_mul_f32 v82, v134, v134
v_mul_f32 v83, v135, v135
v_fma_f32 v80, v80, v233, v229
v_fma_f32 v81, v81, v233, v229
s_add_u32 m0, s39, 128000
s_add_u32 s37, s37, s38
buffer_load_dwordx4 v21, s[8:11], s37 offen sc1 lds
v_fma_f32 v82, v82, v233, v229
v_fma_f32 v83, v83, v233, v229
v_mul_f32 v80, v80, v132
v_mul_f32 v81, v81, v133
s_add_u32 m0, s39, 129024
s_add_u32 s37, s37, s38
buffer_load_dwordx4 v21, s[8:11], s37 offen sc1 lds
v_mul_f32 v82, v82, v134
v_mul_f32 v83, v83, v135
v_exp_f32 v80, v80
v_exp_f32 v81, v81
s_add_u32 m0, s39, 130048
s_add_u32 s37, s37, s38
buffer_load_dwordx4 v21, s[8:11], s37 offen sc1 lds
v_exp_f32 v82, v82
v_exp_f32 v83, v83
v_mul_f32 v180, v132, v180
s_waitcnt vmcnt(33)
s_barrier
s_add_u32 m0, s39, 0
s_add_u32 s37, s37, s40
buffer_load_dwordx4 v21, s[8:11], s37 offen sc1 lds
v_mul_f32 v181, v133, v181
v_mul_f32 v182, v134, v182
v_mul_f32 v183, v135, v183
v_fma_f32 v80, v80, v237, v237
s_add_u32 m0, s39, 1024
s_add_u32 s37, s37, s38
buffer_load_dwordx4 v21, s[8:11], s37 offen sc1 lds
v_fma_f32 v81, v81, v237, v237
v_fma_f32 v82, v82, v237, v237
v_fma_f32 v83, v83, v237, v237
v_rcp_f32 v80, v80
s_add_u32 m0, s39, 2048
s_add_u32 s37, s37, s38
buffer_load_dwordx4 v21, s[8:11], s37 offen sc1 lds
v_rcp_f32 v81, v81
v_rcp_f32 v82, v82
v_rcp_f32 v83, v83
v_mul_f32 v180, v180, v80
s_add_u32 m0, s39, 3072
s_add_u32 s37, s37, s38
buffer_load_dwordx4 v21, s[8:11], s37 offen sc1 lds
v_mul_f32 v181, v181, v81
v_mul_f32 v182, v182, v82
v_mul_f32 v183, v183, v83
s_add_u32 m0, s39, 4096
s_add_u32 s37, s37, s55
buffer_load_dwordx4 v21, s[8:11], s37 offen sc1 lds
v_cvt_pk_bf16_f32 v100, v180, v181
v_cvt_pk_bf16_f32 v101, v182, v183
v_mul_f32 v84, v148, v148
v_mul_f32 v85, v149, v149
s_add_u32 m0, s39, 5120
s_add_u32 s37, s37, s38
buffer_load_dwordx4 v21, s[8:11], s37 offen sc1 lds
v_mul_f32 v86, v150, v150
v_mul_f32 v87, v151, v151
v_fma_f32 v84, v84, v233, v229
v_fma_f32 v85, v85, v233, v229
s_add_u32 m0, s39, 6144
s_add_u32 s37, s37, s38
buffer_load_dwordx4 v21, s[8:11], s37 offen sc1 lds
v_fma_f32 v86, v86, v233, v229
v_fma_f32 v87, v87, v233, v229
v_mul_f32 v84, v84, v148
v_mul_f32 v85, v85, v149
s_add_u32 m0, s39, 7168
s_add_u32 s37, s37, s38
buffer_load_dwordx4 v21, s[8:11], s37 offen sc1 lds
v_mul_f32 v86, v86, v150
v_mul_f32 v87, v87, v151
v_exp_f32 v84, v84
s_waitcnt vmcnt(33)
s_barrier
s_add_u32 m0, s39, 24576
s_add_u32 s37, s37, s40
buffer_load_dwordx4 v21, s[8:11], s37 offen sc1 lds
v_exp_f32 v85, v85
v_exp_f32 v86, v86
v_exp_f32 v87, v87
v_mul_f32 v196, v148, v196
s_add_u32 m0, s39, 25600
s_add_u32 s37, s37, s38
buffer_load_dwordx4 v21, s[8:11], s37 offen sc1 lds
v_mul_f32 v197, v149, v197
v_mul_f32 v198, v150, v198
v_mul_f32 v199, v151, v199
v_fma_f32 v84, v84, v237, v237
s_add_u32 m0, s39, 26624
s_add_u32 s37, s37, s38
buffer_load_dwordx4 v21, s[8:11], s37 offen sc1 lds
v_fma_f32 v85, v85, v237, v237
v_fma_f32 v86, v86, v237, v237
v_fma_f32 v87, v87, v237, v237
v_rcp_f32 v84, v84
s_add_u32 m0, s39, 27648
s_add_u32 s37, s37, s38
buffer_load_dwordx4 v21, s[8:11], s37 offen sc1 lds
v_rcp_f32 v85, v85
v_rcp_f32 v86, v86
v_rcp_f32 v87, v87
s_add_u32 m0, s39, 28672
s_add_u32 s37, s37, s55
buffer_load_dwordx4 v21, s[8:11], s37 offen sc1 lds
v_mul_f32 v196, v196, v84
v_mul_f32 v197, v197, v85
v_mul_f32 v198, v198, v86
v_mul_f32 v199, v199, v87
s_add_u32 m0, s39, 29696
s_add_u32 s37, s37, s38
buffer_load_dwordx4 v21, s[8:11], s37 offen sc1 lds
v_cvt_pk_bf16_f32 v102, v196, v197
v_cvt_pk_bf16_f32 v103, v198, v199
v_mul_f32 v80, v164, v164
s_add_u32 m0, s39, 30720
s_add_u32 s37, s37, s38
buffer_load_dwordx4 v21, s[8:11], s37 offen sc1 lds
v_mul_f32 v81, v165, v165
v_mul_f32 v82, v166, v166
v_mul_f32 v83, v167, v167
v_fma_f32 v80, v80, v233, v229
s_add_u32 m0, s39, 31744
s_add_u32 s37, s37, s38
buffer_load_dwordx4 v21, s[8:11], s37 offen sc1 lds
v_fma_f32 v81, v81, v233, v229
v_fma_f32 v82, v82, v233, v229
v_fma_f32 v83, v83, v233, v229
buffer_store_dwordx4 v[100:103], v27, s[24:27], 0 offen offset:256 sc1
s_waitcnt vmcnt(34)
s_barrier
s_add_u32 m0, s39, 49152
s_add_u32 s37, s37, s40
buffer_load_dwordx4 v21, s[8:11], s37 offen sc1 lds
v_mul_f32 v80, v80, v164
v_mul_f32 v81, v81, v165
v_mul_f32 v82, v82, v166
v_mul_f32 v83, v83, v167
s_add_u32 m0, s39, 50176
s_add_u32 s37, s37, s38
buffer_load_dwordx4 v21, s[8:11], s37 offen sc1 lds
v_exp_f32 v80, v80
v_exp_f32 v81, v81
v_exp_f32 v82, v82
v_exp_f32 v83, v83
s_add_u32 m0, s39, 51200
s_add_u32 s37, s37, s38
buffer_load_dwordx4 v21, s[8:11], s37 offen sc1 lds
v_mul_f32 v212, v164, v212
v_mul_f32 v213, v165, v213
v_mul_f32 v214, v166, v214
v_mul_f32 v215, v167, v215
s_add_u32 m0, s39, 52224
s_add_u32 s37, s37, s38
buffer_load_dwordx4 v21, s[8:11], s37 offen sc1 lds
v_fma_f32 v80, v80, v237, v237
v_fma_f32 v81, v81, v237, v237
v_fma_f32 v82, v82, v237, v237
s_add_u32 m0, s39, 53248
s_add_u32 s37, s37, s55
buffer_load_dwordx4 v21, s[8:11], s37 offen sc1 lds
v_fma_f32 v83, v83, v237, v237
v_rcp_f32 v80, v80
v_rcp_f32 v81, v81
v_rcp_f32 v82, v82
s_add_u32 m0, s39, 54272
s_add_u32 s37, s37, s38
buffer_load_dwordx4 v21, s[8:11], s37 offen sc1 lds
v_rcp_f32 v83, v83
v_mul_f32 v212, v212, v80
v_mul_f32 v213, v213, v81
v_mul_f32 v214, v214, v82
s_add_u32 m0, s39, 55296
s_add_u32 s37, s37, s38
buffer_load_dwordx4 v21, s[8:11], s37 offen sc1 lds
v_mul_f32 v215, v215, v83
v_cvt_pk_bf16_f32 v114, v212, v213
v_cvt_pk_bf16_f32 v115, v214, v215
s_nop 1
s_add_u32 m0, s39, 56320
s_add_u32 s37, s37, s38
buffer_load_dwordx4 v21, s[8:11], s37 offen sc1 lds
v_permlane32_swap_b32 v112, v114
v_permlane32_swap_b32 v113, v115
buffer_store_dwordx4 v[112:115], v28, s[24:27], 0 offen offset:0 sc1
s_waitcnt vmcnt(35)
s_barrier
s_add_u32 m0, s39, 73728
s_add_u32 s37, s37, s40
buffer_load_dwordx4 v21, s[8:11], s37 offen sc1 lds
v_mul_f32 v80, v136, v136
v_mul_f32 v81, v137, v137
v_mul_f32 v82, v138, v138
v_mul_f32 v83, v139, v139
s_add_u32 m0, s39, 74752
s_add_u32 s37, s37, s38
buffer_load_dwordx4 v21, s[8:11], s37 offen sc1 lds
v_fma_f32 v80, v80, v234, v230
v_fma_f32 v81, v81, v234, v230
v_fma_f32 v82, v82, v234, v230
v_fma_f32 v83, v83, v234, v230
s_add_u32 m0, s39, 75776
s_add_u32 s37, s37, s38
buffer_load_dwordx4 v21, s[8:11], s37 offen sc1 lds
v_mul_f32 v80, v80, v136
v_mul_f32 v81, v81, v137
v_mul_f32 v82, v82, v138
v_mul_f32 v83, v83, v139
s_add_u32 m0, s39, 76800
s_add_u32 s37, s37, s38
buffer_load_dwordx4 v21, s[8:11], s37 offen sc1 lds
v_exp_f32 v80, v80
v_exp_f32 v81, v81
v_exp_f32 v82, v82
s_add_u32 m0, s39, 77824
s_add_u32 s37, s37, s55
buffer_load_dwordx4 v21, s[8:11], s37 offen sc1 lds
v_exp_f32 v83, v83
v_mul_f32 v184, v136, v184
v_mul_f32 v185, v137, v185
v_mul_f32 v186, v138, v186
s_add_u32 m0, s39, 78848
s_add_u32 s37, s37, s38
buffer_load_dwordx4 v21, s[8:11], s37 offen sc1 lds
v_mul_f32 v187, v139, v187
v_fma_f32 v80, v80, v238, v238
v_fma_f32 v81, v81, v238, v238
v_fma_f32 v82, v82, v238, v238
s_add_u32 m0, s39, 79872
s_add_u32 s37, s37, s38
buffer_load_dwordx4 v21, s[8:11], s37 offen sc1 lds
v_fma_f32 v83, v83, v238, v238
v_rcp_f32 v80, v80
v_rcp_f32 v81, v81
v_rcp_f32 v82, v82
s_add_u32 m0, s39, 80896
s_add_u32 s37, s37, s38
buffer_load_dwordx4 v21, s[8:11], s37 offen sc1 lds
v_rcp_f32 v83, v83
v_mul_f32 v184, v184, v80
v_mul_f32 v185, v185, v81
s_waitcnt vmcnt(34)
s_barrier
s_add_u32 m0, s39, 98304
s_add_u32 s37, s37, s40
buffer_load_dwordx4 v21, s[8:11], s37 offen sc1 lds
v_mul_f32 v186, v186, v82
v_mul_f32 v187, v187, v83
v_cvt_pk_bf16_f32 v104, v184, v185
v_cvt_pk_bf16_f32 v105, v186, v187
s_add_u32 m0, s39, 99328
s_add_u32 s37, s37, s38
buffer_load_dwordx4 v21, s[8:11], s37 offen sc1 lds
v_mul_f32 v84, v152, v152
v_mul_f32 v85, v153, v153
v_mul_f32 v86, v154, v154
v_mul_f32 v87, v155, v155
s_add_u32 m0, s39, 100352
s_add_u32 s37, s37, s38
buffer_load_dwordx4 v21, s[8:11], s37 offen sc1 lds
v_fma_f32 v84, v84, v234, v230
v_fma_f32 v85, v85, v234, v230
v_fma_f32 v86, v86, v234, v230
v_fma_f32 v87, v87, v234, v230
s_add_u32 m0, s39, 101376
s_add_u32 s37, s37, s38
buffer_load_dwordx4 v21, s[8:11], s37 offen sc1 lds
v_mul_f32 v84, v84, v152
v_mul_f32 v85, v85, v153
v_mul_f32 v86, v86, v154
s_add_u32 m0, s39, 102400
s_add_u32 s37, s37, s55
buffer_load_dwordx4 v21, s[8:11], s37 offen sc1 lds
v_mul_f32 v87, v87, v155
v_exp_f32 v84, v84
v_exp_f32 v85, v85
v_exp_f32 v86, v86
s_add_u32 m0, s39, 103424
s_add_u32 s37, s37, s38
buffer_load_dwordx4 v21, s[8:11], s37 offen sc1 lds
v_exp_f32 v87, v87
v_mul_f32 v200, v152, v200
v_mul_f32 v201, v153, v201
v_mul_f32 v202, v154, v202
s_add_u32 m0, s39, 104448
s_add_u32 s37, s37, s38
buffer_load_dwordx4 v21, s[8:11], s37 offen sc1 lds
v_mul_f32 v203, v155, v203
v_fma_f32 v84, v84, v238, v238
v_fma_f32 v85, v85, v238, v238
v_fma_f32 v86, v86, v238, v238
s_add_u32 m0, s39, 105472
s_add_u32 s37, s37, s38
buffer_load_dwordx4 v21, s[8:11], s37 offen sc1 lds
v_fma_f32 v87, v87, v238, v238
v_rcp_f32 v84, v84
v_rcp_f32 v85, v85
s_waitcnt vmcnt(34)
s_barrier
s_add_u32 m0, s39, 122880
s_add_u32 s37, s37, s40
buffer_load_dwordx4 v21, s[8:11], s37 offen sc1 lds
v_rcp_f32 v86, v86
v_rcp_f32 v87, v87
v_mul_f32 v200, v200, v84
v_mul_f32 v201, v201, v85
s_add_u32 m0, s39, 123904
s_add_u32 s37, s37, s38
buffer_load_dwordx4 v21, s[8:11], s37 offen sc1 lds
v_mul_f32 v202, v202, v86
v_mul_f32 v203, v203, v87
v_cvt_pk_bf16_f32 v106, v200, v201
v_cvt_pk_bf16_f32 v107, v202, v203
s_add_u32 m0, s39, 124928
s_add_u32 s37, s37, s38
buffer_load_dwordx4 v21, s[8:11], s37 offen sc1 lds
v_mul_f32 v80, v168, v168
v_mul_f32 v81, v169, v169
v_mul_f32 v82, v170, v170
s_add_u32 m0, s39, 125952
s_add_u32 s37, s37, s38
buffer_load_dwordx4 v21, s[8:11], s37 offen sc1 lds
v_mul_f32 v83, v171, v171
v_fma_f32 v80, v80, v234, v230
v_fma_f32 v81, v81, v234, v230
s_add_u32 m0, s39, 126976
s_add_u32 s37, s37, s55
buffer_load_dwordx4 v21, s[8:11], s37 offen sc1 lds
v_fma_f32 v82, v82, v234, v230
v_fma_f32 v83, v83, v234, v230
v_mul_f32 v80, v80, v168
v_mul_f32 v81, v81, v169
s_add_u32 m0, s39, 128000
s_add_u32 s37, s37, s38
buffer_load_dwordx4 v21, s[8:11], s37 offen sc1 lds
v_mul_f32 v82, v82, v170
v_mul_f32 v83, v83, v171
v_exp_f32 v80, v80
v_exp_f32 v81, v81
s_add_u32 m0, s39, 129024
s_add_u32 s37, s37, s38
buffer_load_dwordx4 v21, s[8:11], s37 offen sc1 lds
v_exp_f32 v82, v82
v_exp_f32 v83, v83
v_mul_f32 v216, v168, v216
v_mul_f32 v217, v169, v217
s_add_u32 m0, s39, 130048
s_add_u32 s37, s37, s38
buffer_load_dwordx4 v21, s[8:11], s37 offen sc1 lds
v_mul_f32 v218, v170, v218
v_mul_f32 v219, v171, v219
v_fma_f32 v80, v80, v238, v238
buffer_store_dwordx4 v[104:107], v27, s[24:27], 0 offen offset:512 sc1
s_waitcnt vmcnt(35)
s_barrier
s_add_u32 s37, s37, s54
s_add_u32 m0, s39, 0
s_add_u32 s37, s37, s40
buffer_load_dwordx4 v21, s[8:11], s37 offen sc1 lds
v_fma_f32 v81, v81, v238, v238
v_fma_f32 v82, v82, v238, v238
v_fma_f32 v83, v83, v238, v238
v_rcp_f32 v80, v80
s_add_u32 m0, s39, 1024
s_add_u32 s37, s37, s38
buffer_load_dwordx4 v21, s[8:11], s37 offen sc1 lds
v_rcp_f32 v81, v81
v_rcp_f32 v82, v82
v_rcp_f32 v83, v83
v_mul_f32 v216, v216, v80
s_add_u32 m0, s39, 2048
s_add_u32 s37, s37, s38
buffer_load_dwordx4 v21, s[8:11], s37 offen sc1 lds
v_mul_f32 v217, v217, v81
v_mul_f32 v218, v218, v82
v_mul_f32 v219, v219, v83
v_cvt_pk_bf16_f32 v116, v216, v217
s_add_u32 m0, s39, 3072
s_add_u32 s37, s37, s38
buffer_load_dwordx4 v21, s[8:11], s37 offen sc1 lds
v_cvt_pk_bf16_f32 v117, v218, v219
v_mul_f32 v80, v140, v140
v_mul_f32 v81, v141, v141
s_add_u32 m0, s39, 4096
s_add_u32 s37, s37, s55
buffer_load_dwordx4 v21, s[8:11], s37 offen sc1 lds
v_mul_f32 v82, v142, v142
v_mul_f32 v83, v143, v143
v_fma_f32 v80, v80, v235, v231
v_fma_f32 v81, v81, v235, v231
s_add_u32 m0, s39, 5120
s_add_u32 s37, s37, s38
buffer_load_dwordx4 v21, s[8:11], s37 offen sc1 lds
v_fma_f32 v82, v82, v235, v231
v_fma_f32 v83, v83, v235, v231
v_mul_f32 v80, v80, v140
v_mul_f32 v81, v81, v141
s_add_u32 m0, s39, 6144
s_add_u32 s37, s37, s38
buffer_load_dwordx4 v21, s[8:11], s37 offen sc1 lds
v_mul_f32 v82, v82, v142
v_mul_f32 v83, v83, v143
v_exp_f32 v80, v80
v_exp_f32 v81, v81
s_add_u32 m0, s39, 7168
s_add_u32 s37, s37, s38
buffer_load_dwordx4 v21, s[8:11], s37 offen sc1 lds
v_exp_f32 v82, v82
v_exp_f32 v83, v83
v_mul_f32 v188, v140, v188
s_waitcnt vmcnt(34)
s_barrier
s_add_u32 m0, s39, 24576
s_add_u32 s37, s37, s40
buffer_load_dwordx4 v21, s[8:11], s37 offen sc1 lds
v_mul_f32 v189, v141, v189
v_mul_f32 v190, v142, v190
v_mul_f32 v191, v143, v191
v_fma_f32 v80, v80, v239, v239
s_add_u32 m0, s39, 25600
s_add_u32 s37, s37, s38
buffer_load_dwordx4 v21, s[8:11], s37 offen sc1 lds
v_fma_f32 v81, v81, v239, v239
v_fma_f32 v82, v82, v239, v239
v_fma_f32 v83, v83, v239, v239
v_rcp_f32 v80, v80
s_add_u32 m0, s39, 26624
s_add_u32 s37, s37, s38
buffer_load_dwordx4 v21, s[8:11], s37 offen sc1 lds
v_rcp_f32 v81, v81
v_rcp_f32 v82, v82
v_rcp_f32 v83, v83
v_mul_f32 v188, v188, v80
s_add_u32 m0, s39, 27648
s_add_u32 s37, s37, s38
buffer_load_dwordx4 v21, s[8:11], s37 offen sc1 lds
v_mul_f32 v189, v189, v81
v_mul_f32 v190, v190, v82
v_mul_f32 v191, v191, v83
s_add_u32 m0, s39, 28672
s_add_u32 s37, s37, s55
buffer_load_dwordx4 v21, s[8:11], s37 offen sc1 lds
v_cvt_pk_bf16_f32 v108, v188, v189
v_cvt_pk_bf16_f32 v109, v190, v191
v_mul_f32 v84, v156, v156
v_mul_f32 v85, v157, v157
s_add_u32 m0, s39, 29696
s_add_u32 s37, s37, s38
buffer_load_dwordx4 v21, s[8:11], s37 offen sc1 lds
v_mul_f32 v86, v158, v158
v_mul_f32 v87, v159, v159
v_fma_f32 v84, v84, v235, v231
v_fma_f32 v85, v85, v235, v231
s_add_u32 m0, s39, 30720
s_add_u32 s37, s37, s38
buffer_load_dwordx4 v21, s[8:11], s37 offen sc1 lds
v_fma_f32 v86, v86, v235, v231
v_fma_f32 v87, v87, v235, v231
v_mul_f32 v84, v84, v156
v_mul_f32 v85, v85, v157
s_add_u32 m0, s39, 31744
s_add_u32 s37, s37, s38
buffer_load_dwordx4 v21, s[8:11], s37 offen sc1 lds
v_mul_f32 v86, v86, v158
v_mul_f32 v87, v87, v159
v_exp_f32 v84, v84
s_waitcnt vmcnt(33)
s_barrier
s_add_u32 m0, s39, 49152
s_add_u32 s37, s37, s40
buffer_load_dwordx4 v21, s[8:11], s37 offen sc1 lds
v_exp_f32 v85, v85
v_exp_f32 v86, v86
v_exp_f32 v87, v87
v_mul_f32 v204, v156, v204
s_add_u32 m0, s39, 50176
s_add_u32 s37, s37, s38
buffer_load_dwordx4 v21, s[8:11], s37 offen sc1 lds
v_mul_f32 v205, v157, v205
v_mul_f32 v206, v158, v206
v_mul_f32 v207, v159, v207
v_fma_f32 v84, v84, v239, v239
s_add_u32 m0, s39, 51200
s_add_u32 s37, s37, s38
buffer_load_dwordx4 v21, s[8:11], s37 offen sc1 lds
v_fma_f32 v85, v85, v239, v239
v_fma_f32 v86, v86, v239, v239
v_fma_f32 v87, v87, v239, v239
v_rcp_f32 v84, v84
s_add_u32 m0, s39, 52224
s_add_u32 s37, s37, s38
buffer_load_dwordx4 v21, s[8:11], s37 offen sc1 lds
v_rcp_f32 v85, v85
v_rcp_f32 v86, v86
v_rcp_f32 v87, v87
s_add_u32 m0, s39, 53248
s_add_u32 s37, s37, s55
buffer_load_dwordx4 v21, s[8:11], s37 offen sc1 lds
v_mul_f32 v204, v204, v84
v_mul_f32 v205, v205, v85
v_mul_f32 v206, v206, v86
v_mul_f32 v207, v207, v87
s_add_u32 m0, s39, 54272
s_add_u32 s37, s37, s38
buffer_load_dwordx4 v21, s[8:11], s37 offen sc1 lds
v_cvt_pk_bf16_f32 v110, v204, v205
v_cvt_pk_bf16_f32 v111, v206, v207
v_mul_f32 v80, v172, v172
s_add_u32 m0, s39, 55296
s_add_u32 s37, s37, s38
buffer_load_dwordx4 v21, s[8:11], s37 offen sc1 lds
v_mul_f32 v81, v173, v173
v_mul_f32 v82, v174, v174
v_mul_f32 v83, v175, v175
v_fma_f32 v80, v80, v235, v231
s_add_u32 m0, s39, 56320
s_add_u32 s37, s37, s38
buffer_load_dwordx4 v21, s[8:11], s37 offen sc1 lds
v_fma_f32 v81, v81, v235, v231
v_fma_f32 v82, v82, v235, v231
v_fma_f32 v83, v83, v235, v231
buffer_store_dwordx4 v[108:111], v27, s[24:27], 0 offen offset:768 sc1
s_waitcnt vmcnt(34)
s_barrier
s_add_u32 m0, s39, 73728
s_add_u32 s37, s37, s40
buffer_load_dwordx4 v21, s[8:11], s37 offen sc1 lds
v_mul_f32 v80, v80, v172
v_mul_f32 v81, v81, v173
v_mul_f32 v82, v82, v174
v_mul_f32 v83, v83, v175
s_add_u32 m0, s39, 74752
s_add_u32 s37, s37, s38
buffer_load_dwordx4 v21, s[8:11], s37 offen sc1 lds
v_exp_f32 v80, v80
v_exp_f32 v81, v81
v_exp_f32 v82, v82
v_exp_f32 v83, v83
s_add_u32 m0, s39, 75776
s_add_u32 s37, s37, s38
buffer_load_dwordx4 v21, s[8:11], s37 offen sc1 lds
v_mul_f32 v220, v172, v220
v_mul_f32 v221, v173, v221
v_mul_f32 v222, v174, v222
v_mul_f32 v223, v175, v223
s_add_u32 m0, s39, 76800
s_add_u32 s37, s37, s38
buffer_load_dwordx4 v21, s[8:11], s37 offen sc1 lds
v_fma_f32 v80, v80, v239, v239
v_fma_f32 v81, v81, v239, v239
v_fma_f32 v82, v82, v239, v239
s_add_u32 m0, s39, 77824
s_add_u32 s37, s37, s55
buffer_load_dwordx4 v21, s[8:11], s37 offen sc1 lds
v_fma_f32 v83, v83, v239, v239
v_rcp_f32 v80, v80
v_rcp_f32 v81, v81
v_rcp_f32 v82, v82
s_add_u32 m0, s39, 78848
s_add_u32 s37, s37, s38
buffer_load_dwordx4 v21, s[8:11], s37 offen sc1 lds
v_rcp_f32 v83, v83
v_mul_f32 v220, v220, v80
v_mul_f32 v221, v221, v81
v_mul_f32 v222, v222, v82
s_add_u32 m0, s39, 79872
s_add_u32 s37, s37, s38
buffer_load_dwordx4 v21, s[8:11], s37 offen sc1 lds
v_mul_f32 v223, v223, v83
v_cvt_pk_bf16_f32 v118, v220, v221
v_cvt_pk_bf16_f32 v119, v222, v223
s_nop 1
s_add_u32 m0, s39, 80896
s_add_u32 s37, s37, s38
buffer_load_dwordx4 v21, s[8:11], s37 offen sc1 lds
v_permlane32_swap_b32 v116, v118
v_permlane32_swap_b32 v117, v119
buffer_store_dwordx4 v[116:119], v28, s[24:27], 0 offen offset:512 sc1
s_waitcnt vmcnt(35)
s_barrier
s_add_u32 m0, s39, 98304
s_add_u32 s37, s37, s40
buffer_load_dwordx4 v21, s[8:11], s37 offen sc1 lds
s_add_u32 m0, s39, 99328
s_add_u32 s37, s37, s38
buffer_load_dwordx4 v21, s[8:11], s37 offen sc1 lds
s_add_u32 m0, s39, 100352
s_add_u32 s37, s37, s38
buffer_load_dwordx4 v21, s[8:11], s37 offen sc1 lds
s_add_u32 m0, s39, 101376
s_add_u32 s37, s37, s38
buffer_load_dwordx4 v21, s[8:11], s37 offen sc1 lds
s_add_u32 m0, s39, 102400
s_add_u32 s37, s37, s55
buffer_load_dwordx4 v21, s[8:11], s37 offen sc1 lds
s_add_u32 m0, s39, 103424
s_add_u32 s37, s37, s38
buffer_load_dwordx4 v21, s[8:11], s37 offen sc1 lds
s_add_u32 m0, s39, 104448
s_add_u32 s37, s37, s38
buffer_load_dwordx4 v21, s[8:11], s37 offen sc1 lds
s_add_u32 m0, s39, 105472
s_add_u32 s37, s37, s38
buffer_load_dwordx4 v21, s[8:11], s37 offen sc1 lds
s_waitcnt vmcnt(34)
s_barrier
s_add_u32 m0, s39, 122880
s_add_u32 s37, s37, s40
buffer_load_dwordx4 v21, s[8:11], s37 offen sc1 lds
s_add_u32 m0, s39, 123904
s_add_u32 s37, s37, s38
buffer_load_dwordx4 v21, s[8:11], s37 offen sc1 lds
s_add_u32 m0, s39, 124928
s_add_u32 s37, s37, s38
buffer_load_dwordx4 v21, s[8:11], s37 offen sc1 lds
s_add_u32 m0, s39, 125952
s_add_u32 s37, s37, s38
buffer_load_dwordx4 v21, s[8:11], s37 offen sc1 lds
s_add_u32 m0, s39, 126976
s_add_u32 s37, s37, s55
buffer_load_dwordx4 v21, s[8:11], s37 offen sc1 lds
s_add_u32 m0, s39, 128000
s_add_u32 s37, s37, s38
buffer_load_dwordx4 v21, s[8:11], s37 offen sc1 lds
s_add_u32 m0, s39, 129024
s_add_u32 s37, s37, s38
buffer_load_dwordx4 v21, s[8:11], s37 offen sc1 lds
s_add_u32 m0, s39, 130048
s_add_u32 s37, s37, s38
buffer_load_dwordx4 v21, s[8:11], s37 offen sc1 lds
s_waitcnt vmcnt(16)
s_barrier
s_add_u32 m0, s39, 0
s_add_u32 s37, s37, s40
buffer_load_dwordx4 v21, s[8:11], s37 offen sc1 lds
s_add_u32 m0, s39, 1024
s_add_u32 s37, s37, s38
buffer_load_dwordx4 v21, s[8:11], s37 offen sc1 lds
s_add_u32 m0, s39, 2048
s_add_u32 s37, s37, s38
buffer_load_dwordx4 v21, s[8:11], s37 offen sc1 lds
s_add_u32 m0, s39, 3072
s_add_u32 s37, s37, s38
buffer_load_dwordx4 v21, s[8:11], s37 offen sc1 lds
s_add_u32 m0, s39, 4096
s_add_u32 s37, s37, s55
buffer_load_dwordx4 v21, s[8:11], s37 offen sc1 lds
s_add_u32 m0, s39, 5120
s_add_u32 s37, s37, s38
buffer_load_dwordx4 v21, s[8:11], s37 offen sc1 lds
s_add_u32 m0, s39, 6144
s_add_u32 s37, s37, s38
buffer_load_dwordx4 v21, s[8:11], s37 offen sc1 lds
s_add_u32 m0, s39, 7168
s_add_u32 s37, s37, s38
buffer_load_dwordx4 v21, s[8:11], s37 offen sc1 lds
s_waitcnt vmcnt(34)
s_barrier
s_add_u32 m0, s39, 24576
s_add_u32 s37, s37, s40
buffer_load_dwordx4 v21, s[8:11], s37 offen sc1 lds
s_add_u32 m0, s39, 25600
s_add_u32 s37, s37, s38
buffer_load_dwordx4 v21, s[8:11], s37 offen sc1 lds
s_add_u32 m0, s39, 26624
s_add_u32 s37, s37, s38
buffer_load_dwordx4 v21, s[8:11], s37 offen sc1 lds
s_add_u32 m0, s39, 27648
s_add_u32 s37, s37, s38
buffer_load_dwordx4 v21, s[8:11], s37 offen sc1 lds
s_add_u32 m0, s39, 28672
s_add_u32 s37, s37, s55
buffer_load_dwordx4 v21, s[8:11], s37 offen sc1 lds
s_add_u32 m0, s39, 29696
s_add_u32 s37, s37, s38
buffer_load_dwordx4 v21, s[8:11], s37 offen sc1 lds
s_add_u32 m0, s39, 30720
s_add_u32 s37, s37, s38
buffer_load_dwordx4 v21, s[8:11], s37 offen sc1 lds
s_add_u32 m0, s39, 31744
s_add_u32 s37, s37, s38
buffer_load_dwordx4 v21, s[8:11], s37 offen sc1 lds
s_waitcnt vmcnt(33)
s_barrier
s_add_u32 m0, s39, 49152
s_add_u32 s37, s37, s40
buffer_load_dwordx4 v21, s[8:11], s37 offen sc1 lds
s_add_u32 m0, s39, 50176
s_add_u32 s37, s37, s38
buffer_load_dwordx4 v21, s[8:11], s37 offen sc1 lds
s_add_u32 m0, s39, 51200
s_add_u32 s37, s37, s38
buffer_load_dwordx4 v21, s[8:11], s37 offen sc1 lds
s_add_u32 m0, s39, 52224
s_add_u32 s37, s37, s38
buffer_load_dwordx4 v21, s[8:11], s37 offen sc1 lds
s_add_u32 m0, s39, 53248
s_add_u32 s37, s37, s55
buffer_load_dwordx4 v21, s[8:11], s37 offen sc1 lds
s_add_u32 m0, s39, 54272
s_add_u32 s37, s37, s38
buffer_load_dwordx4 v21, s[8:11], s37 offen sc1 lds
s_add_u32 m0, s39, 55296
s_add_u32 s37, s37, s38
buffer_load_dwordx4 v21, s[8:11], s37 offen sc1 lds
s_add_u32 m0, s39, 56320
s_add_u32 s37, s37, s38
buffer_load_dwordx4 v21, s[8:11], s37 offen sc1 lds
s_waitcnt vmcnt(32)
s_barrier
s_add_u32 m0, s39, 73728
s_add_u32 s37, s37, s40
buffer_load_dwordx4 v21, s[8:11], s37 offen sc1 lds
s_add_u32 m0, s39, 74752
s_add_u32 s37, s37, s38
buffer_load_dwordx4 v21, s[8:11], s37 offen sc1 lds
s_add_u32 m0, s39, 75776
s_add_u32 s37, s37, s38
buffer_load_dwordx4 v21, s[8:11], s37 offen sc1 lds
s_add_u32 m0, s39, 76800
s_add_u32 s37, s37, s38
buffer_load_dwordx4 v21, s[8:11], s37 offen sc1 lds
s_add_u32 m0, s39, 77824
s_add_u32 s37, s37, s55
buffer_load_dwordx4 v21, s[8:11], s37 offen sc1 lds
s_add_u32 m0, s39, 78848
s_add_u32 s37, s37, s38
buffer_load_dwordx4 v21, s[8:11], s37 offen sc1 lds
s_add_u32 m0, s39, 79872
s_add_u32 s37, s37, s38
buffer_load_dwordx4 v21, s[8:11], s37 offen sc1 lds
s_add_u32 m0, s39, 80896
s_add_u32 s37, s37, s38
buffer_load_dwordx4 v21, s[8:11], s37 offen sc1 lds
s_waitcnt vmcnt(32)
s_barrier
s_mov_b32 s41, 1
Lp4_44:
s_add_u32 m0, s39, 98304
s_add_u32 s37, s37, s40
buffer_load_dwordx4 v21, s[8:11], s37 offen sc1 lds
s_add_u32 m0, s39, 99328
s_add_u32 s37, s37, s38
buffer_load_dwordx4 v21, s[8:11], s37 offen sc1 lds
s_add_u32 m0, s39, 100352
s_add_u32 s37, s37, s38
buffer_load_dwordx4 v21, s[8:11], s37 offen sc1 lds
s_add_u32 m0, s39, 101376
s_add_u32 s37, s37, s38
buffer_load_dwordx4 v21, s[8:11], s37 offen sc1 lds
s_add_u32 m0, s39, 102400
s_add_u32 s37, s37, s55
buffer_load_dwordx4 v21, s[8:11], s37 offen sc1 lds
s_add_u32 m0, s39, 103424
s_add_u32 s37, s37, s38
buffer_load_dwordx4 v21, s[8:11], s37 offen sc1 lds
s_add_u32 m0, s39, 104448
s_add_u32 s37, s37, s38
buffer_load_dwordx4 v21, s[8:11], s37 offen sc1 lds
s_add_u32 m0, s39, 105472
s_add_u32 s37, s37, s38
buffer_load_dwordx4 v21, s[8:11], s37 offen sc1 lds
s_waitcnt vmcnt(32)
s_barrier
s_add_u32 m0, s39, 122880
s_add_u32 s37, s37, s40
buffer_load_dwordx4 v21, s[8:11], s37 offen sc1 lds
s_add_u32 m0, s39, 123904
s_add_u32 s37, s37, s38
buffer_load_dwordx4 v21, s[8:11], s37 offen sc1 lds
s_add_u32 m0, s39, 124928
s_add_u32 s37, s37, s38
buffer_load_dwordx4 v21, s[8:11], s37 offen sc1 lds
s_add_u32 m0, s39, 125952
s_add_u32 s37, s37, s38
buffer_load_dwordx4 v21, s[8:11], s37 offen sc1 lds
s_add_u32 m0, s39, 126976
s_add_u32 s37, s37, s55
buffer_load_dwordx4 v21, s[8:11], s37 offen sc1 lds
s_add_u32 m0, s39, 128000
s_add_u32 s37, s37, s38
buffer_load_dwordx4 v21, s[8:11], s37 offen sc1 lds
s_add_u32 m0, s39, 129024
s_add_u32 s37, s37, s38
buffer_load_dwordx4 v21, s[8:11], s37 offen sc1 lds
s_add_u32 m0, s39, 130048
s_add_u32 s37, s37, s38
buffer_load_dwordx4 v21, s[8:11], s37 offen sc1 lds
s_waitcnt vmcnt(32)
s_barrier
s_add_u32 m0, s39, 0
s_add_u32 s37, s37, s40
buffer_load_dwordx4 v21, s[8:11], s37 offen sc1 lds
s_add_u32 m0, s39, 1024
s_add_u32 s37, s37, s38
buffer_load_dwordx4 v21, s[8:11], s37 offen sc1 lds
s_add_u32 m0, s39, 2048
s_add_u32 s37, s37, s38
buffer_load_dwordx4 v21, s[8:11], s37 offen sc1 lds
s_add_u32 m0, s39, 3072
s_add_u32 s37, s37, s38
buffer_load_dwordx4 v21, s[8:11], s37 offen sc1 lds
s_add_u32 m0, s39, 4096
s_add_u32 s37, s37, s55
buffer_load_dwordx4 v21, s[8:11], s37 offen sc1 lds
s_add_u32 m0, s39, 5120
s_add_u32 s37, s37, s38
buffer_load_dwordx4 v21, s[8:11], s37 offen sc1 lds
s_add_u32 m0, s39, 6144
s_add_u32 s37, s37, s38
buffer_load_dwordx4 v21, s[8:11], s37 offen sc1 lds
s_add_u32 m0, s39, 7168
s_add_u32 s37, s37, s38
buffer_load_dwordx4 v21, s[8:11], s37 offen sc1 lds
s_waitcnt vmcnt(32)
s_barrier
s_add_u32 m0, s39, 24576
s_add_u32 s37, s37, s40
buffer_load_dwordx4 v21, s[8:11], s37 offen sc1 lds
s_add_u32 m0, s39, 25600
s_add_u32 s37, s37, s38
buffer_load_dwordx4 v21, s[8:11], s37 offen sc1 lds
s_add_u32 m0, s39, 26624
s_add_u32 s37, s37, s38
buffer_load_dwordx4 v21, s[8:11], s37 offen sc1 lds
s_add_u32 m0, s39, 27648
s_add_u32 s37, s37, s38
buffer_load_dwordx4 v21, s[8:11], s37 offen sc1 lds
s_add_u32 m0, s39, 28672
s_add_u32 s37, s37, s55
buffer_load_dwordx4 v21, s[8:11], s37 offen sc1 lds
s_add_u32 m0, s39, 29696
s_add_u32 s37, s37, s38
buffer_load_dwordx4 v21, s[8:11], s37 offen sc1 lds
s_add_u32 m0, s39, 30720
s_add_u32 s37, s37, s38
buffer_load_dwordx4 v21, s[8:11], s37 offen sc1 lds
s_add_u32 m0, s39, 31744
s_add_u32 s37, s37, s38
buffer_load_dwordx4 v21, s[8:11], s37 offen sc1 lds
s_waitcnt vmcnt(32)
s_barrier
s_add_u32 m0, s39, 49152
s_add_u32 s37, s37, s40
buffer_load_dwordx4 v21, s[8:11], s37 offen sc1 lds
s_add_u32 m0, s39, 50176
s_add_u32 s37, s37, s38
buffer_load_dwordx4 v21, s[8:11], s37 offen sc1 lds
s_add_u32 m0, s39, 51200
s_add_u32 s37, s37, s38
buffer_load_dwordx4 v21, s[8:11], s37 offen sc1 lds
s_add_u32 m0, s39, 52224
s_add_u32 s37, s37, s38
buffer_load_dwordx4 v21, s[8:11], s37 offen sc1 lds
s_add_u32 m0, s39, 53248
s_add_u32 s37, s37, s55
buffer_load_dwordx4 v21, s[8:11], s37 offen sc1 lds
s_add_u32 m0, s39, 54272
s_add_u32 s37, s37, s38
buffer_load_dwordx4 v21, s[8:11], s37 offen sc1 lds
s_add_u32 m0, s39, 55296
s_add_u32 s37, s37, s38
buffer_load_dwordx4 v21, s[8:11], s37 offen sc1 lds
s_add_u32 m0, s39, 56320
s_add_u32 s37, s37, s38
buffer_load_dwordx4 v21, s[8:11], s37 offen sc1 lds
s_waitcnt vmcnt(32)
s_barrier
s_add_u32 m0, s39, 73728
s_add_u32 s37, s37, s40
buffer_load_dwordx4 v21, s[8:11], s37 offen sc1 lds
s_add_u32 m0, s39, 74752
s_add_u32 s37, s37, s38
buffer_load_dwordx4 v21, s[8:11], s37 offen sc1 lds
s_add_u32 m0, s39, 75776
s_add_u32 s37, s37, s38
buffer_load_dwordx4 v21, s[8:11], s37 offen sc1 lds
s_add_u32 m0, s39, 76800
s_add_u32 s37, s37, s38
buffer_load_dwordx4 v21, s[8:11], s37 offen sc1 lds
s_add_u32 m0, s39, 77824
s_add_u32 s37, s37, s55
buffer_load_dwordx4 v21, s[8:11], s37 offen sc1 lds
s_add_u32 m0, s39, 78848
s_add_u32 s37, s37, s38
buffer_load_dwordx4 v21, s[8:11], s37 offen sc1 lds
s_add_u32 m0, s39, 79872
s_add_u32 s37, s37, s38
buffer_load_dwordx4 v21, s[8:11], s37 offen sc1 lds
s_add_u32 m0, s39, 80896
s_add_u32 s37, s37, s38
buffer_load_dwordx4 v21, s[8:11], s37 offen sc1 lds
s_waitcnt vmcnt(32)
s_barrier
s_sub_u32 s41, s41, 1
s_cmp_lg_u32 s41, 0
s_cbranch_scc1 Lp4_44
s_cmp_eq_u32 s51, 2
s_cbranch_scc1 LW4_45
s_mov_b32 s41, 4
Lp4_46:
s_add_u32 m0, s39, 98304
s_add_u32 s37, s37, s40
buffer_load_dwordx4 v21, s[8:11], s37 offen sc1 lds
s_add_u32 m0, s39, 99328
s_add_u32 s37, s37, s38
buffer_load_dwordx4 v21, s[8:11], s37 offen sc1 lds
s_add_u32 m0, s39, 100352
s_add_u32 s37, s37, s38
buffer_load_dwordx4 v21, s[8:11], s37 offen sc1 lds
s_add_u32 m0, s39, 101376
s_add_u32 s37, s37, s38
buffer_load_dwordx4 v21, s[8:11], s37 offen sc1 lds
s_add_u32 m0, s39, 102400
s_add_u32 s37, s37, s55
buffer_load_dwordx4 v21, s[8:11], s37 offen sc1 lds
s_add_u32 m0, s39, 103424
s_add_u32 s37, s37, s38
buffer_load_dwordx4 v21, s[8:11], s37 offen sc1 lds
s_add_u32 m0, s39, 104448
s_add_u32 s37, s37, s38
buffer_load_dwordx4 v21, s[8:11], s37 offen sc1 lds
s_add_u32 m0, s39, 105472
s_add_u32 s37, s37, s38
buffer_load_dwordx4 v21, s[8:11], s37 offen sc1 lds
s_waitcnt vmcnt(32)
s_barrier
s_add_u32 m0, s39, 122880
s_add_u32 s37, s37, s40
buffer_load_dwordx4 v21, s[8:11], s37 offen sc1 lds
s_add_u32 m0, s39, 123904
s_add_u32 s37, s37, s38
buffer_load_dwordx4 v21, s[8:11], s37 offen sc1 lds
s_add_u32 m0, s39, 124928
s_add_u32 s37, s37, s38
buffer_load_dwordx4 v21, s[8:11], s37 offen sc1 lds
s_add_u32 m0, s39, 125952
s_add_u32 s37, s37, s38
buffer_load_dwordx4 v21, s[8:11], s37 offen sc1 lds
s_add_u32 m0, s39, 126976
s_add_u32 s37, s37, s55
buffer_load_dwordx4 v21, s[8:11], s37 offen sc1 lds
s_add_u32 m0, s39, 128000
s_add_u32 s37, s37, s38
buffer_load_dwordx4 v21, s[8:11], s37 offen sc1 lds
s_add_u32 m0, s39, 129024
s_add_u32 s37, s37, s38
buffer_load_dwordx4 v21, s[8:11], s37 offen sc1 lds
s_add_u32 m0, s39, 130048
s_add_u32 s37, s37, s38
buffer_load_dwordx4 v21, s[8:11], s37 offen sc1 lds
s_waitcnt vmcnt(32)
s_barrier
s_add_u32 m0, s39, 0
s_add_u32 s37, s37, s40
buffer_load_dwordx4 v21, s[8:11], s37 offen sc1 lds
s_add_u32 m0, s39, 1024
s_add_u32 s37, s37, s38
buffer_load_dwordx4 v21, s[8:11], s37 offen sc1 lds
s_add_u32 m0, s39, 2048
s_add_u32 s37, s37, s38
buffer_load_dwordx4 v21, s[8:11], s37 offen sc1 lds
s_add_u32 m0, s39, 3072
s_add_u32 s37, s37, s38
buffer_load_dwordx4 v21, s[8:11], s37 offen sc1 lds
s_add_u32 m0, s39, 4096
s_add_u32 s37, s37, s55
buffer_load_dwordx4 v21, s[8:11], s37 offen sc1 lds
s_add_u32 m0, s39, 5120
s_add_u32 s37, s37, s38
buffer_load_dwordx4 v21, s[8:11], s37 offen sc1 lds
s_add_u32 m0, s39, 6144
s_add_u32 s37, s37, s38
buffer_load_dwordx4 v21, s[8:11], s37 offen sc1 lds
s_add_u32 m0, s39, 7168
s_add_u32 s37, s37, s38
buffer_load_dwordx4 v21, s[8:11], s37 offen sc1 lds
s_waitcnt vmcnt(32)
s_barrier
s_add_u32 m0, s39, 24576
s_add_u32 s37, s37, s40
buffer_load_dwordx4 v21, s[8:11], s37 offen sc1 lds
s_add_u32 m0, s39, 25600
s_add_u32 s37, s37, s38
buffer_load_dwordx4 v21, s[8:11], s37 offen sc1 lds
s_add_u32 m0, s39, 26624
s_add_u32 s37, s37, s38
buffer_load_dwordx4 v21, s[8:11], s37 offen sc1 lds
s_add_u32 m0, s39, 27648
s_add_u32 s37, s37, s38
buffer_load_dwordx4 v21, s[8:11], s37 offen sc1 lds
s_add_u32 m0, s39, 28672
s_add_u32 s37, s37, s55
buffer_load_dwordx4 v21, s[8:11], s37 offen sc1 lds
s_add_u32 m0, s39, 29696
s_add_u32 s37, s37, s38
buffer_load_dwordx4 v21, s[8:11], s37 offen sc1 lds
s_add_u32 m0, s39, 30720
s_add_u32 s37, s37, s38
buffer_load_dwordx4 v21, s[8:11], s37 offen sc1 lds
s_add_u32 m0, s39, 31744
s_add_u32 s37, s37, s38
buffer_load_dwordx4 v21, s[8:11], s37 offen sc1 lds
s_waitcnt vmcnt(32)
s_barrier
s_add_u32 m0, s39, 49152
s_add_u32 s37, s37, s40
buffer_load_dwordx4 v21, s[8:11], s37 offen sc1 lds
s_add_u32 m0, s39, 50176
s_add_u32 s37, s37, s38
buffer_load_dwordx4 v21, s[8:11], s37 offen sc1 lds
s_add_u32 m0, s39, 51200
s_add_u32 s37, s37, s38
buffer_load_dwordx4 v21, s[8:11], s37 offen sc1 lds
s_add_u32 m0, s39, 52224
s_add_u32 s37, s37, s38
buffer_load_dwordx4 v21, s[8:11], s37 offen sc1 lds
s_add_u32 m0, s39, 53248
s_add_u32 s37, s37, s55
buffer_load_dwordx4 v21, s[8:11], s37 offen sc1 lds
s_add_u32 m0, s39, 54272
s_add_u32 s37, s37, s38
buffer_load_dwordx4 v21, s[8:11], s37 offen sc1 lds
s_add_u32 m0, s39, 55296
s_add_u32 s37, s37, s38
buffer_load_dwordx4 v21, s[8:11], s37 offen sc1 lds
s_add_u32 m0, s39, 56320
s_add_u32 s37, s37, s38
buffer_load_dwordx4 v21, s[8:11], s37 offen sc1 lds
s_waitcnt vmcnt(32)
s_barrier
s_add_u32 m0, s39, 73728
s_add_u32 s37, s37, s40
buffer_load_dwordx4 v21, s[8:11], s37 offen sc1 lds
s_add_u32 m0, s39, 74752
s_add_u32 s37, s37, s38
buffer_load_dwordx4 v21, s[8:11], s37 offen sc1 lds
s_add_u32 m0, s39, 75776
s_add_u32 s37, s37, s38
buffer_load_dwordx4 v21, s[8:11], s37 offen sc1 lds
s_add_u32 m0, s39, 76800
s_add_u32 s37, s37, s38
buffer_load_dwordx4 v21, s[8:11], s37 offen sc1 lds
s_add_u32 m0, s39, 77824
s_add_u32 s37, s37, s55
buffer_load_dwordx4 v21, s[8:11], s37 offen sc1 lds
s_add_u32 m0, s39, 78848
s_add_u32 s37, s37, s38
buffer_load_dwordx4 v21, s[8:11], s37 offen sc1 lds
s_add_u32 m0, s39, 79872
s_add_u32 s37, s37, s38
buffer_load_dwordx4 v21, s[8:11], s37 offen sc1 lds
s_add_u32 m0, s39, 80896
s_add_u32 s37, s37, s38
buffer_load_dwordx4 v21, s[8:11], s37 offen sc1 lds
s_waitcnt vmcnt(32)
s_barrier
s_sub_u32 s41, s41, 1
s_cmp_lg_u32 s41, 0
s_cbranch_scc1 Lp4_46
s_waitcnt vmcnt(24)
s_barrier
s_waitcnt vmcnt(16)
s_barrier
s_waitcnt vmcnt(8)
s_barrier
s_waitcnt vmcnt(0)
s_barrier
s_branch Ldone_1
LW4_45:
s_mov_b32 s41, 4
Lp4_47:
s_add_u32 m0, s39, 98304
s_add_u32 s37, s37, 16384
buffer_load_dwordx4 v21, s[8:11], s37 offen sc1 lds
s_add_u32 m0, s39, 99328
s_add_u32 s37, s37, 16384
buffer_load_dwordx4 v21, s[8:11], s37 offen sc1 lds
s_add_u32 m0, s39, 100352
s_add_u32 s37, s37, 16384
buffer_load_dwordx4 v21, s[8:11], s37 offen sc1 lds
s_add_u32 m0, s39, 101376
s_add_u32 s37, s37, 16384
buffer_load_dwordx4 v21, s[8:11], s37 offen sc1 lds
s_add_u32 m0, s39, 102400
s_add_u32 s37, s37, 49152
buffer_load_dwordx4 v21, s[8:11], s37 offen sc1 lds
s_add_u32 m0, s39, 103424
s_add_u32 s37, s37, 16384
buffer_load_dwordx4 v21, s[8:11], s37 offen sc1 lds
s_add_u32 m0, s39, 104448
s_add_u32 s37, s37, 16384
buffer_load_dwordx4 v21, s[8:11], s37 offen sc1 lds
s_add_u32 m0, s39, 105472
s_add_u32 s37, s37, 16384
buffer_load_dwordx4 v21, s[8:11], s37 offen sc1 lds
s_waitcnt vmcnt(32)
s_barrier
s_add_u32 m0, s39, 122880
s_add_u32 s37, s37, 4294885376
buffer_load_dwordx4 v21, s[8:11], s37 offen sc1 lds
s_add_u32 m0, s39, 123904
s_add_u32 s37, s37, 98304
buffer_load_dwordx4 v21, s[8:11], s37 offen sc1 lds
s_add_u32 m0, s39, 124928
s_add_u32 s37, s37, 4294885376
buffer_load_dwordx4 v21, s[8:11], s37 offen sc1 lds
s_add_u32 m0, s39, 125952
s_add_u32 s37, s37, 98304
buffer_load_dwordx4 v21, s[8:11], s37 offen sc1 lds
s_add_u32 m0, s39, 126976
s_add_u32 s37, s37, 16384
buffer_load_dwordx4 v21, s[8:11], s37 offen sc1 lds
s_add_u32 m0, s39, 128000
s_add_u32 s37, s37, 16384
buffer_load_dwordx4 v21, s[8:11], s37 offen sc1 lds
s_add_u32 m0, s39, 129024
s_add_u32 s37, s37, 16384
buffer_load_dwordx4 v21, s[8:11], s37 offen sc1 lds
s_add_u32 m0, s39, 130048
s_add_u32 s37, s37, 16384
buffer_load_dwordx4 v21, s[8:11], s37 offen sc1 lds
s_waitcnt vmcnt(32)
s_barrier
s_add_u32 m0, s39, 0
s_add_u32 s37, s37, 49152
buffer_load_dwordx4 v21, s[8:11], s37 offen sc1 lds
s_add_u32 m0, s39, 1024
s_add_u32 s37, s37, 16384
buffer_load_dwordx4 v21, s[8:11], s37 offen sc1 lds
s_add_u32 m0, s39, 2048
s_add_u32 s37, s37, 16384
buffer_load_dwordx4 v21, s[8:11], s37 offen sc1 lds
s_add_u32 m0, s39, 3072
s_add_u32 s37, s37, 16384
buffer_load_dwordx4 v21, s[8:11], s37 offen sc1 lds
s_add_u32 m0, s39, 4096
s_add_u32 s37, s37, 4294885376
buffer_load_dwordx4 v21, s[8:11], s37 offen sc1 lds
s_add_u32 m0, s39, 5120
s_add_u32 s37, s37, 98304
buffer_load_dwordx4 v21, s[8:11], s37 offen sc1 lds
s_add_u32 m0, s39, 6144
s_add_u32 s37, s37, 4294885376
buffer_load_dwordx4 v21, s[8:11], s37 offen sc1 lds
s_add_u32 m0, s39, 7168
s_add_u32 s37, s37, 98304
buffer_load_dwordx4 v21, s[8:11], s37 offen sc1 lds
s_waitcnt vmcnt(32)
s_barrier
s_add_u32 m0, s39, 24576
s_add_u32 s37, s37, 16384
buffer_load_dwordx4 v21, s[8:11], s37 offen sc1 lds
s_add_u32 m0, s39, 25600
s_add_u32 s37, s37, 16384
buffer_load_dwordx4 v21, s[8:11], s37 offen sc1 lds
s_add_u32 m0, s39, 26624
s_add_u32 s37, s37, 16384
buffer_load_dwordx4 v21, s[8:11], s37 offen sc1 lds
s_add_u32 m0, s39, 27648
s_add_u32 s37, s37, 16384
buffer_load_dwordx4 v21, s[8:11], s37 offen sc1 lds
s_add_u32 m0, s39, 28672
s_add_u32 s37, s37, 49152
buffer_load_dwordx4 v21, s[8:11], s37 offen sc1 lds
s_add_u32 m0, s39, 29696
s_add_u32 s37, s37, 16384
buffer_load_dwordx4 v21, s[8:11], s37 offen sc1 lds
s_add_u32 m0, s39, 30720
s_add_u32 s37, s37, 16384
buffer_load_dwordx4 v21, s[8:11], s37 offen sc1 lds
s_add_u32 m0, s39, 31744
s_add_u32 s37, s37, 16384
buffer_load_dwordx4 v21, s[8:11], s37 offen sc1 lds
s_waitcnt vmcnt(32)
s_barrier
s_add_u32 m0, s39, 49152
s_add_u32 s37, s37, 4294885376
buffer_load_dwordx4 v21, s[8:11], s37 offen sc1 lds
s_add_u32 m0, s39, 50176
s_add_u32 s37, s37, 98304
buffer_load_dwordx4 v21, s[8:11], s37 offen sc1 lds
s_add_u32 m0, s39, 51200
s_add_u32 s37, s37, 4294885376
buffer_load_dwordx4 v21, s[8:11], s37 offen sc1 lds
s_add_u32 m0, s39, 52224
s_add_u32 s37, s37, 98304
buffer_load_dwordx4 v21, s[8:11], s37 offen sc1 lds
s_add_u32 m0, s39, 53248
s_add_u32 s37, s37, 16384
buffer_load_dwordx4 v21, s[8:11], s37 offen sc1 lds
s_add_u32 m0, s39, 54272
s_add_u32 s37, s37, 16384
buffer_load_dwordx4 v21, s[8:11], s37 offen sc1 lds
s_add_u32 m0, s39, 55296
s_add_u32 s37, s37, 16384
buffer_load_dwordx4 v21, s[8:11], s37 offen sc1 lds
s_add_u32 m0, s39, 56320
s_add_u32 s37, s37, 16384
buffer_load_dwordx4 v21, s[8:11], s37 offen sc1 lds
s_waitcnt vmcnt(32)
s_barrier
s_add_u32 m0, s39, 73728
s_add_u32 s37, s37, 49152
buffer_load_dwordx4 v21, s[8:11], s37 offen sc1 lds
s_add_u32 m0, s39, 74752
s_add_u32 s37, s37, 16384
buffer_load_dwordx4 v21, s[8:11], s37 offen sc1 lds
s_add_u32 m0, s39, 75776
s_add_u32 s37, s37, 16384
buffer_load_dwordx4 v21, s[8:11], s37 offen sc1 lds
s_add_u32 m0, s39, 76800
s_add_u32 s37, s37, 16384
buffer_load_dwordx4 v21, s[8:11], s37 offen sc1 lds
s_add_u32 m0, s39, 77824
s_add_u32 s37, s37, 4294885376
buffer_load_dwordx4 v21, s[8:11], s37 offen sc1 lds
s_add_u32 m0, s39, 78848
s_add_u32 s37, s37, 98304
buffer_load_dwordx4 v21, s[8:11], s37 offen sc1 lds
s_add_u32 m0, s39, 79872
s_add_u32 s37, s37, 4294885376
buffer_load_dwordx4 v21, s[8:11], s37 offen sc1 lds
s_add_u32 m0, s39, 80896
s_add_u32 s37, s37, 98304
buffer_load_dwordx4 v21, s[8:11], s37 offen sc1 lds
s_waitcnt vmcnt(32)
s_barrier
s_sub_u32 s41, s41, 1
s_cmp_lg_u32 s41, 0
s_cbranch_scc1 Lp4_47
s_waitcnt vmcnt(24)
s_barrier
s_waitcnt vmcnt(16)
s_barrier
s_waitcnt vmcnt(8)
s_barrier
s_waitcnt vmcnt(0)
s_barrier
s_branch Ldone_1
L7b_43:
s_add_u32 s43, s34, 48
s_lshl_b32 s43, s43, 7
v_mov_b32 v21, s43
v_mov_b32 v22, 1
s_mov_b64 exec, 1
buffer_atomic_add v22, v21, s[56:59], 0 offen sc1
s_mov_b64 exec, -1
v_mfma_f32_16x16x32_bf16 v[128:131], v[96:99], v[80:83], v[128:131]
v_mfma_f32_16x16x32_bf16 v[132:135], v[96:99], v[84:87], v[132:135]
v_mfma_f32_16x16x32_bf16 v[136:139], v[96:99], v[88:91], v[136:139]
v_mfma_f32_16x16x32_bf16 v[140:143], v[96:99], v[92:95], v[140:143]
v_mfma_f32_16x16x32_bf16 v[176:179], v[108:111], v[80:83], v[176:179]
v_mfma_f32_16x16x32_bf16 v[180:183], v[108:111], v[84:87], v[180:183]
v_mfma_f32_16x16x32_bf16 v[184:187], v[108:111], v[88:91], v[184:187]
v_mfma_f32_16x16x32_bf16 v[188:191], v[108:111], v[92:95], v[188:191]
v_mfma_f32_16x16x32_bf16 v[144:147], v[100:103], v[80:83], v[144:147]
v_mfma_f32_16x16x32_bf16 v[148:151], v[100:103], v[84:87], v[148:151]
v_mfma_f32_16x16x32_bf16 v[152:155], v[100:103], v[88:91], v[152:155]
v_mfma_f32_16x16x32_bf16 v[156:159], v[100:103], v[92:95], v[156:159]
v_mfma_f32_16x16x32_bf16 v[192:195], v[112:115], v[80:83], v[192:195]
v_mfma_f32_16x16x32_bf16 v[196:199], v[112:115], v[84:87], v[196:199]
v_mfma_f32_16x16x32_bf16 v[200:203], v[112:115], v[88:91], v[200:203]
v_mfma_f32_16x16x32_bf16 v[204:207], v[112:115], v[92:95], v[204:207]
v_mfma_f32_16x16x32_bf16 v[160:163], v[104:107], v[80:83], v[160:163]
v_mfma_f32_16x16x32_bf16 v[164:167], v[104:107], v[84:87], v[164:167]
v_mfma_f32_16x16x32_bf16 v[168:171], v[104:107], v[88:91], v[168:171]
v_mfma_f32_16x16x32_bf16 v[172:175], v[104:107], v[92:95], v[172:175]
v_mfma_f32_16x16x32_bf16 v[208:211], v[116:119], v[80:83], v[208:211]
v_mfma_f32_16x16x32_bf16 v[212:215], v[116:119], v[84:87], v[212:215]
v_mfma_f32_16x16x32_bf16 v[216:219], v[116:119], v[88:91], v[216:219]
v_mfma_f32_16x16x32_bf16 v[220:223], v[116:119], v[92:95], v[220:223]
s_setprio 0
s_barrier
s_mov_b32 s80, s60
s_mov_b32 s81, s61
s_mov_b32 s82, 7340032
s_mov_b32 s83, 0x20000
v_and_b32 v29, 31, v1
v_lshlrev_b32 v29, 11, v29
s_and_b32 s43, s35, 8
s_or_b32 s43, s43, 3
s_lshl_b32 s43, s43, 7
v_add_u32 v29, s43, v29
v_mul_f32 v80, v128, v128
v_mul_f32 v81, v129, v129
v_mul_f32 v82, v130, v130
v_mul_f32 v83, v131, v131
v_fma_f32 v80, v80, v232, v228
v_fma_f32 v81, v81, v232, v228
v_fma_f32 v82, v82, v232, v228
v_fma_f32 v83, v83, v232, v228
v_mul_f32 v80, v80, v128
v_mul_f32 v81, v81, v129
v_mul_f32 v82, v82, v130
v_mul_f32 v83, v83, v131
v_exp_f32 v80, v80
v_exp_f32 v81, v81
v_exp_f32 v82, v82
v_exp_f32 v83, v83
v_mul_f32 v176, v128, v176
v_mul_f32 v177, v129, v177
v_mul_f32 v178, v130, v178
v_mul_f32 v179, v131, v179
v_fma_f32 v80, v80, v236, v236
v_fma_f32 v81, v81, v236, v236
v_fma_f32 v82, v82, v236, v236
v_fma_f32 v83, v83, v236, v236
v_rcp_f32 v80, v80
v_rcp_f32 v81, v81
v_rcp_f32 v82, v82
v_rcp_f32 v83, v83
v_mul_f32 v176, v176, v80
v_mul_f32 v177, v177, v81
s_barrier
v_mul_f32 v178, v178, v82
v_mul_f32 v179, v179, v83
v_cvt_pk_bf16_f32 v96, v176, v177
v_cvt_pk_bf16_f32 v97, v178, v179
v_mul_f32 v84, v144, v144
v_mul_f32 v85, v145, v145
v_mul_f32 v86, v146, v146
v_mul_f32 v87, v147, v147
v_fma_f32 v84, v84, v232, v228
v_fma_f32 v85, v85, v232, v228
v_fma_f32 v86, v86, v232, v228
v_fma_f32 v87, v87, v232, v228
v_mul_f32 v84, v84, v144
v_mul_f32 v85, v85, v145
v_mul_f32 v86, v86, v146
v_mul_f32 v87, v87, v147
v_exp_f32 v84, v84
v_exp_f32 v85, v85
v_exp_f32 v86, v86
v_exp_f32 v87, v87
v_mul_f32 v192, v144, v192
v_mul_f32 v193, v145, v193
v_mul_f32 v194, v146, v194
v_mul_f32 v195, v147, v195
v_fma_f32 v84, v84, v236, v236
v_fma_f32 v85, v85, v236, v236
v_fma_f32 v86, v86, v236, v236
v_fma_f32 v87, v87, v236, v236
v_rcp_f32 v84, v84
v_rcp_f32 v85, v85
s_barrier
v_rcp_f32 v86, v86
v_rcp_f32 v87, v87
v_mul_f32 v192, v192, v84
v_mul_f32 v193, v193, v85
v_mul_f32 v194, v194, v86
v_mul_f32 v195, v195, v87
v_cvt_pk_bf16_f32 v98, v192, v193
v_cvt_pk_bf16_f32 v99, v194, v195
buffer_store_dwordx4 v[96:99], v27, s[24:27], 0 offen offset:0 sc1
v_mul_f32 v80, v160, v160
v_mul_f32 v81, v161, v161
v_mul_f32 v82, v162, v162
v_mul_f32 v83, v163, v163
v_fma_f32 v80, v80, v232, v228
v_fma_f32 v81, v81, v232, v228
v_fma_f32 v82, v82, v232, v228
v_fma_f32 v83, v83, v232, v228
v_mul_f32 v80, v80, v160
v_mul_f32 v81, v81, v161
v_mul_f32 v82, v82, v162
v_mul_f32 v83, v83, v163
v_exp_f32 v80, v80
v_exp_f32 v81, v81
v_exp_f32 v82, v82
v_exp_f32 v83, v83
v_mul_f32 v208, v160, v208
v_mul_f32 v209, v161, v209
v_mul_f32 v210, v162, v210
v_mul_f32 v211, v163, v211
v_fma_f32 v80, v80, v236, v236
s_barrier
v_fma_f32 v81, v81, v236, v236
v_fma_f32 v82, v82, v236, v236
v_fma_f32 v83, v83, v236, v236
v_rcp_f32 v80, v80
v_rcp_f32 v81, v81
v_rcp_f32 v82, v82
v_rcp_f32 v83, v83
v_mul_f32 v208, v208, v80
v_mul_f32 v209, v209, v81
v_mul_f32 v210, v210, v82
v_mul_f32 v211, v211, v83
v_cvt_pk_bf16_f32 v112, v208, v209
v_cvt_pk_bf16_f32 v113, v210, v211
v_mul_f32 v80, v132, v132
v_mul_f32 v81, v133, v133
v_mul_f32 v82, v134, v134
v_mul_f32 v83, v135, v135
v_fma_f32 v80, v80, v233, v229
v_fma_f32 v81, v81, v233, v229
v_fma_f32 v82, v82, v233, v229
v_fma_f32 v83, v83, v233, v229
v_mul_f32 v80, v80, v132
v_mul_f32 v81, v81, v133
v_mul_f32 v82, v82, v134
v_mul_f32 v83, v83, v135
v_exp_f32 v80, v80
v_exp_f32 v81, v81
v_exp_f32 v82, v82
v_exp_f32 v83, v83
v_mul_f32 v180, v132, v180
s_barrier
s_lshr_b32 s44, s2, 3
s_lshl_b32 s44, s44, 17
s_add_u32 s43, s44, 65536
buffer_load_dword v30, v29, s[80:83], s43 offen
v_mul_f32 v181, v133, v181
v_mul_f32 v182, v134, v182
v_mul_f32 v183, v135, v183
v_fma_f32 v80, v80, v237, v237
v_fma_f32 v81, v81, v237, v237
v_fma_f32 v82, v82, v237, v237
v_fma_f32 v83, v83, v237, v237
v_rcp_f32 v80, v80
v_rcp_f32 v81, v81
v_rcp_f32 v82, v82
v_rcp_f32 v83, v83
v_mul_f32 v180, v180, v80
v_mul_f32 v181, v181, v81
v_mul_f32 v182, v182, v82
v_mul_f32 v183, v183, v83
v_cvt_pk_bf16_f32 v100, v180, v181
v_cvt_pk_bf16_f32 v101, v182, v183
v_mul_f32 v84, v148, v148
v_mul_f32 v85, v149, v149
v_mul_f32 v86, v150, v150
v_mul_f32 v87, v151, v151
v_fma_f32 v84, v84, v233, v229
v_fma_f32 v85, v85, v233, v229
v_fma_f32 v86, v86, v233, v229
v_fma_f32 v87, v87, v233, v229
v_mul_f32 v84, v84, v148
v_mul_f32 v85, v85, v149
v_mul_f32 v86, v86, v150
v_mul_f32 v87, v87, v151
v_exp_f32 v84, v84
s_barrier
v_exp_f32 v85, v85
v_exp_f32 v86, v86
v_exp_f32 v87, v87
v_mul_f32 v196, v148, v196
v_mul_f32 v197, v149, v197
v_mul_f32 v198, v150, v198
v_mul_f32 v199, v151, v199
v_fma_f32 v84, v84, v237, v237
v_fma_f32 v85, v85, v237, v237
v_fma_f32 v86, v86, v237, v237
v_fma_f32 v87, v87, v237, v237
v_rcp_f32 v84, v84
v_rcp_f32 v85, v85
v_rcp_f32 v86, v86
v_rcp_f32 v87, v87
v_mul_f32 v196, v196, v84
v_mul_f32 v197, v197, v85
v_mul_f32 v198, v198, v86
v_mul_f32 v199, v199, v87
v_cvt_pk_bf16_f32 v102, v196, v197
v_cvt_pk_bf16_f32 v103, v198, v199
buffer_store_dwordx4 v[100:103], v27, s[24:27], 0 offen offset:256 sc1
v_mul_f32 v80, v164, v164
v_mul_f32 v81, v165, v165
v_mul_f32 v82, v166, v166
v_mul_f32 v83, v167, v167
v_fma_f32 v80, v80, v233, v229
v_fma_f32 v81, v81, v233, v229
v_fma_f32 v82, v82, v233, v229
v_fma_f32 v83, v83, v233, v229
s_barrier
s_add_u32 s43, s34, 48
s_lshl_b32 s43, s43, 7
v_mov_b32 v21, s43
v_mov_b32 v23, 16
buffer_load_dword v22, v21, s[56:59], 0 offen sc1
v_mul_f32 v80, v80, v164
v_mul_f32 v81, v81, v165
v_mul_f32 v82, v82, v166
v_mul_f32 v83, v83, v167
v_exp_f32 v80, v80
v_exp_f32 v81, v81
v_exp_f32 v82, v82
v_exp_f32 v83, v83
v_mul_f32 v212, v164, v212
v_mul_f32 v213, v165, v213
v_mul_f32 v214, v166, v214
v_mul_f32 v215, v167, v215
v_fma_f32 v80, v80, v237, v237
v_fma_f32 v81, v81, v237, v237
v_fma_f32 v82, v82, v237, v237
v_fma_f32 v83, v83, v237, v237
v_rcp_f32 v80, v80
v_rcp_f32 v81, v81
v_rcp_f32 v82, v82
v_rcp_f32 v83, v83
v_mul_f32 v212, v212, v80
v_mul_f32 v213, v213, v81
v_mul_f32 v214, v214, v82
v_mul_f32 v215, v215, v83
v_cvt_pk_bf16_f32 v114, v212, v213
v_cvt_pk_bf16_f32 v115, v214, v215
s_nop 1
v_permlane32_swap_b32 v112, v114
v_permlane32_swap_b32 v113, v115
buffer_store_dwordx4 v[112:115], v28, s[24:27], 0 offen offset:0 sc1
s_barrier
v_mul_f32 v80, v136, v136
v_mul_f32 v81, v137, v137
v_mul_f32 v82, v138, v138
v_mul_f32 v83, v139, v139
v_fma_f32 v80, v80, v234, v230
v_fma_f32 v81, v81, v234, v230
v_fma_f32 v82, v82, v234, v230
v_fma_f32 v83, v83, v234, v230
v_mul_f32 v80, v80, v136
v_mul_f32 v81, v81, v137
v_mul_f32 v82, v82, v138
v_mul_f32 v83, v83, v139
v_exp_f32 v80, v80
v_exp_f32 v81, v81
v_exp_f32 v82, v82
v_exp_f32 v83, v83
v_mul_f32 v184, v136, v184
v_mul_f32 v185, v137, v185
v_mul_f32 v186, v138, v186
v_mul_f32 v187, v139, v187
v_fma_f32 v80, v80, v238, v238
v_fma_f32 v81, v81, v238, v238
v_fma_f32 v82, v82, v238, v238
v_fma_f32 v83, v83, v238, v238
v_rcp_f32 v80, v80
v_rcp_f32 v81, v81
v_rcp_f32 v82, v82
v_rcp_f32 v83, v83
v_mul_f32 v184, v184, v80
v_mul_f32 v185, v185, v81
s_barrier
v_mul_f32 v186, v186, v82
v_mul_f32 v187, v187, v83
v_cvt_pk_bf16_f32 v104, v184, v185
v_cvt_pk_bf16_f32 v105, v186, v187
v_mul_f32 v84, v152, v152
v_mul_f32 v85, v153, v153
v_mul_f32 v86, v154, v154
v_mul_f32 v87, v155, v155
v_fma_f32 v84, v84, v234, v230
v_fma_f32 v85, v85, v234, v230
v_fma_f32 v86, v86, v234, v230
v_fma_f32 v87, v87, v234, v230
v_mul_f32 v84, v84, v152
v_mul_f32 v85, v85, v153
v_mul_f32 v86, v86, v154
v_mul_f32 v87, v87, v155
v_exp_f32 v84, v84
v_exp_f32 v85, v85
v_exp_f32 v86, v86
v_exp_f32 v87, v87
v_mul_f32 v200, v152, v200
v_mul_f32 v201, v153, v201
v_mul_f32 v202, v154, v202
v_mul_f32 v203, v155, v203
v_fma_f32 v84, v84, v238, v238
v_fma_f32 v85, v85, v238, v238
v_fma_f32 v86, v86, v238, v238
v_fma_f32 v87, v87, v238, v238
v_rcp_f32 v84, v84
v_rcp_f32 v85, v85
s_barrier
v_rcp_f32 v86, v86
v_rcp_f32 v87, v87
v_mul_f32 v200, v200, v84
v_mul_f32 v201, v201, v85
v_mul_f32 v202, v202, v86
v_mul_f32 v203, v203, v87
v_cvt_pk_bf16_f32 v106, v200, v201
v_cvt_pk_bf16_f32 v107, v202, v203
buffer_store_dwordx4 v[104:107], v27, s[24:27], 0 offen offset:512 sc1
v_mul_f32 v80, v168, v168
v_mul_f32 v81, v169, v169
v_mul_f32 v82, v170, v170
v_mul_f32 v83, v171, v171
v_fma_f32 v80, v80, v234, v230
v_fma_f32 v81, v81, v234, v230
v_fma_f32 v82, v82, v234, v230
v_fma_f32 v83, v83, v234, v230
v_mul_f32 v80, v80, v168
v_mul_f32 v81, v81, v169
v_mul_f32 v82, v82, v170
v_mul_f32 v83, v83, v171
v_exp_f32 v80, v80
v_exp_f32 v81, v81
v_exp_f32 v82, v82
v_exp_f32 v83, v83
v_mul_f32 v216, v168, v216
v_mul_f32 v217, v169, v217
v_mul_f32 v218, v170, v218
v_mul_f32 v219, v171, v219
v_fma_f32 v80, v80, v238, v238
s_mov_b32 s41, 0x10000
Lpoll_48:
s_waitcnt vmcnt(0)
v_cmp_ne_u32 vcc, v23, v22
s_nop 4
s_cbranch_vccz Lpok_49
buffer_load_dword v22, v21, s[56:59], 0 offen sc1
s_sub_u32 s41, s41, 1
s_cmp_lg_u32 s41, 0
s_cbranch_scc1 Lpoll_48
s_waitcnt vmcnt(0)
Lpok_49:
s_barrier
v_fma_f32 v81, v81, v238, v238
v_fma_f32 v82, v82, v238, v238
v_fma_f32 v83, v83, v238, v238
v_rcp_f32 v80, v80
v_rcp_f32 v81, v81
v_rcp_f32 v82, v82
v_rcp_f32 v83, v83
v_mul_f32 v216, v216, v80
v_mul_f32 v217, v217, v81
v_mul_f32 v218, v218, v82
v_mul_f32 v219, v219, v83
v_cvt_pk_bf16_f32 v116, v216, v217
v_cvt_pk_bf16_f32 v117, v218, v219
v_mul_f32 v80, v140, v140
v_mul_f32 v81, v141, v141
v_mul_f32 v82, v142, v142
v_mul_f32 v83, v143, v143
v_fma_f32 v80, v80, v235, v231
v_fma_f32 v81, v81, v235, v231
v_fma_f32 v82, v82, v235, v231
v_fma_f32 v83, v83, v235, v231
v_mul_f32 v80, v80, v140
v_mul_f32 v81, v81, v141
v_mul_f32 v82, v82, v142
v_mul_f32 v83, v83, v143
v_exp_f32 v80, v80
v_exp_f32 v81, v81
v_exp_f32 v82, v82
v_exp_f32 v83, v83
v_mul_f32 v188, v140, v188
s_barrier
v_mul_f32 v189, v141, v189
v_mul_f32 v190, v142, v190
v_mul_f32 v191, v143, v191
v_fma_f32 v80, v80, v239, v239
v_fma_f32 v81, v81, v239, v239
v_fma_f32 v82, v82, v239, v239
v_fma_f32 v83, v83, v239, v239
v_rcp_f32 v80, v80
v_rcp_f32 v81, v81
v_rcp_f32 v82, v82
v_rcp_f32 v83, v83
v_mul_f32 v188, v188, v80
v_mul_f32 v189, v189, v81
v_mul_f32 v190, v190, v82
v_mul_f32 v191, v191, v83
v_cvt_pk_bf16_f32 v108, v188, v189
v_cvt_pk_bf16_f32 v109, v190, v191
v_mul_f32 v84, v156, v156
v_mul_f32 v85, v157, v157
v_mul_f32 v86, v158, v158
v_mul_f32 v87, v159, v159
v_fma_f32 v84, v84, v235, v231
v_fma_f32 v85, v85, v235, v231
v_fma_f32 v86, v86, v235, v231
v_fma_f32 v87, v87, v235, v231
v_mul_f32 v84, v84, v156
v_mul_f32 v85, v85, v157
v_mul_f32 v86, v86, v158
v_mul_f32 v87, v87, v159
v_exp_f32 v84, v84
s_barrier
v_exp_f32 v85, v85
v_exp_f32 v86, v86
v_exp_f32 v87, v87
v_mul_f32 v204, v156, v204
v_mul_f32 v205, v157, v205
v_mul_f32 v206, v158, v206
v_mul_f32 v207, v159, v207
v_fma_f32 v84, v84, v239, v239
v_fma_f32 v85, v85, v239, v239
v_fma_f32 v86, v86, v239, v239
v_fma_f32 v87, v87, v239, v239
v_rcp_f32 v84, v84
v_rcp_f32 v85, v85
v_rcp_f32 v86, v86
v_rcp_f32 v87, v87
v_mul_f32 v204, v204, v84
v_mul_f32 v205, v205, v85
v_mul_f32 v206, v206, v86
v_mul_f32 v207, v207, v87
v_cvt_pk_bf16_f32 v110, v204, v205
v_cvt_pk_bf16_f32 v111, v206, v207
buffer_store_dwordx4 v[108:111], v27, s[24:27], 0 offen offset:768 sc1
v_mul_f32 v80, v172, v172
v_mul_f32 v81, v173, v173
v_mul_f32 v82, v174, v174
v_mul_f32 v83, v175, v175
v_fma_f32 v80, v80, v235, v231
v_fma_f32 v81, v81, v235, v231
v_fma_f32 v82, v82, v235, v231
v_fma_f32 v83, v83, v235, v231
s_barrier
v_mul_f32 v80, v80, v172
v_mul_f32 v81, v81, v173
v_mul_f32 v82, v82, v174
v_mul_f32 v83, v83, v175
v_exp_f32 v80, v80
v_exp_f32 v81, v81
v_exp_f32 v82, v82
v_exp_f32 v83, v83
v_mul_f32 v220, v172, v220
v_mul_f32 v221, v173, v221
v_mul_f32 v222, v174, v222
v_mul_f32 v223, v175, v223
v_fma_f32 v80, v80, v239, v239
v_fma_f32 v81, v81, v239, v239
v_fma_f32 v82, v82, v239, v239
v_fma_f32 v83, v83, v239, v239
v_rcp_f32 v80, v80
v_rcp_f32 v81, v81
v_rcp_f32 v82, v82
v_rcp_f32 v83, v83
v_mul_f32 v220, v220, v80
v_mul_f32 v221, v221, v81
v_mul_f32 v222, v222, v82
v_mul_f32 v223, v223, v83
v_cvt_pk_bf16_f32 v118, v220, v221
v_cvt_pk_bf16_f32 v119, v222, v223
s_nop 1
v_permlane32_swap_b32 v116, v118
v_permlane32_swap_b32 v117, v119
buffer_store_dwordx4 v[116:119], v28, s[24:27], 0 offen offset:512 sc1
s_barrier
s_barrier
s_waitcnt vmcnt(0)
s_barrier
s_add_u32 s43, s34, 64
s_lshl_b32 s43, s43, 7
v_mov_b32 v21, s43
v_mov_b32 v22, 1
s_mov_b64 exec, 1
buffer_atomic_add v22, v21, s[56:59], 0 offen sc1
s_mov_b64 exec, -1
s_barrier
s_barrier
s_barrier
s_barrier
s_lshr_b32 s44, s2, 3
s_lshl_b32 s44, s44, 16
s_add_u32 s43, s44, 4194304
buffer_load_dword v30, v29, s[80:83], s43 offen
s_barrier
s_barrier
s_add_u32 s43, s34, 64
s_lshl_b32 s43, s43, 7
v_mov_b32 v21, s43
v_mov_b32 v23, 16
buffer_load_dword v22, v21, s[56:59], 0 offen sc1
s_barrier
s_barrier
s_barrier
s_mov_b32 s41, 0x10000
Lpoll_50:
s_waitcnt vmcnt(0)
v_cmp_ne_u32 vcc, v23, v22
s_nop 4
s_cbranch_vccz Lpok_51
buffer_load_dword v22, v21, s[56:59], 0 offen sc1
s_sub_u32 s41, s41, 1
s_cmp_lg_u32 s41, 0
s_cbranch_scc1 Lpoll_50
s_waitcnt vmcnt(0)
Lpok_51:
s_barrier
s_barrier
s_barrier
s_barrier
s_barrier
s_barrier
s_barrier
s_barrier
s_barrier
s_barrier
s_barrier
s_lshr_b32 s44, s2, 3
s_and_b32 s44, s44, 15
s_lshl_b32 s44, s44, 16
s_add_u32 s43, s44, 6291456
buffer_load_dword v30, v29, s[80:83], s43 offen
s_barrier
s_branch Ldone_1
Ldone_1:
s_endpgm
.section .rodata,"a"
.p2align 6
.amdhsa_kernel sequential_preLN__sliding_local_dilated__glu_gated_geglu__prompt_kernel
  .amdhsa_next_free_vgpr 256
  .amdhsa_next_free_sgpr 100
  .amdhsa_accum_offset 256
  .amdhsa_group_segment_fixed_size 0
  .amdhsa_kernarg_size 80
  .amdhsa_user_sgpr_count 2
  .amdhsa_user_sgpr_kernarg_segment_ptr 1
  .amdhsa_system_sgpr_workgroup_id_x 1
  .amdhsa_float_denorm_mode_32 3
  .amdhsa_float_denorm_mode_16_64 3
.end_amdhsa_kernel
```

```asm
; @launch grid=(256,1,1) block=(512,1,1) lds=151552
.amdgcn_target "amdgcn-amd-amdhsa--gfx950"
.text
.globl sequential_preLN__sliding_local_dilated__glu_gated_geglu__prompt_kernel
.p2align 8
.type sequential_preLN__sliding_local_dilated__glu_gated_geglu__prompt_kernel,@function
sequential_preLN__sliding_local_dilated__glu_gated_geglu__prompt_kernel:
s_cmp_ge_u32 s2, 256
s_cbranch_scc1 Ldone_1
s_load_dwordx4 s[4:7], s[0:1], 0
s_load_dwordx2 s[32:33], s[0:1], 72
s_load_dwordx2 s[80:81], s[0:1], 32
s_and_b32 s3, s2, 7
s_lshr_b32 s42, s2, 3
s_and_b32 s48, s42, 3
s_lshr_b32 s49, s42, 2
s_and_b32 s34, s3, 3
s_lshl_b32 s34, s34, 2
s_add_u32 s34, s34, s48
s_lshr_b32 s35, s3, 2
s_lshl_b32 s35, s35, 3
s_add_u32 s35, s35, s49
v_lshrrev_b32 v12, 6, v0
v_and_b32 v1, 63, v0
v_readfirstlane_b32 s36, v12
s_nop 3
s_lshl_b32 s43, s35, 7
s_lshl_b32 s44, s34, 18
s_lshl_b32 s45, s35, 14
s_add_u32 s45, s45, s44
s_lshl_b32 s50, s34, 7
s_sub_u32 s50, s50, 16
s_waitcnt lgkmcnt(0)
s_mov_b32 s8, s4
s_mov_b32 s9, s5
s_mov_b32 s10, 4194304
s_mov_b32 s11, 0x20000
s_add_u32 s12, s6, s43
s_addc_u32 s13, s7, 0
s_mov_b32 s14, 6289536
s_mov_b32 s15, 0x20000
s_add_u32 s16, s32, s45
s_addc_u32 s17, s33, 0
s_mov_b32 s18, 16384
s_mov_b32 s19, 0x20000
v_and_b32 v12, 15, v1
v_lshrrev_b32 v13, 4, v1
s_cmp_ge_u32 s36, 4
s_cbranch_scc1 Lprod_2
s_cmp_ge_u32 s36, 2
s_cbranch_scc1 Lsp_5
s_mov_b32 s84, s6
s_mov_b32 s85, s7
s_mov_b32 s86, 6291456
s_mov_b32 s87, 0x20000
s_and_b32 s43, s35, 8
s_or_b32 s43, s43, 3
s_lshl_b32 s43, s43, 7
s_lshr_b32 s44, s2, 3
s_mul_i32 s44, s44, 196608
s_add_u32 s43, s43, s44
s_lshl_b32 s44, s36, 6
v_add_u32 v15, s44, v1
v_min_u32 v15, 95, v15
v_mul_u32_u24 v16, 21846, v15
v_lshrrev_b32 v16, 16, v16
v_mul_u32_u24 v17, 3, v16
v_sub_u32 v15, v15, v17
v_mul_u32_u24 v16, 6144, v16
v_lshl_add_u32 v15, v15, 11, v16
buffer_load_dword v31, v15, s[84:87], s43 offen
Lsp_5:
v_lshrrev_b32 v16, 1, v12
v_xor_b32 v15, v13, v16
v_lshlrev_b32 v15, 4, v15
v_lshl_add_u32 v2, v12, 7, v15
v_xor_b32 v3, 64, v2
v_add_u32 v4, 86016, v2
v_add_u32 v5, 86016, v3
v_lshrrev_b32 v15, 2, v12
v_and_b32 v16, 3, v1
v_lshl_add_u32 v19, v13, 3, v15
v_lshlrev_b32 v19, 7, v19
v_and_b32 v15, 2, v15
v_and_b32 v17, 1, v13
v_lshl_add_u32 v15, v17, 2, v15
v_lshrrev_b32 v17, 1, v16
s_lshl_b32 s43, s36, 1
v_add_u32 v17, s43, v17
v_xor_b32 v15, v15, v17
v_lshl_add_u32 v19, v15, 4, v19
v_and_b32 v16, 1, v16
v_lshl_add_u32 v19, v16, 3, v19
v_add_u32 v6, 18432, v19
v_add_u32 v7, 61440, v19
v_add_u32 v8, 104448, v19
v_mov_b32 v128, 0
v_mov_b32 v129, 0
v_mov_b32 v130, 0
v_mov_b32 v131, 0
v_mov_b32 v132, 0
v_mov_b32 v133, 0
v_mov_b32 v134, 0
v_mov_b32 v135, 0
v_mov_b32 v136, 0
v_mov_b32 v137, 0
v_mov_b32 v138, 0
v_mov_b32 v139, 0
v_mov_b32 v140, 0
v_mov_b32 v141, 0
v_mov_b32 v142, 0
v_mov_b32 v143, 0
v_mov_b32 v144, 0
v_mov_b32 v145, 0
v_mov_b32 v146, 0
v_mov_b32 v147, 0
v_mov_b32 v148, 0
v_mov_b32 v149, 0
v_mov_b32 v150, 0
v_mov_b32 v151, 0
v_mov_b32 v152, 0
v_mov_b32 v153, 0
v_mov_b32 v154, 0
v_mov_b32 v155, 0
v_mov_b32 v156, 0
v_mov_b32 v157, 0
v_mov_b32 v158, 0
v_mov_b32 v159, 0
v_mov_b32 v160, 0
v_mov_b32 v161, 0
v_mov_b32 v162, 0
v_mov_b32 v163, 0
v_mov_b32 v164, 0
v_mov_b32 v165, 0
v_mov_b32 v166, 0
v_mov_b32 v167, 0
v_mov_b32 v168, 0
v_mov_b32 v169, 0
v_mov_b32 v170, 0
v_mov_b32 v171, 0
v_mov_b32 v172, 0
v_mov_b32 v173, 0
v_mov_b32 v174, 0
v_mov_b32 v175, 0
v_mov_b32 v176, 0
v_mov_b32 v177, 0
v_mov_b32 v178, 0
v_mov_b32 v179, 0
v_mov_b32 v180, 0
v_mov_b32 v181, 0
v_mov_b32 v182, 0
v_mov_b32 v183, 0
v_mov_b32 v184, 0
v_mov_b32 v185, 0
v_mov_b32 v186, 0
v_mov_b32 v187, 0
v_mov_b32 v188, 0
v_mov_b32 v189, 0
v_mov_b32 v190, 0
v_mov_b32 v191, 0
v_mov_b32 v192, 0
v_mov_b32 v193, 0
v_mov_b32 v194, 0
v_mov_b32 v195, 0
v_mov_b32 v196, 0
v_mov_b32 v197, 0
v_mov_b32 v198, 0
v_mov_b32 v199, 0
v_mov_b32 v200, 0
v_mov_b32 v201, 0
v_mov_b32 v202, 0
v_mov_b32 v203, 0
v_mov_b32 v204, 0
v_mov_b32 v205, 0
v_mov_b32 v206, 0
v_mov_b32 v207, 0
v_mov_b32 v208, 0
v_mov_b32 v209, 0
v_mov_b32 v210, 0
v_mov_b32 v211, 0
v_mov_b32 v212, 0
v_mov_b32 v213, 0
v_mov_b32 v214, 0
v_mov_b32 v215, 0
v_mov_b32 v216, 0
v_mov_b32 v217, 0
v_mov_b32 v218, 0
v_mov_b32 v219, 0
v_mov_b32 v220, 0
v_mov_b32 v221, 0
v_mov_b32 v222, 0
v_mov_b32 v223, 0
v_mov_b32 v224, 0
v_mov_b32 v225, 0
v_mov_b32 v226, 0
v_mov_b32 v227, 0
v_mov_b32 v228, 0
v_mov_b32 v229, 0
v_mov_b32 v230, 0
v_mov_b32 v231, 0
v_mov_b32 v232, 0
v_mov_b32 v233, 0
v_mov_b32 v234, 0
v_mov_b32 v235, 0
s_and_b32 s43, s36, 1
s_lshr_b32 s44, s36, 1
s_and_b32 s44, s44, 1
s_lshr_b32 s45, s36, 2
v_lshlrev_b32 v14, 2, v13
v_sub_u32 v14, v12, v14
v_subrev_u32 v15, 0, v14
v_cmp_ge_u32 s[52:53], 7, v15
v_add_u32 v15, 16, v15
v_cmp_ge_u32 s[84:85], 7, v15
v_subrev_u32 v15, 1, v14
v_cmp_ge_u32 s[54:55], 7, v15
v_add_u32 v15, 16, v15
v_cmp_ge_u32 s[86:87], 7, v15
v_subrev_u32 v15, 2, v14
v_cmp_ge_u32 s[56:57], 7, v15
v_add_u32 v15, 16, v15
v_cmp_ge_u32 s[88:89], 7, v15
v_subrev_u32 v15, 3, v14
v_cmp_ge_u32 s[58:59], 7, v15
v_add_u32 v15, 16, v15
v_cmp_ge_u32 s[90:91], 7, v15
s_lshl_b32 s46, s45, 6
s_add_u32 s46, s46, s44
s_add_u32 s46, s46, 16
v_lshl_add_u32 v14, v12, 1, s46
s_lshl_b32 s47, s43, 6
v_lshl_add_u32 v15, v13, 4, s47
v_mul_u32_u24 v20, 400, v14
v_add_u32 v20, v20, v15
v_subrev_u32 v16, 32, v14
v_max_i32 v16, 0, v16
v_mul_u32_u24 v21, 400, v16
v_add_u32 v21, v21, v15
v_lshrrev_b32 v16, 2, v12
v_lshl_add_u32 v16, v13, 2, v16
v_lshl_add_u32 v16, v16, 1, s46
v_and_b32 v17, 3, v1
v_lshl_add_u32 v17, v17, 3, s47
v_mul_u32_u24 v22, 400, v16
v_add_u32 v22, v22, v17
v_subrev_u32 v16, 32, v16
v_max_i32 v16, 0, v16
v_mul_u32_u24 v23, 400, v16
v_add_u32 v23, v23, v17
s_lshl_b32 s60, s43, 13
s_lshl_b32 s61, s45, 10
s_add_u32 s60, s60, s61
s_lshl_b32 s61, s44, 8
s_add_u32 s60, s60, s61
v_lshlrev_b32 v27, 11, v13
v_lshl_add_u32 v27, v12, 4, v27
v_add_u32 v27, s60, v27
v_mov_b32 v28, 0xff800000
s_mov_b32 s61, 0x3e8293ee
s_nop 2
s_or_b32 s62, s34, s45
s_cmp_lg_u32 s62, 0
s_cselect_b64 s[64:65], s[84:85], 0
s_cselect_b64 s[66:67], s[86:87], 0
s_cselect_b64 s[68:69], s[88:89], 0
s_cselect_b64 s[70:71], s[90:91], 0
v_lshlrev_b32 v9, 3, v12
v_add_u32 v9, 129024, v9
v_mul_u32_u24 v14, 400, v12
v_lshl_add_u32 v14, v13, 3, v14
s_lshl_b32 s43, s36, 5
v_add_u32 v14, s43, v14
s_barrier
ds_read_b128 v[32:35], v2 offset:0
ds_read_b64_tr_b16 v[72:73], v6 offset:8192
ds_read_b64_tr_b16 v[74:75], v6 offset:8704
ds_read_b64_tr_b16 v[76:77], v6 offset:16384
ds_read_b64_tr_b16 v[78:79], v6 offset:16896
ds_read_b64_tr_b16 v[68:69], v6 offset:0
ds_read_b64_tr_b16 v[70:71], v6 offset:512
ds_read_b128 v[36:39], v2 offset:2048
ds_read_b128 v[40:43], v2 offset:4096
ds_read_b128 v[44:47], v2 offset:6144
ds_read_b128 v[48:51], v2 offset:8192
ds_read_b128 v[52:55], v2 offset:10240
ds_read_b128 v[56:59], v2 offset:12288
ds_read_b128 v[60:63], v2 offset:14336
ds_read_b128 v[64:67], v2 offset:16384
s_mov_b32 s41, 5
Lcl_6:
s_waitcnt lgkmcnt(0)
v_mfma_f32_16x16x32_bf16 v[164:167], v[72:75], v[32:35], v[164:167]
ds_read_b128 v[80:83], v3 offset:0
v_mfma_f32_16x16x32_bf16 v[200:203], v[76:79], v[32:35], v[200:203]
ds_read_b64_tr_b16 v[120:121], v6 offset:12288
v_mfma_f32_16x16x32_bf16 v[128:131], v[68:71], v[32:35], v[128:131]
ds_read_b64_tr_b16 v[122:123], v6 offset:12800
v_mfma_f32_16x16x32_bf16 v[168:171], v[72:75], v[36:39], v[168:171]
ds_read_b64_tr_b16 v[124:125], v6 offset:20480
v_mfma_f32_16x16x32_bf16 v[204:207], v[76:79], v[36:39], v[204:207]
ds_read_b64_tr_b16 v[126:127], v6 offset:20992
v_mfma_f32_16x16x32_bf16 v[132:135], v[68:71], v[36:39], v[132:135]
ds_read_b64_tr_b16 v[116:117], v6 offset:4096
v_mfma_f32_16x16x32_bf16 v[172:175], v[72:75], v[40:43], v[172:175]
ds_read_b64_tr_b16 v[118:119], v6 offset:4608
v_mfma_f32_16x16x32_bf16 v[208:211], v[76:79], v[40:43], v[208:211]
ds_read_b128 v[84:87], v3 offset:2048
v_mfma_f32_16x16x32_bf16 v[136:139], v[68:71], v[40:43], v[136:139]
ds_read_b128 v[88:91], v3 offset:4096
v_mfma_f32_16x16x32_bf16 v[176:179], v[72:75], v[44:47], v[176:179]
ds_read_b128 v[92:95], v3 offset:6144
v_mfma_f32_16x16x32_bf16 v[212:215], v[76:79], v[44:47], v[212:215]
ds_read_b128 v[96:99], v3 offset:8192
v_mfma_f32_16x16x32_bf16 v[140:143], v[68:71], v[44:47], v[140:143]
ds_read_b128 v[100:103], v3 offset:10240
v_mfma_f32_16x16x32_bf16 v[180:183], v[72:75], v[48:51], v[180:183]
ds_read_b128 v[104:107], v3 offset:12288
v_mfma_f32_16x16x32_bf16 v[216:219], v[76:79], v[48:51], v[216:219]
ds_read_b128 v[108:111], v3 offset:14336
v_mfma_f32_16x16x32_bf16 v[144:147], v[68:71], v[48:51], v[144:147]
ds_read_b128 v[112:115], v3 offset:16384
v_mfma_f32_16x16x32_bf16 v[184:187], v[72:75], v[52:55], v[184:187]
v_mfma_f32_16x16x32_bf16 v[220:223], v[76:79], v[52:55], v[220:223]
v_mfma_f32_16x16x32_bf16 v[148:151], v[68:71], v[52:55], v[148:151]
v_mfma_f32_16x16x32_bf16 v[188:191], v[72:75], v[56:59], v[188:191]
v_mfma_f32_16x16x32_bf16 v[224:227], v[76:79], v[56:59], v[224:227]
v_mfma_f32_16x16x32_bf16 v[152:155], v[68:71], v[56:59], v[152:155]
v_mfma_f32_16x16x32_bf16 v[192:195], v[72:75], v[60:63], v[192:195]
v_mfma_f32_16x16x32_bf16 v[228:231], v[76:79], v[60:63], v[228:231]
v_mfma_f32_16x16x32_bf16 v[156:159], v[68:71], v[60:63], v[156:159]
v_mfma_f32_16x16x32_bf16 v[196:199], v[72:75], v[64:67], v[196:199]
v_mfma_f32_16x16x32_bf16 v[232:235], v[76:79], v[64:67], v[232:235]
v_mfma_f32_16x16x32_bf16 v[160:163], v[68:71], v[64:67], v[160:163]
s_waitcnt lgkmcnt(0)
s_barrier
v_mfma_f32_16x16x32_bf16 v[164:167], v[120:123], v[80:83], v[164:167]
ds_read_b128 v[32:35], v2 offset:43008
v_mfma_f32_16x16x32_bf16 v[200:203], v[124:127], v[80:83], v[200:203]
ds_read_b64_tr_b16 v[72:73], v7 offset:8192
v_mfma_f32_16x16x32_bf16 v[128:131], v[116:119], v[80:83], v[128:131]
ds_read_b64_tr_b16 v[74:75], v7 offset:8704
v_mfma_f32_16x16x32_bf16 v[168:171], v[120:123], v[84:87], v[168:171]
ds_read_b64_tr_b16 v[76:77], v7 offset:16384
v_mfma_f32_16x16x32_bf16 v[204:207], v[124:127], v[84:87], v[204:207]
ds_read_b64_tr_b16 v[78:79], v7 offset:16896
v_mfma_f32_16x16x32_bf16 v[132:135], v[116:119], v[84:87], v[132:135]
ds_read_b64_tr_b16 v[68:69], v7 offset:0
v_mfma_f32_16x16x32_bf16 v[172:175], v[120:123], v[88:91], v[172:175]
ds_read_b64_tr_b16 v[70:71], v7 offset:512
v_mfma_f32_16x16x32_bf16 v[208:211], v[124:127], v[88:91], v[208:211]
ds_read_b128 v[36:39], v2 offset:45056
v_mfma_f32_16x16x32_bf16 v[136:139], v[116:119], v[88:91], v[136:139]
ds_read_b128 v[40:43], v2 offset:47104
v_mfma_f32_16x16x32_bf16 v[176:179], v[120:123], v[92:95], v[176:179]
ds_read_b128 v[44:47], v2 offset:49152
v_mfma_f32_16x16x32_bf16 v[212:215], v[124:127], v[92:95], v[212:215]
ds_read_b128 v[48:51], v2 offset:51200
v_mfma_f32_16x16x32_bf16 v[140:143], v[116:119], v[92:95], v[140:143]
ds_read_b128 v[52:55], v2 offset:53248
v_mfma_f32_16x16x32_bf16 v[180:183], v[120:123], v[96:99], v[180:183]
ds_read_b128 v[56:59], v2 offset:55296
v_mfma_f32_16x16x32_bf16 v[216:219], v[124:127], v[96:99], v[216:219]
ds_read_b128 v[60:63], v2 offset:57344
v_mfma_f32_16x16x32_bf16 v[144:147], v[116:119], v[96:99], v[144:147]
ds_read_b128 v[64:67], v2 offset:59392
v_mfma_f32_16x16x32_bf16 v[184:187], v[120:123], v[100:103], v[184:187]
v_mfma_f32_16x16x32_bf16 v[220:223], v[124:127], v[100:103], v[220:223]
v_mfma_f32_16x16x32_bf16 v[148:151], v[116:119], v[100:103], v[148:151]
v_mfma_f32_16x16x32_bf16 v[188:191], v[120:123], v[104:107], v[188:191]
v_mfma_f32_16x16x32_bf16 v[224:227], v[124:127], v[104:107], v[224:227]
v_mfma_f32_16x16x32_bf16 v[152:155], v[116:119], v[104:107], v[152:155]
v_mfma_f32_16x16x32_bf16 v[192:195], v[120:123], v[108:111], v[192:195]
v_mfma_f32_16x16x32_bf16 v[228:231], v[124:127], v[108:111], v[228:231]
v_mfma_f32_16x16x32_bf16 v[156:159], v[116:119], v[108:111], v[156:159]
v_mfma_f32_16x16x32_bf16 v[196:199], v[120:123], v[112:115], v[196:199]
v_mfma_f32_16x16x32_bf16 v[232:235], v[124:127], v[112:115], v[232:235]
v_mfma_f32_16x16x32_bf16 v[160:163], v[116:119], v[112:115], v[160:163]
s_waitcnt lgkmcnt(0)
v_mfma_f32_16x16x32_bf16 v[164:167], v[72:75], v[32:35], v[164:167]
ds_read_b128 v[80:83], v3 offset:43008
v_mfma_f32_16x16x32_bf16 v[200:203], v[76:79], v[32:35], v[200:203]
ds_read_b64_tr_b16 v[120:121], v7 offset:12288
v_mfma_f32_16x16x32_bf16 v[128:131], v[68:71], v[32:35], v[128:131]
ds_read_b64_tr_b16 v[122:123], v7 offset:12800
v_mfma_f32_16x16x32_bf16 v[168:171], v[72:75], v[36:39], v[168:171]
ds_read_b64_tr_b16 v[124:125], v7 offset:20480
v_mfma_f32_16x16x32_bf16 v[204:207], v[76:79], v[36:39], v[204:207]
ds_read_b64_tr_b16 v[126:127], v7 offset:20992
v_mfma_f32_16x16x32_bf16 v[132:135], v[68:71], v[36:39], v[132:135]
ds_read_b64_tr_b16 v[116:117], v7 offset:4096
v_mfma_f32_16x16x32_bf16 v[172:175], v[72:75], v[40:43], v[172:175]
ds_read_b64_tr_b16 v[118:119], v7 offset:4608
v_mfma_f32_16x16x32_bf16 v[208:211], v[76:79], v[40:43], v[208:211]
ds_read_b128 v[84:87], v3 offset:45056
v_mfma_f32_16x16x32_bf16 v[136:139], v[68:71], v[40:43], v[136:139]
ds_read_b128 v[88:91], v3 offset:47104
v_mfma_f32_16x16x32_bf16 v[176:179], v[72:75], v[44:47], v[176:179]
ds_read_b128 v[92:95], v3 offset:49152
v_mfma_f32_16x16x32_bf16 v[212:215], v[76:79], v[44:47], v[212:215]
ds_read_b128 v[96:99], v3 offset:51200
v_mfma_f32_16x16x32_bf16 v[140:143], v[68:71], v[44:47], v[140:143]
ds_read_b128 v[100:103], v3 offset:53248
v_mfma_f32_16x16x32_bf16 v[180:183], v[72:75], v[48:51], v[180:183]
ds_read_b128 v[104:107], v3 offset:55296
v_mfma_f32_16x16x32_bf16 v[216:219], v[76:79], v[48:51], v[216:219]
ds_read_b128 v[108:111], v3 offset:57344
v_mfma_f32_16x16x32_bf16 v[144:147], v[68:71], v[48:51], v[144:147]
ds_read_b128 v[112:115], v3 offset:59392
v_mfma_f32_16x16x32_bf16 v[184:187], v[72:75], v[52:55], v[184:187]
v_mfma_f32_16x16x32_bf16 v[220:223], v[76:79], v[52:55], v[220:223]
v_mfma_f32_16x16x32_bf16 v[148:151], v[68:71], v[52:55], v[148:151]
v_mfma_f32_16x16x32_bf16 v[188:191], v[72:75], v[56:59], v[188:191]
v_mfma_f32_16x16x32_bf16 v[224:227], v[76:79], v[56:59], v[224:227]
v_mfma_f32_16x16x32_bf16 v[152:155], v[68:71], v[56:59], v[152:155]
v_mfma_f32_16x16x32_bf16 v[192:195], v[72:75], v[60:63], v[192:195]
v_mfma_f32_16x16x32_bf16 v[228:231], v[76:79], v[60:63], v[228:231]
v_mfma_f32_16x16x32_bf16 v[156:159], v[68:71], v[60:63], v[156:159]
v_mfma_f32_16x16x32_bf16 v[196:199], v[72:75], v[64:67], v[196:199]
v_mfma_f32_16x16x32_bf16 v[232:235], v[76:79], v[64:67], v[232:235]
v_mfma_f32_16x16x32_bf16 v[160:163], v[68:71], v[64:67], v[160:163]
s_waitcnt lgkmcnt(0)
s_barrier
v_mfma_f32_16x16x32_bf16 v[164:167], v[120:123], v[80:83], v[164:167]
ds_read_b128 v[32:35], v4 offset:0
v_mfma_f32_16x16x32_bf16 v[200:203], v[124:127], v[80:83], v[200:203]
ds_read_b64_tr_b16 v[72:73], v8 offset:8192
v_mfma_f32_16x16x32_bf16 v[128:131], v[116:119], v[80:83], v[128:131]
ds_read_b64_tr_b16 v[74:75], v8 offset:8704
v_mfma_f32_16x16x32_bf16 v[168:171], v[120:123], v[84:87], v[168:171]
ds_read_b64_tr_b16 v[76:77], v8 offset:16384
v_mfma_f32_16x16x32_bf16 v[204:207], v[124:127], v[84:87], v[204:207]
ds_read_b64_tr_b16 v[78:79], v8 offset:16896
v_mfma_f32_16x16x32_bf16 v[132:135], v[116:119], v[84:87], v[132:135]
ds_read_b64_tr_b16 v[68:69], v8 offset:0
v_mfma_f32_16x16x32_bf16 v[172:175], v[120:123], v[88:91], v[172:175]
ds_read_b64_tr_b16 v[70:71], v8 offset:512
v_mfma_f32_16x16x32_bf16 v[208:211], v[124:127], v[88:91], v[208:211]
ds_read_b128 v[36:39], v4 offset:2048
v_mfma_f32_16x16x32_bf16 v[136:139], v[116:119], v[88:91], v[136:139]
ds_read_b128 v[40:43], v4 offset:4096
v_mfma_f32_16x16x32_bf16 v[176:179], v[120:123], v[92:95], v[176:179]
ds_read_b128 v[44:47], v4 offset:6144
v_mfma_f32_16x16x32_bf16 v[212:215], v[124:127], v[92:95], v[212:215]
ds_read_b128 v[48:51], v4 offset:8192
v_mfma_f32_16x16x32_bf16 v[140:143], v[116:119], v[92:95], v[140:143]
ds_read_b128 v[52:55], v4 offset:10240
v_mfma_f32_16x16x32_bf16 v[180:183], v[120:123], v[96:99], v[180:183]
ds_read_b128 v[56:59], v4 offset:12288
v_mfma_f32_16x16x32_bf16 v[216:219], v[124:127], v[96:99], v[216:219]
ds_read_b128 v[60:63], v4 offset:14336
v_mfma_f32_16x16x32_bf16 v[144:147], v[116:119], v[96:99], v[144:147]
ds_read_b128 v[64:67], v4 offset:16384
v_mfma_f32_16x16x32_bf16 v[184:187], v[120:123], v[100:103], v[184:187]
v_mfma_f32_16x16x32_bf16 v[220:223], v[124:127], v[100:103], v[220:223]
v_mfma_f32_16x16x32_bf16 v[148:151], v[116:119], v[100:103], v[148:151]
v_mfma_f32_16x16x32_bf16 v[188:191], v[120:123], v[104:107], v[188:191]
v_mfma_f32_16x16x32_bf16 v[224:227], v[124:127], v[104:107], v[224:227]
v_mfma_f32_16x16x32_bf16 v[152:155], v[116:119], v[104:107], v[152:155]
v_mfma_f32_16x16x32_bf16 v[192:195], v[120:123], v[108:111], v[192:195]
v_mfma_f32_16x16x32_bf16 v[228:231], v[124:127], v[108:111], v[228:231]
v_mfma_f32_16x16x32_bf16 v[156:159], v[116:119], v[108:111], v[156:159]
v_mfma_f32_16x16x32_bf16 v[196:199], v[120:123], v[112:115], v[196:199]
v_mfma_f32_16x16x32_bf16 v[232:235], v[124:127], v[112:115], v[232:235]
v_mfma_f32_16x16x32_bf16 v[160:163], v[116:119], v[112:115], v[160:163]
s_waitcnt lgkmcnt(0)
v_mfma_f32_16x16x32_bf16 v[164:167], v[72:75], v[32:35], v[164:167]
ds_read_b128 v[80:83], v5 offset:0
v_mfma_f32_16x16x32_bf16 v[200:203], v[76:79], v[32:35], v[200:203]
ds_read_b64_tr_b16 v[120:121], v8 offset:12288
v_mfma_f32_16x16x32_bf16 v[128:131], v[68:71], v[32:35], v[128:131]
ds_read_b64_tr_b16 v[122:123], v8 offset:12800
v_mfma_f32_16x16x32_bf16 v[168:171], v[72:75], v[36:39], v[168:171]
ds_read_b64_tr_b16 v[124:125], v8 offset:20480
v_mfma_f32_16x16x32_bf16 v[204:207], v[76:79], v[36:39], v[204:207]
ds_read_b64_tr_b16 v[126:127], v8 offset:20992
v_mfma_f32_16x16x32_bf16 v[132:135], v[68:71], v[36:39], v[132:135]
ds_read_b64_tr_b16 v[116:117], v8 offset:4096
v_mfma_f32_16x16x32_bf16 v[172:175], v[72:75], v[40:43], v[172:175]
ds_read_b64_tr_b16 v[118:119], v8 offset:4608
v_mfma_f32_16x16x32_bf16 v[208:211], v[76:79], v[40:43], v[208:211]
ds_read_b128 v[84:87], v5 offset:2048
v_mfma_f32_16x16x32_bf16 v[136:139], v[68:71], v[40:43], v[136:139]
ds_read_b128 v[88:91], v5 offset:4096
v_mfma_f32_16x16x32_bf16 v[176:179], v[72:75], v[44:47], v[176:179]
ds_read_b128 v[92:95], v5 offset:6144
v_mfma_f32_16x16x32_bf16 v[212:215], v[76:79], v[44:47], v[212:215]
ds_read_b128 v[96:99], v5 offset:8192
v_mfma_f32_16x16x32_bf16 v[140:143], v[68:71], v[44:47], v[140:143]
ds_read_b128 v[100:103], v5 offset:10240
v_mfma_f32_16x16x32_bf16 v[180:183], v[72:75], v[48:51], v[180:183]
ds_read_b128 v[104:107], v5 offset:12288
v_mfma_f32_16x16x32_bf16 v[216:219], v[76:79], v[48:51], v[216:219]
ds_read_b128 v[108:111], v5 offset:14336
v_mfma_f32_16x16x32_bf16 v[144:147], v[68:71], v[48:51], v[144:147]
ds_read_b128 v[112:115], v5 offset:16384
v_mfma_f32_16x16x32_bf16 v[184:187], v[72:75], v[52:55], v[184:187]
v_mfma_f32_16x16x32_bf16 v[220:223], v[76:79], v[52:55], v[220:223]
v_mfma_f32_16x16x32_bf16 v[148:151], v[68:71], v[52:55], v[148:151]
v_mfma_f32_16x16x32_bf16 v[188:191], v[72:75], v[56:59], v[188:191]
v_mfma_f32_16x16x32_bf16 v[224:227], v[76:79], v[56:59], v[224:227]
v_mfma_f32_16x16x32_bf16 v[152:155], v[68:71], v[56:59], v[152:155]
v_mfma_f32_16x16x32_bf16 v[192:195], v[72:75], v[60:63], v[192:195]
v_mfma_f32_16x16x32_bf16 v[228:231], v[76:79], v[60:63], v[228:231]
v_mfma_f32_16x16x32_bf16 v[156:159], v[68:71], v[60:63], v[156:159]
v_mfma_f32_16x16x32_bf16 v[196:199], v[72:75], v[64:67], v[196:199]
v_mfma_f32_16x16x32_bf16 v[232:235], v[76:79], v[64:67], v[232:235]
v_mfma_f32_16x16x32_bf16 v[160:163], v[68:71], v[64:67], v[160:163]
s_waitcnt lgkmcnt(0)
s_barrier
v_mfma_f32_16x16x32_bf16 v[164:167], v[120:123], v[80:83], v[164:167]
ds_read_b128 v[32:35], v2 offset:0
v_mfma_f32_16x16x32_bf16 v[200:203], v[124:127], v[80:83], v[200:203]
ds_read_b64_tr_b16 v[72:73], v6 offset:8192
v_mfma_f32_16x16x32_bf16 v[128:131], v[116:119], v[80:83], v[128:131]
ds_read_b64_tr_b16 v[74:75], v6 offset:8704
v_mfma_f32_16x16x32_bf16 v[168:171], v[120:123], v[84:87], v[168:171]
ds_read_b64_tr_b16 v[76:77], v6 offset:16384
v_mfma_f32_16x16x32_bf16 v[204:207], v[124:127], v[84:87], v[204:207]
ds_read_b64_tr_b16 v[78:79], v6 offset:16896
v_mfma_f32_16x16x32_bf16 v[132:135], v[116:119], v[84:87], v[132:135]
ds_read_b64_tr_b16 v[68:69], v6 offset:0
v_mfma_f32_16x16x32_bf16 v[172:175], v[120:123], v[88:91], v[172:175]
ds_read_b64_tr_b16 v[70:71], v6 offset:512
v_mfma_f32_16x16x32_bf16 v[208:211], v[124:127], v[88:91], v[208:211]
ds_read_b128 v[36:39], v2 offset:2048
v_mfma_f32_16x16x32_bf16 v[136:139], v[116:119], v[88:91], v[136:139]
ds_read_b128 v[40:43], v2 offset:4096
v_mfma_f32_16x16x32_bf16 v[176:179], v[120:123], v[92:95], v[176:179]
ds_read_b128 v[44:47], v2 offset:6144
v_mfma_f32_16x16x32_bf16 v[212:215], v[124:127], v[92:95], v[212:215]
ds_read_b128 v[48:51], v2 offset:8192
v_mfma_f32_16x16x32_bf16 v[140:143], v[116:119], v[92:95], v[140:143]
ds_read_b128 v[52:55], v2 offset:10240
v_mfma_f32_16x16x32_bf16 v[180:183], v[120:123], v[96:99], v[180:183]
ds_read_b128 v[56:59], v2 offset:12288
v_mfma_f32_16x16x32_bf16 v[216:219], v[124:127], v[96:99], v[216:219]
ds_read_b128 v[60:63], v2 offset:14336
v_mfma_f32_16x16x32_bf16 v[144:147], v[116:119], v[96:99], v[144:147]
ds_read_b128 v[64:67], v2 offset:16384
v_mfma_f32_16x16x32_bf16 v[184:187], v[120:123], v[100:103], v[184:187]
v_mfma_f32_16x16x32_bf16 v[220:223], v[124:127], v[100:103], v[220:223]
v_mfma_f32_16x16x32_bf16 v[148:151], v[116:119], v[100:103], v[148:151]
v_mfma_f32_16x16x32_bf16 v[188:191], v[120:123], v[104:107], v[188:191]
v_mfma_f32_16x16x32_bf16 v[224:227], v[124:127], v[104:107], v[224:227]
v_mfma_f32_16x16x32_bf16 v[152:155], v[116:119], v[104:107], v[152:155]
v_mfma_f32_16x16x32_bf16 v[192:195], v[120:123], v[108:111], v[192:195]
v_mfma_f32_16x16x32_bf16 v[228:231], v[124:127], v[108:111], v[228:231]
v_mfma_f32_16x16x32_bf16 v[156:159], v[116:119], v[108:111], v[156:159]
v_mfma_f32_16x16x32_bf16 v[196:199], v[120:123], v[112:115], v[196:199]
v_mfma_f32_16x16x32_bf16 v[232:235], v[124:127], v[112:115], v[232:235]
v_mfma_f32_16x16x32_bf16 v[160:163], v[116:119], v[112:115], v[160:163]
s_sub_u32 s41, s41, 1
s_cmp_lg_u32 s41, 0
s_cbranch_scc1 Lcl_6
s_waitcnt lgkmcnt(0)
v_mfma_f32_16x16x32_bf16 v[164:167], v[72:75], v[32:35], v[164:167]
ds_read_b128 v[80:83], v3 offset:0
v_mfma_f32_16x16x32_bf16 v[200:203], v[76:79], v[32:35], v[200:203]
ds_read_b64_tr_b16 v[120:121], v6 offset:12288
v_mfma_f32_16x16x32_bf16 v[128:131], v[68:71], v[32:35], v[128:131]
ds_read_b64_tr_b16 v[122:123], v6 offset:12800
v_mfma_f32_16x16x32_bf16 v[168:171], v[72:75], v[36:39], v[168:171]
ds_read_b64_tr_b16 v[124:125], v6 offset:20480
v_mfma_f32_16x16x32_bf16 v[204:207], v[76:79], v[36:39], v[204:207]
ds_read_b64_tr_b16 v[126:127], v6 offset:20992
v_mfma_f32_16x16x32_bf16 v[132:135], v[68:71], v[36:39], v[132:135]
ds_read_b64_tr_b16 v[116:117], v6 offset:4096
v_mfma_f32_16x16x32_bf16 v[172:175], v[72:75], v[40:43], v[172:175]
ds_read_b64_tr_b16 v[118:119], v6 offset:4608
v_mfma_f32_16x16x32_bf16 v[208:211], v[76:79], v[40:43], v[208:211]
ds_read_b128 v[84:87], v3 offset:2048
v_mfma_f32_16x16x32_bf16 v[136:139], v[68:71], v[40:43], v[136:139]
ds_read_b128 v[88:91], v3 offset:4096
v_mfma_f32_16x16x32_bf16 v[176:179], v[72:75], v[44:47], v[176:179]
ds_read_b128 v[92:95], v3 offset:6144
v_mfma_f32_16x16x32_bf16 v[212:215], v[76:79], v[44:47], v[212:215]
ds_read_b128 v[96:99], v3 offset:8192
v_mfma_f32_16x16x32_bf16 v[140:143], v[68:71], v[44:47], v[140:143]
ds_read_b128 v[100:103], v3 offset:10240
v_mfma_f32_16x16x32_bf16 v[180:183], v[72:75], v[48:51], v[180:183]
ds_read_b128 v[104:107], v3 offset:12288
v_mfma_f32_16x16x32_bf16 v[216:219], v[76:79], v[48:51], v[216:219]
ds_read_b128 v[108:111], v3 offset:14336
v_mfma_f32_16x16x32_bf16 v[144:147], v[68:71], v[48:51], v[144:147]
ds_read_b128 v[112:115], v3 offset:16384
v_mfma_f32_16x16x32_bf16 v[184:187], v[72:75], v[52:55], v[184:187]
v_mfma_f32_16x16x32_bf16 v[220:223], v[76:79], v[52:55], v[220:223]
v_mfma_f32_16x16x32_bf16 v[148:151], v[68:71], v[52:55], v[148:151]
v_mfma_f32_16x16x32_bf16 v[188:191], v[72:75], v[56:59], v[188:191]
v_mfma_f32_16x16x32_bf16 v[224:227], v[76:79], v[56:59], v[224:227]
v_mfma_f32_16x16x32_bf16 v[152:155], v[68:71], v[56:59], v[152:155]
v_mfma_f32_16x16x32_bf16 v[192:195], v[72:75], v[60:63], v[192:195]
v_mfma_f32_16x16x32_bf16 v[228:231], v[76:79], v[60:63], v[228:231]
v_mfma_f32_16x16x32_bf16 v[156:159], v[68:71], v[60:63], v[156:159]
v_mfma_f32_16x16x32_bf16 v[196:199], v[72:75], v[64:67], v[196:199]
v_mfma_f32_16x16x32_bf16 v[232:235], v[76:79], v[64:67], v[232:235]
v_mfma_f32_16x16x32_bf16 v[160:163], v[68:71], v[64:67], v[160:163]
s_waitcnt lgkmcnt(0)
s_barrier
v_mfma_f32_16x16x32_bf16 v[164:167], v[120:123], v[80:83], v[164:167]
ds_read_b64 v[32:33], v9 offset:0
v_mfma_f32_16x16x32_bf16 v[200:203], v[124:127], v[80:83], v[200:203]
ds_read_b64 v[34:35], v9 offset:128
v_mfma_f32_16x16x32_bf16 v[128:131], v[116:119], v[80:83], v[128:131]
ds_read_b64 v[36:37], v9 offset:256
v_mfma_f32_16x16x32_bf16 v[168:171], v[120:123], v[84:87], v[168:171]
ds_read_b64 v[38:39], v9 offset:384
v_mfma_f32_16x16x32_bf16 v[204:207], v[124:127], v[84:87], v[204:207]
ds_read_b64 v[40:41], v9 offset:512
v_mfma_f32_16x16x32_bf16 v[132:135], v[116:119], v[84:87], v[132:135]
ds_read_b64 v[42:43], v9 offset:640
v_mfma_f32_16x16x32_bf16 v[172:175], v[120:123], v[88:91], v[172:175]
ds_read_b64 v[44:45], v9 offset:768
v_mfma_f32_16x16x32_bf16 v[208:211], v[124:127], v[88:91], v[208:211]
ds_read_b64 v[46:47], v9 offset:896
v_mfma_f32_16x16x32_bf16 v[136:139], v[116:119], v[88:91], v[136:139]
ds_read_b64 v[48:49], v9 offset:1024
v_mfma_f32_16x16x32_bf16 v[176:179], v[120:123], v[92:95], v[176:179]
v_mfma_f32_16x16x32_bf16 v[212:215], v[124:127], v[92:95], v[212:215]
v_mfma_f32_16x16x32_bf16 v[140:143], v[116:119], v[92:95], v[140:143]
v_mfma_f32_16x16x32_bf16 v[180:183], v[120:123], v[96:99], v[180:183]
v_mfma_f32_16x16x32_bf16 v[216:219], v[124:127], v[96:99], v[216:219]
v_mfma_f32_16x16x32_bf16 v[144:147], v[116:119], v[96:99], v[144:147]
v_mfma_f32_16x16x32_bf16 v[184:187], v[120:123], v[100:103], v[184:187]
v_mfma_f32_16x16x32_bf16 v[220:223], v[124:127], v[100:103], v[220:223]
v_mfma_f32_16x16x32_bf16 v[148:151], v[116:119], v[100:103], v[148:151]
v_mfma_f32_16x16x32_bf16 v[188:191], v[120:123], v[104:107], v[188:191]
v_mfma_f32_16x16x32_bf16 v[224:227], v[124:127], v[104:107], v[224:227]
v_mfma_f32_16x16x32_bf16 v[152:155], v[116:119], v[104:107], v[152:155]
v_mfma_f32_16x16x32_bf16 v[192:195], v[120:123], v[108:111], v[192:195]
v_mfma_f32_16x16x32_bf16 v[228:231], v[124:127], v[108:111], v[228:231]
v_mfma_f32_16x16x32_bf16 v[156:159], v[116:119], v[108:111], v[156:159]
v_mfma_f32_16x16x32_bf16 v[196:199], v[120:123], v[112:115], v[196:199]
v_mfma_f32_16x16x32_bf16 v[232:235], v[124:127], v[112:115], v[232:235]
v_mfma_f32_16x16x32_bf16 v[160:163], v[116:119], v[112:115], v[160:163]
v_mov_b32_dpp v52, v128 row_newbcast:0 row_mask:0xf bank_mask:0xf
v_mov_b32_dpp v53, v129 row_newbcast:0 row_mask:0xf bank_mask:0xf
v_mov_b32_dpp v54, v130 row_newbcast:0 row_mask:0xf bank_mask:0xf
v_mov_b32_dpp v55, v131 row_newbcast:0 row_mask:0xf bank_mask:0xf
v_mov_b32_dpp v56, v164 row_newbcast:0 row_mask:0xf bank_mask:0xf
v_mov_b32_dpp v57, v165 row_newbcast:0 row_mask:0xf bank_mask:0xf
v_mov_b32_dpp v58, v166 row_newbcast:0 row_mask:0xf bank_mask:0xf
v_mov_b32_dpp v59, v167 row_newbcast:0 row_mask:0xf bank_mask:0xf
v_mov_b32_dpp v60, v200 row_newbcast:0 row_mask:0xf bank_mask:0xf
v_mov_b32_dpp v61, v201 row_newbcast:0 row_mask:0xf bank_mask:0xf
v_mov_b32_dpp v62, v202 row_newbcast:0 row_mask:0xf bank_mask:0xf
v_mov_b32_dpp v63, v203 row_newbcast:0 row_mask:0xf bank_mask:0xf
s_waitcnt lgkmcnt(0)
v_pk_fma_f32 v[164:165], v[32:33], v[56:57], v[164:165] op_sel_hi:[0,1,1] neg_lo:[1,0,0] neg_hi:[1,0,0]
v_pk_fma_f32 v[166:167], v[32:33], v[58:59], v[166:167] op_sel_hi:[0,1,1] neg_lo:[1,0,0] neg_hi:[1,0,0]
v_pk_mul_f32 v[164:165], v[32:33], v[164:165] op_sel:[1,0] op_sel_hi:[1,1]
v_pk_mul_f32 v[166:167], v[32:33], v[166:167] op_sel:[1,0] op_sel_hi:[1,1]
v_cvt_pk_bf16_f32 v164, v164, v165
v_cvt_pk_bf16_f32 v165, v166, v167
ds_write_b64 v14, v[164:165] offset:128
v_pk_fma_f32 v[200:201], v[32:33], v[60:61], v[200:201] op_sel_hi:[0,1,1] neg_lo:[1,0,0] neg_hi:[1,0,0]
v_pk_fma_f32 v[202:203], v[32:33], v[62:63], v[202:203] op_sel_hi:[0,1,1] neg_lo:[1,0,0] neg_hi:[1,0,0]
v_pk_mul_f32 v[200:201], v[32:33], v[200:201] op_sel:[1,0] op_sel_hi:[1,1]
v_pk_mul_f32 v[202:203], v[32:33], v[202:203] op_sel:[1,0] op_sel_hi:[1,1]
v_cvt_pk_bf16_f32 v200, v200, v201
v_cvt_pk_bf16_f32 v201, v202, v203
ds_write_b64 v14, v[200:201] offset:256
v_pk_fma_f32 v[132:133], v[34:35], v[52:53], v[132:133] op_sel_hi:[0,1,1] neg_lo:[1,0,0] neg_hi:[1,0,0]
v_pk_fma_f32 v[134:135], v[34:35], v[54:55], v[134:135] op_sel_hi:[0,1,1] neg_lo:[1,0,0] neg_hi:[1,0,0]
v_pk_mul_f32 v[132:133], v[34:35], v[132:133] op_sel:[1,0] op_sel_hi:[1,1]
v_pk_mul_f32 v[134:135], v[34:35], v[134:135] op_sel:[1,0] op_sel_hi:[1,1]
v_cvt_pk_bf16_f32 v132, v132, v133
v_cvt_pk_bf16_f32 v133, v134, v135
ds_write_b64 v14, v[132:133] offset:6400
v_pk_fma_f32 v[168:169], v[34:35], v[56:57], v[168:169] op_sel_hi:[0,1,1] neg_lo:[1,0,0] neg_hi:[1,0,0]
v_pk_fma_f32 v[170:171], v[34:35], v[58:59], v[170:171] op_sel_hi:[0,1,1] neg_lo:[1,0,0] neg_hi:[1,0,0]
v_pk_mul_f32 v[168:169], v[34:35], v[168:169] op_sel:[1,0] op_sel_hi:[1,1]
v_pk_mul_f32 v[170:171], v[34:35], v[170:171] op_sel:[1,0] op_sel_hi:[1,1]
v_cvt_pk_bf16_f32 v168, v168, v169
v_cvt_pk_bf16_f32 v169, v170, v171
ds_write_b64 v14, v[168:169] offset:6528
v_pk_fma_f32 v[204:205], v[34:35], v[60:61], v[204:205] op_sel_hi:[0,1,1] neg_lo:[1,0,0] neg_hi:[1,0,0]
v_pk_fma_f32 v[206:207], v[34:35], v[62:63], v[206:207] op_sel_hi:[0,1,1] neg_lo:[1,0,0] neg_hi:[1,0,0]
v_pk_mul_f32 v[204:205], v[34:35], v[204:205] op_sel:[1,0] op_sel_hi:[1,1]
v_pk_mul_f32 v[206:207], v[34:35], v[206:207] op_sel:[1,0] op_sel_hi:[1,1]
v_cvt_pk_bf16_f32 v204, v204, v205
v_cvt_pk_bf16_f32 v205, v206, v207
ds_write_b64 v14, v[204:205] offset:6656
v_pk_fma_f32 v[136:137], v[36:37], v[52:53], v[136:137] op_sel_hi:[0,1,1] neg_lo:[1,0,0] neg_hi:[1,0,0]
v_pk_fma_f32 v[138:139], v[36:37], v[54:55], v[138:139] op_sel_hi:[0,1,1] neg_lo:[1,0,0] neg_hi:[1,0,0]
v_pk_mul_f32 v[136:137], v[36:37], v[136:137] op_sel:[1,0] op_sel_hi:[1,1]
v_pk_mul_f32 v[138:139], v[36:37], v[138:139] op_sel:[1,0] op_sel_hi:[1,1]
v_cvt_pk_bf16_f32 v136, v136, v137
v_cvt_pk_bf16_f32 v137, v138, v139
ds_write_b64 v14, v[136:137] offset:12800
v_pk_fma_f32 v[172:173], v[36:37], v[56:57], v[172:173] op_sel_hi:[0,1,1] neg_lo:[1,0,0] neg_hi:[1,0,0]
v_pk_fma_f32 v[174:175], v[36:37], v[58:59], v[174:175] op_sel_hi:[0,1,1] neg_lo:[1,0,0] neg_hi:[1,0,0]
v_pk_mul_f32 v[172:173], v[36:37], v[172:173] op_sel:[1,0] op_sel_hi:[1,1]
v_pk_mul_f32 v[174:175], v[36:37], v[174:175] op_sel:[1,0] op_sel_hi:[1,1]
v_cvt_pk_bf16_f32 v172, v172, v173
v_cvt_pk_bf16_f32 v173, v174, v175
ds_write_b64 v14, v[172:173] offset:12928
v_pk_fma_f32 v[208:209], v[36:37], v[60:61], v[208:209] op_sel_hi:[0,1,1] neg_lo:[1,0,0] neg_hi:[1,0,0]
v_pk_fma_f32 v[210:211], v[36:37], v[62:63], v[210:211] op_sel_hi:[0,1,1] neg_lo:[1,0,0] neg_hi:[1,0,0]
v_pk_mul_f32 v[208:209], v[36:37], v[208:209] op_sel:[1,0] op_sel_hi:[1,1]
v_pk_mul_f32 v[210:211], v[36:37], v[210:211] op_sel:[1,0] op_sel_hi:[1,1]
v_cvt_pk_bf16_f32 v208, v208, v209
v_cvt_pk_bf16_f32 v209, v210, v211
ds_write_b64 v14, v[208:209] offset:13056
v_pk_fma_f32 v[140:141], v[38:39], v[52:53], v[140:141] op_sel_hi:[0,1,1] neg_lo:[1,0,0] neg_hi:[1,0,0]
v_pk_fma_f32 v[142:143], v[38:39], v[54:55], v[142:143] op_sel_hi:[0,1,1] neg_lo:[1,0,0] neg_hi:[1,0,0]
v_pk_mul_f32 v[140:141], v[38:39], v[140:141] op_sel:[1,0] op_sel_hi:[1,1]
v_pk_mul_f32 v[142:143], v[38:39], v[142:143] op_sel:[1,0] op_sel_hi:[1,1]
v_cvt_pk_bf16_f32 v140, v140, v141
v_cvt_pk_bf16_f32 v141, v142, v143
ds_write_b64 v14, v[140:141] offset:19200
v_pk_fma_f32 v[176:177], v[38:39], v[56:57], v[176:177] op_sel_hi:[0,1,1] neg_lo:[1,0,0] neg_hi:[1,0,0]
v_pk_fma_f32 v[178:179], v[38:39], v[58:59], v[178:179] op_sel_hi:[0,1,1] neg_lo:[1,0,0] neg_hi:[1,0,0]
v_pk_mul_f32 v[176:177], v[38:39], v[176:177] op_sel:[1,0] op_sel_hi:[1,1]
v_pk_mul_f32 v[178:179], v[38:39], v[178:179] op_sel:[1,0] op_sel_hi:[1,1]
v_cvt_pk_bf16_f32 v176, v176, v177
v_cvt_pk_bf16_f32 v177, v178, v179
ds_write_b64 v14, v[176:177] offset:19328
v_pk_fma_f32 v[212:213], v[38:39], v[60:61], v[212:213] op_sel_hi:[0,1,1] neg_lo:[1,0,0] neg_hi:[1,0,0]
v_pk_fma_f32 v[214:215], v[38:39], v[62:63], v[214:215] op_sel_hi:[0,1,1] neg_lo:[1,0,0] neg_hi:[1,0,0]
v_pk_mul_f32 v[212:213], v[38:39], v[212:213] op_sel:[1,0] op_sel_hi:[1,1]
v_pk_mul_f32 v[214:215], v[38:39], v[214:215] op_sel:[1,0] op_sel_hi:[1,1]
v_cvt_pk_bf16_f32 v212, v212, v213
v_cvt_pk_bf16_f32 v213, v214, v215
ds_write_b64 v14, v[212:213] offset:19456
v_pk_fma_f32 v[144:145], v[40:41], v[52:53], v[144:145] op_sel_hi:[0,1,1] neg_lo:[1,0,0] neg_hi:[1,0,0]
v_pk_fma_f32 v[146:147], v[40:41], v[54:55], v[146:147] op_sel_hi:[0,1,1] neg_lo:[1,0,0] neg_hi:[1,0,0]
v_pk_mul_f32 v[144:145], v[40:41], v[144:145] op_sel:[1,0] op_sel_hi:[1,1]
v_pk_mul_f32 v[146:147], v[40:41], v[146:147] op_sel:[1,0] op_sel_hi:[1,1]
v_cvt_pk_bf16_f32 v144, v144, v145
v_cvt_pk_bf16_f32 v145, v146, v147
ds_write_b64 v14, v[144:145] offset:25600
v_pk_fma_f32 v[180:181], v[40:41], v[56:57], v[180:181] op_sel_hi:[0,1,1] neg_lo:[1,0,0] neg_hi:[1,0,0]
v_pk_fma_f32 v[182:183], v[40:41], v[58:59], v[182:183] op_sel_hi:[0,1,1] neg_lo:[1,0,0] neg_hi:[1,0,0]
v_pk_mul_f32 v[180:181], v[40:41], v[180:181] op_sel:[1,0] op_sel_hi:[1,1]
v_pk_mul_f32 v[182:183], v[40:41], v[182:183] op_sel:[1,0] op_sel_hi:[1,1]
v_cvt_pk_bf16_f32 v180, v180, v181
v_cvt_pk_bf16_f32 v181, v182, v183
ds_write_b64 v14, v[180:181] offset:25728
v_pk_fma_f32 v[216:217], v[40:41], v[60:61], v[216:217] op_sel_hi:[0,1,1] neg_lo:[1,0,0] neg_hi:[1,0,0]
v_pk_fma_f32 v[218:219], v[40:41], v[62:63], v[218:219] op_sel_hi:[0,1,1] neg_lo:[1,0,0] neg_hi:[1,0,0]
v_pk_mul_f32 v[216:217], v[40:41], v[216:217] op_sel:[1,0] op_sel_hi:[1,1]
v_pk_mul_f32 v[218:219], v[40:41], v[218:219] op_sel:[1,0] op_sel_hi:[1,1]
v_cvt_pk_bf16_f32 v216, v216, v217
v_cvt_pk_bf16_f32 v217, v218, v219
ds_write_b64 v14, v[216:217] offset:25856
v_pk_fma_f32 v[148:149], v[42:43], v[52:53], v[148:149] op_sel_hi:[0,1,1] neg_lo:[1,0,0] neg_hi:[1,0,0]
v_pk_fma_f32 v[150:151], v[42:43], v[54:55], v[150:151] op_sel_hi:[0,1,1] neg_lo:[1,0,0] neg_hi:[1,0,0]
v_pk_mul_f32 v[148:149], v[42:43], v[148:149] op_sel:[1,0] op_sel_hi:[1,1]
v_pk_mul_f32 v[150:151], v[42:43], v[150:151] op_sel:[1,0] op_sel_hi:[1,1]
v_cvt_pk_bf16_f32 v148, v148, v149
v_cvt_pk_bf16_f32 v149, v150, v151
ds_write_b64 v14, v[148:149] offset:32000
v_pk_fma_f32 v[184:185], v[42:43], v[56:57], v[184:185] op_sel_hi:[0,1,1] neg_lo:[1,0,0] neg_hi:[1,0,0]
v_pk_fma_f32 v[186:187], v[42:43], v[58:59], v[186:187] op_sel_hi:[0,1,1] neg_lo:[1,0,0] neg_hi:[1,0,0]
v_pk_mul_f32 v[184:185], v[42:43], v[184:185] op_sel:[1,0] op_sel_hi:[1,1]
v_pk_mul_f32 v[186:187], v[42:43], v[186:187] op_sel:[1,0] op_sel_hi:[1,1]
v_cvt_pk_bf16_f32 v184, v184, v185
v_cvt_pk_bf16_f32 v185, v186, v187
ds_write_b64 v14, v[184:185] offset:32128
v_pk_fma_f32 v[220:221], v[42:43], v[60:61], v[220:221] op_sel_hi:[0,1,1] neg_lo:[1,0,0] neg_hi:[1,0,0]
v_pk_fma_f32 v[222:223], v[42:43], v[62:63], v[222:223] op_sel_hi:[0,1,1] neg_lo:[1,0,0] neg_hi:[1,0,0]
v_pk_mul_f32 v[220:221], v[42:43], v[220:221] op_sel:[1,0] op_sel_hi:[1,1]
v_pk_mul_f32 v[222:223], v[42:43], v[222:223] op_sel:[1,0] op_sel_hi:[1,1]
v_cvt_pk_bf16_f32 v220, v220, v221
v_cvt_pk_bf16_f32 v221, v222, v223
ds_write_b64 v14, v[220:221] offset:32256
v_pk_fma_f32 v[152:153], v[44:45], v[52:53], v[152:153] op_sel_hi:[0,1,1] neg_lo:[1,0,0] neg_hi:[1,0,0]
v_pk_fma_f32 v[154:155], v[44:45], v[54:55], v[154:155] op_sel_hi:[0,1,1] neg_lo:[1,0,0] neg_hi:[1,0,0]
v_pk_mul_f32 v[152:153], v[44:45], v[152:153] op_sel:[1,0] op_sel_hi:[1,1]
v_pk_mul_f32 v[154:155], v[44:45], v[154:155] op_sel:[1,0] op_sel_hi:[1,1]
v_cvt_pk_bf16_f32 v152, v152, v153
v_cvt_pk_bf16_f32 v153, v154, v155
ds_write_b64 v14, v[152:153] offset:38400
v_pk_fma_f32 v[188:189], v[44:45], v[56:57], v[188:189] op_sel_hi:[0,1,1] neg_lo:[1,0,0] neg_hi:[1,0,0]
v_pk_fma_f32 v[190:191], v[44:45], v[58:59], v[190:191] op_sel_hi:[0,1,1] neg_lo:[1,0,0] neg_hi:[1,0,0]
v_pk_mul_f32 v[188:189], v[44:45], v[188:189] op_sel:[1,0] op_sel_hi:[1,1]
v_pk_mul_f32 v[190:191], v[44:45], v[190:191] op_sel:[1,0] op_sel_hi:[1,1]
v_cvt_pk_bf16_f32 v188, v188, v189
v_cvt_pk_bf16_f32 v189, v190, v191
ds_write_b64 v14, v[188:189] offset:38528
v_pk_fma_f32 v[224:225], v[44:45], v[60:61], v[224:225] op_sel_hi:[0,1,1] neg_lo:[1,0,0] neg_hi:[1,0,0]
v_pk_fma_f32 v[226:227], v[44:45], v[62:63], v[226:227] op_sel_hi:[0,1,1] neg_lo:[1,0,0] neg_hi:[1,0,0]
v_pk_mul_f32 v[224:225], v[44:45], v[224:225] op_sel:[1,0] op_sel_hi:[1,1]
v_pk_mul_f32 v[226:227], v[44:45], v[226:227] op_sel:[1,0] op_sel_hi:[1,1]
v_cvt_pk_bf16_f32 v224, v224, v225
v_cvt_pk_bf16_f32 v225, v226, v227
ds_write_b64 v14, v[224:225] offset:38656
v_pk_fma_f32 v[156:157], v[46:47], v[52:53], v[156:157] op_sel_hi:[0,1,1] neg_lo:[1,0,0] neg_hi:[1,0,0]
v_pk_fma_f32 v[158:159], v[46:47], v[54:55], v[158:159] op_sel_hi:[0,1,1] neg_lo:[1,0,0] neg_hi:[1,0,0]
v_pk_mul_f32 v[156:157], v[46:47], v[156:157] op_sel:[1,0] op_sel_hi:[1,1]
v_pk_mul_f32 v[158:159], v[46:47], v[158:159] op_sel:[1,0] op_sel_hi:[1,1]
v_cvt_pk_bf16_f32 v156, v156, v157
v_cvt_pk_bf16_f32 v157, v158, v159
ds_write_b64 v14, v[156:157] offset:44800
v_pk_fma_f32 v[192:193], v[46:47], v[56:57], v[192:193] op_sel_hi:[0,1,1] neg_lo:[1,0,0] neg_hi:[1,0,0]
v_pk_fma_f32 v[194:195], v[46:47], v[58:59], v[194:195] op_sel_hi:[0,1,1] neg_lo:[1,0,0] neg_hi:[1,0,0]
v_pk_mul_f32 v[192:193], v[46:47], v[192:193] op_sel:[1,0] op_sel_hi:[1,1]
v_pk_mul_f32 v[194:195], v[46:47], v[194:195] op_sel:[1,0] op_sel_hi:[1,1]
v_cvt_pk_bf16_f32 v192, v192, v193
v_cvt_pk_bf16_f32 v193, v194, v195
ds_write_b64 v14, v[192:193] offset:44928
v_pk_fma_f32 v[228:229], v[46:47], v[60:61], v[228:229] op_sel_hi:[0,1,1] neg_lo:[1,0,0] neg_hi:[1,0,0]
v_pk_fma_f32 v[230:231], v[46:47], v[62:63], v[230:231] op_sel_hi:[0,1,1] neg_lo:[1,0,0] neg_hi:[1,0,0]
v_pk_mul_f32 v[228:229], v[46:47], v[228:229] op_sel:[1,0] op_sel_hi:[1,1]
v_pk_mul_f32 v[230:231], v[46:47], v[230:231] op_sel:[1,0] op_sel_hi:[1,1]
v_cvt_pk_bf16_f32 v228, v228, v229
v_cvt_pk_bf16_f32 v229, v230, v231
ds_write_b64 v14, v[228:229] offset:45056
v_pk_fma_f32 v[160:161], v[48:49], v[52:53], v[160:161] op_sel_hi:[0,1,1] neg_lo:[1,0,0] neg_hi:[1,0,0]
v_pk_fma_f32 v[162:163], v[48:49], v[54:55], v[162:163] op_sel_hi:[0,1,1] neg_lo:[1,0,0] neg_hi:[1,0,0]
v_pk_mul_f32 v[160:161], v[48:49], v[160:161] op_sel:[1,0] op_sel_hi:[1,1]
v_pk_mul_f32 v[162:163], v[48:49], v[162:163] op_sel:[1,0] op_sel_hi:[1,1]
v_cvt_pk_bf16_f32 v160, v160, v161
v_cvt_pk_bf16_f32 v161, v162, v163
ds_write_b64 v14, v[160:161] offset:51200
v_pk_fma_f32 v[196:197], v[48:49], v[56:57], v[196:197] op_sel_hi:[0,1,1] neg_lo:[1,0,0] neg_hi:[1,0,0]
v_pk_fma_f32 v[198:199], v[48:49], v[58:59], v[198:199] op_sel_hi:[0,1,1] neg_lo:[1,0,0] neg_hi:[1,0,0]
v_pk_mul_f32 v[196:197], v[48:49], v[196:197] op_sel:[1,0] op_sel_hi:[1,1]
v_pk_mul_f32 v[198:199], v[48:49], v[198:199] op_sel:[1,0] op_sel_hi:[1,1]
v_cvt_pk_bf16_f32 v196, v196, v197
v_cvt_pk_bf16_f32 v197, v198, v199
ds_write_b64 v14, v[196:197] offset:51328
v_pk_fma_f32 v[232:233], v[48:49], v[60:61], v[232:233] op_sel_hi:[0,1,1] neg_lo:[1,0,0] neg_hi:[1,0,0]
v_pk_fma_f32 v[234:235], v[48:49], v[62:63], v[234:235] op_sel_hi:[0,1,1] neg_lo:[1,0,0] neg_hi:[1,0,0]
v_pk_mul_f32 v[232:233], v[48:49], v[232:233] op_sel:[1,0] op_sel_hi:[1,1]
v_pk_mul_f32 v[234:235], v[48:49], v[234:235] op_sel:[1,0] op_sel_hi:[1,1]
v_cvt_pk_bf16_f32 v232, v232, v233
v_cvt_pk_bf16_f32 v233, v234, v235
ds_write_b64 v14, v[232:233] offset:51456
s_waitcnt lgkmcnt(0)
s_branch Latt_4
Lprod_2:
s_sub_u32 s47, s36, 4
s_lshl_b32 s43, s34, 7
s_lshl_b32 s44, s35, 3
s_add_u32 s43, s43, s44
s_mov_b32 s63, s43
s_lshl_b32 s44, s47, 1
s_add_u32 s51, s43, s44
v_lshlrev_b32 v10, 4, v1
s_add_u32 s20, s32, 26214400
s_addc_u32 s21, s33, 0
s_mov_b32 s22, 16384
s_mov_b32 s23, 0x20000
s_cmp_eq_u32 s47, 3
s_cbranch_scc1 Lpf_3
v_lshrrev_b32 v14, 3, v1
v_and_b32 v15, 7, v1
v_and_b32 v16, 2, v14
v_xor_b32 v16, v15, v16
v_lshlrev_b32 v16, 4, v16
v_mul_u32_u24 v17, 6144, v14
s_lshl_b32 s43, s47, 11
v_add3_u32 v2, v17, v16, s43
v_xor_b32 v3, 64, v2
v_lshrrev_b32 v16, 1, v14
v_xor_b32 v16, v15, v16
v_lshlrev_b32 v16, 4, v16
s_lshl_b32 s43, s47, 3
s_add_u32 s43, s43, s50
v_add_u32 v17, s43, v14
s_and_b32 s44, s47, 1
s_lshl_b32 s44, s44, 6
v_add_u32 v18, 0, v17
v_max_i32 v18, 0, v18
v_lshl_add_u32 v18, v18, 11, v16
v_xor_b32 v18, s44, v18
v_mov_b32 v4, v18
v_add_u32 v18, 24, v17
v_max_i32 v18, 0, v18
v_lshl_add_u32 v18, v18, 11, v16
v_xor_b32 v18, s44, v18
v_xor_b32 v5, 64, v18
v_add_u32 v18, 48, v17
v_max_i32 v18, 0, v18
v_lshl_add_u32 v18, v18, 11, v16
v_xor_b32 v18, s44, v18
v_mov_b32 v6, v18
v_add_u32 v18, 72, v17
v_max_i32 v18, 0, v18
v_lshl_add_u32 v18, v18, 11, v16
v_xor_b32 v18, s44, v18
v_xor_b32 v7, 64, v18
v_add_u32 v18, 96, v17
v_max_i32 v18, 0, v18
v_lshl_add_u32 v18, v18, 11, v16
v_xor_b32 v18, s44, v18
v_mov_b32 v8, v18
v_add_u32 v18, 120, v17
v_max_i32 v18, 0, v18
v_lshl_add_u32 v18, v18, 11, v16
v_xor_b32 v18, s44, v18
v_xor_b32 v9, 64, v18
s_lshl_b32 s39, s47, 10
s_lshl_b32 s40, s47, 13
s_add_u32 s40, s40, 18432
s_mov_b32 s37, 0
s_mov_b32 s38, 0
s_bfm_b64 s[60:61], 56, 8
s_cmp_eq_u32 s47, 0
s_cselect_b64 s[60:61], s[60:61], -1
s_add_u32 m0, s39, 0
s_mov_b64 exec, s[60:61]
buffer_load_dwordx4 v4, s[8:11], s37 offen lds
s_mov_b64 exec, -1
s_add_u32 m0, s39, 3072
s_nop 0
buffer_load_dwordx4 v5, s[8:11], s37 offen lds
s_add_u32 m0, s39, 6144
s_nop 0
buffer_load_dwordx4 v6, s[8:11], s37 offen lds
s_add_u32 m0, s39, 9216
s_nop 0
buffer_load_dwordx4 v7, s[8:11], s37 offen lds
s_add_u32 m0, s39, 12288
s_nop 0
buffer_load_dwordx4 v8, s[8:11], s37 offen lds
s_add_u32 m0, s39, 15360
s_nop 0
buffer_load_dwordx4 v9, s[8:11], s37 offen lds
s_add_u32 m0, s40, 0
s_add_u32 s43, s38, 0
buffer_load_dwordx4 v2, s[12:15], s43 offen lds
s_add_u32 m0, s40, 1024
s_add_u32 s43, s38, 49152
buffer_load_dwordx4 v3, s[12:15], s43 offen lds
s_add_u32 m0, s40, 2048
s_add_u32 s43, s38, 98304
buffer_load_dwordx4 v2, s[12:15], s43 offen lds
s_add_u32 m0, s40, 3072
s_add_u32 s43, s38, 147456
buffer_load_dwordx4 v3, s[12:15], s43 offen lds
s_add_u32 m0, s40, 4096
s_add_u32 s43, s38, 196608
buffer_load_dwordx4 v2, s[12:15], s43 offen lds
s_add_u32 m0, s40, 5120
s_add_u32 s43, s38, 245760
buffer_load_dwordx4 v3, s[12:15], s43 offen lds
s_add_u32 m0, s40, 6144
s_add_u32 s43, s38, 294912
buffer_load_dwordx4 v2, s[12:15], s43 offen lds
s_add_u32 m0, s40, 7168
s_add_u32 s43, s38, 344064
buffer_load_dwordx4 v3, s[12:15], s43 offen lds
s_add_u32 s37, s37, 128
s_add_u32 s38, s38, 393216
s_add_u32 m0, s39, 43008
s_mov_b64 exec, s[60:61]
buffer_load_dwordx4 v4, s[8:11], s37 offen lds
s_mov_b64 exec, -1
s_add_u32 m0, s39, 46080
s_nop 0
buffer_load_dwordx4 v5, s[8:11], s37 offen lds
s_add_u32 m0, s39, 49152
s_nop 0
buffer_load_dwordx4 v6, s[8:11], s37 offen lds
s_add_u32 m0, s39, 52224
s_nop 0
buffer_load_dwordx4 v7, s[8:11], s37 offen lds
s_add_u32 m0, s39, 55296
s_nop 0
buffer_load_dwordx4 v8, s[8:11], s37 offen lds
s_add_u32 m0, s39, 58368
s_nop 0
buffer_load_dwordx4 v9, s[8:11], s37 offen lds
s_add_u32 m0, s40, 43008
s_add_u32 s43, s38, 0
buffer_load_dwordx4 v2, s[12:15], s43 offen lds
s_add_u32 m0, s40, 44032
s_add_u32 s43, s38, 49152
buffer_load_dwordx4 v3, s[12:15], s43 offen lds
s_add_u32 m0, s40, 45056
s_add_u32 s43, s38, 98304
buffer_load_dwordx4 v2, s[12:15], s43 offen lds
s_add_u32 m0, s40, 46080
s_add_u32 s43, s38, 147456
buffer_load_dwordx4 v3, s[12:15], s43 offen lds
s_add_u32 m0, s40, 47104
s_add_u32 s43, s38, 196608
buffer_load_dwordx4 v2, s[12:15], s43 offen lds
s_add_u32 m0, s40, 48128
s_add_u32 s43, s38, 245760
buffer_load_dwordx4 v3, s[12:15], s43 offen lds
s_add_u32 m0, s40, 49152
s_add_u32 s43, s38, 294912
buffer_load_dwordx4 v2, s[12:15], s43 offen lds
s_add_u32 m0, s40, 50176
s_add_u32 s43, s38, 344064
buffer_load_dwordx4 v3, s[12:15], s43 offen lds
s_add_u32 s37, s37, 128
s_add_u32 s38, s38, 393216
s_add_u32 m0, s39, 86016
s_mov_b64 exec, s[60:61]
buffer_load_dwordx4 v4, s[8:11], s37 offen lds
s_mov_b64 exec, -1
s_add_u32 m0, s39, 89088
s_nop 0
buffer_load_dwordx4 v5, s[8:11], s37 offen lds
s_add_u32 m0, s39, 92160
s_nop 0
buffer_load_dwordx4 v6, s[8:11], s37 offen lds
s_add_u32 m0, s39, 95232
s_nop 0
buffer_load_dwordx4 v7, s[8:11], s37 offen lds
s_add_u32 m0, s39, 98304
s_nop 0
buffer_load_dwordx4 v8, s[8:11], s37 offen lds
s_add_u32 m0, s39, 101376
s_nop 0
buffer_load_dwordx4 v9, s[8:11], s37 offen lds
s_add_u32 m0, s40, 86016
s_add_u32 s43, s38, 0
buffer_load_dwordx4 v2, s[12:15], s43 offen lds
s_add_u32 m0, s40, 87040
s_add_u32 s43, s38, 49152
buffer_load_dwordx4 v3, s[12:15], s43 offen lds
s_add_u32 m0, s40, 88064
s_add_u32 s43, s38, 98304
buffer_load_dwordx4 v2, s[12:15], s43 offen lds
s_add_u32 m0, s40, 89088
s_add_u32 s43, s38, 147456
buffer_load_dwordx4 v3, s[12:15], s43 offen lds
s_add_u32 m0, s40, 90112
s_add_u32 s43, s38, 196608
buffer_load_dwordx4 v2, s[12:15], s43 offen lds
s_add_u32 m0, s40, 91136
s_add_u32 s43, s38, 245760
buffer_load_dwordx4 v3, s[12:15], s43 offen lds
s_add_u32 m0, s40, 92160
s_add_u32 s43, s38, 294912
buffer_load_dwordx4 v2, s[12:15], s43 offen lds
s_add_u32 m0, s40, 93184
s_add_u32 s43, s38, 344064
buffer_load_dwordx4 v3, s[12:15], s43 offen lds
s_add_u32 s37, s37, 128
s_add_u32 s38, s38, 393216
s_lshl_b32 s43, s51, 11
buffer_load_dwordx4 v[96:99], v10, s[8:11], s43 offen offset:0
buffer_load_dwordx4 v[100:103], v10, s[8:11], s43 offen offset:1024
buffer_load_dwordx4 v[104:107], v10, s[8:11], s43 offen offset:2048
buffer_load_dwordx4 v[108:111], v10, s[8:11], s43 offen offset:3072
s_waitcnt vmcnt(32)
s_barrier
s_lshr_b32 s43, s2, 5
s_cmp_eq_u32 s43, 3
s_cbranch_scc1 Lsj_7
s_cmp_gt_u32 s43, 3
s_cselect_b32 s43, 32, 0
s_sub_u32 s43, s2, s43
s_lshr_b32 s43, s43, 1
s_and_b32 s44, s2, 1
s_lshl_b32 s44, s44, 3
s_add_u32 s44, s44, 32
s_load_dwordx2 s[80:81], s[0:1], s44
s_mul_i32 s45, s43, 2341
s_lshr_b32 s45, s45, 16
s_mul_i32 s46, s45, 28
s_sub_u32 s46, s43, s46
s_lshl_b32 s45, s45, 8
s_mul_i32 s44, s47, 18
s_add_u32 s45, s45, s44
s_add_u32 s45, s45, 184
s_mul_i32 s45, s45, 7168
s_lshl_b32 s46, s46, 8
s_add_u32 s45, s45, s46
s_waitcnt lgkmcnt(0)
s_add_u32 s80, s80, s45
s_addc_u32 s81, s81, 0
Lsj_7:
s_waitcnt vmcnt(18)
s_barrier
s_add_u32 m0, s39, 0
s_mov_b64 exec, s[60:61]
buffer_load_dwordx4 v4, s[8:11], s37 offen lds
s_mov_b64 exec, -1
s_add_u32 m0, s39, 3072
s_nop 0
buffer_load_dwordx4 v5, s[8:11], s37 offen lds
s_add_u32 m0, s39, 6144
s_nop 0
buffer_load_dwordx4 v6, s[8:11], s37 offen lds
s_add_u32 m0, s39, 9216
s_nop 0
buffer_load_dwordx4 v7, s[8:11], s37 offen lds
s_add_u32 m0, s39, 12288
s_nop 0
buffer_load_dwordx4 v8, s[8:11], s37 offen lds
s_add_u32 m0, s39, 15360
s_nop 0
buffer_load_dwordx4 v9, s[8:11], s37 offen lds
s_add_u32 m0, s40, 0
s_add_u32 s43, s38, 0
buffer_load_dwordx4 v2, s[12:15], s43 offen lds
s_add_u32 m0, s40, 1024
s_add_u32 s43, s38, 49152
buffer_load_dwordx4 v3, s[12:15], s43 offen lds
s_add_u32 m0, s40, 2048
s_add_u32 s43, s38, 98304
buffer_load_dwordx4 v2, s[12:15], s43 offen lds
s_add_u32 m0, s40, 3072
s_add_u32 s43, s38, 147456
buffer_load_dwordx4 v3, s[12:15], s43 offen lds
s_add_u32 m0, s40, 4096
s_add_u32 s43, s38, 196608
buffer_load_dwordx4 v2, s[12:15], s43 offen lds
s_add_u32 m0, s40, 5120
s_add_u32 s43, s38, 245760
buffer_load_dwordx4 v3, s[12:15], s43 offen lds
s_add_u32 m0, s40, 6144
s_add_u32 s43, s38, 294912
buffer_load_dwordx4 v2, s[12:15], s43 offen lds
s_add_u32 m0, s40, 7168
s_add_u32 s43, s38, 344064
buffer_load_dwordx4 v3, s[12:15], s43 offen lds
s_add_u32 s37, s37, 128
s_add_u32 s38, s38, 393216
s_waitcnt vmcnt(14)
s_barrier
s_add_u32 m0, s39, 43008
s_mov_b64 exec, s[60:61]
buffer_load_dwordx4 v4, s[8:11], s37 offen lds
s_mov_b64 exec, -1
s_add_u32 m0, s39, 46080
s_nop 0
buffer_load_dwordx4 v5, s[8:11], s37 offen lds
s_add_u32 m0, s39, 49152
s_nop 0
buffer_load_dwordx4 v6, s[8:11], s37 offen lds
s_add_u32 m0, s39, 52224
s_nop 0
buffer_load_dwordx4 v7, s[8:11], s37 offen lds
s_add_u32 m0, s39, 55296
s_nop 0
buffer_load_dwordx4 v8, s[8:11], s37 offen lds
s_add_u32 m0, s39, 58368
s_nop 0
buffer_load_dwordx4 v9, s[8:11], s37 offen lds
s_add_u32 m0, s40, 43008
s_add_u32 s43, s38, 0
buffer_load_dwordx4 v2, s[12:15], s43 offen lds
s_add_u32 m0, s40, 44032
s_add_u32 s43, s38, 49152
buffer_load_dwordx4 v3, s[12:15], s43 offen lds
s_add_u32 m0, s40, 45056
s_add_u32 s43, s38, 98304
buffer_load_dwordx4 v2, s[12:15], s43 offen lds
s_add_u32 m0, s40, 46080
s_add_u32 s43, s38, 147456
buffer_load_dwordx4 v3, s[12:15], s43 offen lds
s_add_u32 m0, s40, 47104
s_add_u32 s43, s38, 196608
buffer_load_dwordx4 v2, s[12:15], s43 offen lds
s_add_u32 m0, s40, 48128
s_add_u32 s43, s38, 245760
buffer_load_dwordx4 v3, s[12:15], s43 offen lds
s_add_u32 m0, s40, 49152
s_add_u32 s43, s38, 294912
buffer_load_dwordx4 v2, s[12:15], s43 offen lds
s_add_u32 m0, s40, 50176
s_add_u32 s43, s38, 344064
buffer_load_dwordx4 v3, s[12:15], s43 offen lds
s_add_u32 s37, s37, 128
s_add_u32 s38, s38, 393216
v_lshlrev_b32 v124, 16, v96
v_and_b32 v125, 0xffff0000, v96
v_mov_b32 v116, v124
v_mov_b32 v117, v125
v_mul_f32 v118, v124, v124
v_mul_f32 v119, v125, v125
v_lshlrev_b32 v126, 16, v97
v_and_b32 v127, 0xffff0000, v97
v_add_f32 v116, v116, v126
v_add_f32 v117, v117, v127
v_fmac_f32 v118, v126, v126
v_fmac_f32 v119, v127, v127
v_lshlrev_b32 v124, 16, v98
v_and_b32 v125, 0xffff0000, v98
v_add_f32 v116, v116, v124
v_add_f32 v117, v117, v125
v_fmac_f32 v118, v124, v124
v_fmac_f32 v119, v125, v125
v_lshlrev_b32 v126, 16, v99
v_and_b32 v127, 0xffff0000, v99
v_add_f32 v116, v116, v126
v_add_f32 v117, v117, v127
v_fmac_f32 v118, v126, v126
v_fmac_f32 v119, v127, v127
v_lshlrev_b32 v124, 16, v100
v_and_b32 v125, 0xffff0000, v100
v_add_f32 v116, v116, v124
v_add_f32 v117, v117, v125
v_fmac_f32 v118, v124, v124
v_fmac_f32 v119, v125, v125
v_lshlrev_b32 v126, 16, v101
v_and_b32 v127, 0xffff0000, v101
v_add_f32 v116, v116, v126
v_add_f32 v117, v117, v127
v_fmac_f32 v118, v126, v126
v_fmac_f32 v119, v127, v127
v_lshlrev_b32 v124, 16, v102
v_and_b32 v125, 0xffff0000, v102
v_add_f32 v116, v116, v124
v_add_f32 v117, v117, v125
v_fmac_f32 v118, v124, v124
v_fmac_f32 v119, v125, v125
v_lshlrev_b32 v126, 16, v103
v_and_b32 v127, 0xffff0000, v103
v_add_f32 v116, v116, v126
v_add_f32 v117, v117, v127
v_fmac_f32 v118, v126, v126
v_fmac_f32 v119, v127, v127
v_lshlrev_b32 v124, 16, v104
v_and_b32 v125, 0xffff0000, v104
v_mov_b32 v120, v124
v_mov_b32 v121, v125
v_mul_f32 v122, v124, v124
v_mul_f32 v123, v125, v125
v_lshlrev_b32 v126, 16, v105
v_and_b32 v127, 0xffff0000, v105
v_add_f32 v120, v120, v126
v_add_f32 v121, v121, v127
v_fmac_f32 v122, v126, v126
v_fmac_f32 v123, v127, v127
v_lshlrev_b32 v124, 16, v106
v_and_b32 v125, 0xffff0000, v106
v_add_f32 v120, v120, v124
v_add_f32 v121, v121, v125
v_fmac_f32 v122, v124, v124
v_fmac_f32 v123, v125, v125
v_lshlrev_b32 v126, 16, v107
v_and_b32 v127, 0xffff0000, v107
v_add_f32 v120, v120, v126
v_add_f32 v121, v121, v127
v_fmac_f32 v122, v126, v126
v_fmac_f32 v123, v127, v127
v_lshlrev_b32 v124, 16, v108
v_and_b32 v125, 0xffff0000, v108
v_add_f32 v120, v120, v124
v_add_f32 v121, v121, v125
v_fmac_f32 v122, v124, v124
v_fmac_f32 v123, v125, v125
v_lshlrev_b32 v126, 16, v109
v_and_b32 v127, 0xffff0000, v109
v_add_f32 v120, v120, v126
v_add_f32 v121, v121, v127
v_fmac_f32 v122, v126, v126
v_fmac_f32 v123, v127, v127
v_lshlrev_b32 v124, 16, v110
v_and_b32 v125, 0xffff0000, v110
v_add_f32 v120, v120, v124
v_add_f32 v121, v121, v125
v_fmac_f32 v122, v124, v124
v_fmac_f32 v123, v125, v125
v_lshlrev_b32 v126, 16, v111
v_and_b32 v127, 0xffff0000, v111
v_add_f32 v120, v120, v126
v_add_f32 v121, v121, v127
v_fmac_f32 v122, v126, v126
v_fmac_f32 v123, v127, v127
v_add_f32 v116, v116, v117
v_add_f32 v118, v118, v119
v_add_f32 v120, v120, v121
v_add_f32 v122, v122, v123
s_nop 0
v_add_f32_dpp v116, v116, v116 row_ror:8 row_mask:0xf bank_mask:0xf
v_add_f32_dpp v118, v118, v118 row_ror:8 row_mask:0xf bank_mask:0xf
v_add_f32_dpp v120, v120, v120 row_ror:8 row_mask:0xf bank_mask:0xf
v_add_f32_dpp v122, v122, v122 row_ror:8 row_mask:0xf bank_mask:0xf
v_add_f32_dpp v116, v116, v116 row_ror:4 row_mask:0xf bank_mask:0xf
v_add_f32_dpp v118, v118, v118 row_ror:4 row_mask:0xf bank_mask:0xf
v_add_f32_dpp v120, v120, v120 row_ror:4 row_mask:0xf bank_mask:0xf
v_add_f32_dpp v122, v122, v122 row_ror:4 row_mask:0xf bank_mask:0xf
v_add_f32_dpp v116, v116, v116 row_ror:2 row_mask:0xf bank_mask:0xf
v_add_f32_dpp v118, v118, v118 row_ror:2 row_mask:0xf bank_mask:0xf
v_add_f32_dpp v120, v120, v120 row_ror:2 row_mask:0xf bank_mask:0xf
v_add_f32_dpp v122, v122, v122 row_ror:2 row_mask:0xf bank_mask:0xf
v_add_f32_dpp v116, v116, v116 row_ror:1 row_mask:0xf bank_mask:0xf
v_add_f32_dpp v118, v118, v118 row_ror:1 row_mask:0xf bank_mask:0xf
v_add_f32_dpp v120, v120, v120 row_ror:1 row_mask:0xf bank_mask:0xf
v_add_f32_dpp v122, v122, v122 row_ror:1 row_mask:0xf bank_mask:0xf
v_mov_b32 v117, v116
v_mov_b32 v119, v118
v_mov_b32 v121, v120
v_mov_b32 v123, v122
s_nop 0
v_permlane16_swap_b32 v116, v117
v_permlane16_swap_b32 v118, v119
v_permlane16_swap_b32 v120, v121
v_permlane16_swap_b32 v122, v123
v_add_f32 v116, v116, v117
v_add_f32 v118, v118, v119
v_add_f32 v120, v120, v121
v_add_f32 v122, v122, v123
v_mov_b32 v117, v116
v_mov_b32 v119, v118
v_mov_b32 v121, v120
v_mov_b32 v123, v122
s_nop 0
v_permlane32_swap_b32 v116, v117
v_permlane32_swap_b32 v118, v119
v_permlane32_swap_b32 v120, v121
v_permlane32_swap_b32 v122, v123
v_add_f32 v116, v116, v117
v_add_f32 v118, v118, v119
v_add_f32 v120, v120, v121
v_add_f32 v122, v122, v123
v_mul_f32 v112, 0x3a800000, v116
v_mul_f32 v113, 0x3a800000, v118
v_fma_f32 v113, -v112, v112, v113
v_max_f32 v113, 0, v113
v_add_f32 v113, 0x3727c5ac, v113
v_rsq_f32 v113, v113
v_mul_f32 v114, 0x3a800000, v120
v_mul_f32 v115, 0x3a800000, v122
v_fma_f32 v115, -v114, v114, v115
v_max_f32 v115, 0, v115
v_add_f32 v115, 0x3727c5ac, v115
v_rsq_f32 v115, v115
s_nop 0
s_lshl_b32 s43, s47, 4
s_add_u32 s43, s43, 130176
v_mov_b32 v11, s43
ds_write_b128 v11, v[112:115]
s_waitcnt lgkmcnt(0)
s_waitcnt vmcnt(14)
s_barrier
s_add_u32 m0, s39, 86016
s_mov_b64 exec, s[60:61]
buffer_load_dwordx4 v4, s[8:11], s37 offen lds
s_mov_b64 exec, -1
s_add_u32 m0, s39, 89088
s_nop 0
buffer_load_dwordx4 v5, s[8:11], s37 offen lds
s_add_u32 m0, s39, 92160
s_nop 0
buffer_load_dwordx4 v6, s[8:11], s37 offen lds
s_add_u32 m0, s39, 95232
s_nop 0
buffer_load_dwordx4 v7, s[8:11], s37 offen lds
s_add_u32 m0, s39, 98304
s_nop 0
buffer_load_dwordx4 v8, s[8:11], s37 offen lds
s_add_u32 m0, s39, 101376
s_nop 0
buffer_load_dwordx4 v9, s[8:11], s37 offen lds
s_add_u32 m0, s40, 86016
s_add_u32 s43, s38, 0
buffer_load_dwordx4 v2, s[12:15], s43 offen lds
s_add_u32 m0, s40, 87040
s_add_u32 s43, s38, 49152
buffer_load_dwordx4 v3, s[12:15], s43 offen lds
s_add_u32 m0, s40, 88064
s_add_u32 s43, s38, 98304
buffer_load_dwordx4 v2, s[12:15], s43 offen lds
s_add_u32 m0, s40, 89088
s_add_u32 s43, s38, 147456
buffer_load_dwordx4 v3, s[12:15], s43 offen lds
s_add_u32 m0, s40, 90112
s_add_u32 s43, s38, 196608
buffer_load_dwordx4 v2, s[12:15], s43 offen lds
s_add_u32 m0, s40, 91136
s_add_u32 s43, s38, 245760
buffer_load_dwordx4 v3, s[12:15], s43 offen lds
s_add_u32 m0, s40, 92160
s_add_u32 s43, s38, 294912
buffer_load_dwordx4 v2, s[12:15], s43 offen lds
s_add_u32 m0, s40, 93184
s_add_u32 s43, s38, 344064
buffer_load_dwordx4 v3, s[12:15], s43 offen lds
s_add_u32 s37, s37, 128
s_add_u32 s38, s38, 393216
s_load_dword s64, s[80:81], 0
s_load_dword s65, s[80:81], 64
s_load_dword s66, s[80:81], 128
s_load_dword s67, s[80:81], 192
s_load_dword s68, s[80:81], 7168
s_load_dword s69, s[80:81], 7232
s_load_dword s70, s[80:81], 7296
s_load_dword s71, s[80:81], 7360
s_add_u32 s80, s80, 14336
s_addc_u32 s81, s81, 0
s_waitcnt vmcnt(14)
s_barrier
s_mov_b32 s41, 2
Lpl_8:
s_add_u32 m0, s39, 0
s_mov_b64 exec, s[60:61]
buffer_load_dwordx4 v4, s[8:11], s37 offen lds
s_mov_b64 exec, -1
s_add_u32 m0, s39, 3072
s_nop 0
buffer_load_dwordx4 v5, s[8:11], s37 offen lds
s_add_u32 m0, s39, 6144
s_nop 0
buffer_load_dwordx4 v6, s[8:11], s37 offen lds
s_add_u32 m0, s39, 9216
s_nop 0
buffer_load_dwordx4 v7, s[8:11], s37 offen lds
s_add_u32 m0, s39, 12288
s_nop 0
buffer_load_dwordx4 v8, s[8:11], s37 offen lds
s_add_u32 m0, s39, 15360
s_nop 0
buffer_load_dwordx4 v9, s[8:11], s37 offen lds
s_add_u32 m0, s40, 0
s_add_u32 s43, s38, 0
buffer_load_dwordx4 v2, s[12:15], s43 offen lds
s_add_u32 m0, s40, 1024
s_add_u32 s43, s38, 49152
buffer_load_dwordx4 v3, s[12:15], s43 offen lds
s_add_u32 m0, s40, 2048
s_add_u32 s43, s38, 98304
buffer_load_dwordx4 v2, s[12:15], s43 offen lds
s_add_u32 m0, s40, 3072
s_add_u32 s43, s38, 147456
buffer_load_dwordx4 v3, s[12:15], s43 offen lds
s_add_u32 m0, s40, 4096
s_add_u32 s43, s38, 196608
buffer_load_dwordx4 v2, s[12:15], s43 offen lds
s_add_u32 m0, s40, 5120
s_add_u32 s43, s38, 245760
buffer_load_dwordx4 v3, s[12:15], s43 offen lds
s_add_u32 m0, s40, 6144
s_add_u32 s43, s38, 294912
buffer_load_dwordx4 v2, s[12:15], s43 offen lds
s_add_u32 m0, s40, 7168
s_add_u32 s43, s38, 344064
buffer_load_dwordx4 v3, s[12:15], s43 offen lds
s_add_u32 s37, s37, 128
s_add_u32 s38, s38, 393216
s_load_dword s64, s[80:81], 0
s_load_dword s65, s[80:81], 64
s_load_dword s66, s[80:81], 128
s_load_dword s67, s[80:81], 192
s_load_dword s68, s[80:81], 7168
s_load_dword s69, s[80:81], 7232
s_load_dword s70, s[80:81], 7296
s_load_dword s71, s[80:81], 7360
s_add_u32 s80, s80, 14336
s_addc_u32 s81, s81, 0
s_waitcnt vmcnt(14)
s_barrier
s_add_u32 m0, s39, 43008
s_mov_b64 exec, s[60:61]
buffer_load_dwordx4 v4, s[8:11], s37 offen lds
s_mov_b64 exec, -1
s_add_u32 m0, s39, 46080
s_nop 0
buffer_load_dwordx4 v5, s[8:11], s37 offen lds
s_add_u32 m0, s39, 49152
s_nop 0
buffer_load_dwordx4 v6, s[8:11], s37 offen lds
s_add_u32 m0, s39, 52224
s_nop 0
buffer_load_dwordx4 v7, s[8:11], s37 offen lds
s_add_u32 m0, s39, 55296
s_nop 0
buffer_load_dwordx4 v8, s[8:11], s37 offen lds
s_add_u32 m0, s39, 58368
s_nop 0
buffer_load_dwordx4 v9, s[8:11], s37 offen lds
s_add_u32 m0, s40, 43008
s_add_u32 s43, s38, 0
buffer_load_dwordx4 v2, s[12:15], s43 offen lds
s_add_u32 m0, s40, 44032
s_add_u32 s43, s38, 49152
buffer_load_dwordx4 v3, s[12:15], s43 offen lds
s_add_u32 m0, s40, 45056
s_add_u32 s43, s38, 98304
buffer_load_dwordx4 v2, s[12:15], s43 offen lds
s_add_u32 m0, s40, 46080
s_add_u32 s43, s38, 147456
buffer_load_dwordx4 v3, s[12:15], s43 offen lds
s_add_u32 m0, s40, 47104
s_add_u32 s43, s38, 196608
buffer_load_dwordx4 v2, s[12:15], s43 offen lds
s_add_u32 m0, s40, 48128
s_add_u32 s43, s38, 245760
buffer_load_dwordx4 v3, s[12:15], s43 offen lds
s_add_u32 m0, s40, 49152
s_add_u32 s43, s38, 294912
buffer_load_dwordx4 v2, s[12:15], s43 offen lds
s_add_u32 m0, s40, 50176
s_add_u32 s43, s38, 344064
buffer_load_dwordx4 v3, s[12:15], s43 offen lds
s_add_u32 s37, s37, 128
s_add_u32 s38, s38, 393216
s_load_dword s64, s[80:81], 0
s_load_dword s65, s[80:81], 64
s_load_dword s66, s[80:81], 128
s_load_dword s67, s[80:81], 192
s_load_dword s68, s[80:81], 7168
s_load_dword s69, s[80:81], 7232
s_load_dword s70, s[80:81], 7296
s_load_dword s71, s[80:81], 7360
s_add_u32 s80, s80, 14336
s_addc_u32 s81, s81, 0
s_waitcnt vmcnt(14)
s_barrier
s_add_u32 m0, s39, 86016
s_mov_b64 exec, s[60:61]
buffer_load_dwordx4 v4, s[8:11], s37 offen lds
s_mov_b64 exec, -1
s_add_u32 m0, s39, 89088
s_nop 0
buffer_load_dwordx4 v5, s[8:11], s37 offen lds
s_add_u32 m0, s39, 92160
s_nop 0
buffer_load_dwordx4 v6, s[8:11], s37 offen lds
s_add_u32 m0, s39, 95232
s_nop 0
buffer_load_dwordx4 v7, s[8:11], s37 offen lds
s_add_u32 m0, s39, 98304
s_nop 0
buffer_load_dwordx4 v8, s[8:11], s37 offen lds
s_add_u32 m0, s39, 101376
s_nop 0
buffer_load_dwordx4 v9, s[8:11], s37 offen lds
s_add_u32 m0, s40, 86016
s_add_u32 s43, s38, 0
buffer_load_dwordx4 v2, s[12:15], s43 offen lds
s_add_u32 m0, s40, 87040
s_add_u32 s43, s38, 49152
buffer_load_dwordx4 v3, s[12:15], s43 offen lds
s_add_u32 m0, s40, 88064
s_add_u32 s43, s38, 98304
buffer_load_dwordx4 v2, s[12:15], s43 offen lds
s_add_u32 m0, s40, 89088
s_add_u32 s43, s38, 147456
buffer_load_dwordx4 v3, s[12:15], s43 offen lds
s_add_u32 m0, s40, 90112
s_add_u32 s43, s38, 196608
buffer_load_dwordx4 v2, s[12:15], s43 offen lds
s_add_u32 m0, s40, 91136
s_add_u32 s43, s38, 245760
buffer_load_dwordx4 v3, s[12:15], s43 offen lds
s_add_u32 m0, s40, 92160
s_add_u32 s43, s38, 294912
buffer_load_dwordx4 v2, s[12:15], s43 offen lds
s_add_u32 m0, s40, 93184
s_add_u32 s43, s38, 344064
buffer_load_dwordx4 v3, s[12:15], s43 offen lds
s_add_u32 s37, s37, 128
s_add_u32 s38, s38, 393216
s_load_dword s64, s[80:81], 0
s_load_dword s65, s[80:81], 64
s_load_dword s66, s[80:81], 128
s_load_dword s67, s[80:81], 192
s_load_dword s68, s[80:81], 7168
s_load_dword s69, s[80:81], 7232
s_load_dword s70, s[80:81], 7296
s_load_dword s71, s[80:81], 7360
s_add_u32 s80, s80, 14336
s_addc_u32 s81, s81, 0
s_waitcnt vmcnt(14)
s_barrier
s_sub_u32 s41, s41, 1
s_cmp_lg_u32 s41, 0
s_cbranch_scc1 Lpl_8
s_add_u32 m0, s39, 0
s_mov_b64 exec, s[60:61]
buffer_load_dwordx4 v4, s[8:11], s37 offen lds
s_mov_b64 exec, -1
s_add_u32 m0, s39, 3072
s_nop 0
buffer_load_dwordx4 v5, s[8:11], s37 offen lds
s_add_u32 m0, s39, 6144
s_nop 0
buffer_load_dwordx4 v6, s[8:11], s37 offen lds
s_add_u32 m0, s39, 9216
s_nop 0
buffer_load_dwordx4 v7, s[8:11], s37 offen lds
s_add_u32 m0, s39, 12288
s_nop 0
buffer_load_dwordx4 v8, s[8:11], s37 offen lds
s_add_u32 m0, s39, 15360
s_nop 0
buffer_load_dwordx4 v9, s[8:11], s37 offen lds
s_add_u32 m0, s40, 0
s_add_u32 s43, s38, 0
buffer_load_dwordx4 v2, s[12:15], s43 offen lds
s_add_u32 m0, s40, 1024
s_add_u32 s43, s38, 49152
buffer_load_dwordx4 v3, s[12:15], s43 offen lds
s_add_u32 m0, s40, 2048
s_add_u32 s43, s38, 98304
buffer_load_dwordx4 v2, s[12:15], s43 offen lds
s_add_u32 m0, s40, 3072
s_add_u32 s43, s38, 147456
buffer_load_dwordx4 v3, s[12:15], s43 offen lds
s_add_u32 m0, s40, 4096
s_add_u32 s43, s38, 196608
buffer_load_dwordx4 v2, s[12:15], s43 offen lds
s_add_u32 m0, s40, 5120
s_add_u32 s43, s38, 245760
buffer_load_dwordx4 v3, s[12:15], s43 offen lds
s_add_u32 m0, s40, 6144
s_add_u32 s43, s38, 294912
buffer_load_dwordx4 v2, s[12:15], s43 offen lds
s_add_u32 m0, s40, 7168
s_add_u32 s43, s38, 344064
buffer_load_dwordx4 v3, s[12:15], s43 offen lds
s_add_u32 s37, s37, 128
s_add_u32 s38, s38, 393216
s_load_dword s64, s[80:81], 0
s_load_dword s65, s[80:81], 64
s_load_dword s66, s[80:81], 128
s_load_dword s67, s[80:81], 192
s_load_dword s68, s[80:81], 7168
s_load_dword s69, s[80:81], 7232
s_load_dword s70, s[80:81], 7296
s_load_dword s71, s[80:81], 7360
s_add_u32 s80, s80, 14336
s_addc_u32 s81, s81, 0
s_waitcnt vmcnt(14)
s_barrier
s_add_u32 m0, s39, 43008
s_mov_b64 exec, s[60:61]
buffer_load_dwordx4 v4, s[8:11], s37 offen lds
s_mov_b64 exec, -1
s_add_u32 m0, s39, 46080
s_nop 0
buffer_load_dwordx4 v5, s[8:11], s37 offen lds
s_add_u32 m0, s39, 49152
s_nop 0
buffer_load_dwordx4 v6, s[8:11], s37 offen lds
s_add_u32 m0, s39, 52224
s_nop 0
buffer_load_dwordx4 v7, s[8:11], s37 offen lds
s_add_u32 m0, s39, 55296
s_nop 0
buffer_load_dwordx4 v8, s[8:11], s37 offen lds
s_add_u32 m0, s39, 58368
s_nop 0
buffer_load_dwordx4 v9, s[8:11], s37 offen lds
s_add_u32 m0, s40, 43008
s_add_u32 s43, s38, 0
buffer_load_dwordx4 v2, s[12:15], s43 offen lds
s_add_u32 m0, s40, 44032
s_add_u32 s43, s38, 49152
buffer_load_dwordx4 v3, s[12:15], s43 offen lds
s_add_u32 m0, s40, 45056
s_add_u32 s43, s38, 98304
buffer_load_dwordx4 v2, s[12:15], s43 offen lds
s_add_u32 m0, s40, 46080
s_add_u32 s43, s38, 147456
buffer_load_dwordx4 v3, s[12:15], s43 offen lds
s_add_u32 m0, s40, 47104
s_add_u32 s43, s38, 196608
buffer_load_dwordx4 v2, s[12:15], s43 offen lds
s_add_u32 m0, s40, 48128
s_add_u32 s43, s38, 245760
buffer_load_dwordx4 v3, s[12:15], s43 offen lds
s_add_u32 m0, s40, 49152
s_add_u32 s43, s38, 294912
buffer_load_dwordx4 v2, s[12:15], s43 offen lds
s_add_u32 m0, s40, 50176
s_add_u32 s43, s38, 344064
buffer_load_dwordx4 v3, s[12:15], s43 offen lds
s_add_u32 s37, s37, 128
s_add_u32 s38, s38, 393216
s_load_dword s64, s[80:81], 0
s_load_dword s65, s[80:81], 64
s_load_dword s66, s[80:81], 128
s_load_dword s67, s[80:81], 192
s_load_dword s68, s[80:81], 7168
s_load_dword s69, s[80:81], 7232
s_load_dword s70, s[80:81], 7296
s_load_dword s71, s[80:81], 7360
s_add_u32 s80, s80, 14336
s_addc_u32 s81, s81, 0
s_waitcnt vmcnt(14)
s_barrier
s_add_u32 m0, s39, 86016
s_mov_b64 exec, s[60:61]
buffer_load_dwordx4 v4, s[8:11], s37 offen lds
s_mov_b64 exec, -1
s_add_u32 m0, s39, 89088
s_nop 0
buffer_load_dwordx4 v5, s[8:11], s37 offen lds
s_add_u32 m0, s39, 92160
s_nop 0
buffer_load_dwordx4 v6, s[8:11], s37 offen lds
s_add_u32 m0, s39, 95232
s_nop 0
buffer_load_dwordx4 v7, s[8:11], s37 offen lds
s_add_u32 m0, s39, 98304
s_nop 0
buffer_load_dwordx4 v8, s[8:11], s37 offen lds
s_add_u32 m0, s39, 101376
s_nop 0
buffer_load_dwordx4 v9, s[8:11], s37 offen lds
s_add_u32 m0, s40, 86016
s_add_u32 s43, s38, 0
buffer_load_dwordx4 v2, s[12:15], s43 offen lds
s_add_u32 m0, s40, 87040
s_add_u32 s43, s38, 49152
buffer_load_dwordx4 v3, s[12:15], s43 offen lds
s_add_u32 m0, s40, 88064
s_add_u32 s43, s38, 98304
buffer_load_dwordx4 v2, s[12:15], s43 offen lds
s_add_u32 m0, s40, 89088
s_add_u32 s43, s38, 147456
buffer_load_dwordx4 v3, s[12:15], s43 offen lds
s_add_u32 m0, s40, 90112
s_add_u32 s43, s38, 196608
buffer_load_dwordx4 v2, s[12:15], s43 offen lds
s_add_u32 m0, s40, 91136
s_add_u32 s43, s38, 245760
buffer_load_dwordx4 v3, s[12:15], s43 offen lds
s_add_u32 m0, s40, 92160
s_add_u32 s43, s38, 294912
buffer_load_dwordx4 v2, s[12:15], s43 offen lds
s_add_u32 m0, s40, 93184
s_add_u32 s43, s38, 344064
buffer_load_dwordx4 v3, s[12:15], s43 offen lds
s_add_u32 s37, s37, 128
s_add_u32 s38, s38, 393216
s_waitcnt vmcnt(14)
s_barrier
s_add_u32 m0, s39, 0
s_mov_b64 exec, s[60:61]
buffer_load_dwordx4 v4, s[8:11], s37 offen lds
s_mov_b64 exec, -1
s_add_u32 m0, s39, 3072
s_nop 0
buffer_load_dwordx4 v5, s[8:11], s37 offen lds
s_add_u32 m0, s39, 6144
s_nop 0
buffer_load_dwordx4 v6, s[8:11], s37 offen lds
s_add_u32 m0, s39, 9216
s_nop 0
buffer_load_dwordx4 v7, s[8:11], s37 offen lds
s_add_u32 m0, s39, 12288
s_nop 0
buffer_load_dwordx4 v8, s[8:11], s37 offen lds
s_add_u32 m0, s39, 15360
s_nop 0
buffer_load_dwordx4 v9, s[8:11], s37 offen lds
s_add_u32 m0, s40, 0
s_add_u32 s43, s38, 0
buffer_load_dwordx4 v2, s[12:15], s43 offen lds
s_add_u32 m0, s40, 1024
s_add_u32 s43, s38, 49152
buffer_load_dwordx4 v3, s[12:15], s43 offen lds
s_add_u32 m0, s40, 2048
s_add_u32 s43, s38, 98304
buffer_load_dwordx4 v2, s[12:15], s43 offen lds
s_add_u32 m0, s40, 3072
s_add_u32 s43, s38, 147456
buffer_load_dwordx4 v3, s[12:15], s43 offen lds
s_add_u32 m0, s40, 4096
s_add_u32 s43, s38, 196608
buffer_load_dwordx4 v2, s[12:15], s43 offen lds
s_add_u32 m0, s40, 5120
s_add_u32 s43, s38, 245760
buffer_load_dwordx4 v3, s[12:15], s43 offen lds
s_add_u32 m0, s40, 6144
s_add_u32 s43, s38, 294912
buffer_load_dwordx4 v2, s[12:15], s43 offen lds
s_add_u32 m0, s40, 7168
s_add_u32 s43, s38, 344064
buffer_load_dwordx4 v3, s[12:15], s43 offen lds
s_add_u32 s37, s37, 128
s_add_u32 s38, s38, 393216
s_waitcnt vmcnt(14)
s_barrier
s_waitcnt vmcnt(0)
s_barrier
s_barrier
s_waitcnt lgkmcnt(0)
s_and_b32 s43, s36, 1
s_lshr_b32 s44, s36, 1
s_and_b32 s44, s44, 1
s_lshr_b32 s45, s36, 2
v_lshlrev_b32 v14, 2, v13
v_sub_u32 v14, v12, v14
v_subrev_u32 v15, 0, v14
v_cmp_ge_u32 s[52:53], 7, v15
v_add_u32 v15, 16, v15
v_cmp_ge_u32 s[84:85], 7, v15
v_subrev_u32 v15, 1, v14
v_cmp_ge_u32 s[54:55], 7, v15
v_add_u32 v15, 16, v15
v_cmp_ge_u32 s[86:87], 7, v15
v_subrev_u32 v15, 2, v14
v_cmp_ge_u32 s[56:57], 7, v15
v_add_u32 v15, 16, v15
v_cmp_ge_u32 s[88:89], 7, v15
v_subrev_u32 v15, 3, v14
v_cmp_ge_u32 s[58:59], 7, v15
v_add_u32 v15, 16, v15
v_cmp_ge_u32 s[90:91], 7, v15
s_lshl_b32 s46, s45, 6
s_add_u32 s46, s46, s44
s_add_u32 s46, s46, 16
v_lshl_add_u32 v14, v12, 1, s46
s_lshl_b32 s47, s43, 6
v_lshl_add_u32 v15, v13, 4, s47
v_mul_u32_u24 v20, 400, v14
v_add_u32 v20, v20, v15
v_subrev_u32 v16, 32, v14
v_max_i32 v16, 0, v16
v_mul_u32_u24 v21, 400, v16
v_add_u32 v21, v21, v15
v_lshrrev_b32 v16, 2, v12
v_lshl_add_u32 v16, v13, 2, v16
v_lshl_add_u32 v16, v16, 1, s46
v_and_b32 v17, 3, v1
v_lshl_add_u32 v17, v17, 3, s47
v_mul_u32_u24 v22, 400, v16
v_add_u32 v22, v22, v17
v_subrev_u32 v16, 32, v16
v_max_i32 v16, 0, v16
v_mul_u32_u24 v23, 400, v16
v_add_u32 v23, v23, v17
s_lshl_b32 s60, s43, 13
s_lshl_b32 s61, s45, 10
s_add_u32 s60, s60, s61
s_lshl_b32 s61, s44, 8
s_add_u32 s60, s60, s61
v_lshlrev_b32 v27, 11, v13
v_lshl_add_u32 v27, v12, 4, v27
v_add_u32 v27, s60, v27
v_mov_b32 v28, 0xff800000
s_mov_b32 s61, 0x3e8293ee
s_nop 2
s_or_b32 s62, s34, s45
s_cmp_lg_u32 s62, 0
s_cselect_b64 s[64:65], s[84:85], 0
s_cselect_b64 s[66:67], s[86:87], 0
s_cselect_b64 s[68:69], s[88:89], 0
s_cselect_b64 s[70:71], s[90:91], 0
s_branch Latt_4
Lpf_3:
s_load_dwordx2 s[26:27], s[0:1], 64
s_lshl_b32 s43, s51, 11
buffer_load_dwordx4 v[96:99], v10, s[8:11], s43 offen offset:0
buffer_load_dwordx4 v[100:103], v10, s[8:11], s43 offen offset:1024
buffer_load_dwordx4 v[104:107], v10, s[8:11], s43 offen offset:2048
buffer_load_dwordx4 v[108:111], v10, s[8:11], s43 offen offset:3072
v_min_u32 v14, 23, v1
v_lshrrev_b32 v15, 3, v14
v_mul_u32_u24 v15, 43008, v15
v_and_b32 v14, 7, v14
v_lshl_add_u32 v15, v14, 4, v15
v_mov_b32 v32, 0x3f803f80
v_mov_b32 v33, 0x3f803f80
v_mov_b32 v34, 0x3f803f80
v_mov_b32 v35, 0x3f803f80
ds_write_b128 v15, v[32:35]
v_add_u32 v14, 0, v1
v_min_u32 v14, 47, v14
v_mul_u32_u24 v15, 21846, v14
v_lshrrev_b32 v15, 16, v15
v_mul_u32_u24 v16, 3, v15
v_sub_u32 v16, v14, v16
s_mul_i32 s43, s48, 16
v_add_u32 v15, s43, v15
v_mul_u32_u24 v15, 6144, v15
v_lshl_add_u32 v2, v16, 11, v15
s_waitcnt lgkmcnt(0)
s_mov_b32 s56, s26
s_mov_b32 s57, s27
s_mov_b32 s58, 256
s_mov_b32 s59, 0x20000
v_lshlrev_b32 v14, 7, v1
s_or_b32 s43, s34, s35
s_cmp_lg_u32 s43, 0
s_cbranch_scc1 Lz_9
s_add_u32 s84, s32, 28311552
s_addc_u32 s85, s33, 0
s_mov_b32 s86, 16384
s_mov_b32 s87, 0x20000
v_mov_b32 v5, 0
buffer_store_dword v5, v14, s[84:87], 0 offen sc1
s_movk_i32 s43, 0x2000
buffer_store_dword v5, v14, s[84:87], s43 offen sc1
v_mov_b32 v36, 0
v_mov_b32 v37, 0
v_mov_b32 v38, 0
v_mov_b32 v39, 0
v_lshlrev_b32 v5, 4, v1
s_movk_i32 s43, 12288
buffer_store_dwordx4 v[36:39], v5, s[84:87], s43 offen sc1
s_waitcnt vmcnt(0)
Lz_9:
s_barrier
s_cmp_ge_u32 s2, 128
s_cbranch_scc1 Lm_11
s_mov_b32 s84, s6
s_mov_b32 s85, s7
s_mov_b32 s86, 6291456
s_mov_b32 s87, 0x20000
s_mul_i32 s43, s2, 24576
buffer_load_dword v31, v14, s[84:87], s43 offen
s_add_u32 s43, s43, 8192
buffer_load_dword v31, v14, s[84:87], s43 offen
s_add_u32 s43, s43, 8192
buffer_load_dword v31, v14, s[84:87], s43 offen
Lm_11:
s_mov_b32 s84, s6
s_mov_b32 s85, s7
s_mov_b32 s86, 6291456
s_mov_b32 s87, 0x20000
s_lshr_b32 s44, s2, 3
s_xor_b32 s43, s63, 64
s_lshl_b32 s43, s43, 11
buffer_load_dword v31, v14, s[8:11], s43 offen
s_add_u32 s43, s43, 8192
buffer_load_dword v31, v14, s[8:11], s43 offen
s_lshr_b32 s43, s2, 5
s_cmp_eq_u32 s43, 3
s_cbranch_scc1 Lsj_12
s_cmp_gt_u32 s43, 3
s_cselect_b32 s43, 32, 0
s_sub_u32 s43, s2, s43
s_lshr_b32 s43, s43, 1
s_and_b32 s44, s2, 1
s_lshl_b32 s44, s44, 3
s_add_u32 s44, s44, 32
s_load_dwordx2 s[80:81], s[0:1], s44
s_mul_i32 s45, s43, 2341
s_lshr_b32 s45, s45, 16
s_mul_i32 s46, s45, 28
s_sub_u32 s46, s43, s46
s_lshl_b32 s45, s45, 8
s_mul_i32 s44, s47, 18
s_add_u32 s45, s45, s44
s_add_u32 s45, s45, 184
s_mul_i32 s45, s45, 7168
s_lshl_b32 s46, s46, 8
s_add_u32 s45, s45, s46
s_waitcnt lgkmcnt(0)
s_add_u32 s80, s80, s45
s_addc_u32 s81, s81, 0
Lsj_12:
s_barrier
s_cmp_ge_u32 s2, 128
s_cbranch_scc0 Lm_13
s_mov_b32 s84, s6
s_mov_b32 s85, s7
s_mov_b32 s86, 6291456
s_mov_b32 s87, 0x20000
s_mul_i32 s43, s2, 24576
buffer_load_dword v31, v14, s[84:87], s43 offen
s_add_u32 s43, s43, 8192
buffer_load_dword v31, v14, s[84:87], s43 offen
s_add_u32 s43, s43, 8192
buffer_load_dword v31, v14, s[84:87], s43 offen
Lm_13:
s_barrier
s_waitcnt vmcnt(2)
v_lshlrev_b32 v124, 16, v96
v_and_b32 v125, 0xffff0000, v96
v_mov_b32 v116, v124
v_mov_b32 v117, v125
v_mul_f32 v118, v124, v124
v_mul_f32 v119, v125, v125
v_lshlrev_b32 v126, 16, v97
v_and_b32 v127, 0xffff0000, v97
v_add_f32 v116, v116, v126
v_add_f32 v117, v117, v127
v_fmac_f32 v118, v126, v126
v_fmac_f32 v119, v127, v127
v_lshlrev_b32 v124, 16, v98
v_and_b32 v125, 0xffff0000, v98
v_add_f32 v116, v116, v124
v_add_f32 v117, v117, v125
v_fmac_f32 v118, v124, v124
v_fmac_f32 v119, v125, v125
v_lshlrev_b32 v126, 16, v99
v_and_b32 v127, 0xffff0000, v99
v_add_f32 v116, v116, v126
v_add_f32 v117, v117, v127
v_fmac_f32 v118, v126, v126
v_fmac_f32 v119, v127, v127
v_lshlrev_b32 v124, 16, v100
v_and_b32 v125, 0xffff0000, v100
v_add_f32 v116, v116, v124
v_add_f32 v117, v117, v125
v_fmac_f32 v118, v124, v124
v_fmac_f32 v119, v125, v125
v_lshlrev_b32 v126, 16, v101
v_and_b32 v127, 0xffff0000, v101
v_add_f32 v116, v116, v126
v_add_f32 v117, v117, v127
v_fmac_f32 v118, v126, v126
v_fmac_f32 v119, v127, v127
v_lshlrev_b32 v124, 16, v102
v_and_b32 v125, 0xffff0000, v102
v_add_f32 v116, v116, v124
v_add_f32 v117, v117, v125
v_fmac_f32 v118, v124, v124
v_fmac_f32 v119, v125, v125
v_lshlrev_b32 v126, 16, v103
v_and_b32 v127, 0xffff0000, v103
v_add_f32 v116, v116, v126
v_add_f32 v117, v117, v127
v_fmac_f32 v118, v126, v126
v_fmac_f32 v119, v127, v127
v_lshlrev_b32 v124, 16, v104
v_and_b32 v125, 0xffff0000, v104
v_mov_b32 v120, v124
v_mov_b32 v121, v125
v_mul_f32 v122, v124, v124
v_mul_f32 v123, v125, v125
v_lshlrev_b32 v126, 16, v105
v_and_b32 v127, 0xffff0000, v105
v_add_f32 v120, v120, v126
v_add_f32 v121, v121, v127
v_fmac_f32 v122, v126, v126
v_fmac_f32 v123, v127, v127
v_lshlrev_b32 v124, 16, v106
v_and_b32 v125, 0xffff0000, v106
v_add_f32 v120, v120, v124
v_add_f32 v121, v121, v125
v_fmac_f32 v122, v124, v124
v_fmac_f32 v123, v125, v125
v_lshlrev_b32 v126, 16, v107
v_and_b32 v127, 0xffff0000, v107
v_add_f32 v120, v120, v126
v_add_f32 v121, v121, v127
v_fmac_f32 v122, v126, v126
v_fmac_f32 v123, v127, v127
v_lshlrev_b32 v124, 16, v108
v_and_b32 v125, 0xffff0000, v108
v_add_f32 v120, v120, v124
v_add_f32 v121, v121, v125
v_fmac_f32 v122, v124, v124
v_fmac_f32 v123, v125, v125
v_lshlrev_b32 v126, 16, v109
v_and_b32 v127, 0xffff0000, v109
v_add_f32 v120, v120, v126
v_add_f32 v121, v121, v127
v_fmac_f32 v122, v126, v126
v_fmac_f32 v123, v127, v127
v_lshlrev_b32 v124, 16, v110
v_and_b32 v125, 0xffff0000, v110
v_add_f32 v120, v120, v124
v_add_f32 v121, v121, v125
v_fmac_f32 v122, v124, v124
v_fmac_f32 v123, v125, v125
v_lshlrev_b32 v126, 16, v111
v_and_b32 v127, 0xffff0000, v111
v_add_f32 v120, v120, v126
v_add_f32 v121, v121, v127
v_fmac_f32 v122, v126, v126
v_fmac_f32 v123, v127, v127
v_add_f32 v116, v116, v117
v_add_f32 v118, v118, v119
v_add_f32 v120, v120, v121
v_add_f32 v122, v122, v123
s_nop 0
v_add_f32_dpp v116, v116, v116 row_ror:8 row_mask:0xf bank_mask:0xf
v_add_f32_dpp v118, v118, v118 row_ror:8 row_mask:0xf bank_mask:0xf
v_add_f32_dpp v120, v120, v120 row_ror:8 row_mask:0xf bank_mask:0xf
v_add_f32_dpp v122, v122, v122 row_ror:8 row_mask:0xf bank_mask:0xf
v_add_f32_dpp v116, v116, v116 row_ror:4 row_mask:0xf bank_mask:0xf
v_add_f32_dpp v118, v118, v118 row_ror:4 row_mask:0xf bank_mask:0xf
v_add_f32_dpp v120, v120, v120 row_ror:4 row_mask:0xf bank_mask:0xf
v_add_f32_dpp v122, v122, v122 row_ror:4 row_mask:0xf bank_mask:0xf
v_add_f32_dpp v116, v116, v116 row_ror:2 row_mask:0xf bank_mask:0xf
v_add_f32_dpp v118, v118, v118 row_ror:2 row_mask:0xf bank_mask:0xf
v_add_f32_dpp v120, v120, v120 row_ror:2 row_mask:0xf bank_mask:0xf
v_add_f32_dpp v122, v122, v122 row_ror:2 row_mask:0xf bank_mask:0xf
v_add_f32_dpp v116, v116, v116 row_ror:1 row_mask:0xf bank_mask:0xf
v_add_f32_dpp v118, v118, v118 row_ror:1 row_mask:0xf bank_mask:0xf
v_add_f32_dpp v120, v120, v120 row_ror:1 row_mask:0xf bank_mask:0xf
v_add_f32_dpp v122, v122, v122 row_ror:1 row_mask:0xf bank_mask:0xf
v_mov_b32 v117, v116
v_mov_b32 v119, v118
v_mov_b32 v121, v120
v_mov_b32 v123, v122
s_nop 0
v_permlane16_swap_b32 v116, v117
v_permlane16_swap_b32 v118, v119
v_permlane16_swap_b32 v120, v121
v_permlane16_swap_b32 v122, v123
v_add_f32 v116, v116, v117
v_add_f32 v118, v118, v119
v_add_f32 v120, v120, v121
v_add_f32 v122, v122, v123
v_mov_b32 v117, v116
v_mov_b32 v119, v118
v_mov_b32 v121, v120
v_mov_b32 v123, v122
s_nop 0
v_permlane32_swap_b32 v116, v117
v_permlane32_swap_b32 v118, v119
v_permlane32_swap_b32 v120, v121
v_permlane32_swap_b32 v122, v123
v_add_f32 v116, v116, v117
v_add_f32 v118, v118, v119
v_add_f32 v120, v120, v121
v_add_f32 v122, v122, v123
v_mul_f32 v112, 0x3a800000, v116
v_mul_f32 v113, 0x3a800000, v118
v_fma_f32 v113, -v112, v112, v113
v_max_f32 v113, 0, v113
v_add_f32 v113, 0x3727c5ac, v113
v_rsq_f32 v113, v113
v_mul_f32 v114, 0x3a800000, v120
v_mul_f32 v115, 0x3a800000, v122
v_fma_f32 v115, -v114, v114, v115
v_max_f32 v115, 0, v115
v_add_f32 v115, 0x3727c5ac, v115
v_rsq_f32 v115, v115
s_nop 0
s_lshl_b32 s43, s47, 4
s_add_u32 s43, s43, 130176
v_mov_b32 v11, s43
ds_write_b128 v11, v[112:115]
s_waitcnt lgkmcnt(0)
s_barrier
v_lshlrev_b32 v5, 4, v1
v_and_b32 v5, 63, v5
v_add_u32 v6, 130176, v5
ds_read_b128 v[112:115], v6
s_lshl_b32 s43, s63, 3
v_add_u32 v5, s43, v5
s_waitcnt lgkmcnt(0)
s_mov_b64 exec, 15
buffer_store_dwordx4 v[112:115], v5, s[20:23], 0 offen sc1
s_mov_b64 exec, -1
s_load_dword s64, s[80:81], 0
s_load_dword s65, s[80:81], 64
s_load_dword s66, s[80:81], 128
s_load_dword s67, s[80:81], 192
s_load_dword s68, s[80:81], 7168
s_load_dword s69, s[80:81], 7232
s_load_dword s70, s[80:81], 7296
s_load_dword s71, s[80:81], 7360
s_add_u32 s80, s80, 14336
s_addc_u32 s81, s81, 0
s_barrier
s_load_dword s64, s[80:81], 0
s_load_dword s65, s[80:81], 64
s_load_dword s66, s[80:81], 128
s_load_dword s67, s[80:81], 192
s_load_dword s68, s[80:81], 7168
s_load_dword s69, s[80:81], 7232
s_load_dword s70, s[80:81], 7296
s_load_dword s71, s[80:81], 7360
s_add_u32 s80, s80, 14336
s_addc_u32 s81, s81, 0
s_barrier
s_load_dword s64, s[80:81], 0
s_load_dword s65, s[80:81], 64
s_load_dword s66, s[80:81], 128
s_load_dword s67, s[80:81], 192
s_load_dword s68, s[80:81], 7168
s_load_dword s69, s[80:81], 7232
s_load_dword s70, s[80:81], 7296
s_load_dword s71, s[80:81], 7360
s_add_u32 s80, s80, 14336
s_addc_u32 s81, s81, 0
s_barrier
s_load_dword s64, s[80:81], 0
s_load_dword s65, s[80:81], 64
s_load_dword s66, s[80:81], 128
s_load_dword s67, s[80:81], 192
s_load_dword s68, s[80:81], 7168
s_load_dword s69, s[80:81], 7232
s_load_dword s70, s[80:81], 7296
s_load_dword s71, s[80:81], 7360
s_add_u32 s80, s80, 14336
s_addc_u32 s81, s81, 0
s_barrier
s_waitcnt vmcnt(0)
s_lshl_b32 s43, s34, 4
s_add_u32 s43, s43, s35
v_mov_b32 v5, s43
v_mov_b32 v6, 1
s_mov_b64 exec, 1
buffer_store_byte v6, v5, s[56:59], 0 offen sc1
s_mov_b64 exec, -1
s_load_dword s64, s[80:81], 0
s_load_dword s65, s[80:81], 64
s_load_dword s66, s[80:81], 128
s_load_dword s67, s[80:81], 192
s_load_dword s68, s[80:81], 7168
s_load_dword s69, s[80:81], 7232
s_load_dword s70, s[80:81], 7296
s_load_dword s71, s[80:81], 7360
s_add_u32 s80, s80, 14336
s_addc_u32 s81, s81, 0
s_barrier
s_load_dword s64, s[80:81], 0
s_load_dword s65, s[80:81], 64
s_load_dword s66, s[80:81], 128
s_load_dword s67, s[80:81], 192
s_load_dword s68, s[80:81], 7168
s_load_dword s69, s[80:81], 7232
s_load_dword s70, s[80:81], 7296
s_load_dword s71, s[80:81], 7360
s_add_u32 s80, s80, 14336
s_addc_u32 s81, s81, 0
s_barrier
s_load_dword s64, s[80:81], 0
s_load_dword s65, s[80:81], 64
s_load_dword s66, s[80:81], 128
s_load_dword s67, s[80:81], 192
s_load_dword s68, s[80:81], 7168
s_load_dword s69, s[80:81], 7232
s_load_dword s70, s[80:81], 7296
s_load_dword s71, s[80:81], 7360
s_add_u32 s80, s80, 14336
s_addc_u32 s81, s81, 0
s_barrier
s_lshl_b32 s43, s34, 4
s_sub_u32 s44, s43, 4
s_max_i32 s44, s44, 0
v_lshl_add_u32 v5, v1, 2, s43
v_mov_b32 v6, s44
v_cmp_gt_u32 vcc, 4, v1
s_nop 1
v_cndmask_b32 v5, v6, v5, vcc
v_cmp_eq_u32 vcc, 5, v1
s_nop 1
v_cndmask_b32 v5, v5, 0, vcc
buffer_load_dword v6, v5, s[56:59], 0 offen sc1
s_load_dword s64, s[80:81], 0
s_load_dword s65, s[80:81], 64
s_load_dword s66, s[80:81], 128
s_load_dword s67, s[80:81], 192
s_load_dword s68, s[80:81], 7168
s_load_dword s69, s[80:81], 7232
s_load_dword s70, s[80:81], 7296
s_load_dword s71, s[80:81], 7360
s_add_u32 s80, s80, 14336
s_addc_u32 s81, s81, 0
s_barrier
s_load_dword s64, s[80:81], 0
s_load_dword s65, s[80:81], 64
s_load_dword s66, s[80:81], 128
s_load_dword s67, s[80:81], 192
s_load_dword s68, s[80:81], 7168
s_load_dword s69, s[80:81], 7232
s_load_dword s70, s[80:81], 7296
s_load_dword s71, s[80:81], 7360
s_add_u32 s80, s80, 14336
s_addc_u32 s81, s81, 0
s_barrier
s_mov_b32 s41, 200
s_mov_b32 s62, 0
s_waitcnt vmcnt(0)
Lpoll_14:
v_and_b32 v6, 0x01010101, v6
v_cmp_ne_u32 vcc, 0x01010101, v6
s_nop 4
s_cbranch_vccz Lok_15
buffer_load_dword v6, v5, s[56:59], 0 offen sc1
s_waitcnt vmcnt(0)
s_sub_u32 s41, s41, 1
s_cmp_lg_u32 s41, 0
s_cbranch_scc1 Lpoll_14
s_mov_b32 s41, 0
Lfb_16:
s_add_u32 s62, s50, s41
s_max_i32 s62, s62, 0
s_lshl_b32 s43, s62, 11
buffer_load_dwordx4 v[96:99], v10, s[8:11], s43 offen offset:0
buffer_load_dwordx4 v[100:103], v10, s[8:11], s43 offen offset:1024
buffer_load_dwordx4 v[104:107], v10, s[8:11], s43 offen offset:2048
buffer_load_dwordx4 v[108:111], v10, s[8:11], s43 offen offset:3072
s_waitcnt vmcnt(0)
v_lshlrev_b32 v124, 16, v96
v_and_b32 v125, 0xffff0000, v96
v_mov_b32 v116, v124
v_mov_b32 v117, v125
v_mul_f32 v118, v124, v124
v_mul_f32 v119, v125, v125
v_lshlrev_b32 v126, 16, v97
v_and_b32 v127, 0xffff0000, v97
v_add_f32 v116, v116, v126
v_add_f32 v117, v117, v127
v_fmac_f32 v118, v126, v126
v_fmac_f32 v119, v127, v127
v_lshlrev_b32 v124, 16, v98
v_and_b32 v125, 0xffff0000, v98
v_add_f32 v116, v116, v124
v_add_f32 v117, v117, v125
v_fmac_f32 v118, v124, v124
v_fmac_f32 v119, v125, v125
v_lshlrev_b32 v126, 16, v99
v_and_b32 v127, 0xffff0000, v99
v_add_f32 v116, v116, v126
v_add_f32 v117, v117, v127
v_fmac_f32 v118, v126, v126
v_fmac_f32 v119, v127, v127
v_lshlrev_b32 v124, 16, v100
v_and_b32 v125, 0xffff0000, v100
v_add_f32 v116, v116, v124
v_add_f32 v117, v117, v125
v_fmac_f32 v118, v124, v124
v_fmac_f32 v119, v125, v125
v_lshlrev_b32 v126, 16, v101
v_and_b32 v127, 0xffff0000, v101
v_add_f32 v116, v116, v126
v_add_f32 v117, v117, v127
v_fmac_f32 v118, v126, v126
v_fmac_f32 v119, v127, v127
v_lshlrev_b32 v124, 16, v102
v_and_b32 v125, 0xffff0000, v102
v_add_f32 v116, v116, v124
v_add_f32 v117, v117, v125
v_fmac_f32 v118, v124, v124
v_fmac_f32 v119, v125, v125
v_lshlrev_b32 v126, 16, v103
v_and_b32 v127, 0xffff0000, v103
v_add_f32 v116, v116, v126
v_add_f32 v117, v117, v127
v_fmac_f32 v118, v126, v126
v_fmac_f32 v119, v127, v127
v_lshlrev_b32 v124, 16, v104
v_and_b32 v125, 0xffff0000, v104
v_mov_b32 v120, v124
v_mov_b32 v121, v125
v_mul_f32 v122, v124, v124
v_mul_f32 v123, v125, v125
v_lshlrev_b32 v126, 16, v105
v_and_b32 v127, 0xffff0000, v105
v_add_f32 v120, v120, v126
v_add_f32 v121, v121, v127
v_fmac_f32 v122, v126, v126
v_fmac_f32 v123, v127, v127
v_lshlrev_b32 v124, 16, v106
v_and_b32 v125, 0xffff0000, v106
v_add_f32 v120, v120, v124
v_add_f32 v121, v121, v125
v_fmac_f32 v122, v124, v124
v_fmac_f32 v123, v125, v125
v_lshlrev_b32 v126, 16, v107
v_and_b32 v127, 0xffff0000, v107
v_add_f32 v120, v120, v126
v_add_f32 v121, v121, v127
v_fmac_f32 v122, v126, v126
v_fmac_f32 v123, v127, v127
v_lshlrev_b32 v124, 16, v108
v_and_b32 v125, 0xffff0000, v108
v_add_f32 v120, v120, v124
v_add_f32 v121, v121, v125
v_fmac_f32 v122, v124, v124
v_fmac_f32 v123, v125, v125
v_lshlrev_b32 v126, 16, v109
v_and_b32 v127, 0xffff0000, v109
v_add_f32 v120, v120, v126
v_add_f32 v121, v121, v127
v_fmac_f32 v122, v126, v126
v_fmac_f32 v123, v127, v127
v_lshlrev_b32 v124, 16, v110
v_and_b32 v125, 0xffff0000, v110
v_add_f32 v120, v120, v124
v_add_f32 v121, v121, v125
v_fmac_f32 v122, v124, v124
v_fmac_f32 v123, v125, v125
v_lshlrev_b32 v126, 16, v111
v_and_b32 v127, 0xffff0000, v111
v_add_f32 v120, v120, v126
v_add_f32 v121, v121, v127
v_fmac_f32 v122, v126, v126
v_fmac_f32 v123, v127, v127
v_add_f32 v116, v116, v117
v_add_f32 v118, v118, v119
v_add_f32 v120, v120, v121
v_add_f32 v122, v122, v123
s_nop 0
v_add_f32_dpp v116, v116, v116 row_ror:8 row_mask:0xf bank_mask:0xf
v_add_f32_dpp v118, v118, v118 row_ror:8 row_mask:0xf bank_mask:0xf
v_add_f32_dpp v120, v120, v120 row_ror:8 row_mask:0xf bank_mask:0xf
v_add_f32_dpp v122, v122, v122 row_ror:8 row_mask:0xf bank_mask:0xf
v_add_f32_dpp v116, v116, v116 row_ror:4 row_mask:0xf bank_mask:0xf
v_add_f32_dpp v118, v118, v118 row_ror:4 row_mask:0xf bank_mask:0xf
v_add_f32_dpp v120, v120, v120 row_ror:4 row_mask:0xf bank_mask:0xf
v_add_f32_dpp v122, v122, v122 row_ror:4 row_mask:0xf bank_mask:0xf
v_add_f32_dpp v116, v116, v116 row_ror:2 row_mask:0xf bank_mask:0xf
v_add_f32_dpp v118, v118, v118 row_ror:2 row_mask:0xf bank_mask:0xf
v_add_f32_dpp v120, v120, v120 row_ror:2 row_mask:0xf bank_mask:0xf
v_add_f32_dpp v122, v122, v122 row_ror:2 row_mask:0xf bank_mask:0xf
v_add_f32_dpp v116, v116, v116 row_ror:1 row_mask:0xf bank_mask:0xf
v_add_f32_dpp v118, v118, v118 row_ror:1 row_mask:0xf bank_mask:0xf
v_add_f32_dpp v120, v120, v120 row_ror:1 row_mask:0xf bank_mask:0xf
v_add_f32_dpp v122, v122, v122 row_ror:1 row_mask:0xf bank_mask:0xf
v_mov_b32 v117, v116
v_mov_b32 v119, v118
v_mov_b32 v121, v120
v_mov_b32 v123, v122
s_nop 0
v_permlane16_swap_b32 v116, v117
v_permlane16_swap_b32 v118, v119
v_permlane16_swap_b32 v120, v121
v_permlane16_swap_b32 v122, v123
v_add_f32 v116, v116, v117
v_add_f32 v118, v118, v119
v_add_f32 v120, v120, v121
v_add_f32 v122, v122, v123
v_mov_b32 v117, v116
v_mov_b32 v119, v118
v_mov_b32 v121, v120
v_mov_b32 v123, v122
s_nop 0
v_permlane32_swap_b32 v116, v117
v_permlane32_swap_b32 v118, v119
v_permlane32_swap_b32 v120, v121
v_permlane32_swap_b32 v122, v123
v_add_f32 v116, v116, v117
v_add_f32 v118, v118, v119
v_add_f32 v120, v120, v121
v_add_f32 v122, v122, v123
v_mul_f32 v112, 0x3a800000, v116
v_mul_f32 v113, 0x3a800000, v118
v_fma_f32 v113, -v112, v112, v113
v_max_f32 v113, 0, v113
v_add_f32 v113, 0x3727c5ac, v113
v_rsq_f32 v113, v113
v_mul_f32 v114, 0x3a800000, v120
v_mul_f32 v115, 0x3a800000, v122
v_fma_f32 v115, -v114, v114, v115
v_max_f32 v115, 0, v115
v_add_f32 v115, 0x3727c5ac, v115
v_rsq_f32 v115, v115
s_nop 0
s_lshl_b32 s43, s41, 3
s_add_u32 s43, s43, 129024
v_mov_b32 v5, s43
ds_write_b128 v5, v[112:115]
s_add_u32 s41, s41, 2
s_cmp_lt_u32 s41, 144
s_cbranch_scc1 Lfb_16
s_mov_b32 s62, 1
v_mov_b32 v5, 0
s_mov_b32 s41, 0x10000
Lz0_17:
buffer_load_ubyte v6, v5, s[56:59], 0 offen sc1
s_waitcnt vmcnt(0)
v_cmp_eq_u32 vcc, 0, v6
s_nop 4
s_cbranch_vccz Lok_15
s_sub_u32 s41, s41, 1
s_cmp_lg_u32 s41, 0
s_cbranch_scc1 Lz0_17
Lok_15:
v_add_u32 v5, 0, v1
v_min_u32 v5, 143, v5
v_lshlrev_b32 v20, 3, v5
v_add_u32 v5, s50, v5
v_max_i32 v5, 0, v5
v_lshlrev_b32 v5, 3, v5
buffer_load_dwordx2 v[32:33], v5, s[20:23], 0 offen sc1
v_add_u32 v5, 64, v1
v_min_u32 v5, 143, v5
v_lshlrev_b32 v21, 3, v5
v_add_u32 v5, s50, v5
v_max_i32 v5, 0, v5
v_lshlrev_b32 v5, 3, v5
buffer_load_dwordx2 v[34:35], v5, s[20:23], 0 offen sc1
v_add_u32 v5, 128, v1
v_min_u32 v5, 143, v5
v_lshlrev_b32 v22, 3, v5
v_add_u32 v5, s50, v5
v_max_i32 v5, 0, v5
v_lshlrev_b32 v5, 3, v5
buffer_load_dwordx2 v[36:37], v5, s[20:23], 0 offen sc1
s_barrier
s_load_dwordx2 s[88:89], s[0:1], 16
v_lshlrev_b32 v29, 7, v1
s_lshl_b32 s43, s2, 13
s_waitcnt lgkmcnt(0)
s_mov_b32 s84, s88
s_mov_b32 s85, s89
s_mov_b32 s86, 2097152
s_mov_b32 s87, 0x20000
buffer_load_dword v30, v29, s[84:87], s43 offen
v_and_b32 v29, 31, v1
v_lshlrev_b32 v29, 11, v29
s_and_b32 s43, s35, 8
s_or_b32 s43, s43, 3
s_lshl_b32 s43, s43, 7
s_lshr_b32 s44, s2, 3
s_lshl_b32 s44, s44, 16
s_add_u32 s43, s43, s44
buffer_load_dword v30, v29, s[84:87], s43 offen
s_barrier
s_waitcnt vmcnt(2)
s_cmp_eq_u32 s62, 1
s_cbranch_scc1 Lgd_10
v_add_u32 v20, 129024, v20
ds_write_b64 v20, v[32:33]
v_add_u32 v21, 129024, v21
ds_write_b64 v21, v[34:35]
v_add_u32 v22, 129024, v22
ds_write_b64 v22, v[36:37]
Lgd_10:
s_waitcnt lgkmcnt(0)
s_lshr_b32 s43, s2, 5
s_cmp_eq_u32 s43, 3
s_cbranch_scc1 Lnj_18
s_cmp_gt_u32 s43, 3
s_cselect_b32 s43, 32, 0
s_sub_u32 s43, s2, s43
s_lshr_b32 s43, s43, 1
s_and_b32 s44, s2, 1
s_lshl_b32 s45, s44, 3
s_add_u32 s45, s45, 32
s_load_dwordx2 s[88:89], s[0:1], s45
s_mul_i32 s45, s43, 2341
s_lshr_b32 s45, s45, 16
s_mul_i32 s46, s45, 28
s_sub_u32 s46, s43, s46
v_lshrrev_b32 v28, 4, v1
s_lshl_b32 s43, s45, 8
v_add_u32 v28, s43, v28
v_mul_u32_u24 v28, 7168, v28
v_and_b32 v29, 15, v1
v_lshl_add_u32 v28, v29, 4, v28
s_lshl_b32 s43, s46, 8
v_add_u32 v28, s43, v28
s_waitcnt lgkmcnt(0)
s_mov_b32 s84, s88
s_mov_b32 s85, s89
s_mov_b32 s86, 7340032
s_mov_b32 s87, 0x20000
s_mov_b32 s43, 0
buffer_load_dwordx4 v[128:131], v28, s[84:87], s43 offen
s_mov_b32 s43, 28672
buffer_load_dwordx4 v[132:135], v28, s[84:87], s43 offen
s_mov_b32 s43, 57344
buffer_load_dwordx4 v[136:139], v28, s[84:87], s43 offen
s_mov_b32 s43, 86016
buffer_load_dwordx4 v[140:143], v28, s[84:87], s43 offen
s_mov_b32 s43, 114688
buffer_load_dwordx4 v[144:147], v28, s[84:87], s43 offen
s_mov_b32 s43, 143360
buffer_load_dwordx4 v[148:151], v28, s[84:87], s43 offen
s_mov_b32 s43, 172032
buffer_load_dwordx4 v[152:155], v28, s[84:87], s43 offen
s_mov_b32 s43, 200704
buffer_load_dwordx4 v[156:159], v28, s[84:87], s43 offen
s_mov_b32 s43, 229376
buffer_load_dwordx4 v[160:163], v28, s[84:87], s43 offen
s_mov_b32 s43, 258048
buffer_load_dwordx4 v[164:167], v28, s[84:87], s43 offen
s_mov_b32 s43, 286720
buffer_load_dwordx4 v[168:171], v28, s[84:87], s43 offen
s_mov_b32 s43, 315392
buffer_load_dwordx4 v[172:175], v28, s[84:87], s43 offen
s_mov_b32 s43, 344064
buffer_load_dwordx4 v[176:179], v28, s[84:87], s43 offen
s_mov_b32 s43, 372736
buffer_load_dwordx4 v[180:183], v28, s[84:87], s43 offen
s_mov_b32 s43, 401408
buffer_load_dwordx4 v[184:187], v28, s[84:87], s43 offen
s_mov_b32 s43, 430080
buffer_load_dwordx4 v[188:191], v28, s[84:87], s43 offen
Lnj_18:
s_barrier
s_lshr_b32 s43, s2, 5
s_cmp_eq_u32 s43, 3
s_cbranch_scc1 Lnj_19
s_cmp_gt_u32 s43, 3
s_cselect_b32 s43, 32, 0
s_sub_u32 s43, s2, s43
s_lshr_b32 s43, s43, 1
s_and_b32 s44, s2, 1
s_lshl_b32 s45, s44, 3
s_add_u32 s45, s45, 32
s_load_dwordx2 s[88:89], s[0:1], s45
s_mul_i32 s45, s43, 2341
s_lshr_b32 s45, s45, 16
s_mul_i32 s46, s45, 28
s_sub_u32 s46, s43, s46
v_lshrrev_b32 v28, 4, v1
s_lshl_b32 s43, s45, 8
v_add_u32 v28, s43, v28
v_mul_u32_u24 v28, 7168, v28
v_and_b32 v29, 15, v1
v_lshl_add_u32 v28, v29, 4, v28
s_lshl_b32 s43, s46, 8
v_add_u32 v28, s43, v28
s_waitcnt lgkmcnt(0)
s_mov_b32 s84, s88
s_mov_b32 s85, s89
s_mov_b32 s86, 7340032
s_mov_b32 s87, 0x20000
s_mov_b32 s43, 458752
buffer_load_dwordx4 v[192:195], v28, s[84:87], s43 offen
s_mov_b32 s43, 487424
buffer_load_dwordx4 v[196:199], v28, s[84:87], s43 offen
s_mov_b32 s43, 516096
buffer_load_dwordx4 v[200:203], v28, s[84:87], s43 offen
s_mov_b32 s43, 544768
buffer_load_dwordx4 v[204:207], v28, s[84:87], s43 offen
s_mov_b32 s43, 573440
buffer_load_dwordx4 v[208:211], v28, s[84:87], s43 offen
s_mov_b32 s43, 602112
buffer_load_dwordx4 v[212:215], v28, s[84:87], s43 offen
s_mov_b32 s43, 630784
buffer_load_dwordx4 v[216:219], v28, s[84:87], s43 offen
s_mov_b32 s43, 659456
buffer_load_dwordx4 v[220:223], v28, s[84:87], s43 offen
s_mov_b32 s43, 688128
buffer_load_dwordx4 v[224:227], v28, s[84:87], s43 offen
s_mov_b32 s43, 716800
buffer_load_dwordx4 v[228:231], v28, s[84:87], s43 offen
s_mov_b32 s43, 745472
buffer_load_dwordx4 v[232:235], v28, s[84:87], s43 offen
s_mov_b32 s43, 774144
buffer_load_dwordx4 v[236:239], v28, s[84:87], s43 offen
s_mov_b32 s43, 802816
buffer_load_dwordx4 v[240:243], v28, s[84:87], s43 offen
s_mov_b32 s43, 831488
buffer_load_dwordx4 v[244:247], v28, s[84:87], s43 offen
s_mov_b32 s43, 860160
buffer_load_dwordx4 v[248:251], v28, s[84:87], s43 offen
s_mov_b32 s43, 888832
buffer_load_dwordx4 v[252:255], v28, s[84:87], s43 offen
Lnj_19:
s_barrier
s_waitcnt lgkmcnt(0)
s_and_b32 s43, s36, 1
s_lshr_b32 s44, s36, 1
s_and_b32 s44, s44, 1
s_lshr_b32 s45, s36, 2
v_lshlrev_b32 v14, 2, v13
v_sub_u32 v14, v12, v14
v_subrev_u32 v15, 0, v14
v_cmp_ge_u32 s[52:53], 7, v15
v_add_u32 v15, 16, v15
v_cmp_ge_u32 s[84:85], 7, v15
v_subrev_u32 v15, 1, v14
v_cmp_ge_u32 s[54:55], 7, v15
v_add_u32 v15, 16, v15
v_cmp_ge_u32 s[86:87], 7, v15
v_subrev_u32 v15, 2, v14
v_cmp_ge_u32 s[56:57], 7, v15
v_add_u32 v15, 16, v15
v_cmp_ge_u32 s[88:89], 7, v15
v_subrev_u32 v15, 3, v14
v_cmp_ge_u32 s[58:59], 7, v15
v_add_u32 v15, 16, v15
v_cmp_ge_u32 s[90:91], 7, v15
s_lshl_b32 s46, s45, 6
s_add_u32 s46, s46, s44
s_add_u32 s46, s46, 16
v_lshl_add_u32 v14, v12, 1, s46
s_lshl_b32 s47, s43, 6
v_lshl_add_u32 v15, v13, 4, s47
v_mul_u32_u24 v20, 400, v14
v_add_u32 v20, v20, v15
v_subrev_u32 v16, 32, v14
v_max_i32 v16, 0, v16
v_mul_u32_u24 v21, 400, v16
v_add_u32 v21, v21, v15
v_lshrrev_b32 v16, 2, v12
v_lshl_add_u32 v16, v13, 2, v16
v_lshl_add_u32 v16, v16, 1, s46
v_and_b32 v17, 3, v1
v_lshl_add_u32 v17, v17, 3, s47
v_mul_u32_u24 v22, 400, v16
v_add_u32 v22, v22, v17
v_subrev_u32 v16, 32, v16
v_max_i32 v16, 0, v16
v_mul_u32_u24 v23, 400, v16
v_add_u32 v23, v23, v17
s_lshl_b32 s60, s43, 13
s_lshl_b32 s61, s45, 10
s_add_u32 s60, s60, s61
s_lshl_b32 s61, s44, 8
s_add_u32 s60, s60, s61
v_lshlrev_b32 v27, 11, v13
v_lshl_add_u32 v27, v12, 4, v27
v_add_u32 v27, s60, v27
v_mov_b32 v28, 0xff800000
s_mov_b32 s61, 0x3e8293ee
s_nop 2
s_or_b32 s62, s34, s45
s_cmp_lg_u32 s62, 0
s_cselect_b64 s[64:65], s[84:85], 0
s_cselect_b64 s[66:67], s[86:87], 0
s_cselect_b64 s[68:69], s[88:89], 0
s_cselect_b64 s[70:71], s[90:91], 0
Latt_4:
s_barrier
ds_read_b128 v[32:35], v20 offset:0
ds_read_b128 v[36:39], v20 offset:128
ds_read_b128 v[40:43], v21 offset:128
ds_read_b128 v[80:83], v20 offset:12800
ds_read_b128 v[84:87], v20 offset:12928
ds_read_b128 v[88:91], v20 offset:128
ds_read_b64_tr_b16 v[44:45], v23 offset:256
ds_read_b64_tr_b16 v[46:47], v22 offset:256
ds_read_b64_tr_b16 v[48:49], v23 offset:288
ds_read_b64_tr_b16 v[50:51], v22 offset:288
ds_read_b64_tr_b16 v[92:93], v22 offset:256
ds_read_b64_tr_b16 v[94:95], v22 offset:13056
ds_read_b64_tr_b16 v[96:97], v22 offset:288
ds_read_b64_tr_b16 v[98:99], v22 offset:13088
s_waitcnt lgkmcnt(11)
v_mfma_f32_16x16x32_bf16 v[52:55], v[40:43], v[32:35], 0
v_mfma_f32_16x16x32_bf16 v[56:59], v[36:39], v[32:35], 0
s_waitcnt lgkmcnt(8)
v_mfma_f32_16x16x32_bf16 v[100:103], v[88:91], v[80:83], 0
v_mfma_f32_16x16x32_bf16 v[104:107], v[84:87], v[80:83], 0
s_nop 7
v_cndmask_b32 v52, v28, v52, s[64:65]
v_cndmask_b32 v100, v28, v100, s[84:85]
v_cndmask_b32 v53, v28, v53, s[66:67]
v_cndmask_b32 v101, v28, v101, s[86:87]
v_cndmask_b32 v54, v28, v54, s[68:69]
v_cndmask_b32 v102, v28, v102, s[88:89]
v_cndmask_b32 v55, v28, v55, s[70:71]
v_cndmask_b32 v103, v28, v103, s[90:91]
v_cndmask_b32 v56, v28, v56, s[52:53]
v_cndmask_b32 v104, v28, v104, s[52:53]
v_cndmask_b32 v57, v28, v57, s[54:55]
v_cndmask_b32 v105, v28, v105, s[54:55]
v_cndmask_b32 v58, v28, v58, s[56:57]
v_cndmask_b32 v106, v28, v106, s[56:57]
v_cndmask_b32 v59, v28, v59, s[58:59]
v_cndmask_b32 v107, v28, v107, s[58:59]
v_max3_f32 v60, v52, v53, v54
v_max3_f32 v108, v100, v101, v102
v_max3_f32 v61, v55, v56, v57
v_max3_f32 v109, v103, v104, v105
v_max3_f32 v60, v60, v58, v59
v_max3_f32 v108, v108, v106, v107
v_max_f32 v60, v60, v61
v_max_f32 v108, v108, v109
v_mov_b32 v61, v60
v_mov_b32 v109, v108
s_nop 0
v_permlane32_swap_b32 v60, v61
v_permlane32_swap_b32 v108, v109
v_max_f32 v60, v60, v61
v_max_f32 v108, v108, v109
v_mov_b32 v61, v60
v_mov_b32 v109, v108
s_nop 0
v_permlane16_swap_b32 v60, v61
v_permlane16_swap_b32 v108, v109
v_max_f32 v60, v60, v61
v_max_f32 v108, v108, v109
v_mul_f32 v60, s61, v60
v_mul_f32 v108, s61, v108
v_fma_f32 v52, v52, s61, -v60
v_fma_f32 v100, v100, s61, -v108
v_fma_f32 v53, v53, s61, -v60
v_fma_f32 v101, v101, s61, -v108
v_fma_f32 v54, v54, s61, -v60
v_fma_f32 v102, v102, s61, -v108
v_fma_f32 v55, v55, s61, -v60
v_fma_f32 v103, v103, s61, -v108
v_fma_f32 v56, v56, s61, -v60
v_fma_f32 v104, v104, s61, -v108
v_fma_f32 v57, v57, s61, -v60
v_fma_f32 v105, v105, s61, -v108
v_fma_f32 v58, v58, s61, -v60
v_fma_f32 v106, v106, s61, -v108
v_fma_f32 v59, v59, s61, -v60
v_fma_f32 v107, v107, s61, -v108
v_exp_f32 v52, v52
v_exp_f32 v100, v100
v_exp_f32 v53, v53
v_exp_f32 v101, v101
v_exp_f32 v54, v54
v_exp_f32 v102, v102
v_exp_f32 v55, v55
v_exp_f32 v103, v103
v_exp_f32 v56, v56
v_exp_f32 v104, v104
v_exp_f32 v57, v57
v_exp_f32 v105, v105
v_exp_f32 v58, v58
v_exp_f32 v106, v106
v_exp_f32 v59, v59
v_exp_f32 v107, v107
v_cvt_pk_bf16_f32 v64, v52, v53
v_cvt_pk_bf16_f32 v112, v100, v101
v_cvt_pk_bf16_f32 v65, v54, v55
v_cvt_pk_bf16_f32 v113, v102, v103
v_cvt_pk_bf16_f32 v66, v56, v57
v_cvt_pk_bf16_f32 v114, v104, v105
v_cvt_pk_bf16_f32 v67, v58, v59
v_cvt_pk_bf16_f32 v115, v106, v107
s_waitcnt lgkmcnt(0)
v_mfma_f32_16x16x32_bf16 v[68:71], v[44:47], v[64:67], 0
v_mfma_f32_16x16x32_bf16 v[72:75], v[48:51], v[64:67], 0
v_mfma_f32_16x16x32_bf16 v[116:119], v[92:95], v[112:115], 0
v_mfma_f32_16x16x32_bf16 v[120:123], v[96:99], v[112:115], 0
v_add_f32 v60, v52, v53
v_add_f32 v108, v100, v101
v_add_f32 v61, v54, v55
v_add_f32 v109, v102, v103
v_add_f32 v56, v56, v57
v_add_f32 v104, v104, v105
v_add_f32 v58, v58, v59
v_add_f32 v106, v106, v107
v_add_f32 v60, v60, v61
v_add_f32 v108, v108, v109
v_add_f32 v56, v56, v58
v_add_f32 v104, v104, v106
v_add_f32 v60, v60, v56
v_add_f32 v108, v108, v104
v_mov_b32 v61, v60
v_mov_b32 v109, v108
s_nop 0
v_permlane32_swap_b32 v60, v61
v_permlane32_swap_b32 v108, v109
v_add_f32 v60, v60, v61
v_add_f32 v108, v108, v109
v_mov_b32 v61, v60
v_mov_b32 v109, v108
s_nop 0
v_permlane16_swap_b32 v60, v61
v_permlane16_swap_b32 v108, v109
v_add_f32 v60, v60, v61
v_add_f32 v108, v108, v109
v_rcp_f32 v60, v60
v_rcp_f32 v108, v108
s_nop 0
v_pk_mul_f32 v[68:69], v[60:61], v[68:69] op_sel_hi:[0,1]
v_pk_mul_f32 v[70:71], v[60:61], v[70:71] op_sel_hi:[0,1]
v_pk_mul_f32 v[72:73], v[60:61], v[72:73] op_sel_hi:[0,1]
v_pk_mul_f32 v[74:75], v[60:61], v[74:75] op_sel_hi:[0,1]
v_cvt_pk_bf16_f32 v68, v68, v69
v_cvt_pk_bf16_f32 v69, v70, v71
v_cvt_pk_bf16_f32 v70, v72, v73
v_cvt_pk_bf16_f32 v71, v74, v75
buffer_store_dwordx4 v[68:71], v27, s[16:19], 0 offen offset:0 sc1
v_pk_mul_f32 v[116:117], v[108:109], v[116:117] op_sel_hi:[0,1]
v_pk_mul_f32 v[118:119], v[108:109], v[118:119] op_sel_hi:[0,1]
v_pk_mul_f32 v[120:121], v[108:109], v[120:121] op_sel_hi:[0,1]
v_pk_mul_f32 v[122:123], v[108:109], v[122:123] op_sel_hi:[0,1]
v_cvt_pk_bf16_f32 v116, v116, v117
v_cvt_pk_bf16_f32 v117, v118, v119
v_cvt_pk_bf16_f32 v118, v120, v121
v_cvt_pk_bf16_f32 v119, v122, v123
buffer_store_dwordx4 v[116:119], v27, s[16:19], 0 offen offset:512 sc1
s_waitcnt vmcnt(0)
s_barrier
s_add_u32 s56, s32, 28311552
s_addc_u32 s57, s33, 0
s_mov_b32 s58, 16384
s_mov_b32 s59, 0x20000
s_cmp_lg_u32 s36, 0
s_cbranch_scc1 Lsig_20
s_add_u32 s43, s34, 0
s_lshl_b32 s43, s43, 7
v_mov_b32 v5, s43
v_mov_b32 v6, 1
s_mov_b64 exec, 1
buffer_atomic_add v6, v5, s[56:59], 0 offen sc1
s_mov_b64 exec, -1
Lsig_20:
s_load_dwordx4 s[4:7], s[0:1], 32
s_load_dwordx2 s[28:29], s[0:1], 16
s_load_dwordx4 s[60:63], s[0:1], 48
s_load_dwordx2 s[30:31], s[0:1], 0
v_and_b32 v17, 15, v1
v_lshrrev_b32 v18, 4, v1
s_lshr_b32 s46, s36, 1
s_and_b32 s46, s46, 1
s_and_b32 s47, s36, 1
s_and_b32 s51, s36, 3
s_waitcnt lgkmcnt(0)
s_cmp_ge_u32 s36, 4
s_cbranch_scc1 LG1_21
s_lshl_b32 s43, s34, 18
s_lshl_b32 s44, s35, 7
s_add_u32 s43, s43, s44
s_add_u32 s16, s30, s43
s_addc_u32 s17, s31, 0
s_mov_b32 s18, 260224
s_mov_b32 s19, 0x20000
s_lshl_b32 s43, s36, 5
v_lshl_add_u32 v19, v17, 1, s43
v_lshlrev_b32 v19, 11, v19
v_lshl_add_u32 v23, v18, 3, v19
buffer_load_dwordx2 v[160:161], v23, s[16:19], 0 offen offset:0
buffer_load_dwordx2 v[162:163], v23, s[16:19], 0 offen offset:32
buffer_load_dwordx2 v[164:165], v23, s[16:19], 0 offen offset:64
buffer_load_dwordx2 v[166:167], v23, s[16:19], 0 offen offset:96
buffer_load_dwordx2 v[168:169], v23, s[16:19], 0 offen offset:2048
buffer_load_dwordx2 v[170:171], v23, s[16:19], 0 offen offset:2080
buffer_load_dwordx2 v[172:173], v23, s[16:19], 0 offen offset:2112
buffer_load_dwordx2 v[174:175], v23, s[16:19], 0 offen offset:2144
v_lshlrev_b32 v19, 11, v18
v_lshl_add_u32 v19, v17, 4, v19
s_lshl_b32 s43, s36, 9
v_add_u32 v2, s43, v19
v_add_u32 v3, 49152, v2
v_add_u32 v4, 98304, v2
v_lshrrev_b32 v19, 2, v17
v_lshl_add_u32 v20, v18, 2, v19
v_bfe_u32 v21, v20, 1, 2
v_lshlrev_b32 v20, 7, v20
v_lshl_add_u32 v20, v21, 5, v20
v_and_b32 v19, 3, v1
v_lshl_add_u32 v20, v19, 3, v20
v_add_u32 v5, 16384, v20
v_xor_b32 v6, 32, v5
v_xor_b32 v7, 64, v5
v_xor_b32 v8, 96, v5
v_add_u32 v9, 49152, v5
v_add_u32 v10, 49152, v6
v_add_u32 v11, 49152, v7
v_add_u32 v12, 49152, v8
v_add_u32 v13, 98304, v5
v_add_u32 v14, 98304, v6
v_add_u32 v15, 98304, v7
v_add_u32 v16, 98304, v8
s_lshl_b32 s43, s34, 18
s_lshl_b32 s44, s35, 14
s_add_u32 s43, s43, s44
s_add_u32 s20, s32, s43
s_addc_u32 s21, s33, 0
s_add_u32 s20, s20, 4194304
s_addc_u32 s21, s21, 0
s_mov_b32 s22, 16384
s_mov_b32 s23, 0x20000
s_lshl_b32 s43, s34, 14
s_lshl_b32 s44, s35, 10
s_add_u32 s43, s43, s44
s_add_u32 s24, s32, s43
s_addc_u32 s25, s33, 0
s_add_u32 s24, s24, 25165824
s_addc_u32 s25, s25, 0
s_mov_b32 s26, 1024
s_mov_b32 s27, 0x20000
s_movk_i32 s50, 0x2000
s_mov_b32 s52, 0x3f803f80
v_lshrrev_b32 v19, 1, v18
v_lshl_add_u32 v19, v19, 4, v17
s_lshl_b32 s43, s36, 5
v_add_u32 v19, s43, v19
v_and_b32 v20, 1, v18
v_lshlrev_b32 v20, 2, v20
v_lshl_add_u32 v22, v19, 3, v20
s_waitcnt vmcnt(0)
v_lshlrev_b32 v128, 16, v160
v_and_b32 v129, 0xffff0000, v160
v_lshlrev_b32 v130, 16, v161
v_and_b32 v131, 0xffff0000, v161
v_lshlrev_b32 v132, 16, v162
v_and_b32 v133, 0xffff0000, v162
v_lshlrev_b32 v134, 16, v163
v_and_b32 v135, 0xffff0000, v163
v_lshlrev_b32 v136, 16, v164
v_and_b32 v137, 0xffff0000, v164
v_lshlrev_b32 v138, 16, v165
v_and_b32 v139, 0xffff0000, v165
v_lshlrev_b32 v140, 16, v166
v_and_b32 v141, 0xffff0000, v166
v_lshlrev_b32 v142, 16, v167
v_and_b32 v143, 0xffff0000, v167
v_lshlrev_b32 v144, 16, v168
v_and_b32 v145, 0xffff0000, v168
v_lshlrev_b32 v146, 16, v169
v_and_b32 v147, 0xffff0000, v169
v_lshlrev_b32 v148, 16, v170
v_and_b32 v149, 0xffff0000, v170
v_lshlrev_b32 v150, 16, v171
v_and_b32 v151, 0xffff0000, v171
v_lshlrev_b32 v152, 16, v172
v_and_b32 v153, 0xffff0000, v172
v_lshlrev_b32 v154, 16, v173
v_and_b32 v155, 0xffff0000, v173
v_lshlrev_b32 v156, 16, v174
v_and_b32 v157, 0xffff0000, v174
v_lshlrev_b32 v158, 16, v175
v_and_b32 v159, 0xffff0000, v175
s_lshl_b32 s43, s34, 18
s_add_u32 s12, s32, s43
s_addc_u32 s13, s33, 0
s_mov_b32 s14, 262144
s_mov_b32 s15, 0x20000
v_lshlrev_b32 v21, 4, v1
s_lshl_b32 s54, s36, 11
s_barrier
s_add_u32 m0, s54, 0
s_add_u32 s43, s54, 0
buffer_load_dwordx4 v21, s[12:15], s43 offen sc1 lds
s_add_u32 m0, s54, 1024
s_add_u32 s43, s54, 1024
buffer_load_dwordx4 v21, s[12:15], s43 offen sc1 lds
s_add_u32 m0, s54, 24576
s_add_u32 s43, s54, 16384
buffer_load_dwordx4 v21, s[12:15], s43 offen sc1 lds
s_add_u32 m0, s54, 25600
s_add_u32 s43, s54, 17408
buffer_load_dwordx4 v21, s[12:15], s43 offen sc1 lds
s_waitcnt vmcnt(2)
s_barrier
ds_read_b128 v[32:35], v2 offset:0
ds_read_b64_tr_b16 v[48:49], v5 offset:0
ds_read_b64_tr_b16 v[50:51], v5 offset:2048
ds_read_b64_tr_b16 v[52:53], v6 offset:0
ds_read_b64_tr_b16 v[54:55], v6 offset:2048
ds_read_b128 v[36:39], v2 offset:256
ds_read_b64_tr_b16 v[56:57], v7 offset:0
ds_read_b64_tr_b16 v[58:59], v7 offset:2048
ds_read_b64_tr_b16 v[60:61], v8 offset:0
ds_read_b64_tr_b16 v[62:63], v8 offset:2048
ds_read_b128 v[40:43], v2 offset:8192
ds_read_b64_tr_b16 v[64:65], v5 offset:4096
ds_read_b64_tr_b16 v[66:67], v5 offset:6144
ds_read_b64_tr_b16 v[68:69], v6 offset:4096
ds_read_b64_tr_b16 v[70:71], v6 offset:6144
ds_read_b128 v[44:47], v2 offset:8448
ds_read_b64_tr_b16 v[72:73], v7 offset:4096
ds_read_b64_tr_b16 v[74:75], v7 offset:6144
ds_read_b64_tr_b16 v[76:77], v8 offset:4096
ds_read_b64_tr_b16 v[78:79], v8 offset:6144
s_waitcnt vmcnt(0) lgkmcnt(0)
s_barrier
v_mfma_f32_16x16x32_bf16 v[128:131], v[48:51], v[32:35], v[128:131]
ds_read_b128 v[80:83], v2 offset:24576
ds_read_b64_tr_b16 v[96:97], v5 offset:24576
v_mfma_f32_16x16x32_bf16 v[132:135], v[52:55], v[32:35], v[132:135]
ds_read_b64_tr_b16 v[98:99], v5 offset:26624
ds_read_b64_tr_b16 v[100:101], v6 offset:24576
v_mfma_f32_16x16x32_bf16 v[136:139], v[56:59], v[32:35], v[136:139]
ds_read_b64_tr_b16 v[102:103], v6 offset:26624
ds_read_b128 v[84:87], v2 offset:24832
v_mfma_f32_16x16x32_bf16 v[140:143], v[60:63], v[32:35], v[140:143]
ds_read_b64_tr_b16 v[104:105], v7 offset:24576
ds_read_b64_tr_b16 v[106:107], v7 offset:26624
v_mfma_f32_16x16x32_bf16 v[144:147], v[48:51], v[36:39], v[144:147]
ds_read_b64_tr_b16 v[108:109], v8 offset:24576
ds_read_b64_tr_b16 v[110:111], v8 offset:26624
v_mfma_f32_16x16x32_bf16 v[148:151], v[52:55], v[36:39], v[148:151]
ds_read_b128 v[88:91], v2 offset:32768
ds_read_b64_tr_b16 v[112:113], v5 offset:28672
v_mfma_f32_16x16x32_bf16 v[152:155], v[56:59], v[36:39], v[152:155]
ds_read_b64_tr_b16 v[114:115], v5 offset:30720
v_mfma_f32_16x16x32_bf16 v[156:159], v[60:63], v[36:39], v[156:159]
ds_read_b64_tr_b16 v[116:117], v6 offset:28672
v_mfma_f32_16x16x32_bf16 v[128:131], v[64:67], v[40:43], v[128:131]
ds_read_b64_tr_b16 v[118:119], v6 offset:30720
v_mfma_f32_16x16x32_bf16 v[132:135], v[68:71], v[40:43], v[132:135]
ds_read_b128 v[92:95], v2 offset:33024
v_mfma_f32_16x16x32_bf16 v[136:139], v[72:75], v[40:43], v[136:139]
ds_read_b64_tr_b16 v[120:121], v7 offset:28672
v_mfma_f32_16x16x32_bf16 v[140:143], v[76:79], v[40:43], v[140:143]
ds_read_b64_tr_b16 v[122:123], v7 offset:30720
v_mfma_f32_16x16x32_bf16 v[144:147], v[64:67], v[44:47], v[144:147]
ds_read_b64_tr_b16 v[124:125], v8 offset:28672
v_mfma_f32_16x16x32_bf16 v[148:151], v[68:71], v[44:47], v[148:151]
ds_read_b64_tr_b16 v[126:127], v8 offset:30720
v_mfma_f32_16x16x32_bf16 v[152:155], v[72:75], v[44:47], v[152:155]
v_mfma_f32_16x16x32_bf16 v[156:159], v[76:79], v[44:47], v[156:159]
s_waitcnt lgkmcnt(0)
s_barrier
v_mfma_f32_16x16x32_bf16 v[128:131], v[96:99], v[80:83], v[128:131]
ds_read_b128 v[32:35], v3 offset:0
ds_read_b64_tr_b16 v[48:49], v9 offset:0
v_mfma_f32_16x16x32_bf16 v[132:135], v[100:103], v[80:83], v[132:135]
ds_read_b64_tr_b16 v[50:51], v9 offset:2048
ds_read_b64_tr_b16 v[52:53], v10 offset:0
v_mfma_f32_16x16x32_bf16 v[136:139], v[104:107], v[80:83], v[136:139]
ds_read_b64_tr_b16 v[54:55], v10 offset:2048
ds_read_b128 v[36:39], v3 offset:256
v_mfma_f32_16x16x32_bf16 v[140:143], v[108:111], v[80:83], v[140:143]
ds_read_b64_tr_b16 v[56:57], v11 offset:0
ds_read_b64_tr_b16 v[58:59], v11 offset:2048
v_mfma_f32_16x16x32_bf16 v[144:147], v[96:99], v[84:87], v[144:147]
ds_read_b64_tr_b16 v[60:61], v12 offset:0
ds_read_b64_tr_b16 v[62:63], v12 offset:2048
v_mfma_f32_16x16x32_bf16 v[148:151], v[100:103], v[84:87], v[148:151]
ds_read_b128 v[40:43], v3 offset:8192
ds_read_b64_tr_b16 v[64:65], v9 offset:4096
v_mfma_f32_16x16x32_bf16 v[152:155], v[104:107], v[84:87], v[152:155]
ds_read_b64_tr_b16 v[66:67], v9 offset:6144
v_mfma_f32_16x16x32_bf16 v[156:159], v[108:111], v[84:87], v[156:159]
ds_read_b64_tr_b16 v[68:69], v10 offset:4096
v_mfma_f32_16x16x32_bf16 v[128:131], v[112:115], v[88:91], v[128:131]
ds_read_b64_tr_b16 v[70:71], v10 offset:6144
v_mfma_f32_16x16x32_bf16 v[132:135], v[116:119], v[88:91], v[132:135]
ds_read_b128 v[44:47], v3 offset:8448
v_mfma_f32_16x16x32_bf16 v[136:139], v[120:123], v[88:91], v[136:139]
ds_read_b64_tr_b16 v[72:73], v11 offset:4096
v_mfma_f32_16x16x32_bf16 v[140:143], v[124:127], v[88:91], v[140:143]
ds_read_b64_tr_b16 v[74:75], v11 offset:6144
v_mfma_f32_16x16x32_bf16 v[144:147], v[112:115], v[92:95], v[144:147]
ds_read_b64_tr_b16 v[76:77], v12 offset:4096
v_mfma_f32_16x16x32_bf16 v[148:151], v[116:119], v[92:95], v[148:151]
ds_read_b64_tr_b16 v[78:79], v12 offset:6144
v_mfma_f32_16x16x32_bf16 v[152:155], v[120:123], v[92:95], v[152:155]
v_mfma_f32_16x16x32_bf16 v[156:159], v[124:127], v[92:95], v[156:159]
s_mov_b32 s41, 2
Lg2_22:
s_waitcnt lgkmcnt(0)
s_barrier
v_mfma_f32_16x16x32_bf16 v[128:131], v[48:51], v[32:35], v[128:131]
ds_read_b128 v[80:83], v3 offset:24576
ds_read_b64_tr_b16 v[96:97], v9 offset:24576
v_mfma_f32_16x16x32_bf16 v[132:135], v[52:55], v[32:35], v[132:135]
ds_read_b64_tr_b16 v[98:99], v9 offset:26624
ds_read_b64_tr_b16 v[100:101], v10 offset:24576
v_mfma_f32_16x16x32_bf16 v[136:139], v[56:59], v[32:35], v[136:139]
ds_read_b64_tr_b16 v[102:103], v10 offset:26624
ds_read_b128 v[84:87], v3 offset:24832
v_mfma_f32_16x16x32_bf16 v[140:143], v[60:63], v[32:35], v[140:143]
ds_read_b64_tr_b16 v[104:105], v11 offset:24576
ds_read_b64_tr_b16 v[106:107], v11 offset:26624
v_mfma_f32_16x16x32_bf16 v[144:147], v[48:51], v[36:39], v[144:147]
ds_read_b64_tr_b16 v[108:109], v12 offset:24576
ds_read_b64_tr_b16 v[110:111], v12 offset:26624
v_mfma_f32_16x16x32_bf16 v[148:151], v[52:55], v[36:39], v[148:151]
ds_read_b128 v[88:91], v3 offset:32768
ds_read_b64_tr_b16 v[112:113], v9 offset:28672
v_mfma_f32_16x16x32_bf16 v[152:155], v[56:59], v[36:39], v[152:155]
ds_read_b64_tr_b16 v[114:115], v9 offset:30720
v_mfma_f32_16x16x32_bf16 v[156:159], v[60:63], v[36:39], v[156:159]
ds_read_b64_tr_b16 v[116:117], v10 offset:28672
v_mfma_f32_16x16x32_bf16 v[128:131], v[64:67], v[40:43], v[128:131]
ds_read_b64_tr_b16 v[118:119], v10 offset:30720
v_mfma_f32_16x16x32_bf16 v[132:135], v[68:71], v[40:43], v[132:135]
ds_read_b128 v[92:95], v3 offset:33024
v_mfma_f32_16x16x32_bf16 v[136:139], v[72:75], v[40:43], v[136:139]
ds_read_b64_tr_b16 v[120:121], v11 offset:28672
v_mfma_f32_16x16x32_bf16 v[140:143], v[76:79], v[40:43], v[140:143]
ds_read_b64_tr_b16 v[122:123], v11 offset:30720
v_mfma_f32_16x16x32_bf16 v[144:147], v[64:67], v[44:47], v[144:147]
ds_read_b64_tr_b16 v[124:125], v12 offset:28672
v_mfma_f32_16x16x32_bf16 v[148:151], v[68:71], v[44:47], v[148:151]
ds_read_b64_tr_b16 v[126:127], v12 offset:30720
v_mfma_f32_16x16x32_bf16 v[152:155], v[72:75], v[44:47], v[152:155]
v_mfma_f32_16x16x32_bf16 v[156:159], v[76:79], v[44:47], v[156:159]
s_waitcnt lgkmcnt(0)
s_barrier
v_mfma_f32_16x16x32_bf16 v[128:131], v[96:99], v[80:83], v[128:131]
ds_read_b128 v[32:35], v4 offset:0
ds_read_b64_tr_b16 v[48:49], v13 offset:0
v_mfma_f32_16x16x32_bf16 v[132:135], v[100:103], v[80:83], v[132:135]
ds_read_b64_tr_b16 v[50:51], v13 offset:2048
ds_read_b64_tr_b16 v[52:53], v14 offset:0
v_mfma_f32_16x16x32_bf16 v[136:139], v[104:107], v[80:83], v[136:139]
ds_read_b64_tr_b16 v[54:55], v14 offset:2048
ds_read_b128 v[36:39], v4 offset:256
v_mfma_f32_16x16x32_bf16 v[140:143], v[108:111], v[80:83], v[140:143]
ds_read_b64_tr_b16 v[56:57], v15 offset:0
ds_read_b64_tr_b16 v[58:59], v15 offset:2048
v_mfma_f32_16x16x32_bf16 v[144:147], v[96:99], v[84:87], v[144:147]
ds_read_b64_tr_b16 v[60:61], v16 offset:0
ds_read_b64_tr_b16 v[62:63], v16 offset:2048
v_mfma_f32_16x16x32_bf16 v[148:151], v[100:103], v[84:87], v[148:151]
ds_read_b128 v[40:43], v4 offset:8192
ds_read_b64_tr_b16 v[64:65], v13 offset:4096
v_mfma_f32_16x16x32_bf16 v[152:155], v[104:107], v[84:87], v[152:155]
ds_read_b64_tr_b16 v[66:67], v13 offset:6144
v_mfma_f32_16x16x32_bf16 v[156:159], v[108:111], v[84:87], v[156:159]
ds_read_b64_tr_b16 v[68:69], v14 offset:4096
v_mfma_f32_16x16x32_bf16 v[128:131], v[112:115], v[88:91], v[128:131]
ds_read_b64_tr_b16 v[70:71], v14 offset:6144
v_mfma_f32_16x16x32_bf16 v[132:135], v[116:119], v[88:91], v[132:135]
ds_read_b128 v[44:47], v4 offset:8448
v_mfma_f32_16x16x32_bf16 v[136:139], v[120:123], v[88:91], v[136:139]
ds_read_b64_tr_b16 v[72:73], v15 offset:4096
v_mfma_f32_16x16x32_bf16 v[140:143], v[124:127], v[88:91], v[140:143]
ds_read_b64_tr_b16 v[74:75], v15 offset:6144
v_mfma_f32_16x16x32_bf16 v[144:147], v[112:115], v[92:95], v[144:147]
ds_read_b64_tr_b16 v[76:77], v16 offset:4096
v_mfma_f32_16x16x32_bf16 v[148:151], v[116:119], v[92:95], v[148:151]
ds_read_b64_tr_b16 v[78:79], v16 offset:6144
v_mfma_f32_16x16x32_bf16 v[152:155], v[120:123], v[92:95], v[152:155]
v_mfma_f32_16x16x32_bf16 v[156:159], v[124:127], v[92:95], v[156:159]
s_waitcnt lgkmcnt(0)
s_barrier
v_mfma_f32_16x16x32_bf16 v[128:131], v[48:51], v[32:35], v[128:131]
ds_read_b128 v[80:83], v4 offset:24576
ds_read_b64_tr_b16 v[96:97], v13 offset:24576
v_mfma_f32_16x16x32_bf16 v[132:135], v[52:55], v[32:35], v[132:135]
ds_read_b64_tr_b16 v[98:99], v13 offset:26624
ds_read_b64_tr_b16 v[100:101], v14 offset:24576
v_mfma_f32_16x16x32_bf16 v[136:139], v[56:59], v[32:35], v[136:139]
ds_read_b64_tr_b16 v[102:103], v14 offset:26624
ds_read_b128 v[84:87], v4 offset:24832
v_mfma_f32_16x16x32_bf16 v[140:143], v[60:63], v[32:35], v[140:143]
ds_read_b64_tr_b16 v[104:105], v15 offset:24576
ds_read_b64_tr_b16 v[106:107], v15 offset:26624
v_mfma_f32_16x16x32_bf16 v[144:147], v[48:51], v[36:39], v[144:147]
ds_read_b64_tr_b16 v[108:109], v16 offset:24576
ds_read_b64_tr_b16 v[110:111], v16 offset:26624
v_mfma_f32_16x16x32_bf16 v[148:151], v[52:55], v[36:39], v[148:151]
ds_read_b128 v[88:91], v4 offset:32768
ds_read_b64_tr_b16 v[112:113], v13 offset:28672
v_mfma_f32_16x16x32_bf16 v[152:155], v[56:59], v[36:39], v[152:155]
ds_read_b64_tr_b16 v[114:115], v13 offset:30720
v_mfma_f32_16x16x32_bf16 v[156:159], v[60:63], v[36:39], v[156:159]
ds_read_b64_tr_b16 v[116:117], v14 offset:28672
v_mfma_f32_16x16x32_bf16 v[128:131], v[64:67], v[40:43], v[128:131]
ds_read_b64_tr_b16 v[118:119], v14 offset:30720
v_mfma_f32_16x16x32_bf16 v[132:135], v[68:71], v[40:43], v[132:135]
ds_read_b128 v[92:95], v4 offset:33024
v_mfma_f32_16x16x32_bf16 v[136:139], v[72:75], v[40:43], v[136:139]
ds_read_b64_tr_b16 v[120:121], v15 offset:28672
v_mfma_f32_16x16x32_bf16 v[140:143], v[76:79], v[40:43], v[140:143]
ds_read_b64_tr_b16 v[122:123], v15 offset:30720
v_mfma_f32_16x16x32_bf16 v[144:147], v[64:67], v[44:47], v[144:147]
ds_read_b64_tr_b16 v[124:125], v16 offset:28672
v_mfma_f32_16x16x32_bf16 v[148:151], v[68:71], v[44:47], v[148:151]
ds_read_b64_tr_b16 v[126:127], v16 offset:30720
v_mfma_f32_16x16x32_bf16 v[152:155], v[72:75], v[44:47], v[152:155]
v_mfma_f32_16x16x32_bf16 v[156:159], v[76:79], v[44:47], v[156:159]
s_waitcnt lgkmcnt(0)
s_barrier
v_mfma_f32_16x16x32_bf16 v[128:131], v[96:99], v[80:83], v[128:131]
ds_read_b128 v[32:35], v2 offset:0
ds_read_b64_tr_b16 v[48:49], v5 offset:0
v_mfma_f32_16x16x32_bf16 v[132:135], v[100:103], v[80:83], v[132:135]
ds_read_b64_tr_b16 v[50:51], v5 offset:2048
ds_read_b64_tr_b16 v[52:53], v6 offset:0
v_mfma_f32_16x16x32_bf16 v[136:139], v[104:107], v[80:83], v[136:139]
ds_read_b64_tr_b16 v[54:55], v6 offset:2048
ds_read_b128 v[36:39], v2 offset:256
v_mfma_f32_16x16x32_bf16 v[140:143], v[108:111], v[80:83], v[140:143]
ds_read_b64_tr_b16 v[56:57], v7 offset:0
ds_read_b64_tr_b16 v[58:59], v7 offset:2048
v_mfma_f32_16x16x32_bf16 v[144:147], v[96:99], v[84:87], v[144:147]
ds_read_b64_tr_b16 v[60:61], v8 offset:0
ds_read_b64_tr_b16 v[62:63], v8 offset:2048
v_mfma_f32_16x16x32_bf16 v[148:151], v[100:103], v[84:87], v[148:151]
ds_read_b128 v[40:43], v2 offset:8192
ds_read_b64_tr_b16 v[64:65], v5 offset:4096
v_mfma_f32_16x16x32_bf16 v[152:155], v[104:107], v[84:87], v[152:155]
ds_read_b64_tr_b16 v[66:67], v5 offset:6144
v_mfma_f32_16x16x32_bf16 v[156:159], v[108:111], v[84:87], v[156:159]
ds_read_b64_tr_b16 v[68:69], v6 offset:4096
v_mfma_f32_16x16x32_bf16 v[128:131], v[112:115], v[88:91], v[128:131]
ds_read_b64_tr_b16 v[70:71], v6 offset:6144
v_mfma_f32_16x16x32_bf16 v[132:135], v[116:119], v[88:91], v[132:135]
ds_read_b128 v[44:47], v2 offset:8448
v_mfma_f32_16x16x32_bf16 v[136:139], v[120:123], v[88:91], v[136:139]
ds_read_b64_tr_b16 v[72:73], v7 offset:4096
v_mfma_f32_16x16x32_bf16 v[140:143], v[124:127], v[88:91], v[140:143]
ds_read_b64_tr_b16 v[74:75], v7 offset:6144
v_mfma_f32_16x16x32_bf16 v[144:147], v[112:115], v[92:95], v[144:147]
ds_read_b64_tr_b16 v[76:77], v8 offset:4096
v_mfma_f32_16x16x32_bf16 v[148:151], v[116:119], v[92:95], v[148:151]
ds_read_b64_tr_b16 v[78:79], v8 offset:6144
v_mfma_f32_16x16x32_bf16 v[152:155], v[120:123], v[92:95], v[152:155]
v_mfma_f32_16x16x32_bf16 v[156:159], v[124:127], v[92:95], v[156:159]
s_waitcnt lgkmcnt(0)
s_barrier
v_mfma_f32_16x16x32_bf16 v[128:131], v[48:51], v[32:35], v[128:131]
ds_read_b128 v[80:83], v2 offset:24576
ds_read_b64_tr_b16 v[96:97], v5 offset:24576
v_mfma_f32_16x16x32_bf16 v[132:135], v[52:55], v[32:35], v[132:135]
ds_read_b64_tr_b16 v[98:99], v5 offset:26624
ds_read_b64_tr_b16 v[100:101], v6 offset:24576
v_mfma_f32_16x16x32_bf16 v[136:139], v[56:59], v[32:35], v[136:139]
ds_read_b64_tr_b16 v[102:103], v6 offset:26624
ds_read_b128 v[84:87], v2 offset:24832
v_mfma_f32_16x16x32_bf16 v[140:143], v[60:63], v[32:35], v[140:143]
ds_read_b64_tr_b16 v[104:105], v7 offset:24576
ds_read_b64_tr_b16 v[106:107], v7 offset:26624
v_mfma_f32_16x16x32_bf16 v[144:147], v[48:51], v[36:39], v[144:147]
ds_read_b64_tr_b16 v[108:109], v8 offset:24576
ds_read_b64_tr_b16 v[110:111], v8 offset:26624
v_mfma_f32_16x16x32_bf16 v[148:151], v[52:55], v[36:39], v[148:151]
ds_read_b128 v[88:91], v2 offset:32768
ds_read_b64_tr_b16 v[112:113], v5 offset:28672
v_mfma_f32_16x16x32_bf16 v[152:155], v[56:59], v[36:39], v[152:155]
ds_read_b64_tr_b16 v[114:115], v5 offset:30720
v_mfma_f32_16x16x32_bf16 v[156:159], v[60:63], v[36:39], v[156:159]
ds_read_b64_tr_b16 v[116:117], v6 offset:28672
v_mfma_f32_16x16x32_bf16 v[128:131], v[64:67], v[40:43], v[128:131]
ds_read_b64_tr_b16 v[118:119], v6 offset:30720
v_mfma_f32_16x16x32_bf16 v[132:135], v[68:71], v[40:43], v[132:135]
ds_read_b128 v[92:95], v2 offset:33024
v_mfma_f32_16x16x32_bf16 v[136:139], v[72:75], v[40:43], v[136:139]
ds_read_b64_tr_b16 v[120:121], v7 offset:28672
v_mfma_f32_16x16x32_bf16 v[140:143], v[76:79], v[40:43], v[140:143]
ds_read_b64_tr_b16 v[122:123], v7 offset:30720
v_mfma_f32_16x16x32_bf16 v[144:147], v[64:67], v[44:47], v[144:147]
ds_read_b64_tr_b16 v[124:125], v8 offset:28672
v_mfma_f32_16x16x32_bf16 v[148:151], v[68:71], v[44:47], v[148:151]
ds_read_b64_tr_b16 v[126:127], v8 offset:30720
v_mfma_f32_16x16x32_bf16 v[152:155], v[72:75], v[44:47], v[152:155]
v_mfma_f32_16x16x32_bf16 v[156:159], v[76:79], v[44:47], v[156:159]
s_waitcnt lgkmcnt(0)
s_barrier
v_mfma_f32_16x16x32_bf16 v[128:131], v[96:99], v[80:83], v[128:131]
ds_read_b128 v[32:35], v3 offset:0
ds_read_b64_tr_b16 v[48:49], v9 offset:0
v_mfma_f32_16x16x32_bf16 v[132:135], v[100:103], v[80:83], v[132:135]
ds_read_b64_tr_b16 v[50:51], v9 offset:2048
ds_read_b64_tr_b16 v[52:53], v10 offset:0
v_mfma_f32_16x16x32_bf16 v[136:139], v[104:107], v[80:83], v[136:139]
ds_read_b64_tr_b16 v[54:55], v10 offset:2048
ds_read_b128 v[36:39], v3 offset:256
v_mfma_f32_16x16x32_bf16 v[140:143], v[108:111], v[80:83], v[140:143]
ds_read_b64_tr_b16 v[56:57], v11 offset:0
ds_read_b64_tr_b16 v[58:59], v11 offset:2048
v_mfma_f32_16x16x32_bf16 v[144:147], v[96:99], v[84:87], v[144:147]
ds_read_b64_tr_b16 v[60:61], v12 offset:0
ds_read_b64_tr_b16 v[62:63], v12 offset:2048
v_mfma_f32_16x16x32_bf16 v[148:151], v[100:103], v[84:87], v[148:151]
ds_read_b128 v[40:43], v3 offset:8192
ds_read_b64_tr_b16 v[64:65], v9 offset:4096
v_mfma_f32_16x16x32_bf16 v[152:155], v[104:107], v[84:87], v[152:155]
ds_read_b64_tr_b16 v[66:67], v9 offset:6144
v_mfma_f32_16x16x32_bf16 v[156:159], v[108:111], v[84:87], v[156:159]
ds_read_b64_tr_b16 v[68:69], v10 offset:4096
v_mfma_f32_16x16x32_bf16 v[128:131], v[112:115], v[88:91], v[128:131]
ds_read_b64_tr_b16 v[70:71], v10 offset:6144
v_mfma_f32_16x16x32_bf16 v[132:135], v[116:119], v[88:91], v[132:135]
ds_read_b128 v[44:47], v3 offset:8448
v_mfma_f32_16x16x32_bf16 v[136:139], v[120:123], v[88:91], v[136:139]
ds_read_b64_tr_b16 v[72:73], v11 offset:4096
v_mfma_f32_16x16x32_bf16 v[140:143], v[124:127], v[88:91], v[140:143]
ds_read_b64_tr_b16 v[74:75], v11 offset:6144
v_mfma_f32_16x16x32_bf16 v[144:147], v[112:115], v[92:95], v[144:147]
ds_read_b64_tr_b16 v[76:77], v12 offset:4096
v_mfma_f32_16x16x32_bf16 v[148:151], v[116:119], v[92:95], v[148:151]
ds_read_b64_tr_b16 v[78:79], v12 offset:6144
v_mfma_f32_16x16x32_bf16 v[152:155], v[120:123], v[92:95], v[152:155]
v_mfma_f32_16x16x32_bf16 v[156:159], v[124:127], v[92:95], v[156:159]
s_sub_u32 s41, s41, 1
s_cmp_lg_u32 s41, 0
s_cbranch_scc1 Lg2_22
s_waitcnt lgkmcnt(0)
s_barrier
v_mfma_f32_16x16x32_bf16 v[128:131], v[48:51], v[32:35], v[128:131]
ds_read_b128 v[80:83], v3 offset:24576
ds_read_b64_tr_b16 v[96:97], v9 offset:24576
v_mfma_f32_16x16x32_bf16 v[132:135], v[52:55], v[32:35], v[132:135]
ds_read_b64_tr_b16 v[98:99], v9 offset:26624
ds_read_b64_tr_b16 v[100:101], v10 offset:24576
v_mfma_f32_16x16x32_bf16 v[136:139], v[56:59], v[32:35], v[136:139]
ds_read_b64_tr_b16 v[102:103], v10 offset:26624
ds_read_b128 v[84:87], v3 offset:24832
v_mfma_f32_16x16x32_bf16 v[140:143], v[60:63], v[32:35], v[140:143]
ds_read_b64_tr_b16 v[104:105], v11 offset:24576
ds_read_b64_tr_b16 v[106:107], v11 offset:26624
v_mfma_f32_16x16x32_bf16 v[144:147], v[48:51], v[36:39], v[144:147]
ds_read_b64_tr_b16 v[108:109], v12 offset:24576
ds_read_b64_tr_b16 v[110:111], v12 offset:26624
v_mfma_f32_16x16x32_bf16 v[148:151], v[52:55], v[36:39], v[148:151]
ds_read_b128 v[88:91], v3 offset:32768
ds_read_b64_tr_b16 v[112:113], v9 offset:28672
v_mfma_f32_16x16x32_bf16 v[152:155], v[56:59], v[36:39], v[152:155]
ds_read_b64_tr_b16 v[114:115], v9 offset:30720
v_mfma_f32_16x16x32_bf16 v[156:159], v[60:63], v[36:39], v[156:159]
ds_read_b64_tr_b16 v[116:117], v10 offset:28672
v_mfma_f32_16x16x32_bf16 v[128:131], v[64:67], v[40:43], v[128:131]
ds_read_b64_tr_b16 v[118:119], v10 offset:30720
v_mfma_f32_16x16x32_bf16 v[132:135], v[68:71], v[40:43], v[132:135]
ds_read_b128 v[92:95], v3 offset:33024
v_mfma_f32_16x16x32_bf16 v[136:139], v[72:75], v[40:43], v[136:139]
ds_read_b64_tr_b16 v[120:121], v11 offset:28672
v_mfma_f32_16x16x32_bf16 v[140:143], v[76:79], v[40:43], v[140:143]
ds_read_b64_tr_b16 v[122:123], v11 offset:30720
v_mfma_f32_16x16x32_bf16 v[144:147], v[64:67], v[44:47], v[144:147]
ds_read_b64_tr_b16 v[124:125], v12 offset:28672
v_mfma_f32_16x16x32_bf16 v[148:151], v[68:71], v[44:47], v[148:151]
ds_read_b64_tr_b16 v[126:127], v12 offset:30720
v_mfma_f32_16x16x32_bf16 v[152:155], v[72:75], v[44:47], v[152:155]
v_mfma_f32_16x16x32_bf16 v[156:159], v[76:79], v[44:47], v[156:159]
s_waitcnt lgkmcnt(0)
s_barrier
v_mfma_f32_16x16x32_bf16 v[128:131], v[96:99], v[80:83], v[128:131]
v_mfma_f32_16x16x32_bf16 v[132:135], v[100:103], v[80:83], v[132:135]
v_mfma_f32_16x16x32_bf16 v[136:139], v[104:107], v[80:83], v[136:139]
v_mfma_f32_16x16x32_bf16 v[140:143], v[108:111], v[80:83], v[140:143]
v_mfma_f32_16x16x32_bf16 v[144:147], v[96:99], v[84:87], v[144:147]
v_mfma_f32_16x16x32_bf16 v[148:151], v[100:103], v[84:87], v[148:151]
v_mfma_f32_16x16x32_bf16 v[152:155], v[104:107], v[84:87], v[152:155]
v_mfma_f32_16x16x32_bf16 v[156:159], v[108:111], v[84:87], v[156:159]
v_mfma_f32_16x16x32_bf16 v[128:131], v[112:115], v[88:91], v[128:131]
v_mfma_f32_16x16x32_bf16 v[132:135], v[116:119], v[88:91], v[132:135]
v_mfma_f32_16x16x32_bf16 v[136:139], v[120:123], v[88:91], v[136:139]
v_mfma_f32_16x16x32_bf16 v[140:143], v[124:127], v[88:91], v[140:143]
v_mfma_f32_16x16x32_bf16 v[144:147], v[112:115], v[92:95], v[144:147]
v_mfma_f32_16x16x32_bf16 v[148:151], v[116:119], v[92:95], v[148:151]
v_mfma_f32_16x16x32_bf16 v[152:155], v[120:123], v[92:95], v[152:155]
v_mfma_f32_16x16x32_bf16 v[156:159], v[124:127], v[92:95], v[156:159]
s_nop 4
v_cvt_pk_bf16_f32 v96, v128, v129
v_cvt_pk_bf16_f32 v97, v130, v131
v_cvt_pk_bf16_f32 v98, v132, v133
v_cvt_pk_bf16_f32 v99, v134, v135
buffer_store_dwordx4 v[96:99], v2, s[20:23], 0 offen offset:0 sc1
ds_write_b128 v4, v[96:99] offset:0
v_cvt_pk_bf16_f32 v100, v136, v137
v_cvt_pk_bf16_f32 v101, v138, v139
v_cvt_pk_bf16_f32 v102, v140, v141
v_cvt_pk_bf16_f32 v103, v142, v143
buffer_store_dwordx4 v[100:103], v2, s[20:23], s50 offen offset:0 sc1
ds_write_b128 v4, v[100:103] offset:8192
v_cvt_pk_bf16_f32 v104, v144, v145
v_cvt_pk_bf16_f32 v105, v146, v147
v_cvt_pk_bf16_f32 v106, v148, v149
v_cvt_pk_bf16_f32 v107, v150, v151
buffer_store_dwordx4 v[104:107], v2, s[20:23], 0 offen offset:256 sc1
ds_write_b128 v4, v[104:107] offset:256
v_cvt_pk_bf16_f32 v108, v152, v153
v_cvt_pk_bf16_f32 v109, v154, v155
v_cvt_pk_bf16_f32 v110, v156, v157
v_cvt_pk_bf16_f32 v111, v158, v159
buffer_store_dwordx4 v[108:111], v2, s[20:23], s50 offen offset:256 sc1
ds_write_b128 v4, v[108:111] offset:8448
v_dot2_f32_bf16 v112, v96, s52, 0
v_dot2_f32_bf16 v113, v96, v96, 0
v_dot2_f32_bf16 v114, v104, s52, 0
v_dot2_f32_bf16 v115, v104, v104, 0
v_dot2_f32_bf16 v112, v97, s52, v112
v_dot2_f32_bf16 v113, v97, v97, v113
v_dot2_f32_bf16 v114, v105, s52, v114
v_dot2_f32_bf16 v115, v105, v105, v115
v_dot2_f32_bf16 v112, v98, s52, v112
v_dot2_f32_bf16 v113, v98, v98, v113
v_dot2_f32_bf16 v114, v106, s52, v114
v_dot2_f32_bf16 v115, v106, v106, v115
v_dot2_f32_bf16 v112, v99, s52, v112
v_dot2_f32_bf16 v113, v99, v99, v113
v_dot2_f32_bf16 v114, v107, s52, v114
v_dot2_f32_bf16 v115, v107, v107, v115
v_dot2_f32_bf16 v112, v100, s52, v112
v_dot2_f32_bf16 v113, v100, v100, v113
v_dot2_f32_bf16 v114, v108, s52, v114
v_dot2_f32_bf16 v115, v108, v108, v115
v_dot2_f32_bf16 v112, v101, s52, v112
v_dot2_f32_bf16 v113, v101, v101, v113
v_dot2_f32_bf16 v114, v109, s52, v114
v_dot2_f32_bf16 v115, v109, v109, v115
v_dot2_f32_bf16 v112, v102, s52, v112
v_dot2_f32_bf16 v113, v102, v102, v113
v_dot2_f32_bf16 v114, v110, s52, v114
v_dot2_f32_bf16 v115, v110, v110, v115
v_dot2_f32_bf16 v112, v103, s52, v112
v_dot2_f32_bf16 v113, v103, v103, v113
v_dot2_f32_bf16 v114, v111, s52, v114
v_dot2_f32_bf16 v115, v111, v111, v115
s_nop 2
v_permlane32_swap_b32 v112, v114
v_permlane32_swap_b32 v113, v115
v_add_f32 v112, v112, v114
v_add_f32 v113, v113, v115
s_nop 1
v_permlane16_swap_b32 v112, v113
v_add_f32 v112, v112, v113
buffer_store_dword v112, v22, s[24:27], 0 offen sc1
s_waitcnt vmcnt(0) lgkmcnt(0)
s_barrier
s_cmp_lg_u32 s36, 0
s_cbranch_scc1 Lsig_23
s_add_u32 s43, s34, 16
s_lshl_b32 s43, s43, 7
v_mov_b32 v19, s43
v_mov_b32 v20, 1
s_mov_b64 exec, 1
buffer_atomic_add v20, v19, s[56:59], 0 offen sc1
s_mov_b64 exec, -1
Lsig_23:
s_lshl_b32 s53, s47, 2
v_lshlrev_b32 v19, 11, v18
v_lshl_add_u32 v19, v17, 4, v19
s_lshl_b32 s43, s46, 10
v_add_u32 v2, s43, v19
v_add_u32 v3, 49152, v2
v_add_u32 v4, 98304, v2
v_lshrrev_b32 v19, 2, v17
v_lshl_add_u32 v20, v18, 2, v19
v_and_b32 v21, 7, v20
v_lshlrev_b32 v20, 8, v20
v_and_b32 v19, 3, v1
v_lshl_add_u32 v20, v19, 3, v20
s_add_u32 s43, s53, 0
v_xor_b32 v19, s43, v21
v_lshl_add_u32 v5, v19, 5, v20
s_add_u32 s43, s53, 1
v_xor_b32 v19, s43, v21
v_lshl_add_u32 v6, v19, 5, v20
s_add_u32 s43, s53, 2
v_xor_b32 v19, s43, v21
v_lshl_add_u32 v7, v19, 5, v20
s_add_u32 s43, s53, 3
v_xor_b32 v19, s43, v21
v_lshl_add_u32 v8, v19, 5, v20
v_add_u32 v9, 49152, v5
v_add_u32 v10, 49152, v6
v_add_u32 v11, 49152, v7
v_add_u32 v12, 49152, v8
v_add_u32 v13, 98304, v5
v_add_u32 v14, 98304, v6
v_add_u32 v15, 98304, v7
v_add_u32 v16, 98304, v8
v_mov_b32 v128, 0
v_mov_b32 v129, 0
v_mov_b32 v130, 0
v_mov_b32 v131, 0
v_mov_b32 v132, 0
v_mov_b32 v133, 0
v_mov_b32 v134, 0
v_mov_b32 v135, 0
v_mov_b32 v136, 0
v_mov_b32 v137, 0
v_mov_b32 v138, 0
v_mov_b32 v139, 0
v_mov_b32 v140, 0
v_mov_b32 v141, 0
v_mov_b32 v142, 0
v_mov_b32 v143, 0
v_mov_b32 v144, 0
v_mov_b32 v145, 0
v_mov_b32 v146, 0
v_mov_b32 v147, 0
v_mov_b32 v148, 0
v_mov_b32 v149, 0
v_mov_b32 v150, 0
v_mov_b32 v151, 0
v_mov_b32 v152, 0
v_mov_b32 v153, 0
v_mov_b32 v154, 0
v_mov_b32 v155, 0
v_mov_b32 v156, 0
v_mov_b32 v157, 0
v_mov_b32 v158, 0
v_mov_b32 v159, 0
v_mov_b32 v160, 0
v_mov_b32 v161, 0
v_mov_b32 v162, 0
v_mov_b32 v163, 0
v_mov_b32 v164, 0
v_mov_b32 v165, 0
v_mov_b32 v166, 0
v_mov_b32 v167, 0
v_mov_b32 v168, 0
v_mov_b32 v169, 0
v_mov_b32 v170, 0
v_mov_b32 v171, 0
v_mov_b32 v172, 0
v_mov_b32 v173, 0
v_mov_b32 v174, 0
v_mov_b32 v175, 0
v_mov_b32 v176, 0
v_mov_b32 v177, 0
v_mov_b32 v178, 0
v_mov_b32 v179, 0
v_mov_b32 v180, 0
v_mov_b32 v181, 0
v_mov_b32 v182, 0
v_mov_b32 v183, 0
v_mov_b32 v184, 0
v_mov_b32 v185, 0
v_mov_b32 v186, 0
v_mov_b32 v187, 0
v_mov_b32 v188, 0
v_mov_b32 v189, 0
v_mov_b32 v190, 0
v_mov_b32 v191, 0
v_mov_b32 v192, 0
v_mov_b32 v193, 0
v_mov_b32 v194, 0
v_mov_b32 v195, 0
v_mov_b32 v196, 0
v_mov_b32 v197, 0
v_mov_b32 v198, 0
v_mov_b32 v199, 0
v_mov_b32 v200, 0
v_mov_b32 v201, 0
v_mov_b32 v202, 0
v_mov_b32 v203, 0
v_mov_b32 v204, 0
v_mov_b32 v205, 0
v_mov_b32 v206, 0
v_mov_b32 v207, 0
v_mov_b32 v208, 0
v_mov_b32 v209, 0
v_mov_b32 v210, 0
v_mov_b32 v211, 0
v_mov_b32 v212, 0
v_mov_b32 v213, 0
v_mov_b32 v214, 0
v_mov_b32 v215, 0
v_mov_b32 v216, 0
v_mov_b32 v217, 0
v_mov_b32 v218, 0
v_mov_b32 v219, 0
v_mov_b32 v220, 0
v_mov_b32 v221, 0
v_mov_b32 v222, 0
v_mov_b32 v223, 0
v_mov_b32 v224, 0
v_mov_b32 v225, 0
v_mov_b32 v226, 0
v_mov_b32 v227, 0
v_mov_b32 v228, 0
v_mov_b32 v229, 0
v_mov_b32 v230, 0
v_mov_b32 v231, 0
v_mov_b32 v232, 0
v_mov_b32 v233, 0
v_mov_b32 v234, 0
v_mov_b32 v235, 0
v_mov_b32 v236, 0
v_mov_b32 v237, 0
v_mov_b32 v238, 0
v_mov_b32 v239, 0
v_mov_b32 v240, 0
v_mov_b32 v241, 0
v_mov_b32 v242, 0
v_mov_b32 v243, 0
v_mov_b32 v244, 0
v_mov_b32 v245, 0
v_mov_b32 v246, 0
v_mov_b32 v247, 0
v_mov_b32 v248, 0
v_mov_b32 v249, 0
v_mov_b32 v250, 0
v_mov_b32 v251, 0
v_mov_b32 v252, 0
v_mov_b32 v253, 0
v_mov_b32 v254, 0
v_mov_b32 v255, 0
s_mul_i32 s43, s35, 192
s_and_b32 s43, s43, 0xffffff80
s_add_u32 s43, s43, 4096
s_cmp_eq_u32 s51, 1
s_cselect_b32 s8, s4, s6
s_cselect_b32 s9, s5, s7
s_sub_u32 s10, 7340032, s43
s_lshl_b32 s44, s34, 18
s_add_u32 s44, s44, 4194304
s_movk_i32 s38, 28672
s_cmp_eq_u32 s51, 0
s_cselect_b32 s8, s32, s8
s_cselect_b32 s9, s33, s9
s_cselect_b32 s10, 262144, s10
s_cselect_b32 s43, s44, s43
s_cselect_b32 s38, 1024, s38
s_cselect_b32 s45, 0, -1
s_add_u32 s8, s8, s43
s_addc_u32 s9, s9, 0
s_mov_b32 s11, 0x20000
s_lshl_b32 s40, s38, 4
s_add_u32 s42, s35, 17
s_lshl_b32 s39, s51, 14
v_lshrrev_b32 v19, 4, v1
v_lshlrev_b32 v20, 5, v19
v_mul_u32_u24 v19, 6912, v19
v_and_b32 v19, s45, v19
v_and_b32 v20, s45, v20
v_lshlrev_b32 v21, 4, v1
v_xor_b32 v21, v21, v20
v_add_u32 v22, v21, v19
s_and_b32 s45, s45, 128
v_xor_b32 v23, s45, v22
s_mul_i32 s43, s34, 917504
s_mul_i32 s44, s35, 16384
s_add_u32 s43, s43, s44
s_add_u32 s43, s43, 8388608
s_add_u32 s24, s32, s43
s_addc_u32 s25, s33, 0
s_mov_b32 s26, 278528
s_mov_b32 s27, 0x20000
s_mov_b32 s53, 262144
s_lshl_b32 s43, s47, 13
s_lshl_b32 s44, s46, 10
s_add_u32 s43, s43, s44
v_lshlrev_b32 v19, 11, v18
v_lshl_add_u32 v19, v17, 4, v19
v_add_u32 v27, s43, v19
s_lshl_b32 s43, s34, 18
s_lshl_b32 s44, s35, 7
s_add_u32 s43, s43, s44
s_add_u32 s16, s62, s43
s_addc_u32 s17, s63, 0
s_mov_b32 s18, 260224
s_mov_b32 s19, 0x20000
s_lshl_b32 s43, s46, 6
v_lshl_add_u32 v19, v17, 1, s43
v_lshlrev_b32 v19, 11, v19
v_and_b32 v20, 1, v18
v_lshl_add_u32 v19, v20, 5, v19
v_lshrrev_b32 v20, 1, v18
v_lshl_add_u32 v19, v20, 4, v19
s_lshl_b32 s43, s47, 6
v_add_u32 v28, s43, v19
s_lshl_b32 s43, s34, 4
s_add_u32 s43, s43, s35
s_xor_b32 s43, s43, 0
s_lshl_b32 s43, s43, 15
s_add_u32 s43, s43, 33554432
s_add_u32 s64, s32, s43
s_addc_u32 s65, s33, 0
s_mov_b32 s66, 32768
s_mov_b32 s67, 0x20000
s_lshl_b32 s43, s34, 4
s_add_u32 s43, s43, s35
s_xor_b32 s43, s43, 1
s_lshl_b32 s43, s43, 15
s_add_u32 s43, s43, 33554432
s_add_u32 s68, s32, s43
s_addc_u32 s69, s33, 0
s_mov_b32 s70, 32768
s_mov_b32 s71, 0x20000
s_lshl_b32 s43, s34, 18
s_add_u32 s12, s32, s43
s_addc_u32 s13, s33, 0
s_add_u32 s12, s12, 4194304
s_addc_u32 s13, s13, 0
s_mov_b32 s14, 262144
s_mov_b32 s15, 0x20000
v_lshlrev_b32 v21, 4, v1
s_lshl_b32 s54, s36, 11
s_add_u32 s43, s35, 1
s_and_b32 s43, s43, 15
s_lshl_b32 s43, s43, 14
s_add_u32 s30, s43, s54
s_add_u32 s43, s35, 2
s_and_b32 s43, s43, 15
s_lshl_b32 s43, s43, 14
s_add_u32 s31, s43, s54
ds_read_b128 v[32:35], v4 offset:0
ds_read_b64_tr_b16 v[48:49], v13 offset:16384
ds_read_b64_tr_b16 v[50:51], v13 offset:20480
ds_read_b128 v[36:39], v4 offset:256
ds_read_b128 v[40:43], v4 offset:512
ds_read_b128 v[44:47], v4 offset:768
ds_read_b64_tr_b16 v[64:65], v13 offset:32768
ds_read_b64_tr_b16 v[66:67], v13 offset:36864
ds_read_b64_tr_b16 v[52:53], v14 offset:16384
ds_read_b64_tr_b16 v[54:55], v14 offset:20480
ds_read_b64_tr_b16 v[68:69], v14 offset:32768
ds_read_b64_tr_b16 v[70:71], v14 offset:36864
ds_read_b64_tr_b16 v[56:57], v15 offset:16384
ds_read_b64_tr_b16 v[58:59], v15 offset:20480
ds_read_b64_tr_b16 v[72:73], v15 offset:32768
ds_read_b64_tr_b16 v[74:75], v15 offset:36864
ds_read_b64_tr_b16 v[60:61], v16 offset:16384
ds_read_b64_tr_b16 v[62:63], v16 offset:20480
ds_read_b64_tr_b16 v[76:77], v16 offset:32768
ds_read_b64_tr_b16 v[78:79], v16 offset:36864
s_waitcnt lgkmcnt(0)
v_mfma_f32_16x16x32_bf16 v[128:131], v[48:51], v[32:35], v[128:131]
ds_read_b128 v[80:83], v4 offset:8192
v_mfma_f32_16x16x32_bf16 v[132:135], v[48:51], v[36:39], v[132:135]
ds_read_b64_tr_b16 v[96:97], v13 offset:24576
v_mfma_f32_16x16x32_bf16 v[136:139], v[48:51], v[40:43], v[136:139]
ds_read_b64_tr_b16 v[98:99], v13 offset:28672
v_mfma_f32_16x16x32_bf16 v[140:143], v[48:51], v[44:47], v[140:143]
ds_read_b128 v[84:87], v4 offset:8448
v_mfma_f32_16x16x32_bf16 v[204:207], v[64:67], v[44:47], v[204:207]
ds_read_b128 v[88:91], v4 offset:8704
v_mfma_f32_16x16x32_bf16 v[200:203], v[64:67], v[40:43], v[200:203]
ds_read_b128 v[92:95], v4 offset:8960
v_mfma_f32_16x16x32_bf16 v[196:199], v[64:67], v[36:39], v[196:199]
ds_read_b64_tr_b16 v[112:113], v13 offset:40960
v_mfma_f32_16x16x32_bf16 v[192:195], v[64:67], v[32:35], v[192:195]
ds_read_b64_tr_b16 v[114:115], v13 offset:45056
v_mfma_f32_16x16x32_bf16 v[144:147], v[52:55], v[32:35], v[144:147]
ds_read_b64_tr_b16 v[100:101], v14 offset:24576
v_mfma_f32_16x16x32_bf16 v[148:151], v[52:55], v[36:39], v[148:151]
ds_read_b64_tr_b16 v[102:103], v14 offset:28672
v_mfma_f32_16x16x32_bf16 v[152:155], v[52:55], v[40:43], v[152:155]
ds_read_b64_tr_b16 v[116:117], v14 offset:40960
v_mfma_f32_16x16x32_bf16 v[156:159], v[52:55], v[44:47], v[156:159]
ds_read_b64_tr_b16 v[118:119], v14 offset:45056
v_mfma_f32_16x16x32_bf16 v[220:223], v[68:71], v[44:47], v[220:223]
ds_read_b64_tr_b16 v[104:105], v15 offset:24576
v_mfma_f32_16x16x32_bf16 v[216:219], v[68:71], v[40:43], v[216:219]
ds_read_b64_tr_b16 v[106:107], v15 offset:28672
v_mfma_f32_16x16x32_bf16 v[212:215], v[68:71], v[36:39], v[212:215]
ds_read_b64_tr_b16 v[120:121], v15 offset:40960
v_mfma_f32_16x16x32_bf16 v[208:211], v[68:71], v[32:35], v[208:211]
ds_read_b64_tr_b16 v[122:123], v15 offset:45056
v_mfma_f32_16x16x32_bf16 v[160:163], v[56:59], v[32:35], v[160:163]
ds_read_b64_tr_b16 v[108:109], v16 offset:24576
v_mfma_f32_16x16x32_bf16 v[164:167], v[56:59], v[36:39], v[164:167]
ds_read_b64_tr_b16 v[110:111], v16 offset:28672
v_mfma_f32_16x16x32_bf16 v[168:171], v[56:59], v[40:43], v[168:171]
ds_read_b64_tr_b16 v[124:125], v16 offset:40960
v_mfma_f32_16x16x32_bf16 v[172:175], v[56:59], v[44:47], v[172:175]
ds_read_b64_tr_b16 v[126:127], v16 offset:45056
v_mfma_f32_16x16x32_bf16 v[236:239], v[72:75], v[44:47], v[236:239]
v_mfma_f32_16x16x32_bf16 v[232:235], v[72:75], v[40:43], v[232:235]
v_mfma_f32_16x16x32_bf16 v[228:231], v[72:75], v[36:39], v[228:231]
v_mfma_f32_16x16x32_bf16 v[224:227], v[72:75], v[32:35], v[224:227]
v_mfma_f32_16x16x32_bf16 v[176:179], v[60:63], v[32:35], v[176:179]
v_mfma_f32_16x16x32_bf16 v[180:183], v[60:63], v[36:39], v[180:183]
v_mfma_f32_16x16x32_bf16 v[184:187], v[60:63], v[40:43], v[184:187]
v_mfma_f32_16x16x32_bf16 v[188:191], v[60:63], v[44:47], v[188:191]
v_mfma_f32_16x16x32_bf16 v[252:255], v[76:79], v[44:47], v[252:255]
v_mfma_f32_16x16x32_bf16 v[248:251], v[76:79], v[40:43], v[248:251]
v_mfma_f32_16x16x32_bf16 v[244:247], v[76:79], v[36:39], v[244:247]
v_mfma_f32_16x16x32_bf16 v[240:243], v[76:79], v[32:35], v[240:243]
s_waitcnt lgkmcnt(0)
v_mfma_f32_16x16x32_bf16 v[128:131], v[96:99], v[80:83], v[128:131]
v_mfma_f32_16x16x32_bf16 v[132:135], v[96:99], v[84:87], v[132:135]
v_mfma_f32_16x16x32_bf16 v[136:139], v[96:99], v[88:91], v[136:139]
v_mfma_f32_16x16x32_bf16 v[140:143], v[96:99], v[92:95], v[140:143]
v_mfma_f32_16x16x32_bf16 v[204:207], v[112:115], v[92:95], v[204:207]
v_mfma_f32_16x16x32_bf16 v[200:203], v[112:115], v[88:91], v[200:203]
v_mfma_f32_16x16x32_bf16 v[196:199], v[112:115], v[84:87], v[196:199]
v_mfma_f32_16x16x32_bf16 v[192:195], v[112:115], v[80:83], v[192:195]
v_mfma_f32_16x16x32_bf16 v[144:147], v[100:103], v[80:83], v[144:147]
v_mfma_f32_16x16x32_bf16 v[148:151], v[100:103], v[84:87], v[148:151]
v_mfma_f32_16x16x32_bf16 v[152:155], v[100:103], v[88:91], v[152:155]
v_mfma_f32_16x16x32_bf16 v[156:159], v[100:103], v[92:95], v[156:159]
v_mfma_f32_16x16x32_bf16 v[220:223], v[116:119], v[92:95], v[220:223]
v_mfma_f32_16x16x32_bf16 v[216:219], v[116:119], v[88:91], v[216:219]
v_mfma_f32_16x16x32_bf16 v[212:215], v[116:119], v[84:87], v[212:215]
v_mfma_f32_16x16x32_bf16 v[208:211], v[116:119], v[80:83], v[208:211]
v_mfma_f32_16x16x32_bf16 v[160:163], v[104:107], v[80:83], v[160:163]
v_mfma_f32_16x16x32_bf16 v[164:167], v[104:107], v[84:87], v[164:167]
v_mfma_f32_16x16x32_bf16 v[168:171], v[104:107], v[88:91], v[168:171]
v_mfma_f32_16x16x32_bf16 v[172:175], v[104:107], v[92:95], v[172:175]
v_mfma_f32_16x16x32_bf16 v[236:239], v[120:123], v[92:95], v[236:239]
v_mfma_f32_16x16x32_bf16 v[232:235], v[120:123], v[88:91], v[232:235]
v_mfma_f32_16x16x32_bf16 v[228:231], v[120:123], v[84:87], v[228:231]
v_mfma_f32_16x16x32_bf16 v[224:227], v[120:123], v[80:83], v[224:227]
v_mfma_f32_16x16x32_bf16 v[176:179], v[108:111], v[80:83], v[176:179]
v_mfma_f32_16x16x32_bf16 v[180:183], v[108:111], v[84:87], v[180:183]
v_mfma_f32_16x16x32_bf16 v[184:187], v[108:111], v[88:91], v[184:187]
v_mfma_f32_16x16x32_bf16 v[188:191], v[108:111], v[92:95], v[188:191]
v_mfma_f32_16x16x32_bf16 v[252:255], v[124:127], v[92:95], v[252:255]
v_mfma_f32_16x16x32_bf16 v[248:251], v[124:127], v[88:91], v[248:251]
v_mfma_f32_16x16x32_bf16 v[244:247], v[124:127], v[84:87], v[244:247]
v_mfma_f32_16x16x32_bf16 v[240:243], v[124:127], v[80:83], v[240:243]
s_barrier
s_add_u32 m0, s54, 0
s_add_u32 s43, s30, 0
buffer_load_dwordx4 v21, s[12:15], s43 offen sc1 lds
s_add_u32 m0, s54, 1024
s_add_u32 s43, s30, 1024
buffer_load_dwordx4 v21, s[12:15], s43 offen sc1 lds
s_add_u32 m0, s54, 49152
s_add_u32 s43, s31, 0
buffer_load_dwordx4 v21, s[12:15], s43 offen sc1 lds
s_add_u32 m0, s54, 50176
s_add_u32 s43, s31, 1024
buffer_load_dwordx4 v21, s[12:15], s43 offen sc1 lds
s_waitcnt vmcnt(2)
s_barrier
s_setprio 1
ds_read_b128 v[32:35], v2 offset:0
ds_read_b64_tr_b16 v[48:49], v5 offset:16384
ds_read_b64_tr_b16 v[50:51], v5 offset:20480
ds_read_b128 v[36:39], v2 offset:256
ds_read_b128 v[40:43], v2 offset:512
ds_read_b128 v[44:47], v2 offset:768
ds_read_b64_tr_b16 v[64:65], v5 offset:32768
ds_read_b64_tr_b16 v[66:67], v5 offset:36864
ds_read_b64_tr_b16 v[52:53], v6 offset:16384
ds_read_b64_tr_b16 v[54:55], v6 offset:20480
ds_read_b64_tr_b16 v[68:69], v6 offset:32768
ds_read_b64_tr_b16 v[70:71], v6 offset:36864
ds_read_b64_tr_b16 v[56:57], v7 offset:16384
ds_read_b64_tr_b16 v[58:59], v7 offset:20480
ds_read_b64_tr_b16 v[72:73], v7 offset:32768
ds_read_b64_tr_b16 v[74:75], v7 offset:36864
ds_read_b64_tr_b16 v[60:61], v8 offset:16384
ds_read_b64_tr_b16 v[62:63], v8 offset:20480
ds_read_b64_tr_b16 v[76:77], v8 offset:32768
ds_read_b64_tr_b16 v[78:79], v8 offset:36864
s_mov_b32 s41, 4
Lk3_24:
s_waitcnt lgkmcnt(0)
v_mfma_f32_16x16x32_bf16 v[128:131], v[48:51], v[32:35], v[128:131]
ds_read_b128 v[80:83], v2 offset:8192
v_mfma_f32_16x16x32_bf16 v[132:135], v[48:51], v[36:39], v[132:135]
ds_read_b64_tr_b16 v[96:97], v5 offset:24576
v_mfma_f32_16x16x32_bf16 v[136:139], v[48:51], v[40:43], v[136:139]
ds_read_b64_tr_b16 v[98:99], v5 offset:28672
v_mfma_f32_16x16x32_bf16 v[140:143], v[48:51], v[44:47], v[140:143]
ds_read_b128 v[84:87], v2 offset:8448
v_mfma_f32_16x16x32_bf16 v[204:207], v[64:67], v[44:47], v[204:207]
ds_read_b128 v[88:91], v2 offset:8704
v_mfma_f32_16x16x32_bf16 v[200:203], v[64:67], v[40:43], v[200:203]
ds_read_b128 v[92:95], v2 offset:8960
v_mfma_f32_16x16x32_bf16 v[196:199], v[64:67], v[36:39], v[196:199]
ds_read_b64_tr_b16 v[112:113], v5 offset:40960
v_mfma_f32_16x16x32_bf16 v[192:195], v[64:67], v[32:35], v[192:195]
ds_read_b64_tr_b16 v[114:115], v5 offset:45056
v_mfma_f32_16x16x32_bf16 v[144:147], v[52:55], v[32:35], v[144:147]
ds_read_b64_tr_b16 v[100:101], v6 offset:24576
v_mfma_f32_16x16x32_bf16 v[148:151], v[52:55], v[36:39], v[148:151]
ds_read_b64_tr_b16 v[102:103], v6 offset:28672
v_mfma_f32_16x16x32_bf16 v[152:155], v[52:55], v[40:43], v[152:155]
ds_read_b64_tr_b16 v[116:117], v6 offset:40960
v_mfma_f32_16x16x32_bf16 v[156:159], v[52:55], v[44:47], v[156:159]
ds_read_b64_tr_b16 v[118:119], v6 offset:45056
v_mfma_f32_16x16x32_bf16 v[220:223], v[68:71], v[44:47], v[220:223]
ds_read_b64_tr_b16 v[104:105], v7 offset:24576
v_mfma_f32_16x16x32_bf16 v[216:219], v[68:71], v[40:43], v[216:219]
ds_read_b64_tr_b16 v[106:107], v7 offset:28672
v_mfma_f32_16x16x32_bf16 v[212:215], v[68:71], v[36:39], v[212:215]
ds_read_b64_tr_b16 v[120:121], v7 offset:40960
v_mfma_f32_16x16x32_bf16 v[208:211], v[68:71], v[32:35], v[208:211]
ds_read_b64_tr_b16 v[122:123], v7 offset:45056
v_mfma_f32_16x16x32_bf16 v[160:163], v[56:59], v[32:35], v[160:163]
ds_read_b64_tr_b16 v[108:109], v8 offset:24576
v_mfma_f32_16x16x32_bf16 v[164:167], v[56:59], v[36:39], v[164:167]
ds_read_b64_tr_b16 v[110:111], v8 offset:28672
v_mfma_f32_16x16x32_bf16 v[168:171], v[56:59], v[40:43], v[168:171]
ds_read_b64_tr_b16 v[124:125], v8 offset:40960
v_mfma_f32_16x16x32_bf16 v[172:175], v[56:59], v[44:47], v[172:175]
ds_read_b64_tr_b16 v[126:127], v8 offset:45056
v_mfma_f32_16x16x32_bf16 v[236:239], v[72:75], v[44:47], v[236:239]
v_mfma_f32_16x16x32_bf16 v[232:235], v[72:75], v[40:43], v[232:235]
v_mfma_f32_16x16x32_bf16 v[228:231], v[72:75], v[36:39], v[228:231]
v_mfma_f32_16x16x32_bf16 v[224:227], v[72:75], v[32:35], v[224:227]
v_mfma_f32_16x16x32_bf16 v[176:179], v[60:63], v[32:35], v[176:179]
v_mfma_f32_16x16x32_bf16 v[180:183], v[60:63], v[36:39], v[180:183]
v_mfma_f32_16x16x32_bf16 v[184:187], v[60:63], v[40:43], v[184:187]
v_mfma_f32_16x16x32_bf16 v[188:191], v[60:63], v[44:47], v[188:191]
v_mfma_f32_16x16x32_bf16 v[252:255], v[76:79], v[44:47], v[252:255]
v_mfma_f32_16x16x32_bf16 v[248:251], v[76:79], v[40:43], v[248:251]
v_mfma_f32_16x16x32_bf16 v[244:247], v[76:79], v[36:39], v[244:247]
v_mfma_f32_16x16x32_bf16 v[240:243], v[76:79], v[32:35], v[240:243]
s_waitcnt vmcnt(0) lgkmcnt(0)
s_barrier
v_mfma_f32_16x16x32_bf16 v[128:131], v[96:99], v[80:83], v[128:131]
ds_read_b128 v[32:35], v3 offset:0
v_mfma_f32_16x16x32_bf16 v[132:135], v[96:99], v[84:87], v[132:135]
ds_read_b64_tr_b16 v[48:49], v9 offset:16384
v_mfma_f32_16x16x32_bf16 v[136:139], v[96:99], v[88:91], v[136:139]
ds_read_b64_tr_b16 v[50:51], v9 offset:20480
v_mfma_f32_16x16x32_bf16 v[140:143], v[96:99], v[92:95], v[140:143]
ds_read_b128 v[36:39], v3 offset:256
v_mfma_f32_16x16x32_bf16 v[204:207], v[112:115], v[92:95], v[204:207]
ds_read_b128 v[40:43], v3 offset:512
v_mfma_f32_16x16x32_bf16 v[200:203], v[112:115], v[88:91], v[200:203]
ds_read_b128 v[44:47], v3 offset:768
v_mfma_f32_16x16x32_bf16 v[196:199], v[112:115], v[84:87], v[196:199]
ds_read_b64_tr_b16 v[64:65], v9 offset:32768
v_mfma_f32_16x16x32_bf16 v[192:195], v[112:115], v[80:83], v[192:195]
ds_read_b64_tr_b16 v[66:67], v9 offset:36864
v_mfma_f32_16x16x32_bf16 v[144:147], v[100:103], v[80:83], v[144:147]
ds_read_b64_tr_b16 v[52:53], v10 offset:16384
v_mfma_f32_16x16x32_bf16 v[148:151], v[100:103], v[84:87], v[148:151]
ds_read_b64_tr_b16 v[54:55], v10 offset:20480
v_mfma_f32_16x16x32_bf16 v[152:155], v[100:103], v[88:91], v[152:155]
ds_read_b64_tr_b16 v[68:69], v10 offset:32768
v_mfma_f32_16x16x32_bf16 v[156:159], v[100:103], v[92:95], v[156:159]
ds_read_b64_tr_b16 v[70:71], v10 offset:36864
v_mfma_f32_16x16x32_bf16 v[220:223], v[116:119], v[92:95], v[220:223]
ds_read_b64_tr_b16 v[56:57], v11 offset:16384
v_mfma_f32_16x16x32_bf16 v[216:219], v[116:119], v[88:91], v[216:219]
ds_read_b64_tr_b16 v[58:59], v11 offset:20480
v_mfma_f32_16x16x32_bf16 v[212:215], v[116:119], v[84:87], v[212:215]
ds_read_b64_tr_b16 v[72:73], v11 offset:32768
v_mfma_f32_16x16x32_bf16 v[208:211], v[116:119], v[80:83], v[208:211]
ds_read_b64_tr_b16 v[74:75], v11 offset:36864
v_mfma_f32_16x16x32_bf16 v[160:163], v[104:107], v[80:83], v[160:163]
ds_read_b64_tr_b16 v[60:61], v12 offset:16384
v_mfma_f32_16x16x32_bf16 v[164:167], v[104:107], v[84:87], v[164:167]
ds_read_b64_tr_b16 v[62:63], v12 offset:20480
v_mfma_f32_16x16x32_bf16 v[168:171], v[104:107], v[88:91], v[168:171]
ds_read_b64_tr_b16 v[76:77], v12 offset:32768
v_mfma_f32_16x16x32_bf16 v[172:175], v[104:107], v[92:95], v[172:175]
ds_read_b64_tr_b16 v[78:79], v12 offset:36864
v_mfma_f32_16x16x32_bf16 v[236:239], v[120:123], v[92:95], v[236:239]
v_mfma_f32_16x16x32_bf16 v[232:235], v[120:123], v[88:91], v[232:235]
v_mfma_f32_16x16x32_bf16 v[228:231], v[120:123], v[84:87], v[228:231]
v_mfma_f32_16x16x32_bf16 v[224:227], v[120:123], v[80:83], v[224:227]
v_mfma_f32_16x16x32_bf16 v[176:179], v[108:111], v[80:83], v[176:179]
v_mfma_f32_16x16x32_bf16 v[180:183], v[108:111], v[84:87], v[180:183]
v_mfma_f32_16x16x32_bf16 v[184:187], v[108:111], v[88:91], v[184:187]
v_mfma_f32_16x16x32_bf16 v[188:191], v[108:111], v[92:95], v[188:191]
v_mfma_f32_16x16x32_bf16 v[252:255], v[124:127], v[92:95], v[252:255]
v_mfma_f32_16x16x32_bf16 v[248:251], v[124:127], v[88:91], v[248:251]
v_mfma_f32_16x16x32_bf16 v[244:247], v[124:127], v[84:87], v[244:247]
v_mfma_f32_16x16x32_bf16 v[240:243], v[124:127], v[80:83], v[240:243]
s_waitcnt lgkmcnt(0)
v_mfma_f32_16x16x32_bf16 v[128:131], v[48:51], v[32:35], v[128:131]
ds_read_b128 v[80:83], v3 offset:8192
v_mfma_f32_16x16x32_bf16 v[132:135], v[48:51], v[36:39], v[132:135]
ds_read_b64_tr_b16 v[96:97], v9 offset:24576
v_mfma_f32_16x16x32_bf16 v[136:139], v[48:51], v[40:43], v[136:139]
ds_read_b64_tr_b16 v[98:99], v9 offset:28672
v_mfma_f32_16x16x32_bf16 v[140:143], v[48:51], v[44:47], v[140:143]
ds_read_b128 v[84:87], v3 offset:8448
v_mfma_f32_16x16x32_bf16 v[204:207], v[64:67], v[44:47], v[204:207]
ds_read_b128 v[88:91], v3 offset:8704
v_mfma_f32_16x16x32_bf16 v[200:203], v[64:67], v[40:43], v[200:203]
ds_read_b128 v[92:95], v3 offset:8960
v_mfma_f32_16x16x32_bf16 v[196:199], v[64:67], v[36:39], v[196:199]
ds_read_b64_tr_b16 v[112:113], v9 offset:40960
v_mfma_f32_16x16x32_bf16 v[192:195], v[64:67], v[32:35], v[192:195]
ds_read_b64_tr_b16 v[114:115], v9 offset:45056
v_mfma_f32_16x16x32_bf16 v[144:147], v[52:55], v[32:35], v[144:147]
ds_read_b64_tr_b16 v[100:101], v10 offset:24576
v_mfma_f32_16x16x32_bf16 v[148:151], v[52:55], v[36:39], v[148:151]
ds_read_b64_tr_b16 v[102:103], v10 offset:28672
v_mfma_f32_16x16x32_bf16 v[152:155], v[52:55], v[40:43], v[152:155]
ds_read_b64_tr_b16 v[116:117], v10 offset:40960
v_mfma_f32_16x16x32_bf16 v[156:159], v[52:55], v[44:47], v[156:159]
ds_read_b64_tr_b16 v[118:119], v10 offset:45056
v_mfma_f32_16x16x32_bf16 v[220:223], v[68:71], v[44:47], v[220:223]
ds_read_b64_tr_b16 v[104:105], v11 offset:24576
v_mfma_f32_16x16x32_bf16 v[216:219], v[68:71], v[40:43], v[216:219]
ds_read_b64_tr_b16 v[106:107], v11 offset:28672
v_mfma_f32_16x16x32_bf16 v[212:215], v[68:71], v[36:39], v[212:215]
ds_read_b64_tr_b16 v[120:121], v11 offset:40960
v_mfma_f32_16x16x32_bf16 v[208:211], v[68:71], v[32:35], v[208:211]
ds_read_b64_tr_b16 v[122:123], v11 offset:45056
v_mfma_f32_16x16x32_bf16 v[160:163], v[56:59], v[32:35], v[160:163]
ds_read_b64_tr_b16 v[108:109], v12 offset:24576
v_mfma_f32_16x16x32_bf16 v[164:167], v[56:59], v[36:39], v[164:167]
ds_read_b64_tr_b16 v[110:111], v12 offset:28672
v_mfma_f32_16x16x32_bf16 v[168:171], v[56:59], v[40:43], v[168:171]
ds_read_b64_tr_b16 v[124:125], v12 offset:40960
v_mfma_f32_16x16x32_bf16 v[172:175], v[56:59], v[44:47], v[172:175]
ds_read_b64_tr_b16 v[126:127], v12 offset:45056
v_mfma_f32_16x16x32_bf16 v[236:239], v[72:75], v[44:47], v[236:239]
v_mfma_f32_16x16x32_bf16 v[232:235], v[72:75], v[40:43], v[232:235]
v_mfma_f32_16x16x32_bf16 v[228:231], v[72:75], v[36:39], v[228:231]
v_mfma_f32_16x16x32_bf16 v[224:227], v[72:75], v[32:35], v[224:227]
v_mfma_f32_16x16x32_bf16 v[176:179], v[60:63], v[32:35], v[176:179]
v_mfma_f32_16x16x32_bf16 v[180:183], v[60:63], v[36:39], v[180:183]
v_mfma_f32_16x16x32_bf16 v[184:187], v[60:63], v[40:43], v[184:187]
v_mfma_f32_16x16x32_bf16 v[188:191], v[60:63], v[44:47], v[188:191]
v_mfma_f32_16x16x32_bf16 v[252:255], v[76:79], v[44:47], v[252:255]
v_mfma_f32_16x16x32_bf16 v[248:251], v[76:79], v[40:43], v[248:251]
v_mfma_f32_16x16x32_bf16 v[244:247], v[76:79], v[36:39], v[244:247]
v_mfma_f32_16x16x32_bf16 v[240:243], v[76:79], v[32:35], v[240:243]
s_waitcnt lgkmcnt(0)
s_barrier
v_mfma_f32_16x16x32_bf16 v[128:131], v[96:99], v[80:83], v[128:131]
ds_read_b128 v[32:35], v4 offset:0
v_mfma_f32_16x16x32_bf16 v[132:135], v[96:99], v[84:87], v[132:135]
ds_read_b64_tr_b16 v[48:49], v13 offset:16384
v_mfma_f32_16x16x32_bf16 v[136:139], v[96:99], v[88:91], v[136:139]
ds_read_b64_tr_b16 v[50:51], v13 offset:20480
v_mfma_f32_16x16x32_bf16 v[140:143], v[96:99], v[92:95], v[140:143]
ds_read_b128 v[36:39], v4 offset:256
v_mfma_f32_16x16x32_bf16 v[204:207], v[112:115], v[92:95], v[204:207]
ds_read_b128 v[40:43], v4 offset:512
v_mfma_f32_16x16x32_bf16 v[200:203], v[112:115], v[88:91], v[200:203]
ds_read_b128 v[44:47], v4 offset:768
v_mfma_f32_16x16x32_bf16 v[196:199], v[112:115], v[84:87], v[196:199]
ds_read_b64_tr_b16 v[64:65], v13 offset:32768
v_mfma_f32_16x16x32_bf16 v[192:195], v[112:115], v[80:83], v[192:195]
ds_read_b64_tr_b16 v[66:67], v13 offset:36864
v_mfma_f32_16x16x32_bf16 v[144:147], v[100:103], v[80:83], v[144:147]
ds_read_b64_tr_b16 v[52:53], v14 offset:16384
v_mfma_f32_16x16x32_bf16 v[148:151], v[100:103], v[84:87], v[148:151]
ds_read_b64_tr_b16 v[54:55], v14 offset:20480
v_mfma_f32_16x16x32_bf16 v[152:155], v[100:103], v[88:91], v[152:155]
ds_read_b64_tr_b16 v[68:69], v14 offset:32768
v_mfma_f32_16x16x32_bf16 v[156:159], v[100:103], v[92:95], v[156:159]
ds_read_b64_tr_b16 v[70:71], v14 offset:36864
v_mfma_f32_16x16x32_bf16 v[220:223], v[116:119], v[92:95], v[220:223]
ds_read_b64_tr_b16 v[56:57], v15 offset:16384
v_mfma_f32_16x16x32_bf16 v[216:219], v[116:119], v[88:91], v[216:219]
ds_read_b64_tr_b16 v[58:59], v15 offset:20480
v_mfma_f32_16x16x32_bf16 v[212:215], v[116:119], v[84:87], v[212:215]
ds_read_b64_tr_b16 v[72:73], v15 offset:32768
v_mfma_f32_16x16x32_bf16 v[208:211], v[116:119], v[80:83], v[208:211]
ds_read_b64_tr_b16 v[74:75], v15 offset:36864
v_mfma_f32_16x16x32_bf16 v[160:163], v[104:107], v[80:83], v[160:163]
ds_read_b64_tr_b16 v[60:61], v16 offset:16384
v_mfma_f32_16x16x32_bf16 v[164:167], v[104:107], v[84:87], v[164:167]
ds_read_b64_tr_b16 v[62:63], v16 offset:20480
v_mfma_f32_16x16x32_bf16 v[168:171], v[104:107], v[88:91], v[168:171]
ds_read_b64_tr_b16 v[76:77], v16 offset:32768
v_mfma_f32_16x16x32_bf16 v[172:175], v[104:107], v[92:95], v[172:175]
ds_read_b64_tr_b16 v[78:79], v16 offset:36864
v_mfma_f32_16x16x32_bf16 v[236:239], v[120:123], v[92:95], v[236:239]
v_mfma_f32_16x16x32_bf16 v[232:235], v[120:123], v[88:91], v[232:235]
v_mfma_f32_16x16x32_bf16 v[228:231], v[120:123], v[84:87], v[228:231]
v_mfma_f32_16x16x32_bf16 v[224:227], v[120:123], v[80:83], v[224:227]
v_mfma_f32_16x16x32_bf16 v[176:179], v[108:111], v[80:83], v[176:179]
v_mfma_f32_16x16x32_bf16 v[180:183], v[108:111], v[84:87], v[180:183]
v_mfma_f32_16x16x32_bf16 v[184:187], v[108:111], v[88:91], v[184:187]
v_mfma_f32_16x16x32_bf16 v[188:191], v[108:111], v[92:95], v[188:191]
v_mfma_f32_16x16x32_bf16 v[252:255], v[124:127], v[92:95], v[252:255]
v_mfma_f32_16x16x32_bf16 v[248:251], v[124:127], v[88:91], v[248:251]
v_mfma_f32_16x16x32_bf16 v[244:247], v[124:127], v[84:87], v[244:247]
v_mfma_f32_16x16x32_bf16 v[240:243], v[124:127], v[80:83], v[240:243]
s_waitcnt lgkmcnt(0)
v_mfma_f32_16x16x32_bf16 v[128:131], v[48:51], v[32:35], v[128:131]
ds_read_b128 v[80:83], v4 offset:8192
v_mfma_f32_16x16x32_bf16 v[132:135], v[48:51], v[36:39], v[132:135]
ds_read_b64_tr_b16 v[96:97], v13 offset:24576
v_mfma_f32_16x16x32_bf16 v[136:139], v[48:51], v[40:43], v[136:139]
ds_read_b64_tr_b16 v[98:99], v13 offset:28672
v_mfma_f32_16x16x32_bf16 v[140:143], v[48:51], v[44:47], v[140:143]
ds_read_b128 v[84:87], v4 offset:8448
v_mfma_f32_16x16x32_bf16 v[204:207], v[64:67], v[44:47], v[204:207]
ds_read_b128 v[88:91], v4 offset:8704
v_mfma_f32_16x16x32_bf16 v[200:203], v[64:67], v[40:43], v[200:203]
ds_read_b128 v[92:95], v4 offset:8960
v_mfma_f32_16x16x32_bf16 v[196:199], v[64:67], v[36:39], v[196:199]
ds_read_b64_tr_b16 v[112:113], v13 offset:40960
v_mfma_f32_16x16x32_bf16 v[192:195], v[64:67], v[32:35], v[192:195]
ds_read_b64_tr_b16 v[114:115], v13 offset:45056
v_mfma_f32_16x16x32_bf16 v[144:147], v[52:55], v[32:35], v[144:147]
ds_read_b64_tr_b16 v[100:101], v14 offset:24576
v_mfma_f32_16x16x32_bf16 v[148:151], v[52:55], v[36:39], v[148:151]
ds_read_b64_tr_b16 v[102:103], v14 offset:28672
v_mfma_f32_16x16x32_bf16 v[152:155], v[52:55], v[40:43], v[152:155]
ds_read_b64_tr_b16 v[116:117], v14 offset:40960
v_mfma_f32_16x16x32_bf16 v[156:159], v[52:55], v[44:47], v[156:159]
ds_read_b64_tr_b16 v[118:119], v14 offset:45056
v_mfma_f32_16x16x32_bf16 v[220:223], v[68:71], v[44:47], v[220:223]
ds_read_b64_tr_b16 v[104:105], v15 offset:24576
v_mfma_f32_16x16x32_bf16 v[216:219], v[68:71], v[40:43], v[216:219]
ds_read_b64_tr_b16 v[106:107], v15 offset:28672
v_mfma_f32_16x16x32_bf16 v[212:215], v[68:71], v[36:39], v[212:215]
ds_read_b64_tr_b16 v[120:121], v15 offset:40960
v_mfma_f32_16x16x32_bf16 v[208:211], v[68:71], v[32:35], v[208:211]
ds_read_b64_tr_b16 v[122:123], v15 offset:45056
v_mfma_f32_16x16x32_bf16 v[160:163], v[56:59], v[32:35], v[160:163]
ds_read_b64_tr_b16 v[108:109], v16 offset:24576
v_mfma_f32_16x16x32_bf16 v[164:167], v[56:59], v[36:39], v[164:167]
ds_read_b64_tr_b16 v[110:111], v16 offset:28672
v_mfma_f32_16x16x32_bf16 v[168:171], v[56:59], v[40:43], v[168:171]
ds_read_b64_tr_b16 v[124:125], v16 offset:40960
v_mfma_f32_16x16x32_bf16 v[172:175], v[56:59], v[44:47], v[172:175]
ds_read_b64_tr_b16 v[126:127], v16 offset:45056
v_mfma_f32_16x16x32_bf16 v[236:239], v[72:75], v[44:47], v[236:239]
v_mfma_f32_16x16x32_bf16 v[232:235], v[72:75], v[40:43], v[232:235]
v_mfma_f32_16x16x32_bf16 v[228:231], v[72:75], v[36:39], v[228:231]
v_mfma_f32_16x16x32_bf16 v[224:227], v[72:75], v[32:35], v[224:227]
v_mfma_f32_16x16x32_bf16 v[176:179], v[60:63], v[32:35], v[176:179]
v_mfma_f32_16x16x32_bf16 v[180:183], v[60:63], v[36:39], v[180:183]
v_mfma_f32_16x16x32_bf16 v[184:187], v[60:63], v[40:43], v[184:187]
v_mfma_f32_16x16x32_bf16 v[188:191], v[60:63], v[44:47], v[188:191]
v_mfma_f32_16x16x32_bf16 v[252:255], v[76:79], v[44:47], v[252:255]
v_mfma_f32_16x16x32_bf16 v[248:251], v[76:79], v[40:43], v[248:251]
v_mfma_f32_16x16x32_bf16 v[244:247], v[76:79], v[36:39], v[244:247]
v_mfma_f32_16x16x32_bf16 v[240:243], v[76:79], v[32:35], v[240:243]
s_waitcnt lgkmcnt(0)
s_barrier
v_mfma_f32_16x16x32_bf16 v[128:131], v[96:99], v[80:83], v[128:131]
ds_read_b128 v[32:35], v2 offset:0
v_mfma_f32_16x16x32_bf16 v[132:135], v[96:99], v[84:87], v[132:135]
ds_read_b64_tr_b16 v[48:49], v5 offset:16384
v_mfma_f32_16x16x32_bf16 v[136:139], v[96:99], v[88:91], v[136:139]
ds_read_b64_tr_b16 v[50:51], v5 offset:20480
v_mfma_f32_16x16x32_bf16 v[140:143], v[96:99], v[92:95], v[140:143]
ds_read_b128 v[36:39], v2 offset:256
v_mfma_f32_16x16x32_bf16 v[204:207], v[112:115], v[92:95], v[204:207]
ds_read_b128 v[40:43], v2 offset:512
v_mfma_f32_16x16x32_bf16 v[200:203], v[112:115], v[88:91], v[200:203]
ds_read_b128 v[44:47], v2 offset:768
v_mfma_f32_16x16x32_bf16 v[196:199], v[112:115], v[84:87], v[196:199]
ds_read_b64_tr_b16 v[64:65], v5 offset:32768
v_mfma_f32_16x16x32_bf16 v[192:195], v[112:115], v[80:83], v[192:195]
ds_read_b64_tr_b16 v[66:67], v5 offset:36864
v_mfma_f32_16x16x32_bf16 v[144:147], v[100:103], v[80:83], v[144:147]
ds_read_b64_tr_b16 v[52:53], v6 offset:16384
v_mfma_f32_16x16x32_bf16 v[148:151], v[100:103], v[84:87], v[148:151]
ds_read_b64_tr_b16 v[54:55], v6 offset:20480
v_mfma_f32_16x16x32_bf16 v[152:155], v[100:103], v[88:91], v[152:155]
ds_read_b64_tr_b16 v[68:69], v6 offset:32768
v_mfma_f32_16x16x32_bf16 v[156:159], v[100:103], v[92:95], v[156:159]
ds_read_b64_tr_b16 v[70:71], v6 offset:36864
v_mfma_f32_16x16x32_bf16 v[220:223], v[116:119], v[92:95], v[220:223]
ds_read_b64_tr_b16 v[56:57], v7 offset:16384
v_mfma_f32_16x16x32_bf16 v[216:219], v[116:119], v[88:91], v[216:219]
ds_read_b64_tr_b16 v[58:59], v7 offset:20480
v_mfma_f32_16x16x32_bf16 v[212:215], v[116:119], v[84:87], v[212:215]
ds_read_b64_tr_b16 v[72:73], v7 offset:32768
v_mfma_f32_16x16x32_bf16 v[208:211], v[116:119], v[80:83], v[208:211]
ds_read_b64_tr_b16 v[74:75], v7 offset:36864
v_mfma_f32_16x16x32_bf16 v[160:163], v[104:107], v[80:83], v[160:163]
ds_read_b64_tr_b16 v[60:61], v8 offset:16384
v_mfma_f32_16x16x32_bf16 v[164:167], v[104:107], v[84:87], v[164:167]
ds_read_b64_tr_b16 v[62:63], v8 offset:20480
v_mfma_f32_16x16x32_bf16 v[168:171], v[104:107], v[88:91], v[168:171]
ds_read_b64_tr_b16 v[76:77], v8 offset:32768
v_mfma_f32_16x16x32_bf16 v[172:175], v[104:107], v[92:95], v[172:175]
ds_read_b64_tr_b16 v[78:79], v8 offset:36864
v_mfma_f32_16x16x32_bf16 v[236:239], v[120:123], v[92:95], v[236:239]
v_mfma_f32_16x16x32_bf16 v[232:235], v[120:123], v[88:91], v[232:235]
v_mfma_f32_16x16x32_bf16 v[228:231], v[120:123], v[84:87], v[228:231]
v_mfma_f32_16x16x32_bf16 v[224:227], v[120:123], v[80:83], v[224:227]
v_mfma_f32_16x16x32_bf16 v[176:179], v[108:111], v[80:83], v[176:179]
v_mfma_f32_16x16x32_bf16 v[180:183], v[108:111], v[84:87], v[180:183]
v_mfma_f32_16x16x32_bf16 v[184:187], v[108:111], v[88:91], v[184:187]
v_mfma_f32_16x16x32_bf16 v[188:191], v[108:111], v[92:95], v[188:191]
v_mfma_f32_16x16x32_bf16 v[252:255], v[124:127], v[92:95], v[252:255]
v_mfma_f32_16x16x32_bf16 v[248:251], v[124:127], v[88:91], v[248:251]
v_mfma_f32_16x16x32_bf16 v[244:247], v[124:127], v[84:87], v[244:247]
v_mfma_f32_16x16x32_bf16 v[240:243], v[124:127], v[80:83], v[240:243]
s_sub_u32 s41, s41, 1
s_cmp_lg_u32 s41, 0
s_cbranch_scc1 Lk3_24
s_waitcnt lgkmcnt(0)
v_mfma_f32_16x16x32_bf16 v[128:131], v[48:51], v[32:35], v[128:131]
ds_read_b128 v[80:83], v2 offset:8192
v_mfma_f32_16x16x32_bf16 v[132:135], v[48:51], v[36:39], v[132:135]
ds_read_b64_tr_b16 v[96:97], v5 offset:24576
v_mfma_f32_16x16x32_bf16 v[136:139], v[48:51], v[40:43], v[136:139]
ds_read_b64_tr_b16 v[98:99], v5 offset:28672
v_mfma_f32_16x16x32_bf16 v[140:143], v[48:51], v[44:47], v[140:143]
ds_read_b128 v[84:87], v2 offset:8448
v_mfma_f32_16x16x32_bf16 v[204:207], v[64:67], v[44:47], v[204:207]
ds_read_b128 v[88:91], v2 offset:8704
v_mfma_f32_16x16x32_bf16 v[200:203], v[64:67], v[40:43], v[200:203]
ds_read_b128 v[92:95], v2 offset:8960
v_mfma_f32_16x16x32_bf16 v[196:199], v[64:67], v[36:39], v[196:199]
ds_read_b64_tr_b16 v[112:113], v5 offset:40960
v_mfma_f32_16x16x32_bf16 v[192:195], v[64:67], v[32:35], v[192:195]
ds_read_b64_tr_b16 v[114:115], v5 offset:45056
v_mfma_f32_16x16x32_bf16 v[144:147], v[52:55], v[32:35], v[144:147]
ds_read_b64_tr_b16 v[100:101], v6 offset:24576
v_mfma_f32_16x16x32_bf16 v[148:151], v[52:55], v[36:39], v[148:151]
ds_read_b64_tr_b16 v[102:103], v6 offset:28672
v_mfma_f32_16x16x32_bf16 v[152:155], v[52:55], v[40:43], v[152:155]
ds_read_b64_tr_b16 v[116:117], v6 offset:40960
v_mfma_f32_16x16x32_bf16 v[156:159], v[52:55], v[44:47], v[156:159]
ds_read_b64_tr_b16 v[118:119], v6 offset:45056
v_mfma_f32_16x16x32_bf16 v[220:223], v[68:71], v[44:47], v[220:223]
ds_read_b64_tr_b16 v[104:105], v7 offset:24576
v_mfma_f32_16x16x32_bf16 v[216:219], v[68:71], v[40:43], v[216:219]
ds_read_b64_tr_b16 v[106:107], v7 offset:28672
v_mfma_f32_16x16x32_bf16 v[212:215], v[68:71], v[36:39], v[212:215]
ds_read_b64_tr_b16 v[120:121], v7 offset:40960
v_mfma_f32_16x16x32_bf16 v[208:211], v[68:71], v[32:35], v[208:211]
ds_read_b64_tr_b16 v[122:123], v7 offset:45056
v_mfma_f32_16x16x32_bf16 v[160:163], v[56:59], v[32:35], v[160:163]
ds_read_b64_tr_b16 v[108:109], v8 offset:24576
v_mfma_f32_16x16x32_bf16 v[164:167], v[56:59], v[36:39], v[164:167]
ds_read_b64_tr_b16 v[110:111], v8 offset:28672
v_mfma_f32_16x16x32_bf16 v[168:171], v[56:59], v[40:43], v[168:171]
ds_read_b64_tr_b16 v[124:125], v8 offset:40960
v_mfma_f32_16x16x32_bf16 v[172:175], v[56:59], v[44:47], v[172:175]
ds_read_b64_tr_b16 v[126:127], v8 offset:45056
v_mfma_f32_16x16x32_bf16 v[236:239], v[72:75], v[44:47], v[236:239]
v_mfma_f32_16x16x32_bf16 v[232:235], v[72:75], v[40:43], v[232:235]
v_mfma_f32_16x16x32_bf16 v[228:231], v[72:75], v[36:39], v[228:231]
v_mfma_f32_16x16x32_bf16 v[224:227], v[72:75], v[32:35], v[224:227]
v_mfma_f32_16x16x32_bf16 v[176:179], v[60:63], v[32:35], v[176:179]
v_mfma_f32_16x16x32_bf16 v[180:183], v[60:63], v[36:39], v[180:183]
v_mfma_f32_16x16x32_bf16 v[184:187], v[60:63], v[40:43], v[184:187]
v_mfma_f32_16x16x32_bf16 v[188:191], v[60:63], v[44:47], v[188:191]
v_mfma_f32_16x16x32_bf16 v[252:255], v[76:79], v[44:47], v[252:255]
v_mfma_f32_16x16x32_bf16 v[248:251], v[76:79], v[40:43], v[248:251]
v_mfma_f32_16x16x32_bf16 v[244:247], v[76:79], v[36:39], v[244:247]
v_mfma_f32_16x16x32_bf16 v[240:243], v[76:79], v[32:35], v[240:243]
s_waitcnt lgkmcnt(0)
s_barrier
v_mfma_f32_16x16x32_bf16 v[128:131], v[96:99], v[80:83], v[128:131]
ds_read_b128 v[32:35], v3 offset:0
v_mfma_f32_16x16x32_bf16 v[132:135], v[96:99], v[84:87], v[132:135]
ds_read_b64_tr_b16 v[48:49], v9 offset:16384
v_mfma_f32_16x16x32_bf16 v[136:139], v[96:99], v[88:91], v[136:139]
ds_read_b64_tr_b16 v[50:51], v9 offset:20480
v_mfma_f32_16x16x32_bf16 v[140:143], v[96:99], v[92:95], v[140:143]
ds_read_b128 v[36:39], v3 offset:256
v_mfma_f32_16x16x32_bf16 v[204:207], v[112:115], v[92:95], v[204:207]
ds_read_b128 v[40:43], v3 offset:512
v_mfma_f32_16x16x32_bf16 v[200:203], v[112:115], v[88:91], v[200:203]
ds_read_b128 v[44:47], v3 offset:768
v_mfma_f32_16x16x32_bf16 v[196:199], v[112:115], v[84:87], v[196:199]
ds_read_b64_tr_b16 v[64:65], v9 offset:32768
v_mfma_f32_16x16x32_bf16 v[192:195], v[112:115], v[80:83], v[192:195]
ds_read_b64_tr_b16 v[66:67], v9 offset:36864
v_mfma_f32_16x16x32_bf16 v[144:147], v[100:103], v[80:83], v[144:147]
ds_read_b64_tr_b16 v[52:53], v10 offset:16384
v_mfma_f32_16x16x32_bf16 v[148:151], v[100:103], v[84:87], v[148:151]
ds_read_b64_tr_b16 v[54:55], v10 offset:20480
v_mfma_f32_16x16x32_bf16 v[152:155], v[100:103], v[88:91], v[152:155]
ds_read_b64_tr_b16 v[68:69], v10 offset:32768
v_mfma_f32_16x16x32_bf16 v[156:159], v[100:103], v[92:95], v[156:159]
ds_read_b64_tr_b16 v[70:71], v10 offset:36864
v_mfma_f32_16x16x32_bf16 v[220:223], v[116:119], v[92:95], v[220:223]
ds_read_b64_tr_b16 v[56:57], v11 offset:16384
v_mfma_f32_16x16x32_bf16 v[216:219], v[116:119], v[88:91], v[216:219]
ds_read_b64_tr_b16 v[58:59], v11 offset:20480
v_mfma_f32_16x16x32_bf16 v[212:215], v[116:119], v[84:87], v[212:215]
ds_read_b64_tr_b16 v[72:73], v11 offset:32768
v_mfma_f32_16x16x32_bf16 v[208:211], v[116:119], v[80:83], v[208:211]
ds_read_b64_tr_b16 v[74:75], v11 offset:36864
v_mfma_f32_16x16x32_bf16 v[160:163], v[104:107], v[80:83], v[160:163]
ds_read_b64_tr_b16 v[60:61], v12 offset:16384
v_mfma_f32_16x16x32_bf16 v[164:167], v[104:107], v[84:87], v[164:167]
ds_read_b64_tr_b16 v[62:63], v12 offset:20480
v_mfma_f32_16x16x32_bf16 v[168:171], v[104:107], v[88:91], v[168:171]
ds_read_b64_tr_b16 v[76:77], v12 offset:32768
v_mfma_f32_16x16x32_bf16 v[172:175], v[104:107], v[92:95], v[172:175]
ds_read_b64_tr_b16 v[78:79], v12 offset:36864
v_mfma_f32_16x16x32_bf16 v[236:239], v[120:123], v[92:95], v[236:239]
v_mfma_f32_16x16x32_bf16 v[232:235], v[120:123], v[88:91], v[232:235]
v_mfma_f32_16x16x32_bf16 v[228:231], v[120:123], v[84:87], v[228:231]
v_mfma_f32_16x16x32_bf16 v[224:227], v[120:123], v[80:83], v[224:227]
v_mfma_f32_16x16x32_bf16 v[176:179], v[108:111], v[80:83], v[176:179]
v_mfma_f32_16x16x32_bf16 v[180:183], v[108:111], v[84:87], v[180:183]
v_mfma_f32_16x16x32_bf16 v[184:187], v[108:111], v[88:91], v[184:187]
v_mfma_f32_16x16x32_bf16 v[188:191], v[108:111], v[92:95], v[188:191]
v_mfma_f32_16x16x32_bf16 v[252:255], v[124:127], v[92:95], v[252:255]
v_mfma_f32_16x16x32_bf16 v[248:251], v[124:127], v[88:91], v[248:251]
v_mfma_f32_16x16x32_bf16 v[244:247], v[124:127], v[84:87], v[244:247]
v_mfma_f32_16x16x32_bf16 v[240:243], v[124:127], v[80:83], v[240:243]
s_waitcnt lgkmcnt(0)
v_mfma_f32_16x16x32_bf16 v[128:131], v[48:51], v[32:35], v[128:131]
ds_read_b128 v[80:83], v3 offset:8192
v_mfma_f32_16x16x32_bf16 v[132:135], v[48:51], v[36:39], v[132:135]
ds_read_b64_tr_b16 v[96:97], v9 offset:24576
v_mfma_f32_16x16x32_bf16 v[136:139], v[48:51], v[40:43], v[136:139]
ds_read_b64_tr_b16 v[98:99], v9 offset:28672
v_mfma_f32_16x16x32_bf16 v[140:143], v[48:51], v[44:47], v[140:143]
ds_read_b128 v[84:87], v3 offset:8448
v_mfma_f32_16x16x32_bf16 v[204:207], v[64:67], v[44:47], v[204:207]
ds_read_b128 v[88:91], v3 offset:8704
v_mfma_f32_16x16x32_bf16 v[200:203], v[64:67], v[40:43], v[200:203]
ds_read_b128 v[92:95], v3 offset:8960
v_mfma_f32_16x16x32_bf16 v[196:199], v[64:67], v[36:39], v[196:199]
ds_read_b64_tr_b16 v[112:113], v9 offset:40960
v_mfma_f32_16x16x32_bf16 v[192:195], v[64:67], v[32:35], v[192:195]
ds_read_b64_tr_b16 v[114:115], v9 offset:45056
v_mfma_f32_16x16x32_bf16 v[144:147], v[52:55], v[32:35], v[144:147]
ds_read_b64_tr_b16 v[100:101], v10 offset:24576
v_mfma_f32_16x16x32_bf16 v[148:151], v[52:55], v[36:39], v[148:151]
ds_read_b64_tr_b16 v[102:103], v10 offset:28672
v_mfma_f32_16x16x32_bf16 v[152:155], v[52:55], v[40:43], v[152:155]
ds_read_b64_tr_b16 v[116:117], v10 offset:40960
v_mfma_f32_16x16x32_bf16 v[156:159], v[52:55], v[44:47], v[156:159]
ds_read_b64_tr_b16 v[118:119], v10 offset:45056
v_mfma_f32_16x16x32_bf16 v[220:223], v[68:71], v[44:47], v[220:223]
ds_read_b64_tr_b16 v[104:105], v11 offset:24576
v_mfma_f32_16x16x32_bf16 v[216:219], v[68:71], v[40:43], v[216:219]
ds_read_b64_tr_b16 v[106:107], v11 offset:28672
v_mfma_f32_16x16x32_bf16 v[212:215], v[68:71], v[36:39], v[212:215]
ds_read_b64_tr_b16 v[120:121], v11 offset:40960
v_mfma_f32_16x16x32_bf16 v[208:211], v[68:71], v[32:35], v[208:211]
ds_read_b64_tr_b16 v[122:123], v11 offset:45056
v_mfma_f32_16x16x32_bf16 v[160:163], v[56:59], v[32:35], v[160:163]
ds_read_b64_tr_b16 v[108:109], v12 offset:24576
v_mfma_f32_16x16x32_bf16 v[164:167], v[56:59], v[36:39], v[164:167]
ds_read_b64_tr_b16 v[110:111], v12 offset:28672
v_mfma_f32_16x16x32_bf16 v[168:171], v[56:59], v[40:43], v[168:171]
ds_read_b64_tr_b16 v[124:125], v12 offset:40960
v_mfma_f32_16x16x32_bf16 v[172:175], v[56:59], v[44:47], v[172:175]
ds_read_b64_tr_b16 v[126:127], v12 offset:45056
v_mfma_f32_16x16x32_bf16 v[236:239], v[72:75], v[44:47], v[236:239]
v_mfma_f32_16x16x32_bf16 v[232:235], v[72:75], v[40:43], v[232:235]
v_mfma_f32_16x16x32_bf16 v[228:231], v[72:75], v[36:39], v[228:231]
v_mfma_f32_16x16x32_bf16 v[224:227], v[72:75], v[32:35], v[224:227]
v_mfma_f32_16x16x32_bf16 v[176:179], v[60:63], v[32:35], v[176:179]
v_mfma_f32_16x16x32_bf16 v[180:183], v[60:63], v[36:39], v[180:183]
v_mfma_f32_16x16x32_bf16 v[184:187], v[60:63], v[40:43], v[184:187]
v_mfma_f32_16x16x32_bf16 v[188:191], v[60:63], v[44:47], v[188:191]
v_mfma_f32_16x16x32_bf16 v[252:255], v[76:79], v[44:47], v[252:255]
v_mfma_f32_16x16x32_bf16 v[248:251], v[76:79], v[40:43], v[248:251]
v_mfma_f32_16x16x32_bf16 v[244:247], v[76:79], v[36:39], v[244:247]
v_mfma_f32_16x16x32_bf16 v[240:243], v[76:79], v[32:35], v[240:243]
s_waitcnt lgkmcnt(0)
s_barrier
v_mfma_f32_16x16x32_bf16 v[128:131], v[96:99], v[80:83], v[128:131]
ds_read_b128 v[32:35], v4 offset:0
v_mfma_f32_16x16x32_bf16 v[132:135], v[96:99], v[84:87], v[132:135]
ds_read_b64_tr_b16 v[48:49], v13 offset:16384
v_mfma_f32_16x16x32_bf16 v[136:139], v[96:99], v[88:91], v[136:139]
ds_read_b64_tr_b16 v[50:51], v13 offset:20480
v_mfma_f32_16x16x32_bf16 v[140:143], v[96:99], v[92:95], v[140:143]
ds_read_b128 v[36:39], v4 offset:256
v_mfma_f32_16x16x32_bf16 v[204:207], v[112:115], v[92:95], v[204:207]
ds_read_b128 v[40:43], v4 offset:512
v_mfma_f32_16x16x32_bf16 v[200:203], v[112:115], v[88:91], v[200:203]
ds_read_b128 v[44:47], v4 offset:768
v_mfma_f32_16x16x32_bf16 v[196:199], v[112:115], v[84:87], v[196:199]
ds_read_b64_tr_b16 v[64:65], v13 offset:32768
v_mfma_f32_16x16x32_bf16 v[192:195], v[112:115], v[80:83], v[192:195]
ds_read_b64_tr_b16 v[66:67], v13 offset:36864
v_mfma_f32_16x16x32_bf16 v[144:147], v[100:103], v[80:83], v[144:147]
ds_read_b64_tr_b16 v[52:53], v14 offset:16384
v_mfma_f32_16x16x32_bf16 v[148:151], v[100:103], v[84:87], v[148:151]
ds_read_b64_tr_b16 v[54:55], v14 offset:20480
v_mfma_f32_16x16x32_bf16 v[152:155], v[100:103], v[88:91], v[152:155]
ds_read_b64_tr_b16 v[68:69], v14 offset:32768
v_mfma_f32_16x16x32_bf16 v[156:159], v[100:103], v[92:95], v[156:159]
ds_read_b64_tr_b16 v[70:71], v14 offset:36864
v_mfma_f32_16x16x32_bf16 v[220:223], v[116:119], v[92:95], v[220:223]
ds_read_b64_tr_b16 v[56:57], v15 offset:16384
v_mfma_f32_16x16x32_bf16 v[216:219], v[116:119], v[88:91], v[216:219]
ds_read_b64_tr_b16 v[58:59], v15 offset:20480
v_mfma_f32_16x16x32_bf16 v[212:215], v[116:119], v[84:87], v[212:215]
ds_read_b64_tr_b16 v[72:73], v15 offset:32768
v_mfma_f32_16x16x32_bf16 v[208:211], v[116:119], v[80:83], v[208:211]
ds_read_b64_tr_b16 v[74:75], v15 offset:36864
v_mfma_f32_16x16x32_bf16 v[160:163], v[104:107], v[80:83], v[160:163]
ds_read_b64_tr_b16 v[60:61], v16 offset:16384
v_mfma_f32_16x16x32_bf16 v[164:167], v[104:107], v[84:87], v[164:167]
ds_read_b64_tr_b16 v[62:63], v16 offset:20480
v_mfma_f32_16x16x32_bf16 v[168:171], v[104:107], v[88:91], v[168:171]
ds_read_b64_tr_b16 v[76:77], v16 offset:32768
v_mfma_f32_16x16x32_bf16 v[172:175], v[104:107], v[92:95], v[172:175]
ds_read_b64_tr_b16 v[78:79], v16 offset:36864
v_mfma_f32_16x16x32_bf16 v[236:239], v[120:123], v[92:95], v[236:239]
v_mfma_f32_16x16x32_bf16 v[232:235], v[120:123], v[88:91], v[232:235]
v_mfma_f32_16x16x32_bf16 v[228:231], v[120:123], v[84:87], v[228:231]
v_mfma_f32_16x16x32_bf16 v[224:227], v[120:123], v[80:83], v[224:227]
v_mfma_f32_16x16x32_bf16 v[176:179], v[108:111], v[80:83], v[176:179]
v_mfma_f32_16x16x32_bf16 v[180:183], v[108:111], v[84:87], v[180:183]
v_mfma_f32_16x16x32_bf16 v[184:187], v[108:111], v[88:91], v[184:187]
v_mfma_f32_16x16x32_bf16 v[188:191], v[108:111], v[92:95], v[188:191]
v_mfma_f32_16x16x32_bf16 v[252:255], v[124:127], v[92:95], v[252:255]
v_mfma_f32_16x16x32_bf16 v[248:251], v[124:127], v[88:91], v[248:251]
v_mfma_f32_16x16x32_bf16 v[244:247], v[124:127], v[84:87], v[244:247]
v_mfma_f32_16x16x32_bf16 v[240:243], v[124:127], v[80:83], v[240:243]
s_waitcnt lgkmcnt(0)
v_mfma_f32_16x16x32_bf16 v[128:131], v[48:51], v[32:35], v[128:131]
ds_read_b128 v[80:83], v4 offset:8192
v_mfma_f32_16x16x32_bf16 v[132:135], v[48:51], v[36:39], v[132:135]
ds_read_b64_tr_b16 v[96:97], v13 offset:24576
v_mfma_f32_16x16x32_bf16 v[136:139], v[48:51], v[40:43], v[136:139]
ds_read_b64_tr_b16 v[98:99], v13 offset:28672
v_mfma_f32_16x16x32_bf16 v[140:143], v[48:51], v[44:47], v[140:143]
ds_read_b128 v[84:87], v4 offset:8448
v_mfma_f32_16x16x32_bf16 v[204:207], v[64:67], v[44:47], v[204:207]
ds_read_b128 v[88:91], v4 offset:8704
v_mfma_f32_16x16x32_bf16 v[200:203], v[64:67], v[40:43], v[200:203]
ds_read_b128 v[92:95], v4 offset:8960
v_mfma_f32_16x16x32_bf16 v[196:199], v[64:67], v[36:39], v[196:199]
ds_read_b64_tr_b16 v[112:113], v13 offset:40960
v_mfma_f32_16x16x32_bf16 v[192:195], v[64:67], v[32:35], v[192:195]
ds_read_b64_tr_b16 v[114:115], v13 offset:45056
v_mfma_f32_16x16x32_bf16 v[144:147], v[52:55], v[32:35], v[144:147]
ds_read_b64_tr_b16 v[100:101], v14 offset:24576
v_mfma_f32_16x16x32_bf16 v[148:151], v[52:55], v[36:39], v[148:151]
ds_read_b64_tr_b16 v[102:103], v14 offset:28672
v_mfma_f32_16x16x32_bf16 v[152:155], v[52:55], v[40:43], v[152:155]
ds_read_b64_tr_b16 v[116:117], v14 offset:40960
v_mfma_f32_16x16x32_bf16 v[156:159], v[52:55], v[44:47], v[156:159]
ds_read_b64_tr_b16 v[118:119], v14 offset:45056
v_mfma_f32_16x16x32_bf16 v[220:223], v[68:71], v[44:47], v[220:223]
ds_read_b64_tr_b16 v[104:105], v15 offset:24576
v_mfma_f32_16x16x32_bf16 v[216:219], v[68:71], v[40:43], v[216:219]
ds_read_b64_tr_b16 v[106:107], v15 offset:28672
v_mfma_f32_16x16x32_bf16 v[212:215], v[68:71], v[36:39], v[212:215]
ds_read_b64_tr_b16 v[120:121], v15 offset:40960
v_mfma_f32_16x16x32_bf16 v[208:211], v[68:71], v[32:35], v[208:211]
ds_read_b64_tr_b16 v[122:123], v15 offset:45056
v_mfma_f32_16x16x32_bf16 v[160:163], v[56:59], v[32:35], v[160:163]
ds_read_b64_tr_b16 v[108:109], v16 offset:24576
v_mfma_f32_16x16x32_bf16 v[164:167], v[56:59], v[36:39], v[164:167]
ds_read_b64_tr_b16 v[110:111], v16 offset:28672
v_mfma_f32_16x16x32_bf16 v[168:171], v[56:59], v[40:43], v[168:171]
ds_read_b64_tr_b16 v[124:125], v16 offset:40960
v_mfma_f32_16x16x32_bf16 v[172:175], v[56:59], v[44:47], v[172:175]
ds_read_b64_tr_b16 v[126:127], v16 offset:45056
v_mfma_f32_16x16x32_bf16 v[236:239], v[72:75], v[44:47], v[236:239]
v_mfma_f32_16x16x32_bf16 v[232:235], v[72:75], v[40:43], v[232:235]
v_mfma_f32_16x16x32_bf16 v[228:231], v[72:75], v[36:39], v[228:231]
v_mfma_f32_16x16x32_bf16 v[224:227], v[72:75], v[32:35], v[224:227]
v_mfma_f32_16x16x32_bf16 v[176:179], v[60:63], v[32:35], v[176:179]
v_mfma_f32_16x16x32_bf16 v[180:183], v[60:63], v[36:39], v[180:183]
v_mfma_f32_16x16x32_bf16 v[184:187], v[60:63], v[40:43], v[184:187]
v_mfma_f32_16x16x32_bf16 v[188:191], v[60:63], v[44:47], v[188:191]
v_mfma_f32_16x16x32_bf16 v[252:255], v[76:79], v[44:47], v[252:255]
v_mfma_f32_16x16x32_bf16 v[248:251], v[76:79], v[40:43], v[248:251]
v_mfma_f32_16x16x32_bf16 v[244:247], v[76:79], v[36:39], v[244:247]
v_mfma_f32_16x16x32_bf16 v[240:243], v[76:79], v[32:35], v[240:243]
s_waitcnt lgkmcnt(0)
s_barrier
s_cmp_eq_u32 s36, 3
s_cbranch_scc1 L3h_25
s_add_u32 s42, s42, 1
s_and_b32 s42, s42, 15
s_add_u32 m0, s39, 98304
s_mul_i32 s37, s42, s40
buffer_load_dwordx4 v22, s[8:11], s37 offen sc1 lds
v_mfma_f32_16x16x32_bf16 v[128:131], v[96:99], v[80:83], v[128:131]
v_mfma_f32_16x16x32_bf16 v[132:135], v[96:99], v[84:87], v[132:135]
s_add_u32 m0, s39, 99328
s_add_u32 s37, s37, s38
buffer_load_dwordx4 v23, s[8:11], s37 offen sc1 lds
v_mfma_f32_16x16x32_bf16 v[136:139], v[96:99], v[88:91], v[136:139]
v_mfma_f32_16x16x32_bf16 v[140:143], v[96:99], v[92:95], v[140:143]
s_add_u32 m0, s39, 100352
s_add_u32 s37, s37, s38
buffer_load_dwordx4 v22, s[8:11], s37 offen sc1 lds
v_mfma_f32_16x16x32_bf16 v[204:207], v[112:115], v[92:95], v[204:207]
v_mfma_f32_16x16x32_bf16 v[200:203], v[112:115], v[88:91], v[200:203]
s_add_u32 m0, s39, 101376
s_add_u32 s37, s37, s38
buffer_load_dwordx4 v23, s[8:11], s37 offen sc1 lds
v_mfma_f32_16x16x32_bf16 v[196:199], v[112:115], v[84:87], v[196:199]
v_mfma_f32_16x16x32_bf16 v[192:195], v[112:115], v[80:83], v[192:195]
s_add_u32 m0, s39, 102400
s_add_u32 s37, s37, s38
buffer_load_dwordx4 v22, s[8:11], s37 offen sc1 lds
v_mfma_f32_16x16x32_bf16 v[144:147], v[100:103], v[80:83], v[144:147]
v_mfma_f32_16x16x32_bf16 v[148:151], v[100:103], v[84:87], v[148:151]
s_add_u32 m0, s39, 103424
s_add_u32 s37, s37, s38
buffer_load_dwordx4 v23, s[8:11], s37 offen sc1 lds
v_mfma_f32_16x16x32_bf16 v[152:155], v[100:103], v[88:91], v[152:155]
v_mfma_f32_16x16x32_bf16 v[156:159], v[100:103], v[92:95], v[156:159]
s_add_u32 m0, s39, 104448
s_add_u32 s37, s37, s38
buffer_load_dwordx4 v22, s[8:11], s37 offen sc1 lds
v_mfma_f32_16x16x32_bf16 v[220:223], v[116:119], v[92:95], v[220:223]
v_mfma_f32_16x16x32_bf16 v[216:219], v[116:119], v[88:91], v[216:219]
s_add_u32 m0, s39, 105472
s_add_u32 s37, s37, s38
buffer_load_dwordx4 v23, s[8:11], s37 offen sc1 lds
v_mfma_f32_16x16x32_bf16 v[212:215], v[116:119], v[84:87], v[212:215]
v_mfma_f32_16x16x32_bf16 v[208:211], v[116:119], v[80:83], v[208:211]
s_add_u32 m0, s39, 106496
s_add_u32 s37, s37, s38
buffer_load_dwordx4 v22, s[8:11], s37 offen sc1 lds
v_mfma_f32_16x16x32_bf16 v[160:163], v[104:107], v[80:83], v[160:163]
v_mfma_f32_16x16x32_bf16 v[164:167], v[104:107], v[84:87], v[164:167]
s_add_u32 m0, s39, 107520
s_add_u32 s37, s37, s38
buffer_load_dwordx4 v23, s[8:11], s37 offen sc1 lds
v_mfma_f32_16x16x32_bf16 v[168:171], v[104:107], v[88:91], v[168:171]
v_mfma_f32_16x16x32_bf16 v[172:175], v[104:107], v[92:95], v[172:175]
s_add_u32 m0, s39, 108544
s_add_u32 s37, s37, s38
buffer_load_dwordx4 v22, s[8:11], s37 offen sc1 lds
v_mfma_f32_16x16x32_bf16 v[236:239], v[120:123], v[92:95], v[236:239]
v_mfma_f32_16x16x32_bf16 v[232:235], v[120:123], v[88:91], v[232:235]
s_add_u32 m0, s39, 109568
s_add_u32 s37, s37, s38
buffer_load_dwordx4 v23, s[8:11], s37 offen sc1 lds
v_mfma_f32_16x16x32_bf16 v[228:231], v[120:123], v[84:87], v[228:231]
v_mfma_f32_16x16x32_bf16 v[224:227], v[120:123], v[80:83], v[224:227]
s_add_u32 m0, s39, 110592
s_add_u32 s37, s37, s38
buffer_load_dwordx4 v22, s[8:11], s37 offen sc1 lds
v_mfma_f32_16x16x32_bf16 v[176:179], v[108:111], v[80:83], v[176:179]
v_mfma_f32_16x16x32_bf16 v[180:183], v[108:111], v[84:87], v[180:183]
s_add_u32 m0, s39, 111616
s_add_u32 s37, s37, s38
buffer_load_dwordx4 v23, s[8:11], s37 offen sc1 lds
v_mfma_f32_16x16x32_bf16 v[184:187], v[108:111], v[88:91], v[184:187]
v_mfma_f32_16x16x32_bf16 v[188:191], v[108:111], v[92:95], v[188:191]
s_add_u32 m0, s39, 112640
s_add_u32 s37, s37, s38
buffer_load_dwordx4 v22, s[8:11], s37 offen sc1 lds
v_mfma_f32_16x16x32_bf16 v[252:255], v[124:127], v[92:95], v[252:255]
v_mfma_f32_16x16x32_bf16 v[248:251], v[124:127], v[88:91], v[248:251]
s_add_u32 m0, s39, 113664
s_add_u32 s37, s37, s38
buffer_load_dwordx4 v23, s[8:11], s37 offen sc1 lds
v_mfma_f32_16x16x32_bf16 v[244:247], v[124:127], v[84:87], v[244:247]
v_mfma_f32_16x16x32_bf16 v[240:243], v[124:127], v[80:83], v[240:243]
s_setprio 0
s_lshl_b32 s43, s46, 9
s_add_u32 s43, s43, 147456
v_lshl_add_u32 v19, v17, 3, s43
ds_read_b64 v[80:81], v19 offset:0
ds_read_b64 v[82:83], v19 offset:128
ds_read_b64 v[84:85], v19 offset:256
ds_read_b64 v[86:87], v19 offset:384
s_mul_i32 s43, s47, 256
s_add_u32 s43, s43, 148480
v_lshl_add_u32 v19, v18, 4, s43
ds_read_b128 v[48:51], v19 offset:0
ds_read_b128 v[52:55], v19 offset:64
ds_read_b128 v[56:59], v19 offset:128
ds_read_b128 v[60:63], v19 offset:192
ds_read_b128 v[64:67], v19 offset:896
ds_read_b128 v[68:71], v19 offset:960
ds_read_b128 v[72:75], v19 offset:1024
ds_read_b128 v[76:79], v19 offset:1088
s_waitcnt lgkmcnt(0)
v_mov_b32 v32, v80
v_mul_f32 v88, v81, v81
v_mul_f32 v36, 0xc0135761, v81
v_mul_f32 v89, 0xbdd2d3e8, v81
v_rcp_f32 v44, v88
v_mul_f32 v40, v89, v88
v_mov_b32 v33, v82
v_mul_f32 v88, v83, v83
v_mul_f32 v37, 0xc0135761, v83
v_mul_f32 v89, 0xbdd2d3e8, v83
v_rcp_f32 v45, v88
v_mul_f32 v41, v89, v88
v_mov_b32 v34, v84
v_mul_f32 v88, v85, v85
v_mul_f32 v38, 0xc0135761, v85
v_mul_f32 v89, 0xbdd2d3e8, v85
v_rcp_f32 v46, v88
v_mul_f32 v42, v89, v88
v_mov_b32 v35, v86
v_mul_f32 v88, v87, v87
v_mul_f32 v39, 0xc0135761, v87
v_mul_f32 v89, 0xbdd2d3e8, v87
v_rcp_f32 v47, v88
v_mul_f32 v43, v89, v88
s_barrier
s_add_u32 s42, s42, 1
s_and_b32 s42, s42, 15
s_add_u32 m0, s39, 0
s_mul_i32 s37, s42, s40
buffer_load_dwordx4 v22, s[8:11], s37 offen sc1 lds
v_fma_f32 v128, -v32, v48, v128
v_fma_f32 v129, -v32, v49, v129
v_fma_f32 v130, -v32, v50, v130
v_fma_f32 v131, -v32, v51, v131
s_add_u32 m0, s39, 1024
s_add_u32 s37, s37, s38
buffer_load_dwordx4 v23, s[8:11], s37 offen sc1 lds
v_fma_f32 v192, -v32, v64, v192
v_fma_f32 v193, -v32, v65, v193
v_fma_f32 v194, -v32, v66, v194
s_add_u32 m0, s39, 2048
s_add_u32 s37, s37, s38
buffer_load_dwordx4 v22, s[8:11], s37 offen sc1 lds
v_fma_f32 v195, -v32, v67, v195
v_mul_f32 v80, v128, v128
v_mul_f32 v81, v129, v129
s_add_u32 m0, s39, 3072
s_add_u32 s37, s37, s38
buffer_load_dwordx4 v23, s[8:11], s37 offen sc1 lds
v_mul_f32 v82, v130, v130
v_mul_f32 v83, v131, v131
v_fma_f32 v80, v80, v40, v36
s_add_u32 m0, s39, 4096
s_add_u32 s37, s37, s38
buffer_load_dwordx4 v22, s[8:11], s37 offen sc1 lds
v_fma_f32 v81, v81, v40, v36
v_fma_f32 v82, v82, v40, v36
v_fma_f32 v83, v83, v40, v36
v_mul_f32 v80, v80, v128
s_add_u32 m0, s39, 5120
s_add_u32 s37, s37, s38
buffer_load_dwordx4 v23, s[8:11], s37 offen sc1 lds
v_mul_f32 v81, v81, v129
v_mul_f32 v82, v82, v130
v_mul_f32 v83, v83, v131
s_add_u32 m0, s39, 6144
s_add_u32 s37, s37, s38
buffer_load_dwordx4 v22, s[8:11], s37 offen sc1 lds
v_exp_f32 v80, v80
v_exp_f32 v81, v81
v_exp_f32 v82, v82
s_add_u32 m0, s39, 7168
s_add_u32 s37, s37, s38
buffer_load_dwordx4 v23, s[8:11], s37 offen sc1 lds
v_exp_f32 v83, v83
v_mul_f32 v192, v128, v192
v_mul_f32 v193, v129, v193
s_add_u32 m0, s39, 8192
s_add_u32 s37, s37, s38
buffer_load_dwordx4 v22, s[8:11], s37 offen sc1 lds
v_mul_f32 v194, v130, v194
v_mul_f32 v195, v131, v195
v_fma_f32 v80, v80, v44, v44
v_fma_f32 v81, v81, v44, v44
s_add_u32 m0, s39, 9216
s_add_u32 s37, s37, s38
buffer_load_dwordx4 v23, s[8:11], s37 offen sc1 lds
v_fma_f32 v82, v82, v44, v44
v_fma_f32 v83, v83, v44, v44
v_rcp_f32 v80, v80
s_add_u32 m0, s39, 10240
s_add_u32 s37, s37, s38
buffer_load_dwordx4 v22, s[8:11], s37 offen sc1 lds
v_rcp_f32 v81, v81
v_rcp_f32 v82, v82
v_rcp_f32 v83, v83
s_add_u32 m0, s39, 11264
s_add_u32 s37, s37, s38
buffer_load_dwordx4 v23, s[8:11], s37 offen sc1 lds
v_mul_f32 v192, v192, v80
v_mul_f32 v193, v193, v81
v_mul_f32 v194, v194, v82
s_add_u32 m0, s39, 12288
s_add_u32 s37, s37, s38
buffer_load_dwordx4 v22, s[8:11], s37 offen sc1 lds
v_mul_f32 v195, v195, v83
v_cvt_pk_bf16_f32 v96, v192, v193
v_cvt_pk_bf16_f32 v97, v194, v195
v_fma_f32 v144, -v32, v52, v144
s_add_u32 m0, s39, 13312
s_add_u32 s37, s37, s38
buffer_load_dwordx4 v23, s[8:11], s37 offen sc1 lds
v_fma_f32 v145, -v32, v53, v145
v_fma_f32 v146, -v32, v54, v146
v_fma_f32 v147, -v32, v55, v147
s_add_u32 m0, s39, 14336
s_add_u32 s37, s37, s38
buffer_load_dwordx4 v22, s[8:11], s37 offen sc1 lds
v_fma_f32 v208, -v32, v68, v208
v_fma_f32 v209, -v32, v69, v209
v_fma_f32 v210, -v32, v70, v210
s_add_u32 m0, s39, 15360
s_add_u32 s37, s37, s38
buffer_load_dwordx4 v23, s[8:11], s37 offen sc1 lds
v_fma_f32 v211, -v32, v71, v211
v_mul_f32 v84, v144, v144
v_mul_f32 v85, v145, v145
s_waitcnt vmcnt(16)
s_barrier
s_add_u32 s42, s42, 1
s_and_b32 s42, s42, 15
s_add_u32 m0, s39, 49152
s_mul_i32 s37, s42, s40
buffer_load_dwordx4 v22, s[8:11], s37 offen sc1 lds
v_mul_f32 v86, v146, v146
v_mul_f32 v87, v147, v147
v_fma_f32 v84, v84, v40, v36
v_fma_f32 v85, v85, v40, v36
v_fma_f32 v86, v86, v40, v36
s_add_u32 m0, s39, 50176
s_add_u32 s37, s37, s38
buffer_load_dwordx4 v23, s[8:11], s37 offen sc1 lds
v_fma_f32 v87, v87, v40, v36
v_mul_f32 v84, v84, v144
v_mul_f32 v85, v85, v145
v_mul_f32 v86, v86, v146
v_mul_f32 v87, v87, v147
s_add_u32 m0, s39, 51200
s_add_u32 s37, s37, s38
buffer_load_dwordx4 v22, s[8:11], s37 offen sc1 lds
v_exp_f32 v84, v84
v_exp_f32 v85, v85
v_exp_f32 v86, v86
v_exp_f32 v87, v87
s_add_u32 m0, s39, 52224
s_add_u32 s37, s37, s38
buffer_load_dwordx4 v23, s[8:11], s37 offen sc1 lds
v_mul_f32 v208, v144, v208
v_mul_f32 v209, v145, v209
v_mul_f32 v210, v146, v210
v_mul_f32 v211, v147, v211
v_fma_f32 v84, v84, v44, v44
s_add_u32 m0, s39, 53248
s_add_u32 s37, s37, s38
buffer_load_dwordx4 v22, s[8:11], s37 offen sc1 lds
v_fma_f32 v85, v85, v44, v44
v_fma_f32 v86, v86, v44, v44
v_fma_f32 v87, v87, v44, v44
v_rcp_f32 v84, v84
v_rcp_f32 v85, v85
s_add_u32 m0, s39, 54272
s_add_u32 s37, s37, s38
buffer_load_dwordx4 v23, s[8:11], s37 offen sc1 lds
v_rcp_f32 v86, v86
v_rcp_f32 v87, v87
v_mul_f32 v208, v208, v84
v_mul_f32 v209, v209, v85
s_add_u32 m0, s39, 55296
s_add_u32 s37, s37, s38
buffer_load_dwordx4 v22, s[8:11], s37 offen sc1 lds
v_mul_f32 v210, v210, v86
v_mul_f32 v211, v211, v87
v_cvt_pk_bf16_f32 v98, v208, v209
v_cvt_pk_bf16_f32 v99, v210, v211
s_add_u32 m0, s39, 56320
s_add_u32 s37, s37, s38
buffer_load_dwordx4 v23, s[8:11], s37 offen sc1 lds
v_fma_f32 v132, -v33, v48, v132
v_fma_f32 v133, -v33, v49, v133
v_fma_f32 v134, -v33, v50, v134
v_fma_f32 v135, -v33, v51, v135
s_add_u32 m0, s39, 57344
s_add_u32 s37, s37, s38
buffer_load_dwordx4 v22, s[8:11], s37 offen sc1 lds
v_fma_f32 v196, -v33, v64, v196
v_fma_f32 v197, -v33, v65, v197
v_fma_f32 v198, -v33, v66, v198
v_fma_f32 v199, -v33, v67, v199
v_mul_f32 v80, v132, v132
s_add_u32 m0, s39, 58368
s_add_u32 s37, s37, s38
buffer_load_dwordx4 v23, s[8:11], s37 offen sc1 lds
v_mul_f32 v81, v133, v133
v_mul_f32 v82, v134, v134
v_mul_f32 v83, v135, v135
v_fma_f32 v80, v80, v41, v37
v_fma_f32 v81, v81, v41, v37
s_add_u32 m0, s39, 59392
s_add_u32 s37, s37, s38
buffer_load_dwordx4 v22, s[8:11], s37 offen sc1 lds
v_fma_f32 v82, v82, v41, v37
v_fma_f32 v83, v83, v41, v37
v_mul_f32 v80, v80, v132
v_mul_f32 v81, v81, v133
s_add_u32 m0, s39, 60416
s_add_u32 s37, s37, s38
buffer_load_dwordx4 v23, s[8:11], s37 offen sc1 lds
v_mul_f32 v82, v82, v134
v_lshlrev_b32 v19, 11, v18
v_lshl_add_u32 v19, v17, 4, v19
s_lshl_b32 s43, s46, 10
v_add_u32 v2, s43, v19
s_add_u32 m0, s39, 61440
s_add_u32 s37, s37, s38
buffer_load_dwordx4 v22, s[8:11], s37 offen sc1 lds
v_add_u32 v3, 0x10000, v2
v_lshrrev_b32 v19, 2, v17
v_lshl_add_u32 v20, v18, 2, v19
v_bfe_u32 v21, v20, 1, 2
s_lshl_b32 s43, s47, 1
s_add_u32 m0, s39, 62464
s_add_u32 s37, s37, s38
buffer_load_dwordx4 v23, s[8:11], s37 offen sc1 lds
v_xor_b32 v21, s43, v21
v_lshlrev_b32 v20, 7, v20
v_lshl_add_u32 v20, v21, 5, v20
v_and_b32 v19, 3, v1
s_add_u32 m0, s39, 63488
s_add_u32 s37, s37, s38
buffer_load_dwordx4 v22, s[8:11], s37 offen sc1 lds
v_lshl_add_u32 v20, v19, 3, v20
v_add_u32 v5, 16384, v20
v_xor_b32 v6, 32, v5
v_add_u32 v7, 0x10000, v5
v_add_u32 v8, 0x10000, v6
s_add_u32 m0, s39, 64512
s_add_u32 s37, s37, s38
buffer_load_dwordx4 v23, s[8:11], s37 offen sc1 lds
s_lshl_b32 s43, s36, 13
v_lshl_add_u32 v9, v1, 4, s43
s_mov_b32 s54, 0x10000
s_movk_i32 s52, 0x1000
buffer_store_dwordx4 v[96:99], v27, s[24:27], 0 offen offset:0 sc1
s_waitcnt vmcnt(17)
s_barrier
s_add_u32 s42, s42, 1
s_and_b32 s42, s42, 15
s_add_u32 m0, s39, 98304
s_mul_i32 s37, s42, s40
buffer_load_dwordx4 v22, s[8:11], s37 offen sc1 lds
v_mul_f32 v83, v83, v135
v_exp_f32 v80, v80
v_exp_f32 v81, v81
v_exp_f32 v82, v82
s_add_u32 m0, s39, 99328
s_add_u32 s37, s37, s38
buffer_load_dwordx4 v23, s[8:11], s37 offen sc1 lds
v_exp_f32 v83, v83
v_mul_f32 v196, v132, v196
v_mul_f32 v197, v133, v197
s_add_u32 m0, s39, 100352
s_add_u32 s37, s37, s38
buffer_load_dwordx4 v22, s[8:11], s37 offen sc1 lds
v_mul_f32 v198, v134, v198
v_mul_f32 v199, v135, v199
v_fma_f32 v80, v80, v45, v45
s_add_u32 m0, s39, 101376
s_add_u32 s37, s37, s38
buffer_load_dwordx4 v23, s[8:11], s37 offen sc1 lds
v_fma_f32 v81, v81, v45, v45
v_fma_f32 v82, v82, v45, v45
v_fma_f32 v83, v83, v45, v45
s_add_u32 m0, s39, 102400
s_add_u32 s37, s37, s38
buffer_load_dwordx4 v22, s[8:11], s37 offen sc1 lds
v_rcp_f32 v80, v80
v_rcp_f32 v81, v81
v_rcp_f32 v82, v82
v_rcp_f32 v83, v83
s_add_u32 m0, s39, 103424
s_add_u32 s37, s37, s38
buffer_load_dwordx4 v23, s[8:11], s37 offen sc1 lds
v_mul_f32 v196, v196, v80
v_mul_f32 v197, v197, v81
v_mul_f32 v198, v198, v82
s_add_u32 m0, s39, 104448
s_add_u32 s37, s37, s38
buffer_load_dwordx4 v22, s[8:11], s37 offen sc1 lds
v_mul_f32 v199, v199, v83
v_cvt_pk_bf16_f32 v100, v196, v197
v_cvt_pk_bf16_f32 v101, v198, v199
s_add_u32 m0, s39, 105472
s_add_u32 s37, s37, s38
buffer_load_dwordx4 v23, s[8:11], s37 offen sc1 lds
v_fma_f32 v148, -v33, v52, v148
v_fma_f32 v149, -v33, v53, v149
v_fma_f32 v150, -v33, v54, v150
s_add_u32 m0, s39, 106496
s_add_u32 s37, s37, s38
buffer_load_dwordx4 v22, s[8:11], s37 offen sc1 lds
v_fma_f32 v151, -v33, v55, v151
v_fma_f32 v212, -v33, v68, v212
v_fma_f32 v213, -v33, v69, v213
v_fma_f32 v214, -v33, v70, v214
s_add_u32 m0, s39, 107520
s_add_u32 s37, s37, s38
buffer_load_dwordx4 v23, s[8:11], s37 offen sc1 lds
v_fma_f32 v215, -v33, v71, v215
v_mul_f32 v84, v148, v148
v_mul_f32 v85, v149, v149
s_add_u32 m0, s39, 108544
s_add_u32 s37, s37, s38
buffer_load_dwordx4 v22, s[8:11], s37 offen sc1 lds
v_mul_f32 v86, v150, v150
v_mul_f32 v87, v151, v151
v_fma_f32 v84, v84, v41, v37
s_add_u32 m0, s39, 109568
s_add_u32 s37, s37, s38
buffer_load_dwordx4 v23, s[8:11], s37 offen sc1 lds
v_fma_f32 v85, v85, v41, v37
v_fma_f32 v86, v86, v41, v37
v_fma_f32 v87, v87, v41, v37
s_add_u32 m0, s39, 110592
s_add_u32 s37, s37, s38
buffer_load_dwordx4 v22, s[8:11], s37 offen sc1 lds
v_mul_f32 v84, v84, v148
v_mul_f32 v85, v85, v149
v_mul_f32 v86, v86, v150
v_mul_f32 v87, v87, v151
s_add_u32 m0, s39, 111616
s_add_u32 s37, s37, s38
buffer_load_dwordx4 v23, s[8:11], s37 offen sc1 lds
v_exp_f32 v84, v84
v_exp_f32 v85, v85
v_exp_f32 v86, v86
s_add_u32 m0, s39, 112640
s_add_u32 s37, s37, s38
buffer_load_dwordx4 v22, s[8:11], s37 offen sc1 lds
v_exp_f32 v87, v87
v_mul_f32 v212, v148, v212
v_mul_f32 v213, v149, v213
s_add_u32 m0, s39, 113664
s_add_u32 s37, s37, s38
buffer_load_dwordx4 v23, s[8:11], s37 offen sc1 lds
v_mul_f32 v214, v150, v214
v_mul_f32 v215, v151, v215
v_fma_f32 v84, v84, v45, v45
s_waitcnt vmcnt(17)
s_barrier
s_add_u32 s42, s42, 1
s_and_b32 s42, s42, 15
s_add_u32 m0, s39, 0
s_mul_i32 s37, s42, s40
buffer_load_dwordx4 v22, s[8:11], s37 offen sc1 lds
v_fma_f32 v85, v85, v45, v45
v_fma_f32 v86, v86, v45, v45
v_fma_f32 v87, v87, v45, v45
v_rcp_f32 v84, v84
s_add_u32 m0, s39, 1024
s_add_u32 s37, s37, s38
buffer_load_dwordx4 v23, s[8:11], s37 offen sc1 lds
v_rcp_f32 v85, v85
v_rcp_f32 v86, v86
v_rcp_f32 v87, v87
s_add_u32 m0, s39, 2048
s_add_u32 s37, s37, s38
buffer_load_dwordx4 v22, s[8:11], s37 offen sc1 lds
v_mul_f32 v212, v212, v84
v_mul_f32 v213, v213, v85
v_mul_f32 v214, v214, v86
s_add_u32 m0, s39, 3072
s_add_u32 s37, s37, s38
buffer_load_dwordx4 v23, s[8:11], s37 offen sc1 lds
v_mul_f32 v215, v215, v87
v_cvt_pk_bf16_f32 v102, v212, v213
v_cvt_pk_bf16_f32 v103, v214, v215
s_add_u32 m0, s39, 4096
s_add_u32 s37, s37, s38
buffer_load_dwordx4 v22, s[8:11], s37 offen sc1 lds
v_fma_f32 v136, -v34, v48, v136
v_fma_f32 v137, -v34, v49, v137
v_fma_f32 v138, -v34, v50, v138
s_add_u32 m0, s39, 5120
s_add_u32 s37, s37, s38
buffer_load_dwordx4 v23, s[8:11], s37 offen sc1 lds
v_fma_f32 v139, -v34, v51, v139
v_fma_f32 v200, -v34, v64, v200
v_fma_f32 v201, -v34, v65, v201
s_add_u32 m0, s39, 6144
s_add_u32 s37, s37, s38
buffer_load_dwordx4 v22, s[8:11], s37 offen sc1 lds
v_fma_f32 v202, -v34, v66, v202
v_fma_f32 v203, -v34, v67, v203
v_mul_f32 v80, v136, v136
v_mul_f32 v81, v137, v137
s_add_u32 m0, s39, 7168
s_add_u32 s37, s37, s38
buffer_load_dwordx4 v23, s[8:11], s37 offen sc1 lds
v_mul_f32 v82, v138, v138
v_mul_f32 v83, v139, v139
v_fma_f32 v80, v80, v42, v38
s_add_u32 m0, s39, 8192
s_add_u32 s37, s37, s38
buffer_load_dwordx4 v22, s[8:11], s37 offen sc1 lds
v_fma_f32 v81, v81, v42, v38
v_fma_f32 v82, v82, v42, v38
v_fma_f32 v83, v83, v42, v38
s_add_u32 m0, s39, 9216
s_add_u32 s37, s37, s38
buffer_load_dwordx4 v23, s[8:11], s37 offen sc1 lds
v_mul_f32 v80, v80, v136
v_mul_f32 v81, v81, v137
v_mul_f32 v82, v82, v138
v_mul_f32 v83, v83, v139
s_add_u32 m0, s39, 10240
s_add_u32 s37, s37, s38
buffer_load_dwordx4 v22, s[8:11], s37 offen sc1 lds
v_exp_f32 v80, v80
v_exp_f32 v81, v81
v_exp_f32 v82, v82
s_add_u32 m0, s39, 11264
s_add_u32 s37, s37, s38
buffer_load_dwordx4 v23, s[8:11], s37 offen sc1 lds
v_exp_f32 v83, v83
v_mul_f32 v200, v136, v200
v_mul_f32 v201, v137, v201
s_add_u32 m0, s39, 12288
s_add_u32 s37, s37, s38
buffer_load_dwordx4 v22, s[8:11], s37 offen sc1 lds
v_mul_f32 v202, v138, v202
v_mul_f32 v203, v139, v203
v_fma_f32 v80, v80, v46, v46
v_fma_f32 v81, v81, v46, v46
s_add_u32 m0, s39, 13312
s_add_u32 s37, s37, s38
buffer_load_dwordx4 v23, s[8:11], s37 offen sc1 lds
v_fma_f32 v82, v82, v46, v46
v_fma_f32 v83, v83, v46, v46
v_rcp_f32 v80, v80
s_add_u32 m0, s39, 14336
s_add_u32 s37, s37, s38
buffer_load_dwordx4 v22, s[8:11], s37 offen sc1 lds
v_rcp_f32 v81, v81
v_rcp_f32 v82, v82
v_rcp_f32 v83, v83
s_add_u32 m0, s39, 15360
s_add_u32 s37, s37, s38
buffer_load_dwordx4 v23, s[8:11], s37 offen sc1 lds
v_mul_f32 v200, v200, v80
v_mul_f32 v201, v201, v81
v_mul_f32 v202, v202, v82
buffer_store_dwordx4 v[100:103], v27, s[24:27], 0 offen offset:256 sc1
s_waitcnt vmcnt(17)
s_barrier
s_add_u32 s42, s42, 1
s_and_b32 s42, s42, 15
s_add_u32 m0, s39, 49152
s_mul_i32 s37, s42, s40
buffer_load_dwordx4 v22, s[8:11], s37 offen sc1 lds
v_mul_f32 v203, v203, v83
v_cvt_pk_bf16_f32 v104, v200, v201
v_cvt_pk_bf16_f32 v105, v202, v203
v_fma_f32 v152, -v34, v52, v152
s_add_u32 m0, s39, 50176
s_add_u32 s37, s37, s38
buffer_load_dwordx4 v23, s[8:11], s37 offen sc1 lds
v_fma_f32 v153, -v34, v53, v153
v_fma_f32 v154, -v34, v54, v154
v_fma_f32 v155, -v34, v55, v155
s_add_u32 m0, s39, 51200
s_add_u32 s37, s37, s38
buffer_load_dwordx4 v22, s[8:11], s37 offen sc1 lds
v_fma_f32 v216, -v34, v68, v216
v_fma_f32 v217, -v34, v69, v217
v_fma_f32 v218, -v34, v70, v218
s_add_u32 m0, s39, 52224
s_add_u32 s37, s37, s38
buffer_load_dwordx4 v23, s[8:11], s37 offen sc1 lds
v_fma_f32 v219, -v34, v71, v219
v_mul_f32 v84, v152, v152
v_mul_f32 v85, v153, v153
s_add_u32 m0, s39, 53248
s_add_u32 s37, s37, s38
buffer_load_dwordx4 v22, s[8:11], s37 offen sc1 lds
v_mul_f32 v86, v154, v154
v_mul_f32 v87, v155, v155
v_fma_f32 v84, v84, v42, v38
v_fma_f32 v85, v85, v42, v38
s_add_u32 m0, s39, 54272
s_add_u32 s37, s37, s38
buffer_load_dwordx4 v23, s[8:11], s37 offen sc1 lds
v_fma_f32 v86, v86, v42, v38
v_fma_f32 v87, v87, v42, v38
v_mul_f32 v84, v84, v152
s_add_u32 m0, s39, 55296
s_add_u32 s37, s37, s38
buffer_load_dwordx4 v22, s[8:11], s37 offen sc1 lds
v_mul_f32 v85, v85, v153
v_mul_f32 v86, v86, v154
v_mul_f32 v87, v87, v155
s_add_u32 m0, s39, 56320
s_add_u32 s37, s37, s38
buffer_load_dwordx4 v23, s[8:11], s37 offen sc1 lds
v_exp_f32 v84, v84
v_exp_f32 v85, v85
v_exp_f32 v86, v86
s_add_u32 m0, s39, 57344
s_add_u32 s37, s37, s38
buffer_load_dwordx4 v22, s[8:11], s37 offen sc1 lds
v_exp_f32 v87, v87
v_mul_f32 v216, v152, v216
v_mul_f32 v217, v153, v217
v_mul_f32 v218, v154, v218
s_add_u32 m0, s39, 58368
s_add_u32 s37, s37, s38
buffer_load_dwordx4 v23, s[8:11], s37 offen sc1 lds
v_mul_f32 v219, v155, v219
v_fma_f32 v84, v84, v46, v46
v_fma_f32 v85, v85, v46, v46
s_add_u32 m0, s39, 59392
s_add_u32 s37, s37, s38
buffer_load_dwordx4 v22, s[8:11], s37 offen sc1 lds
v_fma_f32 v86, v86, v46, v46
v_fma_f32 v87, v87, v46, v46
v_rcp_f32 v84, v84
s_add_u32 m0, s39, 60416
s_add_u32 s37, s37, s38
buffer_load_dwordx4 v23, s[8:11], s37 offen sc1 lds
v_rcp_f32 v85, v85
v_rcp_f32 v86, v86
v_rcp_f32 v87, v87
s_add_u32 m0, s39, 61440
s_add_u32 s37, s37, s38
buffer_load_dwordx4 v22, s[8:11], s37 offen sc1 lds
v_mul_f32 v216, v216, v84
v_mul_f32 v217, v217, v85
v_mul_f32 v218, v218, v86
v_mul_f32 v219, v219, v87
s_add_u32 m0, s39, 62464
s_add_u32 s37, s37, s38
buffer_load_dwordx4 v23, s[8:11], s37 offen sc1 lds
v_cvt_pk_bf16_f32 v106, v216, v217
v_cvt_pk_bf16_f32 v107, v218, v219
s_add_u32 m0, s39, 63488
s_add_u32 s37, s37, s38
buffer_load_dwordx4 v22, s[8:11], s37 offen sc1 lds
v_fma_f32 v140, -v35, v48, v140
v_fma_f32 v141, -v35, v49, v141
v_fma_f32 v142, -v35, v50, v142
s_add_u32 m0, s39, 64512
s_add_u32 s37, s37, s38
buffer_load_dwordx4 v23, s[8:11], s37 offen sc1 lds
v_fma_f32 v143, -v35, v51, v143
v_fma_f32 v204, -v35, v64, v204
v_fma_f32 v205, -v35, v65, v205
buffer_store_dwordx4 v[104:107], v27, s[24:27], 0 offen offset:512 sc1
s_waitcnt vmcnt(18)
s_barrier
s_add_u32 s42, s42, 1
s_and_b32 s42, s42, 15
s_add_u32 m0, s39, 98304
s_mul_i32 s37, s42, s40
buffer_load_dwordx4 v22, s[8:11], s37 offen sc1 lds
v_fma_f32 v206, -v35, v66, v206
v_fma_f32 v207, -v35, v67, v207
v_mul_f32 v80, v140, v140
v_mul_f32 v81, v141, v141
s_add_u32 m0, s39, 99328
s_add_u32 s37, s37, s38
buffer_load_dwordx4 v23, s[8:11], s37 offen sc1 lds
v_mul_f32 v82, v142, v142
v_mul_f32 v83, v143, v143
v_fma_f32 v80, v80, v43, v39
s_add_u32 m0, s39, 100352
s_add_u32 s37, s37, s38
buffer_load_dwordx4 v22, s[8:11], s37 offen sc1 lds
v_fma_f32 v81, v81, v43, v39
v_fma_f32 v82, v82, v43, v39
v_fma_f32 v83, v83, v43, v39
s_add_u32 m0, s39, 101376
s_add_u32 s37, s37, s38
buffer_load_dwordx4 v23, s[8:11], s37 offen sc1 lds
v_mul_f32 v80, v80, v140
v_mul_f32 v81, v81, v141
v_mul_f32 v82, v82, v142
s_add_u32 m0, s39, 102400
s_add_u32 s37, s37, s38
buffer_load_dwordx4 v22, s[8:11], s37 offen sc1 lds
v_mul_f32 v83, v83, v143
v_exp_f32 v80, v80
v_exp_f32 v81, v81
v_exp_f32 v82, v82
s_add_u32 m0, s39, 103424
s_add_u32 s37, s37, s38
buffer_load_dwordx4 v23, s[8:11], s37 offen sc1 lds
v_exp_f32 v83, v83
v_mul_f32 v204, v140, v204
v_mul_f32 v205, v141, v205
s_add_u32 m0, s39, 104448
s_add_u32 s37, s37, s38
buffer_load_dwordx4 v22, s[8:11], s37 offen sc1 lds
v_mul_f32 v206, v142, v206
v_mul_f32 v207, v143, v207
v_fma_f32 v80, v80, v47, v47
s_add_u32 m0, s39, 105472
s_add_u32 s37, s37, s38
buffer_load_dwordx4 v23, s[8:11], s37 offen sc1 lds
v_fma_f32 v81, v81, v47, v47
v_fma_f32 v82, v82, v47, v47
v_fma_f32 v83, v83, v47, v47
s_add_u32 m0, s39, 106496
s_add_u32 s37, s37, s38
buffer_load_dwordx4 v22, s[8:11], s37 offen sc1 lds
v_rcp_f32 v80, v80
v_rcp_f32 v81, v81
v_rcp_f32 v82, v82
v_rcp_f32 v83, v83
s_add_u32 m0, s39, 107520
s_add_u32 s37, s37, s38
buffer_load_dwordx4 v23, s[8:11], s37 offen sc1 lds
v_mul_f32 v204, v204, v80
v_mul_f32 v205, v205, v81
v_mul_f32 v206, v206, v82
s_add_u32 m0, s39, 108544
s_add_u32 s37, s37, s38
buffer_load_dwordx4 v22, s[8:11], s37 offen sc1 lds
v_mul_f32 v207, v207, v83
v_cvt_pk_bf16_f32 v108, v204, v205
v_cvt_pk_bf16_f32 v109, v206, v207
s_add_u32 m0, s39, 109568
s_add_u32 s37, s37, s38
buffer_load_dwordx4 v23, s[8:11], s37 offen sc1 lds
v_fma_f32 v156, -v35, v52, v156
v_fma_f32 v157, -v35, v53, v157
v_fma_f32 v158, -v35, v54, v158
s_add_u32 m0, s39, 110592
s_add_u32 s37, s37, s38
buffer_load_dwordx4 v22, s[8:11], s37 offen sc1 lds
v_fma_f32 v159, -v35, v55, v159
v_fma_f32 v220, -v35, v68, v220
v_fma_f32 v221, -v35, v69, v221
v_fma_f32 v222, -v35, v70, v222
s_add_u32 m0, s39, 111616
s_add_u32 s37, s37, s38
buffer_load_dwordx4 v23, s[8:11], s37 offen sc1 lds
v_fma_f32 v223, -v35, v71, v223
v_mul_f32 v84, v156, v156
v_mul_f32 v85, v157, v157
s_add_u32 m0, s39, 112640
s_add_u32 s37, s37, s38
buffer_load_dwordx4 v22, s[8:11], s37 offen sc1 lds
v_mul_f32 v86, v158, v158
v_mul_f32 v87, v159, v159
v_fma_f32 v84, v84, v43, v39
s_add_u32 m0, s39, 113664
s_add_u32 s37, s37, s38
buffer_load_dwordx4 v23, s[8:11], s37 offen sc1 lds
v_fma_f32 v85, v85, v43, v39
v_fma_f32 v86, v86, v43, v39
v_fma_f32 v87, v87, v43, v39
s_waitcnt vmcnt(17)
s_barrier
s_add_u32 s42, s42, 1
s_and_b32 s42, s42, 15
s_add_u32 m0, s39, 0
s_mul_i32 s37, s42, s40
buffer_load_dwordx4 v22, s[8:11], s37 offen sc1 lds
v_mul_f32 v84, v84, v156
v_mul_f32 v85, v85, v157
v_mul_f32 v86, v86, v158
v_mul_f32 v87, v87, v159
s_add_u32 m0, s39, 1024
s_add_u32 s37, s37, s38
buffer_load_dwordx4 v23, s[8:11], s37 offen sc1 lds
v_exp_f32 v84, v84
v_exp_f32 v85, v85
v_exp_f32 v86, v86
s_add_u32 m0, s39, 2048
s_add_u32 s37, s37, s38
buffer_load_dwordx4 v22, s[8:11], s37 offen sc1 lds
v_exp_f32 v87, v87
v_mul_f32 v220, v156, v220
v_mul_f32 v221, v157, v221
s_add_u32 m0, s39, 3072
s_add_u32 s37, s37, s38
buffer_load_dwordx4 v23, s[8:11], s37 offen sc1 lds
v_mul_f32 v222, v158, v222
v_mul_f32 v223, v159, v223
v_fma_f32 v84, v84, v47, v47
v_fma_f32 v85, v85, v47, v47
s_add_u32 m0, s39, 4096
s_add_u32 s37, s37, s38
buffer_load_dwordx4 v22, s[8:11], s37 offen sc1 lds
v_fma_f32 v86, v86, v47, v47
v_fma_f32 v87, v87, v47, v47
v_rcp_f32 v84, v84
s_add_u32 m0, s39, 5120
s_add_u32 s37, s37, s38
buffer_load_dwordx4 v23, s[8:11], s37 offen sc1 lds
v_rcp_f32 v85, v85
v_rcp_f32 v86, v86
v_rcp_f32 v87, v87
s_add_u32 m0, s39, 6144
s_add_u32 s37, s37, s38
buffer_load_dwordx4 v22, s[8:11], s37 offen sc1 lds
v_mul_f32 v220, v220, v84
v_mul_f32 v221, v221, v85
v_mul_f32 v222, v222, v86
v_mul_f32 v223, v223, v87
s_add_u32 m0, s39, 7168
s_add_u32 s37, s37, s38
buffer_load_dwordx4 v23, s[8:11], s37 offen sc1 lds
v_cvt_pk_bf16_f32 v110, v220, v221
v_cvt_pk_bf16_f32 v111, v222, v223
s_add_u32 m0, s39, 8192
s_add_u32 s37, s37, s38
buffer_load_dwordx4 v22, s[8:11], s37 offen sc1 lds
v_fma_f32 v160, -v32, v56, v160
v_fma_f32 v161, -v32, v57, v161
v_fma_f32 v162, -v32, v58, v162
s_add_u32 m0, s39, 9216
s_add_u32 s37, s37, s38
buffer_load_dwordx4 v23, s[8:11], s37 offen sc1 lds
v_fma_f32 v163, -v32, v59, v163
v_fma_f32 v224, -v32, v72, v224
v_fma_f32 v225, -v32, v73, v225
v_fma_f32 v226, -v32, v74, v226
s_add_u32 m0, s39, 10240
s_add_u32 s37, s37, s38
buffer_load_dwordx4 v22, s[8:11], s37 offen sc1 lds
v_fma_f32 v227, -v32, v75, v227
v_mul_f32 v80, v160, v160
v_mul_f32 v81, v161, v161
s_add_u32 m0, s39, 11264
s_add_u32 s37, s37, s38
buffer_load_dwordx4 v23, s[8:11], s37 offen sc1 lds
v_mul_f32 v82, v162, v162
v_mul_f32 v83, v163, v163
v_fma_f32 v80, v80, v40, v36
s_add_u32 m0, s39, 12288
s_add_u32 s37, s37, s38
buffer_load_dwordx4 v22, s[8:11], s37 offen sc1 lds
v_fma_f32 v81, v81, v40, v36
v_fma_f32 v82, v82, v40, v36
v_fma_f32 v83, v83, v40, v36
v_mul_f32 v80, v80, v160
s_add_u32 m0, s39, 13312
s_add_u32 s37, s37, s38
buffer_load_dwordx4 v23, s[8:11], s37 offen sc1 lds
v_mul_f32 v81, v81, v161
v_mul_f32 v82, v82, v162
v_mul_f32 v83, v83, v163
s_add_u32 m0, s39, 14336
s_add_u32 s37, s37, s38
buffer_load_dwordx4 v22, s[8:11], s37 offen sc1 lds
v_exp_f32 v80, v80
v_exp_f32 v81, v81
v_exp_f32 v82, v82
s_add_u32 m0, s39, 15360
s_add_u32 s37, s37, s38
buffer_load_dwordx4 v23, s[8:11], s37 offen sc1 lds
v_exp_f32 v83, v83
v_mul_f32 v224, v160, v224
v_mul_f32 v225, v161, v225
buffer_store_dwordx4 v[108:111], v27, s[24:27], 0 offen offset:768 sc1
s_waitcnt vmcnt(17)
s_barrier
s_add_u32 s42, s42, 1
s_and_b32 s42, s42, 15
s_add_u32 m0, s39, 49152
s_mul_i32 s37, s42, s40
buffer_load_dwordx4 v22, s[8:11], s37 offen sc1 lds
v_mul_f32 v226, v162, v226
v_mul_f32 v227, v163, v227
v_fma_f32 v80, v80, v44, v44
v_fma_f32 v81, v81, v44, v44
s_add_u32 m0, s39, 50176
s_add_u32 s37, s37, s38
buffer_load_dwordx4 v23, s[8:11], s37 offen sc1 lds
v_fma_f32 v82, v82, v44, v44
v_fma_f32 v83, v83, v44, v44
v_rcp_f32 v80, v80
v_rcp_f32 v81, v81
s_add_u32 m0, s39, 51200
s_add_u32 s37, s37, s38
buffer_load_dwordx4 v22, s[8:11], s37 offen sc1 lds
v_rcp_f32 v82, v82
v_rcp_f32 v83, v83
v_mul_f32 v224, v224, v80
v_mul_f32 v225, v225, v81
s_add_u32 m0, s39, 52224
s_add_u32 s37, s37, s38
buffer_load_dwordx4 v23, s[8:11], s37 offen sc1 lds
v_mul_f32 v226, v226, v82
v_mul_f32 v227, v227, v83
v_cvt_pk_bf16_f32 v96, v224, v225
v_cvt_pk_bf16_f32 v97, v226, v227
s_add_u32 m0, s39, 53248
s_add_u32 s37, s37, s38
buffer_load_dwordx4 v22, s[8:11], s37 offen sc1 lds
v_fma_f32 v176, -v32, v60, v176
v_fma_f32 v177, -v32, v61, v177
v_fma_f32 v178, -v32, v62, v178
v_fma_f32 v179, -v32, v63, v179
s_add_u32 m0, s39, 54272
s_add_u32 s37, s37, s38
buffer_load_dwordx4 v23, s[8:11], s37 offen sc1 lds
v_fma_f32 v240, -v32, v76, v240
v_fma_f32 v241, -v32, v77, v241
v_fma_f32 v242, -v32, v78, v242
v_fma_f32 v243, -v32, v79, v243
s_add_u32 m0, s39, 55296
s_add_u32 s37, s37, s38
buffer_load_dwordx4 v22, s[8:11], s37 offen sc1 lds
v_mul_f32 v84, v176, v176
v_mul_f32 v85, v177, v177
v_mul_f32 v86, v178, v178
v_mul_f32 v87, v179, v179
s_add_u32 m0, s39, 56320
s_add_u32 s37, s37, s38
buffer_load_dwordx4 v23, s[8:11], s37 offen sc1 lds
v_fma_f32 v84, v84, v40, v36
v_fma_f32 v85, v85, v40, v36
v_fma_f32 v86, v86, v40, v36
s_add_u32 m0, s39, 57344
s_add_u32 s37, s37, s38
buffer_load_dwordx4 v22, s[8:11], s37 offen sc1 lds
v_fma_f32 v87, v87, v40, v36
v_mul_f32 v84, v84, v176
v_mul_f32 v85, v85, v177
v_mul_f32 v86, v86, v178
s_add_u32 m0, s39, 58368
s_add_u32 s37, s37, s38
buffer_load_dwordx4 v23, s[8:11], s37 offen sc1 lds
v_mul_f32 v87, v87, v179
v_exp_f32 v84, v84
v_exp_f32 v85, v85
v_exp_f32 v86, v86
s_add_u32 m0, s39, 59392
s_add_u32 s37, s37, s38
buffer_load_dwordx4 v22, s[8:11], s37 offen sc1 lds
v_exp_f32 v87, v87
v_mul_f32 v240, v176, v240
v_mul_f32 v241, v177, v241
v_mul_f32 v242, v178, v242
s_add_u32 m0, s39, 60416
s_add_u32 s37, s37, s38
buffer_load_dwordx4 v23, s[8:11], s37 offen sc1 lds
v_mul_f32 v243, v179, v243
v_fma_f32 v84, v84, v44, v44
v_fma_f32 v85, v85, v44, v44
v_fma_f32 v86, v86, v44, v44
s_add_u32 m0, s39, 61440
s_add_u32 s37, s37, s38
buffer_load_dwordx4 v22, s[8:11], s37 offen sc1 lds
v_fma_f32 v87, v87, v44, v44
v_rcp_f32 v84, v84
v_rcp_f32 v85, v85
v_rcp_f32 v86, v86
s_add_u32 m0, s39, 62464
s_add_u32 s37, s37, s38
buffer_load_dwordx4 v23, s[8:11], s37 offen sc1 lds
v_rcp_f32 v87, v87
v_lshlrev_b32 v19, 11, v18
v_lshl_add_u32 v19, v17, 4, v19
s_lshl_b32 s43, s46, 10
s_add_u32 m0, s39, 63488
s_add_u32 s37, s37, s38
buffer_load_dwordx4 v22, s[8:11], s37 offen sc1 lds
s_lshl_b32 s44, s47, 13
v_add3_u32 v208, v19, s43, 0
v_add_u32 v208, s44, v208
buffer_load_dwordx4 v[192:195], v208, s[20:23], 0 offen offset:0 sc1
s_add_u32 m0, s39, 64512
s_add_u32 s37, s37, s38
buffer_load_dwordx4 v23, s[8:11], s37 offen sc1 lds
buffer_load_dwordx4 v[196:199], v208, s[20:23], 0 offen offset:256 sc1
buffer_load_dwordx4 v[200:203], v208, s[20:23], 0 offen offset:512 sc1
buffer_load_dwordx4 v[204:207], v208, s[20:23], 0 offen offset:768 sc1
s_waitcnt vmcnt(20)
s_barrier
s_add_u32 s42, s42, 1
s_and_b32 s42, s42, 15
s_add_u32 m0, s39, 98304
s_mul_i32 s37, s42, s40
buffer_load_dwordx4 v22, s[8:11], s37 offen sc1 lds
v_mul_f32 v240, v240, v84
v_mul_f32 v241, v241, v85
v_mul_f32 v242, v242, v86
v_mul_f32 v243, v243, v87
s_add_u32 m0, s39, 99328
s_add_u32 s37, s37, s38
buffer_load_dwordx4 v23, s[8:11], s37 offen sc1 lds
v_cvt_pk_bf16_f32 v98, v240, v241
v_cvt_pk_bf16_f32 v99, v242, v243
s_add_u32 m0, s39, 100352
s_add_u32 s37, s37, s38
buffer_load_dwordx4 v22, s[8:11], s37 offen sc1 lds
v_fma_f32 v164, -v33, v56, v164
v_fma_f32 v165, -v33, v57, v165
v_fma_f32 v166, -v33, v58, v166
s_add_u32 m0, s39, 101376
s_add_u32 s37, s37, s38
buffer_load_dwordx4 v23, s[8:11], s37 offen sc1 lds
v_fma_f32 v167, -v33, v59, v167
v_fma_f32 v228, -v33, v72, v228
v_fma_f32 v229, -v33, v73, v229
s_add_u32 m0, s39, 102400
s_add_u32 s37, s37, s38
buffer_load_dwordx4 v22, s[8:11], s37 offen sc1 lds
v_fma_f32 v230, -v33, v74, v230
v_fma_f32 v231, -v33, v75, v231
v_mul_f32 v80, v164, v164
v_mul_f32 v81, v165, v165
s_add_u32 m0, s39, 103424
s_add_u32 s37, s37, s38
buffer_load_dwordx4 v23, s[8:11], s37 offen sc1 lds
v_mul_f32 v82, v166, v166
v_mul_f32 v83, v167, v167
v_fma_f32 v80, v80, v41, v37
s_add_u32 m0, s39, 104448
s_add_u32 s37, s37, s38
buffer_load_dwordx4 v22, s[8:11], s37 offen sc1 lds
v_fma_f32 v81, v81, v41, v37
v_fma_f32 v82, v82, v41, v37
v_fma_f32 v83, v83, v41, v37
s_add_u32 m0, s39, 105472
s_add_u32 s37, s37, s38
buffer_load_dwordx4 v23, s[8:11], s37 offen sc1 lds
v_mul_f32 v80, v80, v164
v_mul_f32 v81, v81, v165
v_mul_f32 v82, v82, v166
s_add_u32 m0, s39, 106496
s_add_u32 s37, s37, s38
buffer_load_dwordx4 v22, s[8:11], s37 offen sc1 lds
v_mul_f32 v83, v83, v167
v_exp_f32 v80, v80
v_exp_f32 v81, v81
v_exp_f32 v82, v82
s_add_u32 m0, s39, 107520
s_add_u32 s37, s37, s38
buffer_load_dwordx4 v23, s[8:11], s37 offen sc1 lds
v_exp_f32 v83, v83
v_mul_f32 v228, v164, v228
v_mul_f32 v229, v165, v229
s_add_u32 m0, s39, 108544
s_add_u32 s37, s37, s38
buffer_load_dwordx4 v22, s[8:11], s37 offen sc1 lds
v_mul_f32 v230, v166, v230
v_mul_f32 v231, v167, v231
v_fma_f32 v80, v80, v45, v45
s_add_u32 m0, s39, 109568
s_add_u32 s37, s37, s38
buffer_load_dwordx4 v23, s[8:11], s37 offen sc1 lds
v_fma_f32 v81, v81, v45, v45
v_fma_f32 v82, v82, v45, v45
v_fma_f32 v83, v83, v45, v45
s_add_u32 m0, s39, 110592
s_add_u32 s37, s37, s38
buffer_load_dwordx4 v22, s[8:11], s37 offen sc1 lds
v_rcp_f32 v80, v80
v_rcp_f32 v81, v81
v_rcp_f32 v82, v82
v_rcp_f32 v83, v83
s_add_u32 m0, s39, 111616
s_add_u32 s37, s37, s38
buffer_load_dwordx4 v23, s[8:11], s37 offen sc1 lds
v_mul_f32 v228, v228, v80
v_mul_f32 v229, v229, v81
v_mul_f32 v230, v230, v82
s_add_u32 m0, s39, 112640
s_add_u32 s37, s37, s38
buffer_load_dwordx4 v22, s[8:11], s37 offen sc1 lds
v_mul_f32 v231, v231, v83
v_cvt_pk_bf16_f32 v100, v228, v229
v_cvt_pk_bf16_f32 v101, v230, v231
s_add_u32 m0, s39, 113664
s_add_u32 s37, s37, s38
buffer_load_dwordx4 v23, s[8:11], s37 offen sc1 lds
v_fma_f32 v180, -v33, v60, v180
v_fma_f32 v181, -v33, v61, v181
v_fma_f32 v182, -v33, v62, v182
buffer_store_dwordx4 v[96:99], v27, s[24:27], s53 offen offset:0 sc1
s_waitcnt vmcnt(20)
s_barrier
s_add_u32 s42, s42, 1
s_and_b32 s42, s42, 15
s_add_u32 m0, s39, 0
s_mul_i32 s37, s42, s40
buffer_load_dwordx4 v22, s[8:11], s37 offen sc1 lds
v_fma_f32 v183, -v33, v63, v183
v_fma_f32 v244, -v33, v76, v244
v_fma_f32 v245, -v33, v77, v245
v_fma_f32 v246, -v33, v78, v246
s_add_u32 m0, s39, 1024
s_add_u32 s37, s37, s38
buffer_load_dwordx4 v23, s[8:11], s37 offen sc1 lds
v_fma_f32 v247, -v33, v79, v247
v_mul_f32 v84, v180, v180
v_mul_f32 v85, v181, v181
s_add_u32 m0, s39, 2048
s_add_u32 s37, s37, s38
buffer_load_dwordx4 v22, s[8:11], s37 offen sc1 lds
v_mul_f32 v86, v182, v182
v_mul_f32 v87, v183, v183
v_fma_f32 v84, v84, v41, v37
s_add_u32 m0, s39, 3072
s_add_u32 s37, s37, s38
buffer_load_dwordx4 v23, s[8:11], s37 offen sc1 lds
v_fma_f32 v85, v85, v41, v37
v_fma_f32 v86, v86, v41, v37
v_fma_f32 v87, v87, v41, v37
v_mul_f32 v84, v84, v180
s_add_u32 m0, s39, 4096
s_add_u32 s37, s37, s38
buffer_load_dwordx4 v22, s[8:11], s37 offen sc1 lds
v_mul_f32 v85, v85, v181
v_mul_f32 v86, v86, v182
v_mul_f32 v87, v87, v183
s_add_u32 m0, s39, 5120
s_add_u32 s37, s37, s38
buffer_load_dwordx4 v23, s[8:11], s37 offen sc1 lds
v_exp_f32 v84, v84
v_exp_f32 v85, v85
v_exp_f32 v86, v86
s_add_u32 m0, s39, 6144
s_add_u32 s37, s37, s38
buffer_load_dwordx4 v22, s[8:11], s37 offen sc1 lds
v_exp_f32 v87, v87
v_mul_f32 v244, v180, v244
v_mul_f32 v245, v181, v245
v_mul_f32 v246, v182, v246
s_add_u32 m0, s39, 7168
s_add_u32 s37, s37, s38
buffer_load_dwordx4 v23, s[8:11], s37 offen sc1 lds
v_mul_f32 v247, v183, v247
v_fma_f32 v84, v84, v45, v45
v_fma_f32 v85, v85, v45, v45
s_add_u32 m0, s39, 8192
s_add_u32 s37, s37, s38
buffer_load_dwordx4 v22, s[8:11], s37 offen sc1 lds
v_fma_f32 v86, v86, v45, v45
v_fma_f32 v87, v87, v45, v45
v_rcp_f32 v84, v84
s_add_u32 m0, s39, 9216
s_add_u32 s37, s37, s38
buffer_load_dwordx4 v23, s[8:11], s37 offen sc1 lds
v_rcp_f32 v85, v85
v_rcp_f32 v86, v86
v_rcp_f32 v87, v87
v_mul_f32 v244, v244, v84
s_add_u32 m0, s39, 10240
s_add_u32 s37, s37, s38
buffer_load_dwordx4 v22, s[8:11], s37 offen sc1 lds
v_mul_f32 v245, v245, v85
v_mul_f32 v246, v246, v86
v_mul_f32 v247, v247, v87
s_add_u32 m0, s39, 11264
s_add_u32 s37, s37, s38
buffer_load_dwordx4 v23, s[8:11], s37 offen sc1 lds
v_cvt_pk_bf16_f32 v102, v244, v245
v_cvt_pk_bf16_f32 v103, v246, v247
s_add_u32 m0, s39, 12288
s_add_u32 s37, s37, s38
buffer_load_dwordx4 v22, s[8:11], s37 offen sc1 lds
v_fma_f32 v168, -v34, v56, v168
v_fma_f32 v169, -v34, v57, v169
v_fma_f32 v170, -v34, v58, v170
v_fma_f32 v171, -v34, v59, v171
s_add_u32 m0, s39, 13312
s_add_u32 s37, s37, s38
buffer_load_dwordx4 v23, s[8:11], s37 offen sc1 lds
v_fma_f32 v232, -v34, v72, v232
v_fma_f32 v233, -v34, v73, v233
v_fma_f32 v234, -v34, v74, v234
s_add_u32 m0, s39, 14336
s_add_u32 s37, s37, s38
buffer_load_dwordx4 v22, s[8:11], s37 offen sc1 lds
v_fma_f32 v235, -v34, v75, v235
v_mul_f32 v80, v168, v168
v_mul_f32 v81, v169, v169
s_add_u32 m0, s39, 15360
s_add_u32 s37, s37, s38
buffer_load_dwordx4 v23, s[8:11], s37 offen sc1 lds
v_mul_f32 v82, v170, v170
v_mul_f32 v83, v171, v171
v_fma_f32 v80, v80, v42, v38
buffer_store_dwordx4 v[100:103], v27, s[24:27], s53 offen offset:256 sc1
s_waitcnt vmcnt(18)
s_barrier
s_add_u32 s42, s42, 1
s_and_b32 s42, s42, 15
s_add_u32 m0, s39, 49152
s_mul_i32 s37, s42, s40
buffer_load_dwordx4 v22, s[8:11], s37 offen sc1 lds
v_fma_f32 v81, v81, v42, v38
v_fma_f32 v82, v82, v42, v38
v_fma_f32 v83, v83, v42, v38
v_mul_f32 v80, v80, v168
s_add_u32 m0, s39, 50176
s_add_u32 s37, s37, s38
buffer_load_dwordx4 v23, s[8:11], s37 offen sc1 lds
v_mul_f32 v81, v81, v169
v_mul_f32 v82, v82, v170
v_mul_f32 v83, v83, v171
s_add_u32 m0, s39, 51200
s_add_u32 s37, s37, s38
buffer_load_dwordx4 v22, s[8:11], s37 offen sc1 lds
v_exp_f32 v80, v80
v_exp_f32 v81, v81
v_exp_f32 v82, v82
s_add_u32 m0, s39, 52224
s_add_u32 s37, s37, s38
buffer_load_dwordx4 v23, s[8:11], s37 offen sc1 lds
v_exp_f32 v83, v83
v_mul_f32 v232, v168, v232
v_mul_f32 v233, v169, v233
s_add_u32 m0, s39, 53248
s_add_u32 s37, s37, s38
buffer_load_dwordx4 v22, s[8:11], s37 offen sc1 lds
v_mul_f32 v234, v170, v234
v_mul_f32 v235, v171, v235
v_fma_f32 v80, v80, v46, v46
v_fma_f32 v81, v81, v46, v46
s_add_u32 m0, s39, 54272
s_add_u32 s37, s37, s38
buffer_load_dwordx4 v23, s[8:11], s37 offen sc1 lds
v_fma_f32 v82, v82, v46, v46
v_fma_f32 v83, v83, v46, v46
v_rcp_f32 v80, v80
s_add_u32 m0, s39, 55296
s_add_u32 s37, s37, s38
buffer_load_dwordx4 v22, s[8:11], s37 offen sc1 lds
v_rcp_f32 v81, v81
v_rcp_f32 v82, v82
v_rcp_f32 v83, v83
s_add_u32 m0, s39, 56320
s_add_u32 s37, s37, s38
buffer_load_dwordx4 v23, s[8:11], s37 offen sc1 lds
v_mul_f32 v232, v232, v80
v_mul_f32 v233, v233, v81
v_mul_f32 v234, v234, v82
s_add_u32 m0, s39, 57344
s_add_u32 s37, s37, s38
buffer_load_dwordx4 v22, s[8:11], s37 offen sc1 lds
v_mul_f32 v235, v235, v83
v_cvt_pk_bf16_f32 v104, v232, v233
v_cvt_pk_bf16_f32 v105, v234, v235
v_fma_f32 v184, -v34, v60, v184
s_add_u32 m0, s39, 58368
s_add_u32 s37, s37, s38
buffer_load_dwordx4 v23, s[8:11], s37 offen sc1 lds
v_fma_f32 v185, -v34, v61, v185
v_fma_f32 v186, -v34, v62, v186
v_fma_f32 v187, -v34, v63, v187
s_add_u32 m0, s39, 59392
s_add_u32 s37, s37, s38
buffer_load_dwordx4 v22, s[8:11], s37 offen sc1 lds
v_fma_f32 v248, -v34, v76, v248
v_fma_f32 v249, -v34, v77, v249
v_fma_f32 v250, -v34, v78, v250
s_add_u32 m0, s39, 60416
s_add_u32 s37, s37, s38
buffer_load_dwordx4 v23, s[8:11], s37 offen sc1 lds
v_fma_f32 v251, -v34, v79, v251
v_mul_f32 v84, v184, v184
v_mul_f32 v85, v185, v185
s_add_u32 m0, s39, 61440
s_add_u32 s37, s37, s38
buffer_load_dwordx4 v22, s[8:11], s37 offen sc1 lds
v_mul_f32 v86, v186, v186
v_mul_f32 v87, v187, v187
v_fma_f32 v84, v84, v42, v38
v_fma_f32 v85, v85, v42, v38
s_add_u32 m0, s39, 62464
s_add_u32 s37, s37, s38
buffer_load_dwordx4 v23, s[8:11], s37 offen sc1 lds
v_fma_f32 v86, v86, v42, v38
v_fma_f32 v87, v87, v42, v38
v_mul_f32 v84, v84, v184
s_add_u32 m0, s39, 63488
s_add_u32 s37, s37, s38
buffer_load_dwordx4 v22, s[8:11], s37 offen sc1 lds
v_mul_f32 v85, v85, v185
v_mul_f32 v86, v86, v186
v_mul_f32 v87, v87, v187
s_add_u32 m0, s39, 64512
s_add_u32 s37, s37, s38
buffer_load_dwordx4 v23, s[8:11], s37 offen sc1 lds
v_exp_f32 v84, v84
v_exp_f32 v85, v85
v_exp_f32 v86, v86
s_waitcnt vmcnt(17)
s_barrier
s_add_u32 s42, s42, 1
s_and_b32 s42, s42, 15
s_add_u32 m0, s39, 98304
s_mul_i32 s37, s42, s40
buffer_load_dwordx4 v22, s[8:11], s37 offen sc1 lds
v_exp_f32 v87, v87
v_mul_f32 v248, v184, v248
v_mul_f32 v249, v185, v249
v_mul_f32 v250, v186, v250
s_add_u32 m0, s39, 99328
s_add_u32 s37, s37, s38
buffer_load_dwordx4 v23, s[8:11], s37 offen sc1 lds
v_mul_f32 v251, v187, v251
v_fma_f32 v84, v84, v46, v46
v_fma_f32 v85, v85, v46, v46
s_add_u32 m0, s39, 100352
s_add_u32 s37, s37, s38
buffer_load_dwordx4 v22, s[8:11], s37 offen sc1 lds
v_fma_f32 v86, v86, v46, v46
v_fma_f32 v87, v87, v46, v46
v_rcp_f32 v84, v84
s_add_u32 m0, s39, 101376
s_add_u32 s37, s37, s38
buffer_load_dwordx4 v23, s[8:11], s37 offen sc1 lds
v_rcp_f32 v85, v85
v_rcp_f32 v86, v86
v_rcp_f32 v87, v87
s_add_u32 m0, s39, 102400
s_add_u32 s37, s37, s38
buffer_load_dwordx4 v22, s[8:11], s37 offen sc1 lds
v_mul_f32 v248, v248, v84
v_mul_f32 v249, v249, v85
v_mul_f32 v250, v250, v86
v_mul_f32 v251, v251, v87
s_add_u32 m0, s39, 103424
s_add_u32 s37, s37, s38
buffer_load_dwordx4 v23, s[8:11], s37 offen sc1 lds
v_cvt_pk_bf16_f32 v106, v248, v249
v_cvt_pk_bf16_f32 v107, v250, v251
s_add_u32 m0, s39, 104448
s_add_u32 s37, s37, s38
buffer_load_dwordx4 v22, s[8:11], s37 offen sc1 lds
v_fma_f32 v172, -v35, v56, v172
v_fma_f32 v173, -v35, v57, v173
v_fma_f32 v174, -v35, v58, v174
s_add_u32 m0, s39, 105472
s_add_u32 s37, s37, s38
buffer_load_dwordx4 v23, s[8:11], s37 offen sc1 lds
v_fma_f32 v175, -v35, v59, v175
v_fma_f32 v236, -v35, v72, v236
v_fma_f32 v237, -v35, v73, v237
s_add_u32 m0, s39, 106496
s_add_u32 s37, s37, s38
buffer_load_dwordx4 v22, s[8:11], s37 offen sc1 lds
v_fma_f32 v238, -v35, v74, v238
v_fma_f32 v239, -v35, v75, v239
v_mul_f32 v80, v172, v172
v_mul_f32 v81, v173, v173
s_add_u32 m0, s39, 107520
s_add_u32 s37, s37, s38
buffer_load_dwordx4 v23, s[8:11], s37 offen sc1 lds
v_mul_f32 v82, v174, v174
v_mul_f32 v83, v175, v175
v_fma_f32 v80, v80, v43, v39
s_add_u32 m0, s39, 108544
s_add_u32 s37, s37, s38
buffer_load_dwordx4 v22, s[8:11], s37 offen sc1 lds
v_fma_f32 v81, v81, v43, v39
v_fma_f32 v82, v82, v43, v39
v_fma_f32 v83, v83, v43, v39
s_add_u32 m0, s39, 109568
s_add_u32 s37, s37, s38
buffer_load_dwordx4 v23, s[8:11], s37 offen sc1 lds
v_mul_f32 v80, v80, v172
v_mul_f32 v81, v81, v173
v_mul_f32 v82, v82, v174
s_add_u32 m0, s39, 110592
s_add_u32 s37, s37, s38
buffer_load_dwordx4 v22, s[8:11], s37 offen sc1 lds
v_mul_f32 v83, v83, v175
v_exp_f32 v80, v80
v_exp_f32 v81, v81
v_exp_f32 v82, v82
s_add_u32 m0, s39, 111616
s_add_u32 s37, s37, s38
buffer_load_dwordx4 v23, s[8:11], s37 offen sc1 lds
v_exp_f32 v83, v83
v_mul_f32 v236, v172, v236
v_mul_f32 v237, v173, v237
s_add_u32 m0, s39, 112640
s_add_u32 s37, s37, s38
buffer_load_dwordx4 v22, s[8:11], s37 offen sc1 lds
v_mul_f32 v238, v174, v238
v_mul_f32 v239, v175, v239
v_fma_f32 v80, v80, v47, v47
s_add_u32 m0, s39, 113664
s_add_u32 s37, s37, s38
buffer_load_dwordx4 v23, s[8:11], s37 offen sc1 lds
v_fma_f32 v81, v81, v47, v47
v_fma_f32 v82, v82, v47, v47
v_fma_f32 v83, v83, v47, v47
buffer_store_dwordx4 v[104:107], v27, s[24:27], s53 offen offset:512 sc1
s_waitcnt vmcnt(17)
s_barrier
s_add_u32 s42, s42, 1
s_and_b32 s42, s42, 15
s_add_u32 m0, s39, 0
s_mul_i32 s37, s42, s40
buffer_load_dwordx4 v22, s[8:11], s37 offen sc1 lds
v_rcp_f32 v80, v80
v_rcp_f32 v81, v81
v_rcp_f32 v82, v82
v_rcp_f32 v83, v83
s_add_u32 m0, s39, 1024
s_add_u32 s37, s37, s38
buffer_load_dwordx4 v23, s[8:11], s37 offen sc1 lds
v_mul_f32 v236, v236, v80
v_mul_f32 v237, v237, v81
v_mul_f32 v238, v238, v82
s_add_u32 m0, s39, 2048
s_add_u32 s37, s37, s38
buffer_load_dwordx4 v22, s[8:11], s37 offen sc1 lds
v_mul_f32 v239, v239, v83
v_cvt_pk_bf16_f32 v108, v236, v237
v_cvt_pk_bf16_f32 v109, v238, v239
s_add_u32 m0, s39, 3072
s_add_u32 s37, s37, s38
buffer_load_dwordx4 v23, s[8:11], s37 offen sc1 lds
v_fma_f32 v188, -v35, v60, v188
v_fma_f32 v189, -v35, v61, v189
v_fma_f32 v190, -v35, v62, v190
v_fma_f32 v191, -v35, v63, v191
s_add_u32 m0, s39, 4096
s_add_u32 s37, s37, s38
buffer_load_dwordx4 v22, s[8:11], s37 offen sc1 lds
v_fma_f32 v252, -v35, v76, v252
v_fma_f32 v253, -v35, v77, v253
v_fma_f32 v254, -v35, v78, v254
s_add_u32 m0, s39, 5120
s_add_u32 s37, s37, s38
buffer_load_dwordx4 v23, s[8:11], s37 offen sc1 lds
v_fma_f32 v255, -v35, v79, v255
v_mul_f32 v84, v188, v188
v_mul_f32 v85, v189, v189
s_add_u32 m0, s39, 6144
s_add_u32 s37, s37, s38
buffer_load_dwordx4 v22, s[8:11], s37 offen sc1 lds
v_mul_f32 v86, v190, v190
v_mul_f32 v87, v191, v191
v_fma_f32 v84, v84, v43, v39
v_fma_f32 v85, v85, v43, v39
s_add_u32 m0, s39, 7168
s_add_u32 s37, s37, s38
buffer_load_dwordx4 v23, s[8:11], s37 offen sc1 lds
v_fma_f32 v86, v86, v43, v39
v_fma_f32 v87, v87, v43, v39
v_mul_f32 v84, v84, v188
s_add_u32 m0, s39, 8192
s_add_u32 s37, s37, s38
buffer_load_dwordx4 v22, s[8:11], s37 offen sc1 lds
v_mul_f32 v85, v85, v189
v_mul_f32 v86, v86, v190
v_mul_f32 v87, v87, v191
s_add_u32 m0, s39, 9216
s_add_u32 s37, s37, s38
buffer_load_dwordx4 v23, s[8:11], s37 offen sc1 lds
v_exp_f32 v84, v84
v_exp_f32 v85, v85
v_exp_f32 v86, v86
v_exp_f32 v87, v87
s_add_u32 m0, s39, 10240
s_add_u32 s37, s37, s38
buffer_load_dwordx4 v22, s[8:11], s37 offen sc1 lds
v_mul_f32 v252, v188, v252
v_mul_f32 v253, v189, v253
v_mul_f32 v254, v190, v254
s_add_u32 m0, s39, 11264
s_add_u32 s37, s37, s38
buffer_load_dwordx4 v23, s[8:11], s37 offen sc1 lds
v_mul_f32 v255, v191, v255
v_fma_f32 v84, v84, v47, v47
v_fma_f32 v85, v85, v47, v47
s_add_u32 m0, s39, 12288
s_add_u32 s37, s37, s38
buffer_load_dwordx4 v22, s[8:11], s37 offen sc1 lds
v_fma_f32 v86, v86, v47, v47
v_fma_f32 v87, v87, v47, v47
v_rcp_f32 v84, v84
v_rcp_f32 v85, v85
s_add_u32 m0, s39, 13312
s_add_u32 s37, s37, s38
buffer_load_dwordx4 v23, s[8:11], s37 offen sc1 lds
v_rcp_f32 v86, v86
v_rcp_f32 v87, v87
v_mul_f32 v252, v252, v84
s_add_u32 m0, s39, 14336
s_add_u32 s37, s37, s38
buffer_load_dwordx4 v22, s[8:11], s37 offen sc1 lds
v_mul_f32 v253, v253, v85
v_mul_f32 v254, v254, v86
v_mul_f32 v255, v255, v87
s_add_u32 m0, s39, 15360
s_add_u32 s37, s37, s38
buffer_load_dwordx4 v23, s[8:11], s37 offen sc1 lds
v_cvt_pk_bf16_f32 v110, v252, v253
v_cvt_pk_bf16_f32 v111, v254, v255
buffer_store_dwordx4 v[108:111], v27, s[24:27], s53 offen offset:768 sc1
s_waitcnt vmcnt(18)
s_barrier
s_mul_i32 s44, s34, 917504
s_lshl_b32 s39, s51, 13
s_add_u32 s44, s44, s39
s_add_u32 s44, s44, 8388608
s_and_b32 s43, s51, 1
s_xor_b32 s43, s43, s35
s_lshl_b32 s43, s43, 7
s_mov_b32 s10, 909312
s_movk_i32 s38, 1024
s_movk_i32 s40, 9216
s_movk_i32 s37, 0x4000
s_cmp_ge_u32 s51, 2
s_cselect_b32 s8, s60, s32
s_cselect_b32 s9, s61, s33
s_cselect_b32 s10, 7338112, s10
s_cselect_b32 s43, s43, s44
s_cselect_b32 s38, 16384, s38
s_cselect_b32 s40, 81920, s40
s_cselect_b32 s55, 81920, s38
s_cselect_b32 s37, 262144, s37
s_cselect_b32 s45, -1, 0
s_add_u32 s8, s8, s43
s_addc_u32 s9, s9, 0
s_mov_b32 s11, 0x20000
s_and_b32 s53, s35, 1
s_mul_i32 s54, s53, 6
s_mul_i32 s54, s54, s37
s_mul_i32 s29, s53, 2
s_add_u32 s29, s29, 6
s_mul_i32 s29, s29, s37
s_and_b32 s43, s45, 4290838528
s_add_u32 s29, s29, s43
s_mul_i32 s37, s37, 0
s_sub_u32 s37, s37, s40
v_lshrrev_b32 v19, 3, v1
v_mul_u32_u24 v19, 1920, v19
v_lshrrev_b32 v20, 4, v1
v_lshlrev_b32 v20, 5, v20
v_and_b32 v19, s45, v19
v_and_b32 v20, s45, v20
v_lshlrev_b32 v21, 4, v1
v_xor_b32 v21, v21, v20
v_add_u32 v21, v21, v19
s_add_u32 m0, s39, 65536
s_add_u32 s37, s37, s40
buffer_load_dwordx4 v21, s[8:11], s37 offen sc1 lds
v_lshlrev_b32 v128, 16, v192
v_and_b32 v129, 0xffff0000, v192
v_lshlrev_b32 v130, 16, v193
v_and_b32 v131, 0xffff0000, v193
s_add_u32 m0, s39, 66560
s_add_u32 s37, s37, s38
buffer_load_dwordx4 v21, s[8:11], s37 offen sc1 lds
v_lshlrev_b32 v132, 16, v194
v_and_b32 v133, 0xffff0000, v194
v_lshlrev_b32 v134, 16, v195
v_and_b32 v135, 0xffff0000, v195
s_add_u32 m0, s39, 67584
s_add_u32 s37, s37, s38
buffer_load_dwordx4 v21, s[8:11], s37 offen sc1 lds
v_lshlrev_b32 v136, 16, v196
v_and_b32 v137, 0xffff0000, v196
v_lshlrev_b32 v138, 16, v197
v_and_b32 v139, 0xffff0000, v197
s_add_u32 m0, s39, 68608
s_add_u32 s37, s37, s38
buffer_load_dwordx4 v21, s[8:11], s37 offen sc1 lds
v_lshlrev_b32 v140, 16, v198
v_and_b32 v141, 0xffff0000, v198
v_lshlrev_b32 v142, 16, v199
v_and_b32 v143, 0xffff0000, v199
s_add_u32 m0, s39, 69632
s_add_u32 s37, s37, s55
buffer_load_dwordx4 v21, s[8:11], s37 offen sc1 lds
v_lshlrev_b32 v144, 16, v200
v_and_b32 v145, 0xffff0000, v200
v_lshlrev_b32 v146, 16, v201
v_and_b32 v147, 0xffff0000, v201
s_add_u32 m0, s39, 70656
s_add_u32 s37, s37, s38
buffer_load_dwordx4 v21, s[8:11], s37 offen sc1 lds
v_lshlrev_b32 v148, 16, v202
v_and_b32 v149, 0xffff0000, v202
v_lshlrev_b32 v150, 16, v203
v_and_b32 v151, 0xffff0000, v203
s_add_u32 m0, s39, 71680
s_add_u32 s37, s37, s38
buffer_load_dwordx4 v21, s[8:11], s37 offen sc1 lds
v_lshlrev_b32 v152, 16, v204
v_and_b32 v153, 0xffff0000, v204
v_lshlrev_b32 v154, 16, v205
v_and_b32 v155, 0xffff0000, v205
s_add_u32 m0, s39, 72704
s_add_u32 s37, s37, s38
buffer_load_dwordx4 v21, s[8:11], s37 offen sc1 lds
v_lshlrev_b32 v156, 16, v206
v_and_b32 v157, 0xffff0000, v206
v_lshlrev_b32 v158, 16, v207
v_and_b32 v159, 0xffff0000, v207
s_waitcnt vmcnt(8)
s_barrier
s_add_u32 m0, s39, 98304
s_add_u32 s37, s37, s40
buffer_load_dwordx4 v21, s[8:11], s37 offen sc1 lds
v_mov_b32 v192, 0
v_mov_b32 v193, 0
v_mov_b32 v194, 0
v_mov_b32 v195, 0
s_add_u32 m0, s39, 99328
s_add_u32 s37, s37, s38
buffer_load_dwordx4 v21, s[8:11], s37 offen sc1 lds
v_mov_b32 v196, 0
v_mov_b32 v197, 0
v_mov_b32 v198, 0
v_mov_b32 v199, 0
s_add_u32 m0, s39, 100352
s_add_u32 s37, s37, s38
buffer_load_dwordx4 v21, s[8:11], s37 offen sc1 lds
v_mov_b32 v200, 0
v_mov_b32 v201, 0
v_mov_b32 v202, 0
v_mov_b32 v203, 0
s_add_u32 m0, s39, 101376
s_add_u32 s37, s37, s38
buffer_load_dwordx4 v21, s[8:11], s37 offen sc1 lds
v_mov_b32 v204, 0
v_mov_b32 v205, 0
v_mov_b32 v206, 0
v_mov_b32 v207, 0
s_add_u32 m0, s39, 102400
s_add_u32 s37, s37, s55
buffer_load_dwordx4 v21, s[8:11], s37 offen sc1 lds
v_mov_b32 v208, 0
v_mov_b32 v209, 0
v_mov_b32 v210, 0
v_mov_b32 v211, 0
s_add_u32 m0, s39, 103424
s_add_u32 s37, s37, s38
buffer_load_dwordx4 v21, s[8:11], s37 offen sc1 lds
v_mov_b32 v212, 0
v_mov_b32 v213, 0
v_mov_b32 v214, 0
v_mov_b32 v215, 0
s_add_u32 m0, s39, 104448
s_add_u32 s37, s37, s38
buffer_load_dwordx4 v21, s[8:11], s37 offen sc1 lds
v_mov_b32 v216, 0
v_mov_b32 v217, 0
v_mov_b32 v218, 0
v_mov_b32 v219, 0
s_add_u32 m0, s39, 105472
s_add_u32 s37, s37, s38
buffer_load_dwordx4 v21, s[8:11], s37 offen sc1 lds
v_mov_b32 v220, 0
v_mov_b32 v221, 0
v_mov_b32 v222, 0
v_mov_b32 v223, 0
s_waitcnt vmcnt(8)
s_barrier
s_branch LK4_26
L3h_25:
v_mfma_f32_16x16x32_bf16 v[128:131], v[96:99], v[80:83], v[128:131]
v_mfma_f32_16x16x32_bf16 v[132:135], v[96:99], v[84:87], v[132:135]
v_mfma_f32_16x16x32_bf16 v[136:139], v[96:99], v[88:91], v[136:139]
v_mfma_f32_16x16x32_bf16 v[140:143], v[96:99], v[92:95], v[140:143]
v_mfma_f32_16x16x32_bf16 v[204:207], v[112:115], v[92:95], v[204:207]
v_mfma_f32_16x16x32_bf16 v[200:203], v[112:115], v[88:91], v[200:203]
v_mfma_f32_16x16x32_bf16 v[196:199], v[112:115], v[84:87], v[196:199]
v_mfma_f32_16x16x32_bf16 v[192:195], v[112:115], v[80:83], v[192:195]
v_mfma_f32_16x16x32_bf16 v[144:147], v[100:103], v[80:83], v[144:147]
v_mfma_f32_16x16x32_bf16 v[148:151], v[100:103], v[84:87], v[148:151]
v_mfma_f32_16x16x32_bf16 v[152:155], v[100:103], v[88:91], v[152:155]
v_mfma_f32_16x16x32_bf16 v[156:159], v[100:103], v[92:95], v[156:159]
v_mfma_f32_16x16x32_bf16 v[220:223], v[116:119], v[92:95], v[220:223]
v_mfma_f32_16x16x32_bf16 v[216:219], v[116:119], v[88:91], v[216:219]
v_mfma_f32_16x16x32_bf16 v[212:215], v[116:119], v[84:87], v[212:215]
v_mfma_f32_16x16x32_bf16 v[208:211], v[116:119], v[80:83], v[208:211]
v_mfma_f32_16x16x32_bf16 v[160:163], v[104:107], v[80:83], v[160:163]
v_mfma_f32_16x16x32_bf16 v[164:167], v[104:107], v[84:87], v[164:167]
v_mfma_f32_16x16x32_bf16 v[168:171], v[104:107], v[88:91], v[168:171]
v_mfma_f32_16x16x32_bf16 v[172:175], v[104:107], v[92:95], v[172:175]
v_mfma_f32_16x16x32_bf16 v[236:239], v[120:123], v[92:95], v[236:239]
v_mfma_f32_16x16x32_bf16 v[232:235], v[120:123], v[88:91], v[232:235]
v_mfma_f32_16x16x32_bf16 v[228:231], v[120:123], v[84:87], v[228:231]
v_mfma_f32_16x16x32_bf16 v[224:227], v[120:123], v[80:83], v[224:227]
v_mfma_f32_16x16x32_bf16 v[176:179], v[108:111], v[80:83], v[176:179]
v_mfma_f32_16x16x32_bf16 v[180:183], v[108:111], v[84:87], v[180:183]
v_mfma_f32_16x16x32_bf16 v[184:187], v[108:111], v[88:91], v[184:187]
v_mfma_f32_16x16x32_bf16 v[188:191], v[108:111], v[92:95], v[188:191]
v_mfma_f32_16x16x32_bf16 v[252:255], v[124:127], v[92:95], v[252:255]
v_mfma_f32_16x16x32_bf16 v[248:251], v[124:127], v[88:91], v[248:251]
v_mfma_f32_16x16x32_bf16 v[244:247], v[124:127], v[84:87], v[244:247]
v_mfma_f32_16x16x32_bf16 v[240:243], v[124:127], v[80:83], v[240:243]
s_setprio 0
s_lshl_b32 s43, s46, 9
s_add_u32 s43, s43, 147456
v_lshl_add_u32 v19, v17, 3, s43
ds_read_b64 v[80:81], v19 offset:0
ds_read_b64 v[82:83], v19 offset:128
ds_read_b64 v[84:85], v19 offset:256
ds_read_b64 v[86:87], v19 offset:384
s_mul_i32 s43, s47, 256
s_add_u32 s43, s43, 148480
v_lshl_add_u32 v19, v18, 4, s43
ds_read_b128 v[48:51], v19 offset:0
ds_read_b128 v[52:55], v19 offset:64
ds_read_b128 v[56:59], v19 offset:128
ds_read_b128 v[60:63], v19 offset:192
ds_read_b128 v[64:67], v19 offset:896
ds_read_b128 v[68:71], v19 offset:960
ds_read_b128 v[72:75], v19 offset:1024
ds_read_b128 v[76:79], v19 offset:1088
s_waitcnt lgkmcnt(0)
v_mov_b32 v32, v80
v_mul_f32 v88, v81, v81
v_mul_f32 v36, 0xc0135761, v81
v_mul_f32 v89, 0xbdd2d3e8, v81
v_rcp_f32 v44, v88
v_mul_f32 v40, v89, v88
v_mov_b32 v33, v82
v_mul_f32 v88, v83, v83
v_mul_f32 v37, 0xc0135761, v83
v_mul_f32 v89, 0xbdd2d3e8, v83
v_rcp_f32 v45, v88
v_mul_f32 v41, v89, v88
v_mov_b32 v34, v84
v_mul_f32 v88, v85, v85
v_mul_f32 v38, 0xc0135761, v85
v_mul_f32 v89, 0xbdd2d3e8, v85
v_rcp_f32 v46, v88
v_mul_f32 v42, v89, v88
v_mov_b32 v35, v86
v_mul_f32 v88, v87, v87
v_mul_f32 v39, 0xc0135761, v87
v_mul_f32 v89, 0xbdd2d3e8, v87
v_rcp_f32 v47, v88
v_mul_f32 v43, v89, v88
s_barrier
v_fma_f32 v128, -v32, v48, v128
v_fma_f32 v129, -v32, v49, v129
v_fma_f32 v130, -v32, v50, v130
v_fma_f32 v131, -v32, v51, v131
v_fma_f32 v192, -v32, v64, v192
v_fma_f32 v193, -v32, v65, v193
v_fma_f32 v194, -v32, v66, v194
v_fma_f32 v195, -v32, v67, v195
v_mul_f32 v80, v128, v128
v_mul_f32 v81, v129, v129
v_mul_f32 v82, v130, v130
v_mul_f32 v83, v131, v131
v_fma_f32 v80, v80, v40, v36
v_fma_f32 v81, v81, v40, v36
v_fma_f32 v82, v82, v40, v36
v_fma_f32 v83, v83, v40, v36
v_mul_f32 v80, v80, v128
v_mul_f32 v81, v81, v129
v_mul_f32 v82, v82, v130
v_mul_f32 v83, v83, v131
v_exp_f32 v80, v80
v_exp_f32 v81, v81
v_exp_f32 v82, v82
v_exp_f32 v83, v83
v_mul_f32 v192, v128, v192
v_mul_f32 v193, v129, v193
v_mul_f32 v194, v130, v194
v_mul_f32 v195, v131, v195
v_fma_f32 v80, v80, v44, v44
v_fma_f32 v81, v81, v44, v44
v_fma_f32 v82, v82, v44, v44
v_fma_f32 v83, v83, v44, v44
v_rcp_f32 v80, v80
v_rcp_f32 v81, v81
v_rcp_f32 v82, v82
v_rcp_f32 v83, v83
v_mul_f32 v192, v192, v80
v_mul_f32 v193, v193, v81
v_mul_f32 v194, v194, v82
v_mul_f32 v195, v195, v83
v_cvt_pk_bf16_f32 v96, v192, v193
v_cvt_pk_bf16_f32 v97, v194, v195
v_fma_f32 v144, -v32, v52, v144
v_fma_f32 v145, -v32, v53, v145
v_fma_f32 v146, -v32, v54, v146
v_fma_f32 v147, -v32, v55, v147
v_fma_f32 v208, -v32, v68, v208
v_fma_f32 v209, -v32, v69, v209
v_fma_f32 v210, -v32, v70, v210
v_fma_f32 v211, -v32, v71, v211
v_mul_f32 v84, v144, v144
v_mul_f32 v85, v145, v145
s_barrier
v_mul_f32 v86, v146, v146
v_mul_f32 v87, v147, v147
v_fma_f32 v84, v84, v40, v36
v_fma_f32 v85, v85, v40, v36
v_fma_f32 v86, v86, v40, v36
v_fma_f32 v87, v87, v40, v36
v_mul_f32 v84, v84, v144
v_mul_f32 v85, v85, v145
v_mul_f32 v86, v86, v146
v_mul_f32 v87, v87, v147
v_exp_f32 v84, v84
v_exp_f32 v85, v85
v_exp_f32 v86, v86
v_exp_f32 v87, v87
v_mul_f32 v208, v144, v208
v_mul_f32 v209, v145, v209
v_mul_f32 v210, v146, v210
v_mul_f32 v211, v147, v211
v_fma_f32 v84, v84, v44, v44
v_fma_f32 v85, v85, v44, v44
v_fma_f32 v86, v86, v44, v44
v_fma_f32 v87, v87, v44, v44
v_rcp_f32 v84, v84
v_rcp_f32 v85, v85
v_rcp_f32 v86, v86
v_rcp_f32 v87, v87
v_mul_f32 v208, v208, v84
v_mul_f32 v209, v209, v85
v_mul_f32 v210, v210, v86
v_mul_f32 v211, v211, v87
v_cvt_pk_bf16_f32 v98, v208, v209
v_cvt_pk_bf16_f32 v99, v210, v211
buffer_store_dwordx4 v[96:99], v27, s[24:27], 0 offen offset:0 sc1
v_fma_f32 v132, -v33, v48, v132
v_fma_f32 v133, -v33, v49, v133
v_fma_f32 v134, -v33, v50, v134
v_fma_f32 v135, -v33, v51, v135
v_fma_f32 v196, -v33, v64, v196
v_fma_f32 v197, -v33, v65, v197
v_fma_f32 v198, -v33, v66, v198
v_fma_f32 v199, -v33, v67, v199
v_mul_f32 v80, v132, v132
v_mul_f32 v81, v133, v133
v_mul_f32 v82, v134, v134
v_mul_f32 v83, v135, v135
v_fma_f32 v80, v80, v41, v37
v_fma_f32 v81, v81, v41, v37
v_fma_f32 v82, v82, v41, v37
v_fma_f32 v83, v83, v41, v37
v_mul_f32 v80, v80, v132
v_mul_f32 v81, v81, v133
v_mul_f32 v82, v82, v134
v_lshlrev_b32 v19, 11, v18
v_lshl_add_u32 v19, v17, 4, v19
s_lshl_b32 s43, s46, 10
v_add_u32 v2, s43, v19
v_add_u32 v3, 0x10000, v2
v_lshrrev_b32 v19, 2, v17
v_lshl_add_u32 v20, v18, 2, v19
v_bfe_u32 v21, v20, 1, 2
s_lshl_b32 s43, s47, 1
v_xor_b32 v21, s43, v21
v_lshlrev_b32 v20, 7, v20
v_lshl_add_u32 v20, v21, 5, v20
v_and_b32 v19, 3, v1
v_lshl_add_u32 v20, v19, 3, v20
v_add_u32 v5, 16384, v20
v_xor_b32 v6, 32, v5
v_add_u32 v7, 0x10000, v5
v_add_u32 v8, 0x10000, v6
s_lshl_b32 s43, s36, 13
v_lshl_add_u32 v9, v1, 4, s43
s_mov_b32 s54, 0x10000
s_movk_i32 s52, 0x1000
s_barrier
s_mov_b32 s88, s4
s_mov_b32 s89, s5
s_mov_b32 s90, 7340032
s_mov_b32 s91, 0x20000
s_mov_b32 s92, s6
s_mov_b32 s93, s7
s_mov_b32 s94, 7340032
s_mov_b32 s95, 0x20000
s_lshr_b32 s43, s35, 3
v_and_b32 v19, 1, v1
v_bfe_u32 v23, v1, 2, 3
s_mul_i32 s44, s43, 10
s_add_u32 s44, s44, 2
v_add_u32 v23, s44, v23
s_lshl_b32 s44, s43, 2
s_sub_u32 s44, 5, s44
v_mad_u32_u24 v23, v19, s44, v23
s_lshl_b32 s44, s43, 10
s_xor_b32 s44, s44, 1024
s_lshl_b32 s43, s43, 11
s_add_u32 s43, s43, 4480
s_lshr_b32 s45, s2, 3
s_mul_i32 s45, s45, 14336
s_add_u32 s43, s43, s45
v_mul_lo_u32 v31, v19, s44
v_bfe_u32 v19, v1, 1, 1
v_mul_u32_u24 v19, 7168, v19
v_add3_u32 v31, v31, v19, s43
v_add_u32 v19, 8, v23
v_and_b32 v19, 15, v19
v_mul_u32_u24 v19, 458752, v19
v_add_u32 v19, v19, v31
buffer_load_dword v30, v19, s[88:91], 0 offen
buffer_load_dword v30, v19, s[92:95], 0 offen
v_mul_f32 v83, v83, v135
v_exp_f32 v80, v80
v_exp_f32 v81, v81
v_exp_f32 v82, v82
v_exp_f32 v83, v83
v_mul_f32 v196, v132, v196
v_mul_f32 v197, v133, v197
v_mul_f32 v198, v134, v198
v_mul_f32 v199, v135, v199
v_fma_f32 v80, v80, v45, v45
v_fma_f32 v81, v81, v45, v45
v_fma_f32 v82, v82, v45, v45
v_fma_f32 v83, v83, v45, v45
v_rcp_f32 v80, v80
v_rcp_f32 v81, v81
v_rcp_f32 v82, v82
v_rcp_f32 v83, v83
v_mul_f32 v196, v196, v80
v_mul_f32 v197, v197, v81
v_mul_f32 v198, v198, v82
v_mul_f32 v199, v199, v83
v_cvt_pk_bf16_f32 v100, v196, v197
v_cvt_pk_bf16_f32 v101, v198, v199
v_fma_f32 v148, -v33, v52, v148
v_fma_f32 v149, -v33, v53, v149
v_fma_f32 v150, -v33, v54, v150
v_fma_f32 v151, -v33, v55, v151
v_fma_f32 v212, -v33, v68, v212
v_fma_f32 v213, -v33, v69, v213
v_fma_f32 v214, -v33, v70, v214
v_fma_f32 v215, -v33, v71, v215
v_mul_f32 v84, v148, v148
v_mul_f32 v85, v149, v149
v_mul_f32 v86, v150, v150
v_mul_f32 v87, v151, v151
v_fma_f32 v84, v84, v41, v37
v_fma_f32 v85, v85, v41, v37
v_fma_f32 v86, v86, v41, v37
v_fma_f32 v87, v87, v41, v37
v_mul_f32 v84, v84, v148
v_mul_f32 v85, v85, v149
v_mul_f32 v86, v86, v150
v_mul_f32 v87, v87, v151
v_exp_f32 v84, v84
v_exp_f32 v85, v85
v_exp_f32 v86, v86
v_exp_f32 v87, v87
v_mul_f32 v212, v148, v212
v_mul_f32 v213, v149, v213
v_mul_f32 v214, v150, v214
v_mul_f32 v215, v151, v215
v_fma_f32 v84, v84, v45, v45
s_barrier
v_fma_f32 v85, v85, v45, v45
v_fma_f32 v86, v86, v45, v45
v_fma_f32 v87, v87, v45, v45
v_rcp_f32 v84, v84
v_rcp_f32 v85, v85
v_rcp_f32 v86, v86
v_rcp_f32 v87, v87
v_mul_f32 v212, v212, v84
v_mul_f32 v213, v213, v85
v_mul_f32 v214, v214, v86
v_mul_f32 v215, v215, v87
v_cvt_pk_bf16_f32 v102, v212, v213
v_cvt_pk_bf16_f32 v103, v214, v215
buffer_store_dwordx4 v[100:103], v27, s[24:27], 0 offen offset:256 sc1
v_fma_f32 v136, -v34, v48, v136
v_fma_f32 v137, -v34, v49, v137
v_fma_f32 v138, -v34, v50, v138
v_fma_f32 v139, -v34, v51, v139
v_fma_f32 v200, -v34, v64, v200
v_fma_f32 v201, -v34, v65, v201
v_fma_f32 v202, -v34, v66, v202
v_fma_f32 v203, -v34, v67, v203
v_mul_f32 v80, v136, v136
v_mul_f32 v81, v137, v137
v_mul_f32 v82, v138, v138
v_mul_f32 v83, v139, v139
v_fma_f32 v80, v80, v42, v38
v_fma_f32 v81, v81, v42, v38
v_fma_f32 v82, v82, v42, v38
v_fma_f32 v83, v83, v42, v38
v_mul_f32 v80, v80, v136
v_mul_f32 v81, v81, v137
v_mul_f32 v82, v82, v138
v_mul_f32 v83, v83, v139
v_exp_f32 v80, v80
v_exp_f32 v81, v81
v_exp_f32 v82, v82
v_exp_f32 v83, v83
v_mul_f32 v200, v136, v200
v_mul_f32 v201, v137, v201
v_mul_f32 v202, v138, v202
v_mul_f32 v203, v139, v203
v_fma_f32 v80, v80, v46, v46
v_fma_f32 v81, v81, v46, v46
v_fma_f32 v82, v82, v46, v46
v_fma_f32 v83, v83, v46, v46
v_rcp_f32 v80, v80
v_rcp_f32 v81, v81
v_rcp_f32 v82, v82
v_rcp_f32 v83, v83
v_mul_f32 v200, v200, v80
v_mul_f32 v201, v201, v81
v_mul_f32 v202, v202, v82
s_barrier
v_mul_f32 v203, v203, v83
v_cvt_pk_bf16_f32 v104, v200, v201
v_cvt_pk_bf16_f32 v105, v202, v203
v_fma_f32 v152, -v34, v52, v152
v_fma_f32 v153, -v34, v53, v153
v_fma_f32 v154, -v34, v54, v154
v_fma_f32 v155, -v34, v55, v155
v_fma_f32 v216, -v34, v68, v216
v_fma_f32 v217, -v34, v69, v217
v_fma_f32 v218, -v34, v70, v218
v_fma_f32 v219, -v34, v71, v219
v_mul_f32 v84, v152, v152
v_mul_f32 v85, v153, v153
v_mul_f32 v86, v154, v154
v_mul_f32 v87, v155, v155
v_fma_f32 v84, v84, v42, v38
v_fma_f32 v85, v85, v42, v38
v_fma_f32 v86, v86, v42, v38
v_fma_f32 v87, v87, v42, v38
v_mul_f32 v84, v84, v152
v_mul_f32 v85, v85, v153
v_mul_f32 v86, v86, v154
v_mul_f32 v87, v87, v155
v_exp_f32 v84, v84
v_exp_f32 v85, v85
v_exp_f32 v86, v86
v_exp_f32 v87, v87
v_mul_f32 v216, v152, v216
v_mul_f32 v217, v153, v217
v_mul_f32 v218, v154, v218
v_mul_f32 v219, v155, v219
v_fma_f32 v84, v84, v46, v46
v_fma_f32 v85, v85, v46, v46
v_fma_f32 v86, v86, v46, v46
v_fma_f32 v87, v87, v46, v46
v_rcp_f32 v84, v84
v_rcp_f32 v85, v85
v_rcp_f32 v86, v86
v_rcp_f32 v87, v87
v_mul_f32 v216, v216, v84
v_mul_f32 v217, v217, v85
v_mul_f32 v218, v218, v86
v_mul_f32 v219, v219, v87
v_cvt_pk_bf16_f32 v106, v216, v217
v_cvt_pk_bf16_f32 v107, v218, v219
buffer_store_dwordx4 v[104:107], v27, s[24:27], 0 offen offset:512 sc1
v_fma_f32 v140, -v35, v48, v140
v_fma_f32 v141, -v35, v49, v141
v_fma_f32 v142, -v35, v50, v142
v_fma_f32 v143, -v35, v51, v143
v_fma_f32 v204, -v35, v64, v204
v_fma_f32 v205, -v35, v65, v205
s_barrier
v_fma_f32 v206, -v35, v66, v206
v_fma_f32 v207, -v35, v67, v207
v_mul_f32 v80, v140, v140
v_mul_f32 v81, v141, v141
v_mul_f32 v82, v142, v142
v_mul_f32 v83, v143, v143
v_fma_f32 v80, v80, v43, v39
v_fma_f32 v81, v81, v43, v39
v_fma_f32 v82, v82, v43, v39
v_fma_f32 v83, v83, v43, v39
v_mul_f32 v80, v80, v140
v_mul_f32 v81, v81, v141
v_mul_f32 v82, v82, v142
v_mul_f32 v83, v83, v143
v_exp_f32 v80, v80
v_exp_f32 v81, v81
v_exp_f32 v82, v82
v_exp_f32 v83, v83
v_mul_f32 v204, v140, v204
v_mul_f32 v205, v141, v205
v_mul_f32 v206, v142, v206
v_mul_f32 v207, v143, v207
v_fma_f32 v80, v80, v47, v47
v_fma_f32 v81, v81, v47, v47
v_fma_f32 v82, v82, v47, v47
v_fma_f32 v83, v83, v47, v47
v_rcp_f32 v80, v80
v_rcp_f32 v81, v81
v_rcp_f32 v82, v82
v_rcp_f32 v83, v83
v_mul_f32 v204, v204, v80
v_mul_f32 v205, v205, v81
v_mul_f32 v206, v206, v82
v_mul_f32 v207, v207, v83
v_cvt_pk_bf16_f32 v108, v204, v205
v_cvt_pk_bf16_f32 v109, v206, v207
v_fma_f32 v156, -v35, v52, v156
v_fma_f32 v157, -v35, v53, v157
v_fma_f32 v158, -v35, v54, v158
v_fma_f32 v159, -v35, v55, v159
v_fma_f32 v220, -v35, v68, v220
v_fma_f32 v221, -v35, v69, v221
v_fma_f32 v222, -v35, v70, v222
v_fma_f32 v223, -v35, v71, v223
v_mul_f32 v84, v156, v156
v_mul_f32 v85, v157, v157
v_mul_f32 v86, v158, v158
v_mul_f32 v87, v159, v159
v_fma_f32 v84, v84, v43, v39
v_fma_f32 v85, v85, v43, v39
v_fma_f32 v86, v86, v43, v39
v_fma_f32 v87, v87, v43, v39
s_barrier
v_mul_f32 v84, v84, v156
v_mul_f32 v85, v85, v157
v_mul_f32 v86, v86, v158
v_mul_f32 v87, v87, v159
v_exp_f32 v84, v84
v_exp_f32 v85, v85
v_exp_f32 v86, v86
v_exp_f32 v87, v87
v_mul_f32 v220, v156, v220
v_mul_f32 v221, v157, v221
v_mul_f32 v222, v158, v222
v_mul_f32 v223, v159, v223
v_fma_f32 v84, v84, v47, v47
v_fma_f32 v85, v85, v47, v47
v_fma_f32 v86, v86, v47, v47
v_fma_f32 v87, v87, v47, v47
v_rcp_f32 v84, v84
v_rcp_f32 v85, v85
v_rcp_f32 v86, v86
v_rcp_f32 v87, v87
v_mul_f32 v220, v220, v84
v_mul_f32 v221, v221, v85
v_mul_f32 v222, v222, v86
v_mul_f32 v223, v223, v87
v_cvt_pk_bf16_f32 v110, v220, v221
v_cvt_pk_bf16_f32 v111, v222, v223
buffer_store_dwordx4 v[108:111], v27, s[24:27], 0 offen offset:768 sc1
v_fma_f32 v160, -v32, v56, v160
v_fma_f32 v161, -v32, v57, v161
v_fma_f32 v162, -v32, v58, v162
v_fma_f32 v163, -v32, v59, v163
v_fma_f32 v224, -v32, v72, v224
v_fma_f32 v225, -v32, v73, v225
v_fma_f32 v226, -v32, v74, v226
v_fma_f32 v227, -v32, v75, v227
v_mul_f32 v80, v160, v160
v_mul_f32 v81, v161, v161
v_mul_f32 v82, v162, v162
v_mul_f32 v83, v163, v163
v_fma_f32 v80, v80, v40, v36
v_fma_f32 v81, v81, v40, v36
v_fma_f32 v82, v82, v40, v36
v_fma_f32 v83, v83, v40, v36
v_mul_f32 v80, v80, v160
v_mul_f32 v81, v81, v161
v_mul_f32 v82, v82, v162
v_mul_f32 v83, v83, v163
v_exp_f32 v80, v80
v_exp_f32 v81, v81
v_exp_f32 v82, v82
v_exp_f32 v83, v83
v_mul_f32 v224, v160, v224
v_mul_f32 v225, v161, v225
s_barrier
v_mul_f32 v226, v162, v226
v_mul_f32 v227, v163, v227
v_fma_f32 v80, v80, v44, v44
v_fma_f32 v81, v81, v44, v44
v_fma_f32 v82, v82, v44, v44
v_fma_f32 v83, v83, v44, v44
v_rcp_f32 v80, v80
v_rcp_f32 v81, v81
v_rcp_f32 v82, v82
v_rcp_f32 v83, v83
v_mul_f32 v224, v224, v80
v_mul_f32 v225, v225, v81
v_mul_f32 v226, v226, v82
v_mul_f32 v227, v227, v83
v_cvt_pk_bf16_f32 v96, v224, v225
v_cvt_pk_bf16_f32 v97, v226, v227
v_fma_f32 v176, -v32, v60, v176
v_fma_f32 v177, -v32, v61, v177
v_fma_f32 v178, -v32, v62, v178
v_fma_f32 v179, -v32, v63, v179
v_fma_f32 v240, -v32, v76, v240
v_fma_f32 v241, -v32, v77, v241
v_fma_f32 v242, -v32, v78, v242
v_fma_f32 v243, -v32, v79, v243
v_mul_f32 v84, v176, v176
v_mul_f32 v85, v177, v177
v_mul_f32 v86, v178, v178
v_mul_f32 v87, v179, v179
v_fma_f32 v84, v84, v40, v36
v_fma_f32 v85, v85, v40, v36
v_fma_f32 v86, v86, v40, v36
v_fma_f32 v87, v87, v40, v36
v_mul_f32 v84, v84, v176
v_mul_f32 v85, v85, v177
v_mul_f32 v86, v86, v178
v_mul_f32 v87, v87, v179
v_exp_f32 v84, v84
v_exp_f32 v85, v85
v_exp_f32 v86, v86
v_exp_f32 v87, v87
v_mul_f32 v240, v176, v240
v_mul_f32 v241, v177, v241
v_mul_f32 v242, v178, v242
v_mul_f32 v243, v179, v243
v_fma_f32 v84, v84, v44, v44
v_fma_f32 v85, v85, v44, v44
v_fma_f32 v86, v86, v44, v44
v_fma_f32 v87, v87, v44, v44
v_rcp_f32 v84, v84
v_rcp_f32 v85, v85
v_rcp_f32 v86, v86
v_rcp_f32 v87, v87
v_lshlrev_b32 v19, 11, v18
v_lshl_add_u32 v19, v17, 4, v19
s_lshl_b32 s43, s46, 10
s_lshl_b32 s44, s47, 13
v_add3_u32 v208, v19, s43, 0
v_add_u32 v208, s44, v208
buffer_load_dwordx4 v[192:195], v208, s[20:23], 0 offen offset:0 sc1
buffer_load_dwordx4 v[196:199], v208, s[20:23], 0 offen offset:256 sc1
buffer_load_dwordx4 v[200:203], v208, s[20:23], 0 offen offset:512 sc1
buffer_load_dwordx4 v[204:207], v208, s[20:23], 0 offen offset:768 sc1
s_waitcnt vmcnt(4)
s_barrier
s_add_u32 s43, s34, 32
s_lshl_b32 s43, s43, 7
v_mov_b32 v21, s43
v_mov_b32 v22, 1
s_mov_b64 exec, 1
buffer_atomic_add v22, v21, s[56:59], 0 offen sc1
s_mov_b64 exec, -1
v_mul_f32 v240, v240, v84
v_mul_f32 v241, v241, v85
v_mul_f32 v242, v242, v86
v_mul_f32 v243, v243, v87
v_cvt_pk_bf16_f32 v98, v240, v241
v_cvt_pk_bf16_f32 v99, v242, v243
buffer_store_dwordx4 v[96:99], v27, s[24:27], s53 offen offset:0 sc1
v_fma_f32 v164, -v33, v56, v164
v_fma_f32 v165, -v33, v57, v165
v_fma_f32 v166, -v33, v58, v166
v_fma_f32 v167, -v33, v59, v167
v_fma_f32 v228, -v33, v72, v228
v_fma_f32 v229, -v33, v73, v229
v_fma_f32 v230, -v33, v74, v230
v_fma_f32 v231, -v33, v75, v231
v_mul_f32 v80, v164, v164
v_mul_f32 v81, v165, v165
v_mul_f32 v82, v166, v166
v_mul_f32 v83, v167, v167
v_fma_f32 v80, v80, v41, v37
v_fma_f32 v81, v81, v41, v37
v_fma_f32 v82, v82, v41, v37
v_fma_f32 v83, v83, v41, v37
v_mul_f32 v80, v80, v164
v_mul_f32 v81, v81, v165
v_mul_f32 v82, v82, v166
v_mul_f32 v83, v83, v167
v_exp_f32 v80, v80
v_exp_f32 v81, v81
v_exp_f32 v82, v82
v_exp_f32 v83, v83
v_mul_f32 v228, v164, v228
v_mul_f32 v229, v165, v229
v_mul_f32 v230, v166, v230
v_mul_f32 v231, v167, v231
v_fma_f32 v80, v80, v45, v45
v_fma_f32 v81, v81, v45, v45
v_fma_f32 v82, v82, v45, v45
v_fma_f32 v83, v83, v45, v45
v_rcp_f32 v80, v80
v_rcp_f32 v81, v81
v_rcp_f32 v82, v82
v_rcp_f32 v83, v83
v_mul_f32 v228, v228, v80
v_mul_f32 v229, v229, v81
v_mul_f32 v230, v230, v82
v_mul_f32 v231, v231, v83
v_cvt_pk_bf16_f32 v100, v228, v229
v_cvt_pk_bf16_f32 v101, v230, v231
v_fma_f32 v180, -v33, v60, v180
v_fma_f32 v181, -v33, v61, v181
v_fma_f32 v182, -v33, v62, v182
s_barrier
s_mov_b32 s80, s60
s_mov_b32 s81, s61
s_mov_b32 s82, 7340032
s_mov_b32 s83, 0x20000
v_and_b32 v29, 31, v1
v_lshlrev_b32 v29, 11, v29
s_and_b32 s43, s35, 8
s_or_b32 s43, s43, 3
s_lshl_b32 s43, s43, 7
v_add_u32 v29, s43, v29
s_lshr_b32 s44, s2, 3
s_lshl_b32 s44, s44, 17
s_add_u32 s43, s44, 0
buffer_load_dword v30, v29, s[80:83], s43 offen
v_fma_f32 v183, -v33, v63, v183
v_fma_f32 v244, -v33, v76, v244
v_fma_f32 v245, -v33, v77, v245
v_fma_f32 v246, -v33, v78, v246
v_fma_f32 v247, -v33, v79, v247
v_mul_f32 v84, v180, v180
v_mul_f32 v85, v181, v181
v_mul_f32 v86, v182, v182
v_mul_f32 v87, v183, v183
v_fma_f32 v84, v84, v41, v37
v_fma_f32 v85, v85, v41, v37
v_fma_f32 v86, v86, v41, v37
v_fma_f32 v87, v87, v41, v37
v_mul_f32 v84, v84, v180
v_mul_f32 v85, v85, v181
v_mul_f32 v86, v86, v182
v_mul_f32 v87, v87, v183
v_exp_f32 v84, v84
v_exp_f32 v85, v85
v_exp_f32 v86, v86
v_exp_f32 v87, v87
v_mul_f32 v244, v180, v244
v_mul_f32 v245, v181, v245
v_mul_f32 v246, v182, v246
v_mul_f32 v247, v183, v247
v_fma_f32 v84, v84, v45, v45
v_fma_f32 v85, v85, v45, v45
v_fma_f32 v86, v86, v45, v45
v_fma_f32 v87, v87, v45, v45
v_rcp_f32 v84, v84
v_rcp_f32 v85, v85
v_rcp_f32 v86, v86
v_rcp_f32 v87, v87
v_mul_f32 v244, v244, v84
v_mul_f32 v245, v245, v85
v_mul_f32 v246, v246, v86
v_mul_f32 v247, v247, v87
v_cvt_pk_bf16_f32 v102, v244, v245
v_cvt_pk_bf16_f32 v103, v246, v247
buffer_store_dwordx4 v[100:103], v27, s[24:27], s53 offen offset:256 sc1
v_fma_f32 v168, -v34, v56, v168
v_fma_f32 v169, -v34, v57, v169
v_fma_f32 v170, -v34, v58, v170
v_fma_f32 v171, -v34, v59, v171
v_fma_f32 v232, -v34, v72, v232
v_fma_f32 v233, -v34, v73, v233
v_fma_f32 v234, -v34, v74, v234
v_fma_f32 v235, -v34, v75, v235
v_mul_f32 v80, v168, v168
v_mul_f32 v81, v169, v169
v_mul_f32 v82, v170, v170
v_mul_f32 v83, v171, v171
v_fma_f32 v80, v80, v42, v38
s_waitcnt vmcnt(2)
s_barrier
v_fma_f32 v81, v81, v42, v38
v_fma_f32 v82, v82, v42, v38
v_fma_f32 v83, v83, v42, v38
v_mul_f32 v80, v80, v168
v_mul_f32 v81, v81, v169
v_mul_f32 v82, v82, v170
v_mul_f32 v83, v83, v171
v_exp_f32 v80, v80
v_exp_f32 v81, v81
v_exp_f32 v82, v82
v_exp_f32 v83, v83
v_mul_f32 v232, v168, v232
v_mul_f32 v233, v169, v233
v_mul_f32 v234, v170, v234
v_mul_f32 v235, v171, v235
v_fma_f32 v80, v80, v46, v46
v_fma_f32 v81, v81, v46, v46
v_fma_f32 v82, v82, v46, v46
v_fma_f32 v83, v83, v46, v46
v_rcp_f32 v80, v80
v_rcp_f32 v81, v81
v_rcp_f32 v82, v82
v_rcp_f32 v83, v83
v_mul_f32 v232, v232, v80
v_mul_f32 v233, v233, v81
v_mul_f32 v234, v234, v82
v_mul_f32 v235, v235, v83
v_cvt_pk_bf16_f32 v104, v232, v233
v_cvt_pk_bf16_f32 v105, v234, v235
v_fma_f32 v184, -v34, v60, v184
v_fma_f32 v185, -v34, v61, v185
v_fma_f32 v186, -v34, v62, v186
v_fma_f32 v187, -v34, v63, v187
v_fma_f32 v248, -v34, v76, v248
v_fma_f32 v249, -v34, v77, v249
v_fma_f32 v250, -v34, v78, v250
v_fma_f32 v251, -v34, v79, v251
v_mul_f32 v84, v184, v184
v_mul_f32 v85, v185, v185
v_mul_f32 v86, v186, v186
v_mul_f32 v87, v187, v187
v_fma_f32 v84, v84, v42, v38
v_fma_f32 v85, v85, v42, v38
v_fma_f32 v86, v86, v42, v38
v_fma_f32 v87, v87, v42, v38
v_mul_f32 v84, v84, v184
v_mul_f32 v85, v85, v185
v_mul_f32 v86, v86, v186
v_mul_f32 v87, v87, v187
v_exp_f32 v84, v84
v_exp_f32 v85, v85
v_exp_f32 v86, v86
s_barrier
v_exp_f32 v87, v87
v_mul_f32 v248, v184, v248
v_mul_f32 v249, v185, v249
v_mul_f32 v250, v186, v250
v_mul_f32 v251, v187, v251
v_fma_f32 v84, v84, v46, v46
v_fma_f32 v85, v85, v46, v46
v_fma_f32 v86, v86, v46, v46
v_fma_f32 v87, v87, v46, v46
v_rcp_f32 v84, v84
v_rcp_f32 v85, v85
v_rcp_f32 v86, v86
v_rcp_f32 v87, v87
v_mul_f32 v248, v248, v84
v_mul_f32 v249, v249, v85
v_mul_f32 v250, v250, v86
v_mul_f32 v251, v251, v87
v_cvt_pk_bf16_f32 v106, v248, v249
v_cvt_pk_bf16_f32 v107, v250, v251
buffer_store_dwordx4 v[104:107], v27, s[24:27], s53 offen offset:512 sc1
v_fma_f32 v172, -v35, v56, v172
v_fma_f32 v173, -v35, v57, v173
v_fma_f32 v174, -v35, v58, v174
v_fma_f32 v175, -v35, v59, v175
v_fma_f32 v236, -v35, v72, v236
v_fma_f32 v237, -v35, v73, v237
v_fma_f32 v238, -v35, v74, v238
v_fma_f32 v239, -v35, v75, v239
v_mul_f32 v80, v172, v172
v_mul_f32 v81, v173, v173
v_mul_f32 v82, v174, v174
v_mul_f32 v83, v175, v175
v_fma_f32 v80, v80, v43, v39
v_fma_f32 v81, v81, v43, v39
v_fma_f32 v82, v82, v43, v39
v_fma_f32 v83, v83, v43, v39
v_mul_f32 v80, v80, v172
v_mul_f32 v81, v81, v173
v_mul_f32 v82, v82, v174
v_mul_f32 v83, v83, v175
v_exp_f32 v80, v80
v_exp_f32 v81, v81
v_exp_f32 v82, v82
v_exp_f32 v83, v83
v_mul_f32 v236, v172, v236
v_mul_f32 v237, v173, v237
v_mul_f32 v238, v174, v238
v_mul_f32 v239, v175, v239
v_fma_f32 v80, v80, v47, v47
v_fma_f32 v81, v81, v47, v47
v_fma_f32 v82, v82, v47, v47
v_fma_f32 v83, v83, v47, v47
s_barrier
s_add_u32 s43, s34, 32
s_lshl_b32 s43, s43, 7
v_mov_b32 v21, s43
v_mov_b32 v23, 16
buffer_load_dword v22, v21, s[56:59], 0 offen sc1
v_rcp_f32 v80, v80
v_rcp_f32 v81, v81
v_rcp_f32 v82, v82
v_rcp_f32 v83, v83
v_mul_f32 v236, v236, v80
v_mul_f32 v237, v237, v81
v_mul_f32 v238, v238, v82
v_mul_f32 v239, v239, v83
v_cvt_pk_bf16_f32 v108, v236, v237
v_cvt_pk_bf16_f32 v109, v238, v239
v_fma_f32 v188, -v35, v60, v188
v_fma_f32 v189, -v35, v61, v189
v_fma_f32 v190, -v35, v62, v190
v_fma_f32 v191, -v35, v63, v191
v_fma_f32 v252, -v35, v76, v252
v_fma_f32 v253, -v35, v77, v253
v_fma_f32 v254, -v35, v78, v254
v_fma_f32 v255, -v35, v79, v255
v_mul_f32 v84, v188, v188
v_mul_f32 v85, v189, v189
v_mul_f32 v86, v190, v190
v_mul_f32 v87, v191, v191
v_fma_f32 v84, v84, v43, v39
v_fma_f32 v85, v85, v43, v39
v_fma_f32 v86, v86, v43, v39
v_fma_f32 v87, v87, v43, v39
v_mul_f32 v84, v84, v188
v_mul_f32 v85, v85, v189
v_mul_f32 v86, v86, v190
v_mul_f32 v87, v87, v191
v_exp_f32 v84, v84
v_exp_f32 v85, v85
v_exp_f32 v86, v86
v_exp_f32 v87, v87
v_mul_f32 v252, v188, v252
v_mul_f32 v253, v189, v253
v_mul_f32 v254, v190, v254
v_mul_f32 v255, v191, v255
v_fma_f32 v84, v84, v47, v47
v_fma_f32 v85, v85, v47, v47
v_fma_f32 v86, v86, v47, v47
v_fma_f32 v87, v87, v47, v47
v_rcp_f32 v84, v84
v_rcp_f32 v85, v85
v_rcp_f32 v86, v86
v_rcp_f32 v87, v87
v_mul_f32 v252, v252, v84
v_mul_f32 v253, v253, v85
v_mul_f32 v254, v254, v86
v_mul_f32 v255, v255, v87
v_cvt_pk_bf16_f32 v110, v252, v253
v_cvt_pk_bf16_f32 v111, v254, v255
buffer_store_dwordx4 v[108:111], v27, s[24:27], s53 offen offset:768 sc1
s_mov_b32 s41, 0x10000
Lpoll_27:
s_waitcnt vmcnt(0)
Lpf_29:
v_cmp_ne_u32 vcc, v23, v22
s_nop 4
s_cbranch_vccz Lpok_28
buffer_load_dword v22, v21, s[56:59], 0 offen sc1
s_sub_u32 s41, s41, 1
s_cmp_lg_u32 s41, 0
s_cbranch_scc1 Lpoll_27
s_waitcnt vmcnt(0)
Lpok_28:
s_barrier
v_lshlrev_b32 v128, 16, v192
v_and_b32 v129, 0xffff0000, v192
v_lshlrev_b32 v130, 16, v193
v_and_b32 v131, 0xffff0000, v193
v_lshlrev_b32 v132, 16, v194
v_and_b32 v133, 0xffff0000, v194
v_lshlrev_b32 v134, 16, v195
v_and_b32 v135, 0xffff0000, v195
v_lshlrev_b32 v136, 16, v196
v_and_b32 v137, 0xffff0000, v196
v_lshlrev_b32 v138, 16, v197
v_and_b32 v139, 0xffff0000, v197
v_lshlrev_b32 v140, 16, v198
v_and_b32 v141, 0xffff0000, v198
v_lshlrev_b32 v142, 16, v199
v_and_b32 v143, 0xffff0000, v199
v_lshlrev_b32 v144, 16, v200
v_and_b32 v145, 0xffff0000, v200
v_lshlrev_b32 v146, 16, v201
v_and_b32 v147, 0xffff0000, v201
v_lshlrev_b32 v148, 16, v202
v_and_b32 v149, 0xffff0000, v202
v_lshlrev_b32 v150, 16, v203
v_and_b32 v151, 0xffff0000, v203
v_lshlrev_b32 v152, 16, v204
v_and_b32 v153, 0xffff0000, v204
v_lshlrev_b32 v154, 16, v205
v_and_b32 v155, 0xffff0000, v205
v_lshlrev_b32 v156, 16, v206
v_and_b32 v157, 0xffff0000, v206
v_lshlrev_b32 v158, 16, v207
v_and_b32 v159, 0xffff0000, v207
s_waitcnt vmcnt(0)
s_barrier
s_add_u32 s43, s34, 48
s_lshl_b32 s43, s43, 7
v_mov_b32 v22, s43
v_mov_b32 v23, 1
s_mov_b64 exec, 1
buffer_atomic_add v23, v22, s[56:59], 0 offen sc1
s_mov_b64 exec, -1
v_mov_b32 v192, 0
v_mov_b32 v193, 0
v_mov_b32 v194, 0
v_mov_b32 v195, 0
v_mov_b32 v196, 0
v_mov_b32 v197, 0
v_mov_b32 v198, 0
v_mov_b32 v199, 0
v_mov_b32 v200, 0
v_mov_b32 v201, 0
v_mov_b32 v202, 0
v_mov_b32 v203, 0
v_mov_b32 v204, 0
v_mov_b32 v205, 0
v_mov_b32 v206, 0
v_mov_b32 v207, 0
v_mov_b32 v208, 0
v_mov_b32 v209, 0
v_mov_b32 v210, 0
v_mov_b32 v211, 0
v_mov_b32 v212, 0
v_mov_b32 v213, 0
v_mov_b32 v214, 0
v_mov_b32 v215, 0
v_mov_b32 v216, 0
v_mov_b32 v217, 0
v_mov_b32 v218, 0
v_mov_b32 v219, 0
v_mov_b32 v220, 0
v_mov_b32 v221, 0
v_mov_b32 v222, 0
v_mov_b32 v223, 0
s_barrier
LK4_26:
s_setprio 1
ds_read_b64_tr_b16 v[64:65], v7 offset:0
ds_read_b128 v[32:35], v3 offset:0
ds_read_b64_tr_b16 v[66:67], v7 offset:2048
ds_read_b128 v[36:39], v3 offset:256
ds_read_b64_tr_b16 v[68:69], v8 offset:0
ds_read_b128 v[40:43], v3 offset:512
ds_read_b64_tr_b16 v[70:71], v8 offset:2048
ds_read_b128 v[44:47], v3 offset:768
ds_read_b64_tr_b16 v[72:73], v7 offset:4096
ds_read_b128 v[48:51], v3 offset:8192
ds_read_b64_tr_b16 v[74:75], v7 offset:6144
ds_read_b128 v[52:55], v3 offset:8448
ds_read_b64_tr_b16 v[76:77], v8 offset:4096
ds_read_b128 v[56:59], v3 offset:8704
ds_read_b64_tr_b16 v[78:79], v8 offset:6144
ds_read_b128 v[60:63], v3 offset:8960
s_mov_b32 s54, 0x10000
s_waitcnt vmcnt(0) lgkmcnt(0)
s_barrier
v_mfma_f32_16x16x32_bf16 v[128:131], v[64:67], v[32:35], v[128:131]
ds_read_b64_tr_b16 v[160:161], v7 offset:32768
v_mfma_f32_16x16x32_bf16 v[132:135], v[68:71], v[32:35], v[132:135]
ds_read_b128 v[96:99], v3 offset:32768
v_mfma_f32_16x16x32_bf16 v[136:139], v[64:67], v[36:39], v[136:139]
ds_read_b64_tr_b16 v[162:163], v7 offset:34816
v_mfma_f32_16x16x32_bf16 v[140:143], v[68:71], v[36:39], v[140:143]
ds_read_b128 v[100:103], v3 offset:33024
v_mfma_f32_16x16x32_bf16 v[144:147], v[64:67], v[40:43], v[144:147]
ds_read_b64_tr_b16 v[164:165], v8 offset:32768
v_mfma_f32_16x16x32_bf16 v[148:151], v[68:71], v[40:43], v[148:151]
ds_read_b128 v[104:107], v3 offset:33280
v_mfma_f32_16x16x32_bf16 v[152:155], v[64:67], v[44:47], v[152:155]
ds_read_b64_tr_b16 v[166:167], v8 offset:34816
v_mfma_f32_16x16x32_bf16 v[156:159], v[68:71], v[44:47], v[156:159]
ds_read_b128 v[108:111], v3 offset:33536
v_mfma_f32_16x16x32_bf16 v[128:131], v[72:75], v[48:51], v[128:131]
ds_read_b64_tr_b16 v[168:169], v7 offset:36864
v_mfma_f32_16x16x32_bf16 v[132:135], v[76:79], v[48:51], v[132:135]
ds_read_b128 v[112:115], v3 offset:40960
v_mfma_f32_16x16x32_bf16 v[136:139], v[72:75], v[52:55], v[136:139]
ds_read_b64_tr_b16 v[170:171], v7 offset:38912
v_mfma_f32_16x16x32_bf16 v[140:143], v[76:79], v[52:55], v[140:143]
ds_read_b128 v[116:119], v3 offset:41216
v_mfma_f32_16x16x32_bf16 v[144:147], v[72:75], v[56:59], v[144:147]
ds_read_b64_tr_b16 v[172:173], v8 offset:36864
v_mfma_f32_16x16x32_bf16 v[148:151], v[76:79], v[56:59], v[148:151]
ds_read_b128 v[120:123], v3 offset:41472
v_mfma_f32_16x16x32_bf16 v[152:155], v[72:75], v[60:63], v[152:155]
ds_read_b64_tr_b16 v[174:175], v8 offset:38912
v_mfma_f32_16x16x32_bf16 v[156:159], v[76:79], v[60:63], v[156:159]
ds_read_b128 v[124:127], v3 offset:41728
s_waitcnt lgkmcnt(0)
s_barrier
v_mfma_f32_16x16x32_bf16 v[128:131], v[160:163], v[96:99], v[128:131]
ds_read_b64_tr_b16 v[64:65], v5 offset:0
v_mfma_f32_16x16x32_bf16 v[132:135], v[164:167], v[96:99], v[132:135]
ds_read_b128 v[32:35], v2 offset:0
v_mfma_f32_16x16x32_bf16 v[136:139], v[160:163], v[100:103], v[136:139]
ds_read_b64_tr_b16 v[66:67], v5 offset:2048
v_mfma_f32_16x16x32_bf16 v[140:143], v[164:167], v[100:103], v[140:143]
ds_read_b128 v[36:39], v2 offset:256
v_mfma_f32_16x16x32_bf16 v[144:147], v[160:163], v[104:107], v[144:147]
ds_read_b64_tr_b16 v[68:69], v6 offset:0
v_mfma_f32_16x16x32_bf16 v[148:151], v[164:167], v[104:107], v[148:151]
ds_read_b128 v[40:43], v2 offset:512
v_mfma_f32_16x16x32_bf16 v[152:155], v[160:163], v[108:111], v[152:155]
ds_read_b64_tr_b16 v[70:71], v6 offset:2048
v_mfma_f32_16x16x32_bf16 v[156:159], v[164:167], v[108:111], v[156:159]
ds_read_b128 v[44:47], v2 offset:768
v_mfma_f32_16x16x32_bf16 v[128:131], v[168:171], v[112:115], v[128:131]
ds_read_b64_tr_b16 v[72:73], v5 offset:4096
v_mfma_f32_16x16x32_bf16 v[132:135], v[172:175], v[112:115], v[132:135]
ds_read_b128 v[48:51], v2 offset:8192
v_mfma_f32_16x16x32_bf16 v[136:139], v[168:171], v[116:119], v[136:139]
ds_read_b64_tr_b16 v[74:75], v5 offset:6144
v_mfma_f32_16x16x32_bf16 v[140:143], v[172:175], v[116:119], v[140:143]
ds_read_b128 v[52:55], v2 offset:8448
v_mfma_f32_16x16x32_bf16 v[144:147], v[168:171], v[120:123], v[144:147]
ds_read_b64_tr_b16 v[76:77], v6 offset:4096
v_mfma_f32_16x16x32_bf16 v[148:151], v[172:175], v[120:123], v[148:151]
ds_read_b128 v[56:59], v2 offset:8704
v_mfma_f32_16x16x32_bf16 v[152:155], v[168:171], v[124:127], v[152:155]
ds_read_b64_tr_b16 v[78:79], v6 offset:6144
v_mfma_f32_16x16x32_bf16 v[156:159], v[172:175], v[124:127], v[156:159]
ds_read_b128 v[60:63], v2 offset:8960
s_waitcnt lgkmcnt(0)
s_barrier
v_mfma_f32_16x16x32_bf16 v[128:131], v[64:67], v[32:35], v[128:131]
ds_read_b64_tr_b16 v[160:161], v5 offset:32768
v_mfma_f32_16x16x32_bf16 v[132:135], v[68:71], v[32:35], v[132:135]
ds_read_b128 v[96:99], v2 offset:32768
v_mfma_f32_16x16x32_bf16 v[136:139], v[64:67], v[36:39], v[136:139]
ds_read_b64_tr_b16 v[162:163], v5 offset:34816
v_mfma_f32_16x16x32_bf16 v[140:143], v[68:71], v[36:39], v[140:143]
ds_read_b128 v[100:103], v2 offset:33024
v_mfma_f32_16x16x32_bf16 v[144:147], v[64:67], v[40:43], v[144:147]
ds_read_b64_tr_b16 v[164:165], v6 offset:32768
v_mfma_f32_16x16x32_bf16 v[148:151], v[68:71], v[40:43], v[148:151]
ds_read_b128 v[104:107], v2 offset:33280
v_mfma_f32_16x16x32_bf16 v[152:155], v[64:67], v[44:47], v[152:155]
ds_read_b64_tr_b16 v[166:167], v6 offset:34816
v_mfma_f32_16x16x32_bf16 v[156:159], v[68:71], v[44:47], v[156:159]
ds_read_b128 v[108:111], v2 offset:33536
v_mfma_f32_16x16x32_bf16 v[128:131], v[72:75], v[48:51], v[128:131]
ds_read_b64_tr_b16 v[168:169], v5 offset:36864
v_mfma_f32_16x16x32_bf16 v[132:135], v[76:79], v[48:51], v[132:135]
ds_read_b128 v[112:115], v2 offset:40960
v_mfma_f32_16x16x32_bf16 v[136:139], v[72:75], v[52:55], v[136:139]
ds_read_b64_tr_b16 v[170:171], v5 offset:38912
v_mfma_f32_16x16x32_bf16 v[140:143], v[76:79], v[52:55], v[140:143]
ds_read_b128 v[116:119], v2 offset:41216
v_mfma_f32_16x16x32_bf16 v[144:147], v[72:75], v[56:59], v[144:147]
ds_read_b64_tr_b16 v[172:173], v6 offset:36864
v_mfma_f32_16x16x32_bf16 v[148:151], v[76:79], v[56:59], v[148:151]
ds_read_b128 v[120:123], v2 offset:41472
v_mfma_f32_16x16x32_bf16 v[152:155], v[72:75], v[60:63], v[152:155]
ds_read_b64_tr_b16 v[174:175], v6 offset:38912
v_mfma_f32_16x16x32_bf16 v[156:159], v[76:79], v[60:63], v[156:159]
ds_read_b128 v[124:127], v2 offset:41728
s_waitcnt lgkmcnt(0)
s_barrier
v_mfma_f32_16x16x32_bf16 v[128:131], v[160:163], v[96:99], v[128:131]
ds_read_b64_tr_b16 v[64:65], v7 offset:0
v_mfma_f32_16x16x32_bf16 v[132:135], v[164:167], v[96:99], v[132:135]
ds_read_b128 v[32:35], v3 offset:0
v_mfma_f32_16x16x32_bf16 v[136:139], v[160:163], v[100:103], v[136:139]
ds_read_b64_tr_b16 v[66:67], v7 offset:2048
v_mfma_f32_16x16x32_bf16 v[140:143], v[164:167], v[100:103], v[140:143]
ds_read_b128 v[36:39], v3 offset:256
v_mfma_f32_16x16x32_bf16 v[144:147], v[160:163], v[104:107], v[144:147]
ds_read_b64_tr_b16 v[68:69], v8 offset:0
v_mfma_f32_16x16x32_bf16 v[148:151], v[164:167], v[104:107], v[148:151]
ds_read_b128 v[40:43], v3 offset:512
v_mfma_f32_16x16x32_bf16 v[152:155], v[160:163], v[108:111], v[152:155]
ds_read_b64_tr_b16 v[70:71], v8 offset:2048
v_mfma_f32_16x16x32_bf16 v[156:159], v[164:167], v[108:111], v[156:159]
ds_read_b128 v[44:47], v3 offset:768
v_mfma_f32_16x16x32_bf16 v[128:131], v[168:171], v[112:115], v[128:131]
ds_read_b64_tr_b16 v[80:81], v7 offset:8192
v_mfma_f32_16x16x32_bf16 v[132:135], v[172:175], v[112:115], v[132:135]
ds_read_b64_tr_b16 v[82:83], v7 offset:10240
v_mfma_f32_16x16x32_bf16 v[136:139], v[168:171], v[116:119], v[136:139]
ds_read_b64_tr_b16 v[84:85], v8 offset:8192
v_mfma_f32_16x16x32_bf16 v[140:143], v[172:175], v[116:119], v[140:143]
ds_read_b64_tr_b16 v[86:87], v8 offset:10240
v_mfma_f32_16x16x32_bf16 v[144:147], v[168:171], v[120:123], v[144:147]
ds_read_b64_tr_b16 v[72:73], v7 offset:4096
v_mfma_f32_16x16x32_bf16 v[148:151], v[172:175], v[120:123], v[148:151]
ds_read_b128 v[48:51], v3 offset:8192
v_mfma_f32_16x16x32_bf16 v[152:155], v[168:171], v[124:127], v[152:155]
ds_read_b64_tr_b16 v[74:75], v7 offset:6144
v_mfma_f32_16x16x32_bf16 v[156:159], v[172:175], v[124:127], v[156:159]
ds_read_b128 v[52:55], v3 offset:8448
ds_read_b64_tr_b16 v[76:77], v8 offset:4096
ds_read_b128 v[56:59], v3 offset:8704
ds_read_b64_tr_b16 v[78:79], v8 offset:6144
ds_read_b128 v[60:63], v3 offset:8960
ds_read_b64_tr_b16 v[88:89], v7 offset:12288
ds_read_b64_tr_b16 v[90:91], v7 offset:14336
ds_read_b64_tr_b16 v[92:93], v8 offset:12288
ds_read_b64_tr_b16 v[94:95], v8 offset:14336
s_mov_b32 s41, 4
Lk4_30:
s_waitcnt lgkmcnt(0)
s_barrier
v_mfma_f32_16x16x32_bf16 v[128:131], v[64:67], v[32:35], v[128:131]
ds_read_b64_tr_b16 v[160:161], v7 offset:32768
v_mfma_f32_16x16x32_bf16 v[132:135], v[68:71], v[32:35], v[132:135]
ds_read_b128 v[96:99], v3 offset:32768
v_mfma_f32_16x16x32_bf16 v[192:195], v[80:83], v[32:35], v[192:195]
ds_read_b64_tr_b16 v[162:163], v7 offset:34816
v_mfma_f32_16x16x32_bf16 v[196:199], v[84:87], v[32:35], v[196:199]
ds_read_b128 v[100:103], v3 offset:33024
v_mfma_f32_16x16x32_bf16 v[136:139], v[64:67], v[36:39], v[136:139]
ds_read_b64_tr_b16 v[164:165], v8 offset:32768
v_mfma_f32_16x16x32_bf16 v[140:143], v[68:71], v[36:39], v[140:143]
ds_read_b128 v[104:107], v3 offset:33280
v_mfma_f32_16x16x32_bf16 v[200:203], v[80:83], v[36:39], v[200:203]
ds_read_b64_tr_b16 v[166:167], v8 offset:34816
v_mfma_f32_16x16x32_bf16 v[204:207], v[84:87], v[36:39], v[204:207]
ds_read_b128 v[108:111], v3 offset:33536
v_mfma_f32_16x16x32_bf16 v[144:147], v[64:67], v[40:43], v[144:147]
ds_read_b64_tr_b16 v[176:177], v7 offset:40960
v_mfma_f32_16x16x32_bf16 v[148:151], v[68:71], v[40:43], v[148:151]
ds_read_b64_tr_b16 v[178:179], v7 offset:43008
v_mfma_f32_16x16x32_bf16 v[208:211], v[80:83], v[40:43], v[208:211]
ds_read_b64_tr_b16 v[180:181], v8 offset:40960
v_mfma_f32_16x16x32_bf16 v[212:215], v[84:87], v[40:43], v[212:215]
ds_read_b64_tr_b16 v[182:183], v8 offset:43008
v_mfma_f32_16x16x32_bf16 v[152:155], v[64:67], v[44:47], v[152:155]
ds_read_b64_tr_b16 v[168:169], v7 offset:36864
v_mfma_f32_16x16x32_bf16 v[156:159], v[68:71], v[44:47], v[156:159]
ds_read_b128 v[112:115], v3 offset:40960
v_mfma_f32_16x16x32_bf16 v[216:219], v[80:83], v[44:47], v[216:219]
ds_read_b64_tr_b16 v[170:171], v7 offset:38912
v_mfma_f32_16x16x32_bf16 v[220:223], v[84:87], v[44:47], v[220:223]
ds_read_b128 v[116:119], v3 offset:41216
v_mfma_f32_16x16x32_bf16 v[128:131], v[72:75], v[48:51], v[128:131]
ds_read_b64_tr_b16 v[172:173], v8 offset:36864
v_mfma_f32_16x16x32_bf16 v[132:135], v[76:79], v[48:51], v[132:135]
ds_read_b128 v[120:123], v3 offset:41472
v_mfma_f32_16x16x32_bf16 v[192:195], v[88:91], v[48:51], v[192:195]
ds_read_b64_tr_b16 v[174:175], v8 offset:38912
v_mfma_f32_16x16x32_bf16 v[196:199], v[92:95], v[48:51], v[196:199]
ds_read_b128 v[124:127], v3 offset:41728
v_mfma_f32_16x16x32_bf16 v[136:139], v[72:75], v[52:55], v[136:139]
ds_read_b64_tr_b16 v[184:185], v7 offset:45056
v_mfma_f32_16x16x32_bf16 v[140:143], v[76:79], v[52:55], v[140:143]
ds_read_b64_tr_b16 v[186:187], v7 offset:47104
v_mfma_f32_16x16x32_bf16 v[200:203], v[88:91], v[52:55], v[200:203]
ds_read_b64_tr_b16 v[188:189], v8 offset:45056
v_mfma_f32_16x16x32_bf16 v[204:207], v[92:95], v[52:55], v[204:207]
ds_read_b64_tr_b16 v[190:191], v8 offset:47104
v_mfma_f32_16x16x32_bf16 v[144:147], v[72:75], v[56:59], v[144:147]
v_mfma_f32_16x16x32_bf16 v[148:151], v[76:79], v[56:59], v[148:151]
v_mfma_f32_16x16x32_bf16 v[208:211], v[88:91], v[56:59], v[208:211]
v_mfma_f32_16x16x32_bf16 v[212:215], v[92:95], v[56:59], v[212:215]
v_mfma_f32_16x16x32_bf16 v[152:155], v[72:75], v[60:63], v[152:155]
v_mfma_f32_16x16x32_bf16 v[156:159], v[76:79], v[60:63], v[156:159]
v_mfma_f32_16x16x32_bf16 v[216:219], v[88:91], v[60:63], v[216:219]
v_mfma_f32_16x16x32_bf16 v[220:223], v[92:95], v[60:63], v[220:223]
s_waitcnt lgkmcnt(0)
s_barrier
v_mfma_f32_16x16x32_bf16 v[128:131], v[160:163], v[96:99], v[128:131]
ds_read_b64_tr_b16 v[64:65], v5 offset:0
v_mfma_f32_16x16x32_bf16 v[132:135], v[164:167], v[96:99], v[132:135]
ds_read_b128 v[32:35], v2 offset:0
v_mfma_f32_16x16x32_bf16 v[192:195], v[176:179], v[96:99], v[192:195]
ds_read_b64_tr_b16 v[66:67], v5 offset:2048
v_mfma_f32_16x16x32_bf16 v[196:199], v[180:183], v[96:99], v[196:199]
ds_read_b128 v[36:39], v2 offset:256
v_mfma_f32_16x16x32_bf16 v[136:139], v[160:163], v[100:103], v[136:139]
ds_read_b64_tr_b16 v[68:69], v6 offset:0
v_mfma_f32_16x16x32_bf16 v[140:143], v[164:167], v[100:103], v[140:143]
ds_read_b128 v[40:43], v2 offset:512
v_mfma_f32_16x16x32_bf16 v[200:203], v[176:179], v[100:103], v[200:203]
ds_read_b64_tr_b16 v[70:71], v6 offset:2048
v_mfma_f32_16x16x32_bf16 v[204:207], v[180:183], v[100:103], v[204:207]
ds_read_b128 v[44:47], v2 offset:768
v_mfma_f32_16x16x32_bf16 v[144:147], v[160:163], v[104:107], v[144:147]
ds_read_b64_tr_b16 v[80:81], v5 offset:8192
v_mfma_f32_16x16x32_bf16 v[148:151], v[164:167], v[104:107], v[148:151]
ds_read_b64_tr_b16 v[82:83], v5 offset:10240
v_mfma_f32_16x16x32_bf16 v[208:211], v[176:179], v[104:107], v[208:211]
ds_read_b64_tr_b16 v[84:85], v6 offset:8192
v_mfma_f32_16x16x32_bf16 v[212:215], v[180:183], v[104:107], v[212:215]
ds_read_b64_tr_b16 v[86:87], v6 offset:10240
v_mfma_f32_16x16x32_bf16 v[152:155], v[160:163], v[108:111], v[152:155]
ds_read_b64_tr_b16 v[72:73], v5 offset:4096
v_mfma_f32_16x16x32_bf16 v[156:159], v[164:167], v[108:111], v[156:159]
ds_read_b128 v[48:51], v2 offset:8192
v_mfma_f32_16x16x32_bf16 v[216:219], v[176:179], v[108:111], v[216:219]
ds_read_b64_tr_b16 v[74:75], v5 offset:6144
v_mfma_f32_16x16x32_bf16 v[220:223], v[180:183], v[108:111], v[220:223]
ds_read_b128 v[52:55], v2 offset:8448
v_mfma_f32_16x16x32_bf16 v[128:131], v[168:171], v[112:115], v[128:131]
ds_read_b64_tr_b16 v[76:77], v6 offset:4096
v_mfma_f32_16x16x32_bf16 v[132:135], v[172:175], v[112:115], v[132:135]
ds_read_b128 v[56:59], v2 offset:8704
v_mfma_f32_16x16x32_bf16 v[192:195], v[184:187], v[112:115], v[192:195]
ds_read_b64_tr_b16 v[78:79], v6 offset:6144
v_mfma_f32_16x16x32_bf16 v[196:199], v[188:191], v[112:115], v[196:199]
ds_read_b128 v[60:63], v2 offset:8960
v_mfma_f32_16x16x32_bf16 v[136:139], v[168:171], v[116:119], v[136:139]
ds_read_b64_tr_b16 v[88:89], v5 offset:12288
v_mfma_f32_16x16x32_bf16 v[140:143], v[172:175], v[116:119], v[140:143]
ds_read_b64_tr_b16 v[90:91], v5 offset:14336
v_mfma_f32_16x16x32_bf16 v[200:203], v[184:187], v[116:119], v[200:203]
ds_read_b64_tr_b16 v[92:93], v6 offset:12288
v_mfma_f32_16x16x32_bf16 v[204:207], v[188:191], v[116:119], v[204:207]
ds_read_b64_tr_b16 v[94:95], v6 offset:14336
v_mfma_f32_16x16x32_bf16 v[144:147], v[168:171], v[120:123], v[144:147]
v_mfma_f32_16x16x32_bf16 v[148:151], v[172:175], v[120:123], v[148:151]
v_mfma_f32_16x16x32_bf16 v[208:211], v[184:187], v[120:123], v[208:211]
v_mfma_f32_16x16x32_bf16 v[212:215], v[188:191], v[120:123], v[212:215]
v_mfma_f32_16x16x32_bf16 v[152:155], v[168:171], v[124:127], v[152:155]
v_mfma_f32_16x16x32_bf16 v[156:159], v[172:175], v[124:127], v[156:159]
v_mfma_f32_16x16x32_bf16 v[216:219], v[184:187], v[124:127], v[216:219]
v_mfma_f32_16x16x32_bf16 v[220:223], v[188:191], v[124:127], v[220:223]
s_waitcnt lgkmcnt(0)
s_barrier
v_mfma_f32_16x16x32_bf16 v[128:131], v[64:67], v[32:35], v[128:131]
ds_read_b64_tr_b16 v[160:161], v5 offset:32768
v_mfma_f32_16x16x32_bf16 v[132:135], v[68:71], v[32:35], v[132:135]
ds_read_b128 v[96:99], v2 offset:32768
v_mfma_f32_16x16x32_bf16 v[192:195], v[80:83], v[32:35], v[192:195]
ds_read_b64_tr_b16 v[162:163], v5 offset:34816
v_mfma_f32_16x16x32_bf16 v[196:199], v[84:87], v[32:35], v[196:199]
ds_read_b128 v[100:103], v2 offset:33024
v_mfma_f32_16x16x32_bf16 v[136:139], v[64:67], v[36:39], v[136:139]
ds_read_b64_tr_b16 v[164:165], v6 offset:32768
v_mfma_f32_16x16x32_bf16 v[140:143], v[68:71], v[36:39], v[140:143]
ds_read_b128 v[104:107], v2 offset:33280
v_mfma_f32_16x16x32_bf16 v[200:203], v[80:83], v[36:39], v[200:203]
ds_read_b64_tr_b16 v[166:167], v6 offset:34816
v_mfma_f32_16x16x32_bf16 v[204:207], v[84:87], v[36:39], v[204:207]
ds_read_b128 v[108:111], v2 offset:33536
v_mfma_f32_16x16x32_bf16 v[144:147], v[64:67], v[40:43], v[144:147]
ds_read_b64_tr_b16 v[176:177], v5 offset:40960
v_mfma_f32_16x16x32_bf16 v[148:151], v[68:71], v[40:43], v[148:151]
ds_read_b64_tr_b16 v[178:179], v5 offset:43008
v_mfma_f32_16x16x32_bf16 v[208:211], v[80:83], v[40:43], v[208:211]
ds_read_b64_tr_b16 v[180:181], v6 offset:40960
v_mfma_f32_16x16x32_bf16 v[212:215], v[84:87], v[40:43], v[212:215]
ds_read_b64_tr_b16 v[182:183], v6 offset:43008
v_mfma_f32_16x16x32_bf16 v[152:155], v[64:67], v[44:47], v[152:155]
ds_read_b64_tr_b16 v[168:169], v5 offset:36864
v_mfma_f32_16x16x32_bf16 v[156:159], v[68:71], v[44:47], v[156:159]
ds_read_b128 v[112:115], v2 offset:40960
v_mfma_f32_16x16x32_bf16 v[216:219], v[80:83], v[44:47], v[216:219]
ds_read_b64_tr_b16 v[170:171], v5 offset:38912
v_mfma_f32_16x16x32_bf16 v[220:223], v[84:87], v[44:47], v[220:223]
ds_read_b128 v[116:119], v2 offset:41216
v_mfma_f32_16x16x32_bf16 v[128:131], v[72:75], v[48:51], v[128:131]
ds_read_b64_tr_b16 v[172:173], v6 offset:36864
v_mfma_f32_16x16x32_bf16 v[132:135], v[76:79], v[48:51], v[132:135]
ds_read_b128 v[120:123], v2 offset:41472
v_mfma_f32_16x16x32_bf16 v[192:195], v[88:91], v[48:51], v[192:195]
ds_read_b64_tr_b16 v[174:175], v6 offset:38912
v_mfma_f32_16x16x32_bf16 v[196:199], v[92:95], v[48:51], v[196:199]
ds_read_b128 v[124:127], v2 offset:41728
v_mfma_f32_16x16x32_bf16 v[136:139], v[72:75], v[52:55], v[136:139]
ds_read_b64_tr_b16 v[184:185], v5 offset:45056
v_mfma_f32_16x16x32_bf16 v[140:143], v[76:79], v[52:55], v[140:143]
ds_read_b64_tr_b16 v[186:187], v5 offset:47104
v_mfma_f32_16x16x32_bf16 v[200:203], v[88:91], v[52:55], v[200:203]
ds_read_b64_tr_b16 v[188:189], v6 offset:45056
v_mfma_f32_16x16x32_bf16 v[204:207], v[92:95], v[52:55], v[204:207]
ds_read_b64_tr_b16 v[190:191], v6 offset:47104
v_mfma_f32_16x16x32_bf16 v[144:147], v[72:75], v[56:59], v[144:147]
v_mfma_f32_16x16x32_bf16 v[148:151], v[76:79], v[56:59], v[148:151]
v_mfma_f32_16x16x32_bf16 v[208:211], v[88:91], v[56:59], v[208:211]
v_mfma_f32_16x16x32_bf16 v[212:215], v[92:95], v[56:59], v[212:215]
v_mfma_f32_16x16x32_bf16 v[152:155], v[72:75], v[60:63], v[152:155]
v_mfma_f32_16x16x32_bf16 v[156:159], v[76:79], v[60:63], v[156:159]
v_mfma_f32_16x16x32_bf16 v[216:219], v[88:91], v[60:63], v[216:219]
v_mfma_f32_16x16x32_bf16 v[220:223], v[92:95], v[60:63], v[220:223]
s_waitcnt lgkmcnt(0)
s_barrier
v_mfma_f32_16x16x32_bf16 v[128:131], v[160:163], v[96:99], v[128:131]
ds_read_b64_tr_b16 v[64:65], v7 offset:0
v_mfma_f32_16x16x32_bf16 v[132:135], v[164:167], v[96:99], v[132:135]
ds_read_b128 v[32:35], v3 offset:0
v_mfma_f32_16x16x32_bf16 v[192:195], v[176:179], v[96:99], v[192:195]
ds_read_b64_tr_b16 v[66:67], v7 offset:2048
v_mfma_f32_16x16x32_bf16 v[196:199], v[180:183], v[96:99], v[196:199]
ds_read_b128 v[36:39], v3 offset:256
v_mfma_f32_16x16x32_bf16 v[136:139], v[160:163], v[100:103], v[136:139]
ds_read_b64_tr_b16 v[68:69], v8 offset:0
v_mfma_f32_16x16x32_bf16 v[140:143], v[164:167], v[100:103], v[140:143]
ds_read_b128 v[40:43], v3 offset:512
v_mfma_f32_16x16x32_bf16 v[200:203], v[176:179], v[100:103], v[200:203]
ds_read_b64_tr_b16 v[70:71], v8 offset:2048
v_mfma_f32_16x16x32_bf16 v[204:207], v[180:183], v[100:103], v[204:207]
ds_read_b128 v[44:47], v3 offset:768
v_mfma_f32_16x16x32_bf16 v[144:147], v[160:163], v[104:107], v[144:147]
ds_read_b64_tr_b16 v[80:81], v7 offset:8192
v_mfma_f32_16x16x32_bf16 v[148:151], v[164:167], v[104:107], v[148:151]
ds_read_b64_tr_b16 v[82:83], v7 offset:10240
v_mfma_f32_16x16x32_bf16 v[208:211], v[176:179], v[104:107], v[208:211]
ds_read_b64_tr_b16 v[84:85], v8 offset:8192
v_mfma_f32_16x16x32_bf16 v[212:215], v[180:183], v[104:107], v[212:215]
ds_read_b64_tr_b16 v[86:87], v8 offset:10240
v_mfma_f32_16x16x32_bf16 v[152:155], v[160:163], v[108:111], v[152:155]
ds_read_b64_tr_b16 v[72:73], v7 offset:4096
v_mfma_f32_16x16x32_bf16 v[156:159], v[164:167], v[108:111], v[156:159]
ds_read_b128 v[48:51], v3 offset:8192
v_mfma_f32_16x16x32_bf16 v[216:219], v[176:179], v[108:111], v[216:219]
ds_read_b64_tr_b16 v[74:75], v7 offset:6144
v_mfma_f32_16x16x32_bf16 v[220:223], v[180:183], v[108:111], v[220:223]
ds_read_b128 v[52:55], v3 offset:8448
v_mfma_f32_16x16x32_bf16 v[128:131], v[168:171], v[112:115], v[128:131]
ds_read_b64_tr_b16 v[76:77], v8 offset:4096
v_mfma_f32_16x16x32_bf16 v[132:135], v[172:175], v[112:115], v[132:135]
ds_read_b128 v[56:59], v3 offset:8704
v_mfma_f32_16x16x32_bf16 v[192:195], v[184:187], v[112:115], v[192:195]
ds_read_b64_tr_b16 v[78:79], v8 offset:6144
v_mfma_f32_16x16x32_bf16 v[196:199], v[188:191], v[112:115], v[196:199]
ds_read_b128 v[60:63], v3 offset:8960
v_mfma_f32_16x16x32_bf16 v[136:139], v[168:171], v[116:119], v[136:139]
ds_read_b64_tr_b16 v[88:89], v7 offset:12288
v_mfma_f32_16x16x32_bf16 v[140:143], v[172:175], v[116:119], v[140:143]
ds_read_b64_tr_b16 v[90:91], v7 offset:14336
v_mfma_f32_16x16x32_bf16 v[200:203], v[184:187], v[116:119], v[200:203]
ds_read_b64_tr_b16 v[92:93], v8 offset:12288
v_mfma_f32_16x16x32_bf16 v[204:207], v[188:191], v[116:119], v[204:207]
ds_read_b64_tr_b16 v[94:95], v8 offset:14336
v_mfma_f32_16x16x32_bf16 v[144:147], v[168:171], v[120:123], v[144:147]
v_mfma_f32_16x16x32_bf16 v[148:151], v[172:175], v[120:123], v[148:151]
v_mfma_f32_16x16x32_bf16 v[208:211], v[184:187], v[120:123], v[208:211]
v_mfma_f32_16x16x32_bf16 v[212:215], v[188:191], v[120:123], v[212:215]
v_mfma_f32_16x16x32_bf16 v[152:155], v[168:171], v[124:127], v[152:155]
v_mfma_f32_16x16x32_bf16 v[156:159], v[172:175], v[124:127], v[156:159]
v_mfma_f32_16x16x32_bf16 v[216:219], v[184:187], v[124:127], v[216:219]
v_mfma_f32_16x16x32_bf16 v[220:223], v[188:191], v[124:127], v[220:223]
s_sub_u32 s41, s41, 1
s_cmp_lg_u32 s41, 0
s_cbranch_scc1 Lk4_30
s_waitcnt lgkmcnt(0)
s_barrier
v_mfma_f32_16x16x32_bf16 v[128:131], v[64:67], v[32:35], v[128:131]
ds_read_b64_tr_b16 v[160:161], v7 offset:32768
v_mfma_f32_16x16x32_bf16 v[132:135], v[68:71], v[32:35], v[132:135]
ds_read_b128 v[96:99], v3 offset:32768
v_mfma_f32_16x16x32_bf16 v[192:195], v[80:83], v[32:35], v[192:195]
ds_read_b64_tr_b16 v[162:163], v7 offset:34816
v_mfma_f32_16x16x32_bf16 v[196:199], v[84:87], v[32:35], v[196:199]
ds_read_b128 v[100:103], v3 offset:33024
v_mfma_f32_16x16x32_bf16 v[136:139], v[64:67], v[36:39], v[136:139]
ds_read_b64_tr_b16 v[164:165], v8 offset:32768
v_mfma_f32_16x16x32_bf16 v[140:143], v[68:71], v[36:39], v[140:143]
ds_read_b128 v[104:107], v3 offset:33280
v_mfma_f32_16x16x32_bf16 v[200:203], v[80:83], v[36:39], v[200:203]
ds_read_b64_tr_b16 v[166:167], v8 offset:34816
v_mfma_f32_16x16x32_bf16 v[204:207], v[84:87], v[36:39], v[204:207]
ds_read_b128 v[108:111], v3 offset:33536
v_mfma_f32_16x16x32_bf16 v[144:147], v[64:67], v[40:43], v[144:147]
ds_read_b64_tr_b16 v[176:177], v7 offset:40960
v_mfma_f32_16x16x32_bf16 v[148:151], v[68:71], v[40:43], v[148:151]
ds_read_b64_tr_b16 v[178:179], v7 offset:43008
v_mfma_f32_16x16x32_bf16 v[208:211], v[80:83], v[40:43], v[208:211]
ds_read_b64_tr_b16 v[180:181], v8 offset:40960
v_mfma_f32_16x16x32_bf16 v[212:215], v[84:87], v[40:43], v[212:215]
ds_read_b64_tr_b16 v[182:183], v8 offset:43008
v_mfma_f32_16x16x32_bf16 v[152:155], v[64:67], v[44:47], v[152:155]
ds_read_b64_tr_b16 v[168:169], v7 offset:36864
v_mfma_f32_16x16x32_bf16 v[156:159], v[68:71], v[44:47], v[156:159]
ds_read_b128 v[112:115], v3 offset:40960
v_mfma_f32_16x16x32_bf16 v[216:219], v[80:83], v[44:47], v[216:219]
ds_read_b64_tr_b16 v[170:171], v7 offset:38912
v_mfma_f32_16x16x32_bf16 v[220:223], v[84:87], v[44:47], v[220:223]
ds_read_b128 v[116:119], v3 offset:41216
v_mfma_f32_16x16x32_bf16 v[128:131], v[72:75], v[48:51], v[128:131]
ds_read_b64_tr_b16 v[172:173], v8 offset:36864
v_mfma_f32_16x16x32_bf16 v[132:135], v[76:79], v[48:51], v[132:135]
ds_read_b128 v[120:123], v3 offset:41472
v_mfma_f32_16x16x32_bf16 v[192:195], v[88:91], v[48:51], v[192:195]
ds_read_b64_tr_b16 v[174:175], v8 offset:38912
v_mfma_f32_16x16x32_bf16 v[196:199], v[92:95], v[48:51], v[196:199]
ds_read_b128 v[124:127], v3 offset:41728
v_mfma_f32_16x16x32_bf16 v[136:139], v[72:75], v[52:55], v[136:139]
ds_read_b64_tr_b16 v[184:185], v7 offset:45056
v_mfma_f32_16x16x32_bf16 v[140:143], v[76:79], v[52:55], v[140:143]
ds_read_b64_tr_b16 v[186:187], v7 offset:47104
v_mfma_f32_16x16x32_bf16 v[200:203], v[88:91], v[52:55], v[200:203]
ds_read_b64_tr_b16 v[188:189], v8 offset:45056
v_mfma_f32_16x16x32_bf16 v[204:207], v[92:95], v[52:55], v[204:207]
ds_read_b64_tr_b16 v[190:191], v8 offset:47104
v_mfma_f32_16x16x32_bf16 v[144:147], v[72:75], v[56:59], v[144:147]
v_mfma_f32_16x16x32_bf16 v[148:151], v[76:79], v[56:59], v[148:151]
v_mfma_f32_16x16x32_bf16 v[208:211], v[88:91], v[56:59], v[208:211]
v_mfma_f32_16x16x32_bf16 v[212:215], v[92:95], v[56:59], v[212:215]
v_mfma_f32_16x16x32_bf16 v[152:155], v[72:75], v[60:63], v[152:155]
v_mfma_f32_16x16x32_bf16 v[156:159], v[76:79], v[60:63], v[156:159]
v_mfma_f32_16x16x32_bf16 v[216:219], v[88:91], v[60:63], v[216:219]
v_mfma_f32_16x16x32_bf16 v[220:223], v[92:95], v[60:63], v[220:223]
s_waitcnt lgkmcnt(0)
s_barrier
v_mfma_f32_16x16x32_bf16 v[128:131], v[160:163], v[96:99], v[128:131]
ds_read_b64_tr_b16 v[64:65], v5 offset:0
v_mfma_f32_16x16x32_bf16 v[132:135], v[164:167], v[96:99], v[132:135]
ds_read_b128 v[32:35], v2 offset:0
v_mfma_f32_16x16x32_bf16 v[192:195], v[176:179], v[96:99], v[192:195]
ds_read_b64_tr_b16 v[66:67], v5 offset:2048
v_mfma_f32_16x16x32_bf16 v[196:199], v[180:183], v[96:99], v[196:199]
ds_read_b128 v[36:39], v2 offset:256
v_mfma_f32_16x16x32_bf16 v[136:139], v[160:163], v[100:103], v[136:139]
ds_read_b64_tr_b16 v[68:69], v6 offset:0
v_mfma_f32_16x16x32_bf16 v[140:143], v[164:167], v[100:103], v[140:143]
ds_read_b128 v[40:43], v2 offset:512
v_mfma_f32_16x16x32_bf16 v[200:203], v[176:179], v[100:103], v[200:203]
ds_read_b64_tr_b16 v[70:71], v6 offset:2048
v_mfma_f32_16x16x32_bf16 v[204:207], v[180:183], v[100:103], v[204:207]
ds_read_b128 v[44:47], v2 offset:768
v_mfma_f32_16x16x32_bf16 v[144:147], v[160:163], v[104:107], v[144:147]
ds_read_b64_tr_b16 v[80:81], v5 offset:8192
v_mfma_f32_16x16x32_bf16 v[148:151], v[164:167], v[104:107], v[148:151]
ds_read_b64_tr_b16 v[82:83], v5 offset:10240
v_mfma_f32_16x16x32_bf16 v[208:211], v[176:179], v[104:107], v[208:211]
ds_read_b64_tr_b16 v[84:85], v6 offset:8192
v_mfma_f32_16x16x32_bf16 v[212:215], v[180:183], v[104:107], v[212:215]
ds_read_b64_tr_b16 v[86:87], v6 offset:10240
v_mfma_f32_16x16x32_bf16 v[152:155], v[160:163], v[108:111], v[152:155]
ds_read_b64_tr_b16 v[72:73], v5 offset:4096
v_mfma_f32_16x16x32_bf16 v[156:159], v[164:167], v[108:111], v[156:159]
ds_read_b128 v[48:51], v2 offset:8192
v_mfma_f32_16x16x32_bf16 v[216:219], v[176:179], v[108:111], v[216:219]
ds_read_b64_tr_b16 v[74:75], v5 offset:6144
v_mfma_f32_16x16x32_bf16 v[220:223], v[180:183], v[108:111], v[220:223]
ds_read_b128 v[52:55], v2 offset:8448
v_mfma_f32_16x16x32_bf16 v[128:131], v[168:171], v[112:115], v[128:131]
ds_read_b64_tr_b16 v[76:77], v6 offset:4096
v_mfma_f32_16x16x32_bf16 v[132:135], v[172:175], v[112:115], v[132:135]
ds_read_b128 v[56:59], v2 offset:8704
v_mfma_f32_16x16x32_bf16 v[192:195], v[184:187], v[112:115], v[192:195]
ds_read_b64_tr_b16 v[78:79], v6 offset:6144
v_mfma_f32_16x16x32_bf16 v[196:199], v[188:191], v[112:115], v[196:199]
ds_read_b128 v[60:63], v2 offset:8960
v_mfma_f32_16x16x32_bf16 v[136:139], v[168:171], v[116:119], v[136:139]
ds_read_b64_tr_b16 v[88:89], v5 offset:12288
v_mfma_f32_16x16x32_bf16 v[140:143], v[172:175], v[116:119], v[140:143]
ds_read_b64_tr_b16 v[90:91], v5 offset:14336
v_mfma_f32_16x16x32_bf16 v[200:203], v[184:187], v[116:119], v[200:203]
ds_read_b64_tr_b16 v[92:93], v6 offset:12288
v_mfma_f32_16x16x32_bf16 v[204:207], v[188:191], v[116:119], v[204:207]
ds_read_b64_tr_b16 v[94:95], v6 offset:14336
v_mfma_f32_16x16x32_bf16 v[144:147], v[168:171], v[120:123], v[144:147]
v_mfma_f32_16x16x32_bf16 v[148:151], v[172:175], v[120:123], v[148:151]
v_mfma_f32_16x16x32_bf16 v[208:211], v[184:187], v[120:123], v[208:211]
v_mfma_f32_16x16x32_bf16 v[212:215], v[188:191], v[120:123], v[212:215]
v_mfma_f32_16x16x32_bf16 v[152:155], v[168:171], v[124:127], v[152:155]
v_mfma_f32_16x16x32_bf16 v[156:159], v[172:175], v[124:127], v[156:159]
v_mfma_f32_16x16x32_bf16 v[216:219], v[184:187], v[124:127], v[216:219]
v_mfma_f32_16x16x32_bf16 v[220:223], v[188:191], v[124:127], v[220:223]
s_waitcnt lgkmcnt(0)
s_barrier
v_mfma_f32_16x16x32_bf16 v[128:131], v[64:67], v[32:35], v[128:131]
ds_read_b64_tr_b16 v[160:161], v5 offset:32768
v_mfma_f32_16x16x32_bf16 v[132:135], v[68:71], v[32:35], v[132:135]
ds_read_b128 v[96:99], v2 offset:32768
v_mfma_f32_16x16x32_bf16 v[192:195], v[80:83], v[32:35], v[192:195]
ds_read_b64_tr_b16 v[162:163], v5 offset:34816
v_mfma_f32_16x16x32_bf16 v[196:199], v[84:87], v[32:35], v[196:199]
ds_read_b128 v[100:103], v2 offset:33024
v_mfma_f32_16x16x32_bf16 v[136:139], v[64:67], v[36:39], v[136:139]
ds_read_b64_tr_b16 v[164:165], v6 offset:32768
v_mfma_f32_16x16x32_bf16 v[140:143], v[68:71], v[36:39], v[140:143]
ds_read_b128 v[104:107], v2 offset:33280
v_mfma_f32_16x16x32_bf16 v[200:203], v[80:83], v[36:39], v[200:203]
ds_read_b64_tr_b16 v[166:167], v6 offset:34816
v_mfma_f32_16x16x32_bf16 v[204:207], v[84:87], v[36:39], v[204:207]
ds_read_b128 v[108:111], v2 offset:33536
v_mfma_f32_16x16x32_bf16 v[144:147], v[64:67], v[40:43], v[144:147]
ds_read_b64_tr_b16 v[176:177], v5 offset:40960
v_mfma_f32_16x16x32_bf16 v[148:151], v[68:71], v[40:43], v[148:151]
ds_read_b64_tr_b16 v[178:179], v5 offset:43008
v_mfma_f32_16x16x32_bf16 v[208:211], v[80:83], v[40:43], v[208:211]
ds_read_b64_tr_b16 v[180:181], v6 offset:40960
v_mfma_f32_16x16x32_bf16 v[212:215], v[84:87], v[40:43], v[212:215]
ds_read_b64_tr_b16 v[182:183], v6 offset:43008
v_mfma_f32_16x16x32_bf16 v[152:155], v[64:67], v[44:47], v[152:155]
ds_read_b64_tr_b16 v[168:169], v5 offset:36864
v_mfma_f32_16x16x32_bf16 v[156:159], v[68:71], v[44:47], v[156:159]
ds_read_b128 v[112:115], v2 offset:40960
v_mfma_f32_16x16x32_bf16 v[216:219], v[80:83], v[44:47], v[216:219]
ds_read_b64_tr_b16 v[170:171], v5 offset:38912
v_mfma_f32_16x16x32_bf16 v[220:223], v[84:87], v[44:47], v[220:223]
ds_read_b128 v[116:119], v2 offset:41216
v_mfma_f32_16x16x32_bf16 v[128:131], v[72:75], v[48:51], v[128:131]
ds_read_b64_tr_b16 v[172:173], v6 offset:36864
v_mfma_f32_16x16x32_bf16 v[132:135], v[76:79], v[48:51], v[132:135]
ds_read_b128 v[120:123], v2 offset:41472
v_mfma_f32_16x16x32_bf16 v[192:195], v[88:91], v[48:51], v[192:195]
ds_read_b64_tr_b16 v[174:175], v6 offset:38912
v_mfma_f32_16x16x32_bf16 v[196:199], v[92:95], v[48:51], v[196:199]
ds_read_b128 v[124:127], v2 offset:41728
v_mfma_f32_16x16x32_bf16 v[136:139], v[72:75], v[52:55], v[136:139]
ds_read_b64_tr_b16 v[184:185], v5 offset:45056
v_mfma_f32_16x16x32_bf16 v[140:143], v[76:79], v[52:55], v[140:143]
ds_read_b64_tr_b16 v[186:187], v5 offset:47104
v_mfma_f32_16x16x32_bf16 v[200:203], v[88:91], v[52:55], v[200:203]
ds_read_b64_tr_b16 v[188:189], v6 offset:45056
v_mfma_f32_16x16x32_bf16 v[204:207], v[92:95], v[52:55], v[204:207]
ds_read_b64_tr_b16 v[190:191], v6 offset:47104
v_mfma_f32_16x16x32_bf16 v[144:147], v[72:75], v[56:59], v[144:147]
v_mfma_f32_16x16x32_bf16 v[148:151], v[76:79], v[56:59], v[148:151]
v_mfma_f32_16x16x32_bf16 v[208:211], v[88:91], v[56:59], v[208:211]
v_mfma_f32_16x16x32_bf16 v[212:215], v[92:95], v[56:59], v[212:215]
v_mfma_f32_16x16x32_bf16 v[152:155], v[72:75], v[60:63], v[152:155]
v_mfma_f32_16x16x32_bf16 v[156:159], v[76:79], v[60:63], v[156:159]
v_mfma_f32_16x16x32_bf16 v[216:219], v[88:91], v[60:63], v[216:219]
v_mfma_f32_16x16x32_bf16 v[220:223], v[92:95], v[60:63], v[220:223]
s_waitcnt lgkmcnt(0)
s_barrier
v_mfma_f32_16x16x32_bf16 v[128:131], v[160:163], v[96:99], v[128:131]
ds_read_b64_tr_b16 v[64:65], v7 offset:0
v_mfma_f32_16x16x32_bf16 v[132:135], v[164:167], v[96:99], v[132:135]
ds_read_b128 v[32:35], v3 offset:0
v_mfma_f32_16x16x32_bf16 v[192:195], v[176:179], v[96:99], v[192:195]
ds_read_b64_tr_b16 v[66:67], v7 offset:2048
v_mfma_f32_16x16x32_bf16 v[196:199], v[180:183], v[96:99], v[196:199]
ds_read_b128 v[36:39], v3 offset:256
v_mfma_f32_16x16x32_bf16 v[136:139], v[160:163], v[100:103], v[136:139]
ds_read_b64_tr_b16 v[68:69], v8 offset:0
v_mfma_f32_16x16x32_bf16 v[140:143], v[164:167], v[100:103], v[140:143]
ds_read_b128 v[40:43], v3 offset:512
v_mfma_f32_16x16x32_bf16 v[200:203], v[176:179], v[100:103], v[200:203]
ds_read_b64_tr_b16 v[70:71], v8 offset:2048
v_mfma_f32_16x16x32_bf16 v[204:207], v[180:183], v[100:103], v[204:207]
ds_read_b128 v[44:47], v3 offset:768
v_mfma_f32_16x16x32_bf16 v[144:147], v[160:163], v[104:107], v[144:147]
ds_read_b64_tr_b16 v[72:73], v7 offset:4096
v_mfma_f32_16x16x32_bf16 v[148:151], v[164:167], v[104:107], v[148:151]
ds_read_b128 v[48:51], v3 offset:8192
v_mfma_f32_16x16x32_bf16 v[208:211], v[176:179], v[104:107], v[208:211]
ds_read_b64_tr_b16 v[74:75], v7 offset:6144
v_mfma_f32_16x16x32_bf16 v[212:215], v[180:183], v[104:107], v[212:215]
ds_read_b128 v[52:55], v3 offset:8448
v_mfma_f32_16x16x32_bf16 v[152:155], v[160:163], v[108:111], v[152:155]
ds_read_b64_tr_b16 v[76:77], v8 offset:4096
v_mfma_f32_16x16x32_bf16 v[156:159], v[164:167], v[108:111], v[156:159]
ds_read_b128 v[56:59], v3 offset:8704
v_mfma_f32_16x16x32_bf16 v[216:219], v[176:179], v[108:111], v[216:219]
ds_read_b64_tr_b16 v[78:79], v8 offset:6144
v_mfma_f32_16x16x32_bf16 v[220:223], v[180:183], v[108:111], v[220:223]
ds_read_b128 v[60:63], v3 offset:8960
v_mfma_f32_16x16x32_bf16 v[128:131], v[168:171], v[112:115], v[128:131]
v_mfma_f32_16x16x32_bf16 v[132:135], v[172:175], v[112:115], v[132:135]
v_mfma_f32_16x16x32_bf16 v[192:195], v[184:187], v[112:115], v[192:195]
v_mfma_f32_16x16x32_bf16 v[196:199], v[188:191], v[112:115], v[196:199]
v_mfma_f32_16x16x32_bf16 v[136:139], v[168:171], v[116:119], v[136:139]
v_mfma_f32_16x16x32_bf16 v[140:143], v[172:175], v[116:119], v[140:143]
v_mfma_f32_16x16x32_bf16 v[200:203], v[184:187], v[116:119], v[200:203]
v_mfma_f32_16x16x32_bf16 v[204:207], v[188:191], v[116:119], v[204:207]
v_mfma_f32_16x16x32_bf16 v[144:147], v[168:171], v[120:123], v[144:147]
v_mfma_f32_16x16x32_bf16 v[148:151], v[172:175], v[120:123], v[148:151]
v_mfma_f32_16x16x32_bf16 v[208:211], v[184:187], v[120:123], v[208:211]
v_mfma_f32_16x16x32_bf16 v[212:215], v[188:191], v[120:123], v[212:215]
v_mfma_f32_16x16x32_bf16 v[152:155], v[168:171], v[124:127], v[152:155]
v_mfma_f32_16x16x32_bf16 v[156:159], v[172:175], v[124:127], v[156:159]
v_mfma_f32_16x16x32_bf16 v[216:219], v[184:187], v[124:127], v[216:219]
v_mfma_f32_16x16x32_bf16 v[220:223], v[188:191], v[124:127], v[220:223]
s_waitcnt lgkmcnt(0)
s_barrier
v_mfma_f32_16x16x32_bf16 v[128:131], v[64:67], v[32:35], v[128:131]
ds_read_b64_tr_b16 v[160:161], v7 offset:32768
v_mfma_f32_16x16x32_bf16 v[132:135], v[68:71], v[32:35], v[132:135]
ds_read_b128 v[96:99], v3 offset:32768
v_mfma_f32_16x16x32_bf16 v[136:139], v[64:67], v[36:39], v[136:139]
ds_read_b64_tr_b16 v[162:163], v7 offset:34816
v_mfma_f32_16x16x32_bf16 v[140:143], v[68:71], v[36:39], v[140:143]
ds_read_b128 v[100:103], v3 offset:33024
v_cvt_pk_bf16_f32 v224, v192, v193
v_mfma_f32_16x16x32_bf16 v[144:147], v[64:67], v[40:43], v[144:147]
ds_read_b64_tr_b16 v[164:165], v8 offset:32768
v_cvt_pk_bf16_f32 v225, v194, v195
v_mfma_f32_16x16x32_bf16 v[148:151], v[68:71], v[40:43], v[148:151]
v_cvt_pk_bf16_f32 v226, v196, v197
ds_read_b128 v[104:107], v3 offset:33280
v_cvt_pk_bf16_f32 v227, v198, v199
v_mfma_f32_16x16x32_bf16 v[152:155], v[64:67], v[44:47], v[152:155]
buffer_store_dwordx4 v[224:227], v9, s[64:67], 0 offen offset:0 sc1
ds_read_b64_tr_b16 v[166:167], v8 offset:34816
v_cvt_pk_bf16_f32 v228, v200, v201
v_mfma_f32_16x16x32_bf16 v[156:159], v[68:71], v[44:47], v[156:159]
ds_read_b128 v[108:111], v3 offset:33536
v_cvt_pk_bf16_f32 v229, v202, v203
v_mfma_f32_16x16x32_bf16 v[128:131], v[72:75], v[48:51], v[128:131]
v_cvt_pk_bf16_f32 v230, v204, v205
ds_read_b64_tr_b16 v[168:169], v7 offset:36864
v_cvt_pk_bf16_f32 v231, v206, v207
v_mfma_f32_16x16x32_bf16 v[132:135], v[76:79], v[48:51], v[132:135]
buffer_store_dwordx4 v[228:231], v9, s[64:67], 0 offen offset:1024 sc1
ds_read_b128 v[112:115], v3 offset:40960
v_cvt_pk_bf16_f32 v232, v208, v209
v_mfma_f32_16x16x32_bf16 v[136:139], v[72:75], v[52:55], v[136:139]
ds_read_b64_tr_b16 v[170:171], v7 offset:38912
v_cvt_pk_bf16_f32 v233, v210, v211
v_mfma_f32_16x16x32_bf16 v[140:143], v[76:79], v[52:55], v[140:143]
v_cvt_pk_bf16_f32 v234, v212, v213
ds_read_b128 v[116:119], v3 offset:41216
v_cvt_pk_bf16_f32 v235, v214, v215
v_mfma_f32_16x16x32_bf16 v[144:147], v[72:75], v[56:59], v[144:147]
buffer_store_dwordx4 v[232:235], v9, s[64:67], 0 offen offset:2048 sc1
ds_read_b64_tr_b16 v[172:173], v8 offset:36864
v_cvt_pk_bf16_f32 v236, v216, v217
v_mfma_f32_16x16x32_bf16 v[148:151], v[76:79], v[56:59], v[148:151]
ds_read_b128 v[120:123], v3 offset:41472
v_cvt_pk_bf16_f32 v237, v218, v219
v_mfma_f32_16x16x32_bf16 v[152:155], v[72:75], v[60:63], v[152:155]
v_cvt_pk_bf16_f32 v238, v220, v221
ds_read_b64_tr_b16 v[174:175], v8 offset:38912
v_cvt_pk_bf16_f32 v239, v222, v223
v_mfma_f32_16x16x32_bf16 v[156:159], v[76:79], v[60:63], v[156:159]
buffer_store_dwordx4 v[236:239], v9, s[64:67], 0 offen offset:3072 sc1
ds_read_b128 v[124:127], v3 offset:41728
s_waitcnt lgkmcnt(0)
s_barrier
v_mfma_f32_16x16x32_bf16 v[128:131], v[160:163], v[96:99], v[128:131]
ds_read_b64_tr_b16 v[64:65], v5 offset:0
v_mfma_f32_16x16x32_bf16 v[132:135], v[164:167], v[96:99], v[132:135]
ds_read_b128 v[32:35], v2 offset:0
v_mfma_f32_16x16x32_bf16 v[136:139], v[160:163], v[100:103], v[136:139]
ds_read_b64_tr_b16 v[66:67], v5 offset:2048
v_mfma_f32_16x16x32_bf16 v[140:143], v[164:167], v[100:103], v[140:143]
ds_read_b128 v[36:39], v2 offset:256
v_mfma_f32_16x16x32_bf16 v[144:147], v[160:163], v[104:107], v[144:147]
ds_read_b64_tr_b16 v[68:69], v6 offset:0
v_mfma_f32_16x16x32_bf16 v[148:151], v[164:167], v[104:107], v[148:151]
ds_read_b128 v[40:43], v2 offset:512
v_mfma_f32_16x16x32_bf16 v[152:155], v[160:163], v[108:111], v[152:155]
ds_read_b64_tr_b16 v[70:71], v6 offset:2048
v_mfma_f32_16x16x32_bf16 v[156:159], v[164:167], v[108:111], v[156:159]
ds_read_b128 v[44:47], v2 offset:768
v_mfma_f32_16x16x32_bf16 v[128:131], v[168:171], v[112:115], v[128:131]
ds_read_b64_tr_b16 v[72:73], v5 offset:4096
v_mfma_f32_16x16x32_bf16 v[132:135], v[172:175], v[112:115], v[132:135]
ds_read_b128 v[48:51], v2 offset:8192
v_mfma_f32_16x16x32_bf16 v[136:139], v[168:171], v[116:119], v[136:139]
ds_read_b64_tr_b16 v[74:75], v5 offset:6144
v_mfma_f32_16x16x32_bf16 v[140:143], v[172:175], v[116:119], v[140:143]
ds_read_b128 v[52:55], v2 offset:8448
v_mfma_f32_16x16x32_bf16 v[144:147], v[168:171], v[120:123], v[144:147]
ds_read_b64_tr_b16 v[76:77], v6 offset:4096
v_mfma_f32_16x16x32_bf16 v[148:151], v[172:175], v[120:123], v[148:151]
ds_read_b128 v[56:59], v2 offset:8704
v_mfma_f32_16x16x32_bf16 v[152:155], v[168:171], v[124:127], v[152:155]
ds_read_b64_tr_b16 v[78:79], v6 offset:6144
v_mfma_f32_16x16x32_bf16 v[156:159], v[172:175], v[124:127], v[156:159]
ds_read_b128 v[60:63], v2 offset:8960
s_waitcnt lgkmcnt(0)
s_barrier
v_mfma_f32_16x16x32_bf16 v[128:131], v[64:67], v[32:35], v[128:131]
ds_read_b64_tr_b16 v[160:161], v5 offset:32768
v_mfma_f32_16x16x32_bf16 v[132:135], v[68:71], v[32:35], v[132:135]
ds_read_b128 v[96:99], v2 offset:32768
v_mfma_f32_16x16x32_bf16 v[136:139], v[64:67], v[36:39], v[136:139]
ds_read_b64_tr_b16 v[162:163], v5 offset:34816
v_mfma_f32_16x16x32_bf16 v[140:143], v[68:71], v[36:39], v[140:143]
ds_read_b128 v[100:103], v2 offset:33024
v_mfma_f32_16x16x32_bf16 v[144:147], v[64:67], v[40:43], v[144:147]
ds_read_b64_tr_b16 v[164:165], v6 offset:32768
v_mfma_f32_16x16x32_bf16 v[148:151], v[68:71], v[40:43], v[148:151]
ds_read_b128 v[104:107], v2 offset:33280
v_mfma_f32_16x16x32_bf16 v[152:155], v[64:67], v[44:47], v[152:155]
ds_read_b64_tr_b16 v[166:167], v6 offset:34816
v_mfma_f32_16x16x32_bf16 v[156:159], v[68:71], v[44:47], v[156:159]
ds_read_b128 v[108:111], v2 offset:33536
v_mfma_f32_16x16x32_bf16 v[128:131], v[72:75], v[48:51], v[128:131]
ds_read_b64_tr_b16 v[168:169], v5 offset:36864
v_mfma_f32_16x16x32_bf16 v[132:135], v[76:79], v[48:51], v[132:135]
ds_read_b128 v[112:115], v2 offset:40960
v_mfma_f32_16x16x32_bf16 v[136:139], v[72:75], v[52:55], v[136:139]
ds_read_b64_tr_b16 v[170:171], v5 offset:38912
v_mfma_f32_16x16x32_bf16 v[140:143], v[76:79], v[52:55], v[140:143]
ds_read_b128 v[116:119], v2 offset:41216
v_mfma_f32_16x16x32_bf16 v[144:147], v[72:75], v[56:59], v[144:147]
ds_read_b64_tr_b16 v[172:173], v6 offset:36864
v_mfma_f32_16x16x32_bf16 v[148:151], v[76:79], v[56:59], v[148:151]
ds_read_b128 v[120:123], v2 offset:41472
v_mfma_f32_16x16x32_bf16 v[152:155], v[72:75], v[60:63], v[152:155]
ds_read_b64_tr_b16 v[174:175], v6 offset:38912
v_mfma_f32_16x16x32_bf16 v[156:159], v[76:79], v[60:63], v[156:159]
ds_read_b128 v[124:127], v2 offset:41728
s_waitcnt vmcnt(0) lgkmcnt(0)
s_barrier
v_mfma_f32_16x16x32_bf16 v[128:131], v[160:163], v[96:99], v[128:131]
ds_read_b64_tr_b16 v[64:65], v7 offset:0
v_mfma_f32_16x16x32_bf16 v[132:135], v[164:167], v[96:99], v[132:135]
ds_read_b128 v[32:35], v3 offset:0
v_mfma_f32_16x16x32_bf16 v[136:139], v[160:163], v[100:103], v[136:139]
ds_read_b64_tr_b16 v[66:67], v7 offset:2048
v_mfma_f32_16x16x32_bf16 v[140:143], v[164:167], v[100:103], v[140:143]
ds_read_b128 v[36:39], v3 offset:256
v_mfma_f32_16x16x32_bf16 v[144:147], v[160:163], v[104:107], v[144:147]
ds_read_b64_tr_b16 v[68:69], v8 offset:0
v_mfma_f32_16x16x32_bf16 v[148:151], v[164:167], v[104:107], v[148:151]
ds_read_b128 v[40:43], v3 offset:512
v_mfma_f32_16x16x32_bf16 v[152:155], v[160:163], v[108:111], v[152:155]
ds_read_b64_tr_b16 v[70:71], v8 offset:2048
v_mfma_f32_16x16x32_bf16 v[156:159], v[164:167], v[108:111], v[156:159]
ds_read_b128 v[44:47], v3 offset:768
v_mfma_f32_16x16x32_bf16 v[128:131], v[168:171], v[112:115], v[128:131]
ds_read_b64_tr_b16 v[72:73], v7 offset:4096
v_mfma_f32_16x16x32_bf16 v[132:135], v[172:175], v[112:115], v[132:135]
ds_read_b128 v[48:51], v3 offset:8192
v_mfma_f32_16x16x32_bf16 v[136:139], v[168:171], v[116:119], v[136:139]
ds_read_b64_tr_b16 v[74:75], v7 offset:6144
v_mfma_f32_16x16x32_bf16 v[140:143], v[172:175], v[116:119], v[140:143]
ds_read_b128 v[52:55], v3 offset:8448
v_mfma_f32_16x16x32_bf16 v[144:147], v[168:171], v[120:123], v[144:147]
ds_read_b64_tr_b16 v[76:77], v8 offset:4096
v_mfma_f32_16x16x32_bf16 v[148:151], v[172:175], v[120:123], v[148:151]
ds_read_b128 v[56:59], v3 offset:8704
v_mfma_f32_16x16x32_bf16 v[152:155], v[168:171], v[124:127], v[152:155]
ds_read_b64_tr_b16 v[78:79], v8 offset:6144
v_mfma_f32_16x16x32_bf16 v[156:159], v[172:175], v[124:127], v[156:159]
ds_read_b128 v[60:63], v3 offset:8960
s_waitcnt lgkmcnt(0)
s_barrier
v_mfma_f32_16x16x32_bf16 v[128:131], v[64:67], v[32:35], v[128:131]
ds_read_b64_tr_b16 v[160:161], v7 offset:32768
v_mfma_f32_16x16x32_bf16 v[132:135], v[68:71], v[32:35], v[132:135]
ds_read_b128 v[96:99], v3 offset:32768
v_mfma_f32_16x16x32_bf16 v[136:139], v[64:67], v[36:39], v[136:139]
ds_read_b64_tr_b16 v[162:163], v7 offset:34816
v_mfma_f32_16x16x32_bf16 v[140:143], v[68:71], v[36:39], v[140:143]
ds_read_b128 v[100:103], v3 offset:33024
v_mfma_f32_16x16x32_bf16 v[144:147], v[64:67], v[40:43], v[144:147]
ds_read_b64_tr_b16 v[164:165], v8 offset:32768
v_mfma_f32_16x16x32_bf16 v[148:151], v[68:71], v[40:43], v[148:151]
ds_read_b128 v[104:107], v3 offset:33280
v_mfma_f32_16x16x32_bf16 v[152:155], v[64:67], v[44:47], v[152:155]
ds_read_b64_tr_b16 v[166:167], v8 offset:34816
v_mfma_f32_16x16x32_bf16 v[156:159], v[68:71], v[44:47], v[156:159]
ds_read_b128 v[108:111], v3 offset:33536
v_mfma_f32_16x16x32_bf16 v[128:131], v[72:75], v[48:51], v[128:131]
ds_read_b64_tr_b16 v[168:169], v7 offset:36864
v_mfma_f32_16x16x32_bf16 v[132:135], v[76:79], v[48:51], v[132:135]
ds_read_b128 v[112:115], v3 offset:40960
v_mfma_f32_16x16x32_bf16 v[136:139], v[72:75], v[52:55], v[136:139]
ds_read_b64_tr_b16 v[170:171], v7 offset:38912
v_mfma_f32_16x16x32_bf16 v[140:143], v[76:79], v[52:55], v[140:143]
ds_read_b128 v[116:119], v3 offset:41216
v_mfma_f32_16x16x32_bf16 v[144:147], v[72:75], v[56:59], v[144:147]
ds_read_b64_tr_b16 v[172:173], v8 offset:36864
v_mfma_f32_16x16x32_bf16 v[148:151], v[76:79], v[56:59], v[148:151]
ds_read_b128 v[120:123], v3 offset:41472
v_mfma_f32_16x16x32_bf16 v[152:155], v[72:75], v[60:63], v[152:155]
ds_read_b64_tr_b16 v[174:175], v8 offset:38912
v_mfma_f32_16x16x32_bf16 v[156:159], v[76:79], v[60:63], v[156:159]
ds_read_b128 v[124:127], v3 offset:41728
s_waitcnt lgkmcnt(0)
s_barrier
v_mfma_f32_16x16x32_bf16 v[128:131], v[160:163], v[96:99], v[128:131]
ds_read_b64_tr_b16 v[64:65], v5 offset:0
v_mfma_f32_16x16x32_bf16 v[132:135], v[164:167], v[96:99], v[132:135]
ds_read_b128 v[32:35], v2 offset:0
v_mfma_f32_16x16x32_bf16 v[136:139], v[160:163], v[100:103], v[136:139]
ds_read_b64_tr_b16 v[66:67], v5 offset:2048
v_mfma_f32_16x16x32_bf16 v[140:143], v[164:167], v[100:103], v[140:143]
ds_read_b128 v[36:39], v2 offset:256
v_mfma_f32_16x16x32_bf16 v[144:147], v[160:163], v[104:107], v[144:147]
ds_read_b64_tr_b16 v[68:69], v6 offset:0
v_mfma_f32_16x16x32_bf16 v[148:151], v[164:167], v[104:107], v[148:151]
ds_read_b128 v[40:43], v2 offset:512
v_mfma_f32_16x16x32_bf16 v[152:155], v[160:163], v[108:111], v[152:155]
ds_read_b64_tr_b16 v[70:71], v6 offset:2048
v_mfma_f32_16x16x32_bf16 v[156:159], v[164:167], v[108:111], v[156:159]
ds_read_b128 v[44:47], v2 offset:768
v_mfma_f32_16x16x32_bf16 v[128:131], v[168:171], v[112:115], v[128:131]
ds_read_b64_tr_b16 v[72:73], v5 offset:4096
v_mfma_f32_16x16x32_bf16 v[132:135], v[172:175], v[112:115], v[132:135]
ds_read_b128 v[48:51], v2 offset:8192
v_mfma_f32_16x16x32_bf16 v[136:139], v[168:171], v[116:119], v[136:139]
ds_read_b64_tr_b16 v[74:75], v5 offset:6144
v_mfma_f32_16x16x32_bf16 v[140:143], v[172:175], v[116:119], v[140:143]
ds_read_b128 v[52:55], v2 offset:8448
v_mfma_f32_16x16x32_bf16 v[144:147], v[168:171], v[120:123], v[144:147]
ds_read_b64_tr_b16 v[76:77], v6 offset:4096
v_mfma_f32_16x16x32_bf16 v[148:151], v[172:175], v[120:123], v[148:151]
ds_read_b128 v[56:59], v2 offset:8704
v_mfma_f32_16x16x32_bf16 v[152:155], v[168:171], v[124:127], v[152:155]
ds_read_b64_tr_b16 v[78:79], v6 offset:6144
v_mfma_f32_16x16x32_bf16 v[156:159], v[172:175], v[124:127], v[156:159]
ds_read_b128 v[60:63], v2 offset:8960
s_waitcnt lgkmcnt(0)
s_barrier
v_mfma_f32_16x16x32_bf16 v[128:131], v[64:67], v[32:35], v[128:131]
ds_read_b64_tr_b16 v[160:161], v5 offset:32768
v_mfma_f32_16x16x32_bf16 v[132:135], v[68:71], v[32:35], v[132:135]
ds_read_b128 v[96:99], v2 offset:32768
v_mfma_f32_16x16x32_bf16 v[136:139], v[64:67], v[36:39], v[136:139]
ds_read_b64_tr_b16 v[162:163], v5 offset:34816
v_mfma_f32_16x16x32_bf16 v[140:143], v[68:71], v[36:39], v[140:143]
ds_read_b128 v[100:103], v2 offset:33024
v_mfma_f32_16x16x32_bf16 v[144:147], v[64:67], v[40:43], v[144:147]
ds_read_b64_tr_b16 v[164:165], v6 offset:32768
v_mfma_f32_16x16x32_bf16 v[148:151], v[68:71], v[40:43], v[148:151]
ds_read_b128 v[104:107], v2 offset:33280
v_mfma_f32_16x16x32_bf16 v[152:155], v[64:67], v[44:47], v[152:155]
ds_read_b64_tr_b16 v[166:167], v6 offset:34816
v_mfma_f32_16x16x32_bf16 v[156:159], v[68:71], v[44:47], v[156:159]
ds_read_b128 v[108:111], v2 offset:33536
v_mfma_f32_16x16x32_bf16 v[128:131], v[72:75], v[48:51], v[128:131]
ds_read_b64_tr_b16 v[168:169], v5 offset:36864
v_mfma_f32_16x16x32_bf16 v[132:135], v[76:79], v[48:51], v[132:135]
ds_read_b128 v[112:115], v2 offset:40960
v_mfma_f32_16x16x32_bf16 v[136:139], v[72:75], v[52:55], v[136:139]
ds_read_b64_tr_b16 v[170:171], v5 offset:38912
v_mfma_f32_16x16x32_bf16 v[140:143], v[76:79], v[52:55], v[140:143]
ds_read_b128 v[116:119], v2 offset:41216
v_mfma_f32_16x16x32_bf16 v[144:147], v[72:75], v[56:59], v[144:147]
ds_read_b64_tr_b16 v[172:173], v6 offset:36864
v_mfma_f32_16x16x32_bf16 v[148:151], v[76:79], v[56:59], v[148:151]
ds_read_b128 v[120:123], v2 offset:41472
v_mfma_f32_16x16x32_bf16 v[152:155], v[72:75], v[60:63], v[152:155]
ds_read_b64_tr_b16 v[174:175], v6 offset:38912
v_mfma_f32_16x16x32_bf16 v[156:159], v[76:79], v[60:63], v[156:159]
ds_read_b128 v[124:127], v2 offset:41728
s_waitcnt lgkmcnt(0)
s_barrier
v_mfma_f32_16x16x32_bf16 v[128:131], v[160:163], v[96:99], v[128:131]
ds_read_b64_tr_b16 v[64:65], v7 offset:0
v_mfma_f32_16x16x32_bf16 v[132:135], v[164:167], v[96:99], v[132:135]
ds_read_b128 v[32:35], v3 offset:0
v_mfma_f32_16x16x32_bf16 v[136:139], v[160:163], v[100:103], v[136:139]
ds_read_b64_tr_b16 v[66:67], v7 offset:2048
v_mfma_f32_16x16x32_bf16 v[140:143], v[164:167], v[100:103], v[140:143]
ds_read_b128 v[36:39], v3 offset:256
v_mfma_f32_16x16x32_bf16 v[144:147], v[160:163], v[104:107], v[144:147]
ds_read_b64_tr_b16 v[68:69], v8 offset:0
v_mfma_f32_16x16x32_bf16 v[148:151], v[164:167], v[104:107], v[148:151]
ds_read_b128 v[40:43], v3 offset:512
v_mfma_f32_16x16x32_bf16 v[152:155], v[160:163], v[108:111], v[152:155]
ds_read_b64_tr_b16 v[70:71], v8 offset:2048
v_mfma_f32_16x16x32_bf16 v[156:159], v[164:167], v[108:111], v[156:159]
ds_read_b128 v[44:47], v3 offset:768
v_mfma_f32_16x16x32_bf16 v[128:131], v[168:171], v[112:115], v[128:131]
ds_read_b64_tr_b16 v[72:73], v7 offset:4096
v_mfma_f32_16x16x32_bf16 v[132:135], v[172:175], v[112:115], v[132:135]
ds_read_b128 v[48:51], v3 offset:8192
v_mfma_f32_16x16x32_bf16 v[136:139], v[168:171], v[116:119], v[136:139]
ds_read_b64_tr_b16 v[74:75], v7 offset:6144
v_mfma_f32_16x16x32_bf16 v[140:143], v[172:175], v[116:119], v[140:143]
ds_read_b128 v[52:55], v3 offset:8448
v_mfma_f32_16x16x32_bf16 v[144:147], v[168:171], v[120:123], v[144:147]
ds_read_b64_tr_b16 v[76:77], v8 offset:4096
v_mfma_f32_16x16x32_bf16 v[148:151], v[172:175], v[120:123], v[148:151]
ds_read_b128 v[56:59], v3 offset:8704
v_mfma_f32_16x16x32_bf16 v[152:155], v[168:171], v[124:127], v[152:155]
ds_read_b64_tr_b16 v[78:79], v8 offset:6144
v_mfma_f32_16x16x32_bf16 v[156:159], v[172:175], v[124:127], v[156:159]
ds_read_b128 v[60:63], v3 offset:8960
s_waitcnt lgkmcnt(0)
s_barrier
v_mfma_f32_16x16x32_bf16 v[128:131], v[64:67], v[32:35], v[128:131]
ds_read_b64_tr_b16 v[160:161], v7 offset:32768
v_mfma_f32_16x16x32_bf16 v[132:135], v[68:71], v[32:35], v[132:135]
ds_read_b128 v[96:99], v3 offset:32768
v_mfma_f32_16x16x32_bf16 v[136:139], v[64:67], v[36:39], v[136:139]
ds_read_b64_tr_b16 v[162:163], v7 offset:34816
v_mfma_f32_16x16x32_bf16 v[140:143], v[68:71], v[36:39], v[140:143]
ds_read_b128 v[100:103], v3 offset:33024
v_mfma_f32_16x16x32_bf16 v[144:147], v[64:67], v[40:43], v[144:147]
ds_read_b64_tr_b16 v[164:165], v8 offset:32768
v_mfma_f32_16x16x32_bf16 v[148:151], v[68:71], v[40:43], v[148:151]
ds_read_b128 v[104:107], v3 offset:33280
v_mfma_f32_16x16x32_bf16 v[152:155], v[64:67], v[44:47], v[152:155]
ds_read_b64_tr_b16 v[166:167], v8 offset:34816
v_mfma_f32_16x16x32_bf16 v[156:159], v[68:71], v[44:47], v[156:159]
ds_read_b128 v[108:111], v3 offset:33536
v_mfma_f32_16x16x32_bf16 v[128:131], v[72:75], v[48:51], v[128:131]
ds_read_b64_tr_b16 v[168:169], v7 offset:36864
v_mfma_f32_16x16x32_bf16 v[132:135], v[76:79], v[48:51], v[132:135]
ds_read_b128 v[112:115], v3 offset:40960
v_mfma_f32_16x16x32_bf16 v[136:139], v[72:75], v[52:55], v[136:139]
ds_read_b64_tr_b16 v[170:171], v7 offset:38912
v_mfma_f32_16x16x32_bf16 v[140:143], v[76:79], v[52:55], v[140:143]
ds_read_b128 v[116:119], v3 offset:41216
v_mfma_f32_16x16x32_bf16 v[144:147], v[72:75], v[56:59], v[144:147]
ds_read_b64_tr_b16 v[172:173], v8 offset:36864
v_mfma_f32_16x16x32_bf16 v[148:151], v[76:79], v[56:59], v[148:151]
ds_read_b128 v[120:123], v3 offset:41472
v_mfma_f32_16x16x32_bf16 v[152:155], v[72:75], v[60:63], v[152:155]
ds_read_b64_tr_b16 v[174:175], v8 offset:38912
v_mfma_f32_16x16x32_bf16 v[156:159], v[76:79], v[60:63], v[156:159]
ds_read_b128 v[124:127], v3 offset:41728
s_waitcnt lgkmcnt(0)
s_barrier
v_mfma_f32_16x16x32_bf16 v[128:131], v[160:163], v[96:99], v[128:131]
ds_read_b64_tr_b16 v[64:65], v5 offset:0
v_mfma_f32_16x16x32_bf16 v[132:135], v[164:167], v[96:99], v[132:135]
ds_read_b128 v[32:35], v2 offset:0
v_mfma_f32_16x16x32_bf16 v[136:139], v[160:163], v[100:103], v[136:139]
ds_read_b64_tr_b16 v[66:67], v5 offset:2048
v_mfma_f32_16x16x32_bf16 v[140:143], v[164:167], v[100:103], v[140:143]
ds_read_b128 v[36:39], v2 offset:256
buffer_load_dwordx4 v[192:195], v9, s[68:71], 0 offen offset:0 sc1
v_mfma_f32_16x16x32_bf16 v[144:147], v[160:163], v[104:107], v[144:147]
ds_read_b64_tr_b16 v[68:69], v6 offset:0
v_mfma_f32_16x16x32_bf16 v[148:151], v[164:167], v[104:107], v[148:151]
ds_read_b128 v[40:43], v2 offset:512
v_mfma_f32_16x16x32_bf16 v[152:155], v[160:163], v[108:111], v[152:155]
ds_read_b64_tr_b16 v[70:71], v6 offset:2048
buffer_load_dwordx4 v[196:199], v9, s[68:71], 0 offen offset:1024 sc1
v_mfma_f32_16x16x32_bf16 v[156:159], v[164:167], v[108:111], v[156:159]
ds_read_b128 v[44:47], v2 offset:768
v_mfma_f32_16x16x32_bf16 v[128:131], v[168:171], v[112:115], v[128:131]
ds_read_b64_tr_b16 v[72:73], v5 offset:4096
v_mfma_f32_16x16x32_bf16 v[132:135], v[172:175], v[112:115], v[132:135]
ds_read_b128 v[48:51], v2 offset:8192
buffer_load_dwordx4 v[200:203], v9, s[68:71], 0 offen offset:2048 sc1
v_mfma_f32_16x16x32_bf16 v[136:139], v[168:171], v[116:119], v[136:139]
ds_read_b64_tr_b16 v[74:75], v5 offset:6144
v_mfma_f32_16x16x32_bf16 v[140:143], v[172:175], v[116:119], v[140:143]
ds_read_b128 v[52:55], v2 offset:8448
v_mfma_f32_16x16x32_bf16 v[144:147], v[168:171], v[120:123], v[144:147]
ds_read_b64_tr_b16 v[76:77], v6 offset:4096
buffer_load_dwordx4 v[204:207], v9, s[68:71], 0 offen offset:3072 sc1
v_mfma_f32_16x16x32_bf16 v[148:151], v[172:175], v[120:123], v[148:151]
ds_read_b128 v[56:59], v2 offset:8704
v_mfma_f32_16x16x32_bf16 v[152:155], v[168:171], v[124:127], v[152:155]
ds_read_b64_tr_b16 v[78:79], v6 offset:6144
v_mfma_f32_16x16x32_bf16 v[156:159], v[172:175], v[124:127], v[156:159]
ds_read_b128 v[60:63], v2 offset:8960
s_waitcnt lgkmcnt(0)
s_barrier
v_mfma_f32_16x16x32_bf16 v[128:131], v[64:67], v[32:35], v[128:131]
ds_read_b64_tr_b16 v[160:161], v5 offset:32768
v_mfma_f32_16x16x32_bf16 v[132:135], v[68:71], v[32:35], v[132:135]
ds_read_b128 v[96:99], v2 offset:32768
v_mfma_f32_16x16x32_bf16 v[136:139], v[64:67], v[36:39], v[136:139]
ds_read_b64_tr_b16 v[162:163], v5 offset:34816
v_mfma_f32_16x16x32_bf16 v[140:143], v[68:71], v[36:39], v[140:143]
ds_read_b128 v[100:103], v2 offset:33024
v_mfma_f32_16x16x32_bf16 v[144:147], v[64:67], v[40:43], v[144:147]
ds_read_b64_tr_b16 v[164:165], v6 offset:32768
v_mfma_f32_16x16x32_bf16 v[148:151], v[68:71], v[40:43], v[148:151]
ds_read_b128 v[104:107], v2 offset:33280
v_mfma_f32_16x16x32_bf16 v[152:155], v[64:67], v[44:47], v[152:155]
ds_read_b64_tr_b16 v[166:167], v6 offset:34816
v_mfma_f32_16x16x32_bf16 v[156:159], v[68:71], v[44:47], v[156:159]
ds_read_b128 v[108:111], v2 offset:33536
v_mfma_f32_16x16x32_bf16 v[128:131], v[72:75], v[48:51], v[128:131]
ds_read_b64_tr_b16 v[168:169], v5 offset:36864
v_mfma_f32_16x16x32_bf16 v[132:135], v[76:79], v[48:51], v[132:135]
ds_read_b128 v[112:115], v2 offset:40960
v_mfma_f32_16x16x32_bf16 v[136:139], v[72:75], v[52:55], v[136:139]
ds_read_b64_tr_b16 v[170:171], v5 offset:38912
v_mfma_f32_16x16x32_bf16 v[140:143], v[76:79], v[52:55], v[140:143]
ds_read_b128 v[116:119], v2 offset:41216
v_mfma_f32_16x16x32_bf16 v[144:147], v[72:75], v[56:59], v[144:147]
ds_read_b64_tr_b16 v[172:173], v6 offset:36864
v_mfma_f32_16x16x32_bf16 v[148:151], v[76:79], v[56:59], v[148:151]
ds_read_b128 v[120:123], v2 offset:41472
v_mfma_f32_16x16x32_bf16 v[152:155], v[72:75], v[60:63], v[152:155]
ds_read_b64_tr_b16 v[174:175], v6 offset:38912
v_mfma_f32_16x16x32_bf16 v[156:159], v[76:79], v[60:63], v[156:159]
ds_read_b128 v[124:127], v2 offset:41728
s_waitcnt lgkmcnt(0)
s_barrier
v_mfma_f32_16x16x32_bf16 v[128:131], v[160:163], v[96:99], v[128:131]
v_mfma_f32_16x16x32_bf16 v[132:135], v[164:167], v[96:99], v[132:135]
v_mfma_f32_16x16x32_bf16 v[136:139], v[160:163], v[100:103], v[136:139]
v_mfma_f32_16x16x32_bf16 v[140:143], v[164:167], v[100:103], v[140:143]
v_mfma_f32_16x16x32_bf16 v[144:147], v[160:163], v[104:107], v[144:147]
v_mfma_f32_16x16x32_bf16 v[148:151], v[164:167], v[104:107], v[148:151]
v_mfma_f32_16x16x32_bf16 v[152:155], v[160:163], v[108:111], v[152:155]
v_mfma_f32_16x16x32_bf16 v[156:159], v[164:167], v[108:111], v[156:159]
s_waitcnt vmcnt(0)
v_mfma_f32_16x16x32_bf16 v[128:131], v[168:171], v[112:115], v[128:131]
v_lshlrev_b32 v224, 16, v192
v_and_b32 v225, 0xffff0000, v192
v_lshlrev_b32 v226, 16, v193
v_and_b32 v227, 0xffff0000, v193
v_mfma_f32_16x16x32_bf16 v[132:135], v[172:175], v[112:115], v[132:135]
v_lshlrev_b32 v228, 16, v194
v_and_b32 v229, 0xffff0000, v194
v_lshlrev_b32 v230, 16, v195
v_and_b32 v231, 0xffff0000, v195
v_mfma_f32_16x16x32_bf16 v[136:139], v[168:171], v[116:119], v[136:139]
v_lshlrev_b32 v232, 16, v196
v_and_b32 v233, 0xffff0000, v196
v_lshlrev_b32 v234, 16, v197
v_and_b32 v235, 0xffff0000, v197
v_mfma_f32_16x16x32_bf16 v[140:143], v[172:175], v[116:119], v[140:143]
v_lshlrev_b32 v236, 16, v198
v_and_b32 v237, 0xffff0000, v198
v_lshlrev_b32 v238, 16, v199
v_and_b32 v239, 0xffff0000, v199
v_mfma_f32_16x16x32_bf16 v[144:147], v[168:171], v[120:123], v[144:147]
v_lshlrev_b32 v240, 16, v200
v_and_b32 v241, 0xffff0000, v200
v_lshlrev_b32 v242, 16, v201
v_and_b32 v243, 0xffff0000, v201
v_mfma_f32_16x16x32_bf16 v[148:151], v[172:175], v[120:123], v[148:151]
v_lshlrev_b32 v244, 16, v202
v_and_b32 v245, 0xffff0000, v202
v_lshlrev_b32 v246, 16, v203
v_and_b32 v247, 0xffff0000, v203
v_mfma_f32_16x16x32_bf16 v[152:155], v[168:171], v[124:127], v[152:155]
v_lshlrev_b32 v248, 16, v204
v_and_b32 v249, 0xffff0000, v204
v_lshlrev_b32 v250, 16, v205
v_and_b32 v251, 0xffff0000, v205
v_mfma_f32_16x16x32_bf16 v[156:159], v[172:175], v[124:127], v[156:159]
v_lshlrev_b32 v252, 16, v206
v_and_b32 v253, 0xffff0000, v206
v_lshlrev_b32 v254, 16, v207
v_and_b32 v255, 0xffff0000, v207
s_waitcnt vmcnt(0)
s_nop 4
v_pk_add_f32 v[128:129], v[128:129], v[224:225]
v_pk_add_f32 v[130:131], v[130:131], v[226:227]
v_pk_add_f32 v[132:133], v[132:133], v[228:229]
v_pk_add_f32 v[134:135], v[134:135], v[230:231]
v_cvt_pk_bf16_f32 v32, v128, v129
v_cvt_pk_bf16_f32 v33, v130, v131
v_cvt_pk_bf16_f32 v34, v132, v133
v_cvt_pk_bf16_f32 v35, v134, v135
v_pk_add_f32 v[136:137], v[136:137], v[232:233]
v_pk_add_f32 v[138:139], v[138:139], v[234:235]
v_pk_add_f32 v[140:141], v[140:141], v[236:237]
v_pk_add_f32 v[142:143], v[142:143], v[238:239]
v_cvt_pk_bf16_f32 v36, v136, v137
v_cvt_pk_bf16_f32 v37, v138, v139
v_cvt_pk_bf16_f32 v38, v140, v141
v_cvt_pk_bf16_f32 v39, v142, v143
v_pk_add_f32 v[144:145], v[144:145], v[240:241]
v_pk_add_f32 v[146:147], v[146:147], v[242:243]
v_pk_add_f32 v[148:149], v[148:149], v[244:245]
v_pk_add_f32 v[150:151], v[150:151], v[246:247]
v_cvt_pk_bf16_f32 v40, v144, v145
v_cvt_pk_bf16_f32 v41, v146, v147
v_cvt_pk_bf16_f32 v42, v148, v149
v_cvt_pk_bf16_f32 v43, v150, v151
v_pk_add_f32 v[152:153], v[152:153], v[248:249]
v_pk_add_f32 v[154:155], v[154:155], v[250:251]
v_pk_add_f32 v[156:157], v[156:157], v[252:253]
v_pk_add_f32 v[158:159], v[158:159], v[254:255]
v_cvt_pk_bf16_f32 v44, v152, v153
v_cvt_pk_bf16_f32 v45, v154, v155
v_cvt_pk_bf16_f32 v46, v156, v157
v_cvt_pk_bf16_f32 v47, v158, v159
v_permlane16_swap_b32 v32, v34
v_permlane16_swap_b32 v33, v35
buffer_store_dwordx4 v[32:35], v28, s[16:19], 0 offen offset:0
v_permlane16_swap_b32 v36, v38
v_permlane16_swap_b32 v37, v39
buffer_store_dwordx4 v[36:39], v28, s[16:19], 0 offen offset:2048
v_permlane16_swap_b32 v40, v42
v_permlane16_swap_b32 v41, v43
buffer_store_dwordx4 v[40:43], v28, s[16:19], s54 offen offset:0
v_permlane16_swap_b32 v44, v46
v_permlane16_swap_b32 v45, v47
buffer_store_dwordx4 v[44:47], v28, s[16:19], s54 offen offset:2048
s_branch Ldone_1
LG1_21:
s_cmp_eq_u32 s36, 7
s_cbranch_scc1 L7_31
s_mul_i32 s44, s34, 262144
s_lshl_b32 s39, s51, 13
s_add_u32 s44, s44, s39
s_add_u32 s44, s44, 0
s_lshl_b32 s43, s35, 7
s_mov_b32 s10, 253952
s_movk_i32 s38, 1024
s_movk_i32 s40, 9216
s_cmp_eq_u32 s51, 2
s_cselect_b32 s8, s28, s32
s_cselect_b32 s9, s29, s33
s_cselect_b32 s10, 2095232, s10
s_cselect_b32 s43, s43, s44
s_cselect_b32 s38, 16384, s38
s_cselect_b32 s40, 16384, s40
s_cselect_b32 s55, 16384, s38
s_cselect_b32 s45, -1, 0
s_add_u32 s8, s8, s43
s_addc_u32 s9, s9, 0
s_mov_b32 s11, 0x20000
s_sub_u32 s37, 0, s40
v_lshrrev_b32 v19, 3, v1
v_mul_u32_u24 v19, 1920, v19
v_lshrrev_b32 v20, 4, v1
v_lshlrev_b32 v20, 5, v20
v_and_b32 v19, s45, v19
v_and_b32 v20, s45, v20
v_lshlrev_b32 v23, 4, v1
v_xor_b32 v23, v23, v20
v_add_u32 v23, v23, v19
s_lshl_b32 s43, s34, 18
s_add_u32 s12, s32, s43
s_addc_u32 s13, s33, 0
s_mov_b32 s14, 262144
s_mov_b32 s15, 0x20000
v_lshlrev_b32 v21, 4, v1
s_lshl_b32 s54, s36, 11
s_cmp_eq_u32 s51, 1
s_cbranch_scc1 Lp_35
s_cmp_eq_u32 s51, 2
s_cbranch_scc1 Lp_36
Lp_34:
s_add_u32 s43, s34, 0
s_lshl_b32 s43, s43, 7
v_mov_b32 v8, s43
v_mov_b32 v9, 16
s_mov_b32 s41, 0x8000
buffer_load_dword v10, v8, s[56:59], 0 offen sc1
s_sleep 3
buffer_load_dword v11, v8, s[56:59], 0 offen sc1
s_sleep 3
buffer_load_dword v12, v8, s[56:59], 0 offen sc1
s_sleep 3
Lpoll_37:
buffer_load_dword v13, v8, s[56:59], 0 offen sc1
s_waitcnt vmcnt(3)
v_cmp_ne_u32 vcc, v9, v10
s_nop 4
s_cbranch_vccz Lpok_38
buffer_load_dword v10, v8, s[56:59], 0 offen sc1
s_waitcnt vmcnt(3)
v_cmp_ne_u32 vcc, v9, v11
s_nop 4
s_cbranch_vccz Lpok_38
buffer_load_dword v11, v8, s[56:59], 0 offen sc1
s_waitcnt vmcnt(3)
v_cmp_ne_u32 vcc, v9, v12
s_nop 4
s_cbranch_vccz Lpok_38
buffer_load_dword v12, v8, s[56:59], 0 offen sc1
s_waitcnt vmcnt(3)
v_cmp_ne_u32 vcc, v9, v13
s_nop 4
s_cbranch_vccz Lpok_38
s_sub_u32 s41, s41, 1
s_cmp_lg_u32 s41, 0
s_cbranch_scc1 Lpoll_37
Lpok_38:
s_barrier
s_add_u32 m0, s54, 0
s_add_u32 s43, s54, 0
buffer_load_dwordx4 v21, s[12:15], s43 offen sc1 lds
s_add_u32 m0, s54, 1024
s_add_u32 s43, s54, 1024
buffer_load_dwordx4 v21, s[12:15], s43 offen sc1 lds
s_add_u32 m0, s54, 24576
s_add_u32 s43, s54, 16384
buffer_load_dwordx4 v21, s[12:15], s43 offen sc1 lds
s_add_u32 m0, s54, 25600
s_add_u32 s43, s54, 17408
buffer_load_dwordx4 v21, s[12:15], s43 offen sc1 lds
s_add_u32 s37, s37, 32768
s_add_u32 m0, s39, 49152
s_add_u32 s37, s37, s40
buffer_load_dwordx4 v23, s[8:11], s37 offen sc1 lds
s_add_u32 m0, s39, 50176
s_add_u32 s37, s37, s38
buffer_load_dwordx4 v23, s[8:11], s37 offen sc1 lds
s_add_u32 m0, s39, 51200
s_add_u32 s37, s37, s38
buffer_load_dwordx4 v23, s[8:11], s37 offen sc1 lds
s_add_u32 m0, s39, 52224
s_add_u32 s37, s37, s38
buffer_load_dwordx4 v23, s[8:11], s37 offen sc1 lds
s_add_u32 m0, s39, 53248
s_add_u32 s37, s37, s55
buffer_load_dwordx4 v23, s[8:11], s37 offen sc1 lds
s_add_u32 m0, s39, 54272
s_add_u32 s37, s37, s38
buffer_load_dwordx4 v23, s[8:11], s37 offen sc1 lds
s_add_u32 m0, s39, 55296
s_add_u32 s37, s37, s38
buffer_load_dwordx4 v23, s[8:11], s37 offen sc1 lds
s_add_u32 m0, s39, 56320
s_add_u32 s37, s37, s38
buffer_load_dwordx4 v23, s[8:11], s37 offen sc1 lds
s_add_u32 m0, s39, 73728
s_add_u32 s37, s37, s40
buffer_load_dwordx4 v23, s[8:11], s37 offen sc1 lds
s_add_u32 m0, s39, 74752
s_add_u32 s37, s37, s38
buffer_load_dwordx4 v23, s[8:11], s37 offen sc1 lds
s_add_u32 m0, s39, 75776
s_add_u32 s37, s37, s38
buffer_load_dwordx4 v23, s[8:11], s37 offen sc1 lds
s_add_u32 m0, s39, 76800
s_add_u32 s37, s37, s38
buffer_load_dwordx4 v23, s[8:11], s37 offen sc1 lds
s_add_u32 m0, s39, 77824
s_add_u32 s37, s37, s55
buffer_load_dwordx4 v23, s[8:11], s37 offen sc1 lds
s_add_u32 m0, s39, 78848
s_add_u32 s37, s37, s38
buffer_load_dwordx4 v23, s[8:11], s37 offen sc1 lds
s_add_u32 m0, s39, 79872
s_add_u32 s37, s37, s38
buffer_load_dwordx4 v23, s[8:11], s37 offen sc1 lds
s_add_u32 m0, s39, 80896
s_add_u32 s37, s37, s38
buffer_load_dwordx4 v23, s[8:11], s37 offen sc1 lds
s_add_u32 m0, s39, 98304
s_add_u32 s37, s37, s40
buffer_load_dwordx4 v23, s[8:11], s37 offen sc1 lds
s_add_u32 m0, s39, 99328
s_add_u32 s37, s37, s38
buffer_load_dwordx4 v23, s[8:11], s37 offen sc1 lds
s_add_u32 m0, s39, 100352
s_add_u32 s37, s37, s38
buffer_load_dwordx4 v23, s[8:11], s37 offen sc1 lds
s_add_u32 m0, s39, 101376
s_add_u32 s37, s37, s38
buffer_load_dwordx4 v23, s[8:11], s37 offen sc1 lds
s_add_u32 m0, s39, 102400
s_add_u32 s37, s37, s55
buffer_load_dwordx4 v23, s[8:11], s37 offen sc1 lds
s_add_u32 m0, s39, 103424
s_add_u32 s37, s37, s38
buffer_load_dwordx4 v23, s[8:11], s37 offen sc1 lds
s_add_u32 m0, s39, 104448
s_add_u32 s37, s37, s38
buffer_load_dwordx4 v23, s[8:11], s37 offen sc1 lds
s_add_u32 m0, s39, 105472
s_add_u32 s37, s37, s38
buffer_load_dwordx4 v23, s[8:11], s37 offen sc1 lds
s_add_u32 m0, s39, 122880
s_add_u32 s37, s37, s40
buffer_load_dwordx4 v23, s[8:11], s37 offen sc1 lds
s_add_u32 m0, s39, 123904
s_add_u32 s37, s37, s38
buffer_load_dwordx4 v23, s[8:11], s37 offen sc1 lds
s_add_u32 m0, s39, 124928
s_add_u32 s37, s37, s38
buffer_load_dwordx4 v23, s[8:11], s37 offen sc1 lds
s_add_u32 m0, s39, 125952
s_add_u32 s37, s37, s38
buffer_load_dwordx4 v23, s[8:11], s37 offen sc1 lds
s_add_u32 m0, s39, 126976
s_add_u32 s37, s37, s55
buffer_load_dwordx4 v23, s[8:11], s37 offen sc1 lds
s_add_u32 m0, s39, 128000
s_add_u32 s37, s37, s38
buffer_load_dwordx4 v23, s[8:11], s37 offen sc1 lds
s_add_u32 m0, s39, 129024
s_add_u32 s37, s37, s38
buffer_load_dwordx4 v23, s[8:11], s37 offen sc1 lds
s_add_u32 m0, s39, 130048
s_add_u32 s37, s37, s38
buffer_load_dwordx4 v23, s[8:11], s37 offen sc1 lds
s_waitcnt vmcnt(34)
s_barrier
s_waitcnt vmcnt(32)
s_barrier
s_add_u32 m0, s39, 0
s_add_u32 s37, s37, s40
buffer_load_dwordx4 v23, s[8:11], s37 offen sc1 lds
s_add_u32 m0, s39, 1024
s_add_u32 s37, s37, s38
buffer_load_dwordx4 v23, s[8:11], s37 offen sc1 lds
s_add_u32 m0, s39, 2048
s_add_u32 s37, s37, s38
buffer_load_dwordx4 v23, s[8:11], s37 offen sc1 lds
s_add_u32 m0, s39, 3072
s_add_u32 s37, s37, s38
buffer_load_dwordx4 v23, s[8:11], s37 offen sc1 lds
s_add_u32 m0, s39, 4096
s_add_u32 s37, s37, s55
buffer_load_dwordx4 v23, s[8:11], s37 offen sc1 lds
s_add_u32 m0, s39, 5120
s_add_u32 s37, s37, s38
buffer_load_dwordx4 v23, s[8:11], s37 offen sc1 lds
s_add_u32 m0, s39, 6144
s_add_u32 s37, s37, s38
buffer_load_dwordx4 v23, s[8:11], s37 offen sc1 lds
s_add_u32 m0, s39, 7168
s_add_u32 s37, s37, s38
buffer_load_dwordx4 v23, s[8:11], s37 offen sc1 lds
s_waitcnt vmcnt(32)
s_barrier
s_add_u32 m0, s39, 24576
s_add_u32 s37, s37, s40
buffer_load_dwordx4 v23, s[8:11], s37 offen sc1 lds
s_add_u32 m0, s39, 25600
s_add_u32 s37, s37, s38
buffer_load_dwordx4 v23, s[8:11], s37 offen sc1 lds
s_add_u32 m0, s39, 26624
s_add_u32 s37, s37, s38
buffer_load_dwordx4 v23, s[8:11], s37 offen sc1 lds
s_add_u32 m0, s39, 27648
s_add_u32 s37, s37, s38
buffer_load_dwordx4 v23, s[8:11], s37 offen sc1 lds
s_add_u32 m0, s39, 28672
s_add_u32 s37, s37, s55
buffer_load_dwordx4 v23, s[8:11], s37 offen sc1 lds
s_add_u32 m0, s39, 29696
s_add_u32 s37, s37, s38
buffer_load_dwordx4 v23, s[8:11], s37 offen sc1 lds
s_add_u32 m0, s39, 30720
s_add_u32 s37, s37, s38
buffer_load_dwordx4 v23, s[8:11], s37 offen sc1 lds
s_add_u32 m0, s39, 31744
s_add_u32 s37, s37, s38
buffer_load_dwordx4 v23, s[8:11], s37 offen sc1 lds
s_waitcnt vmcnt(32)
s_barrier
s_add_u32 m0, s39, 49152
s_add_u32 s37, s37, s40
buffer_load_dwordx4 v23, s[8:11], s37 offen sc1 lds
s_add_u32 m0, s39, 50176
s_add_u32 s37, s37, s38
buffer_load_dwordx4 v23, s[8:11], s37 offen sc1 lds
s_add_u32 m0, s39, 51200
s_add_u32 s37, s37, s38
buffer_load_dwordx4 v23, s[8:11], s37 offen sc1 lds
s_add_u32 m0, s39, 52224
s_add_u32 s37, s37, s38
buffer_load_dwordx4 v23, s[8:11], s37 offen sc1 lds
s_add_u32 m0, s39, 53248
s_add_u32 s37, s37, s55
buffer_load_dwordx4 v23, s[8:11], s37 offen sc1 lds
s_add_u32 m0, s39, 54272
s_add_u32 s37, s37, s38
buffer_load_dwordx4 v23, s[8:11], s37 offen sc1 lds
s_add_u32 m0, s39, 55296
s_add_u32 s37, s37, s38
buffer_load_dwordx4 v23, s[8:11], s37 offen sc1 lds
s_add_u32 m0, s39, 56320
s_add_u32 s37, s37, s38
buffer_load_dwordx4 v23, s[8:11], s37 offen sc1 lds
s_waitcnt vmcnt(32)
s_barrier
s_add_u32 m0, s39, 73728
s_add_u32 s37, s37, s40
buffer_load_dwordx4 v23, s[8:11], s37 offen sc1 lds
s_add_u32 m0, s39, 74752
s_add_u32 s37, s37, s38
buffer_load_dwordx4 v23, s[8:11], s37 offen sc1 lds
s_add_u32 m0, s39, 75776
s_add_u32 s37, s37, s38
buffer_load_dwordx4 v23, s[8:11], s37 offen sc1 lds
s_add_u32 m0, s39, 76800
s_add_u32 s37, s37, s38
buffer_load_dwordx4 v23, s[8:11], s37 offen sc1 lds
s_add_u32 m0, s39, 77824
s_add_u32 s37, s37, s55
buffer_load_dwordx4 v23, s[8:11], s37 offen sc1 lds
s_add_u32 m0, s39, 78848
s_add_u32 s37, s37, s38
buffer_load_dwordx4 v23, s[8:11], s37 offen sc1 lds
s_add_u32 m0, s39, 79872
s_add_u32 s37, s37, s38
buffer_load_dwordx4 v23, s[8:11], s37 offen sc1 lds
s_add_u32 m0, s39, 80896
s_add_u32 s37, s37, s38
buffer_load_dwordx4 v23, s[8:11], s37 offen sc1 lds
s_waitcnt vmcnt(32)
s_barrier
s_add_u32 m0, s39, 98304
s_add_u32 s37, s37, s40
buffer_load_dwordx4 v23, s[8:11], s37 offen sc1 lds
s_add_u32 m0, s39, 99328
s_add_u32 s37, s37, s38
buffer_load_dwordx4 v23, s[8:11], s37 offen sc1 lds
s_add_u32 m0, s39, 100352
s_add_u32 s37, s37, s38
buffer_load_dwordx4 v23, s[8:11], s37 offen sc1 lds
s_add_u32 m0, s39, 101376
s_add_u32 s37, s37, s38
buffer_load_dwordx4 v23, s[8:11], s37 offen sc1 lds
s_add_u32 m0, s39, 102400
s_add_u32 s37, s37, s55
buffer_load_dwordx4 v23, s[8:11], s37 offen sc1 lds
s_add_u32 m0, s39, 103424
s_add_u32 s37, s37, s38
buffer_load_dwordx4 v23, s[8:11], s37 offen sc1 lds
s_add_u32 m0, s39, 104448
s_add_u32 s37, s37, s38
buffer_load_dwordx4 v23, s[8:11], s37 offen sc1 lds
s_add_u32 m0, s39, 105472
s_add_u32 s37, s37, s38
buffer_load_dwordx4 v23, s[8:11], s37 offen sc1 lds
s_waitcnt vmcnt(32)
s_barrier
s_add_u32 m0, s39, 122880
s_add_u32 s37, s37, s40
buffer_load_dwordx4 v23, s[8:11], s37 offen sc1 lds
s_add_u32 m0, s39, 123904
s_add_u32 s37, s37, s38
buffer_load_dwordx4 v23, s[8:11], s37 offen sc1 lds
s_add_u32 m0, s39, 124928
s_add_u32 s37, s37, s38
buffer_load_dwordx4 v23, s[8:11], s37 offen sc1 lds
s_add_u32 m0, s39, 125952
s_add_u32 s37, s37, s38
buffer_load_dwordx4 v23, s[8:11], s37 offen sc1 lds
s_add_u32 m0, s39, 126976
s_add_u32 s37, s37, s55
buffer_load_dwordx4 v23, s[8:11], s37 offen sc1 lds
s_add_u32 m0, s39, 128000
s_add_u32 s37, s37, s38
buffer_load_dwordx4 v23, s[8:11], s37 offen sc1 lds
s_add_u32 m0, s39, 129024
s_add_u32 s37, s37, s38
buffer_load_dwordx4 v23, s[8:11], s37 offen sc1 lds
s_add_u32 m0, s39, 130048
s_add_u32 s37, s37, s38
buffer_load_dwordx4 v23, s[8:11], s37 offen sc1 lds
s_waitcnt vmcnt(32)
s_barrier
s_add_u32 m0, s39, 0
s_add_u32 s37, s37, s40
buffer_load_dwordx4 v23, s[8:11], s37 offen sc1 lds
s_add_u32 m0, s39, 1024
s_add_u32 s37, s37, s38
buffer_load_dwordx4 v23, s[8:11], s37 offen sc1 lds
s_add_u32 m0, s39, 2048
s_add_u32 s37, s37, s38
buffer_load_dwordx4 v23, s[8:11], s37 offen sc1 lds
s_add_u32 m0, s39, 3072
s_add_u32 s37, s37, s38
buffer_load_dwordx4 v23, s[8:11], s37 offen sc1 lds
s_add_u32 m0, s39, 4096
s_add_u32 s37, s37, s55
buffer_load_dwordx4 v23, s[8:11], s37 offen sc1 lds
s_add_u32 m0, s39, 5120
s_add_u32 s37, s37, s38
buffer_load_dwordx4 v23, s[8:11], s37 offen sc1 lds
s_add_u32 m0, s39, 6144
s_add_u32 s37, s37, s38
buffer_load_dwordx4 v23, s[8:11], s37 offen sc1 lds
s_add_u32 m0, s39, 7168
s_add_u32 s37, s37, s38
buffer_load_dwordx4 v23, s[8:11], s37 offen sc1 lds
s_waitcnt vmcnt(32)
s_barrier
s_add_u32 m0, s39, 24576
s_add_u32 s37, s37, s40
buffer_load_dwordx4 v23, s[8:11], s37 offen sc1 lds
s_add_u32 m0, s39, 25600
s_add_u32 s37, s37, s38
buffer_load_dwordx4 v23, s[8:11], s37 offen sc1 lds
s_add_u32 m0, s39, 26624
s_add_u32 s37, s37, s38
buffer_load_dwordx4 v23, s[8:11], s37 offen sc1 lds
s_add_u32 m0, s39, 27648
s_add_u32 s37, s37, s38
buffer_load_dwordx4 v23, s[8:11], s37 offen sc1 lds
s_add_u32 m0, s39, 28672
s_add_u32 s37, s37, s55
buffer_load_dwordx4 v23, s[8:11], s37 offen sc1 lds
s_add_u32 m0, s39, 29696
s_add_u32 s37, s37, s38
buffer_load_dwordx4 v23, s[8:11], s37 offen sc1 lds
s_add_u32 m0, s39, 30720
s_add_u32 s37, s37, s38
buffer_load_dwordx4 v23, s[8:11], s37 offen sc1 lds
s_add_u32 m0, s39, 31744
s_add_u32 s37, s37, s38
buffer_load_dwordx4 v23, s[8:11], s37 offen sc1 lds
s_waitcnt vmcnt(32)
s_barrier
s_add_u32 m0, s39, 49152
s_add_u32 s37, s37, s40
buffer_load_dwordx4 v23, s[8:11], s37 offen sc1 lds
s_add_u32 m0, s39, 50176
s_add_u32 s37, s37, s38
buffer_load_dwordx4 v23, s[8:11], s37 offen sc1 lds
s_add_u32 m0, s39, 51200
s_add_u32 s37, s37, s38
buffer_load_dwordx4 v23, s[8:11], s37 offen sc1 lds
s_add_u32 m0, s39, 52224
s_add_u32 s37, s37, s38
buffer_load_dwordx4 v23, s[8:11], s37 offen sc1 lds
s_add_u32 m0, s39, 53248
s_add_u32 s37, s37, s55
buffer_load_dwordx4 v23, s[8:11], s37 offen sc1 lds
s_add_u32 m0, s39, 54272
s_add_u32 s37, s37, s38
buffer_load_dwordx4 v23, s[8:11], s37 offen sc1 lds
s_add_u32 m0, s39, 55296
s_add_u32 s37, s37, s38
buffer_load_dwordx4 v23, s[8:11], s37 offen sc1 lds
s_add_u32 m0, s39, 56320
s_add_u32 s37, s37, s38
buffer_load_dwordx4 v23, s[8:11], s37 offen sc1 lds
s_waitcnt vmcnt(32)
s_barrier
s_add_u32 m0, s39, 73728
s_add_u32 s37, s37, s40
buffer_load_dwordx4 v23, s[8:11], s37 offen sc1 lds
s_add_u32 m0, s39, 74752
s_add_u32 s37, s37, s38
buffer_load_dwordx4 v23, s[8:11], s37 offen sc1 lds
s_add_u32 m0, s39, 75776
s_add_u32 s37, s37, s38
buffer_load_dwordx4 v23, s[8:11], s37 offen sc1 lds
s_add_u32 m0, s39, 76800
s_add_u32 s37, s37, s38
buffer_load_dwordx4 v23, s[8:11], s37 offen sc1 lds
s_add_u32 m0, s39, 77824
s_add_u32 s37, s37, s55
buffer_load_dwordx4 v23, s[8:11], s37 offen sc1 lds
s_add_u32 m0, s39, 78848
s_add_u32 s37, s37, s38
buffer_load_dwordx4 v23, s[8:11], s37 offen sc1 lds
s_add_u32 m0, s39, 79872
s_add_u32 s37, s37, s38
buffer_load_dwordx4 v23, s[8:11], s37 offen sc1 lds
s_add_u32 m0, s39, 80896
s_add_u32 s37, s37, s38
buffer_load_dwordx4 v23, s[8:11], s37 offen sc1 lds
s_waitcnt vmcnt(32)
s_barrier
s_lshl_b32 s43, s35, 8
s_cmp_eq_u32 s51, 1
s_cselect_b32 s8, s4, s6
s_cselect_b32 s9, s5, s7
s_sub_u32 s10, 7340032, s43
s_lshl_b32 s44, s34, 18
s_add_u32 s44, s44, 4194304
s_movk_i32 s38, 28672
s_cmp_eq_u32 s51, 0
s_cselect_b32 s8, s32, s8
s_cselect_b32 s9, s33, s9
s_cselect_b32 s10, 262144, s10
s_cselect_b32 s43, s44, s43
s_cselect_b32 s38, 1024, s38
s_cselect_b32 s45, 0, -1
s_add_u32 s8, s8, s43
s_addc_u32 s9, s9, 0
s_mov_b32 s11, 0x20000
s_lshl_b32 s40, s38, 4
s_add_u32 s42, s35, 15
s_lshl_b32 s39, s51, 14
v_lshrrev_b32 v19, 4, v1
v_lshlrev_b32 v20, 5, v19
v_mul_u32_u24 v19, 6912, v19
v_and_b32 v19, s45, v19
v_and_b32 v20, s45, v20
v_lshlrev_b32 v21, 4, v1
v_xor_b32 v21, v21, v20
v_add_u32 v22, v21, v19
s_and_b32 s45, s45, 128
v_xor_b32 v23, s45, v22
s_waitcnt vmcnt(24)
s_barrier
s_waitcnt vmcnt(16)
s_barrier
s_waitcnt vmcnt(8)
s_barrier
s_waitcnt vmcnt(0)
s_barrier
s_barrier
s_barrier
s_add_u32 s42, s42, 3
s_add_u32 s43, s34, 16
s_lshl_b32 s43, s43, 7
v_mov_b32 v8, s43
v_mov_b32 v9, 16
s_mov_b32 s41, 0x8000
buffer_load_dword v10, v8, s[56:59], 0 offen sc1
s_sleep 3
buffer_load_dword v11, v8, s[56:59], 0 offen sc1
s_sleep 3
buffer_load_dword v12, v8, s[56:59], 0 offen sc1
s_sleep 3
Lpoll_39:
buffer_load_dword v13, v8, s[56:59], 0 offen sc1
s_waitcnt vmcnt(3)
v_cmp_ne_u32 vcc, v9, v10
s_nop 4
s_cbranch_vccz Lpok_40
buffer_load_dword v10, v8, s[56:59], 0 offen sc1
s_waitcnt vmcnt(3)
v_cmp_ne_u32 vcc, v9, v11
s_nop 4
s_cbranch_vccz Lpok_40
buffer_load_dword v11, v8, s[56:59], 0 offen sc1
s_waitcnt vmcnt(3)
v_cmp_ne_u32 vcc, v9, v12
s_nop 4
s_cbranch_vccz Lpok_40
buffer_load_dword v12, v8, s[56:59], 0 offen sc1
s_waitcnt vmcnt(3)
v_cmp_ne_u32 vcc, v9, v13
s_nop 4
s_cbranch_vccz Lpok_40
s_sub_u32 s41, s41, 1
s_cmp_lg_u32 s41, 0
s_cbranch_scc1 Lpoll_39
Lpok_40:
s_branch LP3_33
Lp_35:
s_barrier
s_add_u32 m0, s54, 0
s_add_u32 s43, s54, 0
buffer_load_dwordx4 v21, s[12:15], s43 offen sc1 lds
s_add_u32 m0, s54, 1024
s_add_u32 s43, s54, 1024
buffer_load_dwordx4 v21, s[12:15], s43 offen sc1 lds
s_add_u32 m0, s54, 24576
s_add_u32 s43, s54, 16384
buffer_load_dwordx4 v21, s[12:15], s43 offen sc1 lds
s_add_u32 m0, s54, 25600
s_add_u32 s43, s54, 17408
buffer_load_dwordx4 v21, s[12:15], s43 offen sc1 lds
s_add_u32 s37, s37, 32768
s_add_u32 m0, s39, 49152
s_add_u32 s37, s37, s40
buffer_load_dwordx4 v23, s[8:11], s37 offen sc1 lds
s_add_u32 m0, s39, 50176
s_add_u32 s37, s37, s38
buffer_load_dwordx4 v23, s[8:11], s37 offen sc1 lds
s_add_u32 m0, s39, 51200
s_add_u32 s37, s37, s38
buffer_load_dwordx4 v23, s[8:11], s37 offen sc1 lds
s_add_u32 m0, s39, 52224
s_add_u32 s37, s37, s38
buffer_load_dwordx4 v23, s[8:11], s37 offen sc1 lds
s_add_u32 m0, s39, 53248
s_add_u32 s37, s37, s55
buffer_load_dwordx4 v23, s[8:11], s37 offen sc1 lds
s_add_u32 m0, s39, 54272
s_add_u32 s37, s37, s38
buffer_load_dwordx4 v23, s[8:11], s37 offen sc1 lds
s_add_u32 m0, s39, 55296
s_add_u32 s37, s37, s38
buffer_load_dwordx4 v23, s[8:11], s37 offen sc1 lds
s_add_u32 m0, s39, 56320
s_add_u32 s37, s37, s38
buffer_load_dwordx4 v23, s[8:11], s37 offen sc1 lds
s_add_u32 m0, s39, 73728
s_add_u32 s37, s37, s40
buffer_load_dwordx4 v23, s[8:11], s37 offen sc1 lds
s_add_u32 m0, s39, 74752
s_add_u32 s37, s37, s38
buffer_load_dwordx4 v23, s[8:11], s37 offen sc1 lds
s_add_u32 m0, s39, 75776
s_add_u32 s37, s37, s38
buffer_load_dwordx4 v23, s[8:11], s37 offen sc1 lds
s_add_u32 m0, s39, 76800
s_add_u32 s37, s37, s38
buffer_load_dwordx4 v23, s[8:11], s37 offen sc1 lds
s_add_u32 m0, s39, 77824
s_add_u32 s37, s37, s55
buffer_load_dwordx4 v23, s[8:11], s37 offen sc1 lds
s_add_u32 m0, s39, 78848
s_add_u32 s37, s37, s38
buffer_load_dwordx4 v23, s[8:11], s37 offen sc1 lds
s_add_u32 m0, s39, 79872
s_add_u32 s37, s37, s38
buffer_load_dwordx4 v23, s[8:11], s37 offen sc1 lds
s_add_u32 m0, s39, 80896
s_add_u32 s37, s37, s38
buffer_load_dwordx4 v23, s[8:11], s37 offen sc1 lds
s_add_u32 m0, s39, 98304
s_add_u32 s37, s37, s40
buffer_load_dwordx4 v23, s[8:11], s37 offen sc1 lds
s_add_u32 m0, s39, 99328
s_add_u32 s37, s37, s38
buffer_load_dwordx4 v23, s[8:11], s37 offen sc1 lds
s_add_u32 m0, s39, 100352
s_add_u32 s37, s37, s38
buffer_load_dwordx4 v23, s[8:11], s37 offen sc1 lds
s_add_u32 m0, s39, 101376
s_add_u32 s37, s37, s38
buffer_load_dwordx4 v23, s[8:11], s37 offen sc1 lds
s_add_u32 m0, s39, 102400
s_add_u32 s37, s37, s55
buffer_load_dwordx4 v23, s[8:11], s37 offen sc1 lds
s_add_u32 m0, s39, 103424
s_add_u32 s37, s37, s38
buffer_load_dwordx4 v23, s[8:11], s37 offen sc1 lds
s_add_u32 m0, s39, 104448
s_add_u32 s37, s37, s38
buffer_load_dwordx4 v23, s[8:11], s37 offen sc1 lds
s_add_u32 m0, s39, 105472
s_add_u32 s37, s37, s38
buffer_load_dwordx4 v23, s[8:11], s37 offen sc1 lds
s_add_u32 m0, s39, 122880
s_add_u32 s37, s37, s40
buffer_load_dwordx4 v23, s[8:11], s37 offen sc1 lds
s_add_u32 m0, s39, 123904
s_add_u32 s37, s37, s38
buffer_load_dwordx4 v23, s[8:11], s37 offen sc1 lds
s_add_u32 m0, s39, 124928
s_add_u32 s37, s37, s38
buffer_load_dwordx4 v23, s[8:11], s37 offen sc1 lds
s_add_u32 m0, s39, 125952
s_add_u32 s37, s37, s38
buffer_load_dwordx4 v23, s[8:11], s37 offen sc1 lds
s_add_u32 m0, s39, 126976
s_add_u32 s37, s37, s55
buffer_load_dwordx4 v23, s[8:11], s37 offen sc1 lds
s_add_u32 m0, s39, 128000
s_add_u32 s37, s37, s38
buffer_load_dwordx4 v23, s[8:11], s37 offen sc1 lds
s_add_u32 m0, s39, 129024
s_add_u32 s37, s37, s38
buffer_load_dwordx4 v23, s[8:11], s37 offen sc1 lds
s_add_u32 m0, s39, 130048
s_add_u32 s37, s37, s38
buffer_load_dwordx4 v23, s[8:11], s37 offen sc1 lds
s_waitcnt vmcnt(34)
s_barrier
s_waitcnt vmcnt(32)
s_barrier
s_add_u32 m0, s39, 0
s_add_u32 s37, s37, s40
buffer_load_dwordx4 v23, s[8:11], s37 offen sc1 lds
s_add_u32 m0, s39, 1024
s_add_u32 s37, s37, s38
buffer_load_dwordx4 v23, s[8:11], s37 offen sc1 lds
s_add_u32 m0, s39, 2048
s_add_u32 s37, s37, s38
buffer_load_dwordx4 v23, s[8:11], s37 offen sc1 lds
s_add_u32 m0, s39, 3072
s_add_u32 s37, s37, s38
buffer_load_dwordx4 v23, s[8:11], s37 offen sc1 lds
s_add_u32 m0, s39, 4096
s_add_u32 s37, s37, s55
buffer_load_dwordx4 v23, s[8:11], s37 offen sc1 lds
s_add_u32 m0, s39, 5120
s_add_u32 s37, s37, s38
buffer_load_dwordx4 v23, s[8:11], s37 offen sc1 lds
s_add_u32 m0, s39, 6144
s_add_u32 s37, s37, s38
buffer_load_dwordx4 v23, s[8:11], s37 offen sc1 lds
s_add_u32 m0, s39, 7168
s_add_u32 s37, s37, s38
buffer_load_dwordx4 v23, s[8:11], s37 offen sc1 lds
s_waitcnt vmcnt(32)
s_barrier
s_add_u32 m0, s39, 24576
s_add_u32 s37, s37, s40
buffer_load_dwordx4 v23, s[8:11], s37 offen sc1 lds
s_add_u32 m0, s39, 25600
s_add_u32 s37, s37, s38
buffer_load_dwordx4 v23, s[8:11], s37 offen sc1 lds
s_add_u32 m0, s39, 26624
s_add_u32 s37, s37, s38
buffer_load_dwordx4 v23, s[8:11], s37 offen sc1 lds
s_add_u32 m0, s39, 27648
s_add_u32 s37, s37, s38
buffer_load_dwordx4 v23, s[8:11], s37 offen sc1 lds
s_add_u32 m0, s39, 28672
s_add_u32 s37, s37, s55
buffer_load_dwordx4 v23, s[8:11], s37 offen sc1 lds
s_add_u32 m0, s39, 29696
s_add_u32 s37, s37, s38
buffer_load_dwordx4 v23, s[8:11], s37 offen sc1 lds
s_add_u32 m0, s39, 30720
s_add_u32 s37, s37, s38
buffer_load_dwordx4 v23, s[8:11], s37 offen sc1 lds
s_add_u32 m0, s39, 31744
s_add_u32 s37, s37, s38
buffer_load_dwordx4 v23, s[8:11], s37 offen sc1 lds
s_waitcnt vmcnt(32)
s_barrier
s_add_u32 m0, s39, 49152
s_add_u32 s37, s37, s40
buffer_load_dwordx4 v23, s[8:11], s37 offen sc1 lds
s_add_u32 m0, s39, 50176
s_add_u32 s37, s37, s38
buffer_load_dwordx4 v23, s[8:11], s37 offen sc1 lds
s_add_u32 m0, s39, 51200
s_add_u32 s37, s37, s38
buffer_load_dwordx4 v23, s[8:11], s37 offen sc1 lds
s_add_u32 m0, s39, 52224
s_add_u32 s37, s37, s38
buffer_load_dwordx4 v23, s[8:11], s37 offen sc1 lds
s_add_u32 m0, s39, 53248
s_add_u32 s37, s37, s55
buffer_load_dwordx4 v23, s[8:11], s37 offen sc1 lds
s_add_u32 m0, s39, 54272
s_add_u32 s37, s37, s38
buffer_load_dwordx4 v23, s[8:11], s37 offen sc1 lds
s_add_u32 m0, s39, 55296
s_add_u32 s37, s37, s38
buffer_load_dwordx4 v23, s[8:11], s37 offen sc1 lds
s_add_u32 m0, s39, 56320
s_add_u32 s37, s37, s38
buffer_load_dwordx4 v23, s[8:11], s37 offen sc1 lds
s_waitcnt vmcnt(32)
s_barrier
s_add_u32 m0, s39, 73728
s_add_u32 s37, s37, s40
buffer_load_dwordx4 v23, s[8:11], s37 offen sc1 lds
s_add_u32 m0, s39, 74752
s_add_u32 s37, s37, s38
buffer_load_dwordx4 v23, s[8:11], s37 offen sc1 lds
s_add_u32 m0, s39, 75776
s_add_u32 s37, s37, s38
buffer_load_dwordx4 v23, s[8:11], s37 offen sc1 lds
s_add_u32 m0, s39, 76800
s_add_u32 s37, s37, s38
buffer_load_dwordx4 v23, s[8:11], s37 offen sc1 lds
s_add_u32 m0, s39, 77824
s_add_u32 s37, s37, s55
buffer_load_dwordx4 v23, s[8:11], s37 offen sc1 lds
s_add_u32 m0, s39, 78848
s_add_u32 s37, s37, s38
buffer_load_dwordx4 v23, s[8:11], s37 offen sc1 lds
s_add_u32 m0, s39, 79872
s_add_u32 s37, s37, s38
buffer_load_dwordx4 v23, s[8:11], s37 offen sc1 lds
s_add_u32 m0, s39, 80896
s_add_u32 s37, s37, s38
buffer_load_dwordx4 v23, s[8:11], s37 offen sc1 lds
s_waitcnt vmcnt(32)
s_barrier
s_add_u32 m0, s39, 98304
s_add_u32 s37, s37, s40
buffer_load_dwordx4 v23, s[8:11], s37 offen sc1 lds
s_add_u32 m0, s39, 99328
s_add_u32 s37, s37, s38
buffer_load_dwordx4 v23, s[8:11], s37 offen sc1 lds
s_add_u32 m0, s39, 100352
s_add_u32 s37, s37, s38
buffer_load_dwordx4 v23, s[8:11], s37 offen sc1 lds
s_add_u32 m0, s39, 101376
s_add_u32 s37, s37, s38
buffer_load_dwordx4 v23, s[8:11], s37 offen sc1 lds
s_add_u32 m0, s39, 102400
s_add_u32 s37, s37, s55
buffer_load_dwordx4 v23, s[8:11], s37 offen sc1 lds
s_add_u32 m0, s39, 103424
s_add_u32 s37, s37, s38
buffer_load_dwordx4 v23, s[8:11], s37 offen sc1 lds
s_add_u32 m0, s39, 104448
s_add_u32 s37, s37, s38
buffer_load_dwordx4 v23, s[8:11], s37 offen sc1 lds
s_add_u32 m0, s39, 105472
s_add_u32 s37, s37, s38
buffer_load_dwordx4 v23, s[8:11], s37 offen sc1 lds
s_waitcnt vmcnt(32)
s_barrier
s_add_u32 m0, s39, 122880
s_add_u32 s37, s37, s40
buffer_load_dwordx4 v23, s[8:11], s37 offen sc1 lds
s_add_u32 m0, s39, 123904
s_add_u32 s37, s37, s38
buffer_load_dwordx4 v23, s[8:11], s37 offen sc1 lds
s_add_u32 m0, s39, 124928
s_add_u32 s37, s37, s38
buffer_load_dwordx4 v23, s[8:11], s37 offen sc1 lds
s_add_u32 m0, s39, 125952
s_add_u32 s37, s37, s38
buffer_load_dwordx4 v23, s[8:11], s37 offen sc1 lds
s_add_u32 m0, s39, 126976
s_add_u32 s37, s37, s55
buffer_load_dwordx4 v23, s[8:11], s37 offen sc1 lds
s_add_u32 m0, s39, 128000
s_add_u32 s37, s37, s38
buffer_load_dwordx4 v23, s[8:11], s37 offen sc1 lds
s_add_u32 m0, s39, 129024
s_add_u32 s37, s37, s38
buffer_load_dwordx4 v23, s[8:11], s37 offen sc1 lds
s_add_u32 m0, s39, 130048
s_add_u32 s37, s37, s38
buffer_load_dwordx4 v23, s[8:11], s37 offen sc1 lds
s_waitcnt vmcnt(32)
s_barrier
s_add_u32 m0, s39, 0
s_add_u32 s37, s37, s40
buffer_load_dwordx4 v23, s[8:11], s37 offen sc1 lds
s_add_u32 m0, s39, 1024
s_add_u32 s37, s37, s38
buffer_load_dwordx4 v23, s[8:11], s37 offen sc1 lds
s_add_u32 m0, s39, 2048
s_add_u32 s37, s37, s38
buffer_load_dwordx4 v23, s[8:11], s37 offen sc1 lds
s_add_u32 m0, s39, 3072
s_add_u32 s37, s37, s38
buffer_load_dwordx4 v23, s[8:11], s37 offen sc1 lds
s_add_u32 m0, s39, 4096
s_add_u32 s37, s37, s55
buffer_load_dwordx4 v23, s[8:11], s37 offen sc1 lds
s_add_u32 m0, s39, 5120
s_add_u32 s37, s37, s38
buffer_load_dwordx4 v23, s[8:11], s37 offen sc1 lds
s_add_u32 m0, s39, 6144
s_add_u32 s37, s37, s38
buffer_load_dwordx4 v23, s[8:11], s37 offen sc1 lds
s_add_u32 m0, s39, 7168
s_add_u32 s37, s37, s38
buffer_load_dwordx4 v23, s[8:11], s37 offen sc1 lds
s_waitcnt vmcnt(32)
s_barrier
s_add_u32 m0, s39, 24576
s_add_u32 s37, s37, s40
buffer_load_dwordx4 v23, s[8:11], s37 offen sc1 lds
s_add_u32 m0, s39, 25600
s_add_u32 s37, s37, s38
buffer_load_dwordx4 v23, s[8:11], s37 offen sc1 lds
s_add_u32 m0, s39, 26624
s_add_u32 s37, s37, s38
buffer_load_dwordx4 v23, s[8:11], s37 offen sc1 lds
s_add_u32 m0, s39, 27648
s_add_u32 s37, s37, s38
buffer_load_dwordx4 v23, s[8:11], s37 offen sc1 lds
s_add_u32 m0, s39, 28672
s_add_u32 s37, s37, s55
buffer_load_dwordx4 v23, s[8:11], s37 offen sc1 lds
s_add_u32 m0, s39, 29696
s_add_u32 s37, s37, s38
buffer_load_dwordx4 v23, s[8:11], s37 offen sc1 lds
s_add_u32 m0, s39, 30720
s_add_u32 s37, s37, s38
buffer_load_dwordx4 v23, s[8:11], s37 offen sc1 lds
s_add_u32 m0, s39, 31744
s_add_u32 s37, s37, s38
buffer_load_dwordx4 v23, s[8:11], s37 offen sc1 lds
s_waitcnt vmcnt(32)
s_barrier
s_add_u32 m0, s39, 49152
s_add_u32 s37, s37, s40
buffer_load_dwordx4 v23, s[8:11], s37 offen sc1 lds
s_add_u32 m0, s39, 50176
s_add_u32 s37, s37, s38
buffer_load_dwordx4 v23, s[8:11], s37 offen sc1 lds
s_add_u32 m0, s39, 51200
s_add_u32 s37, s37, s38
buffer_load_dwordx4 v23, s[8:11], s37 offen sc1 lds
s_add_u32 m0, s39, 52224
s_add_u32 s37, s37, s38
buffer_load_dwordx4 v23, s[8:11], s37 offen sc1 lds
s_add_u32 m0, s39, 53248
s_add_u32 s37, s37, s55
buffer_load_dwordx4 v23, s[8:11], s37 offen sc1 lds
s_add_u32 m0, s39, 54272
s_add_u32 s37, s37, s38
buffer_load_dwordx4 v23, s[8:11], s37 offen sc1 lds
s_add_u32 m0, s39, 55296
s_add_u32 s37, s37, s38
buffer_load_dwordx4 v23, s[8:11], s37 offen sc1 lds
s_add_u32 m0, s39, 56320
s_add_u32 s37, s37, s38
buffer_load_dwordx4 v23, s[8:11], s37 offen sc1 lds
s_waitcnt vmcnt(32)
s_barrier
s_add_u32 m0, s39, 73728
s_add_u32 s37, s37, s40
buffer_load_dwordx4 v23, s[8:11], s37 offen sc1 lds
s_add_u32 m0, s39, 74752
s_add_u32 s37, s37, s38
buffer_load_dwordx4 v23, s[8:11], s37 offen sc1 lds
s_add_u32 m0, s39, 75776
s_add_u32 s37, s37, s38
buffer_load_dwordx4 v23, s[8:11], s37 offen sc1 lds
s_add_u32 m0, s39, 76800
s_add_u32 s37, s37, s38
buffer_load_dwordx4 v23, s[8:11], s37 offen sc1 lds
s_add_u32 m0, s39, 77824
s_add_u32 s37, s37, s55
buffer_load_dwordx4 v23, s[8:11], s37 offen sc1 lds
s_add_u32 m0, s39, 78848
s_add_u32 s37, s37, s38
buffer_load_dwordx4 v23, s[8:11], s37 offen sc1 lds
s_add_u32 m0, s39, 79872
s_add_u32 s37, s37, s38
buffer_load_dwordx4 v23, s[8:11], s37 offen sc1 lds
s_add_u32 m0, s39, 80896
s_add_u32 s37, s37, s38
buffer_load_dwordx4 v23, s[8:11], s37 offen sc1 lds
s_waitcnt vmcnt(32)
s_barrier
s_lshl_b32 s43, s35, 8
s_cmp_eq_u32 s51, 1
s_cselect_b32 s8, s4, s6
s_cselect_b32 s9, s5, s7
s_sub_u32 s10, 7340032, s43
s_lshl_b32 s44, s34, 18
s_add_u32 s44, s44, 4194304
s_movk_i32 s38, 28672
s_cmp_eq_u32 s51, 0
s_cselect_b32 s8, s32, s8
s_cselect_b32 s9, s33, s9
s_cselect_b32 s10, 262144, s10
s_cselect_b32 s43, s44, s43
s_cselect_b32 s38, 1024, s38
s_cselect_b32 s45, 0, -1
s_add_u32 s8, s8, s43
s_addc_u32 s9, s9, 0
s_mov_b32 s11, 0x20000
s_lshl_b32 s40, s38, 4
s_add_u32 s42, s35, 15
s_lshl_b32 s39, s51, 14
v_lshrrev_b32 v19, 4, v1
v_lshlrev_b32 v20, 5, v19
v_mul_u32_u24 v19, 6912, v19
v_and_b32 v19, s45, v19
v_and_b32 v20, s45, v20
v_lshlrev_b32 v21, 4, v1
v_xor_b32 v21, v21, v20
v_add_u32 v22, v21, v19
s_and_b32 s45, s45, 128
v_xor_b32 v23, s45, v22
s_waitcnt vmcnt(24)
s_barrier
s_add_u32 s42, s42, 1
s_and_b32 s42, s42, 15
s_add_u32 m0, s39, 98304
s_mul_i32 s37, s42, s40
buffer_load_dwordx4 v22, s[8:11], s37 offen sc1 lds
s_add_u32 m0, s39, 99328
s_add_u32 s37, s37, s38
buffer_load_dwordx4 v23, s[8:11], s37 offen sc1 lds
s_add_u32 m0, s39, 100352
s_add_u32 s37, s37, s38
buffer_load_dwordx4 v22, s[8:11], s37 offen sc1 lds
s_add_u32 m0, s39, 101376
s_add_u32 s37, s37, s38
buffer_load_dwordx4 v23, s[8:11], s37 offen sc1 lds
s_add_u32 m0, s39, 102400
s_add_u32 s37, s37, s38
buffer_load_dwordx4 v22, s[8:11], s37 offen sc1 lds
s_add_u32 m0, s39, 103424
s_add_u32 s37, s37, s38
buffer_load_dwordx4 v23, s[8:11], s37 offen sc1 lds
s_add_u32 m0, s39, 104448
s_add_u32 s37, s37, s38
buffer_load_dwordx4 v22, s[8:11], s37 offen sc1 lds
s_add_u32 m0, s39, 105472
s_add_u32 s37, s37, s38
buffer_load_dwordx4 v23, s[8:11], s37 offen sc1 lds
s_add_u32 m0, s39, 106496
s_add_u32 s37, s37, s38
buffer_load_dwordx4 v22, s[8:11], s37 offen sc1 lds
s_add_u32 m0, s39, 107520
s_add_u32 s37, s37, s38
buffer_load_dwordx4 v23, s[8:11], s37 offen sc1 lds
s_add_u32 m0, s39, 108544
s_add_u32 s37, s37, s38
buffer_load_dwordx4 v22, s[8:11], s37 offen sc1 lds
s_add_u32 m0, s39, 109568
s_add_u32 s37, s37, s38
buffer_load_dwordx4 v23, s[8:11], s37 offen sc1 lds
s_add_u32 m0, s39, 110592
s_add_u32 s37, s37, s38
buffer_load_dwordx4 v22, s[8:11], s37 offen sc1 lds
s_add_u32 m0, s39, 111616
s_add_u32 s37, s37, s38
buffer_load_dwordx4 v23, s[8:11], s37 offen sc1 lds
s_add_u32 m0, s39, 112640
s_add_u32 s37, s37, s38
buffer_load_dwordx4 v22, s[8:11], s37 offen sc1 lds
s_add_u32 m0, s39, 113664
s_add_u32 s37, s37, s38
buffer_load_dwordx4 v23, s[8:11], s37 offen sc1 lds
s_waitcnt vmcnt(32)
s_barrier
s_waitcnt vmcnt(24)
s_barrier
s_add_u32 s42, s42, 1
s_and_b32 s42, s42, 15
s_add_u32 m0, s39, 0
s_mul_i32 s37, s42, s40
buffer_load_dwordx4 v22, s[8:11], s37 offen sc1 lds
s_add_u32 m0, s39, 1024
s_add_u32 s37, s37, s38
buffer_load_dwordx4 v23, s[8:11], s37 offen sc1 lds
s_add_u32 m0, s39, 2048
s_add_u32 s37, s37, s38
buffer_load_dwordx4 v22, s[8:11], s37 offen sc1 lds
s_add_u32 m0, s39, 3072
s_add_u32 s37, s37, s38
buffer_load_dwordx4 v23, s[8:11], s37 offen sc1 lds
s_add_u32 m0, s39, 4096
s_add_u32 s37, s37, s38
buffer_load_dwordx4 v22, s[8:11], s37 offen sc1 lds
s_add_u32 m0, s39, 5120
s_add_u32 s37, s37, s38
buffer_load_dwordx4 v23, s[8:11], s37 offen sc1 lds
s_add_u32 m0, s39, 6144
s_add_u32 s37, s37, s38
buffer_load_dwordx4 v22, s[8:11], s37 offen sc1 lds
s_add_u32 m0, s39, 7168
s_add_u32 s37, s37, s38
buffer_load_dwordx4 v23, s[8:11], s37 offen sc1 lds
s_add_u32 m0, s39, 8192
s_add_u32 s37, s37, s38
buffer_load_dwordx4 v22, s[8:11], s37 offen sc1 lds
s_add_u32 m0, s39, 9216
s_add_u32 s37, s37, s38
buffer_load_dwordx4 v23, s[8:11], s37 offen sc1 lds
s_add_u32 m0, s39, 10240
s_add_u32 s37, s37, s38
buffer_load_dwordx4 v22, s[8:11], s37 offen sc1 lds
s_add_u32 m0, s39, 11264
s_add_u32 s37, s37, s38
buffer_load_dwordx4 v23, s[8:11], s37 offen sc1 lds
s_add_u32 m0, s39, 12288
s_add_u32 s37, s37, s38
buffer_load_dwordx4 v22, s[8:11], s37 offen sc1 lds
s_add_u32 m0, s39, 13312
s_add_u32 s37, s37, s38
buffer_load_dwordx4 v23, s[8:11], s37 offen sc1 lds
s_add_u32 m0, s39, 14336
s_add_u32 s37, s37, s38
buffer_load_dwordx4 v22, s[8:11], s37 offen sc1 lds
s_add_u32 m0, s39, 15360
s_add_u32 s37, s37, s38
buffer_load_dwordx4 v23, s[8:11], s37 offen sc1 lds
s_waitcnt vmcnt(32)
s_barrier
s_barrier
s_waitcnt vmcnt(16)
s_barrier
s_add_u32 s42, s42, 1
s_and_b32 s42, s42, 15
s_add_u32 m0, s39, 49152
s_mul_i32 s37, s42, s40
buffer_load_dwordx4 v22, s[8:11], s37 offen sc1 lds
s_add_u32 m0, s39, 50176
s_add_u32 s37, s37, s38
buffer_load_dwordx4 v23, s[8:11], s37 offen sc1 lds
s_add_u32 m0, s39, 51200
s_add_u32 s37, s37, s38
buffer_load_dwordx4 v22, s[8:11], s37 offen sc1 lds
s_add_u32 m0, s39, 52224
s_add_u32 s37, s37, s38
buffer_load_dwordx4 v23, s[8:11], s37 offen sc1 lds
s_add_u32 m0, s39, 53248
s_add_u32 s37, s37, s38
buffer_load_dwordx4 v22, s[8:11], s37 offen sc1 lds
s_add_u32 m0, s39, 54272
s_add_u32 s37, s37, s38
buffer_load_dwordx4 v23, s[8:11], s37 offen sc1 lds
s_add_u32 m0, s39, 55296
s_add_u32 s37, s37, s38
buffer_load_dwordx4 v22, s[8:11], s37 offen sc1 lds
s_add_u32 m0, s39, 56320
s_add_u32 s37, s37, s38
buffer_load_dwordx4 v23, s[8:11], s37 offen sc1 lds
s_add_u32 m0, s39, 57344
s_add_u32 s37, s37, s38
buffer_load_dwordx4 v22, s[8:11], s37 offen sc1 lds
s_add_u32 m0, s39, 58368
s_add_u32 s37, s37, s38
buffer_load_dwordx4 v23, s[8:11], s37 offen sc1 lds
s_add_u32 m0, s39, 59392
s_add_u32 s37, s37, s38
buffer_load_dwordx4 v22, s[8:11], s37 offen sc1 lds
s_add_u32 m0, s39, 60416
s_add_u32 s37, s37, s38
buffer_load_dwordx4 v23, s[8:11], s37 offen sc1 lds
s_add_u32 m0, s39, 61440
s_add_u32 s37, s37, s38
buffer_load_dwordx4 v22, s[8:11], s37 offen sc1 lds
s_add_u32 m0, s39, 62464
s_add_u32 s37, s37, s38
buffer_load_dwordx4 v23, s[8:11], s37 offen sc1 lds
s_add_u32 m0, s39, 63488
s_add_u32 s37, s37, s38
buffer_load_dwordx4 v22, s[8:11], s37 offen sc1 lds
s_add_u32 m0, s39, 64512
s_add_u32 s37, s37, s38
buffer_load_dwordx4 v23, s[8:11], s37 offen sc1 lds
s_branch LP3_33
Lp_36:
s_add_u32 m0, s39, 0
s_add_u32 s37, s37, s40
buffer_load_dwordx4 v23, s[8:11], s37 offen sc1 lds
s_add_u32 m0, s39, 1024
s_add_u32 s37, s37, s38
buffer_load_dwordx4 v23, s[8:11], s37 offen sc1 lds
s_add_u32 m0, s39, 2048
s_add_u32 s37, s37, s38
buffer_load_dwordx4 v23, s[8:11], s37 offen sc1 lds
s_add_u32 m0, s39, 3072
s_add_u32 s37, s37, s38
buffer_load_dwordx4 v23, s[8:11], s37 offen sc1 lds
s_add_u32 m0, s39, 4096
s_add_u32 s37, s37, s55
buffer_load_dwordx4 v23, s[8:11], s37 offen sc1 lds
s_add_u32 m0, s39, 5120
s_add_u32 s37, s37, s38
buffer_load_dwordx4 v23, s[8:11], s37 offen sc1 lds
s_add_u32 m0, s39, 6144
s_add_u32 s37, s37, s38
buffer_load_dwordx4 v23, s[8:11], s37 offen sc1 lds
s_add_u32 m0, s39, 7168
s_add_u32 s37, s37, s38
buffer_load_dwordx4 v23, s[8:11], s37 offen sc1 lds
s_add_u32 m0, s39, 24576
s_add_u32 s37, s37, s40
buffer_load_dwordx4 v23, s[8:11], s37 offen sc1 lds
s_add_u32 m0, s39, 25600
s_add_u32 s37, s37, s38
buffer_load_dwordx4 v23, s[8:11], s37 offen sc1 lds
s_add_u32 m0, s39, 26624
s_add_u32 s37, s37, s38
buffer_load_dwordx4 v23, s[8:11], s37 offen sc1 lds
s_add_u32 m0, s39, 27648
s_add_u32 s37, s37, s38
buffer_load_dwordx4 v23, s[8:11], s37 offen sc1 lds
s_add_u32 m0, s39, 28672
s_add_u32 s37, s37, s55
buffer_load_dwordx4 v23, s[8:11], s37 offen sc1 lds
s_add_u32 m0, s39, 29696
s_add_u32 s37, s37, s38
buffer_load_dwordx4 v23, s[8:11], s37 offen sc1 lds
s_add_u32 m0, s39, 30720
s_add_u32 s37, s37, s38
buffer_load_dwordx4 v23, s[8:11], s37 offen sc1 lds
s_add_u32 m0, s39, 31744
s_add_u32 s37, s37, s38
buffer_load_dwordx4 v23, s[8:11], s37 offen sc1 lds
s_add_u32 m0, s39, 49152
s_add_u32 s37, s37, s40
buffer_load_dwordx4 v23, s[8:11], s37 offen sc1 lds
s_add_u32 m0, s39, 50176
s_add_u32 s37, s37, s38
buffer_load_dwordx4 v23, s[8:11], s37 offen sc1 lds
s_add_u32 m0, s39, 51200
s_add_u32 s37, s37, s38
buffer_load_dwordx4 v23, s[8:11], s37 offen sc1 lds
s_add_u32 m0, s39, 52224
s_add_u32 s37, s37, s38
buffer_load_dwordx4 v23, s[8:11], s37 offen sc1 lds
s_add_u32 m0, s39, 53248
s_add_u32 s37, s37, s55
buffer_load_dwordx4 v23, s[8:11], s37 offen sc1 lds
s_add_u32 m0, s39, 54272
s_add_u32 s37, s37, s38
buffer_load_dwordx4 v23, s[8:11], s37 offen sc1 lds
s_add_u32 m0, s39, 55296
s_add_u32 s37, s37, s38
buffer_load_dwordx4 v23, s[8:11], s37 offen sc1 lds
s_add_u32 m0, s39, 56320
s_add_u32 s37, s37, s38
buffer_load_dwordx4 v23, s[8:11], s37 offen sc1 lds
s_add_u32 m0, s39, 73728
s_add_u32 s37, s37, s40
buffer_load_dwordx4 v23, s[8:11], s37 offen sc1 lds
s_add_u32 m0, s39, 74752
s_add_u32 s37, s37, s38
buffer_load_dwordx4 v23, s[8:11], s37 offen sc1 lds
s_add_u32 m0, s39, 75776
s_add_u32 s37, s37, s38
buffer_load_dwordx4 v23, s[8:11], s37 offen sc1 lds
s_add_u32 m0, s39, 76800
s_add_u32 s37, s37, s38
buffer_load_dwordx4 v23, s[8:11], s37 offen sc1 lds
s_add_u32 m0, s39, 77824
s_add_u32 s37, s37, s55
buffer_load_dwordx4 v23, s[8:11], s37 offen sc1 lds
s_add_u32 m0, s39, 78848
s_add_u32 s37, s37, s38
buffer_load_dwordx4 v23, s[8:11], s37 offen sc1 lds
s_add_u32 m0, s39, 79872
s_add_u32 s37, s37, s38
buffer_load_dwordx4 v23, s[8:11], s37 offen sc1 lds
s_add_u32 m0, s39, 80896
s_add_u32 s37, s37, s38
buffer_load_dwordx4 v23, s[8:11], s37 offen sc1 lds
s_add_u32 m0, s39, 98304
s_add_u32 s37, s37, s40
buffer_load_dwordx4 v23, s[8:11], s37 offen sc1 lds
s_add_u32 m0, s39, 99328
s_add_u32 s37, s37, s38
buffer_load_dwordx4 v23, s[8:11], s37 offen sc1 lds
s_add_u32 m0, s39, 100352
s_add_u32 s37, s37, s38
buffer_load_dwordx4 v23, s[8:11], s37 offen sc1 lds
s_add_u32 m0, s39, 101376
s_add_u32 s37, s37, s38
buffer_load_dwordx4 v23, s[8:11], s37 offen sc1 lds
s_add_u32 m0, s39, 102400
s_add_u32 s37, s37, s55
buffer_load_dwordx4 v23, s[8:11], s37 offen sc1 lds
s_add_u32 m0, s39, 103424
s_add_u32 s37, s37, s38
buffer_load_dwordx4 v23, s[8:11], s37 offen sc1 lds
s_add_u32 m0, s39, 104448
s_add_u32 s37, s37, s38
buffer_load_dwordx4 v23, s[8:11], s37 offen sc1 lds
s_add_u32 m0, s39, 105472
s_add_u32 s37, s37, s38
buffer_load_dwordx4 v23, s[8:11], s37 offen sc1 lds
s_add_u32 m0, s39, 122880
s_add_u32 s37, s37, s40
buffer_load_dwordx4 v23, s[8:11], s37 offen sc1 lds
s_add_u32 m0, s39, 123904
s_add_u32 s37, s37, s38
buffer_load_dwordx4 v23, s[8:11], s37 offen sc1 lds
s_add_u32 m0, s39, 124928
s_add_u32 s37, s37, s38
buffer_load_dwordx4 v23, s[8:11], s37 offen sc1 lds
s_add_u32 m0, s39, 125952
s_add_u32 s37, s37, s38
buffer_load_dwordx4 v23, s[8:11], s37 offen sc1 lds
s_add_u32 m0, s39, 126976
s_add_u32 s37, s37, s55
buffer_load_dwordx4 v23, s[8:11], s37 offen sc1 lds
s_add_u32 m0, s39, 128000
s_add_u32 s37, s37, s38
buffer_load_dwordx4 v23, s[8:11], s37 offen sc1 lds
s_add_u32 m0, s39, 129024
s_add_u32 s37, s37, s38
buffer_load_dwordx4 v23, s[8:11], s37 offen sc1 lds
s_add_u32 m0, s39, 130048
s_add_u32 s37, s37, s38
buffer_load_dwordx4 v23, s[8:11], s37 offen sc1 lds
s_barrier
s_add_u32 m0, s54, 0
s_add_u32 s43, s54, 0
buffer_load_dwordx4 v21, s[12:15], s43 offen sc1 lds
s_add_u32 m0, s54, 1024
s_add_u32 s43, s54, 1024
buffer_load_dwordx4 v21, s[12:15], s43 offen sc1 lds
s_add_u32 m0, s54, 24576
s_add_u32 s43, s54, 16384
buffer_load_dwordx4 v21, s[12:15], s43 offen sc1 lds
s_add_u32 m0, s54, 25600
s_add_u32 s43, s54, 17408
buffer_load_dwordx4 v21, s[12:15], s43 offen sc1 lds
s_waitcnt vmcnt(2)
s_barrier
s_waitcnt vmcnt(0)
s_barrier
s_add_u32 m0, s39, 0
s_add_u32 s37, s37, s40
buffer_load_dwordx4 v23, s[8:11], s37 offen sc1 lds
s_add_u32 m0, s39, 1024
s_add_u32 s37, s37, s38
buffer_load_dwordx4 v23, s[8:11], s37 offen sc1 lds
s_add_u32 m0, s39, 2048
s_add_u32 s37, s37, s38
buffer_load_dwordx4 v23, s[8:11], s37 offen sc1 lds
s_add_u32 m0, s39, 3072
s_add_u32 s37, s37, s38
buffer_load_dwordx4 v23, s[8:11], s37 offen sc1 lds
s_add_u32 m0, s39, 4096
s_add_u32 s37, s37, s55
buffer_load_dwordx4 v23, s[8:11], s37 offen sc1 lds
s_add_u32 m0, s39, 5120
s_add_u32 s37, s37, s38
buffer_load_dwordx4 v23, s[8:11], s37 offen sc1 lds
s_add_u32 m0, s39, 6144
s_add_u32 s37, s37, s38
buffer_load_dwordx4 v23, s[8:11], s37 offen sc1 lds
s_add_u32 m0, s39, 7168
s_add_u32 s37, s37, s38
buffer_load_dwordx4 v23, s[8:11], s37 offen sc1 lds
s_waitcnt vmcnt(36)
s_barrier
s_add_u32 m0, s39, 24576
s_add_u32 s37, s37, s40
buffer_load_dwordx4 v23, s[8:11], s37 offen sc1 lds
s_add_u32 m0, s39, 25600
s_add_u32 s37, s37, s38
buffer_load_dwordx4 v23, s[8:11], s37 offen sc1 lds
s_add_u32 m0, s39, 26624
s_add_u32 s37, s37, s38
buffer_load_dwordx4 v23, s[8:11], s37 offen sc1 lds
s_add_u32 m0, s39, 27648
s_add_u32 s37, s37, s38
buffer_load_dwordx4 v23, s[8:11], s37 offen sc1 lds
s_add_u32 m0, s39, 28672
s_add_u32 s37, s37, s55
buffer_load_dwordx4 v23, s[8:11], s37 offen sc1 lds
s_add_u32 m0, s39, 29696
s_add_u32 s37, s37, s38
buffer_load_dwordx4 v23, s[8:11], s37 offen sc1 lds
s_add_u32 m0, s39, 30720
s_add_u32 s37, s37, s38
buffer_load_dwordx4 v23, s[8:11], s37 offen sc1 lds
s_add_u32 m0, s39, 31744
s_add_u32 s37, s37, s38
buffer_load_dwordx4 v23, s[8:11], s37 offen sc1 lds
s_waitcnt vmcnt(36)
s_barrier
s_add_u32 m0, s39, 49152
s_add_u32 s37, s37, s40
buffer_load_dwordx4 v23, s[8:11], s37 offen sc1 lds
s_add_u32 m0, s39, 50176
s_add_u32 s37, s37, s38
buffer_load_dwordx4 v23, s[8:11], s37 offen sc1 lds
s_add_u32 m0, s39, 51200
s_add_u32 s37, s37, s38
buffer_load_dwordx4 v23, s[8:11], s37 offen sc1 lds
s_add_u32 m0, s39, 52224
s_add_u32 s37, s37, s38
buffer_load_dwordx4 v23, s[8:11], s37 offen sc1 lds
s_add_u32 m0, s39, 53248
s_add_u32 s37, s37, s55
buffer_load_dwordx4 v23, s[8:11], s37 offen sc1 lds
s_add_u32 m0, s39, 54272
s_add_u32 s37, s37, s38
buffer_load_dwordx4 v23, s[8:11], s37 offen sc1 lds
s_add_u32 m0, s39, 55296
s_add_u32 s37, s37, s38
buffer_load_dwordx4 v23, s[8:11], s37 offen sc1 lds
s_add_u32 m0, s39, 56320
s_add_u32 s37, s37, s38
buffer_load_dwordx4 v23, s[8:11], s37 offen sc1 lds
s_waitcnt vmcnt(36)
s_barrier
s_add_u32 m0, s39, 73728
s_add_u32 s37, s37, s40
buffer_load_dwordx4 v23, s[8:11], s37 offen sc1 lds
s_add_u32 m0, s39, 74752
s_add_u32 s37, s37, s38
buffer_load_dwordx4 v23, s[8:11], s37 offen sc1 lds
s_add_u32 m0, s39, 75776
s_add_u32 s37, s37, s38
buffer_load_dwordx4 v23, s[8:11], s37 offen sc1 lds
s_add_u32 m0, s39, 76800
s_add_u32 s37, s37, s38
buffer_load_dwordx4 v23, s[8:11], s37 offen sc1 lds
s_add_u32 m0, s39, 77824
s_add_u32 s37, s37, s55
buffer_load_dwordx4 v23, s[8:11], s37 offen sc1 lds
s_add_u32 m0, s39, 78848
s_add_u32 s37, s37, s38
buffer_load_dwordx4 v23, s[8:11], s37 offen sc1 lds
s_add_u32 m0, s39, 79872
s_add_u32 s37, s37, s38
buffer_load_dwordx4 v23, s[8:11], s37 offen sc1 lds
s_add_u32 m0, s39, 80896
s_add_u32 s37, s37, s38
buffer_load_dwordx4 v23, s[8:11], s37 offen sc1 lds
s_waitcnt vmcnt(36)
s_barrier
s_add_u32 m0, s39, 98304
s_add_u32 s37, s37, s40
buffer_load_dwordx4 v23, s[8:11], s37 offen sc1 lds
s_add_u32 m0, s39, 99328
s_add_u32 s37, s37, s38
buffer_load_dwordx4 v23, s[8:11], s37 offen sc1 lds
s_add_u32 m0, s39, 100352
s_add_u32 s37, s37, s38
buffer_load_dwordx4 v23, s[8:11], s37 offen sc1 lds
s_add_u32 m0, s39, 101376
s_add_u32 s37, s37, s38
buffer_load_dwordx4 v23, s[8:11], s37 offen sc1 lds
s_add_u32 m0, s39, 102400
s_add_u32 s37, s37, s55
buffer_load_dwordx4 v23, s[8:11], s37 offen sc1 lds
s_add_u32 m0, s39, 103424
s_add_u32 s37, s37, s38
buffer_load_dwordx4 v23, s[8:11], s37 offen sc1 lds
s_add_u32 m0, s39, 104448
s_add_u32 s37, s37, s38
buffer_load_dwordx4 v23, s[8:11], s37 offen sc1 lds
s_add_u32 m0, s39, 105472
s_add_u32 s37, s37, s38
buffer_load_dwordx4 v23, s[8:11], s37 offen sc1 lds
s_waitcnt vmcnt(32)
s_barrier
s_add_u32 m0, s39, 122880
s_add_u32 s37, s37, s40
buffer_load_dwordx4 v23, s[8:11], s37 offen sc1 lds
s_add_u32 m0, s39, 123904
s_add_u32 s37, s37, s38
buffer_load_dwordx4 v23, s[8:11], s37 offen sc1 lds
s_add_u32 m0, s39, 124928
s_add_u32 s37, s37, s38
buffer_load_dwordx4 v23, s[8:11], s37 offen sc1 lds
s_add_u32 m0, s39, 125952
s_add_u32 s37, s37, s38
buffer_load_dwordx4 v23, s[8:11], s37 offen sc1 lds
s_add_u32 m0, s39, 126976
s_add_u32 s37, s37, s55
buffer_load_dwordx4 v23, s[8:11], s37 offen sc1 lds
s_add_u32 m0, s39, 128000
s_add_u32 s37, s37, s38
buffer_load_dwordx4 v23, s[8:11], s37 offen sc1 lds
s_add_u32 m0, s39, 129024
s_add_u32 s37, s37, s38
buffer_load_dwordx4 v23, s[8:11], s37 offen sc1 lds
s_add_u32 m0, s39, 130048
s_add_u32 s37, s37, s38
buffer_load_dwordx4 v23, s[8:11], s37 offen sc1 lds
s_waitcnt vmcnt(32)
s_barrier
s_add_u32 m0, s39, 0
s_add_u32 s37, s37, s40
buffer_load_dwordx4 v23, s[8:11], s37 offen sc1 lds
s_add_u32 m0, s39, 1024
s_add_u32 s37, s37, s38
buffer_load_dwordx4 v23, s[8:11], s37 offen sc1 lds
s_add_u32 m0, s39, 2048
s_add_u32 s37, s37, s38
buffer_load_dwordx4 v23, s[8:11], s37 offen sc1 lds
s_add_u32 m0, s39, 3072
s_add_u32 s37, s37, s38
buffer_load_dwordx4 v23, s[8:11], s37 offen sc1 lds
s_add_u32 m0, s39, 4096
s_add_u32 s37, s37, s55
buffer_load_dwordx4 v23, s[8:11], s37 offen sc1 lds
s_add_u32 m0, s39, 5120
s_add_u32 s37, s37, s38
buffer_load_dwordx4 v23, s[8:11], s37 offen sc1 lds
s_add_u32 m0, s39, 6144
s_add_u32 s37, s37, s38
buffer_load_dwordx4 v23, s[8:11], s37 offen sc1 lds
s_add_u32 m0, s39, 7168
s_add_u32 s37, s37, s38
buffer_load_dwordx4 v23, s[8:11], s37 offen sc1 lds
s_waitcnt vmcnt(32)
s_barrier
s_add_u32 m0, s39, 24576
s_add_u32 s37, s37, s40
buffer_load_dwordx4 v23, s[8:11], s37 offen sc1 lds
s_add_u32 m0, s39, 25600
s_add_u32 s37, s37, s38
buffer_load_dwordx4 v23, s[8:11], s37 offen sc1 lds
s_add_u32 m0, s39, 26624
s_add_u32 s37, s37, s38
buffer_load_dwordx4 v23, s[8:11], s37 offen sc1 lds
s_add_u32 m0, s39, 27648
s_add_u32 s37, s37, s38
buffer_load_dwordx4 v23, s[8:11], s37 offen sc1 lds
s_add_u32 m0, s39, 28672
s_add_u32 s37, s37, s55
buffer_load_dwordx4 v23, s[8:11], s37 offen sc1 lds
s_add_u32 m0, s39, 29696
s_add_u32 s37, s37, s38
buffer_load_dwordx4 v23, s[8:11], s37 offen sc1 lds
s_add_u32 m0, s39, 30720
s_add_u32 s37, s37, s38
buffer_load_dwordx4 v23, s[8:11], s37 offen sc1 lds
s_add_u32 m0, s39, 31744
s_add_u32 s37, s37, s38
buffer_load_dwordx4 v23, s[8:11], s37 offen sc1 lds
s_waitcnt vmcnt(32)
s_barrier
s_add_u32 m0, s39, 49152
s_add_u32 s37, s37, s40
buffer_load_dwordx4 v23, s[8:11], s37 offen sc1 lds
s_add_u32 m0, s39, 50176
s_add_u32 s37, s37, s38
buffer_load_dwordx4 v23, s[8:11], s37 offen sc1 lds
s_add_u32 m0, s39, 51200
s_add_u32 s37, s37, s38
buffer_load_dwordx4 v23, s[8:11], s37 offen sc1 lds
s_add_u32 m0, s39, 52224
s_add_u32 s37, s37, s38
buffer_load_dwordx4 v23, s[8:11], s37 offen sc1 lds
s_add_u32 m0, s39, 53248
s_add_u32 s37, s37, s55
buffer_load_dwordx4 v23, s[8:11], s37 offen sc1 lds
s_add_u32 m0, s39, 54272
s_add_u32 s37, s37, s38
buffer_load_dwordx4 v23, s[8:11], s37 offen sc1 lds
s_add_u32 m0, s39, 55296
s_add_u32 s37, s37, s38
buffer_load_dwordx4 v23, s[8:11], s37 offen sc1 lds
s_add_u32 m0, s39, 56320
s_add_u32 s37, s37, s38
buffer_load_dwordx4 v23, s[8:11], s37 offen sc1 lds
s_waitcnt vmcnt(32)
s_barrier
s_add_u32 m0, s39, 73728
s_add_u32 s37, s37, s40
buffer_load_dwordx4 v23, s[8:11], s37 offen sc1 lds
s_add_u32 m0, s39, 74752
s_add_u32 s37, s37, s38
buffer_load_dwordx4 v23, s[8:11], s37 offen sc1 lds
s_add_u32 m0, s39, 75776
s_add_u32 s37, s37, s38
buffer_load_dwordx4 v23, s[8:11], s37 offen sc1 lds
s_add_u32 m0, s39, 76800
s_add_u32 s37, s37, s38
buffer_load_dwordx4 v23, s[8:11], s37 offen sc1 lds
s_add_u32 m0, s39, 77824
s_add_u32 s37, s37, s55
buffer_load_dwordx4 v23, s[8:11], s37 offen sc1 lds
s_add_u32 m0, s39, 78848
s_add_u32 s37, s37, s38
buffer_load_dwordx4 v23, s[8:11], s37 offen sc1 lds
s_add_u32 m0, s39, 79872
s_add_u32 s37, s37, s38
buffer_load_dwordx4 v23, s[8:11], s37 offen sc1 lds
s_add_u32 m0, s39, 80896
s_add_u32 s37, s37, s38
buffer_load_dwordx4 v23, s[8:11], s37 offen sc1 lds
s_waitcnt vmcnt(32)
s_barrier
s_lshl_b32 s43, s35, 8
s_cmp_eq_u32 s51, 1
s_cselect_b32 s8, s4, s6
s_cselect_b32 s9, s5, s7
s_sub_u32 s10, 7340032, s43
s_lshl_b32 s44, s34, 18
s_add_u32 s44, s44, 4194304
s_movk_i32 s38, 28672
s_cmp_eq_u32 s51, 0
s_cselect_b32 s8, s32, s8
s_cselect_b32 s9, s33, s9
s_cselect_b32 s10, 262144, s10
s_cselect_b32 s43, s44, s43
s_cselect_b32 s38, 1024, s38
s_cselect_b32 s45, 0, -1
s_add_u32 s8, s8, s43
s_addc_u32 s9, s9, 0
s_mov_b32 s11, 0x20000
s_lshl_b32 s40, s38, 4
s_add_u32 s42, s35, 15
s_lshl_b32 s39, s51, 14
v_lshrrev_b32 v19, 4, v1
v_lshlrev_b32 v20, 5, v19
v_mul_u32_u24 v19, 6912, v19
v_and_b32 v19, s45, v19
v_and_b32 v20, s45, v20
v_lshlrev_b32 v21, 4, v1
v_xor_b32 v21, v21, v20
v_add_u32 v22, v21, v19
s_and_b32 s45, s45, 128
v_xor_b32 v23, s45, v22
s_waitcnt vmcnt(24)
s_barrier
s_add_u32 s42, s42, 1
s_and_b32 s42, s42, 15
s_add_u32 m0, s39, 98304
s_mul_i32 s37, s42, s40
buffer_load_dwordx4 v22, s[8:11], s37 offen sc1 lds
s_add_u32 m0, s39, 99328
s_add_u32 s37, s37, s38
buffer_load_dwordx4 v23, s[8:11], s37 offen sc1 lds
s_add_u32 m0, s39, 100352
s_add_u32 s37, s37, s38
buffer_load_dwordx4 v22, s[8:11], s37 offen sc1 lds
s_add_u32 m0, s39, 101376
s_add_u32 s37, s37, s38
buffer_load_dwordx4 v23, s[8:11], s37 offen sc1 lds
s_add_u32 m0, s39, 102400
s_add_u32 s37, s37, s38
buffer_load_dwordx4 v22, s[8:11], s37 offen sc1 lds
s_add_u32 m0, s39, 103424
s_add_u32 s37, s37, s38
buffer_load_dwordx4 v23, s[8:11], s37 offen sc1 lds
s_add_u32 m0, s39, 104448
s_add_u32 s37, s37, s38
buffer_load_dwordx4 v22, s[8:11], s37 offen sc1 lds
s_add_u32 m0, s39, 105472
s_add_u32 s37, s37, s38
buffer_load_dwordx4 v23, s[8:11], s37 offen sc1 lds
s_add_u32 m0, s39, 106496
s_add_u32 s37, s37, s38
buffer_load_dwordx4 v22, s[8:11], s37 offen sc1 lds
s_add_u32 m0, s39, 107520
s_add_u32 s37, s37, s38
buffer_load_dwordx4 v23, s[8:11], s37 offen sc1 lds
s_add_u32 m0, s39, 108544
s_add_u32 s37, s37, s38
buffer_load_dwordx4 v22, s[8:11], s37 offen sc1 lds
s_add_u32 m0, s39, 109568
s_add_u32 s37, s37, s38
buffer_load_dwordx4 v23, s[8:11], s37 offen sc1 lds
s_add_u32 m0, s39, 110592
s_add_u32 s37, s37, s38
buffer_load_dwordx4 v22, s[8:11], s37 offen sc1 lds
s_add_u32 m0, s39, 111616
s_add_u32 s37, s37, s38
buffer_load_dwordx4 v23, s[8:11], s37 offen sc1 lds
s_add_u32 m0, s39, 112640
s_add_u32 s37, s37, s38
buffer_load_dwordx4 v22, s[8:11], s37 offen sc1 lds
s_add_u32 m0, s39, 113664
s_add_u32 s37, s37, s38
buffer_load_dwordx4 v23, s[8:11], s37 offen sc1 lds
s_waitcnt vmcnt(32)
s_barrier
s_waitcnt vmcnt(24)
s_barrier
s_add_u32 s42, s42, 1
s_and_b32 s42, s42, 15
s_add_u32 m0, s39, 0
s_mul_i32 s37, s42, s40
buffer_load_dwordx4 v22, s[8:11], s37 offen sc1 lds
s_add_u32 m0, s39, 1024
s_add_u32 s37, s37, s38
buffer_load_dwordx4 v23, s[8:11], s37 offen sc1 lds
s_add_u32 m0, s39, 2048
s_add_u32 s37, s37, s38
buffer_load_dwordx4 v22, s[8:11], s37 offen sc1 lds
s_add_u32 m0, s39, 3072
s_add_u32 s37, s37, s38
buffer_load_dwordx4 v23, s[8:11], s37 offen sc1 lds
s_add_u32 m0, s39, 4096
s_add_u32 s37, s37, s38
buffer_load_dwordx4 v22, s[8:11], s37 offen sc1 lds
s_add_u32 m0, s39, 5120
s_add_u32 s37, s37, s38
buffer_load_dwordx4 v23, s[8:11], s37 offen sc1 lds
s_add_u32 m0, s39, 6144
s_add_u32 s37, s37, s38
buffer_load_dwordx4 v22, s[8:11], s37 offen sc1 lds
s_add_u32 m0, s39, 7168
s_add_u32 s37, s37, s38
buffer_load_dwordx4 v23, s[8:11], s37 offen sc1 lds
s_add_u32 m0, s39, 8192
s_add_u32 s37, s37, s38
buffer_load_dwordx4 v22, s[8:11], s37 offen sc1 lds
s_add_u32 m0, s39, 9216
s_add_u32 s37, s37, s38
buffer_load_dwordx4 v23, s[8:11], s37 offen sc1 lds
s_add_u32 m0, s39, 10240
s_add_u32 s37, s37, s38
buffer_load_dwordx4 v22, s[8:11], s37 offen sc1 lds
s_add_u32 m0, s39, 11264
s_add_u32 s37, s37, s38
buffer_load_dwordx4 v23, s[8:11], s37 offen sc1 lds
s_add_u32 m0, s39, 12288
s_add_u32 s37, s37, s38
buffer_load_dwordx4 v22, s[8:11], s37 offen sc1 lds
s_add_u32 m0, s39, 13312
s_add_u32 s37, s37, s38
buffer_load_dwordx4 v23, s[8:11], s37 offen sc1 lds
s_add_u32 m0, s39, 14336
s_add_u32 s37, s37, s38
buffer_load_dwordx4 v22, s[8:11], s37 offen sc1 lds
s_add_u32 m0, s39, 15360
s_add_u32 s37, s37, s38
buffer_load_dwordx4 v23, s[8:11], s37 offen sc1 lds
s_waitcnt vmcnt(32)
s_barrier
s_barrier
s_waitcnt vmcnt(16)
s_barrier
s_add_u32 s42, s42, 1
s_and_b32 s42, s42, 15
s_add_u32 m0, s39, 49152
s_mul_i32 s37, s42, s40
buffer_load_dwordx4 v22, s[8:11], s37 offen sc1 lds
s_add_u32 m0, s39, 50176
s_add_u32 s37, s37, s38
buffer_load_dwordx4 v23, s[8:11], s37 offen sc1 lds
s_add_u32 m0, s39, 51200
s_add_u32 s37, s37, s38
buffer_load_dwordx4 v22, s[8:11], s37 offen sc1 lds
s_add_u32 m0, s39, 52224
s_add_u32 s37, s37, s38
buffer_load_dwordx4 v23, s[8:11], s37 offen sc1 lds
s_add_u32 m0, s39, 53248
s_add_u32 s37, s37, s38
buffer_load_dwordx4 v22, s[8:11], s37 offen sc1 lds
s_add_u32 m0, s39, 54272
s_add_u32 s37, s37, s38
buffer_load_dwordx4 v23, s[8:11], s37 offen sc1 lds
s_add_u32 m0, s39, 55296
s_add_u32 s37, s37, s38
buffer_load_dwordx4 v22, s[8:11], s37 offen sc1 lds
s_add_u32 m0, s39, 56320
s_add_u32 s37, s37, s38
buffer_load_dwordx4 v23, s[8:11], s37 offen sc1 lds
s_add_u32 m0, s39, 57344
s_add_u32 s37, s37, s38
buffer_load_dwordx4 v22, s[8:11], s37 offen sc1 lds
s_add_u32 m0, s39, 58368
s_add_u32 s37, s37, s38
buffer_load_dwordx4 v23, s[8:11], s37 offen sc1 lds
s_add_u32 m0, s39, 59392
s_add_u32 s37, s37, s38
buffer_load_dwordx4 v22, s[8:11], s37 offen sc1 lds
s_add_u32 m0, s39, 60416
s_add_u32 s37, s37, s38
buffer_load_dwordx4 v23, s[8:11], s37 offen sc1 lds
s_add_u32 m0, s39, 61440
s_add_u32 s37, s37, s38
buffer_load_dwordx4 v22, s[8:11], s37 offen sc1 lds
s_add_u32 m0, s39, 62464
s_add_u32 s37, s37, s38
buffer_load_dwordx4 v23, s[8:11], s37 offen sc1 lds
s_add_u32 m0, s39, 63488
s_add_u32 s37, s37, s38
buffer_load_dwordx4 v22, s[8:11], s37 offen sc1 lds
s_add_u32 m0, s39, 64512
s_add_u32 s37, s37, s38
buffer_load_dwordx4 v23, s[8:11], s37 offen sc1 lds
LP3_33:
s_mul_i32 s43, s2, 28672
s_mul_i32 s44, s51, 7168
s_add_u32 s43, s43, s44
s_add_u32 s80, s60, s43
s_addc_u32 s81, s61, 0
s_lshl_b32 s43, s34, 18
s_add_u32 s12, s32, s43
s_addc_u32 s13, s33, 0
s_add_u32 s12, s12, 4194304
s_addc_u32 s13, s13, 0
s_mov_b32 s14, 262144
s_mov_b32 s15, 0x20000
v_lshlrev_b32 v21, 4, v1
s_lshl_b32 s54, s36, 11
s_add_u32 s43, s35, 1
s_and_b32 s43, s43, 15
s_lshl_b32 s43, s43, 14
s_add_u32 s30, s43, s54
s_add_u32 s43, s35, 2
s_and_b32 s43, s43, 15
s_lshl_b32 s43, s43, 14
s_add_u32 s31, s43, s54
s_barrier
s_add_u32 m0, s54, 0
s_add_u32 s43, s30, 0
buffer_load_dwordx4 v21, s[12:15], s43 offen sc1 lds
s_add_u32 m0, s54, 1024
s_add_u32 s43, s30, 1024
buffer_load_dwordx4 v21, s[12:15], s43 offen sc1 lds
s_add_u32 m0, s54, 49152
s_add_u32 s43, s31, 0
buffer_load_dwordx4 v21, s[12:15], s43 offen sc1 lds
s_add_u32 m0, s54, 50176
s_add_u32 s43, s31, 1024
buffer_load_dwordx4 v21, s[12:15], s43 offen sc1 lds
s_add_u32 s42, s42, 1
s_and_b32 s42, s42, 15
s_add_u32 m0, s39, 98304
s_mul_i32 s37, s42, s40
buffer_load_dwordx4 v22, s[8:11], s37 offen sc1 lds
s_add_u32 m0, s39, 99328
s_add_u32 s37, s37, s38
buffer_load_dwordx4 v23, s[8:11], s37 offen sc1 lds
s_add_u32 m0, s39, 100352
s_add_u32 s37, s37, s38
buffer_load_dwordx4 v22, s[8:11], s37 offen sc1 lds
s_add_u32 m0, s39, 101376
s_add_u32 s37, s37, s38
buffer_load_dwordx4 v23, s[8:11], s37 offen sc1 lds
s_add_u32 m0, s39, 102400
s_add_u32 s37, s37, s38
buffer_load_dwordx4 v22, s[8:11], s37 offen sc1 lds
s_add_u32 m0, s39, 103424
s_add_u32 s37, s37, s38
buffer_load_dwordx4 v23, s[8:11], s37 offen sc1 lds
s_add_u32 m0, s39, 104448
s_add_u32 s37, s37, s38
buffer_load_dwordx4 v22, s[8:11], s37 offen sc1 lds
s_add_u32 m0, s39, 105472
s_add_u32 s37, s37, s38
buffer_load_dwordx4 v23, s[8:11], s37 offen sc1 lds
s_add_u32 m0, s39, 106496
s_add_u32 s37, s37, s38
buffer_load_dwordx4 v22, s[8:11], s37 offen sc1 lds
s_add_u32 m0, s39, 107520
s_add_u32 s37, s37, s38
buffer_load_dwordx4 v23, s[8:11], s37 offen sc1 lds
s_add_u32 m0, s39, 108544
s_add_u32 s37, s37, s38
buffer_load_dwordx4 v22, s[8:11], s37 offen sc1 lds
s_add_u32 m0, s39, 109568
s_add_u32 s37, s37, s38
buffer_load_dwordx4 v23, s[8:11], s37 offen sc1 lds
s_add_u32 m0, s39, 110592
s_add_u32 s37, s37, s38
buffer_load_dwordx4 v22, s[8:11], s37 offen sc1 lds
s_add_u32 m0, s39, 111616
s_add_u32 s37, s37, s38
buffer_load_dwordx4 v23, s[8:11], s37 offen sc1 lds
s_add_u32 m0, s39, 112640
s_add_u32 s37, s37, s38
buffer_load_dwordx4 v22, s[8:11], s37 offen sc1 lds
s_add_u32 m0, s39, 113664
s_add_u32 s37, s37, s38
buffer_load_dwordx4 v23, s[8:11], s37 offen sc1 lds
s_load_dword s64, s[80:81], 0
s_load_dword s65, s[80:81], 64
s_load_dword s66, s[80:81], 128
s_load_dword s67, s[80:81], 192
s_load_dword s68, s[80:81], 256
s_load_dword s69, s[80:81], 320
s_load_dword s70, s[80:81], 384
s_load_dword s71, s[80:81], 448
s_load_dword s72, s[80:81], 512
s_add_u32 s80, s80, 576
s_addc_u32 s81, s81, 0
s_waitcnt vmcnt(18)
s_barrier
s_waitcnt vmcnt(16)
s_barrier
s_mov_b32 s41, 2
Lp3_41:
s_add_u32 s42, s42, 1
s_and_b32 s42, s42, 15
s_add_u32 m0, s39, 0
s_mul_i32 s37, s42, s40
buffer_load_dwordx4 v22, s[8:11], s37 offen sc1 lds
s_add_u32 m0, s39, 1024
s_add_u32 s37, s37, s38
buffer_load_dwordx4 v23, s[8:11], s37 offen sc1 lds
s_add_u32 m0, s39, 2048
s_add_u32 s37, s37, s38
buffer_load_dwordx4 v22, s[8:11], s37 offen sc1 lds
s_add_u32 m0, s39, 3072
s_add_u32 s37, s37, s38
buffer_load_dwordx4 v23, s[8:11], s37 offen sc1 lds
s_add_u32 m0, s39, 4096
s_add_u32 s37, s37, s38
buffer_load_dwordx4 v22, s[8:11], s37 offen sc1 lds
s_add_u32 m0, s39, 5120
s_add_u32 s37, s37, s38
buffer_load_dwordx4 v23, s[8:11], s37 offen sc1 lds
s_add_u32 m0, s39, 6144
s_add_u32 s37, s37, s38
buffer_load_dwordx4 v22, s[8:11], s37 offen sc1 lds
s_add_u32 m0, s39, 7168
s_add_u32 s37, s37, s38
buffer_load_dwordx4 v23, s[8:11], s37 offen sc1 lds
s_add_u32 m0, s39, 8192
s_add_u32 s37, s37, s38
buffer_load_dwordx4 v22, s[8:11], s37 offen sc1 lds
s_add_u32 m0, s39, 9216
s_add_u32 s37, s37, s38
buffer_load_dwordx4 v23, s[8:11], s37 offen sc1 lds
s_add_u32 m0, s39, 10240
s_add_u32 s37, s37, s38
buffer_load_dwordx4 v22, s[8:11], s37 offen sc1 lds
s_add_u32 m0, s39, 11264
s_add_u32 s37, s37, s38
buffer_load_dwordx4 v23, s[8:11], s37 offen sc1 lds
s_add_u32 m0, s39, 12288
s_add_u32 s37, s37, s38
buffer_load_dwordx4 v22, s[8:11], s37 offen sc1 lds
s_add_u32 m0, s39, 13312
s_add_u32 s37, s37, s38
buffer_load_dwordx4 v23, s[8:11], s37 offen sc1 lds
s_add_u32 m0, s39, 14336
s_add_u32 s37, s37, s38
buffer_load_dwordx4 v22, s[8:11], s37 offen sc1 lds
s_add_u32 m0, s39, 15360
s_add_u32 s37, s37, s38
buffer_load_dwordx4 v23, s[8:11], s37 offen sc1 lds
s_load_dword s64, s[80:81], 0
s_load_dword s65, s[80:81], 64
s_load_dword s66, s[80:81], 128
s_load_dword s67, s[80:81], 192
s_load_dword s68, s[80:81], 256
s_load_dword s69, s[80:81], 320
s_load_dword s70, s[80:81], 384
s_load_dword s71, s[80:81], 448
s_load_dword s72, s[80:81], 512
s_add_u32 s80, s80, 576
s_addc_u32 s81, s81, 0
s_waitcnt vmcnt(16)
s_barrier
s_add_u32 s42, s42, 1
s_and_b32 s42, s42, 15
s_add_u32 m0, s39, 49152
s_mul_i32 s37, s42, s40
buffer_load_dwordx4 v22, s[8:11], s37 offen sc1 lds
s_add_u32 m0, s39, 50176
s_add_u32 s37, s37, s38
buffer_load_dwordx4 v23, s[8:11], s37 offen sc1 lds
s_add_u32 m0, s39, 51200
s_add_u32 s37, s37, s38
buffer_load_dwordx4 v22, s[8:11], s37 offen sc1 lds
s_add_u32 m0, s39, 52224
s_add_u32 s37, s37, s38
buffer_load_dwordx4 v23, s[8:11], s37 offen sc1 lds
s_add_u32 m0, s39, 53248
s_add_u32 s37, s37, s38
buffer_load_dwordx4 v22, s[8:11], s37 offen sc1 lds
s_add_u32 m0, s39, 54272
s_add_u32 s37, s37, s38
buffer_load_dwordx4 v23, s[8:11], s37 offen sc1 lds
s_add_u32 m0, s39, 55296
s_add_u32 s37, s37, s38
buffer_load_dwordx4 v22, s[8:11], s37 offen sc1 lds
s_add_u32 m0, s39, 56320
s_add_u32 s37, s37, s38
buffer_load_dwordx4 v23, s[8:11], s37 offen sc1 lds
s_add_u32 m0, s39, 57344
s_add_u32 s37, s37, s38
buffer_load_dwordx4 v22, s[8:11], s37 offen sc1 lds
s_add_u32 m0, s39, 58368
s_add_u32 s37, s37, s38
buffer_load_dwordx4 v23, s[8:11], s37 offen sc1 lds
s_add_u32 m0, s39, 59392
s_add_u32 s37, s37, s38
buffer_load_dwordx4 v22, s[8:11], s37 offen sc1 lds
s_add_u32 m0, s39, 60416
s_add_u32 s37, s37, s38
buffer_load_dwordx4 v23, s[8:11], s37 offen sc1 lds
s_add_u32 m0, s39, 61440
s_add_u32 s37, s37, s38
buffer_load_dwordx4 v22, s[8:11], s37 offen sc1 lds
s_add_u32 m0, s39, 62464
s_add_u32 s37, s37, s38
buffer_load_dwordx4 v23, s[8:11], s37 offen sc1 lds
s_add_u32 m0, s39, 63488
s_add_u32 s37, s37, s38
buffer_load_dwordx4 v22, s[8:11], s37 offen sc1 lds
s_add_u32 m0, s39, 64512
s_add_u32 s37, s37, s38
buffer_load_dwordx4 v23, s[8:11], s37 offen sc1 lds
s_load_dword s64, s[80:81], 0
s_load_dword s65, s[80:81], 64
s_load_dword s66, s[80:81], 128
s_load_dword s67, s[80:81], 192
s_load_dword s68, s[80:81], 256
s_load_dword s69, s[80:81], 320
s_load_dword s70, s[80:81], 384
s_load_dword s71, s[80:81], 448
s_load_dword s72, s[80:81], 512
s_add_u32 s80, s80, 576
s_addc_u32 s81, s81, 0
s_waitcnt vmcnt(16)
s_barrier
s_add_u32 s42, s42, 1
s_and_b32 s42, s42, 15
s_add_u32 m0, s39, 98304
s_mul_i32 s37, s42, s40
buffer_load_dwordx4 v22, s[8:11], s37 offen sc1 lds
s_add_u32 m0, s39, 99328
s_add_u32 s37, s37, s38
buffer_load_dwordx4 v23, s[8:11], s37 offen sc1 lds
s_add_u32 m0, s39, 100352
s_add_u32 s37, s37, s38
buffer_load_dwordx4 v22, s[8:11], s37 offen sc1 lds
s_add_u32 m0, s39, 101376
s_add_u32 s37, s37, s38
buffer_load_dwordx4 v23, s[8:11], s37 offen sc1 lds
s_add_u32 m0, s39, 102400
s_add_u32 s37, s37, s38
buffer_load_dwordx4 v22, s[8:11], s37 offen sc1 lds
s_add_u32 m0, s39, 103424
s_add_u32 s37, s37, s38
buffer_load_dwordx4 v23, s[8:11], s37 offen sc1 lds
s_add_u32 m0, s39, 104448
s_add_u32 s37, s37, s38
buffer_load_dwordx4 v22, s[8:11], s37 offen sc1 lds
s_add_u32 m0, s39, 105472
s_add_u32 s37, s37, s38
buffer_load_dwordx4 v23, s[8:11], s37 offen sc1 lds
s_add_u32 m0, s39, 106496
s_add_u32 s37, s37, s38
buffer_load_dwordx4 v22, s[8:11], s37 offen sc1 lds
s_add_u32 m0, s39, 107520
s_add_u32 s37, s37, s38
buffer_load_dwordx4 v23, s[8:11], s37 offen sc1 lds
s_add_u32 m0, s39, 108544
s_add_u32 s37, s37, s38
buffer_load_dwordx4 v22, s[8:11], s37 offen sc1 lds
s_add_u32 m0, s39, 109568
s_add_u32 s37, s37, s38
buffer_load_dwordx4 v23, s[8:11], s37 offen sc1 lds
s_add_u32 m0, s39, 110592
s_add_u32 s37, s37, s38
buffer_load_dwordx4 v22, s[8:11], s37 offen sc1 lds
s_add_u32 m0, s39, 111616
s_add_u32 s37, s37, s38
buffer_load_dwordx4 v23, s[8:11], s37 offen sc1 lds
s_add_u32 m0, s39, 112640
s_add_u32 s37, s37, s38
buffer_load_dwordx4 v22, s[8:11], s37 offen sc1 lds
s_add_u32 m0, s39, 113664
s_add_u32 s37, s37, s38
buffer_load_dwordx4 v23, s[8:11], s37 offen sc1 lds
s_load_dword s64, s[80:81], 0
s_load_dword s65, s[80:81], 64
s_load_dword s66, s[80:81], 128
s_load_dword s67, s[80:81], 192
s_load_dword s68, s[80:81], 256
s_load_dword s69, s[80:81], 320
s_load_dword s70, s[80:81], 384
s_load_dword s71, s[80:81], 448
s_load_dword s72, s[80:81], 512
s_add_u32 s80, s80, 576
s_addc_u32 s81, s81, 0
s_waitcnt vmcnt(16)
s_barrier
s_sub_u32 s41, s41, 1
s_cmp_lg_u32 s41, 0
s_cbranch_scc1 Lp3_41
s_add_u32 s42, s42, 1
s_and_b32 s42, s42, 15
s_add_u32 m0, s39, 0
s_mul_i32 s37, s42, s40
buffer_load_dwordx4 v22, s[8:11], s37 offen sc1 lds
s_add_u32 m0, s39, 1024
s_add_u32 s37, s37, s38
buffer_load_dwordx4 v23, s[8:11], s37 offen sc1 lds
s_add_u32 m0, s39, 2048
s_add_u32 s37, s37, s38
buffer_load_dwordx4 v22, s[8:11], s37 offen sc1 lds
s_add_u32 m0, s39, 3072
s_add_u32 s37, s37, s38
buffer_load_dwordx4 v23, s[8:11], s37 offen sc1 lds
s_add_u32 m0, s39, 4096
s_add_u32 s37, s37, s38
buffer_load_dwordx4 v22, s[8:11], s37 offen sc1 lds
s_add_u32 m0, s39, 5120
s_add_u32 s37, s37, s38
buffer_load_dwordx4 v23, s[8:11], s37 offen sc1 lds
s_add_u32 m0, s39, 6144
s_add_u32 s37, s37, s38
buffer_load_dwordx4 v22, s[8:11], s37 offen sc1 lds
s_add_u32 m0, s39, 7168
s_add_u32 s37, s37, s38
buffer_load_dwordx4 v23, s[8:11], s37 offen sc1 lds
s_add_u32 m0, s39, 8192
s_add_u32 s37, s37, s38
buffer_load_dwordx4 v22, s[8:11], s37 offen sc1 lds
s_add_u32 m0, s39, 9216
s_add_u32 s37, s37, s38
buffer_load_dwordx4 v23, s[8:11], s37 offen sc1 lds
s_add_u32 m0, s39, 10240
s_add_u32 s37, s37, s38
buffer_load_dwordx4 v22, s[8:11], s37 offen sc1 lds
s_add_u32 m0, s39, 11264
s_add_u32 s37, s37, s38
buffer_load_dwordx4 v23, s[8:11], s37 offen sc1 lds
s_add_u32 m0, s39, 12288
s_add_u32 s37, s37, s38
buffer_load_dwordx4 v22, s[8:11], s37 offen sc1 lds
s_add_u32 m0, s39, 13312
s_add_u32 s37, s37, s38
buffer_load_dwordx4 v23, s[8:11], s37 offen sc1 lds
s_add_u32 m0, s39, 14336
s_add_u32 s37, s37, s38
buffer_load_dwordx4 v22, s[8:11], s37 offen sc1 lds
s_add_u32 m0, s39, 15360
s_add_u32 s37, s37, s38
buffer_load_dwordx4 v23, s[8:11], s37 offen sc1 lds
s_load_dword s64, s[80:81], 0
s_load_dword s65, s[80:81], 64
s_load_dword s66, s[80:81], 128
s_load_dword s67, s[80:81], 192
s_load_dword s68, s[80:81], 256
s_load_dword s69, s[80:81], 320
s_load_dword s70, s[80:81], 384
s_load_dword s71, s[80:81], 448
s_load_dword s72, s[80:81], 512
s_add_u32 s80, s80, 576
s_addc_u32 s81, s81, 0
s_waitcnt vmcnt(16)
s_barrier
s_add_u32 s42, s42, 1
s_and_b32 s42, s42, 15
s_add_u32 m0, s39, 49152
s_mul_i32 s37, s42, s40
buffer_load_dwordx4 v22, s[8:11], s37 offen sc1 lds
s_add_u32 m0, s39, 50176
s_add_u32 s37, s37, s38
buffer_load_dwordx4 v23, s[8:11], s37 offen sc1 lds
s_add_u32 m0, s39, 51200
s_add_u32 s37, s37, s38
buffer_load_dwordx4 v22, s[8:11], s37 offen sc1 lds
s_add_u32 m0, s39, 52224
s_add_u32 s37, s37, s38
buffer_load_dwordx4 v23, s[8:11], s37 offen sc1 lds
s_add_u32 m0, s39, 53248
s_add_u32 s37, s37, s38
buffer_load_dwordx4 v22, s[8:11], s37 offen sc1 lds
s_add_u32 m0, s39, 54272
s_add_u32 s37, s37, s38
buffer_load_dwordx4 v23, s[8:11], s37 offen sc1 lds
s_add_u32 m0, s39, 55296
s_add_u32 s37, s37, s38
buffer_load_dwordx4 v22, s[8:11], s37 offen sc1 lds
s_add_u32 m0, s39, 56320
s_add_u32 s37, s37, s38
buffer_load_dwordx4 v23, s[8:11], s37 offen sc1 lds
s_add_u32 m0, s39, 57344
s_add_u32 s37, s37, s38
buffer_load_dwordx4 v22, s[8:11], s37 offen sc1 lds
s_add_u32 m0, s39, 58368
s_add_u32 s37, s37, s38
buffer_load_dwordx4 v23, s[8:11], s37 offen sc1 lds
s_add_u32 m0, s39, 59392
s_add_u32 s37, s37, s38
buffer_load_dwordx4 v22, s[8:11], s37 offen sc1 lds
s_add_u32 m0, s39, 60416
s_add_u32 s37, s37, s38
buffer_load_dwordx4 v23, s[8:11], s37 offen sc1 lds
s_add_u32 m0, s39, 61440
s_add_u32 s37, s37, s38
buffer_load_dwordx4 v22, s[8:11], s37 offen sc1 lds
s_add_u32 m0, s39, 62464
s_add_u32 s37, s37, s38
buffer_load_dwordx4 v23, s[8:11], s37 offen sc1 lds
s_add_u32 m0, s39, 63488
s_add_u32 s37, s37, s38
buffer_load_dwordx4 v22, s[8:11], s37 offen sc1 lds
s_add_u32 m0, s39, 64512
s_add_u32 s37, s37, s38
buffer_load_dwordx4 v23, s[8:11], s37 offen sc1 lds
s_load_dword s64, s[80:81], 0
s_load_dword s65, s[80:81], 64
s_load_dword s66, s[80:81], 128
s_load_dword s67, s[80:81], 192
s_load_dword s68, s[80:81], 256
s_load_dword s69, s[80:81], 320
s_load_dword s70, s[80:81], 384
s_load_dword s71, s[80:81], 448
s_load_dword s72, s[80:81], 512
s_add_u32 s80, s80, 576
s_addc_u32 s81, s81, 0
s_waitcnt vmcnt(16)
s_barrier
s_add_u32 s42, s42, 1
s_and_b32 s42, s42, 15
s_add_u32 m0, s39, 98304
s_mul_i32 s37, s42, s40
buffer_load_dwordx4 v22, s[8:11], s37 offen sc1 lds
s_and_b32 s53, s35, 1
s_lshl_b32 s53, s53, 1
s_mul_i32 s43, s47, 3
s_add_u32 m0, s39, 99328
s_add_u32 s37, s37, s38
buffer_load_dwordx4 v23, s[8:11], s37 offen sc1 lds
s_add_u32 s53, s53, s43
v_lshlrev_b32 v19, 11, v18
v_lshl_add_u32 v19, v17, 4, v19
s_add_u32 m0, s39, 100352
s_add_u32 s37, s37, s38
buffer_load_dwordx4 v22, s[8:11], s37 offen sc1 lds
s_lshl_b32 s43, s46, 10
v_add_u32 v2, s43, v19
v_add_u32 v3, 49152, v2
s_add_u32 m0, s39, 101376
s_add_u32 s37, s37, s38
buffer_load_dwordx4 v23, s[8:11], s37 offen sc1 lds
v_add_u32 v4, 98304, v2
v_lshrrev_b32 v19, 2, v17
v_lshl_add_u32 v20, v18, 2, v19
s_add_u32 m0, s39, 102400
s_add_u32 s37, s37, s38
buffer_load_dwordx4 v22, s[8:11], s37 offen sc1 lds
v_and_b32 v21, 7, v20
v_lshlrev_b32 v20, 8, v20
v_and_b32 v19, 3, v1
s_add_u32 m0, s39, 103424
s_add_u32 s37, s37, s38
buffer_load_dwordx4 v23, s[8:11], s37 offen sc1 lds
v_lshl_add_u32 v20, v19, 3, v20
s_add_u32 s43, s53, 0
v_xor_b32 v19, s43, v21
s_add_u32 m0, s39, 104448
s_add_u32 s37, s37, s38
buffer_load_dwordx4 v22, s[8:11], s37 offen sc1 lds
v_lshl_add_u32 v5, v19, 5, v20
s_add_u32 s43, s53, 1
v_xor_b32 v19, s43, v21
s_add_u32 m0, s39, 105472
s_add_u32 s37, s37, s38
buffer_load_dwordx4 v23, s[8:11], s37 offen sc1 lds
v_lshl_add_u32 v6, v19, 5, v20
s_add_u32 s43, s53, 2
v_xor_b32 v19, s43, v21
s_add_u32 m0, s39, 106496
s_add_u32 s37, s37, s38
buffer_load_dwordx4 v22, s[8:11], s37 offen sc1 lds
v_lshl_add_u32 v7, v19, 5, v20
v_add_u32 v9, 49152, v5
v_add_u32 v10, 49152, v6
s_add_u32 m0, s39, 107520
s_add_u32 s37, s37, s38
buffer_load_dwordx4 v23, s[8:11], s37 offen sc1 lds
v_add_u32 v11, 49152, v7
v_add_u32 v13, 98304, v5
v_add_u32 v14, 98304, v6
s_add_u32 m0, s39, 108544
s_add_u32 s37, s37, s38
buffer_load_dwordx4 v22, s[8:11], s37 offen sc1 lds
v_add_u32 v15, 98304, v7
s_lshl_b32 s43, s46, 9
s_add_u32 s43, s43, 147456
s_add_u32 m0, s39, 109568
s_add_u32 s37, s37, s38
buffer_load_dwordx4 v23, s[8:11], s37 offen sc1 lds
v_lshl_add_u32 v19, v17, 3, s43
ds_read_b64 v[80:81], v19 offset:0
ds_read_b64 v[82:83], v19 offset:128
s_add_u32 m0, s39, 110592
s_add_u32 s37, s37, s38
buffer_load_dwordx4 v22, s[8:11], s37 offen sc1 lds
ds_read_b64 v[84:85], v19 offset:256
ds_read_b64 v[86:87], v19 offset:384
s_mul_i32 s43, s47, 192
s_add_u32 m0, s39, 111616
s_add_u32 s37, s37, s38
buffer_load_dwordx4 v23, s[8:11], s37 offen sc1 lds
s_add_u32 s43, s43, 148992
v_lshl_add_u32 v19, v18, 4, s43
ds_read_b128 v[48:51], v19 offset:0
s_add_u32 m0, s39, 112640
s_add_u32 s37, s37, s38
buffer_load_dwordx4 v22, s[8:11], s37 offen sc1 lds
ds_read_b128 v[52:55], v19 offset:64
ds_read_b128 v[56:59], v19 offset:128
ds_read_b128 v[60:63], v19 offset:896
s_add_u32 m0, s39, 113664
s_add_u32 s37, s37, s38
buffer_load_dwordx4 v23, s[8:11], s37 offen sc1 lds
ds_read_b128 v[64:67], v19 offset:960
ds_read_b128 v[68:71], v19 offset:1024
s_waitcnt vmcnt(16)
s_barrier
s_add_u32 s42, s42, 1
s_and_b32 s42, s42, 15
s_add_u32 m0, s39, 0
s_mul_i32 s37, s42, s40
buffer_load_dwordx4 v22, s[8:11], s37 offen sc1 lds
s_waitcnt lgkmcnt(0)
v_mul_f32 v88, v81, v81
s_add_u32 m0, s39, 1024
s_add_u32 s37, s37, s38
buffer_load_dwordx4 v23, s[8:11], s37 offen sc1 lds
v_mul_f32 v228, 0xc0135761, v81
s_add_u32 m0, s39, 2048
s_add_u32 s37, s37, s38
buffer_load_dwordx4 v22, s[8:11], s37 offen sc1 lds
v_mul_f32 v89, 0xbdd2d3e8, v81
s_add_u32 m0, s39, 3072
s_add_u32 s37, s37, s38
buffer_load_dwordx4 v23, s[8:11], s37 offen sc1 lds
v_rcp_f32 v236, v88
v_mul_f32 v232, v89, v88
s_add_u32 m0, s39, 4096
s_add_u32 s37, s37, s38
buffer_load_dwordx4 v22, s[8:11], s37 offen sc1 lds
v_mul_f32 v88, v83, v83
s_add_u32 m0, s39, 5120
s_add_u32 s37, s37, s38
buffer_load_dwordx4 v23, s[8:11], s37 offen sc1 lds
v_mul_f32 v229, 0xc0135761, v83
s_add_u32 m0, s39, 6144
s_add_u32 s37, s37, s38
buffer_load_dwordx4 v22, s[8:11], s37 offen sc1 lds
v_mul_f32 v89, 0xbdd2d3e8, v83
v_rcp_f32 v237, v88
s_add_u32 m0, s39, 7168
s_add_u32 s37, s37, s38
buffer_load_dwordx4 v23, s[8:11], s37 offen sc1 lds
v_mul_f32 v233, v89, v88
s_add_u32 m0, s39, 8192
s_add_u32 s37, s37, s38
buffer_load_dwordx4 v22, s[8:11], s37 offen sc1 lds
v_mul_f32 v88, v85, v85
s_add_u32 m0, s39, 9216
s_add_u32 s37, s37, s38
buffer_load_dwordx4 v23, s[8:11], s37 offen sc1 lds
v_mul_f32 v230, 0xc0135761, v85
v_mul_f32 v89, 0xbdd2d3e8, v85
s_add_u32 m0, s39, 10240
s_add_u32 s37, s37, s38
buffer_load_dwordx4 v22, s[8:11], s37 offen sc1 lds
v_rcp_f32 v238, v88
s_add_u32 m0, s39, 11264
s_add_u32 s37, s37, s38
buffer_load_dwordx4 v23, s[8:11], s37 offen sc1 lds
v_mul_f32 v234, v89, v88
s_add_u32 m0, s39, 12288
s_add_u32 s37, s37, s38
buffer_load_dwordx4 v22, s[8:11], s37 offen sc1 lds
v_mul_f32 v88, v87, v87
v_mul_f32 v231, 0xc0135761, v87
s_add_u32 m0, s39, 13312
s_add_u32 s37, s37, s38
buffer_load_dwordx4 v23, s[8:11], s37 offen sc1 lds
v_mul_f32 v89, 0xbdd2d3e8, v87
s_add_u32 m0, s39, 14336
s_add_u32 s37, s37, s38
buffer_load_dwordx4 v22, s[8:11], s37 offen sc1 lds
v_rcp_f32 v239, v88
s_add_u32 m0, s39, 15360
s_add_u32 s37, s37, s38
buffer_load_dwordx4 v23, s[8:11], s37 offen sc1 lds
v_mul_f32 v235, v89, v88
s_mul_i32 s43, s34, 917504
s_mul_i32 s44, s35, 24576
s_add_u32 s43, s43, s44
s_add_u32 s43, s43, 8912896
s_add_u32 s24, s32, s43
s_addc_u32 s25, s33, 0
s_mov_b32 s26, 24576
s_mov_b32 s27, 0x20000
s_mov_b32 s53, 262144
s_lshl_b32 s43, s47, 13
s_lshl_b32 s44, s46, 10
s_add_u32 s43, s43, s44
v_lshlrev_b32 v19, 11, v18
v_lshl_add_u32 v19, v17, 4, v19
v_add_u32 v27, s43, v19
s_lshl_b32 s43, s47, 12
s_add_u32 s43, s43, s44
s_add_u32 s43, s43, 16384
v_and_b32 v19, 1, v18
v_lshlrev_b32 v19, 11, v19
v_lshrrev_b32 v20, 1, v18
v_lshl_add_u32 v19, v20, 8, v19
v_lshl_add_u32 v19, v17, 4, v19
v_add_u32 v28, s43, v19
s_load_dword s64, s[80:81], 0
s_load_dword s65, s[80:81], 64
s_load_dword s66, s[80:81], 128
s_load_dword s67, s[80:81], 192
s_load_dword s68, s[80:81], 256
s_load_dword s69, s[80:81], 320
s_load_dword s70, s[80:81], 384
s_load_dword s71, s[80:81], 448
s_add_u32 s80, s80, 512
s_addc_u32 s81, s81, 0
s_waitcnt vmcnt(16)
s_barrier
s_add_u32 s42, s42, 1
s_and_b32 s42, s42, 15
s_add_u32 m0, s39, 49152
s_mul_i32 s37, s42, s40
buffer_load_dwordx4 v22, s[8:11], s37 offen sc1 lds
v_mul_f32 v128, -v80, v48
v_mul_f32 v129, -v80, v49
s_add_u32 m0, s39, 50176
s_add_u32 s37, s37, s38
buffer_load_dwordx4 v23, s[8:11], s37 offen sc1 lds
v_mul_f32 v130, -v80, v50
v_mul_f32 v131, -v80, v51
s_add_u32 m0, s39, 51200
s_add_u32 s37, s37, s38
buffer_load_dwordx4 v22, s[8:11], s37 offen sc1 lds
v_mul_f32 v132, -v82, v48
v_mul_f32 v133, -v82, v49
s_add_u32 m0, s39, 52224
s_add_u32 s37, s37, s38
buffer_load_dwordx4 v23, s[8:11], s37 offen sc1 lds
v_mul_f32 v134, -v82, v50
v_mul_f32 v135, -v82, v51
s_add_u32 m0, s39, 53248
s_add_u32 s37, s37, s38
buffer_load_dwordx4 v22, s[8:11], s37 offen sc1 lds
v_mul_f32 v136, -v84, v48
v_mul_f32 v137, -v84, v49
s_add_u32 m0, s39, 54272
s_add_u32 s37, s37, s38
buffer_load_dwordx4 v23, s[8:11], s37 offen sc1 lds
v_mul_f32 v138, -v84, v50
v_mul_f32 v139, -v84, v51
s_add_u32 m0, s39, 55296
s_add_u32 s37, s37, s38
buffer_load_dwordx4 v22, s[8:11], s37 offen sc1 lds
v_mul_f32 v140, -v86, v48
v_mul_f32 v141, -v86, v49
s_add_u32 m0, s39, 56320
s_add_u32 s37, s37, s38
buffer_load_dwordx4 v23, s[8:11], s37 offen sc1 lds
v_mul_f32 v142, -v86, v50
v_mul_f32 v143, -v86, v51
s_add_u32 m0, s39, 57344
s_add_u32 s37, s37, s38
buffer_load_dwordx4 v22, s[8:11], s37 offen sc1 lds
v_mul_f32 v144, -v80, v52
v_mul_f32 v145, -v80, v53
s_add_u32 m0, s39, 58368
s_add_u32 s37, s37, s38
buffer_load_dwordx4 v23, s[8:11], s37 offen sc1 lds
v_mul_f32 v146, -v80, v54
v_mul_f32 v147, -v80, v55
s_add_u32 m0, s39, 59392
s_add_u32 s37, s37, s38
buffer_load_dwordx4 v22, s[8:11], s37 offen sc1 lds
v_mul_f32 v148, -v82, v52
v_mul_f32 v149, -v82, v53
s_add_u32 m0, s39, 60416
s_add_u32 s37, s37, s38
buffer_load_dwordx4 v23, s[8:11], s37 offen sc1 lds
v_mul_f32 v150, -v82, v54
v_mul_f32 v151, -v82, v55
s_add_u32 m0, s39, 61440
s_add_u32 s37, s37, s38
buffer_load_dwordx4 v22, s[8:11], s37 offen sc1 lds
v_mul_f32 v152, -v84, v52
v_mul_f32 v153, -v84, v53
s_add_u32 m0, s39, 62464
s_add_u32 s37, s37, s38
buffer_load_dwordx4 v23, s[8:11], s37 offen sc1 lds
v_mul_f32 v154, -v84, v54
v_mul_f32 v155, -v84, v55
s_add_u32 m0, s39, 63488
s_add_u32 s37, s37, s38
buffer_load_dwordx4 v22, s[8:11], s37 offen sc1 lds
v_mul_f32 v156, -v86, v52
v_mul_f32 v157, -v86, v53
s_add_u32 m0, s39, 64512
s_add_u32 s37, s37, s38
buffer_load_dwordx4 v23, s[8:11], s37 offen sc1 lds
v_mul_f32 v158, -v86, v54
v_mul_f32 v159, -v86, v55
s_load_dword s64, s[80:81], 0
s_load_dword s65, s[80:81], 64
s_load_dword s66, s[80:81], 128
s_load_dword s67, s[80:81], 192
s_load_dword s68, s[80:81], 256
s_load_dword s69, s[80:81], 320
s_load_dword s70, s[80:81], 384
s_load_dword s71, s[80:81], 448
s_add_u32 s80, s80, 512
s_addc_u32 s81, s81, 0
s_waitcnt vmcnt(16)
s_barrier
s_add_u32 s42, s42, 1
s_and_b32 s42, s42, 15
s_add_u32 m0, s39, 98304
s_mul_i32 s37, s42, s40
buffer_load_dwordx4 v22, s[8:11], s37 offen sc1 lds
v_mul_f32 v160, -v80, v56
v_mul_f32 v161, -v80, v57
s_add_u32 m0, s39, 99328
s_add_u32 s37, s37, s38
buffer_load_dwordx4 v23, s[8:11], s37 offen sc1 lds
v_mul_f32 v162, -v80, v58
v_mul_f32 v163, -v80, v59
s_add_u32 m0, s39, 100352
s_add_u32 s37, s37, s38
buffer_load_dwordx4 v22, s[8:11], s37 offen sc1 lds
v_mul_f32 v164, -v82, v56
v_mul_f32 v165, -v82, v57
s_add_u32 m0, s39, 101376
s_add_u32 s37, s37, s38
buffer_load_dwordx4 v23, s[8:11], s37 offen sc1 lds
v_mul_f32 v166, -v82, v58
v_mul_f32 v167, -v82, v59
s_add_u32 m0, s39, 102400
s_add_u32 s37, s37, s38
buffer_load_dwordx4 v22, s[8:11], s37 offen sc1 lds
v_mul_f32 v168, -v84, v56
v_mul_f32 v169, -v84, v57
s_add_u32 m0, s39, 103424
s_add_u32 s37, s37, s38
buffer_load_dwordx4 v23, s[8:11], s37 offen sc1 lds
v_mul_f32 v170, -v84, v58
v_mul_f32 v171, -v84, v59
s_add_u32 m0, s39, 104448
s_add_u32 s37, s37, s38
buffer_load_dwordx4 v22, s[8:11], s37 offen sc1 lds
v_mul_f32 v172, -v86, v56
v_mul_f32 v173, -v86, v57
s_add_u32 m0, s39, 105472
s_add_u32 s37, s37, s38
buffer_load_dwordx4 v23, s[8:11], s37 offen sc1 lds
v_mul_f32 v174, -v86, v58
v_mul_f32 v175, -v86, v59
s_add_u32 m0, s39, 106496
s_add_u32 s37, s37, s38
buffer_load_dwordx4 v22, s[8:11], s37 offen sc1 lds
v_mul_f32 v176, -v80, v60
v_mul_f32 v177, -v80, v61
s_add_u32 m0, s39, 107520
s_add_u32 s37, s37, s38
buffer_load_dwordx4 v23, s[8:11], s37 offen sc1 lds
v_mul_f32 v178, -v80, v62
v_mul_f32 v179, -v80, v63
s_add_u32 m0, s39, 108544
s_add_u32 s37, s37, s38
buffer_load_dwordx4 v22, s[8:11], s37 offen sc1 lds
v_mul_f32 v180, -v82, v60
v_mul_f32 v181, -v82, v61
s_add_u32 m0, s39, 109568
s_add_u32 s37, s37, s38
buffer_load_dwordx4 v23, s[8:11], s37 offen sc1 lds
v_mul_f32 v182, -v82, v62
v_mul_f32 v183, -v82, v63
s_add_u32 m0, s39, 110592
s_add_u32 s37, s37, s38
buffer_load_dwordx4 v22, s[8:11], s37 offen sc1 lds
v_mul_f32 v184, -v84, v60
v_mul_f32 v185, -v84, v61
s_add_u32 m0, s39, 111616
s_add_u32 s37, s37, s38
buffer_load_dwordx4 v23, s[8:11], s37 offen sc1 lds
v_mul_f32 v186, -v84, v62
v_mul_f32 v187, -v84, v63
s_add_u32 m0, s39, 112640
s_add_u32 s37, s37, s38
buffer_load_dwordx4 v22, s[8:11], s37 offen sc1 lds
v_mul_f32 v188, -v86, v60
v_mul_f32 v189, -v86, v61
s_add_u32 m0, s39, 113664
s_add_u32 s37, s37, s38
buffer_load_dwordx4 v23, s[8:11], s37 offen sc1 lds
v_mul_f32 v190, -v86, v62
v_mul_f32 v191, -v86, v63
s_load_dword s64, s[80:81], 0
s_load_dword s65, s[80:81], 64
s_load_dword s66, s[80:81], 128
s_load_dword s67, s[80:81], 192
s_load_dword s68, s[80:81], 256
s_load_dword s69, s[80:81], 320
s_load_dword s70, s[80:81], 384
s_load_dword s71, s[80:81], 448
s_add_u32 s80, s80, 512
s_addc_u32 s81, s81, 0
s_waitcnt vmcnt(16)
s_barrier
s_mul_i32 s43, s35, 192
s_and_b32 s43, s43, 0xffffff80
s_add_u32 s43, s43, 4096
s_cmp_eq_u32 s51, 1
s_cselect_b32 s8, s4, s6
s_cselect_b32 s9, s5, s7
s_sub_u32 s10, 7340032, s43
s_lshl_b32 s44, s34, 18
s_add_u32 s44, s44, 4194304
s_movk_i32 s38, 28672
s_cmp_eq_u32 s51, 0
s_cselect_b32 s8, s32, s8
s_cselect_b32 s9, s33, s9
s_cselect_b32 s10, 262144, s10
s_cselect_b32 s43, s44, s43
s_cselect_b32 s38, 1024, s38
s_cselect_b32 s45, 0, -1
s_add_u32 s8, s8, s43
s_addc_u32 s9, s9, 0
s_mov_b32 s11, 0x20000
s_lshl_b32 s40, s38, 4
s_add_u32 s42, s35, 15
s_lshl_b32 s39, s51, 14
v_lshrrev_b32 v19, 4, v1
v_lshlrev_b32 v20, 5, v19
v_mul_u32_u24 v19, 6912, v19
v_and_b32 v19, s45, v19
v_and_b32 v20, s45, v20
v_lshlrev_b32 v21, 4, v1
v_xor_b32 v21, v21, v20
v_add_u32 v22, v21, v19
s_and_b32 s45, s45, 128
v_xor_b32 v23, s45, v22
s_add_u32 s42, s42, 1
s_and_b32 s42, s42, 15
s_add_u32 m0, s39, 0
s_mul_i32 s37, s42, s40
buffer_load_dwordx4 v22, s[8:11], s37 offen sc1 lds
v_mul_f32 v192, -v80, v64
v_mul_f32 v193, -v80, v65
s_add_u32 m0, s39, 1024
s_add_u32 s37, s37, s38
buffer_load_dwordx4 v23, s[8:11], s37 offen sc1 lds
v_mul_f32 v194, -v80, v66
v_mul_f32 v195, -v80, v67
s_add_u32 m0, s39, 2048
s_add_u32 s37, s37, s38
buffer_load_dwordx4 v22, s[8:11], s37 offen sc1 lds
v_mul_f32 v196, -v82, v64
v_mul_f32 v197, -v82, v65
s_add_u32 m0, s39, 3072
s_add_u32 s37, s37, s38
buffer_load_dwordx4 v23, s[8:11], s37 offen sc1 lds
v_mul_f32 v198, -v82, v66
v_mul_f32 v199, -v82, v67
s_add_u32 m0, s39, 4096
s_add_u32 s37, s37, s38
buffer_load_dwordx4 v22, s[8:11], s37 offen sc1 lds
v_mul_f32 v200, -v84, v64
v_mul_f32 v201, -v84, v65
s_add_u32 m0, s39, 5120
s_add_u32 s37, s37, s38
buffer_load_dwordx4 v23, s[8:11], s37 offen sc1 lds
v_mul_f32 v202, -v84, v66
v_mul_f32 v203, -v84, v67
s_add_u32 m0, s39, 6144
s_add_u32 s37, s37, s38
buffer_load_dwordx4 v22, s[8:11], s37 offen sc1 lds
v_mul_f32 v204, -v86, v64
v_mul_f32 v205, -v86, v65
s_add_u32 m0, s39, 7168
s_add_u32 s37, s37, s38
buffer_load_dwordx4 v23, s[8:11], s37 offen sc1 lds
v_mul_f32 v206, -v86, v66
v_mul_f32 v207, -v86, v67
s_add_u32 m0, s39, 8192
s_add_u32 s37, s37, s38
buffer_load_dwordx4 v22, s[8:11], s37 offen sc1 lds
v_mul_f32 v208, -v80, v68
v_mul_f32 v209, -v80, v69
s_add_u32 m0, s39, 9216
s_add_u32 s37, s37, s38
buffer_load_dwordx4 v23, s[8:11], s37 offen sc1 lds
v_mul_f32 v210, -v80, v70
v_mul_f32 v211, -v80, v71
s_add_u32 m0, s39, 10240
s_add_u32 s37, s37, s38
buffer_load_dwordx4 v22, s[8:11], s37 offen sc1 lds
v_mul_f32 v212, -v82, v68
v_mul_f32 v213, -v82, v69
s_add_u32 m0, s39, 11264
s_add_u32 s37, s37, s38
buffer_load_dwordx4 v23, s[8:11], s37 offen sc1 lds
v_mul_f32 v214, -v82, v70
v_mul_f32 v215, -v82, v71
s_add_u32 m0, s39, 12288
s_add_u32 s37, s37, s38
buffer_load_dwordx4 v22, s[8:11], s37 offen sc1 lds
v_mul_f32 v216, -v84, v68
v_mul_f32 v217, -v84, v69
s_add_u32 m0, s39, 13312
s_add_u32 s37, s37, s38
buffer_load_dwordx4 v23, s[8:11], s37 offen sc1 lds
v_mul_f32 v218, -v84, v70
v_mul_f32 v219, -v84, v71
s_add_u32 m0, s39, 14336
s_add_u32 s37, s37, s38
buffer_load_dwordx4 v22, s[8:11], s37 offen sc1 lds
v_mul_f32 v220, -v86, v68
v_mul_f32 v221, -v86, v69
s_add_u32 m0, s39, 15360
s_add_u32 s37, s37, s38
buffer_load_dwordx4 v23, s[8:11], s37 offen sc1 lds
v_mul_f32 v222, -v86, v70
v_mul_f32 v223, -v86, v71
s_load_dword s64, s[80:81], 0
s_load_dword s65, s[80:81], 64
s_load_dword s66, s[80:81], 128
s_load_dword s67, s[80:81], 192
s_load_dword s68, s[80:81], 256
s_load_dword s69, s[80:81], 320
s_load_dword s70, s[80:81], 384
s_add_u32 s80, s80, 448
s_addc_u32 s81, s81, 0
s_waitcnt vmcnt(16)
s_barrier
s_add_u32 s42, s42, 1
s_and_b32 s42, s42, 15
s_add_u32 m0, s39, 49152
s_mul_i32 s37, s42, s40
buffer_load_dwordx4 v22, s[8:11], s37 offen sc1 lds
s_add_u32 m0, s39, 50176
s_add_u32 s37, s37, s38
buffer_load_dwordx4 v23, s[8:11], s37 offen sc1 lds
s_add_u32 m0, s39, 51200
s_add_u32 s37, s37, s38
buffer_load_dwordx4 v22, s[8:11], s37 offen sc1 lds
s_add_u32 m0, s39, 52224
s_add_u32 s37, s37, s38
buffer_load_dwordx4 v23, s[8:11], s37 offen sc1 lds
s_add_u32 m0, s39, 53248
s_add_u32 s37, s37, s38
buffer_load_dwordx4 v22, s[8:11], s37 offen sc1 lds
s_add_u32 m0, s39, 54272
s_add_u32 s37, s37, s38
buffer_load_dwordx4 v23, s[8:11], s37 offen sc1 lds
s_add_u32 m0, s39, 55296
s_add_u32 s37, s37, s38
buffer_load_dwordx4 v22, s[8:11], s37 offen sc1 lds
s_add_u32 m0, s39, 56320
s_add_u32 s37, s37, s38
buffer_load_dwordx4 v23, s[8:11], s37 offen sc1 lds
s_add_u32 m0, s39, 57344
s_add_u32 s37, s37, s38
buffer_load_dwordx4 v22, s[8:11], s37 offen sc1 lds
s_add_u32 m0, s39, 58368
s_add_u32 s37, s37, s38
buffer_load_dwordx4 v23, s[8:11], s37 offen sc1 lds
s_add_u32 m0, s39, 59392
s_add_u32 s37, s37, s38
buffer_load_dwordx4 v22, s[8:11], s37 offen sc1 lds
s_add_u32 m0, s39, 60416
s_add_u32 s37, s37, s38
buffer_load_dwordx4 v23, s[8:11], s37 offen sc1 lds
s_add_u32 m0, s39, 61440
s_add_u32 s37, s37, s38
buffer_load_dwordx4 v22, s[8:11], s37 offen sc1 lds
s_add_u32 m0, s39, 62464
s_add_u32 s37, s37, s38
buffer_load_dwordx4 v23, s[8:11], s37 offen sc1 lds
s_add_u32 m0, s39, 63488
s_add_u32 s37, s37, s38
buffer_load_dwordx4 v22, s[8:11], s37 offen sc1 lds
s_add_u32 m0, s39, 64512
s_add_u32 s37, s37, s38
buffer_load_dwordx4 v23, s[8:11], s37 offen sc1 lds
s_mul_i32 s44, s34, 917504
s_lshl_b32 s39, s51, 13
s_add_u32 s44, s44, s39
s_add_u32 s44, s44, 8388608
s_and_b32 s43, s51, 1
s_xor_b32 s43, s43, s35
s_lshl_b32 s43, s43, 7
s_mov_b32 s10, 909312
s_movk_i32 s38, 1024
s_movk_i32 s40, 9216
s_movk_i32 s37, 0x4000
s_cmp_ge_u32 s51, 2
s_cselect_b32 s8, s60, s32
s_cselect_b32 s9, s61, s33
s_cselect_b32 s10, 7338112, s10
s_cselect_b32 s43, s43, s44
s_cselect_b32 s38, 16384, s38
s_cselect_b32 s40, 81920, s40
s_cselect_b32 s55, 81920, s38
s_cselect_b32 s37, 262144, s37
s_cselect_b32 s45, -1, 0
s_add_u32 s8, s8, s43
s_addc_u32 s9, s9, 0
s_mov_b32 s11, 0x20000
s_and_b32 s53, s35, 1
s_mul_i32 s54, s53, 6
s_mul_i32 s54, s54, s37
s_mul_i32 s29, s53, 2
s_add_u32 s29, s29, 6
s_mul_i32 s29, s29, s37
s_and_b32 s43, s45, 4290838528
s_add_u32 s29, s29, s43
s_mul_i32 s37, s37, 2
s_sub_u32 s37, s37, s40
v_lshrrev_b32 v19, 3, v1
v_mul_u32_u24 v19, 1920, v19
v_lshrrev_b32 v20, 4, v1
v_lshlrev_b32 v20, 5, v20
v_and_b32 v19, s45, v19
v_and_b32 v20, s45, v20
v_lshlrev_b32 v21, 4, v1
v_xor_b32 v21, v21, v20
v_add_u32 v21, v21, v19
s_waitcnt vmcnt(16)
s_barrier
s_branch LK3b_32
L7_31:
s_lshr_b32 s43, s2, 5
s_cmp_eq_u32 s43, 3
s_cbranch_scc1 Lnojob_42
s_cmp_gt_u32 s43, 3
s_cselect_b32 s43, 32, 0
s_sub_u32 s43, s2, s43
s_lshr_b32 s43, s43, 1
s_and_b32 s44, s2, 1
s_lshl_b32 s45, s44, 3
s_add_u32 s45, s45, 32
s_load_dwordx2 s[68:69], s[0:1], s45
s_mul_i32 s45, s43, 2341
s_lshr_b32 s45, s45, 16
s_mul_i32 s46, s45, 28
s_sub_u32 s46, s43, s46
v_lshrrev_b32 v4, 4, v1
s_lshl_b32 s43, s45, 8
v_add_u32 v4, s43, v4
v_mul_u32_u24 v4, 7168, v4
v_and_b32 v5, 15, v1
v_lshl_add_u32 v4, v5, 4, v4
s_lshl_b32 s43, s46, 8
v_add_u32 v4, s43, v4
s_waitcnt lgkmcnt(0)
s_mov_b32 s64, s68
s_mov_b32 s65, s69
s_mov_b32 s66, 7340032
s_mov_b32 s67, 0x20000
s_lshl_b32 s55, s45, 1
s_add_u32 s55, s55, s44
s_mul_i32 s55, s55, 14336
s_lshl_b32 s45, s46, 9
s_add_u32 s55, s55, s45
v_lshl_add_u32 v5, v5, 5, s55
s_add_u32 s72, s32, 27262976
s_addc_u32 s73, s33, 0
s_mov_b32 s74, 114688
s_mov_b32 s75, 0x20000
v_mov_b32 v32, 0
v_mov_b32 v33, 0
v_mov_b32 v34, 0
v_mov_b32 v35, 0
v_mov_b32 v36, 0
v_mov_b32 v37, 0
v_mov_b32 v38, 0
v_mov_b32 v39, 0
s_mov_b32 s52, 0x00003f80
s_mov_b32 s53, 0x3f800000
v_dot2_f32_bf16 v32, v128, s52, v32
v_dot2_f32_bf16 v33, v128, s53, v33
v_dot2_f32_bf16 v34, v129, s52, v34
v_dot2_f32_bf16 v35, v129, s53, v35
v_dot2_f32_bf16 v36, v130, s52, v36
v_dot2_f32_bf16 v37, v130, s53, v37
v_dot2_f32_bf16 v38, v131, s52, v38
v_dot2_f32_bf16 v39, v131, s53, v39
s_mov_b32 s43, 917504
buffer_load_dwordx4 v[128:131], v4, s[64:67], s43 offen
v_dot2_f32_bf16 v32, v132, s52, v32
v_dot2_f32_bf16 v33, v132, s53, v33
v_dot2_f32_bf16 v34, v133, s52, v34
v_dot2_f32_bf16 v35, v133, s53, v35
v_dot2_f32_bf16 v36, v134, s52, v36
v_dot2_f32_bf16 v37, v134, s53, v37
v_dot2_f32_bf16 v38, v135, s52, v38
v_dot2_f32_bf16 v39, v135, s53, v39
s_mov_b32 s43, 946176
buffer_load_dwordx4 v[132:135], v4, s[64:67], s43 offen
v_dot2_f32_bf16 v32, v136, s52, v32
v_dot2_f32_bf16 v33, v136, s53, v33
v_dot2_f32_bf16 v34, v137, s52, v34
v_dot2_f32_bf16 v35, v137, s53, v35
v_dot2_f32_bf16 v36, v138, s52, v36
v_dot2_f32_bf16 v37, v138, s53, v37
v_dot2_f32_bf16 v38, v139, s52, v38
v_dot2_f32_bf16 v39, v139, s53, v39
s_mov_b32 s43, 974848
buffer_load_dwordx4 v[136:139], v4, s[64:67], s43 offen
v_dot2_f32_bf16 v32, v140, s52, v32
v_dot2_f32_bf16 v33, v140, s53, v33
v_dot2_f32_bf16 v34, v141, s52, v34
v_dot2_f32_bf16 v35, v141, s53, v35
v_dot2_f32_bf16 v36, v142, s52, v36
v_dot2_f32_bf16 v37, v142, s53, v37
v_dot2_f32_bf16 v38, v143, s52, v38
v_dot2_f32_bf16 v39, v143, s53, v39
s_mov_b32 s43, 1003520
buffer_load_dwordx4 v[140:143], v4, s[64:67], s43 offen
v_dot2_f32_bf16 v32, v144, s52, v32
v_dot2_f32_bf16 v33, v144, s53, v33
v_dot2_f32_bf16 v34, v145, s52, v34
v_dot2_f32_bf16 v35, v145, s53, v35
v_dot2_f32_bf16 v36, v146, s52, v36
v_dot2_f32_bf16 v37, v146, s53, v37
v_dot2_f32_bf16 v38, v147, s52, v38
v_dot2_f32_bf16 v39, v147, s53, v39
s_mov_b32 s43, 1032192
buffer_load_dwordx4 v[144:147], v4, s[64:67], s43 offen
v_dot2_f32_bf16 v32, v148, s52, v32
v_dot2_f32_bf16 v33, v148, s53, v33
v_dot2_f32_bf16 v34, v149, s52, v34
v_dot2_f32_bf16 v35, v149, s53, v35
v_dot2_f32_bf16 v36, v150, s52, v36
v_dot2_f32_bf16 v37, v150, s53, v37
v_dot2_f32_bf16 v38, v151, s52, v38
v_dot2_f32_bf16 v39, v151, s53, v39
s_mov_b32 s43, 1060864
buffer_load_dwordx4 v[148:151], v4, s[64:67], s43 offen
v_dot2_f32_bf16 v32, v152, s52, v32
v_dot2_f32_bf16 v33, v152, s53, v33
v_dot2_f32_bf16 v34, v153, s52, v34
v_dot2_f32_bf16 v35, v153, s53, v35
v_dot2_f32_bf16 v36, v154, s52, v36
v_dot2_f32_bf16 v37, v154, s53, v37
v_dot2_f32_bf16 v38, v155, s52, v38
v_dot2_f32_bf16 v39, v155, s53, v39
s_mov_b32 s43, 1089536
buffer_load_dwordx4 v[152:155], v4, s[64:67], s43 offen
v_dot2_f32_bf16 v32, v156, s52, v32
v_dot2_f32_bf16 v33, v156, s53, v33
v_dot2_f32_bf16 v34, v157, s52, v34
v_dot2_f32_bf16 v35, v157, s53, v35
v_dot2_f32_bf16 v36, v158, s52, v36
v_dot2_f32_bf16 v37, v158, s53, v37
v_dot2_f32_bf16 v38, v159, s52, v38
v_dot2_f32_bf16 v39, v159, s53, v39
s_mov_b32 s43, 1118208
buffer_load_dwordx4 v[156:159], v4, s[64:67], s43 offen
v_dot2_f32_bf16 v32, v160, s52, v32
v_dot2_f32_bf16 v33, v160, s53, v33
v_dot2_f32_bf16 v34, v161, s52, v34
v_dot2_f32_bf16 v35, v161, s53, v35
v_dot2_f32_bf16 v36, v162, s52, v36
v_dot2_f32_bf16 v37, v162, s53, v37
v_dot2_f32_bf16 v38, v163, s52, v38
v_dot2_f32_bf16 v39, v163, s53, v39
s_mov_b32 s43, 1146880
buffer_load_dwordx4 v[160:163], v4, s[64:67], s43 offen
v_dot2_f32_bf16 v32, v164, s52, v32
v_dot2_f32_bf16 v33, v164, s53, v33
v_dot2_f32_bf16 v34, v165, s52, v34
v_dot2_f32_bf16 v35, v165, s53, v35
v_dot2_f32_bf16 v36, v166, s52, v36
v_dot2_f32_bf16 v37, v166, s53, v37
v_dot2_f32_bf16 v38, v167, s52, v38
v_dot2_f32_bf16 v39, v167, s53, v39
s_mov_b32 s43, 1175552
buffer_load_dwordx4 v[164:167], v4, s[64:67], s43 offen
v_dot2_f32_bf16 v32, v168, s52, v32
v_dot2_f32_bf16 v33, v168, s53, v33
v_dot2_f32_bf16 v34, v169, s52, v34
v_dot2_f32_bf16 v35, v169, s53, v35
v_dot2_f32_bf16 v36, v170, s52, v36
v_dot2_f32_bf16 v37, v170, s53, v37
v_dot2_f32_bf16 v38, v171, s52, v38
v_dot2_f32_bf16 v39, v171, s53, v39
s_mov_b32 s43, 1204224
buffer_load_dwordx4 v[168:171], v4, s[64:67], s43 offen
v_dot2_f32_bf16 v32, v172, s52, v32
v_dot2_f32_bf16 v33, v172, s53, v33
v_dot2_f32_bf16 v34, v173, s52, v34
v_dot2_f32_bf16 v35, v173, s53, v35
v_dot2_f32_bf16 v36, v174, s52, v36
v_dot2_f32_bf16 v37, v174, s53, v37
v_dot2_f32_bf16 v38, v175, s52, v38
v_dot2_f32_bf16 v39, v175, s53, v39
s_mov_b32 s43, 1232896
buffer_load_dwordx4 v[172:175], v4, s[64:67], s43 offen
v_dot2_f32_bf16 v32, v176, s52, v32
v_dot2_f32_bf16 v33, v176, s53, v33
v_dot2_f32_bf16 v34, v177, s52, v34
v_dot2_f32_bf16 v35, v177, s53, v35
v_dot2_f32_bf16 v36, v178, s52, v36
v_dot2_f32_bf16 v37, v178, s53, v37
v_dot2_f32_bf16 v38, v179, s52, v38
v_dot2_f32_bf16 v39, v179, s53, v39
s_mov_b32 s43, 1261568
buffer_load_dwordx4 v[176:179], v4, s[64:67], s43 offen
v_dot2_f32_bf16 v32, v180, s52, v32
v_dot2_f32_bf16 v33, v180, s53, v33
v_dot2_f32_bf16 v34, v181, s52, v34
v_dot2_f32_bf16 v35, v181, s53, v35
v_dot2_f32_bf16 v36, v182, s52, v36
v_dot2_f32_bf16 v37, v182, s53, v37
v_dot2_f32_bf16 v38, v183, s52, v38
v_dot2_f32_bf16 v39, v183, s53, v39
s_mov_b32 s43, 1290240
buffer_load_dwordx4 v[180:183], v4, s[64:67], s43 offen
v_dot2_f32_bf16 v32, v184, s52, v32
v_dot2_f32_bf16 v33, v184, s53, v33
v_dot2_f32_bf16 v34, v185, s52, v34
v_dot2_f32_bf16 v35, v185, s53, v35
v_dot2_f32_bf16 v36, v186, s52, v36
v_dot2_f32_bf16 v37, v186, s53, v37
v_dot2_f32_bf16 v38, v187, s52, v38
v_dot2_f32_bf16 v39, v187, s53, v39
s_mov_b32 s43, 1318912
buffer_load_dwordx4 v[184:187], v4, s[64:67], s43 offen
v_dot2_f32_bf16 v32, v188, s52, v32
v_dot2_f32_bf16 v33, v188, s53, v33
v_dot2_f32_bf16 v34, v189, s52, v34
v_dot2_f32_bf16 v35, v189, s53, v35
v_dot2_f32_bf16 v36, v190, s52, v36
v_dot2_f32_bf16 v37, v190, s53, v37
v_dot2_f32_bf16 v38, v191, s52, v38
v_dot2_f32_bf16 v39, v191, s53, v39
s_mov_b32 s43, 1347584
buffer_load_dwordx4 v[188:191], v4, s[64:67], s43 offen
v_dot2_f32_bf16 v32, v192, s52, v32
v_dot2_f32_bf16 v33, v192, s53, v33
v_dot2_f32_bf16 v34, v193, s52, v34
v_dot2_f32_bf16 v35, v193, s53, v35
v_dot2_f32_bf16 v36, v194, s52, v36
v_dot2_f32_bf16 v37, v194, s53, v37
v_dot2_f32_bf16 v38, v195, s52, v38
v_dot2_f32_bf16 v39, v195, s53, v39
s_mov_b32 s43, 1376256
buffer_load_dwordx4 v[192:195], v4, s[64:67], s43 offen
v_dot2_f32_bf16 v32, v196, s52, v32
v_dot2_f32_bf16 v33, v196, s53, v33
v_dot2_f32_bf16 v34, v197, s52, v34
v_dot2_f32_bf16 v35, v197, s53, v35
v_dot2_f32_bf16 v36, v198, s52, v36
v_dot2_f32_bf16 v37, v198, s53, v37
v_dot2_f32_bf16 v38, v199, s52, v38
v_dot2_f32_bf16 v39, v199, s53, v39
s_mov_b32 s43, 1404928
buffer_load_dwordx4 v[196:199], v4, s[64:67], s43 offen
v_dot2_f32_bf16 v32, v200, s52, v32
v_dot2_f32_bf16 v33, v200, s53, v33
v_dot2_f32_bf16 v34, v201, s52, v34
v_dot2_f32_bf16 v35, v201, s53, v35
v_dot2_f32_bf16 v36, v202, s52, v36
v_dot2_f32_bf16 v37, v202, s53, v37
v_dot2_f32_bf16 v38, v203, s52, v38
v_dot2_f32_bf16 v39, v203, s53, v39
s_mov_b32 s43, 1433600
buffer_load_dwordx4 v[200:203], v4, s[64:67], s43 offen
v_dot2_f32_bf16 v32, v204, s52, v32
v_dot2_f32_bf16 v33, v204, s53, v33
v_dot2_f32_bf16 v34, v205, s52, v34
v_dot2_f32_bf16 v35, v205, s53, v35
v_dot2_f32_bf16 v36, v206, s52, v36
v_dot2_f32_bf16 v37, v206, s53, v37
v_dot2_f32_bf16 v38, v207, s52, v38
v_dot2_f32_bf16 v39, v207, s53, v39
s_mov_b32 s43, 1462272
buffer_load_dwordx4 v[204:207], v4, s[64:67], s43 offen
v_dot2_f32_bf16 v32, v208, s52, v32
v_dot2_f32_bf16 v33, v208, s53, v33
v_dot2_f32_bf16 v34, v209, s52, v34
v_dot2_f32_bf16 v35, v209, s53, v35
v_dot2_f32_bf16 v36, v210, s52, v36
v_dot2_f32_bf16 v37, v210, s53, v37
v_dot2_f32_bf16 v38, v211, s52, v38
v_dot2_f32_bf16 v39, v211, s53, v39
s_mov_b32 s43, 1490944
buffer_load_dwordx4 v[208:211], v4, s[64:67], s43 offen
v_dot2_f32_bf16 v32, v212, s52, v32
v_dot2_f32_bf16 v33, v212, s53, v33
v_dot2_f32_bf16 v34, v213, s52, v34
v_dot2_f32_bf16 v35, v213, s53, v35
v_dot2_f32_bf16 v36, v214, s52, v36
v_dot2_f32_bf16 v37, v214, s53, v37
v_dot2_f32_bf16 v38, v215, s52, v38
v_dot2_f32_bf16 v39, v215, s53, v39
s_mov_b32 s43, 1519616
buffer_load_dwordx4 v[212:215], v4, s[64:67], s43 offen
v_dot2_f32_bf16 v32, v216, s52, v32
v_dot2_f32_bf16 v33, v216, s53, v33
v_dot2_f32_bf16 v34, v217, s52, v34
v_dot2_f32_bf16 v35, v217, s53, v35
v_dot2_f32_bf16 v36, v218, s52, v36
v_dot2_f32_bf16 v37, v218, s53, v37
v_dot2_f32_bf16 v38, v219, s52, v38
v_dot2_f32_bf16 v39, v219, s53, v39
s_mov_b32 s43, 1548288
buffer_load_dwordx4 v[216:219], v4, s[64:67], s43 offen
v_dot2_f32_bf16 v32, v220, s52, v32
v_dot2_f32_bf16 v33, v220, s53, v33
v_dot2_f32_bf16 v34, v221, s52, v34
v_dot2_f32_bf16 v35, v221, s53, v35
v_dot2_f32_bf16 v36, v222, s52, v36
v_dot2_f32_bf16 v37, v222, s53, v37
v_dot2_f32_bf16 v38, v223, s52, v38
v_dot2_f32_bf16 v39, v223, s53, v39
s_mov_b32 s43, 1576960
buffer_load_dwordx4 v[220:223], v4, s[64:67], s43 offen
v_dot2_f32_bf16 v32, v224, s52, v32
v_dot2_f32_bf16 v33, v224, s53, v33
v_dot2_f32_bf16 v34, v225, s52, v34
v_dot2_f32_bf16 v35, v225, s53, v35
v_dot2_f32_bf16 v36, v226, s52, v36
v_dot2_f32_bf16 v37, v226, s53, v37
v_dot2_f32_bf16 v38, v227, s52, v38
v_dot2_f32_bf16 v39, v227, s53, v39
s_mov_b32 s43, 1605632
buffer_load_dwordx4 v[224:227], v4, s[64:67], s43 offen
v_dot2_f32_bf16 v32, v228, s52, v32
v_dot2_f32_bf16 v33, v228, s53, v33
v_dot2_f32_bf16 v34, v229, s52, v34
v_dot2_f32_bf16 v35, v229, s53, v35
v_dot2_f32_bf16 v36, v230, s52, v36
v_dot2_f32_bf16 v37, v230, s53, v37
v_dot2_f32_bf16 v38, v231, s52, v38
v_dot2_f32_bf16 v39, v231, s53, v39
s_mov_b32 s43, 1634304
buffer_load_dwordx4 v[228:231], v4, s[64:67], s43 offen
v_dot2_f32_bf16 v32, v232, s52, v32
v_dot2_f32_bf16 v33, v232, s53, v33
v_dot2_f32_bf16 v34, v233, s52, v34
v_dot2_f32_bf16 v35, v233, s53, v35
v_dot2_f32_bf16 v36, v234, s52, v36
v_dot2_f32_bf16 v37, v234, s53, v37
v_dot2_f32_bf16 v38, v235, s52, v38
v_dot2_f32_bf16 v39, v235, s53, v39
s_mov_b32 s43, 1662976
buffer_load_dwordx4 v[232:235], v4, s[64:67], s43 offen
v_dot2_f32_bf16 v32, v236, s52, v32
v_dot2_f32_bf16 v33, v236, s53, v33
v_dot2_f32_bf16 v34, v237, s52, v34
v_dot2_f32_bf16 v35, v237, s53, v35
v_dot2_f32_bf16 v36, v238, s52, v36
v_dot2_f32_bf16 v37, v238, s53, v37
v_dot2_f32_bf16 v38, v239, s52, v38
v_dot2_f32_bf16 v39, v239, s53, v39
s_mov_b32 s43, 1691648
buffer_load_dwordx4 v[236:239], v4, s[64:67], s43 offen
v_dot2_f32_bf16 v32, v240, s52, v32
v_dot2_f32_bf16 v33, v240, s53, v33
v_dot2_f32_bf16 v34, v241, s52, v34
v_dot2_f32_bf16 v35, v241, s53, v35
v_dot2_f32_bf16 v36, v242, s52, v36
v_dot2_f32_bf16 v37, v242, s53, v37
v_dot2_f32_bf16 v38, v243, s52, v38
v_dot2_f32_bf16 v39, v243, s53, v39
s_mov_b32 s43, 1720320
buffer_load_dwordx4 v[240:243], v4, s[64:67], s43 offen
v_dot2_f32_bf16 v32, v244, s52, v32
v_dot2_f32_bf16 v33, v244, s53, v33
v_dot2_f32_bf16 v34, v245, s52, v34
v_dot2_f32_bf16 v35, v245, s53, v35
v_dot2_f32_bf16 v36, v246, s52, v36
v_dot2_f32_bf16 v37, v246, s53, v37
v_dot2_f32_bf16 v38, v247, s52, v38
v_dot2_f32_bf16 v39, v247, s53, v39
s_mov_b32 s43, 1748992
buffer_load_dwordx4 v[244:247], v4, s[64:67], s43 offen
v_dot2_f32_bf16 v32, v248, s52, v32
v_dot2_f32_bf16 v33, v248, s53, v33
v_dot2_f32_bf16 v34, v249, s52, v34
v_dot2_f32_bf16 v35, v249, s53, v35
v_dot2_f32_bf16 v36, v250, s52, v36
v_dot2_f32_bf16 v37, v250, s53, v37
v_dot2_f32_bf16 v38, v251, s52, v38
v_dot2_f32_bf16 v39, v251, s53, v39
s_mov_b32 s43, 1777664
buffer_load_dwordx4 v[248:251], v4, s[64:67], s43 offen
v_dot2_f32_bf16 v32, v252, s52, v32
v_dot2_f32_bf16 v33, v252, s53, v33
v_dot2_f32_bf16 v34, v253, s52, v34
v_dot2_f32_bf16 v35, v253, s53, v35
v_dot2_f32_bf16 v36, v254, s52, v36
v_dot2_f32_bf16 v37, v254, s53, v37
v_dot2_f32_bf16 v38, v255, s52, v38
v_dot2_f32_bf16 v39, v255, s53, v39
s_mov_b32 s43, 1806336
buffer_load_dwordx4 v[252:255], v4, s[64:67], s43 offen
s_lshl_b32 s43, s34, 18
s_add_u32 s12, s32, s43
s_addc_u32 s13, s33, 0
s_mov_b32 s14, 262144
s_mov_b32 s15, 0x20000
v_lshlrev_b32 v21, 4, v1
s_lshl_b32 s54, s36, 11
s_barrier
s_add_u32 m0, s54, 0
s_add_u32 s43, s54, 0
buffer_load_dwordx4 v21, s[12:15], s43 offen sc1 lds
s_add_u32 m0, s54, 1024
s_add_u32 s43, s54, 1024
buffer_load_dwordx4 v21, s[12:15], s43 offen sc1 lds
s_add_u32 m0, s54, 24576
s_add_u32 s43, s54, 16384
buffer_load_dwordx4 v21, s[12:15], s43 offen sc1 lds
s_add_u32 m0, s54, 25600
s_add_u32 s43, s54, 17408
buffer_load_dwordx4 v21, s[12:15], s43 offen sc1 lds
s_waitcnt vmcnt(2)
s_barrier
s_waitcnt vmcnt(0)
s_barrier
s_barrier
s_barrier
s_barrier
s_barrier
s_barrier
s_barrier
v_dot2_f32_bf16 v32, v128, s52, v32
v_dot2_f32_bf16 v33, v128, s53, v33
v_dot2_f32_bf16 v34, v129, s52, v34
v_dot2_f32_bf16 v35, v129, s53, v35
v_dot2_f32_bf16 v36, v130, s52, v36
v_dot2_f32_bf16 v37, v130, s53, v37
v_dot2_f32_bf16 v38, v131, s52, v38
v_dot2_f32_bf16 v39, v131, s53, v39
v_dot2_f32_bf16 v32, v132, s52, v32
v_dot2_f32_bf16 v33, v132, s53, v33
v_dot2_f32_bf16 v34, v133, s52, v34
v_dot2_f32_bf16 v35, v133, s53, v35
v_dot2_f32_bf16 v36, v134, s52, v36
v_dot2_f32_bf16 v37, v134, s53, v37
v_dot2_f32_bf16 v38, v135, s52, v38
v_dot2_f32_bf16 v39, v135, s53, v39
v_dot2_f32_bf16 v32, v136, s52, v32
v_dot2_f32_bf16 v33, v136, s53, v33
v_dot2_f32_bf16 v34, v137, s52, v34
v_dot2_f32_bf16 v35, v137, s53, v35
v_dot2_f32_bf16 v36, v138, s52, v36
v_dot2_f32_bf16 v37, v138, s53, v37
v_dot2_f32_bf16 v38, v139, s52, v38
v_dot2_f32_bf16 v39, v139, s53, v39
v_dot2_f32_bf16 v32, v140, s52, v32
v_dot2_f32_bf16 v33, v140, s53, v33
v_dot2_f32_bf16 v34, v141, s52, v34
v_dot2_f32_bf16 v35, v141, s53, v35
v_dot2_f32_bf16 v36, v142, s52, v36
v_dot2_f32_bf16 v37, v142, s53, v37
v_dot2_f32_bf16 v38, v143, s52, v38
v_dot2_f32_bf16 v39, v143, s53, v39
s_barrier
v_dot2_f32_bf16 v32, v144, s52, v32
v_dot2_f32_bf16 v33, v144, s53, v33
v_dot2_f32_bf16 v34, v145, s52, v34
v_dot2_f32_bf16 v35, v145, s53, v35
v_dot2_f32_bf16 v36, v146, s52, v36
v_dot2_f32_bf16 v37, v146, s53, v37
v_dot2_f32_bf16 v38, v147, s52, v38
v_dot2_f32_bf16 v39, v147, s53, v39
v_dot2_f32_bf16 v32, v148, s52, v32
v_dot2_f32_bf16 v33, v148, s53, v33
v_dot2_f32_bf16 v34, v149, s52, v34
v_dot2_f32_bf16 v35, v149, s53, v35
v_dot2_f32_bf16 v36, v150, s52, v36
v_dot2_f32_bf16 v37, v150, s53, v37
v_dot2_f32_bf16 v38, v151, s52, v38
v_dot2_f32_bf16 v39, v151, s53, v39
v_dot2_f32_bf16 v32, v152, s52, v32
v_dot2_f32_bf16 v33, v152, s53, v33
v_dot2_f32_bf16 v34, v153, s52, v34
v_dot2_f32_bf16 v35, v153, s53, v35
v_dot2_f32_bf16 v36, v154, s52, v36
v_dot2_f32_bf16 v37, v154, s53, v37
v_dot2_f32_bf16 v38, v155, s52, v38
v_dot2_f32_bf16 v39, v155, s53, v39
v_dot2_f32_bf16 v32, v156, s52, v32
v_dot2_f32_bf16 v33, v156, s53, v33
v_dot2_f32_bf16 v34, v157, s52, v34
v_dot2_f32_bf16 v35, v157, s53, v35
v_dot2_f32_bf16 v36, v158, s52, v36
v_dot2_f32_bf16 v37, v158, s53, v37
v_dot2_f32_bf16 v38, v159, s52, v38
v_dot2_f32_bf16 v39, v159, s53, v39
s_barrier
v_dot2_f32_bf16 v32, v160, s52, v32
v_dot2_f32_bf16 v33, v160, s53, v33
v_dot2_f32_bf16 v34, v161, s52, v34
v_dot2_f32_bf16 v35, v161, s53, v35
v_dot2_f32_bf16 v36, v162, s52, v36
v_dot2_f32_bf16 v37, v162, s53, v37
v_dot2_f32_bf16 v38, v163, s52, v38
v_dot2_f32_bf16 v39, v163, s53, v39
v_dot2_f32_bf16 v32, v164, s52, v32
v_dot2_f32_bf16 v33, v164, s53, v33
v_dot2_f32_bf16 v34, v165, s52, v34
v_dot2_f32_bf16 v35, v165, s53, v35
v_dot2_f32_bf16 v36, v166, s52, v36
v_dot2_f32_bf16 v37, v166, s53, v37
v_dot2_f32_bf16 v38, v167, s52, v38
v_dot2_f32_bf16 v39, v167, s53, v39
v_dot2_f32_bf16 v32, v168, s52, v32
v_dot2_f32_bf16 v33, v168, s53, v33
v_dot2_f32_bf16 v34, v169, s52, v34
v_dot2_f32_bf16 v35, v169, s53, v35
v_dot2_f32_bf16 v36, v170, s52, v36
v_dot2_f32_bf16 v37, v170, s53, v37
v_dot2_f32_bf16 v38, v171, s52, v38
v_dot2_f32_bf16 v39, v171, s53, v39
v_dot2_f32_bf16 v32, v172, s52, v32
v_dot2_f32_bf16 v33, v172, s53, v33
v_dot2_f32_bf16 v34, v173, s52, v34
v_dot2_f32_bf16 v35, v173, s53, v35
v_dot2_f32_bf16 v36, v174, s52, v36
v_dot2_f32_bf16 v37, v174, s53, v37
v_dot2_f32_bf16 v38, v175, s52, v38
v_dot2_f32_bf16 v39, v175, s53, v39
s_barrier
v_dot2_f32_bf16 v32, v176, s52, v32
v_dot2_f32_bf16 v33, v176, s53, v33
v_dot2_f32_bf16 v34, v177, s52, v34
v_dot2_f32_bf16 v35, v177, s53, v35
v_dot2_f32_bf16 v36, v178, s52, v36
v_dot2_f32_bf16 v37, v178, s53, v37
v_dot2_f32_bf16 v38, v179, s52, v38
v_dot2_f32_bf16 v39, v179, s53, v39
v_dot2_f32_bf16 v32, v180, s52, v32
v_dot2_f32_bf16 v33, v180, s53, v33
v_dot2_f32_bf16 v34, v181, s52, v34
v_dot2_f32_bf16 v35, v181, s53, v35
v_dot2_f32_bf16 v36, v182, s52, v36
v_dot2_f32_bf16 v37, v182, s53, v37
v_dot2_f32_bf16 v38, v183, s52, v38
v_dot2_f32_bf16 v39, v183, s53, v39
v_dot2_f32_bf16 v32, v184, s52, v32
v_dot2_f32_bf16 v33, v184, s53, v33
v_dot2_f32_bf16 v34, v185, s52, v34
v_dot2_f32_bf16 v35, v185, s53, v35
v_dot2_f32_bf16 v36, v186, s52, v36
v_dot2_f32_bf16 v37, v186, s53, v37
v_dot2_f32_bf16 v38, v187, s52, v38
v_dot2_f32_bf16 v39, v187, s53, v39
v_dot2_f32_bf16 v32, v188, s52, v32
v_dot2_f32_bf16 v33, v188, s53, v33
v_dot2_f32_bf16 v34, v189, s52, v34
v_dot2_f32_bf16 v35, v189, s53, v35
v_dot2_f32_bf16 v36, v190, s52, v36
v_dot2_f32_bf16 v37, v190, s53, v37
v_dot2_f32_bf16 v38, v191, s52, v38
v_dot2_f32_bf16 v39, v191, s53, v39
s_barrier
v_dot2_f32_bf16 v32, v192, s52, v32
v_dot2_f32_bf16 v33, v192, s53, v33
v_dot2_f32_bf16 v34, v193, s52, v34
v_dot2_f32_bf16 v35, v193, s53, v35
v_dot2_f32_bf16 v36, v194, s52, v36
v_dot2_f32_bf16 v37, v194, s53, v37
v_dot2_f32_bf16 v38, v195, s52, v38
v_dot2_f32_bf16 v39, v195, s53, v39
v_dot2_f32_bf16 v32, v196, s52, v32
v_dot2_f32_bf16 v33, v196, s53, v33
v_dot2_f32_bf16 v34, v197, s52, v34
v_dot2_f32_bf16 v35, v197, s53, v35
v_dot2_f32_bf16 v36, v198, s52, v36
v_dot2_f32_bf16 v37, v198, s53, v37
v_dot2_f32_bf16 v38, v199, s52, v38
v_dot2_f32_bf16 v39, v199, s53, v39
v_dot2_f32_bf16 v32, v200, s52, v32
v_dot2_f32_bf16 v33, v200, s53, v33
v_dot2_f32_bf16 v34, v201, s52, v34
v_dot2_f32_bf16 v35, v201, s53, v35
v_dot2_f32_bf16 v36, v202, s52, v36
v_dot2_f32_bf16 v37, v202, s53, v37
v_dot2_f32_bf16 v38, v203, s52, v38
v_dot2_f32_bf16 v39, v203, s53, v39
v_dot2_f32_bf16 v32, v204, s52, v32
v_dot2_f32_bf16 v33, v204, s53, v33
v_dot2_f32_bf16 v34, v205, s52, v34
v_dot2_f32_bf16 v35, v205, s53, v35
v_dot2_f32_bf16 v36, v206, s52, v36
v_dot2_f32_bf16 v37, v206, s53, v37
v_dot2_f32_bf16 v38, v207, s52, v38
v_dot2_f32_bf16 v39, v207, s53, v39
s_barrier
v_dot2_f32_bf16 v32, v208, s52, v32
v_dot2_f32_bf16 v33, v208, s53, v33
v_dot2_f32_bf16 v34, v209, s52, v34
v_dot2_f32_bf16 v35, v209, s53, v35
v_dot2_f32_bf16 v36, v210, s52, v36
v_dot2_f32_bf16 v37, v210, s53, v37
v_dot2_f32_bf16 v38, v211, s52, v38
v_dot2_f32_bf16 v39, v211, s53, v39
v_dot2_f32_bf16 v32, v212, s52, v32
v_dot2_f32_bf16 v33, v212, s53, v33
v_dot2_f32_bf16 v34, v213, s52, v34
v_dot2_f32_bf16 v35, v213, s53, v35
v_dot2_f32_bf16 v36, v214, s52, v36
v_dot2_f32_bf16 v37, v214, s53, v37
v_dot2_f32_bf16 v38, v215, s52, v38
v_dot2_f32_bf16 v39, v215, s53, v39
v_dot2_f32_bf16 v32, v216, s52, v32
v_dot2_f32_bf16 v33, v216, s53, v33
v_dot2_f32_bf16 v34, v217, s52, v34
v_dot2_f32_bf16 v35, v217, s53, v35
v_dot2_f32_bf16 v36, v218, s52, v36
v_dot2_f32_bf16 v37, v218, s53, v37
v_dot2_f32_bf16 v38, v219, s52, v38
v_dot2_f32_bf16 v39, v219, s53, v39
v_dot2_f32_bf16 v32, v220, s52, v32
v_dot2_f32_bf16 v33, v220, s53, v33
v_dot2_f32_bf16 v34, v221, s52, v34
v_dot2_f32_bf16 v35, v221, s53, v35
v_dot2_f32_bf16 v36, v222, s52, v36
v_dot2_f32_bf16 v37, v222, s53, v37
v_dot2_f32_bf16 v38, v223, s52, v38
v_dot2_f32_bf16 v39, v223, s53, v39
s_barrier
v_dot2_f32_bf16 v32, v224, s52, v32
v_dot2_f32_bf16 v33, v224, s53, v33
v_dot2_f32_bf16 v34, v225, s52, v34
v_dot2_f32_bf16 v35, v225, s53, v35
v_dot2_f32_bf16 v36, v226, s52, v36
v_dot2_f32_bf16 v37, v226, s53, v37
v_dot2_f32_bf16 v38, v227, s52, v38
v_dot2_f32_bf16 v39, v227, s53, v39
v_dot2_f32_bf16 v32, v228, s52, v32
v_dot2_f32_bf16 v33, v228, s53, v33
v_dot2_f32_bf16 v34, v229, s52, v34
v_dot2_f32_bf16 v35, v229, s53, v35
v_dot2_f32_bf16 v36, v230, s52, v36
v_dot2_f32_bf16 v37, v230, s53, v37
v_dot2_f32_bf16 v38, v231, s52, v38
v_dot2_f32_bf16 v39, v231, s53, v39
v_dot2_f32_bf16 v32, v232, s52, v32
v_dot2_f32_bf16 v33, v232, s53, v33
v_dot2_f32_bf16 v34, v233, s52, v34
v_dot2_f32_bf16 v35, v233, s53, v35
v_dot2_f32_bf16 v36, v234, s52, v36
v_dot2_f32_bf16 v37, v234, s53, v37
v_dot2_f32_bf16 v38, v235, s52, v38
v_dot2_f32_bf16 v39, v235, s53, v39
v_dot2_f32_bf16 v32, v236, s52, v32
v_dot2_f32_bf16 v33, v236, s53, v33
v_dot2_f32_bf16 v34, v237, s52, v34
v_dot2_f32_bf16 v35, v237, s53, v35
v_dot2_f32_bf16 v36, v238, s52, v36
v_dot2_f32_bf16 v37, v238, s53, v37
v_dot2_f32_bf16 v38, v239, s52, v38
v_dot2_f32_bf16 v39, v239, s53, v39
s_barrier
v_dot2_f32_bf16 v32, v240, s52, v32
v_dot2_f32_bf16 v33, v240, s53, v33
v_dot2_f32_bf16 v34, v241, s52, v34
v_dot2_f32_bf16 v35, v241, s53, v35
v_dot2_f32_bf16 v36, v242, s52, v36
v_dot2_f32_bf16 v37, v242, s53, v37
v_dot2_f32_bf16 v38, v243, s52, v38
v_dot2_f32_bf16 v39, v243, s53, v39
v_dot2_f32_bf16 v32, v244, s52, v32
v_dot2_f32_bf16 v33, v244, s53, v33
v_dot2_f32_bf16 v34, v245, s52, v34
v_dot2_f32_bf16 v35, v245, s53, v35
v_dot2_f32_bf16 v36, v246, s52, v36
v_dot2_f32_bf16 v37, v246, s53, v37
v_dot2_f32_bf16 v38, v247, s52, v38
v_dot2_f32_bf16 v39, v247, s53, v39
v_dot2_f32_bf16 v32, v248, s52, v32
v_dot2_f32_bf16 v33, v248, s53, v33
v_dot2_f32_bf16 v34, v249, s52, v34
v_dot2_f32_bf16 v35, v249, s53, v35
v_dot2_f32_bf16 v36, v250, s52, v36
v_dot2_f32_bf16 v37, v250, s53, v37
v_dot2_f32_bf16 v38, v251, s52, v38
v_dot2_f32_bf16 v39, v251, s53, v39
v_dot2_f32_bf16 v32, v252, s52, v32
v_dot2_f32_bf16 v33, v252, s53, v33
v_dot2_f32_bf16 v34, v253, s52, v34
v_dot2_f32_bf16 v35, v253, s53, v35
v_dot2_f32_bf16 v36, v254, s52, v36
v_dot2_f32_bf16 v37, v254, s53, v37
v_dot2_f32_bf16 v38, v255, s52, v38
v_dot2_f32_bf16 v39, v255, s53, v39
s_nop 2
v_mov_b32 v40, v32
v_mov_b32 v41, v33
v_mov_b32 v42, v34
v_mov_b32 v43, v35
v_mov_b32 v44, v36
v_mov_b32 v45, v37
v_mov_b32 v46, v38
v_mov_b32 v47, v39
s_nop 0
v_permlane16_swap_b32 v32, v40
v_permlane16_swap_b32 v33, v41
v_permlane16_swap_b32 v34, v42
v_permlane16_swap_b32 v35, v43
v_permlane16_swap_b32 v36, v44
v_permlane16_swap_b32 v37, v45
v_permlane16_swap_b32 v38, v46
v_permlane16_swap_b32 v39, v47
v_add_f32 v32, v32, v40
v_add_f32 v33, v33, v41
v_add_f32 v34, v34, v42
v_add_f32 v35, v35, v43
v_add_f32 v36, v36, v44
v_add_f32 v37, v37, v45
v_add_f32 v38, v38, v46
v_add_f32 v39, v39, v47
v_mov_b32 v40, v32
v_mov_b32 v41, v33
v_mov_b32 v42, v34
v_mov_b32 v43, v35
v_mov_b32 v44, v36
v_mov_b32 v45, v37
v_mov_b32 v46, v38
v_mov_b32 v47, v39
s_nop 0
v_permlane32_swap_b32 v32, v40
v_permlane32_swap_b32 v33, v41
v_permlane32_swap_b32 v34, v42
v_permlane32_swap_b32 v35, v43
v_permlane32_swap_b32 v36, v44
v_permlane32_swap_b32 v37, v45
v_permlane32_swap_b32 v38, v46
v_permlane32_swap_b32 v39, v47
v_add_f32 v32, v32, v40
v_add_f32 v33, v33, v41
v_add_f32 v34, v34, v42
v_add_f32 v35, v35, v43
v_add_f32 v36, v36, v44
v_add_f32 v37, v37, v45
v_add_f32 v38, v38, v46
v_add_f32 v39, v39, v47
s_mov_b64 exec, 0xffff
buffer_store_dwordx4 v[32:35], v5, s[72:75], 0 offen sc1
buffer_store_dwordx4 v[36:39], v5, s[72:75], 0 offen offset:16 sc1
s_mov_b64 exec, -1
s_barrier
s_barrier
s_barrier
s_waitcnt vmcnt(0)
v_mov_b32 v12, 10240
v_mov_b32 v13, 1
s_mov_b64 exec, 1
buffer_atomic_add v13, v12, s[56:59], 0 offen sc1
s_mov_b64 exec, -1
s_branch Lcsd_43
Lnojob_42:
s_lshl_b32 s43, s34, 18
s_add_u32 s12, s32, s43
s_addc_u32 s13, s33, 0
s_mov_b32 s14, 262144
s_mov_b32 s15, 0x20000
v_lshlrev_b32 v21, 4, v1
s_lshl_b32 s54, s36, 11
s_barrier
s_add_u32 m0, s54, 0
s_add_u32 s43, s54, 0
buffer_load_dwordx4 v21, s[12:15], s43 offen sc1 lds
s_add_u32 m0, s54, 1024
s_add_u32 s43, s54, 1024
buffer_load_dwordx4 v21, s[12:15], s43 offen sc1 lds
s_add_u32 m0, s54, 24576
s_add_u32 s43, s54, 16384
buffer_load_dwordx4 v21, s[12:15], s43 offen sc1 lds
s_add_u32 m0, s54, 25600
s_add_u32 s43, s54, 17408
buffer_load_dwordx4 v21, s[12:15], s43 offen sc1 lds
s_waitcnt vmcnt(2)
s_barrier
s_waitcnt vmcnt(0)
s_barrier
s_barrier
s_barrier
s_barrier
s_barrier
s_barrier
s_barrier
s_barrier
s_barrier
s_barrier
s_barrier
s_barrier
s_barrier
s_barrier
s_barrier
s_barrier
s_barrier
Lcsd_43:
s_mov_b32 s46, 1
s_lshl_b32 s43, s34, 18
s_add_u32 s12, s32, s43
s_addc_u32 s13, s33, 0
s_add_u32 s12, s12, 4194304
s_addc_u32 s13, s13, 0
s_mov_b32 s14, 262144
s_mov_b32 s15, 0x20000
v_lshlrev_b32 v21, 4, v1
s_lshl_b32 s54, s36, 11
s_add_u32 s43, s35, 1
s_and_b32 s43, s43, 15
s_lshl_b32 s43, s43, 14
s_add_u32 s30, s43, s54
s_add_u32 s43, s35, 2
s_and_b32 s43, s43, 15
s_lshl_b32 s43, s43, 14
s_add_u32 s31, s43, s54
s_mov_b32 s88, s4
s_mov_b32 s89, s5
s_mov_b32 s90, 7340032
s_mov_b32 s91, 0x20000
s_mov_b32 s92, s6
s_mov_b32 s93, s7
s_mov_b32 s94, 7340032
s_mov_b32 s95, 0x20000
s_lshr_b32 s43, s35, 3
v_and_b32 v19, 1, v1
v_bfe_u32 v23, v1, 2, 3
s_lshl_b32 s44, s43, 3
s_add_u32 s44, s44, 1
v_lshl_add_u32 v23, v19, 2, v23
v_add_u32 v23, s44, v23
s_lshl_b32 s43, s43, 11
s_add_u32 s43, s43, 384
s_movk_i32 s44, 1024
s_lshr_b32 s45, s2, 3
s_mul_i32 s45, s45, 14336
s_add_u32 s43, s43, s45
v_mul_lo_u32 v31, v19, s44
v_bfe_u32 v19, v1, 1, 1
v_mul_u32_u24 v19, 7168, v19
v_add3_u32 v31, v31, v19, s43
v_add_u32 v19, 3, v23
v_and_b32 v19, 15, v19
v_mul_u32_u24 v19, 458752, v19
v_add_u32 v19, v19, v31
buffer_load_dword v30, v19, s[88:91], 0 offen
buffer_load_dword v30, v19, s[92:95], 0 offen
s_lshl_b32 s43, s34, 14
s_add_u32 s64, s32, s43
s_addc_u32 s65, s33, 0
s_add_u32 s64, s64, 25165824
s_addc_u32 s65, s65, 0
s_mov_b32 s66, 16384
s_mov_b32 s67, 0x20000
s_add_u32 s72, s32, 27262976
s_addc_u32 s73, s33, 0
s_mov_b32 s74, 114688
s_mov_b32 s75, 0x20000
s_barrier
s_add_u32 m0, s54, 0
s_add_u32 s43, s30, 0
buffer_load_dwordx4 v21, s[12:15], s43 offen sc1 lds
s_add_u32 m0, s54, 1024
s_add_u32 s43, s30, 1024
buffer_load_dwordx4 v21, s[12:15], s43 offen sc1 lds
s_add_u32 m0, s54, 49152
s_add_u32 s43, s31, 0
buffer_load_dwordx4 v21, s[12:15], s43 offen sc1 lds
s_add_u32 m0, s54, 50176
s_add_u32 s43, s31, 1024
buffer_load_dwordx4 v21, s[12:15], s43 offen sc1 lds
s_waitcnt vmcnt(2)
s_barrier
s_waitcnt vmcnt(0)
s_mul_i32 s43, s2, 28672
s_mul_i32 s44, s51, 7168
s_add_u32 s43, s43, s44
s_add_u32 s80, s60, s43
s_addc_u32 s81, s61, 0
s_load_dword s82, s[80:81], 0
s_load_dword s83, s[80:81], 64
s_load_dword s84, s[80:81], 128
s_load_dword s85, s[80:81], 192
s_load_dword s86, s[80:81], 256
s_load_dword s87, s[80:81], 320
s_load_dword s82, s[80:81], 384
s_load_dword s83, s[80:81], 448
s_load_dword s84, s[80:81], 512
s_load_dword s85, s[80:81], 576
s_load_dword s86, s[80:81], 640
s_add_u32 s80, s80, 704
s_addc_u32 s81, s81, 0
s_barrier
s_mov_b32 s43, 0
buffer_load_dwordx4 v[128:131], v21, s[64:67], s43 offen sc1
s_mov_b32 s43, 1024
buffer_load_dwordx4 v[132:135], v21, s[64:67], s43 offen sc1
s_mov_b32 s43, 2048
buffer_load_dwordx4 v[136:139], v21, s[64:67], s43 offen sc1
s_mov_b32 s43, 3072
buffer_load_dwordx4 v[140:143], v21, s[64:67], s43 offen sc1
s_mov_b32 s43, 4096
buffer_load_dwordx4 v[144:147], v21, s[64:67], s43 offen sc1
s_mov_b32 s43, 5120
buffer_load_dwordx4 v[148:151], v21, s[64:67], s43 offen sc1
s_mov_b32 s43, 6144
buffer_load_dwordx4 v[152:155], v21, s[64:67], s43 offen sc1
s_mov_b32 s43, 7168
buffer_load_dwordx4 v[156:159], v21, s[64:67], s43 offen sc1
s_mov_b32 s43, 8192
buffer_load_dwordx4 v[160:163], v21, s[64:67], s43 offen sc1
s_mov_b32 s43, 9216
buffer_load_dwordx4 v[164:167], v21, s[64:67], s43 offen sc1
s_mov_b32 s43, 10240
buffer_load_dwordx4 v[168:171], v21, s[64:67], s43 offen sc1
s_mov_b32 s43, 11264
buffer_load_dwordx4 v[172:175], v21, s[64:67], s43 offen sc1
s_mov_b32 s43, 12288
buffer_load_dwordx4 v[176:179], v21, s[64:67], s43 offen sc1
s_mov_b32 s43, 13312
buffer_load_dwordx4 v[180:183], v21, s[64:67], s43 offen sc1
s_mov_b32 s43, 14336
buffer_load_dwordx4 v[184:187], v21, s[64:67], s43 offen sc1
s_mov_b32 s43, 15360
buffer_load_dwordx4 v[188:191], v21, s[64:67], s43 offen sc1
s_load_dword s82, s[80:81], 0
s_load_dword s83, s[80:81], 64
s_load_dword s84, s[80:81], 128
s_load_dword s85, s[80:81], 192
s_load_dword s86, s[80:81], 256
s_load_dword s87, s[80:81], 320
s_load_dword s82, s[80:81], 384
s_load_dword s83, s[80:81], 448
s_load_dword s84, s[80:81], 512
s_load_dword s85, s[80:81], 576
s_load_dword s86, s[80:81], 640
s_add_u32 s80, s80, 704
s_addc_u32 s81, s81, 0
s_barrier
v_mov_b32 v12, 10240
v_mov_b32 v14, 224
buffer_load_dword v13, v12, s[56:59], 0 offen sc1
s_load_dword s82, s[80:81], 0
s_load_dword s83, s[80:81], 64
s_load_dword s84, s[80:81], 128
s_load_dword s85, s[80:81], 192
s_load_dword s86, s[80:81], 256
s_load_dword s87, s[80:81], 320
s_load_dword s82, s[80:81], 384
s_load_dword s83, s[80:81], 448
s_load_dword s84, s[80:81], 512
s_load_dword s85, s[80:81], 576
s_load_dword s86, s[80:81], 640
s_add_u32 s80, s80, 704
s_addc_u32 s81, s81, 0
s_barrier
s_load_dword s82, s[80:81], 0
s_load_dword s83, s[80:81], 64
s_load_dword s84, s[80:81], 128
s_load_dword s85, s[80:81], 192
s_load_dword s86, s[80:81], 256
s_load_dword s87, s[80:81], 320
s_load_dword s82, s[80:81], 384
s_load_dword s83, s[80:81], 448
s_load_dword s84, s[80:81], 512
s_load_dword s85, s[80:81], 576
s_load_dword s86, s[80:81], 640
s_add_u32 s80, s80, 704
s_addc_u32 s81, s81, 0
s_barrier
s_mov_b32 s41, 0x10000
Lpoll_44:
s_waitcnt vmcnt(0)
Lpf_46:
v_cmp_ne_u32 vcc, v14, v13
s_nop 4
s_cbranch_vccz Lpok_45
buffer_load_dword v13, v12, s[56:59], 0 offen sc1
s_sub_u32 s41, s41, 1
s_cmp_lg_u32 s41, 0
s_cbranch_scc1 Lpoll_44
s_waitcnt vmcnt(0)
Lpok_45:
v_min_u32 v12, 55, v1
v_lshlrev_b32 v13, 4, v12
s_lshl_b32 s43, s35, 9
s_mul_i32 s44, s35, 384
s_add_u32 s44, s44, 7680
v_mov_b32 v14, s44
v_mov_b32 v15, s43
v_cmp_gt_u32 vcc, 32, v12
s_nop 1
v_cndmask_b32 v14, v14, v15, vcc
v_add_u32 v14, v14, v13
v_add_u32 v13, 148480, v13
s_mov_b32 s43, 0
buffer_load_dwordx4 v[192:195], v14, s[72:75], s43 offen sc1
s_mov_b32 s43, 28672
buffer_load_dwordx4 v[196:199], v14, s[72:75], s43 offen sc1
s_mov_b32 s43, 57344
buffer_load_dwordx4 v[200:203], v14, s[72:75], s43 offen sc1
s_mov_b32 s43, 86016
buffer_load_dwordx4 v[204:207], v14, s[72:75], s43 offen sc1
s_mov_b32 s43, 14336
buffer_load_dwordx4 v[208:211], v14, s[72:75], s43 offen sc1
s_mov_b32 s43, 43008
buffer_load_dwordx4 v[212:215], v14, s[72:75], s43 offen sc1
s_mov_b32 s43, 71680
buffer_load_dwordx4 v[216:219], v14, s[72:75], s43 offen sc1
s_mov_b32 s43, 100352
buffer_load_dwordx4 v[220:223], v14, s[72:75], s43 offen sc1
s_load_dword s82, s[80:81], 0
s_load_dword s83, s[80:81], 64
s_load_dword s84, s[80:81], 128
s_load_dword s85, s[80:81], 192
s_load_dword s86, s[80:81], 256
s_load_dword s87, s[80:81], 320
s_load_dword s82, s[80:81], 384
s_load_dword s83, s[80:81], 448
s_load_dword s84, s[80:81], 512
s_load_dword s85, s[80:81], 576
s_load_dword s86, s[80:81], 640
s_add_u32 s80, s80, 704
s_addc_u32 s81, s81, 0
s_barrier
v_add_u32 v19, 8, v23
v_and_b32 v19, 15, v19
v_mul_u32_u24 v19, 458752, v19
v_add_u32 v19, v19, v31
buffer_load_dword v30, v19, s[88:91], 0 offen
buffer_load_dword v30, v19, s[92:95], 0 offen
v_add_f32 v128, v128, v132
v_add_f32 v129, v129, v133
v_add_f32 v130, v130, v134
v_add_f32 v131, v131, v135
v_add_f32 v128, v128, v136
v_add_f32 v129, v129, v137
v_add_f32 v130, v130, v138
v_add_f32 v131, v131, v139
v_add_f32 v128, v128, v140
v_add_f32 v129, v129, v141
v_add_f32 v130, v130, v142
v_add_f32 v131, v131, v143
v_add_f32 v128, v128, v144
v_add_f32 v129, v129, v145
v_add_f32 v130, v130, v146
v_add_f32 v131, v131, v147
v_add_f32 v128, v128, v148
v_add_f32 v129, v129, v149
v_add_f32 v130, v130, v150
v_add_f32 v131, v131, v151
v_add_f32 v128, v128, v152
v_add_f32 v129, v129, v153
v_add_f32 v130, v130, v154
v_add_f32 v131, v131, v155
v_add_f32 v128, v128, v156
v_add_f32 v129, v129, v157
v_add_f32 v130, v130, v158
v_add_f32 v131, v131, v159
v_add_f32 v128, v128, v160
v_add_f32 v129, v129, v161
v_add_f32 v130, v130, v162
v_add_f32 v131, v131, v163
v_add_f32 v128, v128, v164
v_add_f32 v129, v129, v165
v_add_f32 v130, v130, v166
v_add_f32 v131, v131, v167
v_add_f32 v128, v128, v168
v_add_f32 v129, v129, v169
v_add_f32 v130, v130, v170
v_add_f32 v131, v131, v171
v_add_f32 v128, v128, v172
v_add_f32 v129, v129, v173
v_add_f32 v130, v130, v174
v_add_f32 v131, v131, v175
v_add_f32 v128, v128, v176
v_add_f32 v129, v129, v177
v_add_f32 v130, v130, v178
v_add_f32 v131, v131, v179
v_add_f32 v128, v128, v180
v_add_f32 v129, v129, v181
v_add_f32 v130, v130, v182
v_add_f32 v131, v131, v183
v_add_f32 v128, v128, v184
v_add_f32 v129, v129, v185
v_add_f32 v130, v130, v186
v_add_f32 v131, v131, v187
v_add_f32 v128, v128, v188
v_add_f32 v129, v129, v189
v_add_f32 v130, v130, v190
v_add_f32 v131, v131, v191
v_mul_f32 v128, 0x3a800000, v128
v_mul_f32 v129, 0x3a800000, v129
v_fma_f32 v129, -v128, v128, v129
v_max_f32 v129, 0, v129
v_add_f32 v129, 0x3727c5ac, v129
v_rsq_f32 v129, v129
v_mul_f32 v130, 0x3a800000, v130
v_mul_f32 v131, 0x3a800000, v131
v_fma_f32 v131, -v130, v130, v131
v_max_f32 v131, 0, v131
v_add_f32 v131, 0x3727c5ac, v131
v_rsq_f32 v131, v131
v_add_u32 v19, 147456, v21
ds_write_b128 v19, v[128:131]
s_load_dword s82, s[80:81], 0
s_load_dword s83, s[80:81], 64
s_load_dword s84, s[80:81], 128
s_load_dword s85, s[80:81], 192
s_load_dword s86, s[80:81], 256
s_load_dword s87, s[80:81], 320
s_load_dword s82, s[80:81], 384
s_load_dword s83, s[80:81], 448
s_load_dword s84, s[80:81], 512
s_load_dword s85, s[80:81], 576
s_load_dword s86, s[80:81], 640
s_add_u32 s80, s80, 704
s_addc_u32 s81, s81, 0
s_barrier
s_barrier
s_waitcnt vmcnt(0)
v_add_f32 v192, v192, v196
v_add_f32 v200, v200, v204
v_add_f32 v193, v193, v197
v_add_f32 v201, v201, v205
v_add_f32 v194, v194, v198
v_add_f32 v202, v202, v206
v_add_f32 v195, v195, v199
v_add_f32 v203, v203, v207
v_add_f32 v192, v192, v200
v_add_f32 v193, v193, v201
v_add_f32 v194, v194, v202
v_add_f32 v195, v195, v203
ds_write_b128 v13, v[192:195] offset:0
v_add_f32 v208, v208, v212
v_add_f32 v216, v216, v220
v_add_f32 v209, v209, v213
v_add_f32 v217, v217, v221
v_add_f32 v210, v210, v214
v_add_f32 v218, v218, v222
v_add_f32 v211, v211, v215
v_add_f32 v219, v219, v223
v_add_f32 v208, v208, v216
v_add_f32 v209, v209, v217
v_add_f32 v210, v210, v218
v_add_f32 v211, v211, v219
ds_write_b128 v13, v[208:211] offset:896
s_waitcnt lgkmcnt(0)
s_load_dword s82, s[80:81], 0
s_load_dword s83, s[80:81], 64
s_load_dword s84, s[80:81], 128
s_load_dword s85, s[80:81], 192
s_load_dword s86, s[80:81], 256
s_load_dword s87, s[80:81], 320
s_load_dword s82, s[80:81], 384
s_load_dword s83, s[80:81], 448
s_load_dword s84, s[80:81], 512
s_load_dword s85, s[80:81], 576
s_load_dword s86, s[80:81], 640
s_add_u32 s80, s80, 704
s_addc_u32 s81, s81, 0
s_barrier
s_load_dword s82, s[80:81], 0
s_load_dword s83, s[80:81], 64
s_load_dword s84, s[80:81], 128
s_load_dword s85, s[80:81], 192
s_load_dword s86, s[80:81], 256
s_load_dword s87, s[80:81], 320
s_load_dword s82, s[80:81], 384
s_load_dword s83, s[80:81], 448
s_load_dword s84, s[80:81], 512
s_load_dword s85, s[80:81], 576
s_load_dword s86, s[80:81], 640
s_add_u32 s80, s80, 704
s_addc_u32 s81, s81, 0
s_barrier
s_and_b32 s53, s35, 1
s_lshl_b32 s53, s53, 1
s_mul_i32 s43, s47, 3
s_add_u32 s53, s53, s43
v_lshlrev_b32 v19, 11, v18
v_lshl_add_u32 v19, v17, 4, v19
s_lshl_b32 s43, s46, 10
v_add_u32 v2, s43, v19
v_add_u32 v3, 49152, v2
v_add_u32 v4, 98304, v2
v_lshrrev_b32 v19, 2, v17
v_lshl_add_u32 v20, v18, 2, v19
v_and_b32 v21, 7, v20
v_lshlrev_b32 v20, 8, v20
v_and_b32 v19, 3, v1
v_lshl_add_u32 v20, v19, 3, v20
s_add_u32 s43, s53, 0
v_xor_b32 v19, s43, v21
v_lshl_add_u32 v5, v19, 5, v20
s_add_u32 s43, s53, 1
v_xor_b32 v19, s43, v21
v_lshl_add_u32 v6, v19, 5, v20
s_add_u32 s43, s53, 2
v_xor_b32 v19, s43, v21
v_lshl_add_u32 v7, v19, 5, v20
v_add_u32 v9, 49152, v5
v_add_u32 v10, 49152, v6
v_add_u32 v11, 49152, v7
v_add_u32 v13, 98304, v5
v_add_u32 v14, 98304, v6
v_add_u32 v15, 98304, v7
s_lshl_b32 s43, s46, 9
s_add_u32 s43, s43, 147456
v_lshl_add_u32 v19, v17, 3, s43
ds_read_b64 v[80:81], v19 offset:0
ds_read_b64 v[82:83], v19 offset:128
ds_read_b64 v[84:85], v19 offset:256
ds_read_b64 v[86:87], v19 offset:384
s_mul_i32 s43, s47, 192
s_add_u32 s43, s43, 148992
v_lshl_add_u32 v19, v18, 4, s43
ds_read_b128 v[48:51], v19 offset:0
ds_read_b128 v[52:55], v19 offset:64
ds_read_b128 v[56:59], v19 offset:128
ds_read_b128 v[60:63], v19 offset:896
ds_read_b128 v[64:67], v19 offset:960
ds_read_b128 v[68:71], v19 offset:1024
s_barrier
s_mov_b32 s88, s4
s_mov_b32 s89, s5
s_mov_b32 s90, 7340032
s_mov_b32 s91, 0x20000
s_mov_b32 s92, s6
s_mov_b32 s93, s7
s_mov_b32 s94, 7340032
s_mov_b32 s95, 0x20000
s_lshr_b32 s43, s35, 3
v_and_b32 v19, 1, v1
v_bfe_u32 v23, v1, 2, 3
s_mul_i32 s44, s43, 10
s_add_u32 s44, s44, 2
v_add_u32 v23, s44, v23
s_lshl_b32 s44, s43, 2
s_sub_u32 s44, 5, s44
v_mad_u32_u24 v23, v19, s44, v23
s_lshl_b32 s44, s43, 10
s_xor_b32 s44, s44, 1024
s_lshl_b32 s43, s43, 11
s_add_u32 s43, s43, 4480
s_lshr_b32 s45, s2, 3
s_mul_i32 s45, s45, 14336
s_add_u32 s43, s43, s45
v_mul_lo_u32 v31, v19, s44
v_bfe_u32 v19, v1, 1, 1
v_mul_u32_u24 v19, 7168, v19
v_add3_u32 v31, v31, v19, s43
v_add_u32 v19, 0, v23
v_and_b32 v19, 15, v19
v_mul_u32_u24 v19, 458752, v19
v_add_u32 v19, v19, v31
buffer_load_dword v30, v19, s[88:91], 0 offen
buffer_load_dword v30, v19, s[92:95], 0 offen
s_waitcnt lgkmcnt(0)
v_mul_f32 v88, v81, v81
v_mul_f32 v228, 0xc0135761, v81
v_mul_f32 v89, 0xbdd2d3e8, v81
v_rcp_f32 v236, v88
v_mul_f32 v232, v89, v88
v_mul_f32 v88, v83, v83
v_mul_f32 v229, 0xc0135761, v83
v_mul_f32 v89, 0xbdd2d3e8, v83
v_rcp_f32 v237, v88
v_mul_f32 v233, v89, v88
v_mul_f32 v88, v85, v85
v_mul_f32 v230, 0xc0135761, v85
v_mul_f32 v89, 0xbdd2d3e8, v85
v_rcp_f32 v238, v88
v_mul_f32 v234, v89, v88
v_mul_f32 v88, v87, v87
v_mul_f32 v231, 0xc0135761, v87
v_mul_f32 v89, 0xbdd2d3e8, v87
v_rcp_f32 v239, v88
v_mul_f32 v235, v89, v88
s_mul_i32 s43, s34, 917504
s_mul_i32 s44, s35, 24576
s_add_u32 s43, s43, s44
s_add_u32 s43, s43, 8912896
s_add_u32 s24, s32, s43
s_addc_u32 s25, s33, 0
s_mov_b32 s26, 24576
s_mov_b32 s27, 0x20000
s_mov_b32 s53, 262144
s_lshl_b32 s43, s47, 13
s_lshl_b32 s44, s46, 10
s_add_u32 s43, s43, s44
v_lshlrev_b32 v19, 11, v18
v_lshl_add_u32 v19, v17, 4, v19
v_add_u32 v27, s43, v19
s_lshl_b32 s43, s47, 12
s_add_u32 s43, s43, s44
s_add_u32 s43, s43, 16384
v_and_b32 v19, 1, v18
v_lshlrev_b32 v19, 11, v19
v_lshrrev_b32 v20, 1, v18
v_lshl_add_u32 v19, v20, 8, v19
v_lshl_add_u32 v19, v17, 4, v19
v_add_u32 v28, s43, v19
s_load_dword s82, s[80:81], 0
s_load_dword s83, s[80:81], 64
s_load_dword s84, s[80:81], 128
s_load_dword s85, s[80:81], 192
s_load_dword s86, s[80:81], 256
s_load_dword s87, s[80:81], 320
s_load_dword s82, s[80:81], 384
s_load_dword s83, s[80:81], 448
s_add_u32 s80, s80, 512
s_addc_u32 s81, s81, 0
s_barrier
v_mul_f32 v128, -v80, v48
v_mul_f32 v129, -v80, v49
v_mul_f32 v130, -v80, v50
v_mul_f32 v131, -v80, v51
v_mul_f32 v132, -v82, v48
v_mul_f32 v133, -v82, v49
v_mul_f32 v134, -v82, v50
v_mul_f32 v135, -v82, v51
v_mul_f32 v136, -v84, v48
v_mul_f32 v137, -v84, v49
v_mul_f32 v138, -v84, v50
v_mul_f32 v139, -v84, v51
v_mul_f32 v140, -v86, v48
v_mul_f32 v141, -v86, v49
v_mul_f32 v142, -v86, v50
v_mul_f32 v143, -v86, v51
v_mul_f32 v144, -v80, v52
v_mul_f32 v145, -v80, v53
v_mul_f32 v146, -v80, v54
v_mul_f32 v147, -v80, v55
v_mul_f32 v148, -v82, v52
v_mul_f32 v149, -v82, v53
v_mul_f32 v150, -v82, v54
v_mul_f32 v151, -v82, v55
v_mul_f32 v152, -v84, v52
v_mul_f32 v153, -v84, v53
v_mul_f32 v154, -v84, v54
v_mul_f32 v155, -v84, v55
v_mul_f32 v156, -v86, v52
v_mul_f32 v157, -v86, v53
v_mul_f32 v158, -v86, v54
v_mul_f32 v159, -v86, v55
s_load_dword s82, s[80:81], 0
s_load_dword s83, s[80:81], 64
s_load_dword s84, s[80:81], 128
s_load_dword s85, s[80:81], 192
s_load_dword s86, s[80:81], 256
s_load_dword s87, s[80:81], 320
s_load_dword s82, s[80:81], 384
s_load_dword s83, s[80:81], 448
s_add_u32 s80, s80, 512
s_addc_u32 s81, s81, 0
s_barrier
v_mul_f32 v160, -v80, v56
v_mul_f32 v161, -v80, v57
v_mul_f32 v162, -v80, v58
v_mul_f32 v163, -v80, v59
v_mul_f32 v164, -v82, v56
v_mul_f32 v165, -v82, v57
v_mul_f32 v166, -v82, v58
v_mul_f32 v167, -v82, v59
v_mul_f32 v168, -v84, v56
v_mul_f32 v169, -v84, v57
v_mul_f32 v170, -v84, v58
v_mul_f32 v171, -v84, v59
v_mul_f32 v172, -v86, v56
v_mul_f32 v173, -v86, v57
v_mul_f32 v174, -v86, v58
v_mul_f32 v175, -v86, v59
v_mul_f32 v176, -v80, v60
v_mul_f32 v177, -v80, v61
v_mul_f32 v178, -v80, v62
v_mul_f32 v179, -v80, v63
v_mul_f32 v180, -v82, v60
v_mul_f32 v181, -v82, v61
v_mul_f32 v182, -v82, v62
v_mul_f32 v183, -v82, v63
v_mul_f32 v184, -v84, v60
v_mul_f32 v185, -v84, v61
v_mul_f32 v186, -v84, v62
v_mul_f32 v187, -v84, v63
v_mul_f32 v188, -v86, v60
v_mul_f32 v189, -v86, v61
v_mul_f32 v190, -v86, v62
v_mul_f32 v191, -v86, v63
s_load_dword s82, s[80:81], 0
s_load_dword s83, s[80:81], 64
s_load_dword s84, s[80:81], 128
s_load_dword s85, s[80:81], 192
s_load_dword s86, s[80:81], 256
s_load_dword s87, s[80:81], 320
s_load_dword s82, s[80:81], 384
s_load_dword s83, s[80:81], 448
s_add_u32 s80, s80, 512
s_addc_u32 s81, s81, 0
s_barrier
v_mul_f32 v192, -v80, v64
v_mul_f32 v193, -v80, v65
v_mul_f32 v194, -v80, v66
v_mul_f32 v195, -v80, v67
v_mul_f32 v196, -v82, v64
v_mul_f32 v197, -v82, v65
v_mul_f32 v198, -v82, v66
v_mul_f32 v199, -v82, v67
v_mul_f32 v200, -v84, v64
v_mul_f32 v201, -v84, v65
v_mul_f32 v202, -v84, v66
v_mul_f32 v203, -v84, v67
v_mul_f32 v204, -v86, v64
v_mul_f32 v205, -v86, v65
v_mul_f32 v206, -v86, v66
v_mul_f32 v207, -v86, v67
v_mul_f32 v208, -v80, v68
v_mul_f32 v209, -v80, v69
v_mul_f32 v210, -v80, v70
v_mul_f32 v211, -v80, v71
v_mul_f32 v212, -v82, v68
v_mul_f32 v213, -v82, v69
v_mul_f32 v214, -v82, v70
v_mul_f32 v215, -v82, v71
v_mul_f32 v216, -v84, v68
v_mul_f32 v217, -v84, v69
v_mul_f32 v218, -v84, v70
v_mul_f32 v219, -v84, v71
v_mul_f32 v220, -v86, v68
v_mul_f32 v221, -v86, v69
v_mul_f32 v222, -v86, v70
v_mul_f32 v223, -v86, v71
s_barrier
s_mul_i32 s44, s34, 917504
s_lshl_b32 s39, s51, 13
s_add_u32 s44, s44, s39
s_add_u32 s44, s44, 8388608
s_and_b32 s43, s51, 1
s_xor_b32 s43, s43, s35
s_lshl_b32 s43, s43, 7
s_mov_b32 s10, 909312
s_movk_i32 s38, 1024
s_movk_i32 s40, 9216
s_movk_i32 s37, 0x4000
s_cmp_ge_u32 s51, 2
s_cselect_b32 s8, s60, s32
s_cselect_b32 s9, s61, s33
s_cselect_b32 s10, 7338112, s10
s_cselect_b32 s43, s43, s44
s_cselect_b32 s38, 16384, s38
s_cselect_b32 s40, 81920, s40
s_cselect_b32 s55, 81920, s38
s_cselect_b32 s37, 262144, s37
s_cselect_b32 s45, -1, 0
s_add_u32 s8, s8, s43
s_addc_u32 s9, s9, 0
s_mov_b32 s11, 0x20000
s_and_b32 s53, s35, 1
s_mul_i32 s54, s53, 6
s_mul_i32 s54, s54, s37
s_mul_i32 s29, s53, 2
s_add_u32 s29, s29, 6
s_mul_i32 s29, s29, s37
s_and_b32 s43, s45, 4290838528
s_add_u32 s29, s29, s43
s_mul_i32 s37, s37, 2
s_sub_u32 s37, s37, s40
v_lshrrev_b32 v19, 3, v1
v_mul_u32_u24 v19, 1920, v19
v_lshrrev_b32 v20, 4, v1
v_lshlrev_b32 v20, 5, v20
v_and_b32 v19, s45, v19
v_and_b32 v20, s45, v20
v_lshlrev_b32 v21, 4, v1
v_xor_b32 v21, v21, v20
v_add_u32 v21, v21, v19
s_barrier
LK3b_32:
s_setprio 1
ds_read_b128 v[32:35], v2 offset:0
ds_read_b64_tr_b16 v[48:49], v5 offset:16384
ds_read_b64_tr_b16 v[50:51], v5 offset:20480
ds_read_b128 v[36:39], v2 offset:256
ds_read_b128 v[40:43], v2 offset:512
ds_read_b128 v[44:47], v2 offset:768
ds_read_b64_tr_b16 v[60:61], v5 offset:32768
ds_read_b64_tr_b16 v[62:63], v5 offset:36864
ds_read_b64_tr_b16 v[52:53], v6 offset:16384
ds_read_b64_tr_b16 v[54:55], v6 offset:20480
ds_read_b64_tr_b16 v[64:65], v6 offset:32768
ds_read_b64_tr_b16 v[66:67], v6 offset:36864
ds_read_b64_tr_b16 v[56:57], v7 offset:16384
ds_read_b64_tr_b16 v[58:59], v7 offset:20480
ds_read_b64_tr_b16 v[68:69], v7 offset:32768
ds_read_b64_tr_b16 v[70:71], v7 offset:36864
s_mov_b32 s41, 5
Lk3_47:
s_waitcnt lgkmcnt(0)
v_mfma_f32_16x16x32_bf16 v[128:131], v[48:51], v[32:35], v[128:131]
ds_read_b128 v[80:83], v2 offset:8192
v_mfma_f32_16x16x32_bf16 v[132:135], v[48:51], v[36:39], v[132:135]
ds_read_b64_tr_b16 v[96:97], v5 offset:24576
v_mfma_f32_16x16x32_bf16 v[136:139], v[48:51], v[40:43], v[136:139]
ds_read_b64_tr_b16 v[98:99], v5 offset:28672
v_mfma_f32_16x16x32_bf16 v[140:143], v[48:51], v[44:47], v[140:143]
ds_read_b128 v[84:87], v2 offset:8448
v_mfma_f32_16x16x32_bf16 v[188:191], v[60:63], v[44:47], v[188:191]
ds_read_b128 v[88:91], v2 offset:8704
v_mfma_f32_16x16x32_bf16 v[184:187], v[60:63], v[40:43], v[184:187]
ds_read_b128 v[92:95], v2 offset:8960
v_mfma_f32_16x16x32_bf16 v[180:183], v[60:63], v[36:39], v[180:183]
ds_read_b64_tr_b16 v[108:109], v5 offset:40960
v_mfma_f32_16x16x32_bf16 v[176:179], v[60:63], v[32:35], v[176:179]
ds_read_b64_tr_b16 v[110:111], v5 offset:45056
v_mfma_f32_16x16x32_bf16 v[144:147], v[52:55], v[32:35], v[144:147]
ds_read_b64_tr_b16 v[100:101], v6 offset:24576
v_mfma_f32_16x16x32_bf16 v[148:151], v[52:55], v[36:39], v[148:151]
ds_read_b64_tr_b16 v[102:103], v6 offset:28672
v_mfma_f32_16x16x32_bf16 v[152:155], v[52:55], v[40:43], v[152:155]
ds_read_b64_tr_b16 v[112:113], v6 offset:40960
v_mfma_f32_16x16x32_bf16 v[156:159], v[52:55], v[44:47], v[156:159]
ds_read_b64_tr_b16 v[114:115], v6 offset:45056
v_mfma_f32_16x16x32_bf16 v[204:207], v[64:67], v[44:47], v[204:207]
ds_read_b64_tr_b16 v[104:105], v7 offset:24576
v_mfma_f32_16x16x32_bf16 v[200:203], v[64:67], v[40:43], v[200:203]
ds_read_b64_tr_b16 v[106:107], v7 offset:28672
v_mfma_f32_16x16x32_bf16 v[196:199], v[64:67], v[36:39], v[196:199]
ds_read_b64_tr_b16 v[116:117], v7 offset:40960
v_mfma_f32_16x16x32_bf16 v[192:195], v[64:67], v[32:35], v[192:195]
ds_read_b64_tr_b16 v[118:119], v7 offset:45056
v_mfma_f32_16x16x32_bf16 v[160:163], v[56:59], v[32:35], v[160:163]
v_mfma_f32_16x16x32_bf16 v[164:167], v[56:59], v[36:39], v[164:167]
v_mfma_f32_16x16x32_bf16 v[168:171], v[56:59], v[40:43], v[168:171]
v_mfma_f32_16x16x32_bf16 v[172:175], v[56:59], v[44:47], v[172:175]
v_mfma_f32_16x16x32_bf16 v[220:223], v[68:71], v[44:47], v[220:223]
v_mfma_f32_16x16x32_bf16 v[216:219], v[68:71], v[40:43], v[216:219]
v_mfma_f32_16x16x32_bf16 v[212:215], v[68:71], v[36:39], v[212:215]
v_mfma_f32_16x16x32_bf16 v[208:211], v[68:71], v[32:35], v[208:211]
s_waitcnt vmcnt(0) lgkmcnt(0)
s_barrier
v_mfma_f32_16x16x32_bf16 v[128:131], v[96:99], v[80:83], v[128:131]
ds_read_b128 v[32:35], v3 offset:0
v_mfma_f32_16x16x32_bf16 v[132:135], v[96:99], v[84:87], v[132:135]
ds_read_b64_tr_b16 v[48:49], v9 offset:16384
v_mfma_f32_16x16x32_bf16 v[136:139], v[96:99], v[88:91], v[136:139]
ds_read_b64_tr_b16 v[50:51], v9 offset:20480
v_mfma_f32_16x16x32_bf16 v[140:143], v[96:99], v[92:95], v[140:143]
ds_read_b128 v[36:39], v3 offset:256
v_mfma_f32_16x16x32_bf16 v[188:191], v[108:111], v[92:95], v[188:191]
ds_read_b128 v[40:43], v3 offset:512
v_mfma_f32_16x16x32_bf16 v[184:187], v[108:111], v[88:91], v[184:187]
ds_read_b128 v[44:47], v3 offset:768
v_mfma_f32_16x16x32_bf16 v[180:183], v[108:111], v[84:87], v[180:183]
ds_read_b64_tr_b16 v[60:61], v9 offset:32768
v_mfma_f32_16x16x32_bf16 v[176:179], v[108:111], v[80:83], v[176:179]
ds_read_b64_tr_b16 v[62:63], v9 offset:36864
v_mfma_f32_16x16x32_bf16 v[144:147], v[100:103], v[80:83], v[144:147]
ds_read_b64_tr_b16 v[52:53], v10 offset:16384
v_mfma_f32_16x16x32_bf16 v[148:151], v[100:103], v[84:87], v[148:151]
ds_read_b64_tr_b16 v[54:55], v10 offset:20480
v_mfma_f32_16x16x32_bf16 v[152:155], v[100:103], v[88:91], v[152:155]
ds_read_b64_tr_b16 v[64:65], v10 offset:32768
v_mfma_f32_16x16x32_bf16 v[156:159], v[100:103], v[92:95], v[156:159]
ds_read_b64_tr_b16 v[66:67], v10 offset:36864
v_mfma_f32_16x16x32_bf16 v[204:207], v[112:115], v[92:95], v[204:207]
ds_read_b64_tr_b16 v[56:57], v11 offset:16384
v_mfma_f32_16x16x32_bf16 v[200:203], v[112:115], v[88:91], v[200:203]
ds_read_b64_tr_b16 v[58:59], v11 offset:20480
v_mfma_f32_16x16x32_bf16 v[196:199], v[112:115], v[84:87], v[196:199]
ds_read_b64_tr_b16 v[68:69], v11 offset:32768
v_mfma_f32_16x16x32_bf16 v[192:195], v[112:115], v[80:83], v[192:195]
ds_read_b64_tr_b16 v[70:71], v11 offset:36864
v_mfma_f32_16x16x32_bf16 v[160:163], v[104:107], v[80:83], v[160:163]
v_mfma_f32_16x16x32_bf16 v[164:167], v[104:107], v[84:87], v[164:167]
v_mfma_f32_16x16x32_bf16 v[168:171], v[104:107], v[88:91], v[168:171]
v_mfma_f32_16x16x32_bf16 v[172:175], v[104:107], v[92:95], v[172:175]
v_mfma_f32_16x16x32_bf16 v[220:223], v[116:119], v[92:95], v[220:223]
v_mfma_f32_16x16x32_bf16 v[216:219], v[116:119], v[88:91], v[216:219]
v_mfma_f32_16x16x32_bf16 v[212:215], v[116:119], v[84:87], v[212:215]
v_mfma_f32_16x16x32_bf16 v[208:211], v[116:119], v[80:83], v[208:211]
s_waitcnt lgkmcnt(0)
v_mfma_f32_16x16x32_bf16 v[128:131], v[48:51], v[32:35], v[128:131]
ds_read_b128 v[80:83], v3 offset:8192
v_mfma_f32_16x16x32_bf16 v[132:135], v[48:51], v[36:39], v[132:135]
ds_read_b64_tr_b16 v[96:97], v9 offset:24576
v_mfma_f32_16x16x32_bf16 v[136:139], v[48:51], v[40:43], v[136:139]
ds_read_b64_tr_b16 v[98:99], v9 offset:28672
v_mfma_f32_16x16x32_bf16 v[140:143], v[48:51], v[44:47], v[140:143]
ds_read_b128 v[84:87], v3 offset:8448
v_mfma_f32_16x16x32_bf16 v[188:191], v[60:63], v[44:47], v[188:191]
ds_read_b128 v[88:91], v3 offset:8704
v_mfma_f32_16x16x32_bf16 v[184:187], v[60:63], v[40:43], v[184:187]
ds_read_b128 v[92:95], v3 offset:8960
v_mfma_f32_16x16x32_bf16 v[180:183], v[60:63], v[36:39], v[180:183]
ds_read_b64_tr_b16 v[108:109], v9 offset:40960
v_mfma_f32_16x16x32_bf16 v[176:179], v[60:63], v[32:35], v[176:179]
ds_read_b64_tr_b16 v[110:111], v9 offset:45056
v_mfma_f32_16x16x32_bf16 v[144:147], v[52:55], v[32:35], v[144:147]
ds_read_b64_tr_b16 v[100:101], v10 offset:24576
v_mfma_f32_16x16x32_bf16 v[148:151], v[52:55], v[36:39], v[148:151]
ds_read_b64_tr_b16 v[102:103], v10 offset:28672
v_mfma_f32_16x16x32_bf16 v[152:155], v[52:55], v[40:43], v[152:155]
ds_read_b64_tr_b16 v[112:113], v10 offset:40960
v_mfma_f32_16x16x32_bf16 v[156:159], v[52:55], v[44:47], v[156:159]
ds_read_b64_tr_b16 v[114:115], v10 offset:45056
v_mfma_f32_16x16x32_bf16 v[204:207], v[64:67], v[44:47], v[204:207]
ds_read_b64_tr_b16 v[104:105], v11 offset:24576
v_mfma_f32_16x16x32_bf16 v[200:203], v[64:67], v[40:43], v[200:203]
ds_read_b64_tr_b16 v[106:107], v11 offset:28672
v_mfma_f32_16x16x32_bf16 v[196:199], v[64:67], v[36:39], v[196:199]
ds_read_b64_tr_b16 v[116:117], v11 offset:40960
v_mfma_f32_16x16x32_bf16 v[192:195], v[64:67], v[32:35], v[192:195]
ds_read_b64_tr_b16 v[118:119], v11 offset:45056
v_mfma_f32_16x16x32_bf16 v[160:163], v[56:59], v[32:35], v[160:163]
v_mfma_f32_16x16x32_bf16 v[164:167], v[56:59], v[36:39], v[164:167]
v_mfma_f32_16x16x32_bf16 v[168:171], v[56:59], v[40:43], v[168:171]
v_mfma_f32_16x16x32_bf16 v[172:175], v[56:59], v[44:47], v[172:175]
v_mfma_f32_16x16x32_bf16 v[220:223], v[68:71], v[44:47], v[220:223]
v_mfma_f32_16x16x32_bf16 v[216:219], v[68:71], v[40:43], v[216:219]
v_mfma_f32_16x16x32_bf16 v[212:215], v[68:71], v[36:39], v[212:215]
v_mfma_f32_16x16x32_bf16 v[208:211], v[68:71], v[32:35], v[208:211]
s_waitcnt lgkmcnt(0)
s_barrier
v_mfma_f32_16x16x32_bf16 v[128:131], v[96:99], v[80:83], v[128:131]
ds_read_b128 v[32:35], v4 offset:0
v_mfma_f32_16x16x32_bf16 v[132:135], v[96:99], v[84:87], v[132:135]
ds_read_b64_tr_b16 v[48:49], v13 offset:16384
v_mfma_f32_16x16x32_bf16 v[136:139], v[96:99], v[88:91], v[136:139]
ds_read_b64_tr_b16 v[50:51], v13 offset:20480
v_mfma_f32_16x16x32_bf16 v[140:143], v[96:99], v[92:95], v[140:143]
ds_read_b128 v[36:39], v4 offset:256
v_mfma_f32_16x16x32_bf16 v[188:191], v[108:111], v[92:95], v[188:191]
ds_read_b128 v[40:43], v4 offset:512
v_mfma_f32_16x16x32_bf16 v[184:187], v[108:111], v[88:91], v[184:187]
ds_read_b128 v[44:47], v4 offset:768
v_mfma_f32_16x16x32_bf16 v[180:183], v[108:111], v[84:87], v[180:183]
ds_read_b64_tr_b16 v[60:61], v13 offset:32768
v_mfma_f32_16x16x32_bf16 v[176:179], v[108:111], v[80:83], v[176:179]
ds_read_b64_tr_b16 v[62:63], v13 offset:36864
v_mfma_f32_16x16x32_bf16 v[144:147], v[100:103], v[80:83], v[144:147]
ds_read_b64_tr_b16 v[52:53], v14 offset:16384
v_mfma_f32_16x16x32_bf16 v[148:151], v[100:103], v[84:87], v[148:151]
ds_read_b64_tr_b16 v[54:55], v14 offset:20480
v_mfma_f32_16x16x32_bf16 v[152:155], v[100:103], v[88:91], v[152:155]
ds_read_b64_tr_b16 v[64:65], v14 offset:32768
v_mfma_f32_16x16x32_bf16 v[156:159], v[100:103], v[92:95], v[156:159]
ds_read_b64_tr_b16 v[66:67], v14 offset:36864
v_mfma_f32_16x16x32_bf16 v[204:207], v[112:115], v[92:95], v[204:207]
ds_read_b64_tr_b16 v[56:57], v15 offset:16384
v_mfma_f32_16x16x32_bf16 v[200:203], v[112:115], v[88:91], v[200:203]
ds_read_b64_tr_b16 v[58:59], v15 offset:20480
v_mfma_f32_16x16x32_bf16 v[196:199], v[112:115], v[84:87], v[196:199]
ds_read_b64_tr_b16 v[68:69], v15 offset:32768
v_mfma_f32_16x16x32_bf16 v[192:195], v[112:115], v[80:83], v[192:195]
ds_read_b64_tr_b16 v[70:71], v15 offset:36864
v_mfma_f32_16x16x32_bf16 v[160:163], v[104:107], v[80:83], v[160:163]
v_mfma_f32_16x16x32_bf16 v[164:167], v[104:107], v[84:87], v[164:167]
v_mfma_f32_16x16x32_bf16 v[168:171], v[104:107], v[88:91], v[168:171]
v_mfma_f32_16x16x32_bf16 v[172:175], v[104:107], v[92:95], v[172:175]
v_mfma_f32_16x16x32_bf16 v[220:223], v[116:119], v[92:95], v[220:223]
v_mfma_f32_16x16x32_bf16 v[216:219], v[116:119], v[88:91], v[216:219]
v_mfma_f32_16x16x32_bf16 v[212:215], v[116:119], v[84:87], v[212:215]
v_mfma_f32_16x16x32_bf16 v[208:211], v[116:119], v[80:83], v[208:211]
s_waitcnt lgkmcnt(0)
v_mfma_f32_16x16x32_bf16 v[128:131], v[48:51], v[32:35], v[128:131]
ds_read_b128 v[80:83], v4 offset:8192
v_mfma_f32_16x16x32_bf16 v[132:135], v[48:51], v[36:39], v[132:135]
ds_read_b64_tr_b16 v[96:97], v13 offset:24576
v_mfma_f32_16x16x32_bf16 v[136:139], v[48:51], v[40:43], v[136:139]
ds_read_b64_tr_b16 v[98:99], v13 offset:28672
v_mfma_f32_16x16x32_bf16 v[140:143], v[48:51], v[44:47], v[140:143]
ds_read_b128 v[84:87], v4 offset:8448
v_mfma_f32_16x16x32_bf16 v[188:191], v[60:63], v[44:47], v[188:191]
ds_read_b128 v[88:91], v4 offset:8704
v_mfma_f32_16x16x32_bf16 v[184:187], v[60:63], v[40:43], v[184:187]
ds_read_b128 v[92:95], v4 offset:8960
v_mfma_f32_16x16x32_bf16 v[180:183], v[60:63], v[36:39], v[180:183]
ds_read_b64_tr_b16 v[108:109], v13 offset:40960
v_mfma_f32_16x16x32_bf16 v[176:179], v[60:63], v[32:35], v[176:179]
ds_read_b64_tr_b16 v[110:111], v13 offset:45056
v_mfma_f32_16x16x32_bf16 v[144:147], v[52:55], v[32:35], v[144:147]
ds_read_b64_tr_b16 v[100:101], v14 offset:24576
v_mfma_f32_16x16x32_bf16 v[148:151], v[52:55], v[36:39], v[148:151]
ds_read_b64_tr_b16 v[102:103], v14 offset:28672
v_mfma_f32_16x16x32_bf16 v[152:155], v[52:55], v[40:43], v[152:155]
ds_read_b64_tr_b16 v[112:113], v14 offset:40960
v_mfma_f32_16x16x32_bf16 v[156:159], v[52:55], v[44:47], v[156:159]
ds_read_b64_tr_b16 v[114:115], v14 offset:45056
v_mfma_f32_16x16x32_bf16 v[204:207], v[64:67], v[44:47], v[204:207]
ds_read_b64_tr_b16 v[104:105], v15 offset:24576
v_mfma_f32_16x16x32_bf16 v[200:203], v[64:67], v[40:43], v[200:203]
ds_read_b64_tr_b16 v[106:107], v15 offset:28672
v_mfma_f32_16x16x32_bf16 v[196:199], v[64:67], v[36:39], v[196:199]
ds_read_b64_tr_b16 v[116:117], v15 offset:40960
v_mfma_f32_16x16x32_bf16 v[192:195], v[64:67], v[32:35], v[192:195]
ds_read_b64_tr_b16 v[118:119], v15 offset:45056
v_mfma_f32_16x16x32_bf16 v[160:163], v[56:59], v[32:35], v[160:163]
v_mfma_f32_16x16x32_bf16 v[164:167], v[56:59], v[36:39], v[164:167]
v_mfma_f32_16x16x32_bf16 v[168:171], v[56:59], v[40:43], v[168:171]
v_mfma_f32_16x16x32_bf16 v[172:175], v[56:59], v[44:47], v[172:175]
v_mfma_f32_16x16x32_bf16 v[220:223], v[68:71], v[44:47], v[220:223]
v_mfma_f32_16x16x32_bf16 v[216:219], v[68:71], v[40:43], v[216:219]
v_mfma_f32_16x16x32_bf16 v[212:215], v[68:71], v[36:39], v[212:215]
v_mfma_f32_16x16x32_bf16 v[208:211], v[68:71], v[32:35], v[208:211]
s_waitcnt lgkmcnt(0)
s_barrier
v_mfma_f32_16x16x32_bf16 v[128:131], v[96:99], v[80:83], v[128:131]
ds_read_b128 v[32:35], v2 offset:0
v_mfma_f32_16x16x32_bf16 v[132:135], v[96:99], v[84:87], v[132:135]
ds_read_b64_tr_b16 v[48:49], v5 offset:16384
v_mfma_f32_16x16x32_bf16 v[136:139], v[96:99], v[88:91], v[136:139]
ds_read_b64_tr_b16 v[50:51], v5 offset:20480
v_mfma_f32_16x16x32_bf16 v[140:143], v[96:99], v[92:95], v[140:143]
ds_read_b128 v[36:39], v2 offset:256
v_mfma_f32_16x16x32_bf16 v[188:191], v[108:111], v[92:95], v[188:191]
ds_read_b128 v[40:43], v2 offset:512
v_mfma_f32_16x16x32_bf16 v[184:187], v[108:111], v[88:91], v[184:187]
ds_read_b128 v[44:47], v2 offset:768
v_mfma_f32_16x16x32_bf16 v[180:183], v[108:111], v[84:87], v[180:183]
ds_read_b64_tr_b16 v[60:61], v5 offset:32768
v_mfma_f32_16x16x32_bf16 v[176:179], v[108:111], v[80:83], v[176:179]
ds_read_b64_tr_b16 v[62:63], v5 offset:36864
v_mfma_f32_16x16x32_bf16 v[144:147], v[100:103], v[80:83], v[144:147]
ds_read_b64_tr_b16 v[52:53], v6 offset:16384
v_mfma_f32_16x16x32_bf16 v[148:151], v[100:103], v[84:87], v[148:151]
ds_read_b64_tr_b16 v[54:55], v6 offset:20480
v_mfma_f32_16x16x32_bf16 v[152:155], v[100:103], v[88:91], v[152:155]
ds_read_b64_tr_b16 v[64:65], v6 offset:32768
v_mfma_f32_16x16x32_bf16 v[156:159], v[100:103], v[92:95], v[156:159]
ds_read_b64_tr_b16 v[66:67], v6 offset:36864
v_mfma_f32_16x16x32_bf16 v[204:207], v[112:115], v[92:95], v[204:207]
ds_read_b64_tr_b16 v[56:57], v7 offset:16384
v_mfma_f32_16x16x32_bf16 v[200:203], v[112:115], v[88:91], v[200:203]
ds_read_b64_tr_b16 v[58:59], v7 offset:20480
v_mfma_f32_16x16x32_bf16 v[196:199], v[112:115], v[84:87], v[196:199]
ds_read_b64_tr_b16 v[68:69], v7 offset:32768
v_mfma_f32_16x16x32_bf16 v[192:195], v[112:115], v[80:83], v[192:195]
ds_read_b64_tr_b16 v[70:71], v7 offset:36864
v_mfma_f32_16x16x32_bf16 v[160:163], v[104:107], v[80:83], v[160:163]
v_mfma_f32_16x16x32_bf16 v[164:167], v[104:107], v[84:87], v[164:167]
v_mfma_f32_16x16x32_bf16 v[168:171], v[104:107], v[88:91], v[168:171]
v_mfma_f32_16x16x32_bf16 v[172:175], v[104:107], v[92:95], v[172:175]
v_mfma_f32_16x16x32_bf16 v[220:223], v[116:119], v[92:95], v[220:223]
v_mfma_f32_16x16x32_bf16 v[216:219], v[116:119], v[88:91], v[216:219]
v_mfma_f32_16x16x32_bf16 v[212:215], v[116:119], v[84:87], v[212:215]
v_mfma_f32_16x16x32_bf16 v[208:211], v[116:119], v[80:83], v[208:211]
s_sub_u32 s41, s41, 1
s_cmp_lg_u32 s41, 0
s_cbranch_scc1 Lk3_47
s_waitcnt lgkmcnt(0)
v_mfma_f32_16x16x32_bf16 v[128:131], v[48:51], v[32:35], v[128:131]
ds_read_b128 v[80:83], v2 offset:8192
v_mfma_f32_16x16x32_bf16 v[132:135], v[48:51], v[36:39], v[132:135]
ds_read_b64_tr_b16 v[96:97], v5 offset:24576
v_mfma_f32_16x16x32_bf16 v[136:139], v[48:51], v[40:43], v[136:139]
ds_read_b64_tr_b16 v[98:99], v5 offset:28672
v_mfma_f32_16x16x32_bf16 v[140:143], v[48:51], v[44:47], v[140:143]
ds_read_b128 v[84:87], v2 offset:8448
v_mfma_f32_16x16x32_bf16 v[188:191], v[60:63], v[44:47], v[188:191]
ds_read_b128 v[88:91], v2 offset:8704
v_mfma_f32_16x16x32_bf16 v[184:187], v[60:63], v[40:43], v[184:187]
ds_read_b128 v[92:95], v2 offset:8960
v_mfma_f32_16x16x32_bf16 v[180:183], v[60:63], v[36:39], v[180:183]
ds_read_b64_tr_b16 v[108:109], v5 offset:40960
v_mfma_f32_16x16x32_bf16 v[176:179], v[60:63], v[32:35], v[176:179]
ds_read_b64_tr_b16 v[110:111], v5 offset:45056
v_mfma_f32_16x16x32_bf16 v[144:147], v[52:55], v[32:35], v[144:147]
ds_read_b64_tr_b16 v[100:101], v6 offset:24576
v_mfma_f32_16x16x32_bf16 v[148:151], v[52:55], v[36:39], v[148:151]
ds_read_b64_tr_b16 v[102:103], v6 offset:28672
v_mfma_f32_16x16x32_bf16 v[152:155], v[52:55], v[40:43], v[152:155]
ds_read_b64_tr_b16 v[112:113], v6 offset:40960
v_mfma_f32_16x16x32_bf16 v[156:159], v[52:55], v[44:47], v[156:159]
ds_read_b64_tr_b16 v[114:115], v6 offset:45056
v_mfma_f32_16x16x32_bf16 v[204:207], v[64:67], v[44:47], v[204:207]
ds_read_b64_tr_b16 v[104:105], v7 offset:24576
v_mfma_f32_16x16x32_bf16 v[200:203], v[64:67], v[40:43], v[200:203]
ds_read_b64_tr_b16 v[106:107], v7 offset:28672
v_mfma_f32_16x16x32_bf16 v[196:199], v[64:67], v[36:39], v[196:199]
ds_read_b64_tr_b16 v[116:117], v7 offset:40960
v_mfma_f32_16x16x32_bf16 v[192:195], v[64:67], v[32:35], v[192:195]
ds_read_b64_tr_b16 v[118:119], v7 offset:45056
v_mfma_f32_16x16x32_bf16 v[160:163], v[56:59], v[32:35], v[160:163]
v_mfma_f32_16x16x32_bf16 v[164:167], v[56:59], v[36:39], v[164:167]
v_mfma_f32_16x16x32_bf16 v[168:171], v[56:59], v[40:43], v[168:171]
v_mfma_f32_16x16x32_bf16 v[172:175], v[56:59], v[44:47], v[172:175]
v_mfma_f32_16x16x32_bf16 v[220:223], v[68:71], v[44:47], v[220:223]
v_mfma_f32_16x16x32_bf16 v[216:219], v[68:71], v[40:43], v[216:219]
v_mfma_f32_16x16x32_bf16 v[212:215], v[68:71], v[36:39], v[212:215]
v_mfma_f32_16x16x32_bf16 v[208:211], v[68:71], v[32:35], v[208:211]
s_waitcnt lgkmcnt(0)
s_barrier
s_cmp_eq_u32 s36, 7
s_cbranch_scc1 L7b_48
s_add_u32 m0, s39, 0
s_add_u32 s37, s37, s40
buffer_load_dwordx4 v21, s[8:11], s37 offen sc1 lds
v_mfma_f32_16x16x32_bf16 v[128:131], v[96:99], v[80:83], v[128:131]
v_mfma_f32_16x16x32_bf16 v[132:135], v[96:99], v[84:87], v[132:135]
s_add_u32 m0, s39, 1024
s_add_u32 s37, s37, s38
buffer_load_dwordx4 v21, s[8:11], s37 offen sc1 lds
v_mfma_f32_16x16x32_bf16 v[136:139], v[96:99], v[88:91], v[136:139]
s_add_u32 m0, s39, 2048
s_add_u32 s37, s37, s38
buffer_load_dwordx4 v21, s[8:11], s37 offen sc1 lds
v_mfma_f32_16x16x32_bf16 v[140:143], v[96:99], v[92:95], v[140:143]
v_mfma_f32_16x16x32_bf16 v[188:191], v[108:111], v[92:95], v[188:191]
s_add_u32 m0, s39, 3072
s_add_u32 s37, s37, s38
buffer_load_dwordx4 v21, s[8:11], s37 offen sc1 lds
v_mfma_f32_16x16x32_bf16 v[184:187], v[108:111], v[88:91], v[184:187]
s_add_u32 m0, s39, 4096
s_add_u32 s37, s37, s55
buffer_load_dwordx4 v21, s[8:11], s37 offen sc1 lds
v_mfma_f32_16x16x32_bf16 v[180:183], v[108:111], v[84:87], v[180:183]
v_mfma_f32_16x16x32_bf16 v[176:179], v[108:111], v[80:83], v[176:179]
s_add_u32 m0, s39, 5120
s_add_u32 s37, s37, s38
buffer_load_dwordx4 v21, s[8:11], s37 offen sc1 lds
v_mfma_f32_16x16x32_bf16 v[144:147], v[100:103], v[80:83], v[144:147]
s_add_u32 m0, s39, 6144
s_add_u32 s37, s37, s38
buffer_load_dwordx4 v21, s[8:11], s37 offen sc1 lds
v_mfma_f32_16x16x32_bf16 v[148:151], v[100:103], v[84:87], v[148:151]
v_mfma_f32_16x16x32_bf16 v[152:155], v[100:103], v[88:91], v[152:155]
s_add_u32 m0, s39, 7168
s_add_u32 s37, s37, s38
buffer_load_dwordx4 v21, s[8:11], s37 offen sc1 lds
v_mfma_f32_16x16x32_bf16 v[156:159], v[100:103], v[92:95], v[156:159]
s_add_u32 m0, s39, 32768
s_add_u32 s37, s37, s40
buffer_load_dwordx4 v21, s[8:11], s37 offen sc1 lds
v_mfma_f32_16x16x32_bf16 v[204:207], v[112:115], v[92:95], v[204:207]
v_mfma_f32_16x16x32_bf16 v[200:203], v[112:115], v[88:91], v[200:203]
s_add_u32 m0, s39, 33792
s_add_u32 s37, s37, s38
buffer_load_dwordx4 v21, s[8:11], s37 offen sc1 lds
v_mfma_f32_16x16x32_bf16 v[196:199], v[112:115], v[84:87], v[196:199]
s_add_u32 m0, s39, 34816
s_add_u32 s37, s37, s38
buffer_load_dwordx4 v21, s[8:11], s37 offen sc1 lds
v_mfma_f32_16x16x32_bf16 v[192:195], v[112:115], v[80:83], v[192:195]
v_mfma_f32_16x16x32_bf16 v[160:163], v[104:107], v[80:83], v[160:163]
s_add_u32 m0, s39, 35840
s_add_u32 s37, s37, s38
buffer_load_dwordx4 v21, s[8:11], s37 offen sc1 lds
v_mfma_f32_16x16x32_bf16 v[164:167], v[104:107], v[84:87], v[164:167]
s_add_u32 m0, s39, 36864
s_add_u32 s37, s37, s55
buffer_load_dwordx4 v21, s[8:11], s37 offen sc1 lds
v_mfma_f32_16x16x32_bf16 v[168:171], v[104:107], v[88:91], v[168:171]
v_mfma_f32_16x16x32_bf16 v[172:175], v[104:107], v[92:95], v[172:175]
s_add_u32 m0, s39, 37888
s_add_u32 s37, s37, s38
buffer_load_dwordx4 v21, s[8:11], s37 offen sc1 lds
v_mfma_f32_16x16x32_bf16 v[220:223], v[116:119], v[92:95], v[220:223]
s_add_u32 m0, s39, 38912
s_add_u32 s37, s37, s38
buffer_load_dwordx4 v21, s[8:11], s37 offen sc1 lds
v_mfma_f32_16x16x32_bf16 v[216:219], v[116:119], v[88:91], v[216:219]
v_mfma_f32_16x16x32_bf16 v[212:215], v[116:119], v[84:87], v[212:215]
s_add_u32 m0, s39, 39936
s_add_u32 s37, s37, s38
buffer_load_dwordx4 v21, s[8:11], s37 offen sc1 lds
v_mfma_f32_16x16x32_bf16 v[208:211], v[116:119], v[80:83], v[208:211]
s_setprio 0
s_barrier
s_add_u32 s37, s37, s54
s_add_u32 m0, s39, 65536
s_add_u32 s37, s37, s40
buffer_load_dwordx4 v21, s[8:11], s37 offen sc1 lds
v_mul_f32 v80, v128, v128
v_mul_f32 v81, v129, v129
v_mul_f32 v82, v130, v130
v_mul_f32 v83, v131, v131
v_fma_f32 v80, v80, v232, v228
v_fma_f32 v81, v81, v232, v228
v_fma_f32 v82, v82, v232, v228
s_add_u32 m0, s39, 66560
s_add_u32 s37, s37, s38
buffer_load_dwordx4 v21, s[8:11], s37 offen sc1 lds
v_fma_f32 v83, v83, v232, v228
v_mul_f32 v80, v80, v128
v_mul_f32 v81, v81, v129
v_mul_f32 v82, v82, v130
v_mul_f32 v83, v83, v131
v_exp_f32 v80, v80
s_add_u32 m0, s39, 67584
s_add_u32 s37, s37, s38
buffer_load_dwordx4 v21, s[8:11], s37 offen sc1 lds
v_exp_f32 v81, v81
v_exp_f32 v82, v82
v_exp_f32 v83, v83
v_mul_f32 v176, v128, v176
v_mul_f32 v177, v129, v177
v_mul_f32 v178, v130, v178
v_mul_f32 v179, v131, v179
s_add_u32 m0, s39, 68608
s_add_u32 s37, s37, s38
buffer_load_dwordx4 v21, s[8:11], s37 offen sc1 lds
v_fma_f32 v80, v80, v236, v236
v_fma_f32 v81, v81, v236, v236
v_fma_f32 v82, v82, v236, v236
v_fma_f32 v83, v83, v236, v236
v_rcp_f32 v80, v80
v_rcp_f32 v81, v81
s_add_u32 m0, s39, 69632
s_add_u32 s37, s37, s55
buffer_load_dwordx4 v21, s[8:11], s37 offen sc1 lds
v_rcp_f32 v82, v82
v_rcp_f32 v83, v83
v_mul_f32 v176, v176, v80
v_mul_f32 v177, v177, v81
v_mul_f32 v178, v178, v82
v_mul_f32 v179, v179, v83
v_cvt_pk_bf16_f32 v96, v176, v177
s_add_u32 m0, s39, 70656
s_add_u32 s37, s37, s38
buffer_load_dwordx4 v21, s[8:11], s37 offen sc1 lds
v_cvt_pk_bf16_f32 v97, v178, v179
v_mul_f32 v84, v144, v144
v_mul_f32 v85, v145, v145
v_mul_f32 v86, v146, v146
v_mul_f32 v87, v147, v147
v_fma_f32 v84, v84, v232, v228
s_add_u32 m0, s39, 71680
s_add_u32 s37, s37, s38
buffer_load_dwordx4 v21, s[8:11], s37 offen sc1 lds
v_fma_f32 v85, v85, v232, v228
v_fma_f32 v86, v86, v232, v228
v_fma_f32 v87, v87, v232, v228
v_mul_f32 v84, v84, v144
v_mul_f32 v85, v85, v145
v_mul_f32 v86, v86, v146
v_mul_f32 v87, v87, v147
s_add_u32 m0, s39, 72704
s_add_u32 s37, s37, s38
buffer_load_dwordx4 v21, s[8:11], s37 offen sc1 lds
v_exp_f32 v84, v84
v_exp_f32 v85, v85
v_exp_f32 v86, v86
v_exp_f32 v87, v87
v_mul_f32 v192, v144, v192
v_mul_f32 v193, v145, v193
s_waitcnt vmcnt(16)
s_barrier
s_add_u32 m0, s39, 98304
s_add_u32 s37, s37, s40
buffer_load_dwordx4 v21, s[8:11], s37 offen sc1 lds
v_mul_f32 v194, v146, v194
v_mul_f32 v195, v147, v195
v_fma_f32 v84, v84, v236, v236
v_fma_f32 v85, v85, v236, v236
v_fma_f32 v86, v86, v236, v236
v_fma_f32 v87, v87, v236, v236
v_rcp_f32 v84, v84
s_add_u32 m0, s39, 99328
s_add_u32 s37, s37, s38
buffer_load_dwordx4 v21, s[8:11], s37 offen sc1 lds
v_rcp_f32 v85, v85
v_rcp_f32 v86, v86
v_rcp_f32 v87, v87
v_mul_f32 v192, v192, v84
v_mul_f32 v193, v193, v85
v_mul_f32 v194, v194, v86
v_mul_f32 v195, v195, v87
s_add_u32 m0, s39, 100352
s_add_u32 s37, s37, s38
buffer_load_dwordx4 v21, s[8:11], s37 offen sc1 lds
v_cvt_pk_bf16_f32 v98, v192, v193
v_cvt_pk_bf16_f32 v99, v194, v195
v_mul_f32 v80, v160, v160
v_mul_f32 v81, v161, v161
v_mul_f32 v82, v162, v162
s_add_u32 m0, s39, 101376
s_add_u32 s37, s37, s38
buffer_load_dwordx4 v21, s[8:11], s37 offen sc1 lds
v_mul_f32 v83, v163, v163
v_fma_f32 v80, v80, v232, v228
v_fma_f32 v81, v81, v232, v228
v_fma_f32 v82, v82, v232, v228
v_fma_f32 v83, v83, v232, v228
v_mul_f32 v80, v80, v160
v_mul_f32 v81, v81, v161
s_add_u32 m0, s39, 102400
s_add_u32 s37, s37, s55
buffer_load_dwordx4 v21, s[8:11], s37 offen sc1 lds
v_mul_f32 v82, v82, v162
v_mul_f32 v83, v83, v163
v_exp_f32 v80, v80
v_exp_f32 v81, v81
v_exp_f32 v82, v82
v_exp_f32 v83, v83
v_mul_f32 v208, v160, v208
s_add_u32 m0, s39, 103424
s_add_u32 s37, s37, s38
buffer_load_dwordx4 v21, s[8:11], s37 offen sc1 lds
v_mul_f32 v209, v161, v209
v_mul_f32 v210, v162, v210
v_mul_f32 v211, v163, v211
v_fma_f32 v80, v80, v236, v236
v_fma_f32 v81, v81, v236, v236
v_fma_f32 v82, v82, v236, v236
s_add_u32 m0, s39, 104448
s_add_u32 s37, s37, s38
buffer_load_dwordx4 v21, s[8:11], s37 offen sc1 lds
v_fma_f32 v83, v83, v236, v236
v_rcp_f32 v80, v80
v_rcp_f32 v81, v81
v_rcp_f32 v82, v82
v_rcp_f32 v83, v83
v_mul_f32 v208, v208, v80
v_mul_f32 v209, v209, v81
s_add_u32 m0, s39, 105472
s_add_u32 s37, s37, s38
buffer_load_dwordx4 v21, s[8:11], s37 offen sc1 lds
v_mul_f32 v210, v210, v82
v_mul_f32 v211, v211, v83
v_cvt_pk_bf16_f32 v112, v208, v209
v_cvt_pk_bf16_f32 v113, v210, v211
v_mul_f32 v80, v132, v132
v_mul_f32 v81, v133, v133
buffer_store_dwordx4 v[96:99], v27, s[24:27], 0 offen offset:0 sc1
s_waitcnt vmcnt(17)
s_barrier
s_add_u32 m0, s39, 0
s_add_u32 s37, s37, s40
buffer_load_dwordx4 v21, s[8:11], s37 offen sc1 lds
v_mul_f32 v82, v134, v134
v_mul_f32 v83, v135, v135
v_fma_f32 v80, v80, v233, v229
v_fma_f32 v81, v81, v233, v229
v_fma_f32 v82, v82, v233, v229
v_fma_f32 v83, v83, v233, v229
v_mul_f32 v80, v80, v132
s_add_u32 m0, s39, 1024
s_add_u32 s37, s37, s38
buffer_load_dwordx4 v21, s[8:11], s37 offen sc1 lds
v_mul_f32 v81, v81, v133
v_mul_f32 v82, v82, v134
v_mul_f32 v83, v83, v135
v_exp_f32 v80, v80
v_exp_f32 v81, v81
v_exp_f32 v82, v82
s_add_u32 m0, s39, 2048
s_add_u32 s37, s37, s38
buffer_load_dwordx4 v21, s[8:11], s37 offen sc1 lds
v_exp_f32 v83, v83
v_mul_f32 v180, v132, v180
v_mul_f32 v181, v133, v181
v_mul_f32 v182, v134, v182
v_mul_f32 v183, v135, v183
v_fma_f32 v80, v80, v237, v237
v_fma_f32 v81, v81, v237, v237
s_add_u32 m0, s39, 3072
s_add_u32 s37, s37, s38
buffer_load_dwordx4 v21, s[8:11], s37 offen sc1 lds
v_fma_f32 v82, v82, v237, v237
v_fma_f32 v83, v83, v237, v237
v_rcp_f32 v80, v80
v_rcp_f32 v81, v81
v_rcp_f32 v82, v82
v_rcp_f32 v83, v83
s_add_u32 m0, s39, 4096
s_add_u32 s37, s37, s55
buffer_load_dwordx4 v21, s[8:11], s37 offen sc1 lds
v_mul_f32 v180, v180, v80
v_mul_f32 v181, v181, v81
v_mul_f32 v182, v182, v82
v_mul_f32 v183, v183, v83
v_cvt_pk_bf16_f32 v100, v180, v181
v_cvt_pk_bf16_f32 v101, v182, v183
v_mul_f32 v84, v148, v148
s_add_u32 m0, s39, 5120
s_add_u32 s37, s37, s38
buffer_load_dwordx4 v21, s[8:11], s37 offen sc1 lds
v_mul_f32 v85, v149, v149
v_mul_f32 v86, v150, v150
v_mul_f32 v87, v151, v151
v_fma_f32 v84, v84, v233, v229
v_fma_f32 v85, v85, v233, v229
v_fma_f32 v86, v86, v233, v229
s_add_u32 m0, s39, 6144
s_add_u32 s37, s37, s38
buffer_load_dwordx4 v21, s[8:11], s37 offen sc1 lds
v_fma_f32 v87, v87, v233, v229
v_mul_f32 v84, v84, v148
v_mul_f32 v85, v85, v149
v_mul_f32 v86, v86, v150
v_mul_f32 v87, v87, v151
v_exp_f32 v84, v84
v_exp_f32 v85, v85
s_add_u32 m0, s39, 7168
s_add_u32 s37, s37, s38
buffer_load_dwordx4 v21, s[8:11], s37 offen sc1 lds
v_exp_f32 v86, v86
v_exp_f32 v87, v87
v_mul_f32 v196, v148, v196
v_mul_f32 v197, v149, v197
v_mul_f32 v198, v150, v198
v_mul_f32 v199, v151, v199
s_waitcnt vmcnt(17)
s_barrier
s_add_u32 m0, s39, 32768
s_add_u32 s37, s37, s40
buffer_load_dwordx4 v21, s[8:11], s37 offen sc1 lds
v_fma_f32 v84, v84, v237, v237
v_fma_f32 v85, v85, v237, v237
v_fma_f32 v86, v86, v237, v237
v_fma_f32 v87, v87, v237, v237
v_rcp_f32 v84, v84
v_rcp_f32 v85, v85
v_rcp_f32 v86, v86
s_add_u32 m0, s39, 33792
s_add_u32 s37, s37, s38
buffer_load_dwordx4 v21, s[8:11], s37 offen sc1 lds
v_rcp_f32 v87, v87
v_mul_f32 v196, v196, v84
v_mul_f32 v197, v197, v85
v_mul_f32 v198, v198, v86
v_mul_f32 v199, v199, v87
v_cvt_pk_bf16_f32 v102, v196, v197
v_cvt_pk_bf16_f32 v103, v198, v199
s_add_u32 m0, s39, 34816
s_add_u32 s37, s37, s38
buffer_load_dwordx4 v21, s[8:11], s37 offen sc1 lds
v_mul_f32 v80, v164, v164
v_mul_f32 v81, v165, v165
v_mul_f32 v82, v166, v166
v_mul_f32 v83, v167, v167
v_fma_f32 v80, v80, v233, v229
s_add_u32 m0, s39, 35840
s_add_u32 s37, s37, s38
buffer_load_dwordx4 v21, s[8:11], s37 offen sc1 lds
v_fma_f32 v81, v81, v233, v229
v_fma_f32 v82, v82, v233, v229
v_fma_f32 v83, v83, v233, v229
v_mul_f32 v80, v80, v164
v_mul_f32 v81, v81, v165
v_mul_f32 v82, v82, v166
v_mul_f32 v83, v83, v167
s_add_u32 m0, s39, 36864
s_add_u32 s37, s37, s55
buffer_load_dwordx4 v21, s[8:11], s37 offen sc1 lds
v_exp_f32 v80, v80
v_exp_f32 v81, v81
v_exp_f32 v82, v82
v_exp_f32 v83, v83
v_mul_f32 v212, v164, v212
v_mul_f32 v213, v165, v213
v_mul_f32 v214, v166, v214
s_add_u32 m0, s39, 37888
s_add_u32 s37, s37, s38
buffer_load_dwordx4 v21, s[8:11], s37 offen sc1 lds
v_mul_f32 v215, v167, v215
v_fma_f32 v80, v80, v237, v237
v_fma_f32 v81, v81, v237, v237
v_fma_f32 v82, v82, v237, v237
v_fma_f32 v83, v83, v237, v237
v_rcp_f32 v80, v80
s_add_u32 m0, s39, 38912
s_add_u32 s37, s37, s38
buffer_load_dwordx4 v21, s[8:11], s37 offen sc1 lds
v_rcp_f32 v81, v81
v_rcp_f32 v82, v82
v_rcp_f32 v83, v83
v_mul_f32 v212, v212, v80
v_mul_f32 v213, v213, v81
v_mul_f32 v214, v214, v82
v_mul_f32 v215, v215, v83
s_add_u32 m0, s39, 39936
s_add_u32 s37, s37, s38
buffer_load_dwordx4 v21, s[8:11], s37 offen sc1 lds
v_cvt_pk_bf16_f32 v114, v212, v213
v_cvt_pk_bf16_f32 v115, v214, v215
s_nop 1
v_permlane32_swap_b32 v112, v114
v_permlane32_swap_b32 v113, v115
buffer_store_dwordx4 v[100:103], v27, s[24:27], 0 offen offset:256 sc1
buffer_store_dwordx4 v[112:115], v28, s[24:27], 0 offen offset:0 sc1
s_waitcnt vmcnt(19)
s_barrier
s_add_u32 m0, s39, 65536
s_add_u32 s37, s37, s40
buffer_load_dwordx4 v21, s[8:11], s37 offen sc1 lds
v_mul_f32 v80, v136, v136
v_mul_f32 v81, v137, v137
v_mul_f32 v82, v138, v138
v_mul_f32 v83, v139, v139
v_fma_f32 v80, v80, v234, v230
v_fma_f32 v81, v81, v234, v230
v_fma_f32 v82, v82, v234, v230
s_add_u32 m0, s39, 66560
s_add_u32 s37, s37, s38
buffer_load_dwordx4 v21, s[8:11], s37 offen sc1 lds
v_fma_f32 v83, v83, v234, v230
v_mul_f32 v80, v80, v136
v_mul_f32 v81, v81, v137
v_mul_f32 v82, v82, v138
v_mul_f32 v83, v83, v139
v_exp_f32 v80, v80
s_add_u32 m0, s39, 67584
s_add_u32 s37, s37, s38
buffer_load_dwordx4 v21, s[8:11], s37 offen sc1 lds
v_exp_f32 v81, v81
v_exp_f32 v82, v82
v_exp_f32 v83, v83
v_mul_f32 v184, v136, v184
v_mul_f32 v185, v137, v185
v_mul_f32 v186, v138, v186
v_mul_f32 v187, v139, v187
s_add_u32 m0, s39, 68608
s_add_u32 s37, s37, s38
buffer_load_dwordx4 v21, s[8:11], s37 offen sc1 lds
v_fma_f32 v80, v80, v238, v238
v_fma_f32 v81, v81, v238, v238
v_fma_f32 v82, v82, v238, v238
v_fma_f32 v83, v83, v238, v238
v_rcp_f32 v80, v80
v_rcp_f32 v81, v81
s_add_u32 m0, s39, 69632
s_add_u32 s37, s37, s55
buffer_load_dwordx4 v21, s[8:11], s37 offen sc1 lds
v_rcp_f32 v82, v82
v_rcp_f32 v83, v83
v_mul_f32 v184, v184, v80
v_mul_f32 v185, v185, v81
v_mul_f32 v186, v186, v82
v_mul_f32 v187, v187, v83
v_cvt_pk_bf16_f32 v104, v184, v185
s_add_u32 m0, s39, 70656
s_add_u32 s37, s37, s38
buffer_load_dwordx4 v21, s[8:11], s37 offen sc1 lds
v_cvt_pk_bf16_f32 v105, v186, v187
v_mul_f32 v84, v152, v152
v_mul_f32 v85, v153, v153
v_mul_f32 v86, v154, v154
v_mul_f32 v87, v155, v155
v_fma_f32 v84, v84, v234, v230
s_add_u32 m0, s39, 71680
s_add_u32 s37, s37, s38
buffer_load_dwordx4 v21, s[8:11], s37 offen sc1 lds
v_fma_f32 v85, v85, v234, v230
v_fma_f32 v86, v86, v234, v230
v_fma_f32 v87, v87, v234, v230
v_mul_f32 v84, v84, v152
v_mul_f32 v85, v85, v153
v_mul_f32 v86, v86, v154
v_mul_f32 v87, v87, v155
s_add_u32 m0, s39, 72704
s_add_u32 s37, s37, s38
buffer_load_dwordx4 v21, s[8:11], s37 offen sc1 lds
v_exp_f32 v84, v84
v_exp_f32 v85, v85
v_exp_f32 v86, v86
v_exp_f32 v87, v87
v_mul_f32 v200, v152, v200
v_mul_f32 v201, v153, v201
s_waitcnt vmcnt(18)
s_barrier
s_add_u32 m0, s39, 98304
s_add_u32 s37, s37, s40
buffer_load_dwordx4 v21, s[8:11], s37 offen sc1 lds
v_mul_f32 v202, v154, v202
v_mul_f32 v203, v155, v203
v_fma_f32 v84, v84, v238, v238
v_fma_f32 v85, v85, v238, v238
v_fma_f32 v86, v86, v238, v238
v_fma_f32 v87, v87, v238, v238
v_rcp_f32 v84, v84
s_add_u32 m0, s39, 99328
s_add_u32 s37, s37, s38
buffer_load_dwordx4 v21, s[8:11], s37 offen sc1 lds
v_rcp_f32 v85, v85
v_rcp_f32 v86, v86
v_rcp_f32 v87, v87
v_mul_f32 v200, v200, v84
v_mul_f32 v201, v201, v85
v_mul_f32 v202, v202, v86
v_mul_f32 v203, v203, v87
s_add_u32 m0, s39, 100352
s_add_u32 s37, s37, s38
buffer_load_dwordx4 v21, s[8:11], s37 offen sc1 lds
v_cvt_pk_bf16_f32 v106, v200, v201
v_cvt_pk_bf16_f32 v107, v202, v203
v_mul_f32 v80, v168, v168
v_mul_f32 v81, v169, v169
v_mul_f32 v82, v170, v170
s_add_u32 m0, s39, 101376
s_add_u32 s37, s37, s38
buffer_load_dwordx4 v21, s[8:11], s37 offen sc1 lds
v_mul_f32 v83, v171, v171
v_fma_f32 v80, v80, v234, v230
v_fma_f32 v81, v81, v234, v230
v_fma_f32 v82, v82, v234, v230
v_fma_f32 v83, v83, v234, v230
v_mul_f32 v80, v80, v168
v_mul_f32 v81, v81, v169
s_add_u32 m0, s39, 102400
s_add_u32 s37, s37, s55
buffer_load_dwordx4 v21, s[8:11], s37 offen sc1 lds
v_mul_f32 v82, v82, v170
v_mul_f32 v83, v83, v171
v_exp_f32 v80, v80
v_exp_f32 v81, v81
v_exp_f32 v82, v82
v_exp_f32 v83, v83
v_mul_f32 v216, v168, v216
s_add_u32 m0, s39, 103424
s_add_u32 s37, s37, s38
buffer_load_dwordx4 v21, s[8:11], s37 offen sc1 lds
v_mul_f32 v217, v169, v217
v_mul_f32 v218, v170, v218
v_mul_f32 v219, v171, v219
v_fma_f32 v80, v80, v238, v238
v_fma_f32 v81, v81, v238, v238
v_fma_f32 v82, v82, v238, v238
s_add_u32 m0, s39, 104448
s_add_u32 s37, s37, s38
buffer_load_dwordx4 v21, s[8:11], s37 offen sc1 lds
v_fma_f32 v83, v83, v238, v238
v_rcp_f32 v80, v80
v_rcp_f32 v81, v81
v_rcp_f32 v82, v82
v_rcp_f32 v83, v83
v_mul_f32 v216, v216, v80
v_mul_f32 v217, v217, v81
s_add_u32 m0, s39, 105472
s_add_u32 s37, s37, s38
buffer_load_dwordx4 v21, s[8:11], s37 offen sc1 lds
v_mul_f32 v218, v218, v82
v_mul_f32 v219, v219, v83
v_cvt_pk_bf16_f32 v116, v216, v217
v_cvt_pk_bf16_f32 v117, v218, v219
v_mul_f32 v80, v140, v140
v_mul_f32 v81, v141, v141
buffer_store_dwordx4 v[104:107], v27, s[24:27], 0 offen offset:512 sc1
s_waitcnt vmcnt(19)
s_barrier
s_add_u32 s37, s37, s29
s_add_u32 m0, s39, 0
s_add_u32 s37, s37, s40
buffer_load_dwordx4 v21, s[8:11], s37 offen sc1 lds
v_mul_f32 v82, v142, v142
v_mul_f32 v83, v143, v143
v_fma_f32 v80, v80, v235, v231
v_fma_f32 v81, v81, v235, v231
v_fma_f32 v82, v82, v235, v231
v_fma_f32 v83, v83, v235, v231
v_mul_f32 v80, v80, v140
s_add_u32 m0, s39, 1024
s_add_u32 s37, s37, s38
buffer_load_dwordx4 v21, s[8:11], s37 offen sc1 lds
v_mul_f32 v81, v81, v141
v_mul_f32 v82, v82, v142
v_mul_f32 v83, v83, v143
v_exp_f32 v80, v80
v_exp_f32 v81, v81
v_exp_f32 v82, v82
s_add_u32 m0, s39, 2048
s_add_u32 s37, s37, s38
buffer_load_dwordx4 v21, s[8:11], s37 offen sc1 lds
v_exp_f32 v83, v83
v_mul_f32 v188, v140, v188
v_mul_f32 v189, v141, v189
v_mul_f32 v190, v142, v190
v_mul_f32 v191, v143, v191
v_fma_f32 v80, v80, v239, v239
v_fma_f32 v81, v81, v239, v239
s_add_u32 m0, s39, 3072
s_add_u32 s37, s37, s38
buffer_load_dwordx4 v21, s[8:11], s37 offen sc1 lds
v_fma_f32 v82, v82, v239, v239
v_fma_f32 v83, v83, v239, v239
v_rcp_f32 v80, v80
v_rcp_f32 v81, v81
v_rcp_f32 v82, v82
v_rcp_f32 v83, v83
s_add_u32 m0, s39, 4096
s_add_u32 s37, s37, s55
buffer_load_dwordx4 v21, s[8:11], s37 offen sc1 lds
v_mul_f32 v188, v188, v80
v_mul_f32 v189, v189, v81
v_mul_f32 v190, v190, v82
v_mul_f32 v191, v191, v83
v_cvt_pk_bf16_f32 v108, v188, v189
v_cvt_pk_bf16_f32 v109, v190, v191
v_mul_f32 v84, v156, v156
s_add_u32 m0, s39, 5120
s_add_u32 s37, s37, s38
buffer_load_dwordx4 v21, s[8:11], s37 offen sc1 lds
v_mul_f32 v85, v157, v157
v_mul_f32 v86, v158, v158
v_mul_f32 v87, v159, v159
v_fma_f32 v84, v84, v235, v231
v_fma_f32 v85, v85, v235, v231
v_fma_f32 v86, v86, v235, v231
s_add_u32 m0, s39, 6144
s_add_u32 s37, s37, s38
buffer_load_dwordx4 v21, s[8:11], s37 offen sc1 lds
v_fma_f32 v87, v87, v235, v231
v_mul_f32 v84, v84, v156
v_mul_f32 v85, v85, v157
v_mul_f32 v86, v86, v158
v_mul_f32 v87, v87, v159
v_exp_f32 v84, v84
v_exp_f32 v85, v85
s_add_u32 m0, s39, 7168
s_add_u32 s37, s37, s38
buffer_load_dwordx4 v21, s[8:11], s37 offen sc1 lds
v_exp_f32 v86, v86
v_exp_f32 v87, v87
v_mul_f32 v204, v156, v204
v_mul_f32 v205, v157, v205
v_mul_f32 v206, v158, v206
v_mul_f32 v207, v159, v207
s_waitcnt vmcnt(17)
s_barrier
s_add_u32 m0, s39, 32768
s_add_u32 s37, s37, s40
buffer_load_dwordx4 v21, s[8:11], s37 offen sc1 lds
v_fma_f32 v84, v84, v239, v239
v_fma_f32 v85, v85, v239, v239
v_fma_f32 v86, v86, v239, v239
v_fma_f32 v87, v87, v239, v239
v_rcp_f32 v84, v84
v_rcp_f32 v85, v85
v_rcp_f32 v86, v86
s_add_u32 m0, s39, 33792
s_add_u32 s37, s37, s38
buffer_load_dwordx4 v21, s[8:11], s37 offen sc1 lds
v_rcp_f32 v87, v87
v_mul_f32 v204, v204, v84
v_mul_f32 v205, v205, v85
v_mul_f32 v206, v206, v86
v_mul_f32 v207, v207, v87
v_cvt_pk_bf16_f32 v110, v204, v205
v_cvt_pk_bf16_f32 v111, v206, v207
s_add_u32 m0, s39, 34816
s_add_u32 s37, s37, s38
buffer_load_dwordx4 v21, s[8:11], s37 offen sc1 lds
v_mul_f32 v80, v172, v172
v_mul_f32 v81, v173, v173
v_mul_f32 v82, v174, v174
v_mul_f32 v83, v175, v175
v_fma_f32 v80, v80, v235, v231
s_add_u32 m0, s39, 35840
s_add_u32 s37, s37, s38
buffer_load_dwordx4 v21, s[8:11], s37 offen sc1 lds
v_fma_f32 v81, v81, v235, v231
v_fma_f32 v82, v82, v235, v231
v_fma_f32 v83, v83, v235, v231
v_mul_f32 v80, v80, v172
v_mul_f32 v81, v81, v173
v_mul_f32 v82, v82, v174
v_mul_f32 v83, v83, v175
s_add_u32 m0, s39, 36864
s_add_u32 s37, s37, s55
buffer_load_dwordx4 v21, s[8:11], s37 offen sc1 lds
v_exp_f32 v80, v80
v_exp_f32 v81, v81
v_exp_f32 v82, v82
v_exp_f32 v83, v83
v_mul_f32 v220, v172, v220
v_mul_f32 v221, v173, v221
v_mul_f32 v222, v174, v222
s_add_u32 m0, s39, 37888
s_add_u32 s37, s37, s38
buffer_load_dwordx4 v21, s[8:11], s37 offen sc1 lds
v_mul_f32 v223, v175, v223
v_fma_f32 v80, v80, v239, v239
v_fma_f32 v81, v81, v239, v239
v_fma_f32 v82, v82, v239, v239
v_fma_f32 v83, v83, v239, v239
v_rcp_f32 v80, v80
s_add_u32 m0, s39, 38912
s_add_u32 s37, s37, s38
buffer_load_dwordx4 v21, s[8:11], s37 offen sc1 lds
v_rcp_f32 v81, v81
v_rcp_f32 v82, v82
v_rcp_f32 v83, v83
v_mul_f32 v220, v220, v80
v_mul_f32 v221, v221, v81
v_mul_f32 v222, v222, v82
v_mul_f32 v223, v223, v83
s_add_u32 m0, s39, 39936
s_add_u32 s37, s37, s38
buffer_load_dwordx4 v21, s[8:11], s37 offen sc1 lds
v_cvt_pk_bf16_f32 v118, v220, v221
v_cvt_pk_bf16_f32 v119, v222, v223
s_nop 1
v_permlane32_swap_b32 v116, v118
v_permlane32_swap_b32 v117, v119
buffer_store_dwordx4 v[108:111], v27, s[24:27], 0 offen offset:768 sc1
buffer_store_dwordx4 v[116:119], v28, s[24:27], 0 offen offset:512 sc1
s_waitcnt vmcnt(19)
s_barrier
s_add_u32 m0, s39, 65536
s_add_u32 s37, s37, s40
buffer_load_dwordx4 v21, s[8:11], s37 offen sc1 lds
s_add_u32 m0, s39, 66560
s_add_u32 s37, s37, s38
buffer_load_dwordx4 v21, s[8:11], s37 offen sc1 lds
s_add_u32 m0, s39, 67584
s_add_u32 s37, s37, s38
buffer_load_dwordx4 v21, s[8:11], s37 offen sc1 lds
s_add_u32 m0, s39, 68608
s_add_u32 s37, s37, s38
buffer_load_dwordx4 v21, s[8:11], s37 offen sc1 lds
s_add_u32 m0, s39, 69632
s_add_u32 s37, s37, s55
buffer_load_dwordx4 v21, s[8:11], s37 offen sc1 lds
s_add_u32 m0, s39, 70656
s_add_u32 s37, s37, s38
buffer_load_dwordx4 v21, s[8:11], s37 offen sc1 lds
s_add_u32 m0, s39, 71680
s_add_u32 s37, s37, s38
buffer_load_dwordx4 v21, s[8:11], s37 offen sc1 lds
s_add_u32 m0, s39, 72704
s_add_u32 s37, s37, s38
buffer_load_dwordx4 v21, s[8:11], s37 offen sc1 lds
s_waitcnt vmcnt(8)
s_barrier
s_add_u32 m0, s39, 98304
s_add_u32 s37, s37, s40
buffer_load_dwordx4 v21, s[8:11], s37 offen sc1 lds
s_add_u32 m0, s39, 99328
s_add_u32 s37, s37, s38
buffer_load_dwordx4 v21, s[8:11], s37 offen sc1 lds
s_add_u32 m0, s39, 100352
s_add_u32 s37, s37, s38
buffer_load_dwordx4 v21, s[8:11], s37 offen sc1 lds
s_add_u32 m0, s39, 101376
s_add_u32 s37, s37, s38
buffer_load_dwordx4 v21, s[8:11], s37 offen sc1 lds
s_add_u32 m0, s39, 102400
s_add_u32 s37, s37, s55
buffer_load_dwordx4 v21, s[8:11], s37 offen sc1 lds
s_add_u32 m0, s39, 103424
s_add_u32 s37, s37, s38
buffer_load_dwordx4 v21, s[8:11], s37 offen sc1 lds
s_add_u32 m0, s39, 104448
s_add_u32 s37, s37, s38
buffer_load_dwordx4 v21, s[8:11], s37 offen sc1 lds
s_add_u32 m0, s39, 105472
s_add_u32 s37, s37, s38
buffer_load_dwordx4 v21, s[8:11], s37 offen sc1 lds
s_waitcnt vmcnt(18)
s_barrier
s_add_u32 m0, s39, 0
s_add_u32 s37, s37, s40
buffer_load_dwordx4 v21, s[8:11], s37 offen sc1 lds
s_add_u32 m0, s39, 1024
s_add_u32 s37, s37, s38
buffer_load_dwordx4 v21, s[8:11], s37 offen sc1 lds
s_add_u32 m0, s39, 2048
s_add_u32 s37, s37, s38
buffer_load_dwordx4 v21, s[8:11], s37 offen sc1 lds
s_add_u32 m0, s39, 3072
s_add_u32 s37, s37, s38
buffer_load_dwordx4 v21, s[8:11], s37 offen sc1 lds
s_add_u32 m0, s39, 4096
s_add_u32 s37, s37, s55
buffer_load_dwordx4 v21, s[8:11], s37 offen sc1 lds
s_add_u32 m0, s39, 5120
s_add_u32 s37, s37, s38
buffer_load_dwordx4 v21, s[8:11], s37 offen sc1 lds
s_add_u32 m0, s39, 6144
s_add_u32 s37, s37, s38
buffer_load_dwordx4 v21, s[8:11], s37 offen sc1 lds
s_add_u32 m0, s39, 7168
s_add_u32 s37, s37, s38
buffer_load_dwordx4 v21, s[8:11], s37 offen sc1 lds
s_waitcnt vmcnt(16)
s_barrier
s_add_u32 m0, s39, 32768
s_add_u32 s37, s37, s40
buffer_load_dwordx4 v21, s[8:11], s37 offen sc1 lds
s_add_u32 m0, s39, 33792
s_add_u32 s37, s37, s38
buffer_load_dwordx4 v21, s[8:11], s37 offen sc1 lds
s_add_u32 m0, s39, 34816
s_add_u32 s37, s37, s38
buffer_load_dwordx4 v21, s[8:11], s37 offen sc1 lds
s_add_u32 m0, s39, 35840
s_add_u32 s37, s37, s38
buffer_load_dwordx4 v21, s[8:11], s37 offen sc1 lds
s_add_u32 m0, s39, 36864
s_add_u32 s37, s37, s55
buffer_load_dwordx4 v21, s[8:11], s37 offen sc1 lds
s_add_u32 m0, s39, 37888
s_add_u32 s37, s37, s38
buffer_load_dwordx4 v21, s[8:11], s37 offen sc1 lds
s_add_u32 m0, s39, 38912
s_add_u32 s37, s37, s38
buffer_load_dwordx4 v21, s[8:11], s37 offen sc1 lds
s_add_u32 m0, s39, 39936
s_add_u32 s37, s37, s38
buffer_load_dwordx4 v21, s[8:11], s37 offen sc1 lds
s_waitcnt vmcnt(16)
s_barrier
s_add_u32 m0, s39, 65536
s_add_u32 s37, s37, s40
buffer_load_dwordx4 v21, s[8:11], s37 offen sc1 lds
s_add_u32 m0, s39, 66560
s_add_u32 s37, s37, s38
buffer_load_dwordx4 v21, s[8:11], s37 offen sc1 lds
s_add_u32 m0, s39, 67584
s_add_u32 s37, s37, s38
buffer_load_dwordx4 v21, s[8:11], s37 offen sc1 lds
s_add_u32 m0, s39, 68608
s_add_u32 s37, s37, s38
buffer_load_dwordx4 v21, s[8:11], s37 offen sc1 lds
s_add_u32 m0, s39, 69632
s_add_u32 s37, s37, s55
buffer_load_dwordx4 v21, s[8:11], s37 offen sc1 lds
s_add_u32 m0, s39, 70656
s_add_u32 s37, s37, s38
buffer_load_dwordx4 v21, s[8:11], s37 offen sc1 lds
s_add_u32 m0, s39, 71680
s_add_u32 s37, s37, s38
buffer_load_dwordx4 v21, s[8:11], s37 offen sc1 lds
s_add_u32 m0, s39, 72704
s_add_u32 s37, s37, s38
buffer_load_dwordx4 v21, s[8:11], s37 offen sc1 lds
s_waitcnt vmcnt(16)
s_barrier
s_add_u32 m0, s39, 98304
s_add_u32 s37, s37, s40
buffer_load_dwordx4 v21, s[8:11], s37 offen sc1 lds
s_add_u32 m0, s39, 99328
s_add_u32 s37, s37, s38
buffer_load_dwordx4 v21, s[8:11], s37 offen sc1 lds
s_add_u32 m0, s39, 100352
s_add_u32 s37, s37, s38
buffer_load_dwordx4 v21, s[8:11], s37 offen sc1 lds
s_add_u32 m0, s39, 101376
s_add_u32 s37, s37, s38
buffer_load_dwordx4 v21, s[8:11], s37 offen sc1 lds
s_add_u32 m0, s39, 102400
s_add_u32 s37, s37, s55
buffer_load_dwordx4 v21, s[8:11], s37 offen sc1 lds
s_add_u32 m0, s39, 103424
s_add_u32 s37, s37, s38
buffer_load_dwordx4 v21, s[8:11], s37 offen sc1 lds
s_add_u32 m0, s39, 104448
s_add_u32 s37, s37, s38
buffer_load_dwordx4 v21, s[8:11], s37 offen sc1 lds
s_add_u32 m0, s39, 105472
s_add_u32 s37, s37, s38
buffer_load_dwordx4 v21, s[8:11], s37 offen sc1 lds
s_waitcnt vmcnt(16)
s_barrier
s_cmp_eq_u32 s51, 2
s_cbranch_scc1 LW4_49
s_mul_i32 s40, s53, 98304
s_add_u32 m0, s39, 0
s_add_u32 s37, s40, 524288
buffer_load_dwordx4 v21, s[8:11], s37 offen sc1 lds
s_add_u32 m0, s39, 1024
s_add_u32 s37, s40, 525312
buffer_load_dwordx4 v21, s[8:11], s37 offen sc1 lds
s_add_u32 m0, s39, 2048
s_add_u32 s37, s40, 526336
buffer_load_dwordx4 v21, s[8:11], s37 offen sc1 lds
s_add_u32 m0, s39, 3072
s_add_u32 s37, s40, 527360
buffer_load_dwordx4 v21, s[8:11], s37 offen sc1 lds
s_add_u32 m0, s39, 4096
s_add_u32 s37, s40, 528384
buffer_load_dwordx4 v21, s[8:11], s37 offen sc1 lds
s_add_u32 m0, s39, 5120
s_add_u32 s37, s40, 529408
buffer_load_dwordx4 v21, s[8:11], s37 offen sc1 lds
s_add_u32 m0, s39, 6144
s_add_u32 s37, s40, 530432
buffer_load_dwordx4 v21, s[8:11], s37 offen sc1 lds
s_add_u32 m0, s39, 7168
s_add_u32 s37, s40, 531456
buffer_load_dwordx4 v21, s[8:11], s37 offen sc1 lds
s_waitcnt vmcnt(16)
s_barrier
s_add_u32 m0, s39, 32768
s_add_u32 s37, s40, 540672
buffer_load_dwordx4 v21, s[8:11], s37 offen sc1 lds
s_add_u32 m0, s39, 33792
s_add_u32 s37, s40, 541696
buffer_load_dwordx4 v21, s[8:11], s37 offen sc1 lds
s_add_u32 m0, s39, 34816
s_add_u32 s37, s40, 542720
buffer_load_dwordx4 v21, s[8:11], s37 offen sc1 lds
s_add_u32 m0, s39, 35840
s_add_u32 s37, s40, 543744
buffer_load_dwordx4 v21, s[8:11], s37 offen sc1 lds
s_add_u32 m0, s39, 36864
s_add_u32 s37, s40, 544768
buffer_load_dwordx4 v21, s[8:11], s37 offen sc1 lds
s_add_u32 m0, s39, 37888
s_add_u32 s37, s40, 545792
buffer_load_dwordx4 v21, s[8:11], s37 offen sc1 lds
s_add_u32 m0, s39, 38912
s_add_u32 s37, s40, 546816
buffer_load_dwordx4 v21, s[8:11], s37 offen sc1 lds
s_add_u32 m0, s39, 39936
s_add_u32 s37, s40, 547840
buffer_load_dwordx4 v21, s[8:11], s37 offen sc1 lds
s_waitcnt vmcnt(16)
s_barrier
s_add_u32 m0, s39, 65536
s_add_u32 s37, s40, 557056
buffer_load_dwordx4 v21, s[8:11], s37 offen sc1 lds
s_add_u32 m0, s39, 66560
s_add_u32 s37, s40, 558080
buffer_load_dwordx4 v21, s[8:11], s37 offen sc1 lds
s_add_u32 m0, s39, 67584
s_add_u32 s37, s40, 559104
buffer_load_dwordx4 v21, s[8:11], s37 offen sc1 lds
s_add_u32 m0, s39, 68608
s_add_u32 s37, s40, 560128
buffer_load_dwordx4 v21, s[8:11], s37 offen sc1 lds
s_add_u32 m0, s39, 69632
s_add_u32 s37, s40, 561152
buffer_load_dwordx4 v21, s[8:11], s37 offen sc1 lds
s_add_u32 m0, s39, 70656
s_add_u32 s37, s40, 562176
buffer_load_dwordx4 v21, s[8:11], s37 offen sc1 lds
s_add_u32 m0, s39, 71680
s_add_u32 s37, s40, 563200
buffer_load_dwordx4 v21, s[8:11], s37 offen sc1 lds
s_add_u32 m0, s39, 72704
s_add_u32 s37, s40, 564224
buffer_load_dwordx4 v21, s[8:11], s37 offen sc1 lds
s_waitcnt vmcnt(16)
s_barrier
s_add_u32 m0, s39, 98304
s_add_u32 s37, s40, 573440
buffer_load_dwordx4 v21, s[8:11], s37 offen sc1 lds
s_add_u32 m0, s39, 99328
s_add_u32 s37, s40, 574464
buffer_load_dwordx4 v21, s[8:11], s37 offen sc1 lds
s_add_u32 m0, s39, 100352
s_add_u32 s37, s40, 575488
buffer_load_dwordx4 v21, s[8:11], s37 offen sc1 lds
s_add_u32 m0, s39, 101376
s_add_u32 s37, s40, 576512
buffer_load_dwordx4 v21, s[8:11], s37 offen sc1 lds
s_add_u32 m0, s39, 102400
s_add_u32 s37, s40, 577536
buffer_load_dwordx4 v21, s[8:11], s37 offen sc1 lds
s_add_u32 m0, s39, 103424
s_add_u32 s37, s40, 578560
buffer_load_dwordx4 v21, s[8:11], s37 offen sc1 lds
s_add_u32 m0, s39, 104448
s_add_u32 s37, s40, 579584
buffer_load_dwordx4 v21, s[8:11], s37 offen sc1 lds
s_add_u32 m0, s39, 105472
s_add_u32 s37, s40, 580608
buffer_load_dwordx4 v21, s[8:11], s37 offen sc1 lds
s_waitcnt vmcnt(16)
s_barrier
s_add_u32 m0, s39, 0
s_add_u32 s37, s40, 589824
buffer_load_dwordx4 v21, s[8:11], s37 offen sc1 lds
s_add_u32 m0, s39, 1024
s_add_u32 s37, s40, 590848
buffer_load_dwordx4 v21, s[8:11], s37 offen sc1 lds
s_add_u32 m0, s39, 2048
s_add_u32 s37, s40, 591872
buffer_load_dwordx4 v21, s[8:11], s37 offen sc1 lds
s_add_u32 m0, s39, 3072
s_add_u32 s37, s40, 592896
buffer_load_dwordx4 v21, s[8:11], s37 offen sc1 lds
s_add_u32 m0, s39, 4096
s_add_u32 s37, s40, 593920
buffer_load_dwordx4 v21, s[8:11], s37 offen sc1 lds
s_add_u32 m0, s39, 5120
s_add_u32 s37, s40, 594944
buffer_load_dwordx4 v21, s[8:11], s37 offen sc1 lds
s_add_u32 m0, s39, 6144
s_add_u32 s37, s40, 595968
buffer_load_dwordx4 v21, s[8:11], s37 offen sc1 lds
s_add_u32 m0, s39, 7168
s_add_u32 s37, s40, 596992
buffer_load_dwordx4 v21, s[8:11], s37 offen sc1 lds
s_waitcnt vmcnt(16)
s_barrier
s_add_u32 m0, s39, 32768
s_add_u32 s37, s40, 606208
buffer_load_dwordx4 v21, s[8:11], s37 offen sc1 lds
s_add_u32 m0, s39, 33792
s_add_u32 s37, s40, 607232
buffer_load_dwordx4 v21, s[8:11], s37 offen sc1 lds
s_add_u32 m0, s39, 34816
s_add_u32 s37, s40, 608256
buffer_load_dwordx4 v21, s[8:11], s37 offen sc1 lds
s_add_u32 m0, s39, 35840
s_add_u32 s37, s40, 609280
buffer_load_dwordx4 v21, s[8:11], s37 offen sc1 lds
s_add_u32 m0, s39, 36864
s_add_u32 s37, s40, 610304
buffer_load_dwordx4 v21, s[8:11], s37 offen sc1 lds
s_add_u32 m0, s39, 37888
s_add_u32 s37, s40, 611328
buffer_load_dwordx4 v21, s[8:11], s37 offen sc1 lds
s_add_u32 m0, s39, 38912
s_add_u32 s37, s40, 612352
buffer_load_dwordx4 v21, s[8:11], s37 offen sc1 lds
s_add_u32 m0, s39, 39936
s_add_u32 s37, s40, 613376
buffer_load_dwordx4 v21, s[8:11], s37 offen sc1 lds
s_waitcnt vmcnt(16)
s_barrier
s_add_u32 m0, s39, 65536
s_mov_b32 s37, 720896
buffer_load_dwordx4 v21, s[8:11], s37 offen sc1 lds
s_add_u32 m0, s39, 66560
s_mov_b32 s37, 721920
buffer_load_dwordx4 v21, s[8:11], s37 offen sc1 lds
s_add_u32 m0, s39, 67584
s_mov_b32 s37, 722944
buffer_load_dwordx4 v21, s[8:11], s37 offen sc1 lds
s_add_u32 m0, s39, 68608
s_mov_b32 s37, 723968
buffer_load_dwordx4 v21, s[8:11], s37 offen sc1 lds
s_add_u32 m0, s39, 69632
s_mov_b32 s37, 724992
buffer_load_dwordx4 v21, s[8:11], s37 offen sc1 lds
s_add_u32 m0, s39, 70656
s_mov_b32 s37, 726016
buffer_load_dwordx4 v21, s[8:11], s37 offen sc1 lds
s_add_u32 m0, s39, 71680
s_mov_b32 s37, 727040
buffer_load_dwordx4 v21, s[8:11], s37 offen sc1 lds
s_add_u32 m0, s39, 72704
s_mov_b32 s37, 728064
buffer_load_dwordx4 v21, s[8:11], s37 offen sc1 lds
s_waitcnt vmcnt(16)
s_barrier
s_add_u32 m0, s39, 98304
s_mov_b32 s37, 737280
buffer_load_dwordx4 v21, s[8:11], s37 offen sc1 lds
s_add_u32 m0, s39, 99328
s_mov_b32 s37, 738304
buffer_load_dwordx4 v21, s[8:11], s37 offen sc1 lds
s_add_u32 m0, s39, 100352
s_mov_b32 s37, 739328
buffer_load_dwordx4 v21, s[8:11], s37 offen sc1 lds
s_add_u32 m0, s39, 101376
s_mov_b32 s37, 740352
buffer_load_dwordx4 v21, s[8:11], s37 offen sc1 lds
s_add_u32 m0, s39, 102400
s_mov_b32 s37, 741376
buffer_load_dwordx4 v21, s[8:11], s37 offen sc1 lds
s_add_u32 m0, s39, 103424
s_mov_b32 s37, 742400
buffer_load_dwordx4 v21, s[8:11], s37 offen sc1 lds
s_add_u32 m0, s39, 104448
s_mov_b32 s37, 743424
buffer_load_dwordx4 v21, s[8:11], s37 offen sc1 lds
s_add_u32 m0, s39, 105472
s_mov_b32 s37, 744448
buffer_load_dwordx4 v21, s[8:11], s37 offen sc1 lds
s_waitcnt vmcnt(16)
s_barrier
s_add_u32 m0, s39, 0
s_mov_b32 s37, 753664
buffer_load_dwordx4 v21, s[8:11], s37 offen sc1 lds
s_add_u32 m0, s39, 1024
s_mov_b32 s37, 754688
buffer_load_dwordx4 v21, s[8:11], s37 offen sc1 lds
s_add_u32 m0, s39, 2048
s_mov_b32 s37, 755712
buffer_load_dwordx4 v21, s[8:11], s37 offen sc1 lds
s_add_u32 m0, s39, 3072
s_mov_b32 s37, 756736
buffer_load_dwordx4 v21, s[8:11], s37 offen sc1 lds
s_add_u32 m0, s39, 4096
s_mov_b32 s37, 757760
buffer_load_dwordx4 v21, s[8:11], s37 offen sc1 lds
s_add_u32 m0, s39, 5120
s_mov_b32 s37, 758784
buffer_load_dwordx4 v21, s[8:11], s37 offen sc1 lds
s_add_u32 m0, s39, 6144
s_mov_b32 s37, 759808
buffer_load_dwordx4 v21, s[8:11], s37 offen sc1 lds
s_add_u32 m0, s39, 7168
s_mov_b32 s37, 760832
buffer_load_dwordx4 v21, s[8:11], s37 offen sc1 lds
s_waitcnt vmcnt(16)
s_barrier
s_add_u32 m0, s39, 32768
s_mov_b32 s37, 770048
buffer_load_dwordx4 v21, s[8:11], s37 offen sc1 lds
s_add_u32 m0, s39, 33792
s_mov_b32 s37, 771072
buffer_load_dwordx4 v21, s[8:11], s37 offen sc1 lds
s_add_u32 m0, s39, 34816
s_mov_b32 s37, 772096
buffer_load_dwordx4 v21, s[8:11], s37 offen sc1 lds
s_add_u32 m0, s39, 35840
s_mov_b32 s37, 773120
buffer_load_dwordx4 v21, s[8:11], s37 offen sc1 lds
s_add_u32 m0, s39, 36864
s_mov_b32 s37, 774144
buffer_load_dwordx4 v21, s[8:11], s37 offen sc1 lds
s_add_u32 m0, s39, 37888
s_mov_b32 s37, 775168
buffer_load_dwordx4 v21, s[8:11], s37 offen sc1 lds
s_add_u32 m0, s39, 38912
s_mov_b32 s37, 776192
buffer_load_dwordx4 v21, s[8:11], s37 offen sc1 lds
s_add_u32 m0, s39, 39936
s_mov_b32 s37, 777216
buffer_load_dwordx4 v21, s[8:11], s37 offen sc1 lds
s_waitcnt vmcnt(16)
s_barrier
s_add_u32 m0, s39, 65536
s_mov_b32 s37, 786432
buffer_load_dwordx4 v21, s[8:11], s37 offen sc1 lds
s_add_u32 m0, s39, 66560
s_mov_b32 s37, 787456
buffer_load_dwordx4 v21, s[8:11], s37 offen sc1 lds
s_add_u32 m0, s39, 67584
s_mov_b32 s37, 788480
buffer_load_dwordx4 v21, s[8:11], s37 offen sc1 lds
s_add_u32 m0, s39, 68608
s_mov_b32 s37, 789504
buffer_load_dwordx4 v21, s[8:11], s37 offen sc1 lds
s_add_u32 m0, s39, 69632
s_mov_b32 s37, 790528
buffer_load_dwordx4 v21, s[8:11], s37 offen sc1 lds
s_add_u32 m0, s39, 70656
s_mov_b32 s37, 791552
buffer_load_dwordx4 v21, s[8:11], s37 offen sc1 lds
s_add_u32 m0, s39, 71680
s_mov_b32 s37, 792576
buffer_load_dwordx4 v21, s[8:11], s37 offen sc1 lds
s_add_u32 m0, s39, 72704
s_mov_b32 s37, 793600
buffer_load_dwordx4 v21, s[8:11], s37 offen sc1 lds
s_waitcnt vmcnt(16)
s_barrier
s_add_u32 m0, s39, 98304
s_mov_b32 s37, 802816
buffer_load_dwordx4 v21, s[8:11], s37 offen sc1 lds
s_add_u32 m0, s39, 99328
s_mov_b32 s37, 803840
buffer_load_dwordx4 v21, s[8:11], s37 offen sc1 lds
s_add_u32 m0, s39, 100352
s_mov_b32 s37, 804864
buffer_load_dwordx4 v21, s[8:11], s37 offen sc1 lds
s_add_u32 m0, s39, 101376
s_mov_b32 s37, 805888
buffer_load_dwordx4 v21, s[8:11], s37 offen sc1 lds
s_add_u32 m0, s39, 102400
s_mov_b32 s37, 806912
buffer_load_dwordx4 v21, s[8:11], s37 offen sc1 lds
s_add_u32 m0, s39, 103424
s_mov_b32 s37, 807936
buffer_load_dwordx4 v21, s[8:11], s37 offen sc1 lds
s_add_u32 m0, s39, 104448
s_mov_b32 s37, 808960
buffer_load_dwordx4 v21, s[8:11], s37 offen sc1 lds
s_add_u32 m0, s39, 105472
s_mov_b32 s37, 809984
buffer_load_dwordx4 v21, s[8:11], s37 offen sc1 lds
s_waitcnt vmcnt(16)
s_barrier
s_add_u32 m0, s39, 0
s_mov_b32 s37, 819200
buffer_load_dwordx4 v21, s[8:11], s37 offen sc1 lds
s_add_u32 m0, s39, 1024
s_mov_b32 s37, 820224
buffer_load_dwordx4 v21, s[8:11], s37 offen sc1 lds
s_add_u32 m0, s39, 2048
s_mov_b32 s37, 821248
buffer_load_dwordx4 v21, s[8:11], s37 offen sc1 lds
s_add_u32 m0, s39, 3072
s_mov_b32 s37, 822272
buffer_load_dwordx4 v21, s[8:11], s37 offen sc1 lds
s_add_u32 m0, s39, 4096
s_mov_b32 s37, 823296
buffer_load_dwordx4 v21, s[8:11], s37 offen sc1 lds
s_add_u32 m0, s39, 5120
s_mov_b32 s37, 824320
buffer_load_dwordx4 v21, s[8:11], s37 offen sc1 lds
s_add_u32 m0, s39, 6144
s_mov_b32 s37, 825344
buffer_load_dwordx4 v21, s[8:11], s37 offen sc1 lds
s_add_u32 m0, s39, 7168
s_mov_b32 s37, 826368
buffer_load_dwordx4 v21, s[8:11], s37 offen sc1 lds
s_waitcnt vmcnt(16)
s_barrier
s_add_u32 m0, s39, 32768
s_mov_b32 s37, 835584
buffer_load_dwordx4 v21, s[8:11], s37 offen sc1 lds
s_add_u32 m0, s39, 33792
s_mov_b32 s37, 836608
buffer_load_dwordx4 v21, s[8:11], s37 offen sc1 lds
s_add_u32 m0, s39, 34816
s_mov_b32 s37, 837632
buffer_load_dwordx4 v21, s[8:11], s37 offen sc1 lds
s_add_u32 m0, s39, 35840
s_mov_b32 s37, 838656
buffer_load_dwordx4 v21, s[8:11], s37 offen sc1 lds
s_add_u32 m0, s39, 36864
s_mov_b32 s37, 839680
buffer_load_dwordx4 v21, s[8:11], s37 offen sc1 lds
s_add_u32 m0, s39, 37888
s_mov_b32 s37, 840704
buffer_load_dwordx4 v21, s[8:11], s37 offen sc1 lds
s_add_u32 m0, s39, 38912
s_mov_b32 s37, 841728
buffer_load_dwordx4 v21, s[8:11], s37 offen sc1 lds
s_add_u32 m0, s39, 39936
s_mov_b32 s37, 842752
buffer_load_dwordx4 v21, s[8:11], s37 offen sc1 lds
s_waitcnt vmcnt(16)
s_barrier
s_add_u32 m0, s39, 65536
s_mov_b32 s37, 851968
buffer_load_dwordx4 v21, s[8:11], s37 offen sc1 lds
s_add_u32 m0, s39, 66560
s_mov_b32 s37, 852992
buffer_load_dwordx4 v21, s[8:11], s37 offen sc1 lds
s_add_u32 m0, s39, 67584
s_mov_b32 s37, 854016
buffer_load_dwordx4 v21, s[8:11], s37 offen sc1 lds
s_add_u32 m0, s39, 68608
s_mov_b32 s37, 855040
buffer_load_dwordx4 v21, s[8:11], s37 offen sc1 lds
s_add_u32 m0, s39, 69632
s_mov_b32 s37, 856064
buffer_load_dwordx4 v21, s[8:11], s37 offen sc1 lds
s_add_u32 m0, s39, 70656
s_mov_b32 s37, 857088
buffer_load_dwordx4 v21, s[8:11], s37 offen sc1 lds
s_add_u32 m0, s39, 71680
s_mov_b32 s37, 858112
buffer_load_dwordx4 v21, s[8:11], s37 offen sc1 lds
s_add_u32 m0, s39, 72704
s_mov_b32 s37, 859136
buffer_load_dwordx4 v21, s[8:11], s37 offen sc1 lds
s_waitcnt vmcnt(16)
s_barrier
s_add_u32 m0, s39, 98304
s_mov_b32 s37, 868352
buffer_load_dwordx4 v21, s[8:11], s37 offen sc1 lds
s_add_u32 m0, s39, 99328
s_mov_b32 s37, 869376
buffer_load_dwordx4 v21, s[8:11], s37 offen sc1 lds
s_add_u32 m0, s39, 100352
s_mov_b32 s37, 870400
buffer_load_dwordx4 v21, s[8:11], s37 offen sc1 lds
s_add_u32 m0, s39, 101376
s_mov_b32 s37, 871424
buffer_load_dwordx4 v21, s[8:11], s37 offen sc1 lds
s_add_u32 m0, s39, 102400
s_mov_b32 s37, 872448
buffer_load_dwordx4 v21, s[8:11], s37 offen sc1 lds
s_add_u32 m0, s39, 103424
s_mov_b32 s37, 873472
buffer_load_dwordx4 v21, s[8:11], s37 offen sc1 lds
s_add_u32 m0, s39, 104448
s_mov_b32 s37, 874496
buffer_load_dwordx4 v21, s[8:11], s37 offen sc1 lds
s_add_u32 m0, s39, 105472
s_mov_b32 s37, 875520
buffer_load_dwordx4 v21, s[8:11], s37 offen sc1 lds
s_waitcnt vmcnt(16)
s_barrier
s_add_u32 m0, s39, 0
s_mov_b32 s37, 884736
buffer_load_dwordx4 v21, s[8:11], s37 offen sc1 lds
s_add_u32 m0, s39, 1024
s_mov_b32 s37, 885760
buffer_load_dwordx4 v21, s[8:11], s37 offen sc1 lds
s_add_u32 m0, s39, 2048
s_mov_b32 s37, 886784
buffer_load_dwordx4 v21, s[8:11], s37 offen sc1 lds
s_add_u32 m0, s39, 3072
s_mov_b32 s37, 887808
buffer_load_dwordx4 v21, s[8:11], s37 offen sc1 lds
s_add_u32 m0, s39, 4096
s_mov_b32 s37, 888832
buffer_load_dwordx4 v21, s[8:11], s37 offen sc1 lds
s_add_u32 m0, s39, 5120
s_mov_b32 s37, 889856
buffer_load_dwordx4 v21, s[8:11], s37 offen sc1 lds
s_add_u32 m0, s39, 6144
s_mov_b32 s37, 890880
buffer_load_dwordx4 v21, s[8:11], s37 offen sc1 lds
s_add_u32 m0, s39, 7168
s_mov_b32 s37, 891904
buffer_load_dwordx4 v21, s[8:11], s37 offen sc1 lds
s_waitcnt vmcnt(16)
s_barrier
s_add_u32 m0, s39, 32768
s_mov_b32 s37, 901120
buffer_load_dwordx4 v21, s[8:11], s37 offen sc1 lds
s_add_u32 m0, s39, 33792
s_mov_b32 s37, 902144
buffer_load_dwordx4 v21, s[8:11], s37 offen sc1 lds
s_add_u32 m0, s39, 34816
s_mov_b32 s37, 903168
buffer_load_dwordx4 v21, s[8:11], s37 offen sc1 lds
s_add_u32 m0, s39, 35840
s_mov_b32 s37, 904192
buffer_load_dwordx4 v21, s[8:11], s37 offen sc1 lds
s_add_u32 m0, s39, 36864
s_mov_b32 s37, 905216
buffer_load_dwordx4 v21, s[8:11], s37 offen sc1 lds
s_add_u32 m0, s39, 37888
s_mov_b32 s37, 906240
buffer_load_dwordx4 v21, s[8:11], s37 offen sc1 lds
s_add_u32 m0, s39, 38912
s_mov_b32 s37, 907264
buffer_load_dwordx4 v21, s[8:11], s37 offen sc1 lds
s_add_u32 m0, s39, 39936
s_mov_b32 s37, 908288
buffer_load_dwordx4 v21, s[8:11], s37 offen sc1 lds
s_waitcnt vmcnt(16)
s_barrier
s_waitcnt vmcnt(8)
s_barrier
s_waitcnt vmcnt(0)
s_barrier
s_branch Ldone_1
LW4_49:
s_mul_i32 s40, s53, 786432
s_add_u32 m0, s39, 0
s_add_u32 s37, s40, 4194304
buffer_load_dwordx4 v21, s[8:11], s37 offen sc1 lds
s_add_u32 m0, s39, 1024
s_add_u32 s37, s40, 4210688
buffer_load_dwordx4 v21, s[8:11], s37 offen sc1 lds
s_add_u32 m0, s39, 2048
s_add_u32 s37, s40, 4227072
buffer_load_dwordx4 v21, s[8:11], s37 offen sc1 lds
s_add_u32 m0, s39, 3072
s_add_u32 s37, s40, 4243456
buffer_load_dwordx4 v21, s[8:11], s37 offen sc1 lds
s_add_u32 m0, s39, 4096
s_add_u32 s37, s40, 4292608
buffer_load_dwordx4 v21, s[8:11], s37 offen sc1 lds
s_add_u32 m0, s39, 5120
s_add_u32 s37, s40, 4308992
buffer_load_dwordx4 v21, s[8:11], s37 offen sc1 lds
s_add_u32 m0, s39, 6144
s_add_u32 s37, s40, 4325376
buffer_load_dwordx4 v21, s[8:11], s37 offen sc1 lds
s_add_u32 m0, s39, 7168
s_add_u32 s37, s40, 4341760
buffer_load_dwordx4 v21, s[8:11], s37 offen sc1 lds
s_waitcnt vmcnt(16)
s_barrier
s_add_u32 m0, s39, 32768
s_add_u32 s37, s40, 4259840
buffer_load_dwordx4 v21, s[8:11], s37 offen sc1 lds
s_add_u32 m0, s39, 33792
s_add_u32 s37, s40, 4358144
buffer_load_dwordx4 v21, s[8:11], s37 offen sc1 lds
s_add_u32 m0, s39, 34816
s_add_u32 s37, s40, 4276224
buffer_load_dwordx4 v21, s[8:11], s37 offen sc1 lds
s_add_u32 m0, s39, 35840
s_add_u32 s37, s40, 4374528
buffer_load_dwordx4 v21, s[8:11], s37 offen sc1 lds
s_add_u32 m0, s39, 36864
s_add_u32 s37, s40, 4390912
buffer_load_dwordx4 v21, s[8:11], s37 offen sc1 lds
s_add_u32 m0, s39, 37888
s_add_u32 s37, s40, 4407296
buffer_load_dwordx4 v21, s[8:11], s37 offen sc1 lds
s_add_u32 m0, s39, 38912
s_add_u32 s37, s40, 4423680
buffer_load_dwordx4 v21, s[8:11], s37 offen sc1 lds
s_add_u32 m0, s39, 39936
s_add_u32 s37, s40, 4440064
buffer_load_dwordx4 v21, s[8:11], s37 offen sc1 lds
s_waitcnt vmcnt(16)
s_barrier
s_add_u32 m0, s39, 65536
s_add_u32 s37, s40, 4489216
buffer_load_dwordx4 v21, s[8:11], s37 offen sc1 lds
s_add_u32 m0, s39, 66560
s_add_u32 s37, s40, 4505600
buffer_load_dwordx4 v21, s[8:11], s37 offen sc1 lds
s_add_u32 m0, s39, 67584
s_add_u32 s37, s40, 4521984
buffer_load_dwordx4 v21, s[8:11], s37 offen sc1 lds
s_add_u32 m0, s39, 68608
s_add_u32 s37, s40, 4538368
buffer_load_dwordx4 v21, s[8:11], s37 offen sc1 lds
s_add_u32 m0, s39, 69632
s_add_u32 s37, s40, 4456448
buffer_load_dwordx4 v21, s[8:11], s37 offen sc1 lds
s_add_u32 m0, s39, 70656
s_add_u32 s37, s40, 4554752
buffer_load_dwordx4 v21, s[8:11], s37 offen sc1 lds
s_add_u32 m0, s39, 71680
s_add_u32 s37, s40, 4472832
buffer_load_dwordx4 v21, s[8:11], s37 offen sc1 lds
s_add_u32 m0, s39, 72704
s_add_u32 s37, s40, 4571136
buffer_load_dwordx4 v21, s[8:11], s37 offen sc1 lds
s_waitcnt vmcnt(16)
s_barrier
s_add_u32 m0, s39, 98304
s_add_u32 s37, s40, 4587520
buffer_load_dwordx4 v21, s[8:11], s37 offen sc1 lds
s_add_u32 m0, s39, 99328
s_add_u32 s37, s40, 4603904
buffer_load_dwordx4 v21, s[8:11], s37 offen sc1 lds
s_add_u32 m0, s39, 100352
s_add_u32 s37, s40, 4620288
buffer_load_dwordx4 v21, s[8:11], s37 offen sc1 lds
s_add_u32 m0, s39, 101376
s_add_u32 s37, s40, 4636672
buffer_load_dwordx4 v21, s[8:11], s37 offen sc1 lds
s_add_u32 m0, s39, 102400
s_add_u32 s37, s40, 4685824
buffer_load_dwordx4 v21, s[8:11], s37 offen sc1 lds
s_add_u32 m0, s39, 103424
s_add_u32 s37, s40, 4702208
buffer_load_dwordx4 v21, s[8:11], s37 offen sc1 lds
s_add_u32 m0, s39, 104448
s_add_u32 s37, s40, 4718592
buffer_load_dwordx4 v21, s[8:11], s37 offen sc1 lds
s_add_u32 m0, s39, 105472
s_add_u32 s37, s40, 4734976
buffer_load_dwordx4 v21, s[8:11], s37 offen sc1 lds
s_waitcnt vmcnt(16)
s_barrier
s_add_u32 m0, s39, 0
s_add_u32 s37, s40, 4653056
buffer_load_dwordx4 v21, s[8:11], s37 offen sc1 lds
s_add_u32 m0, s39, 1024
s_add_u32 s37, s40, 4751360
buffer_load_dwordx4 v21, s[8:11], s37 offen sc1 lds
s_add_u32 m0, s39, 2048
s_add_u32 s37, s40, 4669440
buffer_load_dwordx4 v21, s[8:11], s37 offen sc1 lds
s_add_u32 m0, s39, 3072
s_add_u32 s37, s40, 4767744
buffer_load_dwordx4 v21, s[8:11], s37 offen sc1 lds
s_add_u32 m0, s39, 4096
s_add_u32 s37, s40, 4784128
buffer_load_dwordx4 v21, s[8:11], s37 offen sc1 lds
s_add_u32 m0, s39, 5120
s_add_u32 s37, s40, 4800512
buffer_load_dwordx4 v21, s[8:11], s37 offen sc1 lds
s_add_u32 m0, s39, 6144
s_add_u32 s37, s40, 4816896
buffer_load_dwordx4 v21, s[8:11], s37 offen sc1 lds
s_add_u32 m0, s39, 7168
s_add_u32 s37, s40, 4833280
buffer_load_dwordx4 v21, s[8:11], s37 offen sc1 lds
s_waitcnt vmcnt(16)
s_barrier
s_add_u32 m0, s39, 32768
s_add_u32 s37, s40, 4882432
buffer_load_dwordx4 v21, s[8:11], s37 offen sc1 lds
s_add_u32 m0, s39, 33792
s_add_u32 s37, s40, 4898816
buffer_load_dwordx4 v21, s[8:11], s37 offen sc1 lds
s_add_u32 m0, s39, 34816
s_add_u32 s37, s40, 4915200
buffer_load_dwordx4 v21, s[8:11], s37 offen sc1 lds
s_add_u32 m0, s39, 35840
s_add_u32 s37, s40, 4931584
buffer_load_dwordx4 v21, s[8:11], s37 offen sc1 lds
s_add_u32 m0, s39, 36864
s_add_u32 s37, s40, 4849664
buffer_load_dwordx4 v21, s[8:11], s37 offen sc1 lds
s_add_u32 m0, s39, 37888
s_add_u32 s37, s40, 4947968
buffer_load_dwordx4 v21, s[8:11], s37 offen sc1 lds
s_add_u32 m0, s39, 38912
s_add_u32 s37, s40, 4866048
buffer_load_dwordx4 v21, s[8:11], s37 offen sc1 lds
s_add_u32 m0, s39, 39936
s_add_u32 s37, s40, 4964352
buffer_load_dwordx4 v21, s[8:11], s37 offen sc1 lds
s_waitcnt vmcnt(16)
s_barrier
s_add_u32 m0, s39, 65536
s_mov_b32 s37, 5767168
buffer_load_dwordx4 v21, s[8:11], s37 offen sc1 lds
s_add_u32 m0, s39, 66560
s_mov_b32 s37, 5783552
buffer_load_dwordx4 v21, s[8:11], s37 offen sc1 lds
s_add_u32 m0, s39, 67584
s_mov_b32 s37, 5799936
buffer_load_dwordx4 v21, s[8:11], s37 offen sc1 lds
s_add_u32 m0, s39, 68608
s_mov_b32 s37, 5816320
buffer_load_dwordx4 v21, s[8:11], s37 offen sc1 lds
s_add_u32 m0, s39, 69632
s_mov_b32 s37, 5865472
buffer_load_dwordx4 v21, s[8:11], s37 offen sc1 lds
s_add_u32 m0, s39, 70656
s_mov_b32 s37, 5881856
buffer_load_dwordx4 v21, s[8:11], s37 offen sc1 lds
s_add_u32 m0, s39, 71680
s_mov_b32 s37, 5898240
buffer_load_dwordx4 v21, s[8:11], s37 offen sc1 lds
s_add_u32 m0, s39, 72704
s_mov_b32 s37, 5914624
buffer_load_dwordx4 v21, s[8:11], s37 offen sc1 lds
s_waitcnt vmcnt(16)
s_barrier
s_add_u32 m0, s39, 98304
s_mov_b32 s37, 5832704
buffer_load_dwordx4 v21, s[8:11], s37 offen sc1 lds
s_add_u32 m0, s39, 99328
s_mov_b32 s37, 5931008
buffer_load_dwordx4 v21, s[8:11], s37 offen sc1 lds
s_add_u32 m0, s39, 100352
s_mov_b32 s37, 5849088
buffer_load_dwordx4 v21, s[8:11], s37 offen sc1 lds
s_add_u32 m0, s39, 101376
s_mov_b32 s37, 5947392
buffer_load_dwordx4 v21, s[8:11], s37 offen sc1 lds
s_add_u32 m0, s39, 102400
s_mov_b32 s37, 5963776
buffer_load_dwordx4 v21, s[8:11], s37 offen sc1 lds
s_add_u32 m0, s39, 103424
s_mov_b32 s37, 5980160
buffer_load_dwordx4 v21, s[8:11], s37 offen sc1 lds
s_add_u32 m0, s39, 104448
s_mov_b32 s37, 5996544
buffer_load_dwordx4 v21, s[8:11], s37 offen sc1 lds
s_add_u32 m0, s39, 105472
s_mov_b32 s37, 6012928
buffer_load_dwordx4 v21, s[8:11], s37 offen sc1 lds
s_waitcnt vmcnt(16)
s_barrier
s_add_u32 m0, s39, 0
s_mov_b32 s37, 6062080
buffer_load_dwordx4 v21, s[8:11], s37 offen sc1 lds
s_add_u32 m0, s39, 1024
s_mov_b32 s37, 6078464
buffer_load_dwordx4 v21, s[8:11], s37 offen sc1 lds
s_add_u32 m0, s39, 2048
s_mov_b32 s37, 6094848
buffer_load_dwordx4 v21, s[8:11], s37 offen sc1 lds
s_add_u32 m0, s39, 3072
s_mov_b32 s37, 6111232
buffer_load_dwordx4 v21, s[8:11], s37 offen sc1 lds
s_add_u32 m0, s39, 4096
s_mov_b32 s37, 6029312
buffer_load_dwordx4 v21, s[8:11], s37 offen sc1 lds
s_add_u32 m0, s39, 5120
s_mov_b32 s37, 6127616
buffer_load_dwordx4 v21, s[8:11], s37 offen sc1 lds
s_add_u32 m0, s39, 6144
s_mov_b32 s37, 6045696
buffer_load_dwordx4 v21, s[8:11], s37 offen sc1 lds
s_add_u32 m0, s39, 7168
s_mov_b32 s37, 6144000
buffer_load_dwordx4 v21, s[8:11], s37 offen sc1 lds
s_waitcnt vmcnt(16)
s_barrier
s_add_u32 m0, s39, 32768
s_mov_b32 s37, 6160384
buffer_load_dwordx4 v21, s[8:11], s37 offen sc1 lds
s_add_u32 m0, s39, 33792
s_mov_b32 s37, 6176768
buffer_load_dwordx4 v21, s[8:11], s37 offen sc1 lds
s_add_u32 m0, s39, 34816
s_mov_b32 s37, 6193152
buffer_load_dwordx4 v21, s[8:11], s37 offen sc1 lds
s_add_u32 m0, s39, 35840
s_mov_b32 s37, 6209536
buffer_load_dwordx4 v21, s[8:11], s37 offen sc1 lds
s_add_u32 m0, s39, 36864
s_mov_b32 s37, 6258688
buffer_load_dwordx4 v21, s[8:11], s37 offen sc1 lds
s_add_u32 m0, s39, 37888
s_mov_b32 s37, 6275072
buffer_load_dwordx4 v21, s[8:11], s37 offen sc1 lds
s_add_u32 m0, s39, 38912
s_mov_b32 s37, 6291456
buffer_load_dwordx4 v21, s[8:11], s37 offen sc1 lds
s_add_u32 m0, s39, 39936
s_mov_b32 s37, 6307840
buffer_load_dwordx4 v21, s[8:11], s37 offen sc1 lds
s_waitcnt vmcnt(16)
s_barrier
s_add_u32 m0, s39, 65536
s_mov_b32 s37, 6225920
buffer_load_dwordx4 v21, s[8:11], s37 offen sc1 lds
s_add_u32 m0, s39, 66560
s_mov_b32 s37, 6324224
buffer_load_dwordx4 v21, s[8:11], s37 offen sc1 lds
s_add_u32 m0, s39, 67584
s_mov_b32 s37, 6242304
buffer_load_dwordx4 v21, s[8:11], s37 offen sc1 lds
s_add_u32 m0, s39, 68608
s_mov_b32 s37, 6340608
buffer_load_dwordx4 v21, s[8:11], s37 offen sc1 lds
s_add_u32 m0, s39, 69632
s_mov_b32 s37, 6356992
buffer_load_dwordx4 v21, s[8:11], s37 offen sc1 lds
s_add_u32 m0, s39, 70656
s_mov_b32 s37, 6373376
buffer_load_dwordx4 v21, s[8:11], s37 offen sc1 lds
s_add_u32 m0, s39, 71680
s_mov_b32 s37, 6389760
buffer_load_dwordx4 v21, s[8:11], s37 offen sc1 lds
s_add_u32 m0, s39, 72704
s_mov_b32 s37, 6406144
buffer_load_dwordx4 v21, s[8:11], s37 offen sc1 lds
s_waitcnt vmcnt(16)
s_barrier
s_add_u32 m0, s39, 98304
s_mov_b32 s37, 6455296
buffer_load_dwordx4 v21, s[8:11], s37 offen sc1 lds
s_add_u32 m0, s39, 99328
s_mov_b32 s37, 6471680
buffer_load_dwordx4 v21, s[8:11], s37 offen sc1 lds
s_add_u32 m0, s39, 100352
s_mov_b32 s37, 6488064
buffer_load_dwordx4 v21, s[8:11], s37 offen sc1 lds
s_add_u32 m0, s39, 101376
s_mov_b32 s37, 6504448
buffer_load_dwordx4 v21, s[8:11], s37 offen sc1 lds
s_add_u32 m0, s39, 102400
s_mov_b32 s37, 6422528
buffer_load_dwordx4 v21, s[8:11], s37 offen sc1 lds
s_add_u32 m0, s39, 103424
s_mov_b32 s37, 6520832
buffer_load_dwordx4 v21, s[8:11], s37 offen sc1 lds
s_add_u32 m0, s39, 104448
s_mov_b32 s37, 6438912
buffer_load_dwordx4 v21, s[8:11], s37 offen sc1 lds
s_add_u32 m0, s39, 105472
s_mov_b32 s37, 6537216
buffer_load_dwordx4 v21, s[8:11], s37 offen sc1 lds
s_waitcnt vmcnt(16)
s_barrier
s_add_u32 m0, s39, 0
s_mov_b32 s37, 6553600
buffer_load_dwordx4 v21, s[8:11], s37 offen sc1 lds
s_add_u32 m0, s39, 1024
s_mov_b32 s37, 6569984
buffer_load_dwordx4 v21, s[8:11], s37 offen sc1 lds
s_add_u32 m0, s39, 2048
s_mov_b32 s37, 6586368
buffer_load_dwordx4 v21, s[8:11], s37 offen sc1 lds
s_add_u32 m0, s39, 3072
s_mov_b32 s37, 6602752
buffer_load_dwordx4 v21, s[8:11], s37 offen sc1 lds
s_add_u32 m0, s39, 4096
s_mov_b32 s37, 6651904
buffer_load_dwordx4 v21, s[8:11], s37 offen sc1 lds
s_add_u32 m0, s39, 5120
s_mov_b32 s37, 6668288
buffer_load_dwordx4 v21, s[8:11], s37 offen sc1 lds
s_add_u32 m0, s39, 6144
s_mov_b32 s37, 6684672
buffer_load_dwordx4 v21, s[8:11], s37 offen sc1 lds
s_add_u32 m0, s39, 7168
s_mov_b32 s37, 6701056
buffer_load_dwordx4 v21, s[8:11], s37 offen sc1 lds
s_waitcnt vmcnt(16)
s_barrier
s_add_u32 m0, s39, 32768
s_mov_b32 s37, 6619136
buffer_load_dwordx4 v21, s[8:11], s37 offen sc1 lds
s_add_u32 m0, s39, 33792
s_mov_b32 s37, 6717440
buffer_load_dwordx4 v21, s[8:11], s37 offen sc1 lds
s_add_u32 m0, s39, 34816
s_mov_b32 s37, 6635520
buffer_load_dwordx4 v21, s[8:11], s37 offen sc1 lds
s_add_u32 m0, s39, 35840
s_mov_b32 s37, 6733824
buffer_load_dwordx4 v21, s[8:11], s37 offen sc1 lds
s_add_u32 m0, s39, 36864
s_mov_b32 s37, 6750208
buffer_load_dwordx4 v21, s[8:11], s37 offen sc1 lds
s_add_u32 m0, s39, 37888
s_mov_b32 s37, 6766592
buffer_load_dwordx4 v21, s[8:11], s37 offen sc1 lds
s_add_u32 m0, s39, 38912
s_mov_b32 s37, 6782976
buffer_load_dwordx4 v21, s[8:11], s37 offen sc1 lds
s_add_u32 m0, s39, 39936
s_mov_b32 s37, 6799360
buffer_load_dwordx4 v21, s[8:11], s37 offen sc1 lds
s_waitcnt vmcnt(16)
s_barrier
s_add_u32 m0, s39, 65536
s_mov_b32 s37, 6848512
buffer_load_dwordx4 v21, s[8:11], s37 offen sc1 lds
s_add_u32 m0, s39, 66560
s_mov_b32 s37, 6864896
buffer_load_dwordx4 v21, s[8:11], s37 offen sc1 lds
s_add_u32 m0, s39, 67584
s_mov_b32 s37, 6881280
buffer_load_dwordx4 v21, s[8:11], s37 offen sc1 lds
s_add_u32 m0, s39, 68608
s_mov_b32 s37, 6897664
buffer_load_dwordx4 v21, s[8:11], s37 offen sc1 lds
s_add_u32 m0, s39, 69632
s_mov_b32 s37, 6815744
buffer_load_dwordx4 v21, s[8:11], s37 offen sc1 lds
s_add_u32 m0, s39, 70656
s_mov_b32 s37, 6914048
buffer_load_dwordx4 v21, s[8:11], s37 offen sc1 lds
s_add_u32 m0, s39, 71680
s_mov_b32 s37, 6832128
buffer_load_dwordx4 v21, s[8:11], s37 offen sc1 lds
s_add_u32 m0, s39, 72704
s_mov_b32 s37, 6930432
buffer_load_dwordx4 v21, s[8:11], s37 offen sc1 lds
s_waitcnt vmcnt(16)
s_barrier
s_add_u32 m0, s39, 98304
s_mov_b32 s37, 6946816
buffer_load_dwordx4 v21, s[8:11], s37 offen sc1 lds
s_add_u32 m0, s39, 99328
s_mov_b32 s37, 6963200
buffer_load_dwordx4 v21, s[8:11], s37 offen sc1 lds
s_add_u32 m0, s39, 100352
s_mov_b32 s37, 6979584
buffer_load_dwordx4 v21, s[8:11], s37 offen sc1 lds
s_add_u32 m0, s39, 101376
s_mov_b32 s37, 6995968
buffer_load_dwordx4 v21, s[8:11], s37 offen sc1 lds
s_add_u32 m0, s39, 102400
s_mov_b32 s37, 7045120
buffer_load_dwordx4 v21, s[8:11], s37 offen sc1 lds
s_add_u32 m0, s39, 103424
s_mov_b32 s37, 7061504
buffer_load_dwordx4 v21, s[8:11], s37 offen sc1 lds
s_add_u32 m0, s39, 104448
s_mov_b32 s37, 7077888
buffer_load_dwordx4 v21, s[8:11], s37 offen sc1 lds
s_add_u32 m0, s39, 105472
s_mov_b32 s37, 7094272
buffer_load_dwordx4 v21, s[8:11], s37 offen sc1 lds
s_waitcnt vmcnt(16)
s_barrier
s_add_u32 m0, s39, 0
s_mov_b32 s37, 7012352
buffer_load_dwordx4 v21, s[8:11], s37 offen sc1 lds
s_add_u32 m0, s39, 1024
s_mov_b32 s37, 7110656
buffer_load_dwordx4 v21, s[8:11], s37 offen sc1 lds
s_add_u32 m0, s39, 2048
s_mov_b32 s37, 7028736
buffer_load_dwordx4 v21, s[8:11], s37 offen sc1 lds
s_add_u32 m0, s39, 3072
s_mov_b32 s37, 7127040
buffer_load_dwordx4 v21, s[8:11], s37 offen sc1 lds
s_add_u32 m0, s39, 4096
s_mov_b32 s37, 7143424
buffer_load_dwordx4 v21, s[8:11], s37 offen sc1 lds
s_add_u32 m0, s39, 5120
s_mov_b32 s37, 7159808
buffer_load_dwordx4 v21, s[8:11], s37 offen sc1 lds
s_add_u32 m0, s39, 6144
s_mov_b32 s37, 7176192
buffer_load_dwordx4 v21, s[8:11], s37 offen sc1 lds
s_add_u32 m0, s39, 7168
s_mov_b32 s37, 7192576
buffer_load_dwordx4 v21, s[8:11], s37 offen sc1 lds
s_waitcnt vmcnt(16)
s_barrier
s_add_u32 m0, s39, 32768
s_mov_b32 s37, 7241728
buffer_load_dwordx4 v21, s[8:11], s37 offen sc1 lds
s_add_u32 m0, s39, 33792
s_mov_b32 s37, 7258112
buffer_load_dwordx4 v21, s[8:11], s37 offen sc1 lds
s_add_u32 m0, s39, 34816
s_mov_b32 s37, 7274496
buffer_load_dwordx4 v21, s[8:11], s37 offen sc1 lds
s_add_u32 m0, s39, 35840
s_mov_b32 s37, 7290880
buffer_load_dwordx4 v21, s[8:11], s37 offen sc1 lds
s_add_u32 m0, s39, 36864
s_mov_b32 s37, 7208960
buffer_load_dwordx4 v21, s[8:11], s37 offen sc1 lds
s_add_u32 m0, s39, 37888
s_mov_b32 s37, 7307264
buffer_load_dwordx4 v21, s[8:11], s37 offen sc1 lds
s_add_u32 m0, s39, 38912
s_mov_b32 s37, 7225344
buffer_load_dwordx4 v21, s[8:11], s37 offen sc1 lds
s_add_u32 m0, s39, 39936
s_mov_b32 s37, 7323648
buffer_load_dwordx4 v21, s[8:11], s37 offen sc1 lds
s_waitcnt vmcnt(16)
s_barrier
s_waitcnt vmcnt(8)
s_barrier
s_waitcnt vmcnt(0)
s_barrier
s_branch Ldone_1
L7b_48:
v_mfma_f32_16x16x32_bf16 v[128:131], v[96:99], v[80:83], v[128:131]
v_mfma_f32_16x16x32_bf16 v[132:135], v[96:99], v[84:87], v[132:135]
v_mfma_f32_16x16x32_bf16 v[136:139], v[96:99], v[88:91], v[136:139]
v_mfma_f32_16x16x32_bf16 v[140:143], v[96:99], v[92:95], v[140:143]
v_mfma_f32_16x16x32_bf16 v[188:191], v[108:111], v[92:95], v[188:191]
v_mfma_f32_16x16x32_bf16 v[184:187], v[108:111], v[88:91], v[184:187]
v_mfma_f32_16x16x32_bf16 v[180:183], v[108:111], v[84:87], v[180:183]
v_mfma_f32_16x16x32_bf16 v[176:179], v[108:111], v[80:83], v[176:179]
v_mfma_f32_16x16x32_bf16 v[144:147], v[100:103], v[80:83], v[144:147]
v_mfma_f32_16x16x32_bf16 v[148:151], v[100:103], v[84:87], v[148:151]
v_mfma_f32_16x16x32_bf16 v[152:155], v[100:103], v[88:91], v[152:155]
v_mfma_f32_16x16x32_bf16 v[156:159], v[100:103], v[92:95], v[156:159]
v_mfma_f32_16x16x32_bf16 v[204:207], v[112:115], v[92:95], v[204:207]
v_mfma_f32_16x16x32_bf16 v[200:203], v[112:115], v[88:91], v[200:203]
v_mfma_f32_16x16x32_bf16 v[196:199], v[112:115], v[84:87], v[196:199]
v_mfma_f32_16x16x32_bf16 v[192:195], v[112:115], v[80:83], v[192:195]
v_mfma_f32_16x16x32_bf16 v[160:163], v[104:107], v[80:83], v[160:163]
v_mfma_f32_16x16x32_bf16 v[164:167], v[104:107], v[84:87], v[164:167]
v_mfma_f32_16x16x32_bf16 v[168:171], v[104:107], v[88:91], v[168:171]
v_mfma_f32_16x16x32_bf16 v[172:175], v[104:107], v[92:95], v[172:175]
v_mfma_f32_16x16x32_bf16 v[220:223], v[116:119], v[92:95], v[220:223]
v_mfma_f32_16x16x32_bf16 v[216:219], v[116:119], v[88:91], v[216:219]
v_mfma_f32_16x16x32_bf16 v[212:215], v[116:119], v[84:87], v[212:215]
v_mfma_f32_16x16x32_bf16 v[208:211], v[116:119], v[80:83], v[208:211]
s_mul_i32 s43, s38, 32
s_add_u32 s37, s37, s43
s_setprio 0
s_barrier
s_mov_b32 s80, s60
s_mov_b32 s81, s61
s_mov_b32 s82, 7340032
s_mov_b32 s83, 0x20000
v_and_b32 v29, 31, v1
v_lshlrev_b32 v29, 11, v29
s_and_b32 s43, s35, 8
s_or_b32 s43, s43, 3
s_lshl_b32 s43, s43, 7
v_add_u32 v29, s43, v29
s_add_u32 s37, s37, s54
s_add_u32 m0, s39, 65536
s_add_u32 s37, s37, s40
buffer_load_dwordx4 v21, s[8:11], s37 offen sc1 lds
v_mul_f32 v80, v128, v128
v_mul_f32 v81, v129, v129
v_mul_f32 v82, v130, v130
v_mul_f32 v83, v131, v131
v_fma_f32 v80, v80, v232, v228
v_fma_f32 v81, v81, v232, v228
v_fma_f32 v82, v82, v232, v228
s_add_u32 m0, s39, 66560
s_add_u32 s37, s37, s38
buffer_load_dwordx4 v21, s[8:11], s37 offen sc1 lds
v_fma_f32 v83, v83, v232, v228
v_mul_f32 v80, v80, v128
v_mul_f32 v81, v81, v129
v_mul_f32 v82, v82, v130
v_mul_f32 v83, v83, v131
v_exp_f32 v80, v80
s_add_u32 m0, s39, 67584
s_add_u32 s37, s37, s38
buffer_load_dwordx4 v21, s[8:11], s37 offen sc1 lds
v_exp_f32 v81, v81
v_exp_f32 v82, v82
v_exp_f32 v83, v83
v_mul_f32 v176, v128, v176
v_mul_f32 v177, v129, v177
v_mul_f32 v178, v130, v178
v_mul_f32 v179, v131, v179
s_add_u32 m0, s39, 68608
s_add_u32 s37, s37, s38
buffer_load_dwordx4 v21, s[8:11], s37 offen sc1 lds
v_fma_f32 v80, v80, v236, v236
v_fma_f32 v81, v81, v236, v236
v_fma_f32 v82, v82, v236, v236
v_fma_f32 v83, v83, v236, v236
v_rcp_f32 v80, v80
v_rcp_f32 v81, v81
s_add_u32 m0, s39, 69632
s_add_u32 s37, s37, s55
buffer_load_dwordx4 v21, s[8:11], s37 offen sc1 lds
v_rcp_f32 v82, v82
v_rcp_f32 v83, v83
v_mul_f32 v176, v176, v80
v_mul_f32 v177, v177, v81
v_mul_f32 v178, v178, v82
v_mul_f32 v179, v179, v83
v_cvt_pk_bf16_f32 v96, v176, v177
s_add_u32 m0, s39, 70656
s_add_u32 s37, s37, s38
buffer_load_dwordx4 v21, s[8:11], s37 offen sc1 lds
v_cvt_pk_bf16_f32 v97, v178, v179
v_mul_f32 v84, v144, v144
v_mul_f32 v85, v145, v145
v_mul_f32 v86, v146, v146
v_mul_f32 v87, v147, v147
v_fma_f32 v84, v84, v232, v228
s_add_u32 m0, s39, 71680
s_add_u32 s37, s37, s38
buffer_load_dwordx4 v21, s[8:11], s37 offen sc1 lds
v_fma_f32 v85, v85, v232, v228
v_fma_f32 v86, v86, v232, v228
v_fma_f32 v87, v87, v232, v228
v_mul_f32 v84, v84, v144
v_mul_f32 v85, v85, v145
v_mul_f32 v86, v86, v146
v_mul_f32 v87, v87, v147
s_add_u32 m0, s39, 72704
s_add_u32 s37, s37, s38
buffer_load_dwordx4 v21, s[8:11], s37 offen sc1 lds
v_exp_f32 v84, v84
v_exp_f32 v85, v85
v_exp_f32 v86, v86
v_exp_f32 v87, v87
v_mul_f32 v192, v144, v192
v_mul_f32 v193, v145, v193
s_barrier
s_lshr_b32 s44, s2, 3
s_lshl_b32 s44, s44, 17
s_add_u32 s43, s44, 65536
buffer_load_dword v30, v29, s[80:83], s43 offen
s_add_u32 m0, s39, 98304
s_add_u32 s37, s37, s40
buffer_load_dwordx4 v21, s[8:11], s37 offen sc1 lds
v_mul_f32 v194, v146, v194
v_mul_f32 v195, v147, v195
v_fma_f32 v84, v84, v236, v236
v_fma_f32 v85, v85, v236, v236
v_fma_f32 v86, v86, v236, v236
v_fma_f32 v87, v87, v236, v236
v_rcp_f32 v84, v84
s_add_u32 m0, s39, 99328
s_add_u32 s37, s37, s38
buffer_load_dwordx4 v21, s[8:11], s37 offen sc1 lds
v_rcp_f32 v85, v85
v_rcp_f32 v86, v86
v_rcp_f32 v87, v87
v_mul_f32 v192, v192, v84
v_mul_f32 v193, v193, v85
v_mul_f32 v194, v194, v86
v_mul_f32 v195, v195, v87
s_add_u32 m0, s39, 100352
s_add_u32 s37, s37, s38
buffer_load_dwordx4 v21, s[8:11], s37 offen sc1 lds
v_cvt_pk_bf16_f32 v98, v192, v193
v_cvt_pk_bf16_f32 v99, v194, v195
v_mul_f32 v80, v160, v160
v_mul_f32 v81, v161, v161
v_mul_f32 v82, v162, v162
s_add_u32 m0, s39, 101376
s_add_u32 s37, s37, s38
buffer_load_dwordx4 v21, s[8:11], s37 offen sc1 lds
v_mul_f32 v83, v163, v163
v_fma_f32 v80, v80, v232, v228
v_fma_f32 v81, v81, v232, v228
v_fma_f32 v82, v82, v232, v228
v_fma_f32 v83, v83, v232, v228
v_mul_f32 v80, v80, v160
v_mul_f32 v81, v81, v161
s_add_u32 m0, s39, 102400
s_add_u32 s37, s37, s55
buffer_load_dwordx4 v21, s[8:11], s37 offen sc1 lds
v_mul_f32 v82, v82, v162
v_mul_f32 v83, v83, v163
v_exp_f32 v80, v80
v_exp_f32 v81, v81
v_exp_f32 v82, v82
v_exp_f32 v83, v83
v_mul_f32 v208, v160, v208
s_add_u32 m0, s39, 103424
s_add_u32 s37, s37, s38
buffer_load_dwordx4 v21, s[8:11], s37 offen sc1 lds
v_mul_f32 v209, v161, v209
v_mul_f32 v210, v162, v210
v_mul_f32 v211, v163, v211
v_fma_f32 v80, v80, v236, v236
v_fma_f32 v81, v81, v236, v236
v_fma_f32 v82, v82, v236, v236
s_add_u32 m0, s39, 104448
s_add_u32 s37, s37, s38
buffer_load_dwordx4 v21, s[8:11], s37 offen sc1 lds
v_fma_f32 v83, v83, v236, v236
v_rcp_f32 v80, v80
v_rcp_f32 v81, v81
v_rcp_f32 v82, v82
v_rcp_f32 v83, v83
v_mul_f32 v208, v208, v80
v_mul_f32 v209, v209, v81
s_add_u32 m0, s39, 105472
s_add_u32 s37, s37, s38
buffer_load_dwordx4 v21, s[8:11], s37 offen sc1 lds
v_mul_f32 v210, v210, v82
v_mul_f32 v211, v211, v83
v_cvt_pk_bf16_f32 v112, v208, v209
v_cvt_pk_bf16_f32 v113, v210, v211
v_mul_f32 v80, v132, v132
v_mul_f32 v81, v133, v133
buffer_store_dwordx4 v[96:99], v27, s[24:27], 0 offen offset:0 sc1
s_barrier
s_add_u32 m0, s39, 0
s_add_u32 s37, s37, s40
buffer_load_dwordx4 v21, s[8:11], s37 offen sc1 lds
v_mul_f32 v82, v134, v134
v_mul_f32 v83, v135, v135
v_fma_f32 v80, v80, v233, v229
v_fma_f32 v81, v81, v233, v229
v_fma_f32 v82, v82, v233, v229
v_fma_f32 v83, v83, v233, v229
v_mul_f32 v80, v80, v132
s_add_u32 m0, s39, 1024
s_add_u32 s37, s37, s38
buffer_load_dwordx4 v21, s[8:11], s37 offen sc1 lds
v_mul_f32 v81, v81, v133
v_mul_f32 v82, v82, v134
v_mul_f32 v83, v83, v135
v_exp_f32 v80, v80
v_exp_f32 v81, v81
v_exp_f32 v82, v82
s_add_u32 m0, s39, 2048
s_add_u32 s37, s37, s38
buffer_load_dwordx4 v21, s[8:11], s37 offen sc1 lds
v_exp_f32 v83, v83
v_mul_f32 v180, v132, v180
v_mul_f32 v181, v133, v181
v_mul_f32 v182, v134, v182
v_mul_f32 v183, v135, v183
v_fma_f32 v80, v80, v237, v237
v_fma_f32 v81, v81, v237, v237
s_add_u32 m0, s39, 3072
s_add_u32 s37, s37, s38
buffer_load_dwordx4 v21, s[8:11], s37 offen sc1 lds
v_fma_f32 v82, v82, v237, v237
v_fma_f32 v83, v83, v237, v237
v_rcp_f32 v80, v80
v_rcp_f32 v81, v81
v_rcp_f32 v82, v82
v_rcp_f32 v83, v83
s_add_u32 m0, s39, 4096
s_add_u32 s37, s37, s55
buffer_load_dwordx4 v21, s[8:11], s37 offen sc1 lds
v_mul_f32 v180, v180, v80
v_mul_f32 v181, v181, v81
v_mul_f32 v182, v182, v82
v_mul_f32 v183, v183, v83
v_cvt_pk_bf16_f32 v100, v180, v181
v_cvt_pk_bf16_f32 v101, v182, v183
v_mul_f32 v84, v148, v148
s_add_u32 m0, s39, 5120
s_add_u32 s37, s37, s38
buffer_load_dwordx4 v21, s[8:11], s37 offen sc1 lds
v_mul_f32 v85, v149, v149
v_mul_f32 v86, v150, v150
v_mul_f32 v87, v151, v151
v_fma_f32 v84, v84, v233, v229
v_fma_f32 v85, v85, v233, v229
v_fma_f32 v86, v86, v233, v229
s_add_u32 m0, s39, 6144
s_add_u32 s37, s37, s38
buffer_load_dwordx4 v21, s[8:11], s37 offen sc1 lds
v_fma_f32 v87, v87, v233, v229
v_mul_f32 v84, v84, v148
v_mul_f32 v85, v85, v149
v_mul_f32 v86, v86, v150
v_mul_f32 v87, v87, v151
v_exp_f32 v84, v84
v_exp_f32 v85, v85
s_add_u32 m0, s39, 7168
s_add_u32 s37, s37, s38
buffer_load_dwordx4 v21, s[8:11], s37 offen sc1 lds
v_exp_f32 v86, v86
v_exp_f32 v87, v87
v_mul_f32 v196, v148, v196
v_mul_f32 v197, v149, v197
v_mul_f32 v198, v150, v198
v_mul_f32 v199, v151, v199
s_waitcnt vmcnt(18)
s_barrier
s_add_u32 s43, s34, 48
s_lshl_b32 s43, s43, 7
v_mov_b32 v10, s43
v_mov_b32 v12, 16
buffer_load_dword v11, v10, s[56:59], 0 offen sc1
s_add_u32 m0, s39, 32768
s_add_u32 s37, s37, s40
buffer_load_dwordx4 v21, s[8:11], s37 offen sc1 lds
v_fma_f32 v84, v84, v237, v237
v_fma_f32 v85, v85, v237, v237
v_fma_f32 v86, v86, v237, v237
v_fma_f32 v87, v87, v237, v237
v_rcp_f32 v84, v84
v_rcp_f32 v85, v85
v_rcp_f32 v86, v86
s_add_u32 m0, s39, 33792
s_add_u32 s37, s37, s38
buffer_load_dwordx4 v21, s[8:11], s37 offen sc1 lds
v_rcp_f32 v87, v87
v_mul_f32 v196, v196, v84
v_mul_f32 v197, v197, v85
v_mul_f32 v198, v198, v86
v_mul_f32 v199, v199, v87
v_cvt_pk_bf16_f32 v102, v196, v197
v_cvt_pk_bf16_f32 v103, v198, v199
s_add_u32 m0, s39, 34816
s_add_u32 s37, s37, s38
buffer_load_dwordx4 v21, s[8:11], s37 offen sc1 lds
v_mul_f32 v80, v164, v164
v_mul_f32 v81, v165, v165
v_mul_f32 v82, v166, v166
v_mul_f32 v83, v167, v167
v_fma_f32 v80, v80, v233, v229
s_add_u32 m0, s39, 35840
s_add_u32 s37, s37, s38
buffer_load_dwordx4 v21, s[8:11], s37 offen sc1 lds
v_fma_f32 v81, v81, v233, v229
v_fma_f32 v82, v82, v233, v229
v_fma_f32 v83, v83, v233, v229
v_mul_f32 v80, v80, v164
v_mul_f32 v81, v81, v165
v_mul_f32 v82, v82, v166
v_mul_f32 v83, v83, v167
s_add_u32 m0, s39, 36864
s_add_u32 s37, s37, s55
buffer_load_dwordx4 v21, s[8:11], s37 offen sc1 lds
v_exp_f32 v80, v80
v_exp_f32 v81, v81
v_exp_f32 v82, v82
v_exp_f32 v83, v83
v_mul_f32 v212, v164, v212
v_mul_f32 v213, v165, v213
v_mul_f32 v214, v166, v214
s_add_u32 m0, s39, 37888
s_add_u32 s37, s37, s38
buffer_load_dwordx4 v21, s[8:11], s37 offen sc1 lds
v_mul_f32 v215, v167, v215
v_fma_f32 v80, v80, v237, v237
v_fma_f32 v81, v81, v237, v237
v_fma_f32 v82, v82, v237, v237
v_fma_f32 v83, v83, v237, v237
v_rcp_f32 v80, v80
s_add_u32 m0, s39, 38912
s_add_u32 s37, s37, s38
buffer_load_dwordx4 v21, s[8:11], s37 offen sc1 lds
v_rcp_f32 v81, v81
v_rcp_f32 v82, v82
v_rcp_f32 v83, v83
v_mul_f32 v212, v212, v80
v_mul_f32 v213, v213, v81
v_mul_f32 v214, v214, v82
v_mul_f32 v215, v215, v83
s_add_u32 m0, s39, 39936
s_add_u32 s37, s37, s38
buffer_load_dwordx4 v21, s[8:11], s37 offen sc1 lds
v_cvt_pk_bf16_f32 v114, v212, v213
v_cvt_pk_bf16_f32 v115, v214, v215
s_nop 1
v_permlane32_swap_b32 v112, v114
v_permlane32_swap_b32 v113, v115
buffer_store_dwordx4 v[100:103], v27, s[24:27], 0 offen offset:256 sc1
buffer_store_dwordx4 v[112:115], v28, s[24:27], 0 offen offset:0 sc1
s_waitcnt vmcnt(20)
s_barrier
s_add_u32 m0, s39, 65536
s_add_u32 s37, s37, s40
buffer_load_dwordx4 v21, s[8:11], s37 offen sc1 lds
v_mul_f32 v80, v136, v136
v_mul_f32 v81, v137, v137
v_mul_f32 v82, v138, v138
v_mul_f32 v83, v139, v139
v_fma_f32 v80, v80, v234, v230
v_fma_f32 v81, v81, v234, v230
v_fma_f32 v82, v82, v234, v230
s_add_u32 m0, s39, 66560
s_add_u32 s37, s37, s38
buffer_load_dwordx4 v21, s[8:11], s37 offen sc1 lds
v_fma_f32 v83, v83, v234, v230
v_mul_f32 v80, v80, v136
v_mul_f32 v81, v81, v137
v_mul_f32 v82, v82, v138
v_mul_f32 v83, v83, v139
v_exp_f32 v80, v80
s_add_u32 m0, s39, 67584
s_add_u32 s37, s37, s38
buffer_load_dwordx4 v21, s[8:11], s37 offen sc1 lds
v_exp_f32 v81, v81
v_exp_f32 v82, v82
v_exp_f32 v83, v83
v_mul_f32 v184, v136, v184
v_mul_f32 v185, v137, v185
v_mul_f32 v186, v138, v186
v_mul_f32 v187, v139, v187
s_add_u32 m0, s39, 68608
s_add_u32 s37, s37, s38
buffer_load_dwordx4 v21, s[8:11], s37 offen sc1 lds
v_fma_f32 v80, v80, v238, v238
v_fma_f32 v81, v81, v238, v238
v_fma_f32 v82, v82, v238, v238
v_fma_f32 v83, v83, v238, v238
v_rcp_f32 v80, v80
v_rcp_f32 v81, v81
s_add_u32 m0, s39, 69632
s_add_u32 s37, s37, s55
buffer_load_dwordx4 v21, s[8:11], s37 offen sc1 lds
v_rcp_f32 v82, v82
v_rcp_f32 v83, v83
v_mul_f32 v184, v184, v80
v_mul_f32 v185, v185, v81
v_mul_f32 v186, v186, v82
v_mul_f32 v187, v187, v83
v_cvt_pk_bf16_f32 v104, v184, v185
s_add_u32 m0, s39, 70656
s_add_u32 s37, s37, s38
buffer_load_dwordx4 v21, s[8:11], s37 offen sc1 lds
v_cvt_pk_bf16_f32 v105, v186, v187
v_mul_f32 v84, v152, v152
v_mul_f32 v85, v153, v153
v_mul_f32 v86, v154, v154
v_mul_f32 v87, v155, v155
v_fma_f32 v84, v84, v234, v230
s_add_u32 m0, s39, 71680
s_add_u32 s37, s37, s38
buffer_load_dwordx4 v21, s[8:11], s37 offen sc1 lds
v_fma_f32 v85, v85, v234, v230
v_fma_f32 v86, v86, v234, v230
v_fma_f32 v87, v87, v234, v230
v_mul_f32 v84, v84, v152
v_mul_f32 v85, v85, v153
v_mul_f32 v86, v86, v154
v_mul_f32 v87, v87, v155
s_add_u32 m0, s39, 72704
s_add_u32 s37, s37, s38
buffer_load_dwordx4 v21, s[8:11], s37 offen sc1 lds
v_exp_f32 v84, v84
v_exp_f32 v85, v85
v_exp_f32 v86, v86
v_exp_f32 v87, v87
v_mul_f32 v200, v152, v200
v_mul_f32 v201, v153, v201
s_waitcnt vmcnt(19)
s_barrier
s_add_u32 m0, s39, 98304
s_add_u32 s37, s37, s40
buffer_load_dwordx4 v21, s[8:11], s37 offen sc1 lds
v_mul_f32 v202, v154, v202
v_mul_f32 v203, v155, v203
v_fma_f32 v84, v84, v238, v238
v_fma_f32 v85, v85, v238, v238
v_fma_f32 v86, v86, v238, v238
v_fma_f32 v87, v87, v238, v238
v_rcp_f32 v84, v84
s_add_u32 m0, s39, 99328
s_add_u32 s37, s37, s38
buffer_load_dwordx4 v21, s[8:11], s37 offen sc1 lds
v_rcp_f32 v85, v85
v_rcp_f32 v86, v86
v_rcp_f32 v87, v87
v_mul_f32 v200, v200, v84
v_mul_f32 v201, v201, v85
v_mul_f32 v202, v202, v86
v_mul_f32 v203, v203, v87
s_add_u32 m0, s39, 100352
s_add_u32 s37, s37, s38
buffer_load_dwordx4 v21, s[8:11], s37 offen sc1 lds
v_cvt_pk_bf16_f32 v106, v200, v201
v_cvt_pk_bf16_f32 v107, v202, v203
v_mul_f32 v80, v168, v168
v_mul_f32 v81, v169, v169
v_mul_f32 v82, v170, v170
s_add_u32 m0, s39, 101376
s_add_u32 s37, s37, s38
buffer_load_dwordx4 v21, s[8:11], s37 offen sc1 lds
v_mul_f32 v83, v171, v171
v_fma_f32 v80, v80, v234, v230
v_fma_f32 v81, v81, v234, v230
v_fma_f32 v82, v82, v234, v230
v_fma_f32 v83, v83, v234, v230
v_mul_f32 v80, v80, v168
v_mul_f32 v81, v81, v169
s_add_u32 m0, s39, 102400
s_add_u32 s37, s37, s55
buffer_load_dwordx4 v21, s[8:11], s37 offen sc1 lds
v_mul_f32 v82, v82, v170
v_mul_f32 v83, v83, v171
v_exp_f32 v80, v80
v_exp_f32 v81, v81
v_exp_f32 v82, v82
v_exp_f32 v83, v83
v_mul_f32 v216, v168, v216
s_add_u32 m0, s39, 103424
s_add_u32 s37, s37, s38
buffer_load_dwordx4 v21, s[8:11], s37 offen sc1 lds
v_mul_f32 v217, v169, v217
v_mul_f32 v218, v170, v218
v_mul_f32 v219, v171, v219
v_fma_f32 v80, v80, v238, v238
v_fma_f32 v81, v81, v238, v238
v_fma_f32 v82, v82, v238, v238
s_add_u32 m0, s39, 104448
s_add_u32 s37, s37, s38
buffer_load_dwordx4 v21, s[8:11], s37 offen sc1 lds
v_fma_f32 v83, v83, v238, v238
v_rcp_f32 v80, v80
v_rcp_f32 v81, v81
v_rcp_f32 v82, v82
v_rcp_f32 v83, v83
v_mul_f32 v216, v216, v80
v_mul_f32 v217, v217, v81
s_add_u32 m0, s39, 105472
s_add_u32 s37, s37, s38
buffer_load_dwordx4 v21, s[8:11], s37 offen sc1 lds
v_mul_f32 v218, v218, v82
v_mul_f32 v219, v219, v83
v_cvt_pk_bf16_f32 v116, v216, v217
v_cvt_pk_bf16_f32 v117, v218, v219
v_mul_f32 v80, v140, v140
v_mul_f32 v81, v141, v141
buffer_store_dwordx4 v[104:107], v27, s[24:27], 0 offen offset:512 sc1
s_waitcnt vmcnt(19)
s_mov_b32 s41, 0x10000
s_waitcnt vmcnt(27)
s_branch Lpf_52
Lpoll_50:
s_waitcnt vmcnt(0)
Lpf_52:
v_cmp_ne_u32 vcc, v12, v11
s_nop 4
s_cbranch_vccz Lpok_51
buffer_load_dword v11, v10, s[56:59], 0 offen sc1
s_sub_u32 s41, s41, 1
s_cmp_lg_u32 s41, 0
s_cbranch_scc1 Lpoll_50
s_waitcnt vmcnt(0)
Lpok_51:
s_barrier
s_add_u32 s37, s37, s29
s_add_u32 m0, s39, 0
s_add_u32 s37, s37, s40
buffer_load_dwordx4 v21, s[8:11], s37 offen sc1 lds
v_mul_f32 v82, v142, v142
v_mul_f32 v83, v143, v143
v_fma_f32 v80, v80, v235, v231
v_fma_f32 v81, v81, v235, v231
v_fma_f32 v82, v82, v235, v231
v_fma_f32 v83, v83, v235, v231
v_mul_f32 v80, v80, v140
s_add_u32 m0, s39, 1024
s_add_u32 s37, s37, s38
buffer_load_dwordx4 v21, s[8:11], s37 offen sc1 lds
v_mul_f32 v81, v81, v141
v_mul_f32 v82, v82, v142
v_mul_f32 v83, v83, v143
v_exp_f32 v80, v80
v_exp_f32 v81, v81
v_exp_f32 v82, v82
s_add_u32 m0, s39, 2048
s_add_u32 s37, s37, s38
buffer_load_dwordx4 v21, s[8:11], s37 offen sc1 lds
v_exp_f32 v83, v83
v_mul_f32 v188, v140, v188
v_mul_f32 v189, v141, v189
v_mul_f32 v190, v142, v190
v_mul_f32 v191, v143, v191
v_fma_f32 v80, v80, v239, v239
v_fma_f32 v81, v81, v239, v239
s_add_u32 m0, s39, 3072
s_add_u32 s37, s37, s38
buffer_load_dwordx4 v21, s[8:11], s37 offen sc1 lds
v_fma_f32 v82, v82, v239, v239
v_fma_f32 v83, v83, v239, v239
v_rcp_f32 v80, v80
v_rcp_f32 v81, v81
v_rcp_f32 v82, v82
v_rcp_f32 v83, v83
s_add_u32 m0, s39, 4096
s_add_u32 s37, s37, s55
buffer_load_dwordx4 v21, s[8:11], s37 offen sc1 lds
v_mul_f32 v188, v188, v80
v_mul_f32 v189, v189, v81
v_mul_f32 v190, v190, v82
v_mul_f32 v191, v191, v83
v_cvt_pk_bf16_f32 v108, v188, v189
v_cvt_pk_bf16_f32 v109, v190, v191
v_mul_f32 v84, v156, v156
s_add_u32 m0, s39, 5120
s_add_u32 s37, s37, s38
buffer_load_dwordx4 v21, s[8:11], s37 offen sc1 lds
v_mul_f32 v85, v157, v157
v_mul_f32 v86, v158, v158
v_mul_f32 v87, v159, v159
v_fma_f32 v84, v84, v235, v231
v_fma_f32 v85, v85, v235, v231
v_fma_f32 v86, v86, v235, v231
s_add_u32 m0, s39, 6144
s_add_u32 s37, s37, s38
buffer_load_dwordx4 v21, s[8:11], s37 offen sc1 lds
v_fma_f32 v87, v87, v235, v231
v_mul_f32 v84, v84, v156
v_mul_f32 v85, v85, v157
v_mul_f32 v86, v86, v158
v_mul_f32 v87, v87, v159
v_exp_f32 v84, v84
v_exp_f32 v85, v85
s_add_u32 m0, s39, 7168
s_add_u32 s37, s37, s38
buffer_load_dwordx4 v21, s[8:11], s37 offen sc1 lds
v_exp_f32 v86, v86
v_exp_f32 v87, v87
v_mul_f32 v204, v156, v204
v_mul_f32 v205, v157, v205
v_mul_f32 v206, v158, v206
v_mul_f32 v207, v159, v207
s_waitcnt vmcnt(17)
s_barrier
s_add_u32 m0, s39, 32768
s_add_u32 s37, s37, s40
buffer_load_dwordx4 v21, s[8:11], s37 offen sc1 lds
v_fma_f32 v84, v84, v239, v239
v_fma_f32 v85, v85, v239, v239
v_fma_f32 v86, v86, v239, v239
v_fma_f32 v87, v87, v239, v239
v_rcp_f32 v84, v84
v_rcp_f32 v85, v85
v_rcp_f32 v86, v86
s_add_u32 m0, s39, 33792
s_add_u32 s37, s37, s38
buffer_load_dwordx4 v21, s[8:11], s37 offen sc1 lds
v_rcp_f32 v87, v87
v_mul_f32 v204, v204, v84
v_mul_f32 v205, v205, v85
v_mul_f32 v206, v206, v86
v_mul_f32 v207, v207, v87
v_cvt_pk_bf16_f32 v110, v204, v205
v_cvt_pk_bf16_f32 v111, v206, v207
s_add_u32 m0, s39, 34816
s_add_u32 s37, s37, s38
buffer_load_dwordx4 v21, s[8:11], s37 offen sc1 lds
v_mul_f32 v80, v172, v172
v_mul_f32 v81, v173, v173
v_mul_f32 v82, v174, v174
v_mul_f32 v83, v175, v175
v_fma_f32 v80, v80, v235, v231
s_add_u32 m0, s39, 35840
s_add_u32 s37, s37, s38
buffer_load_dwordx4 v21, s[8:11], s37 offen sc1 lds
v_fma_f32 v81, v81, v235, v231
v_fma_f32 v82, v82, v235, v231
v_fma_f32 v83, v83, v235, v231
v_mul_f32 v80, v80, v172
v_mul_f32 v81, v81, v173
v_mul_f32 v82, v82, v174
v_mul_f32 v83, v83, v175
s_add_u32 m0, s39, 36864
s_add_u32 s37, s37, s55
buffer_load_dwordx4 v21, s[8:11], s37 offen sc1 lds
v_exp_f32 v80, v80
v_exp_f32 v81, v81
v_exp_f32 v82, v82
v_exp_f32 v83, v83
v_mul_f32 v220, v172, v220
v_mul_f32 v221, v173, v221
v_mul_f32 v222, v174, v222
s_add_u32 m0, s39, 37888
s_add_u32 s37, s37, s38
buffer_load_dwordx4 v21, s[8:11], s37 offen sc1 lds
v_mul_f32 v223, v175, v223
v_fma_f32 v80, v80, v239, v239
v_fma_f32 v81, v81, v239, v239
v_fma_f32 v82, v82, v239, v239
v_fma_f32 v83, v83, v239, v239
v_rcp_f32 v80, v80
s_add_u32 m0, s39, 38912
s_add_u32 s37, s37, s38
buffer_load_dwordx4 v21, s[8:11], s37 offen sc1 lds
v_rcp_f32 v81, v81
v_rcp_f32 v82, v82
v_rcp_f32 v83, v83
v_mul_f32 v220, v220, v80
v_mul_f32 v221, v221, v81
v_mul_f32 v222, v222, v82
v_mul_f32 v223, v223, v83
s_add_u32 m0, s39, 39936
s_add_u32 s37, s37, s38
buffer_load_dwordx4 v21, s[8:11], s37 offen sc1 lds
v_cvt_pk_bf16_f32 v118, v220, v221
v_cvt_pk_bf16_f32 v119, v222, v223
s_nop 1
v_permlane32_swap_b32 v116, v118
v_permlane32_swap_b32 v117, v119
buffer_store_dwordx4 v[108:111], v27, s[24:27], 0 offen offset:768 sc1
buffer_store_dwordx4 v[116:119], v28, s[24:27], 0 offen offset:512 sc1
s_waitcnt vmcnt(19)
s_barrier
s_add_u32 m0, s39, 65536
s_add_u32 s37, s37, s40
buffer_load_dwordx4 v21, s[8:11], s37 offen sc1 lds
s_add_u32 m0, s39, 66560
s_add_u32 s37, s37, s38
buffer_load_dwordx4 v21, s[8:11], s37 offen sc1 lds
s_add_u32 m0, s39, 67584
s_add_u32 s37, s37, s38
buffer_load_dwordx4 v21, s[8:11], s37 offen sc1 lds
s_add_u32 m0, s39, 68608
s_add_u32 s37, s37, s38
buffer_load_dwordx4 v21, s[8:11], s37 offen sc1 lds
s_add_u32 m0, s39, 69632
s_add_u32 s37, s37, s55
buffer_load_dwordx4 v21, s[8:11], s37 offen sc1 lds
s_add_u32 m0, s39, 70656
s_add_u32 s37, s37, s38
buffer_load_dwordx4 v21, s[8:11], s37 offen sc1 lds
s_add_u32 m0, s39, 71680
s_add_u32 s37, s37, s38
buffer_load_dwordx4 v21, s[8:11], s37 offen sc1 lds
s_add_u32 m0, s39, 72704
s_add_u32 s37, s37, s38
buffer_load_dwordx4 v21, s[8:11], s37 offen sc1 lds
s_waitcnt vmcnt(8)
s_barrier
s_add_u32 s43, s34, 64
s_lshl_b32 s43, s43, 7
v_mov_b32 v10, s43
v_mov_b32 v11, 1
s_mov_b64 exec, 1
buffer_atomic_add v11, v10, s[56:59], 0 offen sc1
s_mov_b64 exec, -1
s_add_u32 m0, s39, 98304
s_add_u32 s37, s37, s40
buffer_load_dwordx4 v21, s[8:11], s37 offen sc1 lds
s_add_u32 m0, s39, 99328
s_add_u32 s37, s37, s38
buffer_load_dwordx4 v21, s[8:11], s37 offen sc1 lds
s_add_u32 m0, s39, 100352
s_add_u32 s37, s37, s38
buffer_load_dwordx4 v21, s[8:11], s37 offen sc1 lds
s_add_u32 m0, s39, 101376
s_add_u32 s37, s37, s38
buffer_load_dwordx4 v21, s[8:11], s37 offen sc1 lds
s_add_u32 m0, s39, 102400
s_add_u32 s37, s37, s55
buffer_load_dwordx4 v21, s[8:11], s37 offen sc1 lds
s_add_u32 m0, s39, 103424
s_add_u32 s37, s37, s38
buffer_load_dwordx4 v21, s[8:11], s37 offen sc1 lds
s_add_u32 m0, s39, 104448
s_add_u32 s37, s37, s38
buffer_load_dwordx4 v21, s[8:11], s37 offen sc1 lds
s_add_u32 m0, s39, 105472
s_add_u32 s37, s37, s38
buffer_load_dwordx4 v21, s[8:11], s37 offen sc1 lds
s_waitcnt vmcnt(19)
s_barrier
s_lshr_b32 s44, s2, 3
s_lshl_b32 s44, s44, 16
s_add_u32 s43, s44, 4194304
buffer_load_dword v30, v29, s[80:83], s43 offen
s_add_u32 m0, s39, 0
s_add_u32 s37, s37, s40
buffer_load_dwordx4 v21, s[8:11], s37 offen sc1 lds
s_add_u32 m0, s39, 1024
s_add_u32 s37, s37, s38
buffer_load_dwordx4 v21, s[8:11], s37 offen sc1 lds
s_add_u32 m0, s39, 2048
s_add_u32 s37, s37, s38
buffer_load_dwordx4 v21, s[8:11], s37 offen sc1 lds
s_add_u32 m0, s39, 3072
s_add_u32 s37, s37, s38
buffer_load_dwordx4 v21, s[8:11], s37 offen sc1 lds
s_add_u32 m0, s39, 4096
s_add_u32 s37, s37, s55
buffer_load_dwordx4 v21, s[8:11], s37 offen sc1 lds
s_add_u32 m0, s39, 5120
s_add_u32 s37, s37, s38
buffer_load_dwordx4 v21, s[8:11], s37 offen sc1 lds
s_add_u32 m0, s39, 6144
s_add_u32 s37, s37, s38
buffer_load_dwordx4 v21, s[8:11], s37 offen sc1 lds
s_add_u32 m0, s39, 7168
s_add_u32 s37, s37, s38
buffer_load_dwordx4 v21, s[8:11], s37 offen sc1 lds
s_waitcnt vmcnt(18)
s_barrier
s_add_u32 s43, s34, 64
s_lshl_b32 s43, s43, 7
v_mov_b32 v10, s43
v_mov_b32 v12, 16
buffer_load_dword v11, v10, s[56:59], 0 offen sc1
s_add_u32 m0, s39, 32768
s_add_u32 s37, s37, s40
buffer_load_dwordx4 v21, s[8:11], s37 offen sc1 lds
s_add_u32 m0, s39, 33792
s_add_u32 s37, s37, s38
buffer_load_dwordx4 v21, s[8:11], s37 offen sc1 lds
s_add_u32 m0, s39, 34816
s_add_u32 s37, s37, s38
buffer_load_dwordx4 v21, s[8:11], s37 offen sc1 lds
s_add_u32 m0, s39, 35840
s_add_u32 s37, s37, s38
buffer_load_dwordx4 v21, s[8:11], s37 offen sc1 lds
s_add_u32 m0, s39, 36864
s_add_u32 s37, s37, s55
buffer_load_dwordx4 v21, s[8:11], s37 offen sc1 lds
s_add_u32 m0, s39, 37888
s_add_u32 s37, s37, s38
buffer_load_dwordx4 v21, s[8:11], s37 offen sc1 lds
s_add_u32 m0, s39, 38912
s_add_u32 s37, s37, s38
buffer_load_dwordx4 v21, s[8:11], s37 offen sc1 lds
s_add_u32 m0, s39, 39936
s_add_u32 s37, s37, s38
buffer_load_dwordx4 v21, s[8:11], s37 offen sc1 lds
s_waitcnt vmcnt(18)
s_barrier
s_add_u32 m0, s39, 65536
s_add_u32 s37, s37, s40
buffer_load_dwordx4 v21, s[8:11], s37 offen sc1 lds
s_add_u32 m0, s39, 66560
s_add_u32 s37, s37, s38
buffer_load_dwordx4 v21, s[8:11], s37 offen sc1 lds
s_add_u32 m0, s39, 67584
s_add_u32 s37, s37, s38
buffer_load_dwordx4 v21, s[8:11], s37 offen sc1 lds
s_add_u32 m0, s39, 68608
s_add_u32 s37, s37, s38
buffer_load_dwordx4 v21, s[8:11], s37 offen sc1 lds
s_add_u32 m0, s39, 69632
s_add_u32 s37, s37, s55
buffer_load_dwordx4 v21, s[8:11], s37 offen sc1 lds
s_add_u32 m0, s39, 70656
s_add_u32 s37, s37, s38
buffer_load_dwordx4 v21, s[8:11], s37 offen sc1 lds
s_add_u32 m0, s39, 71680
s_add_u32 s37, s37, s38
buffer_load_dwordx4 v21, s[8:11], s37 offen sc1 lds
s_add_u32 m0, s39, 72704
s_add_u32 s37, s37, s38
buffer_load_dwordx4 v21, s[8:11], s37 offen sc1 lds
s_waitcnt vmcnt(17)
s_barrier
s_add_u32 m0, s39, 98304
s_add_u32 s37, s37, s40
buffer_load_dwordx4 v21, s[8:11], s37 offen sc1 lds
s_add_u32 m0, s39, 99328
s_add_u32 s37, s37, s38
buffer_load_dwordx4 v21, s[8:11], s37 offen sc1 lds
s_add_u32 m0, s39, 100352
s_add_u32 s37, s37, s38
buffer_load_dwordx4 v21, s[8:11], s37 offen sc1 lds
s_add_u32 m0, s39, 101376
s_add_u32 s37, s37, s38
buffer_load_dwordx4 v21, s[8:11], s37 offen sc1 lds
s_add_u32 m0, s39, 102400
s_add_u32 s37, s37, s55
buffer_load_dwordx4 v21, s[8:11], s37 offen sc1 lds
s_add_u32 m0, s39, 103424
s_add_u32 s37, s37, s38
buffer_load_dwordx4 v21, s[8:11], s37 offen sc1 lds
s_add_u32 m0, s39, 104448
s_add_u32 s37, s37, s38
buffer_load_dwordx4 v21, s[8:11], s37 offen sc1 lds
s_add_u32 m0, s39, 105472
s_add_u32 s37, s37, s38
buffer_load_dwordx4 v21, s[8:11], s37 offen sc1 lds
s_waitcnt vmcnt(16)
s_mov_b32 s41, 0x10000
s_waitcnt vmcnt(24)
s_branch Lpf_55
Lpoll_53:
s_waitcnt vmcnt(0)
Lpf_55:
v_cmp_ne_u32 vcc, v12, v11
s_nop 4
s_cbranch_vccz Lpok_54
buffer_load_dword v11, v10, s[56:59], 0 offen sc1
s_sub_u32 s41, s41, 1
s_cmp_lg_u32 s41, 0
s_cbranch_scc1 Lpoll_53
s_waitcnt vmcnt(0)
Lpok_54:
s_barrier
s_mul_i32 s40, s53, 786432
s_add_u32 m0, s39, 0
s_add_u32 s37, s40, 4194304
buffer_load_dwordx4 v21, s[8:11], s37 offen sc1 lds
s_add_u32 m0, s39, 1024
s_add_u32 s37, s40, 4210688
buffer_load_dwordx4 v21, s[8:11], s37 offen sc1 lds
s_add_u32 m0, s39, 2048
s_add_u32 s37, s40, 4227072
buffer_load_dwordx4 v21, s[8:11], s37 offen sc1 lds
s_add_u32 m0, s39, 3072
s_add_u32 s37, s40, 4243456
buffer_load_dwordx4 v21, s[8:11], s37 offen sc1 lds
s_add_u32 m0, s39, 4096
s_add_u32 s37, s40, 4292608
buffer_load_dwordx4 v21, s[8:11], s37 offen sc1 lds
s_add_u32 m0, s39, 5120
s_add_u32 s37, s40, 4308992
buffer_load_dwordx4 v21, s[8:11], s37 offen sc1 lds
s_add_u32 m0, s39, 6144
s_add_u32 s37, s40, 4325376
buffer_load_dwordx4 v21, s[8:11], s37 offen sc1 lds
s_add_u32 m0, s39, 7168
s_add_u32 s37, s40, 4341760
buffer_load_dwordx4 v21, s[8:11], s37 offen sc1 lds
s_waitcnt vmcnt(16)
s_barrier
s_add_u32 m0, s39, 32768
s_add_u32 s37, s40, 4259840
buffer_load_dwordx4 v21, s[8:11], s37 offen sc1 lds
s_add_u32 m0, s39, 33792
s_add_u32 s37, s40, 4358144
buffer_load_dwordx4 v21, s[8:11], s37 offen sc1 lds
s_add_u32 m0, s39, 34816
s_add_u32 s37, s40, 4276224
buffer_load_dwordx4 v21, s[8:11], s37 offen sc1 lds
s_add_u32 m0, s39, 35840
s_add_u32 s37, s40, 4374528
buffer_load_dwordx4 v21, s[8:11], s37 offen sc1 lds
s_add_u32 m0, s39, 36864
s_add_u32 s37, s40, 4390912
buffer_load_dwordx4 v21, s[8:11], s37 offen sc1 lds
s_add_u32 m0, s39, 37888
s_add_u32 s37, s40, 4407296
buffer_load_dwordx4 v21, s[8:11], s37 offen sc1 lds
s_add_u32 m0, s39, 38912
s_add_u32 s37, s40, 4423680
buffer_load_dwordx4 v21, s[8:11], s37 offen sc1 lds
s_add_u32 m0, s39, 39936
s_add_u32 s37, s40, 4440064
buffer_load_dwordx4 v21, s[8:11], s37 offen sc1 lds
s_waitcnt vmcnt(16)
s_barrier
s_add_u32 m0, s39, 65536
s_add_u32 s37, s40, 4489216
buffer_load_dwordx4 v21, s[8:11], s37 offen sc1 lds
s_add_u32 m0, s39, 66560
s_add_u32 s37, s40, 4505600
buffer_load_dwordx4 v21, s[8:11], s37 offen sc1 lds
s_add_u32 m0, s39, 67584
s_add_u32 s37, s40, 4521984
buffer_load_dwordx4 v21, s[8:11], s37 offen sc1 lds
s_add_u32 m0, s39, 68608
s_add_u32 s37, s40, 4538368
buffer_load_dwordx4 v21, s[8:11], s37 offen sc1 lds
s_add_u32 m0, s39, 69632
s_add_u32 s37, s40, 4456448
buffer_load_dwordx4 v21, s[8:11], s37 offen sc1 lds
s_add_u32 m0, s39, 70656
s_add_u32 s37, s40, 4554752
buffer_load_dwordx4 v21, s[8:11], s37 offen sc1 lds
s_add_u32 m0, s39, 71680
s_add_u32 s37, s40, 4472832
buffer_load_dwordx4 v21, s[8:11], s37 offen sc1 lds
s_add_u32 m0, s39, 72704
s_add_u32 s37, s40, 4571136
buffer_load_dwordx4 v21, s[8:11], s37 offen sc1 lds
s_waitcnt vmcnt(16)
s_barrier
s_add_u32 m0, s39, 98304
s_add_u32 s37, s40, 4587520
buffer_load_dwordx4 v21, s[8:11], s37 offen sc1 lds
s_add_u32 m0, s39, 99328
s_add_u32 s37, s40, 4603904
buffer_load_dwordx4 v21, s[8:11], s37 offen sc1 lds
s_add_u32 m0, s39, 100352
s_add_u32 s37, s40, 4620288
buffer_load_dwordx4 v21, s[8:11], s37 offen sc1 lds
s_add_u32 m0, s39, 101376
s_add_u32 s37, s40, 4636672
buffer_load_dwordx4 v21, s[8:11], s37 offen sc1 lds
s_add_u32 m0, s39, 102400
s_add_u32 s37, s40, 4685824
buffer_load_dwordx4 v21, s[8:11], s37 offen sc1 lds
s_add_u32 m0, s39, 103424
s_add_u32 s37, s40, 4702208
buffer_load_dwordx4 v21, s[8:11], s37 offen sc1 lds
s_add_u32 m0, s39, 104448
s_add_u32 s37, s40, 4718592
buffer_load_dwordx4 v21, s[8:11], s37 offen sc1 lds
s_add_u32 m0, s39, 105472
s_add_u32 s37, s40, 4734976
buffer_load_dwordx4 v21, s[8:11], s37 offen sc1 lds
s_waitcnt vmcnt(16)
s_barrier
s_add_u32 m0, s39, 0
s_add_u32 s37, s40, 4653056
buffer_load_dwordx4 v21, s[8:11], s37 offen sc1 lds
s_add_u32 m0, s39, 1024
s_add_u32 s37, s40, 4751360
buffer_load_dwordx4 v21, s[8:11], s37 offen sc1 lds
s_add_u32 m0, s39, 2048
s_add_u32 s37, s40, 4669440
buffer_load_dwordx4 v21, s[8:11], s37 offen sc1 lds
s_add_u32 m0, s39, 3072
s_add_u32 s37, s40, 4767744
buffer_load_dwordx4 v21, s[8:11], s37 offen sc1 lds
s_add_u32 m0, s39, 4096
s_add_u32 s37, s40, 4784128
buffer_load_dwordx4 v21, s[8:11], s37 offen sc1 lds
s_add_u32 m0, s39, 5120
s_add_u32 s37, s40, 4800512
buffer_load_dwordx4 v21, s[8:11], s37 offen sc1 lds
s_add_u32 m0, s39, 6144
s_add_u32 s37, s40, 4816896
buffer_load_dwordx4 v21, s[8:11], s37 offen sc1 lds
s_add_u32 m0, s39, 7168
s_add_u32 s37, s40, 4833280
buffer_load_dwordx4 v21, s[8:11], s37 offen sc1 lds
s_waitcnt vmcnt(16)
s_barrier
s_add_u32 m0, s39, 32768
s_add_u32 s37, s40, 4882432
buffer_load_dwordx4 v21, s[8:11], s37 offen sc1 lds
s_add_u32 m0, s39, 33792
s_add_u32 s37, s40, 4898816
buffer_load_dwordx4 v21, s[8:11], s37 offen sc1 lds
s_add_u32 m0, s39, 34816
s_add_u32 s37, s40, 4915200
buffer_load_dwordx4 v21, s[8:11], s37 offen sc1 lds
s_add_u32 m0, s39, 35840
s_add_u32 s37, s40, 4931584
buffer_load_dwordx4 v21, s[8:11], s37 offen sc1 lds
s_add_u32 m0, s39, 36864
s_add_u32 s37, s40, 4849664
buffer_load_dwordx4 v21, s[8:11], s37 offen sc1 lds
s_add_u32 m0, s39, 37888
s_add_u32 s37, s40, 4947968
buffer_load_dwordx4 v21, s[8:11], s37 offen sc1 lds
s_add_u32 m0, s39, 38912
s_add_u32 s37, s40, 4866048
buffer_load_dwordx4 v21, s[8:11], s37 offen sc1 lds
s_add_u32 m0, s39, 39936
s_add_u32 s37, s40, 4964352
buffer_load_dwordx4 v21, s[8:11], s37 offen sc1 lds
s_waitcnt vmcnt(16)
s_barrier
s_lshr_b32 s44, s2, 3
s_and_b32 s44, s44, 15
s_lshl_b32 s44, s44, 16
s_add_u32 s43, s44, 6291456
buffer_load_dword v30, v29, s[80:83], s43 offen
s_waitcnt vmcnt(9)
s_barrier
s_waitcnt vmcnt(1)
s_barrier
s_barrier
s_barrier
s_barrier
s_barrier
s_barrier
s_lshl_b32 s43, s34, 4
s_add_u32 s43, s43, s35
s_lshl_b32 s43, s43, 2
s_add_u32 s43, s43, 12288
v_mov_b32 v10, s43
v_mov_b32 v11, 1
s_mov_b64 exec, 1
buffer_store_dword v11, v10, s[56:59], 0 offen sc1
s_mov_b64 exec, -1
s_barrier
s_barrier
s_barrier
s_lshl_b32 s43, s34, 4
s_add_u32 s43, s43, s35
s_xor_b32 s43, s43, 1
s_lshl_b32 s43, s43, 2
s_add_u32 s43, s43, 12288
v_mov_b32 v10, s43
v_mov_b32 v12, 1
buffer_load_dword v11, v10, s[56:59], 0 offen sc1
s_barrier
s_barrier
s_mov_b32 s41, 0x10000
Lpoll_56:
s_waitcnt vmcnt(0)
Lpf_58:
v_cmp_ne_u32 vcc, v12, v11
s_nop 4
s_cbranch_vccz Lpok_57
buffer_load_dword v11, v10, s[56:59], 0 offen sc1
s_sub_u32 s41, s41, 1
s_cmp_lg_u32 s41, 0
s_cbranch_scc1 Lpoll_56
s_waitcnt vmcnt(0)
Lpok_57:
s_barrier
s_branch Ldone_1
Ldone_1:
s_endpgm
.section .rodata,"a"
.p2align 6
.amdhsa_kernel sequential_preLN__sliding_local_dilated__glu_gated_geglu__prompt_kernel
  .amdhsa_next_free_vgpr 256
  .amdhsa_next_free_sgpr 100
  .amdhsa_accum_offset 256
  .amdhsa_group_segment_fixed_size 0
  .amdhsa_kernarg_size 80
  .amdhsa_user_sgpr_count 2
  .amdhsa_user_sgpr_kernarg_segment_ptr 1
  .amdhsa_system_sgpr_workgroup_id_x 1
  .amdhsa_float_denorm_mode_32 3
  .amdhsa_float_denorm_mode_16_64 3
.end_amdhsa_kernel
```

```asm
; @launch grid=(256,1,1) block=(512,1,1) lds=151552
.amdgcn_target "amdgcn-amd-amdhsa--gfx950"
.text
.globl sequential_preLN__sliding_local_dilated__glu_gated_geglu__prompt_kernel
.p2align 8
.type sequential_preLN__sliding_local_dilated__glu_gated_geglu__prompt_kernel,@function
sequential_preLN__sliding_local_dilated__glu_gated_geglu__prompt_kernel:
s_cmp_ge_u32 s2, 256
s_cbranch_scc1 Ldone_1
s_load_dwordx4 s[4:7], s[0:1], 0
s_load_dwordx2 s[32:33], s[0:1], 72
s_load_dwordx2 s[80:81], s[0:1], 32
s_and_b32 s3, s2, 7
s_lshr_b32 s42, s2, 3
s_and_b32 s48, s42, 3
s_lshr_b32 s49, s42, 2
s_and_b32 s34, s3, 3
s_lshl_b32 s34, s34, 2
s_add_u32 s34, s34, s48
s_lshr_b32 s35, s3, 2
s_lshl_b32 s35, s35, 3
s_add_u32 s35, s35, s49
v_lshrrev_b32 v12, 6, v0
v_and_b32 v1, 63, v0
v_readfirstlane_b32 s36, v12
s_nop 3
s_lshl_b32 s44, s34, 18
s_lshl_b32 s45, s35, 14
s_add_u32 s45, s45, s44
s_lshl_b32 s50, s34, 7
s_sub_u32 s50, s50, 16
s_and_b32 s47, s36, 3
s_lshl_b32 s43, s34, 7
s_lshl_b32 s44, s35, 3
s_add_u32 s43, s43, s44
s_mov_b32 s63, s43
s_lshl_b32 s44, s47, 1
s_add_u32 s51, s43, s44
v_lshlrev_b32 v10, 4, v1
v_lshrrev_b32 v14, 3, v1
v_and_b32 v15, 7, v1
v_and_b32 v16, 2, v14
v_xor_b32 v16, v15, v16
v_lshlrev_b32 v16, 4, v16
v_mul_u32_u24 v17, 6144, v14
s_lshl_b32 s43, s47, 11
v_add3_u32 v2, v17, v16, s43
v_xor_b32 v3, 64, v2
v_lshrrev_b32 v16, 1, v14
v_xor_b32 v16, v15, v16
v_lshlrev_b32 v16, 4, v16
s_lshl_b32 s43, s47, 3
s_add_u32 s43, s43, s50
v_add_u32 v17, s43, v14
s_and_b32 s44, s47, 1
s_lshl_b32 s44, s44, 6
v_add_u32 v18, 0, v17
v_max_i32 v18, 0, v18
v_lshl_add_u32 v18, v18, 11, v16
v_xor_b32 v18, s44, v18
v_mov_b32 v4, v18
v_add_u32 v18, 24, v17
v_max_i32 v18, 0, v18
v_lshl_add_u32 v18, v18, 11, v16
v_xor_b32 v18, s44, v18
v_xor_b32 v5, 64, v18
v_add_u32 v18, 48, v17
v_max_i32 v18, 0, v18
v_lshl_add_u32 v18, v18, 11, v16
v_xor_b32 v18, s44, v18
v_mov_b32 v6, v18
v_add_u32 v18, 72, v17
v_max_i32 v18, 0, v18
v_lshl_add_u32 v18, v18, 11, v16
v_xor_b32 v18, s44, v18
v_xor_b32 v7, 64, v18
v_add_u32 v18, 96, v17
v_max_i32 v18, 0, v18
v_lshl_add_u32 v18, v18, 11, v16
v_xor_b32 v18, s44, v18
v_mov_b32 v8, v18
v_add_u32 v18, 120, v17
v_max_i32 v18, 0, v18
v_lshl_add_u32 v18, v18, 11, v16
v_xor_b32 v18, s44, v18
v_xor_b32 v9, 64, v18
s_lshl_b32 s39, s47, 10
s_lshl_b32 s40, s47, 13
s_add_u32 s40, s40, 18432
s_mov_b32 s37, 0
s_mov_b32 s38, 0
s_bfm_b64 s[60:61], 56, 8
s_cmp_eq_u32 s47, 0
s_cselect_b64 s[60:61], s[60:61], -1
s_mov_b32 s53, 0x3f803f80
v_and_b32 v12, 15, v1
v_lshrrev_b32 v13, 4, v1
s_lshl_b32 s43, s35, 7
s_waitcnt lgkmcnt(0)
s_mov_b32 s8, s4
s_mov_b32 s9, s5
s_mov_b32 s10, 4194304
s_mov_b32 s11, 0x20000
s_add_u32 s12, s6, s43
s_addc_u32 s13, s7, 0
s_mov_b32 s14, 6289536
s_mov_b32 s15, 0x20000
s_add_u32 s16, s32, s45
s_addc_u32 s17, s33, 0
s_mov_b32 s18, 16384
s_mov_b32 s19, 0x20000
s_add_u32 s20, s32, 26214400
s_addc_u32 s21, s33, 0
s_mov_b32 s22, 16384
s_mov_b32 s23, 0x20000
s_cmp_lt_u32 s36, 4
s_cbranch_scc1 Lcons_2
s_cmp_eq_u32 s36, 7
s_cbranch_scc1 Lpf_3
s_add_u32 m0, s39, 0
s_mov_b64 exec, s[60:61]
buffer_load_dwordx4 v4, s[8:11], s37 offen lds
s_mov_b64 exec, -1
s_add_u32 m0, s39, 3072
s_nop 0
buffer_load_dwordx4 v5, s[8:11], s37 offen lds
s_add_u32 m0, s39, 6144
s_nop 0
buffer_load_dwordx4 v6, s[8:11], s37 offen lds
s_add_u32 m0, s39, 9216
s_nop 0
buffer_load_dwordx4 v7, s[8:11], s37 offen lds
s_add_u32 m0, s39, 12288
s_nop 0
buffer_load_dwordx4 v8, s[8:11], s37 offen lds
s_add_u32 m0, s39, 15360
s_nop 0
buffer_load_dwordx4 v9, s[8:11], s37 offen lds
s_add_u32 m0, s40, 0
s_add_u32 s43, s38, 0
buffer_load_dwordx4 v2, s[12:15], s43 offen lds
s_add_u32 m0, s40, 1024
s_add_u32 s43, s38, 49152
buffer_load_dwordx4 v3, s[12:15], s43 offen lds
s_add_u32 m0, s40, 2048
s_add_u32 s43, s38, 98304
buffer_load_dwordx4 v2, s[12:15], s43 offen lds
s_add_u32 m0, s40, 3072
s_add_u32 s43, s38, 147456
buffer_load_dwordx4 v3, s[12:15], s43 offen lds
s_add_u32 m0, s40, 4096
s_add_u32 s43, s38, 196608
buffer_load_dwordx4 v2, s[12:15], s43 offen lds
s_add_u32 m0, s40, 5120
s_add_u32 s43, s38, 245760
buffer_load_dwordx4 v3, s[12:15], s43 offen lds
s_add_u32 m0, s40, 6144
s_add_u32 s43, s38, 294912
buffer_load_dwordx4 v2, s[12:15], s43 offen lds
s_add_u32 m0, s40, 7168
s_add_u32 s43, s38, 344064
buffer_load_dwordx4 v3, s[12:15], s43 offen lds
s_add_u32 s37, s37, 128
s_add_u32 s38, s38, 393216
s_add_u32 m0, s39, 43008
s_mov_b64 exec, s[60:61]
buffer_load_dwordx4 v4, s[8:11], s37 offen lds
s_mov_b64 exec, -1
s_add_u32 m0, s39, 46080
s_nop 0
buffer_load_dwordx4 v5, s[8:11], s37 offen lds
s_add_u32 m0, s39, 49152
s_nop 0
buffer_load_dwordx4 v6, s[8:11], s37 offen lds
s_add_u32 m0, s39, 52224
s_nop 0
buffer_load_dwordx4 v7, s[8:11], s37 offen lds
s_add_u32 m0, s39, 55296
s_nop 0
buffer_load_dwordx4 v8, s[8:11], s37 offen lds
s_add_u32 m0, s39, 58368
s_nop 0
buffer_load_dwordx4 v9, s[8:11], s37 offen lds
s_add_u32 m0, s40, 43008
s_add_u32 s43, s38, 0
buffer_load_dwordx4 v2, s[12:15], s43 offen lds
s_add_u32 m0, s40, 44032
s_add_u32 s43, s38, 49152
buffer_load_dwordx4 v3, s[12:15], s43 offen lds
s_add_u32 m0, s40, 45056
s_add_u32 s43, s38, 98304
buffer_load_dwordx4 v2, s[12:15], s43 offen lds
s_add_u32 m0, s40, 46080
s_add_u32 s43, s38, 147456
buffer_load_dwordx4 v3, s[12:15], s43 offen lds
s_add_u32 m0, s40, 47104
s_add_u32 s43, s38, 196608
buffer_load_dwordx4 v2, s[12:15], s43 offen lds
s_add_u32 m0, s40, 48128
s_add_u32 s43, s38, 245760
buffer_load_dwordx4 v3, s[12:15], s43 offen lds
s_add_u32 m0, s40, 49152
s_add_u32 s43, s38, 294912
buffer_load_dwordx4 v2, s[12:15], s43 offen lds
s_add_u32 m0, s40, 50176
s_add_u32 s43, s38, 344064
buffer_load_dwordx4 v3, s[12:15], s43 offen lds
s_add_u32 s37, s37, 128
s_add_u32 s38, s38, 393216
s_waitcnt vmcnt(14)
s_barrier
s_add_u32 m0, s39, 86016
s_mov_b64 exec, s[60:61]
buffer_load_dwordx4 v4, s[8:11], s37 offen lds
s_mov_b64 exec, -1
s_add_u32 m0, s39, 89088
s_nop 0
buffer_load_dwordx4 v5, s[8:11], s37 offen lds
s_add_u32 m0, s39, 92160
s_nop 0
buffer_load_dwordx4 v6, s[8:11], s37 offen lds
s_add_u32 m0, s39, 95232
s_nop 0
buffer_load_dwordx4 v7, s[8:11], s37 offen lds
s_add_u32 m0, s39, 98304
s_nop 0
buffer_load_dwordx4 v8, s[8:11], s37 offen lds
s_add_u32 m0, s39, 101376
s_nop 0
buffer_load_dwordx4 v9, s[8:11], s37 offen lds
s_add_u32 m0, s40, 86016
s_add_u32 s43, s38, 0
buffer_load_dwordx4 v2, s[12:15], s43 offen lds
s_add_u32 m0, s40, 87040
s_add_u32 s43, s38, 49152
buffer_load_dwordx4 v3, s[12:15], s43 offen lds
s_add_u32 m0, s40, 88064
s_add_u32 s43, s38, 98304
buffer_load_dwordx4 v2, s[12:15], s43 offen lds
s_add_u32 m0, s40, 89088
s_add_u32 s43, s38, 147456
buffer_load_dwordx4 v3, s[12:15], s43 offen lds
s_add_u32 m0, s40, 90112
s_add_u32 s43, s38, 196608
buffer_load_dwordx4 v2, s[12:15], s43 offen lds
s_add_u32 m0, s40, 91136
s_add_u32 s43, s38, 245760
buffer_load_dwordx4 v3, s[12:15], s43 offen lds
s_add_u32 m0, s40, 92160
s_add_u32 s43, s38, 294912
buffer_load_dwordx4 v2, s[12:15], s43 offen lds
s_add_u32 m0, s40, 93184
s_add_u32 s43, s38, 344064
buffer_load_dwordx4 v3, s[12:15], s43 offen lds
s_add_u32 s37, s37, 128
s_add_u32 s38, s38, 393216
s_lshl_b32 s43, s51, 11
buffer_load_dwordx4 v[96:99], v10, s[8:11], s43 offen offset:0
buffer_load_dwordx4 v[100:103], v10, s[8:11], s43 offen offset:1024
buffer_load_dwordx4 v[104:107], v10, s[8:11], s43 offen offset:2048
buffer_load_dwordx4 v[108:111], v10, s[8:11], s43 offen offset:3072
s_lshr_b32 s43, s2, 5
s_cmp_eq_u32 s43, 3
s_cbranch_scc1 Lsj_7
s_cmp_gt_u32 s43, 3
s_cselect_b32 s43, 32, 0
s_sub_u32 s43, s2, s43
s_lshr_b32 s43, s43, 1
s_and_b32 s44, s2, 1
s_lshl_b32 s44, s44, 3
s_add_u32 s44, s44, 32
s_load_dwordx2 s[80:81], s[0:1], s44
s_mul_i32 s45, s43, 2341
s_lshr_b32 s45, s45, 16
s_mul_i32 s46, s45, 28
s_sub_u32 s46, s43, s46
s_lshl_b32 s45, s45, 8
s_mul_i32 s44, s47, 18
s_add_u32 s45, s45, s44
s_add_u32 s45, s45, 184
s_mul_i32 s45, s45, 7168
s_lshl_b32 s46, s46, 8
s_add_u32 s45, s45, s46
s_waitcnt lgkmcnt(0)
s_add_u32 s80, s80, s45
s_addc_u32 s81, s81, 0
Lsj_7:
s_waitcnt vmcnt(18)
s_barrier
s_add_u32 m0, s39, 0
s_mov_b64 exec, s[60:61]
buffer_load_dwordx4 v4, s[8:11], s37 offen lds
s_mov_b64 exec, -1
s_add_u32 m0, s39, 3072
s_nop 0
buffer_load_dwordx4 v5, s[8:11], s37 offen lds
s_add_u32 m0, s39, 6144
s_nop 0
buffer_load_dwordx4 v6, s[8:11], s37 offen lds
s_add_u32 m0, s39, 9216
s_nop 0
buffer_load_dwordx4 v7, s[8:11], s37 offen lds
s_add_u32 m0, s39, 12288
s_nop 0
buffer_load_dwordx4 v8, s[8:11], s37 offen lds
s_add_u32 m0, s39, 15360
s_nop 0
buffer_load_dwordx4 v9, s[8:11], s37 offen lds
s_add_u32 m0, s40, 0
s_add_u32 s43, s38, 0
buffer_load_dwordx4 v2, s[12:15], s43 offen lds
s_add_u32 m0, s40, 1024
s_add_u32 s43, s38, 49152
buffer_load_dwordx4 v3, s[12:15], s43 offen lds
s_add_u32 m0, s40, 2048
s_add_u32 s43, s38, 98304
buffer_load_dwordx4 v2, s[12:15], s43 offen lds
s_add_u32 m0, s40, 3072
s_add_u32 s43, s38, 147456
buffer_load_dwordx4 v3, s[12:15], s43 offen lds
s_add_u32 m0, s40, 4096
s_add_u32 s43, s38, 196608
buffer_load_dwordx4 v2, s[12:15], s43 offen lds
s_add_u32 m0, s40, 5120
s_add_u32 s43, s38, 245760
buffer_load_dwordx4 v3, s[12:15], s43 offen lds
s_add_u32 m0, s40, 6144
s_add_u32 s43, s38, 294912
buffer_load_dwordx4 v2, s[12:15], s43 offen lds
s_add_u32 m0, s40, 7168
s_add_u32 s43, s38, 344064
buffer_load_dwordx4 v3, s[12:15], s43 offen lds
s_add_u32 s37, s37, 128
s_add_u32 s38, s38, 393216
s_waitcnt vmcnt(14)
s_barrier
s_add_u32 m0, s39, 43008
s_mov_b64 exec, s[60:61]
buffer_load_dwordx4 v4, s[8:11], s37 offen lds
s_mov_b64 exec, -1
s_add_u32 m0, s39, 46080
s_nop 0
buffer_load_dwordx4 v5, s[8:11], s37 offen lds
s_add_u32 m0, s39, 49152
s_nop 0
buffer_load_dwordx4 v6, s[8:11], s37 offen lds
s_add_u32 m0, s39, 52224
s_nop 0
buffer_load_dwordx4 v7, s[8:11], s37 offen lds
s_add_u32 m0, s39, 55296
s_nop 0
buffer_load_dwordx4 v8, s[8:11], s37 offen lds
s_add_u32 m0, s39, 58368
s_nop 0
buffer_load_dwordx4 v9, s[8:11], s37 offen lds
s_add_u32 m0, s40, 43008
s_add_u32 s43, s38, 0
buffer_load_dwordx4 v2, s[12:15], s43 offen lds
s_add_u32 m0, s40, 44032
s_add_u32 s43, s38, 49152
buffer_load_dwordx4 v3, s[12:15], s43 offen lds
s_add_u32 m0, s40, 45056
s_add_u32 s43, s38, 98304
buffer_load_dwordx4 v2, s[12:15], s43 offen lds
s_add_u32 m0, s40, 46080
s_add_u32 s43, s38, 147456
buffer_load_dwordx4 v3, s[12:15], s43 offen lds
s_add_u32 m0, s40, 47104
s_add_u32 s43, s38, 196608
buffer_load_dwordx4 v2, s[12:15], s43 offen lds
s_add_u32 m0, s40, 48128
s_add_u32 s43, s38, 245760
buffer_load_dwordx4 v3, s[12:15], s43 offen lds
s_add_u32 m0, s40, 49152
s_add_u32 s43, s38, 294912
buffer_load_dwordx4 v2, s[12:15], s43 offen lds
s_add_u32 m0, s40, 50176
s_add_u32 s43, s38, 344064
buffer_load_dwordx4 v3, s[12:15], s43 offen lds
s_add_u32 s37, s37, 128
s_add_u32 s38, s38, 393216
v_lshlrev_b32 v116, 16, v96
v_and_b32 v117, 0xffff0000, v96
v_mul_f32 v118, v116, v116
v_mul_f32 v119, v117, v117
v_lshlrev_b32 v126, 16, v97
v_and_b32 v127, 0xffff0000, v97
v_add_f32 v116, v116, v126
v_add_f32 v117, v117, v127
v_fmac_f32 v118, v126, v126
v_fmac_f32 v119, v127, v127
v_lshlrev_b32 v124, 16, v98
v_and_b32 v125, 0xffff0000, v98
v_add_f32 v116, v116, v124
v_add_f32 v117, v117, v125
v_fmac_f32 v118, v124, v124
v_fmac_f32 v119, v125, v125
v_lshlrev_b32 v126, 16, v99
v_and_b32 v127, 0xffff0000, v99
v_add_f32 v116, v116, v126
v_add_f32 v117, v117, v127
v_fmac_f32 v118, v126, v126
v_fmac_f32 v119, v127, v127
v_lshlrev_b32 v124, 16, v100
v_and_b32 v125, 0xffff0000, v100
v_add_f32 v116, v116, v124
v_add_f32 v117, v117, v125
v_fmac_f32 v118, v124, v124
v_fmac_f32 v119, v125, v125
v_lshlrev_b32 v126, 16, v101
v_and_b32 v127, 0xffff0000, v101
v_add_f32 v116, v116, v126
v_add_f32 v117, v117, v127
v_fmac_f32 v118, v126, v126
v_fmac_f32 v119, v127, v127
v_lshlrev_b32 v124, 16, v102
v_and_b32 v125, 0xffff0000, v102
v_add_f32 v116, v116, v124
v_add_f32 v117, v117, v125
v_fmac_f32 v118, v124, v124
v_fmac_f32 v119, v125, v125
v_lshlrev_b32 v126, 16, v103
v_and_b32 v127, 0xffff0000, v103
v_add_f32 v116, v116, v126
v_add_f32 v117, v117, v127
v_fmac_f32 v118, v126, v126
v_fmac_f32 v119, v127, v127
v_lshlrev_b32 v120, 16, v104
v_and_b32 v121, 0xffff0000, v104
v_mul_f32 v122, v120, v120
v_mul_f32 v123, v121, v121
s_waitcnt vmcnt(14)
s_barrier
s_add_u32 m0, s39, 86016
s_mov_b64 exec, s[60:61]
buffer_load_dwordx4 v4, s[8:11], s37 offen lds
s_mov_b64 exec, -1
s_add_u32 m0, s39, 89088
s_nop 0
buffer_load_dwordx4 v5, s[8:11], s37 offen lds
s_add_u32 m0, s39, 92160
s_nop 0
buffer_load_dwordx4 v6, s[8:11], s37 offen lds
s_add_u32 m0, s39, 95232
s_nop 0
buffer_load_dwordx4 v7, s[8:11], s37 offen lds
s_add_u32 m0, s39, 98304
s_nop 0
buffer_load_dwordx4 v8, s[8:11], s37 offen lds
s_add_u32 m0, s39, 101376
s_nop 0
buffer_load_dwordx4 v9, s[8:11], s37 offen lds
s_add_u32 m0, s40, 86016
s_add_u32 s43, s38, 0
buffer_load_dwordx4 v2, s[12:15], s43 offen lds
s_add_u32 m0, s40, 87040
s_add_u32 s43, s38, 49152
buffer_load_dwordx4 v3, s[12:15], s43 offen lds
s_add_u32 m0, s40, 88064
s_add_u32 s43, s38, 98304
buffer_load_dwordx4 v2, s[12:15], s43 offen lds
s_add_u32 m0, s40, 89088
s_add_u32 s43, s38, 147456
buffer_load_dwordx4 v3, s[12:15], s43 offen lds
s_add_u32 m0, s40, 90112
s_add_u32 s43, s38, 196608
buffer_load_dwordx4 v2, s[12:15], s43 offen lds
s_add_u32 m0, s40, 91136
s_add_u32 s43, s38, 245760
buffer_load_dwordx4 v3, s[12:15], s43 offen lds
s_add_u32 m0, s40, 92160
s_add_u32 s43, s38, 294912
buffer_load_dwordx4 v2, s[12:15], s43 offen lds
s_add_u32 m0, s40, 93184
s_add_u32 s43, s38, 344064
buffer_load_dwordx4 v3, s[12:15], s43 offen lds
s_add_u32 s37, s37, 128
s_add_u32 s38, s38, 393216
v_lshlrev_b32 v126, 16, v105
v_and_b32 v127, 0xffff0000, v105
v_add_f32 v120, v120, v126
v_add_f32 v121, v121, v127
v_fmac_f32 v122, v126, v126
v_fmac_f32 v123, v127, v127
v_lshlrev_b32 v124, 16, v106
v_and_b32 v125, 0xffff0000, v106
v_add_f32 v120, v120, v124
v_add_f32 v121, v121, v125
v_fmac_f32 v122, v124, v124
v_fmac_f32 v123, v125, v125
v_lshlrev_b32 v126, 16, v107
v_and_b32 v127, 0xffff0000, v107
v_add_f32 v120, v120, v126
v_add_f32 v121, v121, v127
v_fmac_f32 v122, v126, v126
v_fmac_f32 v123, v127, v127
v_lshlrev_b32 v124, 16, v108
v_and_b32 v125, 0xffff0000, v108
v_add_f32 v120, v120, v124
v_add_f32 v121, v121, v125
v_fmac_f32 v122, v124, v124
v_fmac_f32 v123, v125, v125
v_lshlrev_b32 v126, 16, v109
v_and_b32 v127, 0xffff0000, v109
v_add_f32 v120, v120, v126
v_add_f32 v121, v121, v127
v_fmac_f32 v122, v126, v126
v_fmac_f32 v123, v127, v127
v_lshlrev_b32 v124, 16, v110
v_and_b32 v125, 0xffff0000, v110
v_add_f32 v120, v120, v124
v_add_f32 v121, v121, v125
v_fmac_f32 v122, v124, v124
v_fmac_f32 v123, v125, v125
v_lshlrev_b32 v126, 16, v111
v_and_b32 v127, 0xffff0000, v111
v_add_f32 v120, v120, v126
v_add_f32 v121, v121, v127
v_fmac_f32 v122, v126, v126
v_fmac_f32 v123, v127, v127
v_add_f32 v116, v116, v117
v_add_f32 v118, v118, v119
v_add_f32 v120, v120, v121
v_add_f32 v122, v122, v123
v_add_f32_dpp v116, v116, v116 row_ror:8 row_mask:0xf bank_mask:0xf
v_add_f32_dpp v118, v118, v118 row_ror:8 row_mask:0xf bank_mask:0xf
v_add_f32_dpp v120, v120, v120 row_ror:8 row_mask:0xf bank_mask:0xf
v_add_f32_dpp v122, v122, v122 row_ror:8 row_mask:0xf bank_mask:0xf
s_waitcnt vmcnt(14)
s_barrier
s_add_u32 m0, s39, 0
s_mov_b64 exec, s[60:61]
buffer_load_dwordx4 v4, s[8:11], s37 offen lds
s_mov_b64 exec, -1
s_add_u32 m0, s39, 3072
s_nop 0
buffer_load_dwordx4 v5, s[8:11], s37 offen lds
s_add_u32 m0, s39, 6144
s_nop 0
buffer_load_dwordx4 v6, s[8:11], s37 offen lds
s_add_u32 m0, s39, 9216
s_nop 0
buffer_load_dwordx4 v7, s[8:11], s37 offen lds
s_add_u32 m0, s39, 12288
s_nop 0
buffer_load_dwordx4 v8, s[8:11], s37 offen lds
s_add_u32 m0, s39, 15360
s_nop 0
buffer_load_dwordx4 v9, s[8:11], s37 offen lds
s_add_u32 m0, s40, 0
s_add_u32 s43, s38, 0
buffer_load_dwordx4 v2, s[12:15], s43 offen lds
s_add_u32 m0, s40, 1024
s_add_u32 s43, s38, 49152
buffer_load_dwordx4 v3, s[12:15], s43 offen lds
s_add_u32 m0, s40, 2048
s_add_u32 s43, s38, 98304
buffer_load_dwordx4 v2, s[12:15], s43 offen lds
s_add_u32 m0, s40, 3072
s_add_u32 s43, s38, 147456
buffer_load_dwordx4 v3, s[12:15], s43 offen lds
s_add_u32 m0, s40, 4096
s_add_u32 s43, s38, 196608
buffer_load_dwordx4 v2, s[12:15], s43 offen lds
s_add_u32 m0, s40, 5120
s_add_u32 s43, s38, 245760
buffer_load_dwordx4 v3, s[12:15], s43 offen lds
s_add_u32 m0, s40, 6144
s_add_u32 s43, s38, 294912
buffer_load_dwordx4 v2, s[12:15], s43 offen lds
s_add_u32 m0, s40, 7168
s_add_u32 s43, s38, 344064
buffer_load_dwordx4 v3, s[12:15], s43 offen lds
s_add_u32 s37, s37, 128
s_add_u32 s38, s38, 393216
v_add_f32_dpp v116, v116, v116 row_ror:4 row_mask:0xf bank_mask:0xf
v_add_f32_dpp v118, v118, v118 row_ror:4 row_mask:0xf bank_mask:0xf
v_add_f32_dpp v120, v120, v120 row_ror:4 row_mask:0xf bank_mask:0xf
v_add_f32_dpp v122, v122, v122 row_ror:4 row_mask:0xf bank_mask:0xf
v_add_f32_dpp v116, v116, v116 row_ror:2 row_mask:0xf bank_mask:0xf
v_add_f32_dpp v118, v118, v118 row_ror:2 row_mask:0xf bank_mask:0xf
v_add_f32_dpp v120, v120, v120 row_ror:2 row_mask:0xf bank_mask:0xf
v_add_f32_dpp v122, v122, v122 row_ror:2 row_mask:0xf bank_mask:0xf
v_add_f32_dpp v116, v116, v116 row_ror:1 row_mask:0xf bank_mask:0xf
v_add_f32_dpp v118, v118, v118 row_ror:1 row_mask:0xf bank_mask:0xf
v_add_f32_dpp v120, v120, v120 row_ror:1 row_mask:0xf bank_mask:0xf
v_add_f32_dpp v122, v122, v122 row_ror:1 row_mask:0xf bank_mask:0xf
v_mov_b32 v117, v116
v_mov_b32 v119, v118
v_mov_b32 v121, v120
v_mov_b32 v123, v122
s_nop 0
v_permlane16_swap_b32 v116, v117
v_permlane16_swap_b32 v118, v119
v_permlane16_swap_b32 v120, v121
v_permlane16_swap_b32 v122, v123
v_add_f32 v116, v116, v117
v_add_f32 v118, v118, v119
v_add_f32 v120, v120, v121
v_add_f32 v122, v122, v123
v_mov_b32 v117, v116
v_mov_b32 v119, v118
v_mov_b32 v121, v120
v_mov_b32 v123, v122
s_nop 0
v_permlane32_swap_b32 v116, v117
v_permlane32_swap_b32 v118, v119
v_permlane32_swap_b32 v120, v121
v_permlane32_swap_b32 v122, v123
v_add_f32 v116, v116, v117
v_add_f32 v118, v118, v119
v_add_f32 v120, v120, v121
v_add_f32 v122, v122, v123
v_mul_f32 v112, 0x3a800000, v116
v_mul_f32 v113, 0x3a800000, v118
v_fma_f32 v113, -v112, v112, v113
v_max_f32 v113, 0, v113
v_add_f32 v113, 0x3727c5ac, v113
v_rsq_f32 v113, v113
v_mul_f32 v114, 0x3a800000, v120
v_mul_f32 v115, 0x3a800000, v122
v_fma_f32 v115, -v114, v114, v115
v_max_f32 v115, 0, v115
v_add_f32 v115, 0x3727c5ac, v115
v_rsq_f32 v115, v115
s_nop 0
s_lshl_b32 s43, s47, 4
s_add_u32 s43, s43, 130176
v_mov_b32 v11, s43
ds_write_b128 v11, v[112:115]
s_waitcnt lgkmcnt(0)
s_load_dword s64, s[80:81], 0
s_load_dword s65, s[80:81], 64
s_load_dword s66, s[80:81], 128
s_load_dword s67, s[80:81], 192
s_load_dword s68, s[80:81], 7168
s_load_dword s69, s[80:81], 7232
s_load_dword s70, s[80:81], 7296
s_load_dword s71, s[80:81], 7360
s_add_u32 s80, s80, 14336
s_addc_u32 s81, s81, 0
s_waitcnt vmcnt(14)
s_barrier
s_mov_b32 s41, 2
Lpl_8:
s_add_u32 m0, s39, 43008
s_mov_b64 exec, s[60:61]
buffer_load_dwordx4 v4, s[8:11], s37 offen lds
s_mov_b64 exec, -1
s_add_u32 m0, s39, 46080
s_nop 0
buffer_load_dwordx4 v5, s[8:11], s37 offen lds
s_add_u32 m0, s39, 49152
s_nop 0
buffer_load_dwordx4 v6, s[8:11], s37 offen lds
s_add_u32 m0, s39, 52224
s_nop 0
buffer_load_dwordx4 v7, s[8:11], s37 offen lds
s_add_u32 m0, s39, 55296
s_nop 0
buffer_load_dwordx4 v8, s[8:11], s37 offen lds
s_add_u32 m0, s39, 58368
s_nop 0
buffer_load_dwordx4 v9, s[8:11], s37 offen lds
s_add_u32 m0, s40, 43008
s_add_u32 s43, s38, 0
buffer_load_dwordx4 v2, s[12:15], s43 offen lds
s_add_u32 m0, s40, 44032
s_add_u32 s43, s38, 49152
buffer_load_dwordx4 v3, s[12:15], s43 offen lds
s_add_u32 m0, s40, 45056
s_add_u32 s43, s38, 98304
buffer_load_dwordx4 v2, s[12:15], s43 offen lds
s_add_u32 m0, s40, 46080
s_add_u32 s43, s38, 147456
buffer_load_dwordx4 v3, s[12:15], s43 offen lds
s_add_u32 m0, s40, 47104
s_add_u32 s43, s38, 196608
buffer_load_dwordx4 v2, s[12:15], s43 offen lds
s_add_u32 m0, s40, 48128
s_add_u32 s43, s38, 245760
buffer_load_dwordx4 v3, s[12:15], s43 offen lds
s_add_u32 m0, s40, 49152
s_add_u32 s43, s38, 294912
buffer_load_dwordx4 v2, s[12:15], s43 offen lds
s_add_u32 m0, s40, 50176
s_add_u32 s43, s38, 344064
buffer_load_dwordx4 v3, s[12:15], s43 offen lds
s_add_u32 s37, s37, 128
s_add_u32 s38, s38, 393216
s_load_dword s64, s[80:81], 0
s_load_dword s65, s[80:81], 64
s_load_dword s66, s[80:81], 128
s_load_dword s67, s[80:81], 192
s_load_dword s68, s[80:81], 7168
s_load_dword s69, s[80:81], 7232
s_load_dword s70, s[80:81], 7296
s_load_dword s71, s[80:81], 7360
s_add_u32 s80, s80, 14336
s_addc_u32 s81, s81, 0
s_waitcnt vmcnt(14)
s_barrier
s_add_u32 m0, s39, 86016
s_mov_b64 exec, s[60:61]
buffer_load_dwordx4 v4, s[8:11], s37 offen lds
s_mov_b64 exec, -1
s_add_u32 m0, s39, 89088
s_nop 0
buffer_load_dwordx4 v5, s[8:11], s37 offen lds
s_add_u32 m0, s39, 92160
s_nop 0
buffer_load_dwordx4 v6, s[8:11], s37 offen lds
s_add_u32 m0, s39, 95232
s_nop 0
buffer_load_dwordx4 v7, s[8:11], s37 offen lds
s_add_u32 m0, s39, 98304
s_nop 0
buffer_load_dwordx4 v8, s[8:11], s37 offen lds
s_add_u32 m0, s39, 101376
s_nop 0
buffer_load_dwordx4 v9, s[8:11], s37 offen lds
s_add_u32 m0, s40, 86016
s_add_u32 s43, s38, 0
buffer_load_dwordx4 v2, s[12:15], s43 offen lds
s_add_u32 m0, s40, 87040
s_add_u32 s43, s38, 49152
buffer_load_dwordx4 v3, s[12:15], s43 offen lds
s_add_u32 m0, s40, 88064
s_add_u32 s43, s38, 98304
buffer_load_dwordx4 v2, s[12:15], s43 offen lds
s_add_u32 m0, s40, 89088
s_add_u32 s43, s38, 147456
buffer_load_dwordx4 v3, s[12:15], s43 offen lds
s_add_u32 m0, s40, 90112
s_add_u32 s43, s38, 196608
buffer_load_dwordx4 v2, s[12:15], s43 offen lds
s_add_u32 m0, s40, 91136
s_add_u32 s43, s38, 245760
buffer_load_dwordx4 v3, s[12:15], s43 offen lds
s_add_u32 m0, s40, 92160
s_add_u32 s43, s38, 294912
buffer_load_dwordx4 v2, s[12:15], s43 offen lds
s_add_u32 m0, s40, 93184
s_add_u32 s43, s38, 344064
buffer_load_dwordx4 v3, s[12:15], s43 offen lds
s_add_u32 s37, s37, 128
s_add_u32 s38, s38, 393216
s_load_dword s64, s[80:81], 0
s_load_dword s65, s[80:81], 64
s_load_dword s66, s[80:81], 128
s_load_dword s67, s[80:81], 192
s_load_dword s68, s[80:81], 7168
s_load_dword s69, s[80:81], 7232
s_load_dword s70, s[80:81], 7296
s_load_dword s71, s[80:81], 7360
s_add_u32 s80, s80, 14336
s_addc_u32 s81, s81, 0
s_waitcnt vmcnt(14)
s_barrier
s_add_u32 m0, s39, 0
s_mov_b64 exec, s[60:61]
buffer_load_dwordx4 v4, s[8:11], s37 offen lds
s_mov_b64 exec, -1
s_add_u32 m0, s39, 3072
s_nop 0
buffer_load_dwordx4 v5, s[8:11], s37 offen lds
s_add_u32 m0, s39, 6144
s_nop 0
buffer_load_dwordx4 v6, s[8:11], s37 offen lds
s_add_u32 m0, s39, 9216
s_nop 0
buffer_load_dwordx4 v7, s[8:11], s37 offen lds
s_add_u32 m0, s39, 12288
s_nop 0
buffer_load_dwordx4 v8, s[8:11], s37 offen lds
s_add_u32 m0, s39, 15360
s_nop 0
buffer_load_dwordx4 v9, s[8:11], s37 offen lds
s_add_u32 m0, s40, 0
s_add_u32 s43, s38, 0
buffer_load_dwordx4 v2, s[12:15], s43 offen lds
s_add_u32 m0, s40, 1024
s_add_u32 s43, s38, 49152
buffer_load_dwordx4 v3, s[12:15], s43 offen lds
s_add_u32 m0, s40, 2048
s_add_u32 s43, s38, 98304
buffer_load_dwordx4 v2, s[12:15], s43 offen lds
s_add_u32 m0, s40, 3072
s_add_u32 s43, s38, 147456
buffer_load_dwordx4 v3, s[12:15], s43 offen lds
s_add_u32 m0, s40, 4096
s_add_u32 s43, s38, 196608
buffer_load_dwordx4 v2, s[12:15], s43 offen lds
s_add_u32 m0, s40, 5120
s_add_u32 s43, s38, 245760
buffer_load_dwordx4 v3, s[12:15], s43 offen lds
s_add_u32 m0, s40, 6144
s_add_u32 s43, s38, 294912
buffer_load_dwordx4 v2, s[12:15], s43 offen lds
s_add_u32 m0, s40, 7168
s_add_u32 s43, s38, 344064
buffer_load_dwordx4 v3, s[12:15], s43 offen lds
s_add_u32 s37, s37, 128
s_add_u32 s38, s38, 393216
s_load_dword s64, s[80:81], 0
s_load_dword s65, s[80:81], 64
s_load_dword s66, s[80:81], 128
s_load_dword s67, s[80:81], 192
s_load_dword s68, s[80:81], 7168
s_load_dword s69, s[80:81], 7232
s_load_dword s70, s[80:81], 7296
s_load_dword s71, s[80:81], 7360
s_add_u32 s80, s80, 14336
s_addc_u32 s81, s81, 0
s_waitcnt vmcnt(14)
s_barrier
s_sub_u32 s41, s41, 1
s_cmp_lg_u32 s41, 0
s_cbranch_scc1 Lpl_8
s_add_u32 m0, s39, 43008
s_mov_b64 exec, s[60:61]
buffer_load_dwordx4 v4, s[8:11], s37 offen lds
s_mov_b64 exec, -1
s_add_u32 m0, s39, 46080
s_nop 0
buffer_load_dwordx4 v5, s[8:11], s37 offen lds
s_add_u32 m0, s39, 49152
s_nop 0
buffer_load_dwordx4 v6, s[8:11], s37 offen lds
s_add_u32 m0, s39, 52224
s_nop 0
buffer_load_dwordx4 v7, s[8:11], s37 offen lds
s_add_u32 m0, s39, 55296
s_nop 0
buffer_load_dwordx4 v8, s[8:11], s37 offen lds
s_add_u32 m0, s39, 58368
s_nop 0
buffer_load_dwordx4 v9, s[8:11], s37 offen lds
s_add_u32 m0, s40, 43008
s_add_u32 s43, s38, 0
buffer_load_dwordx4 v2, s[12:15], s43 offen lds
s_add_u32 m0, s40, 44032
s_add_u32 s43, s38, 49152
buffer_load_dwordx4 v3, s[12:15], s43 offen lds
s_add_u32 m0, s40, 45056
s_add_u32 s43, s38, 98304
buffer_load_dwordx4 v2, s[12:15], s43 offen lds
s_add_u32 m0, s40, 46080
s_add_u32 s43, s38, 147456
buffer_load_dwordx4 v3, s[12:15], s43 offen lds
s_add_u32 m0, s40, 47104
s_add_u32 s43, s38, 196608
buffer_load_dwordx4 v2, s[12:15], s43 offen lds
s_add_u32 m0, s40, 48128
s_add_u32 s43, s38, 245760
buffer_load_dwordx4 v3, s[12:15], s43 offen lds
s_add_u32 m0, s40, 49152
s_add_u32 s43, s38, 294912
buffer_load_dwordx4 v2, s[12:15], s43 offen lds
s_add_u32 m0, s40, 50176
s_add_u32 s43, s38, 344064
buffer_load_dwordx4 v3, s[12:15], s43 offen lds
s_add_u32 s37, s37, 128
s_add_u32 s38, s38, 393216
s_load_dword s64, s[80:81], 0
s_load_dword s65, s[80:81], 64
s_load_dword s66, s[80:81], 128
s_load_dword s67, s[80:81], 192
s_load_dword s68, s[80:81], 7168
s_load_dword s69, s[80:81], 7232
s_load_dword s70, s[80:81], 7296
s_load_dword s71, s[80:81], 7360
s_add_u32 s80, s80, 14336
s_addc_u32 s81, s81, 0
s_waitcnt vmcnt(14)
s_barrier
s_add_u32 m0, s39, 86016
s_mov_b64 exec, s[60:61]
buffer_load_dwordx4 v4, s[8:11], s37 offen lds
s_mov_b64 exec, -1
s_add_u32 m0, s39, 89088
s_nop 0
buffer_load_dwordx4 v5, s[8:11], s37 offen lds
s_add_u32 m0, s39, 92160
s_nop 0
buffer_load_dwordx4 v6, s[8:11], s37 offen lds
s_add_u32 m0, s39, 95232
s_nop 0
buffer_load_dwordx4 v7, s[8:11], s37 offen lds
s_add_u32 m0, s39, 98304
s_nop 0
buffer_load_dwordx4 v8, s[8:11], s37 offen lds
s_add_u32 m0, s39, 101376
s_nop 0
buffer_load_dwordx4 v9, s[8:11], s37 offen lds
s_add_u32 m0, s40, 86016
s_add_u32 s43, s38, 0
buffer_load_dwordx4 v2, s[12:15], s43 offen lds
s_add_u32 m0, s40, 87040
s_add_u32 s43, s38, 49152
buffer_load_dwordx4 v3, s[12:15], s43 offen lds
s_add_u32 m0, s40, 88064
s_add_u32 s43, s38, 98304
buffer_load_dwordx4 v2, s[12:15], s43 offen lds
s_add_u32 m0, s40, 89088
s_add_u32 s43, s38, 147456
buffer_load_dwordx4 v3, s[12:15], s43 offen lds
s_add_u32 m0, s40, 90112
s_add_u32 s43, s38, 196608
buffer_load_dwordx4 v2, s[12:15], s43 offen lds
s_add_u32 m0, s40, 91136
s_add_u32 s43, s38, 245760
buffer_load_dwordx4 v3, s[12:15], s43 offen lds
s_add_u32 m0, s40, 92160
s_add_u32 s43, s38, 294912
buffer_load_dwordx4 v2, s[12:15], s43 offen lds
s_add_u32 m0, s40, 93184
s_add_u32 s43, s38, 344064
buffer_load_dwordx4 v3, s[12:15], s43 offen lds
s_add_u32 s37, s37, 128
s_add_u32 s38, s38, 393216
s_load_dword s64, s[80:81], 0
s_load_dword s65, s[80:81], 64
s_load_dword s66, s[80:81], 128
s_load_dword s67, s[80:81], 192
s_load_dword s68, s[80:81], 7168
s_load_dword s69, s[80:81], 7232
s_load_dword s70, s[80:81], 7296
s_load_dword s71, s[80:81], 7360
s_add_u32 s80, s80, 14336
s_addc_u32 s81, s81, 0
s_waitcnt vmcnt(14)
s_barrier
s_add_u32 m0, s39, 0
s_mov_b64 exec, s[60:61]
buffer_load_dwordx4 v4, s[8:11], s37 offen lds
s_mov_b64 exec, -1
s_add_u32 m0, s39, 3072
s_nop 0
buffer_load_dwordx4 v5, s[8:11], s37 offen lds
s_add_u32 m0, s39, 6144
s_nop 0
buffer_load_dwordx4 v6, s[8:11], s37 offen lds
s_add_u32 m0, s39, 9216
s_nop 0
buffer_load_dwordx4 v7, s[8:11], s37 offen lds
s_add_u32 m0, s39, 12288
s_nop 0
buffer_load_dwordx4 v8, s[8:11], s37 offen lds
s_add_u32 m0, s39, 15360
s_nop 0
buffer_load_dwordx4 v9, s[8:11], s37 offen lds
s_add_u32 m0, s40, 0
s_add_u32 s43, s38, 0
buffer_load_dwordx4 v2, s[12:15], s43 offen lds
s_add_u32 m0, s40, 1024
s_add_u32 s43, s38, 49152
buffer_load_dwordx4 v3, s[12:15], s43 offen lds
s_add_u32 m0, s40, 2048
s_add_u32 s43, s38, 98304
buffer_load_dwordx4 v2, s[12:15], s43 offen lds
s_add_u32 m0, s40, 3072
s_add_u32 s43, s38, 147456
buffer_load_dwordx4 v3, s[12:15], s43 offen lds
s_add_u32 m0, s40, 4096
s_add_u32 s43, s38, 196608
buffer_load_dwordx4 v2, s[12:15], s43 offen lds
s_add_u32 m0, s40, 5120
s_add_u32 s43, s38, 245760
buffer_load_dwordx4 v3, s[12:15], s43 offen lds
s_add_u32 m0, s40, 6144
s_add_u32 s43, s38, 294912
buffer_load_dwordx4 v2, s[12:15], s43 offen lds
s_add_u32 m0, s40, 7168
s_add_u32 s43, s38, 344064
buffer_load_dwordx4 v3, s[12:15], s43 offen lds
s_add_u32 s37, s37, 128
s_add_u32 s38, s38, 393216
s_waitcnt vmcnt(14)
s_barrier
s_waitcnt vmcnt(0)
s_barrier
s_barrier
s_waitcnt lgkmcnt(0)
s_and_b32 s43, s36, 1
s_lshr_b32 s44, s36, 1
s_and_b32 s44, s44, 1
s_lshr_b32 s45, s36, 2
v_lshlrev_b32 v14, 2, v13
v_sub_u32 v14, v12, v14
v_subrev_u32 v15, 0, v14
v_cmp_ge_u32 s[52:53], 7, v15
v_add_u32 v15, 16, v15
v_cmp_ge_u32 s[84:85], 7, v15
v_subrev_u32 v15, 1, v14
v_cmp_ge_u32 s[54:55], 7, v15
v_add_u32 v15, 16, v15
v_cmp_ge_u32 s[86:87], 7, v15
v_subrev_u32 v15, 2, v14
v_cmp_ge_u32 s[56:57], 7, v15
v_add_u32 v15, 16, v15
v_cmp_ge_u32 s[88:89], 7, v15
v_subrev_u32 v15, 3, v14
v_cmp_ge_u32 s[58:59], 7, v15
v_add_u32 v15, 16, v15
v_cmp_ge_u32 s[90:91], 7, v15
s_lshl_b32 s46, s45, 6
s_add_u32 s46, s46, s44
s_add_u32 s46, s46, 16
v_lshl_add_u32 v14, v12, 1, s46
s_lshl_b32 s47, s43, 6
v_lshl_add_u32 v15, v13, 4, s47
v_mul_u32_u24 v20, 400, v14
v_add_u32 v20, v20, v15
v_subrev_u32 v16, 32, v14
v_max_i32 v16, 0, v16
v_mul_u32_u24 v21, 400, v16
v_add_u32 v21, v21, v15
v_lshrrev_b32 v16, 2, v12
v_lshl_add_u32 v16, v13, 2, v16
v_lshl_add_u32 v16, v16, 1, s46
v_and_b32 v17, 3, v1
v_lshl_add_u32 v17, v17, 3, s47
v_mul_u32_u24 v22, 400, v16
v_add_u32 v22, v22, v17
v_subrev_u32 v16, 32, v16
v_max_i32 v16, 0, v16
v_mul_u32_u24 v23, 400, v16
v_add_u32 v23, v23, v17
s_lshl_b32 s60, s43, 13
s_lshl_b32 s61, s45, 10
s_add_u32 s60, s60, s61
s_lshl_b32 s61, s44, 8
s_add_u32 s60, s60, s61
v_lshlrev_b32 v27, 11, v13
v_lshl_add_u32 v27, v12, 4, v27
v_add_u32 v27, s60, v27
v_mov_b32 v28, 0xff800000
s_mov_b32 s61, 0x3e8293ee
s_nop 2
s_or_b32 s62, s34, s45
s_cmp_lg_u32 s62, 0
s_cselect_b64 s[64:65], s[84:85], 0
s_cselect_b64 s[66:67], s[86:87], 0
s_cselect_b64 s[68:69], s[88:89], 0
s_cselect_b64 s[70:71], s[90:91], 0
s_branch Latt_4
Lcons_2:
s_cmp_ge_u32 s36, 2
s_cbranch_scc1 Lsp_5
s_mov_b32 s84, s6
s_mov_b32 s85, s7
s_mov_b32 s86, 6291456
s_mov_b32 s87, 0x20000
s_and_b32 s43, s35, 8
s_or_b32 s43, s43, 3
s_lshl_b32 s43, s43, 7
s_lshr_b32 s44, s2, 3
s_mul_i32 s44, s44, 196608
s_add_u32 s43, s43, s44
s_lshl_b32 s44, s36, 6
v_add_u32 v15, s44, v1
v_min_u32 v15, 95, v15
v_mul_u32_u24 v16, 21846, v15
v_lshrrev_b32 v16, 16, v16
v_mul_u32_u24 v17, 3, v16
v_sub_u32 v15, v15, v17
v_mul_u32_u24 v16, 6144, v16
v_lshl_add_u32 v15, v15, 11, v16
buffer_load_dword v31, v15, s[84:87], s43 offen
Lsp_5:
v_lshrrev_b32 v16, 1, v12
v_xor_b32 v15, v13, v16
v_lshlrev_b32 v15, 4, v15
v_lshl_add_u32 v2, v12, 7, v15
v_xor_b32 v3, 64, v2
v_add_u32 v4, 86016, v2
v_add_u32 v5, 86016, v3
v_lshrrev_b32 v15, 2, v12
v_and_b32 v16, 3, v1
v_lshl_add_u32 v19, v13, 3, v15
v_lshlrev_b32 v19, 7, v19
v_and_b32 v15, 2, v15
v_and_b32 v17, 1, v13
v_lshl_add_u32 v15, v17, 2, v15
v_lshrrev_b32 v17, 1, v16
s_lshl_b32 s43, s36, 1
v_add_u32 v17, s43, v17
v_xor_b32 v15, v15, v17
v_lshl_add_u32 v19, v15, 4, v19
v_and_b32 v16, 1, v16
v_lshl_add_u32 v19, v16, 3, v19
v_add_u32 v6, 18432, v19
v_add_u32 v7, 61440, v19
v_add_u32 v8, 104448, v19
v_mov_b32 v128, 0
v_mov_b32 v129, 0
v_mov_b32 v130, 0
v_mov_b32 v131, 0
v_mov_b32 v132, 0
v_mov_b32 v133, 0
v_mov_b32 v134, 0
v_mov_b32 v135, 0
v_mov_b32 v136, 0
v_mov_b32 v137, 0
v_mov_b32 v138, 0
v_mov_b32 v139, 0
v_mov_b32 v140, 0
v_mov_b32 v141, 0
v_mov_b32 v142, 0
v_mov_b32 v143, 0
v_mov_b32 v144, 0
v_mov_b32 v145, 0
v_mov_b32 v146, 0
v_mov_b32 v147, 0
v_mov_b32 v148, 0
v_mov_b32 v149, 0
v_mov_b32 v150, 0
v_mov_b32 v151, 0
v_mov_b32 v152, 0
v_mov_b32 v153, 0
v_mov_b32 v154, 0
v_mov_b32 v155, 0
v_mov_b32 v156, 0
v_mov_b32 v157, 0
v_mov_b32 v158, 0
v_mov_b32 v159, 0
v_mov_b32 v160, 0
v_mov_b32 v161, 0
v_mov_b32 v162, 0
v_mov_b32 v163, 0
v_mov_b32 v164, 0
v_mov_b32 v165, 0
v_mov_b32 v166, 0
v_mov_b32 v167, 0
v_mov_b32 v168, 0
v_mov_b32 v169, 0
v_mov_b32 v170, 0
v_mov_b32 v171, 0
v_mov_b32 v172, 0
v_mov_b32 v173, 0
v_mov_b32 v174, 0
v_mov_b32 v175, 0
v_mov_b32 v176, 0
v_mov_b32 v177, 0
v_mov_b32 v178, 0
v_mov_b32 v179, 0
v_mov_b32 v180, 0
v_mov_b32 v181, 0
v_mov_b32 v182, 0
v_mov_b32 v183, 0
v_mov_b32 v184, 0
v_mov_b32 v185, 0
v_mov_b32 v186, 0
v_mov_b32 v187, 0
v_mov_b32 v188, 0
v_mov_b32 v189, 0
v_mov_b32 v190, 0
v_mov_b32 v191, 0
v_mov_b32 v192, 0
v_mov_b32 v193, 0
v_mov_b32 v194, 0
v_mov_b32 v195, 0
v_mov_b32 v196, 0
v_mov_b32 v197, 0
v_mov_b32 v198, 0
v_mov_b32 v199, 0
v_mov_b32 v200, 0
v_mov_b32 v201, 0
v_mov_b32 v202, 0
v_mov_b32 v203, 0
v_mov_b32 v204, 0
v_mov_b32 v205, 0
v_mov_b32 v206, 0
v_mov_b32 v207, 0
v_mov_b32 v208, 0
v_mov_b32 v209, 0
v_mov_b32 v210, 0
v_mov_b32 v211, 0
v_mov_b32 v212, 0
v_mov_b32 v213, 0
v_mov_b32 v214, 0
v_mov_b32 v215, 0
v_mov_b32 v216, 0
v_mov_b32 v217, 0
v_mov_b32 v218, 0
v_mov_b32 v219, 0
v_mov_b32 v220, 0
v_mov_b32 v221, 0
v_mov_b32 v222, 0
v_mov_b32 v223, 0
v_mov_b32 v224, 0
v_mov_b32 v225, 0
v_mov_b32 v226, 0
v_mov_b32 v227, 0
v_mov_b32 v228, 0
v_mov_b32 v229, 0
v_mov_b32 v230, 0
v_mov_b32 v231, 0
v_mov_b32 v232, 0
v_mov_b32 v233, 0
v_mov_b32 v234, 0
v_mov_b32 v235, 0
s_and_b32 s43, s36, 1
s_lshr_b32 s44, s36, 1
s_and_b32 s44, s44, 1
s_lshr_b32 s45, s36, 2
v_lshlrev_b32 v14, 2, v13
v_sub_u32 v14, v12, v14
v_subrev_u32 v15, 0, v14
v_cmp_ge_u32 s[52:53], 7, v15
v_add_u32 v15, 16, v15
v_cmp_ge_u32 s[84:85], 7, v15
v_subrev_u32 v15, 1, v14
v_cmp_ge_u32 s[54:55], 7, v15
v_add_u32 v15, 16, v15
v_cmp_ge_u32 s[86:87], 7, v15
v_subrev_u32 v15, 2, v14
v_cmp_ge_u32 s[56:57], 7, v15
v_add_u32 v15, 16, v15
v_cmp_ge_u32 s[88:89], 7, v15
v_subrev_u32 v15, 3, v14
v_cmp_ge_u32 s[58:59], 7, v15
v_add_u32 v15, 16, v15
v_cmp_ge_u32 s[90:91], 7, v15
s_lshl_b32 s46, s45, 6
s_add_u32 s46, s46, s44
s_add_u32 s46, s46, 16
v_lshl_add_u32 v14, v12, 1, s46
s_lshl_b32 s47, s43, 6
v_lshl_add_u32 v15, v13, 4, s47
v_mul_u32_u24 v20, 400, v14
v_add_u32 v20, v20, v15
v_subrev_u32 v16, 32, v14
v_max_i32 v16, 0, v16
v_mul_u32_u24 v21, 400, v16
v_add_u32 v21, v21, v15
v_lshrrev_b32 v16, 2, v12
v_lshl_add_u32 v16, v13, 2, v16
v_lshl_add_u32 v16, v16, 1, s46
v_and_b32 v17, 3, v1
v_lshl_add_u32 v17, v17, 3, s47
v_mul_u32_u24 v22, 400, v16
v_add_u32 v22, v22, v17
v_subrev_u32 v16, 32, v16
v_max_i32 v16, 0, v16
v_mul_u32_u24 v23, 400, v16
v_add_u32 v23, v23, v17
s_lshl_b32 s60, s43, 13
s_lshl_b32 s61, s45, 10
s_add_u32 s60, s60, s61
s_lshl_b32 s61, s44, 8
s_add_u32 s60, s60, s61
v_lshlrev_b32 v27, 11, v13
v_lshl_add_u32 v27, v12, 4, v27
v_add_u32 v27, s60, v27
v_mov_b32 v28, 0xff800000
s_mov_b32 s61, 0x3e8293ee
s_nop 2
s_or_b32 s62, s34, s45
s_cmp_lg_u32 s62, 0
s_cselect_b64 s[64:65], s[84:85], 0
s_cselect_b64 s[66:67], s[86:87], 0
s_cselect_b64 s[68:69], s[88:89], 0
s_cselect_b64 s[70:71], s[90:91], 0
v_lshlrev_b32 v9, 3, v12
v_add_u32 v9, 129024, v9
v_mul_u32_u24 v14, 400, v12
v_lshl_add_u32 v14, v13, 3, v14
s_lshl_b32 s43, s36, 5
v_add_u32 v14, s43, v14
s_barrier
ds_read_b128 v[32:35], v2 offset:0
ds_read_b64_tr_b16 v[72:73], v6 offset:8192
ds_read_b64_tr_b16 v[74:75], v6 offset:8704
ds_read_b64_tr_b16 v[76:77], v6 offset:16384
ds_read_b64_tr_b16 v[78:79], v6 offset:16896
ds_read_b64_tr_b16 v[68:69], v6 offset:0
ds_read_b64_tr_b16 v[70:71], v6 offset:512
ds_read_b128 v[36:39], v2 offset:2048
ds_read_b128 v[40:43], v2 offset:4096
ds_read_b128 v[44:47], v2 offset:6144
ds_read_b128 v[48:51], v2 offset:8192
ds_read_b128 v[52:55], v2 offset:10240
ds_read_b128 v[56:59], v2 offset:12288
ds_read_b128 v[60:63], v2 offset:14336
ds_read_b128 v[64:67], v2 offset:16384
s_mov_b32 s41, 5
Lcl_6:
s_waitcnt lgkmcnt(0)
v_mfma_f32_16x16x32_bf16 v[164:167], v[72:75], v[32:35], v[164:167]
ds_read_b128 v[80:83], v3 offset:0
v_mfma_f32_16x16x32_bf16 v[200:203], v[76:79], v[32:35], v[200:203]
ds_read_b64_tr_b16 v[120:121], v6 offset:12288
v_mfma_f32_16x16x32_bf16 v[128:131], v[68:71], v[32:35], v[128:131]
ds_read_b64_tr_b16 v[122:123], v6 offset:12800
v_mfma_f32_16x16x32_bf16 v[168:171], v[72:75], v[36:39], v[168:171]
ds_read_b64_tr_b16 v[124:125], v6 offset:20480
v_mfma_f32_16x16x32_bf16 v[204:207], v[76:79], v[36:39], v[204:207]
ds_read_b64_tr_b16 v[126:127], v6 offset:20992
v_mfma_f32_16x16x32_bf16 v[132:135], v[68:71], v[36:39], v[132:135]
ds_read_b64_tr_b16 v[116:117], v6 offset:4096
v_mfma_f32_16x16x32_bf16 v[172:175], v[72:75], v[40:43], v[172:175]
ds_read_b64_tr_b16 v[118:119], v6 offset:4608
v_mfma_f32_16x16x32_bf16 v[208:211], v[76:79], v[40:43], v[208:211]
ds_read_b128 v[84:87], v3 offset:2048
v_mfma_f32_16x16x32_bf16 v[136:139], v[68:71], v[40:43], v[136:139]
ds_read_b128 v[88:91], v3 offset:4096
v_mfma_f32_16x16x32_bf16 v[176:179], v[72:75], v[44:47], v[176:179]
ds_read_b128 v[92:95], v3 offset:6144
v_mfma_f32_16x16x32_bf16 v[212:215], v[76:79], v[44:47], v[212:215]
ds_read_b128 v[96:99], v3 offset:8192
v_mfma_f32_16x16x32_bf16 v[140:143], v[68:71], v[44:47], v[140:143]
ds_read_b128 v[100:103], v3 offset:10240
v_mfma_f32_16x16x32_bf16 v[180:183], v[72:75], v[48:51], v[180:183]
ds_read_b128 v[104:107], v3 offset:12288
v_mfma_f32_16x16x32_bf16 v[216:219], v[76:79], v[48:51], v[216:219]
ds_read_b128 v[108:111], v3 offset:14336
v_mfma_f32_16x16x32_bf16 v[144:147], v[68:71], v[48:51], v[144:147]
ds_read_b128 v[112:115], v3 offset:16384
v_mfma_f32_16x16x32_bf16 v[184:187], v[72:75], v[52:55], v[184:187]
v_mfma_f32_16x16x32_bf16 v[220:223], v[76:79], v[52:55], v[220:223]
v_mfma_f32_16x16x32_bf16 v[148:151], v[68:71], v[52:55], v[148:151]
v_mfma_f32_16x16x32_bf16 v[188:191], v[72:75], v[56:59], v[188:191]
v_mfma_f32_16x16x32_bf16 v[224:227], v[76:79], v[56:59], v[224:227]
v_mfma_f32_16x16x32_bf16 v[152:155], v[68:71], v[56:59], v[152:155]
v_mfma_f32_16x16x32_bf16 v[192:195], v[72:75], v[60:63], v[192:195]
v_mfma_f32_16x16x32_bf16 v[228:231], v[76:79], v[60:63], v[228:231]
v_mfma_f32_16x16x32_bf16 v[156:159], v[68:71], v[60:63], v[156:159]
v_mfma_f32_16x16x32_bf16 v[196:199], v[72:75], v[64:67], v[196:199]
v_mfma_f32_16x16x32_bf16 v[232:235], v[76:79], v[64:67], v[232:235]
v_mfma_f32_16x16x32_bf16 v[160:163], v[68:71], v[64:67], v[160:163]
s_waitcnt lgkmcnt(0)
s_barrier
v_mfma_f32_16x16x32_bf16 v[164:167], v[120:123], v[80:83], v[164:167]
ds_read_b128 v[32:35], v2 offset:43008
v_mfma_f32_16x16x32_bf16 v[200:203], v[124:127], v[80:83], v[200:203]
ds_read_b64_tr_b16 v[72:73], v7 offset:8192
v_mfma_f32_16x16x32_bf16 v[128:131], v[116:119], v[80:83], v[128:131]
ds_read_b64_tr_b16 v[74:75], v7 offset:8704
v_mfma_f32_16x16x32_bf16 v[168:171], v[120:123], v[84:87], v[168:171]
ds_read_b64_tr_b16 v[76:77], v7 offset:16384
v_mfma_f32_16x16x32_bf16 v[204:207], v[124:127], v[84:87], v[204:207]
ds_read_b64_tr_b16 v[78:79], v7 offset:16896
v_mfma_f32_16x16x32_bf16 v[132:135], v[116:119], v[84:87], v[132:135]
ds_read_b64_tr_b16 v[68:69], v7 offset:0
v_mfma_f32_16x16x32_bf16 v[172:175], v[120:123], v[88:91], v[172:175]
ds_read_b64_tr_b16 v[70:71], v7 offset:512
v_mfma_f32_16x16x32_bf16 v[208:211], v[124:127], v[88:91], v[208:211]
ds_read_b128 v[36:39], v2 offset:45056
v_mfma_f32_16x16x32_bf16 v[136:139], v[116:119], v[88:91], v[136:139]
ds_read_b128 v[40:43], v2 offset:47104
v_mfma_f32_16x16x32_bf16 v[176:179], v[120:123], v[92:95], v[176:179]
ds_read_b128 v[44:47], v2 offset:49152
v_mfma_f32_16x16x32_bf16 v[212:215], v[124:127], v[92:95], v[212:215]
ds_read_b128 v[48:51], v2 offset:51200
v_mfma_f32_16x16x32_bf16 v[140:143], v[116:119], v[92:95], v[140:143]
ds_read_b128 v[52:55], v2 offset:53248
v_mfma_f32_16x16x32_bf16 v[180:183], v[120:123], v[96:99], v[180:183]
ds_read_b128 v[56:59], v2 offset:55296
v_mfma_f32_16x16x32_bf16 v[216:219], v[124:127], v[96:99], v[216:219]
ds_read_b128 v[60:63], v2 offset:57344
v_mfma_f32_16x16x32_bf16 v[144:147], v[116:119], v[96:99], v[144:147]
ds_read_b128 v[64:67], v2 offset:59392
v_mfma_f32_16x16x32_bf16 v[184:187], v[120:123], v[100:103], v[184:187]
v_mfma_f32_16x16x32_bf16 v[220:223], v[124:127], v[100:103], v[220:223]
v_mfma_f32_16x16x32_bf16 v[148:151], v[116:119], v[100:103], v[148:151]
v_mfma_f32_16x16x32_bf16 v[188:191], v[120:123], v[104:107], v[188:191]
v_mfma_f32_16x16x32_bf16 v[224:227], v[124:127], v[104:107], v[224:227]
v_mfma_f32_16x16x32_bf16 v[152:155], v[116:119], v[104:107], v[152:155]
v_mfma_f32_16x16x32_bf16 v[192:195], v[120:123], v[108:111], v[192:195]
v_mfma_f32_16x16x32_bf16 v[228:231], v[124:127], v[108:111], v[228:231]
v_mfma_f32_16x16x32_bf16 v[156:159], v[116:119], v[108:111], v[156:159]
v_mfma_f32_16x16x32_bf16 v[196:199], v[120:123], v[112:115], v[196:199]
v_mfma_f32_16x16x32_bf16 v[232:235], v[124:127], v[112:115], v[232:235]
v_mfma_f32_16x16x32_bf16 v[160:163], v[116:119], v[112:115], v[160:163]
s_waitcnt lgkmcnt(0)
v_mfma_f32_16x16x32_bf16 v[164:167], v[72:75], v[32:35], v[164:167]
ds_read_b128 v[80:83], v3 offset:43008
v_mfma_f32_16x16x32_bf16 v[200:203], v[76:79], v[32:35], v[200:203]
ds_read_b64_tr_b16 v[120:121], v7 offset:12288
v_mfma_f32_16x16x32_bf16 v[128:131], v[68:71], v[32:35], v[128:131]
ds_read_b64_tr_b16 v[122:123], v7 offset:12800
v_mfma_f32_16x16x32_bf16 v[168:171], v[72:75], v[36:39], v[168:171]
ds_read_b64_tr_b16 v[124:125], v7 offset:20480
v_mfma_f32_16x16x32_bf16 v[204:207], v[76:79], v[36:39], v[204:207]
ds_read_b64_tr_b16 v[126:127], v7 offset:20992
v_mfma_f32_16x16x32_bf16 v[132:135], v[68:71], v[36:39], v[132:135]
ds_read_b64_tr_b16 v[116:117], v7 offset:4096
v_mfma_f32_16x16x32_bf16 v[172:175], v[72:75], v[40:43], v[172:175]
ds_read_b64_tr_b16 v[118:119], v7 offset:4608
v_mfma_f32_16x16x32_bf16 v[208:211], v[76:79], v[40:43], v[208:211]
ds_read_b128 v[84:87], v3 offset:45056
v_mfma_f32_16x16x32_bf16 v[136:139], v[68:71], v[40:43], v[136:139]
ds_read_b128 v[88:91], v3 offset:47104
v_mfma_f32_16x16x32_bf16 v[176:179], v[72:75], v[44:47], v[176:179]
ds_read_b128 v[92:95], v3 offset:49152
v_mfma_f32_16x16x32_bf16 v[212:215], v[76:79], v[44:47], v[212:215]
ds_read_b128 v[96:99], v3 offset:51200
v_mfma_f32_16x16x32_bf16 v[140:143], v[68:71], v[44:47], v[140:143]
ds_read_b128 v[100:103], v3 offset:53248
v_mfma_f32_16x16x32_bf16 v[180:183], v[72:75], v[48:51], v[180:183]
ds_read_b128 v[104:107], v3 offset:55296
v_mfma_f32_16x16x32_bf16 v[216:219], v[76:79], v[48:51], v[216:219]
ds_read_b128 v[108:111], v3 offset:57344
v_mfma_f32_16x16x32_bf16 v[144:147], v[68:71], v[48:51], v[144:147]
ds_read_b128 v[112:115], v3 offset:59392
v_mfma_f32_16x16x32_bf16 v[184:187], v[72:75], v[52:55], v[184:187]
v_mfma_f32_16x16x32_bf16 v[220:223], v[76:79], v[52:55], v[220:223]
v_mfma_f32_16x16x32_bf16 v[148:151], v[68:71], v[52:55], v[148:151]
v_mfma_f32_16x16x32_bf16 v[188:191], v[72:75], v[56:59], v[188:191]
v_mfma_f32_16x16x32_bf16 v[224:227], v[76:79], v[56:59], v[224:227]
v_mfma_f32_16x16x32_bf16 v[152:155], v[68:71], v[56:59], v[152:155]
v_mfma_f32_16x16x32_bf16 v[192:195], v[72:75], v[60:63], v[192:195]
v_mfma_f32_16x16x32_bf16 v[228:231], v[76:79], v[60:63], v[228:231]
v_mfma_f32_16x16x32_bf16 v[156:159], v[68:71], v[60:63], v[156:159]
v_mfma_f32_16x16x32_bf16 v[196:199], v[72:75], v[64:67], v[196:199]
v_mfma_f32_16x16x32_bf16 v[232:235], v[76:79], v[64:67], v[232:235]
v_mfma_f32_16x16x32_bf16 v[160:163], v[68:71], v[64:67], v[160:163]
s_waitcnt lgkmcnt(0)
s_barrier
v_mfma_f32_16x16x32_bf16 v[164:167], v[120:123], v[80:83], v[164:167]
ds_read_b128 v[32:35], v4 offset:0
v_mfma_f32_16x16x32_bf16 v[200:203], v[124:127], v[80:83], v[200:203]
ds_read_b64_tr_b16 v[72:73], v8 offset:8192
v_mfma_f32_16x16x32_bf16 v[128:131], v[116:119], v[80:83], v[128:131]
ds_read_b64_tr_b16 v[74:75], v8 offset:8704
v_mfma_f32_16x16x32_bf16 v[168:171], v[120:123], v[84:87], v[168:171]
ds_read_b64_tr_b16 v[76:77], v8 offset:16384
v_mfma_f32_16x16x32_bf16 v[204:207], v[124:127], v[84:87], v[204:207]
ds_read_b64_tr_b16 v[78:79], v8 offset:16896
v_mfma_f32_16x16x32_bf16 v[132:135], v[116:119], v[84:87], v[132:135]
ds_read_b64_tr_b16 v[68:69], v8 offset:0
v_mfma_f32_16x16x32_bf16 v[172:175], v[120:123], v[88:91], v[172:175]
ds_read_b64_tr_b16 v[70:71], v8 offset:512
v_mfma_f32_16x16x32_bf16 v[208:211], v[124:127], v[88:91], v[208:211]
ds_read_b128 v[36:39], v4 offset:2048
v_mfma_f32_16x16x32_bf16 v[136:139], v[116:119], v[88:91], v[136:139]
ds_read_b128 v[40:43], v4 offset:4096
v_mfma_f32_16x16x32_bf16 v[176:179], v[120:123], v[92:95], v[176:179]
ds_read_b128 v[44:47], v4 offset:6144
v_mfma_f32_16x16x32_bf16 v[212:215], v[124:127], v[92:95], v[212:215]
ds_read_b128 v[48:51], v4 offset:8192
v_mfma_f32_16x16x32_bf16 v[140:143], v[116:119], v[92:95], v[140:143]
ds_read_b128 v[52:55], v4 offset:10240
v_mfma_f32_16x16x32_bf16 v[180:183], v[120:123], v[96:99], v[180:183]
ds_read_b128 v[56:59], v4 offset:12288
v_mfma_f32_16x16x32_bf16 v[216:219], v[124:127], v[96:99], v[216:219]
ds_read_b128 v[60:63], v4 offset:14336
v_mfma_f32_16x16x32_bf16 v[144:147], v[116:119], v[96:99], v[144:147]
ds_read_b128 v[64:67], v4 offset:16384
v_mfma_f32_16x16x32_bf16 v[184:187], v[120:123], v[100:103], v[184:187]
v_mfma_f32_16x16x32_bf16 v[220:223], v[124:127], v[100:103], v[220:223]
v_mfma_f32_16x16x32_bf16 v[148:151], v[116:119], v[100:103], v[148:151]
v_mfma_f32_16x16x32_bf16 v[188:191], v[120:123], v[104:107], v[188:191]
v_mfma_f32_16x16x32_bf16 v[224:227], v[124:127], v[104:107], v[224:227]
v_mfma_f32_16x16x32_bf16 v[152:155], v[116:119], v[104:107], v[152:155]
v_mfma_f32_16x16x32_bf16 v[192:195], v[120:123], v[108:111], v[192:195]
v_mfma_f32_16x16x32_bf16 v[228:231], v[124:127], v[108:111], v[228:231]
v_mfma_f32_16x16x32_bf16 v[156:159], v[116:119], v[108:111], v[156:159]
v_mfma_f32_16x16x32_bf16 v[196:199], v[120:123], v[112:115], v[196:199]
v_mfma_f32_16x16x32_bf16 v[232:235], v[124:127], v[112:115], v[232:235]
v_mfma_f32_16x16x32_bf16 v[160:163], v[116:119], v[112:115], v[160:163]
s_waitcnt lgkmcnt(0)
v_mfma_f32_16x16x32_bf16 v[164:167], v[72:75], v[32:35], v[164:167]
ds_read_b128 v[80:83], v5 offset:0
v_mfma_f32_16x16x32_bf16 v[200:203], v[76:79], v[32:35], v[200:203]
ds_read_b64_tr_b16 v[120:121], v8 offset:12288
v_mfma_f32_16x16x32_bf16 v[128:131], v[68:71], v[32:35], v[128:131]
ds_read_b64_tr_b16 v[122:123], v8 offset:12800
v_mfma_f32_16x16x32_bf16 v[168:171], v[72:75], v[36:39], v[168:171]
ds_read_b64_tr_b16 v[124:125], v8 offset:20480
v_mfma_f32_16x16x32_bf16 v[204:207], v[76:79], v[36:39], v[204:207]
ds_read_b64_tr_b16 v[126:127], v8 offset:20992
v_mfma_f32_16x16x32_bf16 v[132:135], v[68:71], v[36:39], v[132:135]
ds_read_b64_tr_b16 v[116:117], v8 offset:4096
v_mfma_f32_16x16x32_bf16 v[172:175], v[72:75], v[40:43], v[172:175]
ds_read_b64_tr_b16 v[118:119], v8 offset:4608
v_mfma_f32_16x16x32_bf16 v[208:211], v[76:79], v[40:43], v[208:211]
ds_read_b128 v[84:87], v5 offset:2048
v_mfma_f32_16x16x32_bf16 v[136:139], v[68:71], v[40:43], v[136:139]
ds_read_b128 v[88:91], v5 offset:4096
v_mfma_f32_16x16x32_bf16 v[176:179], v[72:75], v[44:47], v[176:179]
ds_read_b128 v[92:95], v5 offset:6144
v_mfma_f32_16x16x32_bf16 v[212:215], v[76:79], v[44:47], v[212:215]
ds_read_b128 v[96:99], v5 offset:8192
v_mfma_f32_16x16x32_bf16 v[140:143], v[68:71], v[44:47], v[140:143]
ds_read_b128 v[100:103], v5 offset:10240
v_mfma_f32_16x16x32_bf16 v[180:183], v[72:75], v[48:51], v[180:183]
ds_read_b128 v[104:107], v5 offset:12288
v_mfma_f32_16x16x32_bf16 v[216:219], v[76:79], v[48:51], v[216:219]
ds_read_b128 v[108:111], v5 offset:14336
v_mfma_f32_16x16x32_bf16 v[144:147], v[68:71], v[48:51], v[144:147]
ds_read_b128 v[112:115], v5 offset:16384
v_mfma_f32_16x16x32_bf16 v[184:187], v[72:75], v[52:55], v[184:187]
v_mfma_f32_16x16x32_bf16 v[220:223], v[76:79], v[52:55], v[220:223]
v_mfma_f32_16x16x32_bf16 v[148:151], v[68:71], v[52:55], v[148:151]
v_mfma_f32_16x16x32_bf16 v[188:191], v[72:75], v[56:59], v[188:191]
v_mfma_f32_16x16x32_bf16 v[224:227], v[76:79], v[56:59], v[224:227]
v_mfma_f32_16x16x32_bf16 v[152:155], v[68:71], v[56:59], v[152:155]
v_mfma_f32_16x16x32_bf16 v[192:195], v[72:75], v[60:63], v[192:195]
v_mfma_f32_16x16x32_bf16 v[228:231], v[76:79], v[60:63], v[228:231]
v_mfma_f32_16x16x32_bf16 v[156:159], v[68:71], v[60:63], v[156:159]
v_mfma_f32_16x16x32_bf16 v[196:199], v[72:75], v[64:67], v[196:199]
v_mfma_f32_16x16x32_bf16 v[232:235], v[76:79], v[64:67], v[232:235]
v_mfma_f32_16x16x32_bf16 v[160:163], v[68:71], v[64:67], v[160:163]
s_waitcnt lgkmcnt(0)
s_barrier
v_mfma_f32_16x16x32_bf16 v[164:167], v[120:123], v[80:83], v[164:167]
ds_read_b128 v[32:35], v2 offset:0
v_mfma_f32_16x16x32_bf16 v[200:203], v[124:127], v[80:83], v[200:203]
ds_read_b64_tr_b16 v[72:73], v6 offset:8192
v_mfma_f32_16x16x32_bf16 v[128:131], v[116:119], v[80:83], v[128:131]
ds_read_b64_tr_b16 v[74:75], v6 offset:8704
v_mfma_f32_16x16x32_bf16 v[168:171], v[120:123], v[84:87], v[168:171]
ds_read_b64_tr_b16 v[76:77], v6 offset:16384
v_mfma_f32_16x16x32_bf16 v[204:207], v[124:127], v[84:87], v[204:207]
ds_read_b64_tr_b16 v[78:79], v6 offset:16896
v_mfma_f32_16x16x32_bf16 v[132:135], v[116:119], v[84:87], v[132:135]
ds_read_b64_tr_b16 v[68:69], v6 offset:0
v_mfma_f32_16x16x32_bf16 v[172:175], v[120:123], v[88:91], v[172:175]
ds_read_b64_tr_b16 v[70:71], v6 offset:512
v_mfma_f32_16x16x32_bf16 v[208:211], v[124:127], v[88:91], v[208:211]
ds_read_b128 v[36:39], v2 offset:2048
v_mfma_f32_16x16x32_bf16 v[136:139], v[116:119], v[88:91], v[136:139]
ds_read_b128 v[40:43], v2 offset:4096
v_mfma_f32_16x16x32_bf16 v[176:179], v[120:123], v[92:95], v[176:179]
ds_read_b128 v[44:47], v2 offset:6144
v_mfma_f32_16x16x32_bf16 v[212:215], v[124:127], v[92:95], v[212:215]
ds_read_b128 v[48:51], v2 offset:8192
v_mfma_f32_16x16x32_bf16 v[140:143], v[116:119], v[92:95], v[140:143]
ds_read_b128 v[52:55], v2 offset:10240
v_mfma_f32_16x16x32_bf16 v[180:183], v[120:123], v[96:99], v[180:183]
ds_read_b128 v[56:59], v2 offset:12288
v_mfma_f32_16x16x32_bf16 v[216:219], v[124:127], v[96:99], v[216:219]
ds_read_b128 v[60:63], v2 offset:14336
v_mfma_f32_16x16x32_bf16 v[144:147], v[116:119], v[96:99], v[144:147]
ds_read_b128 v[64:67], v2 offset:16384
v_mfma_f32_16x16x32_bf16 v[184:187], v[120:123], v[100:103], v[184:187]
v_mfma_f32_16x16x32_bf16 v[220:223], v[124:127], v[100:103], v[220:223]
v_mfma_f32_16x16x32_bf16 v[148:151], v[116:119], v[100:103], v[148:151]
v_mfma_f32_16x16x32_bf16 v[188:191], v[120:123], v[104:107], v[188:191]
v_mfma_f32_16x16x32_bf16 v[224:227], v[124:127], v[104:107], v[224:227]
v_mfma_f32_16x16x32_bf16 v[152:155], v[116:119], v[104:107], v[152:155]
v_mfma_f32_16x16x32_bf16 v[192:195], v[120:123], v[108:111], v[192:195]
v_mfma_f32_16x16x32_bf16 v[228:231], v[124:127], v[108:111], v[228:231]
v_mfma_f32_16x16x32_bf16 v[156:159], v[116:119], v[108:111], v[156:159]
v_mfma_f32_16x16x32_bf16 v[196:199], v[120:123], v[112:115], v[196:199]
v_mfma_f32_16x16x32_bf16 v[232:235], v[124:127], v[112:115], v[232:235]
v_mfma_f32_16x16x32_bf16 v[160:163], v[116:119], v[112:115], v[160:163]
s_sub_u32 s41, s41, 1
s_cmp_lg_u32 s41, 0
s_cbranch_scc1 Lcl_6
s_waitcnt lgkmcnt(0)
v_mfma_f32_16x16x32_bf16 v[164:167], v[72:75], v[32:35], v[164:167]
ds_read_b128 v[80:83], v3 offset:0
v_mfma_f32_16x16x32_bf16 v[200:203], v[76:79], v[32:35], v[200:203]
ds_read_b64_tr_b16 v[120:121], v6 offset:12288
v_mfma_f32_16x16x32_bf16 v[128:131], v[68:71], v[32:35], v[128:131]
ds_read_b64_tr_b16 v[122:123], v6 offset:12800
v_mfma_f32_16x16x32_bf16 v[168:171], v[72:75], v[36:39], v[168:171]
ds_read_b64_tr_b16 v[124:125], v6 offset:20480
v_mfma_f32_16x16x32_bf16 v[204:207], v[76:79], v[36:39], v[204:207]
ds_read_b64_tr_b16 v[126:127], v6 offset:20992
v_mfma_f32_16x16x32_bf16 v[132:135], v[68:71], v[36:39], v[132:135]
ds_read_b64_tr_b16 v[116:117], v6 offset:4096
v_mfma_f32_16x16x32_bf16 v[172:175], v[72:75], v[40:43], v[172:175]
ds_read_b64_tr_b16 v[118:119], v6 offset:4608
v_mfma_f32_16x16x32_bf16 v[208:211], v[76:79], v[40:43], v[208:211]
ds_read_b128 v[84:87], v3 offset:2048
v_mfma_f32_16x16x32_bf16 v[136:139], v[68:71], v[40:43], v[136:139]
ds_read_b128 v[88:91], v3 offset:4096
v_mfma_f32_16x16x32_bf16 v[176:179], v[72:75], v[44:47], v[176:179]
ds_read_b128 v[92:95], v3 offset:6144
v_mfma_f32_16x16x32_bf16 v[212:215], v[76:79], v[44:47], v[212:215]
ds_read_b128 v[96:99], v3 offset:8192
v_mfma_f32_16x16x32_bf16 v[140:143], v[68:71], v[44:47], v[140:143]
ds_read_b128 v[100:103], v3 offset:10240
v_mfma_f32_16x16x32_bf16 v[180:183], v[72:75], v[48:51], v[180:183]
ds_read_b128 v[104:107], v3 offset:12288
v_mfma_f32_16x16x32_bf16 v[216:219], v[76:79], v[48:51], v[216:219]
ds_read_b128 v[108:111], v3 offset:14336
v_mfma_f32_16x16x32_bf16 v[144:147], v[68:71], v[48:51], v[144:147]
ds_read_b128 v[112:115], v3 offset:16384
v_mfma_f32_16x16x32_bf16 v[184:187], v[72:75], v[52:55], v[184:187]
v_mfma_f32_16x16x32_bf16 v[220:223], v[76:79], v[52:55], v[220:223]
v_mfma_f32_16x16x32_bf16 v[148:151], v[68:71], v[52:55], v[148:151]
v_mfma_f32_16x16x32_bf16 v[188:191], v[72:75], v[56:59], v[188:191]
v_mfma_f32_16x16x32_bf16 v[224:227], v[76:79], v[56:59], v[224:227]
v_mfma_f32_16x16x32_bf16 v[152:155], v[68:71], v[56:59], v[152:155]
v_mfma_f32_16x16x32_bf16 v[192:195], v[72:75], v[60:63], v[192:195]
v_mfma_f32_16x16x32_bf16 v[228:231], v[76:79], v[60:63], v[228:231]
v_mfma_f32_16x16x32_bf16 v[156:159], v[68:71], v[60:63], v[156:159]
v_mfma_f32_16x16x32_bf16 v[196:199], v[72:75], v[64:67], v[196:199]
v_mfma_f32_16x16x32_bf16 v[232:235], v[76:79], v[64:67], v[232:235]
v_mfma_f32_16x16x32_bf16 v[160:163], v[68:71], v[64:67], v[160:163]
s_waitcnt lgkmcnt(0)
s_barrier
v_mfma_f32_16x16x32_bf16 v[164:167], v[120:123], v[80:83], v[164:167]
ds_read_b64 v[32:33], v9 offset:0
v_mfma_f32_16x16x32_bf16 v[200:203], v[124:127], v[80:83], v[200:203]
ds_read_b64 v[34:35], v9 offset:128
v_mfma_f32_16x16x32_bf16 v[128:131], v[116:119], v[80:83], v[128:131]
ds_read_b64 v[36:37], v9 offset:256
v_mfma_f32_16x16x32_bf16 v[168:171], v[120:123], v[84:87], v[168:171]
ds_read_b64 v[38:39], v9 offset:384
v_mfma_f32_16x16x32_bf16 v[204:207], v[124:127], v[84:87], v[204:207]
ds_read_b64 v[40:41], v9 offset:512
v_mfma_f32_16x16x32_bf16 v[132:135], v[116:119], v[84:87], v[132:135]
ds_read_b64 v[42:43], v9 offset:640
v_mfma_f32_16x16x32_bf16 v[172:175], v[120:123], v[88:91], v[172:175]
ds_read_b64 v[44:45], v9 offset:768
v_mfma_f32_16x16x32_bf16 v[208:211], v[124:127], v[88:91], v[208:211]
ds_read_b64 v[46:47], v9 offset:896
v_mfma_f32_16x16x32_bf16 v[136:139], v[116:119], v[88:91], v[136:139]
ds_read_b64 v[48:49], v9 offset:1024
v_mfma_f32_16x16x32_bf16 v[176:179], v[120:123], v[92:95], v[176:179]
v_mfma_f32_16x16x32_bf16 v[212:215], v[124:127], v[92:95], v[212:215]
v_mfma_f32_16x16x32_bf16 v[140:143], v[116:119], v[92:95], v[140:143]
v_mfma_f32_16x16x32_bf16 v[180:183], v[120:123], v[96:99], v[180:183]
v_mfma_f32_16x16x32_bf16 v[216:219], v[124:127], v[96:99], v[216:219]
v_mfma_f32_16x16x32_bf16 v[144:147], v[116:119], v[96:99], v[144:147]
v_mfma_f32_16x16x32_bf16 v[184:187], v[120:123], v[100:103], v[184:187]
v_mfma_f32_16x16x32_bf16 v[220:223], v[124:127], v[100:103], v[220:223]
v_mfma_f32_16x16x32_bf16 v[148:151], v[116:119], v[100:103], v[148:151]
v_mfma_f32_16x16x32_bf16 v[188:191], v[120:123], v[104:107], v[188:191]
v_mfma_f32_16x16x32_bf16 v[224:227], v[124:127], v[104:107], v[224:227]
v_mfma_f32_16x16x32_bf16 v[152:155], v[116:119], v[104:107], v[152:155]
v_mfma_f32_16x16x32_bf16 v[192:195], v[120:123], v[108:111], v[192:195]
v_mfma_f32_16x16x32_bf16 v[228:231], v[124:127], v[108:111], v[228:231]
v_mfma_f32_16x16x32_bf16 v[156:159], v[116:119], v[108:111], v[156:159]
v_mfma_f32_16x16x32_bf16 v[196:199], v[120:123], v[112:115], v[196:199]
v_mfma_f32_16x16x32_bf16 v[232:235], v[124:127], v[112:115], v[232:235]
v_mfma_f32_16x16x32_bf16 v[160:163], v[116:119], v[112:115], v[160:163]
v_mov_b32_dpp v52, v128 row_newbcast:0 row_mask:0xf bank_mask:0xf
v_mov_b32_dpp v53, v129 row_newbcast:0 row_mask:0xf bank_mask:0xf
v_mov_b32_dpp v54, v130 row_newbcast:0 row_mask:0xf bank_mask:0xf
v_mov_b32_dpp v55, v131 row_newbcast:0 row_mask:0xf bank_mask:0xf
v_mov_b32_dpp v56, v164 row_newbcast:0 row_mask:0xf bank_mask:0xf
v_mov_b32_dpp v57, v165 row_newbcast:0 row_mask:0xf bank_mask:0xf
v_mov_b32_dpp v58, v166 row_newbcast:0 row_mask:0xf bank_mask:0xf
v_mov_b32_dpp v59, v167 row_newbcast:0 row_mask:0xf bank_mask:0xf
v_mov_b32_dpp v60, v200 row_newbcast:0 row_mask:0xf bank_mask:0xf
v_mov_b32_dpp v61, v201 row_newbcast:0 row_mask:0xf bank_mask:0xf
v_mov_b32_dpp v62, v202 row_newbcast:0 row_mask:0xf bank_mask:0xf
v_mov_b32_dpp v63, v203 row_newbcast:0 row_mask:0xf bank_mask:0xf
s_waitcnt lgkmcnt(0)
v_pk_fma_f32 v[164:165], v[32:33], v[56:57], v[164:165] op_sel_hi:[0,1,1] neg_lo:[1,0,0] neg_hi:[1,0,0]
v_pk_fma_f32 v[166:167], v[32:33], v[58:59], v[166:167] op_sel_hi:[0,1,1] neg_lo:[1,0,0] neg_hi:[1,0,0]
v_pk_mul_f32 v[164:165], v[32:33], v[164:165] op_sel:[1,0] op_sel_hi:[1,1]
v_pk_mul_f32 v[166:167], v[32:33], v[166:167] op_sel:[1,0] op_sel_hi:[1,1]
v_cvt_pk_bf16_f32 v164, v164, v165
v_cvt_pk_bf16_f32 v165, v166, v167
ds_write_b64 v14, v[164:165] offset:128
v_pk_fma_f32 v[200:201], v[32:33], v[60:61], v[200:201] op_sel_hi:[0,1,1] neg_lo:[1,0,0] neg_hi:[1,0,0]
v_pk_fma_f32 v[202:203], v[32:33], v[62:63], v[202:203] op_sel_hi:[0,1,1] neg_lo:[1,0,0] neg_hi:[1,0,0]
v_pk_mul_f32 v[200:201], v[32:33], v[200:201] op_sel:[1,0] op_sel_hi:[1,1]
v_pk_mul_f32 v[202:203], v[32:33], v[202:203] op_sel:[1,0] op_sel_hi:[1,1]
v_cvt_pk_bf16_f32 v200, v200, v201
v_cvt_pk_bf16_f32 v201, v202, v203
ds_write_b64 v14, v[200:201] offset:256
v_pk_fma_f32 v[132:133], v[34:35], v[52:53], v[132:133] op_sel_hi:[0,1,1] neg_lo:[1,0,0] neg_hi:[1,0,0]
v_pk_fma_f32 v[134:135], v[34:35], v[54:55], v[134:135] op_sel_hi:[0,1,1] neg_lo:[1,0,0] neg_hi:[1,0,0]
v_pk_mul_f32 v[132:133], v[34:35], v[132:133] op_sel:[1,0] op_sel_hi:[1,1]
v_pk_mul_f32 v[134:135], v[34:35], v[134:135] op_sel:[1,0] op_sel_hi:[1,1]
v_cvt_pk_bf16_f32 v132, v132, v133
v_cvt_pk_bf16_f32 v133, v134, v135
ds_write_b64 v14, v[132:133] offset:6400
v_pk_fma_f32 v[168:169], v[34:35], v[56:57], v[168:169] op_sel_hi:[0,1,1] neg_lo:[1,0,0] neg_hi:[1,0,0]
v_pk_fma_f32 v[170:171], v[34:35], v[58:59], v[170:171] op_sel_hi:[0,1,1] neg_lo:[1,0,0] neg_hi:[1,0,0]
v_pk_mul_f32 v[168:169], v[34:35], v[168:169] op_sel:[1,0] op_sel_hi:[1,1]
v_pk_mul_f32 v[170:171], v[34:35], v[170:171] op_sel:[1,0] op_sel_hi:[1,1]
v_cvt_pk_bf16_f32 v168, v168, v169
v_cvt_pk_bf16_f32 v169, v170, v171
ds_write_b64 v14, v[168:169] offset:6528
v_pk_fma_f32 v[204:205], v[34:35], v[60:61], v[204:205] op_sel_hi:[0,1,1] neg_lo:[1,0,0] neg_hi:[1,0,0]
v_pk_fma_f32 v[206:207], v[34:35], v[62:63], v[206:207] op_sel_hi:[0,1,1] neg_lo:[1,0,0] neg_hi:[1,0,0]
v_pk_mul_f32 v[204:205], v[34:35], v[204:205] op_sel:[1,0] op_sel_hi:[1,1]
v_pk_mul_f32 v[206:207], v[34:35], v[206:207] op_sel:[1,0] op_sel_hi:[1,1]
v_cvt_pk_bf16_f32 v204, v204, v205
v_cvt_pk_bf16_f32 v205, v206, v207
ds_write_b64 v14, v[204:205] offset:6656
v_pk_fma_f32 v[136:137], v[36:37], v[52:53], v[136:137] op_sel_hi:[0,1,1] neg_lo:[1,0,0] neg_hi:[1,0,0]
v_pk_fma_f32 v[138:139], v[36:37], v[54:55], v[138:139] op_sel_hi:[0,1,1] neg_lo:[1,0,0] neg_hi:[1,0,0]
v_pk_mul_f32 v[136:137], v[36:37], v[136:137] op_sel:[1,0] op_sel_hi:[1,1]
v_pk_mul_f32 v[138:139], v[36:37], v[138:139] op_sel:[1,0] op_sel_hi:[1,1]
v_cvt_pk_bf16_f32 v136, v136, v137
v_cvt_pk_bf16_f32 v137, v138, v139
ds_write_b64 v14, v[136:137] offset:12800
v_pk_fma_f32 v[172:173], v[36:37], v[56:57], v[172:173] op_sel_hi:[0,1,1] neg_lo:[1,0,0] neg_hi:[1,0,0]
v_pk_fma_f32 v[174:175], v[36:37], v[58:59], v[174:175] op_sel_hi:[0,1,1] neg_lo:[1,0,0] neg_hi:[1,0,0]
v_pk_mul_f32 v[172:173], v[36:37], v[172:173] op_sel:[1,0] op_sel_hi:[1,1]
v_pk_mul_f32 v[174:175], v[36:37], v[174:175] op_sel:[1,0] op_sel_hi:[1,1]
v_cvt_pk_bf16_f32 v172, v172, v173
v_cvt_pk_bf16_f32 v173, v174, v175
ds_write_b64 v14, v[172:173] offset:12928
v_pk_fma_f32 v[208:209], v[36:37], v[60:61], v[208:209] op_sel_hi:[0,1,1] neg_lo:[1,0,0] neg_hi:[1,0,0]
v_pk_fma_f32 v[210:211], v[36:37], v[62:63], v[210:211] op_sel_hi:[0,1,1] neg_lo:[1,0,0] neg_hi:[1,0,0]
v_pk_mul_f32 v[208:209], v[36:37], v[208:209] op_sel:[1,0] op_sel_hi:[1,1]
v_pk_mul_f32 v[210:211], v[36:37], v[210:211] op_sel:[1,0] op_sel_hi:[1,1]
v_cvt_pk_bf16_f32 v208, v208, v209
v_cvt_pk_bf16_f32 v209, v210, v211
ds_write_b64 v14, v[208:209] offset:13056
v_pk_fma_f32 v[140:141], v[38:39], v[52:53], v[140:141] op_sel_hi:[0,1,1] neg_lo:[1,0,0] neg_hi:[1,0,0]
v_pk_fma_f32 v[142:143], v[38:39], v[54:55], v[142:143] op_sel_hi:[0,1,1] neg_lo:[1,0,0] neg_hi:[1,0,0]
v_pk_mul_f32 v[140:141], v[38:39], v[140:141] op_sel:[1,0] op_sel_hi:[1,1]
v_pk_mul_f32 v[142:143], v[38:39], v[142:143] op_sel:[1,0] op_sel_hi:[1,1]
v_cvt_pk_bf16_f32 v140, v140, v141
v_cvt_pk_bf16_f32 v141, v142, v143
ds_write_b64 v14, v[140:141] offset:19200
v_pk_fma_f32 v[176:177], v[38:39], v[56:57], v[176:177] op_sel_hi:[0,1,1] neg_lo:[1,0,0] neg_hi:[1,0,0]
v_pk_fma_f32 v[178:179], v[38:39], v[58:59], v[178:179] op_sel_hi:[0,1,1] neg_lo:[1,0,0] neg_hi:[1,0,0]
v_pk_mul_f32 v[176:177], v[38:39], v[176:177] op_sel:[1,0] op_sel_hi:[1,1]
v_pk_mul_f32 v[178:179], v[38:39], v[178:179] op_sel:[1,0] op_sel_hi:[1,1]
v_cvt_pk_bf16_f32 v176, v176, v177
v_cvt_pk_bf16_f32 v177, v178, v179
ds_write_b64 v14, v[176:177] offset:19328
v_pk_fma_f32 v[212:213], v[38:39], v[60:61], v[212:213] op_sel_hi:[0,1,1] neg_lo:[1,0,0] neg_hi:[1,0,0]
v_pk_fma_f32 v[214:215], v[38:39], v[62:63], v[214:215] op_sel_hi:[0,1,1] neg_lo:[1,0,0] neg_hi:[1,0,0]
v_pk_mul_f32 v[212:213], v[38:39], v[212:213] op_sel:[1,0] op_sel_hi:[1,1]
v_pk_mul_f32 v[214:215], v[38:39], v[214:215] op_sel:[1,0] op_sel_hi:[1,1]
v_cvt_pk_bf16_f32 v212, v212, v213
v_cvt_pk_bf16_f32 v213, v214, v215
ds_write_b64 v14, v[212:213] offset:19456
v_pk_fma_f32 v[144:145], v[40:41], v[52:53], v[144:145] op_sel_hi:[0,1,1] neg_lo:[1,0,0] neg_hi:[1,0,0]
v_pk_fma_f32 v[146:147], v[40:41], v[54:55], v[146:147] op_sel_hi:[0,1,1] neg_lo:[1,0,0] neg_hi:[1,0,0]
v_pk_mul_f32 v[144:145], v[40:41], v[144:145] op_sel:[1,0] op_sel_hi:[1,1]
v_pk_mul_f32 v[146:147], v[40:41], v[146:147] op_sel:[1,0] op_sel_hi:[1,1]
v_cvt_pk_bf16_f32 v144, v144, v145
v_cvt_pk_bf16_f32 v145, v146, v147
ds_write_b64 v14, v[144:145] offset:25600
v_pk_fma_f32 v[180:181], v[40:41], v[56:57], v[180:181] op_sel_hi:[0,1,1] neg_lo:[1,0,0] neg_hi:[1,0,0]
v_pk_fma_f32 v[182:183], v[40:41], v[58:59], v[182:183] op_sel_hi:[0,1,1] neg_lo:[1,0,0] neg_hi:[1,0,0]
v_pk_mul_f32 v[180:181], v[40:41], v[180:181] op_sel:[1,0] op_sel_hi:[1,1]
v_pk_mul_f32 v[182:183], v[40:41], v[182:183] op_sel:[1,0] op_sel_hi:[1,1]
v_cvt_pk_bf16_f32 v180, v180, v181
v_cvt_pk_bf16_f32 v181, v182, v183
ds_write_b64 v14, v[180:181] offset:25728
v_pk_fma_f32 v[216:217], v[40:41], v[60:61], v[216:217] op_sel_hi:[0,1,1] neg_lo:[1,0,0] neg_hi:[1,0,0]
v_pk_fma_f32 v[218:219], v[40:41], v[62:63], v[218:219] op_sel_hi:[0,1,1] neg_lo:[1,0,0] neg_hi:[1,0,0]
v_pk_mul_f32 v[216:217], v[40:41], v[216:217] op_sel:[1,0] op_sel_hi:[1,1]
v_pk_mul_f32 v[218:219], v[40:41], v[218:219] op_sel:[1,0] op_sel_hi:[1,1]
v_cvt_pk_bf16_f32 v216, v216, v217
v_cvt_pk_bf16_f32 v217, v218, v219
ds_write_b64 v14, v[216:217] offset:25856
v_pk_fma_f32 v[148:149], v[42:43], v[52:53], v[148:149] op_sel_hi:[0,1,1] neg_lo:[1,0,0] neg_hi:[1,0,0]
v_pk_fma_f32 v[150:151], v[42:43], v[54:55], v[150:151] op_sel_hi:[0,1,1] neg_lo:[1,0,0] neg_hi:[1,0,0]
v_pk_mul_f32 v[148:149], v[42:43], v[148:149] op_sel:[1,0] op_sel_hi:[1,1]
v_pk_mul_f32 v[150:151], v[42:43], v[150:151] op_sel:[1,0] op_sel_hi:[1,1]
v_cvt_pk_bf16_f32 v148, v148, v149
v_cvt_pk_bf16_f32 v149, v150, v151
ds_write_b64 v14, v[148:149] offset:32000
v_pk_fma_f32 v[184:185], v[42:43], v[56:57], v[184:185] op_sel_hi:[0,1,1] neg_lo:[1,0,0] neg_hi:[1,0,0]
v_pk_fma_f32 v[186:187], v[42:43], v[58:59], v[186:187] op_sel_hi:[0,1,1] neg_lo:[1,0,0] neg_hi:[1,0,0]
v_pk_mul_f32 v[184:185], v[42:43], v[184:185] op_sel:[1,0] op_sel_hi:[1,1]
v_pk_mul_f32 v[186:187], v[42:43], v[186:187] op_sel:[1,0] op_sel_hi:[1,1]
v_cvt_pk_bf16_f32 v184, v184, v185
v_cvt_pk_bf16_f32 v185, v186, v187
ds_write_b64 v14, v[184:185] offset:32128
v_pk_fma_f32 v[220:221], v[42:43], v[60:61], v[220:221] op_sel_hi:[0,1,1] neg_lo:[1,0,0] neg_hi:[1,0,0]
v_pk_fma_f32 v[222:223], v[42:43], v[62:63], v[222:223] op_sel_hi:[0,1,1] neg_lo:[1,0,0] neg_hi:[1,0,0]
v_pk_mul_f32 v[220:221], v[42:43], v[220:221] op_sel:[1,0] op_sel_hi:[1,1]
v_pk_mul_f32 v[222:223], v[42:43], v[222:223] op_sel:[1,0] op_sel_hi:[1,1]
v_cvt_pk_bf16_f32 v220, v220, v221
v_cvt_pk_bf16_f32 v221, v222, v223
ds_write_b64 v14, v[220:221] offset:32256
v_pk_fma_f32 v[152:153], v[44:45], v[52:53], v[152:153] op_sel_hi:[0,1,1] neg_lo:[1,0,0] neg_hi:[1,0,0]
v_pk_fma_f32 v[154:155], v[44:45], v[54:55], v[154:155] op_sel_hi:[0,1,1] neg_lo:[1,0,0] neg_hi:[1,0,0]
v_pk_mul_f32 v[152:153], v[44:45], v[152:153] op_sel:[1,0] op_sel_hi:[1,1]
v_pk_mul_f32 v[154:155], v[44:45], v[154:155] op_sel:[1,0] op_sel_hi:[1,1]
v_cvt_pk_bf16_f32 v152, v152, v153
v_cvt_pk_bf16_f32 v153, v154, v155
ds_write_b64 v14, v[152:153] offset:38400
v_pk_fma_f32 v[188:189], v[44:45], v[56:57], v[188:189] op_sel_hi:[0,1,1] neg_lo:[1,0,0] neg_hi:[1,0,0]
v_pk_fma_f32 v[190:191], v[44:45], v[58:59], v[190:191] op_sel_hi:[0,1,1] neg_lo:[1,0,0] neg_hi:[1,0,0]
v_pk_mul_f32 v[188:189], v[44:45], v[188:189] op_sel:[1,0] op_sel_hi:[1,1]
v_pk_mul_f32 v[190:191], v[44:45], v[190:191] op_sel:[1,0] op_sel_hi:[1,1]
v_cvt_pk_bf16_f32 v188, v188, v189
v_cvt_pk_bf16_f32 v189, v190, v191
ds_write_b64 v14, v[188:189] offset:38528
v_pk_fma_f32 v[224:225], v[44:45], v[60:61], v[224:225] op_sel_hi:[0,1,1] neg_lo:[1,0,0] neg_hi:[1,0,0]
v_pk_fma_f32 v[226:227], v[44:45], v[62:63], v[226:227] op_sel_hi:[0,1,1] neg_lo:[1,0,0] neg_hi:[1,0,0]
v_pk_mul_f32 v[224:225], v[44:45], v[224:225] op_sel:[1,0] op_sel_hi:[1,1]
v_pk_mul_f32 v[226:227], v[44:45], v[226:227] op_sel:[1,0] op_sel_hi:[1,1]
v_cvt_pk_bf16_f32 v224, v224, v225
v_cvt_pk_bf16_f32 v225, v226, v227
ds_write_b64 v14, v[224:225] offset:38656
v_pk_fma_f32 v[156:157], v[46:47], v[52:53], v[156:157] op_sel_hi:[0,1,1] neg_lo:[1,0,0] neg_hi:[1,0,0]
v_pk_fma_f32 v[158:159], v[46:47], v[54:55], v[158:159] op_sel_hi:[0,1,1] neg_lo:[1,0,0] neg_hi:[1,0,0]
v_pk_mul_f32 v[156:157], v[46:47], v[156:157] op_sel:[1,0] op_sel_hi:[1,1]
v_pk_mul_f32 v[158:159], v[46:47], v[158:159] op_sel:[1,0] op_sel_hi:[1,1]
v_cvt_pk_bf16_f32 v156, v156, v157
v_cvt_pk_bf16_f32 v157, v158, v159
ds_write_b64 v14, v[156:157] offset:44800
v_pk_fma_f32 v[192:193], v[46:47], v[56:57], v[192:193] op_sel_hi:[0,1,1] neg_lo:[1,0,0] neg_hi:[1,0,0]
v_pk_fma_f32 v[194:195], v[46:47], v[58:59], v[194:195] op_sel_hi:[0,1,1] neg_lo:[1,0,0] neg_hi:[1,0,0]
v_pk_mul_f32 v[192:193], v[46:47], v[192:193] op_sel:[1,0] op_sel_hi:[1,1]
v_pk_mul_f32 v[194:195], v[46:47], v[194:195] op_sel:[1,0] op_sel_hi:[1,1]
v_cvt_pk_bf16_f32 v192, v192, v193
v_cvt_pk_bf16_f32 v193, v194, v195
ds_write_b64 v14, v[192:193] offset:44928
v_pk_fma_f32 v[228:229], v[46:47], v[60:61], v[228:229] op_sel_hi:[0,1,1] neg_lo:[1,0,0] neg_hi:[1,0,0]
v_pk_fma_f32 v[230:231], v[46:47], v[62:63], v[230:231] op_sel_hi:[0,1,1] neg_lo:[1,0,0] neg_hi:[1,0,0]
v_pk_mul_f32 v[228:229], v[46:47], v[228:229] op_sel:[1,0] op_sel_hi:[1,1]
v_pk_mul_f32 v[230:231], v[46:47], v[230:231] op_sel:[1,0] op_sel_hi:[1,1]
v_cvt_pk_bf16_f32 v228, v228, v229
v_cvt_pk_bf16_f32 v229, v230, v231
ds_write_b64 v14, v[228:229] offset:45056
v_pk_fma_f32 v[160:161], v[48:49], v[52:53], v[160:161] op_sel_hi:[0,1,1] neg_lo:[1,0,0] neg_hi:[1,0,0]
v_pk_fma_f32 v[162:163], v[48:49], v[54:55], v[162:163] op_sel_hi:[0,1,1] neg_lo:[1,0,0] neg_hi:[1,0,0]
v_pk_mul_f32 v[160:161], v[48:49], v[160:161] op_sel:[1,0] op_sel_hi:[1,1]
v_pk_mul_f32 v[162:163], v[48:49], v[162:163] op_sel:[1,0] op_sel_hi:[1,1]
v_cvt_pk_bf16_f32 v160, v160, v161
v_cvt_pk_bf16_f32 v161, v162, v163
ds_write_b64 v14, v[160:161] offset:51200
v_pk_fma_f32 v[196:197], v[48:49], v[56:57], v[196:197] op_sel_hi:[0,1,1] neg_lo:[1,0,0] neg_hi:[1,0,0]
v_pk_fma_f32 v[198:199], v[48:49], v[58:59], v[198:199] op_sel_hi:[0,1,1] neg_lo:[1,0,0] neg_hi:[1,0,0]
v_pk_mul_f32 v[196:197], v[48:49], v[196:197] op_sel:[1,0] op_sel_hi:[1,1]
v_pk_mul_f32 v[198:199], v[48:49], v[198:199] op_sel:[1,0] op_sel_hi:[1,1]
v_cvt_pk_bf16_f32 v196, v196, v197
v_cvt_pk_bf16_f32 v197, v198, v199
ds_write_b64 v14, v[196:197] offset:51328
v_pk_fma_f32 v[232:233], v[48:49], v[60:61], v[232:233] op_sel_hi:[0,1,1] neg_lo:[1,0,0] neg_hi:[1,0,0]
v_pk_fma_f32 v[234:235], v[48:49], v[62:63], v[234:235] op_sel_hi:[0,1,1] neg_lo:[1,0,0] neg_hi:[1,0,0]
v_pk_mul_f32 v[232:233], v[48:49], v[232:233] op_sel:[1,0] op_sel_hi:[1,1]
v_pk_mul_f32 v[234:235], v[48:49], v[234:235] op_sel:[1,0] op_sel_hi:[1,1]
v_cvt_pk_bf16_f32 v232, v232, v233
v_cvt_pk_bf16_f32 v233, v234, v235
ds_write_b64 v14, v[232:233] offset:51456
s_waitcnt lgkmcnt(0)
s_branch Latt_4
Lpf_3:
s_load_dwordx2 s[26:27], s[0:1], 64
s_or_b32 s43, s34, s35
s_cmp_lg_u32 s43, 0
s_cbranch_scc1 Lz_9
s_add_u32 s84, s32, 28311552
s_addc_u32 s85, s33, 0
s_mov_b32 s86, 32768
s_mov_b32 s87, 0x20000
v_lshlrev_b32 v14, 7, v1
v_mov_b32 v36, 0
v_mov_b32 v37, 0
s_mov_b32 s43, 0
buffer_store_dwordx2 v[36:37], v14, s[84:87], s43 offen sc1
s_mov_b32 s43, 8192
buffer_store_dwordx2 v[36:37], v14, s[84:87], s43 offen sc1
s_mov_b32 s43, 16384
buffer_store_dwordx2 v[36:37], v14, s[84:87], s43 offen sc1
s_mov_b32 s43, 24576
buffer_store_dwordx2 v[36:37], v14, s[84:87], s43 offen sc1
Lz_9:
s_lshl_b32 s43, s51, 11
buffer_load_dwordx4 v[96:99], v10, s[8:11], s43 offen offset:0
buffer_load_dwordx4 v[100:103], v10, s[8:11], s43 offen offset:1024
buffer_load_dwordx4 v[104:107], v10, s[8:11], s43 offen offset:2048
buffer_load_dwordx4 v[108:111], v10, s[8:11], s43 offen offset:3072
v_min_u32 v14, 23, v1
v_lshrrev_b32 v15, 3, v14
v_mul_u32_u24 v15, 43008, v15
v_and_b32 v14, 7, v14
v_lshl_add_u32 v15, v14, 4, v15
v_mov_b32 v32, 0x3f803f80
v_mov_b32 v33, 0x3f803f80
v_mov_b32 v34, 0x3f803f80
v_mov_b32 v35, 0x3f803f80
ds_write_b128 v15, v[32:35]
v_add_u32 v14, 0, v1
v_min_u32 v14, 47, v14
v_mul_u32_u24 v15, 21846, v14
v_lshrrev_b32 v15, 16, v15
v_mul_u32_u24 v16, 3, v15
v_sub_u32 v16, v14, v16
s_mul_i32 s43, s48, 16
v_add_u32 v15, s43, v15
v_mul_u32_u24 v15, 6144, v15
v_lshl_add_u32 v2, v16, 11, v15
s_waitcnt lgkmcnt(0)
s_mov_b32 s56, s26
s_mov_b32 s57, s27
s_mov_b32 s58, 256
s_mov_b32 s59, 0x20000
v_lshlrev_b32 v14, 7, v1
s_barrier
s_cmp_ge_u32 s2, 128
s_cbranch_scc1 Lm_11
s_mov_b32 s84, s6
s_mov_b32 s85, s7
s_mov_b32 s86, 6291456
s_mov_b32 s87, 0x20000
s_mul_i32 s43, s2, 24576
buffer_load_dword v31, v14, s[84:87], s43 offen
s_add_u32 s43, s43, 8192
buffer_load_dword v31, v14, s[84:87], s43 offen
s_add_u32 s43, s43, 8192
buffer_load_dword v31, v14, s[84:87], s43 offen
Lm_11:
s_mov_b32 s84, s6
s_mov_b32 s85, s7
s_mov_b32 s86, 6291456
s_mov_b32 s87, 0x20000
s_lshr_b32 s44, s2, 3
s_lshr_b32 s43, s2, 5
s_cmp_eq_u32 s43, 3
s_cbranch_scc1 Lsj_12
s_cmp_gt_u32 s43, 3
s_cselect_b32 s43, 32, 0
s_sub_u32 s43, s2, s43
s_lshr_b32 s43, s43, 1
s_and_b32 s44, s2, 1
s_lshl_b32 s44, s44, 3
s_add_u32 s44, s44, 32
s_load_dwordx2 s[80:81], s[0:1], s44
s_mul_i32 s45, s43, 2341
s_lshr_b32 s45, s45, 16
s_mul_i32 s46, s45, 28
s_sub_u32 s46, s43, s46
s_lshl_b32 s45, s45, 8
s_mul_i32 s44, s47, 18
s_add_u32 s45, s45, s44
s_add_u32 s45, s45, 184
s_mul_i32 s45, s45, 7168
s_lshl_b32 s46, s46, 8
s_add_u32 s45, s45, s46
s_waitcnt lgkmcnt(0)
s_add_u32 s80, s80, s45
s_addc_u32 s81, s81, 0
Lsj_12:
s_barrier
s_cmp_ge_u32 s2, 128
s_cbranch_scc0 Lm_13
s_mov_b32 s84, s6
s_mov_b32 s85, s7
s_mov_b32 s86, 6291456
s_mov_b32 s87, 0x20000
s_mul_i32 s43, s2, 24576
buffer_load_dword v31, v14, s[84:87], s43 offen
s_add_u32 s43, s43, 8192
buffer_load_dword v31, v14, s[84:87], s43 offen
s_add_u32 s43, s43, 8192
buffer_load_dword v31, v14, s[84:87], s43 offen
Lm_13:
s_barrier
s_waitcnt vmcnt(0)
s_or_b32 s43, s34, s35
s_cmp_lg_u32 s43, 0
s_cbranch_scc1 Lz_14
s_waitcnt vmcnt(0)
v_mov_b32 v5, 1
v_mov_b32 v6, 0
s_mov_b64 exec, 1
buffer_store_dword v5, v6, s[56:59], 0 offen sc1
s_mov_b64 exec, -1
Lz_14:
v_lshlrev_b32 v116, 16, v96
v_and_b32 v117, 0xffff0000, v96
v_mul_f32 v118, v116, v116
v_mul_f32 v119, v117, v117
v_lshlrev_b32 v126, 16, v97
v_and_b32 v127, 0xffff0000, v97
v_add_f32 v116, v116, v126
v_add_f32 v117, v117, v127
v_fmac_f32 v118, v126, v126
v_fmac_f32 v119, v127, v127
v_lshlrev_b32 v124, 16, v98
v_and_b32 v125, 0xffff0000, v98
v_add_f32 v116, v116, v124
v_add_f32 v117, v117, v125
v_fmac_f32 v118, v124, v124
v_fmac_f32 v119, v125, v125
v_lshlrev_b32 v126, 16, v99
v_and_b32 v127, 0xffff0000, v99
v_add_f32 v116, v116, v126
v_add_f32 v117, v117, v127
v_fmac_f32 v118, v126, v126
v_fmac_f32 v119, v127, v127
v_lshlrev_b32 v124, 16, v100
v_and_b32 v125, 0xffff0000, v100
v_add_f32 v116, v116, v124
v_add_f32 v117, v117, v125
v_fmac_f32 v118, v124, v124
v_fmac_f32 v119, v125, v125
v_lshlrev_b32 v126, 16, v101
v_and_b32 v127, 0xffff0000, v101
v_add_f32 v116, v116, v126
v_add_f32 v117, v117, v127
v_fmac_f32 v118, v126, v126
v_fmac_f32 v119, v127, v127
v_lshlrev_b32 v124, 16, v102
v_and_b32 v125, 0xffff0000, v102
v_add_f32 v116, v116, v124
v_add_f32 v117, v117, v125
v_fmac_f32 v118, v124, v124
v_fmac_f32 v119, v125, v125
v_lshlrev_b32 v126, 16, v103
v_and_b32 v127, 0xffff0000, v103
v_add_f32 v116, v116, v126
v_add_f32 v117, v117, v127
v_fmac_f32 v118, v126, v126
v_fmac_f32 v119, v127, v127
v_lshlrev_b32 v120, 16, v104
v_and_b32 v121, 0xffff0000, v104
v_mul_f32 v122, v120, v120
v_mul_f32 v123, v121, v121
s_barrier
v_lshlrev_b32 v126, 16, v105
v_and_b32 v127, 0xffff0000, v105
v_add_f32 v120, v120, v126
v_add_f32 v121, v121, v127
v_fmac_f32 v122, v126, v126
v_fmac_f32 v123, v127, v127
v_lshlrev_b32 v124, 16, v106
v_and_b32 v125, 0xffff0000, v106
v_add_f32 v120, v120, v124
v_add_f32 v121, v121, v125
v_fmac_f32 v122, v124, v124
v_fmac_f32 v123, v125, v125
v_lshlrev_b32 v126, 16, v107
v_and_b32 v127, 0xffff0000, v107
v_add_f32 v120, v120, v126
v_add_f32 v121, v121, v127
v_fmac_f32 v122, v126, v126
v_fmac_f32 v123, v127, v127
v_lshlrev_b32 v124, 16, v108
v_and_b32 v125, 0xffff0000, v108
v_add_f32 v120, v120, v124
v_add_f32 v121, v121, v125
v_fmac_f32 v122, v124, v124
v_fmac_f32 v123, v125, v125
v_lshlrev_b32 v126, 16, v109
v_and_b32 v127, 0xffff0000, v109
v_add_f32 v120, v120, v126
v_add_f32 v121, v121, v127
v_fmac_f32 v122, v126, v126
v_fmac_f32 v123, v127, v127
v_lshlrev_b32 v124, 16, v110
v_and_b32 v125, 0xffff0000, v110
v_add_f32 v120, v120, v124
v_add_f32 v121, v121, v125
v_fmac_f32 v122, v124, v124
v_fmac_f32 v123, v125, v125
v_lshlrev_b32 v126, 16, v111
v_and_b32 v127, 0xffff0000, v111
v_add_f32 v120, v120, v126
v_add_f32 v121, v121, v127
v_fmac_f32 v122, v126, v126
v_fmac_f32 v123, v127, v127
v_add_f32 v116, v116, v117
v_add_f32 v118, v118, v119
v_add_f32 v120, v120, v121
v_add_f32 v122, v122, v123
v_add_f32_dpp v116, v116, v116 row_ror:8 row_mask:0xf bank_mask:0xf
v_add_f32_dpp v118, v118, v118 row_ror:8 row_mask:0xf bank_mask:0xf
v_add_f32_dpp v120, v120, v120 row_ror:8 row_mask:0xf bank_mask:0xf
v_add_f32_dpp v122, v122, v122 row_ror:8 row_mask:0xf bank_mask:0xf
s_barrier
v_add_f32_dpp v116, v116, v116 row_ror:4 row_mask:0xf bank_mask:0xf
v_add_f32_dpp v118, v118, v118 row_ror:4 row_mask:0xf bank_mask:0xf
v_add_f32_dpp v120, v120, v120 row_ror:4 row_mask:0xf bank_mask:0xf
v_add_f32_dpp v122, v122, v122 row_ror:4 row_mask:0xf bank_mask:0xf
v_add_f32_dpp v116, v116, v116 row_ror:2 row_mask:0xf bank_mask:0xf
v_add_f32_dpp v118, v118, v118 row_ror:2 row_mask:0xf bank_mask:0xf
v_add_f32_dpp v120, v120, v120 row_ror:2 row_mask:0xf bank_mask:0xf
v_add_f32_dpp v122, v122, v122 row_ror:2 row_mask:0xf bank_mask:0xf
v_add_f32_dpp v116, v116, v116 row_ror:1 row_mask:0xf bank_mask:0xf
v_add_f32_dpp v118, v118, v118 row_ror:1 row_mask:0xf bank_mask:0xf
v_add_f32_dpp v120, v120, v120 row_ror:1 row_mask:0xf bank_mask:0xf
v_add_f32_dpp v122, v122, v122 row_ror:1 row_mask:0xf bank_mask:0xf
v_mov_b32 v117, v116
v_mov_b32 v119, v118
v_mov_b32 v121, v120
v_mov_b32 v123, v122
s_nop 0
v_permlane16_swap_b32 v116, v117
v_permlane16_swap_b32 v118, v119
v_permlane16_swap_b32 v120, v121
v_permlane16_swap_b32 v122, v123
v_add_f32 v116, v116, v117
v_add_f32 v118, v118, v119
v_add_f32 v120, v120, v121
v_add_f32 v122, v122, v123
v_mov_b32 v117, v116
v_mov_b32 v119, v118
v_mov_b32 v121, v120
v_mov_b32 v123, v122
s_nop 0
v_permlane32_swap_b32 v116, v117
v_permlane32_swap_b32 v118, v119
v_permlane32_swap_b32 v120, v121
v_permlane32_swap_b32 v122, v123
v_add_f32 v116, v116, v117
v_add_f32 v118, v118, v119
v_add_f32 v120, v120, v121
v_add_f32 v122, v122, v123
v_mul_f32 v112, 0x3a800000, v116
v_mul_f32 v113, 0x3a800000, v118
v_fma_f32 v113, -v112, v112, v113
v_max_f32 v113, 0, v113
v_add_f32 v113, 0x3727c5ac, v113
v_rsq_f32 v113, v113
v_mul_f32 v114, 0x3a800000, v120
v_mul_f32 v115, 0x3a800000, v122
v_fma_f32 v115, -v114, v114, v115
v_max_f32 v115, 0, v115
v_add_f32 v115, 0x3727c5ac, v115
v_rsq_f32 v115, v115
s_nop 0
s_lshl_b32 s43, s47, 4
s_add_u32 s43, s43, 130176
v_mov_b32 v11, s43
ds_write_b128 v11, v[112:115]
s_waitcnt lgkmcnt(0)
s_barrier
v_lshlrev_b32 v5, 4, v1
v_and_b32 v5, 63, v5
v_add_u32 v6, 130176, v5
ds_read_b128 v[112:115], v6
s_lshl_b32 s43, s63, 3
v_add_u32 v5, s43, v5
s_waitcnt lgkmcnt(0)
s_mov_b64 exec, 15
buffer_store_dwordx4 v[112:115], v5, s[20:23], 0 offen sc1
s_mov_b64 exec, -1
v_mov_b32 v7, 0
v_mov_b32 v9, 1
buffer_load_dword v8, v7, s[56:59], 0 offen sc1
s_load_dword s64, s[80:81], 0
s_load_dword s65, s[80:81], 64
s_load_dword s66, s[80:81], 128
s_load_dword s67, s[80:81], 192
s_load_dword s68, s[80:81], 7168
s_load_dword s69, s[80:81], 7232
s_load_dword s70, s[80:81], 7296
s_load_dword s71, s[80:81], 7360
s_add_u32 s80, s80, 14336
s_addc_u32 s81, s81, 0
s_barrier
s_load_dword s64, s[80:81], 0
s_load_dword s65, s[80:81], 64
s_load_dword s66, s[80:81], 128
s_load_dword s67, s[80:81], 192
s_load_dword s68, s[80:81], 7168
s_load_dword s69, s[80:81], 7232
s_load_dword s70, s[80:81], 7296
s_load_dword s71, s[80:81], 7360
s_add_u32 s80, s80, 14336
s_addc_u32 s81, s81, 0
s_barrier
s_mov_b32 s41, 0x10000
Lpoll_15:
s_waitcnt vmcnt(0)
Lpf_17:
v_cmp_ne_u32 vcc, v9, v8
s_nop 4
s_cbranch_vccz Lpok_16
buffer_load_dword v8, v7, s[56:59], 0 offen sc1
s_sub_u32 s41, s41, 1
s_cmp_lg_u32 s41, 0
s_cbranch_scc1 Lpoll_15
s_waitcnt vmcnt(0)
Lpok_16:
s_add_u32 s56, s32, 28311552
s_addc_u32 s57, s33, 0
s_mov_b32 s58, 32768
s_mov_b32 s59, 0x20000
s_add_u32 s43, s34, 80
s_lshl_b32 s43, s43, 7
v_mov_b32 v5, s43
v_mov_b32 v6, 1
s_mov_b64 exec, 1
buffer_atomic_add v6, v5, s[56:59], 0 offen sc1
s_mov_b64 exec, -1
s_load_dword s64, s[80:81], 0
s_load_dword s65, s[80:81], 64
s_load_dword s66, s[80:81], 128
s_load_dword s67, s[80:81], 192
s_load_dword s68, s[80:81], 7168
s_load_dword s69, s[80:81], 7232
s_load_dword s70, s[80:81], 7296
s_load_dword s71, s[80:81], 7360
s_add_u32 s80, s80, 14336
s_addc_u32 s81, s81, 0
s_barrier
s_load_dword s64, s[80:81], 0
s_load_dword s65, s[80:81], 64
s_load_dword s66, s[80:81], 128
s_load_dword s67, s[80:81], 192
s_load_dword s68, s[80:81], 7168
s_load_dword s69, s[80:81], 7232
s_load_dword s70, s[80:81], 7296
s_load_dword s71, s[80:81], 7360
s_add_u32 s80, s80, 14336
s_addc_u32 s81, s81, 0
s_barrier
s_load_dword s64, s[80:81], 0
s_load_dword s65, s[80:81], 64
s_load_dword s66, s[80:81], 128
s_load_dword s67, s[80:81], 192
s_load_dword s68, s[80:81], 7168
s_load_dword s69, s[80:81], 7232
s_load_dword s70, s[80:81], 7296
s_load_dword s71, s[80:81], 7360
s_add_u32 s80, s80, 14336
s_addc_u32 s81, s81, 0
s_barrier
s_sub_u32 s44, s34, 1
s_max_i32 s44, s44, 0
v_mov_b32 v5, s44
v_mov_b32 v6, s34
v_cmp_eq_u32 vcc, 0, v1
s_nop 1
v_cndmask_b32 v5, v5, v6, vcc
v_add_u32 v5, 80, v5
v_lshlrev_b32 v5, 7, v5
buffer_load_dword v6, v5, s[56:59], 0 offen sc1
s_load_dword s64, s[80:81], 0
s_load_dword s65, s[80:81], 64
s_load_dword s66, s[80:81], 128
s_load_dword s67, s[80:81], 192
s_load_dword s68, s[80:81], 7168
s_load_dword s69, s[80:81], 7232
s_load_dword s70, s[80:81], 7296
s_load_dword s71, s[80:81], 7360
s_add_u32 s80, s80, 14336
s_addc_u32 s81, s81, 0
s_barrier
s_load_dword s64, s[80:81], 0
s_load_dword s65, s[80:81], 64
s_load_dword s66, s[80:81], 128
s_load_dword s67, s[80:81], 192
s_load_dword s68, s[80:81], 7168
s_load_dword s69, s[80:81], 7232
s_load_dword s70, s[80:81], 7296
s_load_dword s71, s[80:81], 7360
s_add_u32 s80, s80, 14336
s_addc_u32 s81, s81, 0
s_barrier
s_mov_b32 s41, 200
s_mov_b32 s62, 0
s_waitcnt vmcnt(0)
Lpoll_18:
v_cmp_ne_u32 vcc, 16, v6
s_nop 4
s_cbranch_vccz Lok_19
buffer_load_dword v6, v5, s[56:59], 0 offen sc1
s_waitcnt vmcnt(0)
s_sub_u32 s41, s41, 1
s_cmp_lg_u32 s41, 0
s_cbranch_scc1 Lpoll_18
s_mov_b32 s41, 0
Lfb_20:
s_add_u32 s62, s50, s41
s_max_i32 s62, s62, 0
s_lshl_b32 s43, s62, 11
buffer_load_dwordx4 v[96:99], v10, s[8:11], s43 offen offset:0
buffer_load_dwordx4 v[100:103], v10, s[8:11], s43 offen offset:1024
buffer_load_dwordx4 v[104:107], v10, s[8:11], s43 offen offset:2048
buffer_load_dwordx4 v[108:111], v10, s[8:11], s43 offen offset:3072
s_waitcnt vmcnt(0)
v_lshlrev_b32 v116, 16, v96
v_and_b32 v117, 0xffff0000, v96
v_mul_f32 v118, v116, v116
v_mul_f32 v119, v117, v117
v_lshlrev_b32 v126, 16, v97
v_and_b32 v127, 0xffff0000, v97
v_add_f32 v116, v116, v126
v_add_f32 v117, v117, v127
v_fmac_f32 v118, v126, v126
v_fmac_f32 v119, v127, v127
v_lshlrev_b32 v124, 16, v98
v_and_b32 v125, 0xffff0000, v98
v_add_f32 v116, v116, v124
v_add_f32 v117, v117, v125
v_fmac_f32 v118, v124, v124
v_fmac_f32 v119, v125, v125
v_lshlrev_b32 v126, 16, v99
v_and_b32 v127, 0xffff0000, v99
v_add_f32 v116, v116, v126
v_add_f32 v117, v117, v127
v_fmac_f32 v118, v126, v126
v_fmac_f32 v119, v127, v127
v_lshlrev_b32 v124, 16, v100
v_and_b32 v125, 0xffff0000, v100
v_add_f32 v116, v116, v124
v_add_f32 v117, v117, v125
v_fmac_f32 v118, v124, v124
v_fmac_f32 v119, v125, v125
v_lshlrev_b32 v126, 16, v101
v_and_b32 v127, 0xffff0000, v101
v_add_f32 v116, v116, v126
v_add_f32 v117, v117, v127
v_fmac_f32 v118, v126, v126
v_fmac_f32 v119, v127, v127
v_lshlrev_b32 v124, 16, v102
v_and_b32 v125, 0xffff0000, v102
v_add_f32 v116, v116, v124
v_add_f32 v117, v117, v125
v_fmac_f32 v118, v124, v124
v_fmac_f32 v119, v125, v125
v_lshlrev_b32 v126, 16, v103
v_and_b32 v127, 0xffff0000, v103
v_add_f32 v116, v116, v126
v_add_f32 v117, v117, v127
v_fmac_f32 v118, v126, v126
v_fmac_f32 v119, v127, v127
v_lshlrev_b32 v120, 16, v104
v_and_b32 v121, 0xffff0000, v104
v_mul_f32 v122, v120, v120
v_mul_f32 v123, v121, v121
v_lshlrev_b32 v126, 16, v105
v_and_b32 v127, 0xffff0000, v105
v_add_f32 v120, v120, v126
v_add_f32 v121, v121, v127
v_fmac_f32 v122, v126, v126
v_fmac_f32 v123, v127, v127
v_lshlrev_b32 v124, 16, v106
v_and_b32 v125, 0xffff0000, v106
v_add_f32 v120, v120, v124
v_add_f32 v121, v121, v125
v_fmac_f32 v122, v124, v124
v_fmac_f32 v123, v125, v125
v_lshlrev_b32 v126, 16, v107
v_and_b32 v127, 0xffff0000, v107
v_add_f32 v120, v120, v126
v_add_f32 v121, v121, v127
v_fmac_f32 v122, v126, v126
v_fmac_f32 v123, v127, v127
v_lshlrev_b32 v124, 16, v108
v_and_b32 v125, 0xffff0000, v108
v_add_f32 v120, v120, v124
v_add_f32 v121, v121, v125
v_fmac_f32 v122, v124, v124
v_fmac_f32 v123, v125, v125
v_lshlrev_b32 v126, 16, v109
v_and_b32 v127, 0xffff0000, v109
v_add_f32 v120, v120, v126
v_add_f32 v121, v121, v127
v_fmac_f32 v122, v126, v126
v_fmac_f32 v123, v127, v127
v_lshlrev_b32 v124, 16, v110
v_and_b32 v125, 0xffff0000, v110
v_add_f32 v120, v120, v124
v_add_f32 v121, v121, v125
v_fmac_f32 v122, v124, v124
v_fmac_f32 v123, v125, v125
v_lshlrev_b32 v126, 16, v111
v_and_b32 v127, 0xffff0000, v111
v_add_f32 v120, v120, v126
v_add_f32 v121, v121, v127
v_fmac_f32 v122, v126, v126
v_fmac_f32 v123, v127, v127
v_add_f32 v116, v116, v117
v_add_f32 v118, v118, v119
v_add_f32 v120, v120, v121
v_add_f32 v122, v122, v123
v_add_f32_dpp v116, v116, v116 row_ror:8 row_mask:0xf bank_mask:0xf
v_add_f32_dpp v118, v118, v118 row_ror:8 row_mask:0xf bank_mask:0xf
v_add_f32_dpp v120, v120, v120 row_ror:8 row_mask:0xf bank_mask:0xf
v_add_f32_dpp v122, v122, v122 row_ror:8 row_mask:0xf bank_mask:0xf
v_add_f32_dpp v116, v116, v116 row_ror:4 row_mask:0xf bank_mask:0xf
v_add_f32_dpp v118, v118, v118 row_ror:4 row_mask:0xf bank_mask:0xf
v_add_f32_dpp v120, v120, v120 row_ror:4 row_mask:0xf bank_mask:0xf
v_add_f32_dpp v122, v122, v122 row_ror:4 row_mask:0xf bank_mask:0xf
v_add_f32_dpp v116, v116, v116 row_ror:2 row_mask:0xf bank_mask:0xf
v_add_f32_dpp v118, v118, v118 row_ror:2 row_mask:0xf bank_mask:0xf
v_add_f32_dpp v120, v120, v120 row_ror:2 row_mask:0xf bank_mask:0xf
v_add_f32_dpp v122, v122, v122 row_ror:2 row_mask:0xf bank_mask:0xf
v_add_f32_dpp v116, v116, v116 row_ror:1 row_mask:0xf bank_mask:0xf
v_add_f32_dpp v118, v118, v118 row_ror:1 row_mask:0xf bank_mask:0xf
v_add_f32_dpp v120, v120, v120 row_ror:1 row_mask:0xf bank_mask:0xf
v_add_f32_dpp v122, v122, v122 row_ror:1 row_mask:0xf bank_mask:0xf
v_mov_b32 v117, v116
v_mov_b32 v119, v118
v_mov_b32 v121, v120
v_mov_b32 v123, v122
s_nop 0
v_permlane16_swap_b32 v116, v117
v_permlane16_swap_b32 v118, v119
v_permlane16_swap_b32 v120, v121
v_permlane16_swap_b32 v122, v123
v_add_f32 v116, v116, v117
v_add_f32 v118, v118, v119
v_add_f32 v120, v120, v121
v_add_f32 v122, v122, v123
v_mov_b32 v117, v116
v_mov_b32 v119, v118
v_mov_b32 v121, v120
v_mov_b32 v123, v122
s_nop 0
v_permlane32_swap_b32 v116, v117
v_permlane32_swap_b32 v118, v119
v_permlane32_swap_b32 v120, v121
v_permlane32_swap_b32 v122, v123
v_add_f32 v116, v116, v117
v_add_f32 v118, v118, v119
v_add_f32 v120, v120, v121
v_add_f32 v122, v122, v123
v_mul_f32 v112, 0x3a800000, v116
v_mul_f32 v113, 0x3a800000, v118
v_fma_f32 v113, -v112, v112, v113
v_max_f32 v113, 0, v113
v_add_f32 v113, 0x3727c5ac, v113
v_rsq_f32 v113, v113
v_mul_f32 v114, 0x3a800000, v120
v_mul_f32 v115, 0x3a800000, v122
v_fma_f32 v115, -v114, v114, v115
v_max_f32 v115, 0, v115
v_add_f32 v115, 0x3727c5ac, v115
v_rsq_f32 v115, v115
s_nop 0
s_lshl_b32 s43, s41, 3
s_add_u32 s43, s43, 129024
v_mov_b32 v5, s43
ds_write_b128 v5, v[112:115]
s_add_u32 s41, s41, 2
s_cmp_lt_u32 s41, 144
s_cbranch_scc1 Lfb_20
s_mov_b32 s62, 1
Lok_19:
v_add_u32 v5, 0, v1
v_min_u32 v5, 143, v5
v_lshlrev_b32 v20, 3, v5
v_add_u32 v5, s50, v5
v_max_i32 v5, 0, v5
v_lshlrev_b32 v5, 3, v5
buffer_load_dwordx2 v[32:33], v5, s[20:23], 0 offen sc1
v_add_u32 v5, 64, v1
v_min_u32 v5, 143, v5
v_lshlrev_b32 v21, 3, v5
v_add_u32 v5, s50, v5
v_max_i32 v5, 0, v5
v_lshlrev_b32 v5, 3, v5
buffer_load_dwordx2 v[34:35], v5, s[20:23], 0 offen sc1
v_add_u32 v5, 128, v1
v_min_u32 v5, 143, v5
v_lshlrev_b32 v22, 3, v5
v_add_u32 v5, s50, v5
v_max_i32 v5, 0, v5
v_lshlrev_b32 v5, 3, v5
buffer_load_dwordx2 v[36:37], v5, s[20:23], 0 offen sc1
s_load_dword s64, s[80:81], 0
s_load_dword s65, s[80:81], 64
s_load_dword s66, s[80:81], 128
s_load_dword s67, s[80:81], 192
s_load_dword s68, s[80:81], 7168
s_load_dword s69, s[80:81], 7232
s_load_dword s70, s[80:81], 7296
s_load_dword s71, s[80:81], 7360
s_add_u32 s80, s80, 14336
s_addc_u32 s81, s81, 0
s_barrier
s_load_dwordx2 s[88:89], s[0:1], 16
v_lshlrev_b32 v29, 7, v1
s_lshl_b32 s43, s2, 13
s_waitcnt lgkmcnt(0)
s_mov_b32 s84, s88
s_mov_b32 s85, s89
s_mov_b32 s86, 2097152
s_mov_b32 s87, 0x20000
buffer_load_dword v30, v29, s[84:87], s43 offen
v_and_b32 v29, 31, v1
v_lshlrev_b32 v29, 11, v29
s_and_b32 s43, s35, 8
s_or_b32 s43, s43, 3
s_lshl_b32 s43, s43, 7
s_lshr_b32 s44, s2, 3
s_lshl_b32 s44, s44, 16
s_add_u32 s43, s43, s44
buffer_load_dword v30, v29, s[84:87], s43 offen
s_barrier
s_waitcnt vmcnt(2)
s_cmp_eq_u32 s62, 1
s_cbranch_scc1 Lgd_10
v_add_u32 v20, 129024, v20
ds_write_b64 v20, v[32:33]
v_add_u32 v21, 129024, v21
ds_write_b64 v21, v[34:35]
v_add_u32 v22, 129024, v22
ds_write_b64 v22, v[36:37]
Lgd_10:
s_waitcnt lgkmcnt(0)
s_lshr_b32 s43, s2, 5
s_cmp_eq_u32 s43, 3
s_cbranch_scc1 Lnj_21
s_cmp_gt_u32 s43, 3
s_cselect_b32 s43, 32, 0
s_sub_u32 s43, s2, s43
s_lshr_b32 s43, s43, 1
s_and_b32 s44, s2, 1
s_lshl_b32 s45, s44, 3
s_add_u32 s45, s45, 32
s_load_dwordx2 s[88:89], s[0:1], s45
s_mul_i32 s45, s43, 2341
s_lshr_b32 s45, s45, 16
s_mul_i32 s46, s45, 28
s_sub_u32 s46, s43, s46
v_lshrrev_b32 v28, 4, v1
s_lshl_b32 s43, s45, 8
v_add_u32 v28, s43, v28
v_mul_u32_u24 v28, 7168, v28
v_and_b32 v29, 15, v1
v_lshl_add_u32 v28, v29, 4, v28
s_lshl_b32 s43, s46, 8
v_add_u32 v28, s43, v28
s_waitcnt lgkmcnt(0)
s_mov_b32 s84, s88
s_mov_b32 s85, s89
s_mov_b32 s86, 7340032
s_mov_b32 s87, 0x20000
s_mov_b32 s43, 0
buffer_load_dwordx4 v[128:131], v28, s[84:87], s43 offen
s_mov_b32 s43, 28672
buffer_load_dwordx4 v[132:135], v28, s[84:87], s43 offen
s_mov_b32 s43, 57344
buffer_load_dwordx4 v[136:139], v28, s[84:87], s43 offen
s_mov_b32 s43, 86016
buffer_load_dwordx4 v[140:143], v28, s[84:87], s43 offen
s_mov_b32 s43, 114688
buffer_load_dwordx4 v[144:147], v28, s[84:87], s43 offen
s_mov_b32 s43, 143360
buffer_load_dwordx4 v[148:151], v28, s[84:87], s43 offen
s_mov_b32 s43, 172032
buffer_load_dwordx4 v[152:155], v28, s[84:87], s43 offen
s_mov_b32 s43, 200704
buffer_load_dwordx4 v[156:159], v28, s[84:87], s43 offen
s_mov_b32 s43, 229376
buffer_load_dwordx4 v[160:163], v28, s[84:87], s43 offen
s_mov_b32 s43, 258048
buffer_load_dwordx4 v[164:167], v28, s[84:87], s43 offen
s_mov_b32 s43, 286720
buffer_load_dwordx4 v[168:171], v28, s[84:87], s43 offen
s_mov_b32 s43, 315392
buffer_load_dwordx4 v[172:175], v28, s[84:87], s43 offen
s_mov_b32 s43, 344064
buffer_load_dwordx4 v[176:179], v28, s[84:87], s43 offen
s_mov_b32 s43, 372736
buffer_load_dwordx4 v[180:183], v28, s[84:87], s43 offen
s_mov_b32 s43, 401408
buffer_load_dwordx4 v[184:187], v28, s[84:87], s43 offen
s_mov_b32 s43, 430080
buffer_load_dwordx4 v[188:191], v28, s[84:87], s43 offen
Lnj_21:
s_barrier
s_lshr_b32 s43, s2, 5
s_cmp_eq_u32 s43, 3
s_cbranch_scc1 Lnj_22
s_cmp_gt_u32 s43, 3
s_cselect_b32 s43, 32, 0
s_sub_u32 s43, s2, s43
s_lshr_b32 s43, s43, 1
s_and_b32 s44, s2, 1
s_lshl_b32 s45, s44, 3
s_add_u32 s45, s45, 32
s_load_dwordx2 s[88:89], s[0:1], s45
s_mul_i32 s45, s43, 2341
s_lshr_b32 s45, s45, 16
s_mul_i32 s46, s45, 28
s_sub_u32 s46, s43, s46
v_lshrrev_b32 v28, 4, v1
s_lshl_b32 s43, s45, 8
v_add_u32 v28, s43, v28
v_mul_u32_u24 v28, 7168, v28
v_and_b32 v29, 15, v1
v_lshl_add_u32 v28, v29, 4, v28
s_lshl_b32 s43, s46, 8
v_add_u32 v28, s43, v28
s_waitcnt lgkmcnt(0)
s_mov_b32 s84, s88
s_mov_b32 s85, s89
s_mov_b32 s86, 7340032
s_mov_b32 s87, 0x20000
s_mov_b32 s43, 458752
buffer_load_dwordx4 v[192:195], v28, s[84:87], s43 offen
s_mov_b32 s43, 487424
buffer_load_dwordx4 v[196:199], v28, s[84:87], s43 offen
s_mov_b32 s43, 516096
buffer_load_dwordx4 v[200:203], v28, s[84:87], s43 offen
s_mov_b32 s43, 544768
buffer_load_dwordx4 v[204:207], v28, s[84:87], s43 offen
s_mov_b32 s43, 573440
buffer_load_dwordx4 v[208:211], v28, s[84:87], s43 offen
s_mov_b32 s43, 602112
buffer_load_dwordx4 v[212:215], v28, s[84:87], s43 offen
s_mov_b32 s43, 630784
buffer_load_dwordx4 v[216:219], v28, s[84:87], s43 offen
s_mov_b32 s43, 659456
buffer_load_dwordx4 v[220:223], v28, s[84:87], s43 offen
s_mov_b32 s43, 688128
buffer_load_dwordx4 v[224:227], v28, s[84:87], s43 offen
s_mov_b32 s43, 716800
buffer_load_dwordx4 v[228:231], v28, s[84:87], s43 offen
s_mov_b32 s43, 745472
buffer_load_dwordx4 v[232:235], v28, s[84:87], s43 offen
s_mov_b32 s43, 774144
buffer_load_dwordx4 v[236:239], v28, s[84:87], s43 offen
s_mov_b32 s43, 802816
buffer_load_dwordx4 v[240:243], v28, s[84:87], s43 offen
s_mov_b32 s43, 831488
buffer_load_dwordx4 v[244:247], v28, s[84:87], s43 offen
s_mov_b32 s43, 860160
buffer_load_dwordx4 v[248:251], v28, s[84:87], s43 offen
s_mov_b32 s43, 888832
buffer_load_dwordx4 v[252:255], v28, s[84:87], s43 offen
Lnj_22:
s_barrier
s_waitcnt lgkmcnt(0)
s_and_b32 s43, s36, 1
s_lshr_b32 s44, s36, 1
s_and_b32 s44, s44, 1
s_lshr_b32 s45, s36, 2
v_lshlrev_b32 v14, 2, v13
v_sub_u32 v14, v12, v14
v_subrev_u32 v15, 0, v14
v_cmp_ge_u32 s[52:53], 7, v15
v_add_u32 v15, 16, v15
v_cmp_ge_u32 s[84:85], 7, v15
v_subrev_u32 v15, 1, v14
v_cmp_ge_u32 s[54:55], 7, v15
v_add_u32 v15, 16, v15
v_cmp_ge_u32 s[86:87], 7, v15
v_subrev_u32 v15, 2, v14
v_cmp_ge_u32 s[56:57], 7, v15
v_add_u32 v15, 16, v15
v_cmp_ge_u32 s[88:89], 7, v15
v_subrev_u32 v15, 3, v14
v_cmp_ge_u32 s[58:59], 7, v15
v_add_u32 v15, 16, v15
v_cmp_ge_u32 s[90:91], 7, v15
s_lshl_b32 s46, s45, 6
s_add_u32 s46, s46, s44
s_add_u32 s46, s46, 16
v_lshl_add_u32 v14, v12, 1, s46
s_lshl_b32 s47, s43, 6
v_lshl_add_u32 v15, v13, 4, s47
v_mul_u32_u24 v20, 400, v14
v_add_u32 v20, v20, v15
v_subrev_u32 v16, 32, v14
v_max_i32 v16, 0, v16
v_mul_u32_u24 v21, 400, v16
v_add_u32 v21, v21, v15
v_lshrrev_b32 v16, 2, v12
v_lshl_add_u32 v16, v13, 2, v16
v_lshl_add_u32 v16, v16, 1, s46
v_and_b32 v17, 3, v1
v_lshl_add_u32 v17, v17, 3, s47
v_mul_u32_u24 v22, 400, v16
v_add_u32 v22, v22, v17
v_subrev_u32 v16, 32, v16
v_max_i32 v16, 0, v16
v_mul_u32_u24 v23, 400, v16
v_add_u32 v23, v23, v17
s_lshl_b32 s60, s43, 13
s_lshl_b32 s61, s45, 10
s_add_u32 s60, s60, s61
s_lshl_b32 s61, s44, 8
s_add_u32 s60, s60, s61
v_lshlrev_b32 v27, 11, v13
v_lshl_add_u32 v27, v12, 4, v27
v_add_u32 v27, s60, v27
v_mov_b32 v28, 0xff800000
s_mov_b32 s61, 0x3e8293ee
s_nop 2
s_or_b32 s62, s34, s45
s_cmp_lg_u32 s62, 0
s_cselect_b64 s[64:65], s[84:85], 0
s_cselect_b64 s[66:67], s[86:87], 0
s_cselect_b64 s[68:69], s[88:89], 0
s_cselect_b64 s[70:71], s[90:91], 0
Latt_4:
s_barrier
ds_read_b128 v[32:35], v20 offset:0
ds_read_b128 v[36:39], v20 offset:128
ds_read_b128 v[40:43], v21 offset:128
ds_read_b128 v[80:83], v20 offset:12800
ds_read_b128 v[84:87], v20 offset:12928
ds_read_b128 v[88:91], v20 offset:128
ds_read_b64_tr_b16 v[44:45], v23 offset:256
ds_read_b64_tr_b16 v[46:47], v22 offset:256
ds_read_b64_tr_b16 v[48:49], v23 offset:288
ds_read_b64_tr_b16 v[50:51], v22 offset:288
ds_read_b64_tr_b16 v[92:93], v22 offset:256
ds_read_b64_tr_b16 v[94:95], v22 offset:13056
ds_read_b64_tr_b16 v[96:97], v22 offset:288
ds_read_b64_tr_b16 v[98:99], v22 offset:13088
s_waitcnt lgkmcnt(11)
v_mfma_f32_16x16x32_bf16 v[52:55], v[40:43], v[32:35], 0
v_mfma_f32_16x16x32_bf16 v[56:59], v[36:39], v[32:35], 0
s_waitcnt lgkmcnt(8)
v_mfma_f32_16x16x32_bf16 v[100:103], v[88:91], v[80:83], 0
v_mfma_f32_16x16x32_bf16 v[104:107], v[84:87], v[80:83], 0
s_nop 7
v_cndmask_b32 v52, v28, v52, s[64:65]
v_cndmask_b32 v100, v28, v100, s[84:85]
v_cndmask_b32 v53, v28, v53, s[66:67]
v_cndmask_b32 v101, v28, v101, s[86:87]
v_cndmask_b32 v54, v28, v54, s[68:69]
v_cndmask_b32 v102, v28, v102, s[88:89]
v_cndmask_b32 v55, v28, v55, s[70:71]
v_cndmask_b32 v103, v28, v103, s[90:91]
v_cndmask_b32 v56, v28, v56, s[52:53]
v_cndmask_b32 v104, v28, v104, s[52:53]
v_cndmask_b32 v57, v28, v57, s[54:55]
v_cndmask_b32 v105, v28, v105, s[54:55]
v_cndmask_b32 v58, v28, v58, s[56:57]
v_cndmask_b32 v106, v28, v106, s[56:57]
v_cndmask_b32 v59, v28, v59, s[58:59]
v_cndmask_b32 v107, v28, v107, s[58:59]
v_max3_f32 v60, v52, v53, v54
v_max3_f32 v108, v100, v101, v102
v_max3_f32 v61, v55, v56, v57
v_max3_f32 v109, v103, v104, v105
v_max3_f32 v60, v60, v58, v59
v_max3_f32 v108, v108, v106, v107
v_max_f32 v60, v60, v61
v_max_f32 v108, v108, v109
v_mov_b32 v61, v60
v_mov_b32 v109, v108
s_nop 0
v_permlane32_swap_b32 v60, v61
v_permlane32_swap_b32 v108, v109
v_max_f32 v60, v60, v61
v_max_f32 v108, v108, v109
v_mov_b32 v61, v60
v_mov_b32 v109, v108
s_nop 0
v_permlane16_swap_b32 v60, v61
v_permlane16_swap_b32 v108, v109
v_max_f32 v60, v60, v61
v_max_f32 v108, v108, v109
v_mul_f32 v60, s61, v60
v_mul_f32 v108, s61, v108
v_fma_f32 v52, v52, s61, -v60
v_fma_f32 v100, v100, s61, -v108
v_fma_f32 v53, v53, s61, -v60
v_fma_f32 v101, v101, s61, -v108
v_fma_f32 v54, v54, s61, -v60
v_fma_f32 v102, v102, s61, -v108
v_fma_f32 v55, v55, s61, -v60
v_fma_f32 v103, v103, s61, -v108
v_fma_f32 v56, v56, s61, -v60
v_fma_f32 v104, v104, s61, -v108
v_fma_f32 v57, v57, s61, -v60
v_fma_f32 v105, v105, s61, -v108
v_fma_f32 v58, v58, s61, -v60
v_fma_f32 v106, v106, s61, -v108
v_fma_f32 v59, v59, s61, -v60
v_fma_f32 v107, v107, s61, -v108
v_exp_f32 v52, v52
v_exp_f32 v100, v100
v_exp_f32 v53, v53
v_exp_f32 v101, v101
v_exp_f32 v54, v54
v_exp_f32 v102, v102
v_exp_f32 v55, v55
v_exp_f32 v103, v103
v_exp_f32 v56, v56
v_exp_f32 v104, v104
v_exp_f32 v57, v57
v_exp_f32 v105, v105
v_exp_f32 v58, v58
v_exp_f32 v106, v106
v_exp_f32 v59, v59
v_exp_f32 v107, v107
v_cvt_pk_bf16_f32 v64, v52, v53
v_cvt_pk_bf16_f32 v112, v100, v101
v_cvt_pk_bf16_f32 v65, v54, v55
v_cvt_pk_bf16_f32 v113, v102, v103
v_cvt_pk_bf16_f32 v66, v56, v57
v_cvt_pk_bf16_f32 v114, v104, v105
v_cvt_pk_bf16_f32 v67, v58, v59
v_cvt_pk_bf16_f32 v115, v106, v107
s_waitcnt lgkmcnt(0)
v_mfma_f32_16x16x32_bf16 v[68:71], v[44:47], v[64:67], 0
v_mfma_f32_16x16x32_bf16 v[72:75], v[48:51], v[64:67], 0
v_mfma_f32_16x16x32_bf16 v[116:119], v[92:95], v[112:115], 0
v_mfma_f32_16x16x32_bf16 v[120:123], v[96:99], v[112:115], 0
v_add_f32 v60, v52, v53
v_add_f32 v108, v100, v101
v_add_f32 v61, v54, v55
v_add_f32 v109, v102, v103
v_add_f32 v56, v56, v57
v_add_f32 v104, v104, v105
v_add_f32 v58, v58, v59
v_add_f32 v106, v106, v107
v_add_f32 v60, v60, v61
v_add_f32 v108, v108, v109
v_add_f32 v56, v56, v58
v_add_f32 v104, v104, v106
v_add_f32 v60, v60, v56
v_add_f32 v108, v108, v104
v_mov_b32 v61, v60
v_mov_b32 v109, v108
s_nop 0
v_permlane32_swap_b32 v60, v61
v_permlane32_swap_b32 v108, v109
v_add_f32 v60, v60, v61
v_add_f32 v108, v108, v109
v_mov_b32 v61, v60
v_mov_b32 v109, v108
s_nop 0
v_permlane16_swap_b32 v60, v61
v_permlane16_swap_b32 v108, v109
v_add_f32 v60, v60, v61
v_add_f32 v108, v108, v109
v_rcp_f32 v60, v60
v_rcp_f32 v108, v108
s_nop 0
v_pk_mul_f32 v[68:69], v[60:61], v[68:69] op_sel_hi:[0,1]
v_pk_mul_f32 v[70:71], v[60:61], v[70:71] op_sel_hi:[0,1]
v_pk_mul_f32 v[72:73], v[60:61], v[72:73] op_sel_hi:[0,1]
v_pk_mul_f32 v[74:75], v[60:61], v[74:75] op_sel_hi:[0,1]
v_cvt_pk_bf16_f32 v68, v68, v69
v_cvt_pk_bf16_f32 v69, v70, v71
v_cvt_pk_bf16_f32 v70, v72, v73
v_cvt_pk_bf16_f32 v71, v74, v75
buffer_store_dwordx4 v[68:71], v27, s[16:19], 0 offen offset:0 sc1
v_pk_mul_f32 v[116:117], v[108:109], v[116:117] op_sel_hi:[0,1]
v_pk_mul_f32 v[118:119], v[108:109], v[118:119] op_sel_hi:[0,1]
v_pk_mul_f32 v[120:121], v[108:109], v[120:121] op_sel_hi:[0,1]
v_pk_mul_f32 v[122:123], v[108:109], v[122:123] op_sel_hi:[0,1]
v_cvt_pk_bf16_f32 v116, v116, v117
v_cvt_pk_bf16_f32 v117, v118, v119
v_cvt_pk_bf16_f32 v118, v120, v121
v_cvt_pk_bf16_f32 v119, v122, v123
buffer_store_dwordx4 v[116:119], v27, s[16:19], 0 offen offset:512 sc1
s_waitcnt vmcnt(0)
s_barrier
s_add_u32 s56, s32, 28311552
s_addc_u32 s57, s33, 0
s_mov_b32 s58, 32768
s_mov_b32 s59, 0x20000
s_cmp_lg_u32 s36, 0
s_cbranch_scc1 Lsig_23
s_add_u32 s43, s34, 0
s_lshl_b32 s43, s43, 7
v_mov_b32 v5, s43
v_mov_b32 v6, 1
s_mov_b64 exec, 1
buffer_atomic_add v6, v5, s[56:59], 0 offen sc1
s_mov_b64 exec, -1
Lsig_23:
s_load_dwordx4 s[4:7], s[0:1], 32
s_load_dwordx2 s[28:29], s[0:1], 16
s_load_dwordx4 s[60:63], s[0:1], 48
s_load_dwordx2 s[30:31], s[0:1], 0
v_and_b32 v17, 15, v1
v_lshrrev_b32 v18, 4, v1
s_lshr_b32 s46, s36, 1
s_and_b32 s46, s46, 1
s_and_b32 s47, s36, 1
s_and_b32 s51, s36, 3
s_waitcnt lgkmcnt(0)
s_cmp_ge_u32 s36, 4
s_cbranch_scc1 LG1_24
s_lshl_b32 s43, s34, 18
s_lshl_b32 s44, s35, 7
s_add_u32 s43, s43, s44
s_add_u32 s16, s30, s43
s_addc_u32 s17, s31, 0
s_mov_b32 s18, 260224
s_mov_b32 s19, 0x20000
s_lshl_b32 s43, s36, 5
v_lshl_add_u32 v19, v17, 1, s43
v_lshlrev_b32 v19, 11, v19
v_lshl_add_u32 v23, v18, 3, v19
buffer_load_dwordx2 v[160:161], v23, s[16:19], 0 offen offset:0
buffer_load_dwordx2 v[162:163], v23, s[16:19], 0 offen offset:32
buffer_load_dwordx2 v[164:165], v23, s[16:19], 0 offen offset:64
buffer_load_dwordx2 v[166:167], v23, s[16:19], 0 offen offset:96
buffer_load_dwordx2 v[168:169], v23, s[16:19], 0 offen offset:2048
buffer_load_dwordx2 v[170:171], v23, s[16:19], 0 offen offset:2080
buffer_load_dwordx2 v[172:173], v23, s[16:19], 0 offen offset:2112
buffer_load_dwordx2 v[174:175], v23, s[16:19], 0 offen offset:2144
v_lshlrev_b32 v19, 11, v18
v_lshl_add_u32 v19, v17, 4, v19
s_lshl_b32 s43, s36, 9
v_add_u32 v2, s43, v19
v_add_u32 v3, 49152, v2
v_add_u32 v4, 98304, v2
v_lshrrev_b32 v19, 2, v17
v_lshl_add_u32 v20, v18, 2, v19
v_bfe_u32 v21, v20, 1, 2
v_lshlrev_b32 v20, 7, v20
v_lshl_add_u32 v20, v21, 5, v20
v_and_b32 v19, 3, v1
v_lshl_add_u32 v20, v19, 3, v20
v_add_u32 v5, 16384, v20
v_xor_b32 v6, 32, v5
v_xor_b32 v7, 64, v5
v_xor_b32 v8, 96, v5
v_add_u32 v9, 49152, v5
v_add_u32 v10, 49152, v6
v_add_u32 v11, 49152, v7
v_add_u32 v12, 49152, v8
v_add_u32 v13, 98304, v5
v_add_u32 v14, 98304, v6
v_add_u32 v15, 98304, v7
v_add_u32 v16, 98304, v8
s_lshl_b32 s43, s34, 18
s_lshl_b32 s44, s35, 14
s_add_u32 s43, s43, s44
s_add_u32 s20, s32, s43
s_addc_u32 s21, s33, 0
s_add_u32 s20, s20, 4194304
s_addc_u32 s21, s21, 0
s_mov_b32 s22, 16384
s_mov_b32 s23, 0x20000
s_lshl_b32 s43, s34, 14
s_lshl_b32 s44, s35, 10
s_add_u32 s43, s43, s44
s_add_u32 s24, s32, s43
s_addc_u32 s25, s33, 0
s_add_u32 s24, s24, 25165824
s_addc_u32 s25, s25, 0
s_mov_b32 s26, 1024
s_mov_b32 s27, 0x20000
s_movk_i32 s50, 0x2000
v_lshrrev_b32 v19, 1, v18
v_lshl_add_u32 v19, v19, 4, v17
s_lshl_b32 s43, s36, 5
v_add_u32 v19, s43, v19
v_and_b32 v20, 1, v18
v_lshlrev_b32 v20, 2, v20
v_lshl_add_u32 v22, v19, 3, v20
s_waitcnt vmcnt(0)
v_lshlrev_b32 v128, 16, v160
v_and_b32 v129, 0xffff0000, v160
v_lshlrev_b32 v130, 16, v161
v_and_b32 v131, 0xffff0000, v161
v_lshlrev_b32 v132, 16, v162
v_and_b32 v133, 0xffff0000, v162
v_lshlrev_b32 v134, 16, v163
v_and_b32 v135, 0xffff0000, v163
v_lshlrev_b32 v136, 16, v164
v_and_b32 v137, 0xffff0000, v164
v_lshlrev_b32 v138, 16, v165
v_and_b32 v139, 0xffff0000, v165
v_lshlrev_b32 v140, 16, v166
v_and_b32 v141, 0xffff0000, v166
v_lshlrev_b32 v142, 16, v167
v_and_b32 v143, 0xffff0000, v167
v_lshlrev_b32 v144, 16, v168
v_and_b32 v145, 0xffff0000, v168
v_lshlrev_b32 v146, 16, v169
v_and_b32 v147, 0xffff0000, v169
v_lshlrev_b32 v148, 16, v170
v_and_b32 v149, 0xffff0000, v170
v_lshlrev_b32 v150, 16, v171
v_and_b32 v151, 0xffff0000, v171
v_lshlrev_b32 v152, 16, v172
v_and_b32 v153, 0xffff0000, v172
v_lshlrev_b32 v154, 16, v173
v_and_b32 v155, 0xffff0000, v173
v_lshlrev_b32 v156, 16, v174
v_and_b32 v157, 0xffff0000, v174
v_lshlrev_b32 v158, 16, v175
v_and_b32 v159, 0xffff0000, v175
s_lshl_b32 s43, s34, 18
s_add_u32 s12, s32, s43
s_addc_u32 s13, s33, 0
s_mov_b32 s14, 262144
s_mov_b32 s15, 0x20000
v_lshlrev_b32 v21, 4, v1
s_lshl_b32 s54, s36, 11
s_barrier
s_add_u32 m0, s54, 0
s_add_u32 s43, s54, 0
buffer_load_dwordx4 v21, s[12:15], s43 offen sc1 lds
s_add_u32 m0, s54, 1024
s_add_u32 s43, s54, 1024
buffer_load_dwordx4 v21, s[12:15], s43 offen sc1 lds
s_add_u32 m0, s54, 24576
s_add_u32 s43, s54, 16384
buffer_load_dwordx4 v21, s[12:15], s43 offen sc1 lds
s_add_u32 m0, s54, 25600
s_add_u32 s43, s54, 17408
buffer_load_dwordx4 v21, s[12:15], s43 offen sc1 lds
s_waitcnt vmcnt(2)
s_barrier
ds_read_b128 v[32:35], v2 offset:0
ds_read_b64_tr_b16 v[48:49], v5 offset:0
ds_read_b64_tr_b16 v[50:51], v5 offset:2048
ds_read_b64_tr_b16 v[52:53], v6 offset:0
ds_read_b64_tr_b16 v[54:55], v6 offset:2048
ds_read_b128 v[36:39], v2 offset:256
ds_read_b64_tr_b16 v[56:57], v7 offset:0
ds_read_b64_tr_b16 v[58:59], v7 offset:2048
ds_read_b64_tr_b16 v[60:61], v8 offset:0
ds_read_b64_tr_b16 v[62:63], v8 offset:2048
ds_read_b128 v[40:43], v2 offset:8192
ds_read_b64_tr_b16 v[64:65], v5 offset:4096
ds_read_b64_tr_b16 v[66:67], v5 offset:6144
ds_read_b64_tr_b16 v[68:69], v6 offset:4096
ds_read_b64_tr_b16 v[70:71], v6 offset:6144
ds_read_b128 v[44:47], v2 offset:8448
ds_read_b64_tr_b16 v[72:73], v7 offset:4096
ds_read_b64_tr_b16 v[74:75], v7 offset:6144
ds_read_b64_tr_b16 v[76:77], v8 offset:4096
ds_read_b64_tr_b16 v[78:79], v8 offset:6144
s_waitcnt vmcnt(0) lgkmcnt(0)
s_barrier
v_mfma_f32_16x16x32_bf16 v[128:131], v[48:51], v[32:35], v[128:131]
ds_read_b128 v[80:83], v2 offset:24576
ds_read_b64_tr_b16 v[96:97], v5 offset:24576
v_mfma_f32_16x16x32_bf16 v[132:135], v[52:55], v[32:35], v[132:135]
ds_read_b64_tr_b16 v[98:99], v5 offset:26624
ds_read_b64_tr_b16 v[100:101], v6 offset:24576
v_mfma_f32_16x16x32_bf16 v[136:139], v[56:59], v[32:35], v[136:139]
ds_read_b64_tr_b16 v[102:103], v6 offset:26624
ds_read_b128 v[84:87], v2 offset:24832
v_mfma_f32_16x16x32_bf16 v[140:143], v[60:63], v[32:35], v[140:143]
ds_read_b64_tr_b16 v[104:105], v7 offset:24576
ds_read_b64_tr_b16 v[106:107], v7 offset:26624
v_mfma_f32_16x16x32_bf16 v[144:147], v[48:51], v[36:39], v[144:147]
ds_read_b64_tr_b16 v[108:109], v8 offset:24576
ds_read_b64_tr_b16 v[110:111], v8 offset:26624
v_mfma_f32_16x16x32_bf16 v[148:151], v[52:55], v[36:39], v[148:151]
ds_read_b128 v[88:91], v2 offset:32768
ds_read_b64_tr_b16 v[112:113], v5 offset:28672
v_mfma_f32_16x16x32_bf16 v[152:155], v[56:59], v[36:39], v[152:155]
ds_read_b64_tr_b16 v[114:115], v5 offset:30720
v_mfma_f32_16x16x32_bf16 v[156:159], v[60:63], v[36:39], v[156:159]
ds_read_b64_tr_b16 v[116:117], v6 offset:28672
v_mfma_f32_16x16x32_bf16 v[128:131], v[64:67], v[40:43], v[128:131]
ds_read_b64_tr_b16 v[118:119], v6 offset:30720
v_mfma_f32_16x16x32_bf16 v[132:135], v[68:71], v[40:43], v[132:135]
ds_read_b128 v[92:95], v2 offset:33024
v_mfma_f32_16x16x32_bf16 v[136:139], v[72:75], v[40:43], v[136:139]
ds_read_b64_tr_b16 v[120:121], v7 offset:28672
v_mfma_f32_16x16x32_bf16 v[140:143], v[76:79], v[40:43], v[140:143]
ds_read_b64_tr_b16 v[122:123], v7 offset:30720
v_mfma_f32_16x16x32_bf16 v[144:147], v[64:67], v[44:47], v[144:147]
ds_read_b64_tr_b16 v[124:125], v8 offset:28672
v_mfma_f32_16x16x32_bf16 v[148:151], v[68:71], v[44:47], v[148:151]
ds_read_b64_tr_b16 v[126:127], v8 offset:30720
v_mfma_f32_16x16x32_bf16 v[152:155], v[72:75], v[44:47], v[152:155]
v_mfma_f32_16x16x32_bf16 v[156:159], v[76:79], v[44:47], v[156:159]
s_waitcnt lgkmcnt(0)
s_barrier
v_mfma_f32_16x16x32_bf16 v[128:131], v[96:99], v[80:83], v[128:131]
ds_read_b128 v[32:35], v3 offset:0
ds_read_b64_tr_b16 v[48:49], v9 offset:0
v_mfma_f32_16x16x32_bf16 v[132:135], v[100:103], v[80:83], v[132:135]
ds_read_b64_tr_b16 v[50:51], v9 offset:2048
ds_read_b64_tr_b16 v[52:53], v10 offset:0
v_mfma_f32_16x16x32_bf16 v[136:139], v[104:107], v[80:83], v[136:139]
ds_read_b64_tr_b16 v[54:55], v10 offset:2048
ds_read_b128 v[36:39], v3 offset:256
v_mfma_f32_16x16x32_bf16 v[140:143], v[108:111], v[80:83], v[140:143]
ds_read_b64_tr_b16 v[56:57], v11 offset:0
ds_read_b64_tr_b16 v[58:59], v11 offset:2048
v_mfma_f32_16x16x32_bf16 v[144:147], v[96:99], v[84:87], v[144:147]
ds_read_b64_tr_b16 v[60:61], v12 offset:0
ds_read_b64_tr_b16 v[62:63], v12 offset:2048
v_mfma_f32_16x16x32_bf16 v[148:151], v[100:103], v[84:87], v[148:151]
ds_read_b128 v[40:43], v3 offset:8192
ds_read_b64_tr_b16 v[64:65], v9 offset:4096
v_mfma_f32_16x16x32_bf16 v[152:155], v[104:107], v[84:87], v[152:155]
ds_read_b64_tr_b16 v[66:67], v9 offset:6144
v_mfma_f32_16x16x32_bf16 v[156:159], v[108:111], v[84:87], v[156:159]
ds_read_b64_tr_b16 v[68:69], v10 offset:4096
v_mfma_f32_16x16x32_bf16 v[128:131], v[112:115], v[88:91], v[128:131]
ds_read_b64_tr_b16 v[70:71], v10 offset:6144
v_mfma_f32_16x16x32_bf16 v[132:135], v[116:119], v[88:91], v[132:135]
ds_read_b128 v[44:47], v3 offset:8448
v_mfma_f32_16x16x32_bf16 v[136:139], v[120:123], v[88:91], v[136:139]
ds_read_b64_tr_b16 v[72:73], v11 offset:4096
v_mfma_f32_16x16x32_bf16 v[140:143], v[124:127], v[88:91], v[140:143]
ds_read_b64_tr_b16 v[74:75], v11 offset:6144
v_mfma_f32_16x16x32_bf16 v[144:147], v[112:115], v[92:95], v[144:147]
ds_read_b64_tr_b16 v[76:77], v12 offset:4096
v_mfma_f32_16x16x32_bf16 v[148:151], v[116:119], v[92:95], v[148:151]
ds_read_b64_tr_b16 v[78:79], v12 offset:6144
v_mfma_f32_16x16x32_bf16 v[152:155], v[120:123], v[92:95], v[152:155]
v_mfma_f32_16x16x32_bf16 v[156:159], v[124:127], v[92:95], v[156:159]
s_mov_b32 s41, 2
Lg2_25:
s_waitcnt lgkmcnt(0)
s_barrier
v_mfma_f32_16x16x32_bf16 v[128:131], v[48:51], v[32:35], v[128:131]
ds_read_b128 v[80:83], v3 offset:24576
ds_read_b64_tr_b16 v[96:97], v9 offset:24576
v_mfma_f32_16x16x32_bf16 v[132:135], v[52:55], v[32:35], v[132:135]
ds_read_b64_tr_b16 v[98:99], v9 offset:26624
ds_read_b64_tr_b16 v[100:101], v10 offset:24576
v_mfma_f32_16x16x32_bf16 v[136:139], v[56:59], v[32:35], v[136:139]
ds_read_b64_tr_b16 v[102:103], v10 offset:26624
ds_read_b128 v[84:87], v3 offset:24832
v_mfma_f32_16x16x32_bf16 v[140:143], v[60:63], v[32:35], v[140:143]
ds_read_b64_tr_b16 v[104:105], v11 offset:24576
ds_read_b64_tr_b16 v[106:107], v11 offset:26624
v_mfma_f32_16x16x32_bf16 v[144:147], v[48:51], v[36:39], v[144:147]
ds_read_b64_tr_b16 v[108:109], v12 offset:24576
ds_read_b64_tr_b16 v[110:111], v12 offset:26624
v_mfma_f32_16x16x32_bf16 v[148:151], v[52:55], v[36:39], v[148:151]
ds_read_b128 v[88:91], v3 offset:32768
ds_read_b64_tr_b16 v[112:113], v9 offset:28672
v_mfma_f32_16x16x32_bf16 v[152:155], v[56:59], v[36:39], v[152:155]
ds_read_b64_tr_b16 v[114:115], v9 offset:30720
v_mfma_f32_16x16x32_bf16 v[156:159], v[60:63], v[36:39], v[156:159]
ds_read_b64_tr_b16 v[116:117], v10 offset:28672
v_mfma_f32_16x16x32_bf16 v[128:131], v[64:67], v[40:43], v[128:131]
ds_read_b64_tr_b16 v[118:119], v10 offset:30720
v_mfma_f32_16x16x32_bf16 v[132:135], v[68:71], v[40:43], v[132:135]
ds_read_b128 v[92:95], v3 offset:33024
v_mfma_f32_16x16x32_bf16 v[136:139], v[72:75], v[40:43], v[136:139]
ds_read_b64_tr_b16 v[120:121], v11 offset:28672
v_mfma_f32_16x16x32_bf16 v[140:143], v[76:79], v[40:43], v[140:143]
ds_read_b64_tr_b16 v[122:123], v11 offset:30720
v_mfma_f32_16x16x32_bf16 v[144:147], v[64:67], v[44:47], v[144:147]
ds_read_b64_tr_b16 v[124:125], v12 offset:28672
v_mfma_f32_16x16x32_bf16 v[148:151], v[68:71], v[44:47], v[148:151]
ds_read_b64_tr_b16 v[126:127], v12 offset:30720
v_mfma_f32_16x16x32_bf16 v[152:155], v[72:75], v[44:47], v[152:155]
v_mfma_f32_16x16x32_bf16 v[156:159], v[76:79], v[44:47], v[156:159]
s_waitcnt lgkmcnt(0)
s_barrier
v_mfma_f32_16x16x32_bf16 v[128:131], v[96:99], v[80:83], v[128:131]
ds_read_b128 v[32:35], v4 offset:0
ds_read_b64_tr_b16 v[48:49], v13 offset:0
v_mfma_f32_16x16x32_bf16 v[132:135], v[100:103], v[80:83], v[132:135]
ds_read_b64_tr_b16 v[50:51], v13 offset:2048
ds_read_b64_tr_b16 v[52:53], v14 offset:0
v_mfma_f32_16x16x32_bf16 v[136:139], v[104:107], v[80:83], v[136:139]
ds_read_b64_tr_b16 v[54:55], v14 offset:2048
ds_read_b128 v[36:39], v4 offset:256
v_mfma_f32_16x16x32_bf16 v[140:143], v[108:111], v[80:83], v[140:143]
ds_read_b64_tr_b16 v[56:57], v15 offset:0
ds_read_b64_tr_b16 v[58:59], v15 offset:2048
v_mfma_f32_16x16x32_bf16 v[144:147], v[96:99], v[84:87], v[144:147]
ds_read_b64_tr_b16 v[60:61], v16 offset:0
ds_read_b64_tr_b16 v[62:63], v16 offset:2048
v_mfma_f32_16x16x32_bf16 v[148:151], v[100:103], v[84:87], v[148:151]
ds_read_b128 v[40:43], v4 offset:8192
ds_read_b64_tr_b16 v[64:65], v13 offset:4096
v_mfma_f32_16x16x32_bf16 v[152:155], v[104:107], v[84:87], v[152:155]
ds_read_b64_tr_b16 v[66:67], v13 offset:6144
v_mfma_f32_16x16x32_bf16 v[156:159], v[108:111], v[84:87], v[156:159]
ds_read_b64_tr_b16 v[68:69], v14 offset:4096
v_mfma_f32_16x16x32_bf16 v[128:131], v[112:115], v[88:91], v[128:131]
ds_read_b64_tr_b16 v[70:71], v14 offset:6144
v_mfma_f32_16x16x32_bf16 v[132:135], v[116:119], v[88:91], v[132:135]
ds_read_b128 v[44:47], v4 offset:8448
v_mfma_f32_16x16x32_bf16 v[136:139], v[120:123], v[88:91], v[136:139]
ds_read_b64_tr_b16 v[72:73], v15 offset:4096
v_mfma_f32_16x16x32_bf16 v[140:143], v[124:127], v[88:91], v[140:143]
ds_read_b64_tr_b16 v[74:75], v15 offset:6144
v_mfma_f32_16x16x32_bf16 v[144:147], v[112:115], v[92:95], v[144:147]
ds_read_b64_tr_b16 v[76:77], v16 offset:4096
v_mfma_f32_16x16x32_bf16 v[148:151], v[116:119], v[92:95], v[148:151]
ds_read_b64_tr_b16 v[78:79], v16 offset:6144
v_mfma_f32_16x16x32_bf16 v[152:155], v[120:123], v[92:95], v[152:155]
v_mfma_f32_16x16x32_bf16 v[156:159], v[124:127], v[92:95], v[156:159]
s_waitcnt lgkmcnt(0)
s_barrier
v_mfma_f32_16x16x32_bf16 v[128:131], v[48:51], v[32:35], v[128:131]
ds_read_b128 v[80:83], v4 offset:24576
ds_read_b64_tr_b16 v[96:97], v13 offset:24576
v_mfma_f32_16x16x32_bf16 v[132:135], v[52:55], v[32:35], v[132:135]
ds_read_b64_tr_b16 v[98:99], v13 offset:26624
ds_read_b64_tr_b16 v[100:101], v14 offset:24576
v_mfma_f32_16x16x32_bf16 v[136:139], v[56:59], v[32:35], v[136:139]
ds_read_b64_tr_b16 v[102:103], v14 offset:26624
ds_read_b128 v[84:87], v4 offset:24832
v_mfma_f32_16x16x32_bf16 v[140:143], v[60:63], v[32:35], v[140:143]
ds_read_b64_tr_b16 v[104:105], v15 offset:24576
ds_read_b64_tr_b16 v[106:107], v15 offset:26624
v_mfma_f32_16x16x32_bf16 v[144:147], v[48:51], v[36:39], v[144:147]
ds_read_b64_tr_b16 v[108:109], v16 offset:24576
ds_read_b64_tr_b16 v[110:111], v16 offset:26624
v_mfma_f32_16x16x32_bf16 v[148:151], v[52:55], v[36:39], v[148:151]
ds_read_b128 v[88:91], v4 offset:32768
ds_read_b64_tr_b16 v[112:113], v13 offset:28672
v_mfma_f32_16x16x32_bf16 v[152:155], v[56:59], v[36:39], v[152:155]
ds_read_b64_tr_b16 v[114:115], v13 offset:30720
v_mfma_f32_16x16x32_bf16 v[156:159], v[60:63], v[36:39], v[156:159]
ds_read_b64_tr_b16 v[116:117], v14 offset:28672
v_mfma_f32_16x16x32_bf16 v[128:131], v[64:67], v[40:43], v[128:131]
ds_read_b64_tr_b16 v[118:119], v14 offset:30720
v_mfma_f32_16x16x32_bf16 v[132:135], v[68:71], v[40:43], v[132:135]
ds_read_b128 v[92:95], v4 offset:33024
v_mfma_f32_16x16x32_bf16 v[136:139], v[72:75], v[40:43], v[136:139]
ds_read_b64_tr_b16 v[120:121], v15 offset:28672
v_mfma_f32_16x16x32_bf16 v[140:143], v[76:79], v[40:43], v[140:143]
ds_read_b64_tr_b16 v[122:123], v15 offset:30720
v_mfma_f32_16x16x32_bf16 v[144:147], v[64:67], v[44:47], v[144:147]
ds_read_b64_tr_b16 v[124:125], v16 offset:28672
v_mfma_f32_16x16x32_bf16 v[148:151], v[68:71], v[44:47], v[148:151]
ds_read_b64_tr_b16 v[126:127], v16 offset:30720
v_mfma_f32_16x16x32_bf16 v[152:155], v[72:75], v[44:47], v[152:155]
v_mfma_f32_16x16x32_bf16 v[156:159], v[76:79], v[44:47], v[156:159]
s_waitcnt lgkmcnt(0)
s_barrier
v_mfma_f32_16x16x32_bf16 v[128:131], v[96:99], v[80:83], v[128:131]
ds_read_b128 v[32:35], v2 offset:0
ds_read_b64_tr_b16 v[48:49], v5 offset:0
v_mfma_f32_16x16x32_bf16 v[132:135], v[100:103], v[80:83], v[132:135]
ds_read_b64_tr_b16 v[50:51], v5 offset:2048
ds_read_b64_tr_b16 v[52:53], v6 offset:0
v_mfma_f32_16x16x32_bf16 v[136:139], v[104:107], v[80:83], v[136:139]
ds_read_b64_tr_b16 v[54:55], v6 offset:2048
ds_read_b128 v[36:39], v2 offset:256
v_mfma_f32_16x16x32_bf16 v[140:143], v[108:111], v[80:83], v[140:143]
ds_read_b64_tr_b16 v[56:57], v7 offset:0
ds_read_b64_tr_b16 v[58:59], v7 offset:2048
v_mfma_f32_16x16x32_bf16 v[144:147], v[96:99], v[84:87], v[144:147]
ds_read_b64_tr_b16 v[60:61], v8 offset:0
ds_read_b64_tr_b16 v[62:63], v8 offset:2048
v_mfma_f32_16x16x32_bf16 v[148:151], v[100:103], v[84:87], v[148:151]
ds_read_b128 v[40:43], v2 offset:8192
ds_read_b64_tr_b16 v[64:65], v5 offset:4096
v_mfma_f32_16x16x32_bf16 v[152:155], v[104:107], v[84:87], v[152:155]
ds_read_b64_tr_b16 v[66:67], v5 offset:6144
v_mfma_f32_16x16x32_bf16 v[156:159], v[108:111], v[84:87], v[156:159]
ds_read_b64_tr_b16 v[68:69], v6 offset:4096
v_mfma_f32_16x16x32_bf16 v[128:131], v[112:115], v[88:91], v[128:131]
ds_read_b64_tr_b16 v[70:71], v6 offset:6144
v_mfma_f32_16x16x32_bf16 v[132:135], v[116:119], v[88:91], v[132:135]
ds_read_b128 v[44:47], v2 offset:8448
v_mfma_f32_16x16x32_bf16 v[136:139], v[120:123], v[88:91], v[136:139]
ds_read_b64_tr_b16 v[72:73], v7 offset:4096
v_mfma_f32_16x16x32_bf16 v[140:143], v[124:127], v[88:91], v[140:143]
ds_read_b64_tr_b16 v[74:75], v7 offset:6144
v_mfma_f32_16x16x32_bf16 v[144:147], v[112:115], v[92:95], v[144:147]
ds_read_b64_tr_b16 v[76:77], v8 offset:4096
v_mfma_f32_16x16x32_bf16 v[148:151], v[116:119], v[92:95], v[148:151]
ds_read_b64_tr_b16 v[78:79], v8 offset:6144
v_mfma_f32_16x16x32_bf16 v[152:155], v[120:123], v[92:95], v[152:155]
v_mfma_f32_16x16x32_bf16 v[156:159], v[124:127], v[92:95], v[156:159]
s_waitcnt lgkmcnt(0)
s_barrier
v_mfma_f32_16x16x32_bf16 v[128:131], v[48:51], v[32:35], v[128:131]
ds_read_b128 v[80:83], v2 offset:24576
ds_read_b64_tr_b16 v[96:97], v5 offset:24576
v_mfma_f32_16x16x32_bf16 v[132:135], v[52:55], v[32:35], v[132:135]
ds_read_b64_tr_b16 v[98:99], v5 offset:26624
ds_read_b64_tr_b16 v[100:101], v6 offset:24576
v_mfma_f32_16x16x32_bf16 v[136:139], v[56:59], v[32:35], v[136:139]
ds_read_b64_tr_b16 v[102:103], v6 offset:26624
ds_read_b128 v[84:87], v2 offset:24832
v_mfma_f32_16x16x32_bf16 v[140:143], v[60:63], v[32:35], v[140:143]
ds_read_b64_tr_b16 v[104:105], v7 offset:24576
ds_read_b64_tr_b16 v[106:107], v7 offset:26624
v_mfma_f32_16x16x32_bf16 v[144:147], v[48:51], v[36:39], v[144:147]
ds_read_b64_tr_b16 v[108:109], v8 offset:24576
ds_read_b64_tr_b16 v[110:111], v8 offset:26624
v_mfma_f32_16x16x32_bf16 v[148:151], v[52:55], v[36:39], v[148:151]
ds_read_b128 v[88:91], v2 offset:32768
ds_read_b64_tr_b16 v[112:113], v5 offset:28672
v_mfma_f32_16x16x32_bf16 v[152:155], v[56:59], v[36:39], v[152:155]
ds_read_b64_tr_b16 v[114:115], v5 offset:30720
v_mfma_f32_16x16x32_bf16 v[156:159], v[60:63], v[36:39], v[156:159]
ds_read_b64_tr_b16 v[116:117], v6 offset:28672
v_mfma_f32_16x16x32_bf16 v[128:131], v[64:67], v[40:43], v[128:131]
ds_read_b64_tr_b16 v[118:119], v6 offset:30720
v_mfma_f32_16x16x32_bf16 v[132:135], v[68:71], v[40:43], v[132:135]
ds_read_b128 v[92:95], v2 offset:33024
v_mfma_f32_16x16x32_bf16 v[136:139], v[72:75], v[40:43], v[136:139]
ds_read_b64_tr_b16 v[120:121], v7 offset:28672
v_mfma_f32_16x16x32_bf16 v[140:143], v[76:79], v[40:43], v[140:143]
ds_read_b64_tr_b16 v[122:123], v7 offset:30720
v_mfma_f32_16x16x32_bf16 v[144:147], v[64:67], v[44:47], v[144:147]
ds_read_b64_tr_b16 v[124:125], v8 offset:28672
v_mfma_f32_16x16x32_bf16 v[148:151], v[68:71], v[44:47], v[148:151]
ds_read_b64_tr_b16 v[126:127], v8 offset:30720
v_mfma_f32_16x16x32_bf16 v[152:155], v[72:75], v[44:47], v[152:155]
v_mfma_f32_16x16x32_bf16 v[156:159], v[76:79], v[44:47], v[156:159]
s_waitcnt lgkmcnt(0)
s_barrier
v_mfma_f32_16x16x32_bf16 v[128:131], v[96:99], v[80:83], v[128:131]
ds_read_b128 v[32:35], v3 offset:0
ds_read_b64_tr_b16 v[48:49], v9 offset:0
v_mfma_f32_16x16x32_bf16 v[132:135], v[100:103], v[80:83], v[132:135]
ds_read_b64_tr_b16 v[50:51], v9 offset:2048
ds_read_b64_tr_b16 v[52:53], v10 offset:0
v_mfma_f32_16x16x32_bf16 v[136:139], v[104:107], v[80:83], v[136:139]
ds_read_b64_tr_b16 v[54:55], v10 offset:2048
ds_read_b128 v[36:39], v3 offset:256
v_mfma_f32_16x16x32_bf16 v[140:143], v[108:111], v[80:83], v[140:143]
ds_read_b64_tr_b16 v[56:57], v11 offset:0
ds_read_b64_tr_b16 v[58:59], v11 offset:2048
v_mfma_f32_16x16x32_bf16 v[144:147], v[96:99], v[84:87], v[144:147]
ds_read_b64_tr_b16 v[60:61], v12 offset:0
ds_read_b64_tr_b16 v[62:63], v12 offset:2048
v_mfma_f32_16x16x32_bf16 v[148:151], v[100:103], v[84:87], v[148:151]
ds_read_b128 v[40:43], v3 offset:8192
ds_read_b64_tr_b16 v[64:65], v9 offset:4096
v_mfma_f32_16x16x32_bf16 v[152:155], v[104:107], v[84:87], v[152:155]
ds_read_b64_tr_b16 v[66:67], v9 offset:6144
v_mfma_f32_16x16x32_bf16 v[156:159], v[108:111], v[84:87], v[156:159]
ds_read_b64_tr_b16 v[68:69], v10 offset:4096
v_mfma_f32_16x16x32_bf16 v[128:131], v[112:115], v[88:91], v[128:131]
ds_read_b64_tr_b16 v[70:71], v10 offset:6144
v_mfma_f32_16x16x32_bf16 v[132:135], v[116:119], v[88:91], v[132:135]
ds_read_b128 v[44:47], v3 offset:8448
v_mfma_f32_16x16x32_bf16 v[136:139], v[120:123], v[88:91], v[136:139]
ds_read_b64_tr_b16 v[72:73], v11 offset:4096
v_mfma_f32_16x16x32_bf16 v[140:143], v[124:127], v[88:91], v[140:143]
ds_read_b64_tr_b16 v[74:75], v11 offset:6144
v_mfma_f32_16x16x32_bf16 v[144:147], v[112:115], v[92:95], v[144:147]
ds_read_b64_tr_b16 v[76:77], v12 offset:4096
v_mfma_f32_16x16x32_bf16 v[148:151], v[116:119], v[92:95], v[148:151]
ds_read_b64_tr_b16 v[78:79], v12 offset:6144
v_mfma_f32_16x16x32_bf16 v[152:155], v[120:123], v[92:95], v[152:155]
v_mfma_f32_16x16x32_bf16 v[156:159], v[124:127], v[92:95], v[156:159]
s_sub_u32 s41, s41, 1
s_cmp_lg_u32 s41, 0
s_cbranch_scc1 Lg2_25
s_waitcnt lgkmcnt(0)
s_barrier
v_mfma_f32_16x16x32_bf16 v[128:131], v[48:51], v[32:35], v[128:131]
ds_read_b128 v[80:83], v3 offset:24576
ds_read_b64_tr_b16 v[96:97], v9 offset:24576
v_mfma_f32_16x16x32_bf16 v[132:135], v[52:55], v[32:35], v[132:135]
ds_read_b64_tr_b16 v[98:99], v9 offset:26624
ds_read_b64_tr_b16 v[100:101], v10 offset:24576
v_mfma_f32_16x16x32_bf16 v[136:139], v[56:59], v[32:35], v[136:139]
ds_read_b64_tr_b16 v[102:103], v10 offset:26624
ds_read_b128 v[84:87], v3 offset:24832
v_mfma_f32_16x16x32_bf16 v[140:143], v[60:63], v[32:35], v[140:143]
ds_read_b64_tr_b16 v[104:105], v11 offset:24576
ds_read_b64_tr_b16 v[106:107], v11 offset:26624
v_mfma_f32_16x16x32_bf16 v[144:147], v[48:51], v[36:39], v[144:147]
ds_read_b64_tr_b16 v[108:109], v12 offset:24576
ds_read_b64_tr_b16 v[110:111], v12 offset:26624
v_mfma_f32_16x16x32_bf16 v[148:151], v[52:55], v[36:39], v[148:151]
ds_read_b128 v[88:91], v3 offset:32768
ds_read_b64_tr_b16 v[112:113], v9 offset:28672
v_mfma_f32_16x16x32_bf16 v[152:155], v[56:59], v[36:39], v[152:155]
ds_read_b64_tr_b16 v[114:115], v9 offset:30720
v_mfma_f32_16x16x32_bf16 v[156:159], v[60:63], v[36:39], v[156:159]
ds_read_b64_tr_b16 v[116:117], v10 offset:28672
v_mfma_f32_16x16x32_bf16 v[128:131], v[64:67], v[40:43], v[128:131]
ds_read_b64_tr_b16 v[118:119], v10 offset:30720
v_mfma_f32_16x16x32_bf16 v[132:135], v[68:71], v[40:43], v[132:135]
ds_read_b128 v[92:95], v3 offset:33024
v_mfma_f32_16x16x32_bf16 v[136:139], v[72:75], v[40:43], v[136:139]
ds_read_b64_tr_b16 v[120:121], v11 offset:28672
v_mfma_f32_16x16x32_bf16 v[140:143], v[76:79], v[40:43], v[140:143]
ds_read_b64_tr_b16 v[122:123], v11 offset:30720
v_mfma_f32_16x16x32_bf16 v[144:147], v[64:67], v[44:47], v[144:147]
ds_read_b64_tr_b16 v[124:125], v12 offset:28672
v_mfma_f32_16x16x32_bf16 v[148:151], v[68:71], v[44:47], v[148:151]
ds_read_b64_tr_b16 v[126:127], v12 offset:30720
v_mfma_f32_16x16x32_bf16 v[152:155], v[72:75], v[44:47], v[152:155]
v_mfma_f32_16x16x32_bf16 v[156:159], v[76:79], v[44:47], v[156:159]
s_waitcnt lgkmcnt(0)
s_barrier
v_mfma_f32_16x16x32_bf16 v[128:131], v[96:99], v[80:83], v[128:131]
v_mfma_f32_16x16x32_bf16 v[132:135], v[100:103], v[80:83], v[132:135]
v_mfma_f32_16x16x32_bf16 v[136:139], v[104:107], v[80:83], v[136:139]
v_mfma_f32_16x16x32_bf16 v[140:143], v[108:111], v[80:83], v[140:143]
v_mfma_f32_16x16x32_bf16 v[144:147], v[96:99], v[84:87], v[144:147]
v_mfma_f32_16x16x32_bf16 v[148:151], v[100:103], v[84:87], v[148:151]
v_mfma_f32_16x16x32_bf16 v[152:155], v[104:107], v[84:87], v[152:155]
v_mfma_f32_16x16x32_bf16 v[156:159], v[108:111], v[84:87], v[156:159]
v_mfma_f32_16x16x32_bf16 v[128:131], v[112:115], v[88:91], v[128:131]
v_mfma_f32_16x16x32_bf16 v[132:135], v[116:119], v[88:91], v[132:135]
v_mfma_f32_16x16x32_bf16 v[136:139], v[120:123], v[88:91], v[136:139]
v_mfma_f32_16x16x32_bf16 v[140:143], v[124:127], v[88:91], v[140:143]
v_mfma_f32_16x16x32_bf16 v[144:147], v[112:115], v[92:95], v[144:147]
v_mfma_f32_16x16x32_bf16 v[148:151], v[116:119], v[92:95], v[148:151]
v_mfma_f32_16x16x32_bf16 v[152:155], v[120:123], v[92:95], v[152:155]
v_mfma_f32_16x16x32_bf16 v[156:159], v[124:127], v[92:95], v[156:159]
s_nop 4
v_cvt_pk_bf16_f32 v96, v128, v129
v_cvt_pk_bf16_f32 v97, v130, v131
v_cvt_pk_bf16_f32 v98, v132, v133
v_cvt_pk_bf16_f32 v99, v134, v135
buffer_store_dwordx4 v[96:99], v2, s[20:23], 0 offen offset:0 sc1
ds_write_b128 v4, v[96:99] offset:0
v_cvt_pk_bf16_f32 v100, v136, v137
v_cvt_pk_bf16_f32 v101, v138, v139
v_cvt_pk_bf16_f32 v102, v140, v141
v_cvt_pk_bf16_f32 v103, v142, v143
buffer_store_dwordx4 v[100:103], v2, s[20:23], s50 offen offset:0 sc1
ds_write_b128 v4, v[100:103] offset:8192
v_cvt_pk_bf16_f32 v104, v144, v145
v_cvt_pk_bf16_f32 v105, v146, v147
v_cvt_pk_bf16_f32 v106, v148, v149
v_cvt_pk_bf16_f32 v107, v150, v151
buffer_store_dwordx4 v[104:107], v2, s[20:23], 0 offen offset:256 sc1
ds_write_b128 v4, v[104:107] offset:256
v_cvt_pk_bf16_f32 v108, v152, v153
v_cvt_pk_bf16_f32 v109, v154, v155
v_cvt_pk_bf16_f32 v110, v156, v157
v_cvt_pk_bf16_f32 v111, v158, v159
buffer_store_dwordx4 v[108:111], v2, s[20:23], s50 offen offset:256 sc1
ds_write_b128 v4, v[108:111] offset:8448
v_pk_mul_f32 v[118:119], v[128:129], v[128:129]
v_pk_mul_f32 v[122:123], v[144:145], v[144:145]
v_pk_fma_f32 v[118:119], v[130:131], v[130:131], v[118:119]
v_pk_add_f32 v[116:117], v[130:131], v[128:129]
v_pk_fma_f32 v[122:123], v[146:147], v[146:147], v[122:123]
v_pk_add_f32 v[120:121], v[146:147], v[144:145]
v_pk_fma_f32 v[118:119], v[132:133], v[132:133], v[118:119]
v_pk_add_f32 v[116:117], v[132:133], v[116:117]
v_pk_fma_f32 v[122:123], v[148:149], v[148:149], v[122:123]
v_pk_add_f32 v[120:121], v[148:149], v[120:121]
v_pk_fma_f32 v[118:119], v[134:135], v[134:135], v[118:119]
v_pk_add_f32 v[116:117], v[134:135], v[116:117]
v_pk_fma_f32 v[122:123], v[150:151], v[150:151], v[122:123]
v_pk_add_f32 v[120:121], v[150:151], v[120:121]
v_pk_fma_f32 v[118:119], v[136:137], v[136:137], v[118:119]
v_pk_add_f32 v[116:117], v[136:137], v[116:117]
v_pk_fma_f32 v[122:123], v[152:153], v[152:153], v[122:123]
v_pk_add_f32 v[120:121], v[152:153], v[120:121]
v_pk_fma_f32 v[118:119], v[138:139], v[138:139], v[118:119]
v_pk_add_f32 v[116:117], v[138:139], v[116:117]
v_pk_fma_f32 v[122:123], v[154:155], v[154:155], v[122:123]
v_pk_add_f32 v[120:121], v[154:155], v[120:121]
v_pk_fma_f32 v[118:119], v[140:141], v[140:141], v[118:119]
v_pk_add_f32 v[116:117], v[140:141], v[116:117]
v_pk_fma_f32 v[122:123], v[156:157], v[156:157], v[122:123]
v_pk_add_f32 v[120:121], v[156:157], v[120:121]
v_pk_fma_f32 v[118:119], v[142:143], v[142:143], v[118:119]
v_pk_add_f32 v[116:117], v[142:143], v[116:117]
v_pk_fma_f32 v[122:123], v[158:159], v[158:159], v[122:123]
v_pk_add_f32 v[120:121], v[158:159], v[120:121]
v_add_f32 v112, v116, v117
v_add_f32 v113, v118, v119
v_add_f32 v114, v120, v121
v_add_f32 v115, v122, v123
s_nop 1
v_permlane32_swap_b32 v112, v114
v_permlane32_swap_b32 v113, v115
v_add_f32 v112, v112, v114
v_add_f32 v113, v113, v115
s_nop 1
v_permlane16_swap_b32 v112, v113
v_add_f32 v112, v112, v113
buffer_store_dword v112, v22, s[24:27], 0 offen sc1
s_waitcnt vmcnt(0) lgkmcnt(0)
s_barrier
s_cmp_lg_u32 s36, 0
s_cbranch_scc1 Lsig_26
s_add_u32 s43, s34, 16
s_lshl_b32 s43, s43, 7
v_mov_b32 v19, s43
v_mov_b32 v20, 1
s_mov_b64 exec, 1
buffer_atomic_add v20, v19, s[56:59], 0 offen sc1
s_mov_b64 exec, -1
Lsig_26:
s_lshl_b32 s53, s47, 2
v_lshlrev_b32 v19, 11, v18
v_lshl_add_u32 v19, v17, 4, v19
s_lshl_b32 s43, s46, 10
v_add_u32 v2, s43, v19
v_add_u32 v3, 49152, v2
v_add_u32 v4, 98304, v2
v_lshrrev_b32 v19, 2, v17
v_lshl_add_u32 v20, v18, 2, v19
v_and_b32 v21, 7, v20
v_lshlrev_b32 v20, 8, v20
v_and_b32 v19, 3, v1
v_lshl_add_u32 v20, v19, 3, v20
s_add_u32 s43, s53, 0
v_xor_b32 v19, s43, v21
v_lshl_add_u32 v5, v19, 5, v20
s_add_u32 s43, s53, 1
v_xor_b32 v19, s43, v21
v_lshl_add_u32 v6, v19, 5, v20
s_add_u32 s43, s53, 2
v_xor_b32 v19, s43, v21
v_lshl_add_u32 v7, v19, 5, v20
s_add_u32 s43, s53, 3
v_xor_b32 v19, s43, v21
v_lshl_add_u32 v8, v19, 5, v20
v_add_u32 v9, 49152, v5
v_add_u32 v10, 49152, v6
v_add_u32 v11, 49152, v7
v_add_u32 v12, 49152, v8
v_add_u32 v13, 98304, v5
v_add_u32 v14, 98304, v6
v_add_u32 v15, 98304, v7
v_add_u32 v16, 98304, v8
v_mov_b32 v128, 0
v_mov_b32 v129, 0
v_mov_b32 v130, 0
v_mov_b32 v131, 0
v_mov_b32 v132, 0
v_mov_b32 v133, 0
v_mov_b32 v134, 0
v_mov_b32 v135, 0
v_mov_b32 v136, 0
v_mov_b32 v137, 0
v_mov_b32 v138, 0
v_mov_b32 v139, 0
v_mov_b32 v140, 0
v_mov_b32 v141, 0
v_mov_b32 v142, 0
v_mov_b32 v143, 0
v_mov_b32 v144, 0
v_mov_b32 v145, 0
v_mov_b32 v146, 0
v_mov_b32 v147, 0
v_mov_b32 v148, 0
v_mov_b32 v149, 0
v_mov_b32 v150, 0
v_mov_b32 v151, 0
v_mov_b32 v152, 0
v_mov_b32 v153, 0
v_mov_b32 v154, 0
v_mov_b32 v155, 0
v_mov_b32 v156, 0
v_mov_b32 v157, 0
v_mov_b32 v158, 0
v_mov_b32 v159, 0
v_mov_b32 v160, 0
v_mov_b32 v161, 0
v_mov_b32 v162, 0
v_mov_b32 v163, 0
v_mov_b32 v164, 0
v_mov_b32 v165, 0
v_mov_b32 v166, 0
v_mov_b32 v167, 0
v_mov_b32 v168, 0
v_mov_b32 v169, 0
v_mov_b32 v170, 0
v_mov_b32 v171, 0
v_mov_b32 v172, 0
v_mov_b32 v173, 0
v_mov_b32 v174, 0
v_mov_b32 v175, 0
v_mov_b32 v176, 0
v_mov_b32 v177, 0
v_mov_b32 v178, 0
v_mov_b32 v179, 0
v_mov_b32 v180, 0
v_mov_b32 v181, 0
v_mov_b32 v182, 0
v_mov_b32 v183, 0
v_mov_b32 v184, 0
v_mov_b32 v185, 0
v_mov_b32 v186, 0
v_mov_b32 v187, 0
v_mov_b32 v188, 0
v_mov_b32 v189, 0
v_mov_b32 v190, 0
v_mov_b32 v191, 0
v_mov_b32 v192, 0
v_mov_b32 v193, 0
v_mov_b32 v194, 0
v_mov_b32 v195, 0
v_mov_b32 v196, 0
v_mov_b32 v197, 0
v_mov_b32 v198, 0
v_mov_b32 v199, 0
v_mov_b32 v200, 0
v_mov_b32 v201, 0
v_mov_b32 v202, 0
v_mov_b32 v203, 0
v_mov_b32 v204, 0
v_mov_b32 v205, 0
v_mov_b32 v206, 0
v_mov_b32 v207, 0
v_mov_b32 v208, 0
v_mov_b32 v209, 0
v_mov_b32 v210, 0
v_mov_b32 v211, 0
v_mov_b32 v212, 0
v_mov_b32 v213, 0
v_mov_b32 v214, 0
v_mov_b32 v215, 0
v_mov_b32 v216, 0
v_mov_b32 v217, 0
v_mov_b32 v218, 0
v_mov_b32 v219, 0
v_mov_b32 v220, 0
v_mov_b32 v221, 0
v_mov_b32 v222, 0
v_mov_b32 v223, 0
v_mov_b32 v224, 0
v_mov_b32 v225, 0
v_mov_b32 v226, 0
v_mov_b32 v227, 0
v_mov_b32 v228, 0
v_mov_b32 v229, 0
v_mov_b32 v230, 0
v_mov_b32 v231, 0
v_mov_b32 v232, 0
v_mov_b32 v233, 0
v_mov_b32 v234, 0
v_mov_b32 v235, 0
v_mov_b32 v236, 0
v_mov_b32 v237, 0
v_mov_b32 v238, 0
v_mov_b32 v239, 0
v_mov_b32 v240, 0
v_mov_b32 v241, 0
v_mov_b32 v242, 0
v_mov_b32 v243, 0
v_mov_b32 v244, 0
v_mov_b32 v245, 0
v_mov_b32 v246, 0
v_mov_b32 v247, 0
v_mov_b32 v248, 0
v_mov_b32 v249, 0
v_mov_b32 v250, 0
v_mov_b32 v251, 0
v_mov_b32 v252, 0
v_mov_b32 v253, 0
v_mov_b32 v254, 0
v_mov_b32 v255, 0
s_mul_i32 s43, s35, 192
s_and_b32 s43, s43, 0xffffff80
s_add_u32 s43, s43, 4096
s_cmp_eq_u32 s51, 1
s_cselect_b32 s8, s4, s6
s_cselect_b32 s9, s5, s7
s_sub_u32 s10, 7340032, s43
s_lshl_b32 s44, s34, 18
s_add_u32 s44, s44, 4194304
s_movk_i32 s38, 28672
s_cmp_eq_u32 s51, 0
s_cselect_b32 s8, s32, s8
s_cselect_b32 s9, s33, s9
s_cselect_b32 s10, 262144, s10
s_cselect_b32 s43, s44, s43
s_cselect_b32 s38, 1024, s38
s_cselect_b32 s45, 0, -1
s_add_u32 s8, s8, s43
s_addc_u32 s9, s9, 0
s_mov_b32 s11, 0x20000
s_lshl_b32 s40, s38, 4
s_add_u32 s42, s35, 17
s_lshl_b32 s39, s51, 14
v_lshrrev_b32 v19, 4, v1
v_lshlrev_b32 v20, 5, v19
v_mul_u32_u24 v19, 6912, v19
v_and_b32 v19, s45, v19
v_and_b32 v20, s45, v20
v_lshlrev_b32 v21, 4, v1
v_xor_b32 v21, v21, v20
v_add_u32 v22, v21, v19
s_and_b32 s45, s45, 128
v_xor_b32 v23, s45, v22
s_mul_i32 s43, s34, 917504
s_mul_i32 s44, s35, 16384
s_add_u32 s43, s43, s44
s_add_u32 s43, s43, 8388608
s_add_u32 s24, s32, s43
s_addc_u32 s25, s33, 0
s_mov_b32 s26, 278528
s_mov_b32 s27, 0x20000
s_mov_b32 s53, 262144
s_lshl_b32 s43, s47, 13
s_lshl_b32 s44, s46, 10
s_add_u32 s43, s43, s44
v_lshlrev_b32 v19, 11, v18
v_lshl_add_u32 v19, v17, 4, v19
v_add_u32 v27, s43, v19
s_lshl_b32 s43, s34, 18
s_lshl_b32 s44, s35, 7
s_add_u32 s43, s43, s44
s_add_u32 s16, s62, s43
s_addc_u32 s17, s63, 0
s_mov_b32 s18, 260224
s_mov_b32 s19, 0x20000
s_lshl_b32 s43, s46, 6
v_lshl_add_u32 v19, v17, 1, s43
v_lshlrev_b32 v19, 11, v19
v_and_b32 v20, 1, v18
v_lshl_add_u32 v19, v20, 5, v19
v_lshrrev_b32 v20, 1, v18
v_lshl_add_u32 v19, v20, 4, v19
s_lshl_b32 s43, s47, 6
v_add_u32 v28, s43, v19
s_lshl_b32 s43, s34, 4
s_add_u32 s43, s43, s35
s_xor_b32 s43, s43, 0
s_lshl_b32 s43, s43, 15
s_add_u32 s43, s43, 33554432
s_add_u32 s64, s32, s43
s_addc_u32 s65, s33, 0
s_mov_b32 s66, 32768
s_mov_b32 s67, 0x20000
s_lshl_b32 s43, s34, 4
s_add_u32 s43, s43, s35
s_xor_b32 s43, s43, 1
s_lshl_b32 s43, s43, 15
s_add_u32 s43, s43, 33554432
s_add_u32 s68, s32, s43
s_addc_u32 s69, s33, 0
s_mov_b32 s70, 32768
s_mov_b32 s71, 0x20000
s_lshl_b32 s43, s34, 18
s_add_u32 s12, s32, s43
s_addc_u32 s13, s33, 0
s_add_u32 s12, s12, 4194304
s_addc_u32 s13, s13, 0
s_mov_b32 s14, 262144
s_mov_b32 s15, 0x20000
v_lshlrev_b32 v21, 4, v1
s_lshl_b32 s54, s36, 11
s_add_u32 s43, s35, 1
s_and_b32 s43, s43, 15
s_lshl_b32 s43, s43, 14
s_add_u32 s30, s43, s54
s_add_u32 s43, s35, 2
s_and_b32 s43, s43, 15
s_lshl_b32 s43, s43, 14
s_add_u32 s31, s43, s54
ds_read_b128 v[32:35], v4 offset:0
ds_read_b64_tr_b16 v[48:49], v13 offset:16384
ds_read_b64_tr_b16 v[50:51], v13 offset:20480
ds_read_b128 v[36:39], v4 offset:256
ds_read_b128 v[40:43], v4 offset:512
ds_read_b128 v[44:47], v4 offset:768
ds_read_b64_tr_b16 v[64:65], v13 offset:32768
ds_read_b64_tr_b16 v[66:67], v13 offset:36864
ds_read_b64_tr_b16 v[52:53], v14 offset:16384
ds_read_b64_tr_b16 v[54:55], v14 offset:20480
ds_read_b64_tr_b16 v[68:69], v14 offset:32768
ds_read_b64_tr_b16 v[70:71], v14 offset:36864
ds_read_b64_tr_b16 v[56:57], v15 offset:16384
ds_read_b64_tr_b16 v[58:59], v15 offset:20480
ds_read_b64_tr_b16 v[72:73], v15 offset:32768
ds_read_b64_tr_b16 v[74:75], v15 offset:36864
ds_read_b64_tr_b16 v[60:61], v16 offset:16384
ds_read_b64_tr_b16 v[62:63], v16 offset:20480
ds_read_b64_tr_b16 v[76:77], v16 offset:32768
ds_read_b64_tr_b16 v[78:79], v16 offset:36864
s_waitcnt lgkmcnt(0)
v_mfma_f32_16x16x32_bf16 v[128:131], v[48:51], v[32:35], v[128:131]
ds_read_b128 v[80:83], v4 offset:8192
v_mfma_f32_16x16x32_bf16 v[132:135], v[48:51], v[36:39], v[132:135]
ds_read_b64_tr_b16 v[96:97], v13 offset:24576
v_mfma_f32_16x16x32_bf16 v[136:139], v[48:51], v[40:43], v[136:139]
ds_read_b64_tr_b16 v[98:99], v13 offset:28672
v_mfma_f32_16x16x32_bf16 v[140:143], v[48:51], v[44:47], v[140:143]
ds_read_b128 v[84:87], v4 offset:8448
v_mfma_f32_16x16x32_bf16 v[204:207], v[64:67], v[44:47], v[204:207]
ds_read_b128 v[88:91], v4 offset:8704
v_mfma_f32_16x16x32_bf16 v[200:203], v[64:67], v[40:43], v[200:203]
ds_read_b128 v[92:95], v4 offset:8960
v_mfma_f32_16x16x32_bf16 v[196:199], v[64:67], v[36:39], v[196:199]
ds_read_b64_tr_b16 v[112:113], v13 offset:40960
v_mfma_f32_16x16x32_bf16 v[192:195], v[64:67], v[32:35], v[192:195]
ds_read_b64_tr_b16 v[114:115], v13 offset:45056
v_mfma_f32_16x16x32_bf16 v[144:147], v[52:55], v[32:35], v[144:147]
ds_read_b64_tr_b16 v[100:101], v14 offset:24576
v_mfma_f32_16x16x32_bf16 v[148:151], v[52:55], v[36:39], v[148:151]
ds_read_b64_tr_b16 v[102:103], v14 offset:28672
v_mfma_f32_16x16x32_bf16 v[152:155], v[52:55], v[40:43], v[152:155]
ds_read_b64_tr_b16 v[116:117], v14 offset:40960
v_mfma_f32_16x16x32_bf16 v[156:159], v[52:55], v[44:47], v[156:159]
ds_read_b64_tr_b16 v[118:119], v14 offset:45056
v_mfma_f32_16x16x32_bf16 v[220:223], v[68:71], v[44:47], v[220:223]
ds_read_b64_tr_b16 v[104:105], v15 offset:24576
v_mfma_f32_16x16x32_bf16 v[216:219], v[68:71], v[40:43], v[216:219]
ds_read_b64_tr_b16 v[106:107], v15 offset:28672
v_mfma_f32_16x16x32_bf16 v[212:215], v[68:71], v[36:39], v[212:215]
ds_read_b64_tr_b16 v[120:121], v15 offset:40960
v_mfma_f32_16x16x32_bf16 v[208:211], v[68:71], v[32:35], v[208:211]
ds_read_b64_tr_b16 v[122:123], v15 offset:45056
v_mfma_f32_16x16x32_bf16 v[160:163], v[56:59], v[32:35], v[160:163]
ds_read_b64_tr_b16 v[108:109], v16 offset:24576
v_mfma_f32_16x16x32_bf16 v[164:167], v[56:59], v[36:39], v[164:167]
ds_read_b64_tr_b16 v[110:111], v16 offset:28672
v_mfma_f32_16x16x32_bf16 v[168:171], v[56:59], v[40:43], v[168:171]
ds_read_b64_tr_b16 v[124:125], v16 offset:40960
v_mfma_f32_16x16x32_bf16 v[172:175], v[56:59], v[44:47], v[172:175]
ds_read_b64_tr_b16 v[126:127], v16 offset:45056
v_mfma_f32_16x16x32_bf16 v[236:239], v[72:75], v[44:47], v[236:239]
v_mfma_f32_16x16x32_bf16 v[232:235], v[72:75], v[40:43], v[232:235]
v_mfma_f32_16x16x32_bf16 v[228:231], v[72:75], v[36:39], v[228:231]
v_mfma_f32_16x16x32_bf16 v[224:227], v[72:75], v[32:35], v[224:227]
v_mfma_f32_16x16x32_bf16 v[176:179], v[60:63], v[32:35], v[176:179]
v_mfma_f32_16x16x32_bf16 v[180:183], v[60:63], v[36:39], v[180:183]
v_mfma_f32_16x16x32_bf16 v[184:187], v[60:63], v[40:43], v[184:187]
v_mfma_f32_16x16x32_bf16 v[188:191], v[60:63], v[44:47], v[188:191]
v_mfma_f32_16x16x32_bf16 v[252:255], v[76:79], v[44:47], v[252:255]
v_mfma_f32_16x16x32_bf16 v[248:251], v[76:79], v[40:43], v[248:251]
v_mfma_f32_16x16x32_bf16 v[244:247], v[76:79], v[36:39], v[244:247]
v_mfma_f32_16x16x32_bf16 v[240:243], v[76:79], v[32:35], v[240:243]
s_waitcnt lgkmcnt(0)
v_mfma_f32_16x16x32_bf16 v[128:131], v[96:99], v[80:83], v[128:131]
v_mfma_f32_16x16x32_bf16 v[132:135], v[96:99], v[84:87], v[132:135]
v_mfma_f32_16x16x32_bf16 v[136:139], v[96:99], v[88:91], v[136:139]
v_mfma_f32_16x16x32_bf16 v[140:143], v[96:99], v[92:95], v[140:143]
v_mfma_f32_16x16x32_bf16 v[204:207], v[112:115], v[92:95], v[204:207]
v_mfma_f32_16x16x32_bf16 v[200:203], v[112:115], v[88:91], v[200:203]
v_mfma_f32_16x16x32_bf16 v[196:199], v[112:115], v[84:87], v[196:199]
v_mfma_f32_16x16x32_bf16 v[192:195], v[112:115], v[80:83], v[192:195]
v_mfma_f32_16x16x32_bf16 v[144:147], v[100:103], v[80:83], v[144:147]
v_mfma_f32_16x16x32_bf16 v[148:151], v[100:103], v[84:87], v[148:151]
v_mfma_f32_16x16x32_bf16 v[152:155], v[100:103], v[88:91], v[152:155]
v_mfma_f32_16x16x32_bf16 v[156:159], v[100:103], v[92:95], v[156:159]
v_mfma_f32_16x16x32_bf16 v[220:223], v[116:119], v[92:95], v[220:223]
v_mfma_f32_16x16x32_bf16 v[216:219], v[116:119], v[88:91], v[216:219]
v_mfma_f32_16x16x32_bf16 v[212:215], v[116:119], v[84:87], v[212:215]
v_mfma_f32_16x16x32_bf16 v[208:211], v[116:119], v[80:83], v[208:211]
v_mfma_f32_16x16x32_bf16 v[160:163], v[104:107], v[80:83], v[160:163]
v_mfma_f32_16x16x32_bf16 v[164:167], v[104:107], v[84:87], v[164:167]
v_mfma_f32_16x16x32_bf16 v[168:171], v[104:107], v[88:91], v[168:171]
v_mfma_f32_16x16x32_bf16 v[172:175], v[104:107], v[92:95], v[172:175]
v_mfma_f32_16x16x32_bf16 v[236:239], v[120:123], v[92:95], v[236:239]
v_mfma_f32_16x16x32_bf16 v[232:235], v[120:123], v[88:91], v[232:235]
v_mfma_f32_16x16x32_bf16 v[228:231], v[120:123], v[84:87], v[228:231]
v_mfma_f32_16x16x32_bf16 v[224:227], v[120:123], v[80:83], v[224:227]
v_mfma_f32_16x16x32_bf16 v[176:179], v[108:111], v[80:83], v[176:179]
v_mfma_f32_16x16x32_bf16 v[180:183], v[108:111], v[84:87], v[180:183]
v_mfma_f32_16x16x32_bf16 v[184:187], v[108:111], v[88:91], v[184:187]
v_mfma_f32_16x16x32_bf16 v[188:191], v[108:111], v[92:95], v[188:191]
v_mfma_f32_16x16x32_bf16 v[252:255], v[124:127], v[92:95], v[252:255]
v_mfma_f32_16x16x32_bf16 v[248:251], v[124:127], v[88:91], v[248:251]
v_mfma_f32_16x16x32_bf16 v[244:247], v[124:127], v[84:87], v[244:247]
v_mfma_f32_16x16x32_bf16 v[240:243], v[124:127], v[80:83], v[240:243]
s_barrier
s_add_u32 m0, s54, 0
s_add_u32 s43, s30, 0
buffer_load_dwordx4 v21, s[12:15], s43 offen sc1 lds
s_add_u32 m0, s54, 1024
s_add_u32 s43, s30, 1024
buffer_load_dwordx4 v21, s[12:15], s43 offen sc1 lds
s_add_u32 m0, s54, 49152
s_add_u32 s43, s31, 0
buffer_load_dwordx4 v21, s[12:15], s43 offen sc1 lds
s_add_u32 m0, s54, 50176
s_add_u32 s43, s31, 1024
buffer_load_dwordx4 v21, s[12:15], s43 offen sc1 lds
s_waitcnt vmcnt(2)
s_barrier
s_setprio 1
ds_read_b128 v[32:35], v2 offset:0
ds_read_b64_tr_b16 v[48:49], v5 offset:16384
ds_read_b64_tr_b16 v[50:51], v5 offset:20480
ds_read_b128 v[36:39], v2 offset:256
ds_read_b128 v[40:43], v2 offset:512
ds_read_b128 v[44:47], v2 offset:768
ds_read_b64_tr_b16 v[64:65], v5 offset:32768
ds_read_b64_tr_b16 v[66:67], v5 offset:36864
ds_read_b64_tr_b16 v[52:53], v6 offset:16384
ds_read_b64_tr_b16 v[54:55], v6 offset:20480
ds_read_b64_tr_b16 v[68:69], v6 offset:32768
ds_read_b64_tr_b16 v[70:71], v6 offset:36864
ds_read_b64_tr_b16 v[56:57], v7 offset:16384
ds_read_b64_tr_b16 v[58:59], v7 offset:20480
ds_read_b64_tr_b16 v[72:73], v7 offset:32768
ds_read_b64_tr_b16 v[74:75], v7 offset:36864
ds_read_b64_tr_b16 v[60:61], v8 offset:16384
ds_read_b64_tr_b16 v[62:63], v8 offset:20480
ds_read_b64_tr_b16 v[76:77], v8 offset:32768
ds_read_b64_tr_b16 v[78:79], v8 offset:36864
s_mov_b32 s41, 4
Lk3_27:
s_waitcnt lgkmcnt(0)
v_mfma_f32_16x16x32_bf16 v[128:131], v[48:51], v[32:35], v[128:131]
ds_read_b128 v[80:83], v2 offset:8192
v_mfma_f32_16x16x32_bf16 v[132:135], v[48:51], v[36:39], v[132:135]
ds_read_b64_tr_b16 v[96:97], v5 offset:24576
v_mfma_f32_16x16x32_bf16 v[136:139], v[48:51], v[40:43], v[136:139]
ds_read_b64_tr_b16 v[98:99], v5 offset:28672
v_mfma_f32_16x16x32_bf16 v[140:143], v[48:51], v[44:47], v[140:143]
ds_read_b128 v[84:87], v2 offset:8448
v_mfma_f32_16x16x32_bf16 v[204:207], v[64:67], v[44:47], v[204:207]
ds_read_b128 v[88:91], v2 offset:8704
v_mfma_f32_16x16x32_bf16 v[200:203], v[64:67], v[40:43], v[200:203]
ds_read_b128 v[92:95], v2 offset:8960
v_mfma_f32_16x16x32_bf16 v[196:199], v[64:67], v[36:39], v[196:199]
ds_read_b64_tr_b16 v[112:113], v5 offset:40960
v_mfma_f32_16x16x32_bf16 v[192:195], v[64:67], v[32:35], v[192:195]
ds_read_b64_tr_b16 v[114:115], v5 offset:45056
v_mfma_f32_16x16x32_bf16 v[144:147], v[52:55], v[32:35], v[144:147]
ds_read_b64_tr_b16 v[100:101], v6 offset:24576
v_mfma_f32_16x16x32_bf16 v[148:151], v[52:55], v[36:39], v[148:151]
ds_read_b64_tr_b16 v[102:103], v6 offset:28672
v_mfma_f32_16x16x32_bf16 v[152:155], v[52:55], v[40:43], v[152:155]
ds_read_b64_tr_b16 v[116:117], v6 offset:40960
v_mfma_f32_16x16x32_bf16 v[156:159], v[52:55], v[44:47], v[156:159]
ds_read_b64_tr_b16 v[118:119], v6 offset:45056
v_mfma_f32_16x16x32_bf16 v[220:223], v[68:71], v[44:47], v[220:223]
ds_read_b64_tr_b16 v[104:105], v7 offset:24576
v_mfma_f32_16x16x32_bf16 v[216:219], v[68:71], v[40:43], v[216:219]
ds_read_b64_tr_b16 v[106:107], v7 offset:28672
v_mfma_f32_16x16x32_bf16 v[212:215], v[68:71], v[36:39], v[212:215]
ds_read_b64_tr_b16 v[120:121], v7 offset:40960
v_mfma_f32_16x16x32_bf16 v[208:211], v[68:71], v[32:35], v[208:211]
ds_read_b64_tr_b16 v[122:123], v7 offset:45056
v_mfma_f32_16x16x32_bf16 v[160:163], v[56:59], v[32:35], v[160:163]
ds_read_b64_tr_b16 v[108:109], v8 offset:24576
v_mfma_f32_16x16x32_bf16 v[164:167], v[56:59], v[36:39], v[164:167]
ds_read_b64_tr_b16 v[110:111], v8 offset:28672
v_mfma_f32_16x16x32_bf16 v[168:171], v[56:59], v[40:43], v[168:171]
ds_read_b64_tr_b16 v[124:125], v8 offset:40960
v_mfma_f32_16x16x32_bf16 v[172:175], v[56:59], v[44:47], v[172:175]
ds_read_b64_tr_b16 v[126:127], v8 offset:45056
v_mfma_f32_16x16x32_bf16 v[236:239], v[72:75], v[44:47], v[236:239]
v_mfma_f32_16x16x32_bf16 v[232:235], v[72:75], v[40:43], v[232:235]
v_mfma_f32_16x16x32_bf16 v[228:231], v[72:75], v[36:39], v[228:231]
v_mfma_f32_16x16x32_bf16 v[224:227], v[72:75], v[32:35], v[224:227]
v_mfma_f32_16x16x32_bf16 v[176:179], v[60:63], v[32:35], v[176:179]
v_mfma_f32_16x16x32_bf16 v[180:183], v[60:63], v[36:39], v[180:183]
v_mfma_f32_16x16x32_bf16 v[184:187], v[60:63], v[40:43], v[184:187]
v_mfma_f32_16x16x32_bf16 v[188:191], v[60:63], v[44:47], v[188:191]
v_mfma_f32_16x16x32_bf16 v[252:255], v[76:79], v[44:47], v[252:255]
v_mfma_f32_16x16x32_bf16 v[248:251], v[76:79], v[40:43], v[248:251]
v_mfma_f32_16x16x32_bf16 v[244:247], v[76:79], v[36:39], v[244:247]
v_mfma_f32_16x16x32_bf16 v[240:243], v[76:79], v[32:35], v[240:243]
s_waitcnt vmcnt(0) lgkmcnt(0)
s_barrier
v_mfma_f32_16x16x32_bf16 v[128:131], v[96:99], v[80:83], v[128:131]
ds_read_b128 v[32:35], v3 offset:0
v_mfma_f32_16x16x32_bf16 v[132:135], v[96:99], v[84:87], v[132:135]
ds_read_b64_tr_b16 v[48:49], v9 offset:16384
v_mfma_f32_16x16x32_bf16 v[136:139], v[96:99], v[88:91], v[136:139]
ds_read_b64_tr_b16 v[50:51], v9 offset:20480
v_mfma_f32_16x16x32_bf16 v[140:143], v[96:99], v[92:95], v[140:143]
ds_read_b128 v[36:39], v3 offset:256
v_mfma_f32_16x16x32_bf16 v[204:207], v[112:115], v[92:95], v[204:207]
ds_read_b128 v[40:43], v3 offset:512
v_mfma_f32_16x16x32_bf16 v[200:203], v[112:115], v[88:91], v[200:203]
ds_read_b128 v[44:47], v3 offset:768
v_mfma_f32_16x16x32_bf16 v[196:199], v[112:115], v[84:87], v[196:199]
ds_read_b64_tr_b16 v[64:65], v9 offset:32768
v_mfma_f32_16x16x32_bf16 v[192:195], v[112:115], v[80:83], v[192:195]
ds_read_b64_tr_b16 v[66:67], v9 offset:36864
v_mfma_f32_16x16x32_bf16 v[144:147], v[100:103], v[80:83], v[144:147]
ds_read_b64_tr_b16 v[52:53], v10 offset:16384
v_mfma_f32_16x16x32_bf16 v[148:151], v[100:103], v[84:87], v[148:151]
ds_read_b64_tr_b16 v[54:55], v10 offset:20480
v_mfma_f32_16x16x32_bf16 v[152:155], v[100:103], v[88:91], v[152:155]
ds_read_b64_tr_b16 v[68:69], v10 offset:32768
v_mfma_f32_16x16x32_bf16 v[156:159], v[100:103], v[92:95], v[156:159]
ds_read_b64_tr_b16 v[70:71], v10 offset:36864
v_mfma_f32_16x16x32_bf16 v[220:223], v[116:119], v[92:95], v[220:223]
ds_read_b64_tr_b16 v[56:57], v11 offset:16384
v_mfma_f32_16x16x32_bf16 v[216:219], v[116:119], v[88:91], v[216:219]
ds_read_b64_tr_b16 v[58:59], v11 offset:20480
v_mfma_f32_16x16x32_bf16 v[212:215], v[116:119], v[84:87], v[212:215]
ds_read_b64_tr_b16 v[72:73], v11 offset:32768
v_mfma_f32_16x16x32_bf16 v[208:211], v[116:119], v[80:83], v[208:211]
ds_read_b64_tr_b16 v[74:75], v11 offset:36864
v_mfma_f32_16x16x32_bf16 v[160:163], v[104:107], v[80:83], v[160:163]
ds_read_b64_tr_b16 v[60:61], v12 offset:16384
v_mfma_f32_16x16x32_bf16 v[164:167], v[104:107], v[84:87], v[164:167]
ds_read_b64_tr_b16 v[62:63], v12 offset:20480
v_mfma_f32_16x16x32_bf16 v[168:171], v[104:107], v[88:91], v[168:171]
ds_read_b64_tr_b16 v[76:77], v12 offset:32768
v_mfma_f32_16x16x32_bf16 v[172:175], v[104:107], v[92:95], v[172:175]
ds_read_b64_tr_b16 v[78:79], v12 offset:36864
v_mfma_f32_16x16x32_bf16 v[236:239], v[120:123], v[92:95], v[236:239]
v_mfma_f32_16x16x32_bf16 v[232:235], v[120:123], v[88:91], v[232:235]
v_mfma_f32_16x16x32_bf16 v[228:231], v[120:123], v[84:87], v[228:231]
v_mfma_f32_16x16x32_bf16 v[224:227], v[120:123], v[80:83], v[224:227]
v_mfma_f32_16x16x32_bf16 v[176:179], v[108:111], v[80:83], v[176:179]
v_mfma_f32_16x16x32_bf16 v[180:183], v[108:111], v[84:87], v[180:183]
v_mfma_f32_16x16x32_bf16 v[184:187], v[108:111], v[88:91], v[184:187]
v_mfma_f32_16x16x32_bf16 v[188:191], v[108:111], v[92:95], v[188:191]
v_mfma_f32_16x16x32_bf16 v[252:255], v[124:127], v[92:95], v[252:255]
v_mfma_f32_16x16x32_bf16 v[248:251], v[124:127], v[88:91], v[248:251]
v_mfma_f32_16x16x32_bf16 v[244:247], v[124:127], v[84:87], v[244:247]
v_mfma_f32_16x16x32_bf16 v[240:243], v[124:127], v[80:83], v[240:243]
s_waitcnt lgkmcnt(0)
v_mfma_f32_16x16x32_bf16 v[128:131], v[48:51], v[32:35], v[128:131]
ds_read_b128 v[80:83], v3 offset:8192
v_mfma_f32_16x16x32_bf16 v[132:135], v[48:51], v[36:39], v[132:135]
ds_read_b64_tr_b16 v[96:97], v9 offset:24576
v_mfma_f32_16x16x32_bf16 v[136:139], v[48:51], v[40:43], v[136:139]
ds_read_b64_tr_b16 v[98:99], v9 offset:28672
v_mfma_f32_16x16x32_bf16 v[140:143], v[48:51], v[44:47], v[140:143]
ds_read_b128 v[84:87], v3 offset:8448
v_mfma_f32_16x16x32_bf16 v[204:207], v[64:67], v[44:47], v[204:207]
ds_read_b128 v[88:91], v3 offset:8704
v_mfma_f32_16x16x32_bf16 v[200:203], v[64:67], v[40:43], v[200:203]
ds_read_b128 v[92:95], v3 offset:8960
v_mfma_f32_16x16x32_bf16 v[196:199], v[64:67], v[36:39], v[196:199]
ds_read_b64_tr_b16 v[112:113], v9 offset:40960
v_mfma_f32_16x16x32_bf16 v[192:195], v[64:67], v[32:35], v[192:195]
ds_read_b64_tr_b16 v[114:115], v9 offset:45056
v_mfma_f32_16x16x32_bf16 v[144:147], v[52:55], v[32:35], v[144:147]
ds_read_b64_tr_b16 v[100:101], v10 offset:24576
v_mfma_f32_16x16x32_bf16 v[148:151], v[52:55], v[36:39], v[148:151]
ds_read_b64_tr_b16 v[102:103], v10 offset:28672
v_mfma_f32_16x16x32_bf16 v[152:155], v[52:55], v[40:43], v[152:155]
ds_read_b64_tr_b16 v[116:117], v10 offset:40960
v_mfma_f32_16x16x32_bf16 v[156:159], v[52:55], v[44:47], v[156:159]
ds_read_b64_tr_b16 v[118:119], v10 offset:45056
v_mfma_f32_16x16x32_bf16 v[220:223], v[68:71], v[44:47], v[220:223]
ds_read_b64_tr_b16 v[104:105], v11 offset:24576
v_mfma_f32_16x16x32_bf16 v[216:219], v[68:71], v[40:43], v[216:219]
ds_read_b64_tr_b16 v[106:107], v11 offset:28672
v_mfma_f32_16x16x32_bf16 v[212:215], v[68:71], v[36:39], v[212:215]
ds_read_b64_tr_b16 v[120:121], v11 offset:40960
v_mfma_f32_16x16x32_bf16 v[208:211], v[68:71], v[32:35], v[208:211]
ds_read_b64_tr_b16 v[122:123], v11 offset:45056
v_mfma_f32_16x16x32_bf16 v[160:163], v[56:59], v[32:35], v[160:163]
ds_read_b64_tr_b16 v[108:109], v12 offset:24576
v_mfma_f32_16x16x32_bf16 v[164:167], v[56:59], v[36:39], v[164:167]
ds_read_b64_tr_b16 v[110:111], v12 offset:28672
v_mfma_f32_16x16x32_bf16 v[168:171], v[56:59], v[40:43], v[168:171]
ds_read_b64_tr_b16 v[124:125], v12 offset:40960
v_mfma_f32_16x16x32_bf16 v[172:175], v[56:59], v[44:47], v[172:175]
ds_read_b64_tr_b16 v[126:127], v12 offset:45056
v_mfma_f32_16x16x32_bf16 v[236:239], v[72:75], v[44:47], v[236:239]
v_mfma_f32_16x16x32_bf16 v[232:235], v[72:75], v[40:43], v[232:235]
v_mfma_f32_16x16x32_bf16 v[228:231], v[72:75], v[36:39], v[228:231]
v_mfma_f32_16x16x32_bf16 v[224:227], v[72:75], v[32:35], v[224:227]
v_mfma_f32_16x16x32_bf16 v[176:179], v[60:63], v[32:35], v[176:179]
v_mfma_f32_16x16x32_bf16 v[180:183], v[60:63], v[36:39], v[180:183]
v_mfma_f32_16x16x32_bf16 v[184:187], v[60:63], v[40:43], v[184:187]
v_mfma_f32_16x16x32_bf16 v[188:191], v[60:63], v[44:47], v[188:191]
v_mfma_f32_16x16x32_bf16 v[252:255], v[76:79], v[44:47], v[252:255]
v_mfma_f32_16x16x32_bf16 v[248:251], v[76:79], v[40:43], v[248:251]
v_mfma_f32_16x16x32_bf16 v[244:247], v[76:79], v[36:39], v[244:247]
v_mfma_f32_16x16x32_bf16 v[240:243], v[76:79], v[32:35], v[240:243]
s_waitcnt lgkmcnt(0)
s_barrier
v_mfma_f32_16x16x32_bf16 v[128:131], v[96:99], v[80:83], v[128:131]
ds_read_b128 v[32:35], v4 offset:0
v_mfma_f32_16x16x32_bf16 v[132:135], v[96:99], v[84:87], v[132:135]
ds_read_b64_tr_b16 v[48:49], v13 offset:16384
v_mfma_f32_16x16x32_bf16 v[136:139], v[96:99], v[88:91], v[136:139]
ds_read_b64_tr_b16 v[50:51], v13 offset:20480
v_mfma_f32_16x16x32_bf16 v[140:143], v[96:99], v[92:95], v[140:143]
ds_read_b128 v[36:39], v4 offset:256
v_mfma_f32_16x16x32_bf16 v[204:207], v[112:115], v[92:95], v[204:207]
ds_read_b128 v[40:43], v4 offset:512
v_mfma_f32_16x16x32_bf16 v[200:203], v[112:115], v[88:91], v[200:203]
ds_read_b128 v[44:47], v4 offset:768
v_mfma_f32_16x16x32_bf16 v[196:199], v[112:115], v[84:87], v[196:199]
ds_read_b64_tr_b16 v[64:65], v13 offset:32768
v_mfma_f32_16x16x32_bf16 v[192:195], v[112:115], v[80:83], v[192:195]
ds_read_b64_tr_b16 v[66:67], v13 offset:36864
v_mfma_f32_16x16x32_bf16 v[144:147], v[100:103], v[80:83], v[144:147]
ds_read_b64_tr_b16 v[52:53], v14 offset:16384
v_mfma_f32_16x16x32_bf16 v[148:151], v[100:103], v[84:87], v[148:151]
ds_read_b64_tr_b16 v[54:55], v14 offset:20480
v_mfma_f32_16x16x32_bf16 v[152:155], v[100:103], v[88:91], v[152:155]
ds_read_b64_tr_b16 v[68:69], v14 offset:32768
v_mfma_f32_16x16x32_bf16 v[156:159], v[100:103], v[92:95], v[156:159]
ds_read_b64_tr_b16 v[70:71], v14 offset:36864
v_mfma_f32_16x16x32_bf16 v[220:223], v[116:119], v[92:95], v[220:223]
ds_read_b64_tr_b16 v[56:57], v15 offset:16384
v_mfma_f32_16x16x32_bf16 v[216:219], v[116:119], v[88:91], v[216:219]
ds_read_b64_tr_b16 v[58:59], v15 offset:20480
v_mfma_f32_16x16x32_bf16 v[212:215], v[116:119], v[84:87], v[212:215]
ds_read_b64_tr_b16 v[72:73], v15 offset:32768
v_mfma_f32_16x16x32_bf16 v[208:211], v[116:119], v[80:83], v[208:211]
ds_read_b64_tr_b16 v[74:75], v15 offset:36864
v_mfma_f32_16x16x32_bf16 v[160:163], v[104:107], v[80:83], v[160:163]
ds_read_b64_tr_b16 v[60:61], v16 offset:16384
v_mfma_f32_16x16x32_bf16 v[164:167], v[104:107], v[84:87], v[164:167]
ds_read_b64_tr_b16 v[62:63], v16 offset:20480
v_mfma_f32_16x16x32_bf16 v[168:171], v[104:107], v[88:91], v[168:171]
ds_read_b64_tr_b16 v[76:77], v16 offset:32768
v_mfma_f32_16x16x32_bf16 v[172:175], v[104:107], v[92:95], v[172:175]
ds_read_b64_tr_b16 v[78:79], v16 offset:36864
v_mfma_f32_16x16x32_bf16 v[236:239], v[120:123], v[92:95], v[236:239]
v_mfma_f32_16x16x32_bf16 v[232:235], v[120:123], v[88:91], v[232:235]
v_mfma_f32_16x16x32_bf16 v[228:231], v[120:123], v[84:87], v[228:231]
v_mfma_f32_16x16x32_bf16 v[224:227], v[120:123], v[80:83], v[224:227]
v_mfma_f32_16x16x32_bf16 v[176:179], v[108:111], v[80:83], v[176:179]
v_mfma_f32_16x16x32_bf16 v[180:183], v[108:111], v[84:87], v[180:183]
v_mfma_f32_16x16x32_bf16 v[184:187], v[108:111], v[88:91], v[184:187]
v_mfma_f32_16x16x32_bf16 v[188:191], v[108:111], v[92:95], v[188:191]
v_mfma_f32_16x16x32_bf16 v[252:255], v[124:127], v[92:95], v[252:255]
v_mfma_f32_16x16x32_bf16 v[248:251], v[124:127], v[88:91], v[248:251]
v_mfma_f32_16x16x32_bf16 v[244:247], v[124:127], v[84:87], v[244:247]
v_mfma_f32_16x16x32_bf16 v[240:243], v[124:127], v[80:83], v[240:243]
s_waitcnt lgkmcnt(0)
v_mfma_f32_16x16x32_bf16 v[128:131], v[48:51], v[32:35], v[128:131]
ds_read_b128 v[80:83], v4 offset:8192
v_mfma_f32_16x16x32_bf16 v[132:135], v[48:51], v[36:39], v[132:135]
ds_read_b64_tr_b16 v[96:97], v13 offset:24576
v_mfma_f32_16x16x32_bf16 v[136:139], v[48:51], v[40:43], v[136:139]
ds_read_b64_tr_b16 v[98:99], v13 offset:28672
v_mfma_f32_16x16x32_bf16 v[140:143], v[48:51], v[44:47], v[140:143]
ds_read_b128 v[84:87], v4 offset:8448
v_mfma_f32_16x16x32_bf16 v[204:207], v[64:67], v[44:47], v[204:207]
ds_read_b128 v[88:91], v4 offset:8704
v_mfma_f32_16x16x32_bf16 v[200:203], v[64:67], v[40:43], v[200:203]
ds_read_b128 v[92:95], v4 offset:8960
v_mfma_f32_16x16x32_bf16 v[196:199], v[64:67], v[36:39], v[196:199]
ds_read_b64_tr_b16 v[112:113], v13 offset:40960
v_mfma_f32_16x16x32_bf16 v[192:195], v[64:67], v[32:35], v[192:195]
ds_read_b64_tr_b16 v[114:115], v13 offset:45056
v_mfma_f32_16x16x32_bf16 v[144:147], v[52:55], v[32:35], v[144:147]
ds_read_b64_tr_b16 v[100:101], v14 offset:24576
v_mfma_f32_16x16x32_bf16 v[148:151], v[52:55], v[36:39], v[148:151]
ds_read_b64_tr_b16 v[102:103], v14 offset:28672
v_mfma_f32_16x16x32_bf16 v[152:155], v[52:55], v[40:43], v[152:155]
ds_read_b64_tr_b16 v[116:117], v14 offset:40960
v_mfma_f32_16x16x32_bf16 v[156:159], v[52:55], v[44:47], v[156:159]
ds_read_b64_tr_b16 v[118:119], v14 offset:45056
v_mfma_f32_16x16x32_bf16 v[220:223], v[68:71], v[44:47], v[220:223]
ds_read_b64_tr_b16 v[104:105], v15 offset:24576
v_mfma_f32_16x16x32_bf16 v[216:219], v[68:71], v[40:43], v[216:219]
ds_read_b64_tr_b16 v[106:107], v15 offset:28672
v_mfma_f32_16x16x32_bf16 v[212:215], v[68:71], v[36:39], v[212:215]
ds_read_b64_tr_b16 v[120:121], v15 offset:40960
v_mfma_f32_16x16x32_bf16 v[208:211], v[68:71], v[32:35], v[208:211]
ds_read_b64_tr_b16 v[122:123], v15 offset:45056
v_mfma_f32_16x16x32_bf16 v[160:163], v[56:59], v[32:35], v[160:163]
ds_read_b64_tr_b16 v[108:109], v16 offset:24576
v_mfma_f32_16x16x32_bf16 v[164:167], v[56:59], v[36:39], v[164:167]
ds_read_b64_tr_b16 v[110:111], v16 offset:28672
v_mfma_f32_16x16x32_bf16 v[168:171], v[56:59], v[40:43], v[168:171]
ds_read_b64_tr_b16 v[124:125], v16 offset:40960
v_mfma_f32_16x16x32_bf16 v[172:175], v[56:59], v[44:47], v[172:175]
ds_read_b64_tr_b16 v[126:127], v16 offset:45056
v_mfma_f32_16x16x32_bf16 v[236:239], v[72:75], v[44:47], v[236:239]
v_mfma_f32_16x16x32_bf16 v[232:235], v[72:75], v[40:43], v[232:235]
v_mfma_f32_16x16x32_bf16 v[228:231], v[72:75], v[36:39], v[228:231]
v_mfma_f32_16x16x32_bf16 v[224:227], v[72:75], v[32:35], v[224:227]
v_mfma_f32_16x16x32_bf16 v[176:179], v[60:63], v[32:35], v[176:179]
v_mfma_f32_16x16x32_bf16 v[180:183], v[60:63], v[36:39], v[180:183]
v_mfma_f32_16x16x32_bf16 v[184:187], v[60:63], v[40:43], v[184:187]
v_mfma_f32_16x16x32_bf16 v[188:191], v[60:63], v[44:47], v[188:191]
v_mfma_f32_16x16x32_bf16 v[252:255], v[76:79], v[44:47], v[252:255]
v_mfma_f32_16x16x32_bf16 v[248:251], v[76:79], v[40:43], v[248:251]
v_mfma_f32_16x16x32_bf16 v[244:247], v[76:79], v[36:39], v[244:247]
v_mfma_f32_16x16x32_bf16 v[240:243], v[76:79], v[32:35], v[240:243]
s_waitcnt lgkmcnt(0)
s_barrier
v_mfma_f32_16x16x32_bf16 v[128:131], v[96:99], v[80:83], v[128:131]
ds_read_b128 v[32:35], v2 offset:0
v_mfma_f32_16x16x32_bf16 v[132:135], v[96:99], v[84:87], v[132:135]
ds_read_b64_tr_b16 v[48:49], v5 offset:16384
v_mfma_f32_16x16x32_bf16 v[136:139], v[96:99], v[88:91], v[136:139]
ds_read_b64_tr_b16 v[50:51], v5 offset:20480
v_mfma_f32_16x16x32_bf16 v[140:143], v[96:99], v[92:95], v[140:143]
ds_read_b128 v[36:39], v2 offset:256
v_mfma_f32_16x16x32_bf16 v[204:207], v[112:115], v[92:95], v[204:207]
ds_read_b128 v[40:43], v2 offset:512
v_mfma_f32_16x16x32_bf16 v[200:203], v[112:115], v[88:91], v[200:203]
ds_read_b128 v[44:47], v2 offset:768
v_mfma_f32_16x16x32_bf16 v[196:199], v[112:115], v[84:87], v[196:199]
ds_read_b64_tr_b16 v[64:65], v5 offset:32768
v_mfma_f32_16x16x32_bf16 v[192:195], v[112:115], v[80:83], v[192:195]
ds_read_b64_tr_b16 v[66:67], v5 offset:36864
v_mfma_f32_16x16x32_bf16 v[144:147], v[100:103], v[80:83], v[144:147]
ds_read_b64_tr_b16 v[52:53], v6 offset:16384
v_mfma_f32_16x16x32_bf16 v[148:151], v[100:103], v[84:87], v[148:151]
ds_read_b64_tr_b16 v[54:55], v6 offset:20480
v_mfma_f32_16x16x32_bf16 v[152:155], v[100:103], v[88:91], v[152:155]
ds_read_b64_tr_b16 v[68:69], v6 offset:32768
v_mfma_f32_16x16x32_bf16 v[156:159], v[100:103], v[92:95], v[156:159]
ds_read_b64_tr_b16 v[70:71], v6 offset:36864
v_mfma_f32_16x16x32_bf16 v[220:223], v[116:119], v[92:95], v[220:223]
ds_read_b64_tr_b16 v[56:57], v7 offset:16384
v_mfma_f32_16x16x32_bf16 v[216:219], v[116:119], v[88:91], v[216:219]
ds_read_b64_tr_b16 v[58:59], v7 offset:20480
v_mfma_f32_16x16x32_bf16 v[212:215], v[116:119], v[84:87], v[212:215]
ds_read_b64_tr_b16 v[72:73], v7 offset:32768
v_mfma_f32_16x16x32_bf16 v[208:211], v[116:119], v[80:83], v[208:211]
ds_read_b64_tr_b16 v[74:75], v7 offset:36864
v_mfma_f32_16x16x32_bf16 v[160:163], v[104:107], v[80:83], v[160:163]
ds_read_b64_tr_b16 v[60:61], v8 offset:16384
v_mfma_f32_16x16x32_bf16 v[164:167], v[104:107], v[84:87], v[164:167]
ds_read_b64_tr_b16 v[62:63], v8 offset:20480
v_mfma_f32_16x16x32_bf16 v[168:171], v[104:107], v[88:91], v[168:171]
ds_read_b64_tr_b16 v[76:77], v8 offset:32768
v_mfma_f32_16x16x32_bf16 v[172:175], v[104:107], v[92:95], v[172:175]
ds_read_b64_tr_b16 v[78:79], v8 offset:36864
v_mfma_f32_16x16x32_bf16 v[236:239], v[120:123], v[92:95], v[236:239]
v_mfma_f32_16x16x32_bf16 v[232:235], v[120:123], v[88:91], v[232:235]
v_mfma_f32_16x16x32_bf16 v[228:231], v[120:123], v[84:87], v[228:231]
v_mfma_f32_16x16x32_bf16 v[224:227], v[120:123], v[80:83], v[224:227]
v_mfma_f32_16x16x32_bf16 v[176:179], v[108:111], v[80:83], v[176:179]
v_mfma_f32_16x16x32_bf16 v[180:183], v[108:111], v[84:87], v[180:183]
v_mfma_f32_16x16x32_bf16 v[184:187], v[108:111], v[88:91], v[184:187]
v_mfma_f32_16x16x32_bf16 v[188:191], v[108:111], v[92:95], v[188:191]
v_mfma_f32_16x16x32_bf16 v[252:255], v[124:127], v[92:95], v[252:255]
v_mfma_f32_16x16x32_bf16 v[248:251], v[124:127], v[88:91], v[248:251]
v_mfma_f32_16x16x32_bf16 v[244:247], v[124:127], v[84:87], v[244:247]
v_mfma_f32_16x16x32_bf16 v[240:243], v[124:127], v[80:83], v[240:243]
s_sub_u32 s41, s41, 1
s_cmp_lg_u32 s41, 0
s_cbranch_scc1 Lk3_27
s_waitcnt lgkmcnt(0)
v_mfma_f32_16x16x32_bf16 v[128:131], v[48:51], v[32:35], v[128:131]
ds_read_b128 v[80:83], v2 offset:8192
v_mfma_f32_16x16x32_bf16 v[132:135], v[48:51], v[36:39], v[132:135]
ds_read_b64_tr_b16 v[96:97], v5 offset:24576
v_mfma_f32_16x16x32_bf16 v[136:139], v[48:51], v[40:43], v[136:139]
ds_read_b64_tr_b16 v[98:99], v5 offset:28672
v_mfma_f32_16x16x32_bf16 v[140:143], v[48:51], v[44:47], v[140:143]
ds_read_b128 v[84:87], v2 offset:8448
v_mfma_f32_16x16x32_bf16 v[204:207], v[64:67], v[44:47], v[204:207]
ds_read_b128 v[88:91], v2 offset:8704
v_mfma_f32_16x16x32_bf16 v[200:203], v[64:67], v[40:43], v[200:203]
ds_read_b128 v[92:95], v2 offset:8960
v_mfma_f32_16x16x32_bf16 v[196:199], v[64:67], v[36:39], v[196:199]
ds_read_b64_tr_b16 v[112:113], v5 offset:40960
v_mfma_f32_16x16x32_bf16 v[192:195], v[64:67], v[32:35], v[192:195]
ds_read_b64_tr_b16 v[114:115], v5 offset:45056
v_mfma_f32_16x16x32_bf16 v[144:147], v[52:55], v[32:35], v[144:147]
ds_read_b64_tr_b16 v[100:101], v6 offset:24576
v_mfma_f32_16x16x32_bf16 v[148:151], v[52:55], v[36:39], v[148:151]
ds_read_b64_tr_b16 v[102:103], v6 offset:28672
v_mfma_f32_16x16x32_bf16 v[152:155], v[52:55], v[40:43], v[152:155]
ds_read_b64_tr_b16 v[116:117], v6 offset:40960
v_mfma_f32_16x16x32_bf16 v[156:159], v[52:55], v[44:47], v[156:159]
ds_read_b64_tr_b16 v[118:119], v6 offset:45056
v_mfma_f32_16x16x32_bf16 v[220:223], v[68:71], v[44:47], v[220:223]
ds_read_b64_tr_b16 v[104:105], v7 offset:24576
v_mfma_f32_16x16x32_bf16 v[216:219], v[68:71], v[40:43], v[216:219]
ds_read_b64_tr_b16 v[106:107], v7 offset:28672
v_mfma_f32_16x16x32_bf16 v[212:215], v[68:71], v[36:39], v[212:215]
ds_read_b64_tr_b16 v[120:121], v7 offset:40960
v_mfma_f32_16x16x32_bf16 v[208:211], v[68:71], v[32:35], v[208:211]
ds_read_b64_tr_b16 v[122:123], v7 offset:45056
v_mfma_f32_16x16x32_bf16 v[160:163], v[56:59], v[32:35], v[160:163]
ds_read_b64_tr_b16 v[108:109], v8 offset:24576
v_mfma_f32_16x16x32_bf16 v[164:167], v[56:59], v[36:39], v[164:167]
ds_read_b64_tr_b16 v[110:111], v8 offset:28672
v_mfma_f32_16x16x32_bf16 v[168:171], v[56:59], v[40:43], v[168:171]
ds_read_b64_tr_b16 v[124:125], v8 offset:40960
v_mfma_f32_16x16x32_bf16 v[172:175], v[56:59], v[44:47], v[172:175]
ds_read_b64_tr_b16 v[126:127], v8 offset:45056
v_mfma_f32_16x16x32_bf16 v[236:239], v[72:75], v[44:47], v[236:239]
v_mfma_f32_16x16x32_bf16 v[232:235], v[72:75], v[40:43], v[232:235]
v_mfma_f32_16x16x32_bf16 v[228:231], v[72:75], v[36:39], v[228:231]
v_mfma_f32_16x16x32_bf16 v[224:227], v[72:75], v[32:35], v[224:227]
v_mfma_f32_16x16x32_bf16 v[176:179], v[60:63], v[32:35], v[176:179]
v_mfma_f32_16x16x32_bf16 v[180:183], v[60:63], v[36:39], v[180:183]
v_mfma_f32_16x16x32_bf16 v[184:187], v[60:63], v[40:43], v[184:187]
v_mfma_f32_16x16x32_bf16 v[188:191], v[60:63], v[44:47], v[188:191]
v_mfma_f32_16x16x32_bf16 v[252:255], v[76:79], v[44:47], v[252:255]
v_mfma_f32_16x16x32_bf16 v[248:251], v[76:79], v[40:43], v[248:251]
v_mfma_f32_16x16x32_bf16 v[244:247], v[76:79], v[36:39], v[244:247]
v_mfma_f32_16x16x32_bf16 v[240:243], v[76:79], v[32:35], v[240:243]
s_waitcnt lgkmcnt(0)
s_barrier
v_mfma_f32_16x16x32_bf16 v[128:131], v[96:99], v[80:83], v[128:131]
ds_read_b128 v[32:35], v3 offset:0
v_mfma_f32_16x16x32_bf16 v[132:135], v[96:99], v[84:87], v[132:135]
ds_read_b64_tr_b16 v[48:49], v9 offset:16384
v_mfma_f32_16x16x32_bf16 v[136:139], v[96:99], v[88:91], v[136:139]
ds_read_b64_tr_b16 v[50:51], v9 offset:20480
v_mfma_f32_16x16x32_bf16 v[140:143], v[96:99], v[92:95], v[140:143]
ds_read_b128 v[36:39], v3 offset:256
v_mfma_f32_16x16x32_bf16 v[204:207], v[112:115], v[92:95], v[204:207]
ds_read_b128 v[40:43], v3 offset:512
v_mfma_f32_16x16x32_bf16 v[200:203], v[112:115], v[88:91], v[200:203]
ds_read_b128 v[44:47], v3 offset:768
v_mfma_f32_16x16x32_bf16 v[196:199], v[112:115], v[84:87], v[196:199]
ds_read_b64_tr_b16 v[64:65], v9 offset:32768
v_mfma_f32_16x16x32_bf16 v[192:195], v[112:115], v[80:83], v[192:195]
ds_read_b64_tr_b16 v[66:67], v9 offset:36864
v_mfma_f32_16x16x32_bf16 v[144:147], v[100:103], v[80:83], v[144:147]
ds_read_b64_tr_b16 v[52:53], v10 offset:16384
v_mfma_f32_16x16x32_bf16 v[148:151], v[100:103], v[84:87], v[148:151]
ds_read_b64_tr_b16 v[54:55], v10 offset:20480
v_mfma_f32_16x16x32_bf16 v[152:155], v[100:103], v[88:91], v[152:155]
ds_read_b64_tr_b16 v[68:69], v10 offset:32768
v_mfma_f32_16x16x32_bf16 v[156:159], v[100:103], v[92:95], v[156:159]
ds_read_b64_tr_b16 v[70:71], v10 offset:36864
v_mfma_f32_16x16x32_bf16 v[220:223], v[116:119], v[92:95], v[220:223]
ds_read_b64_tr_b16 v[56:57], v11 offset:16384
v_mfma_f32_16x16x32_bf16 v[216:219], v[116:119], v[88:91], v[216:219]
ds_read_b64_tr_b16 v[58:59], v11 offset:20480
v_mfma_f32_16x16x32_bf16 v[212:215], v[116:119], v[84:87], v[212:215]
ds_read_b64_tr_b16 v[72:73], v11 offset:32768
v_mfma_f32_16x16x32_bf16 v[208:211], v[116:119], v[80:83], v[208:211]
ds_read_b64_tr_b16 v[74:75], v11 offset:36864
v_mfma_f32_16x16x32_bf16 v[160:163], v[104:107], v[80:83], v[160:163]
ds_read_b64_tr_b16 v[60:61], v12 offset:16384
v_mfma_f32_16x16x32_bf16 v[164:167], v[104:107], v[84:87], v[164:167]
ds_read_b64_tr_b16 v[62:63], v12 offset:20480
v_mfma_f32_16x16x32_bf16 v[168:171], v[104:107], v[88:91], v[168:171]
ds_read_b64_tr_b16 v[76:77], v12 offset:32768
v_mfma_f32_16x16x32_bf16 v[172:175], v[104:107], v[92:95], v[172:175]
ds_read_b64_tr_b16 v[78:79], v12 offset:36864
v_mfma_f32_16x16x32_bf16 v[236:239], v[120:123], v[92:95], v[236:239]
v_mfma_f32_16x16x32_bf16 v[232:235], v[120:123], v[88:91], v[232:235]
v_mfma_f32_16x16x32_bf16 v[228:231], v[120:123], v[84:87], v[228:231]
v_mfma_f32_16x16x32_bf16 v[224:227], v[120:123], v[80:83], v[224:227]
v_mfma_f32_16x16x32_bf16 v[176:179], v[108:111], v[80:83], v[176:179]
v_mfma_f32_16x16x32_bf16 v[180:183], v[108:111], v[84:87], v[180:183]
v_mfma_f32_16x16x32_bf16 v[184:187], v[108:111], v[88:91], v[184:187]
v_mfma_f32_16x16x32_bf16 v[188:191], v[108:111], v[92:95], v[188:191]
v_mfma_f32_16x16x32_bf16 v[252:255], v[124:127], v[92:95], v[252:255]
v_mfma_f32_16x16x32_bf16 v[248:251], v[124:127], v[88:91], v[248:251]
v_mfma_f32_16x16x32_bf16 v[244:247], v[124:127], v[84:87], v[244:247]
v_mfma_f32_16x16x32_bf16 v[240:243], v[124:127], v[80:83], v[240:243]
s_waitcnt lgkmcnt(0)
v_mfma_f32_16x16x32_bf16 v[128:131], v[48:51], v[32:35], v[128:131]
ds_read_b128 v[80:83], v3 offset:8192
v_mfma_f32_16x16x32_bf16 v[132:135], v[48:51], v[36:39], v[132:135]
ds_read_b64_tr_b16 v[96:97], v9 offset:24576
v_mfma_f32_16x16x32_bf16 v[136:139], v[48:51], v[40:43], v[136:139]
ds_read_b64_tr_b16 v[98:99], v9 offset:28672
v_mfma_f32_16x16x32_bf16 v[140:143], v[48:51], v[44:47], v[140:143]
ds_read_b128 v[84:87], v3 offset:8448
v_mfma_f32_16x16x32_bf16 v[204:207], v[64:67], v[44:47], v[204:207]
ds_read_b128 v[88:91], v3 offset:8704
v_mfma_f32_16x16x32_bf16 v[200:203], v[64:67], v[40:43], v[200:203]
ds_read_b128 v[92:95], v3 offset:8960
v_mfma_f32_16x16x32_bf16 v[196:199], v[64:67], v[36:39], v[196:199]
ds_read_b64_tr_b16 v[112:113], v9 offset:40960
v_mfma_f32_16x16x32_bf16 v[192:195], v[64:67], v[32:35], v[192:195]
ds_read_b64_tr_b16 v[114:115], v9 offset:45056
v_mfma_f32_16x16x32_bf16 v[144:147], v[52:55], v[32:35], v[144:147]
ds_read_b64_tr_b16 v[100:101], v10 offset:24576
v_mfma_f32_16x16x32_bf16 v[148:151], v[52:55], v[36:39], v[148:151]
ds_read_b64_tr_b16 v[102:103], v10 offset:28672
v_mfma_f32_16x16x32_bf16 v[152:155], v[52:55], v[40:43], v[152:155]
ds_read_b64_tr_b16 v[116:117], v10 offset:40960
v_mfma_f32_16x16x32_bf16 v[156:159], v[52:55], v[44:47], v[156:159]
ds_read_b64_tr_b16 v[118:119], v10 offset:45056
v_mfma_f32_16x16x32_bf16 v[220:223], v[68:71], v[44:47], v[220:223]
ds_read_b64_tr_b16 v[104:105], v11 offset:24576
v_mfma_f32_16x16x32_bf16 v[216:219], v[68:71], v[40:43], v[216:219]
ds_read_b64_tr_b16 v[106:107], v11 offset:28672
v_mfma_f32_16x16x32_bf16 v[212:215], v[68:71], v[36:39], v[212:215]
ds_read_b64_tr_b16 v[120:121], v11 offset:40960
v_mfma_f32_16x16x32_bf16 v[208:211], v[68:71], v[32:35], v[208:211]
ds_read_b64_tr_b16 v[122:123], v11 offset:45056
v_mfma_f32_16x16x32_bf16 v[160:163], v[56:59], v[32:35], v[160:163]
ds_read_b64_tr_b16 v[108:109], v12 offset:24576
v_mfma_f32_16x16x32_bf16 v[164:167], v[56:59], v[36:39], v[164:167]
ds_read_b64_tr_b16 v[110:111], v12 offset:28672
v_mfma_f32_16x16x32_bf16 v[168:171], v[56:59], v[40:43], v[168:171]
ds_read_b64_tr_b16 v[124:125], v12 offset:40960
v_mfma_f32_16x16x32_bf16 v[172:175], v[56:59], v[44:47], v[172:175]
ds_read_b64_tr_b16 v[126:127], v12 offset:45056
v_mfma_f32_16x16x32_bf16 v[236:239], v[72:75], v[44:47], v[236:239]
v_mfma_f32_16x16x32_bf16 v[232:235], v[72:75], v[40:43], v[232:235]
v_mfma_f32_16x16x32_bf16 v[228:231], v[72:75], v[36:39], v[228:231]
v_mfma_f32_16x16x32_bf16 v[224:227], v[72:75], v[32:35], v[224:227]
v_mfma_f32_16x16x32_bf16 v[176:179], v[60:63], v[32:35], v[176:179]
v_mfma_f32_16x16x32_bf16 v[180:183], v[60:63], v[36:39], v[180:183]
v_mfma_f32_16x16x32_bf16 v[184:187], v[60:63], v[40:43], v[184:187]
v_mfma_f32_16x16x32_bf16 v[188:191], v[60:63], v[44:47], v[188:191]
v_mfma_f32_16x16x32_bf16 v[252:255], v[76:79], v[44:47], v[252:255]
v_mfma_f32_16x16x32_bf16 v[248:251], v[76:79], v[40:43], v[248:251]
v_mfma_f32_16x16x32_bf16 v[244:247], v[76:79], v[36:39], v[244:247]
v_mfma_f32_16x16x32_bf16 v[240:243], v[76:79], v[32:35], v[240:243]
s_waitcnt lgkmcnt(0)
s_barrier
v_mfma_f32_16x16x32_bf16 v[128:131], v[96:99], v[80:83], v[128:131]
ds_read_b128 v[32:35], v4 offset:0
v_mfma_f32_16x16x32_bf16 v[132:135], v[96:99], v[84:87], v[132:135]
ds_read_b64_tr_b16 v[48:49], v13 offset:16384
v_mfma_f32_16x16x32_bf16 v[136:139], v[96:99], v[88:91], v[136:139]
ds_read_b64_tr_b16 v[50:51], v13 offset:20480
v_mfma_f32_16x16x32_bf16 v[140:143], v[96:99], v[92:95], v[140:143]
ds_read_b128 v[36:39], v4 offset:256
v_mfma_f32_16x16x32_bf16 v[204:207], v[112:115], v[92:95], v[204:207]
ds_read_b128 v[40:43], v4 offset:512
v_mfma_f32_16x16x32_bf16 v[200:203], v[112:115], v[88:91], v[200:203]
ds_read_b128 v[44:47], v4 offset:768
v_mfma_f32_16x16x32_bf16 v[196:199], v[112:115], v[84:87], v[196:199]
ds_read_b64_tr_b16 v[64:65], v13 offset:32768
v_mfma_f32_16x16x32_bf16 v[192:195], v[112:115], v[80:83], v[192:195]
ds_read_b64_tr_b16 v[66:67], v13 offset:36864
v_mfma_f32_16x16x32_bf16 v[144:147], v[100:103], v[80:83], v[144:147]
ds_read_b64_tr_b16 v[52:53], v14 offset:16384
v_mfma_f32_16x16x32_bf16 v[148:151], v[100:103], v[84:87], v[148:151]
ds_read_b64_tr_b16 v[54:55], v14 offset:20480
v_mfma_f32_16x16x32_bf16 v[152:155], v[100:103], v[88:91], v[152:155]
ds_read_b64_tr_b16 v[68:69], v14 offset:32768
v_mfma_f32_16x16x32_bf16 v[156:159], v[100:103], v[92:95], v[156:159]
ds_read_b64_tr_b16 v[70:71], v14 offset:36864
v_mfma_f32_16x16x32_bf16 v[220:223], v[116:119], v[92:95], v[220:223]
ds_read_b64_tr_b16 v[56:57], v15 offset:16384
v_mfma_f32_16x16x32_bf16 v[216:219], v[116:119], v[88:91], v[216:219]
ds_read_b64_tr_b16 v[58:59], v15 offset:20480
v_mfma_f32_16x16x32_bf16 v[212:215], v[116:119], v[84:87], v[212:215]
ds_read_b64_tr_b16 v[72:73], v15 offset:32768
v_mfma_f32_16x16x32_bf16 v[208:211], v[116:119], v[80:83], v[208:211]
ds_read_b64_tr_b16 v[74:75], v15 offset:36864
v_mfma_f32_16x16x32_bf16 v[160:163], v[104:107], v[80:83], v[160:163]
ds_read_b64_tr_b16 v[60:61], v16 offset:16384
v_mfma_f32_16x16x32_bf16 v[164:167], v[104:107], v[84:87], v[164:167]
ds_read_b64_tr_b16 v[62:63], v16 offset:20480
v_mfma_f32_16x16x32_bf16 v[168:171], v[104:107], v[88:91], v[168:171]
ds_read_b64_tr_b16 v[76:77], v16 offset:32768
v_mfma_f32_16x16x32_bf16 v[172:175], v[104:107], v[92:95], v[172:175]
ds_read_b64_tr_b16 v[78:79], v16 offset:36864
v_mfma_f32_16x16x32_bf16 v[236:239], v[120:123], v[92:95], v[236:239]
v_mfma_f32_16x16x32_bf16 v[232:235], v[120:123], v[88:91], v[232:235]
v_mfma_f32_16x16x32_bf16 v[228:231], v[120:123], v[84:87], v[228:231]
v_mfma_f32_16x16x32_bf16 v[224:227], v[120:123], v[80:83], v[224:227]
v_mfma_f32_16x16x32_bf16 v[176:179], v[108:111], v[80:83], v[176:179]
v_mfma_f32_16x16x32_bf16 v[180:183], v[108:111], v[84:87], v[180:183]
v_mfma_f32_16x16x32_bf16 v[184:187], v[108:111], v[88:91], v[184:187]
v_mfma_f32_16x16x32_bf16 v[188:191], v[108:111], v[92:95], v[188:191]
v_mfma_f32_16x16x32_bf16 v[252:255], v[124:127], v[92:95], v[252:255]
v_mfma_f32_16x16x32_bf16 v[248:251], v[124:127], v[88:91], v[248:251]
v_mfma_f32_16x16x32_bf16 v[244:247], v[124:127], v[84:87], v[244:247]
v_mfma_f32_16x16x32_bf16 v[240:243], v[124:127], v[80:83], v[240:243]
s_waitcnt lgkmcnt(0)
v_mfma_f32_16x16x32_bf16 v[128:131], v[48:51], v[32:35], v[128:131]
ds_read_b128 v[80:83], v4 offset:8192
v_mfma_f32_16x16x32_bf16 v[132:135], v[48:51], v[36:39], v[132:135]
ds_read_b64_tr_b16 v[96:97], v13 offset:24576
v_mfma_f32_16x16x32_bf16 v[136:139], v[48:51], v[40:43], v[136:139]
ds_read_b64_tr_b16 v[98:99], v13 offset:28672
v_mfma_f32_16x16x32_bf16 v[140:143], v[48:51], v[44:47], v[140:143]
ds_read_b128 v[84:87], v4 offset:8448
v_mfma_f32_16x16x32_bf16 v[204:207], v[64:67], v[44:47], v[204:207]
ds_read_b128 v[88:91], v4 offset:8704
v_mfma_f32_16x16x32_bf16 v[200:203], v[64:67], v[40:43], v[200:203]
ds_read_b128 v[92:95], v4 offset:8960
v_mfma_f32_16x16x32_bf16 v[196:199], v[64:67], v[36:39], v[196:199]
ds_read_b64_tr_b16 v[112:113], v13 offset:40960
v_mfma_f32_16x16x32_bf16 v[192:195], v[64:67], v[32:35], v[192:195]
ds_read_b64_tr_b16 v[114:115], v13 offset:45056
v_mfma_f32_16x16x32_bf16 v[144:147], v[52:55], v[32:35], v[144:147]
ds_read_b64_tr_b16 v[100:101], v14 offset:24576
v_mfma_f32_16x16x32_bf16 v[148:151], v[52:55], v[36:39], v[148:151]
ds_read_b64_tr_b16 v[102:103], v14 offset:28672
v_mfma_f32_16x16x32_bf16 v[152:155], v[52:55], v[40:43], v[152:155]
ds_read_b64_tr_b16 v[116:117], v14 offset:40960
v_mfma_f32_16x16x32_bf16 v[156:159], v[52:55], v[44:47], v[156:159]
ds_read_b64_tr_b16 v[118:119], v14 offset:45056
v_mfma_f32_16x16x32_bf16 v[220:223], v[68:71], v[44:47], v[220:223]
ds_read_b64_tr_b16 v[104:105], v15 offset:24576
v_mfma_f32_16x16x32_bf16 v[216:219], v[68:71], v[40:43], v[216:219]
ds_read_b64_tr_b16 v[106:107], v15 offset:28672
v_mfma_f32_16x16x32_bf16 v[212:215], v[68:71], v[36:39], v[212:215]
ds_read_b64_tr_b16 v[120:121], v15 offset:40960
v_mfma_f32_16x16x32_bf16 v[208:211], v[68:71], v[32:35], v[208:211]
ds_read_b64_tr_b16 v[122:123], v15 offset:45056
v_mfma_f32_16x16x32_bf16 v[160:163], v[56:59], v[32:35], v[160:163]
ds_read_b64_tr_b16 v[108:109], v16 offset:24576
v_mfma_f32_16x16x32_bf16 v[164:167], v[56:59], v[36:39], v[164:167]
ds_read_b64_tr_b16 v[110:111], v16 offset:28672
v_mfma_f32_16x16x32_bf16 v[168:171], v[56:59], v[40:43], v[168:171]
ds_read_b64_tr_b16 v[124:125], v16 offset:40960
v_mfma_f32_16x16x32_bf16 v[172:175], v[56:59], v[44:47], v[172:175]
ds_read_b64_tr_b16 v[126:127], v16 offset:45056
v_mfma_f32_16x16x32_bf16 v[236:239], v[72:75], v[44:47], v[236:239]
v_mfma_f32_16x16x32_bf16 v[232:235], v[72:75], v[40:43], v[232:235]
v_mfma_f32_16x16x32_bf16 v[228:231], v[72:75], v[36:39], v[228:231]
v_mfma_f32_16x16x32_bf16 v[224:227], v[72:75], v[32:35], v[224:227]
v_mfma_f32_16x16x32_bf16 v[176:179], v[60:63], v[32:35], v[176:179]
v_mfma_f32_16x16x32_bf16 v[180:183], v[60:63], v[36:39], v[180:183]
v_mfma_f32_16x16x32_bf16 v[184:187], v[60:63], v[40:43], v[184:187]
v_mfma_f32_16x16x32_bf16 v[188:191], v[60:63], v[44:47], v[188:191]
v_mfma_f32_16x16x32_bf16 v[252:255], v[76:79], v[44:47], v[252:255]
v_mfma_f32_16x16x32_bf16 v[248:251], v[76:79], v[40:43], v[248:251]
v_mfma_f32_16x16x32_bf16 v[244:247], v[76:79], v[36:39], v[244:247]
v_mfma_f32_16x16x32_bf16 v[240:243], v[76:79], v[32:35], v[240:243]
s_waitcnt lgkmcnt(0)
s_barrier
s_cmp_eq_u32 s36, 3
s_cbranch_scc1 L3h_28
s_add_u32 s42, s42, 1
s_and_b32 s42, s42, 15
s_add_u32 m0, s39, 98304
s_mul_i32 s37, s42, s40
buffer_load_dwordx4 v22, s[8:11], s37 offen sc1 lds
v_mfma_f32_16x16x32_bf16 v[128:131], v[96:99], v[80:83], v[128:131]
v_mfma_f32_16x16x32_bf16 v[132:135], v[96:99], v[84:87], v[132:135]
s_add_u32 m0, s39, 99328
s_add_u32 s37, s37, s38
buffer_load_dwordx4 v23, s[8:11], s37 offen sc1 lds
v_mfma_f32_16x16x32_bf16 v[136:139], v[96:99], v[88:91], v[136:139]
v_mfma_f32_16x16x32_bf16 v[140:143], v[96:99], v[92:95], v[140:143]
s_add_u32 m0, s39, 100352
s_add_u32 s37, s37, s38
buffer_load_dwordx4 v22, s[8:11], s37 offen sc1 lds
v_mfma_f32_16x16x32_bf16 v[204:207], v[112:115], v[92:95], v[204:207]
v_mfma_f32_16x16x32_bf16 v[200:203], v[112:115], v[88:91], v[200:203]
s_add_u32 m0, s39, 101376
s_add_u32 s37, s37, s38
buffer_load_dwordx4 v23, s[8:11], s37 offen sc1 lds
v_mfma_f32_16x16x32_bf16 v[196:199], v[112:115], v[84:87], v[196:199]
v_mfma_f32_16x16x32_bf16 v[192:195], v[112:115], v[80:83], v[192:195]
s_add_u32 m0, s39, 102400
s_add_u32 s37, s37, s38
buffer_load_dwordx4 v22, s[8:11], s37 offen sc1 lds
v_mfma_f32_16x16x32_bf16 v[144:147], v[100:103], v[80:83], v[144:147]
v_mfma_f32_16x16x32_bf16 v[148:151], v[100:103], v[84:87], v[148:151]
s_add_u32 m0, s39, 103424
s_add_u32 s37, s37, s38
buffer_load_dwordx4 v23, s[8:11], s37 offen sc1 lds
v_mfma_f32_16x16x32_bf16 v[152:155], v[100:103], v[88:91], v[152:155]
v_mfma_f32_16x16x32_bf16 v[156:159], v[100:103], v[92:95], v[156:159]
s_add_u32 m0, s39, 104448
s_add_u32 s37, s37, s38
buffer_load_dwordx4 v22, s[8:11], s37 offen sc1 lds
v_mfma_f32_16x16x32_bf16 v[220:223], v[116:119], v[92:95], v[220:223]
v_mfma_f32_16x16x32_bf16 v[216:219], v[116:119], v[88:91], v[216:219]
s_add_u32 m0, s39, 105472
s_add_u32 s37, s37, s38
buffer_load_dwordx4 v23, s[8:11], s37 offen sc1 lds
v_mfma_f32_16x16x32_bf16 v[212:215], v[116:119], v[84:87], v[212:215]
v_mfma_f32_16x16x32_bf16 v[208:211], v[116:119], v[80:83], v[208:211]
s_add_u32 m0, s39, 106496
s_add_u32 s37, s37, s38
buffer_load_dwordx4 v22, s[8:11], s37 offen sc1 lds
v_mfma_f32_16x16x32_bf16 v[160:163], v[104:107], v[80:83], v[160:163]
v_mfma_f32_16x16x32_bf16 v[164:167], v[104:107], v[84:87], v[164:167]
s_add_u32 m0, s39, 107520
s_add_u32 s37, s37, s38
buffer_load_dwordx4 v23, s[8:11], s37 offen sc1 lds
v_mfma_f32_16x16x32_bf16 v[168:171], v[104:107], v[88:91], v[168:171]
v_mfma_f32_16x16x32_bf16 v[172:175], v[104:107], v[92:95], v[172:175]
s_add_u32 m0, s39, 108544
s_add_u32 s37, s37, s38
buffer_load_dwordx4 v22, s[8:11], s37 offen sc1 lds
v_mfma_f32_16x16x32_bf16 v[236:239], v[120:123], v[92:95], v[236:239]
v_mfma_f32_16x16x32_bf16 v[232:235], v[120:123], v[88:91], v[232:235]
s_add_u32 m0, s39, 109568
s_add_u32 s37, s37, s38
buffer_load_dwordx4 v23, s[8:11], s37 offen sc1 lds
v_mfma_f32_16x16x32_bf16 v[228:231], v[120:123], v[84:87], v[228:231]
v_mfma_f32_16x16x32_bf16 v[224:227], v[120:123], v[80:83], v[224:227]
s_add_u32 m0, s39, 110592
s_add_u32 s37, s37, s38
buffer_load_dwordx4 v22, s[8:11], s37 offen sc1 lds
v_mfma_f32_16x16x32_bf16 v[176:179], v[108:111], v[80:83], v[176:179]
v_mfma_f32_16x16x32_bf16 v[180:183], v[108:111], v[84:87], v[180:183]
s_add_u32 m0, s39, 111616
s_add_u32 s37, s37, s38
buffer_load_dwordx4 v23, s[8:11], s37 offen sc1 lds
v_mfma_f32_16x16x32_bf16 v[184:187], v[108:111], v[88:91], v[184:187]
v_mfma_f32_16x16x32_bf16 v[188:191], v[108:111], v[92:95], v[188:191]
s_add_u32 m0, s39, 112640
s_add_u32 s37, s37, s38
buffer_load_dwordx4 v22, s[8:11], s37 offen sc1 lds
v_mfma_f32_16x16x32_bf16 v[252:255], v[124:127], v[92:95], v[252:255]
v_mfma_f32_16x16x32_bf16 v[248:251], v[124:127], v[88:91], v[248:251]
s_add_u32 m0, s39, 113664
s_add_u32 s37, s37, s38
buffer_load_dwordx4 v23, s[8:11], s37 offen sc1 lds
v_mfma_f32_16x16x32_bf16 v[244:247], v[124:127], v[84:87], v[244:247]
v_mfma_f32_16x16x32_bf16 v[240:243], v[124:127], v[80:83], v[240:243]
s_setprio 0
s_lshl_b32 s43, s46, 9
s_add_u32 s43, s43, 147456
v_lshl_add_u32 v19, v17, 3, s43
ds_read_b64 v[80:81], v19 offset:0
ds_read_b64 v[82:83], v19 offset:128
ds_read_b64 v[84:85], v19 offset:256
ds_read_b64 v[86:87], v19 offset:384
s_mul_i32 s43, s47, 256
s_add_u32 s43, s43, 148480
v_lshl_add_u32 v19, v18, 4, s43
ds_read_b128 v[48:51], v19 offset:0
ds_read_b128 v[52:55], v19 offset:64
ds_read_b128 v[56:59], v19 offset:128
ds_read_b128 v[60:63], v19 offset:192
ds_read_b128 v[64:67], v19 offset:896
ds_read_b128 v[68:71], v19 offset:960
ds_read_b128 v[72:75], v19 offset:1024
ds_read_b128 v[76:79], v19 offset:1088
s_waitcnt lgkmcnt(0)
v_mov_b32 v32, v80
v_mul_f32 v88, v81, v81
v_mul_f32 v36, 0xc0135761, v81
v_mul_f32 v89, 0xbdd2d3e8, v81
v_rcp_f32 v44, v88
v_mul_f32 v40, v89, v88
v_mov_b32 v33, v82
v_mul_f32 v88, v83, v83
v_mul_f32 v37, 0xc0135761, v83
v_mul_f32 v89, 0xbdd2d3e8, v83
v_rcp_f32 v45, v88
v_mul_f32 v41, v89, v88
v_mov_b32 v34, v84
v_mul_f32 v88, v85, v85
v_mul_f32 v38, 0xc0135761, v85
v_mul_f32 v89, 0xbdd2d3e8, v85
v_rcp_f32 v46, v88
v_mul_f32 v42, v89, v88
v_mov_b32 v35, v86
v_mul_f32 v88, v87, v87
v_mul_f32 v39, 0xc0135761, v87
v_mul_f32 v89, 0xbdd2d3e8, v87
v_rcp_f32 v47, v88
v_mul_f32 v43, v89, v88
s_barrier
s_add_u32 s42, s42, 1
s_and_b32 s42, s42, 15
s_add_u32 m0, s39, 0
s_mul_i32 s37, s42, s40
buffer_load_dwordx4 v22, s[8:11], s37 offen sc1 lds
v_fma_f32 v128, -v32, v48, v128
v_fma_f32 v129, -v32, v49, v129
v_fma_f32 v130, -v32, v50, v130
v_fma_f32 v131, -v32, v51, v131
s_add_u32 m0, s39, 1024
s_add_u32 s37, s37, s38
buffer_load_dwordx4 v23, s[8:11], s37 offen sc1 lds
v_fma_f32 v192, -v32, v64, v192
v_fma_f32 v193, -v32, v65, v193
v_fma_f32 v194, -v32, v66, v194
s_add_u32 m0, s39, 2048
s_add_u32 s37, s37, s38
buffer_load_dwordx4 v22, s[8:11], s37 offen sc1 lds
v_fma_f32 v195, -v32, v67, v195
v_mul_f32 v80, v128, v128
v_mul_f32 v81, v129, v129
s_add_u32 m0, s39, 3072
s_add_u32 s37, s37, s38
buffer_load_dwordx4 v23, s[8:11], s37 offen sc1 lds
v_mul_f32 v82, v130, v130
v_mul_f32 v83, v131, v131
v_fma_f32 v80, v80, v40, v36
s_add_u32 m0, s39, 4096
s_add_u32 s37, s37, s38
buffer_load_dwordx4 v22, s[8:11], s37 offen sc1 lds
v_fma_f32 v81, v81, v40, v36
v_fma_f32 v82, v82, v40, v36
v_fma_f32 v83, v83, v40, v36
v_mul_f32 v80, v80, v128
s_add_u32 m0, s39, 5120
s_add_u32 s37, s37, s38
buffer_load_dwordx4 v23, s[8:11], s37 offen sc1 lds
v_mul_f32 v81, v81, v129
v_mul_f32 v82, v82, v130
v_mul_f32 v83, v83, v131
s_add_u32 m0, s39, 6144
s_add_u32 s37, s37, s38
buffer_load_dwordx4 v22, s[8:11], s37 offen sc1 lds
v_exp_f32 v80, v80
v_exp_f32 v81, v81
v_exp_f32 v82, v82
s_add_u32 m0, s39, 7168
s_add_u32 s37, s37, s38
buffer_load_dwordx4 v23, s[8:11], s37 offen sc1 lds
v_exp_f32 v83, v83
v_mul_f32 v192, v128, v192
v_mul_f32 v193, v129, v193
s_add_u32 m0, s39, 8192
s_add_u32 s37, s37, s38
buffer_load_dwordx4 v22, s[8:11], s37 offen sc1 lds
v_mul_f32 v194, v130, v194
v_mul_f32 v195, v131, v195
v_fma_f32 v80, v80, v44, v44
v_fma_f32 v81, v81, v44, v44
s_add_u32 m0, s39, 9216
s_add_u32 s37, s37, s38
buffer_load_dwordx4 v23, s[8:11], s37 offen sc1 lds
v_fma_f32 v82, v82, v44, v44
v_fma_f32 v83, v83, v44, v44
v_rcp_f32 v80, v80
s_add_u32 m0, s39, 10240
s_add_u32 s37, s37, s38
buffer_load_dwordx4 v22, s[8:11], s37 offen sc1 lds
v_rcp_f32 v81, v81
v_rcp_f32 v82, v82
v_rcp_f32 v83, v83
s_add_u32 m0, s39, 11264
s_add_u32 s37, s37, s38
buffer_load_dwordx4 v23, s[8:11], s37 offen sc1 lds
v_mul_f32 v192, v192, v80
v_mul_f32 v193, v193, v81
v_mul_f32 v194, v194, v82
s_add_u32 m0, s39, 12288
s_add_u32 s37, s37, s38
buffer_load_dwordx4 v22, s[8:11], s37 offen sc1 lds
v_mul_f32 v195, v195, v83
v_cvt_pk_bf16_f32 v96, v192, v193
v_cvt_pk_bf16_f32 v97, v194, v195
v_fma_f32 v144, -v32, v52, v144
s_add_u32 m0, s39, 13312
s_add_u32 s37, s37, s38
buffer_load_dwordx4 v23, s[8:11], s37 offen sc1 lds
v_fma_f32 v145, -v32, v53, v145
v_fma_f32 v146, -v32, v54, v146
v_fma_f32 v147, -v32, v55, v147
s_add_u32 m0, s39, 14336
s_add_u32 s37, s37, s38
buffer_load_dwordx4 v22, s[8:11], s37 offen sc1 lds
v_fma_f32 v208, -v32, v68, v208
v_fma_f32 v209, -v32, v69, v209
v_fma_f32 v210, -v32, v70, v210
s_add_u32 m0, s39, 15360
s_add_u32 s37, s37, s38
buffer_load_dwordx4 v23, s[8:11], s37 offen sc1 lds
v_fma_f32 v211, -v32, v71, v211
v_mul_f32 v84, v144, v144
v_mul_f32 v85, v145, v145
s_waitcnt vmcnt(16)
s_barrier
s_add_u32 s42, s42, 1
s_and_b32 s42, s42, 15
s_add_u32 m0, s39, 49152
s_mul_i32 s37, s42, s40
buffer_load_dwordx4 v22, s[8:11], s37 offen sc1 lds
v_mul_f32 v86, v146, v146
v_mul_f32 v87, v147, v147
v_fma_f32 v84, v84, v40, v36
v_fma_f32 v85, v85, v40, v36
v_fma_f32 v86, v86, v40, v36
s_add_u32 m0, s39, 50176
s_add_u32 s37, s37, s38
buffer_load_dwordx4 v23, s[8:11], s37 offen sc1 lds
v_fma_f32 v87, v87, v40, v36
v_mul_f32 v84, v84, v144
v_mul_f32 v85, v85, v145
v_mul_f32 v86, v86, v146
v_mul_f32 v87, v87, v147
s_add_u32 m0, s39, 51200
s_add_u32 s37, s37, s38
buffer_load_dwordx4 v22, s[8:11], s37 offen sc1 lds
v_exp_f32 v84, v84
v_exp_f32 v85, v85
v_exp_f32 v86, v86
v_exp_f32 v87, v87
s_add_u32 m0, s39, 52224
s_add_u32 s37, s37, s38
buffer_load_dwordx4 v23, s[8:11], s37 offen sc1 lds
v_mul_f32 v208, v144, v208
v_mul_f32 v209, v145, v209
v_mul_f32 v210, v146, v210
v_mul_f32 v211, v147, v211
v_fma_f32 v84, v84, v44, v44
s_add_u32 m0, s39, 53248
s_add_u32 s37, s37, s38
buffer_load_dwordx4 v22, s[8:11], s37 offen sc1 lds
v_fma_f32 v85, v85, v44, v44
v_fma_f32 v86, v86, v44, v44
v_fma_f32 v87, v87, v44, v44
v_rcp_f32 v84, v84
v_rcp_f32 v85, v85
s_add_u32 m0, s39, 54272
s_add_u32 s37, s37, s38
buffer_load_dwordx4 v23, s[8:11], s37 offen sc1 lds
v_rcp_f32 v86, v86
v_rcp_f32 v87, v87
v_mul_f32 v208, v208, v84
v_mul_f32 v209, v209, v85
s_add_u32 m0, s39, 55296
s_add_u32 s37, s37, s38
buffer_load_dwordx4 v22, s[8:11], s37 offen sc1 lds
v_mul_f32 v210, v210, v86
v_mul_f32 v211, v211, v87
v_cvt_pk_bf16_f32 v98, v208, v209
v_cvt_pk_bf16_f32 v99, v210, v211
s_add_u32 m0, s39, 56320
s_add_u32 s37, s37, s38
buffer_load_dwordx4 v23, s[8:11], s37 offen sc1 lds
v_fma_f32 v132, -v33, v48, v132
v_fma_f32 v133, -v33, v49, v133
v_fma_f32 v134, -v33, v50, v134
v_fma_f32 v135, -v33, v51, v135
s_add_u32 m0, s39, 57344
s_add_u32 s37, s37, s38
buffer_load_dwordx4 v22, s[8:11], s37 offen sc1 lds
v_fma_f32 v196, -v33, v64, v196
v_fma_f32 v197, -v33, v65, v197
v_fma_f32 v198, -v33, v66, v198
v_fma_f32 v199, -v33, v67, v199
v_mul_f32 v80, v132, v132
s_add_u32 m0, s39, 58368
s_add_u32 s37, s37, s38
buffer_load_dwordx4 v23, s[8:11], s37 offen sc1 lds
v_mul_f32 v81, v133, v133
v_mul_f32 v82, v134, v134
v_mul_f32 v83, v135, v135
v_fma_f32 v80, v80, v41, v37
v_fma_f32 v81, v81, v41, v37
s_add_u32 m0, s39, 59392
s_add_u32 s37, s37, s38
buffer_load_dwordx4 v22, s[8:11], s37 offen sc1 lds
v_fma_f32 v82, v82, v41, v37
v_fma_f32 v83, v83, v41, v37
v_mul_f32 v80, v80, v132
v_mul_f32 v81, v81, v133
s_add_u32 m0, s39, 60416
s_add_u32 s37, s37, s38
buffer_load_dwordx4 v23, s[8:11], s37 offen sc1 lds
v_mul_f32 v82, v82, v134
v_lshlrev_b32 v19, 11, v18
v_lshl_add_u32 v19, v17, 4, v19
s_lshl_b32 s43, s46, 10
v_add_u32 v2, s43, v19
s_add_u32 m0, s39, 61440
s_add_u32 s37, s37, s38
buffer_load_dwordx4 v22, s[8:11], s37 offen sc1 lds
v_add_u32 v3, 0x10000, v2
v_lshrrev_b32 v19, 2, v17
v_lshl_add_u32 v20, v18, 2, v19
v_bfe_u32 v21, v20, 1, 2
s_lshl_b32 s43, s47, 1
s_add_u32 m0, s39, 62464
s_add_u32 s37, s37, s38
buffer_load_dwordx4 v23, s[8:11], s37 offen sc1 lds
v_xor_b32 v21, s43, v21
v_lshlrev_b32 v20, 7, v20
v_lshl_add_u32 v20, v21, 5, v20
v_and_b32 v19, 3, v1
s_add_u32 m0, s39, 63488
s_add_u32 s37, s37, s38
buffer_load_dwordx4 v22, s[8:11], s37 offen sc1 lds
v_lshl_add_u32 v20, v19, 3, v20
v_add_u32 v5, 16384, v20
v_xor_b32 v6, 32, v5
v_add_u32 v7, 0x10000, v5
v_add_u32 v8, 0x10000, v6
s_add_u32 m0, s39, 64512
s_add_u32 s37, s37, s38
buffer_load_dwordx4 v23, s[8:11], s37 offen sc1 lds
s_lshl_b32 s43, s36, 13
v_lshl_add_u32 v9, v1, 4, s43
s_mov_b32 s54, 0x10000
s_movk_i32 s52, 0x1000
buffer_store_dwordx4 v[96:99], v27, s[24:27], 0 offen offset:0 sc1
s_waitcnt vmcnt(17)
s_barrier
s_add_u32 s42, s42, 1
s_and_b32 s42, s42, 15
s_add_u32 m0, s39, 98304
s_mul_i32 s37, s42, s40
buffer_load_dwordx4 v22, s[8:11], s37 offen sc1 lds
v_mul_f32 v83, v83, v135
v_exp_f32 v80, v80
v_exp_f32 v81, v81
v_exp_f32 v82, v82
s_add_u32 m0, s39, 99328
s_add_u32 s37, s37, s38
buffer_load_dwordx4 v23, s[8:11], s37 offen sc1 lds
v_exp_f32 v83, v83
v_mul_f32 v196, v132, v196
v_mul_f32 v197, v133, v197
s_add_u32 m0, s39, 100352
s_add_u32 s37, s37, s38
buffer_load_dwordx4 v22, s[8:11], s37 offen sc1 lds
v_mul_f32 v198, v134, v198
v_mul_f32 v199, v135, v199
v_fma_f32 v80, v80, v45, v45
s_add_u32 m0, s39, 101376
s_add_u32 s37, s37, s38
buffer_load_dwordx4 v23, s[8:11], s37 offen sc1 lds
v_fma_f32 v81, v81, v45, v45
v_fma_f32 v82, v82, v45, v45
v_fma_f32 v83, v83, v45, v45
s_add_u32 m0, s39, 102400
s_add_u32 s37, s37, s38
buffer_load_dwordx4 v22, s[8:11], s37 offen sc1 lds
v_rcp_f32 v80, v80
v_rcp_f32 v81, v81
v_rcp_f32 v82, v82
v_rcp_f32 v83, v83
s_add_u32 m0, s39, 103424
s_add_u32 s37, s37, s38
buffer_load_dwordx4 v23, s[8:11], s37 offen sc1 lds
v_mul_f32 v196, v196, v80
v_mul_f32 v197, v197, v81
v_mul_f32 v198, v198, v82
s_add_u32 m0, s39, 104448
s_add_u32 s37, s37, s38
buffer_load_dwordx4 v22, s[8:11], s37 offen sc1 lds
v_mul_f32 v199, v199, v83
v_cvt_pk_bf16_f32 v100, v196, v197
v_cvt_pk_bf16_f32 v101, v198, v199
s_add_u32 m0, s39, 105472
s_add_u32 s37, s37, s38
buffer_load_dwordx4 v23, s[8:11], s37 offen sc1 lds
v_fma_f32 v148, -v33, v52, v148
v_fma_f32 v149, -v33, v53, v149
v_fma_f32 v150, -v33, v54, v150
s_add_u32 m0, s39, 106496
s_add_u32 s37, s37, s38
buffer_load_dwordx4 v22, s[8:11], s37 offen sc1 lds
v_fma_f32 v151, -v33, v55, v151
v_fma_f32 v212, -v33, v68, v212
v_fma_f32 v213, -v33, v69, v213
v_fma_f32 v214, -v33, v70, v214
s_add_u32 m0, s39, 107520
s_add_u32 s37, s37, s38
buffer_load_dwordx4 v23, s[8:11], s37 offen sc1 lds
v_fma_f32 v215, -v33, v71, v215
v_mul_f32 v84, v148, v148
v_mul_f32 v85, v149, v149
s_add_u32 m0, s39, 108544
s_add_u32 s37, s37, s38
buffer_load_dwordx4 v22, s[8:11], s37 offen sc1 lds
v_mul_f32 v86, v150, v150
v_mul_f32 v87, v151, v151
v_fma_f32 v84, v84, v41, v37
s_add_u32 m0, s39, 109568
s_add_u32 s37, s37, s38
buffer_load_dwordx4 v23, s[8:11], s37 offen sc1 lds
v_fma_f32 v85, v85, v41, v37
v_fma_f32 v86, v86, v41, v37
v_fma_f32 v87, v87, v41, v37
s_add_u32 m0, s39, 110592
s_add_u32 s37, s37, s38
buffer_load_dwordx4 v22, s[8:11], s37 offen sc1 lds
v_mul_f32 v84, v84, v148
v_mul_f32 v85, v85, v149
v_mul_f32 v86, v86, v150
v_mul_f32 v87, v87, v151
s_add_u32 m0, s39, 111616
s_add_u32 s37, s37, s38
buffer_load_dwordx4 v23, s[8:11], s37 offen sc1 lds
v_exp_f32 v84, v84
v_exp_f32 v85, v85
v_exp_f32 v86, v86
s_add_u32 m0, s39, 112640
s_add_u32 s37, s37, s38
buffer_load_dwordx4 v22, s[8:11], s37 offen sc1 lds
v_exp_f32 v87, v87
v_mul_f32 v212, v148, v212
v_mul_f32 v213, v149, v213
s_add_u32 m0, s39, 113664
s_add_u32 s37, s37, s38
buffer_load_dwordx4 v23, s[8:11], s37 offen sc1 lds
v_mul_f32 v214, v150, v214
v_mul_f32 v215, v151, v215
v_fma_f32 v84, v84, v45, v45
s_waitcnt vmcnt(17)
s_barrier
s_add_u32 s42, s42, 1
s_and_b32 s42, s42, 15
s_add_u32 m0, s39, 0
s_mul_i32 s37, s42, s40
buffer_load_dwordx4 v22, s[8:11], s37 offen sc1 lds
v_fma_f32 v85, v85, v45, v45
v_fma_f32 v86, v86, v45, v45
v_fma_f32 v87, v87, v45, v45
v_rcp_f32 v84, v84
s_add_u32 m0, s39, 1024
s_add_u32 s37, s37, s38
buffer_load_dwordx4 v23, s[8:11], s37 offen sc1 lds
v_rcp_f32 v85, v85
v_rcp_f32 v86, v86
v_rcp_f32 v87, v87
s_add_u32 m0, s39, 2048
s_add_u32 s37, s37, s38
buffer_load_dwordx4 v22, s[8:11], s37 offen sc1 lds
v_mul_f32 v212, v212, v84
v_mul_f32 v213, v213, v85
v_mul_f32 v214, v214, v86
s_add_u32 m0, s39, 3072
s_add_u32 s37, s37, s38
buffer_load_dwordx4 v23, s[8:11], s37 offen sc1 lds
v_mul_f32 v215, v215, v87
v_cvt_pk_bf16_f32 v102, v212, v213
v_cvt_pk_bf16_f32 v103, v214, v215
s_add_u32 m0, s39, 4096
s_add_u32 s37, s37, s38
buffer_load_dwordx4 v22, s[8:11], s37 offen sc1 lds
v_fma_f32 v136, -v34, v48, v136
v_fma_f32 v137, -v34, v49, v137
v_fma_f32 v138, -v34, v50, v138
s_add_u32 m0, s39, 5120
s_add_u32 s37, s37, s38
buffer_load_dwordx4 v23, s[8:11], s37 offen sc1 lds
v_fma_f32 v139, -v34, v51, v139
v_fma_f32 v200, -v34, v64, v200
v_fma_f32 v201, -v34, v65, v201
s_add_u32 m0, s39, 6144
s_add_u32 s37, s37, s38
buffer_load_dwordx4 v22, s[8:11], s37 offen sc1 lds
v_fma_f32 v202, -v34, v66, v202
v_fma_f32 v203, -v34, v67, v203
v_mul_f32 v80, v136, v136
v_mul_f32 v81, v137, v137
s_add_u32 m0, s39, 7168
s_add_u32 s37, s37, s38
buffer_load_dwordx4 v23, s[8:11], s37 offen sc1 lds
v_mul_f32 v82, v138, v138
v_mul_f32 v83, v139, v139
v_fma_f32 v80, v80, v42, v38
s_add_u32 m0, s39, 8192
s_add_u32 s37, s37, s38
buffer_load_dwordx4 v22, s[8:11], s37 offen sc1 lds
v_fma_f32 v81, v81, v42, v38
v_fma_f32 v82, v82, v42, v38
v_fma_f32 v83, v83, v42, v38
s_add_u32 m0, s39, 9216
s_add_u32 s37, s37, s38
buffer_load_dwordx4 v23, s[8:11], s37 offen sc1 lds
v_mul_f32 v80, v80, v136
v_mul_f32 v81, v81, v137
v_mul_f32 v82, v82, v138
v_mul_f32 v83, v83, v139
s_add_u32 m0, s39, 10240
s_add_u32 s37, s37, s38
buffer_load_dwordx4 v22, s[8:11], s37 offen sc1 lds
v_exp_f32 v80, v80
v_exp_f32 v81, v81
v_exp_f32 v82, v82
s_add_u32 m0, s39, 11264
s_add_u32 s37, s37, s38
buffer_load_dwordx4 v23, s[8:11], s37 offen sc1 lds
v_exp_f32 v83, v83
v_mul_f32 v200, v136, v200
v_mul_f32 v201, v137, v201
s_add_u32 m0, s39, 12288
s_add_u32 s37, s37, s38
buffer_load_dwordx4 v22, s[8:11], s37 offen sc1 lds
v_mul_f32 v202, v138, v202
v_mul_f32 v203, v139, v203
v_fma_f32 v80, v80, v46, v46
v_fma_f32 v81, v81, v46, v46
s_add_u32 m0, s39, 13312
s_add_u32 s37, s37, s38
buffer_load_dwordx4 v23, s[8:11], s37 offen sc1 lds
v_fma_f32 v82, v82, v46, v46
v_fma_f32 v83, v83, v46, v46
v_rcp_f32 v80, v80
s_add_u32 m0, s39, 14336
s_add_u32 s37, s37, s38
buffer_load_dwordx4 v22, s[8:11], s37 offen sc1 lds
v_rcp_f32 v81, v81
v_rcp_f32 v82, v82
v_rcp_f32 v83, v83
s_add_u32 m0, s39, 15360
s_add_u32 s37, s37, s38
buffer_load_dwordx4 v23, s[8:11], s37 offen sc1 lds
v_mul_f32 v200, v200, v80
v_mul_f32 v201, v201, v81
v_mul_f32 v202, v202, v82
buffer_store_dwordx4 v[100:103], v27, s[24:27], 0 offen offset:256 sc1
s_waitcnt vmcnt(17)
s_barrier
s_add_u32 s42, s42, 1
s_and_b32 s42, s42, 15
s_add_u32 m0, s39, 49152
s_mul_i32 s37, s42, s40
buffer_load_dwordx4 v22, s[8:11], s37 offen sc1 lds
v_mul_f32 v203, v203, v83
v_cvt_pk_bf16_f32 v104, v200, v201
v_cvt_pk_bf16_f32 v105, v202, v203
v_fma_f32 v152, -v34, v52, v152
s_add_u32 m0, s39, 50176
s_add_u32 s37, s37, s38
buffer_load_dwordx4 v23, s[8:11], s37 offen sc1 lds
v_fma_f32 v153, -v34, v53, v153
v_fma_f32 v154, -v34, v54, v154
v_fma_f32 v155, -v34, v55, v155
s_add_u32 m0, s39, 51200
s_add_u32 s37, s37, s38
buffer_load_dwordx4 v22, s[8:11], s37 offen sc1 lds
v_fma_f32 v216, -v34, v68, v216
v_fma_f32 v217, -v34, v69, v217
v_fma_f32 v218, -v34, v70, v218
s_add_u32 m0, s39, 52224
s_add_u32 s37, s37, s38
buffer_load_dwordx4 v23, s[8:11], s37 offen sc1 lds
v_fma_f32 v219, -v34, v71, v219
v_mul_f32 v84, v152, v152
v_mul_f32 v85, v153, v153
s_add_u32 m0, s39, 53248
s_add_u32 s37, s37, s38
buffer_load_dwordx4 v22, s[8:11], s37 offen sc1 lds
v_mul_f32 v86, v154, v154
v_mul_f32 v87, v155, v155
v_fma_f32 v84, v84, v42, v38
v_fma_f32 v85, v85, v42, v38
s_add_u32 m0, s39, 54272
s_add_u32 s37, s37, s38
buffer_load_dwordx4 v23, s[8:11], s37 offen sc1 lds
v_fma_f32 v86, v86, v42, v38
v_fma_f32 v87, v87, v42, v38
v_mul_f32 v84, v84, v152
s_add_u32 m0, s39, 55296
s_add_u32 s37, s37, s38
buffer_load_dwordx4 v22, s[8:11], s37 offen sc1 lds
v_mul_f32 v85, v85, v153
v_mul_f32 v86, v86, v154
v_mul_f32 v87, v87, v155
s_add_u32 m0, s39, 56320
s_add_u32 s37, s37, s38
buffer_load_dwordx4 v23, s[8:11], s37 offen sc1 lds
v_exp_f32 v84, v84
v_exp_f32 v85, v85
v_exp_f32 v86, v86
s_add_u32 m0, s39, 57344
s_add_u32 s37, s37, s38
buffer_load_dwordx4 v22, s[8:11], s37 offen sc1 lds
v_exp_f32 v87, v87
v_mul_f32 v216, v152, v216
v_mul_f32 v217, v153, v217
v_mul_f32 v218, v154, v218
s_add_u32 m0, s39, 58368
s_add_u32 s37, s37, s38
buffer_load_dwordx4 v23, s[8:11], s37 offen sc1 lds
v_mul_f32 v219, v155, v219
v_fma_f32 v84, v84, v46, v46
v_fma_f32 v85, v85, v46, v46
s_add_u32 m0, s39, 59392
s_add_u32 s37, s37, s38
buffer_load_dwordx4 v22, s[8:11], s37 offen sc1 lds
v_fma_f32 v86, v86, v46, v46
v_fma_f32 v87, v87, v46, v46
v_rcp_f32 v84, v84
s_add_u32 m0, s39, 60416
s_add_u32 s37, s37, s38
buffer_load_dwordx4 v23, s[8:11], s37 offen sc1 lds
v_rcp_f32 v85, v85
v_rcp_f32 v86, v86
v_rcp_f32 v87, v87
s_add_u32 m0, s39, 61440
s_add_u32 s37, s37, s38
buffer_load_dwordx4 v22, s[8:11], s37 offen sc1 lds
v_mul_f32 v216, v216, v84
v_mul_f32 v217, v217, v85
v_mul_f32 v218, v218, v86
v_mul_f32 v219, v219, v87
s_add_u32 m0, s39, 62464
s_add_u32 s37, s37, s38
buffer_load_dwordx4 v23, s[8:11], s37 offen sc1 lds
v_cvt_pk_bf16_f32 v106, v216, v217
v_cvt_pk_bf16_f32 v107, v218, v219
s_add_u32 m0, s39, 63488
s_add_u32 s37, s37, s38
buffer_load_dwordx4 v22, s[8:11], s37 offen sc1 lds
v_fma_f32 v140, -v35, v48, v140
v_fma_f32 v141, -v35, v49, v141
v_fma_f32 v142, -v35, v50, v142
s_add_u32 m0, s39, 64512
s_add_u32 s37, s37, s38
buffer_load_dwordx4 v23, s[8:11], s37 offen sc1 lds
v_fma_f32 v143, -v35, v51, v143
v_fma_f32 v204, -v35, v64, v204
v_fma_f32 v205, -v35, v65, v205
buffer_store_dwordx4 v[104:107], v27, s[24:27], 0 offen offset:512 sc1
s_waitcnt vmcnt(18)
s_barrier
s_add_u32 s42, s42, 1
s_and_b32 s42, s42, 15
s_add_u32 m0, s39, 98304
s_mul_i32 s37, s42, s40
buffer_load_dwordx4 v22, s[8:11], s37 offen sc1 lds
v_fma_f32 v206, -v35, v66, v206
v_fma_f32 v207, -v35, v67, v207
v_mul_f32 v80, v140, v140
v_mul_f32 v81, v141, v141
s_add_u32 m0, s39, 99328
s_add_u32 s37, s37, s38
buffer_load_dwordx4 v23, s[8:11], s37 offen sc1 lds
v_mul_f32 v82, v142, v142
v_mul_f32 v83, v143, v143
v_fma_f32 v80, v80, v43, v39
s_add_u32 m0, s39, 100352
s_add_u32 s37, s37, s38
buffer_load_dwordx4 v22, s[8:11], s37 offen sc1 lds
v_fma_f32 v81, v81, v43, v39
v_fma_f32 v82, v82, v43, v39
v_fma_f32 v83, v83, v43, v39
s_add_u32 m0, s39, 101376
s_add_u32 s37, s37, s38
buffer_load_dwordx4 v23, s[8:11], s37 offen sc1 lds
v_mul_f32 v80, v80, v140
v_mul_f32 v81, v81, v141
v_mul_f32 v82, v82, v142
s_add_u32 m0, s39, 102400
s_add_u32 s37, s37, s38
buffer_load_dwordx4 v22, s[8:11], s37 offen sc1 lds
v_mul_f32 v83, v83, v143
v_exp_f32 v80, v80
v_exp_f32 v81, v81
v_exp_f32 v82, v82
s_add_u32 m0, s39, 103424
s_add_u32 s37, s37, s38
buffer_load_dwordx4 v23, s[8:11], s37 offen sc1 lds
v_exp_f32 v83, v83
v_mul_f32 v204, v140, v204
v_mul_f32 v205, v141, v205
s_add_u32 m0, s39, 104448
s_add_u32 s37, s37, s38
buffer_load_dwordx4 v22, s[8:11], s37 offen sc1 lds
v_mul_f32 v206, v142, v206
v_mul_f32 v207, v143, v207
v_fma_f32 v80, v80, v47, v47
s_add_u32 m0, s39, 105472
s_add_u32 s37, s37, s38
buffer_load_dwordx4 v23, s[8:11], s37 offen sc1 lds
v_fma_f32 v81, v81, v47, v47
v_fma_f32 v82, v82, v47, v47
v_fma_f32 v83, v83, v47, v47
s_add_u32 m0, s39, 106496
s_add_u32 s37, s37, s38
buffer_load_dwordx4 v22, s[8:11], s37 offen sc1 lds
v_rcp_f32 v80, v80
v_rcp_f32 v81, v81
v_rcp_f32 v82, v82
v_rcp_f32 v83, v83
s_add_u32 m0, s39, 107520
s_add_u32 s37, s37, s38
buffer_load_dwordx4 v23, s[8:11], s37 offen sc1 lds
v_mul_f32 v204, v204, v80
v_mul_f32 v205, v205, v81
v_mul_f32 v206, v206, v82
s_add_u32 m0, s39, 108544
s_add_u32 s37, s37, s38
buffer_load_dwordx4 v22, s[8:11], s37 offen sc1 lds
v_mul_f32 v207, v207, v83
v_cvt_pk_bf16_f32 v108, v204, v205
v_cvt_pk_bf16_f32 v109, v206, v207
s_add_u32 m0, s39, 109568
s_add_u32 s37, s37, s38
buffer_load_dwordx4 v23, s[8:11], s37 offen sc1 lds
v_fma_f32 v156, -v35, v52, v156
v_fma_f32 v157, -v35, v53, v157
v_fma_f32 v158, -v35, v54, v158
s_add_u32 m0, s39, 110592
s_add_u32 s37, s37, s38
buffer_load_dwordx4 v22, s[8:11], s37 offen sc1 lds
v_fma_f32 v159, -v35, v55, v159
v_fma_f32 v220, -v35, v68, v220
v_fma_f32 v221, -v35, v69, v221
v_fma_f32 v222, -v35, v70, v222
s_add_u32 m0, s39, 111616
s_add_u32 s37, s37, s38
buffer_load_dwordx4 v23, s[8:11], s37 offen sc1 lds
v_fma_f32 v223, -v35, v71, v223
v_mul_f32 v84, v156, v156
v_mul_f32 v85, v157, v157
s_add_u32 m0, s39, 112640
s_add_u32 s37, s37, s38
buffer_load_dwordx4 v22, s[8:11], s37 offen sc1 lds
v_mul_f32 v86, v158, v158
v_mul_f32 v87, v159, v159
v_fma_f32 v84, v84, v43, v39
s_add_u32 m0, s39, 113664
s_add_u32 s37, s37, s38
buffer_load_dwordx4 v23, s[8:11], s37 offen sc1 lds
v_fma_f32 v85, v85, v43, v39
v_fma_f32 v86, v86, v43, v39
v_fma_f32 v87, v87, v43, v39
s_waitcnt vmcnt(17)
s_barrier
s_add_u32 s42, s42, 1
s_and_b32 s42, s42, 15
s_add_u32 m0, s39, 0
s_mul_i32 s37, s42, s40
buffer_load_dwordx4 v22, s[8:11], s37 offen sc1 lds
v_mul_f32 v84, v84, v156
v_mul_f32 v85, v85, v157
v_mul_f32 v86, v86, v158
v_mul_f32 v87, v87, v159
s_add_u32 m0, s39, 1024
s_add_u32 s37, s37, s38
buffer_load_dwordx4 v23, s[8:11], s37 offen sc1 lds
v_exp_f32 v84, v84
v_exp_f32 v85, v85
v_exp_f32 v86, v86
s_add_u32 m0, s39, 2048
s_add_u32 s37, s37, s38
buffer_load_dwordx4 v22, s[8:11], s37 offen sc1 lds
v_exp_f32 v87, v87
v_mul_f32 v220, v156, v220
v_mul_f32 v221, v157, v221
s_add_u32 m0, s39, 3072
s_add_u32 s37, s37, s38
buffer_load_dwordx4 v23, s[8:11], s37 offen sc1 lds
v_mul_f32 v222, v158, v222
v_mul_f32 v223, v159, v223
v_fma_f32 v84, v84, v47, v47
v_fma_f32 v85, v85, v47, v47
s_add_u32 m0, s39, 4096
s_add_u32 s37, s37, s38
buffer_load_dwordx4 v22, s[8:11], s37 offen sc1 lds
v_fma_f32 v86, v86, v47, v47
v_fma_f32 v87, v87, v47, v47
v_rcp_f32 v84, v84
s_add_u32 m0, s39, 5120
s_add_u32 s37, s37, s38
buffer_load_dwordx4 v23, s[8:11], s37 offen sc1 lds
v_rcp_f32 v85, v85
v_rcp_f32 v86, v86
v_rcp_f32 v87, v87
s_add_u32 m0, s39, 6144
s_add_u32 s37, s37, s38
buffer_load_dwordx4 v22, s[8:11], s37 offen sc1 lds
v_mul_f32 v220, v220, v84
v_mul_f32 v221, v221, v85
v_mul_f32 v222, v222, v86
v_mul_f32 v223, v223, v87
s_add_u32 m0, s39, 7168
s_add_u32 s37, s37, s38
buffer_load_dwordx4 v23, s[8:11], s37 offen sc1 lds
v_cvt_pk_bf16_f32 v110, v220, v221
v_cvt_pk_bf16_f32 v111, v222, v223
s_add_u32 m0, s39, 8192
s_add_u32 s37, s37, s38
buffer_load_dwordx4 v22, s[8:11], s37 offen sc1 lds
v_fma_f32 v160, -v32, v56, v160
v_fma_f32 v161, -v32, v57, v161
v_fma_f32 v162, -v32, v58, v162
s_add_u32 m0, s39, 9216
s_add_u32 s37, s37, s38
buffer_load_dwordx4 v23, s[8:11], s37 offen sc1 lds
v_fma_f32 v163, -v32, v59, v163
v_fma_f32 v224, -v32, v72, v224
v_fma_f32 v225, -v32, v73, v225
v_fma_f32 v226, -v32, v74, v226
s_add_u32 m0, s39, 10240
s_add_u32 s37, s37, s38
buffer_load_dwordx4 v22, s[8:11], s37 offen sc1 lds
v_fma_f32 v227, -v32, v75, v227
v_mul_f32 v80, v160, v160
v_mul_f32 v81, v161, v161
s_add_u32 m0, s39, 11264
s_add_u32 s37, s37, s38
buffer_load_dwordx4 v23, s[8:11], s37 offen sc1 lds
v_mul_f32 v82, v162, v162
v_mul_f32 v83, v163, v163
v_fma_f32 v80, v80, v40, v36
s_add_u32 m0, s39, 12288
s_add_u32 s37, s37, s38
buffer_load_dwordx4 v22, s[8:11], s37 offen sc1 lds
v_fma_f32 v81, v81, v40, v36
v_fma_f32 v82, v82, v40, v36
v_fma_f32 v83, v83, v40, v36
v_mul_f32 v80, v80, v160
s_add_u32 m0, s39, 13312
s_add_u32 s37, s37, s38
buffer_load_dwordx4 v23, s[8:11], s37 offen sc1 lds
v_mul_f32 v81, v81, v161
v_mul_f32 v82, v82, v162
v_mul_f32 v83, v83, v163
s_add_u32 m0, s39, 14336
s_add_u32 s37, s37, s38
buffer_load_dwordx4 v22, s[8:11], s37 offen sc1 lds
v_exp_f32 v80, v80
v_exp_f32 v81, v81
v_exp_f32 v82, v82
s_add_u32 m0, s39, 15360
s_add_u32 s37, s37, s38
buffer_load_dwordx4 v23, s[8:11], s37 offen sc1 lds
v_exp_f32 v83, v83
v_mul_f32 v224, v160, v224
v_mul_f32 v225, v161, v225
buffer_store_dwordx4 v[108:111], v27, s[24:27], 0 offen offset:768 sc1
s_waitcnt vmcnt(17)
s_barrier
s_add_u32 s42, s42, 1
s_and_b32 s42, s42, 15
s_add_u32 m0, s39, 49152
s_mul_i32 s37, s42, s40
buffer_load_dwordx4 v22, s[8:11], s37 offen sc1 lds
v_mul_f32 v226, v162, v226
v_mul_f32 v227, v163, v227
v_fma_f32 v80, v80, v44, v44
v_fma_f32 v81, v81, v44, v44
s_add_u32 m0, s39, 50176
s_add_u32 s37, s37, s38
buffer_load_dwordx4 v23, s[8:11], s37 offen sc1 lds
v_fma_f32 v82, v82, v44, v44
v_fma_f32 v83, v83, v44, v44
v_rcp_f32 v80, v80
v_rcp_f32 v81, v81
s_add_u32 m0, s39, 51200
s_add_u32 s37, s37, s38
buffer_load_dwordx4 v22, s[8:11], s37 offen sc1 lds
v_rcp_f32 v82, v82
v_rcp_f32 v83, v83
v_mul_f32 v224, v224, v80
v_mul_f32 v225, v225, v81
s_add_u32 m0, s39, 52224
s_add_u32 s37, s37, s38
buffer_load_dwordx4 v23, s[8:11], s37 offen sc1 lds
v_mul_f32 v226, v226, v82
v_mul_f32 v227, v227, v83
v_cvt_pk_bf16_f32 v96, v224, v225
v_cvt_pk_bf16_f32 v97, v226, v227
s_add_u32 m0, s39, 53248
s_add_u32 s37, s37, s38
buffer_load_dwordx4 v22, s[8:11], s37 offen sc1 lds
v_fma_f32 v176, -v32, v60, v176
v_fma_f32 v177, -v32, v61, v177
v_fma_f32 v178, -v32, v62, v178
v_fma_f32 v179, -v32, v63, v179
s_add_u32 m0, s39, 54272
s_add_u32 s37, s37, s38
buffer_load_dwordx4 v23, s[8:11], s37 offen sc1 lds
v_fma_f32 v240, -v32, v76, v240
v_fma_f32 v241, -v32, v77, v241
v_fma_f32 v242, -v32, v78, v242
v_fma_f32 v243, -v32, v79, v243
s_add_u32 m0, s39, 55296
s_add_u32 s37, s37, s38
buffer_load_dwordx4 v22, s[8:11], s37 offen sc1 lds
v_mul_f32 v84, v176, v176
v_mul_f32 v85, v177, v177
v_mul_f32 v86, v178, v178
v_mul_f32 v87, v179, v179
s_add_u32 m0, s39, 56320
s_add_u32 s37, s37, s38
buffer_load_dwordx4 v23, s[8:11], s37 offen sc1 lds
v_fma_f32 v84, v84, v40, v36
v_fma_f32 v85, v85, v40, v36
v_fma_f32 v86, v86, v40, v36
s_add_u32 m0, s39, 57344
s_add_u32 s37, s37, s38
buffer_load_dwordx4 v22, s[8:11], s37 offen sc1 lds
v_fma_f32 v87, v87, v40, v36
v_mul_f32 v84, v84, v176
v_mul_f32 v85, v85, v177
v_mul_f32 v86, v86, v178
s_add_u32 m0, s39, 58368
s_add_u32 s37, s37, s38
buffer_load_dwordx4 v23, s[8:11], s37 offen sc1 lds
v_mul_f32 v87, v87, v179
v_exp_f32 v84, v84
v_exp_f32 v85, v85
v_exp_f32 v86, v86
s_add_u32 m0, s39, 59392
s_add_u32 s37, s37, s38
buffer_load_dwordx4 v22, s[8:11], s37 offen sc1 lds
v_exp_f32 v87, v87
v_mul_f32 v240, v176, v240
v_mul_f32 v241, v177, v241
v_mul_f32 v242, v178, v242
s_add_u32 m0, s39, 60416
s_add_u32 s37, s37, s38
buffer_load_dwordx4 v23, s[8:11], s37 offen sc1 lds
v_mul_f32 v243, v179, v243
v_fma_f32 v84, v84, v44, v44
v_fma_f32 v85, v85, v44, v44
v_fma_f32 v86, v86, v44, v44
s_add_u32 m0, s39, 61440
s_add_u32 s37, s37, s38
buffer_load_dwordx4 v22, s[8:11], s37 offen sc1 lds
v_fma_f32 v87, v87, v44, v44
v_rcp_f32 v84, v84
v_rcp_f32 v85, v85
v_rcp_f32 v86, v86
s_add_u32 m0, s39, 62464
s_add_u32 s37, s37, s38
buffer_load_dwordx4 v23, s[8:11], s37 offen sc1 lds
v_rcp_f32 v87, v87
v_lshlrev_b32 v19, 11, v18
v_lshl_add_u32 v19, v17, 4, v19
s_lshl_b32 s43, s46, 10
s_add_u32 m0, s39, 63488
s_add_u32 s37, s37, s38
buffer_load_dwordx4 v22, s[8:11], s37 offen sc1 lds
s_lshl_b32 s44, s47, 13
v_add3_u32 v208, v19, s43, 0
v_add_u32 v208, s44, v208
buffer_load_dwordx4 v[192:195], v208, s[20:23], 0 offen offset:0 sc1
s_add_u32 m0, s39, 64512
s_add_u32 s37, s37, s38
buffer_load_dwordx4 v23, s[8:11], s37 offen sc1 lds
buffer_load_dwordx4 v[196:199], v208, s[20:23], 0 offen offset:256 sc1
buffer_load_dwordx4 v[200:203], v208, s[20:23], 0 offen offset:512 sc1
buffer_load_dwordx4 v[204:207], v208, s[20:23], 0 offen offset:768 sc1
s_waitcnt vmcnt(20)
s_barrier
s_add_u32 s42, s42, 1
s_and_b32 s42, s42, 15
s_add_u32 m0, s39, 98304
s_mul_i32 s37, s42, s40
buffer_load_dwordx4 v22, s[8:11], s37 offen sc1 lds
v_mul_f32 v240, v240, v84
v_mul_f32 v241, v241, v85
v_mul_f32 v242, v242, v86
v_mul_f32 v243, v243, v87
s_add_u32 m0, s39, 99328
s_add_u32 s37, s37, s38
buffer_load_dwordx4 v23, s[8:11], s37 offen sc1 lds
v_cvt_pk_bf16_f32 v98, v240, v241
v_cvt_pk_bf16_f32 v99, v242, v243
s_add_u32 m0, s39, 100352
s_add_u32 s37, s37, s38
buffer_load_dwordx4 v22, s[8:11], s37 offen sc1 lds
v_fma_f32 v164, -v33, v56, v164
v_fma_f32 v165, -v33, v57, v165
v_fma_f32 v166, -v33, v58, v166
s_add_u32 m0, s39, 101376
s_add_u32 s37, s37, s38
buffer_load_dwordx4 v23, s[8:11], s37 offen sc1 lds
v_fma_f32 v167, -v33, v59, v167
v_fma_f32 v228, -v33, v72, v228
v_fma_f32 v229, -v33, v73, v229
s_add_u32 m0, s39, 102400
s_add_u32 s37, s37, s38
buffer_load_dwordx4 v22, s[8:11], s37 offen sc1 lds
v_fma_f32 v230, -v33, v74, v230
v_fma_f32 v231, -v33, v75, v231
v_mul_f32 v80, v164, v164
v_mul_f32 v81, v165, v165
s_add_u32 m0, s39, 103424
s_add_u32 s37, s37, s38
buffer_load_dwordx4 v23, s[8:11], s37 offen sc1 lds
v_mul_f32 v82, v166, v166
v_mul_f32 v83, v167, v167
v_fma_f32 v80, v80, v41, v37
s_add_u32 m0, s39, 104448
s_add_u32 s37, s37, s38
buffer_load_dwordx4 v22, s[8:11], s37 offen sc1 lds
v_fma_f32 v81, v81, v41, v37
v_fma_f32 v82, v82, v41, v37
v_fma_f32 v83, v83, v41, v37
s_add_u32 m0, s39, 105472
s_add_u32 s37, s37, s38
buffer_load_dwordx4 v23, s[8:11], s37 offen sc1 lds
v_mul_f32 v80, v80, v164
v_mul_f32 v81, v81, v165
v_mul_f32 v82, v82, v166
s_add_u32 m0, s39, 106496
s_add_u32 s37, s37, s38
buffer_load_dwordx4 v22, s[8:11], s37 offen sc1 lds
v_mul_f32 v83, v83, v167
v_exp_f32 v80, v80
v_exp_f32 v81, v81
v_exp_f32 v82, v82
s_add_u32 m0, s39, 107520
s_add_u32 s37, s37, s38
buffer_load_dwordx4 v23, s[8:11], s37 offen sc1 lds
v_exp_f32 v83, v83
v_mul_f32 v228, v164, v228
v_mul_f32 v229, v165, v229
s_add_u32 m0, s39, 108544
s_add_u32 s37, s37, s38
buffer_load_dwordx4 v22, s[8:11], s37 offen sc1 lds
v_mul_f32 v230, v166, v230
v_mul_f32 v231, v167, v231
v_fma_f32 v80, v80, v45, v45
s_add_u32 m0, s39, 109568
s_add_u32 s37, s37, s38
buffer_load_dwordx4 v23, s[8:11], s37 offen sc1 lds
v_fma_f32 v81, v81, v45, v45
v_fma_f32 v82, v82, v45, v45
v_fma_f32 v83, v83, v45, v45
s_add_u32 m0, s39, 110592
s_add_u32 s37, s37, s38
buffer_load_dwordx4 v22, s[8:11], s37 offen sc1 lds
v_rcp_f32 v80, v80
v_rcp_f32 v81, v81
v_rcp_f32 v82, v82
v_rcp_f32 v83, v83
s_add_u32 m0, s39, 111616
s_add_u32 s37, s37, s38
buffer_load_dwordx4 v23, s[8:11], s37 offen sc1 lds
v_mul_f32 v228, v228, v80
v_mul_f32 v229, v229, v81
v_mul_f32 v230, v230, v82
s_add_u32 m0, s39, 112640
s_add_u32 s37, s37, s38
buffer_load_dwordx4 v22, s[8:11], s37 offen sc1 lds
v_mul_f32 v231, v231, v83
v_cvt_pk_bf16_f32 v100, v228, v229
v_cvt_pk_bf16_f32 v101, v230, v231
s_add_u32 m0, s39, 113664
s_add_u32 s37, s37, s38
buffer_load_dwordx4 v23, s[8:11], s37 offen sc1 lds
v_fma_f32 v180, -v33, v60, v180
v_fma_f32 v181, -v33, v61, v181
v_fma_f32 v182, -v33, v62, v182
buffer_store_dwordx4 v[96:99], v27, s[24:27], s53 offen offset:0 sc1
s_waitcnt vmcnt(20)
s_barrier
s_add_u32 s42, s42, 1
s_and_b32 s42, s42, 15
s_add_u32 m0, s39, 0
s_mul_i32 s37, s42, s40
buffer_load_dwordx4 v22, s[8:11], s37 offen sc1 lds
v_fma_f32 v183, -v33, v63, v183
v_fma_f32 v244, -v33, v76, v244
v_fma_f32 v245, -v33, v77, v245
v_fma_f32 v246, -v33, v78, v246
s_add_u32 m0, s39, 1024
s_add_u32 s37, s37, s38
buffer_load_dwordx4 v23, s[8:11], s37 offen sc1 lds
v_fma_f32 v247, -v33, v79, v247
v_mul_f32 v84, v180, v180
v_mul_f32 v85, v181, v181
s_add_u32 m0, s39, 2048
s_add_u32 s37, s37, s38
buffer_load_dwordx4 v22, s[8:11], s37 offen sc1 lds
v_mul_f32 v86, v182, v182
v_mul_f32 v87, v183, v183
v_fma_f32 v84, v84, v41, v37
s_add_u32 m0, s39, 3072
s_add_u32 s37, s37, s38
buffer_load_dwordx4 v23, s[8:11], s37 offen sc1 lds
v_fma_f32 v85, v85, v41, v37
v_fma_f32 v86, v86, v41, v37
v_fma_f32 v87, v87, v41, v37
v_mul_f32 v84, v84, v180
s_add_u32 m0, s39, 4096
s_add_u32 s37, s37, s38
buffer_load_dwordx4 v22, s[8:11], s37 offen sc1 lds
v_mul_f32 v85, v85, v181
v_mul_f32 v86, v86, v182
v_mul_f32 v87, v87, v183
s_add_u32 m0, s39, 5120
s_add_u32 s37, s37, s38
buffer_load_dwordx4 v23, s[8:11], s37 offen sc1 lds
v_exp_f32 v84, v84
v_exp_f32 v85, v85
v_exp_f32 v86, v86
s_add_u32 m0, s39, 6144
s_add_u32 s37, s37, s38
buffer_load_dwordx4 v22, s[8:11], s37 offen sc1 lds
v_exp_f32 v87, v87
v_mul_f32 v244, v180, v244
v_mul_f32 v245, v181, v245
v_mul_f32 v246, v182, v246
s_add_u32 m0, s39, 7168
s_add_u32 s37, s37, s38
buffer_load_dwordx4 v23, s[8:11], s37 offen sc1 lds
v_mul_f32 v247, v183, v247
v_fma_f32 v84, v84, v45, v45
v_fma_f32 v85, v85, v45, v45
s_add_u32 m0, s39, 8192
s_add_u32 s37, s37, s38
buffer_load_dwordx4 v22, s[8:11], s37 offen sc1 lds
v_fma_f32 v86, v86, v45, v45
v_fma_f32 v87, v87, v45, v45
v_rcp_f32 v84, v84
s_add_u32 m0, s39, 9216
s_add_u32 s37, s37, s38
buffer_load_dwordx4 v23, s[8:11], s37 offen sc1 lds
v_rcp_f32 v85, v85
v_rcp_f32 v86, v86
v_rcp_f32 v87, v87
v_mul_f32 v244, v244, v84
s_add_u32 m0, s39, 10240
s_add_u32 s37, s37, s38
buffer_load_dwordx4 v22, s[8:11], s37 offen sc1 lds
v_mul_f32 v245, v245, v85
v_mul_f32 v246, v246, v86
v_mul_f32 v247, v247, v87
s_add_u32 m0, s39, 11264
s_add_u32 s37, s37, s38
buffer_load_dwordx4 v23, s[8:11], s37 offen sc1 lds
v_cvt_pk_bf16_f32 v102, v244, v245
v_cvt_pk_bf16_f32 v103, v246, v247
s_add_u32 m0, s39, 12288
s_add_u32 s37, s37, s38
buffer_load_dwordx4 v22, s[8:11], s37 offen sc1 lds
v_fma_f32 v168, -v34, v56, v168
v_fma_f32 v169, -v34, v57, v169
v_fma_f32 v170, -v34, v58, v170
v_fma_f32 v171, -v34, v59, v171
s_add_u32 m0, s39, 13312
s_add_u32 s37, s37, s38
buffer_load_dwordx4 v23, s[8:11], s37 offen sc1 lds
v_fma_f32 v232, -v34, v72, v232
v_fma_f32 v233, -v34, v73, v233
v_fma_f32 v234, -v34, v74, v234
s_add_u32 m0, s39, 14336
s_add_u32 s37, s37, s38
buffer_load_dwordx4 v22, s[8:11], s37 offen sc1 lds
v_fma_f32 v235, -v34, v75, v235
v_mul_f32 v80, v168, v168
v_mul_f32 v81, v169, v169
s_add_u32 m0, s39, 15360
s_add_u32 s37, s37, s38
buffer_load_dwordx4 v23, s[8:11], s37 offen sc1 lds
v_mul_f32 v82, v170, v170
v_mul_f32 v83, v171, v171
v_fma_f32 v80, v80, v42, v38
buffer_store_dwordx4 v[100:103], v27, s[24:27], s53 offen offset:256 sc1
s_waitcnt vmcnt(18)
s_barrier
s_add_u32 s42, s42, 1
s_and_b32 s42, s42, 15
s_add_u32 m0, s39, 49152
s_mul_i32 s37, s42, s40
buffer_load_dwordx4 v22, s[8:11], s37 offen sc1 lds
v_fma_f32 v81, v81, v42, v38
v_fma_f32 v82, v82, v42, v38
v_fma_f32 v83, v83, v42, v38
v_mul_f32 v80, v80, v168
s_add_u32 m0, s39, 50176
s_add_u32 s37, s37, s38
buffer_load_dwordx4 v23, s[8:11], s37 offen sc1 lds
v_mul_f32 v81, v81, v169
v_mul_f32 v82, v82, v170
v_mul_f32 v83, v83, v171
s_add_u32 m0, s39, 51200
s_add_u32 s37, s37, s38
buffer_load_dwordx4 v22, s[8:11], s37 offen sc1 lds
v_exp_f32 v80, v80
v_exp_f32 v81, v81
v_exp_f32 v82, v82
s_add_u32 m0, s39, 52224
s_add_u32 s37, s37, s38
buffer_load_dwordx4 v23, s[8:11], s37 offen sc1 lds
v_exp_f32 v83, v83
v_mul_f32 v232, v168, v232
v_mul_f32 v233, v169, v233
s_add_u32 m0, s39, 53248
s_add_u32 s37, s37, s38
buffer_load_dwordx4 v22, s[8:11], s37 offen sc1 lds
v_mul_f32 v234, v170, v234
v_mul_f32 v235, v171, v235
v_fma_f32 v80, v80, v46, v46
v_fma_f32 v81, v81, v46, v46
s_add_u32 m0, s39, 54272
s_add_u32 s37, s37, s38
buffer_load_dwordx4 v23, s[8:11], s37 offen sc1 lds
v_fma_f32 v82, v82, v46, v46
v_fma_f32 v83, v83, v46, v46
v_rcp_f32 v80, v80
s_add_u32 m0, s39, 55296
s_add_u32 s37, s37, s38
buffer_load_dwordx4 v22, s[8:11], s37 offen sc1 lds
v_rcp_f32 v81, v81
v_rcp_f32 v82, v82
v_rcp_f32 v83, v83
s_add_u32 m0, s39, 56320
s_add_u32 s37, s37, s38
buffer_load_dwordx4 v23, s[8:11], s37 offen sc1 lds
v_mul_f32 v232, v232, v80
v_mul_f32 v233, v233, v81
v_mul_f32 v234, v234, v82
s_add_u32 m0, s39, 57344
s_add_u32 s37, s37, s38
buffer_load_dwordx4 v22, s[8:11], s37 offen sc1 lds
v_mul_f32 v235, v235, v83
v_cvt_pk_bf16_f32 v104, v232, v233
v_cvt_pk_bf16_f32 v105, v234, v235
v_fma_f32 v184, -v34, v60, v184
s_add_u32 m0, s39, 58368
s_add_u32 s37, s37, s38
buffer_load_dwordx4 v23, s[8:11], s37 offen sc1 lds
v_fma_f32 v185, -v34, v61, v185
v_fma_f32 v186, -v34, v62, v186
v_fma_f32 v187, -v34, v63, v187
s_add_u32 m0, s39, 59392
s_add_u32 s37, s37, s38
buffer_load_dwordx4 v22, s[8:11], s37 offen sc1 lds
v_fma_f32 v248, -v34, v76, v248
v_fma_f32 v249, -v34, v77, v249
v_fma_f32 v250, -v34, v78, v250
s_add_u32 m0, s39, 60416
s_add_u32 s37, s37, s38
buffer_load_dwordx4 v23, s[8:11], s37 offen sc1 lds
v_fma_f32 v251, -v34, v79, v251
v_mul_f32 v84, v184, v184
v_mul_f32 v85, v185, v185
s_add_u32 m0, s39, 61440
s_add_u32 s37, s37, s38
buffer_load_dwordx4 v22, s[8:11], s37 offen sc1 lds
v_mul_f32 v86, v186, v186
v_mul_f32 v87, v187, v187
v_fma_f32 v84, v84, v42, v38
v_fma_f32 v85, v85, v42, v38
s_add_u32 m0, s39, 62464
s_add_u32 s37, s37, s38
buffer_load_dwordx4 v23, s[8:11], s37 offen sc1 lds
v_fma_f32 v86, v86, v42, v38
v_fma_f32 v87, v87, v42, v38
v_mul_f32 v84, v84, v184
s_add_u32 m0, s39, 63488
s_add_u32 s37, s37, s38
buffer_load_dwordx4 v22, s[8:11], s37 offen sc1 lds
v_mul_f32 v85, v85, v185
v_mul_f32 v86, v86, v186
v_mul_f32 v87, v87, v187
s_add_u32 m0, s39, 64512
s_add_u32 s37, s37, s38
buffer_load_dwordx4 v23, s[8:11], s37 offen sc1 lds
v_exp_f32 v84, v84
v_exp_f32 v85, v85
v_exp_f32 v86, v86
s_waitcnt vmcnt(17)
s_barrier
s_add_u32 s42, s42, 1
s_and_b32 s42, s42, 15
s_add_u32 m0, s39, 98304
s_mul_i32 s37, s42, s40
buffer_load_dwordx4 v22, s[8:11], s37 offen sc1 lds
v_exp_f32 v87, v87
v_mul_f32 v248, v184, v248
v_mul_f32 v249, v185, v249
v_mul_f32 v250, v186, v250
s_add_u32 m0, s39, 99328
s_add_u32 s37, s37, s38
buffer_load_dwordx4 v23, s[8:11], s37 offen sc1 lds
v_mul_f32 v251, v187, v251
v_fma_f32 v84, v84, v46, v46
v_fma_f32 v85, v85, v46, v46
s_add_u32 m0, s39, 100352
s_add_u32 s37, s37, s38
buffer_load_dwordx4 v22, s[8:11], s37 offen sc1 lds
v_fma_f32 v86, v86, v46, v46
v_fma_f32 v87, v87, v46, v46
v_rcp_f32 v84, v84
s_add_u32 m0, s39, 101376
s_add_u32 s37, s37, s38
buffer_load_dwordx4 v23, s[8:11], s37 offen sc1 lds
v_rcp_f32 v85, v85
v_rcp_f32 v86, v86
v_rcp_f32 v87, v87
s_add_u32 m0, s39, 102400
s_add_u32 s37, s37, s38
buffer_load_dwordx4 v22, s[8:11], s37 offen sc1 lds
v_mul_f32 v248, v248, v84
v_mul_f32 v249, v249, v85
v_mul_f32 v250, v250, v86
v_mul_f32 v251, v251, v87
s_add_u32 m0, s39, 103424
s_add_u32 s37, s37, s38
buffer_load_dwordx4 v23, s[8:11], s37 offen sc1 lds
v_cvt_pk_bf16_f32 v106, v248, v249
v_cvt_pk_bf16_f32 v107, v250, v251
s_add_u32 m0, s39, 104448
s_add_u32 s37, s37, s38
buffer_load_dwordx4 v22, s[8:11], s37 offen sc1 lds
v_fma_f32 v172, -v35, v56, v172
v_fma_f32 v173, -v35, v57, v173
v_fma_f32 v174, -v35, v58, v174
s_add_u32 m0, s39, 105472
s_add_u32 s37, s37, s38
buffer_load_dwordx4 v23, s[8:11], s37 offen sc1 lds
v_fma_f32 v175, -v35, v59, v175
v_fma_f32 v236, -v35, v72, v236
v_fma_f32 v237, -v35, v73, v237
s_add_u32 m0, s39, 106496
s_add_u32 s37, s37, s38
buffer_load_dwordx4 v22, s[8:11], s37 offen sc1 lds
v_fma_f32 v238, -v35, v74, v238
v_fma_f32 v239, -v35, v75, v239
v_mul_f32 v80, v172, v172
v_mul_f32 v81, v173, v173
s_add_u32 m0, s39, 107520
s_add_u32 s37, s37, s38
buffer_load_dwordx4 v23, s[8:11], s37 offen sc1 lds
v_mul_f32 v82, v174, v174
v_mul_f32 v83, v175, v175
v_fma_f32 v80, v80, v43, v39
s_add_u32 m0, s39, 108544
s_add_u32 s37, s37, s38
buffer_load_dwordx4 v22, s[8:11], s37 offen sc1 lds
v_fma_f32 v81, v81, v43, v39
v_fma_f32 v82, v82, v43, v39
v_fma_f32 v83, v83, v43, v39
s_add_u32 m0, s39, 109568
s_add_u32 s37, s37, s38
buffer_load_dwordx4 v23, s[8:11], s37 offen sc1 lds
v_mul_f32 v80, v80, v172
v_mul_f32 v81, v81, v173
v_mul_f32 v82, v82, v174
s_add_u32 m0, s39, 110592
s_add_u32 s37, s37, s38
buffer_load_dwordx4 v22, s[8:11], s37 offen sc1 lds
v_mul_f32 v83, v83, v175
v_exp_f32 v80, v80
v_exp_f32 v81, v81
v_exp_f32 v82, v82
s_add_u32 m0, s39, 111616
s_add_u32 s37, s37, s38
buffer_load_dwordx4 v23, s[8:11], s37 offen sc1 lds
v_exp_f32 v83, v83
v_mul_f32 v236, v172, v236
v_mul_f32 v237, v173, v237
s_add_u32 m0, s39, 112640
s_add_u32 s37, s37, s38
buffer_load_dwordx4 v22, s[8:11], s37 offen sc1 lds
v_mul_f32 v238, v174, v238
v_mul_f32 v239, v175, v239
v_fma_f32 v80, v80, v47, v47
s_add_u32 m0, s39, 113664
s_add_u32 s37, s37, s38
buffer_load_dwordx4 v23, s[8:11], s37 offen sc1 lds
v_fma_f32 v81, v81, v47, v47
v_fma_f32 v82, v82, v47, v47
v_fma_f32 v83, v83, v47, v47
buffer_store_dwordx4 v[104:107], v27, s[24:27], s53 offen offset:512 sc1
s_waitcnt vmcnt(17)
s_barrier
s_add_u32 s42, s42, 1
s_and_b32 s42, s42, 15
s_add_u32 m0, s39, 0
s_mul_i32 s37, s42, s40
buffer_load_dwordx4 v22, s[8:11], s37 offen sc1 lds
v_rcp_f32 v80, v80
v_rcp_f32 v81, v81
v_rcp_f32 v82, v82
v_rcp_f32 v83, v83
s_add_u32 m0, s39, 1024
s_add_u32 s37, s37, s38
buffer_load_dwordx4 v23, s[8:11], s37 offen sc1 lds
v_mul_f32 v236, v236, v80
v_mul_f32 v237, v237, v81
v_mul_f32 v238, v238, v82
s_add_u32 m0, s39, 2048
s_add_u32 s37, s37, s38
buffer_load_dwordx4 v22, s[8:11], s37 offen sc1 lds
v_mul_f32 v239, v239, v83
v_cvt_pk_bf16_f32 v108, v236, v237
v_cvt_pk_bf16_f32 v109, v238, v239
s_add_u32 m0, s39, 3072
s_add_u32 s37, s37, s38
buffer_load_dwordx4 v23, s[8:11], s37 offen sc1 lds
v_fma_f32 v188, -v35, v60, v188
v_fma_f32 v189, -v35, v61, v189
v_fma_f32 v190, -v35, v62, v190
v_fma_f32 v191, -v35, v63, v191
s_add_u32 m0, s39, 4096
s_add_u32 s37, s37, s38
buffer_load_dwordx4 v22, s[8:11], s37 offen sc1 lds
v_fma_f32 v252, -v35, v76, v252
v_fma_f32 v253, -v35, v77, v253
v_fma_f32 v254, -v35, v78, v254
s_add_u32 m0, s39, 5120
s_add_u32 s37, s37, s38
buffer_load_dwordx4 v23, s[8:11], s37 offen sc1 lds
v_fma_f32 v255, -v35, v79, v255
v_mul_f32 v84, v188, v188
v_mul_f32 v85, v189, v189
s_add_u32 m0, s39, 6144
s_add_u32 s37, s37, s38
buffer_load_dwordx4 v22, s[8:11], s37 offen sc1 lds
v_mul_f32 v86, v190, v190
v_mul_f32 v87, v191, v191
v_fma_f32 v84, v84, v43, v39
v_fma_f32 v85, v85, v43, v39
s_add_u32 m0, s39, 7168
s_add_u32 s37, s37, s38
buffer_load_dwordx4 v23, s[8:11], s37 offen sc1 lds
v_fma_f32 v86, v86, v43, v39
v_fma_f32 v87, v87, v43, v39
v_mul_f32 v84, v84, v188
s_add_u32 m0, s39, 8192
s_add_u32 s37, s37, s38
buffer_load_dwordx4 v22, s[8:11], s37 offen sc1 lds
v_mul_f32 v85, v85, v189
v_mul_f32 v86, v86, v190
v_mul_f32 v87, v87, v191
s_add_u32 m0, s39, 9216
s_add_u32 s37, s37, s38
buffer_load_dwordx4 v23, s[8:11], s37 offen sc1 lds
v_exp_f32 v84, v84
v_exp_f32 v85, v85
v_exp_f32 v86, v86
v_exp_f32 v87, v87
s_add_u32 m0, s39, 10240
s_add_u32 s37, s37, s38
buffer_load_dwordx4 v22, s[8:11], s37 offen sc1 lds
v_mul_f32 v252, v188, v252
v_mul_f32 v253, v189, v253
v_mul_f32 v254, v190, v254
s_add_u32 m0, s39, 11264
s_add_u32 s37, s37, s38
buffer_load_dwordx4 v23, s[8:11], s37 offen sc1 lds
v_mul_f32 v255, v191, v255
v_fma_f32 v84, v84, v47, v47
v_fma_f32 v85, v85, v47, v47
s_add_u32 m0, s39, 12288
s_add_u32 s37, s37, s38
buffer_load_dwordx4 v22, s[8:11], s37 offen sc1 lds
v_fma_f32 v86, v86, v47, v47
v_fma_f32 v87, v87, v47, v47
v_rcp_f32 v84, v84
v_rcp_f32 v85, v85
s_add_u32 m0, s39, 13312
s_add_u32 s37, s37, s38
buffer_load_dwordx4 v23, s[8:11], s37 offen sc1 lds
v_rcp_f32 v86, v86
v_rcp_f32 v87, v87
v_mul_f32 v252, v252, v84
s_add_u32 m0, s39, 14336
s_add_u32 s37, s37, s38
buffer_load_dwordx4 v22, s[8:11], s37 offen sc1 lds
v_mul_f32 v253, v253, v85
v_mul_f32 v254, v254, v86
v_mul_f32 v255, v255, v87
s_add_u32 m0, s39, 15360
s_add_u32 s37, s37, s38
buffer_load_dwordx4 v23, s[8:11], s37 offen sc1 lds
v_cvt_pk_bf16_f32 v110, v252, v253
v_cvt_pk_bf16_f32 v111, v254, v255
buffer_store_dwordx4 v[108:111], v27, s[24:27], s53 offen offset:768 sc1
s_waitcnt vmcnt(18)
s_barrier
s_mul_i32 s44, s34, 917504
s_lshl_b32 s39, s51, 13
s_add_u32 s44, s44, s39
s_add_u32 s44, s44, 8388608
s_and_b32 s43, s51, 1
s_xor_b32 s43, s43, s35
s_lshl_b32 s43, s43, 7
s_mov_b32 s10, 909312
s_movk_i32 s38, 1024
s_movk_i32 s40, 9216
s_movk_i32 s37, 0x4000
s_cmp_ge_u32 s51, 2
s_cselect_b32 s8, s60, s32
s_cselect_b32 s9, s61, s33
s_cselect_b32 s10, 7338112, s10
s_cselect_b32 s43, s43, s44
s_cselect_b32 s38, 16384, s38
s_cselect_b32 s40, 81920, s40
s_cselect_b32 s55, 81920, s38
s_cselect_b32 s37, 262144, s37
s_cselect_b32 s45, -1, 0
s_add_u32 s8, s8, s43
s_addc_u32 s9, s9, 0
s_mov_b32 s11, 0x20000
s_and_b32 s53, s35, 1
s_mul_i32 s54, s53, 6
s_mul_i32 s54, s54, s37
s_mul_i32 s29, s53, 2
s_add_u32 s29, s29, 6
s_mul_i32 s29, s29, s37
s_and_b32 s43, s45, 4290838528
s_add_u32 s29, s29, s43
s_mul_i32 s37, s37, 0
s_sub_u32 s37, s37, s40
v_lshrrev_b32 v19, 3, v1
v_mul_u32_u24 v19, 1920, v19
v_lshrrev_b32 v20, 4, v1
v_lshlrev_b32 v20, 5, v20
v_and_b32 v19, s45, v19
v_and_b32 v20, s45, v20
v_lshlrev_b32 v21, 4, v1
v_xor_b32 v21, v21, v20
v_add_u32 v21, v21, v19
s_mov_b64 s[72:73], -1
s_add_u32 m0, s39, 65536
s_add_u32 s37, s37, s40
buffer_load_dwordx4 v21, s[8:11], s37 offen sc1 lds
v_lshlrev_b32 v128, 16, v192
v_and_b32 v129, 0xffff0000, v192
v_lshlrev_b32 v130, 16, v193
v_and_b32 v131, 0xffff0000, v193
s_add_u32 m0, s39, 66560
s_add_u32 s37, s37, s38
buffer_load_dwordx4 v21, s[8:11], s37 offen sc1 lds
v_lshlrev_b32 v132, 16, v194
v_and_b32 v133, 0xffff0000, v194
v_lshlrev_b32 v134, 16, v195
v_and_b32 v135, 0xffff0000, v195
s_add_u32 m0, s39, 67584
s_add_u32 s37, s37, s38
buffer_load_dwordx4 v21, s[8:11], s37 offen sc1 lds
v_lshlrev_b32 v136, 16, v196
v_and_b32 v137, 0xffff0000, v196
v_lshlrev_b32 v138, 16, v197
v_and_b32 v139, 0xffff0000, v197
s_add_u32 m0, s39, 68608
s_add_u32 s37, s37, s38
buffer_load_dwordx4 v21, s[8:11], s37 offen sc1 lds
v_lshlrev_b32 v140, 16, v198
v_and_b32 v141, 0xffff0000, v198
v_lshlrev_b32 v142, 16, v199
v_and_b32 v143, 0xffff0000, v199
s_add_u32 m0, s39, 69632
s_add_u32 s37, s37, s55
buffer_load_dwordx4 v21, s[8:11], s37 offen sc1 lds
v_lshlrev_b32 v144, 16, v200
v_and_b32 v145, 0xffff0000, v200
v_lshlrev_b32 v146, 16, v201
v_and_b32 v147, 0xffff0000, v201
s_add_u32 m0, s39, 70656
s_add_u32 s37, s37, s38
buffer_load_dwordx4 v21, s[8:11], s37 offen sc1 lds
v_lshlrev_b32 v148, 16, v202
v_and_b32 v149, 0xffff0000, v202
v_lshlrev_b32 v150, 16, v203
v_and_b32 v151, 0xffff0000, v203
s_add_u32 m0, s39, 71680
s_add_u32 s37, s37, s38
buffer_load_dwordx4 v21, s[8:11], s37 offen sc1 lds
v_lshlrev_b32 v152, 16, v204
v_and_b32 v153, 0xffff0000, v204
v_lshlrev_b32 v154, 16, v205
v_and_b32 v155, 0xffff0000, v205
s_add_u32 m0, s39, 72704
s_add_u32 s37, s37, s38
buffer_load_dwordx4 v21, s[8:11], s37 offen sc1 lds
v_lshlrev_b32 v156, 16, v206
v_and_b32 v157, 0xffff0000, v206
v_lshlrev_b32 v158, 16, v207
v_and_b32 v159, 0xffff0000, v207
s_waitcnt vmcnt(8)
s_barrier
s_add_u32 m0, s39, 98304
s_add_u32 s37, s37, s40
buffer_load_dwordx4 v21, s[8:11], s37 offen sc1 lds
v_mov_b32 v192, 0
v_mov_b32 v193, 0
v_mov_b32 v194, 0
v_mov_b32 v195, 0
s_add_u32 m0, s39, 99328
s_add_u32 s37, s37, s38
buffer_load_dwordx4 v21, s[8:11], s37 offen sc1 lds
v_mov_b32 v196, 0
v_mov_b32 v197, 0
v_mov_b32 v198, 0
v_mov_b32 v199, 0
s_add_u32 m0, s39, 100352
s_add_u32 s37, s37, s38
buffer_load_dwordx4 v21, s[8:11], s37 offen sc1 lds
v_mov_b32 v200, 0
v_mov_b32 v201, 0
v_mov_b32 v202, 0
v_mov_b32 v203, 0
s_add_u32 m0, s39, 101376
s_add_u32 s37, s37, s38
buffer_load_dwordx4 v21, s[8:11], s37 offen sc1 lds
v_mov_b32 v204, 0
v_mov_b32 v205, 0
v_mov_b32 v206, 0
v_mov_b32 v207, 0
s_add_u32 m0, s39, 102400
s_add_u32 s37, s37, s55
buffer_load_dwordx4 v21, s[8:11], s37 offen sc1 lds
v_mov_b32 v208, 0
v_mov_b32 v209, 0
v_mov_b32 v210, 0
v_mov_b32 v211, 0
s_add_u32 m0, s39, 103424
s_add_u32 s37, s37, s38
buffer_load_dwordx4 v21, s[8:11], s37 offen sc1 lds
v_mov_b32 v212, 0
v_mov_b32 v213, 0
v_mov_b32 v214, 0
v_mov_b32 v215, 0
s_add_u32 m0, s39, 104448
s_add_u32 s37, s37, s38
buffer_load_dwordx4 v21, s[8:11], s37 offen sc1 lds
v_mov_b32 v216, 0
v_mov_b32 v217, 0
v_mov_b32 v218, 0
v_mov_b32 v219, 0
s_add_u32 m0, s39, 105472
s_add_u32 s37, s37, s38
buffer_load_dwordx4 v21, s[8:11], s37 offen sc1 lds
v_mov_b32 v220, 0
v_mov_b32 v221, 0
v_mov_b32 v222, 0
v_mov_b32 v223, 0
s_waitcnt vmcnt(8)
s_barrier
s_branch LK4_29
L3h_28:
v_mfma_f32_16x16x32_bf16 v[128:131], v[96:99], v[80:83], v[128:131]
v_mfma_f32_16x16x32_bf16 v[132:135], v[96:99], v[84:87], v[132:135]
v_mfma_f32_16x16x32_bf16 v[136:139], v[96:99], v[88:91], v[136:139]
v_mfma_f32_16x16x32_bf16 v[140:143], v[96:99], v[92:95], v[140:143]
v_mfma_f32_16x16x32_bf16 v[204:207], v[112:115], v[92:95], v[204:207]
v_mfma_f32_16x16x32_bf16 v[200:203], v[112:115], v[88:91], v[200:203]
v_mfma_f32_16x16x32_bf16 v[196:199], v[112:115], v[84:87], v[196:199]
v_mfma_f32_16x16x32_bf16 v[192:195], v[112:115], v[80:83], v[192:195]
v_mfma_f32_16x16x32_bf16 v[144:147], v[100:103], v[80:83], v[144:147]
v_mfma_f32_16x16x32_bf16 v[148:151], v[100:103], v[84:87], v[148:151]
v_mfma_f32_16x16x32_bf16 v[152:155], v[100:103], v[88:91], v[152:155]
v_mfma_f32_16x16x32_bf16 v[156:159], v[100:103], v[92:95], v[156:159]
v_mfma_f32_16x16x32_bf16 v[220:223], v[116:119], v[92:95], v[220:223]
v_mfma_f32_16x16x32_bf16 v[216:219], v[116:119], v[88:91], v[216:219]
v_mfma_f32_16x16x32_bf16 v[212:215], v[116:119], v[84:87], v[212:215]
v_mfma_f32_16x16x32_bf16 v[208:211], v[116:119], v[80:83], v[208:211]
v_mfma_f32_16x16x32_bf16 v[160:163], v[104:107], v[80:83], v[160:163]
v_mfma_f32_16x16x32_bf16 v[164:167], v[104:107], v[84:87], v[164:167]
v_mfma_f32_16x16x32_bf16 v[168:171], v[104:107], v[88:91], v[168:171]
v_mfma_f32_16x16x32_bf16 v[172:175], v[104:107], v[92:95], v[172:175]
v_mfma_f32_16x16x32_bf16 v[236:239], v[120:123], v[92:95], v[236:239]
v_mfma_f32_16x16x32_bf16 v[232:235], v[120:123], v[88:91], v[232:235]
v_mfma_f32_16x16x32_bf16 v[228:231], v[120:123], v[84:87], v[228:231]
v_mfma_f32_16x16x32_bf16 v[224:227], v[120:123], v[80:83], v[224:227]
v_mfma_f32_16x16x32_bf16 v[176:179], v[108:111], v[80:83], v[176:179]
v_mfma_f32_16x16x32_bf16 v[180:183], v[108:111], v[84:87], v[180:183]
v_mfma_f32_16x16x32_bf16 v[184:187], v[108:111], v[88:91], v[184:187]
v_mfma_f32_16x16x32_bf16 v[188:191], v[108:111], v[92:95], v[188:191]
v_mfma_f32_16x16x32_bf16 v[252:255], v[124:127], v[92:95], v[252:255]
v_mfma_f32_16x16x32_bf16 v[248:251], v[124:127], v[88:91], v[248:251]
v_mfma_f32_16x16x32_bf16 v[244:247], v[124:127], v[84:87], v[244:247]
v_mfma_f32_16x16x32_bf16 v[240:243], v[124:127], v[80:83], v[240:243]
s_setprio 0
s_lshl_b32 s43, s46, 9
s_add_u32 s43, s43, 147456
v_lshl_add_u32 v19, v17, 3, s43
ds_read_b64 v[80:81], v19 offset:0
ds_read_b64 v[82:83], v19 offset:128
ds_read_b64 v[84:85], v19 offset:256
ds_read_b64 v[86:87], v19 offset:384
s_mul_i32 s43, s47, 256
s_add_u32 s43, s43, 148480
v_lshl_add_u32 v19, v18, 4, s43
ds_read_b128 v[48:51], v19 offset:0
ds_read_b128 v[52:55], v19 offset:64
ds_read_b128 v[56:59], v19 offset:128
ds_read_b128 v[60:63], v19 offset:192
ds_read_b128 v[64:67], v19 offset:896
ds_read_b128 v[68:71], v19 offset:960
ds_read_b128 v[72:75], v19 offset:1024
ds_read_b128 v[76:79], v19 offset:1088
s_waitcnt lgkmcnt(0)
v_mov_b32 v32, v80
v_mul_f32 v88, v81, v81
v_mul_f32 v36, 0xc0135761, v81
v_mul_f32 v89, 0xbdd2d3e8, v81
v_rcp_f32 v44, v88
v_mul_f32 v40, v89, v88
v_mov_b32 v33, v82
v_mul_f32 v88, v83, v83
v_mul_f32 v37, 0xc0135761, v83
v_mul_f32 v89, 0xbdd2d3e8, v83
v_rcp_f32 v45, v88
v_mul_f32 v41, v89, v88
v_mov_b32 v34, v84
v_mul_f32 v88, v85, v85
v_mul_f32 v38, 0xc0135761, v85
v_mul_f32 v89, 0xbdd2d3e8, v85
v_rcp_f32 v46, v88
v_mul_f32 v42, v89, v88
v_mov_b32 v35, v86
v_mul_f32 v88, v87, v87
v_mul_f32 v39, 0xc0135761, v87
v_mul_f32 v89, 0xbdd2d3e8, v87
v_rcp_f32 v47, v88
v_mul_f32 v43, v89, v88
s_barrier
v_fma_f32 v128, -v32, v48, v128
v_fma_f32 v129, -v32, v49, v129
v_fma_f32 v130, -v32, v50, v130
v_fma_f32 v131, -v32, v51, v131
v_fma_f32 v192, -v32, v64, v192
v_fma_f32 v193, -v32, v65, v193
v_fma_f32 v194, -v32, v66, v194
v_fma_f32 v195, -v32, v67, v195
v_mul_f32 v80, v128, v128
v_mul_f32 v81, v129, v129
v_mul_f32 v82, v130, v130
v_mul_f32 v83, v131, v131
v_fma_f32 v80, v80, v40, v36
v_fma_f32 v81, v81, v40, v36
v_fma_f32 v82, v82, v40, v36
v_fma_f32 v83, v83, v40, v36
v_mul_f32 v80, v80, v128
v_mul_f32 v81, v81, v129
v_mul_f32 v82, v82, v130
v_mul_f32 v83, v83, v131
v_exp_f32 v80, v80
v_exp_f32 v81, v81
v_exp_f32 v82, v82
v_exp_f32 v83, v83
v_mul_f32 v192, v128, v192
v_mul_f32 v193, v129, v193
v_mul_f32 v194, v130, v194
v_mul_f32 v195, v131, v195
v_fma_f32 v80, v80, v44, v44
v_fma_f32 v81, v81, v44, v44
v_fma_f32 v82, v82, v44, v44
v_fma_f32 v83, v83, v44, v44
v_rcp_f32 v80, v80
v_rcp_f32 v81, v81
v_rcp_f32 v82, v82
v_rcp_f32 v83, v83
v_mul_f32 v192, v192, v80
v_mul_f32 v193, v193, v81
v_mul_f32 v194, v194, v82
v_mul_f32 v195, v195, v83
v_cvt_pk_bf16_f32 v96, v192, v193
v_cvt_pk_bf16_f32 v97, v194, v195
v_fma_f32 v144, -v32, v52, v144
v_fma_f32 v145, -v32, v53, v145
v_fma_f32 v146, -v32, v54, v146
v_fma_f32 v147, -v32, v55, v147
v_fma_f32 v208, -v32, v68, v208
v_fma_f32 v209, -v32, v69, v209
v_fma_f32 v210, -v32, v70, v210
v_fma_f32 v211, -v32, v71, v211
v_mul_f32 v84, v144, v144
v_mul_f32 v85, v145, v145
s_barrier
v_mul_f32 v86, v146, v146
v_mul_f32 v87, v147, v147
v_fma_f32 v84, v84, v40, v36
v_fma_f32 v85, v85, v40, v36
v_fma_f32 v86, v86, v40, v36
v_fma_f32 v87, v87, v40, v36
v_mul_f32 v84, v84, v144
v_mul_f32 v85, v85, v145
v_mul_f32 v86, v86, v146
v_mul_f32 v87, v87, v147
v_exp_f32 v84, v84
v_exp_f32 v85, v85
v_exp_f32 v86, v86
v_exp_f32 v87, v87
v_mul_f32 v208, v144, v208
v_mul_f32 v209, v145, v209
v_mul_f32 v210, v146, v210
v_mul_f32 v211, v147, v211
v_fma_f32 v84, v84, v44, v44
v_fma_f32 v85, v85, v44, v44
v_fma_f32 v86, v86, v44, v44
v_fma_f32 v87, v87, v44, v44
v_rcp_f32 v84, v84
v_rcp_f32 v85, v85
v_rcp_f32 v86, v86
v_rcp_f32 v87, v87
v_mul_f32 v208, v208, v84
v_mul_f32 v209, v209, v85
v_mul_f32 v210, v210, v86
v_mul_f32 v211, v211, v87
v_cvt_pk_bf16_f32 v98, v208, v209
v_cvt_pk_bf16_f32 v99, v210, v211
buffer_store_dwordx4 v[96:99], v27, s[24:27], 0 offen offset:0 sc1
v_fma_f32 v132, -v33, v48, v132
v_fma_f32 v133, -v33, v49, v133
v_fma_f32 v134, -v33, v50, v134
v_fma_f32 v135, -v33, v51, v135
v_fma_f32 v196, -v33, v64, v196
v_fma_f32 v197, -v33, v65, v197
v_fma_f32 v198, -v33, v66, v198
v_fma_f32 v199, -v33, v67, v199
v_mul_f32 v80, v132, v132
v_mul_f32 v81, v133, v133
v_mul_f32 v82, v134, v134
v_mul_f32 v83, v135, v135
v_fma_f32 v80, v80, v41, v37
v_fma_f32 v81, v81, v41, v37
v_fma_f32 v82, v82, v41, v37
v_fma_f32 v83, v83, v41, v37
v_mul_f32 v80, v80, v132
v_mul_f32 v81, v81, v133
v_mul_f32 v82, v82, v134
v_lshlrev_b32 v19, 11, v18
v_lshl_add_u32 v19, v17, 4, v19
s_lshl_b32 s43, s46, 10
v_add_u32 v2, s43, v19
v_add_u32 v3, 0x10000, v2
v_lshrrev_b32 v19, 2, v17
v_lshl_add_u32 v20, v18, 2, v19
v_bfe_u32 v21, v20, 1, 2
s_lshl_b32 s43, s47, 1
v_xor_b32 v21, s43, v21
v_lshlrev_b32 v20, 7, v20
v_lshl_add_u32 v20, v21, 5, v20
v_and_b32 v19, 3, v1
v_lshl_add_u32 v20, v19, 3, v20
v_add_u32 v5, 16384, v20
v_xor_b32 v6, 32, v5
v_add_u32 v7, 0x10000, v5
v_add_u32 v8, 0x10000, v6
s_lshl_b32 s43, s36, 13
v_lshl_add_u32 v9, v1, 4, s43
s_mov_b32 s54, 0x10000
s_movk_i32 s52, 0x1000
s_barrier
s_mov_b32 s88, s4
s_mov_b32 s89, s5
s_mov_b32 s90, 7340032
s_mov_b32 s91, 0x20000
s_mov_b32 s92, s6
s_mov_b32 s93, s7
s_mov_b32 s94, 7340032
s_mov_b32 s95, 0x20000
s_lshr_b32 s43, s35, 3
v_and_b32 v19, 1, v1
v_bfe_u32 v23, v1, 2, 3
s_mul_i32 s44, s43, 10
s_add_u32 s44, s44, 2
v_add_u32 v23, s44, v23
s_lshl_b32 s44, s43, 2
s_sub_u32 s44, 5, s44
v_mad_u32_u24 v23, v19, s44, v23
s_lshl_b32 s44, s43, 10
s_xor_b32 s44, s44, 1024
s_lshl_b32 s43, s43, 11
s_add_u32 s43, s43, 4480
s_lshr_b32 s45, s2, 3
s_mul_i32 s45, s45, 14336
s_add_u32 s43, s43, s45
v_mul_lo_u32 v31, v19, s44
v_bfe_u32 v19, v1, 1, 1
v_mul_u32_u24 v19, 7168, v19
v_add3_u32 v31, v31, v19, s43
v_add_u32 v19, 8, v23
v_and_b32 v19, 15, v19
v_mul_u32_u24 v19, 458752, v19
v_add_u32 v19, v19, v31
buffer_load_dword v30, v19, s[88:91], 0 offen
buffer_load_dword v30, v19, s[92:95], 0 offen
v_mul_f32 v83, v83, v135
v_exp_f32 v80, v80
v_exp_f32 v81, v81
v_exp_f32 v82, v82
v_exp_f32 v83, v83
v_mul_f32 v196, v132, v196
v_mul_f32 v197, v133, v197
v_mul_f32 v198, v134, v198
v_mul_f32 v199, v135, v199
v_fma_f32 v80, v80, v45, v45
v_fma_f32 v81, v81, v45, v45
v_fma_f32 v82, v82, v45, v45
v_fma_f32 v83, v83, v45, v45
v_rcp_f32 v80, v80
v_rcp_f32 v81, v81
v_rcp_f32 v82, v82
v_rcp_f32 v83, v83
v_mul_f32 v196, v196, v80
v_mul_f32 v197, v197, v81
v_mul_f32 v198, v198, v82
v_mul_f32 v199, v199, v83
v_cvt_pk_bf16_f32 v100, v196, v197
v_cvt_pk_bf16_f32 v101, v198, v199
v_fma_f32 v148, -v33, v52, v148
v_fma_f32 v149, -v33, v53, v149
v_fma_f32 v150, -v33, v54, v150
v_fma_f32 v151, -v33, v55, v151
v_fma_f32 v212, -v33, v68, v212
v_fma_f32 v213, -v33, v69, v213
v_fma_f32 v214, -v33, v70, v214
v_fma_f32 v215, -v33, v71, v215
v_mul_f32 v84, v148, v148
v_mul_f32 v85, v149, v149
v_mul_f32 v86, v150, v150
v_mul_f32 v87, v151, v151
v_fma_f32 v84, v84, v41, v37
v_fma_f32 v85, v85, v41, v37
v_fma_f32 v86, v86, v41, v37
v_fma_f32 v87, v87, v41, v37
v_mul_f32 v84, v84, v148
v_mul_f32 v85, v85, v149
v_mul_f32 v86, v86, v150
v_mul_f32 v87, v87, v151
v_exp_f32 v84, v84
v_exp_f32 v85, v85
v_exp_f32 v86, v86
v_exp_f32 v87, v87
v_mul_f32 v212, v148, v212
v_mul_f32 v213, v149, v213
v_mul_f32 v214, v150, v214
v_mul_f32 v215, v151, v215
v_fma_f32 v84, v84, v45, v45
s_barrier
v_fma_f32 v85, v85, v45, v45
v_fma_f32 v86, v86, v45, v45
v_fma_f32 v87, v87, v45, v45
v_rcp_f32 v84, v84
v_rcp_f32 v85, v85
v_rcp_f32 v86, v86
v_rcp_f32 v87, v87
v_mul_f32 v212, v212, v84
v_mul_f32 v213, v213, v85
v_mul_f32 v214, v214, v86
v_mul_f32 v215, v215, v87
v_cvt_pk_bf16_f32 v102, v212, v213
v_cvt_pk_bf16_f32 v103, v214, v215
buffer_store_dwordx4 v[100:103], v27, s[24:27], 0 offen offset:256 sc1
v_fma_f32 v136, -v34, v48, v136
v_fma_f32 v137, -v34, v49, v137
v_fma_f32 v138, -v34, v50, v138
v_fma_f32 v139, -v34, v51, v139
v_fma_f32 v200, -v34, v64, v200
v_fma_f32 v201, -v34, v65, v201
v_fma_f32 v202, -v34, v66, v202
v_fma_f32 v203, -v34, v67, v203
v_mul_f32 v80, v136, v136
v_mul_f32 v81, v137, v137
v_mul_f32 v82, v138, v138
v_mul_f32 v83, v139, v139
v_fma_f32 v80, v80, v42, v38
v_fma_f32 v81, v81, v42, v38
v_fma_f32 v82, v82, v42, v38
v_fma_f32 v83, v83, v42, v38
v_mul_f32 v80, v80, v136
v_mul_f32 v81, v81, v137
v_mul_f32 v82, v82, v138
v_mul_f32 v83, v83, v139
v_exp_f32 v80, v80
v_exp_f32 v81, v81
v_exp_f32 v82, v82
v_exp_f32 v83, v83
v_mul_f32 v200, v136, v200
v_mul_f32 v201, v137, v201
v_mul_f32 v202, v138, v202
v_mul_f32 v203, v139, v203
v_fma_f32 v80, v80, v46, v46
v_fma_f32 v81, v81, v46, v46
v_fma_f32 v82, v82, v46, v46
v_fma_f32 v83, v83, v46, v46
v_rcp_f32 v80, v80
v_rcp_f32 v81, v81
v_rcp_f32 v82, v82
v_rcp_f32 v83, v83
v_mul_f32 v200, v200, v80
v_mul_f32 v201, v201, v81
v_mul_f32 v202, v202, v82
s_barrier
v_mul_f32 v203, v203, v83
v_cvt_pk_bf16_f32 v104, v200, v201
v_cvt_pk_bf16_f32 v105, v202, v203
v_fma_f32 v152, -v34, v52, v152
v_fma_f32 v153, -v34, v53, v153
v_fma_f32 v154, -v34, v54, v154
v_fma_f32 v155, -v34, v55, v155
v_fma_f32 v216, -v34, v68, v216
v_fma_f32 v217, -v34, v69, v217
v_fma_f32 v218, -v34, v70, v218
v_fma_f32 v219, -v34, v71, v219
v_mul_f32 v84, v152, v152
v_mul_f32 v85, v153, v153
v_mul_f32 v86, v154, v154
v_mul_f32 v87, v155, v155
v_fma_f32 v84, v84, v42, v38
v_fma_f32 v85, v85, v42, v38
v_fma_f32 v86, v86, v42, v38
v_fma_f32 v87, v87, v42, v38
v_mul_f32 v84, v84, v152
v_mul_f32 v85, v85, v153
v_mul_f32 v86, v86, v154
v_mul_f32 v87, v87, v155
v_exp_f32 v84, v84
v_exp_f32 v85, v85
v_exp_f32 v86, v86
v_exp_f32 v87, v87
v_mul_f32 v216, v152, v216
v_mul_f32 v217, v153, v217
v_mul_f32 v218, v154, v218
v_mul_f32 v219, v155, v219
v_fma_f32 v84, v84, v46, v46
v_fma_f32 v85, v85, v46, v46
v_fma_f32 v86, v86, v46, v46
v_fma_f32 v87, v87, v46, v46
v_rcp_f32 v84, v84
v_rcp_f32 v85, v85
v_rcp_f32 v86, v86
v_rcp_f32 v87, v87
v_mul_f32 v216, v216, v84
v_mul_f32 v217, v217, v85
v_mul_f32 v218, v218, v86
v_mul_f32 v219, v219, v87
v_cvt_pk_bf16_f32 v106, v216, v217
v_cvt_pk_bf16_f32 v107, v218, v219
buffer_store_dwordx4 v[104:107], v27, s[24:27], 0 offen offset:512 sc1
v_fma_f32 v140, -v35, v48, v140
v_fma_f32 v141, -v35, v49, v141
v_fma_f32 v142, -v35, v50, v142
v_fma_f32 v143, -v35, v51, v143
v_fma_f32 v204, -v35, v64, v204
v_fma_f32 v205, -v35, v65, v205
s_barrier
v_fma_f32 v206, -v35, v66, v206
v_fma_f32 v207, -v35, v67, v207
v_mul_f32 v80, v140, v140
v_mul_f32 v81, v141, v141
v_mul_f32 v82, v142, v142
v_mul_f32 v83, v143, v143
v_fma_f32 v80, v80, v43, v39
v_fma_f32 v81, v81, v43, v39
v_fma_f32 v82, v82, v43, v39
v_fma_f32 v83, v83, v43, v39
v_mul_f32 v80, v80, v140
v_mul_f32 v81, v81, v141
v_mul_f32 v82, v82, v142
v_mul_f32 v83, v83, v143
v_exp_f32 v80, v80
v_exp_f32 v81, v81
v_exp_f32 v82, v82
v_exp_f32 v83, v83
v_mul_f32 v204, v140, v204
v_mul_f32 v205, v141, v205
v_mul_f32 v206, v142, v206
v_mul_f32 v207, v143, v207
v_fma_f32 v80, v80, v47, v47
v_fma_f32 v81, v81, v47, v47
v_fma_f32 v82, v82, v47, v47
v_fma_f32 v83, v83, v47, v47
v_rcp_f32 v80, v80
v_rcp_f32 v81, v81
v_rcp_f32 v82, v82
v_rcp_f32 v83, v83
v_mul_f32 v204, v204, v80
v_mul_f32 v205, v205, v81
v_mul_f32 v206, v206, v82
v_mul_f32 v207, v207, v83
v_cvt_pk_bf16_f32 v108, v204, v205
v_cvt_pk_bf16_f32 v109, v206, v207
v_fma_f32 v156, -v35, v52, v156
v_fma_f32 v157, -v35, v53, v157
v_fma_f32 v158, -v35, v54, v158
v_fma_f32 v159, -v35, v55, v159
v_fma_f32 v220, -v35, v68, v220
v_fma_f32 v221, -v35, v69, v221
v_fma_f32 v222, -v35, v70, v222
v_fma_f32 v223, -v35, v71, v223
v_mul_f32 v84, v156, v156
v_mul_f32 v85, v157, v157
v_mul_f32 v86, v158, v158
v_mul_f32 v87, v159, v159
v_fma_f32 v84, v84, v43, v39
v_fma_f32 v85, v85, v43, v39
v_fma_f32 v86, v86, v43, v39
v_fma_f32 v87, v87, v43, v39
s_barrier
v_mul_f32 v84, v84, v156
v_mul_f32 v85, v85, v157
v_mul_f32 v86, v86, v158
v_mul_f32 v87, v87, v159
v_exp_f32 v84, v84
v_exp_f32 v85, v85
v_exp_f32 v86, v86
v_exp_f32 v87, v87
v_mul_f32 v220, v156, v220
v_mul_f32 v221, v157, v221
v_mul_f32 v222, v158, v222
v_mul_f32 v223, v159, v223
v_fma_f32 v84, v84, v47, v47
v_fma_f32 v85, v85, v47, v47
v_fma_f32 v86, v86, v47, v47
v_fma_f32 v87, v87, v47, v47
v_rcp_f32 v84, v84
v_rcp_f32 v85, v85
v_rcp_f32 v86, v86
v_rcp_f32 v87, v87
v_mul_f32 v220, v220, v84
v_mul_f32 v221, v221, v85
v_mul_f32 v222, v222, v86
v_mul_f32 v223, v223, v87
v_cvt_pk_bf16_f32 v110, v220, v221
v_cvt_pk_bf16_f32 v111, v222, v223
buffer_store_dwordx4 v[108:111], v27, s[24:27], 0 offen offset:768 sc1
v_fma_f32 v160, -v32, v56, v160
v_fma_f32 v161, -v32, v57, v161
v_fma_f32 v162, -v32, v58, v162
v_fma_f32 v163, -v32, v59, v163
v_fma_f32 v224, -v32, v72, v224
v_fma_f32 v225, -v32, v73, v225
v_fma_f32 v226, -v32, v74, v226
v_fma_f32 v227, -v32, v75, v227
v_mul_f32 v80, v160, v160
v_mul_f32 v81, v161, v161
v_mul_f32 v82, v162, v162
v_mul_f32 v83, v163, v163
v_fma_f32 v80, v80, v40, v36
v_fma_f32 v81, v81, v40, v36
v_fma_f32 v82, v82, v40, v36
v_fma_f32 v83, v83, v40, v36
v_mul_f32 v80, v80, v160
v_mul_f32 v81, v81, v161
v_mul_f32 v82, v82, v162
v_mul_f32 v83, v83, v163
v_exp_f32 v80, v80
v_exp_f32 v81, v81
v_exp_f32 v82, v82
v_exp_f32 v83, v83
v_mul_f32 v224, v160, v224
v_mul_f32 v225, v161, v225
s_barrier
v_mul_f32 v226, v162, v226
v_mul_f32 v227, v163, v227
v_fma_f32 v80, v80, v44, v44
v_fma_f32 v81, v81, v44, v44
v_fma_f32 v82, v82, v44, v44
v_fma_f32 v83, v83, v44, v44
v_rcp_f32 v80, v80
v_rcp_f32 v81, v81
v_rcp_f32 v82, v82
v_rcp_f32 v83, v83
v_mul_f32 v224, v224, v80
v_mul_f32 v225, v225, v81
v_mul_f32 v226, v226, v82
v_mul_f32 v227, v227, v83
v_cvt_pk_bf16_f32 v96, v224, v225
v_cvt_pk_bf16_f32 v97, v226, v227
v_fma_f32 v176, -v32, v60, v176
v_fma_f32 v177, -v32, v61, v177
v_fma_f32 v178, -v32, v62, v178
v_fma_f32 v179, -v32, v63, v179
v_fma_f32 v240, -v32, v76, v240
v_fma_f32 v241, -v32, v77, v241
v_fma_f32 v242, -v32, v78, v242
v_fma_f32 v243, -v32, v79, v243
v_mul_f32 v84, v176, v176
v_mul_f32 v85, v177, v177
v_mul_f32 v86, v178, v178
v_mul_f32 v87, v179, v179
v_fma_f32 v84, v84, v40, v36
v_fma_f32 v85, v85, v40, v36
v_fma_f32 v86, v86, v40, v36
v_fma_f32 v87, v87, v40, v36
v_mul_f32 v84, v84, v176
v_mul_f32 v85, v85, v177
v_mul_f32 v86, v86, v178
v_mul_f32 v87, v87, v179
v_exp_f32 v84, v84
v_exp_f32 v85, v85
v_exp_f32 v86, v86
v_exp_f32 v87, v87
v_mul_f32 v240, v176, v240
v_mul_f32 v241, v177, v241
v_mul_f32 v242, v178, v242
v_mul_f32 v243, v179, v243
v_fma_f32 v84, v84, v44, v44
v_fma_f32 v85, v85, v44, v44
v_fma_f32 v86, v86, v44, v44
v_fma_f32 v87, v87, v44, v44
v_rcp_f32 v84, v84
v_rcp_f32 v85, v85
v_rcp_f32 v86, v86
v_rcp_f32 v87, v87
v_lshlrev_b32 v19, 11, v18
v_lshl_add_u32 v19, v17, 4, v19
s_lshl_b32 s43, s46, 10
s_lshl_b32 s44, s47, 13
v_add3_u32 v208, v19, s43, 0
v_add_u32 v208, s44, v208
buffer_load_dwordx4 v[192:195], v208, s[20:23], 0 offen offset:0 sc1
buffer_load_dwordx4 v[196:199], v208, s[20:23], 0 offen offset:256 sc1
buffer_load_dwordx4 v[200:203], v208, s[20:23], 0 offen offset:512 sc1
buffer_load_dwordx4 v[204:207], v208, s[20:23], 0 offen offset:768 sc1
s_waitcnt vmcnt(4)
s_barrier
s_add_u32 s43, s34, 32
s_lshl_b32 s43, s43, 7
v_mov_b32 v21, s43
v_mov_b32 v22, 1
s_mov_b64 exec, 1
buffer_atomic_add v22, v21, s[56:59], 0 offen sc1
s_mov_b64 exec, -1
v_mul_f32 v240, v240, v84
v_mul_f32 v241, v241, v85
v_mul_f32 v242, v242, v86
v_mul_f32 v243, v243, v87
v_cvt_pk_bf16_f32 v98, v240, v241
v_cvt_pk_bf16_f32 v99, v242, v243
buffer_store_dwordx4 v[96:99], v27, s[24:27], s53 offen offset:0 sc1
v_fma_f32 v164, -v33, v56, v164
v_fma_f32 v165, -v33, v57, v165
v_fma_f32 v166, -v33, v58, v166
v_fma_f32 v167, -v33, v59, v167
v_fma_f32 v228, -v33, v72, v228
v_fma_f32 v229, -v33, v73, v229
v_fma_f32 v230, -v33, v74, v230
v_fma_f32 v231, -v33, v75, v231
v_mul_f32 v80, v164, v164
v_mul_f32 v81, v165, v165
v_mul_f32 v82, v166, v166
v_mul_f32 v83, v167, v167
v_fma_f32 v80, v80, v41, v37
v_fma_f32 v81, v81, v41, v37
v_fma_f32 v82, v82, v41, v37
v_fma_f32 v83, v83, v41, v37
v_mul_f32 v80, v80, v164
v_mul_f32 v81, v81, v165
v_mul_f32 v82, v82, v166
v_mul_f32 v83, v83, v167
v_exp_f32 v80, v80
v_exp_f32 v81, v81
v_exp_f32 v82, v82
v_exp_f32 v83, v83
v_mul_f32 v228, v164, v228
v_mul_f32 v229, v165, v229
v_mul_f32 v230, v166, v230
v_mul_f32 v231, v167, v231
v_fma_f32 v80, v80, v45, v45
v_fma_f32 v81, v81, v45, v45
v_fma_f32 v82, v82, v45, v45
v_fma_f32 v83, v83, v45, v45
v_rcp_f32 v80, v80
v_rcp_f32 v81, v81
v_rcp_f32 v82, v82
v_rcp_f32 v83, v83
v_mul_f32 v228, v228, v80
v_mul_f32 v229, v229, v81
v_mul_f32 v230, v230, v82
v_mul_f32 v231, v231, v83
v_cvt_pk_bf16_f32 v100, v228, v229
v_cvt_pk_bf16_f32 v101, v230, v231
v_fma_f32 v180, -v33, v60, v180
v_fma_f32 v181, -v33, v61, v181
v_fma_f32 v182, -v33, v62, v182
s_barrier
s_mov_b32 s80, s60
s_mov_b32 s81, s61
s_mov_b32 s82, 7340032
s_mov_b32 s83, 0x20000
v_and_b32 v29, 31, v1
v_lshlrev_b32 v29, 11, v29
s_and_b32 s43, s35, 8
s_or_b32 s43, s43, 3
s_lshl_b32 s43, s43, 7
v_add_u32 v29, s43, v29
s_lshr_b32 s44, s2, 3
s_lshl_b32 s44, s44, 17
s_add_u32 s43, s44, 0
buffer_load_dword v30, v29, s[80:83], s43 offen
v_fma_f32 v183, -v33, v63, v183
v_fma_f32 v244, -v33, v76, v244
v_fma_f32 v245, -v33, v77, v245
v_fma_f32 v246, -v33, v78, v246
v_fma_f32 v247, -v33, v79, v247
v_mul_f32 v84, v180, v180
v_mul_f32 v85, v181, v181
v_mul_f32 v86, v182, v182
v_mul_f32 v87, v183, v183
v_fma_f32 v84, v84, v41, v37
v_fma_f32 v85, v85, v41, v37
v_fma_f32 v86, v86, v41, v37
v_fma_f32 v87, v87, v41, v37
v_mul_f32 v84, v84, v180
v_mul_f32 v85, v85, v181
v_mul_f32 v86, v86, v182
v_mul_f32 v87, v87, v183
v_exp_f32 v84, v84
v_exp_f32 v85, v85
v_exp_f32 v86, v86
v_exp_f32 v87, v87
v_mul_f32 v244, v180, v244
v_mul_f32 v245, v181, v245
v_mul_f32 v246, v182, v246
v_mul_f32 v247, v183, v247
v_fma_f32 v84, v84, v45, v45
v_fma_f32 v85, v85, v45, v45
v_fma_f32 v86, v86, v45, v45
v_fma_f32 v87, v87, v45, v45
v_rcp_f32 v84, v84
v_rcp_f32 v85, v85
v_rcp_f32 v86, v86
v_rcp_f32 v87, v87
v_mul_f32 v244, v244, v84
v_mul_f32 v245, v245, v85
v_mul_f32 v246, v246, v86
v_mul_f32 v247, v247, v87
v_cvt_pk_bf16_f32 v102, v244, v245
v_cvt_pk_bf16_f32 v103, v246, v247
buffer_store_dwordx4 v[100:103], v27, s[24:27], s53 offen offset:256 sc1
v_fma_f32 v168, -v34, v56, v168
v_fma_f32 v169, -v34, v57, v169
v_fma_f32 v170, -v34, v58, v170
v_fma_f32 v171, -v34, v59, v171
v_fma_f32 v232, -v34, v72, v232
v_fma_f32 v233, -v34, v73, v233
v_fma_f32 v234, -v34, v74, v234
v_fma_f32 v235, -v34, v75, v235
v_mul_f32 v80, v168, v168
v_mul_f32 v81, v169, v169
v_mul_f32 v82, v170, v170
v_mul_f32 v83, v171, v171
v_fma_f32 v80, v80, v42, v38
s_waitcnt vmcnt(2)
s_barrier
v_fma_f32 v81, v81, v42, v38
v_fma_f32 v82, v82, v42, v38
v_fma_f32 v83, v83, v42, v38
v_mul_f32 v80, v80, v168
v_mul_f32 v81, v81, v169
v_mul_f32 v82, v82, v170
v_mul_f32 v83, v83, v171
v_exp_f32 v80, v80
v_exp_f32 v81, v81
v_exp_f32 v82, v82
v_exp_f32 v83, v83
v_mul_f32 v232, v168, v232
v_mul_f32 v233, v169, v233
v_mul_f32 v234, v170, v234
v_mul_f32 v235, v171, v235
v_fma_f32 v80, v80, v46, v46
v_fma_f32 v81, v81, v46, v46
v_fma_f32 v82, v82, v46, v46
v_fma_f32 v83, v83, v46, v46
v_rcp_f32 v80, v80
v_rcp_f32 v81, v81
v_rcp_f32 v82, v82
v_rcp_f32 v83, v83
v_mul_f32 v232, v232, v80
v_mul_f32 v233, v233, v81
v_mul_f32 v234, v234, v82
v_mul_f32 v235, v235, v83
v_cvt_pk_bf16_f32 v104, v232, v233
v_cvt_pk_bf16_f32 v105, v234, v235
v_fma_f32 v184, -v34, v60, v184
v_fma_f32 v185, -v34, v61, v185
v_fma_f32 v186, -v34, v62, v186
v_fma_f32 v187, -v34, v63, v187
v_fma_f32 v248, -v34, v76, v248
v_fma_f32 v249, -v34, v77, v249
v_fma_f32 v250, -v34, v78, v250
v_fma_f32 v251, -v34, v79, v251
v_mul_f32 v84, v184, v184
v_mul_f32 v85, v185, v185
v_mul_f32 v86, v186, v186
v_mul_f32 v87, v187, v187
v_fma_f32 v84, v84, v42, v38
v_fma_f32 v85, v85, v42, v38
v_fma_f32 v86, v86, v42, v38
v_fma_f32 v87, v87, v42, v38
v_mul_f32 v84, v84, v184
v_mul_f32 v85, v85, v185
v_mul_f32 v86, v86, v186
v_mul_f32 v87, v87, v187
v_exp_f32 v84, v84
v_exp_f32 v85, v85
v_exp_f32 v86, v86
s_barrier
v_exp_f32 v87, v87
v_mul_f32 v248, v184, v248
v_mul_f32 v249, v185, v249
v_mul_f32 v250, v186, v250
v_mul_f32 v251, v187, v251
v_fma_f32 v84, v84, v46, v46
v_fma_f32 v85, v85, v46, v46
v_fma_f32 v86, v86, v46, v46
v_fma_f32 v87, v87, v46, v46
v_rcp_f32 v84, v84
v_rcp_f32 v85, v85
v_rcp_f32 v86, v86
v_rcp_f32 v87, v87
v_mul_f32 v248, v248, v84
v_mul_f32 v249, v249, v85
v_mul_f32 v250, v250, v86
v_mul_f32 v251, v251, v87
v_cvt_pk_bf16_f32 v106, v248, v249
v_cvt_pk_bf16_f32 v107, v250, v251
buffer_store_dwordx4 v[104:107], v27, s[24:27], s53 offen offset:512 sc1
v_fma_f32 v172, -v35, v56, v172
v_fma_f32 v173, -v35, v57, v173
v_fma_f32 v174, -v35, v58, v174
v_fma_f32 v175, -v35, v59, v175
v_fma_f32 v236, -v35, v72, v236
v_fma_f32 v237, -v35, v73, v237
v_fma_f32 v238, -v35, v74, v238
v_fma_f32 v239, -v35, v75, v239
v_mul_f32 v80, v172, v172
v_mul_f32 v81, v173, v173
v_mul_f32 v82, v174, v174
v_mul_f32 v83, v175, v175
v_fma_f32 v80, v80, v43, v39
v_fma_f32 v81, v81, v43, v39
v_fma_f32 v82, v82, v43, v39
v_fma_f32 v83, v83, v43, v39
v_mul_f32 v80, v80, v172
v_mul_f32 v81, v81, v173
v_mul_f32 v82, v82, v174
v_mul_f32 v83, v83, v175
v_exp_f32 v80, v80
v_exp_f32 v81, v81
v_exp_f32 v82, v82
v_exp_f32 v83, v83
v_mul_f32 v236, v172, v236
v_mul_f32 v237, v173, v237
v_mul_f32 v238, v174, v238
v_mul_f32 v239, v175, v239
v_fma_f32 v80, v80, v47, v47
v_fma_f32 v81, v81, v47, v47
v_fma_f32 v82, v82, v47, v47
v_fma_f32 v83, v83, v47, v47
s_barrier
s_add_u32 s43, s34, 32
s_lshl_b32 s43, s43, 7
v_mov_b32 v21, s43
v_mov_b32 v23, 16
buffer_load_dword v22, v21, s[56:59], 0 offen sc1
v_rcp_f32 v80, v80
v_rcp_f32 v81, v81
v_rcp_f32 v82, v82
v_rcp_f32 v83, v83
v_mul_f32 v236, v236, v80
v_mul_f32 v237, v237, v81
v_mul_f32 v238, v238, v82
v_mul_f32 v239, v239, v83
v_cvt_pk_bf16_f32 v108, v236, v237
v_cvt_pk_bf16_f32 v109, v238, v239
v_fma_f32 v188, -v35, v60, v188
v_fma_f32 v189, -v35, v61, v189
v_fma_f32 v190, -v35, v62, v190
v_fma_f32 v191, -v35, v63, v191
v_fma_f32 v252, -v35, v76, v252
v_fma_f32 v253, -v35, v77, v253
v_fma_f32 v254, -v35, v78, v254
v_fma_f32 v255, -v35, v79, v255
v_mul_f32 v84, v188, v188
v_mul_f32 v85, v189, v189
v_mul_f32 v86, v190, v190
v_mul_f32 v87, v191, v191
v_fma_f32 v84, v84, v43, v39
v_fma_f32 v85, v85, v43, v39
v_fma_f32 v86, v86, v43, v39
v_fma_f32 v87, v87, v43, v39
v_mul_f32 v84, v84, v188
v_mul_f32 v85, v85, v189
v_mul_f32 v86, v86, v190
v_mul_f32 v87, v87, v191
v_exp_f32 v84, v84
v_exp_f32 v85, v85
v_exp_f32 v86, v86
v_exp_f32 v87, v87
v_mul_f32 v252, v188, v252
v_mul_f32 v253, v189, v253
v_mul_f32 v254, v190, v254
v_mul_f32 v255, v191, v255
v_fma_f32 v84, v84, v47, v47
v_fma_f32 v85, v85, v47, v47
v_fma_f32 v86, v86, v47, v47
v_fma_f32 v87, v87, v47, v47
v_rcp_f32 v84, v84
v_rcp_f32 v85, v85
v_rcp_f32 v86, v86
v_rcp_f32 v87, v87
v_mul_f32 v252, v252, v84
v_mul_f32 v253, v253, v85
v_mul_f32 v254, v254, v86
v_mul_f32 v255, v255, v87
v_cvt_pk_bf16_f32 v110, v252, v253
v_cvt_pk_bf16_f32 v111, v254, v255
buffer_store_dwordx4 v[108:111], v27, s[24:27], s53 offen offset:768 sc1
s_mov_b32 s41, 0x10000
Lpoll_30:
s_waitcnt vmcnt(0)
Lpf_32:
v_cmp_ne_u32 vcc, v23, v22
s_nop 4
s_cbranch_vccz Lpok_31
buffer_load_dword v22, v21, s[56:59], 0 offen sc1
s_sub_u32 s41, s41, 1
s_cmp_lg_u32 s41, 0
s_cbranch_scc1 Lpoll_30
s_waitcnt vmcnt(0)
Lpok_31:
s_barrier
v_lshlrev_b32 v128, 16, v192
v_and_b32 v129, 0xffff0000, v192
v_lshlrev_b32 v130, 16, v193
v_and_b32 v131, 0xffff0000, v193
v_lshlrev_b32 v132, 16, v194
v_and_b32 v133, 0xffff0000, v194
v_lshlrev_b32 v134, 16, v195
v_and_b32 v135, 0xffff0000, v195
v_lshlrev_b32 v136, 16, v196
v_and_b32 v137, 0xffff0000, v196
v_lshlrev_b32 v138, 16, v197
v_and_b32 v139, 0xffff0000, v197
v_lshlrev_b32 v140, 16, v198
v_and_b32 v141, 0xffff0000, v198
v_lshlrev_b32 v142, 16, v199
v_and_b32 v143, 0xffff0000, v199
v_lshlrev_b32 v144, 16, v200
v_and_b32 v145, 0xffff0000, v200
v_lshlrev_b32 v146, 16, v201
v_and_b32 v147, 0xffff0000, v201
v_lshlrev_b32 v148, 16, v202
v_and_b32 v149, 0xffff0000, v202
v_lshlrev_b32 v150, 16, v203
v_and_b32 v151, 0xffff0000, v203
v_lshlrev_b32 v152, 16, v204
v_and_b32 v153, 0xffff0000, v204
v_lshlrev_b32 v154, 16, v205
v_and_b32 v155, 0xffff0000, v205
v_lshlrev_b32 v156, 16, v206
v_and_b32 v157, 0xffff0000, v206
v_lshlrev_b32 v158, 16, v207
v_and_b32 v159, 0xffff0000, v207
s_waitcnt vmcnt(0)
s_barrier
s_add_u32 s43, s34, 48
s_lshl_b32 s43, s43, 7
v_mov_b32 v22, s43
v_mov_b32 v23, 1
s_mov_b64 exec, 1
buffer_atomic_add v23, v22, s[56:59], 0 offen sc1
s_mov_b64 exec, -1
v_mov_b32 v192, 0
v_mov_b32 v193, 0
v_mov_b32 v194, 0
v_mov_b32 v195, 0
v_mov_b32 v196, 0
v_mov_b32 v197, 0
v_mov_b32 v198, 0
v_mov_b32 v199, 0
v_mov_b32 v200, 0
v_mov_b32 v201, 0
v_mov_b32 v202, 0
v_mov_b32 v203, 0
v_mov_b32 v204, 0
v_mov_b32 v205, 0
v_mov_b32 v206, 0
v_mov_b32 v207, 0
v_mov_b32 v208, 0
v_mov_b32 v209, 0
v_mov_b32 v210, 0
v_mov_b32 v211, 0
v_mov_b32 v212, 0
v_mov_b32 v213, 0
v_mov_b32 v214, 0
v_mov_b32 v215, 0
v_mov_b32 v216, 0
v_mov_b32 v217, 0
v_mov_b32 v218, 0
v_mov_b32 v219, 0
v_mov_b32 v220, 0
v_mov_b32 v221, 0
v_mov_b32 v222, 0
v_mov_b32 v223, 0
s_barrier
LK4_29:
s_setprio 1
ds_read_b64_tr_b16 v[64:65], v7 offset:0
ds_read_b128 v[32:35], v3 offset:0
ds_read_b64_tr_b16 v[66:67], v7 offset:2048
ds_read_b128 v[36:39], v3 offset:256
ds_read_b64_tr_b16 v[68:69], v8 offset:0
ds_read_b128 v[40:43], v3 offset:512
ds_read_b64_tr_b16 v[70:71], v8 offset:2048
ds_read_b128 v[44:47], v3 offset:768
ds_read_b64_tr_b16 v[72:73], v7 offset:4096
ds_read_b128 v[48:51], v3 offset:8192
ds_read_b64_tr_b16 v[74:75], v7 offset:6144
ds_read_b128 v[52:55], v3 offset:8448
ds_read_b64_tr_b16 v[76:77], v8 offset:4096
ds_read_b128 v[56:59], v3 offset:8704
ds_read_b64_tr_b16 v[78:79], v8 offset:6144
ds_read_b128 v[60:63], v3 offset:8960
s_waitcnt vmcnt(0) lgkmcnt(0)
s_barrier
v_mfma_f32_16x16x32_bf16 v[128:131], v[64:67], v[32:35], v[128:131]
ds_read_b64_tr_b16 v[160:161], v7 offset:32768
v_mfma_f32_16x16x32_bf16 v[132:135], v[68:71], v[32:35], v[132:135]
ds_read_b128 v[96:99], v3 offset:32768
v_mfma_f32_16x16x32_bf16 v[136:139], v[64:67], v[36:39], v[136:139]
ds_read_b64_tr_b16 v[162:163], v7 offset:34816
v_mfma_f32_16x16x32_bf16 v[140:143], v[68:71], v[36:39], v[140:143]
ds_read_b128 v[100:103], v3 offset:33024
v_mfma_f32_16x16x32_bf16 v[144:147], v[64:67], v[40:43], v[144:147]
ds_read_b64_tr_b16 v[164:165], v8 offset:32768
v_mfma_f32_16x16x32_bf16 v[148:151], v[68:71], v[40:43], v[148:151]
ds_read_b128 v[104:107], v3 offset:33280
v_mfma_f32_16x16x32_bf16 v[152:155], v[64:67], v[44:47], v[152:155]
ds_read_b64_tr_b16 v[166:167], v8 offset:34816
v_mfma_f32_16x16x32_bf16 v[156:159], v[68:71], v[44:47], v[156:159]
ds_read_b128 v[108:111], v3 offset:33536
v_mfma_f32_16x16x32_bf16 v[128:131], v[72:75], v[48:51], v[128:131]
ds_read_b64_tr_b16 v[168:169], v7 offset:36864
v_mfma_f32_16x16x32_bf16 v[132:135], v[76:79], v[48:51], v[132:135]
ds_read_b128 v[112:115], v3 offset:40960
v_mfma_f32_16x16x32_bf16 v[136:139], v[72:75], v[52:55], v[136:139]
ds_read_b64_tr_b16 v[170:171], v7 offset:38912
v_mfma_f32_16x16x32_bf16 v[140:143], v[76:79], v[52:55], v[140:143]
ds_read_b128 v[116:119], v3 offset:41216
v_mfma_f32_16x16x32_bf16 v[144:147], v[72:75], v[56:59], v[144:147]
ds_read_b64_tr_b16 v[172:173], v8 offset:36864
v_mfma_f32_16x16x32_bf16 v[148:151], v[76:79], v[56:59], v[148:151]
ds_read_b128 v[120:123], v3 offset:41472
v_mfma_f32_16x16x32_bf16 v[152:155], v[72:75], v[60:63], v[152:155]
ds_read_b64_tr_b16 v[174:175], v8 offset:38912
v_mfma_f32_16x16x32_bf16 v[156:159], v[76:79], v[60:63], v[156:159]
ds_read_b128 v[124:127], v3 offset:41728
s_waitcnt lgkmcnt(0)
s_barrier
v_mfma_f32_16x16x32_bf16 v[128:131], v[160:163], v[96:99], v[128:131]
ds_read_b64_tr_b16 v[64:65], v5 offset:0
v_mfma_f32_16x16x32_bf16 v[132:135], v[164:167], v[96:99], v[132:135]
ds_read_b128 v[32:35], v2 offset:0
v_mfma_f32_16x16x32_bf16 v[136:139], v[160:163], v[100:103], v[136:139]
ds_read_b64_tr_b16 v[66:67], v5 offset:2048
v_mfma_f32_16x16x32_bf16 v[140:143], v[164:167], v[100:103], v[140:143]
ds_read_b128 v[36:39], v2 offset:256
v_mfma_f32_16x16x32_bf16 v[144:147], v[160:163], v[104:107], v[144:147]
ds_read_b64_tr_b16 v[68:69], v6 offset:0
v_mfma_f32_16x16x32_bf16 v[148:151], v[164:167], v[104:107], v[148:151]
ds_read_b128 v[40:43], v2 offset:512
v_mfma_f32_16x16x32_bf16 v[152:155], v[160:163], v[108:111], v[152:155]
ds_read_b64_tr_b16 v[70:71], v6 offset:2048
v_mfma_f32_16x16x32_bf16 v[156:159], v[164:167], v[108:111], v[156:159]
ds_read_b128 v[44:47], v2 offset:768
v_mfma_f32_16x16x32_bf16 v[128:131], v[168:171], v[112:115], v[128:131]
ds_read_b64_tr_b16 v[72:73], v5 offset:4096
v_mfma_f32_16x16x32_bf16 v[132:135], v[172:175], v[112:115], v[132:135]
ds_read_b128 v[48:51], v2 offset:8192
v_mfma_f32_16x16x32_bf16 v[136:139], v[168:171], v[116:119], v[136:139]
ds_read_b64_tr_b16 v[74:75], v5 offset:6144
v_mfma_f32_16x16x32_bf16 v[140:143], v[172:175], v[116:119], v[140:143]
ds_read_b128 v[52:55], v2 offset:8448
v_mfma_f32_16x16x32_bf16 v[144:147], v[168:171], v[120:123], v[144:147]
ds_read_b64_tr_b16 v[76:77], v6 offset:4096
v_mfma_f32_16x16x32_bf16 v[148:151], v[172:175], v[120:123], v[148:151]
ds_read_b128 v[56:59], v2 offset:8704
v_mfma_f32_16x16x32_bf16 v[152:155], v[168:171], v[124:127], v[152:155]
ds_read_b64_tr_b16 v[78:79], v6 offset:6144
v_mfma_f32_16x16x32_bf16 v[156:159], v[172:175], v[124:127], v[156:159]
ds_read_b128 v[60:63], v2 offset:8960
s_waitcnt lgkmcnt(0)
s_barrier
v_mfma_f32_16x16x32_bf16 v[128:131], v[64:67], v[32:35], v[128:131]
ds_read_b64_tr_b16 v[160:161], v5 offset:32768
v_mfma_f32_16x16x32_bf16 v[132:135], v[68:71], v[32:35], v[132:135]
ds_read_b128 v[96:99], v2 offset:32768
v_mfma_f32_16x16x32_bf16 v[136:139], v[64:67], v[36:39], v[136:139]
ds_read_b64_tr_b16 v[162:163], v5 offset:34816
v_mfma_f32_16x16x32_bf16 v[140:143], v[68:71], v[36:39], v[140:143]
ds_read_b128 v[100:103], v2 offset:33024
v_mfma_f32_16x16x32_bf16 v[144:147], v[64:67], v[40:43], v[144:147]
ds_read_b64_tr_b16 v[164:165], v6 offset:32768
v_mfma_f32_16x16x32_bf16 v[148:151], v[68:71], v[40:43], v[148:151]
ds_read_b128 v[104:107], v2 offset:33280
v_mfma_f32_16x16x32_bf16 v[152:155], v[64:67], v[44:47], v[152:155]
ds_read_b64_tr_b16 v[166:167], v6 offset:34816
v_mfma_f32_16x16x32_bf16 v[156:159], v[68:71], v[44:47], v[156:159]
ds_read_b128 v[108:111], v2 offset:33536
v_mfma_f32_16x16x32_bf16 v[128:131], v[72:75], v[48:51], v[128:131]
ds_read_b64_tr_b16 v[168:169], v5 offset:36864
v_mfma_f32_16x16x32_bf16 v[132:135], v[76:79], v[48:51], v[132:135]
ds_read_b128 v[112:115], v2 offset:40960
v_mfma_f32_16x16x32_bf16 v[136:139], v[72:75], v[52:55], v[136:139]
ds_read_b64_tr_b16 v[170:171], v5 offset:38912
v_mfma_f32_16x16x32_bf16 v[140:143], v[76:79], v[52:55], v[140:143]
ds_read_b128 v[116:119], v2 offset:41216
v_mfma_f32_16x16x32_bf16 v[144:147], v[72:75], v[56:59], v[144:147]
ds_read_b64_tr_b16 v[172:173], v6 offset:36864
v_mfma_f32_16x16x32_bf16 v[148:151], v[76:79], v[56:59], v[148:151]
ds_read_b128 v[120:123], v2 offset:41472
v_mfma_f32_16x16x32_bf16 v[152:155], v[72:75], v[60:63], v[152:155]
ds_read_b64_tr_b16 v[174:175], v6 offset:38912
v_mfma_f32_16x16x32_bf16 v[156:159], v[76:79], v[60:63], v[156:159]
ds_read_b128 v[124:127], v2 offset:41728
s_waitcnt lgkmcnt(0)
s_barrier
v_mfma_f32_16x16x32_bf16 v[128:131], v[160:163], v[96:99], v[128:131]
ds_read_b64_tr_b16 v[64:65], v7 offset:0
v_mfma_f32_16x16x32_bf16 v[132:135], v[164:167], v[96:99], v[132:135]
ds_read_b128 v[32:35], v3 offset:0
v_mfma_f32_16x16x32_bf16 v[136:139], v[160:163], v[100:103], v[136:139]
ds_read_b64_tr_b16 v[66:67], v7 offset:2048
v_mfma_f32_16x16x32_bf16 v[140:143], v[164:167], v[100:103], v[140:143]
ds_read_b128 v[36:39], v3 offset:256
v_mfma_f32_16x16x32_bf16 v[144:147], v[160:163], v[104:107], v[144:147]
ds_read_b64_tr_b16 v[68:69], v8 offset:0
v_mfma_f32_16x16x32_bf16 v[148:151], v[164:167], v[104:107], v[148:151]
ds_read_b128 v[40:43], v3 offset:512
v_mfma_f32_16x16x32_bf16 v[152:155], v[160:163], v[108:111], v[152:155]
ds_read_b64_tr_b16 v[70:71], v8 offset:2048
v_mfma_f32_16x16x32_bf16 v[156:159], v[164:167], v[108:111], v[156:159]
ds_read_b128 v[44:47], v3 offset:768
v_mfma_f32_16x16x32_bf16 v[128:131], v[168:171], v[112:115], v[128:131]
ds_read_b64_tr_b16 v[80:81], v7 offset:8192
v_mfma_f32_16x16x32_bf16 v[132:135], v[172:175], v[112:115], v[132:135]
ds_read_b64_tr_b16 v[82:83], v7 offset:10240
v_mfma_f32_16x16x32_bf16 v[136:139], v[168:171], v[116:119], v[136:139]
ds_read_b64_tr_b16 v[84:85], v8 offset:8192
v_mfma_f32_16x16x32_bf16 v[140:143], v[172:175], v[116:119], v[140:143]
ds_read_b64_tr_b16 v[86:87], v8 offset:10240
v_mfma_f32_16x16x32_bf16 v[144:147], v[168:171], v[120:123], v[144:147]
ds_read_b64_tr_b16 v[72:73], v7 offset:4096
v_mfma_f32_16x16x32_bf16 v[148:151], v[172:175], v[120:123], v[148:151]
ds_read_b128 v[48:51], v3 offset:8192
v_mfma_f32_16x16x32_bf16 v[152:155], v[168:171], v[124:127], v[152:155]
ds_read_b64_tr_b16 v[74:75], v7 offset:6144
v_mfma_f32_16x16x32_bf16 v[156:159], v[172:175], v[124:127], v[156:159]
ds_read_b128 v[52:55], v3 offset:8448
ds_read_b64_tr_b16 v[76:77], v8 offset:4096
ds_read_b128 v[56:59], v3 offset:8704
ds_read_b64_tr_b16 v[78:79], v8 offset:6144
ds_read_b128 v[60:63], v3 offset:8960
ds_read_b64_tr_b16 v[88:89], v7 offset:12288
ds_read_b64_tr_b16 v[90:91], v7 offset:14336
ds_read_b64_tr_b16 v[92:93], v8 offset:12288
ds_read_b64_tr_b16 v[94:95], v8 offset:14336
s_mov_b32 s41, 4
Lk4_33:
s_waitcnt lgkmcnt(0)
s_barrier
v_mfma_f32_16x16x32_bf16 v[128:131], v[64:67], v[32:35], v[128:131]
ds_read_b64_tr_b16 v[160:161], v7 offset:32768
v_mfma_f32_16x16x32_bf16 v[132:135], v[68:71], v[32:35], v[132:135]
ds_read_b128 v[96:99], v3 offset:32768
v_mfma_f32_16x16x32_bf16 v[192:195], v[80:83], v[32:35], v[192:195]
ds_read_b64_tr_b16 v[162:163], v7 offset:34816
v_mfma_f32_16x16x32_bf16 v[196:199], v[84:87], v[32:35], v[196:199]
ds_read_b128 v[100:103], v3 offset:33024
v_mfma_f32_16x16x32_bf16 v[136:139], v[64:67], v[36:39], v[136:139]
ds_read_b64_tr_b16 v[164:165], v8 offset:32768
v_mfma_f32_16x16x32_bf16 v[140:143], v[68:71], v[36:39], v[140:143]
ds_read_b128 v[104:107], v3 offset:33280
v_mfma_f32_16x16x32_bf16 v[200:203], v[80:83], v[36:39], v[200:203]
ds_read_b64_tr_b16 v[166:167], v8 offset:34816
v_mfma_f32_16x16x32_bf16 v[204:207], v[84:87], v[36:39], v[204:207]
ds_read_b128 v[108:111], v3 offset:33536
v_mfma_f32_16x16x32_bf16 v[144:147], v[64:67], v[40:43], v[144:147]
ds_read_b64_tr_b16 v[176:177], v7 offset:40960
v_mfma_f32_16x16x32_bf16 v[148:151], v[68:71], v[40:43], v[148:151]
ds_read_b64_tr_b16 v[178:179], v7 offset:43008
v_mfma_f32_16x16x32_bf16 v[208:211], v[80:83], v[40:43], v[208:211]
ds_read_b64_tr_b16 v[180:181], v8 offset:40960
v_mfma_f32_16x16x32_bf16 v[212:215], v[84:87], v[40:43], v[212:215]
ds_read_b64_tr_b16 v[182:183], v8 offset:43008
v_mfma_f32_16x16x32_bf16 v[152:155], v[64:67], v[44:47], v[152:155]
ds_read_b64_tr_b16 v[168:169], v7 offset:36864
v_mfma_f32_16x16x32_bf16 v[156:159], v[68:71], v[44:47], v[156:159]
ds_read_b128 v[112:115], v3 offset:40960
v_mfma_f32_16x16x32_bf16 v[216:219], v[80:83], v[44:47], v[216:219]
ds_read_b64_tr_b16 v[170:171], v7 offset:38912
v_mfma_f32_16x16x32_bf16 v[220:223], v[84:87], v[44:47], v[220:223]
ds_read_b128 v[116:119], v3 offset:41216
v_mfma_f32_16x16x32_bf16 v[128:131], v[72:75], v[48:51], v[128:131]
ds_read_b64_tr_b16 v[172:173], v8 offset:36864
v_mfma_f32_16x16x32_bf16 v[132:135], v[76:79], v[48:51], v[132:135]
ds_read_b128 v[120:123], v3 offset:41472
v_mfma_f32_16x16x32_bf16 v[192:195], v[88:91], v[48:51], v[192:195]
ds_read_b64_tr_b16 v[174:175], v8 offset:38912
v_mfma_f32_16x16x32_bf16 v[196:199], v[92:95], v[48:51], v[196:199]
ds_read_b128 v[124:127], v3 offset:41728
v_mfma_f32_16x16x32_bf16 v[136:139], v[72:75], v[52:55], v[136:139]
ds_read_b64_tr_b16 v[184:185], v7 offset:45056
v_mfma_f32_16x16x32_bf16 v[140:143], v[76:79], v[52:55], v[140:143]
ds_read_b64_tr_b16 v[186:187], v7 offset:47104
v_mfma_f32_16x16x32_bf16 v[200:203], v[88:91], v[52:55], v[200:203]
ds_read_b64_tr_b16 v[188:189], v8 offset:45056
v_mfma_f32_16x16x32_bf16 v[204:207], v[92:95], v[52:55], v[204:207]
ds_read_b64_tr_b16 v[190:191], v8 offset:47104
v_mfma_f32_16x16x32_bf16 v[144:147], v[72:75], v[56:59], v[144:147]
v_mfma_f32_16x16x32_bf16 v[148:151], v[76:79], v[56:59], v[148:151]
v_mfma_f32_16x16x32_bf16 v[208:211], v[88:91], v[56:59], v[208:211]
v_mfma_f32_16x16x32_bf16 v[212:215], v[92:95], v[56:59], v[212:215]
v_mfma_f32_16x16x32_bf16 v[152:155], v[72:75], v[60:63], v[152:155]
v_mfma_f32_16x16x32_bf16 v[156:159], v[76:79], v[60:63], v[156:159]
v_mfma_f32_16x16x32_bf16 v[216:219], v[88:91], v[60:63], v[216:219]
v_mfma_f32_16x16x32_bf16 v[220:223], v[92:95], v[60:63], v[220:223]
s_waitcnt lgkmcnt(0)
s_barrier
v_mfma_f32_16x16x32_bf16 v[128:131], v[160:163], v[96:99], v[128:131]
ds_read_b64_tr_b16 v[64:65], v5 offset:0
v_mfma_f32_16x16x32_bf16 v[132:135], v[164:167], v[96:99], v[132:135]
ds_read_b128 v[32:35], v2 offset:0
v_mfma_f32_16x16x32_bf16 v[192:195], v[176:179], v[96:99], v[192:195]
ds_read_b64_tr_b16 v[66:67], v5 offset:2048
v_mfma_f32_16x16x32_bf16 v[196:199], v[180:183], v[96:99], v[196:199]
ds_read_b128 v[36:39], v2 offset:256
v_mfma_f32_16x16x32_bf16 v[136:139], v[160:163], v[100:103], v[136:139]
ds_read_b64_tr_b16 v[68:69], v6 offset:0
v_mfma_f32_16x16x32_bf16 v[140:143], v[164:167], v[100:103], v[140:143]
ds_read_b128 v[40:43], v2 offset:512
v_mfma_f32_16x16x32_bf16 v[200:203], v[176:179], v[100:103], v[200:203]
ds_read_b64_tr_b16 v[70:71], v6 offset:2048
v_mfma_f32_16x16x32_bf16 v[204:207], v[180:183], v[100:103], v[204:207]
ds_read_b128 v[44:47], v2 offset:768
v_mfma_f32_16x16x32_bf16 v[144:147], v[160:163], v[104:107], v[144:147]
ds_read_b64_tr_b16 v[80:81], v5 offset:8192
v_mfma_f32_16x16x32_bf16 v[148:151], v[164:167], v[104:107], v[148:151]
ds_read_b64_tr_b16 v[82:83], v5 offset:10240
v_mfma_f32_16x16x32_bf16 v[208:211], v[176:179], v[104:107], v[208:211]
ds_read_b64_tr_b16 v[84:85], v6 offset:8192
v_mfma_f32_16x16x32_bf16 v[212:215], v[180:183], v[104:107], v[212:215]
ds_read_b64_tr_b16 v[86:87], v6 offset:10240
v_mfma_f32_16x16x32_bf16 v[152:155], v[160:163], v[108:111], v[152:155]
ds_read_b64_tr_b16 v[72:73], v5 offset:4096
v_mfma_f32_16x16x32_bf16 v[156:159], v[164:167], v[108:111], v[156:159]
ds_read_b128 v[48:51], v2 offset:8192
v_mfma_f32_16x16x32_bf16 v[216:219], v[176:179], v[108:111], v[216:219]
ds_read_b64_tr_b16 v[74:75], v5 offset:6144
v_mfma_f32_16x16x32_bf16 v[220:223], v[180:183], v[108:111], v[220:223]
ds_read_b128 v[52:55], v2 offset:8448
v_mfma_f32_16x16x32_bf16 v[128:131], v[168:171], v[112:115], v[128:131]
ds_read_b64_tr_b16 v[76:77], v6 offset:4096
v_mfma_f32_16x16x32_bf16 v[132:135], v[172:175], v[112:115], v[132:135]
ds_read_b128 v[56:59], v2 offset:8704
v_mfma_f32_16x16x32_bf16 v[192:195], v[184:187], v[112:115], v[192:195]
ds_read_b64_tr_b16 v[78:79], v6 offset:6144
v_mfma_f32_16x16x32_bf16 v[196:199], v[188:191], v[112:115], v[196:199]
ds_read_b128 v[60:63], v2 offset:8960
v_mfma_f32_16x16x32_bf16 v[136:139], v[168:171], v[116:119], v[136:139]
ds_read_b64_tr_b16 v[88:89], v5 offset:12288
v_mfma_f32_16x16x32_bf16 v[140:143], v[172:175], v[116:119], v[140:143]
ds_read_b64_tr_b16 v[90:91], v5 offset:14336
v_mfma_f32_16x16x32_bf16 v[200:203], v[184:187], v[116:119], v[200:203]
ds_read_b64_tr_b16 v[92:93], v6 offset:12288
v_mfma_f32_16x16x32_bf16 v[204:207], v[188:191], v[116:119], v[204:207]
ds_read_b64_tr_b16 v[94:95], v6 offset:14336
v_mfma_f32_16x16x32_bf16 v[144:147], v[168:171], v[120:123], v[144:147]
v_mfma_f32_16x16x32_bf16 v[148:151], v[172:175], v[120:123], v[148:151]
v_mfma_f32_16x16x32_bf16 v[208:211], v[184:187], v[120:123], v[208:211]
v_mfma_f32_16x16x32_bf16 v[212:215], v[188:191], v[120:123], v[212:215]
v_mfma_f32_16x16x32_bf16 v[152:155], v[168:171], v[124:127], v[152:155]
v_mfma_f32_16x16x32_bf16 v[156:159], v[172:175], v[124:127], v[156:159]
v_mfma_f32_16x16x32_bf16 v[216:219], v[184:187], v[124:127], v[216:219]
v_mfma_f32_16x16x32_bf16 v[220:223], v[188:191], v[124:127], v[220:223]
s_waitcnt lgkmcnt(0)
s_barrier
v_mfma_f32_16x16x32_bf16 v[128:131], v[64:67], v[32:35], v[128:131]
ds_read_b64_tr_b16 v[160:161], v5 offset:32768
v_mfma_f32_16x16x32_bf16 v[132:135], v[68:71], v[32:35], v[132:135]
ds_read_b128 v[96:99], v2 offset:32768
v_mfma_f32_16x16x32_bf16 v[192:195], v[80:83], v[32:35], v[192:195]
ds_read_b64_tr_b16 v[162:163], v5 offset:34816
v_mfma_f32_16x16x32_bf16 v[196:199], v[84:87], v[32:35], v[196:199]
ds_read_b128 v[100:103], v2 offset:33024
v_mfma_f32_16x16x32_bf16 v[136:139], v[64:67], v[36:39], v[136:139]
ds_read_b64_tr_b16 v[164:165], v6 offset:32768
v_mfma_f32_16x16x32_bf16 v[140:143], v[68:71], v[36:39], v[140:143]
ds_read_b128 v[104:107], v2 offset:33280
v_mfma_f32_16x16x32_bf16 v[200:203], v[80:83], v[36:39], v[200:203]
ds_read_b64_tr_b16 v[166:167], v6 offset:34816
v_mfma_f32_16x16x32_bf16 v[204:207], v[84:87], v[36:39], v[204:207]
ds_read_b128 v[108:111], v2 offset:33536
v_mfma_f32_16x16x32_bf16 v[144:147], v[64:67], v[40:43], v[144:147]
ds_read_b64_tr_b16 v[176:177], v5 offset:40960
v_mfma_f32_16x16x32_bf16 v[148:151], v[68:71], v[40:43], v[148:151]
ds_read_b64_tr_b16 v[178:179], v5 offset:43008
v_mfma_f32_16x16x32_bf16 v[208:211], v[80:83], v[40:43], v[208:211]
ds_read_b64_tr_b16 v[180:181], v6 offset:40960
v_mfma_f32_16x16x32_bf16 v[212:215], v[84:87], v[40:43], v[212:215]
ds_read_b64_tr_b16 v[182:183], v6 offset:43008
v_mfma_f32_16x16x32_bf16 v[152:155], v[64:67], v[44:47], v[152:155]
ds_read_b64_tr_b16 v[168:169], v5 offset:36864
v_mfma_f32_16x16x32_bf16 v[156:159], v[68:71], v[44:47], v[156:159]
ds_read_b128 v[112:115], v2 offset:40960
v_mfma_f32_16x16x32_bf16 v[216:219], v[80:83], v[44:47], v[216:219]
ds_read_b64_tr_b16 v[170:171], v5 offset:38912
v_mfma_f32_16x16x32_bf16 v[220:223], v[84:87], v[44:47], v[220:223]
ds_read_b128 v[116:119], v2 offset:41216
v_mfma_f32_16x16x32_bf16 v[128:131], v[72:75], v[48:51], v[128:131]
ds_read_b64_tr_b16 v[172:173], v6 offset:36864
v_mfma_f32_16x16x32_bf16 v[132:135], v[76:79], v[48:51], v[132:135]
ds_read_b128 v[120:123], v2 offset:41472
v_mfma_f32_16x16x32_bf16 v[192:195], v[88:91], v[48:51], v[192:195]
ds_read_b64_tr_b16 v[174:175], v6 offset:38912
v_mfma_f32_16x16x32_bf16 v[196:199], v[92:95], v[48:51], v[196:199]
ds_read_b128 v[124:127], v2 offset:41728
v_mfma_f32_16x16x32_bf16 v[136:139], v[72:75], v[52:55], v[136:139]
ds_read_b64_tr_b16 v[184:185], v5 offset:45056
v_mfma_f32_16x16x32_bf16 v[140:143], v[76:79], v[52:55], v[140:143]
ds_read_b64_tr_b16 v[186:187], v5 offset:47104
v_mfma_f32_16x16x32_bf16 v[200:203], v[88:91], v[52:55], v[200:203]
ds_read_b64_tr_b16 v[188:189], v6 offset:45056
v_mfma_f32_16x16x32_bf16 v[204:207], v[92:95], v[52:55], v[204:207]
ds_read_b64_tr_b16 v[190:191], v6 offset:47104
v_mfma_f32_16x16x32_bf16 v[144:147], v[72:75], v[56:59], v[144:147]
v_mfma_f32_16x16x32_bf16 v[148:151], v[76:79], v[56:59], v[148:151]
v_mfma_f32_16x16x32_bf16 v[208:211], v[88:91], v[56:59], v[208:211]
v_mfma_f32_16x16x32_bf16 v[212:215], v[92:95], v[56:59], v[212:215]
v_mfma_f32_16x16x32_bf16 v[152:155], v[72:75], v[60:63], v[152:155]
v_mfma_f32_16x16x32_bf16 v[156:159], v[76:79], v[60:63], v[156:159]
v_mfma_f32_16x16x32_bf16 v[216:219], v[88:91], v[60:63], v[216:219]
v_mfma_f32_16x16x32_bf16 v[220:223], v[92:95], v[60:63], v[220:223]
s_waitcnt lgkmcnt(0)
s_barrier
v_mfma_f32_16x16x32_bf16 v[128:131], v[160:163], v[96:99], v[128:131]
ds_read_b64_tr_b16 v[64:65], v7 offset:0
v_mfma_f32_16x16x32_bf16 v[132:135], v[164:167], v[96:99], v[132:135]
ds_read_b128 v[32:35], v3 offset:0
v_mfma_f32_16x16x32_bf16 v[192:195], v[176:179], v[96:99], v[192:195]
ds_read_b64_tr_b16 v[66:67], v7 offset:2048
v_mfma_f32_16x16x32_bf16 v[196:199], v[180:183], v[96:99], v[196:199]
ds_read_b128 v[36:39], v3 offset:256
v_mfma_f32_16x16x32_bf16 v[136:139], v[160:163], v[100:103], v[136:139]
ds_read_b64_tr_b16 v[68:69], v8 offset:0
v_mfma_f32_16x16x32_bf16 v[140:143], v[164:167], v[100:103], v[140:143]
ds_read_b128 v[40:43], v3 offset:512
v_mfma_f32_16x16x32_bf16 v[200:203], v[176:179], v[100:103], v[200:203]
ds_read_b64_tr_b16 v[70:71], v8 offset:2048
v_mfma_f32_16x16x32_bf16 v[204:207], v[180:183], v[100:103], v[204:207]
ds_read_b128 v[44:47], v3 offset:768
v_mfma_f32_16x16x32_bf16 v[144:147], v[160:163], v[104:107], v[144:147]
ds_read_b64_tr_b16 v[80:81], v7 offset:8192
v_mfma_f32_16x16x32_bf16 v[148:151], v[164:167], v[104:107], v[148:151]
ds_read_b64_tr_b16 v[82:83], v7 offset:10240
v_mfma_f32_16x16x32_bf16 v[208:211], v[176:179], v[104:107], v[208:211]
ds_read_b64_tr_b16 v[84:85], v8 offset:8192
v_mfma_f32_16x16x32_bf16 v[212:215], v[180:183], v[104:107], v[212:215]
ds_read_b64_tr_b16 v[86:87], v8 offset:10240
v_mfma_f32_16x16x32_bf16 v[152:155], v[160:163], v[108:111], v[152:155]
ds_read_b64_tr_b16 v[72:73], v7 offset:4096
v_mfma_f32_16x16x32_bf16 v[156:159], v[164:167], v[108:111], v[156:159]
ds_read_b128 v[48:51], v3 offset:8192
v_mfma_f32_16x16x32_bf16 v[216:219], v[176:179], v[108:111], v[216:219]
ds_read_b64_tr_b16 v[74:75], v7 offset:6144
v_mfma_f32_16x16x32_bf16 v[220:223], v[180:183], v[108:111], v[220:223]
ds_read_b128 v[52:55], v3 offset:8448
v_mfma_f32_16x16x32_bf16 v[128:131], v[168:171], v[112:115], v[128:131]
ds_read_b64_tr_b16 v[76:77], v8 offset:4096
v_mfma_f32_16x16x32_bf16 v[132:135], v[172:175], v[112:115], v[132:135]
ds_read_b128 v[56:59], v3 offset:8704
v_mfma_f32_16x16x32_bf16 v[192:195], v[184:187], v[112:115], v[192:195]
ds_read_b64_tr_b16 v[78:79], v8 offset:6144
v_mfma_f32_16x16x32_bf16 v[196:199], v[188:191], v[112:115], v[196:199]
ds_read_b128 v[60:63], v3 offset:8960
v_mfma_f32_16x16x32_bf16 v[136:139], v[168:171], v[116:119], v[136:139]
ds_read_b64_tr_b16 v[88:89], v7 offset:12288
v_mfma_f32_16x16x32_bf16 v[140:143], v[172:175], v[116:119], v[140:143]
ds_read_b64_tr_b16 v[90:91], v7 offset:14336
v_mfma_f32_16x16x32_bf16 v[200:203], v[184:187], v[116:119], v[200:203]
ds_read_b64_tr_b16 v[92:93], v8 offset:12288
v_mfma_f32_16x16x32_bf16 v[204:207], v[188:191], v[116:119], v[204:207]
ds_read_b64_tr_b16 v[94:95], v8 offset:14336
v_mfma_f32_16x16x32_bf16 v[144:147], v[168:171], v[120:123], v[144:147]
v_mfma_f32_16x16x32_bf16 v[148:151], v[172:175], v[120:123], v[148:151]
v_mfma_f32_16x16x32_bf16 v[208:211], v[184:187], v[120:123], v[208:211]
v_mfma_f32_16x16x32_bf16 v[212:215], v[188:191], v[120:123], v[212:215]
v_mfma_f32_16x16x32_bf16 v[152:155], v[168:171], v[124:127], v[152:155]
v_mfma_f32_16x16x32_bf16 v[156:159], v[172:175], v[124:127], v[156:159]
v_mfma_f32_16x16x32_bf16 v[216:219], v[184:187], v[124:127], v[216:219]
v_mfma_f32_16x16x32_bf16 v[220:223], v[188:191], v[124:127], v[220:223]
s_sub_u32 s41, s41, 1
s_cmp_lg_u32 s41, 0
s_cbranch_scc1 Lk4_33
s_waitcnt lgkmcnt(0)
s_barrier
v_mfma_f32_16x16x32_bf16 v[128:131], v[64:67], v[32:35], v[128:131]
ds_read_b64_tr_b16 v[160:161], v7 offset:32768
v_mfma_f32_16x16x32_bf16 v[132:135], v[68:71], v[32:35], v[132:135]
ds_read_b128 v[96:99], v3 offset:32768
v_mfma_f32_16x16x32_bf16 v[192:195], v[80:83], v[32:35], v[192:195]
ds_read_b64_tr_b16 v[162:163], v7 offset:34816
v_mfma_f32_16x16x32_bf16 v[196:199], v[84:87], v[32:35], v[196:199]
ds_read_b128 v[100:103], v3 offset:33024
v_mfma_f32_16x16x32_bf16 v[136:139], v[64:67], v[36:39], v[136:139]
ds_read_b64_tr_b16 v[164:165], v8 offset:32768
v_mfma_f32_16x16x32_bf16 v[140:143], v[68:71], v[36:39], v[140:143]
ds_read_b128 v[104:107], v3 offset:33280
v_mfma_f32_16x16x32_bf16 v[200:203], v[80:83], v[36:39], v[200:203]
ds_read_b64_tr_b16 v[166:167], v8 offset:34816
v_mfma_f32_16x16x32_bf16 v[204:207], v[84:87], v[36:39], v[204:207]
ds_read_b128 v[108:111], v3 offset:33536
v_mfma_f32_16x16x32_bf16 v[144:147], v[64:67], v[40:43], v[144:147]
ds_read_b64_tr_b16 v[176:177], v7 offset:40960
v_mfma_f32_16x16x32_bf16 v[148:151], v[68:71], v[40:43], v[148:151]
ds_read_b64_tr_b16 v[178:179], v7 offset:43008
v_mfma_f32_16x16x32_bf16 v[208:211], v[80:83], v[40:43], v[208:211]
ds_read_b64_tr_b16 v[180:181], v8 offset:40960
v_mfma_f32_16x16x32_bf16 v[212:215], v[84:87], v[40:43], v[212:215]
ds_read_b64_tr_b16 v[182:183], v8 offset:43008
v_mfma_f32_16x16x32_bf16 v[152:155], v[64:67], v[44:47], v[152:155]
ds_read_b64_tr_b16 v[168:169], v7 offset:36864
v_mfma_f32_16x16x32_bf16 v[156:159], v[68:71], v[44:47], v[156:159]
ds_read_b128 v[112:115], v3 offset:40960
v_mfma_f32_16x16x32_bf16 v[216:219], v[80:83], v[44:47], v[216:219]
ds_read_b64_tr_b16 v[170:171], v7 offset:38912
v_mfma_f32_16x16x32_bf16 v[220:223], v[84:87], v[44:47], v[220:223]
ds_read_b128 v[116:119], v3 offset:41216
v_mfma_f32_16x16x32_bf16 v[128:131], v[72:75], v[48:51], v[128:131]
ds_read_b64_tr_b16 v[172:173], v8 offset:36864
v_mfma_f32_16x16x32_bf16 v[132:135], v[76:79], v[48:51], v[132:135]
ds_read_b128 v[120:123], v3 offset:41472
v_mfma_f32_16x16x32_bf16 v[192:195], v[88:91], v[48:51], v[192:195]
ds_read_b64_tr_b16 v[174:175], v8 offset:38912
v_mfma_f32_16x16x32_bf16 v[196:199], v[92:95], v[48:51], v[196:199]
ds_read_b128 v[124:127], v3 offset:41728
v_mfma_f32_16x16x32_bf16 v[136:139], v[72:75], v[52:55], v[136:139]
ds_read_b64_tr_b16 v[184:185], v7 offset:45056
v_mfma_f32_16x16x32_bf16 v[140:143], v[76:79], v[52:55], v[140:143]
ds_read_b64_tr_b16 v[186:187], v7 offset:47104
v_mfma_f32_16x16x32_bf16 v[200:203], v[88:91], v[52:55], v[200:203]
ds_read_b64_tr_b16 v[188:189], v8 offset:45056
v_mfma_f32_16x16x32_bf16 v[204:207], v[92:95], v[52:55], v[204:207]
ds_read_b64_tr_b16 v[190:191], v8 offset:47104
v_mfma_f32_16x16x32_bf16 v[144:147], v[72:75], v[56:59], v[144:147]
v_mfma_f32_16x16x32_bf16 v[148:151], v[76:79], v[56:59], v[148:151]
v_mfma_f32_16x16x32_bf16 v[208:211], v[88:91], v[56:59], v[208:211]
v_mfma_f32_16x16x32_bf16 v[212:215], v[92:95], v[56:59], v[212:215]
v_mfma_f32_16x16x32_bf16 v[152:155], v[72:75], v[60:63], v[152:155]
v_mfma_f32_16x16x32_bf16 v[156:159], v[76:79], v[60:63], v[156:159]
v_mfma_f32_16x16x32_bf16 v[216:219], v[88:91], v[60:63], v[216:219]
v_mfma_f32_16x16x32_bf16 v[220:223], v[92:95], v[60:63], v[220:223]
s_waitcnt lgkmcnt(0)
s_barrier
v_mfma_f32_16x16x32_bf16 v[128:131], v[160:163], v[96:99], v[128:131]
ds_read_b64_tr_b16 v[64:65], v5 offset:0
v_mfma_f32_16x16x32_bf16 v[132:135], v[164:167], v[96:99], v[132:135]
ds_read_b128 v[32:35], v2 offset:0
v_mfma_f32_16x16x32_bf16 v[192:195], v[176:179], v[96:99], v[192:195]
ds_read_b64_tr_b16 v[66:67], v5 offset:2048
v_mfma_f32_16x16x32_bf16 v[196:199], v[180:183], v[96:99], v[196:199]
ds_read_b128 v[36:39], v2 offset:256
v_mfma_f32_16x16x32_bf16 v[136:139], v[160:163], v[100:103], v[136:139]
ds_read_b64_tr_b16 v[68:69], v6 offset:0
v_mfma_f32_16x16x32_bf16 v[140:143], v[164:167], v[100:103], v[140:143]
ds_read_b128 v[40:43], v2 offset:512
v_mfma_f32_16x16x32_bf16 v[200:203], v[176:179], v[100:103], v[200:203]
ds_read_b64_tr_b16 v[70:71], v6 offset:2048
v_mfma_f32_16x16x32_bf16 v[204:207], v[180:183], v[100:103], v[204:207]
ds_read_b128 v[44:47], v2 offset:768
v_mfma_f32_16x16x32_bf16 v[144:147], v[160:163], v[104:107], v[144:147]
ds_read_b64_tr_b16 v[80:81], v5 offset:8192
v_mfma_f32_16x16x32_bf16 v[148:151], v[164:167], v[104:107], v[148:151]
ds_read_b64_tr_b16 v[82:83], v5 offset:10240
v_mfma_f32_16x16x32_bf16 v[208:211], v[176:179], v[104:107], v[208:211]
ds_read_b64_tr_b16 v[84:85], v6 offset:8192
v_mfma_f32_16x16x32_bf16 v[212:215], v[180:183], v[104:107], v[212:215]
ds_read_b64_tr_b16 v[86:87], v6 offset:10240
v_mfma_f32_16x16x32_bf16 v[152:155], v[160:163], v[108:111], v[152:155]
ds_read_b64_tr_b16 v[72:73], v5 offset:4096
v_mfma_f32_16x16x32_bf16 v[156:159], v[164:167], v[108:111], v[156:159]
ds_read_b128 v[48:51], v2 offset:8192
v_mfma_f32_16x16x32_bf16 v[216:219], v[176:179], v[108:111], v[216:219]
ds_read_b64_tr_b16 v[74:75], v5 offset:6144
v_mfma_f32_16x16x32_bf16 v[220:223], v[180:183], v[108:111], v[220:223]
ds_read_b128 v[52:55], v2 offset:8448
v_mfma_f32_16x16x32_bf16 v[128:131], v[168:171], v[112:115], v[128:131]
ds_read_b64_tr_b16 v[76:77], v6 offset:4096
v_mfma_f32_16x16x32_bf16 v[132:135], v[172:175], v[112:115], v[132:135]
ds_read_b128 v[56:59], v2 offset:8704
v_mfma_f32_16x16x32_bf16 v[192:195], v[184:187], v[112:115], v[192:195]
ds_read_b64_tr_b16 v[78:79], v6 offset:6144
v_mfma_f32_16x16x32_bf16 v[196:199], v[188:191], v[112:115], v[196:199]
ds_read_b128 v[60:63], v2 offset:8960
v_mfma_f32_16x16x32_bf16 v[136:139], v[168:171], v[116:119], v[136:139]
ds_read_b64_tr_b16 v[88:89], v5 offset:12288
v_mfma_f32_16x16x32_bf16 v[140:143], v[172:175], v[116:119], v[140:143]
ds_read_b64_tr_b16 v[90:91], v5 offset:14336
v_mfma_f32_16x16x32_bf16 v[200:203], v[184:187], v[116:119], v[200:203]
ds_read_b64_tr_b16 v[92:93], v6 offset:12288
v_mfma_f32_16x16x32_bf16 v[204:207], v[188:191], v[116:119], v[204:207]
ds_read_b64_tr_b16 v[94:95], v6 offset:14336
v_mfma_f32_16x16x32_bf16 v[144:147], v[168:171], v[120:123], v[144:147]
v_mfma_f32_16x16x32_bf16 v[148:151], v[172:175], v[120:123], v[148:151]
v_mfma_f32_16x16x32_bf16 v[208:211], v[184:187], v[120:123], v[208:211]
v_mfma_f32_16x16x32_bf16 v[212:215], v[188:191], v[120:123], v[212:215]
v_mfma_f32_16x16x32_bf16 v[152:155], v[168:171], v[124:127], v[152:155]
v_mfma_f32_16x16x32_bf16 v[156:159], v[172:175], v[124:127], v[156:159]
v_mfma_f32_16x16x32_bf16 v[216:219], v[184:187], v[124:127], v[216:219]
v_mfma_f32_16x16x32_bf16 v[220:223], v[188:191], v[124:127], v[220:223]
s_waitcnt lgkmcnt(0)
s_barrier
v_mfma_f32_16x16x32_bf16 v[128:131], v[64:67], v[32:35], v[128:131]
ds_read_b64_tr_b16 v[160:161], v5 offset:32768
v_mfma_f32_16x16x32_bf16 v[132:135], v[68:71], v[32:35], v[132:135]
ds_read_b128 v[96:99], v2 offset:32768
v_mfma_f32_16x16x32_bf16 v[192:195], v[80:83], v[32:35], v[192:195]
ds_read_b64_tr_b16 v[162:163], v5 offset:34816
v_mfma_f32_16x16x32_bf16 v[196:199], v[84:87], v[32:35], v[196:199]
ds_read_b128 v[100:103], v2 offset:33024
v_mfma_f32_16x16x32_bf16 v[136:139], v[64:67], v[36:39], v[136:139]
ds_read_b64_tr_b16 v[164:165], v6 offset:32768
v_mfma_f32_16x16x32_bf16 v[140:143], v[68:71], v[36:39], v[140:143]
ds_read_b128 v[104:107], v2 offset:33280
v_mfma_f32_16x16x32_bf16 v[200:203], v[80:83], v[36:39], v[200:203]
ds_read_b64_tr_b16 v[166:167], v6 offset:34816
v_mfma_f32_16x16x32_bf16 v[204:207], v[84:87], v[36:39], v[204:207]
ds_read_b128 v[108:111], v2 offset:33536
v_mfma_f32_16x16x32_bf16 v[144:147], v[64:67], v[40:43], v[144:147]
ds_read_b64_tr_b16 v[176:177], v5 offset:40960
v_mfma_f32_16x16x32_bf16 v[148:151], v[68:71], v[40:43], v[148:151]
ds_read_b64_tr_b16 v[178:179], v5 offset:43008
v_mfma_f32_16x16x32_bf16 v[208:211], v[80:83], v[40:43], v[208:211]
ds_read_b64_tr_b16 v[180:181], v6 offset:40960
v_mfma_f32_16x16x32_bf16 v[212:215], v[84:87], v[40:43], v[212:215]
ds_read_b64_tr_b16 v[182:183], v6 offset:43008
v_mfma_f32_16x16x32_bf16 v[152:155], v[64:67], v[44:47], v[152:155]
ds_read_b64_tr_b16 v[168:169], v5 offset:36864
v_mfma_f32_16x16x32_bf16 v[156:159], v[68:71], v[44:47], v[156:159]
ds_read_b128 v[112:115], v2 offset:40960
v_mfma_f32_16x16x32_bf16 v[216:219], v[80:83], v[44:47], v[216:219]
ds_read_b64_tr_b16 v[170:171], v5 offset:38912
v_mfma_f32_16x16x32_bf16 v[220:223], v[84:87], v[44:47], v[220:223]
ds_read_b128 v[116:119], v2 offset:41216
v_mfma_f32_16x16x32_bf16 v[128:131], v[72:75], v[48:51], v[128:131]
ds_read_b64_tr_b16 v[172:173], v6 offset:36864
v_mfma_f32_16x16x32_bf16 v[132:135], v[76:79], v[48:51], v[132:135]
ds_read_b128 v[120:123], v2 offset:41472
v_mfma_f32_16x16x32_bf16 v[192:195], v[88:91], v[48:51], v[192:195]
ds_read_b64_tr_b16 v[174:175], v6 offset:38912
v_mfma_f32_16x16x32_bf16 v[196:199], v[92:95], v[48:51], v[196:199]
ds_read_b128 v[124:127], v2 offset:41728
v_mfma_f32_16x16x32_bf16 v[136:139], v[72:75], v[52:55], v[136:139]
ds_read_b64_tr_b16 v[184:185], v5 offset:45056
v_mfma_f32_16x16x32_bf16 v[140:143], v[76:79], v[52:55], v[140:143]
ds_read_b64_tr_b16 v[186:187], v5 offset:47104
v_mfma_f32_16x16x32_bf16 v[200:203], v[88:91], v[52:55], v[200:203]
ds_read_b64_tr_b16 v[188:189], v6 offset:45056
v_mfma_f32_16x16x32_bf16 v[204:207], v[92:95], v[52:55], v[204:207]
ds_read_b64_tr_b16 v[190:191], v6 offset:47104
v_mfma_f32_16x16x32_bf16 v[144:147], v[72:75], v[56:59], v[144:147]
v_mfma_f32_16x16x32_bf16 v[148:151], v[76:79], v[56:59], v[148:151]
v_mfma_f32_16x16x32_bf16 v[208:211], v[88:91], v[56:59], v[208:211]
v_mfma_f32_16x16x32_bf16 v[212:215], v[92:95], v[56:59], v[212:215]
v_mfma_f32_16x16x32_bf16 v[152:155], v[72:75], v[60:63], v[152:155]
v_mfma_f32_16x16x32_bf16 v[156:159], v[76:79], v[60:63], v[156:159]
v_mfma_f32_16x16x32_bf16 v[216:219], v[88:91], v[60:63], v[216:219]
v_mfma_f32_16x16x32_bf16 v[220:223], v[92:95], v[60:63], v[220:223]
s_waitcnt lgkmcnt(0)
s_barrier
v_mfma_f32_16x16x32_bf16 v[128:131], v[160:163], v[96:99], v[128:131]
ds_read_b64_tr_b16 v[64:65], v7 offset:0
v_mfma_f32_16x16x32_bf16 v[132:135], v[164:167], v[96:99], v[132:135]
ds_read_b128 v[32:35], v3 offset:0
v_mfma_f32_16x16x32_bf16 v[192:195], v[176:179], v[96:99], v[192:195]
ds_read_b64_tr_b16 v[66:67], v7 offset:2048
v_mfma_f32_16x16x32_bf16 v[196:199], v[180:183], v[96:99], v[196:199]
ds_read_b128 v[36:39], v3 offset:256
v_mfma_f32_16x16x32_bf16 v[136:139], v[160:163], v[100:103], v[136:139]
ds_read_b64_tr_b16 v[68:69], v8 offset:0
v_mfma_f32_16x16x32_bf16 v[140:143], v[164:167], v[100:103], v[140:143]
ds_read_b128 v[40:43], v3 offset:512
v_mfma_f32_16x16x32_bf16 v[200:203], v[176:179], v[100:103], v[200:203]
ds_read_b64_tr_b16 v[70:71], v8 offset:2048
v_mfma_f32_16x16x32_bf16 v[204:207], v[180:183], v[100:103], v[204:207]
ds_read_b128 v[44:47], v3 offset:768
v_mfma_f32_16x16x32_bf16 v[144:147], v[160:163], v[104:107], v[144:147]
ds_read_b64_tr_b16 v[72:73], v7 offset:4096
v_mfma_f32_16x16x32_bf16 v[148:151], v[164:167], v[104:107], v[148:151]
ds_read_b128 v[48:51], v3 offset:8192
v_mfma_f32_16x16x32_bf16 v[208:211], v[176:179], v[104:107], v[208:211]
ds_read_b64_tr_b16 v[74:75], v7 offset:6144
v_mfma_f32_16x16x32_bf16 v[212:215], v[180:183], v[104:107], v[212:215]
ds_read_b128 v[52:55], v3 offset:8448
v_mfma_f32_16x16x32_bf16 v[152:155], v[160:163], v[108:111], v[152:155]
ds_read_b64_tr_b16 v[76:77], v8 offset:4096
v_mfma_f32_16x16x32_bf16 v[156:159], v[164:167], v[108:111], v[156:159]
ds_read_b128 v[56:59], v3 offset:8704
v_mfma_f32_16x16x32_bf16 v[216:219], v[176:179], v[108:111], v[216:219]
ds_read_b64_tr_b16 v[78:79], v8 offset:6144
v_mfma_f32_16x16x32_bf16 v[220:223], v[180:183], v[108:111], v[220:223]
ds_read_b128 v[60:63], v3 offset:8960
v_mfma_f32_16x16x32_bf16 v[128:131], v[168:171], v[112:115], v[128:131]
v_mfma_f32_16x16x32_bf16 v[132:135], v[172:175], v[112:115], v[132:135]
v_mfma_f32_16x16x32_bf16 v[192:195], v[184:187], v[112:115], v[192:195]
v_mfma_f32_16x16x32_bf16 v[196:199], v[188:191], v[112:115], v[196:199]
v_mfma_f32_16x16x32_bf16 v[136:139], v[168:171], v[116:119], v[136:139]
v_mfma_f32_16x16x32_bf16 v[140:143], v[172:175], v[116:119], v[140:143]
v_mfma_f32_16x16x32_bf16 v[200:203], v[184:187], v[116:119], v[200:203]
v_mfma_f32_16x16x32_bf16 v[204:207], v[188:191], v[116:119], v[204:207]
v_mfma_f32_16x16x32_bf16 v[144:147], v[168:171], v[120:123], v[144:147]
v_mfma_f32_16x16x32_bf16 v[148:151], v[172:175], v[120:123], v[148:151]
v_mfma_f32_16x16x32_bf16 v[208:211], v[184:187], v[120:123], v[208:211]
v_mfma_f32_16x16x32_bf16 v[212:215], v[188:191], v[120:123], v[212:215]
v_mfma_f32_16x16x32_bf16 v[152:155], v[168:171], v[124:127], v[152:155]
v_mfma_f32_16x16x32_bf16 v[156:159], v[172:175], v[124:127], v[156:159]
v_mfma_f32_16x16x32_bf16 v[216:219], v[184:187], v[124:127], v[216:219]
v_mfma_f32_16x16x32_bf16 v[220:223], v[188:191], v[124:127], v[220:223]
s_mov_b32 s54, 0x10000
s_waitcnt lgkmcnt(0)
s_barrier
v_mfma_f32_16x16x32_bf16 v[128:131], v[64:67], v[32:35], v[128:131]
ds_read_b64_tr_b16 v[160:161], v7 offset:32768
v_mfma_f32_16x16x32_bf16 v[132:135], v[68:71], v[32:35], v[132:135]
ds_read_b128 v[96:99], v3 offset:32768
v_mfma_f32_16x16x32_bf16 v[136:139], v[64:67], v[36:39], v[136:139]
ds_read_b64_tr_b16 v[162:163], v7 offset:34816
v_mfma_f32_16x16x32_bf16 v[140:143], v[68:71], v[36:39], v[140:143]
ds_read_b128 v[100:103], v3 offset:33024
v_cvt_pk_bf16_f32 v224, v192, v193
v_mfma_f32_16x16x32_bf16 v[144:147], v[64:67], v[40:43], v[144:147]
ds_read_b64_tr_b16 v[164:165], v8 offset:32768
v_cvt_pk_bf16_f32 v225, v194, v195
v_mfma_f32_16x16x32_bf16 v[148:151], v[68:71], v[40:43], v[148:151]
v_cvt_pk_bf16_f32 v226, v196, v197
ds_read_b128 v[104:107], v3 offset:33280
v_cvt_pk_bf16_f32 v227, v198, v199
v_mfma_f32_16x16x32_bf16 v[152:155], v[64:67], v[44:47], v[152:155]
buffer_store_dwordx4 v[224:227], v9, s[64:67], 0 offen offset:0 sc1
ds_read_b64_tr_b16 v[166:167], v8 offset:34816
v_cvt_pk_bf16_f32 v228, v200, v201
v_mfma_f32_16x16x32_bf16 v[156:159], v[68:71], v[44:47], v[156:159]
ds_read_b128 v[108:111], v3 offset:33536
v_cvt_pk_bf16_f32 v229, v202, v203
v_mfma_f32_16x16x32_bf16 v[128:131], v[72:75], v[48:51], v[128:131]
v_cvt_pk_bf16_f32 v230, v204, v205
ds_read_b64_tr_b16 v[168:169], v7 offset:36864
v_cvt_pk_bf16_f32 v231, v206, v207
v_mfma_f32_16x16x32_bf16 v[132:135], v[76:79], v[48:51], v[132:135]
buffer_store_dwordx4 v[228:231], v9, s[64:67], 0 offen offset:1024 sc1
ds_read_b128 v[112:115], v3 offset:40960
v_cvt_pk_bf16_f32 v232, v208, v209
v_mfma_f32_16x16x32_bf16 v[136:139], v[72:75], v[52:55], v[136:139]
ds_read_b64_tr_b16 v[170:171], v7 offset:38912
v_cvt_pk_bf16_f32 v233, v210, v211
v_mfma_f32_16x16x32_bf16 v[140:143], v[76:79], v[52:55], v[140:143]
v_cvt_pk_bf16_f32 v234, v212, v213
ds_read_b128 v[116:119], v3 offset:41216
v_cvt_pk_bf16_f32 v235, v214, v215
v_mfma_f32_16x16x32_bf16 v[144:147], v[72:75], v[56:59], v[144:147]
buffer_store_dwordx4 v[232:235], v9, s[64:67], 0 offen offset:2048 sc1
ds_read_b64_tr_b16 v[172:173], v8 offset:36864
v_cvt_pk_bf16_f32 v236, v216, v217
v_mfma_f32_16x16x32_bf16 v[148:151], v[76:79], v[56:59], v[148:151]
ds_read_b128 v[120:123], v3 offset:41472
v_cvt_pk_bf16_f32 v237, v218, v219
v_mfma_f32_16x16x32_bf16 v[152:155], v[72:75], v[60:63], v[152:155]
v_cvt_pk_bf16_f32 v238, v220, v221
ds_read_b64_tr_b16 v[174:175], v8 offset:38912
v_cvt_pk_bf16_f32 v239, v222, v223
v_mfma_f32_16x16x32_bf16 v[156:159], v[76:79], v[60:63], v[156:159]
buffer_store_dwordx4 v[236:239], v9, s[64:67], 0 offen offset:3072 sc1
ds_read_b128 v[124:127], v3 offset:41728
s_waitcnt lgkmcnt(0)
s_barrier
v_mfma_f32_16x16x32_bf16 v[128:131], v[160:163], v[96:99], v[128:131]
ds_read_b64_tr_b16 v[64:65], v5 offset:0
v_mfma_f32_16x16x32_bf16 v[132:135], v[164:167], v[96:99], v[132:135]
ds_read_b128 v[32:35], v2 offset:0
v_mfma_f32_16x16x32_bf16 v[136:139], v[160:163], v[100:103], v[136:139]
ds_read_b64_tr_b16 v[66:67], v5 offset:2048
v_mfma_f32_16x16x32_bf16 v[140:143], v[164:167], v[100:103], v[140:143]
ds_read_b128 v[36:39], v2 offset:256
v_mfma_f32_16x16x32_bf16 v[144:147], v[160:163], v[104:107], v[144:147]
ds_read_b64_tr_b16 v[68:69], v6 offset:0
v_mfma_f32_16x16x32_bf16 v[148:151], v[164:167], v[104:107], v[148:151]
ds_read_b128 v[40:43], v2 offset:512
v_mfma_f32_16x16x32_bf16 v[152:155], v[160:163], v[108:111], v[152:155]
ds_read_b64_tr_b16 v[70:71], v6 offset:2048
v_mfma_f32_16x16x32_bf16 v[156:159], v[164:167], v[108:111], v[156:159]
ds_read_b128 v[44:47], v2 offset:768
v_mfma_f32_16x16x32_bf16 v[128:131], v[168:171], v[112:115], v[128:131]
ds_read_b64_tr_b16 v[72:73], v5 offset:4096
v_mfma_f32_16x16x32_bf16 v[132:135], v[172:175], v[112:115], v[132:135]
ds_read_b128 v[48:51], v2 offset:8192
v_mfma_f32_16x16x32_bf16 v[136:139], v[168:171], v[116:119], v[136:139]
ds_read_b64_tr_b16 v[74:75], v5 offset:6144
v_mfma_f32_16x16x32_bf16 v[140:143], v[172:175], v[116:119], v[140:143]
ds_read_b128 v[52:55], v2 offset:8448
v_mfma_f32_16x16x32_bf16 v[144:147], v[168:171], v[120:123], v[144:147]
ds_read_b64_tr_b16 v[76:77], v6 offset:4096
v_mfma_f32_16x16x32_bf16 v[148:151], v[172:175], v[120:123], v[148:151]
ds_read_b128 v[56:59], v2 offset:8704
v_mfma_f32_16x16x32_bf16 v[152:155], v[168:171], v[124:127], v[152:155]
ds_read_b64_tr_b16 v[78:79], v6 offset:6144
v_mfma_f32_16x16x32_bf16 v[156:159], v[172:175], v[124:127], v[156:159]
ds_read_b128 v[60:63], v2 offset:8960
s_waitcnt lgkmcnt(0)
s_barrier
v_mfma_f32_16x16x32_bf16 v[128:131], v[64:67], v[32:35], v[128:131]
ds_read_b64_tr_b16 v[160:161], v5 offset:32768
v_mfma_f32_16x16x32_bf16 v[132:135], v[68:71], v[32:35], v[132:135]
ds_read_b128 v[96:99], v2 offset:32768
v_mfma_f32_16x16x32_bf16 v[136:139], v[64:67], v[36:39], v[136:139]
ds_read_b64_tr_b16 v[162:163], v5 offset:34816
v_mfma_f32_16x16x32_bf16 v[140:143], v[68:71], v[36:39], v[140:143]
ds_read_b128 v[100:103], v2 offset:33024
v_mfma_f32_16x16x32_bf16 v[144:147], v[64:67], v[40:43], v[144:147]
ds_read_b64_tr_b16 v[164:165], v6 offset:32768
v_mfma_f32_16x16x32_bf16 v[148:151], v[68:71], v[40:43], v[148:151]
ds_read_b128 v[104:107], v2 offset:33280
v_mfma_f32_16x16x32_bf16 v[152:155], v[64:67], v[44:47], v[152:155]
ds_read_b64_tr_b16 v[166:167], v6 offset:34816
v_mfma_f32_16x16x32_bf16 v[156:159], v[68:71], v[44:47], v[156:159]
ds_read_b128 v[108:111], v2 offset:33536
v_mfma_f32_16x16x32_bf16 v[128:131], v[72:75], v[48:51], v[128:131]
ds_read_b64_tr_b16 v[168:169], v5 offset:36864
v_mfma_f32_16x16x32_bf16 v[132:135], v[76:79], v[48:51], v[132:135]
ds_read_b128 v[112:115], v2 offset:40960
v_mfma_f32_16x16x32_bf16 v[136:139], v[72:75], v[52:55], v[136:139]
ds_read_b64_tr_b16 v[170:171], v5 offset:38912
v_mfma_f32_16x16x32_bf16 v[140:143], v[76:79], v[52:55], v[140:143]
ds_read_b128 v[116:119], v2 offset:41216
v_mfma_f32_16x16x32_bf16 v[144:147], v[72:75], v[56:59], v[144:147]
ds_read_b64_tr_b16 v[172:173], v6 offset:36864
v_mfma_f32_16x16x32_bf16 v[148:151], v[76:79], v[56:59], v[148:151]
ds_read_b128 v[120:123], v2 offset:41472
v_mfma_f32_16x16x32_bf16 v[152:155], v[72:75], v[60:63], v[152:155]
ds_read_b64_tr_b16 v[174:175], v6 offset:38912
v_mfma_f32_16x16x32_bf16 v[156:159], v[76:79], v[60:63], v[156:159]
ds_read_b128 v[124:127], v2 offset:41728
s_waitcnt vmcnt(0) lgkmcnt(0)
s_barrier
v_mfma_f32_16x16x32_bf16 v[128:131], v[160:163], v[96:99], v[128:131]
ds_read_b64_tr_b16 v[64:65], v7 offset:0
v_mfma_f32_16x16x32_bf16 v[132:135], v[164:167], v[96:99], v[132:135]
ds_read_b128 v[32:35], v3 offset:0
v_mfma_f32_16x16x32_bf16 v[136:139], v[160:163], v[100:103], v[136:139]
ds_read_b64_tr_b16 v[66:67], v7 offset:2048
v_mfma_f32_16x16x32_bf16 v[140:143], v[164:167], v[100:103], v[140:143]
ds_read_b128 v[36:39], v3 offset:256
v_mfma_f32_16x16x32_bf16 v[144:147], v[160:163], v[104:107], v[144:147]
ds_read_b64_tr_b16 v[68:69], v8 offset:0
v_mfma_f32_16x16x32_bf16 v[148:151], v[164:167], v[104:107], v[148:151]
ds_read_b128 v[40:43], v3 offset:512
v_mfma_f32_16x16x32_bf16 v[152:155], v[160:163], v[108:111], v[152:155]
ds_read_b64_tr_b16 v[70:71], v8 offset:2048
v_mfma_f32_16x16x32_bf16 v[156:159], v[164:167], v[108:111], v[156:159]
ds_read_b128 v[44:47], v3 offset:768
v_mfma_f32_16x16x32_bf16 v[128:131], v[168:171], v[112:115], v[128:131]
ds_read_b64_tr_b16 v[72:73], v7 offset:4096
v_mfma_f32_16x16x32_bf16 v[132:135], v[172:175], v[112:115], v[132:135]
ds_read_b128 v[48:51], v3 offset:8192
v_mfma_f32_16x16x32_bf16 v[136:139], v[168:171], v[116:119], v[136:139]
ds_read_b64_tr_b16 v[74:75], v7 offset:6144
v_mfma_f32_16x16x32_bf16 v[140:143], v[172:175], v[116:119], v[140:143]
ds_read_b128 v[52:55], v3 offset:8448
v_mfma_f32_16x16x32_bf16 v[144:147], v[168:171], v[120:123], v[144:147]
ds_read_b64_tr_b16 v[76:77], v8 offset:4096
v_mfma_f32_16x16x32_bf16 v[148:151], v[172:175], v[120:123], v[148:151]
ds_read_b128 v[56:59], v3 offset:8704
v_mfma_f32_16x16x32_bf16 v[152:155], v[168:171], v[124:127], v[152:155]
ds_read_b64_tr_b16 v[78:79], v8 offset:6144
v_mfma_f32_16x16x32_bf16 v[156:159], v[172:175], v[124:127], v[156:159]
ds_read_b128 v[60:63], v3 offset:8960
s_waitcnt lgkmcnt(0)
s_barrier
v_mfma_f32_16x16x32_bf16 v[128:131], v[64:67], v[32:35], v[128:131]
ds_read_b64_tr_b16 v[160:161], v7 offset:32768
v_mfma_f32_16x16x32_bf16 v[132:135], v[68:71], v[32:35], v[132:135]
ds_read_b128 v[96:99], v3 offset:32768
v_mfma_f32_16x16x32_bf16 v[136:139], v[64:67], v[36:39], v[136:139]
ds_read_b64_tr_b16 v[162:163], v7 offset:34816
v_mfma_f32_16x16x32_bf16 v[140:143], v[68:71], v[36:39], v[140:143]
ds_read_b128 v[100:103], v3 offset:33024
v_mfma_f32_16x16x32_bf16 v[144:147], v[64:67], v[40:43], v[144:147]
ds_read_b64_tr_b16 v[164:165], v8 offset:32768
v_mfma_f32_16x16x32_bf16 v[148:151], v[68:71], v[40:43], v[148:151]
ds_read_b128 v[104:107], v3 offset:33280
v_mfma_f32_16x16x32_bf16 v[152:155], v[64:67], v[44:47], v[152:155]
ds_read_b64_tr_b16 v[166:167], v8 offset:34816
v_mfma_f32_16x16x32_bf16 v[156:159], v[68:71], v[44:47], v[156:159]
ds_read_b128 v[108:111], v3 offset:33536
v_mfma_f32_16x16x32_bf16 v[128:131], v[72:75], v[48:51], v[128:131]
ds_read_b64_tr_b16 v[168:169], v7 offset:36864
v_mfma_f32_16x16x32_bf16 v[132:135], v[76:79], v[48:51], v[132:135]
ds_read_b128 v[112:115], v3 offset:40960
v_mfma_f32_16x16x32_bf16 v[136:139], v[72:75], v[52:55], v[136:139]
ds_read_b64_tr_b16 v[170:171], v7 offset:38912
v_mfma_f32_16x16x32_bf16 v[140:143], v[76:79], v[52:55], v[140:143]
ds_read_b128 v[116:119], v3 offset:41216
v_mfma_f32_16x16x32_bf16 v[144:147], v[72:75], v[56:59], v[144:147]
ds_read_b64_tr_b16 v[172:173], v8 offset:36864
v_mfma_f32_16x16x32_bf16 v[148:151], v[76:79], v[56:59], v[148:151]
ds_read_b128 v[120:123], v3 offset:41472
v_mfma_f32_16x16x32_bf16 v[152:155], v[72:75], v[60:63], v[152:155]
ds_read_b64_tr_b16 v[174:175], v8 offset:38912
v_mfma_f32_16x16x32_bf16 v[156:159], v[76:79], v[60:63], v[156:159]
ds_read_b128 v[124:127], v3 offset:41728
s_waitcnt lgkmcnt(0)
s_barrier
v_mfma_f32_16x16x32_bf16 v[128:131], v[160:163], v[96:99], v[128:131]
ds_read_b64_tr_b16 v[64:65], v5 offset:0
v_mfma_f32_16x16x32_bf16 v[132:135], v[164:167], v[96:99], v[132:135]
ds_read_b128 v[32:35], v2 offset:0
v_mfma_f32_16x16x32_bf16 v[136:139], v[160:163], v[100:103], v[136:139]
ds_read_b64_tr_b16 v[66:67], v5 offset:2048
v_mfma_f32_16x16x32_bf16 v[140:143], v[164:167], v[100:103], v[140:143]
ds_read_b128 v[36:39], v2 offset:256
v_mfma_f32_16x16x32_bf16 v[144:147], v[160:163], v[104:107], v[144:147]
ds_read_b64_tr_b16 v[68:69], v6 offset:0
v_mfma_f32_16x16x32_bf16 v[148:151], v[164:167], v[104:107], v[148:151]
ds_read_b128 v[40:43], v2 offset:512
v_mfma_f32_16x16x32_bf16 v[152:155], v[160:163], v[108:111], v[152:155]
ds_read_b64_tr_b16 v[70:71], v6 offset:2048
v_mfma_f32_16x16x32_bf16 v[156:159], v[164:167], v[108:111], v[156:159]
ds_read_b128 v[44:47], v2 offset:768
v_mfma_f32_16x16x32_bf16 v[128:131], v[168:171], v[112:115], v[128:131]
ds_read_b64_tr_b16 v[72:73], v5 offset:4096
v_mfma_f32_16x16x32_bf16 v[132:135], v[172:175], v[112:115], v[132:135]
ds_read_b128 v[48:51], v2 offset:8192
v_mfma_f32_16x16x32_bf16 v[136:139], v[168:171], v[116:119], v[136:139]
ds_read_b64_tr_b16 v[74:75], v5 offset:6144
v_mfma_f32_16x16x32_bf16 v[140:143], v[172:175], v[116:119], v[140:143]
ds_read_b128 v[52:55], v2 offset:8448
v_mfma_f32_16x16x32_bf16 v[144:147], v[168:171], v[120:123], v[144:147]
ds_read_b64_tr_b16 v[76:77], v6 offset:4096
v_mfma_f32_16x16x32_bf16 v[148:151], v[172:175], v[120:123], v[148:151]
ds_read_b128 v[56:59], v2 offset:8704
v_mfma_f32_16x16x32_bf16 v[152:155], v[168:171], v[124:127], v[152:155]
ds_read_b64_tr_b16 v[78:79], v6 offset:6144
v_mfma_f32_16x16x32_bf16 v[156:159], v[172:175], v[124:127], v[156:159]
ds_read_b128 v[60:63], v2 offset:8960
s_waitcnt lgkmcnt(0)
s_barrier
v_mfma_f32_16x16x32_bf16 v[128:131], v[64:67], v[32:35], v[128:131]
ds_read_b64_tr_b16 v[160:161], v5 offset:32768
v_mfma_f32_16x16x32_bf16 v[132:135], v[68:71], v[32:35], v[132:135]
ds_read_b128 v[96:99], v2 offset:32768
v_mfma_f32_16x16x32_bf16 v[136:139], v[64:67], v[36:39], v[136:139]
ds_read_b64_tr_b16 v[162:163], v5 offset:34816
v_mfma_f32_16x16x32_bf16 v[140:143], v[68:71], v[36:39], v[140:143]
ds_read_b128 v[100:103], v2 offset:33024
v_mfma_f32_16x16x32_bf16 v[144:147], v[64:67], v[40:43], v[144:147]
ds_read_b64_tr_b16 v[164:165], v6 offset:32768
v_mfma_f32_16x16x32_bf16 v[148:151], v[68:71], v[40:43], v[148:151]
ds_read_b128 v[104:107], v2 offset:33280
v_mfma_f32_16x16x32_bf16 v[152:155], v[64:67], v[44:47], v[152:155]
ds_read_b64_tr_b16 v[166:167], v6 offset:34816
v_mfma_f32_16x16x32_bf16 v[156:159], v[68:71], v[44:47], v[156:159]
ds_read_b128 v[108:111], v2 offset:33536
v_mfma_f32_16x16x32_bf16 v[128:131], v[72:75], v[48:51], v[128:131]
ds_read_b64_tr_b16 v[168:169], v5 offset:36864
v_mfma_f32_16x16x32_bf16 v[132:135], v[76:79], v[48:51], v[132:135]
ds_read_b128 v[112:115], v2 offset:40960
v_mfma_f32_16x16x32_bf16 v[136:139], v[72:75], v[52:55], v[136:139]
ds_read_b64_tr_b16 v[170:171], v5 offset:38912
v_mfma_f32_16x16x32_bf16 v[140:143], v[76:79], v[52:55], v[140:143]
ds_read_b128 v[116:119], v2 offset:41216
v_mfma_f32_16x16x32_bf16 v[144:147], v[72:75], v[56:59], v[144:147]
ds_read_b64_tr_b16 v[172:173], v6 offset:36864
v_mfma_f32_16x16x32_bf16 v[148:151], v[76:79], v[56:59], v[148:151]
ds_read_b128 v[120:123], v2 offset:41472
v_mfma_f32_16x16x32_bf16 v[152:155], v[72:75], v[60:63], v[152:155]
ds_read_b64_tr_b16 v[174:175], v6 offset:38912
v_mfma_f32_16x16x32_bf16 v[156:159], v[76:79], v[60:63], v[156:159]
ds_read_b128 v[124:127], v2 offset:41728
s_waitcnt lgkmcnt(0)
s_barrier
v_mfma_f32_16x16x32_bf16 v[128:131], v[160:163], v[96:99], v[128:131]
ds_read_b64_tr_b16 v[64:65], v7 offset:0
v_mfma_f32_16x16x32_bf16 v[132:135], v[164:167], v[96:99], v[132:135]
ds_read_b128 v[32:35], v3 offset:0
v_mfma_f32_16x16x32_bf16 v[136:139], v[160:163], v[100:103], v[136:139]
ds_read_b64_tr_b16 v[66:67], v7 offset:2048
v_mfma_f32_16x16x32_bf16 v[140:143], v[164:167], v[100:103], v[140:143]
ds_read_b128 v[36:39], v3 offset:256
v_mfma_f32_16x16x32_bf16 v[144:147], v[160:163], v[104:107], v[144:147]
ds_read_b64_tr_b16 v[68:69], v8 offset:0
v_mfma_f32_16x16x32_bf16 v[148:151], v[164:167], v[104:107], v[148:151]
ds_read_b128 v[40:43], v3 offset:512
v_mfma_f32_16x16x32_bf16 v[152:155], v[160:163], v[108:111], v[152:155]
ds_read_b64_tr_b16 v[70:71], v8 offset:2048
v_mfma_f32_16x16x32_bf16 v[156:159], v[164:167], v[108:111], v[156:159]
ds_read_b128 v[44:47], v3 offset:768
v_mfma_f32_16x16x32_bf16 v[128:131], v[168:171], v[112:115], v[128:131]
ds_read_b64_tr_b16 v[72:73], v7 offset:4096
v_mfma_f32_16x16x32_bf16 v[132:135], v[172:175], v[112:115], v[132:135]
ds_read_b128 v[48:51], v3 offset:8192
v_mfma_f32_16x16x32_bf16 v[136:139], v[168:171], v[116:119], v[136:139]
ds_read_b64_tr_b16 v[74:75], v7 offset:6144
v_mfma_f32_16x16x32_bf16 v[140:143], v[172:175], v[116:119], v[140:143]
ds_read_b128 v[52:55], v3 offset:8448
v_mfma_f32_16x16x32_bf16 v[144:147], v[168:171], v[120:123], v[144:147]
ds_read_b64_tr_b16 v[76:77], v8 offset:4096
v_mfma_f32_16x16x32_bf16 v[148:151], v[172:175], v[120:123], v[148:151]
ds_read_b128 v[56:59], v3 offset:8704
v_mfma_f32_16x16x32_bf16 v[152:155], v[168:171], v[124:127], v[152:155]
ds_read_b64_tr_b16 v[78:79], v8 offset:6144
v_mfma_f32_16x16x32_bf16 v[156:159], v[172:175], v[124:127], v[156:159]
ds_read_b128 v[60:63], v3 offset:8960
s_waitcnt lgkmcnt(0)
s_barrier
v_mfma_f32_16x16x32_bf16 v[128:131], v[64:67], v[32:35], v[128:131]
ds_read_b64_tr_b16 v[160:161], v7 offset:32768
v_mfma_f32_16x16x32_bf16 v[132:135], v[68:71], v[32:35], v[132:135]
ds_read_b128 v[96:99], v3 offset:32768
v_mfma_f32_16x16x32_bf16 v[136:139], v[64:67], v[36:39], v[136:139]
ds_read_b64_tr_b16 v[162:163], v7 offset:34816
v_mfma_f32_16x16x32_bf16 v[140:143], v[68:71], v[36:39], v[140:143]
ds_read_b128 v[100:103], v3 offset:33024
v_mfma_f32_16x16x32_bf16 v[144:147], v[64:67], v[40:43], v[144:147]
ds_read_b64_tr_b16 v[164:165], v8 offset:32768
v_mfma_f32_16x16x32_bf16 v[148:151], v[68:71], v[40:43], v[148:151]
ds_read_b128 v[104:107], v3 offset:33280
v_mfma_f32_16x16x32_bf16 v[152:155], v[64:67], v[44:47], v[152:155]
ds_read_b64_tr_b16 v[166:167], v8 offset:34816
v_mfma_f32_16x16x32_bf16 v[156:159], v[68:71], v[44:47], v[156:159]
ds_read_b128 v[108:111], v3 offset:33536
v_mfma_f32_16x16x32_bf16 v[128:131], v[72:75], v[48:51], v[128:131]
ds_read_b64_tr_b16 v[168:169], v7 offset:36864
v_mfma_f32_16x16x32_bf16 v[132:135], v[76:79], v[48:51], v[132:135]
ds_read_b128 v[112:115], v3 offset:40960
v_mfma_f32_16x16x32_bf16 v[136:139], v[72:75], v[52:55], v[136:139]
ds_read_b64_tr_b16 v[170:171], v7 offset:38912
v_mfma_f32_16x16x32_bf16 v[140:143], v[76:79], v[52:55], v[140:143]
ds_read_b128 v[116:119], v3 offset:41216
v_mfma_f32_16x16x32_bf16 v[144:147], v[72:75], v[56:59], v[144:147]
ds_read_b64_tr_b16 v[172:173], v8 offset:36864
v_mfma_f32_16x16x32_bf16 v[148:151], v[76:79], v[56:59], v[148:151]
ds_read_b128 v[120:123], v3 offset:41472
v_mfma_f32_16x16x32_bf16 v[152:155], v[72:75], v[60:63], v[152:155]
ds_read_b64_tr_b16 v[174:175], v8 offset:38912
v_mfma_f32_16x16x32_bf16 v[156:159], v[76:79], v[60:63], v[156:159]
ds_read_b128 v[124:127], v3 offset:41728
s_waitcnt lgkmcnt(0)
s_barrier
v_mfma_f32_16x16x32_bf16 v[128:131], v[160:163], v[96:99], v[128:131]
ds_read_b64_tr_b16 v[64:65], v5 offset:0
v_mfma_f32_16x16x32_bf16 v[132:135], v[164:167], v[96:99], v[132:135]
ds_read_b128 v[32:35], v2 offset:0
v_mfma_f32_16x16x32_bf16 v[136:139], v[160:163], v[100:103], v[136:139]
ds_read_b64_tr_b16 v[66:67], v5 offset:2048
v_mfma_f32_16x16x32_bf16 v[140:143], v[164:167], v[100:103], v[140:143]
ds_read_b128 v[36:39], v2 offset:256
buffer_load_dwordx4 v[192:195], v9, s[68:71], 0 offen offset:0 sc1
v_mfma_f32_16x16x32_bf16 v[144:147], v[160:163], v[104:107], v[144:147]
ds_read_b64_tr_b16 v[68:69], v6 offset:0
v_mfma_f32_16x16x32_bf16 v[148:151], v[164:167], v[104:107], v[148:151]
ds_read_b128 v[40:43], v2 offset:512
v_mfma_f32_16x16x32_bf16 v[152:155], v[160:163], v[108:111], v[152:155]
ds_read_b64_tr_b16 v[70:71], v6 offset:2048
buffer_load_dwordx4 v[196:199], v9, s[68:71], 0 offen offset:1024 sc1
v_mfma_f32_16x16x32_bf16 v[156:159], v[164:167], v[108:111], v[156:159]
ds_read_b128 v[44:47], v2 offset:768
v_mfma_f32_16x16x32_bf16 v[128:131], v[168:171], v[112:115], v[128:131]
ds_read_b64_tr_b16 v[72:73], v5 offset:4096
v_mfma_f32_16x16x32_bf16 v[132:135], v[172:175], v[112:115], v[132:135]
ds_read_b128 v[48:51], v2 offset:8192
buffer_load_dwordx4 v[200:203], v9, s[68:71], 0 offen offset:2048 sc1
v_mfma_f32_16x16x32_bf16 v[136:139], v[168:171], v[116:119], v[136:139]
ds_read_b64_tr_b16 v[74:75], v5 offset:6144
v_mfma_f32_16x16x32_bf16 v[140:143], v[172:175], v[116:119], v[140:143]
ds_read_b128 v[52:55], v2 offset:8448
v_mfma_f32_16x16x32_bf16 v[144:147], v[168:171], v[120:123], v[144:147]
ds_read_b64_tr_b16 v[76:77], v6 offset:4096
buffer_load_dwordx4 v[204:207], v9, s[68:71], 0 offen offset:3072 sc1
v_mfma_f32_16x16x32_bf16 v[148:151], v[172:175], v[120:123], v[148:151]
ds_read_b128 v[56:59], v2 offset:8704
v_mfma_f32_16x16x32_bf16 v[152:155], v[168:171], v[124:127], v[152:155]
ds_read_b64_tr_b16 v[78:79], v6 offset:6144
v_mfma_f32_16x16x32_bf16 v[156:159], v[172:175], v[124:127], v[156:159]
ds_read_b128 v[60:63], v2 offset:8960
s_waitcnt lgkmcnt(0)
s_barrier
v_mfma_f32_16x16x32_bf16 v[128:131], v[64:67], v[32:35], v[128:131]
ds_read_b64_tr_b16 v[160:161], v5 offset:32768
v_mfma_f32_16x16x32_bf16 v[132:135], v[68:71], v[32:35], v[132:135]
ds_read_b128 v[96:99], v2 offset:32768
v_mfma_f32_16x16x32_bf16 v[136:139], v[64:67], v[36:39], v[136:139]
ds_read_b64_tr_b16 v[162:163], v5 offset:34816
v_mfma_f32_16x16x32_bf16 v[140:143], v[68:71], v[36:39], v[140:143]
ds_read_b128 v[100:103], v2 offset:33024
v_mfma_f32_16x16x32_bf16 v[144:147], v[64:67], v[40:43], v[144:147]
ds_read_b64_tr_b16 v[164:165], v6 offset:32768
v_mfma_f32_16x16x32_bf16 v[148:151], v[68:71], v[40:43], v[148:151]
ds_read_b128 v[104:107], v2 offset:33280
v_mfma_f32_16x16x32_bf16 v[152:155], v[64:67], v[44:47], v[152:155]
ds_read_b64_tr_b16 v[166:167], v6 offset:34816
v_mfma_f32_16x16x32_bf16 v[156:159], v[68:71], v[44:47], v[156:159]
ds_read_b128 v[108:111], v2 offset:33536
v_mfma_f32_16x16x32_bf16 v[128:131], v[72:75], v[48:51], v[128:131]
ds_read_b64_tr_b16 v[168:169], v5 offset:36864
v_mfma_f32_16x16x32_bf16 v[132:135], v[76:79], v[48:51], v[132:135]
ds_read_b128 v[112:115], v2 offset:40960
v_mfma_f32_16x16x32_bf16 v[136:139], v[72:75], v[52:55], v[136:139]
ds_read_b64_tr_b16 v[170:171], v5 offset:38912
v_mfma_f32_16x16x32_bf16 v[140:143], v[76:79], v[52:55], v[140:143]
ds_read_b128 v[116:119], v2 offset:41216
v_mfma_f32_16x16x32_bf16 v[144:147], v[72:75], v[56:59], v[144:147]
ds_read_b64_tr_b16 v[172:173], v6 offset:36864
v_mfma_f32_16x16x32_bf16 v[148:151], v[76:79], v[56:59], v[148:151]
ds_read_b128 v[120:123], v2 offset:41472
v_mfma_f32_16x16x32_bf16 v[152:155], v[72:75], v[60:63], v[152:155]
ds_read_b64_tr_b16 v[174:175], v6 offset:38912
v_mfma_f32_16x16x32_bf16 v[156:159], v[76:79], v[60:63], v[156:159]
ds_read_b128 v[124:127], v2 offset:41728
s_waitcnt lgkmcnt(0)
s_barrier
v_mfma_f32_16x16x32_bf16 v[128:131], v[160:163], v[96:99], v[128:131]
v_mfma_f32_16x16x32_bf16 v[132:135], v[164:167], v[96:99], v[132:135]
v_mfma_f32_16x16x32_bf16 v[136:139], v[160:163], v[100:103], v[136:139]
v_mfma_f32_16x16x32_bf16 v[140:143], v[164:167], v[100:103], v[140:143]
v_mfma_f32_16x16x32_bf16 v[144:147], v[160:163], v[104:107], v[144:147]
v_mfma_f32_16x16x32_bf16 v[148:151], v[164:167], v[104:107], v[148:151]
v_mfma_f32_16x16x32_bf16 v[152:155], v[160:163], v[108:111], v[152:155]
v_mfma_f32_16x16x32_bf16 v[156:159], v[164:167], v[108:111], v[156:159]
s_waitcnt vmcnt(0)
v_mfma_f32_16x16x32_bf16 v[128:131], v[168:171], v[112:115], v[128:131]
v_lshlrev_b32 v224, 16, v192
v_and_b32 v225, 0xffff0000, v192
v_lshlrev_b32 v226, 16, v193
v_and_b32 v227, 0xffff0000, v193
v_mfma_f32_16x16x32_bf16 v[132:135], v[172:175], v[112:115], v[132:135]
v_lshlrev_b32 v228, 16, v194
v_and_b32 v229, 0xffff0000, v194
v_lshlrev_b32 v230, 16, v195
v_and_b32 v231, 0xffff0000, v195
v_mfma_f32_16x16x32_bf16 v[136:139], v[168:171], v[116:119], v[136:139]
v_lshlrev_b32 v232, 16, v196
v_and_b32 v233, 0xffff0000, v196
v_lshlrev_b32 v234, 16, v197
v_and_b32 v235, 0xffff0000, v197
v_mfma_f32_16x16x32_bf16 v[140:143], v[172:175], v[116:119], v[140:143]
v_lshlrev_b32 v236, 16, v198
v_and_b32 v237, 0xffff0000, v198
v_lshlrev_b32 v238, 16, v199
v_and_b32 v239, 0xffff0000, v199
v_mfma_f32_16x16x32_bf16 v[144:147], v[168:171], v[120:123], v[144:147]
v_lshlrev_b32 v240, 16, v200
v_and_b32 v241, 0xffff0000, v200
v_lshlrev_b32 v242, 16, v201
v_and_b32 v243, 0xffff0000, v201
v_mfma_f32_16x16x32_bf16 v[148:151], v[172:175], v[120:123], v[148:151]
v_lshlrev_b32 v244, 16, v202
v_and_b32 v245, 0xffff0000, v202
v_lshlrev_b32 v246, 16, v203
v_and_b32 v247, 0xffff0000, v203
v_mfma_f32_16x16x32_bf16 v[152:155], v[168:171], v[124:127], v[152:155]
v_lshlrev_b32 v248, 16, v204
v_and_b32 v249, 0xffff0000, v204
v_lshlrev_b32 v250, 16, v205
v_and_b32 v251, 0xffff0000, v205
v_mfma_f32_16x16x32_bf16 v[156:159], v[172:175], v[124:127], v[156:159]
v_lshlrev_b32 v252, 16, v206
v_and_b32 v253, 0xffff0000, v206
v_lshlrev_b32 v254, 16, v207
v_and_b32 v255, 0xffff0000, v207
s_waitcnt vmcnt(0)
s_nop 4
v_pk_add_f32 v[128:129], v[128:129], v[224:225]
v_pk_add_f32 v[130:131], v[130:131], v[226:227]
v_pk_add_f32 v[132:133], v[132:133], v[228:229]
v_pk_add_f32 v[134:135], v[134:135], v[230:231]
v_cvt_pk_bf16_f32 v32, v128, v129
v_cvt_pk_bf16_f32 v33, v130, v131
v_cvt_pk_bf16_f32 v34, v132, v133
v_cvt_pk_bf16_f32 v35, v134, v135
v_pk_add_f32 v[136:137], v[136:137], v[232:233]
v_pk_add_f32 v[138:139], v[138:139], v[234:235]
v_pk_add_f32 v[140:141], v[140:141], v[236:237]
v_pk_add_f32 v[142:143], v[142:143], v[238:239]
v_cvt_pk_bf16_f32 v36, v136, v137
v_cvt_pk_bf16_f32 v37, v138, v139
v_cvt_pk_bf16_f32 v38, v140, v141
v_cvt_pk_bf16_f32 v39, v142, v143
v_pk_add_f32 v[144:145], v[144:145], v[240:241]
v_pk_add_f32 v[146:147], v[146:147], v[242:243]
v_pk_add_f32 v[148:149], v[148:149], v[244:245]
v_pk_add_f32 v[150:151], v[150:151], v[246:247]
v_cvt_pk_bf16_f32 v40, v144, v145
v_cvt_pk_bf16_f32 v41, v146, v147
v_cvt_pk_bf16_f32 v42, v148, v149
v_cvt_pk_bf16_f32 v43, v150, v151
v_pk_add_f32 v[152:153], v[152:153], v[248:249]
v_pk_add_f32 v[154:155], v[154:155], v[250:251]
v_pk_add_f32 v[156:157], v[156:157], v[252:253]
v_pk_add_f32 v[158:159], v[158:159], v[254:255]
v_cvt_pk_bf16_f32 v44, v152, v153
v_cvt_pk_bf16_f32 v45, v154, v155
v_cvt_pk_bf16_f32 v46, v156, v157
v_cvt_pk_bf16_f32 v47, v158, v159
v_permlane16_swap_b32 v32, v34
v_permlane16_swap_b32 v33, v35
buffer_store_dwordx4 v[32:35], v28, s[16:19], 0 offen offset:0
v_permlane16_swap_b32 v36, v38
v_permlane16_swap_b32 v37, v39
buffer_store_dwordx4 v[36:39], v28, s[16:19], 0 offen offset:2048
v_permlane16_swap_b32 v40, v42
v_permlane16_swap_b32 v41, v43
buffer_store_dwordx4 v[40:43], v28, s[16:19], s54 offen offset:0
v_permlane16_swap_b32 v44, v46
v_permlane16_swap_b32 v45, v47
buffer_store_dwordx4 v[44:47], v28, s[16:19], s54 offen offset:2048
s_branch Ldone_1
LG1_24:
s_cmp_eq_u32 s36, 7
s_cbranch_scc1 L7_34
s_mul_i32 s44, s34, 262144
s_lshl_b32 s39, s51, 13
s_add_u32 s44, s44, s39
s_add_u32 s44, s44, 0
s_lshl_b32 s43, s35, 7
s_mov_b32 s10, 253952
s_movk_i32 s38, 1024
s_movk_i32 s40, 9216
s_cmp_eq_u32 s51, 2
s_cselect_b32 s8, s28, s32
s_cselect_b32 s9, s29, s33
s_cselect_b32 s10, 2095232, s10
s_cselect_b32 s43, s43, s44
s_cselect_b32 s38, 16384, s38
s_cselect_b32 s40, 16384, s40
s_cselect_b32 s55, 16384, s38
s_cselect_b32 s45, -1, 0
s_add_u32 s8, s8, s43
s_addc_u32 s9, s9, 0
s_mov_b32 s11, 0x20000
s_sub_u32 s37, 0, s40
v_lshrrev_b32 v19, 3, v1
v_mul_u32_u24 v19, 1920, v19
v_lshrrev_b32 v20, 4, v1
v_lshlrev_b32 v20, 5, v20
v_and_b32 v19, s45, v19
v_and_b32 v20, s45, v20
v_lshlrev_b32 v23, 4, v1
v_xor_b32 v23, v23, v20
v_add_u32 v23, v23, v19
s_lshl_b32 s43, s34, 18
s_add_u32 s12, s32, s43
s_addc_u32 s13, s33, 0
s_mov_b32 s14, 262144
s_mov_b32 s15, 0x20000
v_lshlrev_b32 v21, 4, v1
s_lshl_b32 s54, s36, 11
s_cmp_eq_u32 s51, 1
s_cbranch_scc1 Lp_38
s_cmp_eq_u32 s51, 2
s_cbranch_scc1 Lp_39
Lp_37:
s_add_u32 s43, s34, 0
s_lshl_b32 s43, s43, 7
v_mov_b32 v8, s43
v_mov_b32 v10, 16
buffer_load_dword v9, v8, s[56:59], 0 offen sc1
s_mov_b32 s41, 0x10000
Lpoll_40:
s_waitcnt vmcnt(0)
Lpf_42:
v_cmp_ne_u32 vcc, v10, v9
s_nop 4
s_cbranch_vccz Lpok_41
buffer_load_dword v9, v8, s[56:59], 0 offen sc1
s_sub_u32 s41, s41, 1
s_cmp_lg_u32 s41, 0
s_cbranch_scc1 Lpoll_40
s_waitcnt vmcnt(0)
Lpok_41:
s_barrier
s_add_u32 m0, s54, 0
s_add_u32 s43, s54, 0
buffer_load_dwordx4 v21, s[12:15], s43 offen sc1 lds
s_add_u32 m0, s54, 1024
s_add_u32 s43, s54, 1024
buffer_load_dwordx4 v21, s[12:15], s43 offen sc1 lds
s_add_u32 m0, s54, 24576
s_add_u32 s43, s54, 16384
buffer_load_dwordx4 v21, s[12:15], s43 offen sc1 lds
s_add_u32 m0, s54, 25600
s_add_u32 s43, s54, 17408
buffer_load_dwordx4 v21, s[12:15], s43 offen sc1 lds
s_add_u32 s37, s37, 32768
s_add_u32 m0, s39, 49152
s_add_u32 s37, s37, s40
buffer_load_dwordx4 v23, s[8:11], s37 offen sc1 lds
s_add_u32 m0, s39, 50176
s_add_u32 s37, s37, s38
buffer_load_dwordx4 v23, s[8:11], s37 offen sc1 lds
s_add_u32 m0, s39, 51200
s_add_u32 s37, s37, s38
buffer_load_dwordx4 v23, s[8:11], s37 offen sc1 lds
s_add_u32 m0, s39, 52224
s_add_u32 s37, s37, s38
buffer_load_dwordx4 v23, s[8:11], s37 offen sc1 lds
s_add_u32 m0, s39, 53248
s_add_u32 s37, s37, s55
buffer_load_dwordx4 v23, s[8:11], s37 offen sc1 lds
s_add_u32 m0, s39, 54272
s_add_u32 s37, s37, s38
buffer_load_dwordx4 v23, s[8:11], s37 offen sc1 lds
s_add_u32 m0, s39, 55296
s_add_u32 s37, s37, s38
buffer_load_dwordx4 v23, s[8:11], s37 offen sc1 lds
s_add_u32 m0, s39, 56320
s_add_u32 s37, s37, s38
buffer_load_dwordx4 v23, s[8:11], s37 offen sc1 lds
s_add_u32 m0, s39, 73728
s_add_u32 s37, s37, s40
buffer_load_dwordx4 v23, s[8:11], s37 offen sc1 lds
s_add_u32 m0, s39, 74752
s_add_u32 s37, s37, s38
buffer_load_dwordx4 v23, s[8:11], s37 offen sc1 lds
s_add_u32 m0, s39, 75776
s_add_u32 s37, s37, s38
buffer_load_dwordx4 v23, s[8:11], s37 offen sc1 lds
s_add_u32 m0, s39, 76800
s_add_u32 s37, s37, s38
buffer_load_dwordx4 v23, s[8:11], s37 offen sc1 lds
s_add_u32 m0, s39, 77824
s_add_u32 s37, s37, s55
buffer_load_dwordx4 v23, s[8:11], s37 offen sc1 lds
s_add_u32 m0, s39, 78848
s_add_u32 s37, s37, s38
buffer_load_dwordx4 v23, s[8:11], s37 offen sc1 lds
s_add_u32 m0, s39, 79872
s_add_u32 s37, s37, s38
buffer_load_dwordx4 v23, s[8:11], s37 offen sc1 lds
s_add_u32 m0, s39, 80896
s_add_u32 s37, s37, s38
buffer_load_dwordx4 v23, s[8:11], s37 offen sc1 lds
s_add_u32 m0, s39, 98304
s_add_u32 s37, s37, s40
buffer_load_dwordx4 v23, s[8:11], s37 offen sc1 lds
s_add_u32 m0, s39, 99328
s_add_u32 s37, s37, s38
buffer_load_dwordx4 v23, s[8:11], s37 offen sc1 lds
s_add_u32 m0, s39, 100352
s_add_u32 s37, s37, s38
buffer_load_dwordx4 v23, s[8:11], s37 offen sc1 lds
s_add_u32 m0, s39, 101376
s_add_u32 s37, s37, s38
buffer_load_dwordx4 v23, s[8:11], s37 offen sc1 lds
s_add_u32 m0, s39, 102400
s_add_u32 s37, s37, s55
buffer_load_dwordx4 v23, s[8:11], s37 offen sc1 lds
s_add_u32 m0, s39, 103424
s_add_u32 s37, s37, s38
buffer_load_dwordx4 v23, s[8:11], s37 offen sc1 lds
s_add_u32 m0, s39, 104448
s_add_u32 s37, s37, s38
buffer_load_dwordx4 v23, s[8:11], s37 offen sc1 lds
s_add_u32 m0, s39, 105472
s_add_u32 s37, s37, s38
buffer_load_dwordx4 v23, s[8:11], s37 offen sc1 lds
s_add_u32 m0, s39, 122880
s_add_u32 s37, s37, s40
buffer_load_dwordx4 v23, s[8:11], s37 offen sc1 lds
s_add_u32 m0, s39, 123904
s_add_u32 s37, s37, s38
buffer_load_dwordx4 v23, s[8:11], s37 offen sc1 lds
s_add_u32 m0, s39, 124928
s_add_u32 s37, s37, s38
buffer_load_dwordx4 v23, s[8:11], s37 offen sc1 lds
s_add_u32 m0, s39, 125952
s_add_u32 s37, s37, s38
buffer_load_dwordx4 v23, s[8:11], s37 offen sc1 lds
s_add_u32 m0, s39, 126976
s_add_u32 s37, s37, s55
buffer_load_dwordx4 v23, s[8:11], s37 offen sc1 lds
s_add_u32 m0, s39, 128000
s_add_u32 s37, s37, s38
buffer_load_dwordx4 v23, s[8:11], s37 offen sc1 lds
s_add_u32 m0, s39, 129024
s_add_u32 s37, s37, s38
buffer_load_dwordx4 v23, s[8:11], s37 offen sc1 lds
s_add_u32 m0, s39, 130048
s_add_u32 s37, s37, s38
buffer_load_dwordx4 v23, s[8:11], s37 offen sc1 lds
s_waitcnt vmcnt(34)
s_barrier
s_waitcnt vmcnt(32)
s_barrier
s_add_u32 m0, s39, 0
s_add_u32 s37, s37, s40
buffer_load_dwordx4 v23, s[8:11], s37 offen sc1 lds
s_add_u32 m0, s39, 1024
s_add_u32 s37, s37, s38
buffer_load_dwordx4 v23, s[8:11], s37 offen sc1 lds
s_add_u32 m0, s39, 2048
s_add_u32 s37, s37, s38
buffer_load_dwordx4 v23, s[8:11], s37 offen sc1 lds
s_add_u32 m0, s39, 3072
s_add_u32 s37, s37, s38
buffer_load_dwordx4 v23, s[8:11], s37 offen sc1 lds
s_add_u32 m0, s39, 4096
s_add_u32 s37, s37, s55
buffer_load_dwordx4 v23, s[8:11], s37 offen sc1 lds
s_add_u32 m0, s39, 5120
s_add_u32 s37, s37, s38
buffer_load_dwordx4 v23, s[8:11], s37 offen sc1 lds
s_add_u32 m0, s39, 6144
s_add_u32 s37, s37, s38
buffer_load_dwordx4 v23, s[8:11], s37 offen sc1 lds
s_add_u32 m0, s39, 7168
s_add_u32 s37, s37, s38
buffer_load_dwordx4 v23, s[8:11], s37 offen sc1 lds
s_waitcnt vmcnt(32)
s_barrier
s_add_u32 m0, s39, 24576
s_add_u32 s37, s37, s40
buffer_load_dwordx4 v23, s[8:11], s37 offen sc1 lds
s_add_u32 m0, s39, 25600
s_add_u32 s37, s37, s38
buffer_load_dwordx4 v23, s[8:11], s37 offen sc1 lds
s_add_u32 m0, s39, 26624
s_add_u32 s37, s37, s38
buffer_load_dwordx4 v23, s[8:11], s37 offen sc1 lds
s_add_u32 m0, s39, 27648
s_add_u32 s37, s37, s38
buffer_load_dwordx4 v23, s[8:11], s37 offen sc1 lds
s_add_u32 m0, s39, 28672
s_add_u32 s37, s37, s55
buffer_load_dwordx4 v23, s[8:11], s37 offen sc1 lds
s_add_u32 m0, s39, 29696
s_add_u32 s37, s37, s38
buffer_load_dwordx4 v23, s[8:11], s37 offen sc1 lds
s_add_u32 m0, s39, 30720
s_add_u32 s37, s37, s38
buffer_load_dwordx4 v23, s[8:11], s37 offen sc1 lds
s_add_u32 m0, s39, 31744
s_add_u32 s37, s37, s38
buffer_load_dwordx4 v23, s[8:11], s37 offen sc1 lds
s_waitcnt vmcnt(32)
s_barrier
s_add_u32 m0, s39, 49152
s_add_u32 s37, s37, s40
buffer_load_dwordx4 v23, s[8:11], s37 offen sc1 lds
s_add_u32 m0, s39, 50176
s_add_u32 s37, s37, s38
buffer_load_dwordx4 v23, s[8:11], s37 offen sc1 lds
s_add_u32 m0, s39, 51200
s_add_u32 s37, s37, s38
buffer_load_dwordx4 v23, s[8:11], s37 offen sc1 lds
s_add_u32 m0, s39, 52224
s_add_u32 s37, s37, s38
buffer_load_dwordx4 v23, s[8:11], s37 offen sc1 lds
s_add_u32 m0, s39, 53248
s_add_u32 s37, s37, s55
buffer_load_dwordx4 v23, s[8:11], s37 offen sc1 lds
s_add_u32 m0, s39, 54272
s_add_u32 s37, s37, s38
buffer_load_dwordx4 v23, s[8:11], s37 offen sc1 lds
s_add_u32 m0, s39, 55296
s_add_u32 s37, s37, s38
buffer_load_dwordx4 v23, s[8:11], s37 offen sc1 lds
s_add_u32 m0, s39, 56320
s_add_u32 s37, s37, s38
buffer_load_dwordx4 v23, s[8:11], s37 offen sc1 lds
s_waitcnt vmcnt(32)
s_barrier
s_add_u32 m0, s39, 73728
s_add_u32 s37, s37, s40
buffer_load_dwordx4 v23, s[8:11], s37 offen sc1 lds
s_add_u32 m0, s39, 74752
s_add_u32 s37, s37, s38
buffer_load_dwordx4 v23, s[8:11], s37 offen sc1 lds
s_add_u32 m0, s39, 75776
s_add_u32 s37, s37, s38
buffer_load_dwordx4 v23, s[8:11], s37 offen sc1 lds
s_add_u32 m0, s39, 76800
s_add_u32 s37, s37, s38
buffer_load_dwordx4 v23, s[8:11], s37 offen sc1 lds
s_add_u32 m0, s39, 77824
s_add_u32 s37, s37, s55
buffer_load_dwordx4 v23, s[8:11], s37 offen sc1 lds
s_add_u32 m0, s39, 78848
s_add_u32 s37, s37, s38
buffer_load_dwordx4 v23, s[8:11], s37 offen sc1 lds
s_add_u32 m0, s39, 79872
s_add_u32 s37, s37, s38
buffer_load_dwordx4 v23, s[8:11], s37 offen sc1 lds
s_add_u32 m0, s39, 80896
s_add_u32 s37, s37, s38
buffer_load_dwordx4 v23, s[8:11], s37 offen sc1 lds
s_waitcnt vmcnt(32)
s_barrier
s_add_u32 m0, s39, 98304
s_add_u32 s37, s37, s40
buffer_load_dwordx4 v23, s[8:11], s37 offen sc1 lds
s_add_u32 m0, s39, 99328
s_add_u32 s37, s37, s38
buffer_load_dwordx4 v23, s[8:11], s37 offen sc1 lds
s_add_u32 m0, s39, 100352
s_add_u32 s37, s37, s38
buffer_load_dwordx4 v23, s[8:11], s37 offen sc1 lds
s_add_u32 m0, s39, 101376
s_add_u32 s37, s37, s38
buffer_load_dwordx4 v23, s[8:11], s37 offen sc1 lds
s_add_u32 m0, s39, 102400
s_add_u32 s37, s37, s55
buffer_load_dwordx4 v23, s[8:11], s37 offen sc1 lds
s_add_u32 m0, s39, 103424
s_add_u32 s37, s37, s38
buffer_load_dwordx4 v23, s[8:11], s37 offen sc1 lds
s_add_u32 m0, s39, 104448
s_add_u32 s37, s37, s38
buffer_load_dwordx4 v23, s[8:11], s37 offen sc1 lds
s_add_u32 m0, s39, 105472
s_add_u32 s37, s37, s38
buffer_load_dwordx4 v23, s[8:11], s37 offen sc1 lds
s_waitcnt vmcnt(32)
s_barrier
s_add_u32 m0, s39, 122880
s_add_u32 s37, s37, s40
buffer_load_dwordx4 v23, s[8:11], s37 offen sc1 lds
s_add_u32 m0, s39, 123904
s_add_u32 s37, s37, s38
buffer_load_dwordx4 v23, s[8:11], s37 offen sc1 lds
s_add_u32 m0, s39, 124928
s_add_u32 s37, s37, s38
buffer_load_dwordx4 v23, s[8:11], s37 offen sc1 lds
s_add_u32 m0, s39, 125952
s_add_u32 s37, s37, s38
buffer_load_dwordx4 v23, s[8:11], s37 offen sc1 lds
s_add_u32 m0, s39, 126976
s_add_u32 s37, s37, s55
buffer_load_dwordx4 v23, s[8:11], s37 offen sc1 lds
s_add_u32 m0, s39, 128000
s_add_u32 s37, s37, s38
buffer_load_dwordx4 v23, s[8:11], s37 offen sc1 lds
s_add_u32 m0, s39, 129024
s_add_u32 s37, s37, s38
buffer_load_dwordx4 v23, s[8:11], s37 offen sc1 lds
s_add_u32 m0, s39, 130048
s_add_u32 s37, s37, s38
buffer_load_dwordx4 v23, s[8:11], s37 offen sc1 lds
s_waitcnt vmcnt(32)
s_barrier
s_add_u32 m0, s39, 0
s_add_u32 s37, s37, s40
buffer_load_dwordx4 v23, s[8:11], s37 offen sc1 lds
s_add_u32 m0, s39, 1024
s_add_u32 s37, s37, s38
buffer_load_dwordx4 v23, s[8:11], s37 offen sc1 lds
s_add_u32 m0, s39, 2048
s_add_u32 s37, s37, s38
buffer_load_dwordx4 v23, s[8:11], s37 offen sc1 lds
s_add_u32 m0, s39, 3072
s_add_u32 s37, s37, s38
buffer_load_dwordx4 v23, s[8:11], s37 offen sc1 lds
s_add_u32 m0, s39, 4096
s_add_u32 s37, s37, s55
buffer_load_dwordx4 v23, s[8:11], s37 offen sc1 lds
s_add_u32 m0, s39, 5120
s_add_u32 s37, s37, s38
buffer_load_dwordx4 v23, s[8:11], s37 offen sc1 lds
s_add_u32 m0, s39, 6144
s_add_u32 s37, s37, s38
buffer_load_dwordx4 v23, s[8:11], s37 offen sc1 lds
s_add_u32 m0, s39, 7168
s_add_u32 s37, s37, s38
buffer_load_dwordx4 v23, s[8:11], s37 offen sc1 lds
s_waitcnt vmcnt(32)
s_barrier
s_add_u32 m0, s39, 24576
s_add_u32 s37, s37, s40
buffer_load_dwordx4 v23, s[8:11], s37 offen sc1 lds
s_add_u32 m0, s39, 25600
s_add_u32 s37, s37, s38
buffer_load_dwordx4 v23, s[8:11], s37 offen sc1 lds
s_add_u32 m0, s39, 26624
s_add_u32 s37, s37, s38
buffer_load_dwordx4 v23, s[8:11], s37 offen sc1 lds
s_add_u32 m0, s39, 27648
s_add_u32 s37, s37, s38
buffer_load_dwordx4 v23, s[8:11], s37 offen sc1 lds
s_add_u32 m0, s39, 28672
s_add_u32 s37, s37, s55
buffer_load_dwordx4 v23, s[8:11], s37 offen sc1 lds
s_add_u32 m0, s39, 29696
s_add_u32 s37, s37, s38
buffer_load_dwordx4 v23, s[8:11], s37 offen sc1 lds
s_add_u32 m0, s39, 30720
s_add_u32 s37, s37, s38
buffer_load_dwordx4 v23, s[8:11], s37 offen sc1 lds
s_add_u32 m0, s39, 31744
s_add_u32 s37, s37, s38
buffer_load_dwordx4 v23, s[8:11], s37 offen sc1 lds
s_waitcnt vmcnt(32)
s_barrier
s_add_u32 m0, s39, 49152
s_add_u32 s37, s37, s40
buffer_load_dwordx4 v23, s[8:11], s37 offen sc1 lds
s_add_u32 m0, s39, 50176
s_add_u32 s37, s37, s38
buffer_load_dwordx4 v23, s[8:11], s37 offen sc1 lds
s_add_u32 m0, s39, 51200
s_add_u32 s37, s37, s38
buffer_load_dwordx4 v23, s[8:11], s37 offen sc1 lds
s_add_u32 m0, s39, 52224
s_add_u32 s37, s37, s38
buffer_load_dwordx4 v23, s[8:11], s37 offen sc1 lds
s_add_u32 m0, s39, 53248
s_add_u32 s37, s37, s55
buffer_load_dwordx4 v23, s[8:11], s37 offen sc1 lds
s_add_u32 m0, s39, 54272
s_add_u32 s37, s37, s38
buffer_load_dwordx4 v23, s[8:11], s37 offen sc1 lds
s_add_u32 m0, s39, 55296
s_add_u32 s37, s37, s38
buffer_load_dwordx4 v23, s[8:11], s37 offen sc1 lds
s_add_u32 m0, s39, 56320
s_add_u32 s37, s37, s38
buffer_load_dwordx4 v23, s[8:11], s37 offen sc1 lds
s_waitcnt vmcnt(32)
s_barrier
s_add_u32 m0, s39, 73728
s_add_u32 s37, s37, s40
buffer_load_dwordx4 v23, s[8:11], s37 offen sc1 lds
s_add_u32 m0, s39, 74752
s_add_u32 s37, s37, s38
buffer_load_dwordx4 v23, s[8:11], s37 offen sc1 lds
s_add_u32 m0, s39, 75776
s_add_u32 s37, s37, s38
buffer_load_dwordx4 v23, s[8:11], s37 offen sc1 lds
s_add_u32 m0, s39, 76800
s_add_u32 s37, s37, s38
buffer_load_dwordx4 v23, s[8:11], s37 offen sc1 lds
s_add_u32 m0, s39, 77824
s_add_u32 s37, s37, s55
buffer_load_dwordx4 v23, s[8:11], s37 offen sc1 lds
s_add_u32 m0, s39, 78848
s_add_u32 s37, s37, s38
buffer_load_dwordx4 v23, s[8:11], s37 offen sc1 lds
s_add_u32 m0, s39, 79872
s_add_u32 s37, s37, s38
buffer_load_dwordx4 v23, s[8:11], s37 offen sc1 lds
s_add_u32 m0, s39, 80896
s_add_u32 s37, s37, s38
buffer_load_dwordx4 v23, s[8:11], s37 offen sc1 lds
s_waitcnt vmcnt(32)
s_barrier
s_lshl_b32 s43, s35, 8
s_cmp_eq_u32 s51, 1
s_cselect_b32 s8, s4, s6
s_cselect_b32 s9, s5, s7
s_sub_u32 s10, 7340032, s43
s_lshl_b32 s44, s34, 18
s_add_u32 s44, s44, 4194304
s_movk_i32 s38, 28672
s_cmp_eq_u32 s51, 0
s_cselect_b32 s8, s32, s8
s_cselect_b32 s9, s33, s9
s_cselect_b32 s10, 262144, s10
s_cselect_b32 s43, s44, s43
s_cselect_b32 s38, 1024, s38
s_cselect_b32 s45, 0, -1
s_add_u32 s8, s8, s43
s_addc_u32 s9, s9, 0
s_mov_b32 s11, 0x20000
s_lshl_b32 s40, s38, 4
s_add_u32 s42, s35, 15
s_lshl_b32 s39, s51, 14
v_lshrrev_b32 v19, 4, v1
v_lshlrev_b32 v20, 5, v19
v_mul_u32_u24 v19, 6912, v19
v_and_b32 v19, s45, v19
v_and_b32 v20, s45, v20
v_lshlrev_b32 v21, 4, v1
v_xor_b32 v21, v21, v20
v_add_u32 v22, v21, v19
s_and_b32 s45, s45, 128
v_xor_b32 v23, s45, v22
s_waitcnt vmcnt(24)
s_barrier
s_waitcnt vmcnt(16)
s_barrier
s_waitcnt vmcnt(8)
s_barrier
s_waitcnt vmcnt(0)
s_barrier
s_barrier
s_barrier
s_add_u32 s42, s42, 3
s_add_u32 s43, s34, 16
s_lshl_b32 s43, s43, 7
v_mov_b32 v8, s43
v_mov_b32 v10, 16
buffer_load_dword v9, v8, s[56:59], 0 offen sc1
s_mov_b32 s41, 0x10000
Lpoll_43:
s_waitcnt vmcnt(0)
Lpf_45:
v_cmp_ne_u32 vcc, v10, v9
s_nop 4
s_cbranch_vccz Lpok_44
buffer_load_dword v9, v8, s[56:59], 0 offen sc1
s_sub_u32 s41, s41, 1
s_cmp_lg_u32 s41, 0
s_cbranch_scc1 Lpoll_43
s_waitcnt vmcnt(0)
Lpok_44:
s_branch LP3_36
Lp_38:
s_barrier
s_add_u32 m0, s54, 0
s_add_u32 s43, s54, 0
buffer_load_dwordx4 v21, s[12:15], s43 offen sc1 lds
s_add_u32 m0, s54, 1024
s_add_u32 s43, s54, 1024
buffer_load_dwordx4 v21, s[12:15], s43 offen sc1 lds
s_add_u32 m0, s54, 24576
s_add_u32 s43, s54, 16384
buffer_load_dwordx4 v21, s[12:15], s43 offen sc1 lds
s_add_u32 m0, s54, 25600
s_add_u32 s43, s54, 17408
buffer_load_dwordx4 v21, s[12:15], s43 offen sc1 lds
s_add_u32 s37, s37, 32768
s_add_u32 m0, s39, 49152
s_add_u32 s37, s37, s40
buffer_load_dwordx4 v23, s[8:11], s37 offen sc1 lds
s_add_u32 m0, s39, 50176
s_add_u32 s37, s37, s38
buffer_load_dwordx4 v23, s[8:11], s37 offen sc1 lds
s_add_u32 m0, s39, 51200
s_add_u32 s37, s37, s38
buffer_load_dwordx4 v23, s[8:11], s37 offen sc1 lds
s_add_u32 m0, s39, 52224
s_add_u32 s37, s37, s38
buffer_load_dwordx4 v23, s[8:11], s37 offen sc1 lds
s_add_u32 m0, s39, 53248
s_add_u32 s37, s37, s55
buffer_load_dwordx4 v23, s[8:11], s37 offen sc1 lds
s_add_u32 m0, s39, 54272
s_add_u32 s37, s37, s38
buffer_load_dwordx4 v23, s[8:11], s37 offen sc1 lds
s_add_u32 m0, s39, 55296
s_add_u32 s37, s37, s38
buffer_load_dwordx4 v23, s[8:11], s37 offen sc1 lds
s_add_u32 m0, s39, 56320
s_add_u32 s37, s37, s38
buffer_load_dwordx4 v23, s[8:11], s37 offen sc1 lds
s_add_u32 m0, s39, 73728
s_add_u32 s37, s37, s40
buffer_load_dwordx4 v23, s[8:11], s37 offen sc1 lds
s_add_u32 m0, s39, 74752
s_add_u32 s37, s37, s38
buffer_load_dwordx4 v23, s[8:11], s37 offen sc1 lds
s_add_u32 m0, s39, 75776
s_add_u32 s37, s37, s38
buffer_load_dwordx4 v23, s[8:11], s37 offen sc1 lds
s_add_u32 m0, s39, 76800
s_add_u32 s37, s37, s38
buffer_load_dwordx4 v23, s[8:11], s37 offen sc1 lds
s_add_u32 m0, s39, 77824
s_add_u32 s37, s37, s55
buffer_load_dwordx4 v23, s[8:11], s37 offen sc1 lds
s_add_u32 m0, s39, 78848
s_add_u32 s37, s37, s38
buffer_load_dwordx4 v23, s[8:11], s37 offen sc1 lds
s_add_u32 m0, s39, 79872
s_add_u32 s37, s37, s38
buffer_load_dwordx4 v23, s[8:11], s37 offen sc1 lds
s_add_u32 m0, s39, 80896
s_add_u32 s37, s37, s38
buffer_load_dwordx4 v23, s[8:11], s37 offen sc1 lds
s_add_u32 m0, s39, 98304
s_add_u32 s37, s37, s40
buffer_load_dwordx4 v23, s[8:11], s37 offen sc1 lds
s_add_u32 m0, s39, 99328
s_add_u32 s37, s37, s38
buffer_load_dwordx4 v23, s[8:11], s37 offen sc1 lds
s_add_u32 m0, s39, 100352
s_add_u32 s37, s37, s38
buffer_load_dwordx4 v23, s[8:11], s37 offen sc1 lds
s_add_u32 m0, s39, 101376
s_add_u32 s37, s37, s38
buffer_load_dwordx4 v23, s[8:11], s37 offen sc1 lds
s_add_u32 m0, s39, 102400
s_add_u32 s37, s37, s55
buffer_load_dwordx4 v23, s[8:11], s37 offen sc1 lds
s_add_u32 m0, s39, 103424
s_add_u32 s37, s37, s38
buffer_load_dwordx4 v23, s[8:11], s37 offen sc1 lds
s_add_u32 m0, s39, 104448
s_add_u32 s37, s37, s38
buffer_load_dwordx4 v23, s[8:11], s37 offen sc1 lds
s_add_u32 m0, s39, 105472
s_add_u32 s37, s37, s38
buffer_load_dwordx4 v23, s[8:11], s37 offen sc1 lds
s_add_u32 m0, s39, 122880
s_add_u32 s37, s37, s40
buffer_load_dwordx4 v23, s[8:11], s37 offen sc1 lds
s_add_u32 m0, s39, 123904
s_add_u32 s37, s37, s38
buffer_load_dwordx4 v23, s[8:11], s37 offen sc1 lds
s_add_u32 m0, s39, 124928
s_add_u32 s37, s37, s38
buffer_load_dwordx4 v23, s[8:11], s37 offen sc1 lds
s_add_u32 m0, s39, 125952
s_add_u32 s37, s37, s38
buffer_load_dwordx4 v23, s[8:11], s37 offen sc1 lds
s_add_u32 m0, s39, 126976
s_add_u32 s37, s37, s55
buffer_load_dwordx4 v23, s[8:11], s37 offen sc1 lds
s_add_u32 m0, s39, 128000
s_add_u32 s37, s37, s38
buffer_load_dwordx4 v23, s[8:11], s37 offen sc1 lds
s_add_u32 m0, s39, 129024
s_add_u32 s37, s37, s38
buffer_load_dwordx4 v23, s[8:11], s37 offen sc1 lds
s_add_u32 m0, s39, 130048
s_add_u32 s37, s37, s38
buffer_load_dwordx4 v23, s[8:11], s37 offen sc1 lds
s_waitcnt vmcnt(34)
s_barrier
s_waitcnt vmcnt(32)
s_barrier
s_add_u32 m0, s39, 0
s_add_u32 s37, s37, s40
buffer_load_dwordx4 v23, s[8:11], s37 offen sc1 lds
s_add_u32 m0, s39, 1024
s_add_u32 s37, s37, s38
buffer_load_dwordx4 v23, s[8:11], s37 offen sc1 lds
s_add_u32 m0, s39, 2048
s_add_u32 s37, s37, s38
buffer_load_dwordx4 v23, s[8:11], s37 offen sc1 lds
s_add_u32 m0, s39, 3072
s_add_u32 s37, s37, s38
buffer_load_dwordx4 v23, s[8:11], s37 offen sc1 lds
s_add_u32 m0, s39, 4096
s_add_u32 s37, s37, s55
buffer_load_dwordx4 v23, s[8:11], s37 offen sc1 lds
s_add_u32 m0, s39, 5120
s_add_u32 s37, s37, s38
buffer_load_dwordx4 v23, s[8:11], s37 offen sc1 lds
s_add_u32 m0, s39, 6144
s_add_u32 s37, s37, s38
buffer_load_dwordx4 v23, s[8:11], s37 offen sc1 lds
s_add_u32 m0, s39, 7168
s_add_u32 s37, s37, s38
buffer_load_dwordx4 v23, s[8:11], s37 offen sc1 lds
s_waitcnt vmcnt(32)
s_barrier
s_add_u32 m0, s39, 24576
s_add_u32 s37, s37, s40
buffer_load_dwordx4 v23, s[8:11], s37 offen sc1 lds
s_add_u32 m0, s39, 25600
s_add_u32 s37, s37, s38
buffer_load_dwordx4 v23, s[8:11], s37 offen sc1 lds
s_add_u32 m0, s39, 26624
s_add_u32 s37, s37, s38
buffer_load_dwordx4 v23, s[8:11], s37 offen sc1 lds
s_add_u32 m0, s39, 27648
s_add_u32 s37, s37, s38
buffer_load_dwordx4 v23, s[8:11], s37 offen sc1 lds
s_add_u32 m0, s39, 28672
s_add_u32 s37, s37, s55
buffer_load_dwordx4 v23, s[8:11], s37 offen sc1 lds
s_add_u32 m0, s39, 29696
s_add_u32 s37, s37, s38
buffer_load_dwordx4 v23, s[8:11], s37 offen sc1 lds
s_add_u32 m0, s39, 30720
s_add_u32 s37, s37, s38
buffer_load_dwordx4 v23, s[8:11], s37 offen sc1 lds
s_add_u32 m0, s39, 31744
s_add_u32 s37, s37, s38
buffer_load_dwordx4 v23, s[8:11], s37 offen sc1 lds
s_waitcnt vmcnt(32)
s_barrier
s_add_u32 m0, s39, 49152
s_add_u32 s37, s37, s40
buffer_load_dwordx4 v23, s[8:11], s37 offen sc1 lds
s_add_u32 m0, s39, 50176
s_add_u32 s37, s37, s38
buffer_load_dwordx4 v23, s[8:11], s37 offen sc1 lds
s_add_u32 m0, s39, 51200
s_add_u32 s37, s37, s38
buffer_load_dwordx4 v23, s[8:11], s37 offen sc1 lds
s_add_u32 m0, s39, 52224
s_add_u32 s37, s37, s38
buffer_load_dwordx4 v23, s[8:11], s37 offen sc1 lds
s_add_u32 m0, s39, 53248
s_add_u32 s37, s37, s55
buffer_load_dwordx4 v23, s[8:11], s37 offen sc1 lds
s_add_u32 m0, s39, 54272
s_add_u32 s37, s37, s38
buffer_load_dwordx4 v23, s[8:11], s37 offen sc1 lds
s_add_u32 m0, s39, 55296
s_add_u32 s37, s37, s38
buffer_load_dwordx4 v23, s[8:11], s37 offen sc1 lds
s_add_u32 m0, s39, 56320
s_add_u32 s37, s37, s38
buffer_load_dwordx4 v23, s[8:11], s37 offen sc1 lds
s_waitcnt vmcnt(32)
s_barrier
s_add_u32 m0, s39, 73728
s_add_u32 s37, s37, s40
buffer_load_dwordx4 v23, s[8:11], s37 offen sc1 lds
s_add_u32 m0, s39, 74752
s_add_u32 s37, s37, s38
buffer_load_dwordx4 v23, s[8:11], s37 offen sc1 lds
s_add_u32 m0, s39, 75776
s_add_u32 s37, s37, s38
buffer_load_dwordx4 v23, s[8:11], s37 offen sc1 lds
s_add_u32 m0, s39, 76800
s_add_u32 s37, s37, s38
buffer_load_dwordx4 v23, s[8:11], s37 offen sc1 lds
s_add_u32 m0, s39, 77824
s_add_u32 s37, s37, s55
buffer_load_dwordx4 v23, s[8:11], s37 offen sc1 lds
s_add_u32 m0, s39, 78848
s_add_u32 s37, s37, s38
buffer_load_dwordx4 v23, s[8:11], s37 offen sc1 lds
s_add_u32 m0, s39, 79872
s_add_u32 s37, s37, s38
buffer_load_dwordx4 v23, s[8:11], s37 offen sc1 lds
s_add_u32 m0, s39, 80896
s_add_u32 s37, s37, s38
buffer_load_dwordx4 v23, s[8:11], s37 offen sc1 lds
s_waitcnt vmcnt(32)
s_barrier
s_add_u32 m0, s39, 98304
s_add_u32 s37, s37, s40
buffer_load_dwordx4 v23, s[8:11], s37 offen sc1 lds
s_add_u32 m0, s39, 99328
s_add_u32 s37, s37, s38
buffer_load_dwordx4 v23, s[8:11], s37 offen sc1 lds
s_add_u32 m0, s39, 100352
s_add_u32 s37, s37, s38
buffer_load_dwordx4 v23, s[8:11], s37 offen sc1 lds
s_add_u32 m0, s39, 101376
s_add_u32 s37, s37, s38
buffer_load_dwordx4 v23, s[8:11], s37 offen sc1 lds
s_add_u32 m0, s39, 102400
s_add_u32 s37, s37, s55
buffer_load_dwordx4 v23, s[8:11], s37 offen sc1 lds
s_add_u32 m0, s39, 103424
s_add_u32 s37, s37, s38
buffer_load_dwordx4 v23, s[8:11], s37 offen sc1 lds
s_add_u32 m0, s39, 104448
s_add_u32 s37, s37, s38
buffer_load_dwordx4 v23, s[8:11], s37 offen sc1 lds
s_add_u32 m0, s39, 105472
s_add_u32 s37, s37, s38
buffer_load_dwordx4 v23, s[8:11], s37 offen sc1 lds
s_waitcnt vmcnt(32)
s_barrier
s_add_u32 m0, s39, 122880
s_add_u32 s37, s37, s40
buffer_load_dwordx4 v23, s[8:11], s37 offen sc1 lds
s_add_u32 m0, s39, 123904
s_add_u32 s37, s37, s38
buffer_load_dwordx4 v23, s[8:11], s37 offen sc1 lds
s_add_u32 m0, s39, 124928
s_add_u32 s37, s37, s38
buffer_load_dwordx4 v23, s[8:11], s37 offen sc1 lds
s_add_u32 m0, s39, 125952
s_add_u32 s37, s37, s38
buffer_load_dwordx4 v23, s[8:11], s37 offen sc1 lds
s_add_u32 m0, s39, 126976
s_add_u32 s37, s37, s55
buffer_load_dwordx4 v23, s[8:11], s37 offen sc1 lds
s_add_u32 m0, s39, 128000
s_add_u32 s37, s37, s38
buffer_load_dwordx4 v23, s[8:11], s37 offen sc1 lds
s_add_u32 m0, s39, 129024
s_add_u32 s37, s37, s38
buffer_load_dwordx4 v23, s[8:11], s37 offen sc1 lds
s_add_u32 m0, s39, 130048
s_add_u32 s37, s37, s38
buffer_load_dwordx4 v23, s[8:11], s37 offen sc1 lds
s_waitcnt vmcnt(32)
s_barrier
s_add_u32 m0, s39, 0
s_add_u32 s37, s37, s40
buffer_load_dwordx4 v23, s[8:11], s37 offen sc1 lds
s_add_u32 m0, s39, 1024
s_add_u32 s37, s37, s38
buffer_load_dwordx4 v23, s[8:11], s37 offen sc1 lds
s_add_u32 m0, s39, 2048
s_add_u32 s37, s37, s38
buffer_load_dwordx4 v23, s[8:11], s37 offen sc1 lds
s_add_u32 m0, s39, 3072
s_add_u32 s37, s37, s38
buffer_load_dwordx4 v23, s[8:11], s37 offen sc1 lds
s_add_u32 m0, s39, 4096
s_add_u32 s37, s37, s55
buffer_load_dwordx4 v23, s[8:11], s37 offen sc1 lds
s_add_u32 m0, s39, 5120
s_add_u32 s37, s37, s38
buffer_load_dwordx4 v23, s[8:11], s37 offen sc1 lds
s_add_u32 m0, s39, 6144
s_add_u32 s37, s37, s38
buffer_load_dwordx4 v23, s[8:11], s37 offen sc1 lds
s_add_u32 m0, s39, 7168
s_add_u32 s37, s37, s38
buffer_load_dwordx4 v23, s[8:11], s37 offen sc1 lds
s_waitcnt vmcnt(32)
s_barrier
s_add_u32 m0, s39, 24576
s_add_u32 s37, s37, s40
buffer_load_dwordx4 v23, s[8:11], s37 offen sc1 lds
s_add_u32 m0, s39, 25600
s_add_u32 s37, s37, s38
buffer_load_dwordx4 v23, s[8:11], s37 offen sc1 lds
s_add_u32 m0, s39, 26624
s_add_u32 s37, s37, s38
buffer_load_dwordx4 v23, s[8:11], s37 offen sc1 lds
s_add_u32 m0, s39, 27648
s_add_u32 s37, s37, s38
buffer_load_dwordx4 v23, s[8:11], s37 offen sc1 lds
s_add_u32 m0, s39, 28672
s_add_u32 s37, s37, s55
buffer_load_dwordx4 v23, s[8:11], s37 offen sc1 lds
s_add_u32 m0, s39, 29696
s_add_u32 s37, s37, s38
buffer_load_dwordx4 v23, s[8:11], s37 offen sc1 lds
s_add_u32 m0, s39, 30720
s_add_u32 s37, s37, s38
buffer_load_dwordx4 v23, s[8:11], s37 offen sc1 lds
s_add_u32 m0, s39, 31744
s_add_u32 s37, s37, s38
buffer_load_dwordx4 v23, s[8:11], s37 offen sc1 lds
s_waitcnt vmcnt(32)
s_barrier
s_add_u32 m0, s39, 49152
s_add_u32 s37, s37, s40
buffer_load_dwordx4 v23, s[8:11], s37 offen sc1 lds
s_add_u32 m0, s39, 50176
s_add_u32 s37, s37, s38
buffer_load_dwordx4 v23, s[8:11], s37 offen sc1 lds
s_add_u32 m0, s39, 51200
s_add_u32 s37, s37, s38
buffer_load_dwordx4 v23, s[8:11], s37 offen sc1 lds
s_add_u32 m0, s39, 52224
s_add_u32 s37, s37, s38
buffer_load_dwordx4 v23, s[8:11], s37 offen sc1 lds
s_add_u32 m0, s39, 53248
s_add_u32 s37, s37, s55
buffer_load_dwordx4 v23, s[8:11], s37 offen sc1 lds
s_add_u32 m0, s39, 54272
s_add_u32 s37, s37, s38
buffer_load_dwordx4 v23, s[8:11], s37 offen sc1 lds
s_add_u32 m0, s39, 55296
s_add_u32 s37, s37, s38
buffer_load_dwordx4 v23, s[8:11], s37 offen sc1 lds
s_add_u32 m0, s39, 56320
s_add_u32 s37, s37, s38
buffer_load_dwordx4 v23, s[8:11], s37 offen sc1 lds
s_waitcnt vmcnt(32)
s_barrier
s_add_u32 m0, s39, 73728
s_add_u32 s37, s37, s40
buffer_load_dwordx4 v23, s[8:11], s37 offen sc1 lds
s_add_u32 m0, s39, 74752
s_add_u32 s37, s37, s38
buffer_load_dwordx4 v23, s[8:11], s37 offen sc1 lds
s_add_u32 m0, s39, 75776
s_add_u32 s37, s37, s38
buffer_load_dwordx4 v23, s[8:11], s37 offen sc1 lds
s_add_u32 m0, s39, 76800
s_add_u32 s37, s37, s38
buffer_load_dwordx4 v23, s[8:11], s37 offen sc1 lds
s_add_u32 m0, s39, 77824
s_add_u32 s37, s37, s55
buffer_load_dwordx4 v23, s[8:11], s37 offen sc1 lds
s_add_u32 m0, s39, 78848
s_add_u32 s37, s37, s38
buffer_load_dwordx4 v23, s[8:11], s37 offen sc1 lds
s_add_u32 m0, s39, 79872
s_add_u32 s37, s37, s38
buffer_load_dwordx4 v23, s[8:11], s37 offen sc1 lds
s_add_u32 m0, s39, 80896
s_add_u32 s37, s37, s38
buffer_load_dwordx4 v23, s[8:11], s37 offen sc1 lds
s_waitcnt vmcnt(32)
s_barrier
s_lshl_b32 s43, s35, 8
s_cmp_eq_u32 s51, 1
s_cselect_b32 s8, s4, s6
s_cselect_b32 s9, s5, s7
s_sub_u32 s10, 7340032, s43
s_lshl_b32 s44, s34, 18
s_add_u32 s44, s44, 4194304
s_movk_i32 s38, 28672
s_cmp_eq_u32 s51, 0
s_cselect_b32 s8, s32, s8
s_cselect_b32 s9, s33, s9
s_cselect_b32 s10, 262144, s10
s_cselect_b32 s43, s44, s43
s_cselect_b32 s38, 1024, s38
s_cselect_b32 s45, 0, -1
s_add_u32 s8, s8, s43
s_addc_u32 s9, s9, 0
s_mov_b32 s11, 0x20000
s_lshl_b32 s40, s38, 4
s_add_u32 s42, s35, 15
s_lshl_b32 s39, s51, 14
v_lshrrev_b32 v19, 4, v1
v_lshlrev_b32 v20, 5, v19
v_mul_u32_u24 v19, 6912, v19
v_and_b32 v19, s45, v19
v_and_b32 v20, s45, v20
v_lshlrev_b32 v21, 4, v1
v_xor_b32 v21, v21, v20
v_add_u32 v22, v21, v19
s_and_b32 s45, s45, 128
v_xor_b32 v23, s45, v22
s_waitcnt vmcnt(24)
s_barrier
s_add_u32 s42, s42, 1
s_and_b32 s42, s42, 15
s_add_u32 m0, s39, 98304
s_mul_i32 s37, s42, s40
buffer_load_dwordx4 v22, s[8:11], s37 offen sc1 lds
s_add_u32 m0, s39, 99328
s_add_u32 s37, s37, s38
buffer_load_dwordx4 v23, s[8:11], s37 offen sc1 lds
s_add_u32 m0, s39, 100352
s_add_u32 s37, s37, s38
buffer_load_dwordx4 v22, s[8:11], s37 offen sc1 lds
s_add_u32 m0, s39, 101376
s_add_u32 s37, s37, s38
buffer_load_dwordx4 v23, s[8:11], s37 offen sc1 lds
s_add_u32 m0, s39, 102400
s_add_u32 s37, s37, s38
buffer_load_dwordx4 v22, s[8:11], s37 offen sc1 lds
s_add_u32 m0, s39, 103424
s_add_u32 s37, s37, s38
buffer_load_dwordx4 v23, s[8:11], s37 offen sc1 lds
s_add_u32 m0, s39, 104448
s_add_u32 s37, s37, s38
buffer_load_dwordx4 v22, s[8:11], s37 offen sc1 lds
s_add_u32 m0, s39, 105472
s_add_u32 s37, s37, s38
buffer_load_dwordx4 v23, s[8:11], s37 offen sc1 lds
s_add_u32 m0, s39, 106496
s_add_u32 s37, s37, s38
buffer_load_dwordx4 v22, s[8:11], s37 offen sc1 lds
s_add_u32 m0, s39, 107520
s_add_u32 s37, s37, s38
buffer_load_dwordx4 v23, s[8:11], s37 offen sc1 lds
s_add_u32 m0, s39, 108544
s_add_u32 s37, s37, s38
buffer_load_dwordx4 v22, s[8:11], s37 offen sc1 lds
s_add_u32 m0, s39, 109568
s_add_u32 s37, s37, s38
buffer_load_dwordx4 v23, s[8:11], s37 offen sc1 lds
s_add_u32 m0, s39, 110592
s_add_u32 s37, s37, s38
buffer_load_dwordx4 v22, s[8:11], s37 offen sc1 lds
s_add_u32 m0, s39, 111616
s_add_u32 s37, s37, s38
buffer_load_dwordx4 v23, s[8:11], s37 offen sc1 lds
s_add_u32 m0, s39, 112640
s_add_u32 s37, s37, s38
buffer_load_dwordx4 v22, s[8:11], s37 offen sc1 lds
s_add_u32 m0, s39, 113664
s_add_u32 s37, s37, s38
buffer_load_dwordx4 v23, s[8:11], s37 offen sc1 lds
s_waitcnt vmcnt(32)
s_barrier
s_waitcnt vmcnt(24)
s_barrier
s_add_u32 s42, s42, 1
s_and_b32 s42, s42, 15
s_add_u32 m0, s39, 0
s_mul_i32 s37, s42, s40
buffer_load_dwordx4 v22, s[8:11], s37 offen sc1 lds
s_add_u32 m0, s39, 1024
s_add_u32 s37, s37, s38
buffer_load_dwordx4 v23, s[8:11], s37 offen sc1 lds
s_add_u32 m0, s39, 2048
s_add_u32 s37, s37, s38
buffer_load_dwordx4 v22, s[8:11], s37 offen sc1 lds
s_add_u32 m0, s39, 3072
s_add_u32 s37, s37, s38
buffer_load_dwordx4 v23, s[8:11], s37 offen sc1 lds
s_add_u32 m0, s39, 4096
s_add_u32 s37, s37, s38
buffer_load_dwordx4 v22, s[8:11], s37 offen sc1 lds
s_add_u32 m0, s39, 5120
s_add_u32 s37, s37, s38
buffer_load_dwordx4 v23, s[8:11], s37 offen sc1 lds
s_add_u32 m0, s39, 6144
s_add_u32 s37, s37, s38
buffer_load_dwordx4 v22, s[8:11], s37 offen sc1 lds
s_add_u32 m0, s39, 7168
s_add_u32 s37, s37, s38
buffer_load_dwordx4 v23, s[8:11], s37 offen sc1 lds
s_add_u32 m0, s39, 8192
s_add_u32 s37, s37, s38
buffer_load_dwordx4 v22, s[8:11], s37 offen sc1 lds
s_add_u32 m0, s39, 9216
s_add_u32 s37, s37, s38
buffer_load_dwordx4 v23, s[8:11], s37 offen sc1 lds
s_add_u32 m0, s39, 10240
s_add_u32 s37, s37, s38
buffer_load_dwordx4 v22, s[8:11], s37 offen sc1 lds
s_add_u32 m0, s39, 11264
s_add_u32 s37, s37, s38
buffer_load_dwordx4 v23, s[8:11], s37 offen sc1 lds
s_add_u32 m0, s39, 12288
s_add_u32 s37, s37, s38
buffer_load_dwordx4 v22, s[8:11], s37 offen sc1 lds
s_add_u32 m0, s39, 13312
s_add_u32 s37, s37, s38
buffer_load_dwordx4 v23, s[8:11], s37 offen sc1 lds
s_add_u32 m0, s39, 14336
s_add_u32 s37, s37, s38
buffer_load_dwordx4 v22, s[8:11], s37 offen sc1 lds
s_add_u32 m0, s39, 15360
s_add_u32 s37, s37, s38
buffer_load_dwordx4 v23, s[8:11], s37 offen sc1 lds
s_waitcnt vmcnt(32)
s_barrier
s_barrier
s_waitcnt vmcnt(16)
s_barrier
s_add_u32 s42, s42, 1
s_and_b32 s42, s42, 15
s_add_u32 m0, s39, 49152
s_mul_i32 s37, s42, s40
buffer_load_dwordx4 v22, s[8:11], s37 offen sc1 lds
s_add_u32 m0, s39, 50176
s_add_u32 s37, s37, s38
buffer_load_dwordx4 v23, s[8:11], s37 offen sc1 lds
s_add_u32 m0, s39, 51200
s_add_u32 s37, s37, s38
buffer_load_dwordx4 v22, s[8:11], s37 offen sc1 lds
s_add_u32 m0, s39, 52224
s_add_u32 s37, s37, s38
buffer_load_dwordx4 v23, s[8:11], s37 offen sc1 lds
s_add_u32 m0, s39, 53248
s_add_u32 s37, s37, s38
buffer_load_dwordx4 v22, s[8:11], s37 offen sc1 lds
s_add_u32 m0, s39, 54272
s_add_u32 s37, s37, s38
buffer_load_dwordx4 v23, s[8:11], s37 offen sc1 lds
s_add_u32 m0, s39, 55296
s_add_u32 s37, s37, s38
buffer_load_dwordx4 v22, s[8:11], s37 offen sc1 lds
s_add_u32 m0, s39, 56320
s_add_u32 s37, s37, s38
buffer_load_dwordx4 v23, s[8:11], s37 offen sc1 lds
s_add_u32 m0, s39, 57344
s_add_u32 s37, s37, s38
buffer_load_dwordx4 v22, s[8:11], s37 offen sc1 lds
s_add_u32 m0, s39, 58368
s_add_u32 s37, s37, s38
buffer_load_dwordx4 v23, s[8:11], s37 offen sc1 lds
s_add_u32 m0, s39, 59392
s_add_u32 s37, s37, s38
buffer_load_dwordx4 v22, s[8:11], s37 offen sc1 lds
s_add_u32 m0, s39, 60416
s_add_u32 s37, s37, s38
buffer_load_dwordx4 v23, s[8:11], s37 offen sc1 lds
s_add_u32 m0, s39, 61440
s_add_u32 s37, s37, s38
buffer_load_dwordx4 v22, s[8:11], s37 offen sc1 lds
s_add_u32 m0, s39, 62464
s_add_u32 s37, s37, s38
buffer_load_dwordx4 v23, s[8:11], s37 offen sc1 lds
s_add_u32 m0, s39, 63488
s_add_u32 s37, s37, s38
buffer_load_dwordx4 v22, s[8:11], s37 offen sc1 lds
s_add_u32 m0, s39, 64512
s_add_u32 s37, s37, s38
buffer_load_dwordx4 v23, s[8:11], s37 offen sc1 lds
s_branch LP3_36
Lp_39:
s_add_u32 m0, s39, 0
s_add_u32 s37, s37, s40
buffer_load_dwordx4 v23, s[8:11], s37 offen sc1 lds
s_add_u32 m0, s39, 1024
s_add_u32 s37, s37, s38
buffer_load_dwordx4 v23, s[8:11], s37 offen sc1 lds
s_add_u32 m0, s39, 2048
s_add_u32 s37, s37, s38
buffer_load_dwordx4 v23, s[8:11], s37 offen sc1 lds
s_add_u32 m0, s39, 3072
s_add_u32 s37, s37, s38
buffer_load_dwordx4 v23, s[8:11], s37 offen sc1 lds
s_add_u32 m0, s39, 4096
s_add_u32 s37, s37, s55
buffer_load_dwordx4 v23, s[8:11], s37 offen sc1 lds
s_add_u32 m0, s39, 5120
s_add_u32 s37, s37, s38
buffer_load_dwordx4 v23, s[8:11], s37 offen sc1 lds
s_add_u32 m0, s39, 6144
s_add_u32 s37, s37, s38
buffer_load_dwordx4 v23, s[8:11], s37 offen sc1 lds
s_add_u32 m0, s39, 7168
s_add_u32 s37, s37, s38
buffer_load_dwordx4 v23, s[8:11], s37 offen sc1 lds
s_add_u32 m0, s39, 24576
s_add_u32 s37, s37, s40
buffer_load_dwordx4 v23, s[8:11], s37 offen sc1 lds
s_add_u32 m0, s39, 25600
s_add_u32 s37, s37, s38
buffer_load_dwordx4 v23, s[8:11], s37 offen sc1 lds
s_add_u32 m0, s39, 26624
s_add_u32 s37, s37, s38
buffer_load_dwordx4 v23, s[8:11], s37 offen sc1 lds
s_add_u32 m0, s39, 27648
s_add_u32 s37, s37, s38
buffer_load_dwordx4 v23, s[8:11], s37 offen sc1 lds
s_add_u32 m0, s39, 28672
s_add_u32 s37, s37, s55
buffer_load_dwordx4 v23, s[8:11], s37 offen sc1 lds
s_add_u32 m0, s39, 29696
s_add_u32 s37, s37, s38
buffer_load_dwordx4 v23, s[8:11], s37 offen sc1 lds
s_add_u32 m0, s39, 30720
s_add_u32 s37, s37, s38
buffer_load_dwordx4 v23, s[8:11], s37 offen sc1 lds
s_add_u32 m0, s39, 31744
s_add_u32 s37, s37, s38
buffer_load_dwordx4 v23, s[8:11], s37 offen sc1 lds
s_add_u32 m0, s39, 49152
s_add_u32 s37, s37, s40
buffer_load_dwordx4 v23, s[8:11], s37 offen sc1 lds
s_add_u32 m0, s39, 50176
s_add_u32 s37, s37, s38
buffer_load_dwordx4 v23, s[8:11], s37 offen sc1 lds
s_add_u32 m0, s39, 51200
s_add_u32 s37, s37, s38
buffer_load_dwordx4 v23, s[8:11], s37 offen sc1 lds
s_add_u32 m0, s39, 52224
s_add_u32 s37, s37, s38
buffer_load_dwordx4 v23, s[8:11], s37 offen sc1 lds
s_add_u32 m0, s39, 53248
s_add_u32 s37, s37, s55
buffer_load_dwordx4 v23, s[8:11], s37 offen sc1 lds
s_add_u32 m0, s39, 54272
s_add_u32 s37, s37, s38
buffer_load_dwordx4 v23, s[8:11], s37 offen sc1 lds
s_add_u32 m0, s39, 55296
s_add_u32 s37, s37, s38
buffer_load_dwordx4 v23, s[8:11], s37 offen sc1 lds
s_add_u32 m0, s39, 56320
s_add_u32 s37, s37, s38
buffer_load_dwordx4 v23, s[8:11], s37 offen sc1 lds
s_add_u32 m0, s39, 73728
s_add_u32 s37, s37, s40
buffer_load_dwordx4 v23, s[8:11], s37 offen sc1 lds
s_add_u32 m0, s39, 74752
s_add_u32 s37, s37, s38
buffer_load_dwordx4 v23, s[8:11], s37 offen sc1 lds
s_add_u32 m0, s39, 75776
s_add_u32 s37, s37, s38
buffer_load_dwordx4 v23, s[8:11], s37 offen sc1 lds
s_add_u32 m0, s39, 76800
s_add_u32 s37, s37, s38
buffer_load_dwordx4 v23, s[8:11], s37 offen sc1 lds
s_add_u32 m0, s39, 77824
s_add_u32 s37, s37, s55
buffer_load_dwordx4 v23, s[8:11], s37 offen sc1 lds
s_add_u32 m0, s39, 78848
s_add_u32 s37, s37, s38
buffer_load_dwordx4 v23, s[8:11], s37 offen sc1 lds
s_add_u32 m0, s39, 79872
s_add_u32 s37, s37, s38
buffer_load_dwordx4 v23, s[8:11], s37 offen sc1 lds
s_add_u32 m0, s39, 80896
s_add_u32 s37, s37, s38
buffer_load_dwordx4 v23, s[8:11], s37 offen sc1 lds
s_add_u32 m0, s39, 98304
s_add_u32 s37, s37, s40
buffer_load_dwordx4 v23, s[8:11], s37 offen sc1 lds
s_add_u32 m0, s39, 99328
s_add_u32 s37, s37, s38
buffer_load_dwordx4 v23, s[8:11], s37 offen sc1 lds
s_add_u32 m0, s39, 100352
s_add_u32 s37, s37, s38
buffer_load_dwordx4 v23, s[8:11], s37 offen sc1 lds
s_add_u32 m0, s39, 101376
s_add_u32 s37, s37, s38
buffer_load_dwordx4 v23, s[8:11], s37 offen sc1 lds
s_add_u32 m0, s39, 102400
s_add_u32 s37, s37, s55
buffer_load_dwordx4 v23, s[8:11], s37 offen sc1 lds
s_add_u32 m0, s39, 103424
s_add_u32 s37, s37, s38
buffer_load_dwordx4 v23, s[8:11], s37 offen sc1 lds
s_add_u32 m0, s39, 104448
s_add_u32 s37, s37, s38
buffer_load_dwordx4 v23, s[8:11], s37 offen sc1 lds
s_add_u32 m0, s39, 105472
s_add_u32 s37, s37, s38
buffer_load_dwordx4 v23, s[8:11], s37 offen sc1 lds
s_add_u32 m0, s39, 122880
s_add_u32 s37, s37, s40
buffer_load_dwordx4 v23, s[8:11], s37 offen sc1 lds
s_add_u32 m0, s39, 123904
s_add_u32 s37, s37, s38
buffer_load_dwordx4 v23, s[8:11], s37 offen sc1 lds
s_add_u32 m0, s39, 124928
s_add_u32 s37, s37, s38
buffer_load_dwordx4 v23, s[8:11], s37 offen sc1 lds
s_add_u32 m0, s39, 125952
s_add_u32 s37, s37, s38
buffer_load_dwordx4 v23, s[8:11], s37 offen sc1 lds
s_add_u32 m0, s39, 126976
s_add_u32 s37, s37, s55
buffer_load_dwordx4 v23, s[8:11], s37 offen sc1 lds
s_add_u32 m0, s39, 128000
s_add_u32 s37, s37, s38
buffer_load_dwordx4 v23, s[8:11], s37 offen sc1 lds
s_add_u32 m0, s39, 129024
s_add_u32 s37, s37, s38
buffer_load_dwordx4 v23, s[8:11], s37 offen sc1 lds
s_add_u32 m0, s39, 130048
s_add_u32 s37, s37, s38
buffer_load_dwordx4 v23, s[8:11], s37 offen sc1 lds
s_barrier
s_add_u32 m0, s54, 0
s_add_u32 s43, s54, 0
buffer_load_dwordx4 v21, s[12:15], s43 offen sc1 lds
s_add_u32 m0, s54, 1024
s_add_u32 s43, s54, 1024
buffer_load_dwordx4 v21, s[12:15], s43 offen sc1 lds
s_add_u32 m0, s54, 24576
s_add_u32 s43, s54, 16384
buffer_load_dwordx4 v21, s[12:15], s43 offen sc1 lds
s_add_u32 m0, s54, 25600
s_add_u32 s43, s54, 17408
buffer_load_dwordx4 v21, s[12:15], s43 offen sc1 lds
s_waitcnt vmcnt(2)
s_barrier
s_waitcnt vmcnt(0)
s_barrier
s_add_u32 m0, s39, 0
s_add_u32 s37, s37, s40
buffer_load_dwordx4 v23, s[8:11], s37 offen sc1 lds
s_add_u32 m0, s39, 1024
s_add_u32 s37, s37, s38
buffer_load_dwordx4 v23, s[8:11], s37 offen sc1 lds
s_add_u32 m0, s39, 2048
s_add_u32 s37, s37, s38
buffer_load_dwordx4 v23, s[8:11], s37 offen sc1 lds
s_add_u32 m0, s39, 3072
s_add_u32 s37, s37, s38
buffer_load_dwordx4 v23, s[8:11], s37 offen sc1 lds
s_add_u32 m0, s39, 4096
s_add_u32 s37, s37, s55
buffer_load_dwordx4 v23, s[8:11], s37 offen sc1 lds
s_add_u32 m0, s39, 5120
s_add_u32 s37, s37, s38
buffer_load_dwordx4 v23, s[8:11], s37 offen sc1 lds
s_add_u32 m0, s39, 6144
s_add_u32 s37, s37, s38
buffer_load_dwordx4 v23, s[8:11], s37 offen sc1 lds
s_add_u32 m0, s39, 7168
s_add_u32 s37, s37, s38
buffer_load_dwordx4 v23, s[8:11], s37 offen sc1 lds
s_waitcnt vmcnt(36)
s_barrier
s_add_u32 m0, s39, 24576
s_add_u32 s37, s37, s40
buffer_load_dwordx4 v23, s[8:11], s37 offen sc1 lds
s_add_u32 m0, s39, 25600
s_add_u32 s37, s37, s38
buffer_load_dwordx4 v23, s[8:11], s37 offen sc1 lds
s_add_u32 m0, s39, 26624
s_add_u32 s37, s37, s38
buffer_load_dwordx4 v23, s[8:11], s37 offen sc1 lds
s_add_u32 m0, s39, 27648
s_add_u32 s37, s37, s38
buffer_load_dwordx4 v23, s[8:11], s37 offen sc1 lds
s_add_u32 m0, s39, 28672
s_add_u32 s37, s37, s55
buffer_load_dwordx4 v23, s[8:11], s37 offen sc1 lds
s_add_u32 m0, s39, 29696
s_add_u32 s37, s37, s38
buffer_load_dwordx4 v23, s[8:11], s37 offen sc1 lds
s_add_u32 m0, s39, 30720
s_add_u32 s37, s37, s38
buffer_load_dwordx4 v23, s[8:11], s37 offen sc1 lds
s_add_u32 m0, s39, 31744
s_add_u32 s37, s37, s38
buffer_load_dwordx4 v23, s[8:11], s37 offen sc1 lds
s_waitcnt vmcnt(36)
s_barrier
s_add_u32 m0, s39, 49152
s_add_u32 s37, s37, s40
buffer_load_dwordx4 v23, s[8:11], s37 offen sc1 lds
s_add_u32 m0, s39, 50176
s_add_u32 s37, s37, s38
buffer_load_dwordx4 v23, s[8:11], s37 offen sc1 lds
s_add_u32 m0, s39, 51200
s_add_u32 s37, s37, s38
buffer_load_dwordx4 v23, s[8:11], s37 offen sc1 lds
s_add_u32 m0, s39, 52224
s_add_u32 s37, s37, s38
buffer_load_dwordx4 v23, s[8:11], s37 offen sc1 lds
s_add_u32 m0, s39, 53248
s_add_u32 s37, s37, s55
buffer_load_dwordx4 v23, s[8:11], s37 offen sc1 lds
s_add_u32 m0, s39, 54272
s_add_u32 s37, s37, s38
buffer_load_dwordx4 v23, s[8:11], s37 offen sc1 lds
s_add_u32 m0, s39, 55296
s_add_u32 s37, s37, s38
buffer_load_dwordx4 v23, s[8:11], s37 offen sc1 lds
s_add_u32 m0, s39, 56320
s_add_u32 s37, s37, s38
buffer_load_dwordx4 v23, s[8:11], s37 offen sc1 lds
s_waitcnt vmcnt(36)
s_barrier
s_add_u32 m0, s39, 73728
s_add_u32 s37, s37, s40
buffer_load_dwordx4 v23, s[8:11], s37 offen sc1 lds
s_add_u32 m0, s39, 74752
s_add_u32 s37, s37, s38
buffer_load_dwordx4 v23, s[8:11], s37 offen sc1 lds
s_add_u32 m0, s39, 75776
s_add_u32 s37, s37, s38
buffer_load_dwordx4 v23, s[8:11], s37 offen sc1 lds
s_add_u32 m0, s39, 76800
s_add_u32 s37, s37, s38
buffer_load_dwordx4 v23, s[8:11], s37 offen sc1 lds
s_add_u32 m0, s39, 77824
s_add_u32 s37, s37, s55
buffer_load_dwordx4 v23, s[8:11], s37 offen sc1 lds
s_add_u32 m0, s39, 78848
s_add_u32 s37, s37, s38
buffer_load_dwordx4 v23, s[8:11], s37 offen sc1 lds
s_add_u32 m0, s39, 79872
s_add_u32 s37, s37, s38
buffer_load_dwordx4 v23, s[8:11], s37 offen sc1 lds
s_add_u32 m0, s39, 80896
s_add_u32 s37, s37, s38
buffer_load_dwordx4 v23, s[8:11], s37 offen sc1 lds
s_waitcnt vmcnt(36)
s_barrier
s_add_u32 m0, s39, 98304
s_add_u32 s37, s37, s40
buffer_load_dwordx4 v23, s[8:11], s37 offen sc1 lds
s_add_u32 m0, s39, 99328
s_add_u32 s37, s37, s38
buffer_load_dwordx4 v23, s[8:11], s37 offen sc1 lds
s_add_u32 m0, s39, 100352
s_add_u32 s37, s37, s38
buffer_load_dwordx4 v23, s[8:11], s37 offen sc1 lds
s_add_u32 m0, s39, 101376
s_add_u32 s37, s37, s38
buffer_load_dwordx4 v23, s[8:11], s37 offen sc1 lds
s_add_u32 m0, s39, 102400
s_add_u32 s37, s37, s55
buffer_load_dwordx4 v23, s[8:11], s37 offen sc1 lds
s_add_u32 m0, s39, 103424
s_add_u32 s37, s37, s38
buffer_load_dwordx4 v23, s[8:11], s37 offen sc1 lds
s_add_u32 m0, s39, 104448
s_add_u32 s37, s37, s38
buffer_load_dwordx4 v23, s[8:11], s37 offen sc1 lds
s_add_u32 m0, s39, 105472
s_add_u32 s37, s37, s38
buffer_load_dwordx4 v23, s[8:11], s37 offen sc1 lds
s_waitcnt vmcnt(32)
s_barrier
s_add_u32 m0, s39, 122880
s_add_u32 s37, s37, s40
buffer_load_dwordx4 v23, s[8:11], s37 offen sc1 lds
s_add_u32 m0, s39, 123904
s_add_u32 s37, s37, s38
buffer_load_dwordx4 v23, s[8:11], s37 offen sc1 lds
s_add_u32 m0, s39, 124928
s_add_u32 s37, s37, s38
buffer_load_dwordx4 v23, s[8:11], s37 offen sc1 lds
s_add_u32 m0, s39, 125952
s_add_u32 s37, s37, s38
buffer_load_dwordx4 v23, s[8:11], s37 offen sc1 lds
s_add_u32 m0, s39, 126976
s_add_u32 s37, s37, s55
buffer_load_dwordx4 v23, s[8:11], s37 offen sc1 lds
s_add_u32 m0, s39, 128000
s_add_u32 s37, s37, s38
buffer_load_dwordx4 v23, s[8:11], s37 offen sc1 lds
s_add_u32 m0, s39, 129024
s_add_u32 s37, s37, s38
buffer_load_dwordx4 v23, s[8:11], s37 offen sc1 lds
s_add_u32 m0, s39, 130048
s_add_u32 s37, s37, s38
buffer_load_dwordx4 v23, s[8:11], s37 offen sc1 lds
s_waitcnt vmcnt(32)
s_barrier
s_add_u32 m0, s39, 0
s_add_u32 s37, s37, s40
buffer_load_dwordx4 v23, s[8:11], s37 offen sc1 lds
s_add_u32 m0, s39, 1024
s_add_u32 s37, s37, s38
buffer_load_dwordx4 v23, s[8:11], s37 offen sc1 lds
s_add_u32 m0, s39, 2048
s_add_u32 s37, s37, s38
buffer_load_dwordx4 v23, s[8:11], s37 offen sc1 lds
s_add_u32 m0, s39, 3072
s_add_u32 s37, s37, s38
buffer_load_dwordx4 v23, s[8:11], s37 offen sc1 lds
s_add_u32 m0, s39, 4096
s_add_u32 s37, s37, s55
buffer_load_dwordx4 v23, s[8:11], s37 offen sc1 lds
s_add_u32 m0, s39, 5120
s_add_u32 s37, s37, s38
buffer_load_dwordx4 v23, s[8:11], s37 offen sc1 lds
s_add_u32 m0, s39, 6144
s_add_u32 s37, s37, s38
buffer_load_dwordx4 v23, s[8:11], s37 offen sc1 lds
s_add_u32 m0, s39, 7168
s_add_u32 s37, s37, s38
buffer_load_dwordx4 v23, s[8:11], s37 offen sc1 lds
s_waitcnt vmcnt(32)
s_barrier
s_add_u32 m0, s39, 24576
s_add_u32 s37, s37, s40
buffer_load_dwordx4 v23, s[8:11], s37 offen sc1 lds
s_add_u32 m0, s39, 25600
s_add_u32 s37, s37, s38
buffer_load_dwordx4 v23, s[8:11], s37 offen sc1 lds
s_add_u32 m0, s39, 26624
s_add_u32 s37, s37, s38
buffer_load_dwordx4 v23, s[8:11], s37 offen sc1 lds
s_add_u32 m0, s39, 27648
s_add_u32 s37, s37, s38
buffer_load_dwordx4 v23, s[8:11], s37 offen sc1 lds
s_add_u32 m0, s39, 28672
s_add_u32 s37, s37, s55
buffer_load_dwordx4 v23, s[8:11], s37 offen sc1 lds
s_add_u32 m0, s39, 29696
s_add_u32 s37, s37, s38
buffer_load_dwordx4 v23, s[8:11], s37 offen sc1 lds
s_add_u32 m0, s39, 30720
s_add_u32 s37, s37, s38
buffer_load_dwordx4 v23, s[8:11], s37 offen sc1 lds
s_add_u32 m0, s39, 31744
s_add_u32 s37, s37, s38
buffer_load_dwordx4 v23, s[8:11], s37 offen sc1 lds
s_waitcnt vmcnt(32)
s_barrier
s_add_u32 m0, s39, 49152
s_add_u32 s37, s37, s40
buffer_load_dwordx4 v23, s[8:11], s37 offen sc1 lds
s_add_u32 m0, s39, 50176
s_add_u32 s37, s37, s38
buffer_load_dwordx4 v23, s[8:11], s37 offen sc1 lds
s_add_u32 m0, s39, 51200
s_add_u32 s37, s37, s38
buffer_load_dwordx4 v23, s[8:11], s37 offen sc1 lds
s_add_u32 m0, s39, 52224
s_add_u32 s37, s37, s38
buffer_load_dwordx4 v23, s[8:11], s37 offen sc1 lds
s_add_u32 m0, s39, 53248
s_add_u32 s37, s37, s55
buffer_load_dwordx4 v23, s[8:11], s37 offen sc1 lds
s_add_u32 m0, s39, 54272
s_add_u32 s37, s37, s38
buffer_load_dwordx4 v23, s[8:11], s37 offen sc1 lds
s_add_u32 m0, s39, 55296
s_add_u32 s37, s37, s38
buffer_load_dwordx4 v23, s[8:11], s37 offen sc1 lds
s_add_u32 m0, s39, 56320
s_add_u32 s37, s37, s38
buffer_load_dwordx4 v23, s[8:11], s37 offen sc1 lds
s_waitcnt vmcnt(32)
s_barrier
s_add_u32 m0, s39, 73728
s_add_u32 s37, s37, s40
buffer_load_dwordx4 v23, s[8:11], s37 offen sc1 lds
s_add_u32 m0, s39, 74752
s_add_u32 s37, s37, s38
buffer_load_dwordx4 v23, s[8:11], s37 offen sc1 lds
s_add_u32 m0, s39, 75776
s_add_u32 s37, s37, s38
buffer_load_dwordx4 v23, s[8:11], s37 offen sc1 lds
s_add_u32 m0, s39, 76800
s_add_u32 s37, s37, s38
buffer_load_dwordx4 v23, s[8:11], s37 offen sc1 lds
s_add_u32 m0, s39, 77824
s_add_u32 s37, s37, s55
buffer_load_dwordx4 v23, s[8:11], s37 offen sc1 lds
s_add_u32 m0, s39, 78848
s_add_u32 s37, s37, s38
buffer_load_dwordx4 v23, s[8:11], s37 offen sc1 lds
s_add_u32 m0, s39, 79872
s_add_u32 s37, s37, s38
buffer_load_dwordx4 v23, s[8:11], s37 offen sc1 lds
s_add_u32 m0, s39, 80896
s_add_u32 s37, s37, s38
buffer_load_dwordx4 v23, s[8:11], s37 offen sc1 lds
s_waitcnt vmcnt(32)
s_barrier
s_lshl_b32 s43, s35, 8
s_cmp_eq_u32 s51, 1
s_cselect_b32 s8, s4, s6
s_cselect_b32 s9, s5, s7
s_sub_u32 s10, 7340032, s43
s_lshl_b32 s44, s34, 18
s_add_u32 s44, s44, 4194304
s_movk_i32 s38, 28672
s_cmp_eq_u32 s51, 0
s_cselect_b32 s8, s32, s8
s_cselect_b32 s9, s33, s9
s_cselect_b32 s10, 262144, s10
s_cselect_b32 s43, s44, s43
s_cselect_b32 s38, 1024, s38
s_cselect_b32 s45, 0, -1
s_add_u32 s8, s8, s43
s_addc_u32 s9, s9, 0
s_mov_b32 s11, 0x20000
s_lshl_b32 s40, s38, 4
s_add_u32 s42, s35, 15
s_lshl_b32 s39, s51, 14
v_lshrrev_b32 v19, 4, v1
v_lshlrev_b32 v20, 5, v19
v_mul_u32_u24 v19, 6912, v19
v_and_b32 v19, s45, v19
v_and_b32 v20, s45, v20
v_lshlrev_b32 v21, 4, v1
v_xor_b32 v21, v21, v20
v_add_u32 v22, v21, v19
s_and_b32 s45, s45, 128
v_xor_b32 v23, s45, v22
s_waitcnt vmcnt(24)
s_barrier
s_add_u32 s42, s42, 1
s_and_b32 s42, s42, 15
s_add_u32 m0, s39, 98304
s_mul_i32 s37, s42, s40
buffer_load_dwordx4 v22, s[8:11], s37 offen sc1 lds
s_add_u32 m0, s39, 99328
s_add_u32 s37, s37, s38
buffer_load_dwordx4 v23, s[8:11], s37 offen sc1 lds
s_add_u32 m0, s39, 100352
s_add_u32 s37, s37, s38
buffer_load_dwordx4 v22, s[8:11], s37 offen sc1 lds
s_add_u32 m0, s39, 101376
s_add_u32 s37, s37, s38
buffer_load_dwordx4 v23, s[8:11], s37 offen sc1 lds
s_add_u32 m0, s39, 102400
s_add_u32 s37, s37, s38
buffer_load_dwordx4 v22, s[8:11], s37 offen sc1 lds
s_add_u32 m0, s39, 103424
s_add_u32 s37, s37, s38
buffer_load_dwordx4 v23, s[8:11], s37 offen sc1 lds
s_add_u32 m0, s39, 104448
s_add_u32 s37, s37, s38
buffer_load_dwordx4 v22, s[8:11], s37 offen sc1 lds
s_add_u32 m0, s39, 105472
s_add_u32 s37, s37, s38
buffer_load_dwordx4 v23, s[8:11], s37 offen sc1 lds
s_add_u32 m0, s39, 106496
s_add_u32 s37, s37, s38
buffer_load_dwordx4 v22, s[8:11], s37 offen sc1 lds
s_add_u32 m0, s39, 107520
s_add_u32 s37, s37, s38
buffer_load_dwordx4 v23, s[8:11], s37 offen sc1 lds
s_add_u32 m0, s39, 108544
s_add_u32 s37, s37, s38
buffer_load_dwordx4 v22, s[8:11], s37 offen sc1 lds
s_add_u32 m0, s39, 109568
s_add_u32 s37, s37, s38
buffer_load_dwordx4 v23, s[8:11], s37 offen sc1 lds
s_add_u32 m0, s39, 110592
s_add_u32 s37, s37, s38
buffer_load_dwordx4 v22, s[8:11], s37 offen sc1 lds
s_add_u32 m0, s39, 111616
s_add_u32 s37, s37, s38
buffer_load_dwordx4 v23, s[8:11], s37 offen sc1 lds
s_add_u32 m0, s39, 112640
s_add_u32 s37, s37, s38
buffer_load_dwordx4 v22, s[8:11], s37 offen sc1 lds
s_add_u32 m0, s39, 113664
s_add_u32 s37, s37, s38
buffer_load_dwordx4 v23, s[8:11], s37 offen sc1 lds
s_waitcnt vmcnt(32)
s_barrier
s_waitcnt vmcnt(24)
s_barrier
s_add_u32 s42, s42, 1
s_and_b32 s42, s42, 15
s_add_u32 m0, s39, 0
s_mul_i32 s37, s42, s40
buffer_load_dwordx4 v22, s[8:11], s37 offen sc1 lds
s_add_u32 m0, s39, 1024
s_add_u32 s37, s37, s38
buffer_load_dwordx4 v23, s[8:11], s37 offen sc1 lds
s_add_u32 m0, s39, 2048
s_add_u32 s37, s37, s38
buffer_load_dwordx4 v22, s[8:11], s37 offen sc1 lds
s_add_u32 m0, s39, 3072
s_add_u32 s37, s37, s38
buffer_load_dwordx4 v23, s[8:11], s37 offen sc1 lds
s_add_u32 m0, s39, 4096
s_add_u32 s37, s37, s38
buffer_load_dwordx4 v22, s[8:11], s37 offen sc1 lds
s_add_u32 m0, s39, 5120
s_add_u32 s37, s37, s38
buffer_load_dwordx4 v23, s[8:11], s37 offen sc1 lds
s_add_u32 m0, s39, 6144
s_add_u32 s37, s37, s38
buffer_load_dwordx4 v22, s[8:11], s37 offen sc1 lds
s_add_u32 m0, s39, 7168
s_add_u32 s37, s37, s38
buffer_load_dwordx4 v23, s[8:11], s37 offen sc1 lds
s_add_u32 m0, s39, 8192
s_add_u32 s37, s37, s38
buffer_load_dwordx4 v22, s[8:11], s37 offen sc1 lds
s_add_u32 m0, s39, 9216
s_add_u32 s37, s37, s38
buffer_load_dwordx4 v23, s[8:11], s37 offen sc1 lds
s_add_u32 m0, s39, 10240
s_add_u32 s37, s37, s38
buffer_load_dwordx4 v22, s[8:11], s37 offen sc1 lds
s_add_u32 m0, s39, 11264
s_add_u32 s37, s37, s38
buffer_load_dwordx4 v23, s[8:11], s37 offen sc1 lds
s_add_u32 m0, s39, 12288
s_add_u32 s37, s37, s38
buffer_load_dwordx4 v22, s[8:11], s37 offen sc1 lds
s_add_u32 m0, s39, 13312
s_add_u32 s37, s37, s38
buffer_load_dwordx4 v23, s[8:11], s37 offen sc1 lds
s_add_u32 m0, s39, 14336
s_add_u32 s37, s37, s38
buffer_load_dwordx4 v22, s[8:11], s37 offen sc1 lds
s_add_u32 m0, s39, 15360
s_add_u32 s37, s37, s38
buffer_load_dwordx4 v23, s[8:11], s37 offen sc1 lds
s_waitcnt vmcnt(32)
s_barrier
s_barrier
s_waitcnt vmcnt(16)
s_barrier
s_add_u32 s42, s42, 1
s_and_b32 s42, s42, 15
s_add_u32 m0, s39, 49152
s_mul_i32 s37, s42, s40
buffer_load_dwordx4 v22, s[8:11], s37 offen sc1 lds
s_add_u32 m0, s39, 50176
s_add_u32 s37, s37, s38
buffer_load_dwordx4 v23, s[8:11], s37 offen sc1 lds
s_add_u32 m0, s39, 51200
s_add_u32 s37, s37, s38
buffer_load_dwordx4 v22, s[8:11], s37 offen sc1 lds
s_add_u32 m0, s39, 52224
s_add_u32 s37, s37, s38
buffer_load_dwordx4 v23, s[8:11], s37 offen sc1 lds
s_add_u32 m0, s39, 53248
s_add_u32 s37, s37, s38
buffer_load_dwordx4 v22, s[8:11], s37 offen sc1 lds
s_add_u32 m0, s39, 54272
s_add_u32 s37, s37, s38
buffer_load_dwordx4 v23, s[8:11], s37 offen sc1 lds
s_add_u32 m0, s39, 55296
s_add_u32 s37, s37, s38
buffer_load_dwordx4 v22, s[8:11], s37 offen sc1 lds
s_add_u32 m0, s39, 56320
s_add_u32 s37, s37, s38
buffer_load_dwordx4 v23, s[8:11], s37 offen sc1 lds
s_add_u32 m0, s39, 57344
s_add_u32 s37, s37, s38
buffer_load_dwordx4 v22, s[8:11], s37 offen sc1 lds
s_add_u32 m0, s39, 58368
s_add_u32 s37, s37, s38
buffer_load_dwordx4 v23, s[8:11], s37 offen sc1 lds
s_add_u32 m0, s39, 59392
s_add_u32 s37, s37, s38
buffer_load_dwordx4 v22, s[8:11], s37 offen sc1 lds
s_add_u32 m0, s39, 60416
s_add_u32 s37, s37, s38
buffer_load_dwordx4 v23, s[8:11], s37 offen sc1 lds
s_add_u32 m0, s39, 61440
s_add_u32 s37, s37, s38
buffer_load_dwordx4 v22, s[8:11], s37 offen sc1 lds
s_add_u32 m0, s39, 62464
s_add_u32 s37, s37, s38
buffer_load_dwordx4 v23, s[8:11], s37 offen sc1 lds
s_add_u32 m0, s39, 63488
s_add_u32 s37, s37, s38
buffer_load_dwordx4 v22, s[8:11], s37 offen sc1 lds
s_add_u32 m0, s39, 64512
s_add_u32 s37, s37, s38
buffer_load_dwordx4 v23, s[8:11], s37 offen sc1 lds
LP3_36:
s_mul_i32 s43, s2, 28672
s_mul_i32 s44, s51, 7168
s_add_u32 s43, s43, s44
s_add_u32 s80, s60, s43
s_addc_u32 s81, s61, 0
s_lshl_b32 s43, s34, 18
s_add_u32 s12, s32, s43
s_addc_u32 s13, s33, 0
s_add_u32 s12, s12, 4194304
s_addc_u32 s13, s13, 0
s_mov_b32 s14, 262144
s_mov_b32 s15, 0x20000
v_lshlrev_b32 v21, 4, v1
s_lshl_b32 s54, s36, 11
s_add_u32 s43, s35, 1
s_and_b32 s43, s43, 15
s_lshl_b32 s43, s43, 14
s_add_u32 s30, s43, s54
s_add_u32 s43, s35, 2
s_and_b32 s43, s43, 15
s_lshl_b32 s43, s43, 14
s_add_u32 s31, s43, s54
s_barrier
s_add_u32 m0, s54, 0
s_add_u32 s43, s30, 0
buffer_load_dwordx4 v21, s[12:15], s43 offen sc1 lds
s_add_u32 m0, s54, 1024
s_add_u32 s43, s30, 1024
buffer_load_dwordx4 v21, s[12:15], s43 offen sc1 lds
s_add_u32 m0, s54, 49152
s_add_u32 s43, s31, 0
buffer_load_dwordx4 v21, s[12:15], s43 offen sc1 lds
s_add_u32 m0, s54, 50176
s_add_u32 s43, s31, 1024
buffer_load_dwordx4 v21, s[12:15], s43 offen sc1 lds
s_add_u32 s42, s42, 1
s_and_b32 s42, s42, 15
s_add_u32 m0, s39, 98304
s_mul_i32 s37, s42, s40
buffer_load_dwordx4 v22, s[8:11], s37 offen sc1 lds
s_add_u32 m0, s39, 99328
s_add_u32 s37, s37, s38
buffer_load_dwordx4 v23, s[8:11], s37 offen sc1 lds
s_add_u32 m0, s39, 100352
s_add_u32 s37, s37, s38
buffer_load_dwordx4 v22, s[8:11], s37 offen sc1 lds
s_add_u32 m0, s39, 101376
s_add_u32 s37, s37, s38
buffer_load_dwordx4 v23, s[8:11], s37 offen sc1 lds
s_add_u32 m0, s39, 102400
s_add_u32 s37, s37, s38
buffer_load_dwordx4 v22, s[8:11], s37 offen sc1 lds
s_add_u32 m0, s39, 103424
s_add_u32 s37, s37, s38
buffer_load_dwordx4 v23, s[8:11], s37 offen sc1 lds
s_add_u32 m0, s39, 104448
s_add_u32 s37, s37, s38
buffer_load_dwordx4 v22, s[8:11], s37 offen sc1 lds
s_add_u32 m0, s39, 105472
s_add_u32 s37, s37, s38
buffer_load_dwordx4 v23, s[8:11], s37 offen sc1 lds
s_add_u32 m0, s39, 106496
s_add_u32 s37, s37, s38
buffer_load_dwordx4 v22, s[8:11], s37 offen sc1 lds
s_add_u32 m0, s39, 107520
s_add_u32 s37, s37, s38
buffer_load_dwordx4 v23, s[8:11], s37 offen sc1 lds
s_add_u32 m0, s39, 108544
s_add_u32 s37, s37, s38
buffer_load_dwordx4 v22, s[8:11], s37 offen sc1 lds
s_add_u32 m0, s39, 109568
s_add_u32 s37, s37, s38
buffer_load_dwordx4 v23, s[8:11], s37 offen sc1 lds
s_add_u32 m0, s39, 110592
s_add_u32 s37, s37, s38
buffer_load_dwordx4 v22, s[8:11], s37 offen sc1 lds
s_add_u32 m0, s39, 111616
s_add_u32 s37, s37, s38
buffer_load_dwordx4 v23, s[8:11], s37 offen sc1 lds
s_add_u32 m0, s39, 112640
s_add_u32 s37, s37, s38
buffer_load_dwordx4 v22, s[8:11], s37 offen sc1 lds
s_add_u32 m0, s39, 113664
s_add_u32 s37, s37, s38
buffer_load_dwordx4 v23, s[8:11], s37 offen sc1 lds
s_load_dword s64, s[80:81], 0
s_load_dword s65, s[80:81], 64
s_load_dword s66, s[80:81], 128
s_load_dword s67, s[80:81], 192
s_load_dword s68, s[80:81], 256
s_load_dword s69, s[80:81], 320
s_load_dword s70, s[80:81], 384
s_load_dword s71, s[80:81], 448
s_load_dword s72, s[80:81], 512
s_add_u32 s80, s80, 576
s_addc_u32 s81, s81, 0
s_waitcnt vmcnt(18)
s_barrier
s_waitcnt vmcnt(16)
s_barrier
s_mov_b32 s41, 2
Lp3_46:
s_add_u32 s42, s42, 1
s_and_b32 s42, s42, 15
s_add_u32 m0, s39, 0
s_mul_i32 s37, s42, s40
buffer_load_dwordx4 v22, s[8:11], s37 offen sc1 lds
s_add_u32 m0, s39, 1024
s_add_u32 s37, s37, s38
buffer_load_dwordx4 v23, s[8:11], s37 offen sc1 lds
s_add_u32 m0, s39, 2048
s_add_u32 s37, s37, s38
buffer_load_dwordx4 v22, s[8:11], s37 offen sc1 lds
s_add_u32 m0, s39, 3072
s_add_u32 s37, s37, s38
buffer_load_dwordx4 v23, s[8:11], s37 offen sc1 lds
s_add_u32 m0, s39, 4096
s_add_u32 s37, s37, s38
buffer_load_dwordx4 v22, s[8:11], s37 offen sc1 lds
s_add_u32 m0, s39, 5120
s_add_u32 s37, s37, s38
buffer_load_dwordx4 v23, s[8:11], s37 offen sc1 lds
s_add_u32 m0, s39, 6144
s_add_u32 s37, s37, s38
buffer_load_dwordx4 v22, s[8:11], s37 offen sc1 lds
s_add_u32 m0, s39, 7168
s_add_u32 s37, s37, s38
buffer_load_dwordx4 v23, s[8:11], s37 offen sc1 lds
s_add_u32 m0, s39, 8192
s_add_u32 s37, s37, s38
buffer_load_dwordx4 v22, s[8:11], s37 offen sc1 lds
s_add_u32 m0, s39, 9216
s_add_u32 s37, s37, s38
buffer_load_dwordx4 v23, s[8:11], s37 offen sc1 lds
s_add_u32 m0, s39, 10240
s_add_u32 s37, s37, s38
buffer_load_dwordx4 v22, s[8:11], s37 offen sc1 lds
s_add_u32 m0, s39, 11264
s_add_u32 s37, s37, s38
buffer_load_dwordx4 v23, s[8:11], s37 offen sc1 lds
s_add_u32 m0, s39, 12288
s_add_u32 s37, s37, s38
buffer_load_dwordx4 v22, s[8:11], s37 offen sc1 lds
s_add_u32 m0, s39, 13312
s_add_u32 s37, s37, s38
buffer_load_dwordx4 v23, s[8:11], s37 offen sc1 lds
s_add_u32 m0, s39, 14336
s_add_u32 s37, s37, s38
buffer_load_dwordx4 v22, s[8:11], s37 offen sc1 lds
s_add_u32 m0, s39, 15360
s_add_u32 s37, s37, s38
buffer_load_dwordx4 v23, s[8:11], s37 offen sc1 lds
s_load_dword s64, s[80:81], 0
s_load_dword s65, s[80:81], 64
s_load_dword s66, s[80:81], 128
s_load_dword s67, s[80:81], 192
s_load_dword s68, s[80:81], 256
s_load_dword s69, s[80:81], 320
s_load_dword s70, s[80:81], 384
s_load_dword s71, s[80:81], 448
s_load_dword s72, s[80:81], 512
s_add_u32 s80, s80, 576
s_addc_u32 s81, s81, 0
s_waitcnt vmcnt(16)
s_barrier
s_add_u32 s42, s42, 1
s_and_b32 s42, s42, 15
s_add_u32 m0, s39, 49152
s_mul_i32 s37, s42, s40
buffer_load_dwordx4 v22, s[8:11], s37 offen sc1 lds
s_add_u32 m0, s39, 50176
s_add_u32 s37, s37, s38
buffer_load_dwordx4 v23, s[8:11], s37 offen sc1 lds
s_add_u32 m0, s39, 51200
s_add_u32 s37, s37, s38
buffer_load_dwordx4 v22, s[8:11], s37 offen sc1 lds
s_add_u32 m0, s39, 52224
s_add_u32 s37, s37, s38
buffer_load_dwordx4 v23, s[8:11], s37 offen sc1 lds
s_add_u32 m0, s39, 53248
s_add_u32 s37, s37, s38
buffer_load_dwordx4 v22, s[8:11], s37 offen sc1 lds
s_add_u32 m0, s39, 54272
s_add_u32 s37, s37, s38
buffer_load_dwordx4 v23, s[8:11], s37 offen sc1 lds
s_add_u32 m0, s39, 55296
s_add_u32 s37, s37, s38
buffer_load_dwordx4 v22, s[8:11], s37 offen sc1 lds
s_add_u32 m0, s39, 56320
s_add_u32 s37, s37, s38
buffer_load_dwordx4 v23, s[8:11], s37 offen sc1 lds
s_add_u32 m0, s39, 57344
s_add_u32 s37, s37, s38
buffer_load_dwordx4 v22, s[8:11], s37 offen sc1 lds
s_add_u32 m0, s39, 58368
s_add_u32 s37, s37, s38
buffer_load_dwordx4 v23, s[8:11], s37 offen sc1 lds
s_add_u32 m0, s39, 59392
s_add_u32 s37, s37, s38
buffer_load_dwordx4 v22, s[8:11], s37 offen sc1 lds
s_add_u32 m0, s39, 60416
s_add_u32 s37, s37, s38
buffer_load_dwordx4 v23, s[8:11], s37 offen sc1 lds
s_add_u32 m0, s39, 61440
s_add_u32 s37, s37, s38
buffer_load_dwordx4 v22, s[8:11], s37 offen sc1 lds
s_add_u32 m0, s39, 62464
s_add_u32 s37, s37, s38
buffer_load_dwordx4 v23, s[8:11], s37 offen sc1 lds
s_add_u32 m0, s39, 63488
s_add_u32 s37, s37, s38
buffer_load_dwordx4 v22, s[8:11], s37 offen sc1 lds
s_add_u32 m0, s39, 64512
s_add_u32 s37, s37, s38
buffer_load_dwordx4 v23, s[8:11], s37 offen sc1 lds
s_load_dword s64, s[80:81], 0
s_load_dword s65, s[80:81], 64
s_load_dword s66, s[80:81], 128
s_load_dword s67, s[80:81], 192
s_load_dword s68, s[80:81], 256
s_load_dword s69, s[80:81], 320
s_load_dword s70, s[80:81], 384
s_load_dword s71, s[80:81], 448
s_load_dword s72, s[80:81], 512
s_add_u32 s80, s80, 576
s_addc_u32 s81, s81, 0
s_waitcnt vmcnt(16)
s_barrier
s_add_u32 s42, s42, 1
s_and_b32 s42, s42, 15
s_add_u32 m0, s39, 98304
s_mul_i32 s37, s42, s40
buffer_load_dwordx4 v22, s[8:11], s37 offen sc1 lds
s_add_u32 m0, s39, 99328
s_add_u32 s37, s37, s38
buffer_load_dwordx4 v23, s[8:11], s37 offen sc1 lds
s_add_u32 m0, s39, 100352
s_add_u32 s37, s37, s38
buffer_load_dwordx4 v22, s[8:11], s37 offen sc1 lds
s_add_u32 m0, s39, 101376
s_add_u32 s37, s37, s38
buffer_load_dwordx4 v23, s[8:11], s37 offen sc1 lds
s_add_u32 m0, s39, 102400
s_add_u32 s37, s37, s38
buffer_load_dwordx4 v22, s[8:11], s37 offen sc1 lds
s_add_u32 m0, s39, 103424
s_add_u32 s37, s37, s38
buffer_load_dwordx4 v23, s[8:11], s37 offen sc1 lds
s_add_u32 m0, s39, 104448
s_add_u32 s37, s37, s38
buffer_load_dwordx4 v22, s[8:11], s37 offen sc1 lds
s_add_u32 m0, s39, 105472
s_add_u32 s37, s37, s38
buffer_load_dwordx4 v23, s[8:11], s37 offen sc1 lds
s_add_u32 m0, s39, 106496
s_add_u32 s37, s37, s38
buffer_load_dwordx4 v22, s[8:11], s37 offen sc1 lds
s_add_u32 m0, s39, 107520
s_add_u32 s37, s37, s38
buffer_load_dwordx4 v23, s[8:11], s37 offen sc1 lds
s_add_u32 m0, s39, 108544
s_add_u32 s37, s37, s38
buffer_load_dwordx4 v22, s[8:11], s37 offen sc1 lds
s_add_u32 m0, s39, 109568
s_add_u32 s37, s37, s38
buffer_load_dwordx4 v23, s[8:11], s37 offen sc1 lds
s_add_u32 m0, s39, 110592
s_add_u32 s37, s37, s38
buffer_load_dwordx4 v22, s[8:11], s37 offen sc1 lds
s_add_u32 m0, s39, 111616
s_add_u32 s37, s37, s38
buffer_load_dwordx4 v23, s[8:11], s37 offen sc1 lds
s_add_u32 m0, s39, 112640
s_add_u32 s37, s37, s38
buffer_load_dwordx4 v22, s[8:11], s37 offen sc1 lds
s_add_u32 m0, s39, 113664
s_add_u32 s37, s37, s38
buffer_load_dwordx4 v23, s[8:11], s37 offen sc1 lds
s_load_dword s64, s[80:81], 0
s_load_dword s65, s[80:81], 64
s_load_dword s66, s[80:81], 128
s_load_dword s67, s[80:81], 192
s_load_dword s68, s[80:81], 256
s_load_dword s69, s[80:81], 320
s_load_dword s70, s[80:81], 384
s_load_dword s71, s[80:81], 448
s_load_dword s72, s[80:81], 512
s_add_u32 s80, s80, 576
s_addc_u32 s81, s81, 0
s_waitcnt vmcnt(16)
s_barrier
s_sub_u32 s41, s41, 1
s_cmp_lg_u32 s41, 0
s_cbranch_scc1 Lp3_46
s_add_u32 s42, s42, 1
s_and_b32 s42, s42, 15
s_add_u32 m0, s39, 0
s_mul_i32 s37, s42, s40
buffer_load_dwordx4 v22, s[8:11], s37 offen sc1 lds
s_add_u32 m0, s39, 1024
s_add_u32 s37, s37, s38
buffer_load_dwordx4 v23, s[8:11], s37 offen sc1 lds
s_add_u32 m0, s39, 2048
s_add_u32 s37, s37, s38
buffer_load_dwordx4 v22, s[8:11], s37 offen sc1 lds
s_add_u32 m0, s39, 3072
s_add_u32 s37, s37, s38
buffer_load_dwordx4 v23, s[8:11], s37 offen sc1 lds
s_add_u32 m0, s39, 4096
s_add_u32 s37, s37, s38
buffer_load_dwordx4 v22, s[8:11], s37 offen sc1 lds
s_add_u32 m0, s39, 5120
s_add_u32 s37, s37, s38
buffer_load_dwordx4 v23, s[8:11], s37 offen sc1 lds
s_add_u32 m0, s39, 6144
s_add_u32 s37, s37, s38
buffer_load_dwordx4 v22, s[8:11], s37 offen sc1 lds
s_add_u32 m0, s39, 7168
s_add_u32 s37, s37, s38
buffer_load_dwordx4 v23, s[8:11], s37 offen sc1 lds
s_add_u32 m0, s39, 8192
s_add_u32 s37, s37, s38
buffer_load_dwordx4 v22, s[8:11], s37 offen sc1 lds
s_add_u32 m0, s39, 9216
s_add_u32 s37, s37, s38
buffer_load_dwordx4 v23, s[8:11], s37 offen sc1 lds
s_add_u32 m0, s39, 10240
s_add_u32 s37, s37, s38
buffer_load_dwordx4 v22, s[8:11], s37 offen sc1 lds
s_add_u32 m0, s39, 11264
s_add_u32 s37, s37, s38
buffer_load_dwordx4 v23, s[8:11], s37 offen sc1 lds
s_add_u32 m0, s39, 12288
s_add_u32 s37, s37, s38
buffer_load_dwordx4 v22, s[8:11], s37 offen sc1 lds
s_add_u32 m0, s39, 13312
s_add_u32 s37, s37, s38
buffer_load_dwordx4 v23, s[8:11], s37 offen sc1 lds
s_add_u32 m0, s39, 14336
s_add_u32 s37, s37, s38
buffer_load_dwordx4 v22, s[8:11], s37 offen sc1 lds
s_add_u32 m0, s39, 15360
s_add_u32 s37, s37, s38
buffer_load_dwordx4 v23, s[8:11], s37 offen sc1 lds
s_load_dword s64, s[80:81], 0
s_load_dword s65, s[80:81], 64
s_load_dword s66, s[80:81], 128
s_load_dword s67, s[80:81], 192
s_load_dword s68, s[80:81], 256
s_load_dword s69, s[80:81], 320
s_load_dword s70, s[80:81], 384
s_load_dword s71, s[80:81], 448
s_load_dword s72, s[80:81], 512
s_add_u32 s80, s80, 576
s_addc_u32 s81, s81, 0
s_waitcnt vmcnt(16)
s_barrier
s_add_u32 s42, s42, 1
s_and_b32 s42, s42, 15
s_add_u32 m0, s39, 49152
s_mul_i32 s37, s42, s40
buffer_load_dwordx4 v22, s[8:11], s37 offen sc1 lds
s_add_u32 m0, s39, 50176
s_add_u32 s37, s37, s38
buffer_load_dwordx4 v23, s[8:11], s37 offen sc1 lds
s_add_u32 m0, s39, 51200
s_add_u32 s37, s37, s38
buffer_load_dwordx4 v22, s[8:11], s37 offen sc1 lds
s_add_u32 m0, s39, 52224
s_add_u32 s37, s37, s38
buffer_load_dwordx4 v23, s[8:11], s37 offen sc1 lds
s_add_u32 m0, s39, 53248
s_add_u32 s37, s37, s38
buffer_load_dwordx4 v22, s[8:11], s37 offen sc1 lds
s_add_u32 m0, s39, 54272
s_add_u32 s37, s37, s38
buffer_load_dwordx4 v23, s[8:11], s37 offen sc1 lds
s_add_u32 m0, s39, 55296
s_add_u32 s37, s37, s38
buffer_load_dwordx4 v22, s[8:11], s37 offen sc1 lds
s_add_u32 m0, s39, 56320
s_add_u32 s37, s37, s38
buffer_load_dwordx4 v23, s[8:11], s37 offen sc1 lds
s_add_u32 m0, s39, 57344
s_add_u32 s37, s37, s38
buffer_load_dwordx4 v22, s[8:11], s37 offen sc1 lds
s_add_u32 m0, s39, 58368
s_add_u32 s37, s37, s38
buffer_load_dwordx4 v23, s[8:11], s37 offen sc1 lds
s_add_u32 m0, s39, 59392
s_add_u32 s37, s37, s38
buffer_load_dwordx4 v22, s[8:11], s37 offen sc1 lds
s_add_u32 m0, s39, 60416
s_add_u32 s37, s37, s38
buffer_load_dwordx4 v23, s[8:11], s37 offen sc1 lds
s_add_u32 m0, s39, 61440
s_add_u32 s37, s37, s38
buffer_load_dwordx4 v22, s[8:11], s37 offen sc1 lds
s_add_u32 m0, s39, 62464
s_add_u32 s37, s37, s38
buffer_load_dwordx4 v23, s[8:11], s37 offen sc1 lds
s_add_u32 m0, s39, 63488
s_add_u32 s37, s37, s38
buffer_load_dwordx4 v22, s[8:11], s37 offen sc1 lds
s_add_u32 m0, s39, 64512
s_add_u32 s37, s37, s38
buffer_load_dwordx4 v23, s[8:11], s37 offen sc1 lds
s_load_dword s64, s[80:81], 0
s_load_dword s65, s[80:81], 64
s_load_dword s66, s[80:81], 128
s_load_dword s67, s[80:81], 192
s_load_dword s68, s[80:81], 256
s_load_dword s69, s[80:81], 320
s_load_dword s70, s[80:81], 384
s_load_dword s71, s[80:81], 448
s_load_dword s72, s[80:81], 512
s_add_u32 s80, s80, 576
s_addc_u32 s81, s81, 0
s_waitcnt vmcnt(16)
s_barrier
s_add_u32 s42, s42, 1
s_and_b32 s42, s42, 15
s_add_u32 m0, s39, 98304
s_mul_i32 s37, s42, s40
buffer_load_dwordx4 v22, s[8:11], s37 offen sc1 lds
s_and_b32 s53, s35, 1
s_lshl_b32 s53, s53, 1
s_mul_i32 s43, s47, 3
s_add_u32 m0, s39, 99328
s_add_u32 s37, s37, s38
buffer_load_dwordx4 v23, s[8:11], s37 offen sc1 lds
s_add_u32 s53, s53, s43
v_lshlrev_b32 v19, 11, v18
v_lshl_add_u32 v19, v17, 4, v19
s_add_u32 m0, s39, 100352
s_add_u32 s37, s37, s38
buffer_load_dwordx4 v22, s[8:11], s37 offen sc1 lds
s_lshl_b32 s43, s46, 10
v_add_u32 v2, s43, v19
v_add_u32 v3, 49152, v2
s_add_u32 m0, s39, 101376
s_add_u32 s37, s37, s38
buffer_load_dwordx4 v23, s[8:11], s37 offen sc1 lds
v_add_u32 v4, 98304, v2
v_lshrrev_b32 v19, 2, v17
v_lshl_add_u32 v20, v18, 2, v19
s_add_u32 m0, s39, 102400
s_add_u32 s37, s37, s38
buffer_load_dwordx4 v22, s[8:11], s37 offen sc1 lds
v_and_b32 v21, 7, v20
v_lshlrev_b32 v20, 8, v20
v_and_b32 v19, 3, v1
s_add_u32 m0, s39, 103424
s_add_u32 s37, s37, s38
buffer_load_dwordx4 v23, s[8:11], s37 offen sc1 lds
v_lshl_add_u32 v20, v19, 3, v20
s_add_u32 s43, s53, 0
v_xor_b32 v19, s43, v21
s_add_u32 m0, s39, 104448
s_add_u32 s37, s37, s38
buffer_load_dwordx4 v22, s[8:11], s37 offen sc1 lds
v_lshl_add_u32 v5, v19, 5, v20
s_add_u32 s43, s53, 1
v_xor_b32 v19, s43, v21
s_add_u32 m0, s39, 105472
s_add_u32 s37, s37, s38
buffer_load_dwordx4 v23, s[8:11], s37 offen sc1 lds
v_lshl_add_u32 v6, v19, 5, v20
s_add_u32 s43, s53, 2
v_xor_b32 v19, s43, v21
s_add_u32 m0, s39, 106496
s_add_u32 s37, s37, s38
buffer_load_dwordx4 v22, s[8:11], s37 offen sc1 lds
v_lshl_add_u32 v7, v19, 5, v20
v_add_u32 v9, 49152, v5
v_add_u32 v10, 49152, v6
s_add_u32 m0, s39, 107520
s_add_u32 s37, s37, s38
buffer_load_dwordx4 v23, s[8:11], s37 offen sc1 lds
v_add_u32 v11, 49152, v7
v_add_u32 v13, 98304, v5
v_add_u32 v14, 98304, v6
s_add_u32 m0, s39, 108544
s_add_u32 s37, s37, s38
buffer_load_dwordx4 v22, s[8:11], s37 offen sc1 lds
v_add_u32 v15, 98304, v7
s_lshl_b32 s43, s46, 9
s_add_u32 s43, s43, 147456
s_add_u32 m0, s39, 109568
s_add_u32 s37, s37, s38
buffer_load_dwordx4 v23, s[8:11], s37 offen sc1 lds
v_lshl_add_u32 v19, v17, 3, s43
ds_read_b64 v[80:81], v19 offset:0
ds_read_b64 v[82:83], v19 offset:128
s_add_u32 m0, s39, 110592
s_add_u32 s37, s37, s38
buffer_load_dwordx4 v22, s[8:11], s37 offen sc1 lds
ds_read_b64 v[84:85], v19 offset:256
ds_read_b64 v[86:87], v19 offset:384
s_mul_i32 s43, s47, 192
s_add_u32 m0, s39, 111616
s_add_u32 s37, s37, s38
buffer_load_dwordx4 v23, s[8:11], s37 offen sc1 lds
s_add_u32 s43, s43, 148992
v_lshl_add_u32 v19, v18, 4, s43
ds_read_b128 v[48:51], v19 offset:0
s_add_u32 m0, s39, 112640
s_add_u32 s37, s37, s38
buffer_load_dwordx4 v22, s[8:11], s37 offen sc1 lds
ds_read_b128 v[52:55], v19 offset:64
ds_read_b128 v[56:59], v19 offset:128
ds_read_b128 v[60:63], v19 offset:896
s_add_u32 m0, s39, 113664
s_add_u32 s37, s37, s38
buffer_load_dwordx4 v23, s[8:11], s37 offen sc1 lds
ds_read_b128 v[64:67], v19 offset:960
ds_read_b128 v[68:71], v19 offset:1024
s_waitcnt vmcnt(16)
s_barrier
s_add_u32 s42, s42, 1
s_and_b32 s42, s42, 15
s_add_u32 m0, s39, 0
s_mul_i32 s37, s42, s40
buffer_load_dwordx4 v22, s[8:11], s37 offen sc1 lds
s_waitcnt lgkmcnt(0)
v_mul_f32 v88, v81, v81
s_add_u32 m0, s39, 1024
s_add_u32 s37, s37, s38
buffer_load_dwordx4 v23, s[8:11], s37 offen sc1 lds
v_mul_f32 v228, 0xc0135761, v81
s_add_u32 m0, s39, 2048
s_add_u32 s37, s37, s38
buffer_load_dwordx4 v22, s[8:11], s37 offen sc1 lds
v_mul_f32 v89, 0xbdd2d3e8, v81
s_add_u32 m0, s39, 3072
s_add_u32 s37, s37, s38
buffer_load_dwordx4 v23, s[8:11], s37 offen sc1 lds
v_rcp_f32 v236, v88
v_mul_f32 v232, v89, v88
s_add_u32 m0, s39, 4096
s_add_u32 s37, s37, s38
buffer_load_dwordx4 v22, s[8:11], s37 offen sc1 lds
v_mul_f32 v88, v83, v83
s_add_u32 m0, s39, 5120
s_add_u32 s37, s37, s38
buffer_load_dwordx4 v23, s[8:11], s37 offen sc1 lds
v_mul_f32 v229, 0xc0135761, v83
s_add_u32 m0, s39, 6144
s_add_u32 s37, s37, s38
buffer_load_dwordx4 v22, s[8:11], s37 offen sc1 lds
v_mul_f32 v89, 0xbdd2d3e8, v83
v_rcp_f32 v237, v88
s_add_u32 m0, s39, 7168
s_add_u32 s37, s37, s38
buffer_load_dwordx4 v23, s[8:11], s37 offen sc1 lds
v_mul_f32 v233, v89, v88
s_add_u32 m0, s39, 8192
s_add_u32 s37, s37, s38
buffer_load_dwordx4 v22, s[8:11], s37 offen sc1 lds
v_mul_f32 v88, v85, v85
s_add_u32 m0, s39, 9216
s_add_u32 s37, s37, s38
buffer_load_dwordx4 v23, s[8:11], s37 offen sc1 lds
v_mul_f32 v230, 0xc0135761, v85
v_mul_f32 v89, 0xbdd2d3e8, v85
s_add_u32 m0, s39, 10240
s_add_u32 s37, s37, s38
buffer_load_dwordx4 v22, s[8:11], s37 offen sc1 lds
v_rcp_f32 v238, v88
s_add_u32 m0, s39, 11264
s_add_u32 s37, s37, s38
buffer_load_dwordx4 v23, s[8:11], s37 offen sc1 lds
v_mul_f32 v234, v89, v88
s_add_u32 m0, s39, 12288
s_add_u32 s37, s37, s38
buffer_load_dwordx4 v22, s[8:11], s37 offen sc1 lds
v_mul_f32 v88, v87, v87
v_mul_f32 v231, 0xc0135761, v87
s_add_u32 m0, s39, 13312
s_add_u32 s37, s37, s38
buffer_load_dwordx4 v23, s[8:11], s37 offen sc1 lds
v_mul_f32 v89, 0xbdd2d3e8, v87
s_add_u32 m0, s39, 14336
s_add_u32 s37, s37, s38
buffer_load_dwordx4 v22, s[8:11], s37 offen sc1 lds
v_rcp_f32 v239, v88
s_add_u32 m0, s39, 15360
s_add_u32 s37, s37, s38
buffer_load_dwordx4 v23, s[8:11], s37 offen sc1 lds
v_mul_f32 v235, v89, v88
s_mul_i32 s43, s34, 917504
s_mul_i32 s44, s35, 24576
s_add_u32 s43, s43, s44
s_add_u32 s43, s43, 8912896
s_add_u32 s24, s32, s43
s_addc_u32 s25, s33, 0
s_mov_b32 s26, 24576
s_mov_b32 s27, 0x20000
s_mov_b32 s53, 262144
s_lshl_b32 s43, s47, 13
s_lshl_b32 s44, s46, 10
s_add_u32 s43, s43, s44
v_lshlrev_b32 v19, 11, v18
v_lshl_add_u32 v19, v17, 4, v19
v_add_u32 v27, s43, v19
s_lshl_b32 s43, s47, 12
s_add_u32 s43, s43, s44
s_add_u32 s43, s43, 16384
v_and_b32 v19, 1, v18
v_lshlrev_b32 v19, 11, v19
v_lshrrev_b32 v20, 1, v18
v_lshl_add_u32 v19, v20, 8, v19
v_lshl_add_u32 v19, v17, 4, v19
v_add_u32 v28, s43, v19
s_load_dword s64, s[80:81], 0
s_load_dword s65, s[80:81], 64
s_load_dword s66, s[80:81], 128
s_load_dword s67, s[80:81], 192
s_load_dword s68, s[80:81], 256
s_load_dword s69, s[80:81], 320
s_load_dword s70, s[80:81], 384
s_load_dword s71, s[80:81], 448
s_add_u32 s80, s80, 512
s_addc_u32 s81, s81, 0
s_waitcnt vmcnt(16)
s_barrier
s_add_u32 s42, s42, 1
s_and_b32 s42, s42, 15
s_add_u32 m0, s39, 49152
s_mul_i32 s37, s42, s40
buffer_load_dwordx4 v22, s[8:11], s37 offen sc1 lds
v_mul_f32 v128, -v80, v48
v_mul_f32 v129, -v80, v49
s_add_u32 m0, s39, 50176
s_add_u32 s37, s37, s38
buffer_load_dwordx4 v23, s[8:11], s37 offen sc1 lds
v_mul_f32 v130, -v80, v50
v_mul_f32 v131, -v80, v51
s_add_u32 m0, s39, 51200
s_add_u32 s37, s37, s38
buffer_load_dwordx4 v22, s[8:11], s37 offen sc1 lds
v_mul_f32 v132, -v82, v48
v_mul_f32 v133, -v82, v49
s_add_u32 m0, s39, 52224
s_add_u32 s37, s37, s38
buffer_load_dwordx4 v23, s[8:11], s37 offen sc1 lds
v_mul_f32 v134, -v82, v50
v_mul_f32 v135, -v82, v51
s_add_u32 m0, s39, 53248
s_add_u32 s37, s37, s38
buffer_load_dwordx4 v22, s[8:11], s37 offen sc1 lds
v_mul_f32 v136, -v84, v48
v_mul_f32 v137, -v84, v49
s_add_u32 m0, s39, 54272
s_add_u32 s37, s37, s38
buffer_load_dwordx4 v23, s[8:11], s37 offen sc1 lds
v_mul_f32 v138, -v84, v50
v_mul_f32 v139, -v84, v51
s_add_u32 m0, s39, 55296
s_add_u32 s37, s37, s38
buffer_load_dwordx4 v22, s[8:11], s37 offen sc1 lds
v_mul_f32 v140, -v86, v48
v_mul_f32 v141, -v86, v49
s_add_u32 m0, s39, 56320
s_add_u32 s37, s37, s38
buffer_load_dwordx4 v23, s[8:11], s37 offen sc1 lds
v_mul_f32 v142, -v86, v50
v_mul_f32 v143, -v86, v51
s_add_u32 m0, s39, 57344
s_add_u32 s37, s37, s38
buffer_load_dwordx4 v22, s[8:11], s37 offen sc1 lds
v_mul_f32 v144, -v80, v52
v_mul_f32 v145, -v80, v53
s_add_u32 m0, s39, 58368
s_add_u32 s37, s37, s38
buffer_load_dwordx4 v23, s[8:11], s37 offen sc1 lds
v_mul_f32 v146, -v80, v54
v_mul_f32 v147, -v80, v55
s_add_u32 m0, s39, 59392
s_add_u32 s37, s37, s38
buffer_load_dwordx4 v22, s[8:11], s37 offen sc1 lds
v_mul_f32 v148, -v82, v52
v_mul_f32 v149, -v82, v53
s_add_u32 m0, s39, 60416
s_add_u32 s37, s37, s38
buffer_load_dwordx4 v23, s[8:11], s37 offen sc1 lds
v_mul_f32 v150, -v82, v54
v_mul_f32 v151, -v82, v55
s_add_u32 m0, s39, 61440
s_add_u32 s37, s37, s38
buffer_load_dwordx4 v22, s[8:11], s37 offen sc1 lds
v_mul_f32 v152, -v84, v52
v_mul_f32 v153, -v84, v53
s_add_u32 m0, s39, 62464
s_add_u32 s37, s37, s38
buffer_load_dwordx4 v23, s[8:11], s37 offen sc1 lds
v_mul_f32 v154, -v84, v54
v_mul_f32 v155, -v84, v55
s_add_u32 m0, s39, 63488
s_add_u32 s37, s37, s38
buffer_load_dwordx4 v22, s[8:11], s37 offen sc1 lds
v_mul_f32 v156, -v86, v52
v_mul_f32 v157, -v86, v53
s_add_u32 m0, s39, 64512
s_add_u32 s37, s37, s38
buffer_load_dwordx4 v23, s[8:11], s37 offen sc1 lds
v_mul_f32 v158, -v86, v54
v_mul_f32 v159, -v86, v55
s_load_dword s64, s[80:81], 0
s_load_dword s65, s[80:81], 64
s_load_dword s66, s[80:81], 128
s_load_dword s67, s[80:81], 192
s_load_dword s68, s[80:81], 256
s_load_dword s69, s[80:81], 320
s_load_dword s70, s[80:81], 384
s_load_dword s71, s[80:81], 448
s_add_u32 s80, s80, 512
s_addc_u32 s81, s81, 0
s_waitcnt vmcnt(16)
s_barrier
s_add_u32 s42, s42, 1
s_and_b32 s42, s42, 15
s_add_u32 m0, s39, 98304
s_mul_i32 s37, s42, s40
buffer_load_dwordx4 v22, s[8:11], s37 offen sc1 lds
v_mul_f32 v160, -v80, v56
v_mul_f32 v161, -v80, v57
s_add_u32 m0, s39, 99328
s_add_u32 s37, s37, s38
buffer_load_dwordx4 v23, s[8:11], s37 offen sc1 lds
v_mul_f32 v162, -v80, v58
v_mul_f32 v163, -v80, v59
s_add_u32 m0, s39, 100352
s_add_u32 s37, s37, s38
buffer_load_dwordx4 v22, s[8:11], s37 offen sc1 lds
v_mul_f32 v164, -v82, v56
v_mul_f32 v165, -v82, v57
s_add_u32 m0, s39, 101376
s_add_u32 s37, s37, s38
buffer_load_dwordx4 v23, s[8:11], s37 offen sc1 lds
v_mul_f32 v166, -v82, v58
v_mul_f32 v167, -v82, v59
s_add_u32 m0, s39, 102400
s_add_u32 s37, s37, s38
buffer_load_dwordx4 v22, s[8:11], s37 offen sc1 lds
v_mul_f32 v168, -v84, v56
v_mul_f32 v169, -v84, v57
s_add_u32 m0, s39, 103424
s_add_u32 s37, s37, s38
buffer_load_dwordx4 v23, s[8:11], s37 offen sc1 lds
v_mul_f32 v170, -v84, v58
v_mul_f32 v171, -v84, v59
s_add_u32 m0, s39, 104448
s_add_u32 s37, s37, s38
buffer_load_dwordx4 v22, s[8:11], s37 offen sc1 lds
v_mul_f32 v172, -v86, v56
v_mul_f32 v173, -v86, v57
s_add_u32 m0, s39, 105472
s_add_u32 s37, s37, s38
buffer_load_dwordx4 v23, s[8:11], s37 offen sc1 lds
v_mul_f32 v174, -v86, v58
v_mul_f32 v175, -v86, v59
s_add_u32 m0, s39, 106496
s_add_u32 s37, s37, s38
buffer_load_dwordx4 v22, s[8:11], s37 offen sc1 lds
v_mul_f32 v176, -v80, v60
v_mul_f32 v177, -v80, v61
s_add_u32 m0, s39, 107520
s_add_u32 s37, s37, s38
buffer_load_dwordx4 v23, s[8:11], s37 offen sc1 lds
v_mul_f32 v178, -v80, v62
v_mul_f32 v179, -v80, v63
s_add_u32 m0, s39, 108544
s_add_u32 s37, s37, s38
buffer_load_dwordx4 v22, s[8:11], s37 offen sc1 lds
v_mul_f32 v180, -v82, v60
v_mul_f32 v181, -v82, v61
s_add_u32 m0, s39, 109568
s_add_u32 s37, s37, s38
buffer_load_dwordx4 v23, s[8:11], s37 offen sc1 lds
v_mul_f32 v182, -v82, v62
v_mul_f32 v183, -v82, v63
s_add_u32 m0, s39, 110592
s_add_u32 s37, s37, s38
buffer_load_dwordx4 v22, s[8:11], s37 offen sc1 lds
v_mul_f32 v184, -v84, v60
v_mul_f32 v185, -v84, v61
s_add_u32 m0, s39, 111616
s_add_u32 s37, s37, s38
buffer_load_dwordx4 v23, s[8:11], s37 offen sc1 lds
v_mul_f32 v186, -v84, v62
v_mul_f32 v187, -v84, v63
s_add_u32 m0, s39, 112640
s_add_u32 s37, s37, s38
buffer_load_dwordx4 v22, s[8:11], s37 offen sc1 lds
v_mul_f32 v188, -v86, v60
v_mul_f32 v189, -v86, v61
s_add_u32 m0, s39, 113664
s_add_u32 s37, s37, s38
buffer_load_dwordx4 v23, s[8:11], s37 offen sc1 lds
v_mul_f32 v190, -v86, v62
v_mul_f32 v191, -v86, v63
s_load_dword s64, s[80:81], 0
s_load_dword s65, s[80:81], 64
s_load_dword s66, s[80:81], 128
s_load_dword s67, s[80:81], 192
s_load_dword s68, s[80:81], 256
s_load_dword s69, s[80:81], 320
s_load_dword s70, s[80:81], 384
s_load_dword s71, s[80:81], 448
s_add_u32 s80, s80, 512
s_addc_u32 s81, s81, 0
s_waitcnt vmcnt(16)
s_barrier
s_mul_i32 s43, s35, 192
s_and_b32 s43, s43, 0xffffff80
s_add_u32 s43, s43, 4096
s_cmp_eq_u32 s51, 1
s_cselect_b32 s8, s4, s6
s_cselect_b32 s9, s5, s7
s_sub_u32 s10, 7340032, s43
s_lshl_b32 s44, s34, 18
s_add_u32 s44, s44, 4194304
s_movk_i32 s38, 28672
s_cmp_eq_u32 s51, 0
s_cselect_b32 s8, s32, s8
s_cselect_b32 s9, s33, s9
s_cselect_b32 s10, 262144, s10
s_cselect_b32 s43, s44, s43
s_cselect_b32 s38, 1024, s38
s_cselect_b32 s45, 0, -1
s_add_u32 s8, s8, s43
s_addc_u32 s9, s9, 0
s_mov_b32 s11, 0x20000
s_lshl_b32 s40, s38, 4
s_add_u32 s42, s35, 15
s_lshl_b32 s39, s51, 14
v_lshrrev_b32 v19, 4, v1
v_lshlrev_b32 v20, 5, v19
v_mul_u32_u24 v19, 6912, v19
v_and_b32 v19, s45, v19
v_and_b32 v20, s45, v20
v_lshlrev_b32 v21, 4, v1
v_xor_b32 v21, v21, v20
v_add_u32 v22, v21, v19
s_and_b32 s45, s45, 128
v_xor_b32 v23, s45, v22
s_add_u32 s42, s42, 1
s_and_b32 s42, s42, 15
s_add_u32 m0, s39, 0
s_mul_i32 s37, s42, s40
buffer_load_dwordx4 v22, s[8:11], s37 offen sc1 lds
v_mul_f32 v192, -v80, v64
v_mul_f32 v193, -v80, v65
s_add_u32 m0, s39, 1024
s_add_u32 s37, s37, s38
buffer_load_dwordx4 v23, s[8:11], s37 offen sc1 lds
v_mul_f32 v194, -v80, v66
v_mul_f32 v195, -v80, v67
s_add_u32 m0, s39, 2048
s_add_u32 s37, s37, s38
buffer_load_dwordx4 v22, s[8:11], s37 offen sc1 lds
v_mul_f32 v196, -v82, v64
v_mul_f32 v197, -v82, v65
s_add_u32 m0, s39, 3072
s_add_u32 s37, s37, s38
buffer_load_dwordx4 v23, s[8:11], s37 offen sc1 lds
v_mul_f32 v198, -v82, v66
v_mul_f32 v199, -v82, v67
s_add_u32 m0, s39, 4096
s_add_u32 s37, s37, s38
buffer_load_dwordx4 v22, s[8:11], s37 offen sc1 lds
v_mul_f32 v200, -v84, v64
v_mul_f32 v201, -v84, v65
s_add_u32 m0, s39, 5120
s_add_u32 s37, s37, s38
buffer_load_dwordx4 v23, s[8:11], s37 offen sc1 lds
v_mul_f32 v202, -v84, v66
v_mul_f32 v203, -v84, v67
s_add_u32 m0, s39, 6144
s_add_u32 s37, s37, s38
buffer_load_dwordx4 v22, s[8:11], s37 offen sc1 lds
v_mul_f32 v204, -v86, v64
v_mul_f32 v205, -v86, v65
s_add_u32 m0, s39, 7168
s_add_u32 s37, s37, s38
buffer_load_dwordx4 v23, s[8:11], s37 offen sc1 lds
v_mul_f32 v206, -v86, v66
v_mul_f32 v207, -v86, v67
s_add_u32 m0, s39, 8192
s_add_u32 s37, s37, s38
buffer_load_dwordx4 v22, s[8:11], s37 offen sc1 lds
v_mul_f32 v208, -v80, v68
v_mul_f32 v209, -v80, v69
s_add_u32 m0, s39, 9216
s_add_u32 s37, s37, s38
buffer_load_dwordx4 v23, s[8:11], s37 offen sc1 lds
v_mul_f32 v210, -v80, v70
v_mul_f32 v211, -v80, v71
s_add_u32 m0, s39, 10240
s_add_u32 s37, s37, s38
buffer_load_dwordx4 v22, s[8:11], s37 offen sc1 lds
v_mul_f32 v212, -v82, v68
v_mul_f32 v213, -v82, v69
s_add_u32 m0, s39, 11264
s_add_u32 s37, s37, s38
buffer_load_dwordx4 v23, s[8:11], s37 offen sc1 lds
v_mul_f32 v214, -v82, v70
v_mul_f32 v215, -v82, v71
s_add_u32 m0, s39, 12288
s_add_u32 s37, s37, s38
buffer_load_dwordx4 v22, s[8:11], s37 offen sc1 lds
v_mul_f32 v216, -v84, v68
v_mul_f32 v217, -v84, v69
s_add_u32 m0, s39, 13312
s_add_u32 s37, s37, s38
buffer_load_dwordx4 v23, s[8:11], s37 offen sc1 lds
v_mul_f32 v218, -v84, v70
v_mul_f32 v219, -v84, v71
s_add_u32 m0, s39, 14336
s_add_u32 s37, s37, s38
buffer_load_dwordx4 v22, s[8:11], s37 offen sc1 lds
v_mul_f32 v220, -v86, v68
v_mul_f32 v221, -v86, v69
s_add_u32 m0, s39, 15360
s_add_u32 s37, s37, s38
buffer_load_dwordx4 v23, s[8:11], s37 offen sc1 lds
v_mul_f32 v222, -v86, v70
v_mul_f32 v223, -v86, v71
s_load_dword s64, s[80:81], 0
s_load_dword s65, s[80:81], 64
s_load_dword s66, s[80:81], 128
s_load_dword s67, s[80:81], 192
s_load_dword s68, s[80:81], 256
s_load_dword s69, s[80:81], 320
s_load_dword s70, s[80:81], 384
s_add_u32 s80, s80, 448
s_addc_u32 s81, s81, 0
s_waitcnt vmcnt(16)
s_barrier
s_add_u32 s42, s42, 1
s_and_b32 s42, s42, 15
s_add_u32 m0, s39, 49152
s_mul_i32 s37, s42, s40
buffer_load_dwordx4 v22, s[8:11], s37 offen sc1 lds
s_add_u32 m0, s39, 50176
s_add_u32 s37, s37, s38
buffer_load_dwordx4 v23, s[8:11], s37 offen sc1 lds
s_add_u32 m0, s39, 51200
s_add_u32 s37, s37, s38
buffer_load_dwordx4 v22, s[8:11], s37 offen sc1 lds
s_add_u32 m0, s39, 52224
s_add_u32 s37, s37, s38
buffer_load_dwordx4 v23, s[8:11], s37 offen sc1 lds
s_add_u32 m0, s39, 53248
s_add_u32 s37, s37, s38
buffer_load_dwordx4 v22, s[8:11], s37 offen sc1 lds
s_add_u32 m0, s39, 54272
s_add_u32 s37, s37, s38
buffer_load_dwordx4 v23, s[8:11], s37 offen sc1 lds
s_add_u32 m0, s39, 55296
s_add_u32 s37, s37, s38
buffer_load_dwordx4 v22, s[8:11], s37 offen sc1 lds
s_add_u32 m0, s39, 56320
s_add_u32 s37, s37, s38
buffer_load_dwordx4 v23, s[8:11], s37 offen sc1 lds
s_add_u32 m0, s39, 57344
s_add_u32 s37, s37, s38
buffer_load_dwordx4 v22, s[8:11], s37 offen sc1 lds
s_add_u32 m0, s39, 58368
s_add_u32 s37, s37, s38
buffer_load_dwordx4 v23, s[8:11], s37 offen sc1 lds
s_add_u32 m0, s39, 59392
s_add_u32 s37, s37, s38
buffer_load_dwordx4 v22, s[8:11], s37 offen sc1 lds
s_add_u32 m0, s39, 60416
s_add_u32 s37, s37, s38
buffer_load_dwordx4 v23, s[8:11], s37 offen sc1 lds
s_add_u32 m0, s39, 61440
s_add_u32 s37, s37, s38
buffer_load_dwordx4 v22, s[8:11], s37 offen sc1 lds
s_add_u32 m0, s39, 62464
s_add_u32 s37, s37, s38
buffer_load_dwordx4 v23, s[8:11], s37 offen sc1 lds
s_add_u32 m0, s39, 63488
s_add_u32 s37, s37, s38
buffer_load_dwordx4 v22, s[8:11], s37 offen sc1 lds
s_add_u32 m0, s39, 64512
s_add_u32 s37, s37, s38
buffer_load_dwordx4 v23, s[8:11], s37 offen sc1 lds
s_mul_i32 s44, s34, 917504
s_lshl_b32 s39, s51, 13
s_add_u32 s44, s44, s39
s_add_u32 s44, s44, 8388608
s_and_b32 s43, s51, 1
s_xor_b32 s43, s43, s35
s_lshl_b32 s43, s43, 7
s_mov_b32 s10, 909312
s_movk_i32 s38, 1024
s_movk_i32 s40, 9216
s_movk_i32 s37, 0x4000
s_cmp_ge_u32 s51, 2
s_cselect_b32 s8, s60, s32
s_cselect_b32 s9, s61, s33
s_cselect_b32 s10, 7338112, s10
s_cselect_b32 s43, s43, s44
s_cselect_b32 s38, 16384, s38
s_cselect_b32 s40, 81920, s40
s_cselect_b32 s55, 81920, s38
s_cselect_b32 s37, 262144, s37
s_cselect_b32 s45, -1, 0
s_add_u32 s8, s8, s43
s_addc_u32 s9, s9, 0
s_mov_b32 s11, 0x20000
s_and_b32 s53, s35, 1
s_mul_i32 s54, s53, 6
s_mul_i32 s54, s54, s37
s_mul_i32 s29, s53, 2
s_add_u32 s29, s29, 6
s_mul_i32 s29, s29, s37
s_and_b32 s43, s45, 4290838528
s_add_u32 s29, s29, s43
s_mul_i32 s37, s37, 2
s_sub_u32 s37, s37, s40
v_lshrrev_b32 v19, 3, v1
v_mul_u32_u24 v19, 1920, v19
v_lshrrev_b32 v20, 4, v1
v_lshlrev_b32 v20, 5, v20
v_and_b32 v19, s45, v19
v_and_b32 v20, s45, v20
v_lshlrev_b32 v21, 4, v1
v_xor_b32 v21, v21, v20
v_add_u32 v21, v21, v19
s_waitcnt vmcnt(16)
s_barrier
s_branch LK3b_35
L7_34:
s_lshr_b32 s43, s2, 5
s_cmp_eq_u32 s43, 3
s_cbranch_scc1 Lnojob_47
s_cmp_gt_u32 s43, 3
s_cselect_b32 s43, 32, 0
s_sub_u32 s43, s2, s43
s_lshr_b32 s43, s43, 1
s_and_b32 s44, s2, 1
s_lshl_b32 s45, s44, 3
s_add_u32 s45, s45, 32
s_load_dwordx2 s[68:69], s[0:1], s45
s_mul_i32 s45, s43, 2341
s_lshr_b32 s45, s45, 16
s_mul_i32 s46, s45, 28
s_sub_u32 s46, s43, s46
v_lshrrev_b32 v4, 4, v1
s_lshl_b32 s43, s45, 8
v_add_u32 v4, s43, v4
v_mul_u32_u24 v4, 7168, v4
v_and_b32 v5, 15, v1
v_lshl_add_u32 v4, v5, 4, v4
s_lshl_b32 s43, s46, 8
v_add_u32 v4, s43, v4
s_waitcnt lgkmcnt(0)
s_mov_b32 s64, s68
s_mov_b32 s65, s69
s_mov_b32 s66, 7340032
s_mov_b32 s67, 0x20000
s_lshl_b32 s55, s45, 1
s_add_u32 s55, s55, s44
s_mul_i32 s55, s55, 14336
s_lshl_b32 s45, s46, 9
s_mov_b32 s50, s46
s_add_u32 s55, s55, s45
v_lshl_add_u32 v5, v5, 5, s55
s_add_u32 s72, s32, 27262976
s_addc_u32 s73, s33, 0
s_mov_b32 s74, 114688
s_mov_b32 s75, 0x20000
v_mov_b32 v32, 0
v_mov_b32 v33, 0
v_mov_b32 v34, 0
v_mov_b32 v35, 0
v_mov_b32 v36, 0
v_mov_b32 v37, 0
v_mov_b32 v38, 0
v_mov_b32 v39, 0
v_lshlrev_b32 v40, 16, v128
v_and_b32 v41, 0xffff0000, v128
v_lshlrev_b32 v42, 16, v129
v_and_b32 v43, 0xffff0000, v129
v_lshlrev_b32 v44, 16, v130
v_and_b32 v45, 0xffff0000, v130
v_lshlrev_b32 v46, 16, v131
v_and_b32 v47, 0xffff0000, v131
v_pk_add_f32 v[32:33], v[32:33], v[40:41]
v_pk_add_f32 v[34:35], v[34:35], v[42:43]
v_pk_add_f32 v[36:37], v[36:37], v[44:45]
v_pk_add_f32 v[38:39], v[38:39], v[46:47]
s_mov_b32 s43, 917504
buffer_load_dwordx4 v[128:131], v4, s[64:67], s43 offen
v_lshlrev_b32 v48, 16, v132
v_and_b32 v49, 0xffff0000, v132
v_lshlrev_b32 v50, 16, v133
v_and_b32 v51, 0xffff0000, v133
v_lshlrev_b32 v52, 16, v134
v_and_b32 v53, 0xffff0000, v134
v_lshlrev_b32 v54, 16, v135
v_and_b32 v55, 0xffff0000, v135
v_pk_add_f32 v[32:33], v[32:33], v[48:49]
v_pk_add_f32 v[34:35], v[34:35], v[50:51]
v_pk_add_f32 v[36:37], v[36:37], v[52:53]
v_pk_add_f32 v[38:39], v[38:39], v[54:55]
s_mov_b32 s43, 946176
buffer_load_dwordx4 v[132:135], v4, s[64:67], s43 offen
v_lshlrev_b32 v40, 16, v136
v_and_b32 v41, 0xffff0000, v136
v_lshlrev_b32 v42, 16, v137
v_and_b32 v43, 0xffff0000, v137
v_lshlrev_b32 v44, 16, v138
v_and_b32 v45, 0xffff0000, v138
v_lshlrev_b32 v46, 16, v139
v_and_b32 v47, 0xffff0000, v139
v_pk_add_f32 v[32:33], v[32:33], v[40:41]
v_pk_add_f32 v[34:35], v[34:35], v[42:43]
v_pk_add_f32 v[36:37], v[36:37], v[44:45]
v_pk_add_f32 v[38:39], v[38:39], v[46:47]
s_mov_b32 s43, 974848
buffer_load_dwordx4 v[136:139], v4, s[64:67], s43 offen
v_lshlrev_b32 v48, 16, v140
v_and_b32 v49, 0xffff0000, v140
v_lshlrev_b32 v50, 16, v141
v_and_b32 v51, 0xffff0000, v141
v_lshlrev_b32 v52, 16, v142
v_and_b32 v53, 0xffff0000, v142
v_lshlrev_b32 v54, 16, v143
v_and_b32 v55, 0xffff0000, v143
v_pk_add_f32 v[32:33], v[32:33], v[48:49]
v_pk_add_f32 v[34:35], v[34:35], v[50:51]
v_pk_add_f32 v[36:37], v[36:37], v[52:53]
v_pk_add_f32 v[38:39], v[38:39], v[54:55]
s_mov_b32 s43, 1003520
buffer_load_dwordx4 v[140:143], v4, s[64:67], s43 offen
v_lshlrev_b32 v40, 16, v144
v_and_b32 v41, 0xffff0000, v144
v_lshlrev_b32 v42, 16, v145
v_and_b32 v43, 0xffff0000, v145
v_lshlrev_b32 v44, 16, v146
v_and_b32 v45, 0xffff0000, v146
v_lshlrev_b32 v46, 16, v147
v_and_b32 v47, 0xffff0000, v147
v_pk_add_f32 v[32:33], v[32:33], v[40:41]
v_pk_add_f32 v[34:35], v[34:35], v[42:43]
v_pk_add_f32 v[36:37], v[36:37], v[44:45]
v_pk_add_f32 v[38:39], v[38:39], v[46:47]
s_mov_b32 s43, 1032192
buffer_load_dwordx4 v[144:147], v4, s[64:67], s43 offen
v_lshlrev_b32 v48, 16, v148
v_and_b32 v49, 0xffff0000, v148
v_lshlrev_b32 v50, 16, v149
v_and_b32 v51, 0xffff0000, v149
v_lshlrev_b32 v52, 16, v150
v_and_b32 v53, 0xffff0000, v150
v_lshlrev_b32 v54, 16, v151
v_and_b32 v55, 0xffff0000, v151
v_pk_add_f32 v[32:33], v[32:33], v[48:49]
v_pk_add_f32 v[34:35], v[34:35], v[50:51]
v_pk_add_f32 v[36:37], v[36:37], v[52:53]
v_pk_add_f32 v[38:39], v[38:39], v[54:55]
s_mov_b32 s43, 1060864
buffer_load_dwordx4 v[148:151], v4, s[64:67], s43 offen
v_lshlrev_b32 v40, 16, v152
v_and_b32 v41, 0xffff0000, v152
v_lshlrev_b32 v42, 16, v153
v_and_b32 v43, 0xffff0000, v153
v_lshlrev_b32 v44, 16, v154
v_and_b32 v45, 0xffff0000, v154
v_lshlrev_b32 v46, 16, v155
v_and_b32 v47, 0xffff0000, v155
v_pk_add_f32 v[32:33], v[32:33], v[40:41]
v_pk_add_f32 v[34:35], v[34:35], v[42:43]
v_pk_add_f32 v[36:37], v[36:37], v[44:45]
v_pk_add_f32 v[38:39], v[38:39], v[46:47]
s_mov_b32 s43, 1089536
buffer_load_dwordx4 v[152:155], v4, s[64:67], s43 offen
v_lshlrev_b32 v48, 16, v156
v_and_b32 v49, 0xffff0000, v156
v_lshlrev_b32 v50, 16, v157
v_and_b32 v51, 0xffff0000, v157
v_lshlrev_b32 v52, 16, v158
v_and_b32 v53, 0xffff0000, v158
v_lshlrev_b32 v54, 16, v159
v_and_b32 v55, 0xffff0000, v159
v_pk_add_f32 v[32:33], v[32:33], v[48:49]
v_pk_add_f32 v[34:35], v[34:35], v[50:51]
v_pk_add_f32 v[36:37], v[36:37], v[52:53]
v_pk_add_f32 v[38:39], v[38:39], v[54:55]
s_mov_b32 s43, 1118208
buffer_load_dwordx4 v[156:159], v4, s[64:67], s43 offen
v_lshlrev_b32 v40, 16, v160
v_and_b32 v41, 0xffff0000, v160
v_lshlrev_b32 v42, 16, v161
v_and_b32 v43, 0xffff0000, v161
v_lshlrev_b32 v44, 16, v162
v_and_b32 v45, 0xffff0000, v162
v_lshlrev_b32 v46, 16, v163
v_and_b32 v47, 0xffff0000, v163
v_pk_add_f32 v[32:33], v[32:33], v[40:41]
v_pk_add_f32 v[34:35], v[34:35], v[42:43]
v_pk_add_f32 v[36:37], v[36:37], v[44:45]
v_pk_add_f32 v[38:39], v[38:39], v[46:47]
s_mov_b32 s43, 1146880
buffer_load_dwordx4 v[160:163], v4, s[64:67], s43 offen
v_lshlrev_b32 v48, 16, v164
v_and_b32 v49, 0xffff0000, v164
v_lshlrev_b32 v50, 16, v165
v_and_b32 v51, 0xffff0000, v165
v_lshlrev_b32 v52, 16, v166
v_and_b32 v53, 0xffff0000, v166
v_lshlrev_b32 v54, 16, v167
v_and_b32 v55, 0xffff0000, v167
v_pk_add_f32 v[32:33], v[32:33], v[48:49]
v_pk_add_f32 v[34:35], v[34:35], v[50:51]
v_pk_add_f32 v[36:37], v[36:37], v[52:53]
v_pk_add_f32 v[38:39], v[38:39], v[54:55]
s_mov_b32 s43, 1175552
buffer_load_dwordx4 v[164:167], v4, s[64:67], s43 offen
v_lshlrev_b32 v40, 16, v168
v_and_b32 v41, 0xffff0000, v168
v_lshlrev_b32 v42, 16, v169
v_and_b32 v43, 0xffff0000, v169
v_lshlrev_b32 v44, 16, v170
v_and_b32 v45, 0xffff0000, v170
v_lshlrev_b32 v46, 16, v171
v_and_b32 v47, 0xffff0000, v171
v_pk_add_f32 v[32:33], v[32:33], v[40:41]
v_pk_add_f32 v[34:35], v[34:35], v[42:43]
v_pk_add_f32 v[36:37], v[36:37], v[44:45]
v_pk_add_f32 v[38:39], v[38:39], v[46:47]
s_mov_b32 s43, 1204224
buffer_load_dwordx4 v[168:171], v4, s[64:67], s43 offen
v_lshlrev_b32 v48, 16, v172
v_and_b32 v49, 0xffff0000, v172
v_lshlrev_b32 v50, 16, v173
v_and_b32 v51, 0xffff0000, v173
v_lshlrev_b32 v52, 16, v174
v_and_b32 v53, 0xffff0000, v174
v_lshlrev_b32 v54, 16, v175
v_and_b32 v55, 0xffff0000, v175
v_pk_add_f32 v[32:33], v[32:33], v[48:49]
v_pk_add_f32 v[34:35], v[34:35], v[50:51]
v_pk_add_f32 v[36:37], v[36:37], v[52:53]
v_pk_add_f32 v[38:39], v[38:39], v[54:55]
s_mov_b32 s43, 1232896
buffer_load_dwordx4 v[172:175], v4, s[64:67], s43 offen
v_lshlrev_b32 v40, 16, v176
v_and_b32 v41, 0xffff0000, v176
v_lshlrev_b32 v42, 16, v177
v_and_b32 v43, 0xffff0000, v177
v_lshlrev_b32 v44, 16, v178
v_and_b32 v45, 0xffff0000, v178
v_lshlrev_b32 v46, 16, v179
v_and_b32 v47, 0xffff0000, v179
v_pk_add_f32 v[32:33], v[32:33], v[40:41]
v_pk_add_f32 v[34:35], v[34:35], v[42:43]
v_pk_add_f32 v[36:37], v[36:37], v[44:45]
v_pk_add_f32 v[38:39], v[38:39], v[46:47]
s_mov_b32 s43, 1261568
buffer_load_dwordx4 v[176:179], v4, s[64:67], s43 offen
v_lshlrev_b32 v48, 16, v180
v_and_b32 v49, 0xffff0000, v180
v_lshlrev_b32 v50, 16, v181
v_and_b32 v51, 0xffff0000, v181
v_lshlrev_b32 v52, 16, v182
v_and_b32 v53, 0xffff0000, v182
v_lshlrev_b32 v54, 16, v183
v_and_b32 v55, 0xffff0000, v183
v_pk_add_f32 v[32:33], v[32:33], v[48:49]
v_pk_add_f32 v[34:35], v[34:35], v[50:51]
v_pk_add_f32 v[36:37], v[36:37], v[52:53]
v_pk_add_f32 v[38:39], v[38:39], v[54:55]
s_mov_b32 s43, 1290240
buffer_load_dwordx4 v[180:183], v4, s[64:67], s43 offen
v_lshlrev_b32 v40, 16, v184
v_and_b32 v41, 0xffff0000, v184
v_lshlrev_b32 v42, 16, v185
v_and_b32 v43, 0xffff0000, v185
v_lshlrev_b32 v44, 16, v186
v_and_b32 v45, 0xffff0000, v186
v_lshlrev_b32 v46, 16, v187
v_and_b32 v47, 0xffff0000, v187
v_pk_add_f32 v[32:33], v[32:33], v[40:41]
v_pk_add_f32 v[34:35], v[34:35], v[42:43]
v_pk_add_f32 v[36:37], v[36:37], v[44:45]
v_pk_add_f32 v[38:39], v[38:39], v[46:47]
s_mov_b32 s43, 1318912
buffer_load_dwordx4 v[184:187], v4, s[64:67], s43 offen
v_lshlrev_b32 v48, 16, v188
v_and_b32 v49, 0xffff0000, v188
v_lshlrev_b32 v50, 16, v189
v_and_b32 v51, 0xffff0000, v189
v_lshlrev_b32 v52, 16, v190
v_and_b32 v53, 0xffff0000, v190
v_lshlrev_b32 v54, 16, v191
v_and_b32 v55, 0xffff0000, v191
v_pk_add_f32 v[32:33], v[32:33], v[48:49]
v_pk_add_f32 v[34:35], v[34:35], v[50:51]
v_pk_add_f32 v[36:37], v[36:37], v[52:53]
v_pk_add_f32 v[38:39], v[38:39], v[54:55]
s_mov_b32 s43, 1347584
buffer_load_dwordx4 v[188:191], v4, s[64:67], s43 offen
v_lshlrev_b32 v40, 16, v192
v_and_b32 v41, 0xffff0000, v192
v_lshlrev_b32 v42, 16, v193
v_and_b32 v43, 0xffff0000, v193
v_lshlrev_b32 v44, 16, v194
v_and_b32 v45, 0xffff0000, v194
v_lshlrev_b32 v46, 16, v195
v_and_b32 v47, 0xffff0000, v195
v_pk_add_f32 v[32:33], v[32:33], v[40:41]
v_pk_add_f32 v[34:35], v[34:35], v[42:43]
v_pk_add_f32 v[36:37], v[36:37], v[44:45]
v_pk_add_f32 v[38:39], v[38:39], v[46:47]
s_mov_b32 s43, 1376256
buffer_load_dwordx4 v[192:195], v4, s[64:67], s43 offen
v_lshlrev_b32 v48, 16, v196
v_and_b32 v49, 0xffff0000, v196
v_lshlrev_b32 v50, 16, v197
v_and_b32 v51, 0xffff0000, v197
v_lshlrev_b32 v52, 16, v198
v_and_b32 v53, 0xffff0000, v198
v_lshlrev_b32 v54, 16, v199
v_and_b32 v55, 0xffff0000, v199
v_pk_add_f32 v[32:33], v[32:33], v[48:49]
v_pk_add_f32 v[34:35], v[34:35], v[50:51]
v_pk_add_f32 v[36:37], v[36:37], v[52:53]
v_pk_add_f32 v[38:39], v[38:39], v[54:55]
s_mov_b32 s43, 1404928
buffer_load_dwordx4 v[196:199], v4, s[64:67], s43 offen
v_lshlrev_b32 v40, 16, v200
v_and_b32 v41, 0xffff0000, v200
v_lshlrev_b32 v42, 16, v201
v_and_b32 v43, 0xffff0000, v201
v_lshlrev_b32 v44, 16, v202
v_and_b32 v45, 0xffff0000, v202
v_lshlrev_b32 v46, 16, v203
v_and_b32 v47, 0xffff0000, v203
v_pk_add_f32 v[32:33], v[32:33], v[40:41]
v_pk_add_f32 v[34:35], v[34:35], v[42:43]
v_pk_add_f32 v[36:37], v[36:37], v[44:45]
v_pk_add_f32 v[38:39], v[38:39], v[46:47]
s_mov_b32 s43, 1433600
buffer_load_dwordx4 v[200:203], v4, s[64:67], s43 offen
v_lshlrev_b32 v48, 16, v204
v_and_b32 v49, 0xffff0000, v204
v_lshlrev_b32 v50, 16, v205
v_and_b32 v51, 0xffff0000, v205
v_lshlrev_b32 v52, 16, v206
v_and_b32 v53, 0xffff0000, v206
v_lshlrev_b32 v54, 16, v207
v_and_b32 v55, 0xffff0000, v207
v_pk_add_f32 v[32:33], v[32:33], v[48:49]
v_pk_add_f32 v[34:35], v[34:35], v[50:51]
v_pk_add_f32 v[36:37], v[36:37], v[52:53]
v_pk_add_f32 v[38:39], v[38:39], v[54:55]
s_mov_b32 s43, 1462272
buffer_load_dwordx4 v[204:207], v4, s[64:67], s43 offen
v_lshlrev_b32 v40, 16, v208
v_and_b32 v41, 0xffff0000, v208
v_lshlrev_b32 v42, 16, v209
v_and_b32 v43, 0xffff0000, v209
v_lshlrev_b32 v44, 16, v210
v_and_b32 v45, 0xffff0000, v210
v_lshlrev_b32 v46, 16, v211
v_and_b32 v47, 0xffff0000, v211
v_pk_add_f32 v[32:33], v[32:33], v[40:41]
v_pk_add_f32 v[34:35], v[34:35], v[42:43]
v_pk_add_f32 v[36:37], v[36:37], v[44:45]
v_pk_add_f32 v[38:39], v[38:39], v[46:47]
s_mov_b32 s43, 1490944
buffer_load_dwordx4 v[208:211], v4, s[64:67], s43 offen
v_lshlrev_b32 v48, 16, v212
v_and_b32 v49, 0xffff0000, v212
v_lshlrev_b32 v50, 16, v213
v_and_b32 v51, 0xffff0000, v213
v_lshlrev_b32 v52, 16, v214
v_and_b32 v53, 0xffff0000, v214
v_lshlrev_b32 v54, 16, v215
v_and_b32 v55, 0xffff0000, v215
v_pk_add_f32 v[32:33], v[32:33], v[48:49]
v_pk_add_f32 v[34:35], v[34:35], v[50:51]
v_pk_add_f32 v[36:37], v[36:37], v[52:53]
v_pk_add_f32 v[38:39], v[38:39], v[54:55]
s_mov_b32 s43, 1519616
buffer_load_dwordx4 v[212:215], v4, s[64:67], s43 offen
v_lshlrev_b32 v40, 16, v216
v_and_b32 v41, 0xffff0000, v216
v_lshlrev_b32 v42, 16, v217
v_and_b32 v43, 0xffff0000, v217
v_lshlrev_b32 v44, 16, v218
v_and_b32 v45, 0xffff0000, v218
v_lshlrev_b32 v46, 16, v219
v_and_b32 v47, 0xffff0000, v219
v_pk_add_f32 v[32:33], v[32:33], v[40:41]
v_pk_add_f32 v[34:35], v[34:35], v[42:43]
v_pk_add_f32 v[36:37], v[36:37], v[44:45]
v_pk_add_f32 v[38:39], v[38:39], v[46:47]
s_mov_b32 s43, 1548288
buffer_load_dwordx4 v[216:219], v4, s[64:67], s43 offen
v_lshlrev_b32 v48, 16, v220
v_and_b32 v49, 0xffff0000, v220
v_lshlrev_b32 v50, 16, v221
v_and_b32 v51, 0xffff0000, v221
v_lshlrev_b32 v52, 16, v222
v_and_b32 v53, 0xffff0000, v222
v_lshlrev_b32 v54, 16, v223
v_and_b32 v55, 0xffff0000, v223
v_pk_add_f32 v[32:33], v[32:33], v[48:49]
v_pk_add_f32 v[34:35], v[34:35], v[50:51]
v_pk_add_f32 v[36:37], v[36:37], v[52:53]
v_pk_add_f32 v[38:39], v[38:39], v[54:55]
s_mov_b32 s43, 1576960
buffer_load_dwordx4 v[220:223], v4, s[64:67], s43 offen
v_lshlrev_b32 v40, 16, v224
v_and_b32 v41, 0xffff0000, v224
v_lshlrev_b32 v42, 16, v225
v_and_b32 v43, 0xffff0000, v225
v_lshlrev_b32 v44, 16, v226
v_and_b32 v45, 0xffff0000, v226
v_lshlrev_b32 v46, 16, v227
v_and_b32 v47, 0xffff0000, v227
v_pk_add_f32 v[32:33], v[32:33], v[40:41]
v_pk_add_f32 v[34:35], v[34:35], v[42:43]
v_pk_add_f32 v[36:37], v[36:37], v[44:45]
v_pk_add_f32 v[38:39], v[38:39], v[46:47]
s_mov_b32 s43, 1605632
buffer_load_dwordx4 v[224:227], v4, s[64:67], s43 offen
v_lshlrev_b32 v48, 16, v228
v_and_b32 v49, 0xffff0000, v228
v_lshlrev_b32 v50, 16, v229
v_and_b32 v51, 0xffff0000, v229
v_lshlrev_b32 v52, 16, v230
v_and_b32 v53, 0xffff0000, v230
v_lshlrev_b32 v54, 16, v231
v_and_b32 v55, 0xffff0000, v231
v_pk_add_f32 v[32:33], v[32:33], v[48:49]
v_pk_add_f32 v[34:35], v[34:35], v[50:51]
v_pk_add_f32 v[36:37], v[36:37], v[52:53]
v_pk_add_f32 v[38:39], v[38:39], v[54:55]
s_mov_b32 s43, 1634304
buffer_load_dwordx4 v[228:231], v4, s[64:67], s43 offen
v_lshlrev_b32 v40, 16, v232
v_and_b32 v41, 0xffff0000, v232
v_lshlrev_b32 v42, 16, v233
v_and_b32 v43, 0xffff0000, v233
v_lshlrev_b32 v44, 16, v234
v_and_b32 v45, 0xffff0000, v234
v_lshlrev_b32 v46, 16, v235
v_and_b32 v47, 0xffff0000, v235
v_pk_add_f32 v[32:33], v[32:33], v[40:41]
v_pk_add_f32 v[34:35], v[34:35], v[42:43]
v_pk_add_f32 v[36:37], v[36:37], v[44:45]
v_pk_add_f32 v[38:39], v[38:39], v[46:47]
s_mov_b32 s43, 1662976
buffer_load_dwordx4 v[232:235], v4, s[64:67], s43 offen
v_lshlrev_b32 v48, 16, v236
v_and_b32 v49, 0xffff0000, v236
v_lshlrev_b32 v50, 16, v237
v_and_b32 v51, 0xffff0000, v237
v_lshlrev_b32 v52, 16, v238
v_and_b32 v53, 0xffff0000, v238
v_lshlrev_b32 v54, 16, v239
v_and_b32 v55, 0xffff0000, v239
v_pk_add_f32 v[32:33], v[32:33], v[48:49]
v_pk_add_f32 v[34:35], v[34:35], v[50:51]
v_pk_add_f32 v[36:37], v[36:37], v[52:53]
v_pk_add_f32 v[38:39], v[38:39], v[54:55]
s_mov_b32 s43, 1691648
buffer_load_dwordx4 v[236:239], v4, s[64:67], s43 offen
v_lshlrev_b32 v40, 16, v240
v_and_b32 v41, 0xffff0000, v240
v_lshlrev_b32 v42, 16, v241
v_and_b32 v43, 0xffff0000, v241
v_lshlrev_b32 v44, 16, v242
v_and_b32 v45, 0xffff0000, v242
v_lshlrev_b32 v46, 16, v243
v_and_b32 v47, 0xffff0000, v243
v_pk_add_f32 v[32:33], v[32:33], v[40:41]
v_pk_add_f32 v[34:35], v[34:35], v[42:43]
v_pk_add_f32 v[36:37], v[36:37], v[44:45]
v_pk_add_f32 v[38:39], v[38:39], v[46:47]
s_mov_b32 s43, 1720320
buffer_load_dwordx4 v[240:243], v4, s[64:67], s43 offen
v_lshlrev_b32 v48, 16, v244
v_and_b32 v49, 0xffff0000, v244
v_lshlrev_b32 v50, 16, v245
v_and_b32 v51, 0xffff0000, v245
v_lshlrev_b32 v52, 16, v246
v_and_b32 v53, 0xffff0000, v246
v_lshlrev_b32 v54, 16, v247
v_and_b32 v55, 0xffff0000, v247
v_pk_add_f32 v[32:33], v[32:33], v[48:49]
v_pk_add_f32 v[34:35], v[34:35], v[50:51]
v_pk_add_f32 v[36:37], v[36:37], v[52:53]
v_pk_add_f32 v[38:39], v[38:39], v[54:55]
s_mov_b32 s43, 1748992
buffer_load_dwordx4 v[244:247], v4, s[64:67], s43 offen
v_lshlrev_b32 v40, 16, v248
v_and_b32 v41, 0xffff0000, v248
v_lshlrev_b32 v42, 16, v249
v_and_b32 v43, 0xffff0000, v249
v_lshlrev_b32 v44, 16, v250
v_and_b32 v45, 0xffff0000, v250
v_lshlrev_b32 v46, 16, v251
v_and_b32 v47, 0xffff0000, v251
v_pk_add_f32 v[32:33], v[32:33], v[40:41]
v_pk_add_f32 v[34:35], v[34:35], v[42:43]
v_pk_add_f32 v[36:37], v[36:37], v[44:45]
v_pk_add_f32 v[38:39], v[38:39], v[46:47]
s_mov_b32 s43, 1777664
buffer_load_dwordx4 v[248:251], v4, s[64:67], s43 offen
v_lshlrev_b32 v48, 16, v252
v_and_b32 v49, 0xffff0000, v252
v_lshlrev_b32 v50, 16, v253
v_and_b32 v51, 0xffff0000, v253
v_lshlrev_b32 v52, 16, v254
v_and_b32 v53, 0xffff0000, v254
v_lshlrev_b32 v54, 16, v255
v_and_b32 v55, 0xffff0000, v255
v_pk_add_f32 v[32:33], v[32:33], v[48:49]
v_pk_add_f32 v[34:35], v[34:35], v[50:51]
v_pk_add_f32 v[36:37], v[36:37], v[52:53]
v_pk_add_f32 v[38:39], v[38:39], v[54:55]
s_mov_b32 s43, 1806336
buffer_load_dwordx4 v[252:255], v4, s[64:67], s43 offen
s_lshl_b32 s43, s34, 18
s_add_u32 s12, s32, s43
s_addc_u32 s13, s33, 0
s_mov_b32 s14, 262144
s_mov_b32 s15, 0x20000
v_lshlrev_b32 v21, 4, v1
s_lshl_b32 s54, s36, 11
s_barrier
s_add_u32 m0, s54, 0
s_add_u32 s43, s54, 0
buffer_load_dwordx4 v21, s[12:15], s43 offen sc1 lds
s_add_u32 m0, s54, 1024
s_add_u32 s43, s54, 1024
buffer_load_dwordx4 v21, s[12:15], s43 offen sc1 lds
s_add_u32 m0, s54, 24576
s_add_u32 s43, s54, 16384
buffer_load_dwordx4 v21, s[12:15], s43 offen sc1 lds
s_add_u32 m0, s54, 25600
s_add_u32 s43, s54, 17408
buffer_load_dwordx4 v21, s[12:15], s43 offen sc1 lds
s_waitcnt vmcnt(2)
s_barrier
s_waitcnt vmcnt(0)
s_barrier
s_barrier
s_barrier
s_barrier
v_lshlrev_b32 v40, 16, v128
v_and_b32 v41, 0xffff0000, v128
v_lshlrev_b32 v42, 16, v129
v_and_b32 v43, 0xffff0000, v129
v_lshlrev_b32 v44, 16, v130
v_and_b32 v45, 0xffff0000, v130
v_lshlrev_b32 v46, 16, v131
v_and_b32 v47, 0xffff0000, v131
v_pk_add_f32 v[32:33], v[32:33], v[40:41]
v_pk_add_f32 v[34:35], v[34:35], v[42:43]
v_pk_add_f32 v[36:37], v[36:37], v[44:45]
v_pk_add_f32 v[38:39], v[38:39], v[46:47]
v_lshlrev_b32 v48, 16, v132
v_and_b32 v49, 0xffff0000, v132
v_lshlrev_b32 v50, 16, v133
v_and_b32 v51, 0xffff0000, v133
v_lshlrev_b32 v52, 16, v134
v_and_b32 v53, 0xffff0000, v134
v_lshlrev_b32 v54, 16, v135
v_and_b32 v55, 0xffff0000, v135
v_pk_add_f32 v[32:33], v[32:33], v[48:49]
v_pk_add_f32 v[34:35], v[34:35], v[50:51]
v_pk_add_f32 v[36:37], v[36:37], v[52:53]
v_pk_add_f32 v[38:39], v[38:39], v[54:55]
v_lshlrev_b32 v40, 16, v136
v_and_b32 v41, 0xffff0000, v136
v_lshlrev_b32 v42, 16, v137
v_and_b32 v43, 0xffff0000, v137
v_lshlrev_b32 v44, 16, v138
v_and_b32 v45, 0xffff0000, v138
v_lshlrev_b32 v46, 16, v139
v_and_b32 v47, 0xffff0000, v139
v_pk_add_f32 v[32:33], v[32:33], v[40:41]
v_pk_add_f32 v[34:35], v[34:35], v[42:43]
v_pk_add_f32 v[36:37], v[36:37], v[44:45]
v_pk_add_f32 v[38:39], v[38:39], v[46:47]
v_lshlrev_b32 v48, 16, v140
v_and_b32 v49, 0xffff0000, v140
v_lshlrev_b32 v50, 16, v141
v_and_b32 v51, 0xffff0000, v141
v_lshlrev_b32 v52, 16, v142
v_and_b32 v53, 0xffff0000, v142
v_lshlrev_b32 v54, 16, v143
v_and_b32 v55, 0xffff0000, v143
v_pk_add_f32 v[32:33], v[32:33], v[48:49]
v_pk_add_f32 v[34:35], v[34:35], v[50:51]
v_pk_add_f32 v[36:37], v[36:37], v[52:53]
v_pk_add_f32 v[38:39], v[38:39], v[54:55]
s_barrier
v_lshlrev_b32 v40, 16, v144
v_and_b32 v41, 0xffff0000, v144
v_lshlrev_b32 v42, 16, v145
v_and_b32 v43, 0xffff0000, v145
v_lshlrev_b32 v44, 16, v146
v_and_b32 v45, 0xffff0000, v146
v_lshlrev_b32 v46, 16, v147
v_and_b32 v47, 0xffff0000, v147
v_pk_add_f32 v[32:33], v[32:33], v[40:41]
v_pk_add_f32 v[34:35], v[34:35], v[42:43]
v_pk_add_f32 v[36:37], v[36:37], v[44:45]
v_pk_add_f32 v[38:39], v[38:39], v[46:47]
v_lshlrev_b32 v48, 16, v148
v_and_b32 v49, 0xffff0000, v148
v_lshlrev_b32 v50, 16, v149
v_and_b32 v51, 0xffff0000, v149
v_lshlrev_b32 v52, 16, v150
v_and_b32 v53, 0xffff0000, v150
v_lshlrev_b32 v54, 16, v151
v_and_b32 v55, 0xffff0000, v151
v_pk_add_f32 v[32:33], v[32:33], v[48:49]
v_pk_add_f32 v[34:35], v[34:35], v[50:51]
v_pk_add_f32 v[36:37], v[36:37], v[52:53]
v_pk_add_f32 v[38:39], v[38:39], v[54:55]
v_lshlrev_b32 v40, 16, v152
v_and_b32 v41, 0xffff0000, v152
v_lshlrev_b32 v42, 16, v153
v_and_b32 v43, 0xffff0000, v153
v_lshlrev_b32 v44, 16, v154
v_and_b32 v45, 0xffff0000, v154
v_lshlrev_b32 v46, 16, v155
v_and_b32 v47, 0xffff0000, v155
v_pk_add_f32 v[32:33], v[32:33], v[40:41]
v_pk_add_f32 v[34:35], v[34:35], v[42:43]
v_pk_add_f32 v[36:37], v[36:37], v[44:45]
v_pk_add_f32 v[38:39], v[38:39], v[46:47]
v_lshlrev_b32 v48, 16, v156
v_and_b32 v49, 0xffff0000, v156
v_lshlrev_b32 v50, 16, v157
v_and_b32 v51, 0xffff0000, v157
v_lshlrev_b32 v52, 16, v158
v_and_b32 v53, 0xffff0000, v158
v_lshlrev_b32 v54, 16, v159
v_and_b32 v55, 0xffff0000, v159
v_pk_add_f32 v[32:33], v[32:33], v[48:49]
v_pk_add_f32 v[34:35], v[34:35], v[50:51]
v_pk_add_f32 v[36:37], v[36:37], v[52:53]
v_pk_add_f32 v[38:39], v[38:39], v[54:55]
s_barrier
v_lshlrev_b32 v40, 16, v160
v_and_b32 v41, 0xffff0000, v160
v_lshlrev_b32 v42, 16, v161
v_and_b32 v43, 0xffff0000, v161
v_lshlrev_b32 v44, 16, v162
v_and_b32 v45, 0xffff0000, v162
v_lshlrev_b32 v46, 16, v163
v_and_b32 v47, 0xffff0000, v163
v_pk_add_f32 v[32:33], v[32:33], v[40:41]
v_pk_add_f32 v[34:35], v[34:35], v[42:43]
v_pk_add_f32 v[36:37], v[36:37], v[44:45]
v_pk_add_f32 v[38:39], v[38:39], v[46:47]
v_lshlrev_b32 v48, 16, v164
v_and_b32 v49, 0xffff0000, v164
v_lshlrev_b32 v50, 16, v165
v_and_b32 v51, 0xffff0000, v165
v_lshlrev_b32 v52, 16, v166
v_and_b32 v53, 0xffff0000, v166
v_lshlrev_b32 v54, 16, v167
v_and_b32 v55, 0xffff0000, v167
v_pk_add_f32 v[32:33], v[32:33], v[48:49]
v_pk_add_f32 v[34:35], v[34:35], v[50:51]
v_pk_add_f32 v[36:37], v[36:37], v[52:53]
v_pk_add_f32 v[38:39], v[38:39], v[54:55]
v_lshlrev_b32 v40, 16, v168
v_and_b32 v41, 0xffff0000, v168
v_lshlrev_b32 v42, 16, v169
v_and_b32 v43, 0xffff0000, v169
v_lshlrev_b32 v44, 16, v170
v_and_b32 v45, 0xffff0000, v170
v_lshlrev_b32 v46, 16, v171
v_and_b32 v47, 0xffff0000, v171
v_pk_add_f32 v[32:33], v[32:33], v[40:41]
v_pk_add_f32 v[34:35], v[34:35], v[42:43]
v_pk_add_f32 v[36:37], v[36:37], v[44:45]
v_pk_add_f32 v[38:39], v[38:39], v[46:47]
v_lshlrev_b32 v48, 16, v172
v_and_b32 v49, 0xffff0000, v172
v_lshlrev_b32 v50, 16, v173
v_and_b32 v51, 0xffff0000, v173
v_lshlrev_b32 v52, 16, v174
v_and_b32 v53, 0xffff0000, v174
v_lshlrev_b32 v54, 16, v175
v_and_b32 v55, 0xffff0000, v175
v_pk_add_f32 v[32:33], v[32:33], v[48:49]
v_pk_add_f32 v[34:35], v[34:35], v[50:51]
v_pk_add_f32 v[36:37], v[36:37], v[52:53]
v_pk_add_f32 v[38:39], v[38:39], v[54:55]
s_barrier
v_lshlrev_b32 v40, 16, v176
v_and_b32 v41, 0xffff0000, v176
v_lshlrev_b32 v42, 16, v177
v_and_b32 v43, 0xffff0000, v177
v_lshlrev_b32 v44, 16, v178
v_and_b32 v45, 0xffff0000, v178
v_lshlrev_b32 v46, 16, v179
v_and_b32 v47, 0xffff0000, v179
v_pk_add_f32 v[32:33], v[32:33], v[40:41]
v_pk_add_f32 v[34:35], v[34:35], v[42:43]
v_pk_add_f32 v[36:37], v[36:37], v[44:45]
v_pk_add_f32 v[38:39], v[38:39], v[46:47]
v_lshlrev_b32 v48, 16, v180
v_and_b32 v49, 0xffff0000, v180
v_lshlrev_b32 v50, 16, v181
v_and_b32 v51, 0xffff0000, v181
v_lshlrev_b32 v52, 16, v182
v_and_b32 v53, 0xffff0000, v182
v_lshlrev_b32 v54, 16, v183
v_and_b32 v55, 0xffff0000, v183
v_pk_add_f32 v[32:33], v[32:33], v[48:49]
v_pk_add_f32 v[34:35], v[34:35], v[50:51]
v_pk_add_f32 v[36:37], v[36:37], v[52:53]
v_pk_add_f32 v[38:39], v[38:39], v[54:55]
v_lshlrev_b32 v40, 16, v184
v_and_b32 v41, 0xffff0000, v184
v_lshlrev_b32 v42, 16, v185
v_and_b32 v43, 0xffff0000, v185
v_lshlrev_b32 v44, 16, v186
v_and_b32 v45, 0xffff0000, v186
v_lshlrev_b32 v46, 16, v187
v_and_b32 v47, 0xffff0000, v187
v_pk_add_f32 v[32:33], v[32:33], v[40:41]
v_pk_add_f32 v[34:35], v[34:35], v[42:43]
v_pk_add_f32 v[36:37], v[36:37], v[44:45]
v_pk_add_f32 v[38:39], v[38:39], v[46:47]
v_lshlrev_b32 v48, 16, v188
v_and_b32 v49, 0xffff0000, v188
v_lshlrev_b32 v50, 16, v189
v_and_b32 v51, 0xffff0000, v189
v_lshlrev_b32 v52, 16, v190
v_and_b32 v53, 0xffff0000, v190
v_lshlrev_b32 v54, 16, v191
v_and_b32 v55, 0xffff0000, v191
v_pk_add_f32 v[32:33], v[32:33], v[48:49]
v_pk_add_f32 v[34:35], v[34:35], v[50:51]
v_pk_add_f32 v[36:37], v[36:37], v[52:53]
v_pk_add_f32 v[38:39], v[38:39], v[54:55]
s_barrier
v_lshlrev_b32 v40, 16, v192
v_and_b32 v41, 0xffff0000, v192
v_lshlrev_b32 v42, 16, v193
v_and_b32 v43, 0xffff0000, v193
v_lshlrev_b32 v44, 16, v194
v_and_b32 v45, 0xffff0000, v194
v_lshlrev_b32 v46, 16, v195
v_and_b32 v47, 0xffff0000, v195
v_pk_add_f32 v[32:33], v[32:33], v[40:41]
v_pk_add_f32 v[34:35], v[34:35], v[42:43]
v_pk_add_f32 v[36:37], v[36:37], v[44:45]
v_pk_add_f32 v[38:39], v[38:39], v[46:47]
v_lshlrev_b32 v48, 16, v196
v_and_b32 v49, 0xffff0000, v196
v_lshlrev_b32 v50, 16, v197
v_and_b32 v51, 0xffff0000, v197
v_lshlrev_b32 v52, 16, v198
v_and_b32 v53, 0xffff0000, v198
v_lshlrev_b32 v54, 16, v199
v_and_b32 v55, 0xffff0000, v199
v_pk_add_f32 v[32:33], v[32:33], v[48:49]
v_pk_add_f32 v[34:35], v[34:35], v[50:51]
v_pk_add_f32 v[36:37], v[36:37], v[52:53]
v_pk_add_f32 v[38:39], v[38:39], v[54:55]
v_lshlrev_b32 v40, 16, v200
v_and_b32 v41, 0xffff0000, v200
v_lshlrev_b32 v42, 16, v201
v_and_b32 v43, 0xffff0000, v201
v_lshlrev_b32 v44, 16, v202
v_and_b32 v45, 0xffff0000, v202
v_lshlrev_b32 v46, 16, v203
v_and_b32 v47, 0xffff0000, v203
v_pk_add_f32 v[32:33], v[32:33], v[40:41]
v_pk_add_f32 v[34:35], v[34:35], v[42:43]
v_pk_add_f32 v[36:37], v[36:37], v[44:45]
v_pk_add_f32 v[38:39], v[38:39], v[46:47]
v_lshlrev_b32 v48, 16, v204
v_and_b32 v49, 0xffff0000, v204
v_lshlrev_b32 v50, 16, v205
v_and_b32 v51, 0xffff0000, v205
v_lshlrev_b32 v52, 16, v206
v_and_b32 v53, 0xffff0000, v206
v_lshlrev_b32 v54, 16, v207
v_and_b32 v55, 0xffff0000, v207
v_pk_add_f32 v[32:33], v[32:33], v[48:49]
v_pk_add_f32 v[34:35], v[34:35], v[50:51]
v_pk_add_f32 v[36:37], v[36:37], v[52:53]
v_pk_add_f32 v[38:39], v[38:39], v[54:55]
s_barrier
v_lshlrev_b32 v40, 16, v208
v_and_b32 v41, 0xffff0000, v208
v_lshlrev_b32 v42, 16, v209
v_and_b32 v43, 0xffff0000, v209
v_lshlrev_b32 v44, 16, v210
v_and_b32 v45, 0xffff0000, v210
v_lshlrev_b32 v46, 16, v211
v_and_b32 v47, 0xffff0000, v211
v_pk_add_f32 v[32:33], v[32:33], v[40:41]
v_pk_add_f32 v[34:35], v[34:35], v[42:43]
v_pk_add_f32 v[36:37], v[36:37], v[44:45]
v_pk_add_f32 v[38:39], v[38:39], v[46:47]
v_lshlrev_b32 v48, 16, v212
v_and_b32 v49, 0xffff0000, v212
v_lshlrev_b32 v50, 16, v213
v_and_b32 v51, 0xffff0000, v213
v_lshlrev_b32 v52, 16, v214
v_and_b32 v53, 0xffff0000, v214
v_lshlrev_b32 v54, 16, v215
v_and_b32 v55, 0xffff0000, v215
v_pk_add_f32 v[32:33], v[32:33], v[48:49]
v_pk_add_f32 v[34:35], v[34:35], v[50:51]
v_pk_add_f32 v[36:37], v[36:37], v[52:53]
v_pk_add_f32 v[38:39], v[38:39], v[54:55]
v_lshlrev_b32 v40, 16, v216
v_and_b32 v41, 0xffff0000, v216
v_lshlrev_b32 v42, 16, v217
v_and_b32 v43, 0xffff0000, v217
v_lshlrev_b32 v44, 16, v218
v_and_b32 v45, 0xffff0000, v218
v_lshlrev_b32 v46, 16, v219
v_and_b32 v47, 0xffff0000, v219
v_pk_add_f32 v[32:33], v[32:33], v[40:41]
v_pk_add_f32 v[34:35], v[34:35], v[42:43]
v_pk_add_f32 v[36:37], v[36:37], v[44:45]
v_pk_add_f32 v[38:39], v[38:39], v[46:47]
v_lshlrev_b32 v48, 16, v220
v_and_b32 v49, 0xffff0000, v220
v_lshlrev_b32 v50, 16, v221
v_and_b32 v51, 0xffff0000, v221
v_lshlrev_b32 v52, 16, v222
v_and_b32 v53, 0xffff0000, v222
v_lshlrev_b32 v54, 16, v223
v_and_b32 v55, 0xffff0000, v223
v_pk_add_f32 v[32:33], v[32:33], v[48:49]
v_pk_add_f32 v[34:35], v[34:35], v[50:51]
v_pk_add_f32 v[36:37], v[36:37], v[52:53]
v_pk_add_f32 v[38:39], v[38:39], v[54:55]
s_barrier
v_lshlrev_b32 v40, 16, v224
v_and_b32 v41, 0xffff0000, v224
v_lshlrev_b32 v42, 16, v225
v_and_b32 v43, 0xffff0000, v225
v_lshlrev_b32 v44, 16, v226
v_and_b32 v45, 0xffff0000, v226
v_lshlrev_b32 v46, 16, v227
v_and_b32 v47, 0xffff0000, v227
v_pk_add_f32 v[32:33], v[32:33], v[40:41]
v_pk_add_f32 v[34:35], v[34:35], v[42:43]
v_pk_add_f32 v[36:37], v[36:37], v[44:45]
v_pk_add_f32 v[38:39], v[38:39], v[46:47]
v_lshlrev_b32 v48, 16, v228
v_and_b32 v49, 0xffff0000, v228
v_lshlrev_b32 v50, 16, v229
v_and_b32 v51, 0xffff0000, v229
v_lshlrev_b32 v52, 16, v230
v_and_b32 v53, 0xffff0000, v230
v_lshlrev_b32 v54, 16, v231
v_and_b32 v55, 0xffff0000, v231
v_pk_add_f32 v[32:33], v[32:33], v[48:49]
v_pk_add_f32 v[34:35], v[34:35], v[50:51]
v_pk_add_f32 v[36:37], v[36:37], v[52:53]
v_pk_add_f32 v[38:39], v[38:39], v[54:55]
v_lshlrev_b32 v40, 16, v232
v_and_b32 v41, 0xffff0000, v232
v_lshlrev_b32 v42, 16, v233
v_and_b32 v43, 0xffff0000, v233
v_lshlrev_b32 v44, 16, v234
v_and_b32 v45, 0xffff0000, v234
v_lshlrev_b32 v46, 16, v235
v_and_b32 v47, 0xffff0000, v235
v_pk_add_f32 v[32:33], v[32:33], v[40:41]
v_pk_add_f32 v[34:35], v[34:35], v[42:43]
v_pk_add_f32 v[36:37], v[36:37], v[44:45]
v_pk_add_f32 v[38:39], v[38:39], v[46:47]
v_lshlrev_b32 v48, 16, v236
v_and_b32 v49, 0xffff0000, v236
v_lshlrev_b32 v50, 16, v237
v_and_b32 v51, 0xffff0000, v237
v_lshlrev_b32 v52, 16, v238
v_and_b32 v53, 0xffff0000, v238
v_lshlrev_b32 v54, 16, v239
v_and_b32 v55, 0xffff0000, v239
v_pk_add_f32 v[32:33], v[32:33], v[48:49]
v_pk_add_f32 v[34:35], v[34:35], v[50:51]
v_pk_add_f32 v[36:37], v[36:37], v[52:53]
v_pk_add_f32 v[38:39], v[38:39], v[54:55]
s_barrier
v_lshlrev_b32 v40, 16, v240
v_and_b32 v41, 0xffff0000, v240
v_lshlrev_b32 v42, 16, v241
v_and_b32 v43, 0xffff0000, v241
v_lshlrev_b32 v44, 16, v242
v_and_b32 v45, 0xffff0000, v242
v_lshlrev_b32 v46, 16, v243
v_and_b32 v47, 0xffff0000, v243
v_pk_add_f32 v[32:33], v[32:33], v[40:41]
v_pk_add_f32 v[34:35], v[34:35], v[42:43]
v_pk_add_f32 v[36:37], v[36:37], v[44:45]
v_pk_add_f32 v[38:39], v[38:39], v[46:47]
v_lshlrev_b32 v48, 16, v244
v_and_b32 v49, 0xffff0000, v244
v_lshlrev_b32 v50, 16, v245
v_and_b32 v51, 0xffff0000, v245
v_lshlrev_b32 v52, 16, v246
v_and_b32 v53, 0xffff0000, v246
v_lshlrev_b32 v54, 16, v247
v_and_b32 v55, 0xffff0000, v247
v_pk_add_f32 v[32:33], v[32:33], v[48:49]
v_pk_add_f32 v[34:35], v[34:35], v[50:51]
v_pk_add_f32 v[36:37], v[36:37], v[52:53]
v_pk_add_f32 v[38:39], v[38:39], v[54:55]
v_lshlrev_b32 v40, 16, v248
v_and_b32 v41, 0xffff0000, v248
v_lshlrev_b32 v42, 16, v249
v_and_b32 v43, 0xffff0000, v249
v_lshlrev_b32 v44, 16, v250
v_and_b32 v45, 0xffff0000, v250
v_lshlrev_b32 v46, 16, v251
v_and_b32 v47, 0xffff0000, v251
v_pk_add_f32 v[32:33], v[32:33], v[40:41]
v_pk_add_f32 v[34:35], v[34:35], v[42:43]
v_pk_add_f32 v[36:37], v[36:37], v[44:45]
v_pk_add_f32 v[38:39], v[38:39], v[46:47]
v_lshlrev_b32 v48, 16, v252
v_and_b32 v49, 0xffff0000, v252
v_lshlrev_b32 v50, 16, v253
v_and_b32 v51, 0xffff0000, v253
v_lshlrev_b32 v52, 16, v254
v_and_b32 v53, 0xffff0000, v254
v_lshlrev_b32 v54, 16, v255
v_and_b32 v55, 0xffff0000, v255
v_pk_add_f32 v[32:33], v[32:33], v[48:49]
v_pk_add_f32 v[34:35], v[34:35], v[50:51]
v_pk_add_f32 v[36:37], v[36:37], v[52:53]
v_pk_add_f32 v[38:39], v[38:39], v[54:55]
s_barrier
s_nop 2
v_mov_b32 v40, v32
v_mov_b32 v41, v33
v_mov_b32 v42, v34
v_mov_b32 v43, v35
v_mov_b32 v44, v36
v_mov_b32 v45, v37
v_mov_b32 v46, v38
v_mov_b32 v47, v39
s_nop 0
v_permlane16_swap_b32 v32, v40
v_permlane16_swap_b32 v33, v41
v_permlane16_swap_b32 v34, v42
v_permlane16_swap_b32 v35, v43
v_permlane16_swap_b32 v36, v44
v_permlane16_swap_b32 v37, v45
v_permlane16_swap_b32 v38, v46
v_permlane16_swap_b32 v39, v47
v_add_f32 v32, v32, v40
v_add_f32 v33, v33, v41
v_add_f32 v34, v34, v42
v_add_f32 v35, v35, v43
v_add_f32 v36, v36, v44
v_add_f32 v37, v37, v45
v_add_f32 v38, v38, v46
v_add_f32 v39, v39, v47
v_mov_b32 v40, v32
v_mov_b32 v41, v33
v_mov_b32 v42, v34
v_mov_b32 v43, v35
v_mov_b32 v44, v36
v_mov_b32 v45, v37
v_mov_b32 v46, v38
v_mov_b32 v47, v39
s_nop 0
v_permlane32_swap_b32 v32, v40
v_permlane32_swap_b32 v33, v41
v_permlane32_swap_b32 v34, v42
v_permlane32_swap_b32 v35, v43
v_permlane32_swap_b32 v36, v44
v_permlane32_swap_b32 v37, v45
v_permlane32_swap_b32 v38, v46
v_permlane32_swap_b32 v39, v47
v_add_f32 v32, v32, v40
v_add_f32 v33, v33, v41
v_add_f32 v34, v34, v42
v_add_f32 v35, v35, v43
v_add_f32 v36, v36, v44
v_add_f32 v37, v37, v45
v_add_f32 v38, v38, v46
v_add_f32 v39, v39, v47
s_mov_b64 exec, 0xffff
buffer_store_dwordx4 v[32:35], v5, s[72:75], 0 offen sc1
buffer_store_dwordx4 v[36:39], v5, s[72:75], 0 offen offset:16 sc1
s_mov_b64 exec, -1
s_barrier
s_barrier
s_barrier
s_barrier
s_barrier
s_waitcnt vmcnt(0)
s_add_u32 s43, s50, 96
s_lshl_b32 s43, s43, 7
v_mov_b32 v12, s43
v_mov_b32 v13, 1
s_mov_b64 exec, 1
buffer_atomic_add v13, v12, s[56:59], 0 offen sc1
s_mov_b64 exec, -1
s_branch Lcsd_48
Lnojob_47:
s_lshl_b32 s43, s34, 18
s_add_u32 s12, s32, s43
s_addc_u32 s13, s33, 0
s_mov_b32 s14, 262144
s_mov_b32 s15, 0x20000
v_lshlrev_b32 v21, 4, v1
s_lshl_b32 s54, s36, 11
s_barrier
s_add_u32 m0, s54, 0
s_add_u32 s43, s54, 0
buffer_load_dwordx4 v21, s[12:15], s43 offen sc1 lds
s_add_u32 m0, s54, 1024
s_add_u32 s43, s54, 1024
buffer_load_dwordx4 v21, s[12:15], s43 offen sc1 lds
s_add_u32 m0, s54, 24576
s_add_u32 s43, s54, 16384
buffer_load_dwordx4 v21, s[12:15], s43 offen sc1 lds
s_add_u32 m0, s54, 25600
s_add_u32 s43, s54, 17408
buffer_load_dwordx4 v21, s[12:15], s43 offen sc1 lds
s_waitcnt vmcnt(2)
s_barrier
s_waitcnt vmcnt(0)
s_barrier
s_barrier
s_barrier
s_barrier
s_barrier
s_barrier
s_barrier
s_barrier
s_barrier
s_barrier
s_barrier
s_barrier
s_barrier
s_barrier
s_barrier
s_barrier
s_barrier
Lcsd_48:
s_mov_b32 s46, 1
s_lshl_b32 s43, s34, 18
s_add_u32 s12, s32, s43
s_addc_u32 s13, s33, 0
s_add_u32 s12, s12, 4194304
s_addc_u32 s13, s13, 0
s_mov_b32 s14, 262144
s_mov_b32 s15, 0x20000
v_lshlrev_b32 v21, 4, v1
s_lshl_b32 s54, s36, 11
s_add_u32 s43, s35, 1
s_and_b32 s43, s43, 15
s_lshl_b32 s43, s43, 14
s_add_u32 s30, s43, s54
s_add_u32 s43, s35, 2
s_and_b32 s43, s43, 15
s_lshl_b32 s43, s43, 14
s_add_u32 s31, s43, s54
s_mov_b32 s88, s4
s_mov_b32 s89, s5
s_mov_b32 s90, 7340032
s_mov_b32 s91, 0x20000
s_mov_b32 s92, s6
s_mov_b32 s93, s7
s_mov_b32 s94, 7340032
s_mov_b32 s95, 0x20000
s_lshr_b32 s43, s35, 3
v_and_b32 v19, 1, v1
v_bfe_u32 v23, v1, 2, 3
s_lshl_b32 s44, s43, 3
s_add_u32 s44, s44, 1
v_lshl_add_u32 v23, v19, 2, v23
v_add_u32 v23, s44, v23
s_lshl_b32 s43, s43, 11
s_add_u32 s43, s43, 384
s_movk_i32 s44, 1024
s_lshr_b32 s45, s2, 3
s_mul_i32 s45, s45, 14336
s_add_u32 s43, s43, s45
v_mul_lo_u32 v31, v19, s44
v_bfe_u32 v19, v1, 1, 1
v_mul_u32_u24 v19, 7168, v19
v_add3_u32 v31, v31, v19, s43
v_add_u32 v19, 3, v23
v_and_b32 v19, 15, v19
v_mul_u32_u24 v19, 458752, v19
v_add_u32 v19, v19, v31
buffer_load_dword v30, v19, s[88:91], 0 offen
buffer_load_dword v30, v19, s[92:95], 0 offen
s_lshl_b32 s43, s34, 14
s_add_u32 s64, s32, s43
s_addc_u32 s65, s33, 0
s_add_u32 s64, s64, 25165824
s_addc_u32 s65, s65, 0
s_mov_b32 s66, 16384
s_mov_b32 s67, 0x20000
s_add_u32 s72, s32, 27262976
s_addc_u32 s73, s33, 0
s_mov_b32 s74, 114688
s_mov_b32 s75, 0x20000
s_barrier
s_add_u32 m0, s54, 0
s_add_u32 s43, s30, 0
buffer_load_dwordx4 v21, s[12:15], s43 offen sc1 lds
s_add_u32 m0, s54, 1024
s_add_u32 s43, s30, 1024
buffer_load_dwordx4 v21, s[12:15], s43 offen sc1 lds
s_add_u32 m0, s54, 49152
s_add_u32 s43, s31, 0
buffer_load_dwordx4 v21, s[12:15], s43 offen sc1 lds
s_add_u32 m0, s54, 50176
s_add_u32 s43, s31, 1024
buffer_load_dwordx4 v21, s[12:15], s43 offen sc1 lds
s_waitcnt vmcnt(2)
s_barrier
s_waitcnt vmcnt(0)
s_mul_i32 s43, s2, 28672
s_mul_i32 s44, s51, 7168
s_add_u32 s43, s43, s44
s_add_u32 s80, s60, s43
s_addc_u32 s81, s61, 0
s_load_dword s82, s[80:81], 0
s_load_dword s83, s[80:81], 64
s_load_dword s84, s[80:81], 128
s_load_dword s85, s[80:81], 192
s_load_dword s86, s[80:81], 256
s_load_dword s87, s[80:81], 320
s_load_dword s82, s[80:81], 384
s_load_dword s83, s[80:81], 448
s_load_dword s84, s[80:81], 512
s_load_dword s85, s[80:81], 576
s_load_dword s86, s[80:81], 640
s_add_u32 s80, s80, 704
s_addc_u32 s81, s81, 0
s_barrier
s_mov_b32 s43, 0
buffer_load_dwordx4 v[128:131], v21, s[64:67], s43 offen sc1
s_mov_b32 s43, 1024
buffer_load_dwordx4 v[132:135], v21, s[64:67], s43 offen sc1
s_mov_b32 s43, 2048
buffer_load_dwordx4 v[136:139], v21, s[64:67], s43 offen sc1
s_mov_b32 s43, 3072
buffer_load_dwordx4 v[140:143], v21, s[64:67], s43 offen sc1
s_mov_b32 s43, 4096
buffer_load_dwordx4 v[144:147], v21, s[64:67], s43 offen sc1
s_mov_b32 s43, 5120
buffer_load_dwordx4 v[148:151], v21, s[64:67], s43 offen sc1
s_mov_b32 s43, 6144
buffer_load_dwordx4 v[152:155], v21, s[64:67], s43 offen sc1
s_mov_b32 s43, 7168
buffer_load_dwordx4 v[156:159], v21, s[64:67], s43 offen sc1
s_mov_b32 s43, 8192
buffer_load_dwordx4 v[160:163], v21, s[64:67], s43 offen sc1
s_mov_b32 s43, 9216
buffer_load_dwordx4 v[164:167], v21, s[64:67], s43 offen sc1
s_mov_b32 s43, 10240
buffer_load_dwordx4 v[168:171], v21, s[64:67], s43 offen sc1
s_mov_b32 s43, 11264
buffer_load_dwordx4 v[172:175], v21, s[64:67], s43 offen sc1
s_mov_b32 s43, 12288
buffer_load_dwordx4 v[176:179], v21, s[64:67], s43 offen sc1
s_mov_b32 s43, 13312
buffer_load_dwordx4 v[180:183], v21, s[64:67], s43 offen sc1
s_mov_b32 s43, 14336
buffer_load_dwordx4 v[184:187], v21, s[64:67], s43 offen sc1
s_mov_b32 s43, 15360
buffer_load_dwordx4 v[188:191], v21, s[64:67], s43 offen sc1
s_load_dword s82, s[80:81], 0
s_load_dword s83, s[80:81], 64
s_load_dword s84, s[80:81], 128
s_load_dword s85, s[80:81], 192
s_load_dword s86, s[80:81], 256
s_load_dword s87, s[80:81], 320
s_load_dword s82, s[80:81], 384
s_load_dword s83, s[80:81], 448
s_load_dword s84, s[80:81], 512
s_load_dword s85, s[80:81], 576
s_load_dword s86, s[80:81], 640
s_add_u32 s80, s80, 704
s_addc_u32 s81, s81, 0
s_barrier
s_mul_i32 s43, s35, 96
s_add_u32 s44, s43, 95
s_lshr_b32 s43, s43, 7
s_lshr_b32 s44, s44, 7
s_add_u32 s43, s43, 16
s_add_u32 s44, s44, 16
v_mov_b32 v12, s44
v_writelane_b32 v12, s35, 0
v_writelane_b32 v12, s43, 1
v_add_u32 v12, 96, v12
v_lshlrev_b32 v12, 7, v12
v_mov_b32 v14, 8
buffer_load_dword v13, v12, s[56:59], 0 offen sc1
s_load_dword s82, s[80:81], 0
s_load_dword s83, s[80:81], 64
s_load_dword s84, s[80:81], 128
s_load_dword s85, s[80:81], 192
s_load_dword s86, s[80:81], 256
s_load_dword s87, s[80:81], 320
s_load_dword s82, s[80:81], 384
s_load_dword s83, s[80:81], 448
s_load_dword s84, s[80:81], 512
s_load_dword s85, s[80:81], 576
s_load_dword s86, s[80:81], 640
s_add_u32 s80, s80, 704
s_addc_u32 s81, s81, 0
s_barrier
s_load_dword s82, s[80:81], 0
s_load_dword s83, s[80:81], 64
s_load_dword s84, s[80:81], 128
s_load_dword s85, s[80:81], 192
s_load_dword s86, s[80:81], 256
s_load_dword s87, s[80:81], 320
s_load_dword s82, s[80:81], 384
s_load_dword s83, s[80:81], 448
s_load_dword s84, s[80:81], 512
s_load_dword s85, s[80:81], 576
s_load_dword s86, s[80:81], 640
s_add_u32 s80, s80, 704
s_addc_u32 s81, s81, 0
s_barrier
s_mov_b32 s41, 0x10000
Lpoll_49:
s_waitcnt vmcnt(0)
Lpf_51:
v_cmp_ne_u32 vcc, v14, v13
s_nop 4
s_cbranch_vccz Lpok_50
buffer_load_dword v13, v12, s[56:59], 0 offen sc1
s_sub_u32 s41, s41, 1
s_cmp_lg_u32 s41, 0
s_cbranch_scc1 Lpoll_49
s_waitcnt vmcnt(0)
Lpok_50:
v_min_u32 v12, 55, v1
v_lshlrev_b32 v13, 4, v12
s_lshl_b32 s43, s35, 9
s_mul_i32 s44, s35, 384
s_add_u32 s44, s44, 7680
v_mov_b32 v14, s44
v_mov_b32 v15, s43
v_cmp_gt_u32 vcc, 32, v12
s_nop 1
v_cndmask_b32 v14, v14, v15, vcc
v_add_u32 v14, v14, v13
v_add_u32 v13, 148480, v13
s_mov_b32 s43, 0
buffer_load_dwordx4 v[192:195], v14, s[72:75], s43 offen sc1
s_mov_b32 s43, 28672
buffer_load_dwordx4 v[196:199], v14, s[72:75], s43 offen sc1
s_mov_b32 s43, 57344
buffer_load_dwordx4 v[200:203], v14, s[72:75], s43 offen sc1
s_mov_b32 s43, 86016
buffer_load_dwordx4 v[204:207], v14, s[72:75], s43 offen sc1
s_mov_b32 s43, 14336
buffer_load_dwordx4 v[208:211], v14, s[72:75], s43 offen sc1
s_mov_b32 s43, 43008
buffer_load_dwordx4 v[212:215], v14, s[72:75], s43 offen sc1
s_mov_b32 s43, 71680
buffer_load_dwordx4 v[216:219], v14, s[72:75], s43 offen sc1
s_mov_b32 s43, 100352
buffer_load_dwordx4 v[220:223], v14, s[72:75], s43 offen sc1
s_load_dword s82, s[80:81], 0
s_load_dword s83, s[80:81], 64
s_load_dword s84, s[80:81], 128
s_load_dword s85, s[80:81], 192
s_load_dword s86, s[80:81], 256
s_load_dword s87, s[80:81], 320
s_load_dword s82, s[80:81], 384
s_load_dword s83, s[80:81], 448
s_load_dword s84, s[80:81], 512
s_load_dword s85, s[80:81], 576
s_load_dword s86, s[80:81], 640
s_add_u32 s80, s80, 704
s_addc_u32 s81, s81, 0
s_barrier
v_add_u32 v19, 8, v23
v_and_b32 v19, 15, v19
v_mul_u32_u24 v19, 458752, v19
v_add_u32 v19, v19, v31
buffer_load_dword v30, v19, s[88:91], 0 offen
buffer_load_dword v30, v19, s[92:95], 0 offen
v_add_f32 v128, v128, v132
v_add_f32 v129, v129, v133
v_add_f32 v130, v130, v134
v_add_f32 v131, v131, v135
v_add_f32 v128, v128, v136
v_add_f32 v129, v129, v137
v_add_f32 v130, v130, v138
v_add_f32 v131, v131, v139
v_add_f32 v128, v128, v140
v_add_f32 v129, v129, v141
v_add_f32 v130, v130, v142
v_add_f32 v131, v131, v143
v_add_f32 v128, v128, v144
v_add_f32 v129, v129, v145
v_add_f32 v130, v130, v146
v_add_f32 v131, v131, v147
v_add_f32 v128, v128, v148
v_add_f32 v129, v129, v149
v_add_f32 v130, v130, v150
v_add_f32 v131, v131, v151
v_add_f32 v128, v128, v152
v_add_f32 v129, v129, v153
v_add_f32 v130, v130, v154
v_add_f32 v131, v131, v155
v_add_f32 v128, v128, v156
v_add_f32 v129, v129, v157
v_add_f32 v130, v130, v158
v_add_f32 v131, v131, v159
v_add_f32 v128, v128, v160
v_add_f32 v129, v129, v161
v_add_f32 v130, v130, v162
v_add_f32 v131, v131, v163
v_add_f32 v128, v128, v164
v_add_f32 v129, v129, v165
v_add_f32 v130, v130, v166
v_add_f32 v131, v131, v167
v_add_f32 v128, v128, v168
v_add_f32 v129, v129, v169
v_add_f32 v130, v130, v170
v_add_f32 v131, v131, v171
v_add_f32 v128, v128, v172
v_add_f32 v129, v129, v173
v_add_f32 v130, v130, v174
v_add_f32 v131, v131, v175
v_add_f32 v128, v128, v176
v_add_f32 v129, v129, v177
v_add_f32 v130, v130, v178
v_add_f32 v131, v131, v179
v_add_f32 v128, v128, v180
v_add_f32 v129, v129, v181
v_add_f32 v130, v130, v182
v_add_f32 v131, v131, v183
v_add_f32 v128, v128, v184
v_add_f32 v129, v129, v185
v_add_f32 v130, v130, v186
v_add_f32 v131, v131, v187
v_add_f32 v128, v128, v188
v_add_f32 v129, v129, v189
v_add_f32 v130, v130, v190
v_add_f32 v131, v131, v191
v_mul_f32 v128, 0x3a800000, v128
v_mul_f32 v129, 0x3a800000, v129
v_fma_f32 v129, -v128, v128, v129
v_max_f32 v129, 0, v129
v_add_f32 v129, 0x3727c5ac, v129
v_rsq_f32 v129, v129
v_mul_f32 v130, 0x3a800000, v130
v_mul_f32 v131, 0x3a800000, v131
v_fma_f32 v131, -v130, v130, v131
v_max_f32 v131, 0, v131
v_add_f32 v131, 0x3727c5ac, v131
v_rsq_f32 v131, v131
v_add_u32 v19, 147456, v21
ds_write_b128 v19, v[128:131]
s_load_dword s82, s[80:81], 0
s_load_dword s83, s[80:81], 64
s_load_dword s84, s[80:81], 128
s_load_dword s85, s[80:81], 192
s_load_dword s86, s[80:81], 256
s_load_dword s87, s[80:81], 320
s_load_dword s82, s[80:81], 384
s_load_dword s83, s[80:81], 448
s_load_dword s84, s[80:81], 512
s_load_dword s85, s[80:81], 576
s_load_dword s86, s[80:81], 640
s_add_u32 s80, s80, 704
s_addc_u32 s81, s81, 0
s_barrier
s_barrier
s_waitcnt vmcnt(0)
v_add_f32 v192, v192, v196
v_add_f32 v200, v200, v204
v_add_f32 v193, v193, v197
v_add_f32 v201, v201, v205
v_add_f32 v194, v194, v198
v_add_f32 v202, v202, v206
v_add_f32 v195, v195, v199
v_add_f32 v203, v203, v207
v_add_f32 v192, v192, v200
v_add_f32 v193, v193, v201
v_add_f32 v194, v194, v202
v_add_f32 v195, v195, v203
ds_write_b128 v13, v[192:195] offset:0
v_add_f32 v208, v208, v212
v_add_f32 v216, v216, v220
v_add_f32 v209, v209, v213
v_add_f32 v217, v217, v221
v_add_f32 v210, v210, v214
v_add_f32 v218, v218, v222
v_add_f32 v211, v211, v215
v_add_f32 v219, v219, v223
v_add_f32 v208, v208, v216
v_add_f32 v209, v209, v217
v_add_f32 v210, v210, v218
v_add_f32 v211, v211, v219
ds_write_b128 v13, v[208:211] offset:896
s_waitcnt lgkmcnt(0)
s_load_dword s82, s[80:81], 0
s_load_dword s83, s[80:81], 64
s_load_dword s84, s[80:81], 128
s_load_dword s85, s[80:81], 192
s_load_dword s86, s[80:81], 256
s_load_dword s87, s[80:81], 320
s_load_dword s82, s[80:81], 384
s_load_dword s83, s[80:81], 448
s_load_dword s84, s[80:81], 512
s_load_dword s85, s[80:81], 576
s_load_dword s86, s[80:81], 640
s_add_u32 s80, s80, 704
s_addc_u32 s81, s81, 0
s_barrier
s_load_dword s82, s[80:81], 0
s_load_dword s83, s[80:81], 64
s_load_dword s84, s[80:81], 128
s_load_dword s85, s[80:81], 192
s_load_dword s86, s[80:81], 256
s_load_dword s87, s[80:81], 320
s_load_dword s82, s[80:81], 384
s_load_dword s83, s[80:81], 448
s_load_dword s84, s[80:81], 512
s_load_dword s85, s[80:81], 576
s_load_dword s86, s[80:81], 640
s_add_u32 s80, s80, 704
s_addc_u32 s81, s81, 0
s_barrier
s_and_b32 s53, s35, 1
s_lshl_b32 s53, s53, 1
s_mul_i32 s43, s47, 3
s_add_u32 s53, s53, s43
v_lshlrev_b32 v19, 11, v18
v_lshl_add_u32 v19, v17, 4, v19
s_lshl_b32 s43, s46, 10
v_add_u32 v2, s43, v19
v_add_u32 v3, 49152, v2
v_add_u32 v4, 98304, v2
v_lshrrev_b32 v19, 2, v17
v_lshl_add_u32 v20, v18, 2, v19
v_and_b32 v21, 7, v20
v_lshlrev_b32 v20, 8, v20
v_and_b32 v19, 3, v1
v_lshl_add_u32 v20, v19, 3, v20
s_add_u32 s43, s53, 0
v_xor_b32 v19, s43, v21
v_lshl_add_u32 v5, v19, 5, v20
s_add_u32 s43, s53, 1
v_xor_b32 v19, s43, v21
v_lshl_add_u32 v6, v19, 5, v20
s_add_u32 s43, s53, 2
v_xor_b32 v19, s43, v21
v_lshl_add_u32 v7, v19, 5, v20
v_add_u32 v9, 49152, v5
v_add_u32 v10, 49152, v6
v_add_u32 v11, 49152, v7
v_add_u32 v13, 98304, v5
v_add_u32 v14, 98304, v6
v_add_u32 v15, 98304, v7
s_lshl_b32 s43, s46, 9
s_add_u32 s43, s43, 147456
v_lshl_add_u32 v19, v17, 3, s43
ds_read_b64 v[80:81], v19 offset:0
ds_read_b64 v[82:83], v19 offset:128
ds_read_b64 v[84:85], v19 offset:256
ds_read_b64 v[86:87], v19 offset:384
s_mul_i32 s43, s47, 192
s_add_u32 s43, s43, 148992
v_lshl_add_u32 v19, v18, 4, s43
ds_read_b128 v[48:51], v19 offset:0
ds_read_b128 v[52:55], v19 offset:64
ds_read_b128 v[56:59], v19 offset:128
ds_read_b128 v[60:63], v19 offset:896
ds_read_b128 v[64:67], v19 offset:960
ds_read_b128 v[68:71], v19 offset:1024
s_barrier
s_mov_b32 s88, s4
s_mov_b32 s89, s5
s_mov_b32 s90, 7340032
s_mov_b32 s91, 0x20000
s_mov_b32 s92, s6
s_mov_b32 s93, s7
s_mov_b32 s94, 7340032
s_mov_b32 s95, 0x20000
s_lshr_b32 s43, s35, 3
v_and_b32 v19, 1, v1
v_bfe_u32 v23, v1, 2, 3
s_mul_i32 s44, s43, 10
s_add_u32 s44, s44, 2
v_add_u32 v23, s44, v23
s_lshl_b32 s44, s43, 2
s_sub_u32 s44, 5, s44
v_mad_u32_u24 v23, v19, s44, v23
s_lshl_b32 s44, s43, 10
s_xor_b32 s44, s44, 1024
s_lshl_b32 s43, s43, 11
s_add_u32 s43, s43, 4480
s_lshr_b32 s45, s2, 3
s_mul_i32 s45, s45, 14336
s_add_u32 s43, s43, s45
v_mul_lo_u32 v31, v19, s44
v_bfe_u32 v19, v1, 1, 1
v_mul_u32_u24 v19, 7168, v19
v_add3_u32 v31, v31, v19, s43
v_add_u32 v19, 0, v23
v_and_b32 v19, 15, v19
v_mul_u32_u24 v19, 458752, v19
v_add_u32 v19, v19, v31
buffer_load_dword v30, v19, s[88:91], 0 offen
buffer_load_dword v30, v19, s[92:95], 0 offen
s_waitcnt lgkmcnt(0)
v_mul_f32 v88, v81, v81
v_mul_f32 v228, 0xc0135761, v81
v_mul_f32 v89, 0xbdd2d3e8, v81
v_rcp_f32 v236, v88
v_mul_f32 v232, v89, v88
v_mul_f32 v88, v83, v83
v_mul_f32 v229, 0xc0135761, v83
v_mul_f32 v89, 0xbdd2d3e8, v83
v_rcp_f32 v237, v88
v_mul_f32 v233, v89, v88
v_mul_f32 v88, v85, v85
v_mul_f32 v230, 0xc0135761, v85
v_mul_f32 v89, 0xbdd2d3e8, v85
v_rcp_f32 v238, v88
v_mul_f32 v234, v89, v88
v_mul_f32 v88, v87, v87
v_mul_f32 v231, 0xc0135761, v87
v_mul_f32 v89, 0xbdd2d3e8, v87
v_rcp_f32 v239, v88
v_mul_f32 v235, v89, v88
s_mul_i32 s43, s34, 917504
s_mul_i32 s44, s35, 24576
s_add_u32 s43, s43, s44
s_add_u32 s43, s43, 8912896
s_add_u32 s24, s32, s43
s_addc_u32 s25, s33, 0
s_mov_b32 s26, 24576
s_mov_b32 s27, 0x20000
s_mov_b32 s53, 262144
s_lshl_b32 s43, s47, 13
s_lshl_b32 s44, s46, 10
s_add_u32 s43, s43, s44
v_lshlrev_b32 v19, 11, v18
v_lshl_add_u32 v19, v17, 4, v19
v_add_u32 v27, s43, v19
s_lshl_b32 s43, s47, 12
s_add_u32 s43, s43, s44
s_add_u32 s43, s43, 16384
v_and_b32 v19, 1, v18
v_lshlrev_b32 v19, 11, v19
v_lshrrev_b32 v20, 1, v18
v_lshl_add_u32 v19, v20, 8, v19
v_lshl_add_u32 v19, v17, 4, v19
v_add_u32 v28, s43, v19
s_load_dword s82, s[80:81], 0
s_load_dword s83, s[80:81], 64
s_load_dword s84, s[80:81], 128
s_load_dword s85, s[80:81], 192
s_load_dword s86, s[80:81], 256
s_load_dword s87, s[80:81], 320
s_load_dword s82, s[80:81], 384
s_load_dword s83, s[80:81], 448
s_add_u32 s80, s80, 512
s_addc_u32 s81, s81, 0
s_barrier
v_mul_f32 v128, -v80, v48
v_mul_f32 v129, -v80, v49
v_mul_f32 v130, -v80, v50
v_mul_f32 v131, -v80, v51
v_mul_f32 v132, -v82, v48
v_mul_f32 v133, -v82, v49
v_mul_f32 v134, -v82, v50
v_mul_f32 v135, -v82, v51
v_mul_f32 v136, -v84, v48
v_mul_f32 v137, -v84, v49
v_mul_f32 v138, -v84, v50
v_mul_f32 v139, -v84, v51
v_mul_f32 v140, -v86, v48
v_mul_f32 v141, -v86, v49
v_mul_f32 v142, -v86, v50
v_mul_f32 v143, -v86, v51
v_mul_f32 v144, -v80, v52
v_mul_f32 v145, -v80, v53
v_mul_f32 v146, -v80, v54
v_mul_f32 v147, -v80, v55
v_mul_f32 v148, -v82, v52
v_mul_f32 v149, -v82, v53
v_mul_f32 v150, -v82, v54
v_mul_f32 v151, -v82, v55
v_mul_f32 v152, -v84, v52
v_mul_f32 v153, -v84, v53
v_mul_f32 v154, -v84, v54
v_mul_f32 v155, -v84, v55
v_mul_f32 v156, -v86, v52
v_mul_f32 v157, -v86, v53
v_mul_f32 v158, -v86, v54
v_mul_f32 v159, -v86, v55
s_load_dword s82, s[80:81], 0
s_load_dword s83, s[80:81], 64
s_load_dword s84, s[80:81], 128
s_load_dword s85, s[80:81], 192
s_load_dword s86, s[80:81], 256
s_load_dword s87, s[80:81], 320
s_load_dword s82, s[80:81], 384
s_load_dword s83, s[80:81], 448
s_add_u32 s80, s80, 512
s_addc_u32 s81, s81, 0
s_barrier
v_mul_f32 v160, -v80, v56
v_mul_f32 v161, -v80, v57
v_mul_f32 v162, -v80, v58
v_mul_f32 v163, -v80, v59
v_mul_f32 v164, -v82, v56
v_mul_f32 v165, -v82, v57
v_mul_f32 v166, -v82, v58
v_mul_f32 v167, -v82, v59
v_mul_f32 v168, -v84, v56
v_mul_f32 v169, -v84, v57
v_mul_f32 v170, -v84, v58
v_mul_f32 v171, -v84, v59
v_mul_f32 v172, -v86, v56
v_mul_f32 v173, -v86, v57
v_mul_f32 v174, -v86, v58
v_mul_f32 v175, -v86, v59
v_mul_f32 v176, -v80, v60
v_mul_f32 v177, -v80, v61
v_mul_f32 v178, -v80, v62
v_mul_f32 v179, -v80, v63
v_mul_f32 v180, -v82, v60
v_mul_f32 v181, -v82, v61
v_mul_f32 v182, -v82, v62
v_mul_f32 v183, -v82, v63
v_mul_f32 v184, -v84, v60
v_mul_f32 v185, -v84, v61
v_mul_f32 v186, -v84, v62
v_mul_f32 v187, -v84, v63
v_mul_f32 v188, -v86, v60
v_mul_f32 v189, -v86, v61
v_mul_f32 v190, -v86, v62
v_mul_f32 v191, -v86, v63
s_load_dword s82, s[80:81], 0
s_load_dword s83, s[80:81], 64
s_load_dword s84, s[80:81], 128
s_load_dword s85, s[80:81], 192
s_load_dword s86, s[80:81], 256
s_load_dword s87, s[80:81], 320
s_load_dword s82, s[80:81], 384
s_load_dword s83, s[80:81], 448
s_add_u32 s80, s80, 512
s_addc_u32 s81, s81, 0
s_barrier
v_mul_f32 v192, -v80, v64
v_mul_f32 v193, -v80, v65
v_mul_f32 v194, -v80, v66
v_mul_f32 v195, -v80, v67
v_mul_f32 v196, -v82, v64
v_mul_f32 v197, -v82, v65
v_mul_f32 v198, -v82, v66
v_mul_f32 v199, -v82, v67
v_mul_f32 v200, -v84, v64
v_mul_f32 v201, -v84, v65
v_mul_f32 v202, -v84, v66
v_mul_f32 v203, -v84, v67
v_mul_f32 v204, -v86, v64
v_mul_f32 v205, -v86, v65
v_mul_f32 v206, -v86, v66
v_mul_f32 v207, -v86, v67
v_mul_f32 v208, -v80, v68
v_mul_f32 v209, -v80, v69
v_mul_f32 v210, -v80, v70
v_mul_f32 v211, -v80, v71
v_mul_f32 v212, -v82, v68
v_mul_f32 v213, -v82, v69
v_mul_f32 v214, -v82, v70
v_mul_f32 v215, -v82, v71
v_mul_f32 v216, -v84, v68
v_mul_f32 v217, -v84, v69
v_mul_f32 v218, -v84, v70
v_mul_f32 v219, -v84, v71
v_mul_f32 v220, -v86, v68
v_mul_f32 v221, -v86, v69
v_mul_f32 v222, -v86, v70
v_mul_f32 v223, -v86, v71
s_barrier
s_mul_i32 s44, s34, 917504
s_lshl_b32 s39, s51, 13
s_add_u32 s44, s44, s39
s_add_u32 s44, s44, 8388608
s_and_b32 s43, s51, 1
s_xor_b32 s43, s43, s35
s_lshl_b32 s43, s43, 7
s_mov_b32 s10, 909312
s_movk_i32 s38, 1024
s_movk_i32 s40, 9216
s_movk_i32 s37, 0x4000
s_cmp_ge_u32 s51, 2
s_cselect_b32 s8, s60, s32
s_cselect_b32 s9, s61, s33
s_cselect_b32 s10, 7338112, s10
s_cselect_b32 s43, s43, s44
s_cselect_b32 s38, 16384, s38
s_cselect_b32 s40, 81920, s40
s_cselect_b32 s55, 81920, s38
s_cselect_b32 s37, 262144, s37
s_cselect_b32 s45, -1, 0
s_add_u32 s8, s8, s43
s_addc_u32 s9, s9, 0
s_mov_b32 s11, 0x20000
s_and_b32 s53, s35, 1
s_mul_i32 s54, s53, 6
s_mul_i32 s54, s54, s37
s_mul_i32 s29, s53, 2
s_add_u32 s29, s29, 6
s_mul_i32 s29, s29, s37
s_and_b32 s43, s45, 4290838528
s_add_u32 s29, s29, s43
s_mul_i32 s37, s37, 2
s_sub_u32 s37, s37, s40
v_lshrrev_b32 v19, 3, v1
v_mul_u32_u24 v19, 1920, v19
v_lshrrev_b32 v20, 4, v1
v_lshlrev_b32 v20, 5, v20
v_and_b32 v19, s45, v19
v_and_b32 v20, s45, v20
v_lshlrev_b32 v21, 4, v1
v_xor_b32 v21, v21, v20
v_add_u32 v21, v21, v19
s_barrier
LK3b_35:
s_setprio 1
ds_read_b128 v[32:35], v2 offset:0
ds_read_b64_tr_b16 v[48:49], v5 offset:16384
ds_read_b64_tr_b16 v[50:51], v5 offset:20480
ds_read_b128 v[36:39], v2 offset:256
ds_read_b128 v[40:43], v2 offset:512
ds_read_b128 v[44:47], v2 offset:768
ds_read_b64_tr_b16 v[60:61], v5 offset:32768
ds_read_b64_tr_b16 v[62:63], v5 offset:36864
ds_read_b64_tr_b16 v[52:53], v6 offset:16384
ds_read_b64_tr_b16 v[54:55], v6 offset:20480
ds_read_b64_tr_b16 v[64:65], v6 offset:32768
ds_read_b64_tr_b16 v[66:67], v6 offset:36864
ds_read_b64_tr_b16 v[56:57], v7 offset:16384
ds_read_b64_tr_b16 v[58:59], v7 offset:20480
ds_read_b64_tr_b16 v[68:69], v7 offset:32768
ds_read_b64_tr_b16 v[70:71], v7 offset:36864
s_mov_b32 s41, 5
Lk3_52:
s_waitcnt lgkmcnt(0)
v_mfma_f32_16x16x32_bf16 v[128:131], v[48:51], v[32:35], v[128:131]
ds_read_b128 v[80:83], v2 offset:8192
v_mfma_f32_16x16x32_bf16 v[132:135], v[48:51], v[36:39], v[132:135]
ds_read_b64_tr_b16 v[96:97], v5 offset:24576
v_mfma_f32_16x16x32_bf16 v[136:139], v[48:51], v[40:43], v[136:139]
ds_read_b64_tr_b16 v[98:99], v5 offset:28672
v_mfma_f32_16x16x32_bf16 v[140:143], v[48:51], v[44:47], v[140:143]
ds_read_b128 v[84:87], v2 offset:8448
v_mfma_f32_16x16x32_bf16 v[188:191], v[60:63], v[44:47], v[188:191]
ds_read_b128 v[88:91], v2 offset:8704
v_mfma_f32_16x16x32_bf16 v[184:187], v[60:63], v[40:43], v[184:187]
ds_read_b128 v[92:95], v2 offset:8960
v_mfma_f32_16x16x32_bf16 v[180:183], v[60:63], v[36:39], v[180:183]
ds_read_b64_tr_b16 v[108:109], v5 offset:40960
v_mfma_f32_16x16x32_bf16 v[176:179], v[60:63], v[32:35], v[176:179]
ds_read_b64_tr_b16 v[110:111], v5 offset:45056
v_mfma_f32_16x16x32_bf16 v[144:147], v[52:55], v[32:35], v[144:147]
ds_read_b64_tr_b16 v[100:101], v6 offset:24576
v_mfma_f32_16x16x32_bf16 v[148:151], v[52:55], v[36:39], v[148:151]
ds_read_b64_tr_b16 v[102:103], v6 offset:28672
v_mfma_f32_16x16x32_bf16 v[152:155], v[52:55], v[40:43], v[152:155]
ds_read_b64_tr_b16 v[112:113], v6 offset:40960
v_mfma_f32_16x16x32_bf16 v[156:159], v[52:55], v[44:47], v[156:159]
ds_read_b64_tr_b16 v[114:115], v6 offset:45056
v_mfma_f32_16x16x32_bf16 v[204:207], v[64:67], v[44:47], v[204:207]
ds_read_b64_tr_b16 v[104:105], v7 offset:24576
v_mfma_f32_16x16x32_bf16 v[200:203], v[64:67], v[40:43], v[200:203]
ds_read_b64_tr_b16 v[106:107], v7 offset:28672
v_mfma_f32_16x16x32_bf16 v[196:199], v[64:67], v[36:39], v[196:199]
ds_read_b64_tr_b16 v[116:117], v7 offset:40960
v_mfma_f32_16x16x32_bf16 v[192:195], v[64:67], v[32:35], v[192:195]
ds_read_b64_tr_b16 v[118:119], v7 offset:45056
v_mfma_f32_16x16x32_bf16 v[160:163], v[56:59], v[32:35], v[160:163]
v_mfma_f32_16x16x32_bf16 v[164:167], v[56:59], v[36:39], v[164:167]
v_mfma_f32_16x16x32_bf16 v[168:171], v[56:59], v[40:43], v[168:171]
v_mfma_f32_16x16x32_bf16 v[172:175], v[56:59], v[44:47], v[172:175]
v_mfma_f32_16x16x32_bf16 v[220:223], v[68:71], v[44:47], v[220:223]
v_mfma_f32_16x16x32_bf16 v[216:219], v[68:71], v[40:43], v[216:219]
v_mfma_f32_16x16x32_bf16 v[212:215], v[68:71], v[36:39], v[212:215]
v_mfma_f32_16x16x32_bf16 v[208:211], v[68:71], v[32:35], v[208:211]
s_waitcnt vmcnt(0) lgkmcnt(0)
s_barrier
v_mfma_f32_16x16x32_bf16 v[128:131], v[96:99], v[80:83], v[128:131]
ds_read_b128 v[32:35], v3 offset:0
v_mfma_f32_16x16x32_bf16 v[132:135], v[96:99], v[84:87], v[132:135]
ds_read_b64_tr_b16 v[48:49], v9 offset:16384
v_mfma_f32_16x16x32_bf16 v[136:139], v[96:99], v[88:91], v[136:139]
ds_read_b64_tr_b16 v[50:51], v9 offset:20480
v_mfma_f32_16x16x32_bf16 v[140:143], v[96:99], v[92:95], v[140:143]
ds_read_b128 v[36:39], v3 offset:256
v_mfma_f32_16x16x32_bf16 v[188:191], v[108:111], v[92:95], v[188:191]
ds_read_b128 v[40:43], v3 offset:512
v_mfma_f32_16x16x32_bf16 v[184:187], v[108:111], v[88:91], v[184:187]
ds_read_b128 v[44:47], v3 offset:768
v_mfma_f32_16x16x32_bf16 v[180:183], v[108:111], v[84:87], v[180:183]
ds_read_b64_tr_b16 v[60:61], v9 offset:32768
v_mfma_f32_16x16x32_bf16 v[176:179], v[108:111], v[80:83], v[176:179]
ds_read_b64_tr_b16 v[62:63], v9 offset:36864
v_mfma_f32_16x16x32_bf16 v[144:147], v[100:103], v[80:83], v[144:147]
ds_read_b64_tr_b16 v[52:53], v10 offset:16384
v_mfma_f32_16x16x32_bf16 v[148:151], v[100:103], v[84:87], v[148:151]
ds_read_b64_tr_b16 v[54:55], v10 offset:20480
v_mfma_f32_16x16x32_bf16 v[152:155], v[100:103], v[88:91], v[152:155]
ds_read_b64_tr_b16 v[64:65], v10 offset:32768
v_mfma_f32_16x16x32_bf16 v[156:159], v[100:103], v[92:95], v[156:159]
ds_read_b64_tr_b16 v[66:67], v10 offset:36864
v_mfma_f32_16x16x32_bf16 v[204:207], v[112:115], v[92:95], v[204:207]
ds_read_b64_tr_b16 v[56:57], v11 offset:16384
v_mfma_f32_16x16x32_bf16 v[200:203], v[112:115], v[88:91], v[200:203]
ds_read_b64_tr_b16 v[58:59], v11 offset:20480
v_mfma_f32_16x16x32_bf16 v[196:199], v[112:115], v[84:87], v[196:199]
ds_read_b64_tr_b16 v[68:69], v11 offset:32768
v_mfma_f32_16x16x32_bf16 v[192:195], v[112:115], v[80:83], v[192:195]
ds_read_b64_tr_b16 v[70:71], v11 offset:36864
v_mfma_f32_16x16x32_bf16 v[160:163], v[104:107], v[80:83], v[160:163]
v_mfma_f32_16x16x32_bf16 v[164:167], v[104:107], v[84:87], v[164:167]
v_mfma_f32_16x16x32_bf16 v[168:171], v[104:107], v[88:91], v[168:171]
v_mfma_f32_16x16x32_bf16 v[172:175], v[104:107], v[92:95], v[172:175]
v_mfma_f32_16x16x32_bf16 v[220:223], v[116:119], v[92:95], v[220:223]
v_mfma_f32_16x16x32_bf16 v[216:219], v[116:119], v[88:91], v[216:219]
v_mfma_f32_16x16x32_bf16 v[212:215], v[116:119], v[84:87], v[212:215]
v_mfma_f32_16x16x32_bf16 v[208:211], v[116:119], v[80:83], v[208:211]
s_waitcnt lgkmcnt(0)
v_mfma_f32_16x16x32_bf16 v[128:131], v[48:51], v[32:35], v[128:131]
ds_read_b128 v[80:83], v3 offset:8192
v_mfma_f32_16x16x32_bf16 v[132:135], v[48:51], v[36:39], v[132:135]
ds_read_b64_tr_b16 v[96:97], v9 offset:24576
v_mfma_f32_16x16x32_bf16 v[136:139], v[48:51], v[40:43], v[136:139]
ds_read_b64_tr_b16 v[98:99], v9 offset:28672
v_mfma_f32_16x16x32_bf16 v[140:143], v[48:51], v[44:47], v[140:143]
ds_read_b128 v[84:87], v3 offset:8448
v_mfma_f32_16x16x32_bf16 v[188:191], v[60:63], v[44:47], v[188:191]
ds_read_b128 v[88:91], v3 offset:8704
v_mfma_f32_16x16x32_bf16 v[184:187], v[60:63], v[40:43], v[184:187]
ds_read_b128 v[92:95], v3 offset:8960
v_mfma_f32_16x16x32_bf16 v[180:183], v[60:63], v[36:39], v[180:183]
ds_read_b64_tr_b16 v[108:109], v9 offset:40960
v_mfma_f32_16x16x32_bf16 v[176:179], v[60:63], v[32:35], v[176:179]
ds_read_b64_tr_b16 v[110:111], v9 offset:45056
v_mfma_f32_16x16x32_bf16 v[144:147], v[52:55], v[32:35], v[144:147]
ds_read_b64_tr_b16 v[100:101], v10 offset:24576
v_mfma_f32_16x16x32_bf16 v[148:151], v[52:55], v[36:39], v[148:151]
ds_read_b64_tr_b16 v[102:103], v10 offset:28672
v_mfma_f32_16x16x32_bf16 v[152:155], v[52:55], v[40:43], v[152:155]
ds_read_b64_tr_b16 v[112:113], v10 offset:40960
v_mfma_f32_16x16x32_bf16 v[156:159], v[52:55], v[44:47], v[156:159]
ds_read_b64_tr_b16 v[114:115], v10 offset:45056
v_mfma_f32_16x16x32_bf16 v[204:207], v[64:67], v[44:47], v[204:207]
ds_read_b64_tr_b16 v[104:105], v11 offset:24576
v_mfma_f32_16x16x32_bf16 v[200:203], v[64:67], v[40:43], v[200:203]
ds_read_b64_tr_b16 v[106:107], v11 offset:28672
v_mfma_f32_16x16x32_bf16 v[196:199], v[64:67], v[36:39], v[196:199]
ds_read_b64_tr_b16 v[116:117], v11 offset:40960
v_mfma_f32_16x16x32_bf16 v[192:195], v[64:67], v[32:35], v[192:195]
ds_read_b64_tr_b16 v[118:119], v11 offset:45056
v_mfma_f32_16x16x32_bf16 v[160:163], v[56:59], v[32:35], v[160:163]
v_mfma_f32_16x16x32_bf16 v[164:167], v[56:59], v[36:39], v[164:167]
v_mfma_f32_16x16x32_bf16 v[168:171], v[56:59], v[40:43], v[168:171]
v_mfma_f32_16x16x32_bf16 v[172:175], v[56:59], v[44:47], v[172:175]
v_mfma_f32_16x16x32_bf16 v[220:223], v[68:71], v[44:47], v[220:223]
v_mfma_f32_16x16x32_bf16 v[216:219], v[68:71], v[40:43], v[216:219]
v_mfma_f32_16x16x32_bf16 v[212:215], v[68:71], v[36:39], v[212:215]
v_mfma_f32_16x16x32_bf16 v[208:211], v[68:71], v[32:35], v[208:211]
s_waitcnt lgkmcnt(0)
s_barrier
v_mfma_f32_16x16x32_bf16 v[128:131], v[96:99], v[80:83], v[128:131]
ds_read_b128 v[32:35], v4 offset:0
v_mfma_f32_16x16x32_bf16 v[132:135], v[96:99], v[84:87], v[132:135]
ds_read_b64_tr_b16 v[48:49], v13 offset:16384
v_mfma_f32_16x16x32_bf16 v[136:139], v[96:99], v[88:91], v[136:139]
ds_read_b64_tr_b16 v[50:51], v13 offset:20480
v_mfma_f32_16x16x32_bf16 v[140:143], v[96:99], v[92:95], v[140:143]
ds_read_b128 v[36:39], v4 offset:256
v_mfma_f32_16x16x32_bf16 v[188:191], v[108:111], v[92:95], v[188:191]
ds_read_b128 v[40:43], v4 offset:512
v_mfma_f32_16x16x32_bf16 v[184:187], v[108:111], v[88:91], v[184:187]
ds_read_b128 v[44:47], v4 offset:768
v_mfma_f32_16x16x32_bf16 v[180:183], v[108:111], v[84:87], v[180:183]
ds_read_b64_tr_b16 v[60:61], v13 offset:32768
v_mfma_f32_16x16x32_bf16 v[176:179], v[108:111], v[80:83], v[176:179]
ds_read_b64_tr_b16 v[62:63], v13 offset:36864
v_mfma_f32_16x16x32_bf16 v[144:147], v[100:103], v[80:83], v[144:147]
ds_read_b64_tr_b16 v[52:53], v14 offset:16384
v_mfma_f32_16x16x32_bf16 v[148:151], v[100:103], v[84:87], v[148:151]
ds_read_b64_tr_b16 v[54:55], v14 offset:20480
v_mfma_f32_16x16x32_bf16 v[152:155], v[100:103], v[88:91], v[152:155]
ds_read_b64_tr_b16 v[64:65], v14 offset:32768
v_mfma_f32_16x16x32_bf16 v[156:159], v[100:103], v[92:95], v[156:159]
ds_read_b64_tr_b16 v[66:67], v14 offset:36864
v_mfma_f32_16x16x32_bf16 v[204:207], v[112:115], v[92:95], v[204:207]
ds_read_b64_tr_b16 v[56:57], v15 offset:16384
v_mfma_f32_16x16x32_bf16 v[200:203], v[112:115], v[88:91], v[200:203]
ds_read_b64_tr_b16 v[58:59], v15 offset:20480
v_mfma_f32_16x16x32_bf16 v[196:199], v[112:115], v[84:87], v[196:199]
ds_read_b64_tr_b16 v[68:69], v15 offset:32768
v_mfma_f32_16x16x32_bf16 v[192:195], v[112:115], v[80:83], v[192:195]
ds_read_b64_tr_b16 v[70:71], v15 offset:36864
v_mfma_f32_16x16x32_bf16 v[160:163], v[104:107], v[80:83], v[160:163]
v_mfma_f32_16x16x32_bf16 v[164:167], v[104:107], v[84:87], v[164:167]
v_mfma_f32_16x16x32_bf16 v[168:171], v[104:107], v[88:91], v[168:171]
v_mfma_f32_16x16x32_bf16 v[172:175], v[104:107], v[92:95], v[172:175]
v_mfma_f32_16x16x32_bf16 v[220:223], v[116:119], v[92:95], v[220:223]
v_mfma_f32_16x16x32_bf16 v[216:219], v[116:119], v[88:91], v[216:219]
v_mfma_f32_16x16x32_bf16 v[212:215], v[116:119], v[84:87], v[212:215]
v_mfma_f32_16x16x32_bf16 v[208:211], v[116:119], v[80:83], v[208:211]
s_waitcnt lgkmcnt(0)
v_mfma_f32_16x16x32_bf16 v[128:131], v[48:51], v[32:35], v[128:131]
ds_read_b128 v[80:83], v4 offset:8192
v_mfma_f32_16x16x32_bf16 v[132:135], v[48:51], v[36:39], v[132:135]
ds_read_b64_tr_b16 v[96:97], v13 offset:24576
v_mfma_f32_16x16x32_bf16 v[136:139], v[48:51], v[40:43], v[136:139]
ds_read_b64_tr_b16 v[98:99], v13 offset:28672
v_mfma_f32_16x16x32_bf16 v[140:143], v[48:51], v[44:47], v[140:143]
ds_read_b128 v[84:87], v4 offset:8448
v_mfma_f32_16x16x32_bf16 v[188:191], v[60:63], v[44:47], v[188:191]
ds_read_b128 v[88:91], v4 offset:8704
v_mfma_f32_16x16x32_bf16 v[184:187], v[60:63], v[40:43], v[184:187]
ds_read_b128 v[92:95], v4 offset:8960
v_mfma_f32_16x16x32_bf16 v[180:183], v[60:63], v[36:39], v[180:183]
ds_read_b64_tr_b16 v[108:109], v13 offset:40960
v_mfma_f32_16x16x32_bf16 v[176:179], v[60:63], v[32:35], v[176:179]
ds_read_b64_tr_b16 v[110:111], v13 offset:45056
v_mfma_f32_16x16x32_bf16 v[144:147], v[52:55], v[32:35], v[144:147]
ds_read_b64_tr_b16 v[100:101], v14 offset:24576
v_mfma_f32_16x16x32_bf16 v[148:151], v[52:55], v[36:39], v[148:151]
ds_read_b64_tr_b16 v[102:103], v14 offset:28672
v_mfma_f32_16x16x32_bf16 v[152:155], v[52:55], v[40:43], v[152:155]
ds_read_b64_tr_b16 v[112:113], v14 offset:40960
v_mfma_f32_16x16x32_bf16 v[156:159], v[52:55], v[44:47], v[156:159]
ds_read_b64_tr_b16 v[114:115], v14 offset:45056
v_mfma_f32_16x16x32_bf16 v[204:207], v[64:67], v[44:47], v[204:207]
ds_read_b64_tr_b16 v[104:105], v15 offset:24576
v_mfma_f32_16x16x32_bf16 v[200:203], v[64:67], v[40:43], v[200:203]
ds_read_b64_tr_b16 v[106:107], v15 offset:28672
v_mfma_f32_16x16x32_bf16 v[196:199], v[64:67], v[36:39], v[196:199]
ds_read_b64_tr_b16 v[116:117], v15 offset:40960
v_mfma_f32_16x16x32_bf16 v[192:195], v[64:67], v[32:35], v[192:195]
ds_read_b64_tr_b16 v[118:119], v15 offset:45056
v_mfma_f32_16x16x32_bf16 v[160:163], v[56:59], v[32:35], v[160:163]
v_mfma_f32_16x16x32_bf16 v[164:167], v[56:59], v[36:39], v[164:167]
v_mfma_f32_16x16x32_bf16 v[168:171], v[56:59], v[40:43], v[168:171]
v_mfma_f32_16x16x32_bf16 v[172:175], v[56:59], v[44:47], v[172:175]
v_mfma_f32_16x16x32_bf16 v[220:223], v[68:71], v[44:47], v[220:223]
v_mfma_f32_16x16x32_bf16 v[216:219], v[68:71], v[40:43], v[216:219]
v_mfma_f32_16x16x32_bf16 v[212:215], v[68:71], v[36:39], v[212:215]
v_mfma_f32_16x16x32_bf16 v[208:211], v[68:71], v[32:35], v[208:211]
s_waitcnt lgkmcnt(0)
s_barrier
v_mfma_f32_16x16x32_bf16 v[128:131], v[96:99], v[80:83], v[128:131]
ds_read_b128 v[32:35], v2 offset:0
v_mfma_f32_16x16x32_bf16 v[132:135], v[96:99], v[84:87], v[132:135]
ds_read_b64_tr_b16 v[48:49], v5 offset:16384
v_mfma_f32_16x16x32_bf16 v[136:139], v[96:99], v[88:91], v[136:139]
ds_read_b64_tr_b16 v[50:51], v5 offset:20480
v_mfma_f32_16x16x32_bf16 v[140:143], v[96:99], v[92:95], v[140:143]
ds_read_b128 v[36:39], v2 offset:256
v_mfma_f32_16x16x32_bf16 v[188:191], v[108:111], v[92:95], v[188:191]
ds_read_b128 v[40:43], v2 offset:512
v_mfma_f32_16x16x32_bf16 v[184:187], v[108:111], v[88:91], v[184:187]
ds_read_b128 v[44:47], v2 offset:768
v_mfma_f32_16x16x32_bf16 v[180:183], v[108:111], v[84:87], v[180:183]
ds_read_b64_tr_b16 v[60:61], v5 offset:32768
v_mfma_f32_16x16x32_bf16 v[176:179], v[108:111], v[80:83], v[176:179]
ds_read_b64_tr_b16 v[62:63], v5 offset:36864
v_mfma_f32_16x16x32_bf16 v[144:147], v[100:103], v[80:83], v[144:147]
ds_read_b64_tr_b16 v[52:53], v6 offset:16384
v_mfma_f32_16x16x32_bf16 v[148:151], v[100:103], v[84:87], v[148:151]
ds_read_b64_tr_b16 v[54:55], v6 offset:20480
v_mfma_f32_16x16x32_bf16 v[152:155], v[100:103], v[88:91], v[152:155]
ds_read_b64_tr_b16 v[64:65], v6 offset:32768
v_mfma_f32_16x16x32_bf16 v[156:159], v[100:103], v[92:95], v[156:159]
ds_read_b64_tr_b16 v[66:67], v6 offset:36864
v_mfma_f32_16x16x32_bf16 v[204:207], v[112:115], v[92:95], v[204:207]
ds_read_b64_tr_b16 v[56:57], v7 offset:16384
v_mfma_f32_16x16x32_bf16 v[200:203], v[112:115], v[88:91], v[200:203]
ds_read_b64_tr_b16 v[58:59], v7 offset:20480
v_mfma_f32_16x16x32_bf16 v[196:199], v[112:115], v[84:87], v[196:199]
ds_read_b64_tr_b16 v[68:69], v7 offset:32768
v_mfma_f32_16x16x32_bf16 v[192:195], v[112:115], v[80:83], v[192:195]
ds_read_b64_tr_b16 v[70:71], v7 offset:36864
v_mfma_f32_16x16x32_bf16 v[160:163], v[104:107], v[80:83], v[160:163]
v_mfma_f32_16x16x32_bf16 v[164:167], v[104:107], v[84:87], v[164:167]
v_mfma_f32_16x16x32_bf16 v[168:171], v[104:107], v[88:91], v[168:171]
v_mfma_f32_16x16x32_bf16 v[172:175], v[104:107], v[92:95], v[172:175]
v_mfma_f32_16x16x32_bf16 v[220:223], v[116:119], v[92:95], v[220:223]
v_mfma_f32_16x16x32_bf16 v[216:219], v[116:119], v[88:91], v[216:219]
v_mfma_f32_16x16x32_bf16 v[212:215], v[116:119], v[84:87], v[212:215]
v_mfma_f32_16x16x32_bf16 v[208:211], v[116:119], v[80:83], v[208:211]
s_sub_u32 s41, s41, 1
s_cmp_lg_u32 s41, 0
s_cbranch_scc1 Lk3_52
s_waitcnt lgkmcnt(0)
v_mfma_f32_16x16x32_bf16 v[128:131], v[48:51], v[32:35], v[128:131]
ds_read_b128 v[80:83], v2 offset:8192
v_mfma_f32_16x16x32_bf16 v[132:135], v[48:51], v[36:39], v[132:135]
ds_read_b64_tr_b16 v[96:97], v5 offset:24576
v_mfma_f32_16x16x32_bf16 v[136:139], v[48:51], v[40:43], v[136:139]
ds_read_b64_tr_b16 v[98:99], v5 offset:28672
v_mfma_f32_16x16x32_bf16 v[140:143], v[48:51], v[44:47], v[140:143]
ds_read_b128 v[84:87], v2 offset:8448
v_mfma_f32_16x16x32_bf16 v[188:191], v[60:63], v[44:47], v[188:191]
ds_read_b128 v[88:91], v2 offset:8704
v_mfma_f32_16x16x32_bf16 v[184:187], v[60:63], v[40:43], v[184:187]
ds_read_b128 v[92:95], v2 offset:8960
v_mfma_f32_16x16x32_bf16 v[180:183], v[60:63], v[36:39], v[180:183]
ds_read_b64_tr_b16 v[108:109], v5 offset:40960
v_mfma_f32_16x16x32_bf16 v[176:179], v[60:63], v[32:35], v[176:179]
ds_read_b64_tr_b16 v[110:111], v5 offset:45056
v_mfma_f32_16x16x32_bf16 v[144:147], v[52:55], v[32:35], v[144:147]
ds_read_b64_tr_b16 v[100:101], v6 offset:24576
v_mfma_f32_16x16x32_bf16 v[148:151], v[52:55], v[36:39], v[148:151]
ds_read_b64_tr_b16 v[102:103], v6 offset:28672
v_mfma_f32_16x16x32_bf16 v[152:155], v[52:55], v[40:43], v[152:155]
ds_read_b64_tr_b16 v[112:113], v6 offset:40960
v_mfma_f32_16x16x32_bf16 v[156:159], v[52:55], v[44:47], v[156:159]
ds_read_b64_tr_b16 v[114:115], v6 offset:45056
v_mfma_f32_16x16x32_bf16 v[204:207], v[64:67], v[44:47], v[204:207]
ds_read_b64_tr_b16 v[104:105], v7 offset:24576
v_mfma_f32_16x16x32_bf16 v[200:203], v[64:67], v[40:43], v[200:203]
ds_read_b64_tr_b16 v[106:107], v7 offset:28672
v_mfma_f32_16x16x32_bf16 v[196:199], v[64:67], v[36:39], v[196:199]
ds_read_b64_tr_b16 v[116:117], v7 offset:40960
v_mfma_f32_16x16x32_bf16 v[192:195], v[64:67], v[32:35], v[192:195]
ds_read_b64_tr_b16 v[118:119], v7 offset:45056
v_mfma_f32_16x16x32_bf16 v[160:163], v[56:59], v[32:35], v[160:163]
v_mfma_f32_16x16x32_bf16 v[164:167], v[56:59], v[36:39], v[164:167]
v_mfma_f32_16x16x32_bf16 v[168:171], v[56:59], v[40:43], v[168:171]
v_mfma_f32_16x16x32_bf16 v[172:175], v[56:59], v[44:47], v[172:175]
v_mfma_f32_16x16x32_bf16 v[220:223], v[68:71], v[44:47], v[220:223]
v_mfma_f32_16x16x32_bf16 v[216:219], v[68:71], v[40:43], v[216:219]
v_mfma_f32_16x16x32_bf16 v[212:215], v[68:71], v[36:39], v[212:215]
v_mfma_f32_16x16x32_bf16 v[208:211], v[68:71], v[32:35], v[208:211]
s_waitcnt lgkmcnt(0)
s_barrier
s_cmp_eq_u32 s36, 7
s_cbranch_scc1 L7b_53
s_add_u32 m0, s39, 0
s_add_u32 s37, s37, s40
buffer_load_dwordx4 v21, s[8:11], s37 offen sc1 lds
v_mfma_f32_16x16x32_bf16 v[128:131], v[96:99], v[80:83], v[128:131]
v_mfma_f32_16x16x32_bf16 v[132:135], v[96:99], v[84:87], v[132:135]
s_add_u32 m0, s39, 1024
s_add_u32 s37, s37, s38
buffer_load_dwordx4 v21, s[8:11], s37 offen sc1 lds
v_mfma_f32_16x16x32_bf16 v[136:139], v[96:99], v[88:91], v[136:139]
s_add_u32 m0, s39, 2048
s_add_u32 s37, s37, s38
buffer_load_dwordx4 v21, s[8:11], s37 offen sc1 lds
v_mfma_f32_16x16x32_bf16 v[140:143], v[96:99], v[92:95], v[140:143]
v_mfma_f32_16x16x32_bf16 v[188:191], v[108:111], v[92:95], v[188:191]
s_add_u32 m0, s39, 3072
s_add_u32 s37, s37, s38
buffer_load_dwordx4 v21, s[8:11], s37 offen sc1 lds
v_mfma_f32_16x16x32_bf16 v[184:187], v[108:111], v[88:91], v[184:187]
s_add_u32 m0, s39, 4096
s_add_u32 s37, s37, s55
buffer_load_dwordx4 v21, s[8:11], s37 offen sc1 lds
v_mfma_f32_16x16x32_bf16 v[180:183], v[108:111], v[84:87], v[180:183]
v_mfma_f32_16x16x32_bf16 v[176:179], v[108:111], v[80:83], v[176:179]
s_add_u32 m0, s39, 5120
s_add_u32 s37, s37, s38
buffer_load_dwordx4 v21, s[8:11], s37 offen sc1 lds
v_mfma_f32_16x16x32_bf16 v[144:147], v[100:103], v[80:83], v[144:147]
s_add_u32 m0, s39, 6144
s_add_u32 s37, s37, s38
buffer_load_dwordx4 v21, s[8:11], s37 offen sc1 lds
v_mfma_f32_16x16x32_bf16 v[148:151], v[100:103], v[84:87], v[148:151]
v_mfma_f32_16x16x32_bf16 v[152:155], v[100:103], v[88:91], v[152:155]
s_add_u32 m0, s39, 7168
s_add_u32 s37, s37, s38
buffer_load_dwordx4 v21, s[8:11], s37 offen sc1 lds
v_mfma_f32_16x16x32_bf16 v[156:159], v[100:103], v[92:95], v[156:159]
s_add_u32 m0, s39, 32768
s_add_u32 s37, s37, s40
buffer_load_dwordx4 v21, s[8:11], s37 offen sc1 lds
v_mfma_f32_16x16x32_bf16 v[204:207], v[112:115], v[92:95], v[204:207]
v_mfma_f32_16x16x32_bf16 v[200:203], v[112:115], v[88:91], v[200:203]
s_add_u32 m0, s39, 33792
s_add_u32 s37, s37, s38
buffer_load_dwordx4 v21, s[8:11], s37 offen sc1 lds
v_mfma_f32_16x16x32_bf16 v[196:199], v[112:115], v[84:87], v[196:199]
s_add_u32 m0, s39, 34816
s_add_u32 s37, s37, s38
buffer_load_dwordx4 v21, s[8:11], s37 offen sc1 lds
v_mfma_f32_16x16x32_bf16 v[192:195], v[112:115], v[80:83], v[192:195]
v_mfma_f32_16x16x32_bf16 v[160:163], v[104:107], v[80:83], v[160:163]
s_add_u32 m0, s39, 35840
s_add_u32 s37, s37, s38
buffer_load_dwordx4 v21, s[8:11], s37 offen sc1 lds
v_mfma_f32_16x16x32_bf16 v[164:167], v[104:107], v[84:87], v[164:167]
s_add_u32 m0, s39, 36864
s_add_u32 s37, s37, s55
buffer_load_dwordx4 v21, s[8:11], s37 offen sc1 lds
v_mfma_f32_16x16x32_bf16 v[168:171], v[104:107], v[88:91], v[168:171]
v_mfma_f32_16x16x32_bf16 v[172:175], v[104:107], v[92:95], v[172:175]
s_add_u32 m0, s39, 37888
s_add_u32 s37, s37, s38
buffer_load_dwordx4 v21, s[8:11], s37 offen sc1 lds
v_mfma_f32_16x16x32_bf16 v[220:223], v[116:119], v[92:95], v[220:223]
s_add_u32 m0, s39, 38912
s_add_u32 s37, s37, s38
buffer_load_dwordx4 v21, s[8:11], s37 offen sc1 lds
v_mfma_f32_16x16x32_bf16 v[216:219], v[116:119], v[88:91], v[216:219]
v_mfma_f32_16x16x32_bf16 v[212:215], v[116:119], v[84:87], v[212:215]
s_add_u32 m0, s39, 39936
s_add_u32 s37, s37, s38
buffer_load_dwordx4 v21, s[8:11], s37 offen sc1 lds
v_mfma_f32_16x16x32_bf16 v[208:211], v[116:119], v[80:83], v[208:211]
s_setprio 0
s_barrier
s_add_u32 s37, s37, s54
s_add_u32 m0, s39, 65536
s_add_u32 s37, s37, s40
buffer_load_dwordx4 v21, s[8:11], s37 offen sc1 lds
v_mul_f32 v80, v128, v128
v_mul_f32 v81, v129, v129
v_mul_f32 v82, v130, v130
v_mul_f32 v83, v131, v131
v_fma_f32 v80, v80, v232, v228
v_fma_f32 v81, v81, v232, v228
v_fma_f32 v82, v82, v232, v228
s_add_u32 m0, s39, 66560
s_add_u32 s37, s37, s38
buffer_load_dwordx4 v21, s[8:11], s37 offen sc1 lds
v_fma_f32 v83, v83, v232, v228
v_mul_f32 v80, v80, v128
v_mul_f32 v81, v81, v129
v_mul_f32 v82, v82, v130
v_mul_f32 v83, v83, v131
v_exp_f32 v80, v80
s_add_u32 m0, s39, 67584
s_add_u32 s37, s37, s38
buffer_load_dwordx4 v21, s[8:11], s37 offen sc1 lds
v_exp_f32 v81, v81
v_exp_f32 v82, v82
v_exp_f32 v83, v83
v_mul_f32 v176, v128, v176
v_mul_f32 v177, v129, v177
v_mul_f32 v178, v130, v178
v_mul_f32 v179, v131, v179
s_add_u32 m0, s39, 68608
s_add_u32 s37, s37, s38
buffer_load_dwordx4 v21, s[8:11], s37 offen sc1 lds
v_fma_f32 v80, v80, v236, v236
v_fma_f32 v81, v81, v236, v236
v_fma_f32 v82, v82, v236, v236
v_fma_f32 v83, v83, v236, v236
v_rcp_f32 v80, v80
v_rcp_f32 v81, v81
s_add_u32 m0, s39, 69632
s_add_u32 s37, s37, s55
buffer_load_dwordx4 v21, s[8:11], s37 offen sc1 lds
v_rcp_f32 v82, v82
v_rcp_f32 v83, v83
v_mul_f32 v176, v176, v80
v_mul_f32 v177, v177, v81
v_mul_f32 v178, v178, v82
v_mul_f32 v179, v179, v83
v_cvt_pk_bf16_f32 v96, v176, v177
s_add_u32 m0, s39, 70656
s_add_u32 s37, s37, s38
buffer_load_dwordx4 v21, s[8:11], s37 offen sc1 lds
v_cvt_pk_bf16_f32 v97, v178, v179
v_mul_f32 v84, v144, v144
v_mul_f32 v85, v145, v145
v_mul_f32 v86, v146, v146
v_mul_f32 v87, v147, v147
v_fma_f32 v84, v84, v232, v228
s_add_u32 m0, s39, 71680
s_add_u32 s37, s37, s38
buffer_load_dwordx4 v21, s[8:11], s37 offen sc1 lds
v_fma_f32 v85, v85, v232, v228
v_fma_f32 v86, v86, v232, v228
v_fma_f32 v87, v87, v232, v228
v_mul_f32 v84, v84, v144
v_mul_f32 v85, v85, v145
v_mul_f32 v86, v86, v146
v_mul_f32 v87, v87, v147
s_add_u32 m0, s39, 72704
s_add_u32 s37, s37, s38
buffer_load_dwordx4 v21, s[8:11], s37 offen sc1 lds
v_exp_f32 v84, v84
v_exp_f32 v85, v85
v_exp_f32 v86, v86
v_exp_f32 v87, v87
v_mul_f32 v192, v144, v192
v_mul_f32 v193, v145, v193
s_waitcnt vmcnt(16)
s_barrier
s_add_u32 m0, s39, 98304
s_add_u32 s37, s37, s40
buffer_load_dwordx4 v21, s[8:11], s37 offen sc1 lds
v_mul_f32 v194, v146, v194
v_mul_f32 v195, v147, v195
v_fma_f32 v84, v84, v236, v236
v_fma_f32 v85, v85, v236, v236
v_fma_f32 v86, v86, v236, v236
v_fma_f32 v87, v87, v236, v236
v_rcp_f32 v84, v84
s_add_u32 m0, s39, 99328
s_add_u32 s37, s37, s38
buffer_load_dwordx4 v21, s[8:11], s37 offen sc1 lds
v_rcp_f32 v85, v85
v_rcp_f32 v86, v86
v_rcp_f32 v87, v87
v_mul_f32 v192, v192, v84
v_mul_f32 v193, v193, v85
v_mul_f32 v194, v194, v86
v_mul_f32 v195, v195, v87
s_add_u32 m0, s39, 100352
s_add_u32 s37, s37, s38
buffer_load_dwordx4 v21, s[8:11], s37 offen sc1 lds
v_cvt_pk_bf16_f32 v98, v192, v193
v_cvt_pk_bf16_f32 v99, v194, v195
v_mul_f32 v80, v160, v160
v_mul_f32 v81, v161, v161
v_mul_f32 v82, v162, v162
s_add_u32 m0, s39, 101376
s_add_u32 s37, s37, s38
buffer_load_dwordx4 v21, s[8:11], s37 offen sc1 lds
v_mul_f32 v83, v163, v163
v_fma_f32 v80, v80, v232, v228
v_fma_f32 v81, v81, v232, v228
v_fma_f32 v82, v82, v232, v228
v_fma_f32 v83, v83, v232, v228
v_mul_f32 v80, v80, v160
v_mul_f32 v81, v81, v161
s_add_u32 m0, s39, 102400
s_add_u32 s37, s37, s55
buffer_load_dwordx4 v21, s[8:11], s37 offen sc1 lds
v_mul_f32 v82, v82, v162
v_mul_f32 v83, v83, v163
v_exp_f32 v80, v80
v_exp_f32 v81, v81
v_exp_f32 v82, v82
v_exp_f32 v83, v83
v_mul_f32 v208, v160, v208
s_add_u32 m0, s39, 103424
s_add_u32 s37, s37, s38
buffer_load_dwordx4 v21, s[8:11], s37 offen sc1 lds
v_mul_f32 v209, v161, v209
v_mul_f32 v210, v162, v210
v_mul_f32 v211, v163, v211
v_fma_f32 v80, v80, v236, v236
v_fma_f32 v81, v81, v236, v236
v_fma_f32 v82, v82, v236, v236
s_add_u32 m0, s39, 104448
s_add_u32 s37, s37, s38
buffer_load_dwordx4 v21, s[8:11], s37 offen sc1 lds
v_fma_f32 v83, v83, v236, v236
v_rcp_f32 v80, v80
v_rcp_f32 v81, v81
v_rcp_f32 v82, v82
v_rcp_f32 v83, v83
v_mul_f32 v208, v208, v80
v_mul_f32 v209, v209, v81
s_add_u32 m0, s39, 105472
s_add_u32 s37, s37, s38
buffer_load_dwordx4 v21, s[8:11], s37 offen sc1 lds
v_mul_f32 v210, v210, v82
v_mul_f32 v211, v211, v83
v_cvt_pk_bf16_f32 v112, v208, v209
v_cvt_pk_bf16_f32 v113, v210, v211
v_mul_f32 v80, v132, v132
v_mul_f32 v81, v133, v133
buffer_store_dwordx4 v[96:99], v27, s[24:27], 0 offen offset:0 sc1
s_waitcnt vmcnt(17)
s_barrier
s_add_u32 m0, s39, 0
s_add_u32 s37, s37, s40
buffer_load_dwordx4 v21, s[8:11], s37 offen sc1 lds
v_mul_f32 v82, v134, v134
v_mul_f32 v83, v135, v135
v_fma_f32 v80, v80, v233, v229
v_fma_f32 v81, v81, v233, v229
v_fma_f32 v82, v82, v233, v229
v_fma_f32 v83, v83, v233, v229
v_mul_f32 v80, v80, v132
s_add_u32 m0, s39, 1024
s_add_u32 s37, s37, s38
buffer_load_dwordx4 v21, s[8:11], s37 offen sc1 lds
v_mul_f32 v81, v81, v133
v_mul_f32 v82, v82, v134
v_mul_f32 v83, v83, v135
v_exp_f32 v80, v80
v_exp_f32 v81, v81
v_exp_f32 v82, v82
s_add_u32 m0, s39, 2048
s_add_u32 s37, s37, s38
buffer_load_dwordx4 v21, s[8:11], s37 offen sc1 lds
v_exp_f32 v83, v83
v_mul_f32 v180, v132, v180
v_mul_f32 v181, v133, v181
v_mul_f32 v182, v134, v182
v_mul_f32 v183, v135, v183
v_fma_f32 v80, v80, v237, v237
v_fma_f32 v81, v81, v237, v237
s_add_u32 m0, s39, 3072
s_add_u32 s37, s37, s38
buffer_load_dwordx4 v21, s[8:11], s37 offen sc1 lds
v_fma_f32 v82, v82, v237, v237
v_fma_f32 v83, v83, v237, v237
v_rcp_f32 v80, v80
v_rcp_f32 v81, v81
v_rcp_f32 v82, v82
v_rcp_f32 v83, v83
s_add_u32 m0, s39, 4096
s_add_u32 s37, s37, s55
buffer_load_dwordx4 v21, s[8:11], s37 offen sc1 lds
v_mul_f32 v180, v180, v80
v_mul_f32 v181, v181, v81
v_mul_f32 v182, v182, v82
v_mul_f32 v183, v183, v83
v_cvt_pk_bf16_f32 v100, v180, v181
v_cvt_pk_bf16_f32 v101, v182, v183
v_mul_f32 v84, v148, v148
s_add_u32 m0, s39, 5120
s_add_u32 s37, s37, s38
buffer_load_dwordx4 v21, s[8:11], s37 offen sc1 lds
v_mul_f32 v85, v149, v149
v_mul_f32 v86, v150, v150
v_mul_f32 v87, v151, v151
v_fma_f32 v84, v84, v233, v229
v_fma_f32 v85, v85, v233, v229
v_fma_f32 v86, v86, v233, v229
s_add_u32 m0, s39, 6144
s_add_u32 s37, s37, s38
buffer_load_dwordx4 v21, s[8:11], s37 offen sc1 lds
v_fma_f32 v87, v87, v233, v229
v_mul_f32 v84, v84, v148
v_mul_f32 v85, v85, v149
v_mul_f32 v86, v86, v150
v_mul_f32 v87, v87, v151
v_exp_f32 v84, v84
v_exp_f32 v85, v85
s_add_u32 m0, s39, 7168
s_add_u32 s37, s37, s38
buffer_load_dwordx4 v21, s[8:11], s37 offen sc1 lds
v_exp_f32 v86, v86
v_exp_f32 v87, v87
v_mul_f32 v196, v148, v196
v_mul_f32 v197, v149, v197
v_mul_f32 v198, v150, v198
v_mul_f32 v199, v151, v199
s_waitcnt vmcnt(17)
s_barrier
s_add_u32 m0, s39, 32768
s_add_u32 s37, s37, s40
buffer_load_dwordx4 v21, s[8:11], s37 offen sc1 lds
v_fma_f32 v84, v84, v237, v237
v_fma_f32 v85, v85, v237, v237
v_fma_f32 v86, v86, v237, v237
v_fma_f32 v87, v87, v237, v237
v_rcp_f32 v84, v84
v_rcp_f32 v85, v85
v_rcp_f32 v86, v86
s_add_u32 m0, s39, 33792
s_add_u32 s37, s37, s38
buffer_load_dwordx4 v21, s[8:11], s37 offen sc1 lds
v_rcp_f32 v87, v87
v_mul_f32 v196, v196, v84
v_mul_f32 v197, v197, v85
v_mul_f32 v198, v198, v86
v_mul_f32 v199, v199, v87
v_cvt_pk_bf16_f32 v102, v196, v197
v_cvt_pk_bf16_f32 v103, v198, v199
s_add_u32 m0, s39, 34816
s_add_u32 s37, s37, s38
buffer_load_dwordx4 v21, s[8:11], s37 offen sc1 lds
v_mul_f32 v80, v164, v164
v_mul_f32 v81, v165, v165
v_mul_f32 v82, v166, v166
v_mul_f32 v83, v167, v167
v_fma_f32 v80, v80, v233, v229
s_add_u32 m0, s39, 35840
s_add_u32 s37, s37, s38
buffer_load_dwordx4 v21, s[8:11], s37 offen sc1 lds
v_fma_f32 v81, v81, v233, v229
v_fma_f32 v82, v82, v233, v229
v_fma_f32 v83, v83, v233, v229
v_mul_f32 v80, v80, v164
v_mul_f32 v81, v81, v165
v_mul_f32 v82, v82, v166
v_mul_f32 v83, v83, v167
s_add_u32 m0, s39, 36864
s_add_u32 s37, s37, s55
buffer_load_dwordx4 v21, s[8:11], s37 offen sc1 lds
v_exp_f32 v80, v80
v_exp_f32 v81, v81
v_exp_f32 v82, v82
v_exp_f32 v83, v83
v_mul_f32 v212, v164, v212
v_mul_f32 v213, v165, v213
v_mul_f32 v214, v166, v214
s_add_u32 m0, s39, 37888
s_add_u32 s37, s37, s38
buffer_load_dwordx4 v21, s[8:11], s37 offen sc1 lds
v_mul_f32 v215, v167, v215
v_fma_f32 v80, v80, v237, v237
v_fma_f32 v81, v81, v237, v237
v_fma_f32 v82, v82, v237, v237
v_fma_f32 v83, v83, v237, v237
v_rcp_f32 v80, v80
s_add_u32 m0, s39, 38912
s_add_u32 s37, s37, s38
buffer_load_dwordx4 v21, s[8:11], s37 offen sc1 lds
v_rcp_f32 v81, v81
v_rcp_f32 v82, v82
v_rcp_f32 v83, v83
v_mul_f32 v212, v212, v80
v_mul_f32 v213, v213, v81
v_mul_f32 v214, v214, v82
v_mul_f32 v215, v215, v83
s_add_u32 m0, s39, 39936
s_add_u32 s37, s37, s38
buffer_load_dwordx4 v21, s[8:11], s37 offen sc1 lds
v_cvt_pk_bf16_f32 v114, v212, v213
v_cvt_pk_bf16_f32 v115, v214, v215
s_nop 1
v_permlane32_swap_b32 v112, v114
v_permlane32_swap_b32 v113, v115
buffer_store_dwordx4 v[100:103], v27, s[24:27], 0 offen offset:256 sc1
buffer_store_dwordx4 v[112:115], v28, s[24:27], 0 offen offset:0 sc1
s_waitcnt vmcnt(19)
s_barrier
s_add_u32 m0, s39, 65536
s_add_u32 s37, s37, s40
buffer_load_dwordx4 v21, s[8:11], s37 offen sc1 lds
v_mul_f32 v80, v136, v136
v_mul_f32 v81, v137, v137
v_mul_f32 v82, v138, v138
v_mul_f32 v83, v139, v139
v_fma_f32 v80, v80, v234, v230
v_fma_f32 v81, v81, v234, v230
v_fma_f32 v82, v82, v234, v230
s_add_u32 m0, s39, 66560
s_add_u32 s37, s37, s38
buffer_load_dwordx4 v21, s[8:11], s37 offen sc1 lds
v_fma_f32 v83, v83, v234, v230
v_mul_f32 v80, v80, v136
v_mul_f32 v81, v81, v137
v_mul_f32 v82, v82, v138
v_mul_f32 v83, v83, v139
v_exp_f32 v80, v80
s_add_u32 m0, s39, 67584
s_add_u32 s37, s37, s38
buffer_load_dwordx4 v21, s[8:11], s37 offen sc1 lds
v_exp_f32 v81, v81
v_exp_f32 v82, v82
v_exp_f32 v83, v83
v_mul_f32 v184, v136, v184
v_mul_f32 v185, v137, v185
v_mul_f32 v186, v138, v186
v_mul_f32 v187, v139, v187
s_add_u32 m0, s39, 68608
s_add_u32 s37, s37, s38
buffer_load_dwordx4 v21, s[8:11], s37 offen sc1 lds
v_fma_f32 v80, v80, v238, v238
v_fma_f32 v81, v81, v238, v238
v_fma_f32 v82, v82, v238, v238
v_fma_f32 v83, v83, v238, v238
v_rcp_f32 v80, v80
v_rcp_f32 v81, v81
s_add_u32 m0, s39, 69632
s_add_u32 s37, s37, s55
buffer_load_dwordx4 v21, s[8:11], s37 offen sc1 lds
v_rcp_f32 v82, v82
v_rcp_f32 v83, v83
v_mul_f32 v184, v184, v80
v_mul_f32 v185, v185, v81
v_mul_f32 v186, v186, v82
v_mul_f32 v187, v187, v83
v_cvt_pk_bf16_f32 v104, v184, v185
s_add_u32 m0, s39, 70656
s_add_u32 s37, s37, s38
buffer_load_dwordx4 v21, s[8:11], s37 offen sc1 lds
v_cvt_pk_bf16_f32 v105, v186, v187
v_mul_f32 v84, v152, v152
v_mul_f32 v85, v153, v153
v_mul_f32 v86, v154, v154
v_mul_f32 v87, v155, v155
v_fma_f32 v84, v84, v234, v230
s_add_u32 m0, s39, 71680
s_add_u32 s37, s37, s38
buffer_load_dwordx4 v21, s[8:11], s37 offen sc1 lds
v_fma_f32 v85, v85, v234, v230
v_fma_f32 v86, v86, v234, v230
v_fma_f32 v87, v87, v234, v230
v_mul_f32 v84, v84, v152
v_mul_f32 v85, v85, v153
v_mul_f32 v86, v86, v154
v_mul_f32 v87, v87, v155
s_add_u32 m0, s39, 72704
s_add_u32 s37, s37, s38
buffer_load_dwordx4 v21, s[8:11], s37 offen sc1 lds
v_exp_f32 v84, v84
v_exp_f32 v85, v85
v_exp_f32 v86, v86
v_exp_f32 v87, v87
v_mul_f32 v200, v152, v200
v_mul_f32 v201, v153, v201
s_waitcnt vmcnt(18)
s_barrier
s_add_u32 m0, s39, 98304
s_add_u32 s37, s37, s40
buffer_load_dwordx4 v21, s[8:11], s37 offen sc1 lds
v_mul_f32 v202, v154, v202
v_mul_f32 v203, v155, v203
v_fma_f32 v84, v84, v238, v238
v_fma_f32 v85, v85, v238, v238
v_fma_f32 v86, v86, v238, v238
v_fma_f32 v87, v87, v238, v238
v_rcp_f32 v84, v84
s_add_u32 m0, s39, 99328
s_add_u32 s37, s37, s38
buffer_load_dwordx4 v21, s[8:11], s37 offen sc1 lds
v_rcp_f32 v85, v85
v_rcp_f32 v86, v86
v_rcp_f32 v87, v87
v_mul_f32 v200, v200, v84
v_mul_f32 v201, v201, v85
v_mul_f32 v202, v202, v86
v_mul_f32 v203, v203, v87
s_add_u32 m0, s39, 100352
s_add_u32 s37, s37, s38
buffer_load_dwordx4 v21, s[8:11], s37 offen sc1 lds
v_cvt_pk_bf16_f32 v106, v200, v201
v_cvt_pk_bf16_f32 v107, v202, v203
v_mul_f32 v80, v168, v168
v_mul_f32 v81, v169, v169
v_mul_f32 v82, v170, v170
s_add_u32 m0, s39, 101376
s_add_u32 s37, s37, s38
buffer_load_dwordx4 v21, s[8:11], s37 offen sc1 lds
v_mul_f32 v83, v171, v171
v_fma_f32 v80, v80, v234, v230
v_fma_f32 v81, v81, v234, v230
v_fma_f32 v82, v82, v234, v230
v_fma_f32 v83, v83, v234, v230
v_mul_f32 v80, v80, v168
v_mul_f32 v81, v81, v169
s_add_u32 m0, s39, 102400
s_add_u32 s37, s37, s55
buffer_load_dwordx4 v21, s[8:11], s37 offen sc1 lds
v_mul_f32 v82, v82, v170
v_mul_f32 v83, v83, v171
v_exp_f32 v80, v80
v_exp_f32 v81, v81
v_exp_f32 v82, v82
v_exp_f32 v83, v83
v_mul_f32 v216, v168, v216
s_add_u32 m0, s39, 103424
s_add_u32 s37, s37, s38
buffer_load_dwordx4 v21, s[8:11], s37 offen sc1 lds
v_mul_f32 v217, v169, v217
v_mul_f32 v218, v170, v218
v_mul_f32 v219, v171, v219
v_fma_f32 v80, v80, v238, v238
v_fma_f32 v81, v81, v238, v238
v_fma_f32 v82, v82, v238, v238
s_add_u32 m0, s39, 104448
s_add_u32 s37, s37, s38
buffer_load_dwordx4 v21, s[8:11], s37 offen sc1 lds
v_fma_f32 v83, v83, v238, v238
v_rcp_f32 v80, v80
v_rcp_f32 v81, v81
v_rcp_f32 v82, v82
v_rcp_f32 v83, v83
v_mul_f32 v216, v216, v80
v_mul_f32 v217, v217, v81
s_add_u32 m0, s39, 105472
s_add_u32 s37, s37, s38
buffer_load_dwordx4 v21, s[8:11], s37 offen sc1 lds
v_mul_f32 v218, v218, v82
v_mul_f32 v219, v219, v83
v_cvt_pk_bf16_f32 v116, v216, v217
v_cvt_pk_bf16_f32 v117, v218, v219
v_mul_f32 v80, v140, v140
v_mul_f32 v81, v141, v141
buffer_store_dwordx4 v[104:107], v27, s[24:27], 0 offen offset:512 sc1
s_waitcnt vmcnt(19)
s_barrier
s_add_u32 s37, s37, s29
s_add_u32 m0, s39, 0
s_add_u32 s37, s37, s40
buffer_load_dwordx4 v21, s[8:11], s37 offen sc1 lds
v_mul_f32 v82, v142, v142
v_mul_f32 v83, v143, v143
v_fma_f32 v80, v80, v235, v231
v_fma_f32 v81, v81, v235, v231
v_fma_f32 v82, v82, v235, v231
v_fma_f32 v83, v83, v235, v231
v_mul_f32 v80, v80, v140
s_add_u32 m0, s39, 1024
s_add_u32 s37, s37, s38
buffer_load_dwordx4 v21, s[8:11], s37 offen sc1 lds
v_mul_f32 v81, v81, v141
v_mul_f32 v82, v82, v142
v_mul_f32 v83, v83, v143
v_exp_f32 v80, v80
v_exp_f32 v81, v81
v_exp_f32 v82, v82
s_add_u32 m0, s39, 2048
s_add_u32 s37, s37, s38
buffer_load_dwordx4 v21, s[8:11], s37 offen sc1 lds
v_exp_f32 v83, v83
v_mul_f32 v188, v140, v188
v_mul_f32 v189, v141, v189
v_mul_f32 v190, v142, v190
v_mul_f32 v191, v143, v191
v_fma_f32 v80, v80, v239, v239
v_fma_f32 v81, v81, v239, v239
s_add_u32 m0, s39, 3072
s_add_u32 s37, s37, s38
buffer_load_dwordx4 v21, s[8:11], s37 offen sc1 lds
v_fma_f32 v82, v82, v239, v239
v_fma_f32 v83, v83, v239, v239
v_rcp_f32 v80, v80
v_rcp_f32 v81, v81
v_rcp_f32 v82, v82
v_rcp_f32 v83, v83
s_add_u32 m0, s39, 4096
s_add_u32 s37, s37, s55
buffer_load_dwordx4 v21, s[8:11], s37 offen sc1 lds
v_mul_f32 v188, v188, v80
v_mul_f32 v189, v189, v81
v_mul_f32 v190, v190, v82
v_mul_f32 v191, v191, v83
v_cvt_pk_bf16_f32 v108, v188, v189
v_cvt_pk_bf16_f32 v109, v190, v191
v_mul_f32 v84, v156, v156
s_add_u32 m0, s39, 5120
s_add_u32 s37, s37, s38
buffer_load_dwordx4 v21, s[8:11], s37 offen sc1 lds
v_mul_f32 v85, v157, v157
v_mul_f32 v86, v158, v158
v_mul_f32 v87, v159, v159
v_fma_f32 v84, v84, v235, v231
v_fma_f32 v85, v85, v235, v231
v_fma_f32 v86, v86, v235, v231
s_add_u32 m0, s39, 6144
s_add_u32 s37, s37, s38
buffer_load_dwordx4 v21, s[8:11], s37 offen sc1 lds
v_fma_f32 v87, v87, v235, v231
v_mul_f32 v84, v84, v156
v_mul_f32 v85, v85, v157
v_mul_f32 v86, v86, v158
v_mul_f32 v87, v87, v159
v_exp_f32 v84, v84
v_exp_f32 v85, v85
s_add_u32 m0, s39, 7168
s_add_u32 s37, s37, s38
buffer_load_dwordx4 v21, s[8:11], s37 offen sc1 lds
v_exp_f32 v86, v86
v_exp_f32 v87, v87
v_mul_f32 v204, v156, v204
v_mul_f32 v205, v157, v205
v_mul_f32 v206, v158, v206
v_mul_f32 v207, v159, v207
s_waitcnt vmcnt(17)
s_barrier
s_add_u32 m0, s39, 32768
s_add_u32 s37, s37, s40
buffer_load_dwordx4 v21, s[8:11], s37 offen sc1 lds
v_fma_f32 v84, v84, v239, v239
v_fma_f32 v85, v85, v239, v239
v_fma_f32 v86, v86, v239, v239
v_fma_f32 v87, v87, v239, v239
v_rcp_f32 v84, v84
v_rcp_f32 v85, v85
v_rcp_f32 v86, v86
s_add_u32 m0, s39, 33792
s_add_u32 s37, s37, s38
buffer_load_dwordx4 v21, s[8:11], s37 offen sc1 lds
v_rcp_f32 v87, v87
v_mul_f32 v204, v204, v84
v_mul_f32 v205, v205, v85
v_mul_f32 v206, v206, v86
v_mul_f32 v207, v207, v87
v_cvt_pk_bf16_f32 v110, v204, v205
v_cvt_pk_bf16_f32 v111, v206, v207
s_add_u32 m0, s39, 34816
s_add_u32 s37, s37, s38
buffer_load_dwordx4 v21, s[8:11], s37 offen sc1 lds
v_mul_f32 v80, v172, v172
v_mul_f32 v81, v173, v173
v_mul_f32 v82, v174, v174
v_mul_f32 v83, v175, v175
v_fma_f32 v80, v80, v235, v231
s_add_u32 m0, s39, 35840
s_add_u32 s37, s37, s38
buffer_load_dwordx4 v21, s[8:11], s37 offen sc1 lds
v_fma_f32 v81, v81, v235, v231
v_fma_f32 v82, v82, v235, v231
v_fma_f32 v83, v83, v235, v231
v_mul_f32 v80, v80, v172
v_mul_f32 v81, v81, v173
v_mul_f32 v82, v82, v174
v_mul_f32 v83, v83, v175
s_add_u32 m0, s39, 36864
s_add_u32 s37, s37, s55
buffer_load_dwordx4 v21, s[8:11], s37 offen sc1 lds
v_exp_f32 v80, v80
v_exp_f32 v81, v81
v_exp_f32 v82, v82
v_exp_f32 v83, v83
v_mul_f32 v220, v172, v220
v_mul_f32 v221, v173, v221
v_mul_f32 v222, v174, v222
s_add_u32 m0, s39, 37888
s_add_u32 s37, s37, s38
buffer_load_dwordx4 v21, s[8:11], s37 offen sc1 lds
v_mul_f32 v223, v175, v223
v_fma_f32 v80, v80, v239, v239
v_fma_f32 v81, v81, v239, v239
v_fma_f32 v82, v82, v239, v239
v_fma_f32 v83, v83, v239, v239
v_rcp_f32 v80, v80
s_add_u32 m0, s39, 38912
s_add_u32 s37, s37, s38
buffer_load_dwordx4 v21, s[8:11], s37 offen sc1 lds
v_rcp_f32 v81, v81
v_rcp_f32 v82, v82
v_rcp_f32 v83, v83
v_mul_f32 v220, v220, v80
v_mul_f32 v221, v221, v81
v_mul_f32 v222, v222, v82
v_mul_f32 v223, v223, v83
s_add_u32 m0, s39, 39936
s_add_u32 s37, s37, s38
buffer_load_dwordx4 v21, s[8:11], s37 offen sc1 lds
v_cvt_pk_bf16_f32 v118, v220, v221
v_cvt_pk_bf16_f32 v119, v222, v223
s_nop 1
v_permlane32_swap_b32 v116, v118
v_permlane32_swap_b32 v117, v119
buffer_store_dwordx4 v[108:111], v27, s[24:27], 0 offen offset:768 sc1
buffer_store_dwordx4 v[116:119], v28, s[24:27], 0 offen offset:512 sc1
s_waitcnt vmcnt(19)
s_barrier
s_add_u32 m0, s39, 65536
s_add_u32 s37, s37, s40
buffer_load_dwordx4 v21, s[8:11], s37 offen sc1 lds
s_add_u32 m0, s39, 66560
s_add_u32 s37, s37, s38
buffer_load_dwordx4 v21, s[8:11], s37 offen sc1 lds
s_add_u32 m0, s39, 67584
s_add_u32 s37, s37, s38
buffer_load_dwordx4 v21, s[8:11], s37 offen sc1 lds
s_add_u32 m0, s39, 68608
s_add_u32 s37, s37, s38
buffer_load_dwordx4 v21, s[8:11], s37 offen sc1 lds
s_add_u32 m0, s39, 69632
s_add_u32 s37, s37, s55
buffer_load_dwordx4 v21, s[8:11], s37 offen sc1 lds
s_add_u32 m0, s39, 70656
s_add_u32 s37, s37, s38
buffer_load_dwordx4 v21, s[8:11], s37 offen sc1 lds
s_add_u32 m0, s39, 71680
s_add_u32 s37, s37, s38
buffer_load_dwordx4 v21, s[8:11], s37 offen sc1 lds
s_add_u32 m0, s39, 72704
s_add_u32 s37, s37, s38
buffer_load_dwordx4 v21, s[8:11], s37 offen sc1 lds
s_waitcnt vmcnt(8)
s_barrier
s_add_u32 m0, s39, 98304
s_add_u32 s37, s37, s40
buffer_load_dwordx4 v21, s[8:11], s37 offen sc1 lds
s_add_u32 m0, s39, 99328
s_add_u32 s37, s37, s38
buffer_load_dwordx4 v21, s[8:11], s37 offen sc1 lds
s_add_u32 m0, s39, 100352
s_add_u32 s37, s37, s38
buffer_load_dwordx4 v21, s[8:11], s37 offen sc1 lds
s_add_u32 m0, s39, 101376
s_add_u32 s37, s37, s38
buffer_load_dwordx4 v21, s[8:11], s37 offen sc1 lds
s_add_u32 m0, s39, 102400
s_add_u32 s37, s37, s55
buffer_load_dwordx4 v21, s[8:11], s37 offen sc1 lds
s_add_u32 m0, s39, 103424
s_add_u32 s37, s37, s38
buffer_load_dwordx4 v21, s[8:11], s37 offen sc1 lds
s_add_u32 m0, s39, 104448
s_add_u32 s37, s37, s38
buffer_load_dwordx4 v21, s[8:11], s37 offen sc1 lds
s_add_u32 m0, s39, 105472
s_add_u32 s37, s37, s38
buffer_load_dwordx4 v21, s[8:11], s37 offen sc1 lds
s_waitcnt vmcnt(18)
s_barrier
s_add_u32 m0, s39, 0
s_add_u32 s37, s37, s40
buffer_load_dwordx4 v21, s[8:11], s37 offen sc1 lds
s_add_u32 m0, s39, 1024
s_add_u32 s37, s37, s38
buffer_load_dwordx4 v21, s[8:11], s37 offen sc1 lds
s_add_u32 m0, s39, 2048
s_add_u32 s37, s37, s38
buffer_load_dwordx4 v21, s[8:11], s37 offen sc1 lds
s_add_u32 m0, s39, 3072
s_add_u32 s37, s37, s38
buffer_load_dwordx4 v21, s[8:11], s37 offen sc1 lds
s_add_u32 m0, s39, 4096
s_add_u32 s37, s37, s55
buffer_load_dwordx4 v21, s[8:11], s37 offen sc1 lds
s_add_u32 m0, s39, 5120
s_add_u32 s37, s37, s38
buffer_load_dwordx4 v21, s[8:11], s37 offen sc1 lds
s_add_u32 m0, s39, 6144
s_add_u32 s37, s37, s38
buffer_load_dwordx4 v21, s[8:11], s37 offen sc1 lds
s_add_u32 m0, s39, 7168
s_add_u32 s37, s37, s38
buffer_load_dwordx4 v21, s[8:11], s37 offen sc1 lds
s_waitcnt vmcnt(16)
s_barrier
s_add_u32 m0, s39, 32768
s_add_u32 s37, s37, s40
buffer_load_dwordx4 v21, s[8:11], s37 offen sc1 lds
s_add_u32 m0, s39, 33792
s_add_u32 s37, s37, s38
buffer_load_dwordx4 v21, s[8:11], s37 offen sc1 lds
s_add_u32 m0, s39, 34816
s_add_u32 s37, s37, s38
buffer_load_dwordx4 v21, s[8:11], s37 offen sc1 lds
s_add_u32 m0, s39, 35840
s_add_u32 s37, s37, s38
buffer_load_dwordx4 v21, s[8:11], s37 offen sc1 lds
s_add_u32 m0, s39, 36864
s_add_u32 s37, s37, s55
buffer_load_dwordx4 v21, s[8:11], s37 offen sc1 lds
s_add_u32 m0, s39, 37888
s_add_u32 s37, s37, s38
buffer_load_dwordx4 v21, s[8:11], s37 offen sc1 lds
s_add_u32 m0, s39, 38912
s_add_u32 s37, s37, s38
buffer_load_dwordx4 v21, s[8:11], s37 offen sc1 lds
s_add_u32 m0, s39, 39936
s_add_u32 s37, s37, s38
buffer_load_dwordx4 v21, s[8:11], s37 offen sc1 lds
s_waitcnt vmcnt(16)
s_barrier
s_add_u32 m0, s39, 65536
s_add_u32 s37, s37, s40
buffer_load_dwordx4 v21, s[8:11], s37 offen sc1 lds
s_add_u32 m0, s39, 66560
s_add_u32 s37, s37, s38
buffer_load_dwordx4 v21, s[8:11], s37 offen sc1 lds
s_add_u32 m0, s39, 67584
s_add_u32 s37, s37, s38
buffer_load_dwordx4 v21, s[8:11], s37 offen sc1 lds
s_add_u32 m0, s39, 68608
s_add_u32 s37, s37, s38
buffer_load_dwordx4 v21, s[8:11], s37 offen sc1 lds
s_add_u32 m0, s39, 69632
s_add_u32 s37, s37, s55
buffer_load_dwordx4 v21, s[8:11], s37 offen sc1 lds
s_add_u32 m0, s39, 70656
s_add_u32 s37, s37, s38
buffer_load_dwordx4 v21, s[8:11], s37 offen sc1 lds
s_add_u32 m0, s39, 71680
s_add_u32 s37, s37, s38
buffer_load_dwordx4 v21, s[8:11], s37 offen sc1 lds
s_add_u32 m0, s39, 72704
s_add_u32 s37, s37, s38
buffer_load_dwordx4 v21, s[8:11], s37 offen sc1 lds
s_waitcnt vmcnt(16)
s_barrier
s_add_u32 m0, s39, 98304
s_add_u32 s37, s37, s40
buffer_load_dwordx4 v21, s[8:11], s37 offen sc1 lds
s_add_u32 m0, s39, 99328
s_add_u32 s37, s37, s38
buffer_load_dwordx4 v21, s[8:11], s37 offen sc1 lds
s_add_u32 m0, s39, 100352
s_add_u32 s37, s37, s38
buffer_load_dwordx4 v21, s[8:11], s37 offen sc1 lds
s_add_u32 m0, s39, 101376
s_add_u32 s37, s37, s38
buffer_load_dwordx4 v21, s[8:11], s37 offen sc1 lds
s_add_u32 m0, s39, 102400
s_add_u32 s37, s37, s55
buffer_load_dwordx4 v21, s[8:11], s37 offen sc1 lds
s_add_u32 m0, s39, 103424
s_add_u32 s37, s37, s38
buffer_load_dwordx4 v21, s[8:11], s37 offen sc1 lds
s_add_u32 m0, s39, 104448
s_add_u32 s37, s37, s38
buffer_load_dwordx4 v21, s[8:11], s37 offen sc1 lds
s_add_u32 m0, s39, 105472
s_add_u32 s37, s37, s38
buffer_load_dwordx4 v21, s[8:11], s37 offen sc1 lds
s_waitcnt vmcnt(16)
s_barrier
s_cmp_eq_u32 s51, 2
s_cbranch_scc1 LW4_54
s_mul_i32 s40, s53, 98304
s_add_u32 m0, s39, 0
s_add_u32 s37, s40, 524288
buffer_load_dwordx4 v21, s[8:11], s37 offen sc1 lds
s_add_u32 m0, s39, 1024
s_add_u32 s37, s40, 525312
buffer_load_dwordx4 v21, s[8:11], s37 offen sc1 lds
s_add_u32 m0, s39, 2048
s_add_u32 s37, s40, 526336
buffer_load_dwordx4 v21, s[8:11], s37 offen sc1 lds
s_add_u32 m0, s39, 3072
s_add_u32 s37, s40, 527360
buffer_load_dwordx4 v21, s[8:11], s37 offen sc1 lds
s_add_u32 m0, s39, 4096
s_add_u32 s37, s40, 528384
buffer_load_dwordx4 v21, s[8:11], s37 offen sc1 lds
s_add_u32 m0, s39, 5120
s_add_u32 s37, s40, 529408
buffer_load_dwordx4 v21, s[8:11], s37 offen sc1 lds
s_add_u32 m0, s39, 6144
s_add_u32 s37, s40, 530432
buffer_load_dwordx4 v21, s[8:11], s37 offen sc1 lds
s_add_u32 m0, s39, 7168
s_add_u32 s37, s40, 531456
buffer_load_dwordx4 v21, s[8:11], s37 offen sc1 lds
s_waitcnt vmcnt(16)
s_barrier
s_add_u32 m0, s39, 32768
s_add_u32 s37, s40, 540672
buffer_load_dwordx4 v21, s[8:11], s37 offen sc1 lds
s_add_u32 m0, s39, 33792
s_add_u32 s37, s40, 541696
buffer_load_dwordx4 v21, s[8:11], s37 offen sc1 lds
s_add_u32 m0, s39, 34816
s_add_u32 s37, s40, 542720
buffer_load_dwordx4 v21, s[8:11], s37 offen sc1 lds
s_add_u32 m0, s39, 35840
s_add_u32 s37, s40, 543744
buffer_load_dwordx4 v21, s[8:11], s37 offen sc1 lds
s_add_u32 m0, s39, 36864
s_add_u32 s37, s40, 544768
buffer_load_dwordx4 v21, s[8:11], s37 offen sc1 lds
s_add_u32 m0, s39, 37888
s_add_u32 s37, s40, 545792
buffer_load_dwordx4 v21, s[8:11], s37 offen sc1 lds
s_add_u32 m0, s39, 38912
s_add_u32 s37, s40, 546816
buffer_load_dwordx4 v21, s[8:11], s37 offen sc1 lds
s_add_u32 m0, s39, 39936
s_add_u32 s37, s40, 547840
buffer_load_dwordx4 v21, s[8:11], s37 offen sc1 lds
s_waitcnt vmcnt(16)
s_barrier
s_add_u32 m0, s39, 65536
s_add_u32 s37, s40, 557056
buffer_load_dwordx4 v21, s[8:11], s37 offen sc1 lds
s_add_u32 m0, s39, 66560
s_add_u32 s37, s40, 558080
buffer_load_dwordx4 v21, s[8:11], s37 offen sc1 lds
s_add_u32 m0, s39, 67584
s_add_u32 s37, s40, 559104
buffer_load_dwordx4 v21, s[8:11], s37 offen sc1 lds
s_add_u32 m0, s39, 68608
s_add_u32 s37, s40, 560128
buffer_load_dwordx4 v21, s[8:11], s37 offen sc1 lds
s_add_u32 m0, s39, 69632
s_add_u32 s37, s40, 561152
buffer_load_dwordx4 v21, s[8:11], s37 offen sc1 lds
s_add_u32 m0, s39, 70656
s_add_u32 s37, s40, 562176
buffer_load_dwordx4 v21, s[8:11], s37 offen sc1 lds
s_add_u32 m0, s39, 71680
s_add_u32 s37, s40, 563200
buffer_load_dwordx4 v21, s[8:11], s37 offen sc1 lds
s_add_u32 m0, s39, 72704
s_add_u32 s37, s40, 564224
buffer_load_dwordx4 v21, s[8:11], s37 offen sc1 lds
s_waitcnt vmcnt(16)
s_barrier
s_add_u32 m0, s39, 98304
s_add_u32 s37, s40, 573440
buffer_load_dwordx4 v21, s[8:11], s37 offen sc1 lds
s_add_u32 m0, s39, 99328
s_add_u32 s37, s40, 574464
buffer_load_dwordx4 v21, s[8:11], s37 offen sc1 lds
s_add_u32 m0, s39, 100352
s_add_u32 s37, s40, 575488
buffer_load_dwordx4 v21, s[8:11], s37 offen sc1 lds
s_add_u32 m0, s39, 101376
s_add_u32 s37, s40, 576512
buffer_load_dwordx4 v21, s[8:11], s37 offen sc1 lds
s_add_u32 m0, s39, 102400
s_add_u32 s37, s40, 577536
buffer_load_dwordx4 v21, s[8:11], s37 offen sc1 lds
s_add_u32 m0, s39, 103424
s_add_u32 s37, s40, 578560
buffer_load_dwordx4 v21, s[8:11], s37 offen sc1 lds
s_add_u32 m0, s39, 104448
s_add_u32 s37, s40, 579584
buffer_load_dwordx4 v21, s[8:11], s37 offen sc1 lds
s_add_u32 m0, s39, 105472
s_add_u32 s37, s40, 580608
buffer_load_dwordx4 v21, s[8:11], s37 offen sc1 lds
s_waitcnt vmcnt(16)
s_barrier
s_add_u32 m0, s39, 0
s_add_u32 s37, s40, 589824
buffer_load_dwordx4 v21, s[8:11], s37 offen sc1 lds
s_add_u32 m0, s39, 1024
s_add_u32 s37, s40, 590848
buffer_load_dwordx4 v21, s[8:11], s37 offen sc1 lds
s_add_u32 m0, s39, 2048
s_add_u32 s37, s40, 591872
buffer_load_dwordx4 v21, s[8:11], s37 offen sc1 lds
s_add_u32 m0, s39, 3072
s_add_u32 s37, s40, 592896
buffer_load_dwordx4 v21, s[8:11], s37 offen sc1 lds
s_add_u32 m0, s39, 4096
s_add_u32 s37, s40, 593920
buffer_load_dwordx4 v21, s[8:11], s37 offen sc1 lds
s_add_u32 m0, s39, 5120
s_add_u32 s37, s40, 594944
buffer_load_dwordx4 v21, s[8:11], s37 offen sc1 lds
s_add_u32 m0, s39, 6144
s_add_u32 s37, s40, 595968
buffer_load_dwordx4 v21, s[8:11], s37 offen sc1 lds
s_add_u32 m0, s39, 7168
s_add_u32 s37, s40, 596992
buffer_load_dwordx4 v21, s[8:11], s37 offen sc1 lds
s_waitcnt vmcnt(16)
s_barrier
s_add_u32 m0, s39, 32768
s_add_u32 s37, s40, 606208
buffer_load_dwordx4 v21, s[8:11], s37 offen sc1 lds
s_add_u32 m0, s39, 33792
s_add_u32 s37, s40, 607232
buffer_load_dwordx4 v21, s[8:11], s37 offen sc1 lds
s_add_u32 m0, s39, 34816
s_add_u32 s37, s40, 608256
buffer_load_dwordx4 v21, s[8:11], s37 offen sc1 lds
s_add_u32 m0, s39, 35840
s_add_u32 s37, s40, 609280
buffer_load_dwordx4 v21, s[8:11], s37 offen sc1 lds
s_add_u32 m0, s39, 36864
s_add_u32 s37, s40, 610304
buffer_load_dwordx4 v21, s[8:11], s37 offen sc1 lds
s_add_u32 m0, s39, 37888
s_add_u32 s37, s40, 611328
buffer_load_dwordx4 v21, s[8:11], s37 offen sc1 lds
s_add_u32 m0, s39, 38912
s_add_u32 s37, s40, 612352
buffer_load_dwordx4 v21, s[8:11], s37 offen sc1 lds
s_add_u32 m0, s39, 39936
s_add_u32 s37, s40, 613376
buffer_load_dwordx4 v21, s[8:11], s37 offen sc1 lds
s_waitcnt vmcnt(16)
s_barrier
s_add_u32 m0, s39, 65536
s_mov_b32 s37, 720896
buffer_load_dwordx4 v21, s[8:11], s37 offen sc1 lds
s_add_u32 m0, s39, 66560
s_mov_b32 s37, 721920
buffer_load_dwordx4 v21, s[8:11], s37 offen sc1 lds
s_add_u32 m0, s39, 67584
s_mov_b32 s37, 722944
buffer_load_dwordx4 v21, s[8:11], s37 offen sc1 lds
s_add_u32 m0, s39, 68608
s_mov_b32 s37, 723968
buffer_load_dwordx4 v21, s[8:11], s37 offen sc1 lds
s_add_u32 m0, s39, 69632
s_mov_b32 s37, 724992
buffer_load_dwordx4 v21, s[8:11], s37 offen sc1 lds
s_add_u32 m0, s39, 70656
s_mov_b32 s37, 726016
buffer_load_dwordx4 v21, s[8:11], s37 offen sc1 lds
s_add_u32 m0, s39, 71680
s_mov_b32 s37, 727040
buffer_load_dwordx4 v21, s[8:11], s37 offen sc1 lds
s_add_u32 m0, s39, 72704
s_mov_b32 s37, 728064
buffer_load_dwordx4 v21, s[8:11], s37 offen sc1 lds
s_waitcnt vmcnt(16)
s_barrier
s_add_u32 m0, s39, 98304
s_mov_b32 s37, 737280
buffer_load_dwordx4 v21, s[8:11], s37 offen sc1 lds
s_add_u32 m0, s39, 99328
s_mov_b32 s37, 738304
buffer_load_dwordx4 v21, s[8:11], s37 offen sc1 lds
s_add_u32 m0, s39, 100352
s_mov_b32 s37, 739328
buffer_load_dwordx4 v21, s[8:11], s37 offen sc1 lds
s_add_u32 m0, s39, 101376
s_mov_b32 s37, 740352
buffer_load_dwordx4 v21, s[8:11], s37 offen sc1 lds
s_add_u32 m0, s39, 102400
s_mov_b32 s37, 741376
buffer_load_dwordx4 v21, s[8:11], s37 offen sc1 lds
s_add_u32 m0, s39, 103424
s_mov_b32 s37, 742400
buffer_load_dwordx4 v21, s[8:11], s37 offen sc1 lds
s_add_u32 m0, s39, 104448
s_mov_b32 s37, 743424
buffer_load_dwordx4 v21, s[8:11], s37 offen sc1 lds
s_add_u32 m0, s39, 105472
s_mov_b32 s37, 744448
buffer_load_dwordx4 v21, s[8:11], s37 offen sc1 lds
s_waitcnt vmcnt(16)
s_barrier
s_add_u32 m0, s39, 0
s_mov_b32 s37, 753664
buffer_load_dwordx4 v21, s[8:11], s37 offen sc1 lds
s_add_u32 m0, s39, 1024
s_mov_b32 s37, 754688
buffer_load_dwordx4 v21, s[8:11], s37 offen sc1 lds
s_add_u32 m0, s39, 2048
s_mov_b32 s37, 755712
buffer_load_dwordx4 v21, s[8:11], s37 offen sc1 lds
s_add_u32 m0, s39, 3072
s_mov_b32 s37, 756736
buffer_load_dwordx4 v21, s[8:11], s37 offen sc1 lds
s_add_u32 m0, s39, 4096
s_mov_b32 s37, 757760
buffer_load_dwordx4 v21, s[8:11], s37 offen sc1 lds
s_add_u32 m0, s39, 5120
s_mov_b32 s37, 758784
buffer_load_dwordx4 v21, s[8:11], s37 offen sc1 lds
s_add_u32 m0, s39, 6144
s_mov_b32 s37, 759808
buffer_load_dwordx4 v21, s[8:11], s37 offen sc1 lds
s_add_u32 m0, s39, 7168
s_mov_b32 s37, 760832
buffer_load_dwordx4 v21, s[8:11], s37 offen sc1 lds
s_waitcnt vmcnt(16)
s_barrier
s_add_u32 m0, s39, 32768
s_mov_b32 s37, 770048
buffer_load_dwordx4 v21, s[8:11], s37 offen sc1 lds
s_add_u32 m0, s39, 33792
s_mov_b32 s37, 771072
buffer_load_dwordx4 v21, s[8:11], s37 offen sc1 lds
s_add_u32 m0, s39, 34816
s_mov_b32 s37, 772096
buffer_load_dwordx4 v21, s[8:11], s37 offen sc1 lds
s_add_u32 m0, s39, 35840
s_mov_b32 s37, 773120
buffer_load_dwordx4 v21, s[8:11], s37 offen sc1 lds
s_add_u32 m0, s39, 36864
s_mov_b32 s37, 774144
buffer_load_dwordx4 v21, s[8:11], s37 offen sc1 lds
s_add_u32 m0, s39, 37888
s_mov_b32 s37, 775168
buffer_load_dwordx4 v21, s[8:11], s37 offen sc1 lds
s_add_u32 m0, s39, 38912
s_mov_b32 s37, 776192
buffer_load_dwordx4 v21, s[8:11], s37 offen sc1 lds
s_add_u32 m0, s39, 39936
s_mov_b32 s37, 777216
buffer_load_dwordx4 v21, s[8:11], s37 offen sc1 lds
s_waitcnt vmcnt(16)
s_barrier
s_add_u32 m0, s39, 65536
s_mov_b32 s37, 786432
buffer_load_dwordx4 v21, s[8:11], s37 offen sc1 lds
s_add_u32 m0, s39, 66560
s_mov_b32 s37, 787456
buffer_load_dwordx4 v21, s[8:11], s37 offen sc1 lds
s_add_u32 m0, s39, 67584
s_mov_b32 s37, 788480
buffer_load_dwordx4 v21, s[8:11], s37 offen sc1 lds
s_add_u32 m0, s39, 68608
s_mov_b32 s37, 789504
buffer_load_dwordx4 v21, s[8:11], s37 offen sc1 lds
s_add_u32 m0, s39, 69632
s_mov_b32 s37, 790528
buffer_load_dwordx4 v21, s[8:11], s37 offen sc1 lds
s_add_u32 m0, s39, 70656
s_mov_b32 s37, 791552
buffer_load_dwordx4 v21, s[8:11], s37 offen sc1 lds
s_add_u32 m0, s39, 71680
s_mov_b32 s37, 792576
buffer_load_dwordx4 v21, s[8:11], s37 offen sc1 lds
s_add_u32 m0, s39, 72704
s_mov_b32 s37, 793600
buffer_load_dwordx4 v21, s[8:11], s37 offen sc1 lds
s_waitcnt vmcnt(16)
s_barrier
s_add_u32 m0, s39, 98304
s_mov_b32 s37, 802816
buffer_load_dwordx4 v21, s[8:11], s37 offen sc1 lds
s_add_u32 m0, s39, 99328
s_mov_b32 s37, 803840
buffer_load_dwordx4 v21, s[8:11], s37 offen sc1 lds
s_add_u32 m0, s39, 100352
s_mov_b32 s37, 804864
buffer_load_dwordx4 v21, s[8:11], s37 offen sc1 lds
s_add_u32 m0, s39, 101376
s_mov_b32 s37, 805888
buffer_load_dwordx4 v21, s[8:11], s37 offen sc1 lds
s_add_u32 m0, s39, 102400
s_mov_b32 s37, 806912
buffer_load_dwordx4 v21, s[8:11], s37 offen sc1 lds
s_add_u32 m0, s39, 103424
s_mov_b32 s37, 807936
buffer_load_dwordx4 v21, s[8:11], s37 offen sc1 lds
s_add_u32 m0, s39, 104448
s_mov_b32 s37, 808960
buffer_load_dwordx4 v21, s[8:11], s37 offen sc1 lds
s_add_u32 m0, s39, 105472
s_mov_b32 s37, 809984
buffer_load_dwordx4 v21, s[8:11], s37 offen sc1 lds
s_waitcnt vmcnt(16)
s_barrier
s_add_u32 m0, s39, 0
s_mov_b32 s37, 819200
buffer_load_dwordx4 v21, s[8:11], s37 offen sc1 lds
s_add_u32 m0, s39, 1024
s_mov_b32 s37, 820224
buffer_load_dwordx4 v21, s[8:11], s37 offen sc1 lds
s_add_u32 m0, s39, 2048
s_mov_b32 s37, 821248
buffer_load_dwordx4 v21, s[8:11], s37 offen sc1 lds
s_add_u32 m0, s39, 3072
s_mov_b32 s37, 822272
buffer_load_dwordx4 v21, s[8:11], s37 offen sc1 lds
s_add_u32 m0, s39, 4096
s_mov_b32 s37, 823296
buffer_load_dwordx4 v21, s[8:11], s37 offen sc1 lds
s_add_u32 m0, s39, 5120
s_mov_b32 s37, 824320
buffer_load_dwordx4 v21, s[8:11], s37 offen sc1 lds
s_add_u32 m0, s39, 6144
s_mov_b32 s37, 825344
buffer_load_dwordx4 v21, s[8:11], s37 offen sc1 lds
s_add_u32 m0, s39, 7168
s_mov_b32 s37, 826368
buffer_load_dwordx4 v21, s[8:11], s37 offen sc1 lds
s_waitcnt vmcnt(16)
s_barrier
s_add_u32 m0, s39, 32768
s_mov_b32 s37, 835584
buffer_load_dwordx4 v21, s[8:11], s37 offen sc1 lds
s_add_u32 m0, s39, 33792
s_mov_b32 s37, 836608
buffer_load_dwordx4 v21, s[8:11], s37 offen sc1 lds
s_add_u32 m0, s39, 34816
s_mov_b32 s37, 837632
buffer_load_dwordx4 v21, s[8:11], s37 offen sc1 lds
s_add_u32 m0, s39, 35840
s_mov_b32 s37, 838656
buffer_load_dwordx4 v21, s[8:11], s37 offen sc1 lds
s_add_u32 m0, s39, 36864
s_mov_b32 s37, 839680
buffer_load_dwordx4 v21, s[8:11], s37 offen sc1 lds
s_add_u32 m0, s39, 37888
s_mov_b32 s37, 840704
buffer_load_dwordx4 v21, s[8:11], s37 offen sc1 lds
s_add_u32 m0, s39, 38912
s_mov_b32 s37, 841728
buffer_load_dwordx4 v21, s[8:11], s37 offen sc1 lds
s_add_u32 m0, s39, 39936
s_mov_b32 s37, 842752
buffer_load_dwordx4 v21, s[8:11], s37 offen sc1 lds
s_waitcnt vmcnt(16)
s_barrier
s_add_u32 m0, s39, 65536
s_mov_b32 s37, 851968
buffer_load_dwordx4 v21, s[8:11], s37 offen sc1 lds
s_add_u32 m0, s39, 66560
s_mov_b32 s37, 852992
buffer_load_dwordx4 v21, s[8:11], s37 offen sc1 lds
s_add_u32 m0, s39, 67584
s_mov_b32 s37, 854016
buffer_load_dwordx4 v21, s[8:11], s37 offen sc1 lds
s_add_u32 m0, s39, 68608
s_mov_b32 s37, 855040
buffer_load_dwordx4 v21, s[8:11], s37 offen sc1 lds
s_add_u32 m0, s39, 69632
s_mov_b32 s37, 856064
buffer_load_dwordx4 v21, s[8:11], s37 offen sc1 lds
s_add_u32 m0, s39, 70656
s_mov_b32 s37, 857088
buffer_load_dwordx4 v21, s[8:11], s37 offen sc1 lds
s_add_u32 m0, s39, 71680
s_mov_b32 s37, 858112
buffer_load_dwordx4 v21, s[8:11], s37 offen sc1 lds
s_add_u32 m0, s39, 72704
s_mov_b32 s37, 859136
buffer_load_dwordx4 v21, s[8:11], s37 offen sc1 lds
s_waitcnt vmcnt(16)
s_barrier
s_add_u32 m0, s39, 98304
s_mov_b32 s37, 868352
buffer_load_dwordx4 v21, s[8:11], s37 offen sc1 lds
s_add_u32 m0, s39, 99328
s_mov_b32 s37, 869376
buffer_load_dwordx4 v21, s[8:11], s37 offen sc1 lds
s_add_u32 m0, s39, 100352
s_mov_b32 s37, 870400
buffer_load_dwordx4 v21, s[8:11], s37 offen sc1 lds
s_add_u32 m0, s39, 101376
s_mov_b32 s37, 871424
buffer_load_dwordx4 v21, s[8:11], s37 offen sc1 lds
s_add_u32 m0, s39, 102400
s_mov_b32 s37, 872448
buffer_load_dwordx4 v21, s[8:11], s37 offen sc1 lds
s_add_u32 m0, s39, 103424
s_mov_b32 s37, 873472
buffer_load_dwordx4 v21, s[8:11], s37 offen sc1 lds
s_add_u32 m0, s39, 104448
s_mov_b32 s37, 874496
buffer_load_dwordx4 v21, s[8:11], s37 offen sc1 lds
s_add_u32 m0, s39, 105472
s_mov_b32 s37, 875520
buffer_load_dwordx4 v21, s[8:11], s37 offen sc1 lds
s_waitcnt vmcnt(16)
s_barrier
s_add_u32 m0, s39, 0
s_mov_b32 s37, 884736
buffer_load_dwordx4 v21, s[8:11], s37 offen sc1 lds
s_add_u32 m0, s39, 1024
s_mov_b32 s37, 885760
buffer_load_dwordx4 v21, s[8:11], s37 offen sc1 lds
s_add_u32 m0, s39, 2048
s_mov_b32 s37, 886784
buffer_load_dwordx4 v21, s[8:11], s37 offen sc1 lds
s_add_u32 m0, s39, 3072
s_mov_b32 s37, 887808
buffer_load_dwordx4 v21, s[8:11], s37 offen sc1 lds
s_add_u32 m0, s39, 4096
s_mov_b32 s37, 888832
buffer_load_dwordx4 v21, s[8:11], s37 offen sc1 lds
s_add_u32 m0, s39, 5120
s_mov_b32 s37, 889856
buffer_load_dwordx4 v21, s[8:11], s37 offen sc1 lds
s_add_u32 m0, s39, 6144
s_mov_b32 s37, 890880
buffer_load_dwordx4 v21, s[8:11], s37 offen sc1 lds
s_add_u32 m0, s39, 7168
s_mov_b32 s37, 891904
buffer_load_dwordx4 v21, s[8:11], s37 offen sc1 lds
s_waitcnt vmcnt(16)
s_barrier
s_add_u32 m0, s39, 32768
s_mov_b32 s37, 901120
buffer_load_dwordx4 v21, s[8:11], s37 offen sc1 lds
s_add_u32 m0, s39, 33792
s_mov_b32 s37, 902144
buffer_load_dwordx4 v21, s[8:11], s37 offen sc1 lds
s_add_u32 m0, s39, 34816
s_mov_b32 s37, 903168
buffer_load_dwordx4 v21, s[8:11], s37 offen sc1 lds
s_add_u32 m0, s39, 35840
s_mov_b32 s37, 904192
buffer_load_dwordx4 v21, s[8:11], s37 offen sc1 lds
s_add_u32 m0, s39, 36864
s_mov_b32 s37, 905216
buffer_load_dwordx4 v21, s[8:11], s37 offen sc1 lds
s_add_u32 m0, s39, 37888
s_mov_b32 s37, 906240
buffer_load_dwordx4 v21, s[8:11], s37 offen sc1 lds
s_add_u32 m0, s39, 38912
s_mov_b32 s37, 907264
buffer_load_dwordx4 v21, s[8:11], s37 offen sc1 lds
s_add_u32 m0, s39, 39936
s_mov_b32 s37, 908288
buffer_load_dwordx4 v21, s[8:11], s37 offen sc1 lds
s_waitcnt vmcnt(16)
s_barrier
s_waitcnt vmcnt(8)
s_barrier
s_waitcnt vmcnt(0)
s_barrier
s_branch Ldone_1
LW4_54:
s_mul_i32 s40, s53, 786432
s_add_u32 m0, s39, 0
s_add_u32 s37, s40, 4194304
buffer_load_dwordx4 v21, s[8:11], s37 offen sc1 lds
s_add_u32 m0, s39, 1024
s_add_u32 s37, s40, 4210688
buffer_load_dwordx4 v21, s[8:11], s37 offen sc1 lds
s_add_u32 m0, s39, 2048
s_add_u32 s37, s40, 4227072
buffer_load_dwordx4 v21, s[8:11], s37 offen sc1 lds
s_add_u32 m0, s39, 3072
s_add_u32 s37, s40, 4243456
buffer_load_dwordx4 v21, s[8:11], s37 offen sc1 lds
s_add_u32 m0, s39, 4096
s_add_u32 s37, s40, 4292608
buffer_load_dwordx4 v21, s[8:11], s37 offen sc1 lds
s_add_u32 m0, s39, 5120
s_add_u32 s37, s40, 4308992
buffer_load_dwordx4 v21, s[8:11], s37 offen sc1 lds
s_add_u32 m0, s39, 6144
s_add_u32 s37, s40, 4325376
buffer_load_dwordx4 v21, s[8:11], s37 offen sc1 lds
s_add_u32 m0, s39, 7168
s_add_u32 s37, s40, 4341760
buffer_load_dwordx4 v21, s[8:11], s37 offen sc1 lds
s_waitcnt vmcnt(16)
s_barrier
s_add_u32 m0, s39, 32768
s_add_u32 s37, s40, 4259840
buffer_load_dwordx4 v21, s[8:11], s37 offen sc1 lds
s_add_u32 m0, s39, 33792
s_add_u32 s37, s40, 4358144
buffer_load_dwordx4 v21, s[8:11], s37 offen sc1 lds
s_add_u32 m0, s39, 34816
s_add_u32 s37, s40, 4276224
buffer_load_dwordx4 v21, s[8:11], s37 offen sc1 lds
s_add_u32 m0, s39, 35840
s_add_u32 s37, s40, 4374528
buffer_load_dwordx4 v21, s[8:11], s37 offen sc1 lds
s_add_u32 m0, s39, 36864
s_add_u32 s37, s40, 4390912
buffer_load_dwordx4 v21, s[8:11], s37 offen sc1 lds
s_add_u32 m0, s39, 37888
s_add_u32 s37, s40, 4407296
buffer_load_dwordx4 v21, s[8:11], s37 offen sc1 lds
s_add_u32 m0, s39, 38912
s_add_u32 s37, s40, 4423680
buffer_load_dwordx4 v21, s[8:11], s37 offen sc1 lds
s_add_u32 m0, s39, 39936
s_add_u32 s37, s40, 4440064
buffer_load_dwordx4 v21, s[8:11], s37 offen sc1 lds
s_waitcnt vmcnt(16)
s_barrier
s_add_u32 m0, s39, 65536
s_add_u32 s37, s40, 4489216
buffer_load_dwordx4 v21, s[8:11], s37 offen sc1 lds
s_add_u32 m0, s39, 66560
s_add_u32 s37, s40, 4505600
buffer_load_dwordx4 v21, s[8:11], s37 offen sc1 lds
s_add_u32 m0, s39, 67584
s_add_u32 s37, s40, 4521984
buffer_load_dwordx4 v21, s[8:11], s37 offen sc1 lds
s_add_u32 m0, s39, 68608
s_add_u32 s37, s40, 4538368
buffer_load_dwordx4 v21, s[8:11], s37 offen sc1 lds
s_add_u32 m0, s39, 69632
s_add_u32 s37, s40, 4456448
buffer_load_dwordx4 v21, s[8:11], s37 offen sc1 lds
s_add_u32 m0, s39, 70656
s_add_u32 s37, s40, 4554752
buffer_load_dwordx4 v21, s[8:11], s37 offen sc1 lds
s_add_u32 m0, s39, 71680
s_add_u32 s37, s40, 4472832
buffer_load_dwordx4 v21, s[8:11], s37 offen sc1 lds
s_add_u32 m0, s39, 72704
s_add_u32 s37, s40, 4571136
buffer_load_dwordx4 v21, s[8:11], s37 offen sc1 lds
s_waitcnt vmcnt(16)
s_barrier
s_add_u32 m0, s39, 98304
s_add_u32 s37, s40, 4587520
buffer_load_dwordx4 v21, s[8:11], s37 offen sc1 lds
s_add_u32 m0, s39, 99328
s_add_u32 s37, s40, 4603904
buffer_load_dwordx4 v21, s[8:11], s37 offen sc1 lds
s_add_u32 m0, s39, 100352
s_add_u32 s37, s40, 4620288
buffer_load_dwordx4 v21, s[8:11], s37 offen sc1 lds
s_add_u32 m0, s39, 101376
s_add_u32 s37, s40, 4636672
buffer_load_dwordx4 v21, s[8:11], s37 offen sc1 lds
s_add_u32 m0, s39, 102400
s_add_u32 s37, s40, 4685824
buffer_load_dwordx4 v21, s[8:11], s37 offen sc1 lds
s_add_u32 m0, s39, 103424
s_add_u32 s37, s40, 4702208
buffer_load_dwordx4 v21, s[8:11], s37 offen sc1 lds
s_add_u32 m0, s39, 104448
s_add_u32 s37, s40, 4718592
buffer_load_dwordx4 v21, s[8:11], s37 offen sc1 lds
s_add_u32 m0, s39, 105472
s_add_u32 s37, s40, 4734976
buffer_load_dwordx4 v21, s[8:11], s37 offen sc1 lds
s_waitcnt vmcnt(16)
s_barrier
s_add_u32 m0, s39, 0
s_add_u32 s37, s40, 4653056
buffer_load_dwordx4 v21, s[8:11], s37 offen sc1 lds
s_add_u32 m0, s39, 1024
s_add_u32 s37, s40, 4751360
buffer_load_dwordx4 v21, s[8:11], s37 offen sc1 lds
s_add_u32 m0, s39, 2048
s_add_u32 s37, s40, 4669440
buffer_load_dwordx4 v21, s[8:11], s37 offen sc1 lds
s_add_u32 m0, s39, 3072
s_add_u32 s37, s40, 4767744
buffer_load_dwordx4 v21, s[8:11], s37 offen sc1 lds
s_add_u32 m0, s39, 4096
s_add_u32 s37, s40, 4784128
buffer_load_dwordx4 v21, s[8:11], s37 offen sc1 lds
s_add_u32 m0, s39, 5120
s_add_u32 s37, s40, 4800512
buffer_load_dwordx4 v21, s[8:11], s37 offen sc1 lds
s_add_u32 m0, s39, 6144
s_add_u32 s37, s40, 4816896
buffer_load_dwordx4 v21, s[8:11], s37 offen sc1 lds
s_add_u32 m0, s39, 7168
s_add_u32 s37, s40, 4833280
buffer_load_dwordx4 v21, s[8:11], s37 offen sc1 lds
s_waitcnt vmcnt(16)
s_barrier
s_add_u32 m0, s39, 32768
s_add_u32 s37, s40, 4882432
buffer_load_dwordx4 v21, s[8:11], s37 offen sc1 lds
s_add_u32 m0, s39, 33792
s_add_u32 s37, s40, 4898816
buffer_load_dwordx4 v21, s[8:11], s37 offen sc1 lds
s_add_u32 m0, s39, 34816
s_add_u32 s37, s40, 4915200
buffer_load_dwordx4 v21, s[8:11], s37 offen sc1 lds
s_add_u32 m0, s39, 35840
s_add_u32 s37, s40, 4931584
buffer_load_dwordx4 v21, s[8:11], s37 offen sc1 lds
s_add_u32 m0, s39, 36864
s_add_u32 s37, s40, 4849664
buffer_load_dwordx4 v21, s[8:11], s37 offen sc1 lds
s_add_u32 m0, s39, 37888
s_add_u32 s37, s40, 4947968
buffer_load_dwordx4 v21, s[8:11], s37 offen sc1 lds
s_add_u32 m0, s39, 38912
s_add_u32 s37, s40, 4866048
buffer_load_dwordx4 v21, s[8:11], s37 offen sc1 lds
s_add_u32 m0, s39, 39936
s_add_u32 s37, s40, 4964352
buffer_load_dwordx4 v21, s[8:11], s37 offen sc1 lds
s_waitcnt vmcnt(16)
s_barrier
s_add_u32 m0, s39, 65536
s_mov_b32 s37, 5767168
buffer_load_dwordx4 v21, s[8:11], s37 offen sc1 lds
s_add_u32 m0, s39, 66560
s_mov_b32 s37, 5783552
buffer_load_dwordx4 v21, s[8:11], s37 offen sc1 lds
s_add_u32 m0, s39, 67584
s_mov_b32 s37, 5799936
buffer_load_dwordx4 v21, s[8:11], s37 offen sc1 lds
s_add_u32 m0, s39, 68608
s_mov_b32 s37, 5816320
buffer_load_dwordx4 v21, s[8:11], s37 offen sc1 lds
s_add_u32 m0, s39, 69632
s_mov_b32 s37, 5865472
buffer_load_dwordx4 v21, s[8:11], s37 offen sc1 lds
s_add_u32 m0, s39, 70656
s_mov_b32 s37, 5881856
buffer_load_dwordx4 v21, s[8:11], s37 offen sc1 lds
s_add_u32 m0, s39, 71680
s_mov_b32 s37, 5898240
buffer_load_dwordx4 v21, s[8:11], s37 offen sc1 lds
s_add_u32 m0, s39, 72704
s_mov_b32 s37, 5914624
buffer_load_dwordx4 v21, s[8:11], s37 offen sc1 lds
s_waitcnt vmcnt(16)
s_barrier
s_add_u32 m0, s39, 98304
s_mov_b32 s37, 5832704
buffer_load_dwordx4 v21, s[8:11], s37 offen sc1 lds
s_add_u32 m0, s39, 99328
s_mov_b32 s37, 5931008
buffer_load_dwordx4 v21, s[8:11], s37 offen sc1 lds
s_add_u32 m0, s39, 100352
s_mov_b32 s37, 5849088
buffer_load_dwordx4 v21, s[8:11], s37 offen sc1 lds
s_add_u32 m0, s39, 101376
s_mov_b32 s37, 5947392
buffer_load_dwordx4 v21, s[8:11], s37 offen sc1 lds
s_add_u32 m0, s39, 102400
s_mov_b32 s37, 5963776
buffer_load_dwordx4 v21, s[8:11], s37 offen sc1 lds
s_add_u32 m0, s39, 103424
s_mov_b32 s37, 5980160
buffer_load_dwordx4 v21, s[8:11], s37 offen sc1 lds
s_add_u32 m0, s39, 104448
s_mov_b32 s37, 5996544
buffer_load_dwordx4 v21, s[8:11], s37 offen sc1 lds
s_add_u32 m0, s39, 105472
s_mov_b32 s37, 6012928
buffer_load_dwordx4 v21, s[8:11], s37 offen sc1 lds
s_waitcnt vmcnt(16)
s_barrier
s_add_u32 m0, s39, 0
s_mov_b32 s37, 6062080
buffer_load_dwordx4 v21, s[8:11], s37 offen sc1 lds
s_add_u32 m0, s39, 1024
s_mov_b32 s37, 6078464
buffer_load_dwordx4 v21, s[8:11], s37 offen sc1 lds
s_add_u32 m0, s39, 2048
s_mov_b32 s37, 6094848
buffer_load_dwordx4 v21, s[8:11], s37 offen sc1 lds
s_add_u32 m0, s39, 3072
s_mov_b32 s37, 6111232
buffer_load_dwordx4 v21, s[8:11], s37 offen sc1 lds
s_add_u32 m0, s39, 4096
s_mov_b32 s37, 6029312
buffer_load_dwordx4 v21, s[8:11], s37 offen sc1 lds
s_add_u32 m0, s39, 5120
s_mov_b32 s37, 6127616
buffer_load_dwordx4 v21, s[8:11], s37 offen sc1 lds
s_add_u32 m0, s39, 6144
s_mov_b32 s37, 6045696
buffer_load_dwordx4 v21, s[8:11], s37 offen sc1 lds
s_add_u32 m0, s39, 7168
s_mov_b32 s37, 6144000
buffer_load_dwordx4 v21, s[8:11], s37 offen sc1 lds
s_waitcnt vmcnt(16)
s_barrier
s_add_u32 m0, s39, 32768
s_mov_b32 s37, 6160384
buffer_load_dwordx4 v21, s[8:11], s37 offen sc1 lds
s_add_u32 m0, s39, 33792
s_mov_b32 s37, 6176768
buffer_load_dwordx4 v21, s[8:11], s37 offen sc1 lds
s_add_u32 m0, s39, 34816
s_mov_b32 s37, 6193152
buffer_load_dwordx4 v21, s[8:11], s37 offen sc1 lds
s_add_u32 m0, s39, 35840
s_mov_b32 s37, 6209536
buffer_load_dwordx4 v21, s[8:11], s37 offen sc1 lds
s_add_u32 m0, s39, 36864
s_mov_b32 s37, 6258688
buffer_load_dwordx4 v21, s[8:11], s37 offen sc1 lds
s_add_u32 m0, s39, 37888
s_mov_b32 s37, 6275072
buffer_load_dwordx4 v21, s[8:11], s37 offen sc1 lds
s_add_u32 m0, s39, 38912
s_mov_b32 s37, 6291456
buffer_load_dwordx4 v21, s[8:11], s37 offen sc1 lds
s_add_u32 m0, s39, 39936
s_mov_b32 s37, 6307840
buffer_load_dwordx4 v21, s[8:11], s37 offen sc1 lds
s_waitcnt vmcnt(16)
s_barrier
s_add_u32 m0, s39, 65536
s_mov_b32 s37, 6225920
buffer_load_dwordx4 v21, s[8:11], s37 offen sc1 lds
s_add_u32 m0, s39, 66560
s_mov_b32 s37, 6324224
buffer_load_dwordx4 v21, s[8:11], s37 offen sc1 lds
s_add_u32 m0, s39, 67584
s_mov_b32 s37, 6242304
buffer_load_dwordx4 v21, s[8:11], s37 offen sc1 lds
s_add_u32 m0, s39, 68608
s_mov_b32 s37, 6340608
buffer_load_dwordx4 v21, s[8:11], s37 offen sc1 lds
s_add_u32 m0, s39, 69632
s_mov_b32 s37, 6356992
buffer_load_dwordx4 v21, s[8:11], s37 offen sc1 lds
s_add_u32 m0, s39, 70656
s_mov_b32 s37, 6373376
buffer_load_dwordx4 v21, s[8:11], s37 offen sc1 lds
s_add_u32 m0, s39, 71680
s_mov_b32 s37, 6389760
buffer_load_dwordx4 v21, s[8:11], s37 offen sc1 lds
s_add_u32 m0, s39, 72704
s_mov_b32 s37, 6406144
buffer_load_dwordx4 v21, s[8:11], s37 offen sc1 lds
s_waitcnt vmcnt(16)
s_barrier
s_add_u32 m0, s39, 98304
s_mov_b32 s37, 6455296
buffer_load_dwordx4 v21, s[8:11], s37 offen sc1 lds
s_add_u32 m0, s39, 99328
s_mov_b32 s37, 6471680
buffer_load_dwordx4 v21, s[8:11], s37 offen sc1 lds
s_add_u32 m0, s39, 100352
s_mov_b32 s37, 6488064
buffer_load_dwordx4 v21, s[8:11], s37 offen sc1 lds
s_add_u32 m0, s39, 101376
s_mov_b32 s37, 6504448
buffer_load_dwordx4 v21, s[8:11], s37 offen sc1 lds
s_add_u32 m0, s39, 102400
s_mov_b32 s37, 6422528
buffer_load_dwordx4 v21, s[8:11], s37 offen sc1 lds
s_add_u32 m0, s39, 103424
s_mov_b32 s37, 6520832
buffer_load_dwordx4 v21, s[8:11], s37 offen sc1 lds
s_add_u32 m0, s39, 104448
s_mov_b32 s37, 6438912
buffer_load_dwordx4 v21, s[8:11], s37 offen sc1 lds
s_add_u32 m0, s39, 105472
s_mov_b32 s37, 6537216
buffer_load_dwordx4 v21, s[8:11], s37 offen sc1 lds
s_waitcnt vmcnt(16)
s_barrier
s_add_u32 m0, s39, 0
s_mov_b32 s37, 6553600
buffer_load_dwordx4 v21, s[8:11], s37 offen sc1 lds
s_add_u32 m0, s39, 1024
s_mov_b32 s37, 6569984
buffer_load_dwordx4 v21, s[8:11], s37 offen sc1 lds
s_add_u32 m0, s39, 2048
s_mov_b32 s37, 6586368
buffer_load_dwordx4 v21, s[8:11], s37 offen sc1 lds
s_add_u32 m0, s39, 3072
s_mov_b32 s37, 6602752
buffer_load_dwordx4 v21, s[8:11], s37 offen sc1 lds
s_add_u32 m0, s39, 4096
s_mov_b32 s37, 6651904
buffer_load_dwordx4 v21, s[8:11], s37 offen sc1 lds
s_add_u32 m0, s39, 5120
s_mov_b32 s37, 6668288
buffer_load_dwordx4 v21, s[8:11], s37 offen sc1 lds
s_add_u32 m0, s39, 6144
s_mov_b32 s37, 6684672
buffer_load_dwordx4 v21, s[8:11], s37 offen sc1 lds
s_add_u32 m0, s39, 7168
s_mov_b32 s37, 6701056
buffer_load_dwordx4 v21, s[8:11], s37 offen sc1 lds
s_waitcnt vmcnt(16)
s_barrier
s_add_u32 m0, s39, 32768
s_mov_b32 s37, 6619136
buffer_load_dwordx4 v21, s[8:11], s37 offen sc1 lds
s_add_u32 m0, s39, 33792
s_mov_b32 s37, 6717440
buffer_load_dwordx4 v21, s[8:11], s37 offen sc1 lds
s_add_u32 m0, s39, 34816
s_mov_b32 s37, 6635520
buffer_load_dwordx4 v21, s[8:11], s37 offen sc1 lds
s_add_u32 m0, s39, 35840
s_mov_b32 s37, 6733824
buffer_load_dwordx4 v21, s[8:11], s37 offen sc1 lds
s_add_u32 m0, s39, 36864
s_mov_b32 s37, 6750208
buffer_load_dwordx4 v21, s[8:11], s37 offen sc1 lds
s_add_u32 m0, s39, 37888
s_mov_b32 s37, 6766592
buffer_load_dwordx4 v21, s[8:11], s37 offen sc1 lds
s_add_u32 m0, s39, 38912
s_mov_b32 s37, 6782976
buffer_load_dwordx4 v21, s[8:11], s37 offen sc1 lds
s_add_u32 m0, s39, 39936
s_mov_b32 s37, 6799360
buffer_load_dwordx4 v21, s[8:11], s37 offen sc1 lds
s_waitcnt vmcnt(16)
s_barrier
s_add_u32 m0, s39, 65536
s_mov_b32 s37, 6848512
buffer_load_dwordx4 v21, s[8:11], s37 offen sc1 lds
s_add_u32 m0, s39, 66560
s_mov_b32 s37, 6864896
buffer_load_dwordx4 v21, s[8:11], s37 offen sc1 lds
s_add_u32 m0, s39, 67584
s_mov_b32 s37, 6881280
buffer_load_dwordx4 v21, s[8:11], s37 offen sc1 lds
s_add_u32 m0, s39, 68608
s_mov_b32 s37, 6897664
buffer_load_dwordx4 v21, s[8:11], s37 offen sc1 lds
s_add_u32 m0, s39, 69632
s_mov_b32 s37, 6815744
buffer_load_dwordx4 v21, s[8:11], s37 offen sc1 lds
s_add_u32 m0, s39, 70656
s_mov_b32 s37, 6914048
buffer_load_dwordx4 v21, s[8:11], s37 offen sc1 lds
s_add_u32 m0, s39, 71680
s_mov_b32 s37, 6832128
buffer_load_dwordx4 v21, s[8:11], s37 offen sc1 lds
s_add_u32 m0, s39, 72704
s_mov_b32 s37, 6930432
buffer_load_dwordx4 v21, s[8:11], s37 offen sc1 lds
s_waitcnt vmcnt(16)
s_barrier
s_add_u32 m0, s39, 98304
s_mov_b32 s37, 6946816
buffer_load_dwordx4 v21, s[8:11], s37 offen sc1 lds
s_add_u32 m0, s39, 99328
s_mov_b32 s37, 6963200
buffer_load_dwordx4 v21, s[8:11], s37 offen sc1 lds
s_add_u32 m0, s39, 100352
s_mov_b32 s37, 6979584
buffer_load_dwordx4 v21, s[8:11], s37 offen sc1 lds
s_add_u32 m0, s39, 101376
s_mov_b32 s37, 6995968
buffer_load_dwordx4 v21, s[8:11], s37 offen sc1 lds
s_add_u32 m0, s39, 102400
s_mov_b32 s37, 7045120
buffer_load_dwordx4 v21, s[8:11], s37 offen sc1 lds
s_add_u32 m0, s39, 103424
s_mov_b32 s37, 7061504
buffer_load_dwordx4 v21, s[8:11], s37 offen sc1 lds
s_add_u32 m0, s39, 104448
s_mov_b32 s37, 7077888
buffer_load_dwordx4 v21, s[8:11], s37 offen sc1 lds
s_add_u32 m0, s39, 105472
s_mov_b32 s37, 7094272
buffer_load_dwordx4 v21, s[8:11], s37 offen sc1 lds
s_waitcnt vmcnt(16)
s_barrier
s_add_u32 m0, s39, 0
s_mov_b32 s37, 7012352
buffer_load_dwordx4 v21, s[8:11], s37 offen sc1 lds
s_add_u32 m0, s39, 1024
s_mov_b32 s37, 7110656
buffer_load_dwordx4 v21, s[8:11], s37 offen sc1 lds
s_add_u32 m0, s39, 2048
s_mov_b32 s37, 7028736
buffer_load_dwordx4 v21, s[8:11], s37 offen sc1 lds
s_add_u32 m0, s39, 3072
s_mov_b32 s37, 7127040
buffer_load_dwordx4 v21, s[8:11], s37 offen sc1 lds
s_add_u32 m0, s39, 4096
s_mov_b32 s37, 7143424
buffer_load_dwordx4 v21, s[8:11], s37 offen sc1 lds
s_add_u32 m0, s39, 5120
s_mov_b32 s37, 7159808
buffer_load_dwordx4 v21, s[8:11], s37 offen sc1 lds
s_add_u32 m0, s39, 6144
s_mov_b32 s37, 7176192
buffer_load_dwordx4 v21, s[8:11], s37 offen sc1 lds
s_add_u32 m0, s39, 7168
s_mov_b32 s37, 7192576
buffer_load_dwordx4 v21, s[8:11], s37 offen sc1 lds
s_waitcnt vmcnt(16)
s_barrier
s_add_u32 m0, s39, 32768
s_mov_b32 s37, 7241728
buffer_load_dwordx4 v21, s[8:11], s37 offen sc1 lds
s_add_u32 m0, s39, 33792
s_mov_b32 s37, 7258112
buffer_load_dwordx4 v21, s[8:11], s37 offen sc1 lds
s_add_u32 m0, s39, 34816
s_mov_b32 s37, 7274496
buffer_load_dwordx4 v21, s[8:11], s37 offen sc1 lds
s_add_u32 m0, s39, 35840
s_mov_b32 s37, 7290880
buffer_load_dwordx4 v21, s[8:11], s37 offen sc1 lds
s_add_u32 m0, s39, 36864
s_mov_b32 s37, 7208960
buffer_load_dwordx4 v21, s[8:11], s37 offen sc1 lds
s_add_u32 m0, s39, 37888
s_mov_b32 s37, 7307264
buffer_load_dwordx4 v21, s[8:11], s37 offen sc1 lds
s_add_u32 m0, s39, 38912
s_mov_b32 s37, 7225344
buffer_load_dwordx4 v21, s[8:11], s37 offen sc1 lds
s_add_u32 m0, s39, 39936
s_mov_b32 s37, 7323648
buffer_load_dwordx4 v21, s[8:11], s37 offen sc1 lds
s_waitcnt vmcnt(16)
s_barrier
s_waitcnt vmcnt(8)
s_barrier
s_waitcnt vmcnt(0)
s_barrier
s_branch Ldone_1
L7b_53:
v_mfma_f32_16x16x32_bf16 v[128:131], v[96:99], v[80:83], v[128:131]
v_mfma_f32_16x16x32_bf16 v[132:135], v[96:99], v[84:87], v[132:135]
v_mfma_f32_16x16x32_bf16 v[136:139], v[96:99], v[88:91], v[136:139]
v_mfma_f32_16x16x32_bf16 v[140:143], v[96:99], v[92:95], v[140:143]
v_mfma_f32_16x16x32_bf16 v[188:191], v[108:111], v[92:95], v[188:191]
v_mfma_f32_16x16x32_bf16 v[184:187], v[108:111], v[88:91], v[184:187]
v_mfma_f32_16x16x32_bf16 v[180:183], v[108:111], v[84:87], v[180:183]
v_mfma_f32_16x16x32_bf16 v[176:179], v[108:111], v[80:83], v[176:179]
v_mfma_f32_16x16x32_bf16 v[144:147], v[100:103], v[80:83], v[144:147]
v_mfma_f32_16x16x32_bf16 v[148:151], v[100:103], v[84:87], v[148:151]
v_mfma_f32_16x16x32_bf16 v[152:155], v[100:103], v[88:91], v[152:155]
v_mfma_f32_16x16x32_bf16 v[156:159], v[100:103], v[92:95], v[156:159]
v_mfma_f32_16x16x32_bf16 v[204:207], v[112:115], v[92:95], v[204:207]
v_mfma_f32_16x16x32_bf16 v[200:203], v[112:115], v[88:91], v[200:203]
v_mfma_f32_16x16x32_bf16 v[196:199], v[112:115], v[84:87], v[196:199]
v_mfma_f32_16x16x32_bf16 v[192:195], v[112:115], v[80:83], v[192:195]
v_mfma_f32_16x16x32_bf16 v[160:163], v[104:107], v[80:83], v[160:163]
v_mfma_f32_16x16x32_bf16 v[164:167], v[104:107], v[84:87], v[164:167]
v_mfma_f32_16x16x32_bf16 v[168:171], v[104:107], v[88:91], v[168:171]
v_mfma_f32_16x16x32_bf16 v[172:175], v[104:107], v[92:95], v[172:175]
v_mfma_f32_16x16x32_bf16 v[220:223], v[116:119], v[92:95], v[220:223]
v_mfma_f32_16x16x32_bf16 v[216:219], v[116:119], v[88:91], v[216:219]
v_mfma_f32_16x16x32_bf16 v[212:215], v[116:119], v[84:87], v[212:215]
v_mfma_f32_16x16x32_bf16 v[208:211], v[116:119], v[80:83], v[208:211]
s_mul_i32 s43, s38, 32
s_add_u32 s37, s37, s43
s_setprio 0
s_barrier
s_mov_b32 s80, s60
s_mov_b32 s81, s61
s_mov_b32 s82, 7340032
s_mov_b32 s83, 0x20000
v_and_b32 v29, 31, v1
v_lshlrev_b32 v29, 11, v29
s_and_b32 s43, s35, 8
s_or_b32 s43, s43, 3
s_lshl_b32 s43, s43, 7
v_add_u32 v29, s43, v29
s_add_u32 s37, s37, s54
s_add_u32 m0, s39, 65536
s_add_u32 s37, s37, s40
buffer_load_dwordx4 v21, s[8:11], s37 offen sc1 lds
v_mul_f32 v80, v128, v128
v_mul_f32 v81, v129, v129
v_mul_f32 v82, v130, v130
v_mul_f32 v83, v131, v131
v_fma_f32 v80, v80, v232, v228
v_fma_f32 v81, v81, v232, v228
v_fma_f32 v82, v82, v232, v228
s_add_u32 m0, s39, 66560
s_add_u32 s37, s37, s38
buffer_load_dwordx4 v21, s[8:11], s37 offen sc1 lds
v_fma_f32 v83, v83, v232, v228
v_mul_f32 v80, v80, v128
v_mul_f32 v81, v81, v129
v_mul_f32 v82, v82, v130
v_mul_f32 v83, v83, v131
v_exp_f32 v80, v80
s_add_u32 m0, s39, 67584
s_add_u32 s37, s37, s38
buffer_load_dwordx4 v21, s[8:11], s37 offen sc1 lds
v_exp_f32 v81, v81
v_exp_f32 v82, v82
v_exp_f32 v83, v83
v_mul_f32 v176, v128, v176
v_mul_f32 v177, v129, v177
v_mul_f32 v178, v130, v178
v_mul_f32 v179, v131, v179
s_add_u32 m0, s39, 68608
s_add_u32 s37, s37, s38
buffer_load_dwordx4 v21, s[8:11], s37 offen sc1 lds
v_fma_f32 v80, v80, v236, v236
v_fma_f32 v81, v81, v236, v236
v_fma_f32 v82, v82, v236, v236
v_fma_f32 v83, v83, v236, v236
v_rcp_f32 v80, v80
v_rcp_f32 v81, v81
s_add_u32 m0, s39, 69632
s_add_u32 s37, s37, s55
buffer_load_dwordx4 v21, s[8:11], s37 offen sc1 lds
v_rcp_f32 v82, v82
v_rcp_f32 v83, v83
v_mul_f32 v176, v176, v80
v_mul_f32 v177, v177, v81
v_mul_f32 v178, v178, v82
v_mul_f32 v179, v179, v83
v_cvt_pk_bf16_f32 v96, v176, v177
s_add_u32 m0, s39, 70656
s_add_u32 s37, s37, s38
buffer_load_dwordx4 v21, s[8:11], s37 offen sc1 lds
v_cvt_pk_bf16_f32 v97, v178, v179
v_mul_f32 v84, v144, v144
v_mul_f32 v85, v145, v145
v_mul_f32 v86, v146, v146
v_mul_f32 v87, v147, v147
v_fma_f32 v84, v84, v232, v228
s_add_u32 m0, s39, 71680
s_add_u32 s37, s37, s38
buffer_load_dwordx4 v21, s[8:11], s37 offen sc1 lds
v_fma_f32 v85, v85, v232, v228
v_fma_f32 v86, v86, v232, v228
v_fma_f32 v87, v87, v232, v228
v_mul_f32 v84, v84, v144
v_mul_f32 v85, v85, v145
v_mul_f32 v86, v86, v146
v_mul_f32 v87, v87, v147
s_add_u32 m0, s39, 72704
s_add_u32 s37, s37, s38
buffer_load_dwordx4 v21, s[8:11], s37 offen sc1 lds
v_exp_f32 v84, v84
v_exp_f32 v85, v85
v_exp_f32 v86, v86
v_exp_f32 v87, v87
v_mul_f32 v192, v144, v192
v_mul_f32 v193, v145, v193
s_barrier
s_lshr_b32 s44, s2, 3
s_lshl_b32 s44, s44, 17
s_add_u32 s43, s44, 65536
buffer_load_dword v30, v29, s[80:83], s43 offen
s_add_u32 m0, s39, 98304
s_add_u32 s37, s37, s40
buffer_load_dwordx4 v21, s[8:11], s37 offen sc1 lds
v_mul_f32 v194, v146, v194
v_mul_f32 v195, v147, v195
v_fma_f32 v84, v84, v236, v236
v_fma_f32 v85, v85, v236, v236
v_fma_f32 v86, v86, v236, v236
v_fma_f32 v87, v87, v236, v236
v_rcp_f32 v84, v84
s_add_u32 m0, s39, 99328
s_add_u32 s37, s37, s38
buffer_load_dwordx4 v21, s[8:11], s37 offen sc1 lds
v_rcp_f32 v85, v85
v_rcp_f32 v86, v86
v_rcp_f32 v87, v87
v_mul_f32 v192, v192, v84
v_mul_f32 v193, v193, v85
v_mul_f32 v194, v194, v86
v_mul_f32 v195, v195, v87
s_add_u32 m0, s39, 100352
s_add_u32 s37, s37, s38
buffer_load_dwordx4 v21, s[8:11], s37 offen sc1 lds
v_cvt_pk_bf16_f32 v98, v192, v193
v_cvt_pk_bf16_f32 v99, v194, v195
v_mul_f32 v80, v160, v160
v_mul_f32 v81, v161, v161
v_mul_f32 v82, v162, v162
s_add_u32 m0, s39, 101376
s_add_u32 s37, s37, s38
buffer_load_dwordx4 v21, s[8:11], s37 offen sc1 lds
v_mul_f32 v83, v163, v163
v_fma_f32 v80, v80, v232, v228
v_fma_f32 v81, v81, v232, v228
v_fma_f32 v82, v82, v232, v228
v_fma_f32 v83, v83, v232, v228
v_mul_f32 v80, v80, v160
v_mul_f32 v81, v81, v161
s_add_u32 m0, s39, 102400
s_add_u32 s37, s37, s55
buffer_load_dwordx4 v21, s[8:11], s37 offen sc1 lds
v_mul_f32 v82, v82, v162
v_mul_f32 v83, v83, v163
v_exp_f32 v80, v80
v_exp_f32 v81, v81
v_exp_f32 v82, v82
v_exp_f32 v83, v83
v_mul_f32 v208, v160, v208
s_add_u32 m0, s39, 103424
s_add_u32 s37, s37, s38
buffer_load_dwordx4 v21, s[8:11], s37 offen sc1 lds
v_mul_f32 v209, v161, v209
v_mul_f32 v210, v162, v210
v_mul_f32 v211, v163, v211
v_fma_f32 v80, v80, v236, v236
v_fma_f32 v81, v81, v236, v236
v_fma_f32 v82, v82, v236, v236
s_add_u32 m0, s39, 104448
s_add_u32 s37, s37, s38
buffer_load_dwordx4 v21, s[8:11], s37 offen sc1 lds
v_fma_f32 v83, v83, v236, v236
v_rcp_f32 v80, v80
v_rcp_f32 v81, v81
v_rcp_f32 v82, v82
v_rcp_f32 v83, v83
v_mul_f32 v208, v208, v80
v_mul_f32 v209, v209, v81
s_add_u32 m0, s39, 105472
s_add_u32 s37, s37, s38
buffer_load_dwordx4 v21, s[8:11], s37 offen sc1 lds
v_mul_f32 v210, v210, v82
v_mul_f32 v211, v211, v83
v_cvt_pk_bf16_f32 v112, v208, v209
v_cvt_pk_bf16_f32 v113, v210, v211
v_mul_f32 v80, v132, v132
v_mul_f32 v81, v133, v133
buffer_store_dwordx4 v[96:99], v27, s[24:27], 0 offen offset:0 sc1
s_barrier
s_add_u32 m0, s39, 0
s_add_u32 s37, s37, s40
buffer_load_dwordx4 v21, s[8:11], s37 offen sc1 lds
v_mul_f32 v82, v134, v134
v_mul_f32 v83, v135, v135
v_fma_f32 v80, v80, v233, v229
v_fma_f32 v81, v81, v233, v229
v_fma_f32 v82, v82, v233, v229
v_fma_f32 v83, v83, v233, v229
v_mul_f32 v80, v80, v132
s_add_u32 m0, s39, 1024
s_add_u32 s37, s37, s38
buffer_load_dwordx4 v21, s[8:11], s37 offen sc1 lds
v_mul_f32 v81, v81, v133
v_mul_f32 v82, v82, v134
v_mul_f32 v83, v83, v135
v_exp_f32 v80, v80
v_exp_f32 v81, v81
v_exp_f32 v82, v82
s_add_u32 m0, s39, 2048
s_add_u32 s37, s37, s38
buffer_load_dwordx4 v21, s[8:11], s37 offen sc1 lds
v_exp_f32 v83, v83
v_mul_f32 v180, v132, v180
v_mul_f32 v181, v133, v181
v_mul_f32 v182, v134, v182
v_mul_f32 v183, v135, v183
v_fma_f32 v80, v80, v237, v237
v_fma_f32 v81, v81, v237, v237
s_add_u32 m0, s39, 3072
s_add_u32 s37, s37, s38
buffer_load_dwordx4 v21, s[8:11], s37 offen sc1 lds
v_fma_f32 v82, v82, v237, v237
v_fma_f32 v83, v83, v237, v237
v_rcp_f32 v80, v80
v_rcp_f32 v81, v81
v_rcp_f32 v82, v82
v_rcp_f32 v83, v83
s_add_u32 m0, s39, 4096
s_add_u32 s37, s37, s55
buffer_load_dwordx4 v21, s[8:11], s37 offen sc1 lds
v_mul_f32 v180, v180, v80
v_mul_f32 v181, v181, v81
v_mul_f32 v182, v182, v82
v_mul_f32 v183, v183, v83
v_cvt_pk_bf16_f32 v100, v180, v181
v_cvt_pk_bf16_f32 v101, v182, v183
v_mul_f32 v84, v148, v148
s_add_u32 m0, s39, 5120
s_add_u32 s37, s37, s38
buffer_load_dwordx4 v21, s[8:11], s37 offen sc1 lds
v_mul_f32 v85, v149, v149
v_mul_f32 v86, v150, v150
v_mul_f32 v87, v151, v151
v_fma_f32 v84, v84, v233, v229
v_fma_f32 v85, v85, v233, v229
v_fma_f32 v86, v86, v233, v229
s_add_u32 m0, s39, 6144
s_add_u32 s37, s37, s38
buffer_load_dwordx4 v21, s[8:11], s37 offen sc1 lds
v_fma_f32 v87, v87, v233, v229
v_mul_f32 v84, v84, v148
v_mul_f32 v85, v85, v149
v_mul_f32 v86, v86, v150
v_mul_f32 v87, v87, v151
v_exp_f32 v84, v84
v_exp_f32 v85, v85
s_add_u32 m0, s39, 7168
s_add_u32 s37, s37, s38
buffer_load_dwordx4 v21, s[8:11], s37 offen sc1 lds
v_exp_f32 v86, v86
v_exp_f32 v87, v87
v_mul_f32 v196, v148, v196
v_mul_f32 v197, v149, v197
v_mul_f32 v198, v150, v198
v_mul_f32 v199, v151, v199
s_waitcnt vmcnt(18)
s_barrier
s_add_u32 s43, s34, 48
s_lshl_b32 s43, s43, 7
v_mov_b32 v10, s43
v_mov_b32 v12, 16
buffer_load_dword v11, v10, s[56:59], 0 offen sc1
s_add_u32 m0, s39, 32768
s_add_u32 s37, s37, s40
buffer_load_dwordx4 v21, s[8:11], s37 offen sc1 lds
v_fma_f32 v84, v84, v237, v237
v_fma_f32 v85, v85, v237, v237
v_fma_f32 v86, v86, v237, v237
v_fma_f32 v87, v87, v237, v237
v_rcp_f32 v84, v84
v_rcp_f32 v85, v85
v_rcp_f32 v86, v86
s_add_u32 m0, s39, 33792
s_add_u32 s37, s37, s38
buffer_load_dwordx4 v21, s[8:11], s37 offen sc1 lds
v_rcp_f32 v87, v87
v_mul_f32 v196, v196, v84
v_mul_f32 v197, v197, v85
v_mul_f32 v198, v198, v86
v_mul_f32 v199, v199, v87
v_cvt_pk_bf16_f32 v102, v196, v197
v_cvt_pk_bf16_f32 v103, v198, v199
s_add_u32 m0, s39, 34816
s_add_u32 s37, s37, s38
buffer_load_dwordx4 v21, s[8:11], s37 offen sc1 lds
v_mul_f32 v80, v164, v164
v_mul_f32 v81, v165, v165
v_mul_f32 v82, v166, v166
v_mul_f32 v83, v167, v167
v_fma_f32 v80, v80, v233, v229
s_add_u32 m0, s39, 35840
s_add_u32 s37, s37, s38
buffer_load_dwordx4 v21, s[8:11], s37 offen sc1 lds
v_fma_f32 v81, v81, v233, v229
v_fma_f32 v82, v82, v233, v229
v_fma_f32 v83, v83, v233, v229
v_mul_f32 v80, v80, v164
v_mul_f32 v81, v81, v165
v_mul_f32 v82, v82, v166
v_mul_f32 v83, v83, v167
s_add_u32 m0, s39, 36864
s_add_u32 s37, s37, s55
buffer_load_dwordx4 v21, s[8:11], s37 offen sc1 lds
v_exp_f32 v80, v80
v_exp_f32 v81, v81
v_exp_f32 v82, v82
v_exp_f32 v83, v83
v_mul_f32 v212, v164, v212
v_mul_f32 v213, v165, v213
v_mul_f32 v214, v166, v214
s_add_u32 m0, s39, 37888
s_add_u32 s37, s37, s38
buffer_load_dwordx4 v21, s[8:11], s37 offen sc1 lds
v_mul_f32 v215, v167, v215
v_fma_f32 v80, v80, v237, v237
v_fma_f32 v81, v81, v237, v237
v_fma_f32 v82, v82, v237, v237
v_fma_f32 v83, v83, v237, v237
v_rcp_f32 v80, v80
s_add_u32 m0, s39, 38912
s_add_u32 s37, s37, s38
buffer_load_dwordx4 v21, s[8:11], s37 offen sc1 lds
v_rcp_f32 v81, v81
v_rcp_f32 v82, v82
v_rcp_f32 v83, v83
v_mul_f32 v212, v212, v80
v_mul_f32 v213, v213, v81
v_mul_f32 v214, v214, v82
v_mul_f32 v215, v215, v83
s_add_u32 m0, s39, 39936
s_add_u32 s37, s37, s38
buffer_load_dwordx4 v21, s[8:11], s37 offen sc1 lds
v_cvt_pk_bf16_f32 v114, v212, v213
v_cvt_pk_bf16_f32 v115, v214, v215
s_nop 1
v_permlane32_swap_b32 v112, v114
v_permlane32_swap_b32 v113, v115
buffer_store_dwordx4 v[100:103], v27, s[24:27], 0 offen offset:256 sc1
buffer_store_dwordx4 v[112:115], v28, s[24:27], 0 offen offset:0 sc1
s_waitcnt vmcnt(20)
s_barrier
s_add_u32 m0, s39, 65536
s_add_u32 s37, s37, s40
buffer_load_dwordx4 v21, s[8:11], s37 offen sc1 lds
v_mul_f32 v80, v136, v136
v_mul_f32 v81, v137, v137
v_mul_f32 v82, v138, v138
v_mul_f32 v83, v139, v139
v_fma_f32 v80, v80, v234, v230
v_fma_f32 v81, v81, v234, v230
v_fma_f32 v82, v82, v234, v230
s_add_u32 m0, s39, 66560
s_add_u32 s37, s37, s38
buffer_load_dwordx4 v21, s[8:11], s37 offen sc1 lds
v_fma_f32 v83, v83, v234, v230
v_mul_f32 v80, v80, v136
v_mul_f32 v81, v81, v137
v_mul_f32 v82, v82, v138
v_mul_f32 v83, v83, v139
v_exp_f32 v80, v80
s_add_u32 m0, s39, 67584
s_add_u32 s37, s37, s38
buffer_load_dwordx4 v21, s[8:11], s37 offen sc1 lds
v_exp_f32 v81, v81
v_exp_f32 v82, v82
v_exp_f32 v83, v83
v_mul_f32 v184, v136, v184
v_mul_f32 v185, v137, v185
v_mul_f32 v186, v138, v186
v_mul_f32 v187, v139, v187
s_add_u32 m0, s39, 68608
s_add_u32 s37, s37, s38
buffer_load_dwordx4 v21, s[8:11], s37 offen sc1 lds
v_fma_f32 v80, v80, v238, v238
v_fma_f32 v81, v81, v238, v238
v_fma_f32 v82, v82, v238, v238
v_fma_f32 v83, v83, v238, v238
v_rcp_f32 v80, v80
v_rcp_f32 v81, v81
s_add_u32 m0, s39, 69632
s_add_u32 s37, s37, s55
buffer_load_dwordx4 v21, s[8:11], s37 offen sc1 lds
v_rcp_f32 v82, v82
v_rcp_f32 v83, v83
v_mul_f32 v184, v184, v80
v_mul_f32 v185, v185, v81
v_mul_f32 v186, v186, v82
v_mul_f32 v187, v187, v83
v_cvt_pk_bf16_f32 v104, v184, v185
s_add_u32 m0, s39, 70656
s_add_u32 s37, s37, s38
buffer_load_dwordx4 v21, s[8:11], s37 offen sc1 lds
v_cvt_pk_bf16_f32 v105, v186, v187
v_mul_f32 v84, v152, v152
v_mul_f32 v85, v153, v153
v_mul_f32 v86, v154, v154
v_mul_f32 v87, v155, v155
v_fma_f32 v84, v84, v234, v230
s_add_u32 m0, s39, 71680
s_add_u32 s37, s37, s38
buffer_load_dwordx4 v21, s[8:11], s37 offen sc1 lds
v_fma_f32 v85, v85, v234, v230
v_fma_f32 v86, v86, v234, v230
v_fma_f32 v87, v87, v234, v230
v_mul_f32 v84, v84, v152
v_mul_f32 v85, v85, v153
v_mul_f32 v86, v86, v154
v_mul_f32 v87, v87, v155
s_add_u32 m0, s39, 72704
s_add_u32 s37, s37, s38
buffer_load_dwordx4 v21, s[8:11], s37 offen sc1 lds
v_exp_f32 v84, v84
v_exp_f32 v85, v85
v_exp_f32 v86, v86
v_exp_f32 v87, v87
v_mul_f32 v200, v152, v200
v_mul_f32 v201, v153, v201
s_waitcnt vmcnt(19)
s_barrier
s_add_u32 m0, s39, 98304
s_add_u32 s37, s37, s40
buffer_load_dwordx4 v21, s[8:11], s37 offen sc1 lds
v_mul_f32 v202, v154, v202
v_mul_f32 v203, v155, v203
v_fma_f32 v84, v84, v238, v238
v_fma_f32 v85, v85, v238, v238
v_fma_f32 v86, v86, v238, v238
v_fma_f32 v87, v87, v238, v238
v_rcp_f32 v84, v84
s_add_u32 m0, s39, 99328
s_add_u32 s37, s37, s38
buffer_load_dwordx4 v21, s[8:11], s37 offen sc1 lds
v_rcp_f32 v85, v85
v_rcp_f32 v86, v86
v_rcp_f32 v87, v87
v_mul_f32 v200, v200, v84
v_mul_f32 v201, v201, v85
v_mul_f32 v202, v202, v86
v_mul_f32 v203, v203, v87
s_add_u32 m0, s39, 100352
s_add_u32 s37, s37, s38
buffer_load_dwordx4 v21, s[8:11], s37 offen sc1 lds
v_cvt_pk_bf16_f32 v106, v200, v201
v_cvt_pk_bf16_f32 v107, v202, v203
v_mul_f32 v80, v168, v168
v_mul_f32 v81, v169, v169
v_mul_f32 v82, v170, v170
s_add_u32 m0, s39, 101376
s_add_u32 s37, s37, s38
buffer_load_dwordx4 v21, s[8:11], s37 offen sc1 lds
v_mul_f32 v83, v171, v171
v_fma_f32 v80, v80, v234, v230
v_fma_f32 v81, v81, v234, v230
v_fma_f32 v82, v82, v234, v230
v_fma_f32 v83, v83, v234, v230
v_mul_f32 v80, v80, v168
v_mul_f32 v81, v81, v169
s_add_u32 m0, s39, 102400
s_add_u32 s37, s37, s55
buffer_load_dwordx4 v21, s[8:11], s37 offen sc1 lds
v_mul_f32 v82, v82, v170
v_mul_f32 v83, v83, v171
v_exp_f32 v80, v80
v_exp_f32 v81, v81
v_exp_f32 v82, v82
v_exp_f32 v83, v83
v_mul_f32 v216, v168, v216
s_add_u32 m0, s39, 103424
s_add_u32 s37, s37, s38
buffer_load_dwordx4 v21, s[8:11], s37 offen sc1 lds
v_mul_f32 v217, v169, v217
v_mul_f32 v218, v170, v218
v_mul_f32 v219, v171, v219
v_fma_f32 v80, v80, v238, v238
v_fma_f32 v81, v81, v238, v238
v_fma_f32 v82, v82, v238, v238
s_add_u32 m0, s39, 104448
s_add_u32 s37, s37, s38
buffer_load_dwordx4 v21, s[8:11], s37 offen sc1 lds
v_fma_f32 v83, v83, v238, v238
v_rcp_f32 v80, v80
v_rcp_f32 v81, v81
v_rcp_f32 v82, v82
v_rcp_f32 v83, v83
v_mul_f32 v216, v216, v80
v_mul_f32 v217, v217, v81
s_add_u32 m0, s39, 105472
s_add_u32 s37, s37, s38
buffer_load_dwordx4 v21, s[8:11], s37 offen sc1 lds
v_mul_f32 v218, v218, v82
v_mul_f32 v219, v219, v83
v_cvt_pk_bf16_f32 v116, v216, v217
v_cvt_pk_bf16_f32 v117, v218, v219
v_mul_f32 v80, v140, v140
v_mul_f32 v81, v141, v141
buffer_store_dwordx4 v[104:107], v27, s[24:27], 0 offen offset:512 sc1
s_waitcnt vmcnt(19)
s_mov_b32 s41, 0x10000
s_waitcnt vmcnt(27)
s_branch Lpf_57
Lpoll_55:
s_waitcnt vmcnt(0)
Lpf_57:
v_cmp_ne_u32 vcc, v12, v11
s_nop 4
s_cbranch_vccz Lpok_56
buffer_load_dword v11, v10, s[56:59], 0 offen sc1
s_sub_u32 s41, s41, 1
s_cmp_lg_u32 s41, 0
s_cbranch_scc1 Lpoll_55
s_waitcnt vmcnt(0)
Lpok_56:
s_barrier
s_add_u32 s37, s37, s29
s_add_u32 m0, s39, 0
s_add_u32 s37, s37, s40
buffer_load_dwordx4 v21, s[8:11], s37 offen sc1 lds
v_mul_f32 v82, v142, v142
v_mul_f32 v83, v143, v143
v_fma_f32 v80, v80, v235, v231
v_fma_f32 v81, v81, v235, v231
v_fma_f32 v82, v82, v235, v231
v_fma_f32 v83, v83, v235, v231
v_mul_f32 v80, v80, v140
s_add_u32 m0, s39, 1024
s_add_u32 s37, s37, s38
buffer_load_dwordx4 v21, s[8:11], s37 offen sc1 lds
v_mul_f32 v81, v81, v141
v_mul_f32 v82, v82, v142
v_mul_f32 v83, v83, v143
v_exp_f32 v80, v80
v_exp_f32 v81, v81
v_exp_f32 v82, v82
s_add_u32 m0, s39, 2048
s_add_u32 s37, s37, s38
buffer_load_dwordx4 v21, s[8:11], s37 offen sc1 lds
v_exp_f32 v83, v83
v_mul_f32 v188, v140, v188
v_mul_f32 v189, v141, v189
v_mul_f32 v190, v142, v190
v_mul_f32 v191, v143, v191
v_fma_f32 v80, v80, v239, v239
v_fma_f32 v81, v81, v239, v239
s_add_u32 m0, s39, 3072
s_add_u32 s37, s37, s38
buffer_load_dwordx4 v21, s[8:11], s37 offen sc1 lds
v_fma_f32 v82, v82, v239, v239
v_fma_f32 v83, v83, v239, v239
v_rcp_f32 v80, v80
v_rcp_f32 v81, v81
v_rcp_f32 v82, v82
v_rcp_f32 v83, v83
s_add_u32 m0, s39, 4096
s_add_u32 s37, s37, s55
buffer_load_dwordx4 v21, s[8:11], s37 offen sc1 lds
v_mul_f32 v188, v188, v80
v_mul_f32 v189, v189, v81
v_mul_f32 v190, v190, v82
v_mul_f32 v191, v191, v83
v_cvt_pk_bf16_f32 v108, v188, v189
v_cvt_pk_bf16_f32 v109, v190, v191
v_mul_f32 v84, v156, v156
s_add_u32 m0, s39, 5120
s_add_u32 s37, s37, s38
buffer_load_dwordx4 v21, s[8:11], s37 offen sc1 lds
v_mul_f32 v85, v157, v157
v_mul_f32 v86, v158, v158
v_mul_f32 v87, v159, v159
v_fma_f32 v84, v84, v235, v231
v_fma_f32 v85, v85, v235, v231
v_fma_f32 v86, v86, v235, v231
s_add_u32 m0, s39, 6144
s_add_u32 s37, s37, s38
buffer_load_dwordx4 v21, s[8:11], s37 offen sc1 lds
v_fma_f32 v87, v87, v235, v231
v_mul_f32 v84, v84, v156
v_mul_f32 v85, v85, v157
v_mul_f32 v86, v86, v158
v_mul_f32 v87, v87, v159
v_exp_f32 v84, v84
v_exp_f32 v85, v85
s_add_u32 m0, s39, 7168
s_add_u32 s37, s37, s38
buffer_load_dwordx4 v21, s[8:11], s37 offen sc1 lds
v_exp_f32 v86, v86
v_exp_f32 v87, v87
v_mul_f32 v204, v156, v204
v_mul_f32 v205, v157, v205
v_mul_f32 v206, v158, v206
v_mul_f32 v207, v159, v207
s_waitcnt vmcnt(17)
s_barrier
s_add_u32 m0, s39, 32768
s_add_u32 s37, s37, s40
buffer_load_dwordx4 v21, s[8:11], s37 offen sc1 lds
v_fma_f32 v84, v84, v239, v239
v_fma_f32 v85, v85, v239, v239
v_fma_f32 v86, v86, v239, v239
v_fma_f32 v87, v87, v239, v239
v_rcp_f32 v84, v84
v_rcp_f32 v85, v85
v_rcp_f32 v86, v86
s_add_u32 m0, s39, 33792
s_add_u32 s37, s37, s38
buffer_load_dwordx4 v21, s[8:11], s37 offen sc1 lds
v_rcp_f32 v87, v87
v_mul_f32 v204, v204, v84
v_mul_f32 v205, v205, v85
v_mul_f32 v206, v206, v86
v_mul_f32 v207, v207, v87
v_cvt_pk_bf16_f32 v110, v204, v205
v_cvt_pk_bf16_f32 v111, v206, v207
s_add_u32 m0, s39, 34816
s_add_u32 s37, s37, s38
buffer_load_dwordx4 v21, s[8:11], s37 offen sc1 lds
v_mul_f32 v80, v172, v172
v_mul_f32 v81, v173, v173
v_mul_f32 v82, v174, v174
v_mul_f32 v83, v175, v175
v_fma_f32 v80, v80, v235, v231
s_add_u32 m0, s39, 35840
s_add_u32 s37, s37, s38
buffer_load_dwordx4 v21, s[8:11], s37 offen sc1 lds
v_fma_f32 v81, v81, v235, v231
v_fma_f32 v82, v82, v235, v231
v_fma_f32 v83, v83, v235, v231
v_mul_f32 v80, v80, v172
v_mul_f32 v81, v81, v173
v_mul_f32 v82, v82, v174
v_mul_f32 v83, v83, v175
s_add_u32 m0, s39, 36864
s_add_u32 s37, s37, s55
buffer_load_dwordx4 v21, s[8:11], s37 offen sc1 lds
v_exp_f32 v80, v80
v_exp_f32 v81, v81
v_exp_f32 v82, v82
v_exp_f32 v83, v83
v_mul_f32 v220, v172, v220
v_mul_f32 v221, v173, v221
v_mul_f32 v222, v174, v222
s_add_u32 m0, s39, 37888
s_add_u32 s37, s37, s38
buffer_load_dwordx4 v21, s[8:11], s37 offen sc1 lds
v_mul_f32 v223, v175, v223
v_fma_f32 v80, v80, v239, v239
v_fma_f32 v81, v81, v239, v239
v_fma_f32 v82, v82, v239, v239
v_fma_f32 v83, v83, v239, v239
v_rcp_f32 v80, v80
s_add_u32 m0, s39, 38912
s_add_u32 s37, s37, s38
buffer_load_dwordx4 v21, s[8:11], s37 offen sc1 lds
v_rcp_f32 v81, v81
v_rcp_f32 v82, v82
v_rcp_f32 v83, v83
v_mul_f32 v220, v220, v80
v_mul_f32 v221, v221, v81
v_mul_f32 v222, v222, v82
v_mul_f32 v223, v223, v83
s_add_u32 m0, s39, 39936
s_add_u32 s37, s37, s38
buffer_load_dwordx4 v21, s[8:11], s37 offen sc1 lds
v_cvt_pk_bf16_f32 v118, v220, v221
v_cvt_pk_bf16_f32 v119, v222, v223
s_nop 1
v_permlane32_swap_b32 v116, v118
v_permlane32_swap_b32 v117, v119
buffer_store_dwordx4 v[108:111], v27, s[24:27], 0 offen offset:768 sc1
buffer_store_dwordx4 v[116:119], v28, s[24:27], 0 offen offset:512 sc1
s_waitcnt vmcnt(19)
s_barrier
s_add_u32 m0, s39, 65536
s_add_u32 s37, s37, s40
buffer_load_dwordx4 v21, s[8:11], s37 offen sc1 lds
s_add_u32 m0, s39, 66560
s_add_u32 s37, s37, s38
buffer_load_dwordx4 v21, s[8:11], s37 offen sc1 lds
s_add_u32 m0, s39, 67584
s_add_u32 s37, s37, s38
buffer_load_dwordx4 v21, s[8:11], s37 offen sc1 lds
s_add_u32 m0, s39, 68608
s_add_u32 s37, s37, s38
buffer_load_dwordx4 v21, s[8:11], s37 offen sc1 lds
s_add_u32 m0, s39, 69632
s_add_u32 s37, s37, s55
buffer_load_dwordx4 v21, s[8:11], s37 offen sc1 lds
s_add_u32 m0, s39, 70656
s_add_u32 s37, s37, s38
buffer_load_dwordx4 v21, s[8:11], s37 offen sc1 lds
s_add_u32 m0, s39, 71680
s_add_u32 s37, s37, s38
buffer_load_dwordx4 v21, s[8:11], s37 offen sc1 lds
s_add_u32 m0, s39, 72704
s_add_u32 s37, s37, s38
buffer_load_dwordx4 v21, s[8:11], s37 offen sc1 lds
s_waitcnt vmcnt(8)
s_barrier
s_add_u32 s43, s34, 64
s_lshl_b32 s43, s43, 7
v_mov_b32 v10, s43
v_mov_b32 v11, 1
s_mov_b64 exec, 1
buffer_atomic_add v11, v10, s[56:59], 0 offen sc1
s_mov_b64 exec, -1
s_add_u32 m0, s39, 98304
s_add_u32 s37, s37, s40
buffer_load_dwordx4 v21, s[8:11], s37 offen sc1 lds
s_add_u32 m0, s39, 99328
s_add_u32 s37, s37, s38
buffer_load_dwordx4 v21, s[8:11], s37 offen sc1 lds
s_add_u32 m0, s39, 100352
s_add_u32 s37, s37, s38
buffer_load_dwordx4 v21, s[8:11], s37 offen sc1 lds
s_add_u32 m0, s39, 101376
s_add_u32 s37, s37, s38
buffer_load_dwordx4 v21, s[8:11], s37 offen sc1 lds
s_add_u32 m0, s39, 102400
s_add_u32 s37, s37, s55
buffer_load_dwordx4 v21, s[8:11], s37 offen sc1 lds
s_add_u32 m0, s39, 103424
s_add_u32 s37, s37, s38
buffer_load_dwordx4 v21, s[8:11], s37 offen sc1 lds
s_add_u32 m0, s39, 104448
s_add_u32 s37, s37, s38
buffer_load_dwordx4 v21, s[8:11], s37 offen sc1 lds
s_add_u32 m0, s39, 105472
s_add_u32 s37, s37, s38
buffer_load_dwordx4 v21, s[8:11], s37 offen sc1 lds
s_waitcnt vmcnt(19)
s_barrier
s_lshr_b32 s44, s2, 3
s_lshl_b32 s44, s44, 16
s_add_u32 s43, s44, 4194304
buffer_load_dword v30, v29, s[80:83], s43 offen
s_add_u32 m0, s39, 0
s_add_u32 s37, s37, s40
buffer_load_dwordx4 v21, s[8:11], s37 offen sc1 lds
s_add_u32 m0, s39, 1024
s_add_u32 s37, s37, s38
buffer_load_dwordx4 v21, s[8:11], s37 offen sc1 lds
s_add_u32 m0, s39, 2048
s_add_u32 s37, s37, s38
buffer_load_dwordx4 v21, s[8:11], s37 offen sc1 lds
s_add_u32 m0, s39, 3072
s_add_u32 s37, s37, s38
buffer_load_dwordx4 v21, s[8:11], s37 offen sc1 lds
s_add_u32 m0, s39, 4096
s_add_u32 s37, s37, s55
buffer_load_dwordx4 v21, s[8:11], s37 offen sc1 lds
s_add_u32 m0, s39, 5120
s_add_u32 s37, s37, s38
buffer_load_dwordx4 v21, s[8:11], s37 offen sc1 lds
s_add_u32 m0, s39, 6144
s_add_u32 s37, s37, s38
buffer_load_dwordx4 v21, s[8:11], s37 offen sc1 lds
s_add_u32 m0, s39, 7168
s_add_u32 s37, s37, s38
buffer_load_dwordx4 v21, s[8:11], s37 offen sc1 lds
s_waitcnt vmcnt(18)
s_barrier
s_add_u32 s43, s34, 64
s_lshl_b32 s43, s43, 7
v_mov_b32 v10, s43
v_mov_b32 v12, 16
buffer_load_dword v11, v10, s[56:59], 0 offen sc1
s_add_u32 m0, s39, 32768
s_add_u32 s37, s37, s40
buffer_load_dwordx4 v21, s[8:11], s37 offen sc1 lds
s_add_u32 m0, s39, 33792
s_add_u32 s37, s37, s38
buffer_load_dwordx4 v21, s[8:11], s37 offen sc1 lds
s_add_u32 m0, s39, 34816
s_add_u32 s37, s37, s38
buffer_load_dwordx4 v21, s[8:11], s37 offen sc1 lds
s_add_u32 m0, s39, 35840
s_add_u32 s37, s37, s38
buffer_load_dwordx4 v21, s[8:11], s37 offen sc1 lds
s_add_u32 m0, s39, 36864
s_add_u32 s37, s37, s55
buffer_load_dwordx4 v21, s[8:11], s37 offen sc1 lds
s_add_u32 m0, s39, 37888
s_add_u32 s37, s37, s38
buffer_load_dwordx4 v21, s[8:11], s37 offen sc1 lds
s_add_u32 m0, s39, 38912
s_add_u32 s37, s37, s38
buffer_load_dwordx4 v21, s[8:11], s37 offen sc1 lds
s_add_u32 m0, s39, 39936
s_add_u32 s37, s37, s38
buffer_load_dwordx4 v21, s[8:11], s37 offen sc1 lds
s_waitcnt vmcnt(18)
s_barrier
s_add_u32 m0, s39, 65536
s_add_u32 s37, s37, s40
buffer_load_dwordx4 v21, s[8:11], s37 offen sc1 lds
s_add_u32 m0, s39, 66560
s_add_u32 s37, s37, s38
buffer_load_dwordx4 v21, s[8:11], s37 offen sc1 lds
s_add_u32 m0, s39, 67584
s_add_u32 s37, s37, s38
buffer_load_dwordx4 v21, s[8:11], s37 offen sc1 lds
s_add_u32 m0, s39, 68608
s_add_u32 s37, s37, s38
buffer_load_dwordx4 v21, s[8:11], s37 offen sc1 lds
s_add_u32 m0, s39, 69632
s_add_u32 s37, s37, s55
buffer_load_dwordx4 v21, s[8:11], s37 offen sc1 lds
s_add_u32 m0, s39, 70656
s_add_u32 s37, s37, s38
buffer_load_dwordx4 v21, s[8:11], s37 offen sc1 lds
s_add_u32 m0, s39, 71680
s_add_u32 s37, s37, s38
buffer_load_dwordx4 v21, s[8:11], s37 offen sc1 lds
s_add_u32 m0, s39, 72704
s_add_u32 s37, s37, s38
buffer_load_dwordx4 v21, s[8:11], s37 offen sc1 lds
s_waitcnt vmcnt(17)
s_barrier
s_add_u32 m0, s39, 98304
s_add_u32 s37, s37, s40
buffer_load_dwordx4 v21, s[8:11], s37 offen sc1 lds
s_add_u32 m0, s39, 99328
s_add_u32 s37, s37, s38
buffer_load_dwordx4 v21, s[8:11], s37 offen sc1 lds
s_add_u32 m0, s39, 100352
s_add_u32 s37, s37, s38
buffer_load_dwordx4 v21, s[8:11], s37 offen sc1 lds
s_add_u32 m0, s39, 101376
s_add_u32 s37, s37, s38
buffer_load_dwordx4 v21, s[8:11], s37 offen sc1 lds
s_add_u32 m0, s39, 102400
s_add_u32 s37, s37, s55
buffer_load_dwordx4 v21, s[8:11], s37 offen sc1 lds
s_add_u32 m0, s39, 103424
s_add_u32 s37, s37, s38
buffer_load_dwordx4 v21, s[8:11], s37 offen sc1 lds
s_add_u32 m0, s39, 104448
s_add_u32 s37, s37, s38
buffer_load_dwordx4 v21, s[8:11], s37 offen sc1 lds
s_add_u32 m0, s39, 105472
s_add_u32 s37, s37, s38
buffer_load_dwordx4 v21, s[8:11], s37 offen sc1 lds
s_waitcnt vmcnt(16)
s_mov_b32 s41, 0x10000
s_waitcnt vmcnt(24)
s_branch Lpf_60
Lpoll_58:
s_waitcnt vmcnt(0)
Lpf_60:
v_cmp_ne_u32 vcc, v12, v11
s_nop 4
s_cbranch_vccz Lpok_59
buffer_load_dword v11, v10, s[56:59], 0 offen sc1
s_sub_u32 s41, s41, 1
s_cmp_lg_u32 s41, 0
s_cbranch_scc1 Lpoll_58
s_waitcnt vmcnt(0)
Lpok_59:
s_barrier
s_mul_i32 s40, s53, 786432
s_add_u32 m0, s39, 0
s_add_u32 s37, s40, 4194304
buffer_load_dwordx4 v21, s[8:11], s37 offen sc1 lds
s_add_u32 m0, s39, 1024
s_add_u32 s37, s40, 4210688
buffer_load_dwordx4 v21, s[8:11], s37 offen sc1 lds
s_add_u32 m0, s39, 2048
s_add_u32 s37, s40, 4227072
buffer_load_dwordx4 v21, s[8:11], s37 offen sc1 lds
s_add_u32 m0, s39, 3072
s_add_u32 s37, s40, 4243456
buffer_load_dwordx4 v21, s[8:11], s37 offen sc1 lds
s_add_u32 m0, s39, 4096
s_add_u32 s37, s40, 4292608
buffer_load_dwordx4 v21, s[8:11], s37 offen sc1 lds
s_add_u32 m0, s39, 5120
s_add_u32 s37, s40, 4308992
buffer_load_dwordx4 v21, s[8:11], s37 offen sc1 lds
s_add_u32 m0, s39, 6144
s_add_u32 s37, s40, 4325376
buffer_load_dwordx4 v21, s[8:11], s37 offen sc1 lds
s_add_u32 m0, s39, 7168
s_add_u32 s37, s40, 4341760
buffer_load_dwordx4 v21, s[8:11], s37 offen sc1 lds
s_waitcnt vmcnt(16)
s_barrier
s_add_u32 m0, s39, 32768
s_add_u32 s37, s40, 4259840
buffer_load_dwordx4 v21, s[8:11], s37 offen sc1 lds
s_add_u32 m0, s39, 33792
s_add_u32 s37, s40, 4358144
buffer_load_dwordx4 v21, s[8:11], s37 offen sc1 lds
s_add_u32 m0, s39, 34816
s_add_u32 s37, s40, 4276224
buffer_load_dwordx4 v21, s[8:11], s37 offen sc1 lds
s_add_u32 m0, s39, 35840
s_add_u32 s37, s40, 4374528
buffer_load_dwordx4 v21, s[8:11], s37 offen sc1 lds
s_add_u32 m0, s39, 36864
s_add_u32 s37, s40, 4390912
buffer_load_dwordx4 v21, s[8:11], s37 offen sc1 lds
s_add_u32 m0, s39, 37888
s_add_u32 s37, s40, 4407296
buffer_load_dwordx4 v21, s[8:11], s37 offen sc1 lds
s_add_u32 m0, s39, 38912
s_add_u32 s37, s40, 4423680
buffer_load_dwordx4 v21, s[8:11], s37 offen sc1 lds
s_add_u32 m0, s39, 39936
s_add_u32 s37, s40, 4440064
buffer_load_dwordx4 v21, s[8:11], s37 offen sc1 lds
s_waitcnt vmcnt(16)
s_barrier
s_add_u32 m0, s39, 65536
s_add_u32 s37, s40, 4489216
buffer_load_dwordx4 v21, s[8:11], s37 offen sc1 lds
s_add_u32 m0, s39, 66560
s_add_u32 s37, s40, 4505600
buffer_load_dwordx4 v21, s[8:11], s37 offen sc1 lds
s_add_u32 m0, s39, 67584
s_add_u32 s37, s40, 4521984
buffer_load_dwordx4 v21, s[8:11], s37 offen sc1 lds
s_add_u32 m0, s39, 68608
s_add_u32 s37, s40, 4538368
buffer_load_dwordx4 v21, s[8:11], s37 offen sc1 lds
s_add_u32 m0, s39, 69632
s_add_u32 s37, s40, 4456448
buffer_load_dwordx4 v21, s[8:11], s37 offen sc1 lds
s_add_u32 m0, s39, 70656
s_add_u32 s37, s40, 4554752
buffer_load_dwordx4 v21, s[8:11], s37 offen sc1 lds
s_add_u32 m0, s39, 71680
s_add_u32 s37, s40, 4472832
buffer_load_dwordx4 v21, s[8:11], s37 offen sc1 lds
s_add_u32 m0, s39, 72704
s_add_u32 s37, s40, 4571136
buffer_load_dwordx4 v21, s[8:11], s37 offen sc1 lds
s_waitcnt vmcnt(16)
s_barrier
s_add_u32 m0, s39, 98304
s_add_u32 s37, s40, 4587520
buffer_load_dwordx4 v21, s[8:11], s37 offen sc1 lds
s_add_u32 m0, s39, 99328
s_add_u32 s37, s40, 4603904
buffer_load_dwordx4 v21, s[8:11], s37 offen sc1 lds
s_add_u32 m0, s39, 100352
s_add_u32 s37, s40, 4620288
buffer_load_dwordx4 v21, s[8:11], s37 offen sc1 lds
s_add_u32 m0, s39, 101376
s_add_u32 s37, s40, 4636672
buffer_load_dwordx4 v21, s[8:11], s37 offen sc1 lds
s_add_u32 m0, s39, 102400
s_add_u32 s37, s40, 4685824
buffer_load_dwordx4 v21, s[8:11], s37 offen sc1 lds
s_add_u32 m0, s39, 103424
s_add_u32 s37, s40, 4702208
buffer_load_dwordx4 v21, s[8:11], s37 offen sc1 lds
s_add_u32 m0, s39, 104448
s_add_u32 s37, s40, 4718592
buffer_load_dwordx4 v21, s[8:11], s37 offen sc1 lds
s_add_u32 m0, s39, 105472
s_add_u32 s37, s40, 4734976
buffer_load_dwordx4 v21, s[8:11], s37 offen sc1 lds
s_waitcnt vmcnt(16)
s_barrier
s_add_u32 m0, s39, 0
s_add_u32 s37, s40, 4653056
buffer_load_dwordx4 v21, s[8:11], s37 offen sc1 lds
s_add_u32 m0, s39, 1024
s_add_u32 s37, s40, 4751360
buffer_load_dwordx4 v21, s[8:11], s37 offen sc1 lds
s_add_u32 m0, s39, 2048
s_add_u32 s37, s40, 4669440
buffer_load_dwordx4 v21, s[8:11], s37 offen sc1 lds
s_add_u32 m0, s39, 3072
s_add_u32 s37, s40, 4767744
buffer_load_dwordx4 v21, s[8:11], s37 offen sc1 lds
s_add_u32 m0, s39, 4096
s_add_u32 s37, s40, 4784128
buffer_load_dwordx4 v21, s[8:11], s37 offen sc1 lds
s_add_u32 m0, s39, 5120
s_add_u32 s37, s40, 4800512
buffer_load_dwordx4 v21, s[8:11], s37 offen sc1 lds
s_add_u32 m0, s39, 6144
s_add_u32 s37, s40, 4816896
buffer_load_dwordx4 v21, s[8:11], s37 offen sc1 lds
s_add_u32 m0, s39, 7168
s_add_u32 s37, s40, 4833280
buffer_load_dwordx4 v21, s[8:11], s37 offen sc1 lds
s_waitcnt vmcnt(16)
s_barrier
s_add_u32 m0, s39, 32768
s_add_u32 s37, s40, 4882432
buffer_load_dwordx4 v21, s[8:11], s37 offen sc1 lds
s_add_u32 m0, s39, 33792
s_add_u32 s37, s40, 4898816
buffer_load_dwordx4 v21, s[8:11], s37 offen sc1 lds
s_add_u32 m0, s39, 34816
s_add_u32 s37, s40, 4915200
buffer_load_dwordx4 v21, s[8:11], s37 offen sc1 lds
s_add_u32 m0, s39, 35840
s_add_u32 s37, s40, 4931584
buffer_load_dwordx4 v21, s[8:11], s37 offen sc1 lds
s_add_u32 m0, s39, 36864
s_add_u32 s37, s40, 4849664
buffer_load_dwordx4 v21, s[8:11], s37 offen sc1 lds
s_add_u32 m0, s39, 37888
s_add_u32 s37, s40, 4947968
buffer_load_dwordx4 v21, s[8:11], s37 offen sc1 lds
s_add_u32 m0, s39, 38912
s_add_u32 s37, s40, 4866048
buffer_load_dwordx4 v21, s[8:11], s37 offen sc1 lds
s_add_u32 m0, s39, 39936
s_add_u32 s37, s40, 4964352
buffer_load_dwordx4 v21, s[8:11], s37 offen sc1 lds
s_waitcnt vmcnt(16)
s_barrier
s_lshr_b32 s44, s2, 3
s_and_b32 s44, s44, 15
s_lshl_b32 s44, s44, 16
s_add_u32 s43, s44, 6291456
buffer_load_dword v30, v29, s[80:83], s43 offen
s_waitcnt vmcnt(9)
s_barrier
s_waitcnt vmcnt(1)
s_barrier
s_barrier
s_barrier
s_barrier
s_barrier
s_barrier
s_lshl_b32 s43, s34, 4
s_add_u32 s43, s43, s35
s_and_b32 s44, s43, 1
s_lshl_b32 s44, s44, 2
s_lshr_b32 s43, s43, 1
s_add_u32 s43, s43, 128
s_lshl_b32 s43, s43, 7
s_add_u32 s43, s43, s44
v_mov_b32 v10, s43
v_mov_b32 v11, 1
s_mov_b64 exec, 1
buffer_store_dword v11, v10, s[56:59], 0 offen sc1
s_mov_b64 exec, -1
s_barrier
s_barrier
s_barrier
s_lshl_b32 s43, s34, 4
s_add_u32 s43, s43, s35
s_xor_b32 s43, s43, 1
s_and_b32 s44, s43, 1
s_lshl_b32 s44, s44, 2
s_lshr_b32 s43, s43, 1
s_add_u32 s43, s43, 128
s_lshl_b32 s43, s43, 7
s_add_u32 s43, s43, s44
v_mov_b32 v10, s43
v_mov_b32 v12, 1
buffer_load_dword v11, v10, s[56:59], 0 offen sc1
s_barrier
s_barrier
s_mov_b32 s41, 0x10000
Lpoll_61:
s_waitcnt vmcnt(0)
Lpf_63:
v_cmp_ne_u32 vcc, v12, v11
s_nop 4
s_cbranch_vccz Lpok_62
buffer_load_dword v11, v10, s[56:59], 0 offen sc1
s_sub_u32 s41, s41, 1
s_cmp_lg_u32 s41, 0
s_cbranch_scc1 Lpoll_61
s_waitcnt vmcnt(0)
Lpok_62:
s_barrier
s_branch Ldone_1
Ldone_1:
s_endpgm
.section .rodata,"a"
.p2align 6
.amdhsa_kernel sequential_preLN__sliding_local_dilated__glu_gated_geglu__prompt_kernel
  .amdhsa_next_free_vgpr 256
  .amdhsa_next_free_sgpr 100
  .amdhsa_accum_offset 256
  .amdhsa_group_segment_fixed_size 0
  .amdhsa_kernarg_size 80
  .amdhsa_user_sgpr_count 2
  .amdhsa_user_sgpr_kernarg_segment_ptr 1
  .amdhsa_system_sgpr_workgroup_id_x 1
  .amdhsa_float_denorm_mode_32 3
  .amdhsa_float_denorm_mode_16_64 3
.end_amdhsa_kernel
```

```asm
; @launch grid=(256,1,1) block=(512,1,1) lds=151552
.amdgcn_target "amdgcn-amd-amdhsa--gfx950"
.text
.globl sequential_preLN__sliding_local_dilated__glu_gated_geglu__prompt_kernel
.p2align 8
.type sequential_preLN__sliding_local_dilated__glu_gated_geglu__prompt_kernel,@function
sequential_preLN__sliding_local_dilated__glu_gated_geglu__prompt_kernel:
s_cmp_ge_u32 s2, 256
s_cbranch_scc1 Ldone_1
s_load_dwordx4 s[4:7], s[0:1], 0
s_load_dwordx2 s[32:33], s[0:1], 72
s_load_dwordx2 s[80:81], s[0:1], 32
s_and_b32 s3, s2, 7
s_lshr_b32 s42, s2, 3
s_and_b32 s48, s42, 3
s_lshr_b32 s49, s42, 2
s_and_b32 s34, s3, 3
s_lshl_b32 s34, s34, 2
s_add_u32 s34, s34, s48
s_lshr_b32 s35, s3, 2
s_lshl_b32 s35, s35, 3
s_add_u32 s35, s35, s49
v_lshrrev_b32 v12, 6, v0
v_and_b32 v1, 63, v0
v_readfirstlane_b32 s36, v12
s_nop 3
s_lshl_b32 s44, s34, 18
s_lshl_b32 s45, s35, 14
s_add_u32 s45, s45, s44
s_lshl_b32 s50, s34, 7
s_sub_u32 s50, s50, 16
s_and_b32 s47, s36, 3
s_lshl_b32 s43, s34, 7
s_lshl_b32 s44, s35, 3
s_add_u32 s43, s43, s44
s_mov_b32 s63, s43
s_lshl_b32 s44, s47, 1
s_add_u32 s51, s43, s44
v_lshlrev_b32 v10, 4, v1
v_lshrrev_b32 v14, 3, v1
v_and_b32 v15, 7, v1
v_and_b32 v16, 2, v14
v_xor_b32 v16, v15, v16
v_lshlrev_b32 v16, 4, v16
v_mul_u32_u24 v17, 6144, v14
s_lshl_b32 s43, s47, 11
v_add3_u32 v2, v17, v16, s43
v_xor_b32 v3, 64, v2
v_lshrrev_b32 v16, 1, v14
v_xor_b32 v16, v15, v16
v_lshlrev_b32 v16, 4, v16
s_lshl_b32 s43, s47, 3
s_add_u32 s43, s43, s50
v_add_u32 v17, s43, v14
s_and_b32 s44, s47, 1
s_lshl_b32 s44, s44, 6
v_add_u32 v18, 0, v17
v_max_i32 v18, 0, v18
v_lshl_add_u32 v18, v18, 11, v16
v_xor_b32 v18, s44, v18
v_mov_b32 v4, v18
v_add_u32 v18, 24, v17
v_max_i32 v18, 0, v18
v_lshl_add_u32 v18, v18, 11, v16
v_xor_b32 v18, s44, v18
v_xor_b32 v5, 64, v18
v_add_u32 v18, 48, v17
v_max_i32 v18, 0, v18
v_lshl_add_u32 v18, v18, 11, v16
v_xor_b32 v18, s44, v18
v_mov_b32 v6, v18
v_add_u32 v18, 72, v17
v_max_i32 v18, 0, v18
v_lshl_add_u32 v18, v18, 11, v16
v_xor_b32 v18, s44, v18
v_xor_b32 v7, 64, v18
v_add_u32 v18, 96, v17
v_max_i32 v18, 0, v18
v_lshl_add_u32 v18, v18, 11, v16
v_xor_b32 v18, s44, v18
v_mov_b32 v8, v18
v_add_u32 v18, 120, v17
v_max_i32 v18, 0, v18
v_lshl_add_u32 v18, v18, 11, v16
v_xor_b32 v18, s44, v18
v_xor_b32 v9, 64, v18
s_lshl_b32 s39, s47, 10
s_lshl_b32 s40, s47, 13
s_add_u32 s40, s40, 18432
s_mov_b32 s37, 0
s_mov_b32 s38, 0
s_bfm_b64 s[60:61], 56, 8
s_cmp_eq_u32 s47, 0
s_cselect_b64 s[60:61], s[60:61], -1
s_mov_b32 s53, 0x3f803f80
v_and_b32 v12, 15, v1
v_lshrrev_b32 v13, 4, v1
s_lshl_b32 s43, s35, 7
s_waitcnt lgkmcnt(0)
s_mov_b32 s8, s4
s_mov_b32 s9, s5
s_mov_b32 s10, 4194304
s_mov_b32 s11, 0x20000
s_add_u32 s12, s6, s43
s_addc_u32 s13, s7, 0
s_mov_b32 s14, 6289536
s_mov_b32 s15, 0x20000
s_add_u32 s16, s32, s45
s_addc_u32 s17, s33, 0
s_mov_b32 s18, 16384
s_mov_b32 s19, 0x20000
s_add_u32 s20, s32, 26214400
s_addc_u32 s21, s33, 0
s_mov_b32 s22, 16384
s_mov_b32 s23, 0x20000
s_cmp_lt_u32 s36, 4
s_cbranch_scc1 Lcons_2
s_cmp_eq_u32 s36, 7
s_cbranch_scc1 Lpf_3
s_add_u32 m0, s39, 0
s_mov_b64 exec, s[60:61]
buffer_load_dwordx4 v4, s[8:11], s37 offen lds
s_mov_b64 exec, -1
s_add_u32 m0, s39, 3072
s_nop 0
buffer_load_dwordx4 v5, s[8:11], s37 offen lds
s_add_u32 m0, s39, 6144
s_nop 0
buffer_load_dwordx4 v6, s[8:11], s37 offen lds
s_add_u32 m0, s39, 9216
s_nop 0
buffer_load_dwordx4 v7, s[8:11], s37 offen lds
s_add_u32 m0, s39, 12288
s_nop 0
buffer_load_dwordx4 v8, s[8:11], s37 offen lds
s_add_u32 m0, s39, 15360
s_nop 0
buffer_load_dwordx4 v9, s[8:11], s37 offen lds
s_add_u32 m0, s40, 0
s_add_u32 s43, s38, 0
buffer_load_dwordx4 v2, s[12:15], s43 offen lds
s_add_u32 m0, s40, 1024
s_add_u32 s43, s38, 49152
buffer_load_dwordx4 v3, s[12:15], s43 offen lds
s_add_u32 m0, s40, 2048
s_add_u32 s43, s38, 98304
buffer_load_dwordx4 v2, s[12:15], s43 offen lds
s_add_u32 m0, s40, 3072
s_add_u32 s43, s38, 147456
buffer_load_dwordx4 v3, s[12:15], s43 offen lds
s_add_u32 m0, s40, 4096
s_add_u32 s43, s38, 196608
buffer_load_dwordx4 v2, s[12:15], s43 offen lds
s_add_u32 m0, s40, 5120
s_add_u32 s43, s38, 245760
buffer_load_dwordx4 v3, s[12:15], s43 offen lds
s_add_u32 m0, s40, 6144
s_add_u32 s43, s38, 294912
buffer_load_dwordx4 v2, s[12:15], s43 offen lds
s_add_u32 m0, s40, 7168
s_add_u32 s43, s38, 344064
buffer_load_dwordx4 v3, s[12:15], s43 offen lds
s_add_u32 s37, s37, 128
s_add_u32 s38, s38, 393216
s_add_u32 m0, s39, 43008
s_mov_b64 exec, s[60:61]
buffer_load_dwordx4 v4, s[8:11], s37 offen lds
s_mov_b64 exec, -1
s_add_u32 m0, s39, 46080
s_nop 0
buffer_load_dwordx4 v5, s[8:11], s37 offen lds
s_add_u32 m0, s39, 49152
s_nop 0
buffer_load_dwordx4 v6, s[8:11], s37 offen lds
s_add_u32 m0, s39, 52224
s_nop 0
buffer_load_dwordx4 v7, s[8:11], s37 offen lds
s_add_u32 m0, s39, 55296
s_nop 0
buffer_load_dwordx4 v8, s[8:11], s37 offen lds
s_add_u32 m0, s39, 58368
s_nop 0
buffer_load_dwordx4 v9, s[8:11], s37 offen lds
s_add_u32 m0, s40, 43008
s_add_u32 s43, s38, 0
buffer_load_dwordx4 v2, s[12:15], s43 offen lds
s_add_u32 m0, s40, 44032
s_add_u32 s43, s38, 49152
buffer_load_dwordx4 v3, s[12:15], s43 offen lds
s_add_u32 m0, s40, 45056
s_add_u32 s43, s38, 98304
buffer_load_dwordx4 v2, s[12:15], s43 offen lds
s_add_u32 m0, s40, 46080
s_add_u32 s43, s38, 147456
buffer_load_dwordx4 v3, s[12:15], s43 offen lds
s_add_u32 m0, s40, 47104
s_add_u32 s43, s38, 196608
buffer_load_dwordx4 v2, s[12:15], s43 offen lds
s_add_u32 m0, s40, 48128
s_add_u32 s43, s38, 245760
buffer_load_dwordx4 v3, s[12:15], s43 offen lds
s_add_u32 m0, s40, 49152
s_add_u32 s43, s38, 294912
buffer_load_dwordx4 v2, s[12:15], s43 offen lds
s_add_u32 m0, s40, 50176
s_add_u32 s43, s38, 344064
buffer_load_dwordx4 v3, s[12:15], s43 offen lds
s_add_u32 s37, s37, 128
s_add_u32 s38, s38, 393216
s_waitcnt vmcnt(14)
s_barrier
s_add_u32 m0, s39, 86016
s_mov_b64 exec, s[60:61]
buffer_load_dwordx4 v4, s[8:11], s37 offen lds
s_mov_b64 exec, -1
s_add_u32 m0, s39, 89088
s_nop 0
buffer_load_dwordx4 v5, s[8:11], s37 offen lds
s_add_u32 m0, s39, 92160
s_nop 0
buffer_load_dwordx4 v6, s[8:11], s37 offen lds
s_add_u32 m0, s39, 95232
s_nop 0
buffer_load_dwordx4 v7, s[8:11], s37 offen lds
s_add_u32 m0, s39, 98304
s_nop 0
buffer_load_dwordx4 v8, s[8:11], s37 offen lds
s_add_u32 m0, s39, 101376
s_nop 0
buffer_load_dwordx4 v9, s[8:11], s37 offen lds
s_add_u32 m0, s40, 86016
s_add_u32 s43, s38, 0
buffer_load_dwordx4 v2, s[12:15], s43 offen lds
s_add_u32 m0, s40, 87040
s_add_u32 s43, s38, 49152
buffer_load_dwordx4 v3, s[12:15], s43 offen lds
s_add_u32 m0, s40, 88064
s_add_u32 s43, s38, 98304
buffer_load_dwordx4 v2, s[12:15], s43 offen lds
s_add_u32 m0, s40, 89088
s_add_u32 s43, s38, 147456
buffer_load_dwordx4 v3, s[12:15], s43 offen lds
s_add_u32 m0, s40, 90112
s_add_u32 s43, s38, 196608
buffer_load_dwordx4 v2, s[12:15], s43 offen lds
s_add_u32 m0, s40, 91136
s_add_u32 s43, s38, 245760
buffer_load_dwordx4 v3, s[12:15], s43 offen lds
s_add_u32 m0, s40, 92160
s_add_u32 s43, s38, 294912
buffer_load_dwordx4 v2, s[12:15], s43 offen lds
s_add_u32 m0, s40, 93184
s_add_u32 s43, s38, 344064
buffer_load_dwordx4 v3, s[12:15], s43 offen lds
s_add_u32 s37, s37, 128
s_add_u32 s38, s38, 393216
s_lshl_b32 s43, s51, 11
buffer_load_dwordx4 v[96:99], v10, s[8:11], s43 offen offset:0
buffer_load_dwordx4 v[100:103], v10, s[8:11], s43 offen offset:1024
buffer_load_dwordx4 v[104:107], v10, s[8:11], s43 offen offset:2048
buffer_load_dwordx4 v[108:111], v10, s[8:11], s43 offen offset:3072
s_lshr_b32 s43, s2, 5
s_cmp_eq_u32 s43, 3
s_cbranch_scc1 Lsj_7
s_cmp_gt_u32 s43, 3
s_cselect_b32 s43, 32, 0
s_sub_u32 s43, s2, s43
s_lshr_b32 s43, s43, 1
s_and_b32 s44, s2, 1
s_lshl_b32 s44, s44, 3
s_add_u32 s44, s44, 32
s_load_dwordx2 s[80:81], s[0:1], s44
s_mul_i32 s45, s43, 2341
s_lshr_b32 s45, s45, 16
s_mul_i32 s46, s45, 28
s_sub_u32 s46, s43, s46
s_lshl_b32 s45, s45, 8
s_mul_i32 s44, s47, 18
s_add_u32 s45, s45, s44
s_add_u32 s45, s45, 184
s_mul_i32 s45, s45, 7168
s_lshl_b32 s46, s46, 8
s_add_u32 s45, s45, s46
s_waitcnt lgkmcnt(0)
s_add_u32 s80, s80, s45
s_addc_u32 s81, s81, 0
Lsj_7:
s_waitcnt vmcnt(18)
s_barrier
s_add_u32 m0, s39, 0
s_mov_b64 exec, s[60:61]
buffer_load_dwordx4 v4, s[8:11], s37 offen lds
s_mov_b64 exec, -1
s_add_u32 m0, s39, 3072
s_nop 0
buffer_load_dwordx4 v5, s[8:11], s37 offen lds
s_add_u32 m0, s39, 6144
s_nop 0
buffer_load_dwordx4 v6, s[8:11], s37 offen lds
s_add_u32 m0, s39, 9216
s_nop 0
buffer_load_dwordx4 v7, s[8:11], s37 offen lds
s_add_u32 m0, s39, 12288
s_nop 0
buffer_load_dwordx4 v8, s[8:11], s37 offen lds
s_add_u32 m0, s39, 15360
s_nop 0
buffer_load_dwordx4 v9, s[8:11], s37 offen lds
s_add_u32 m0, s40, 0
s_add_u32 s43, s38, 0
buffer_load_dwordx4 v2, s[12:15], s43 offen lds
s_add_u32 m0, s40, 1024
s_add_u32 s43, s38, 49152
buffer_load_dwordx4 v3, s[12:15], s43 offen lds
s_add_u32 m0, s40, 2048
s_add_u32 s43, s38, 98304
buffer_load_dwordx4 v2, s[12:15], s43 offen lds
s_add_u32 m0, s40, 3072
s_add_u32 s43, s38, 147456
buffer_load_dwordx4 v3, s[12:15], s43 offen lds
s_add_u32 m0, s40, 4096
s_add_u32 s43, s38, 196608
buffer_load_dwordx4 v2, s[12:15], s43 offen lds
s_add_u32 m0, s40, 5120
s_add_u32 s43, s38, 245760
buffer_load_dwordx4 v3, s[12:15], s43 offen lds
s_add_u32 m0, s40, 6144
s_add_u32 s43, s38, 294912
buffer_load_dwordx4 v2, s[12:15], s43 offen lds
s_add_u32 m0, s40, 7168
s_add_u32 s43, s38, 344064
buffer_load_dwordx4 v3, s[12:15], s43 offen lds
s_add_u32 s37, s37, 128
s_add_u32 s38, s38, 393216
s_waitcnt vmcnt(14)
s_barrier
s_add_u32 m0, s39, 43008
s_mov_b64 exec, s[60:61]
buffer_load_dwordx4 v4, s[8:11], s37 offen lds
s_mov_b64 exec, -1
s_add_u32 m0, s39, 46080
s_nop 0
buffer_load_dwordx4 v5, s[8:11], s37 offen lds
s_add_u32 m0, s39, 49152
s_nop 0
buffer_load_dwordx4 v6, s[8:11], s37 offen lds
s_add_u32 m0, s39, 52224
s_nop 0
buffer_load_dwordx4 v7, s[8:11], s37 offen lds
s_add_u32 m0, s39, 55296
s_nop 0
buffer_load_dwordx4 v8, s[8:11], s37 offen lds
s_add_u32 m0, s39, 58368
s_nop 0
buffer_load_dwordx4 v9, s[8:11], s37 offen lds
s_add_u32 m0, s40, 43008
s_add_u32 s43, s38, 0
buffer_load_dwordx4 v2, s[12:15], s43 offen lds
s_add_u32 m0, s40, 44032
s_add_u32 s43, s38, 49152
buffer_load_dwordx4 v3, s[12:15], s43 offen lds
s_add_u32 m0, s40, 45056
s_add_u32 s43, s38, 98304
buffer_load_dwordx4 v2, s[12:15], s43 offen lds
s_add_u32 m0, s40, 46080
s_add_u32 s43, s38, 147456
buffer_load_dwordx4 v3, s[12:15], s43 offen lds
s_add_u32 m0, s40, 47104
s_add_u32 s43, s38, 196608
buffer_load_dwordx4 v2, s[12:15], s43 offen lds
s_add_u32 m0, s40, 48128
s_add_u32 s43, s38, 245760
buffer_load_dwordx4 v3, s[12:15], s43 offen lds
s_add_u32 m0, s40, 49152
s_add_u32 s43, s38, 294912
buffer_load_dwordx4 v2, s[12:15], s43 offen lds
s_add_u32 m0, s40, 50176
s_add_u32 s43, s38, 344064
buffer_load_dwordx4 v3, s[12:15], s43 offen lds
s_add_u32 s37, s37, 128
s_add_u32 s38, s38, 393216
v_lshlrev_b32 v116, 16, v96
v_and_b32 v117, 0xffff0000, v96
v_mul_f32 v118, v116, v116
v_mul_f32 v119, v117, v117
v_lshlrev_b32 v126, 16, v97
v_and_b32 v127, 0xffff0000, v97
v_add_f32 v116, v116, v126
v_add_f32 v117, v117, v127
v_fmac_f32 v118, v126, v126
v_fmac_f32 v119, v127, v127
v_lshlrev_b32 v124, 16, v98
v_and_b32 v125, 0xffff0000, v98
v_add_f32 v116, v116, v124
v_add_f32 v117, v117, v125
v_fmac_f32 v118, v124, v124
v_fmac_f32 v119, v125, v125
v_lshlrev_b32 v126, 16, v99
v_and_b32 v127, 0xffff0000, v99
v_add_f32 v116, v116, v126
v_add_f32 v117, v117, v127
v_fmac_f32 v118, v126, v126
v_fmac_f32 v119, v127, v127
v_lshlrev_b32 v124, 16, v100
v_and_b32 v125, 0xffff0000, v100
v_add_f32 v116, v116, v124
v_add_f32 v117, v117, v125
v_fmac_f32 v118, v124, v124
v_fmac_f32 v119, v125, v125
v_lshlrev_b32 v126, 16, v101
v_and_b32 v127, 0xffff0000, v101
v_add_f32 v116, v116, v126
v_add_f32 v117, v117, v127
v_fmac_f32 v118, v126, v126
v_fmac_f32 v119, v127, v127
v_lshlrev_b32 v124, 16, v102
v_and_b32 v125, 0xffff0000, v102
v_add_f32 v116, v116, v124
v_add_f32 v117, v117, v125
v_fmac_f32 v118, v124, v124
v_fmac_f32 v119, v125, v125
v_lshlrev_b32 v126, 16, v103
v_and_b32 v127, 0xffff0000, v103
v_add_f32 v116, v116, v126
v_add_f32 v117, v117, v127
v_fmac_f32 v118, v126, v126
v_fmac_f32 v119, v127, v127
v_lshlrev_b32 v120, 16, v104
v_and_b32 v121, 0xffff0000, v104
v_mul_f32 v122, v120, v120
v_mul_f32 v123, v121, v121
s_waitcnt vmcnt(14)
s_barrier
s_add_u32 m0, s39, 86016
s_mov_b64 exec, s[60:61]
buffer_load_dwordx4 v4, s[8:11], s37 offen lds
s_mov_b64 exec, -1
s_add_u32 m0, s39, 89088
s_nop 0
buffer_load_dwordx4 v5, s[8:11], s37 offen lds
s_add_u32 m0, s39, 92160
s_nop 0
buffer_load_dwordx4 v6, s[8:11], s37 offen lds
s_add_u32 m0, s39, 95232
s_nop 0
buffer_load_dwordx4 v7, s[8:11], s37 offen lds
s_add_u32 m0, s39, 98304
s_nop 0
buffer_load_dwordx4 v8, s[8:11], s37 offen lds
s_add_u32 m0, s39, 101376
s_nop 0
buffer_load_dwordx4 v9, s[8:11], s37 offen lds
s_add_u32 m0, s40, 86016
s_add_u32 s43, s38, 0
buffer_load_dwordx4 v2, s[12:15], s43 offen lds
s_add_u32 m0, s40, 87040
s_add_u32 s43, s38, 49152
buffer_load_dwordx4 v3, s[12:15], s43 offen lds
s_add_u32 m0, s40, 88064
s_add_u32 s43, s38, 98304
buffer_load_dwordx4 v2, s[12:15], s43 offen lds
s_add_u32 m0, s40, 89088
s_add_u32 s43, s38, 147456
buffer_load_dwordx4 v3, s[12:15], s43 offen lds
s_add_u32 m0, s40, 90112
s_add_u32 s43, s38, 196608
buffer_load_dwordx4 v2, s[12:15], s43 offen lds
s_add_u32 m0, s40, 91136
s_add_u32 s43, s38, 245760
buffer_load_dwordx4 v3, s[12:15], s43 offen lds
s_add_u32 m0, s40, 92160
s_add_u32 s43, s38, 294912
buffer_load_dwordx4 v2, s[12:15], s43 offen lds
s_add_u32 m0, s40, 93184
s_add_u32 s43, s38, 344064
buffer_load_dwordx4 v3, s[12:15], s43 offen lds
s_add_u32 s37, s37, 128
s_add_u32 s38, s38, 393216
v_lshlrev_b32 v126, 16, v105
v_and_b32 v127, 0xffff0000, v105
v_add_f32 v120, v120, v126
v_add_f32 v121, v121, v127
v_fmac_f32 v122, v126, v126
v_fmac_f32 v123, v127, v127
v_lshlrev_b32 v124, 16, v106
v_and_b32 v125, 0xffff0000, v106
v_add_f32 v120, v120, v124
v_add_f32 v121, v121, v125
v_fmac_f32 v122, v124, v124
v_fmac_f32 v123, v125, v125
v_lshlrev_b32 v126, 16, v107
v_and_b32 v127, 0xffff0000, v107
v_add_f32 v120, v120, v126
v_add_f32 v121, v121, v127
v_fmac_f32 v122, v126, v126
v_fmac_f32 v123, v127, v127
v_lshlrev_b32 v124, 16, v108
v_and_b32 v125, 0xffff0000, v108
v_add_f32 v120, v120, v124
v_add_f32 v121, v121, v125
v_fmac_f32 v122, v124, v124
v_fmac_f32 v123, v125, v125
v_lshlrev_b32 v126, 16, v109
v_and_b32 v127, 0xffff0000, v109
v_add_f32 v120, v120, v126
v_add_f32 v121, v121, v127
v_fmac_f32 v122, v126, v126
v_fmac_f32 v123, v127, v127
v_lshlrev_b32 v124, 16, v110
v_and_b32 v125, 0xffff0000, v110
v_add_f32 v120, v120, v124
v_add_f32 v121, v121, v125
v_fmac_f32 v122, v124, v124
v_fmac_f32 v123, v125, v125
v_lshlrev_b32 v126, 16, v111
v_and_b32 v127, 0xffff0000, v111
v_add_f32 v120, v120, v126
v_add_f32 v121, v121, v127
v_fmac_f32 v122, v126, v126
v_fmac_f32 v123, v127, v127
v_add_f32 v116, v116, v117
v_add_f32 v118, v118, v119
v_add_f32 v120, v120, v121
v_add_f32 v122, v122, v123
v_add_f32_dpp v116, v116, v116 row_ror:8 row_mask:0xf bank_mask:0xf
v_add_f32_dpp v118, v118, v118 row_ror:8 row_mask:0xf bank_mask:0xf
v_add_f32_dpp v120, v120, v120 row_ror:8 row_mask:0xf bank_mask:0xf
v_add_f32_dpp v122, v122, v122 row_ror:8 row_mask:0xf bank_mask:0xf
s_waitcnt vmcnt(14)
s_barrier
s_add_u32 m0, s39, 0
s_mov_b64 exec, s[60:61]
buffer_load_dwordx4 v4, s[8:11], s37 offen lds
s_mov_b64 exec, -1
s_add_u32 m0, s39, 3072
s_nop 0
buffer_load_dwordx4 v5, s[8:11], s37 offen lds
s_add_u32 m0, s39, 6144
s_nop 0
buffer_load_dwordx4 v6, s[8:11], s37 offen lds
s_add_u32 m0, s39, 9216
s_nop 0
buffer_load_dwordx4 v7, s[8:11], s37 offen lds
s_add_u32 m0, s39, 12288
s_nop 0
buffer_load_dwordx4 v8, s[8:11], s37 offen lds
s_add_u32 m0, s39, 15360
s_nop 0
buffer_load_dwordx4 v9, s[8:11], s37 offen lds
s_add_u32 m0, s40, 0
s_add_u32 s43, s38, 0
buffer_load_dwordx4 v2, s[12:15], s43 offen lds
s_add_u32 m0, s40, 1024
s_add_u32 s43, s38, 49152
buffer_load_dwordx4 v3, s[12:15], s43 offen lds
s_add_u32 m0, s40, 2048
s_add_u32 s43, s38, 98304
buffer_load_dwordx4 v2, s[12:15], s43 offen lds
s_add_u32 m0, s40, 3072
s_add_u32 s43, s38, 147456
buffer_load_dwordx4 v3, s[12:15], s43 offen lds
s_add_u32 m0, s40, 4096
s_add_u32 s43, s38, 196608
buffer_load_dwordx4 v2, s[12:15], s43 offen lds
s_add_u32 m0, s40, 5120
s_add_u32 s43, s38, 245760
buffer_load_dwordx4 v3, s[12:15], s43 offen lds
s_add_u32 m0, s40, 6144
s_add_u32 s43, s38, 294912
buffer_load_dwordx4 v2, s[12:15], s43 offen lds
s_add_u32 m0, s40, 7168
s_add_u32 s43, s38, 344064
buffer_load_dwordx4 v3, s[12:15], s43 offen lds
s_add_u32 s37, s37, 128
s_add_u32 s38, s38, 393216
v_add_f32_dpp v116, v116, v116 row_ror:4 row_mask:0xf bank_mask:0xf
v_add_f32_dpp v118, v118, v118 row_ror:4 row_mask:0xf bank_mask:0xf
v_add_f32_dpp v120, v120, v120 row_ror:4 row_mask:0xf bank_mask:0xf
v_add_f32_dpp v122, v122, v122 row_ror:4 row_mask:0xf bank_mask:0xf
v_add_f32_dpp v116, v116, v116 row_ror:2 row_mask:0xf bank_mask:0xf
v_add_f32_dpp v118, v118, v118 row_ror:2 row_mask:0xf bank_mask:0xf
v_add_f32_dpp v120, v120, v120 row_ror:2 row_mask:0xf bank_mask:0xf
v_add_f32_dpp v122, v122, v122 row_ror:2 row_mask:0xf bank_mask:0xf
v_add_f32_dpp v116, v116, v116 row_ror:1 row_mask:0xf bank_mask:0xf
v_add_f32_dpp v118, v118, v118 row_ror:1 row_mask:0xf bank_mask:0xf
v_add_f32_dpp v120, v120, v120 row_ror:1 row_mask:0xf bank_mask:0xf
v_add_f32_dpp v122, v122, v122 row_ror:1 row_mask:0xf bank_mask:0xf
v_mov_b32 v117, v116
v_mov_b32 v119, v118
v_mov_b32 v121, v120
v_mov_b32 v123, v122
s_nop 0
v_permlane16_swap_b32 v116, v117
v_permlane16_swap_b32 v118, v119
v_permlane16_swap_b32 v120, v121
v_permlane16_swap_b32 v122, v123
v_add_f32 v116, v116, v117
v_add_f32 v118, v118, v119
v_add_f32 v120, v120, v121
v_add_f32 v122, v122, v123
v_mov_b32 v117, v116
v_mov_b32 v119, v118
v_mov_b32 v121, v120
v_mov_b32 v123, v122
s_nop 0
v_permlane32_swap_b32 v116, v117
v_permlane32_swap_b32 v118, v119
v_permlane32_swap_b32 v120, v121
v_permlane32_swap_b32 v122, v123
v_add_f32 v116, v116, v117
v_add_f32 v118, v118, v119
v_add_f32 v120, v120, v121
v_add_f32 v122, v122, v123
v_mul_f32 v112, 0x3a800000, v116
v_mul_f32 v113, 0x3a800000, v118
v_fma_f32 v113, -v112, v112, v113
v_max_f32 v113, 0, v113
v_add_f32 v113, 0x3727c5ac, v113
v_rsq_f32 v113, v113
v_mul_f32 v114, 0x3a800000, v120
v_mul_f32 v115, 0x3a800000, v122
v_fma_f32 v115, -v114, v114, v115
v_max_f32 v115, 0, v115
v_add_f32 v115, 0x3727c5ac, v115
v_rsq_f32 v115, v115
s_nop 0
s_lshl_b32 s43, s47, 4
s_add_u32 s43, s43, 130176
v_mov_b32 v11, s43
ds_write_b128 v11, v[112:115]
s_waitcnt lgkmcnt(0)
s_load_dword s64, s[80:81], 0
s_load_dword s65, s[80:81], 64
s_load_dword s66, s[80:81], 128
s_load_dword s67, s[80:81], 192
s_load_dword s68, s[80:81], 7168
s_load_dword s69, s[80:81], 7232
s_load_dword s70, s[80:81], 7296
s_load_dword s71, s[80:81], 7360
s_add_u32 s80, s80, 14336
s_addc_u32 s81, s81, 0
s_waitcnt vmcnt(14)
s_barrier
s_mov_b32 s41, 2
Lpl_8:
s_add_u32 m0, s39, 43008
s_mov_b64 exec, s[60:61]
buffer_load_dwordx4 v4, s[8:11], s37 offen lds
s_mov_b64 exec, -1
s_add_u32 m0, s39, 46080
s_nop 0
buffer_load_dwordx4 v5, s[8:11], s37 offen lds
s_add_u32 m0, s39, 49152
s_nop 0
buffer_load_dwordx4 v6, s[8:11], s37 offen lds
s_add_u32 m0, s39, 52224
s_nop 0
buffer_load_dwordx4 v7, s[8:11], s37 offen lds
s_add_u32 m0, s39, 55296
s_nop 0
buffer_load_dwordx4 v8, s[8:11], s37 offen lds
s_add_u32 m0, s39, 58368
s_nop 0
buffer_load_dwordx4 v9, s[8:11], s37 offen lds
s_add_u32 m0, s40, 43008
s_add_u32 s43, s38, 0
buffer_load_dwordx4 v2, s[12:15], s43 offen lds
s_add_u32 m0, s40, 44032
s_add_u32 s43, s38, 49152
buffer_load_dwordx4 v3, s[12:15], s43 offen lds
s_add_u32 m0, s40, 45056
s_add_u32 s43, s38, 98304
buffer_load_dwordx4 v2, s[12:15], s43 offen lds
s_add_u32 m0, s40, 46080
s_add_u32 s43, s38, 147456
buffer_load_dwordx4 v3, s[12:15], s43 offen lds
s_add_u32 m0, s40, 47104
s_add_u32 s43, s38, 196608
buffer_load_dwordx4 v2, s[12:15], s43 offen lds
s_add_u32 m0, s40, 48128
s_add_u32 s43, s38, 245760
buffer_load_dwordx4 v3, s[12:15], s43 offen lds
s_add_u32 m0, s40, 49152
s_add_u32 s43, s38, 294912
buffer_load_dwordx4 v2, s[12:15], s43 offen lds
s_add_u32 m0, s40, 50176
s_add_u32 s43, s38, 344064
buffer_load_dwordx4 v3, s[12:15], s43 offen lds
s_add_u32 s37, s37, 128
s_add_u32 s38, s38, 393216
s_load_dword s64, s[80:81], 0
s_load_dword s65, s[80:81], 64
s_load_dword s66, s[80:81], 128
s_load_dword s67, s[80:81], 192
s_load_dword s68, s[80:81], 7168
s_load_dword s69, s[80:81], 7232
s_load_dword s70, s[80:81], 7296
s_load_dword s71, s[80:81], 7360
s_add_u32 s80, s80, 14336
s_addc_u32 s81, s81, 0
s_waitcnt vmcnt(14)
s_barrier
s_add_u32 m0, s39, 86016
s_mov_b64 exec, s[60:61]
buffer_load_dwordx4 v4, s[8:11], s37 offen lds
s_mov_b64 exec, -1
s_add_u32 m0, s39, 89088
s_nop 0
buffer_load_dwordx4 v5, s[8:11], s37 offen lds
s_add_u32 m0, s39, 92160
s_nop 0
buffer_load_dwordx4 v6, s[8:11], s37 offen lds
s_add_u32 m0, s39, 95232
s_nop 0
buffer_load_dwordx4 v7, s[8:11], s37 offen lds
s_add_u32 m0, s39, 98304
s_nop 0
buffer_load_dwordx4 v8, s[8:11], s37 offen lds
s_add_u32 m0, s39, 101376
s_nop 0
buffer_load_dwordx4 v9, s[8:11], s37 offen lds
s_add_u32 m0, s40, 86016
s_add_u32 s43, s38, 0
buffer_load_dwordx4 v2, s[12:15], s43 offen lds
s_add_u32 m0, s40, 87040
s_add_u32 s43, s38, 49152
buffer_load_dwordx4 v3, s[12:15], s43 offen lds
s_add_u32 m0, s40, 88064
s_add_u32 s43, s38, 98304
buffer_load_dwordx4 v2, s[12:15], s43 offen lds
s_add_u32 m0, s40, 89088
s_add_u32 s43, s38, 147456
buffer_load_dwordx4 v3, s[12:15], s43 offen lds
s_add_u32 m0, s40, 90112
s_add_u32 s43, s38, 196608
buffer_load_dwordx4 v2, s[12:15], s43 offen lds
s_add_u32 m0, s40, 91136
s_add_u32 s43, s38, 245760
buffer_load_dwordx4 v3, s[12:15], s43 offen lds
s_add_u32 m0, s40, 92160
s_add_u32 s43, s38, 294912
buffer_load_dwordx4 v2, s[12:15], s43 offen lds
s_add_u32 m0, s40, 93184
s_add_u32 s43, s38, 344064
buffer_load_dwordx4 v3, s[12:15], s43 offen lds
s_add_u32 s37, s37, 128
s_add_u32 s38, s38, 393216
s_load_dword s64, s[80:81], 0
s_load_dword s65, s[80:81], 64
s_load_dword s66, s[80:81], 128
s_load_dword s67, s[80:81], 192
s_load_dword s68, s[80:81], 7168
s_load_dword s69, s[80:81], 7232
s_load_dword s70, s[80:81], 7296
s_load_dword s71, s[80:81], 7360
s_add_u32 s80, s80, 14336
s_addc_u32 s81, s81, 0
s_waitcnt vmcnt(14)
s_barrier
s_add_u32 m0, s39, 0
s_mov_b64 exec, s[60:61]
buffer_load_dwordx4 v4, s[8:11], s37 offen lds
s_mov_b64 exec, -1
s_add_u32 m0, s39, 3072
s_nop 0
buffer_load_dwordx4 v5, s[8:11], s37 offen lds
s_add_u32 m0, s39, 6144
s_nop 0
buffer_load_dwordx4 v6, s[8:11], s37 offen lds
s_add_u32 m0, s39, 9216
s_nop 0
buffer_load_dwordx4 v7, s[8:11], s37 offen lds
s_add_u32 m0, s39, 12288
s_nop 0
buffer_load_dwordx4 v8, s[8:11], s37 offen lds
s_add_u32 m0, s39, 15360
s_nop 0
buffer_load_dwordx4 v9, s[8:11], s37 offen lds
s_add_u32 m0, s40, 0
s_add_u32 s43, s38, 0
buffer_load_dwordx4 v2, s[12:15], s43 offen lds
s_add_u32 m0, s40, 1024
s_add_u32 s43, s38, 49152
buffer_load_dwordx4 v3, s[12:15], s43 offen lds
s_add_u32 m0, s40, 2048
s_add_u32 s43, s38, 98304
buffer_load_dwordx4 v2, s[12:15], s43 offen lds
s_add_u32 m0, s40, 3072
s_add_u32 s43, s38, 147456
buffer_load_dwordx4 v3, s[12:15], s43 offen lds
s_add_u32 m0, s40, 4096
s_add_u32 s43, s38, 196608
buffer_load_dwordx4 v2, s[12:15], s43 offen lds
s_add_u32 m0, s40, 5120
s_add_u32 s43, s38, 245760
buffer_load_dwordx4 v3, s[12:15], s43 offen lds
s_add_u32 m0, s40, 6144
s_add_u32 s43, s38, 294912
buffer_load_dwordx4 v2, s[12:15], s43 offen lds
s_add_u32 m0, s40, 7168
s_add_u32 s43, s38, 344064
buffer_load_dwordx4 v3, s[12:15], s43 offen lds
s_add_u32 s37, s37, 128
s_add_u32 s38, s38, 393216
s_load_dword s64, s[80:81], 0
s_load_dword s65, s[80:81], 64
s_load_dword s66, s[80:81], 128
s_load_dword s67, s[80:81], 192
s_load_dword s68, s[80:81], 7168
s_load_dword s69, s[80:81], 7232
s_load_dword s70, s[80:81], 7296
s_load_dword s71, s[80:81], 7360
s_add_u32 s80, s80, 14336
s_addc_u32 s81, s81, 0
s_waitcnt vmcnt(14)
s_barrier
s_sub_u32 s41, s41, 1
s_cmp_lg_u32 s41, 0
s_cbranch_scc1 Lpl_8
s_add_u32 m0, s39, 43008
s_mov_b64 exec, s[60:61]
buffer_load_dwordx4 v4, s[8:11], s37 offen lds
s_mov_b64 exec, -1
s_add_u32 m0, s39, 46080
s_nop 0
buffer_load_dwordx4 v5, s[8:11], s37 offen lds
s_add_u32 m0, s39, 49152
s_nop 0
buffer_load_dwordx4 v6, s[8:11], s37 offen lds
s_add_u32 m0, s39, 52224
s_nop 0
buffer_load_dwordx4 v7, s[8:11], s37 offen lds
s_add_u32 m0, s39, 55296
s_nop 0
buffer_load_dwordx4 v8, s[8:11], s37 offen lds
s_add_u32 m0, s39, 58368
s_nop 0
buffer_load_dwordx4 v9, s[8:11], s37 offen lds
s_add_u32 m0, s40, 43008
s_add_u32 s43, s38, 0
buffer_load_dwordx4 v2, s[12:15], s43 offen lds
s_add_u32 m0, s40, 44032
s_add_u32 s43, s38, 49152
buffer_load_dwordx4 v3, s[12:15], s43 offen lds
s_add_u32 m0, s40, 45056
s_add_u32 s43, s38, 98304
buffer_load_dwordx4 v2, s[12:15], s43 offen lds
s_add_u32 m0, s40, 46080
s_add_u32 s43, s38, 147456
buffer_load_dwordx4 v3, s[12:15], s43 offen lds
s_add_u32 m0, s40, 47104
s_add_u32 s43, s38, 196608
buffer_load_dwordx4 v2, s[12:15], s43 offen lds
s_add_u32 m0, s40, 48128
s_add_u32 s43, s38, 245760
buffer_load_dwordx4 v3, s[12:15], s43 offen lds
s_add_u32 m0, s40, 49152
s_add_u32 s43, s38, 294912
buffer_load_dwordx4 v2, s[12:15], s43 offen lds
s_add_u32 m0, s40, 50176
s_add_u32 s43, s38, 344064
buffer_load_dwordx4 v3, s[12:15], s43 offen lds
s_add_u32 s37, s37, 128
s_add_u32 s38, s38, 393216
s_load_dword s64, s[80:81], 0
s_load_dword s65, s[80:81], 64
s_load_dword s66, s[80:81], 128
s_load_dword s67, s[80:81], 192
s_load_dword s68, s[80:81], 7168
s_load_dword s69, s[80:81], 7232
s_load_dword s70, s[80:81], 7296
s_load_dword s71, s[80:81], 7360
s_add_u32 s80, s80, 14336
s_addc_u32 s81, s81, 0
s_waitcnt vmcnt(14)
s_barrier
s_add_u32 m0, s39, 86016
s_mov_b64 exec, s[60:61]
buffer_load_dwordx4 v4, s[8:11], s37 offen lds
s_mov_b64 exec, -1
s_add_u32 m0, s39, 89088
s_nop 0
buffer_load_dwordx4 v5, s[8:11], s37 offen lds
s_add_u32 m0, s39, 92160
s_nop 0
buffer_load_dwordx4 v6, s[8:11], s37 offen lds
s_add_u32 m0, s39, 95232
s_nop 0
buffer_load_dwordx4 v7, s[8:11], s37 offen lds
s_add_u32 m0, s39, 98304
s_nop 0
buffer_load_dwordx4 v8, s[8:11], s37 offen lds
s_add_u32 m0, s39, 101376
s_nop 0
buffer_load_dwordx4 v9, s[8:11], s37 offen lds
s_add_u32 m0, s40, 86016
s_add_u32 s43, s38, 0
buffer_load_dwordx4 v2, s[12:15], s43 offen lds
s_add_u32 m0, s40, 87040
s_add_u32 s43, s38, 49152
buffer_load_dwordx4 v3, s[12:15], s43 offen lds
s_add_u32 m0, s40, 88064
s_add_u32 s43, s38, 98304
buffer_load_dwordx4 v2, s[12:15], s43 offen lds
s_add_u32 m0, s40, 89088
s_add_u32 s43, s38, 147456
buffer_load_dwordx4 v3, s[12:15], s43 offen lds
s_add_u32 m0, s40, 90112
s_add_u32 s43, s38, 196608
buffer_load_dwordx4 v2, s[12:15], s43 offen lds
s_add_u32 m0, s40, 91136
s_add_u32 s43, s38, 245760
buffer_load_dwordx4 v3, s[12:15], s43 offen lds
s_add_u32 m0, s40, 92160
s_add_u32 s43, s38, 294912
buffer_load_dwordx4 v2, s[12:15], s43 offen lds
s_add_u32 m0, s40, 93184
s_add_u32 s43, s38, 344064
buffer_load_dwordx4 v3, s[12:15], s43 offen lds
s_add_u32 s37, s37, 128
s_add_u32 s38, s38, 393216
s_load_dword s64, s[80:81], 0
s_load_dword s65, s[80:81], 64
s_load_dword s66, s[80:81], 128
s_load_dword s67, s[80:81], 192
s_load_dword s68, s[80:81], 7168
s_load_dword s69, s[80:81], 7232
s_load_dword s70, s[80:81], 7296
s_load_dword s71, s[80:81], 7360
s_add_u32 s80, s80, 14336
s_addc_u32 s81, s81, 0
s_waitcnt vmcnt(14)
s_barrier
s_add_u32 m0, s39, 0
s_mov_b64 exec, s[60:61]
buffer_load_dwordx4 v4, s[8:11], s37 offen lds
s_mov_b64 exec, -1
s_add_u32 m0, s39, 3072
s_nop 0
buffer_load_dwordx4 v5, s[8:11], s37 offen lds
s_add_u32 m0, s39, 6144
s_nop 0
buffer_load_dwordx4 v6, s[8:11], s37 offen lds
s_add_u32 m0, s39, 9216
s_nop 0
buffer_load_dwordx4 v7, s[8:11], s37 offen lds
s_add_u32 m0, s39, 12288
s_nop 0
buffer_load_dwordx4 v8, s[8:11], s37 offen lds
s_add_u32 m0, s39, 15360
s_nop 0
buffer_load_dwordx4 v9, s[8:11], s37 offen lds
s_add_u32 m0, s40, 0
s_add_u32 s43, s38, 0
buffer_load_dwordx4 v2, s[12:15], s43 offen lds
s_add_u32 m0, s40, 1024
s_add_u32 s43, s38, 49152
buffer_load_dwordx4 v3, s[12:15], s43 offen lds
s_add_u32 m0, s40, 2048
s_add_u32 s43, s38, 98304
buffer_load_dwordx4 v2, s[12:15], s43 offen lds
s_add_u32 m0, s40, 3072
s_add_u32 s43, s38, 147456
buffer_load_dwordx4 v3, s[12:15], s43 offen lds
s_add_u32 m0, s40, 4096
s_add_u32 s43, s38, 196608
buffer_load_dwordx4 v2, s[12:15], s43 offen lds
s_add_u32 m0, s40, 5120
s_add_u32 s43, s38, 245760
buffer_load_dwordx4 v3, s[12:15], s43 offen lds
s_add_u32 m0, s40, 6144
s_add_u32 s43, s38, 294912
buffer_load_dwordx4 v2, s[12:15], s43 offen lds
s_add_u32 m0, s40, 7168
s_add_u32 s43, s38, 344064
buffer_load_dwordx4 v3, s[12:15], s43 offen lds
s_add_u32 s37, s37, 128
s_add_u32 s38, s38, 393216
s_waitcnt vmcnt(14)
s_barrier
s_waitcnt vmcnt(0)
s_barrier
s_barrier
s_waitcnt lgkmcnt(0)
s_and_b32 s43, s36, 1
s_lshr_b32 s44, s36, 1
s_and_b32 s44, s44, 1
s_lshr_b32 s45, s36, 2
v_lshlrev_b32 v14, 2, v13
v_sub_u32 v14, v12, v14
v_subrev_u32 v15, 0, v14
v_cmp_ge_u32 s[52:53], 7, v15
v_add_u32 v15, 16, v15
v_cmp_ge_u32 s[84:85], 7, v15
v_subrev_u32 v15, 1, v14
v_cmp_ge_u32 s[54:55], 7, v15
v_add_u32 v15, 16, v15
v_cmp_ge_u32 s[86:87], 7, v15
v_subrev_u32 v15, 2, v14
v_cmp_ge_u32 s[56:57], 7, v15
v_add_u32 v15, 16, v15
v_cmp_ge_u32 s[88:89], 7, v15
v_subrev_u32 v15, 3, v14
v_cmp_ge_u32 s[58:59], 7, v15
v_add_u32 v15, 16, v15
v_cmp_ge_u32 s[90:91], 7, v15
s_lshl_b32 s46, s45, 6
s_add_u32 s46, s46, s44
s_add_u32 s46, s46, 16
v_lshl_add_u32 v14, v12, 1, s46
s_lshl_b32 s47, s43, 6
v_lshl_add_u32 v15, v13, 4, s47
v_mul_u32_u24 v20, 400, v14
v_add_u32 v20, v20, v15
v_subrev_u32 v16, 32, v14
v_max_i32 v16, 0, v16
v_mul_u32_u24 v21, 400, v16
v_add_u32 v21, v21, v15
v_lshrrev_b32 v16, 2, v12
v_lshl_add_u32 v16, v13, 2, v16
v_lshl_add_u32 v16, v16, 1, s46
v_and_b32 v17, 3, v1
v_lshl_add_u32 v17, v17, 3, s47
v_mul_u32_u24 v22, 400, v16
v_add_u32 v22, v22, v17
v_subrev_u32 v16, 32, v16
v_max_i32 v16, 0, v16
v_mul_u32_u24 v23, 400, v16
v_add_u32 v23, v23, v17
s_lshl_b32 s60, s43, 13
s_lshl_b32 s61, s45, 10
s_add_u32 s60, s60, s61
s_lshl_b32 s61, s44, 8
s_add_u32 s60, s60, s61
v_lshlrev_b32 v27, 11, v13
v_lshl_add_u32 v27, v12, 4, v27
v_add_u32 v27, s60, v27
v_mov_b32 v28, 0xff800000
s_mov_b32 s61, 0x3e8293ee
s_nop 2
s_or_b32 s62, s34, s45
s_cmp_lg_u32 s62, 0
s_cselect_b64 s[64:65], s[84:85], 0
s_cselect_b64 s[66:67], s[86:87], 0
s_cselect_b64 s[68:69], s[88:89], 0
s_cselect_b64 s[70:71], s[90:91], 0
s_branch Latt_4
Lcons_2:
s_cmp_ge_u32 s36, 2
s_cbranch_scc1 Lsp_5
s_mov_b32 s84, s6
s_mov_b32 s85, s7
s_mov_b32 s86, 6291456
s_mov_b32 s87, 0x20000
s_and_b32 s43, s35, 8
s_or_b32 s43, s43, 3
s_lshl_b32 s43, s43, 7
s_lshr_b32 s44, s2, 3
s_mul_i32 s44, s44, 196608
s_add_u32 s43, s43, s44
s_lshl_b32 s44, s36, 6
v_add_u32 v15, s44, v1
v_min_u32 v15, 95, v15
v_mul_u32_u24 v16, 21846, v15
v_lshrrev_b32 v16, 16, v16
v_mul_u32_u24 v17, 3, v16
v_sub_u32 v15, v15, v17
v_mul_u32_u24 v16, 6144, v16
v_lshl_add_u32 v15, v15, 11, v16
buffer_load_dword v31, v15, s[84:87], s43 offen
Lsp_5:
v_lshrrev_b32 v16, 1, v12
v_xor_b32 v15, v13, v16
v_lshlrev_b32 v15, 4, v15
v_lshl_add_u32 v2, v12, 7, v15
v_xor_b32 v3, 64, v2
v_add_u32 v4, 86016, v2
v_add_u32 v5, 86016, v3
v_lshrrev_b32 v15, 2, v12
v_and_b32 v16, 3, v1
v_lshl_add_u32 v19, v13, 3, v15
v_lshlrev_b32 v19, 7, v19
v_and_b32 v15, 2, v15
v_and_b32 v17, 1, v13
v_lshl_add_u32 v15, v17, 2, v15
v_lshrrev_b32 v17, 1, v16
s_lshl_b32 s43, s36, 1
v_add_u32 v17, s43, v17
v_xor_b32 v15, v15, v17
v_lshl_add_u32 v19, v15, 4, v19
v_and_b32 v16, 1, v16
v_lshl_add_u32 v19, v16, 3, v19
v_add_u32 v6, 18432, v19
v_add_u32 v7, 61440, v19
v_add_u32 v8, 104448, v19
v_mov_b32 v128, 0
v_mov_b32 v129, 0
v_mov_b32 v130, 0
v_mov_b32 v131, 0
v_mov_b32 v132, 0
v_mov_b32 v133, 0
v_mov_b32 v134, 0
v_mov_b32 v135, 0
v_mov_b32 v136, 0
v_mov_b32 v137, 0
v_mov_b32 v138, 0
v_mov_b32 v139, 0
v_mov_b32 v140, 0
v_mov_b32 v141, 0
v_mov_b32 v142, 0
v_mov_b32 v143, 0
v_mov_b32 v144, 0
v_mov_b32 v145, 0
v_mov_b32 v146, 0
v_mov_b32 v147, 0
v_mov_b32 v148, 0
v_mov_b32 v149, 0
v_mov_b32 v150, 0
v_mov_b32 v151, 0
v_mov_b32 v152, 0
v_mov_b32 v153, 0
v_mov_b32 v154, 0
v_mov_b32 v155, 0
v_mov_b32 v156, 0
v_mov_b32 v157, 0
v_mov_b32 v158, 0
v_mov_b32 v159, 0
v_mov_b32 v160, 0
v_mov_b32 v161, 0
v_mov_b32 v162, 0
v_mov_b32 v163, 0
v_mov_b32 v164, 0
v_mov_b32 v165, 0
v_mov_b32 v166, 0
v_mov_b32 v167, 0
v_mov_b32 v168, 0
v_mov_b32 v169, 0
v_mov_b32 v170, 0
v_mov_b32 v171, 0
v_mov_b32 v172, 0
v_mov_b32 v173, 0
v_mov_b32 v174, 0
v_mov_b32 v175, 0
v_mov_b32 v176, 0
v_mov_b32 v177, 0
v_mov_b32 v178, 0
v_mov_b32 v179, 0
v_mov_b32 v180, 0
v_mov_b32 v181, 0
v_mov_b32 v182, 0
v_mov_b32 v183, 0
v_mov_b32 v184, 0
v_mov_b32 v185, 0
v_mov_b32 v186, 0
v_mov_b32 v187, 0
v_mov_b32 v188, 0
v_mov_b32 v189, 0
v_mov_b32 v190, 0
v_mov_b32 v191, 0
v_mov_b32 v192, 0
v_mov_b32 v193, 0
v_mov_b32 v194, 0
v_mov_b32 v195, 0
v_mov_b32 v196, 0
v_mov_b32 v197, 0
v_mov_b32 v198, 0
v_mov_b32 v199, 0
v_mov_b32 v200, 0
v_mov_b32 v201, 0
v_mov_b32 v202, 0
v_mov_b32 v203, 0
v_mov_b32 v204, 0
v_mov_b32 v205, 0
v_mov_b32 v206, 0
v_mov_b32 v207, 0
v_mov_b32 v208, 0
v_mov_b32 v209, 0
v_mov_b32 v210, 0
v_mov_b32 v211, 0
v_mov_b32 v212, 0
v_mov_b32 v213, 0
v_mov_b32 v214, 0
v_mov_b32 v215, 0
v_mov_b32 v216, 0
v_mov_b32 v217, 0
v_mov_b32 v218, 0
v_mov_b32 v219, 0
v_mov_b32 v220, 0
v_mov_b32 v221, 0
v_mov_b32 v222, 0
v_mov_b32 v223, 0
v_mov_b32 v224, 0
v_mov_b32 v225, 0
v_mov_b32 v226, 0
v_mov_b32 v227, 0
v_mov_b32 v228, 0
v_mov_b32 v229, 0
v_mov_b32 v230, 0
v_mov_b32 v231, 0
v_mov_b32 v232, 0
v_mov_b32 v233, 0
v_mov_b32 v234, 0
v_mov_b32 v235, 0
s_and_b32 s43, s36, 1
s_lshr_b32 s44, s36, 1
s_and_b32 s44, s44, 1
s_lshr_b32 s45, s36, 2
v_lshlrev_b32 v14, 2, v13
v_sub_u32 v14, v12, v14
v_subrev_u32 v15, 0, v14
v_cmp_ge_u32 s[52:53], 7, v15
v_add_u32 v15, 16, v15
v_cmp_ge_u32 s[84:85], 7, v15
v_subrev_u32 v15, 1, v14
v_cmp_ge_u32 s[54:55], 7, v15
v_add_u32 v15, 16, v15
v_cmp_ge_u32 s[86:87], 7, v15
v_subrev_u32 v15, 2, v14
v_cmp_ge_u32 s[56:57], 7, v15
v_add_u32 v15, 16, v15
v_cmp_ge_u32 s[88:89], 7, v15
v_subrev_u32 v15, 3, v14
v_cmp_ge_u32 s[58:59], 7, v15
v_add_u32 v15, 16, v15
v_cmp_ge_u32 s[90:91], 7, v15
s_lshl_b32 s46, s45, 6
s_add_u32 s46, s46, s44
s_add_u32 s46, s46, 16
v_lshl_add_u32 v14, v12, 1, s46
s_lshl_b32 s47, s43, 6
v_lshl_add_u32 v15, v13, 4, s47
v_mul_u32_u24 v20, 400, v14
v_add_u32 v20, v20, v15
v_subrev_u32 v16, 32, v14
v_max_i32 v16, 0, v16
v_mul_u32_u24 v21, 400, v16
v_add_u32 v21, v21, v15
v_lshrrev_b32 v16, 2, v12
v_lshl_add_u32 v16, v13, 2, v16
v_lshl_add_u32 v16, v16, 1, s46
v_and_b32 v17, 3, v1
v_lshl_add_u32 v17, v17, 3, s47
v_mul_u32_u24 v22, 400, v16
v_add_u32 v22, v22, v17
v_subrev_u32 v16, 32, v16
v_max_i32 v16, 0, v16
v_mul_u32_u24 v23, 400, v16
v_add_u32 v23, v23, v17
s_lshl_b32 s60, s43, 13
s_lshl_b32 s61, s45, 10
s_add_u32 s60, s60, s61
s_lshl_b32 s61, s44, 8
s_add_u32 s60, s60, s61
v_lshlrev_b32 v27, 11, v13
v_lshl_add_u32 v27, v12, 4, v27
v_add_u32 v27, s60, v27
v_mov_b32 v28, 0xff800000
s_mov_b32 s61, 0x3e8293ee
s_nop 2
s_or_b32 s62, s34, s45
s_cmp_lg_u32 s62, 0
s_cselect_b64 s[64:65], s[84:85], 0
s_cselect_b64 s[66:67], s[86:87], 0
s_cselect_b64 s[68:69], s[88:89], 0
s_cselect_b64 s[70:71], s[90:91], 0
v_lshlrev_b32 v9, 3, v12
v_add_u32 v9, 129024, v9
v_mul_u32_u24 v14, 400, v12
v_lshl_add_u32 v14, v13, 3, v14
s_lshl_b32 s43, s36, 5
v_add_u32 v14, s43, v14
s_barrier
ds_read_b128 v[32:35], v2 offset:0
ds_read_b64_tr_b16 v[72:73], v6 offset:8192
ds_read_b64_tr_b16 v[74:75], v6 offset:8704
ds_read_b64_tr_b16 v[76:77], v6 offset:16384
ds_read_b64_tr_b16 v[78:79], v6 offset:16896
ds_read_b64_tr_b16 v[68:69], v6 offset:0
ds_read_b64_tr_b16 v[70:71], v6 offset:512
ds_read_b128 v[36:39], v2 offset:2048
ds_read_b128 v[40:43], v2 offset:4096
ds_read_b128 v[44:47], v2 offset:6144
ds_read_b128 v[48:51], v2 offset:8192
ds_read_b128 v[52:55], v2 offset:10240
ds_read_b128 v[56:59], v2 offset:12288
ds_read_b128 v[60:63], v2 offset:14336
ds_read_b128 v[64:67], v2 offset:16384
s_mov_b32 s41, 5
Lcl_6:
s_waitcnt lgkmcnt(0)
v_mfma_f32_16x16x32_bf16 v[164:167], v[72:75], v[32:35], v[164:167]
ds_read_b128 v[80:83], v3 offset:0
v_mfma_f32_16x16x32_bf16 v[200:203], v[76:79], v[32:35], v[200:203]
ds_read_b64_tr_b16 v[120:121], v6 offset:12288
v_mfma_f32_16x16x32_bf16 v[128:131], v[68:71], v[32:35], v[128:131]
ds_read_b64_tr_b16 v[122:123], v6 offset:12800
v_mfma_f32_16x16x32_bf16 v[168:171], v[72:75], v[36:39], v[168:171]
ds_read_b64_tr_b16 v[124:125], v6 offset:20480
v_mfma_f32_16x16x32_bf16 v[204:207], v[76:79], v[36:39], v[204:207]
ds_read_b64_tr_b16 v[126:127], v6 offset:20992
v_mfma_f32_16x16x32_bf16 v[132:135], v[68:71], v[36:39], v[132:135]
ds_read_b64_tr_b16 v[116:117], v6 offset:4096
v_mfma_f32_16x16x32_bf16 v[172:175], v[72:75], v[40:43], v[172:175]
ds_read_b64_tr_b16 v[118:119], v6 offset:4608
v_mfma_f32_16x16x32_bf16 v[208:211], v[76:79], v[40:43], v[208:211]
ds_read_b128 v[84:87], v3 offset:2048
v_mfma_f32_16x16x32_bf16 v[136:139], v[68:71], v[40:43], v[136:139]
ds_read_b128 v[88:91], v3 offset:4096
v_mfma_f32_16x16x32_bf16 v[176:179], v[72:75], v[44:47], v[176:179]
ds_read_b128 v[92:95], v3 offset:6144
v_mfma_f32_16x16x32_bf16 v[212:215], v[76:79], v[44:47], v[212:215]
ds_read_b128 v[96:99], v3 offset:8192
v_mfma_f32_16x16x32_bf16 v[140:143], v[68:71], v[44:47], v[140:143]
ds_read_b128 v[100:103], v3 offset:10240
v_mfma_f32_16x16x32_bf16 v[180:183], v[72:75], v[48:51], v[180:183]
ds_read_b128 v[104:107], v3 offset:12288
v_mfma_f32_16x16x32_bf16 v[216:219], v[76:79], v[48:51], v[216:219]
ds_read_b128 v[108:111], v3 offset:14336
v_mfma_f32_16x16x32_bf16 v[144:147], v[68:71], v[48:51], v[144:147]
ds_read_b128 v[112:115], v3 offset:16384
v_mfma_f32_16x16x32_bf16 v[184:187], v[72:75], v[52:55], v[184:187]
v_mfma_f32_16x16x32_bf16 v[220:223], v[76:79], v[52:55], v[220:223]
v_mfma_f32_16x16x32_bf16 v[148:151], v[68:71], v[52:55], v[148:151]
v_mfma_f32_16x16x32_bf16 v[188:191], v[72:75], v[56:59], v[188:191]
v_mfma_f32_16x16x32_bf16 v[224:227], v[76:79], v[56:59], v[224:227]
v_mfma_f32_16x16x32_bf16 v[152:155], v[68:71], v[56:59], v[152:155]
v_mfma_f32_16x16x32_bf16 v[192:195], v[72:75], v[60:63], v[192:195]
v_mfma_f32_16x16x32_bf16 v[228:231], v[76:79], v[60:63], v[228:231]
v_mfma_f32_16x16x32_bf16 v[156:159], v[68:71], v[60:63], v[156:159]
v_mfma_f32_16x16x32_bf16 v[196:199], v[72:75], v[64:67], v[196:199]
v_mfma_f32_16x16x32_bf16 v[232:235], v[76:79], v[64:67], v[232:235]
v_mfma_f32_16x16x32_bf16 v[160:163], v[68:71], v[64:67], v[160:163]
s_waitcnt lgkmcnt(0)
s_barrier
v_mfma_f32_16x16x32_bf16 v[164:167], v[120:123], v[80:83], v[164:167]
ds_read_b128 v[32:35], v2 offset:43008
v_mfma_f32_16x16x32_bf16 v[200:203], v[124:127], v[80:83], v[200:203]
ds_read_b64_tr_b16 v[72:73], v7 offset:8192
v_mfma_f32_16x16x32_bf16 v[128:131], v[116:119], v[80:83], v[128:131]
ds_read_b64_tr_b16 v[74:75], v7 offset:8704
v_mfma_f32_16x16x32_bf16 v[168:171], v[120:123], v[84:87], v[168:171]
ds_read_b64_tr_b16 v[76:77], v7 offset:16384
v_mfma_f32_16x16x32_bf16 v[204:207], v[124:127], v[84:87], v[204:207]
ds_read_b64_tr_b16 v[78:79], v7 offset:16896
v_mfma_f32_16x16x32_bf16 v[132:135], v[116:119], v[84:87], v[132:135]
ds_read_b64_tr_b16 v[68:69], v7 offset:0
v_mfma_f32_16x16x32_bf16 v[172:175], v[120:123], v[88:91], v[172:175]
ds_read_b64_tr_b16 v[70:71], v7 offset:512
v_mfma_f32_16x16x32_bf16 v[208:211], v[124:127], v[88:91], v[208:211]
ds_read_b128 v[36:39], v2 offset:45056
v_mfma_f32_16x16x32_bf16 v[136:139], v[116:119], v[88:91], v[136:139]
ds_read_b128 v[40:43], v2 offset:47104
v_mfma_f32_16x16x32_bf16 v[176:179], v[120:123], v[92:95], v[176:179]
ds_read_b128 v[44:47], v2 offset:49152
v_mfma_f32_16x16x32_bf16 v[212:215], v[124:127], v[92:95], v[212:215]
ds_read_b128 v[48:51], v2 offset:51200
v_mfma_f32_16x16x32_bf16 v[140:143], v[116:119], v[92:95], v[140:143]
ds_read_b128 v[52:55], v2 offset:53248
v_mfma_f32_16x16x32_bf16 v[180:183], v[120:123], v[96:99], v[180:183]
ds_read_b128 v[56:59], v2 offset:55296
v_mfma_f32_16x16x32_bf16 v[216:219], v[124:127], v[96:99], v[216:219]
ds_read_b128 v[60:63], v2 offset:57344
v_mfma_f32_16x16x32_bf16 v[144:147], v[116:119], v[96:99], v[144:147]
ds_read_b128 v[64:67], v2 offset:59392
v_mfma_f32_16x16x32_bf16 v[184:187], v[120:123], v[100:103], v[184:187]
v_mfma_f32_16x16x32_bf16 v[220:223], v[124:127], v[100:103], v[220:223]
v_mfma_f32_16x16x32_bf16 v[148:151], v[116:119], v[100:103], v[148:151]
v_mfma_f32_16x16x32_bf16 v[188:191], v[120:123], v[104:107], v[188:191]
v_mfma_f32_16x16x32_bf16 v[224:227], v[124:127], v[104:107], v[224:227]
v_mfma_f32_16x16x32_bf16 v[152:155], v[116:119], v[104:107], v[152:155]
v_mfma_f32_16x16x32_bf16 v[192:195], v[120:123], v[108:111], v[192:195]
v_mfma_f32_16x16x32_bf16 v[228:231], v[124:127], v[108:111], v[228:231]
v_mfma_f32_16x16x32_bf16 v[156:159], v[116:119], v[108:111], v[156:159]
v_mfma_f32_16x16x32_bf16 v[196:199], v[120:123], v[112:115], v[196:199]
v_mfma_f32_16x16x32_bf16 v[232:235], v[124:127], v[112:115], v[232:235]
v_mfma_f32_16x16x32_bf16 v[160:163], v[116:119], v[112:115], v[160:163]
s_waitcnt lgkmcnt(0)
v_mfma_f32_16x16x32_bf16 v[164:167], v[72:75], v[32:35], v[164:167]
ds_read_b128 v[80:83], v3 offset:43008
v_mfma_f32_16x16x32_bf16 v[200:203], v[76:79], v[32:35], v[200:203]
ds_read_b64_tr_b16 v[120:121], v7 offset:12288
v_mfma_f32_16x16x32_bf16 v[128:131], v[68:71], v[32:35], v[128:131]
ds_read_b64_tr_b16 v[122:123], v7 offset:12800
v_mfma_f32_16x16x32_bf16 v[168:171], v[72:75], v[36:39], v[168:171]
ds_read_b64_tr_b16 v[124:125], v7 offset:20480
v_mfma_f32_16x16x32_bf16 v[204:207], v[76:79], v[36:39], v[204:207]
ds_read_b64_tr_b16 v[126:127], v7 offset:20992
v_mfma_f32_16x16x32_bf16 v[132:135], v[68:71], v[36:39], v[132:135]
ds_read_b64_tr_b16 v[116:117], v7 offset:4096
v_mfma_f32_16x16x32_bf16 v[172:175], v[72:75], v[40:43], v[172:175]
ds_read_b64_tr_b16 v[118:119], v7 offset:4608
v_mfma_f32_16x16x32_bf16 v[208:211], v[76:79], v[40:43], v[208:211]
ds_read_b128 v[84:87], v3 offset:45056
v_mfma_f32_16x16x32_bf16 v[136:139], v[68:71], v[40:43], v[136:139]
ds_read_b128 v[88:91], v3 offset:47104
v_mfma_f32_16x16x32_bf16 v[176:179], v[72:75], v[44:47], v[176:179]
ds_read_b128 v[92:95], v3 offset:49152
v_mfma_f32_16x16x32_bf16 v[212:215], v[76:79], v[44:47], v[212:215]
ds_read_b128 v[96:99], v3 offset:51200
v_mfma_f32_16x16x32_bf16 v[140:143], v[68:71], v[44:47], v[140:143]
ds_read_b128 v[100:103], v3 offset:53248
v_mfma_f32_16x16x32_bf16 v[180:183], v[72:75], v[48:51], v[180:183]
ds_read_b128 v[104:107], v3 offset:55296
v_mfma_f32_16x16x32_bf16 v[216:219], v[76:79], v[48:51], v[216:219]
ds_read_b128 v[108:111], v3 offset:57344
v_mfma_f32_16x16x32_bf16 v[144:147], v[68:71], v[48:51], v[144:147]
ds_read_b128 v[112:115], v3 offset:59392
v_mfma_f32_16x16x32_bf16 v[184:187], v[72:75], v[52:55], v[184:187]
v_mfma_f32_16x16x32_bf16 v[220:223], v[76:79], v[52:55], v[220:223]
v_mfma_f32_16x16x32_bf16 v[148:151], v[68:71], v[52:55], v[148:151]
v_mfma_f32_16x16x32_bf16 v[188:191], v[72:75], v[56:59], v[188:191]
v_mfma_f32_16x16x32_bf16 v[224:227], v[76:79], v[56:59], v[224:227]
v_mfma_f32_16x16x32_bf16 v[152:155], v[68:71], v[56:59], v[152:155]
v_mfma_f32_16x16x32_bf16 v[192:195], v[72:75], v[60:63], v[192:195]
v_mfma_f32_16x16x32_bf16 v[228:231], v[76:79], v[60:63], v[228:231]
v_mfma_f32_16x16x32_bf16 v[156:159], v[68:71], v[60:63], v[156:159]
v_mfma_f32_16x16x32_bf16 v[196:199], v[72:75], v[64:67], v[196:199]
v_mfma_f32_16x16x32_bf16 v[232:235], v[76:79], v[64:67], v[232:235]
v_mfma_f32_16x16x32_bf16 v[160:163], v[68:71], v[64:67], v[160:163]
s_waitcnt lgkmcnt(0)
s_barrier
v_mfma_f32_16x16x32_bf16 v[164:167], v[120:123], v[80:83], v[164:167]
ds_read_b128 v[32:35], v4 offset:0
v_mfma_f32_16x16x32_bf16 v[200:203], v[124:127], v[80:83], v[200:203]
ds_read_b64_tr_b16 v[72:73], v8 offset:8192
v_mfma_f32_16x16x32_bf16 v[128:131], v[116:119], v[80:83], v[128:131]
ds_read_b64_tr_b16 v[74:75], v8 offset:8704
v_mfma_f32_16x16x32_bf16 v[168:171], v[120:123], v[84:87], v[168:171]
ds_read_b64_tr_b16 v[76:77], v8 offset:16384
v_mfma_f32_16x16x32_bf16 v[204:207], v[124:127], v[84:87], v[204:207]
ds_read_b64_tr_b16 v[78:79], v8 offset:16896
v_mfma_f32_16x16x32_bf16 v[132:135], v[116:119], v[84:87], v[132:135]
ds_read_b64_tr_b16 v[68:69], v8 offset:0
v_mfma_f32_16x16x32_bf16 v[172:175], v[120:123], v[88:91], v[172:175]
ds_read_b64_tr_b16 v[70:71], v8 offset:512
v_mfma_f32_16x16x32_bf16 v[208:211], v[124:127], v[88:91], v[208:211]
ds_read_b128 v[36:39], v4 offset:2048
v_mfma_f32_16x16x32_bf16 v[136:139], v[116:119], v[88:91], v[136:139]
ds_read_b128 v[40:43], v4 offset:4096
v_mfma_f32_16x16x32_bf16 v[176:179], v[120:123], v[92:95], v[176:179]
ds_read_b128 v[44:47], v4 offset:6144
v_mfma_f32_16x16x32_bf16 v[212:215], v[124:127], v[92:95], v[212:215]
ds_read_b128 v[48:51], v4 offset:8192
v_mfma_f32_16x16x32_bf16 v[140:143], v[116:119], v[92:95], v[140:143]
ds_read_b128 v[52:55], v4 offset:10240
v_mfma_f32_16x16x32_bf16 v[180:183], v[120:123], v[96:99], v[180:183]
ds_read_b128 v[56:59], v4 offset:12288
v_mfma_f32_16x16x32_bf16 v[216:219], v[124:127], v[96:99], v[216:219]
ds_read_b128 v[60:63], v4 offset:14336
v_mfma_f32_16x16x32_bf16 v[144:147], v[116:119], v[96:99], v[144:147]
ds_read_b128 v[64:67], v4 offset:16384
v_mfma_f32_16x16x32_bf16 v[184:187], v[120:123], v[100:103], v[184:187]
v_mfma_f32_16x16x32_bf16 v[220:223], v[124:127], v[100:103], v[220:223]
v_mfma_f32_16x16x32_bf16 v[148:151], v[116:119], v[100:103], v[148:151]
v_mfma_f32_16x16x32_bf16 v[188:191], v[120:123], v[104:107], v[188:191]
v_mfma_f32_16x16x32_bf16 v[224:227], v[124:127], v[104:107], v[224:227]
v_mfma_f32_16x16x32_bf16 v[152:155], v[116:119], v[104:107], v[152:155]
v_mfma_f32_16x16x32_bf16 v[192:195], v[120:123], v[108:111], v[192:195]
v_mfma_f32_16x16x32_bf16 v[228:231], v[124:127], v[108:111], v[228:231]
v_mfma_f32_16x16x32_bf16 v[156:159], v[116:119], v[108:111], v[156:159]
v_mfma_f32_16x16x32_bf16 v[196:199], v[120:123], v[112:115], v[196:199]
v_mfma_f32_16x16x32_bf16 v[232:235], v[124:127], v[112:115], v[232:235]
v_mfma_f32_16x16x32_bf16 v[160:163], v[116:119], v[112:115], v[160:163]
s_waitcnt lgkmcnt(0)
v_mfma_f32_16x16x32_bf16 v[164:167], v[72:75], v[32:35], v[164:167]
ds_read_b128 v[80:83], v5 offset:0
v_mfma_f32_16x16x32_bf16 v[200:203], v[76:79], v[32:35], v[200:203]
ds_read_b64_tr_b16 v[120:121], v8 offset:12288
v_mfma_f32_16x16x32_bf16 v[128:131], v[68:71], v[32:35], v[128:131]
ds_read_b64_tr_b16 v[122:123], v8 offset:12800
v_mfma_f32_16x16x32_bf16 v[168:171], v[72:75], v[36:39], v[168:171]
ds_read_b64_tr_b16 v[124:125], v8 offset:20480
v_mfma_f32_16x16x32_bf16 v[204:207], v[76:79], v[36:39], v[204:207]
ds_read_b64_tr_b16 v[126:127], v8 offset:20992
v_mfma_f32_16x16x32_bf16 v[132:135], v[68:71], v[36:39], v[132:135]
ds_read_b64_tr_b16 v[116:117], v8 offset:4096
v_mfma_f32_16x16x32_bf16 v[172:175], v[72:75], v[40:43], v[172:175]
ds_read_b64_tr_b16 v[118:119], v8 offset:4608
v_mfma_f32_16x16x32_bf16 v[208:211], v[76:79], v[40:43], v[208:211]
ds_read_b128 v[84:87], v5 offset:2048
v_mfma_f32_16x16x32_bf16 v[136:139], v[68:71], v[40:43], v[136:139]
ds_read_b128 v[88:91], v5 offset:4096
v_mfma_f32_16x16x32_bf16 v[176:179], v[72:75], v[44:47], v[176:179]
ds_read_b128 v[92:95], v5 offset:6144
v_mfma_f32_16x16x32_bf16 v[212:215], v[76:79], v[44:47], v[212:215]
ds_read_b128 v[96:99], v5 offset:8192
v_mfma_f32_16x16x32_bf16 v[140:143], v[68:71], v[44:47], v[140:143]
ds_read_b128 v[100:103], v5 offset:10240
v_mfma_f32_16x16x32_bf16 v[180:183], v[72:75], v[48:51], v[180:183]
ds_read_b128 v[104:107], v5 offset:12288
v_mfma_f32_16x16x32_bf16 v[216:219], v[76:79], v[48:51], v[216:219]
ds_read_b128 v[108:111], v5 offset:14336
v_mfma_f32_16x16x32_bf16 v[144:147], v[68:71], v[48:51], v[144:147]
ds_read_b128 v[112:115], v5 offset:16384
v_mfma_f32_16x16x32_bf16 v[184:187], v[72:75], v[52:55], v[184:187]
v_mfma_f32_16x16x32_bf16 v[220:223], v[76:79], v[52:55], v[220:223]
v_mfma_f32_16x16x32_bf16 v[148:151], v[68:71], v[52:55], v[148:151]
v_mfma_f32_16x16x32_bf16 v[188:191], v[72:75], v[56:59], v[188:191]
v_mfma_f32_16x16x32_bf16 v[224:227], v[76:79], v[56:59], v[224:227]
v_mfma_f32_16x16x32_bf16 v[152:155], v[68:71], v[56:59], v[152:155]
v_mfma_f32_16x16x32_bf16 v[192:195], v[72:75], v[60:63], v[192:195]
v_mfma_f32_16x16x32_bf16 v[228:231], v[76:79], v[60:63], v[228:231]
v_mfma_f32_16x16x32_bf16 v[156:159], v[68:71], v[60:63], v[156:159]
v_mfma_f32_16x16x32_bf16 v[196:199], v[72:75], v[64:67], v[196:199]
v_mfma_f32_16x16x32_bf16 v[232:235], v[76:79], v[64:67], v[232:235]
v_mfma_f32_16x16x32_bf16 v[160:163], v[68:71], v[64:67], v[160:163]
s_waitcnt lgkmcnt(0)
s_barrier
v_mfma_f32_16x16x32_bf16 v[164:167], v[120:123], v[80:83], v[164:167]
ds_read_b128 v[32:35], v2 offset:0
v_mfma_f32_16x16x32_bf16 v[200:203], v[124:127], v[80:83], v[200:203]
ds_read_b64_tr_b16 v[72:73], v6 offset:8192
v_mfma_f32_16x16x32_bf16 v[128:131], v[116:119], v[80:83], v[128:131]
ds_read_b64_tr_b16 v[74:75], v6 offset:8704
v_mfma_f32_16x16x32_bf16 v[168:171], v[120:123], v[84:87], v[168:171]
ds_read_b64_tr_b16 v[76:77], v6 offset:16384
v_mfma_f32_16x16x32_bf16 v[204:207], v[124:127], v[84:87], v[204:207]
ds_read_b64_tr_b16 v[78:79], v6 offset:16896
v_mfma_f32_16x16x32_bf16 v[132:135], v[116:119], v[84:87], v[132:135]
ds_read_b64_tr_b16 v[68:69], v6 offset:0
v_mfma_f32_16x16x32_bf16 v[172:175], v[120:123], v[88:91], v[172:175]
ds_read_b64_tr_b16 v[70:71], v6 offset:512
v_mfma_f32_16x16x32_bf16 v[208:211], v[124:127], v[88:91], v[208:211]
ds_read_b128 v[36:39], v2 offset:2048
v_mfma_f32_16x16x32_bf16 v[136:139], v[116:119], v[88:91], v[136:139]
ds_read_b128 v[40:43], v2 offset:4096
v_mfma_f32_16x16x32_bf16 v[176:179], v[120:123], v[92:95], v[176:179]
ds_read_b128 v[44:47], v2 offset:6144
v_mfma_f32_16x16x32_bf16 v[212:215], v[124:127], v[92:95], v[212:215]
ds_read_b128 v[48:51], v2 offset:8192
v_mfma_f32_16x16x32_bf16 v[140:143], v[116:119], v[92:95], v[140:143]
ds_read_b128 v[52:55], v2 offset:10240
v_mfma_f32_16x16x32_bf16 v[180:183], v[120:123], v[96:99], v[180:183]
ds_read_b128 v[56:59], v2 offset:12288
v_mfma_f32_16x16x32_bf16 v[216:219], v[124:127], v[96:99], v[216:219]
ds_read_b128 v[60:63], v2 offset:14336
v_mfma_f32_16x16x32_bf16 v[144:147], v[116:119], v[96:99], v[144:147]
ds_read_b128 v[64:67], v2 offset:16384
v_mfma_f32_16x16x32_bf16 v[184:187], v[120:123], v[100:103], v[184:187]
v_mfma_f32_16x16x32_bf16 v[220:223], v[124:127], v[100:103], v[220:223]
v_mfma_f32_16x16x32_bf16 v[148:151], v[116:119], v[100:103], v[148:151]
v_mfma_f32_16x16x32_bf16 v[188:191], v[120:123], v[104:107], v[188:191]
v_mfma_f32_16x16x32_bf16 v[224:227], v[124:127], v[104:107], v[224:227]
v_mfma_f32_16x16x32_bf16 v[152:155], v[116:119], v[104:107], v[152:155]
v_mfma_f32_16x16x32_bf16 v[192:195], v[120:123], v[108:111], v[192:195]
v_mfma_f32_16x16x32_bf16 v[228:231], v[124:127], v[108:111], v[228:231]
v_mfma_f32_16x16x32_bf16 v[156:159], v[116:119], v[108:111], v[156:159]
v_mfma_f32_16x16x32_bf16 v[196:199], v[120:123], v[112:115], v[196:199]
v_mfma_f32_16x16x32_bf16 v[232:235], v[124:127], v[112:115], v[232:235]
v_mfma_f32_16x16x32_bf16 v[160:163], v[116:119], v[112:115], v[160:163]
s_sub_u32 s41, s41, 1
s_cmp_lg_u32 s41, 0
s_cbranch_scc1 Lcl_6
s_waitcnt lgkmcnt(0)
v_mfma_f32_16x16x32_bf16 v[164:167], v[72:75], v[32:35], v[164:167]
ds_read_b128 v[80:83], v3 offset:0
v_mfma_f32_16x16x32_bf16 v[200:203], v[76:79], v[32:35], v[200:203]
ds_read_b64_tr_b16 v[120:121], v6 offset:12288
v_mfma_f32_16x16x32_bf16 v[128:131], v[68:71], v[32:35], v[128:131]
ds_read_b64_tr_b16 v[122:123], v6 offset:12800
v_mfma_f32_16x16x32_bf16 v[168:171], v[72:75], v[36:39], v[168:171]
ds_read_b64_tr_b16 v[124:125], v6 offset:20480
v_mfma_f32_16x16x32_bf16 v[204:207], v[76:79], v[36:39], v[204:207]
ds_read_b64_tr_b16 v[126:127], v6 offset:20992
v_mfma_f32_16x16x32_bf16 v[132:135], v[68:71], v[36:39], v[132:135]
ds_read_b64_tr_b16 v[116:117], v6 offset:4096
v_mfma_f32_16x16x32_bf16 v[172:175], v[72:75], v[40:43], v[172:175]
ds_read_b64_tr_b16 v[118:119], v6 offset:4608
v_mfma_f32_16x16x32_bf16 v[208:211], v[76:79], v[40:43], v[208:211]
ds_read_b128 v[84:87], v3 offset:2048
v_mfma_f32_16x16x32_bf16 v[136:139], v[68:71], v[40:43], v[136:139]
ds_read_b128 v[88:91], v3 offset:4096
v_mfma_f32_16x16x32_bf16 v[176:179], v[72:75], v[44:47], v[176:179]
ds_read_b128 v[92:95], v3 offset:6144
v_mfma_f32_16x16x32_bf16 v[212:215], v[76:79], v[44:47], v[212:215]
ds_read_b128 v[96:99], v3 offset:8192
v_mfma_f32_16x16x32_bf16 v[140:143], v[68:71], v[44:47], v[140:143]
ds_read_b128 v[100:103], v3 offset:10240
v_mfma_f32_16x16x32_bf16 v[180:183], v[72:75], v[48:51], v[180:183]
ds_read_b128 v[104:107], v3 offset:12288
v_mfma_f32_16x16x32_bf16 v[216:219], v[76:79], v[48:51], v[216:219]
ds_read_b128 v[108:111], v3 offset:14336
v_mfma_f32_16x16x32_bf16 v[144:147], v[68:71], v[48:51], v[144:147]
ds_read_b128 v[112:115], v3 offset:16384
v_mfma_f32_16x16x32_bf16 v[184:187], v[72:75], v[52:55], v[184:187]
v_mfma_f32_16x16x32_bf16 v[220:223], v[76:79], v[52:55], v[220:223]
v_mfma_f32_16x16x32_bf16 v[148:151], v[68:71], v[52:55], v[148:151]
v_mfma_f32_16x16x32_bf16 v[188:191], v[72:75], v[56:59], v[188:191]
v_mfma_f32_16x16x32_bf16 v[224:227], v[76:79], v[56:59], v[224:227]
v_mfma_f32_16x16x32_bf16 v[152:155], v[68:71], v[56:59], v[152:155]
v_mfma_f32_16x16x32_bf16 v[192:195], v[72:75], v[60:63], v[192:195]
v_mfma_f32_16x16x32_bf16 v[228:231], v[76:79], v[60:63], v[228:231]
v_mfma_f32_16x16x32_bf16 v[156:159], v[68:71], v[60:63], v[156:159]
v_mfma_f32_16x16x32_bf16 v[196:199], v[72:75], v[64:67], v[196:199]
v_mfma_f32_16x16x32_bf16 v[232:235], v[76:79], v[64:67], v[232:235]
v_mfma_f32_16x16x32_bf16 v[160:163], v[68:71], v[64:67], v[160:163]
s_waitcnt lgkmcnt(0)
s_barrier
v_mfma_f32_16x16x32_bf16 v[164:167], v[120:123], v[80:83], v[164:167]
ds_read_b64 v[32:33], v9 offset:0
v_mfma_f32_16x16x32_bf16 v[200:203], v[124:127], v[80:83], v[200:203]
ds_read_b64 v[34:35], v9 offset:128
v_mfma_f32_16x16x32_bf16 v[128:131], v[116:119], v[80:83], v[128:131]
ds_read_b64 v[36:37], v9 offset:256
v_mfma_f32_16x16x32_bf16 v[168:171], v[120:123], v[84:87], v[168:171]
ds_read_b64 v[38:39], v9 offset:384
v_mfma_f32_16x16x32_bf16 v[204:207], v[124:127], v[84:87], v[204:207]
ds_read_b64 v[40:41], v9 offset:512
v_mfma_f32_16x16x32_bf16 v[132:135], v[116:119], v[84:87], v[132:135]
ds_read_b64 v[42:43], v9 offset:640
v_mfma_f32_16x16x32_bf16 v[172:175], v[120:123], v[88:91], v[172:175]
ds_read_b64 v[44:45], v9 offset:768
v_mfma_f32_16x16x32_bf16 v[208:211], v[124:127], v[88:91], v[208:211]
ds_read_b64 v[46:47], v9 offset:896
v_mfma_f32_16x16x32_bf16 v[136:139], v[116:119], v[88:91], v[136:139]
ds_read_b64 v[48:49], v9 offset:1024
v_mfma_f32_16x16x32_bf16 v[176:179], v[120:123], v[92:95], v[176:179]
v_mfma_f32_16x16x32_bf16 v[212:215], v[124:127], v[92:95], v[212:215]
v_mfma_f32_16x16x32_bf16 v[140:143], v[116:119], v[92:95], v[140:143]
v_mfma_f32_16x16x32_bf16 v[180:183], v[120:123], v[96:99], v[180:183]
v_mfma_f32_16x16x32_bf16 v[216:219], v[124:127], v[96:99], v[216:219]
v_mfma_f32_16x16x32_bf16 v[144:147], v[116:119], v[96:99], v[144:147]
v_mfma_f32_16x16x32_bf16 v[184:187], v[120:123], v[100:103], v[184:187]
v_mfma_f32_16x16x32_bf16 v[220:223], v[124:127], v[100:103], v[220:223]
v_mfma_f32_16x16x32_bf16 v[148:151], v[116:119], v[100:103], v[148:151]
v_mfma_f32_16x16x32_bf16 v[188:191], v[120:123], v[104:107], v[188:191]
v_mfma_f32_16x16x32_bf16 v[224:227], v[124:127], v[104:107], v[224:227]
v_mfma_f32_16x16x32_bf16 v[152:155], v[116:119], v[104:107], v[152:155]
v_mfma_f32_16x16x32_bf16 v[192:195], v[120:123], v[108:111], v[192:195]
v_mfma_f32_16x16x32_bf16 v[228:231], v[124:127], v[108:111], v[228:231]
v_mfma_f32_16x16x32_bf16 v[156:159], v[116:119], v[108:111], v[156:159]
v_mfma_f32_16x16x32_bf16 v[196:199], v[120:123], v[112:115], v[196:199]
v_mfma_f32_16x16x32_bf16 v[232:235], v[124:127], v[112:115], v[232:235]
v_mfma_f32_16x16x32_bf16 v[160:163], v[116:119], v[112:115], v[160:163]
v_mov_b32_dpp v52, v128 row_newbcast:0 row_mask:0xf bank_mask:0xf
v_mov_b32_dpp v53, v129 row_newbcast:0 row_mask:0xf bank_mask:0xf
v_mov_b32_dpp v54, v130 row_newbcast:0 row_mask:0xf bank_mask:0xf
v_mov_b32_dpp v55, v131 row_newbcast:0 row_mask:0xf bank_mask:0xf
v_mov_b32_dpp v56, v164 row_newbcast:0 row_mask:0xf bank_mask:0xf
v_mov_b32_dpp v57, v165 row_newbcast:0 row_mask:0xf bank_mask:0xf
v_mov_b32_dpp v58, v166 row_newbcast:0 row_mask:0xf bank_mask:0xf
v_mov_b32_dpp v59, v167 row_newbcast:0 row_mask:0xf bank_mask:0xf
v_mov_b32_dpp v60, v200 row_newbcast:0 row_mask:0xf bank_mask:0xf
v_mov_b32_dpp v61, v201 row_newbcast:0 row_mask:0xf bank_mask:0xf
v_mov_b32_dpp v62, v202 row_newbcast:0 row_mask:0xf bank_mask:0xf
v_mov_b32_dpp v63, v203 row_newbcast:0 row_mask:0xf bank_mask:0xf
s_waitcnt lgkmcnt(0)
v_pk_fma_f32 v[164:165], v[32:33], v[56:57], v[164:165] op_sel_hi:[0,1,1] neg_lo:[1,0,0] neg_hi:[1,0,0]
v_pk_fma_f32 v[166:167], v[32:33], v[58:59], v[166:167] op_sel_hi:[0,1,1] neg_lo:[1,0,0] neg_hi:[1,0,0]
v_pk_mul_f32 v[164:165], v[32:33], v[164:165] op_sel:[1,0] op_sel_hi:[1,1]
v_pk_mul_f32 v[166:167], v[32:33], v[166:167] op_sel:[1,0] op_sel_hi:[1,1]
v_cvt_pk_bf16_f32 v164, v164, v165
v_cvt_pk_bf16_f32 v165, v166, v167
ds_write_b64 v14, v[164:165] offset:128
v_pk_fma_f32 v[200:201], v[32:33], v[60:61], v[200:201] op_sel_hi:[0,1,1] neg_lo:[1,0,0] neg_hi:[1,0,0]
v_pk_fma_f32 v[202:203], v[32:33], v[62:63], v[202:203] op_sel_hi:[0,1,1] neg_lo:[1,0,0] neg_hi:[1,0,0]
v_pk_mul_f32 v[200:201], v[32:33], v[200:201] op_sel:[1,0] op_sel_hi:[1,1]
v_pk_mul_f32 v[202:203], v[32:33], v[202:203] op_sel:[1,0] op_sel_hi:[1,1]
v_cvt_pk_bf16_f32 v200, v200, v201
v_cvt_pk_bf16_f32 v201, v202, v203
ds_write_b64 v14, v[200:201] offset:256
v_pk_fma_f32 v[132:133], v[34:35], v[52:53], v[132:133] op_sel_hi:[0,1,1] neg_lo:[1,0,0] neg_hi:[1,0,0]
v_pk_fma_f32 v[134:135], v[34:35], v[54:55], v[134:135] op_sel_hi:[0,1,1] neg_lo:[1,0,0] neg_hi:[1,0,0]
v_pk_mul_f32 v[132:133], v[34:35], v[132:133] op_sel:[1,0] op_sel_hi:[1,1]
v_pk_mul_f32 v[134:135], v[34:35], v[134:135] op_sel:[1,0] op_sel_hi:[1,1]
v_cvt_pk_bf16_f32 v132, v132, v133
v_cvt_pk_bf16_f32 v133, v134, v135
ds_write_b64 v14, v[132:133] offset:6400
v_pk_fma_f32 v[168:169], v[34:35], v[56:57], v[168:169] op_sel_hi:[0,1,1] neg_lo:[1,0,0] neg_hi:[1,0,0]
v_pk_fma_f32 v[170:171], v[34:35], v[58:59], v[170:171] op_sel_hi:[0,1,1] neg_lo:[1,0,0] neg_hi:[1,0,0]
v_pk_mul_f32 v[168:169], v[34:35], v[168:169] op_sel:[1,0] op_sel_hi:[1,1]
v_pk_mul_f32 v[170:171], v[34:35], v[170:171] op_sel:[1,0] op_sel_hi:[1,1]
v_cvt_pk_bf16_f32 v168, v168, v169
v_cvt_pk_bf16_f32 v169, v170, v171
ds_write_b64 v14, v[168:169] offset:6528
v_pk_fma_f32 v[204:205], v[34:35], v[60:61], v[204:205] op_sel_hi:[0,1,1] neg_lo:[1,0,0] neg_hi:[1,0,0]
v_pk_fma_f32 v[206:207], v[34:35], v[62:63], v[206:207] op_sel_hi:[0,1,1] neg_lo:[1,0,0] neg_hi:[1,0,0]
v_pk_mul_f32 v[204:205], v[34:35], v[204:205] op_sel:[1,0] op_sel_hi:[1,1]
v_pk_mul_f32 v[206:207], v[34:35], v[206:207] op_sel:[1,0] op_sel_hi:[1,1]
v_cvt_pk_bf16_f32 v204, v204, v205
v_cvt_pk_bf16_f32 v205, v206, v207
ds_write_b64 v14, v[204:205] offset:6656
v_pk_fma_f32 v[136:137], v[36:37], v[52:53], v[136:137] op_sel_hi:[0,1,1] neg_lo:[1,0,0] neg_hi:[1,0,0]
v_pk_fma_f32 v[138:139], v[36:37], v[54:55], v[138:139] op_sel_hi:[0,1,1] neg_lo:[1,0,0] neg_hi:[1,0,0]
v_pk_mul_f32 v[136:137], v[36:37], v[136:137] op_sel:[1,0] op_sel_hi:[1,1]
v_pk_mul_f32 v[138:139], v[36:37], v[138:139] op_sel:[1,0] op_sel_hi:[1,1]
v_cvt_pk_bf16_f32 v136, v136, v137
v_cvt_pk_bf16_f32 v137, v138, v139
ds_write_b64 v14, v[136:137] offset:12800
v_pk_fma_f32 v[172:173], v[36:37], v[56:57], v[172:173] op_sel_hi:[0,1,1] neg_lo:[1,0,0] neg_hi:[1,0,0]
v_pk_fma_f32 v[174:175], v[36:37], v[58:59], v[174:175] op_sel_hi:[0,1,1] neg_lo:[1,0,0] neg_hi:[1,0,0]
v_pk_mul_f32 v[172:173], v[36:37], v[172:173] op_sel:[1,0] op_sel_hi:[1,1]
v_pk_mul_f32 v[174:175], v[36:37], v[174:175] op_sel:[1,0] op_sel_hi:[1,1]
v_cvt_pk_bf16_f32 v172, v172, v173
v_cvt_pk_bf16_f32 v173, v174, v175
ds_write_b64 v14, v[172:173] offset:12928
v_pk_fma_f32 v[208:209], v[36:37], v[60:61], v[208:209] op_sel_hi:[0,1,1] neg_lo:[1,0,0] neg_hi:[1,0,0]
v_pk_fma_f32 v[210:211], v[36:37], v[62:63], v[210:211] op_sel_hi:[0,1,1] neg_lo:[1,0,0] neg_hi:[1,0,0]
v_pk_mul_f32 v[208:209], v[36:37], v[208:209] op_sel:[1,0] op_sel_hi:[1,1]
v_pk_mul_f32 v[210:211], v[36:37], v[210:211] op_sel:[1,0] op_sel_hi:[1,1]
v_cvt_pk_bf16_f32 v208, v208, v209
v_cvt_pk_bf16_f32 v209, v210, v211
ds_write_b64 v14, v[208:209] offset:13056
v_pk_fma_f32 v[140:141], v[38:39], v[52:53], v[140:141] op_sel_hi:[0,1,1] neg_lo:[1,0,0] neg_hi:[1,0,0]
v_pk_fma_f32 v[142:143], v[38:39], v[54:55], v[142:143] op_sel_hi:[0,1,1] neg_lo:[1,0,0] neg_hi:[1,0,0]
v_pk_mul_f32 v[140:141], v[38:39], v[140:141] op_sel:[1,0] op_sel_hi:[1,1]
v_pk_mul_f32 v[142:143], v[38:39], v[142:143] op_sel:[1,0] op_sel_hi:[1,1]
v_cvt_pk_bf16_f32 v140, v140, v141
v_cvt_pk_bf16_f32 v141, v142, v143
ds_write_b64 v14, v[140:141] offset:19200
v_pk_fma_f32 v[176:177], v[38:39], v[56:57], v[176:177] op_sel_hi:[0,1,1] neg_lo:[1,0,0] neg_hi:[1,0,0]
v_pk_fma_f32 v[178:179], v[38:39], v[58:59], v[178:179] op_sel_hi:[0,1,1] neg_lo:[1,0,0] neg_hi:[1,0,0]
v_pk_mul_f32 v[176:177], v[38:39], v[176:177] op_sel:[1,0] op_sel_hi:[1,1]
v_pk_mul_f32 v[178:179], v[38:39], v[178:179] op_sel:[1,0] op_sel_hi:[1,1]
v_cvt_pk_bf16_f32 v176, v176, v177
v_cvt_pk_bf16_f32 v177, v178, v179
ds_write_b64 v14, v[176:177] offset:19328
v_pk_fma_f32 v[212:213], v[38:39], v[60:61], v[212:213] op_sel_hi:[0,1,1] neg_lo:[1,0,0] neg_hi:[1,0,0]
v_pk_fma_f32 v[214:215], v[38:39], v[62:63], v[214:215] op_sel_hi:[0,1,1] neg_lo:[1,0,0] neg_hi:[1,0,0]
v_pk_mul_f32 v[212:213], v[38:39], v[212:213] op_sel:[1,0] op_sel_hi:[1,1]
v_pk_mul_f32 v[214:215], v[38:39], v[214:215] op_sel:[1,0] op_sel_hi:[1,1]
v_cvt_pk_bf16_f32 v212, v212, v213
v_cvt_pk_bf16_f32 v213, v214, v215
ds_write_b64 v14, v[212:213] offset:19456
v_pk_fma_f32 v[144:145], v[40:41], v[52:53], v[144:145] op_sel_hi:[0,1,1] neg_lo:[1,0,0] neg_hi:[1,0,0]
v_pk_fma_f32 v[146:147], v[40:41], v[54:55], v[146:147] op_sel_hi:[0,1,1] neg_lo:[1,0,0] neg_hi:[1,0,0]
v_pk_mul_f32 v[144:145], v[40:41], v[144:145] op_sel:[1,0] op_sel_hi:[1,1]
v_pk_mul_f32 v[146:147], v[40:41], v[146:147] op_sel:[1,0] op_sel_hi:[1,1]
v_cvt_pk_bf16_f32 v144, v144, v145
v_cvt_pk_bf16_f32 v145, v146, v147
ds_write_b64 v14, v[144:145] offset:25600
v_pk_fma_f32 v[180:181], v[40:41], v[56:57], v[180:181] op_sel_hi:[0,1,1] neg_lo:[1,0,0] neg_hi:[1,0,0]
v_pk_fma_f32 v[182:183], v[40:41], v[58:59], v[182:183] op_sel_hi:[0,1,1] neg_lo:[1,0,0] neg_hi:[1,0,0]
v_pk_mul_f32 v[180:181], v[40:41], v[180:181] op_sel:[1,0] op_sel_hi:[1,1]
v_pk_mul_f32 v[182:183], v[40:41], v[182:183] op_sel:[1,0] op_sel_hi:[1,1]
v_cvt_pk_bf16_f32 v180, v180, v181
v_cvt_pk_bf16_f32 v181, v182, v183
ds_write_b64 v14, v[180:181] offset:25728
v_pk_fma_f32 v[216:217], v[40:41], v[60:61], v[216:217] op_sel_hi:[0,1,1] neg_lo:[1,0,0] neg_hi:[1,0,0]
v_pk_fma_f32 v[218:219], v[40:41], v[62:63], v[218:219] op_sel_hi:[0,1,1] neg_lo:[1,0,0] neg_hi:[1,0,0]
v_pk_mul_f32 v[216:217], v[40:41], v[216:217] op_sel:[1,0] op_sel_hi:[1,1]
v_pk_mul_f32 v[218:219], v[40:41], v[218:219] op_sel:[1,0] op_sel_hi:[1,1]
v_cvt_pk_bf16_f32 v216, v216, v217
v_cvt_pk_bf16_f32 v217, v218, v219
ds_write_b64 v14, v[216:217] offset:25856
v_pk_fma_f32 v[148:149], v[42:43], v[52:53], v[148:149] op_sel_hi:[0,1,1] neg_lo:[1,0,0] neg_hi:[1,0,0]
v_pk_fma_f32 v[150:151], v[42:43], v[54:55], v[150:151] op_sel_hi:[0,1,1] neg_lo:[1,0,0] neg_hi:[1,0,0]
v_pk_mul_f32 v[148:149], v[42:43], v[148:149] op_sel:[1,0] op_sel_hi:[1,1]
v_pk_mul_f32 v[150:151], v[42:43], v[150:151] op_sel:[1,0] op_sel_hi:[1,1]
v_cvt_pk_bf16_f32 v148, v148, v149
v_cvt_pk_bf16_f32 v149, v150, v151
ds_write_b64 v14, v[148:149] offset:32000
v_pk_fma_f32 v[184:185], v[42:43], v[56:57], v[184:185] op_sel_hi:[0,1,1] neg_lo:[1,0,0] neg_hi:[1,0,0]
v_pk_fma_f32 v[186:187], v[42:43], v[58:59], v[186:187] op_sel_hi:[0,1,1] neg_lo:[1,0,0] neg_hi:[1,0,0]
v_pk_mul_f32 v[184:185], v[42:43], v[184:185] op_sel:[1,0] op_sel_hi:[1,1]
v_pk_mul_f32 v[186:187], v[42:43], v[186:187] op_sel:[1,0] op_sel_hi:[1,1]
v_cvt_pk_bf16_f32 v184, v184, v185
v_cvt_pk_bf16_f32 v185, v186, v187
ds_write_b64 v14, v[184:185] offset:32128
v_pk_fma_f32 v[220:221], v[42:43], v[60:61], v[220:221] op_sel_hi:[0,1,1] neg_lo:[1,0,0] neg_hi:[1,0,0]
v_pk_fma_f32 v[222:223], v[42:43], v[62:63], v[222:223] op_sel_hi:[0,1,1] neg_lo:[1,0,0] neg_hi:[1,0,0]
v_pk_mul_f32 v[220:221], v[42:43], v[220:221] op_sel:[1,0] op_sel_hi:[1,1]
v_pk_mul_f32 v[222:223], v[42:43], v[222:223] op_sel:[1,0] op_sel_hi:[1,1]
v_cvt_pk_bf16_f32 v220, v220, v221
v_cvt_pk_bf16_f32 v221, v222, v223
ds_write_b64 v14, v[220:221] offset:32256
v_pk_fma_f32 v[152:153], v[44:45], v[52:53], v[152:153] op_sel_hi:[0,1,1] neg_lo:[1,0,0] neg_hi:[1,0,0]
v_pk_fma_f32 v[154:155], v[44:45], v[54:55], v[154:155] op_sel_hi:[0,1,1] neg_lo:[1,0,0] neg_hi:[1,0,0]
v_pk_mul_f32 v[152:153], v[44:45], v[152:153] op_sel:[1,0] op_sel_hi:[1,1]
v_pk_mul_f32 v[154:155], v[44:45], v[154:155] op_sel:[1,0] op_sel_hi:[1,1]
v_cvt_pk_bf16_f32 v152, v152, v153
v_cvt_pk_bf16_f32 v153, v154, v155
ds_write_b64 v14, v[152:153] offset:38400
v_pk_fma_f32 v[188:189], v[44:45], v[56:57], v[188:189] op_sel_hi:[0,1,1] neg_lo:[1,0,0] neg_hi:[1,0,0]
v_pk_fma_f32 v[190:191], v[44:45], v[58:59], v[190:191] op_sel_hi:[0,1,1] neg_lo:[1,0,0] neg_hi:[1,0,0]
v_pk_mul_f32 v[188:189], v[44:45], v[188:189] op_sel:[1,0] op_sel_hi:[1,1]
v_pk_mul_f32 v[190:191], v[44:45], v[190:191] op_sel:[1,0] op_sel_hi:[1,1]
v_cvt_pk_bf16_f32 v188, v188, v189
v_cvt_pk_bf16_f32 v189, v190, v191
ds_write_b64 v14, v[188:189] offset:38528
v_pk_fma_f32 v[224:225], v[44:45], v[60:61], v[224:225] op_sel_hi:[0,1,1] neg_lo:[1,0,0] neg_hi:[1,0,0]
v_pk_fma_f32 v[226:227], v[44:45], v[62:63], v[226:227] op_sel_hi:[0,1,1] neg_lo:[1,0,0] neg_hi:[1,0,0]
v_pk_mul_f32 v[224:225], v[44:45], v[224:225] op_sel:[1,0] op_sel_hi:[1,1]
v_pk_mul_f32 v[226:227], v[44:45], v[226:227] op_sel:[1,0] op_sel_hi:[1,1]
v_cvt_pk_bf16_f32 v224, v224, v225
v_cvt_pk_bf16_f32 v225, v226, v227
ds_write_b64 v14, v[224:225] offset:38656
v_pk_fma_f32 v[156:157], v[46:47], v[52:53], v[156:157] op_sel_hi:[0,1,1] neg_lo:[1,0,0] neg_hi:[1,0,0]
v_pk_fma_f32 v[158:159], v[46:47], v[54:55], v[158:159] op_sel_hi:[0,1,1] neg_lo:[1,0,0] neg_hi:[1,0,0]
v_pk_mul_f32 v[156:157], v[46:47], v[156:157] op_sel:[1,0] op_sel_hi:[1,1]
v_pk_mul_f32 v[158:159], v[46:47], v[158:159] op_sel:[1,0] op_sel_hi:[1,1]
v_cvt_pk_bf16_f32 v156, v156, v157
v_cvt_pk_bf16_f32 v157, v158, v159
ds_write_b64 v14, v[156:157] offset:44800
v_pk_fma_f32 v[192:193], v[46:47], v[56:57], v[192:193] op_sel_hi:[0,1,1] neg_lo:[1,0,0] neg_hi:[1,0,0]
v_pk_fma_f32 v[194:195], v[46:47], v[58:59], v[194:195] op_sel_hi:[0,1,1] neg_lo:[1,0,0] neg_hi:[1,0,0]
v_pk_mul_f32 v[192:193], v[46:47], v[192:193] op_sel:[1,0] op_sel_hi:[1,1]
v_pk_mul_f32 v[194:195], v[46:47], v[194:195] op_sel:[1,0] op_sel_hi:[1,1]
v_cvt_pk_bf16_f32 v192, v192, v193
v_cvt_pk_bf16_f32 v193, v194, v195
ds_write_b64 v14, v[192:193] offset:44928
v_pk_fma_f32 v[228:229], v[46:47], v[60:61], v[228:229] op_sel_hi:[0,1,1] neg_lo:[1,0,0] neg_hi:[1,0,0]
v_pk_fma_f32 v[230:231], v[46:47], v[62:63], v[230:231] op_sel_hi:[0,1,1] neg_lo:[1,0,0] neg_hi:[1,0,0]
v_pk_mul_f32 v[228:229], v[46:47], v[228:229] op_sel:[1,0] op_sel_hi:[1,1]
v_pk_mul_f32 v[230:231], v[46:47], v[230:231] op_sel:[1,0] op_sel_hi:[1,1]
v_cvt_pk_bf16_f32 v228, v228, v229
v_cvt_pk_bf16_f32 v229, v230, v231
ds_write_b64 v14, v[228:229] offset:45056
v_pk_fma_f32 v[160:161], v[48:49], v[52:53], v[160:161] op_sel_hi:[0,1,1] neg_lo:[1,0,0] neg_hi:[1,0,0]
v_pk_fma_f32 v[162:163], v[48:49], v[54:55], v[162:163] op_sel_hi:[0,1,1] neg_lo:[1,0,0] neg_hi:[1,0,0]
v_pk_mul_f32 v[160:161], v[48:49], v[160:161] op_sel:[1,0] op_sel_hi:[1,1]
v_pk_mul_f32 v[162:163], v[48:49], v[162:163] op_sel:[1,0] op_sel_hi:[1,1]
v_cvt_pk_bf16_f32 v160, v160, v161
v_cvt_pk_bf16_f32 v161, v162, v163
ds_write_b64 v14, v[160:161] offset:51200
v_pk_fma_f32 v[196:197], v[48:49], v[56:57], v[196:197] op_sel_hi:[0,1,1] neg_lo:[1,0,0] neg_hi:[1,0,0]
v_pk_fma_f32 v[198:199], v[48:49], v[58:59], v[198:199] op_sel_hi:[0,1,1] neg_lo:[1,0,0] neg_hi:[1,0,0]
v_pk_mul_f32 v[196:197], v[48:49], v[196:197] op_sel:[1,0] op_sel_hi:[1,1]
v_pk_mul_f32 v[198:199], v[48:49], v[198:199] op_sel:[1,0] op_sel_hi:[1,1]
v_cvt_pk_bf16_f32 v196, v196, v197
v_cvt_pk_bf16_f32 v197, v198, v199
ds_write_b64 v14, v[196:197] offset:51328
v_pk_fma_f32 v[232:233], v[48:49], v[60:61], v[232:233] op_sel_hi:[0,1,1] neg_lo:[1,0,0] neg_hi:[1,0,0]
v_pk_fma_f32 v[234:235], v[48:49], v[62:63], v[234:235] op_sel_hi:[0,1,1] neg_lo:[1,0,0] neg_hi:[1,0,0]
v_pk_mul_f32 v[232:233], v[48:49], v[232:233] op_sel:[1,0] op_sel_hi:[1,1]
v_pk_mul_f32 v[234:235], v[48:49], v[234:235] op_sel:[1,0] op_sel_hi:[1,1]
v_cvt_pk_bf16_f32 v232, v232, v233
v_cvt_pk_bf16_f32 v233, v234, v235
ds_write_b64 v14, v[232:233] offset:51456
s_waitcnt lgkmcnt(0)
s_branch Latt_4
Lpf_3:
s_load_dwordx2 s[26:27], s[0:1], 64
s_or_b32 s43, s34, s35
s_cmp_lg_u32 s43, 0
s_cbranch_scc1 Lz_9
s_add_u32 s84, s32, 28311552
s_addc_u32 s85, s33, 0
s_mov_b32 s86, 32768
s_mov_b32 s87, 0x20000
v_lshlrev_b32 v14, 7, v1
v_mov_b32 v36, 0
v_mov_b32 v37, 0
s_mov_b32 s43, 0
buffer_store_dwordx2 v[36:37], v14, s[84:87], s43 offen sc1
s_mov_b32 s43, 8192
buffer_store_dwordx2 v[36:37], v14, s[84:87], s43 offen sc1
s_mov_b32 s43, 16384
buffer_store_dwordx2 v[36:37], v14, s[84:87], s43 offen sc1
s_mov_b32 s43, 24576
buffer_store_dwordx2 v[36:37], v14, s[84:87], s43 offen sc1
Lz_9:
s_lshl_b32 s43, s51, 11
buffer_load_dwordx4 v[96:99], v10, s[8:11], s43 offen offset:0
buffer_load_dwordx4 v[100:103], v10, s[8:11], s43 offen offset:1024
buffer_load_dwordx4 v[104:107], v10, s[8:11], s43 offen offset:2048
buffer_load_dwordx4 v[108:111], v10, s[8:11], s43 offen offset:3072
v_min_u32 v14, 23, v1
v_lshrrev_b32 v15, 3, v14
v_mul_u32_u24 v15, 43008, v15
v_and_b32 v14, 7, v14
v_lshl_add_u32 v15, v14, 4, v15
v_mov_b32 v32, 0x3f803f80
v_mov_b32 v33, 0x3f803f80
v_mov_b32 v34, 0x3f803f80
v_mov_b32 v35, 0x3f803f80
ds_write_b128 v15, v[32:35]
v_add_u32 v14, 0, v1
v_min_u32 v14, 47, v14
v_mul_u32_u24 v15, 21846, v14
v_lshrrev_b32 v15, 16, v15
v_mul_u32_u24 v16, 3, v15
v_sub_u32 v16, v14, v16
s_mul_i32 s43, s48, 16
v_add_u32 v15, s43, v15
v_mul_u32_u24 v15, 6144, v15
v_lshl_add_u32 v2, v16, 11, v15
s_waitcnt lgkmcnt(0)
s_mov_b32 s56, s26
s_mov_b32 s57, s27
s_mov_b32 s58, 256
s_mov_b32 s59, 0x20000
v_lshlrev_b32 v14, 7, v1
s_barrier
s_cmp_ge_u32 s2, 128
s_cbranch_scc1 Lm_11
s_mov_b32 s84, s6
s_mov_b32 s85, s7
s_mov_b32 s86, 6291456
s_mov_b32 s87, 0x20000
s_mul_i32 s43, s2, 24576
buffer_load_dword v31, v14, s[84:87], s43 offen
s_add_u32 s43, s43, 8192
buffer_load_dword v31, v14, s[84:87], s43 offen
s_add_u32 s43, s43, 8192
buffer_load_dword v31, v14, s[84:87], s43 offen
Lm_11:
s_mov_b32 s84, s6
s_mov_b32 s85, s7
s_mov_b32 s86, 6291456
s_mov_b32 s87, 0x20000
s_lshr_b32 s44, s2, 3
s_lshr_b32 s43, s2, 5
s_cmp_eq_u32 s43, 3
s_cbranch_scc1 Lsj_12
s_cmp_gt_u32 s43, 3
s_cselect_b32 s43, 32, 0
s_sub_u32 s43, s2, s43
s_lshr_b32 s43, s43, 1
s_and_b32 s44, s2, 1
s_lshl_b32 s44, s44, 3
s_add_u32 s44, s44, 32
s_load_dwordx2 s[80:81], s[0:1], s44
s_mul_i32 s45, s43, 2341
s_lshr_b32 s45, s45, 16
s_mul_i32 s46, s45, 28
s_sub_u32 s46, s43, s46
s_lshl_b32 s45, s45, 8
s_mul_i32 s44, s47, 18
s_add_u32 s45, s45, s44
s_add_u32 s45, s45, 184
s_mul_i32 s45, s45, 7168
s_lshl_b32 s46, s46, 8
s_add_u32 s45, s45, s46
s_waitcnt lgkmcnt(0)
s_add_u32 s80, s80, s45
s_addc_u32 s81, s81, 0
Lsj_12:
s_barrier
s_cmp_ge_u32 s2, 128
s_cbranch_scc0 Lm_13
s_mov_b32 s84, s6
s_mov_b32 s85, s7
s_mov_b32 s86, 6291456
s_mov_b32 s87, 0x20000
s_mul_i32 s43, s2, 24576
buffer_load_dword v31, v14, s[84:87], s43 offen
s_add_u32 s43, s43, 8192
buffer_load_dword v31, v14, s[84:87], s43 offen
s_add_u32 s43, s43, 8192
buffer_load_dword v31, v14, s[84:87], s43 offen
Lm_13:
s_barrier
s_waitcnt vmcnt(0)
s_or_b32 s43, s34, s35
s_cmp_lg_u32 s43, 0
s_cbranch_scc1 Lz_14
s_waitcnt vmcnt(0)
v_mov_b32 v5, 1
v_mov_b32 v6, 0
s_mov_b64 exec, 1
buffer_store_dword v5, v6, s[56:59], 0 offen sc1
s_mov_b64 exec, -1
Lz_14:
v_lshlrev_b32 v116, 16, v96
v_and_b32 v117, 0xffff0000, v96
v_mul_f32 v118, v116, v116
v_mul_f32 v119, v117, v117
v_lshlrev_b32 v126, 16, v97
v_and_b32 v127, 0xffff0000, v97
v_add_f32 v116, v116, v126
v_add_f32 v117, v117, v127
v_fmac_f32 v118, v126, v126
v_fmac_f32 v119, v127, v127
v_lshlrev_b32 v124, 16, v98
v_and_b32 v125, 0xffff0000, v98
v_add_f32 v116, v116, v124
v_add_f32 v117, v117, v125
v_fmac_f32 v118, v124, v124
v_fmac_f32 v119, v125, v125
v_lshlrev_b32 v126, 16, v99
v_and_b32 v127, 0xffff0000, v99
v_add_f32 v116, v116, v126
v_add_f32 v117, v117, v127
v_fmac_f32 v118, v126, v126
v_fmac_f32 v119, v127, v127
v_lshlrev_b32 v124, 16, v100
v_and_b32 v125, 0xffff0000, v100
v_add_f32 v116, v116, v124
v_add_f32 v117, v117, v125
v_fmac_f32 v118, v124, v124
v_fmac_f32 v119, v125, v125
v_lshlrev_b32 v126, 16, v101
v_and_b32 v127, 0xffff0000, v101
v_add_f32 v116, v116, v126
v_add_f32 v117, v117, v127
v_fmac_f32 v118, v126, v126
v_fmac_f32 v119, v127, v127
v_lshlrev_b32 v124, 16, v102
v_and_b32 v125, 0xffff0000, v102
v_add_f32 v116, v116, v124
v_add_f32 v117, v117, v125
v_fmac_f32 v118, v124, v124
v_fmac_f32 v119, v125, v125
v_lshlrev_b32 v126, 16, v103
v_and_b32 v127, 0xffff0000, v103
v_add_f32 v116, v116, v126
v_add_f32 v117, v117, v127
v_fmac_f32 v118, v126, v126
v_fmac_f32 v119, v127, v127
v_lshlrev_b32 v120, 16, v104
v_and_b32 v121, 0xffff0000, v104
v_mul_f32 v122, v120, v120
v_mul_f32 v123, v121, v121
s_barrier
v_lshlrev_b32 v126, 16, v105
v_and_b32 v127, 0xffff0000, v105
v_add_f32 v120, v120, v126
v_add_f32 v121, v121, v127
v_fmac_f32 v122, v126, v126
v_fmac_f32 v123, v127, v127
v_lshlrev_b32 v124, 16, v106
v_and_b32 v125, 0xffff0000, v106
v_add_f32 v120, v120, v124
v_add_f32 v121, v121, v125
v_fmac_f32 v122, v124, v124
v_fmac_f32 v123, v125, v125
v_lshlrev_b32 v126, 16, v107
v_and_b32 v127, 0xffff0000, v107
v_add_f32 v120, v120, v126
v_add_f32 v121, v121, v127
v_fmac_f32 v122, v126, v126
v_fmac_f32 v123, v127, v127
v_lshlrev_b32 v124, 16, v108
v_and_b32 v125, 0xffff0000, v108
v_add_f32 v120, v120, v124
v_add_f32 v121, v121, v125
v_fmac_f32 v122, v124, v124
v_fmac_f32 v123, v125, v125
v_lshlrev_b32 v126, 16, v109
v_and_b32 v127, 0xffff0000, v109
v_add_f32 v120, v120, v126
v_add_f32 v121, v121, v127
v_fmac_f32 v122, v126, v126
v_fmac_f32 v123, v127, v127
v_lshlrev_b32 v124, 16, v110
v_and_b32 v125, 0xffff0000, v110
v_add_f32 v120, v120, v124
v_add_f32 v121, v121, v125
v_fmac_f32 v122, v124, v124
v_fmac_f32 v123, v125, v125
v_lshlrev_b32 v126, 16, v111
v_and_b32 v127, 0xffff0000, v111
v_add_f32 v120, v120, v126
v_add_f32 v121, v121, v127
v_fmac_f32 v122, v126, v126
v_fmac_f32 v123, v127, v127
v_add_f32 v116, v116, v117
v_add_f32 v118, v118, v119
v_add_f32 v120, v120, v121
v_add_f32 v122, v122, v123
v_add_f32_dpp v116, v116, v116 row_ror:8 row_mask:0xf bank_mask:0xf
v_add_f32_dpp v118, v118, v118 row_ror:8 row_mask:0xf bank_mask:0xf
v_add_f32_dpp v120, v120, v120 row_ror:8 row_mask:0xf bank_mask:0xf
v_add_f32_dpp v122, v122, v122 row_ror:8 row_mask:0xf bank_mask:0xf
s_barrier
v_add_f32_dpp v116, v116, v116 row_ror:4 row_mask:0xf bank_mask:0xf
v_add_f32_dpp v118, v118, v118 row_ror:4 row_mask:0xf bank_mask:0xf
v_add_f32_dpp v120, v120, v120 row_ror:4 row_mask:0xf bank_mask:0xf
v_add_f32_dpp v122, v122, v122 row_ror:4 row_mask:0xf bank_mask:0xf
v_add_f32_dpp v116, v116, v116 row_ror:2 row_mask:0xf bank_mask:0xf
v_add_f32_dpp v118, v118, v118 row_ror:2 row_mask:0xf bank_mask:0xf
v_add_f32_dpp v120, v120, v120 row_ror:2 row_mask:0xf bank_mask:0xf
v_add_f32_dpp v122, v122, v122 row_ror:2 row_mask:0xf bank_mask:0xf
v_add_f32_dpp v116, v116, v116 row_ror:1 row_mask:0xf bank_mask:0xf
v_add_f32_dpp v118, v118, v118 row_ror:1 row_mask:0xf bank_mask:0xf
v_add_f32_dpp v120, v120, v120 row_ror:1 row_mask:0xf bank_mask:0xf
v_add_f32_dpp v122, v122, v122 row_ror:1 row_mask:0xf bank_mask:0xf
v_mov_b32 v117, v116
v_mov_b32 v119, v118
v_mov_b32 v121, v120
v_mov_b32 v123, v122
s_nop 0
v_permlane16_swap_b32 v116, v117
v_permlane16_swap_b32 v118, v119
v_permlane16_swap_b32 v120, v121
v_permlane16_swap_b32 v122, v123
v_add_f32 v116, v116, v117
v_add_f32 v118, v118, v119
v_add_f32 v120, v120, v121
v_add_f32 v122, v122, v123
v_mov_b32 v117, v116
v_mov_b32 v119, v118
v_mov_b32 v121, v120
v_mov_b32 v123, v122
s_nop 0
v_permlane32_swap_b32 v116, v117
v_permlane32_swap_b32 v118, v119
v_permlane32_swap_b32 v120, v121
v_permlane32_swap_b32 v122, v123
v_add_f32 v116, v116, v117
v_add_f32 v118, v118, v119
v_add_f32 v120, v120, v121
v_add_f32 v122, v122, v123
v_mul_f32 v112, 0x3a800000, v116
v_mul_f32 v113, 0x3a800000, v118
v_fma_f32 v113, -v112, v112, v113
v_max_f32 v113, 0, v113
v_add_f32 v113, 0x3727c5ac, v113
v_rsq_f32 v113, v113
v_mul_f32 v114, 0x3a800000, v120
v_mul_f32 v115, 0x3a800000, v122
v_fma_f32 v115, -v114, v114, v115
v_max_f32 v115, 0, v115
v_add_f32 v115, 0x3727c5ac, v115
v_rsq_f32 v115, v115
s_nop 0
s_lshl_b32 s43, s47, 4
s_add_u32 s43, s43, 130176
v_mov_b32 v11, s43
ds_write_b128 v11, v[112:115]
s_waitcnt lgkmcnt(0)
s_barrier
v_lshlrev_b32 v5, 4, v1
v_and_b32 v5, 63, v5
v_add_u32 v6, 130176, v5
ds_read_b128 v[112:115], v6
s_lshl_b32 s43, s63, 3
v_add_u32 v5, s43, v5
s_waitcnt lgkmcnt(0)
s_mov_b64 exec, 15
buffer_store_dwordx4 v[112:115], v5, s[20:23], 0 offen sc1
s_mov_b64 exec, -1
v_mov_b32 v7, 0
v_mov_b32 v9, 1
buffer_load_dword v8, v7, s[56:59], 0 offen sc1
s_load_dword s64, s[80:81], 0
s_load_dword s65, s[80:81], 64
s_load_dword s66, s[80:81], 128
s_load_dword s67, s[80:81], 192
s_load_dword s68, s[80:81], 7168
s_load_dword s69, s[80:81], 7232
s_load_dword s70, s[80:81], 7296
s_load_dword s71, s[80:81], 7360
s_add_u32 s80, s80, 14336
s_addc_u32 s81, s81, 0
s_barrier
s_load_dword s64, s[80:81], 0
s_load_dword s65, s[80:81], 64
s_load_dword s66, s[80:81], 128
s_load_dword s67, s[80:81], 192
s_load_dword s68, s[80:81], 7168
s_load_dword s69, s[80:81], 7232
s_load_dword s70, s[80:81], 7296
s_load_dword s71, s[80:81], 7360
s_add_u32 s80, s80, 14336
s_addc_u32 s81, s81, 0
s_barrier
s_mov_b32 s41, 0x10000
Lpoll_15:
s_waitcnt vmcnt(0)
Lpf_17:
v_cmp_ne_u32 vcc, v9, v8
s_nop 4
s_cbranch_vccz Lpok_16
buffer_load_dword v8, v7, s[56:59], 0 offen sc1
s_sub_u32 s41, s41, 1
s_cmp_lg_u32 s41, 0
s_cbranch_scc1 Lpoll_15
s_waitcnt vmcnt(0)
Lpok_16:
s_add_u32 s56, s32, 28311552
s_addc_u32 s57, s33, 0
s_mov_b32 s58, 32768
s_mov_b32 s59, 0x20000
s_add_u32 s43, s34, 80
s_lshl_b32 s43, s43, 7
v_mov_b32 v5, s43
v_mov_b32 v6, 1
s_mov_b64 exec, 1
buffer_atomic_add v6, v5, s[56:59], 0 offen sc1
s_mov_b64 exec, -1
s_load_dword s64, s[80:81], 0
s_load_dword s65, s[80:81], 64
s_load_dword s66, s[80:81], 128
s_load_dword s67, s[80:81], 192
s_load_dword s68, s[80:81], 7168
s_load_dword s69, s[80:81], 7232
s_load_dword s70, s[80:81], 7296
s_load_dword s71, s[80:81], 7360
s_add_u32 s80, s80, 14336
s_addc_u32 s81, s81, 0
s_barrier
s_load_dword s64, s[80:81], 0
s_load_dword s65, s[80:81], 64
s_load_dword s66, s[80:81], 128
s_load_dword s67, s[80:81], 192
s_load_dword s68, s[80:81], 7168
s_load_dword s69, s[80:81], 7232
s_load_dword s70, s[80:81], 7296
s_load_dword s71, s[80:81], 7360
s_add_u32 s80, s80, 14336
s_addc_u32 s81, s81, 0
s_barrier
s_load_dword s64, s[80:81], 0
s_load_dword s65, s[80:81], 64
s_load_dword s66, s[80:81], 128
s_load_dword s67, s[80:81], 192
s_load_dword s68, s[80:81], 7168
s_load_dword s69, s[80:81], 7232
s_load_dword s70, s[80:81], 7296
s_load_dword s71, s[80:81], 7360
s_add_u32 s80, s80, 14336
s_addc_u32 s81, s81, 0
s_barrier
s_sub_u32 s44, s34, 1
s_max_i32 s44, s44, 0
v_mov_b32 v5, s44
v_mov_b32 v6, s34
v_cmp_eq_u32 vcc, 0, v1
s_nop 1
v_cndmask_b32 v5, v5, v6, vcc
v_add_u32 v5, 80, v5
v_lshlrev_b32 v5, 7, v5
buffer_load_dword v6, v5, s[56:59], 0 offen sc1
s_load_dword s64, s[80:81], 0
s_load_dword s65, s[80:81], 64
s_load_dword s66, s[80:81], 128
s_load_dword s67, s[80:81], 192
s_load_dword s68, s[80:81], 7168
s_load_dword s69, s[80:81], 7232
s_load_dword s70, s[80:81], 7296
s_load_dword s71, s[80:81], 7360
s_add_u32 s80, s80, 14336
s_addc_u32 s81, s81, 0
s_barrier
s_load_dword s64, s[80:81], 0
s_load_dword s65, s[80:81], 64
s_load_dword s66, s[80:81], 128
s_load_dword s67, s[80:81], 192
s_load_dword s68, s[80:81], 7168
s_load_dword s69, s[80:81], 7232
s_load_dword s70, s[80:81], 7296
s_load_dword s71, s[80:81], 7360
s_add_u32 s80, s80, 14336
s_addc_u32 s81, s81, 0
s_barrier
s_mov_b32 s41, 200
s_mov_b32 s62, 0
s_waitcnt vmcnt(0)
Lpoll_18:
v_cmp_ne_u32 vcc, 16, v6
s_nop 4
s_cbranch_vccz Lok_19
buffer_load_dword v6, v5, s[56:59], 0 offen sc1
s_waitcnt vmcnt(0)
s_sub_u32 s41, s41, 1
s_cmp_lg_u32 s41, 0
s_cbranch_scc1 Lpoll_18
s_mov_b32 s41, 0
Lfb_20:
s_add_u32 s62, s50, s41
s_max_i32 s62, s62, 0
s_lshl_b32 s43, s62, 11
buffer_load_dwordx4 v[96:99], v10, s[8:11], s43 offen offset:0
buffer_load_dwordx4 v[100:103], v10, s[8:11], s43 offen offset:1024
buffer_load_dwordx4 v[104:107], v10, s[8:11], s43 offen offset:2048
buffer_load_dwordx4 v[108:111], v10, s[8:11], s43 offen offset:3072
s_waitcnt vmcnt(0)
v_lshlrev_b32 v116, 16, v96
v_and_b32 v117, 0xffff0000, v96
v_mul_f32 v118, v116, v116
v_mul_f32 v119, v117, v117
v_lshlrev_b32 v126, 16, v97
v_and_b32 v127, 0xffff0000, v97
v_add_f32 v116, v116, v126
v_add_f32 v117, v117, v127
v_fmac_f32 v118, v126, v126
v_fmac_f32 v119, v127, v127
v_lshlrev_b32 v124, 16, v98
v_and_b32 v125, 0xffff0000, v98
v_add_f32 v116, v116, v124
v_add_f32 v117, v117, v125
v_fmac_f32 v118, v124, v124
v_fmac_f32 v119, v125, v125
v_lshlrev_b32 v126, 16, v99
v_and_b32 v127, 0xffff0000, v99
v_add_f32 v116, v116, v126
v_add_f32 v117, v117, v127
v_fmac_f32 v118, v126, v126
v_fmac_f32 v119, v127, v127
v_lshlrev_b32 v124, 16, v100
v_and_b32 v125, 0xffff0000, v100
v_add_f32 v116, v116, v124
v_add_f32 v117, v117, v125
v_fmac_f32 v118, v124, v124
v_fmac_f32 v119, v125, v125
v_lshlrev_b32 v126, 16, v101
v_and_b32 v127, 0xffff0000, v101
v_add_f32 v116, v116, v126
v_add_f32 v117, v117, v127
v_fmac_f32 v118, v126, v126
v_fmac_f32 v119, v127, v127
v_lshlrev_b32 v124, 16, v102
v_and_b32 v125, 0xffff0000, v102
v_add_f32 v116, v116, v124
v_add_f32 v117, v117, v125
v_fmac_f32 v118, v124, v124
v_fmac_f32 v119, v125, v125
v_lshlrev_b32 v126, 16, v103
v_and_b32 v127, 0xffff0000, v103
v_add_f32 v116, v116, v126
v_add_f32 v117, v117, v127
v_fmac_f32 v118, v126, v126
v_fmac_f32 v119, v127, v127
v_lshlrev_b32 v120, 16, v104
v_and_b32 v121, 0xffff0000, v104
v_mul_f32 v122, v120, v120
v_mul_f32 v123, v121, v121
v_lshlrev_b32 v126, 16, v105
v_and_b32 v127, 0xffff0000, v105
v_add_f32 v120, v120, v126
v_add_f32 v121, v121, v127
v_fmac_f32 v122, v126, v126
v_fmac_f32 v123, v127, v127
v_lshlrev_b32 v124, 16, v106
v_and_b32 v125, 0xffff0000, v106
v_add_f32 v120, v120, v124
v_add_f32 v121, v121, v125
v_fmac_f32 v122, v124, v124
v_fmac_f32 v123, v125, v125
v_lshlrev_b32 v126, 16, v107
v_and_b32 v127, 0xffff0000, v107
v_add_f32 v120, v120, v126
v_add_f32 v121, v121, v127
v_fmac_f32 v122, v126, v126
v_fmac_f32 v123, v127, v127
v_lshlrev_b32 v124, 16, v108
v_and_b32 v125, 0xffff0000, v108
v_add_f32 v120, v120, v124
v_add_f32 v121, v121, v125
v_fmac_f32 v122, v124, v124
v_fmac_f32 v123, v125, v125
v_lshlrev_b32 v126, 16, v109
v_and_b32 v127, 0xffff0000, v109
v_add_f32 v120, v120, v126
v_add_f32 v121, v121, v127
v_fmac_f32 v122, v126, v126
v_fmac_f32 v123, v127, v127
v_lshlrev_b32 v124, 16, v110
v_and_b32 v125, 0xffff0000, v110
v_add_f32 v120, v120, v124
v_add_f32 v121, v121, v125
v_fmac_f32 v122, v124, v124
v_fmac_f32 v123, v125, v125
v_lshlrev_b32 v126, 16, v111
v_and_b32 v127, 0xffff0000, v111
v_add_f32 v120, v120, v126
v_add_f32 v121, v121, v127
v_fmac_f32 v122, v126, v126
v_fmac_f32 v123, v127, v127
v_add_f32 v116, v116, v117
v_add_f32 v118, v118, v119
v_add_f32 v120, v120, v121
v_add_f32 v122, v122, v123
v_add_f32_dpp v116, v116, v116 row_ror:8 row_mask:0xf bank_mask:0xf
v_add_f32_dpp v118, v118, v118 row_ror:8 row_mask:0xf bank_mask:0xf
v_add_f32_dpp v120, v120, v120 row_ror:8 row_mask:0xf bank_mask:0xf
v_add_f32_dpp v122, v122, v122 row_ror:8 row_mask:0xf bank_mask:0xf
v_add_f32_dpp v116, v116, v116 row_ror:4 row_mask:0xf bank_mask:0xf
v_add_f32_dpp v118, v118, v118 row_ror:4 row_mask:0xf bank_mask:0xf
v_add_f32_dpp v120, v120, v120 row_ror:4 row_mask:0xf bank_mask:0xf
v_add_f32_dpp v122, v122, v122 row_ror:4 row_mask:0xf bank_mask:0xf
v_add_f32_dpp v116, v116, v116 row_ror:2 row_mask:0xf bank_mask:0xf
v_add_f32_dpp v118, v118, v118 row_ror:2 row_mask:0xf bank_mask:0xf
v_add_f32_dpp v120, v120, v120 row_ror:2 row_mask:0xf bank_mask:0xf
v_add_f32_dpp v122, v122, v122 row_ror:2 row_mask:0xf bank_mask:0xf
v_add_f32_dpp v116, v116, v116 row_ror:1 row_mask:0xf bank_mask:0xf
v_add_f32_dpp v118, v118, v118 row_ror:1 row_mask:0xf bank_mask:0xf
v_add_f32_dpp v120, v120, v120 row_ror:1 row_mask:0xf bank_mask:0xf
v_add_f32_dpp v122, v122, v122 row_ror:1 row_mask:0xf bank_mask:0xf
v_mov_b32 v117, v116
v_mov_b32 v119, v118
v_mov_b32 v121, v120
v_mov_b32 v123, v122
s_nop 0
v_permlane16_swap_b32 v116, v117
v_permlane16_swap_b32 v118, v119
v_permlane16_swap_b32 v120, v121
v_permlane16_swap_b32 v122, v123
v_add_f32 v116, v116, v117
v_add_f32 v118, v118, v119
v_add_f32 v120, v120, v121
v_add_f32 v122, v122, v123
v_mov_b32 v117, v116
v_mov_b32 v119, v118
v_mov_b32 v121, v120
v_mov_b32 v123, v122
s_nop 0
v_permlane32_swap_b32 v116, v117
v_permlane32_swap_b32 v118, v119
v_permlane32_swap_b32 v120, v121
v_permlane32_swap_b32 v122, v123
v_add_f32 v116, v116, v117
v_add_f32 v118, v118, v119
v_add_f32 v120, v120, v121
v_add_f32 v122, v122, v123
v_mul_f32 v112, 0x3a800000, v116
v_mul_f32 v113, 0x3a800000, v118
v_fma_f32 v113, -v112, v112, v113
v_max_f32 v113, 0, v113
v_add_f32 v113, 0x3727c5ac, v113
v_rsq_f32 v113, v113
v_mul_f32 v114, 0x3a800000, v120
v_mul_f32 v115, 0x3a800000, v122
v_fma_f32 v115, -v114, v114, v115
v_max_f32 v115, 0, v115
v_add_f32 v115, 0x3727c5ac, v115
v_rsq_f32 v115, v115
s_nop 0
s_lshl_b32 s43, s41, 3
s_add_u32 s43, s43, 129024
v_mov_b32 v5, s43
ds_write_b128 v5, v[112:115]
s_add_u32 s41, s41, 2
s_cmp_lt_u32 s41, 144
s_cbranch_scc1 Lfb_20
s_mov_b32 s62, 1
Lok_19:
v_add_u32 v5, 0, v1
v_min_u32 v5, 143, v5
v_lshlrev_b32 v20, 3, v5
v_add_u32 v5, s50, v5
v_max_i32 v5, 0, v5
v_lshlrev_b32 v5, 3, v5
buffer_load_dwordx2 v[32:33], v5, s[20:23], 0 offen sc1
v_add_u32 v5, 64, v1
v_min_u32 v5, 143, v5
v_lshlrev_b32 v21, 3, v5
v_add_u32 v5, s50, v5
v_max_i32 v5, 0, v5
v_lshlrev_b32 v5, 3, v5
buffer_load_dwordx2 v[34:35], v5, s[20:23], 0 offen sc1
v_add_u32 v5, 128, v1
v_min_u32 v5, 143, v5
v_lshlrev_b32 v22, 3, v5
v_add_u32 v5, s50, v5
v_max_i32 v5, 0, v5
v_lshlrev_b32 v5, 3, v5
buffer_load_dwordx2 v[36:37], v5, s[20:23], 0 offen sc1
s_load_dword s64, s[80:81], 0
s_load_dword s65, s[80:81], 64
s_load_dword s66, s[80:81], 128
s_load_dword s67, s[80:81], 192
s_load_dword s68, s[80:81], 7168
s_load_dword s69, s[80:81], 7232
s_load_dword s70, s[80:81], 7296
s_load_dword s71, s[80:81], 7360
s_add_u32 s80, s80, 14336
s_addc_u32 s81, s81, 0
s_barrier
s_load_dwordx2 s[88:89], s[0:1], 16
v_lshlrev_b32 v29, 7, v1
s_lshl_b32 s43, s2, 13
s_waitcnt lgkmcnt(0)
s_mov_b32 s84, s88
s_mov_b32 s85, s89
s_mov_b32 s86, 2097152
s_mov_b32 s87, 0x20000
buffer_load_dword v30, v29, s[84:87], s43 offen
v_and_b32 v29, 31, v1
v_lshlrev_b32 v29, 11, v29
s_and_b32 s43, s35, 8
s_or_b32 s43, s43, 3
s_lshl_b32 s43, s43, 7
s_lshr_b32 s44, s2, 3
s_lshl_b32 s44, s44, 16
s_add_u32 s43, s43, s44
buffer_load_dword v30, v29, s[84:87], s43 offen
s_barrier
s_waitcnt vmcnt(2)
s_cmp_eq_u32 s62, 1
s_cbranch_scc1 Lgd_10
v_add_u32 v20, 129024, v20
ds_write_b64 v20, v[32:33]
v_add_u32 v21, 129024, v21
ds_write_b64 v21, v[34:35]
v_add_u32 v22, 129024, v22
ds_write_b64 v22, v[36:37]
Lgd_10:
s_waitcnt lgkmcnt(0)
s_lshr_b32 s43, s2, 5
s_cmp_eq_u32 s43, 3
s_cbranch_scc1 Lnj_21
s_cmp_gt_u32 s43, 3
s_cselect_b32 s43, 32, 0
s_sub_u32 s43, s2, s43
s_lshr_b32 s43, s43, 1
s_and_b32 s44, s2, 1
s_lshl_b32 s45, s44, 3
s_add_u32 s45, s45, 32
s_load_dwordx2 s[88:89], s[0:1], s45
s_mul_i32 s45, s43, 2341
s_lshr_b32 s45, s45, 16
s_mul_i32 s46, s45, 28
s_sub_u32 s46, s43, s46
v_lshrrev_b32 v28, 4, v1
s_lshl_b32 s43, s45, 8
v_add_u32 v28, s43, v28
v_mul_u32_u24 v28, 7168, v28
v_and_b32 v29, 15, v1
v_lshl_add_u32 v28, v29, 4, v28
s_lshl_b32 s43, s46, 8
v_add_u32 v28, s43, v28
s_waitcnt lgkmcnt(0)
s_mov_b32 s84, s88
s_mov_b32 s85, s89
s_mov_b32 s86, 7340032
s_mov_b32 s87, 0x20000
s_mov_b32 s43, 0
buffer_load_dwordx4 v[128:131], v28, s[84:87], s43 offen
s_mov_b32 s43, 28672
buffer_load_dwordx4 v[132:135], v28, s[84:87], s43 offen
s_mov_b32 s43, 57344
buffer_load_dwordx4 v[136:139], v28, s[84:87], s43 offen
s_mov_b32 s43, 86016
buffer_load_dwordx4 v[140:143], v28, s[84:87], s43 offen
s_mov_b32 s43, 114688
buffer_load_dwordx4 v[144:147], v28, s[84:87], s43 offen
s_mov_b32 s43, 143360
buffer_load_dwordx4 v[148:151], v28, s[84:87], s43 offen
s_mov_b32 s43, 172032
buffer_load_dwordx4 v[152:155], v28, s[84:87], s43 offen
s_mov_b32 s43, 200704
buffer_load_dwordx4 v[156:159], v28, s[84:87], s43 offen
s_mov_b32 s43, 229376
buffer_load_dwordx4 v[160:163], v28, s[84:87], s43 offen
s_mov_b32 s43, 258048
buffer_load_dwordx4 v[164:167], v28, s[84:87], s43 offen
s_mov_b32 s43, 286720
buffer_load_dwordx4 v[168:171], v28, s[84:87], s43 offen
s_mov_b32 s43, 315392
buffer_load_dwordx4 v[172:175], v28, s[84:87], s43 offen
s_mov_b32 s43, 344064
buffer_load_dwordx4 v[176:179], v28, s[84:87], s43 offen
s_mov_b32 s43, 372736
buffer_load_dwordx4 v[180:183], v28, s[84:87], s43 offen
s_mov_b32 s43, 401408
buffer_load_dwordx4 v[184:187], v28, s[84:87], s43 offen
s_mov_b32 s43, 430080
buffer_load_dwordx4 v[188:191], v28, s[84:87], s43 offen
Lnj_21:
s_barrier
s_lshr_b32 s43, s2, 5
s_cmp_eq_u32 s43, 3
s_cbranch_scc1 Lnj_22
s_cmp_gt_u32 s43, 3
s_cselect_b32 s43, 32, 0
s_sub_u32 s43, s2, s43
s_lshr_b32 s43, s43, 1
s_and_b32 s44, s2, 1
s_lshl_b32 s45, s44, 3
s_add_u32 s45, s45, 32
s_load_dwordx2 s[88:89], s[0:1], s45
s_mul_i32 s45, s43, 2341
s_lshr_b32 s45, s45, 16
s_mul_i32 s46, s45, 28
s_sub_u32 s46, s43, s46
v_lshrrev_b32 v28, 4, v1
s_lshl_b32 s43, s45, 8
v_add_u32 v28, s43, v28
v_mul_u32_u24 v28, 7168, v28
v_and_b32 v29, 15, v1
v_lshl_add_u32 v28, v29, 4, v28
s_lshl_b32 s43, s46, 8
v_add_u32 v28, s43, v28
s_waitcnt lgkmcnt(0)
s_mov_b32 s84, s88
s_mov_b32 s85, s89
s_mov_b32 s86, 7340032
s_mov_b32 s87, 0x20000
s_mov_b32 s43, 458752
buffer_load_dwordx4 v[192:195], v28, s[84:87], s43 offen
s_mov_b32 s43, 487424
buffer_load_dwordx4 v[196:199], v28, s[84:87], s43 offen
s_mov_b32 s43, 516096
buffer_load_dwordx4 v[200:203], v28, s[84:87], s43 offen
s_mov_b32 s43, 544768
buffer_load_dwordx4 v[204:207], v28, s[84:87], s43 offen
s_mov_b32 s43, 573440
buffer_load_dwordx4 v[208:211], v28, s[84:87], s43 offen
s_mov_b32 s43, 602112
buffer_load_dwordx4 v[212:215], v28, s[84:87], s43 offen
s_mov_b32 s43, 630784
buffer_load_dwordx4 v[216:219], v28, s[84:87], s43 offen
s_mov_b32 s43, 659456
buffer_load_dwordx4 v[220:223], v28, s[84:87], s43 offen
s_mov_b32 s43, 688128
buffer_load_dwordx4 v[224:227], v28, s[84:87], s43 offen
s_mov_b32 s43, 716800
buffer_load_dwordx4 v[228:231], v28, s[84:87], s43 offen
s_mov_b32 s43, 745472
buffer_load_dwordx4 v[232:235], v28, s[84:87], s43 offen
s_mov_b32 s43, 774144
buffer_load_dwordx4 v[236:239], v28, s[84:87], s43 offen
s_mov_b32 s43, 802816
buffer_load_dwordx4 v[240:243], v28, s[84:87], s43 offen
s_mov_b32 s43, 831488
buffer_load_dwordx4 v[244:247], v28, s[84:87], s43 offen
s_mov_b32 s43, 860160
buffer_load_dwordx4 v[248:251], v28, s[84:87], s43 offen
s_mov_b32 s43, 888832
buffer_load_dwordx4 v[252:255], v28, s[84:87], s43 offen
Lnj_22:
s_barrier
s_waitcnt lgkmcnt(0)
s_and_b32 s43, s36, 1
s_lshr_b32 s44, s36, 1
s_and_b32 s44, s44, 1
s_lshr_b32 s45, s36, 2
v_lshlrev_b32 v14, 2, v13
v_sub_u32 v14, v12, v14
v_subrev_u32 v15, 0, v14
v_cmp_ge_u32 s[52:53], 7, v15
v_add_u32 v15, 16, v15
v_cmp_ge_u32 s[84:85], 7, v15
v_subrev_u32 v15, 1, v14
v_cmp_ge_u32 s[54:55], 7, v15
v_add_u32 v15, 16, v15
v_cmp_ge_u32 s[86:87], 7, v15
v_subrev_u32 v15, 2, v14
v_cmp_ge_u32 s[56:57], 7, v15
v_add_u32 v15, 16, v15
v_cmp_ge_u32 s[88:89], 7, v15
v_subrev_u32 v15, 3, v14
v_cmp_ge_u32 s[58:59], 7, v15
v_add_u32 v15, 16, v15
v_cmp_ge_u32 s[90:91], 7, v15
s_lshl_b32 s46, s45, 6
s_add_u32 s46, s46, s44
s_add_u32 s46, s46, 16
v_lshl_add_u32 v14, v12, 1, s46
s_lshl_b32 s47, s43, 6
v_lshl_add_u32 v15, v13, 4, s47
v_mul_u32_u24 v20, 400, v14
v_add_u32 v20, v20, v15
v_subrev_u32 v16, 32, v14
v_max_i32 v16, 0, v16
v_mul_u32_u24 v21, 400, v16
v_add_u32 v21, v21, v15
v_lshrrev_b32 v16, 2, v12
v_lshl_add_u32 v16, v13, 2, v16
v_lshl_add_u32 v16, v16, 1, s46
v_and_b32 v17, 3, v1
v_lshl_add_u32 v17, v17, 3, s47
v_mul_u32_u24 v22, 400, v16
v_add_u32 v22, v22, v17
v_subrev_u32 v16, 32, v16
v_max_i32 v16, 0, v16
v_mul_u32_u24 v23, 400, v16
v_add_u32 v23, v23, v17
s_lshl_b32 s60, s43, 13
s_lshl_b32 s61, s45, 10
s_add_u32 s60, s60, s61
s_lshl_b32 s61, s44, 8
s_add_u32 s60, s60, s61
v_lshlrev_b32 v27, 11, v13
v_lshl_add_u32 v27, v12, 4, v27
v_add_u32 v27, s60, v27
v_mov_b32 v28, 0xff800000
s_mov_b32 s61, 0x3e8293ee
s_nop 2
s_or_b32 s62, s34, s45
s_cmp_lg_u32 s62, 0
s_cselect_b64 s[64:65], s[84:85], 0
s_cselect_b64 s[66:67], s[86:87], 0
s_cselect_b64 s[68:69], s[88:89], 0
s_cselect_b64 s[70:71], s[90:91], 0
Latt_4:
s_barrier
ds_read_b128 v[32:35], v20 offset:0
ds_read_b128 v[36:39], v20 offset:128
ds_read_b128 v[40:43], v21 offset:128
ds_read_b128 v[80:83], v20 offset:12800
ds_read_b128 v[84:87], v20 offset:12928
ds_read_b128 v[88:91], v20 offset:128
ds_read_b64_tr_b16 v[44:45], v23 offset:256
ds_read_b64_tr_b16 v[46:47], v22 offset:256
ds_read_b64_tr_b16 v[48:49], v23 offset:288
ds_read_b64_tr_b16 v[50:51], v22 offset:288
ds_read_b64_tr_b16 v[92:93], v22 offset:256
ds_read_b64_tr_b16 v[94:95], v22 offset:13056
ds_read_b64_tr_b16 v[96:97], v22 offset:288
ds_read_b64_tr_b16 v[98:99], v22 offset:13088
s_waitcnt lgkmcnt(11)
v_mfma_f32_16x16x32_bf16 v[52:55], v[40:43], v[32:35], 0
v_mfma_f32_16x16x32_bf16 v[56:59], v[36:39], v[32:35], 0
s_waitcnt lgkmcnt(8)
v_mfma_f32_16x16x32_bf16 v[100:103], v[88:91], v[80:83], 0
v_mfma_f32_16x16x32_bf16 v[104:107], v[84:87], v[80:83], 0
s_nop 7
v_cndmask_b32 v52, v28, v52, s[64:65]
v_cndmask_b32 v100, v28, v100, s[84:85]
v_cndmask_b32 v53, v28, v53, s[66:67]
v_cndmask_b32 v101, v28, v101, s[86:87]
v_cndmask_b32 v54, v28, v54, s[68:69]
v_cndmask_b32 v102, v28, v102, s[88:89]
v_cndmask_b32 v55, v28, v55, s[70:71]
v_cndmask_b32 v103, v28, v103, s[90:91]
v_cndmask_b32 v56, v28, v56, s[52:53]
v_cndmask_b32 v104, v28, v104, s[52:53]
v_cndmask_b32 v57, v28, v57, s[54:55]
v_cndmask_b32 v105, v28, v105, s[54:55]
v_cndmask_b32 v58, v28, v58, s[56:57]
v_cndmask_b32 v106, v28, v106, s[56:57]
v_cndmask_b32 v59, v28, v59, s[58:59]
v_cndmask_b32 v107, v28, v107, s[58:59]
v_max3_f32 v60, v52, v53, v54
v_max3_f32 v108, v100, v101, v102
v_max3_f32 v61, v55, v56, v57
v_max3_f32 v109, v103, v104, v105
v_max3_f32 v60, v60, v58, v59
v_max3_f32 v108, v108, v106, v107
v_max_f32 v60, v60, v61
v_max_f32 v108, v108, v109
v_mov_b32 v61, v60
v_mov_b32 v109, v108
s_nop 0
v_permlane32_swap_b32 v60, v61
v_permlane32_swap_b32 v108, v109
v_max_f32 v60, v60, v61
v_max_f32 v108, v108, v109
v_mov_b32 v61, v60
v_mov_b32 v109, v108
s_nop 0
v_permlane16_swap_b32 v60, v61
v_permlane16_swap_b32 v108, v109
v_max_f32 v60, v60, v61
v_max_f32 v108, v108, v109
v_mul_f32 v60, s61, v60
v_mul_f32 v108, s61, v108
v_fma_f32 v52, v52, s61, -v60
v_fma_f32 v100, v100, s61, -v108
v_fma_f32 v53, v53, s61, -v60
v_fma_f32 v101, v101, s61, -v108
v_fma_f32 v54, v54, s61, -v60
v_fma_f32 v102, v102, s61, -v108
v_fma_f32 v55, v55, s61, -v60
v_fma_f32 v103, v103, s61, -v108
v_fma_f32 v56, v56, s61, -v60
v_fma_f32 v104, v104, s61, -v108
v_fma_f32 v57, v57, s61, -v60
v_fma_f32 v105, v105, s61, -v108
v_fma_f32 v58, v58, s61, -v60
v_fma_f32 v106, v106, s61, -v108
v_fma_f32 v59, v59, s61, -v60
v_fma_f32 v107, v107, s61, -v108
v_exp_f32 v52, v52
v_exp_f32 v100, v100
v_exp_f32 v53, v53
v_exp_f32 v101, v101
v_exp_f32 v54, v54
v_exp_f32 v102, v102
v_exp_f32 v55, v55
v_exp_f32 v103, v103
v_exp_f32 v56, v56
v_exp_f32 v104, v104
v_exp_f32 v57, v57
v_exp_f32 v105, v105
v_exp_f32 v58, v58
v_exp_f32 v106, v106
v_exp_f32 v59, v59
v_exp_f32 v107, v107
v_cvt_pk_bf16_f32 v64, v52, v53
v_cvt_pk_bf16_f32 v112, v100, v101
v_cvt_pk_bf16_f32 v65, v54, v55
v_cvt_pk_bf16_f32 v113, v102, v103
v_cvt_pk_bf16_f32 v66, v56, v57
v_cvt_pk_bf16_f32 v114, v104, v105
v_cvt_pk_bf16_f32 v67, v58, v59
v_cvt_pk_bf16_f32 v115, v106, v107
s_waitcnt lgkmcnt(0)
v_mfma_f32_16x16x32_bf16 v[68:71], v[44:47], v[64:67], 0
v_mfma_f32_16x16x32_bf16 v[72:75], v[48:51], v[64:67], 0
v_mfma_f32_16x16x32_bf16 v[116:119], v[92:95], v[112:115], 0
v_mfma_f32_16x16x32_bf16 v[120:123], v[96:99], v[112:115], 0
v_add_f32 v60, v52, v53
v_add_f32 v108, v100, v101
v_add_f32 v61, v54, v55
v_add_f32 v109, v102, v103
v_add_f32 v56, v56, v57
v_add_f32 v104, v104, v105
v_add_f32 v58, v58, v59
v_add_f32 v106, v106, v107
v_add_f32 v60, v60, v61
v_add_f32 v108, v108, v109
v_add_f32 v56, v56, v58
v_add_f32 v104, v104, v106
v_add_f32 v60, v60, v56
v_add_f32 v108, v108, v104
v_mov_b32 v61, v60
v_mov_b32 v109, v108
s_nop 0
v_permlane32_swap_b32 v60, v61
v_permlane32_swap_b32 v108, v109
v_add_f32 v60, v60, v61
v_add_f32 v108, v108, v109
v_mov_b32 v61, v60
v_mov_b32 v109, v108
s_nop 0
v_permlane16_swap_b32 v60, v61
v_permlane16_swap_b32 v108, v109
v_add_f32 v60, v60, v61
v_add_f32 v108, v108, v109
v_rcp_f32 v60, v60
v_rcp_f32 v108, v108
s_nop 0
v_pk_mul_f32 v[68:69], v[60:61], v[68:69] op_sel_hi:[0,1]
v_pk_mul_f32 v[70:71], v[60:61], v[70:71] op_sel_hi:[0,1]
v_pk_mul_f32 v[72:73], v[60:61], v[72:73] op_sel_hi:[0,1]
v_pk_mul_f32 v[74:75], v[60:61], v[74:75] op_sel_hi:[0,1]
v_cvt_pk_bf16_f32 v68, v68, v69
v_cvt_pk_bf16_f32 v69, v70, v71
v_cvt_pk_bf16_f32 v70, v72, v73
v_cvt_pk_bf16_f32 v71, v74, v75
buffer_store_dwordx4 v[68:71], v27, s[16:19], 0 offen offset:0 sc1
v_pk_mul_f32 v[116:117], v[108:109], v[116:117] op_sel_hi:[0,1]
v_pk_mul_f32 v[118:119], v[108:109], v[118:119] op_sel_hi:[0,1]
v_pk_mul_f32 v[120:121], v[108:109], v[120:121] op_sel_hi:[0,1]
v_pk_mul_f32 v[122:123], v[108:109], v[122:123] op_sel_hi:[0,1]
v_cvt_pk_bf16_f32 v116, v116, v117
v_cvt_pk_bf16_f32 v117, v118, v119
v_cvt_pk_bf16_f32 v118, v120, v121
v_cvt_pk_bf16_f32 v119, v122, v123
buffer_store_dwordx4 v[116:119], v27, s[16:19], 0 offen offset:512 sc1
s_waitcnt vmcnt(0)
s_barrier
ds_write_b128 v27, v[68:71] offset:0
ds_write_b128 v27, v[116:119] offset:512
s_add_u32 s56, s32, 28311552
s_addc_u32 s57, s33, 0
s_mov_b32 s58, 32768
s_mov_b32 s59, 0x20000
s_cmp_lg_u32 s36, 0
s_cbranch_scc1 Lsig_23
s_add_u32 s43, s34, 0
s_lshl_b32 s43, s43, 7
v_mov_b32 v5, s43
v_mov_b32 v6, 1
s_mov_b64 exec, 1
buffer_atomic_add v6, v5, s[56:59], 0 offen sc1
s_mov_b64 exec, -1
Lsig_23:
s_load_dwordx4 s[4:7], s[0:1], 32
s_load_dwordx2 s[28:29], s[0:1], 16
s_load_dwordx4 s[60:63], s[0:1], 48
s_load_dwordx2 s[30:31], s[0:1], 0
v_and_b32 v17, 15, v1
v_lshrrev_b32 v18, 4, v1
s_lshr_b32 s46, s36, 1
s_and_b32 s46, s46, 1
s_and_b32 s47, s36, 1
s_and_b32 s51, s36, 3
s_bfe_u32 s49, s35, 0x20001
s_lshl_b32 s49, s49, 2
s_lshr_b32 s43, s35, 3
s_lshl_b32 s43, s43, 1
s_add_u32 s49, s49, s43
s_and_b32 s43, s35, 1
s_add_u32 s49, s49, s43
s_waitcnt lgkmcnt(0)
s_cmp_ge_u32 s36, 4
s_cbranch_scc1 LG1_24
s_lshl_b32 s43, s34, 18
s_lshl_b32 s44, s35, 7
s_add_u32 s43, s43, s44
s_add_u32 s16, s30, s43
s_addc_u32 s17, s31, 0
s_mov_b32 s18, 260224
s_mov_b32 s19, 0x20000
s_lshl_b32 s43, s36, 5
v_lshl_add_u32 v19, v17, 1, s43
v_lshlrev_b32 v19, 11, v19
v_and_b32 v20, 1, v18
v_lshl_add_u32 v19, v20, 5, v19
v_lshrrev_b32 v20, 1, v18
v_lshl_add_u32 v23, v20, 4, v19
buffer_load_dwordx4 v[160:163], v23, s[16:19], 0 offen offset:0
buffer_load_dwordx4 v[164:167], v23, s[16:19], 0 offen offset:64
buffer_load_dwordx4 v[168:171], v23, s[16:19], 0 offen offset:2048
buffer_load_dwordx4 v[172:175], v23, s[16:19], 0 offen offset:2112
v_lshlrev_b32 v19, 11, v18
v_lshl_add_u32 v19, v17, 4, v19
s_lshl_b32 s43, s36, 9
v_add_u32 v2, s43, v19
v_add_u32 v4, 98304, v2
v_lshrrev_b32 v19, 2, v17
v_lshl_add_u32 v20, v18, 2, v19
v_bfe_u32 v21, v20, 1, 2
v_lshlrev_b32 v20, 7, v20
v_lshl_add_u32 v20, v21, 5, v20
v_and_b32 v19, 3, v1
v_lshl_add_u32 v20, v19, 3, v20
v_add_u32 v5, 0x10000, v20
v_xor_b32 v6, 32, v5
v_xor_b32 v7, 64, v5
v_xor_b32 v8, 96, v5
v_add_u32 v9, 0x10000, v5
v_add_u32 v10, 0x10000, v6
v_add_u32 v11, 0x10000, v7
v_add_u32 v12, 0x10000, v8
s_lshl_b32 s43, s34, 18
s_lshl_b32 s44, s35, 14
s_add_u32 s43, s43, s44
s_add_u32 s20, s32, s43
s_addc_u32 s21, s33, 0
s_add_u32 s20, s20, 4194304
s_addc_u32 s21, s21, 0
s_mov_b32 s22, 16384
s_mov_b32 s23, 0x20000
s_lshl_b32 s43, s34, 14
s_lshl_b32 s44, s35, 10
s_add_u32 s43, s43, s44
s_add_u32 s24, s32, s43
s_addc_u32 s25, s33, 0
s_add_u32 s24, s24, 25165824
s_addc_u32 s25, s25, 0
s_mov_b32 s26, 1024
s_mov_b32 s27, 0x20000
s_movk_i32 s50, 0x2000
v_lshrrev_b32 v19, 1, v18
v_lshl_add_u32 v19, v19, 4, v17
s_lshl_b32 s43, s36, 5
v_add_u32 v19, s43, v19
v_and_b32 v20, 1, v18
v_lshlrev_b32 v20, 2, v20
v_lshl_add_u32 v22, v19, 3, v20
s_waitcnt vmcnt(0)
v_permlane16_swap_b32 v160, v162
v_permlane16_swap_b32 v161, v163
v_permlane16_swap_b32 v164, v166
v_permlane16_swap_b32 v165, v167
v_permlane16_swap_b32 v168, v170
v_permlane16_swap_b32 v169, v171
v_permlane16_swap_b32 v172, v174
v_permlane16_swap_b32 v173, v175
v_lshlrev_b32 v128, 16, v160
v_and_b32 v129, 0xffff0000, v160
v_lshlrev_b32 v130, 16, v161
v_and_b32 v131, 0xffff0000, v161
v_lshlrev_b32 v132, 16, v162
v_and_b32 v133, 0xffff0000, v162
v_lshlrev_b32 v134, 16, v163
v_and_b32 v135, 0xffff0000, v163
v_lshlrev_b32 v136, 16, v164
v_and_b32 v137, 0xffff0000, v164
v_lshlrev_b32 v138, 16, v165
v_and_b32 v139, 0xffff0000, v165
v_lshlrev_b32 v140, 16, v166
v_and_b32 v141, 0xffff0000, v166
v_lshlrev_b32 v142, 16, v167
v_and_b32 v143, 0xffff0000, v167
v_lshlrev_b32 v144, 16, v168
v_and_b32 v145, 0xffff0000, v168
v_lshlrev_b32 v146, 16, v169
v_and_b32 v147, 0xffff0000, v169
v_lshlrev_b32 v148, 16, v170
v_and_b32 v149, 0xffff0000, v170
v_lshlrev_b32 v150, 16, v171
v_and_b32 v151, 0xffff0000, v171
v_lshlrev_b32 v152, 16, v172
v_and_b32 v153, 0xffff0000, v172
v_lshlrev_b32 v154, 16, v173
v_and_b32 v155, 0xffff0000, v173
v_lshlrev_b32 v156, 16, v174
v_and_b32 v157, 0xffff0000, v174
v_lshlrev_b32 v158, 16, v175
v_and_b32 v159, 0xffff0000, v175
s_lshl_b32 s43, s34, 18
s_add_u32 s12, s32, s43
s_addc_u32 s13, s33, 0
s_mov_b32 s14, 262144
s_mov_b32 s15, 0x20000
v_lshlrev_b32 v21, 4, v1
s_lshl_b32 s54, s36, 11
s_add_u32 s43, s35, 1
s_and_b32 s43, s43, 15
s_lshl_b32 s43, s43, 14
s_add_u32 s30, s43, s54
s_add_u32 s43, s35, 2
s_and_b32 s43, s43, 15
s_lshl_b32 s43, s43, 14
s_add_u32 s31, s43, s54
s_waitcnt lgkmcnt(0)
s_barrier
ds_read_b128 v[32:35], v2 offset:0
ds_read_b64_tr_b16 v[48:49], v5 offset:0
ds_read_b64_tr_b16 v[50:51], v5 offset:2048
ds_read_b64_tr_b16 v[52:53], v6 offset:0
ds_read_b64_tr_b16 v[54:55], v6 offset:2048
ds_read_b128 v[36:39], v2 offset:256
ds_read_b64_tr_b16 v[56:57], v7 offset:0
ds_read_b64_tr_b16 v[58:59], v7 offset:2048
ds_read_b64_tr_b16 v[60:61], v8 offset:0
ds_read_b64_tr_b16 v[62:63], v8 offset:2048
ds_read_b128 v[40:43], v2 offset:8192
ds_read_b64_tr_b16 v[64:65], v5 offset:4096
ds_read_b64_tr_b16 v[66:67], v5 offset:6144
ds_read_b64_tr_b16 v[68:69], v6 offset:4096
ds_read_b64_tr_b16 v[70:71], v6 offset:6144
ds_read_b128 v[44:47], v2 offset:8448
ds_read_b64_tr_b16 v[72:73], v7 offset:4096
ds_read_b64_tr_b16 v[74:75], v7 offset:6144
ds_read_b64_tr_b16 v[76:77], v8 offset:4096
ds_read_b64_tr_b16 v[78:79], v8 offset:6144
s_waitcnt lgkmcnt(0)
v_mfma_f32_16x16x32_bf16 v[128:131], v[48:51], v[32:35], v[128:131]
v_mfma_f32_16x16x32_bf16 v[132:135], v[52:55], v[32:35], v[132:135]
v_mfma_f32_16x16x32_bf16 v[136:139], v[56:59], v[32:35], v[136:139]
v_mfma_f32_16x16x32_bf16 v[140:143], v[60:63], v[32:35], v[140:143]
v_mfma_f32_16x16x32_bf16 v[144:147], v[48:51], v[36:39], v[144:147]
v_mfma_f32_16x16x32_bf16 v[148:151], v[52:55], v[36:39], v[148:151]
v_mfma_f32_16x16x32_bf16 v[152:155], v[56:59], v[36:39], v[152:155]
v_mfma_f32_16x16x32_bf16 v[156:159], v[60:63], v[36:39], v[156:159]
v_mfma_f32_16x16x32_bf16 v[128:131], v[64:67], v[40:43], v[128:131]
v_mfma_f32_16x16x32_bf16 v[132:135], v[68:71], v[40:43], v[132:135]
v_mfma_f32_16x16x32_bf16 v[136:139], v[72:75], v[40:43], v[136:139]
v_mfma_f32_16x16x32_bf16 v[140:143], v[76:79], v[40:43], v[140:143]
v_mfma_f32_16x16x32_bf16 v[144:147], v[64:67], v[44:47], v[144:147]
v_mfma_f32_16x16x32_bf16 v[148:151], v[68:71], v[44:47], v[148:151]
v_mfma_f32_16x16x32_bf16 v[152:155], v[72:75], v[44:47], v[152:155]
v_mfma_f32_16x16x32_bf16 v[156:159], v[76:79], v[44:47], v[156:159]
s_barrier
s_add_u32 m0, s54, 16384
s_add_u32 s43, s30, 0
buffer_load_dwordx4 v21, s[12:15], s43 offen sc1 lds
s_add_u32 m0, s54, 17408
s_add_u32 s43, s30, 1024
buffer_load_dwordx4 v21, s[12:15], s43 offen sc1 lds
s_add_u32 m0, s54, 32768
s_add_u32 s43, s31, 0
buffer_load_dwordx4 v21, s[12:15], s43 offen sc1 lds
s_add_u32 m0, s54, 33792
s_add_u32 s43, s31, 1024
buffer_load_dwordx4 v21, s[12:15], s43 offen sc1 lds
s_waitcnt vmcnt(2)
s_barrier
ds_read_b128 v[80:83], v2 offset:16384
ds_read_b64_tr_b16 v[96:97], v5 offset:8192
ds_read_b64_tr_b16 v[98:99], v5 offset:10240
ds_read_b64_tr_b16 v[100:101], v6 offset:8192
ds_read_b64_tr_b16 v[102:103], v6 offset:10240
ds_read_b128 v[84:87], v2 offset:16640
ds_read_b64_tr_b16 v[104:105], v7 offset:8192
ds_read_b64_tr_b16 v[106:107], v7 offset:10240
ds_read_b64_tr_b16 v[108:109], v8 offset:8192
ds_read_b64_tr_b16 v[110:111], v8 offset:10240
ds_read_b128 v[88:91], v2 offset:24576
ds_read_b64_tr_b16 v[112:113], v5 offset:12288
ds_read_b64_tr_b16 v[114:115], v5 offset:14336
ds_read_b64_tr_b16 v[116:117], v6 offset:12288
ds_read_b64_tr_b16 v[118:119], v6 offset:14336
ds_read_b128 v[92:95], v2 offset:24832
ds_read_b64_tr_b16 v[120:121], v7 offset:12288
ds_read_b64_tr_b16 v[122:123], v7 offset:14336
ds_read_b64_tr_b16 v[124:125], v8 offset:12288
ds_read_b64_tr_b16 v[126:127], v8 offset:14336
s_waitcnt vmcnt(0) lgkmcnt(0)
s_barrier
v_mfma_f32_16x16x32_bf16 v[128:131], v[96:99], v[80:83], v[128:131]
ds_read_b128 v[32:35], v2 offset:32768
ds_read_b64_tr_b16 v[48:49], v5 offset:16384
v_mfma_f32_16x16x32_bf16 v[132:135], v[100:103], v[80:83], v[132:135]
ds_read_b64_tr_b16 v[50:51], v5 offset:18432
v_mfma_f32_16x16x32_bf16 v[136:139], v[104:107], v[80:83], v[136:139]
ds_read_b64_tr_b16 v[52:53], v6 offset:16384
v_mfma_f32_16x16x32_bf16 v[140:143], v[108:111], v[80:83], v[140:143]
ds_read_b64_tr_b16 v[54:55], v6 offset:18432
v_mfma_f32_16x16x32_bf16 v[144:147], v[96:99], v[84:87], v[144:147]
ds_read_b128 v[36:39], v2 offset:33024
ds_read_b64_tr_b16 v[56:57], v7 offset:16384
v_mfma_f32_16x16x32_bf16 v[148:151], v[100:103], v[84:87], v[148:151]
ds_read_b64_tr_b16 v[58:59], v7 offset:18432
v_mfma_f32_16x16x32_bf16 v[152:155], v[104:107], v[84:87], v[152:155]
ds_read_b64_tr_b16 v[60:61], v8 offset:16384
v_mfma_f32_16x16x32_bf16 v[156:159], v[108:111], v[84:87], v[156:159]
ds_read_b64_tr_b16 v[62:63], v8 offset:18432
v_mfma_f32_16x16x32_bf16 v[128:131], v[112:115], v[88:91], v[128:131]
ds_read_b128 v[40:43], v2 offset:40960
ds_read_b64_tr_b16 v[64:65], v5 offset:20480
v_mfma_f32_16x16x32_bf16 v[132:135], v[116:119], v[88:91], v[132:135]
ds_read_b64_tr_b16 v[66:67], v5 offset:22528
v_mfma_f32_16x16x32_bf16 v[136:139], v[120:123], v[88:91], v[136:139]
ds_read_b64_tr_b16 v[68:69], v6 offset:20480
v_mfma_f32_16x16x32_bf16 v[140:143], v[124:127], v[88:91], v[140:143]
ds_read_b64_tr_b16 v[70:71], v6 offset:22528
v_mfma_f32_16x16x32_bf16 v[144:147], v[112:115], v[92:95], v[144:147]
ds_read_b128 v[44:47], v2 offset:41216
ds_read_b64_tr_b16 v[72:73], v7 offset:20480
v_mfma_f32_16x16x32_bf16 v[148:151], v[116:119], v[92:95], v[148:151]
ds_read_b64_tr_b16 v[74:75], v7 offset:22528
v_mfma_f32_16x16x32_bf16 v[152:155], v[120:123], v[92:95], v[152:155]
ds_read_b64_tr_b16 v[76:77], v8 offset:20480
v_mfma_f32_16x16x32_bf16 v[156:159], v[124:127], v[92:95], v[156:159]
ds_read_b64_tr_b16 v[78:79], v8 offset:22528
s_waitcnt lgkmcnt(0)
s_barrier
v_mfma_f32_16x16x32_bf16 v[128:131], v[48:51], v[32:35], v[128:131]
ds_read_b128 v[80:83], v2 offset:49152
ds_read_b64_tr_b16 v[96:97], v5 offset:24576
v_mfma_f32_16x16x32_bf16 v[132:135], v[52:55], v[32:35], v[132:135]
ds_read_b64_tr_b16 v[98:99], v5 offset:26624
v_mfma_f32_16x16x32_bf16 v[136:139], v[56:59], v[32:35], v[136:139]
ds_read_b64_tr_b16 v[100:101], v6 offset:24576
v_mfma_f32_16x16x32_bf16 v[140:143], v[60:63], v[32:35], v[140:143]
ds_read_b64_tr_b16 v[102:103], v6 offset:26624
v_mfma_f32_16x16x32_bf16 v[144:147], v[48:51], v[36:39], v[144:147]
ds_read_b128 v[84:87], v2 offset:49408
ds_read_b64_tr_b16 v[104:105], v7 offset:24576
v_mfma_f32_16x16x32_bf16 v[148:151], v[52:55], v[36:39], v[148:151]
ds_read_b64_tr_b16 v[106:107], v7 offset:26624
v_mfma_f32_16x16x32_bf16 v[152:155], v[56:59], v[36:39], v[152:155]
ds_read_b64_tr_b16 v[108:109], v8 offset:24576
v_mfma_f32_16x16x32_bf16 v[156:159], v[60:63], v[36:39], v[156:159]
ds_read_b64_tr_b16 v[110:111], v8 offset:26624
v_mfma_f32_16x16x32_bf16 v[128:131], v[64:67], v[40:43], v[128:131]
ds_read_b128 v[88:91], v2 offset:57344
ds_read_b64_tr_b16 v[112:113], v5 offset:28672
v_mfma_f32_16x16x32_bf16 v[132:135], v[68:71], v[40:43], v[132:135]
ds_read_b64_tr_b16 v[114:115], v5 offset:30720
v_mfma_f32_16x16x32_bf16 v[136:139], v[72:75], v[40:43], v[136:139]
ds_read_b64_tr_b16 v[116:117], v6 offset:28672
v_mfma_f32_16x16x32_bf16 v[140:143], v[76:79], v[40:43], v[140:143]
ds_read_b64_tr_b16 v[118:119], v6 offset:30720
v_mfma_f32_16x16x32_bf16 v[144:147], v[64:67], v[44:47], v[144:147]
ds_read_b128 v[92:95], v2 offset:57600
ds_read_b64_tr_b16 v[120:121], v7 offset:28672
v_mfma_f32_16x16x32_bf16 v[148:151], v[68:71], v[44:47], v[148:151]
ds_read_b64_tr_b16 v[122:123], v7 offset:30720
v_mfma_f32_16x16x32_bf16 v[152:155], v[72:75], v[44:47], v[152:155]
ds_read_b64_tr_b16 v[124:125], v8 offset:28672
v_mfma_f32_16x16x32_bf16 v[156:159], v[76:79], v[44:47], v[156:159]
ds_read_b64_tr_b16 v[126:127], v8 offset:30720
s_waitcnt lgkmcnt(0)
s_barrier
v_mfma_f32_16x16x32_bf16 v[128:131], v[96:99], v[80:83], v[128:131]
ds_read_b128 v[32:35], v2 offset:0
ds_read_b64_tr_b16 v[48:49], v5 offset:32768
v_mfma_f32_16x16x32_bf16 v[132:135], v[100:103], v[80:83], v[132:135]
ds_read_b64_tr_b16 v[50:51], v5 offset:34816
v_mfma_f32_16x16x32_bf16 v[136:139], v[104:107], v[80:83], v[136:139]
ds_read_b64_tr_b16 v[52:53], v6 offset:32768
v_mfma_f32_16x16x32_bf16 v[140:143], v[108:111], v[80:83], v[140:143]
ds_read_b64_tr_b16 v[54:55], v6 offset:34816
v_mfma_f32_16x16x32_bf16 v[144:147], v[96:99], v[84:87], v[144:147]
ds_read_b128 v[36:39], v2 offset:256
ds_read_b64_tr_b16 v[56:57], v7 offset:32768
v_mfma_f32_16x16x32_bf16 v[148:151], v[100:103], v[84:87], v[148:151]
ds_read_b64_tr_b16 v[58:59], v7 offset:34816
v_mfma_f32_16x16x32_bf16 v[152:155], v[104:107], v[84:87], v[152:155]
ds_read_b64_tr_b16 v[60:61], v8 offset:32768
v_mfma_f32_16x16x32_bf16 v[156:159], v[108:111], v[84:87], v[156:159]
ds_read_b64_tr_b16 v[62:63], v8 offset:34816
v_mfma_f32_16x16x32_bf16 v[128:131], v[112:115], v[88:91], v[128:131]
ds_read_b128 v[40:43], v2 offset:8192
ds_read_b64_tr_b16 v[64:65], v5 offset:36864
v_mfma_f32_16x16x32_bf16 v[132:135], v[116:119], v[88:91], v[132:135]
ds_read_b64_tr_b16 v[66:67], v5 offset:38912
v_mfma_f32_16x16x32_bf16 v[136:139], v[120:123], v[88:91], v[136:139]
ds_read_b64_tr_b16 v[68:69], v6 offset:36864
v_mfma_f32_16x16x32_bf16 v[140:143], v[124:127], v[88:91], v[140:143]
ds_read_b64_tr_b16 v[70:71], v6 offset:38912
v_mfma_f32_16x16x32_bf16 v[144:147], v[112:115], v[92:95], v[144:147]
ds_read_b128 v[44:47], v2 offset:8448
ds_read_b64_tr_b16 v[72:73], v7 offset:36864
v_mfma_f32_16x16x32_bf16 v[148:151], v[116:119], v[92:95], v[148:151]
ds_read_b64_tr_b16 v[74:75], v7 offset:38912
v_mfma_f32_16x16x32_bf16 v[152:155], v[120:123], v[92:95], v[152:155]
ds_read_b64_tr_b16 v[76:77], v8 offset:36864
v_mfma_f32_16x16x32_bf16 v[156:159], v[124:127], v[92:95], v[156:159]
ds_read_b64_tr_b16 v[78:79], v8 offset:38912
s_waitcnt lgkmcnt(0)
s_barrier
v_mfma_f32_16x16x32_bf16 v[128:131], v[48:51], v[32:35], v[128:131]
ds_read_b128 v[80:83], v2 offset:16384
ds_read_b64_tr_b16 v[96:97], v5 offset:40960
v_mfma_f32_16x16x32_bf16 v[132:135], v[52:55], v[32:35], v[132:135]
ds_read_b64_tr_b16 v[98:99], v5 offset:43008
v_mfma_f32_16x16x32_bf16 v[136:139], v[56:59], v[32:35], v[136:139]
ds_read_b64_tr_b16 v[100:101], v6 offset:40960
v_mfma_f32_16x16x32_bf16 v[140:143], v[60:63], v[32:35], v[140:143]
ds_read_b64_tr_b16 v[102:103], v6 offset:43008
v_mfma_f32_16x16x32_bf16 v[144:147], v[48:51], v[36:39], v[144:147]
ds_read_b128 v[84:87], v2 offset:16640
ds_read_b64_tr_b16 v[104:105], v7 offset:40960
v_mfma_f32_16x16x32_bf16 v[148:151], v[52:55], v[36:39], v[148:151]
ds_read_b64_tr_b16 v[106:107], v7 offset:43008
v_mfma_f32_16x16x32_bf16 v[152:155], v[56:59], v[36:39], v[152:155]
ds_read_b64_tr_b16 v[108:109], v8 offset:40960
v_mfma_f32_16x16x32_bf16 v[156:159], v[60:63], v[36:39], v[156:159]
ds_read_b64_tr_b16 v[110:111], v8 offset:43008
v_mfma_f32_16x16x32_bf16 v[128:131], v[64:67], v[40:43], v[128:131]
ds_read_b128 v[88:91], v2 offset:24576
ds_read_b64_tr_b16 v[112:113], v5 offset:45056
v_mfma_f32_16x16x32_bf16 v[132:135], v[68:71], v[40:43], v[132:135]
ds_read_b64_tr_b16 v[114:115], v5 offset:47104
v_mfma_f32_16x16x32_bf16 v[136:139], v[72:75], v[40:43], v[136:139]
ds_read_b64_tr_b16 v[116:117], v6 offset:45056
v_mfma_f32_16x16x32_bf16 v[140:143], v[76:79], v[40:43], v[140:143]
ds_read_b64_tr_b16 v[118:119], v6 offset:47104
v_mfma_f32_16x16x32_bf16 v[144:147], v[64:67], v[44:47], v[144:147]
ds_read_b128 v[92:95], v2 offset:24832
ds_read_b64_tr_b16 v[120:121], v7 offset:45056
v_mfma_f32_16x16x32_bf16 v[148:151], v[68:71], v[44:47], v[148:151]
ds_read_b64_tr_b16 v[122:123], v7 offset:47104
v_mfma_f32_16x16x32_bf16 v[152:155], v[72:75], v[44:47], v[152:155]
ds_read_b64_tr_b16 v[124:125], v8 offset:45056
v_mfma_f32_16x16x32_bf16 v[156:159], v[76:79], v[44:47], v[156:159]
ds_read_b64_tr_b16 v[126:127], v8 offset:47104
s_waitcnt lgkmcnt(0)
s_barrier
v_mfma_f32_16x16x32_bf16 v[128:131], v[96:99], v[80:83], v[128:131]
ds_read_b128 v[32:35], v2 offset:32768
ds_read_b64_tr_b16 v[48:49], v5 offset:49152
v_mfma_f32_16x16x32_bf16 v[132:135], v[100:103], v[80:83], v[132:135]
ds_read_b64_tr_b16 v[50:51], v5 offset:51200
v_mfma_f32_16x16x32_bf16 v[136:139], v[104:107], v[80:83], v[136:139]
ds_read_b64_tr_b16 v[52:53], v6 offset:49152
v_mfma_f32_16x16x32_bf16 v[140:143], v[108:111], v[80:83], v[140:143]
ds_read_b64_tr_b16 v[54:55], v6 offset:51200
v_mfma_f32_16x16x32_bf16 v[144:147], v[96:99], v[84:87], v[144:147]
ds_read_b128 v[36:39], v2 offset:33024
ds_read_b64_tr_b16 v[56:57], v7 offset:49152
v_mfma_f32_16x16x32_bf16 v[148:151], v[100:103], v[84:87], v[148:151]
ds_read_b64_tr_b16 v[58:59], v7 offset:51200
v_mfma_f32_16x16x32_bf16 v[152:155], v[104:107], v[84:87], v[152:155]
ds_read_b64_tr_b16 v[60:61], v8 offset:49152
v_mfma_f32_16x16x32_bf16 v[156:159], v[108:111], v[84:87], v[156:159]
ds_read_b64_tr_b16 v[62:63], v8 offset:51200
v_mfma_f32_16x16x32_bf16 v[128:131], v[112:115], v[88:91], v[128:131]
ds_read_b128 v[40:43], v2 offset:40960
ds_read_b64_tr_b16 v[64:65], v5 offset:53248
v_mfma_f32_16x16x32_bf16 v[132:135], v[116:119], v[88:91], v[132:135]
ds_read_b64_tr_b16 v[66:67], v5 offset:55296
v_mfma_f32_16x16x32_bf16 v[136:139], v[120:123], v[88:91], v[136:139]
ds_read_b64_tr_b16 v[68:69], v6 offset:53248
v_mfma_f32_16x16x32_bf16 v[140:143], v[124:127], v[88:91], v[140:143]
ds_read_b64_tr_b16 v[70:71], v6 offset:55296
v_mfma_f32_16x16x32_bf16 v[144:147], v[112:115], v[92:95], v[144:147]
ds_read_b128 v[44:47], v2 offset:41216
ds_read_b64_tr_b16 v[72:73], v7 offset:53248
v_mfma_f32_16x16x32_bf16 v[148:151], v[116:119], v[92:95], v[148:151]
ds_read_b64_tr_b16 v[74:75], v7 offset:55296
v_mfma_f32_16x16x32_bf16 v[152:155], v[120:123], v[92:95], v[152:155]
ds_read_b64_tr_b16 v[76:77], v8 offset:53248
v_mfma_f32_16x16x32_bf16 v[156:159], v[124:127], v[92:95], v[156:159]
ds_read_b64_tr_b16 v[78:79], v8 offset:55296
s_waitcnt lgkmcnt(0)
s_barrier
v_mfma_f32_16x16x32_bf16 v[128:131], v[48:51], v[32:35], v[128:131]
ds_read_b128 v[80:83], v2 offset:49152
ds_read_b64_tr_b16 v[96:97], v5 offset:57344
v_mfma_f32_16x16x32_bf16 v[132:135], v[52:55], v[32:35], v[132:135]
ds_read_b64_tr_b16 v[98:99], v5 offset:59392
v_mfma_f32_16x16x32_bf16 v[136:139], v[56:59], v[32:35], v[136:139]
ds_read_b64_tr_b16 v[100:101], v6 offset:57344
v_mfma_f32_16x16x32_bf16 v[140:143], v[60:63], v[32:35], v[140:143]
ds_read_b64_tr_b16 v[102:103], v6 offset:59392
v_mfma_f32_16x16x32_bf16 v[144:147], v[48:51], v[36:39], v[144:147]
ds_read_b128 v[84:87], v2 offset:49408
ds_read_b64_tr_b16 v[104:105], v7 offset:57344
v_mfma_f32_16x16x32_bf16 v[148:151], v[52:55], v[36:39], v[148:151]
ds_read_b64_tr_b16 v[106:107], v7 offset:59392
v_mfma_f32_16x16x32_bf16 v[152:155], v[56:59], v[36:39], v[152:155]
ds_read_b64_tr_b16 v[108:109], v8 offset:57344
v_mfma_f32_16x16x32_bf16 v[156:159], v[60:63], v[36:39], v[156:159]
ds_read_b64_tr_b16 v[110:111], v8 offset:59392
v_mfma_f32_16x16x32_bf16 v[128:131], v[64:67], v[40:43], v[128:131]
ds_read_b128 v[88:91], v2 offset:57344
ds_read_b64_tr_b16 v[112:113], v5 offset:61440
v_mfma_f32_16x16x32_bf16 v[132:135], v[68:71], v[40:43], v[132:135]
ds_read_b64_tr_b16 v[114:115], v5 offset:63488
v_mfma_f32_16x16x32_bf16 v[136:139], v[72:75], v[40:43], v[136:139]
ds_read_b64_tr_b16 v[116:117], v6 offset:61440
v_mfma_f32_16x16x32_bf16 v[140:143], v[76:79], v[40:43], v[140:143]
ds_read_b64_tr_b16 v[118:119], v6 offset:63488
v_mfma_f32_16x16x32_bf16 v[144:147], v[64:67], v[44:47], v[144:147]
ds_read_b128 v[92:95], v2 offset:57600
ds_read_b64_tr_b16 v[120:121], v7 offset:61440
v_mfma_f32_16x16x32_bf16 v[148:151], v[68:71], v[44:47], v[148:151]
ds_read_b64_tr_b16 v[122:123], v7 offset:63488
v_mfma_f32_16x16x32_bf16 v[152:155], v[72:75], v[44:47], v[152:155]
ds_read_b64_tr_b16 v[124:125], v8 offset:61440
v_mfma_f32_16x16x32_bf16 v[156:159], v[76:79], v[44:47], v[156:159]
ds_read_b64_tr_b16 v[126:127], v8 offset:63488
s_waitcnt lgkmcnt(0)
s_barrier
v_mfma_f32_16x16x32_bf16 v[128:131], v[96:99], v[80:83], v[128:131]
ds_read_b128 v[32:35], v2 offset:0
ds_read_b64_tr_b16 v[48:49], v9 offset:0
v_mfma_f32_16x16x32_bf16 v[132:135], v[100:103], v[80:83], v[132:135]
ds_read_b64_tr_b16 v[50:51], v9 offset:2048
v_mfma_f32_16x16x32_bf16 v[136:139], v[104:107], v[80:83], v[136:139]
ds_read_b64_tr_b16 v[52:53], v10 offset:0
v_mfma_f32_16x16x32_bf16 v[140:143], v[108:111], v[80:83], v[140:143]
ds_read_b64_tr_b16 v[54:55], v10 offset:2048
v_mfma_f32_16x16x32_bf16 v[144:147], v[96:99], v[84:87], v[144:147]
ds_read_b128 v[36:39], v2 offset:256
ds_read_b64_tr_b16 v[56:57], v11 offset:0
v_mfma_f32_16x16x32_bf16 v[148:151], v[100:103], v[84:87], v[148:151]
ds_read_b64_tr_b16 v[58:59], v11 offset:2048
v_mfma_f32_16x16x32_bf16 v[152:155], v[104:107], v[84:87], v[152:155]
ds_read_b64_tr_b16 v[60:61], v12 offset:0
v_mfma_f32_16x16x32_bf16 v[156:159], v[108:111], v[84:87], v[156:159]
ds_read_b64_tr_b16 v[62:63], v12 offset:2048
v_mfma_f32_16x16x32_bf16 v[128:131], v[112:115], v[88:91], v[128:131]
ds_read_b128 v[40:43], v2 offset:8192
ds_read_b64_tr_b16 v[64:65], v9 offset:4096
v_mfma_f32_16x16x32_bf16 v[132:135], v[116:119], v[88:91], v[132:135]
ds_read_b64_tr_b16 v[66:67], v9 offset:6144
v_mfma_f32_16x16x32_bf16 v[136:139], v[120:123], v[88:91], v[136:139]
ds_read_b64_tr_b16 v[68:69], v10 offset:4096
v_mfma_f32_16x16x32_bf16 v[140:143], v[124:127], v[88:91], v[140:143]
ds_read_b64_tr_b16 v[70:71], v10 offset:6144
v_mfma_f32_16x16x32_bf16 v[144:147], v[112:115], v[92:95], v[144:147]
ds_read_b128 v[44:47], v2 offset:8448
ds_read_b64_tr_b16 v[72:73], v11 offset:4096
v_mfma_f32_16x16x32_bf16 v[148:151], v[116:119], v[92:95], v[148:151]
ds_read_b64_tr_b16 v[74:75], v11 offset:6144
v_mfma_f32_16x16x32_bf16 v[152:155], v[120:123], v[92:95], v[152:155]
ds_read_b64_tr_b16 v[76:77], v12 offset:4096
v_mfma_f32_16x16x32_bf16 v[156:159], v[124:127], v[92:95], v[156:159]
ds_read_b64_tr_b16 v[78:79], v12 offset:6144
s_waitcnt lgkmcnt(0)
s_barrier
v_mfma_f32_16x16x32_bf16 v[128:131], v[48:51], v[32:35], v[128:131]
ds_read_b128 v[80:83], v2 offset:16384
ds_read_b64_tr_b16 v[96:97], v9 offset:8192
v_mfma_f32_16x16x32_bf16 v[132:135], v[52:55], v[32:35], v[132:135]
ds_read_b64_tr_b16 v[98:99], v9 offset:10240
v_mfma_f32_16x16x32_bf16 v[136:139], v[56:59], v[32:35], v[136:139]
ds_read_b64_tr_b16 v[100:101], v10 offset:8192
v_mfma_f32_16x16x32_bf16 v[140:143], v[60:63], v[32:35], v[140:143]
ds_read_b64_tr_b16 v[102:103], v10 offset:10240
v_mfma_f32_16x16x32_bf16 v[144:147], v[48:51], v[36:39], v[144:147]
ds_read_b128 v[84:87], v2 offset:16640
ds_read_b64_tr_b16 v[104:105], v11 offset:8192
v_mfma_f32_16x16x32_bf16 v[148:151], v[52:55], v[36:39], v[148:151]
ds_read_b64_tr_b16 v[106:107], v11 offset:10240
v_mfma_f32_16x16x32_bf16 v[152:155], v[56:59], v[36:39], v[152:155]
ds_read_b64_tr_b16 v[108:109], v12 offset:8192
v_mfma_f32_16x16x32_bf16 v[156:159], v[60:63], v[36:39], v[156:159]
ds_read_b64_tr_b16 v[110:111], v12 offset:10240
v_mfma_f32_16x16x32_bf16 v[128:131], v[64:67], v[40:43], v[128:131]
ds_read_b128 v[88:91], v2 offset:24576
ds_read_b64_tr_b16 v[112:113], v9 offset:12288
v_mfma_f32_16x16x32_bf16 v[132:135], v[68:71], v[40:43], v[132:135]
ds_read_b64_tr_b16 v[114:115], v9 offset:14336
v_mfma_f32_16x16x32_bf16 v[136:139], v[72:75], v[40:43], v[136:139]
ds_read_b64_tr_b16 v[116:117], v10 offset:12288
v_mfma_f32_16x16x32_bf16 v[140:143], v[76:79], v[40:43], v[140:143]
ds_read_b64_tr_b16 v[118:119], v10 offset:14336
v_mfma_f32_16x16x32_bf16 v[144:147], v[64:67], v[44:47], v[144:147]
ds_read_b128 v[92:95], v2 offset:24832
ds_read_b64_tr_b16 v[120:121], v11 offset:12288
v_mfma_f32_16x16x32_bf16 v[148:151], v[68:71], v[44:47], v[148:151]
ds_read_b64_tr_b16 v[122:123], v11 offset:14336
v_mfma_f32_16x16x32_bf16 v[152:155], v[72:75], v[44:47], v[152:155]
ds_read_b64_tr_b16 v[124:125], v12 offset:12288
v_mfma_f32_16x16x32_bf16 v[156:159], v[76:79], v[44:47], v[156:159]
ds_read_b64_tr_b16 v[126:127], v12 offset:14336
s_waitcnt lgkmcnt(0)
s_barrier
v_mfma_f32_16x16x32_bf16 v[128:131], v[96:99], v[80:83], v[128:131]
ds_read_b128 v[32:35], v2 offset:32768
ds_read_b64_tr_b16 v[48:49], v5 offset:0
v_mfma_f32_16x16x32_bf16 v[132:135], v[100:103], v[80:83], v[132:135]
ds_read_b64_tr_b16 v[50:51], v5 offset:2048
v_mfma_f32_16x16x32_bf16 v[136:139], v[104:107], v[80:83], v[136:139]
ds_read_b64_tr_b16 v[52:53], v6 offset:0
v_mfma_f32_16x16x32_bf16 v[140:143], v[108:111], v[80:83], v[140:143]
ds_read_b64_tr_b16 v[54:55], v6 offset:2048
v_mfma_f32_16x16x32_bf16 v[144:147], v[96:99], v[84:87], v[144:147]
ds_read_b128 v[36:39], v2 offset:33024
ds_read_b64_tr_b16 v[56:57], v7 offset:0
v_mfma_f32_16x16x32_bf16 v[148:151], v[100:103], v[84:87], v[148:151]
ds_read_b64_tr_b16 v[58:59], v7 offset:2048
v_mfma_f32_16x16x32_bf16 v[152:155], v[104:107], v[84:87], v[152:155]
ds_read_b64_tr_b16 v[60:61], v8 offset:0
v_mfma_f32_16x16x32_bf16 v[156:159], v[108:111], v[84:87], v[156:159]
ds_read_b64_tr_b16 v[62:63], v8 offset:2048
v_mfma_f32_16x16x32_bf16 v[128:131], v[112:115], v[88:91], v[128:131]
ds_read_b128 v[40:43], v2 offset:40960
ds_read_b64_tr_b16 v[64:65], v5 offset:4096
v_mfma_f32_16x16x32_bf16 v[132:135], v[116:119], v[88:91], v[132:135]
ds_read_b64_tr_b16 v[66:67], v5 offset:6144
v_mfma_f32_16x16x32_bf16 v[136:139], v[120:123], v[88:91], v[136:139]
ds_read_b64_tr_b16 v[68:69], v6 offset:4096
v_mfma_f32_16x16x32_bf16 v[140:143], v[124:127], v[88:91], v[140:143]
ds_read_b64_tr_b16 v[70:71], v6 offset:6144
v_mfma_f32_16x16x32_bf16 v[144:147], v[112:115], v[92:95], v[144:147]
ds_read_b128 v[44:47], v2 offset:41216
ds_read_b64_tr_b16 v[72:73], v7 offset:4096
v_mfma_f32_16x16x32_bf16 v[148:151], v[116:119], v[92:95], v[148:151]
ds_read_b64_tr_b16 v[74:75], v7 offset:6144
v_mfma_f32_16x16x32_bf16 v[152:155], v[120:123], v[92:95], v[152:155]
ds_read_b64_tr_b16 v[76:77], v8 offset:4096
v_mfma_f32_16x16x32_bf16 v[156:159], v[124:127], v[92:95], v[156:159]
ds_read_b64_tr_b16 v[78:79], v8 offset:6144
s_waitcnt lgkmcnt(0)
s_barrier
v_mfma_f32_16x16x32_bf16 v[128:131], v[48:51], v[32:35], v[128:131]
ds_read_b128 v[80:83], v2 offset:49152
ds_read_b64_tr_b16 v[96:97], v5 offset:8192
v_mfma_f32_16x16x32_bf16 v[132:135], v[52:55], v[32:35], v[132:135]
ds_read_b64_tr_b16 v[98:99], v5 offset:10240
v_mfma_f32_16x16x32_bf16 v[136:139], v[56:59], v[32:35], v[136:139]
ds_read_b64_tr_b16 v[100:101], v6 offset:8192
v_mfma_f32_16x16x32_bf16 v[140:143], v[60:63], v[32:35], v[140:143]
ds_read_b64_tr_b16 v[102:103], v6 offset:10240
v_mfma_f32_16x16x32_bf16 v[144:147], v[48:51], v[36:39], v[144:147]
ds_read_b128 v[84:87], v2 offset:49408
ds_read_b64_tr_b16 v[104:105], v7 offset:8192
v_mfma_f32_16x16x32_bf16 v[148:151], v[52:55], v[36:39], v[148:151]
ds_read_b64_tr_b16 v[106:107], v7 offset:10240
v_mfma_f32_16x16x32_bf16 v[152:155], v[56:59], v[36:39], v[152:155]
ds_read_b64_tr_b16 v[108:109], v8 offset:8192
v_mfma_f32_16x16x32_bf16 v[156:159], v[60:63], v[36:39], v[156:159]
ds_read_b64_tr_b16 v[110:111], v8 offset:10240
v_mfma_f32_16x16x32_bf16 v[128:131], v[64:67], v[40:43], v[128:131]
ds_read_b128 v[88:91], v2 offset:57344
ds_read_b64_tr_b16 v[112:113], v5 offset:12288
v_mfma_f32_16x16x32_bf16 v[132:135], v[68:71], v[40:43], v[132:135]
ds_read_b64_tr_b16 v[114:115], v5 offset:14336
v_mfma_f32_16x16x32_bf16 v[136:139], v[72:75], v[40:43], v[136:139]
ds_read_b64_tr_b16 v[116:117], v6 offset:12288
v_mfma_f32_16x16x32_bf16 v[140:143], v[76:79], v[40:43], v[140:143]
ds_read_b64_tr_b16 v[118:119], v6 offset:14336
v_mfma_f32_16x16x32_bf16 v[144:147], v[64:67], v[44:47], v[144:147]
ds_read_b128 v[92:95], v2 offset:57600
ds_read_b64_tr_b16 v[120:121], v7 offset:12288
v_mfma_f32_16x16x32_bf16 v[148:151], v[68:71], v[44:47], v[148:151]
ds_read_b64_tr_b16 v[122:123], v7 offset:14336
v_mfma_f32_16x16x32_bf16 v[152:155], v[72:75], v[44:47], v[152:155]
ds_read_b64_tr_b16 v[124:125], v8 offset:12288
v_mfma_f32_16x16x32_bf16 v[156:159], v[76:79], v[44:47], v[156:159]
ds_read_b64_tr_b16 v[126:127], v8 offset:14336
s_waitcnt lgkmcnt(0)
s_barrier
v_mfma_f32_16x16x32_bf16 v[128:131], v[96:99], v[80:83], v[128:131]
ds_read_b128 v[32:35], v2 offset:0
ds_read_b64_tr_b16 v[48:49], v5 offset:16384
v_mfma_f32_16x16x32_bf16 v[132:135], v[100:103], v[80:83], v[132:135]
ds_read_b64_tr_b16 v[50:51], v5 offset:18432
v_mfma_f32_16x16x32_bf16 v[136:139], v[104:107], v[80:83], v[136:139]
ds_read_b64_tr_b16 v[52:53], v6 offset:16384
v_mfma_f32_16x16x32_bf16 v[140:143], v[108:111], v[80:83], v[140:143]
ds_read_b64_tr_b16 v[54:55], v6 offset:18432
v_mfma_f32_16x16x32_bf16 v[144:147], v[96:99], v[84:87], v[144:147]
ds_read_b128 v[36:39], v2 offset:256
ds_read_b64_tr_b16 v[56:57], v7 offset:16384
v_mfma_f32_16x16x32_bf16 v[148:151], v[100:103], v[84:87], v[148:151]
ds_read_b64_tr_b16 v[58:59], v7 offset:18432
v_mfma_f32_16x16x32_bf16 v[152:155], v[104:107], v[84:87], v[152:155]
ds_read_b64_tr_b16 v[60:61], v8 offset:16384
v_mfma_f32_16x16x32_bf16 v[156:159], v[108:111], v[84:87], v[156:159]
ds_read_b64_tr_b16 v[62:63], v8 offset:18432
v_mfma_f32_16x16x32_bf16 v[128:131], v[112:115], v[88:91], v[128:131]
ds_read_b128 v[40:43], v2 offset:8192
ds_read_b64_tr_b16 v[64:65], v5 offset:20480
v_mfma_f32_16x16x32_bf16 v[132:135], v[116:119], v[88:91], v[132:135]
ds_read_b64_tr_b16 v[66:67], v5 offset:22528
v_mfma_f32_16x16x32_bf16 v[136:139], v[120:123], v[88:91], v[136:139]
ds_read_b64_tr_b16 v[68:69], v6 offset:20480
v_mfma_f32_16x16x32_bf16 v[140:143], v[124:127], v[88:91], v[140:143]
ds_read_b64_tr_b16 v[70:71], v6 offset:22528
v_mfma_f32_16x16x32_bf16 v[144:147], v[112:115], v[92:95], v[144:147]
ds_read_b128 v[44:47], v2 offset:8448
ds_read_b64_tr_b16 v[72:73], v7 offset:20480
v_mfma_f32_16x16x32_bf16 v[148:151], v[116:119], v[92:95], v[148:151]
ds_read_b64_tr_b16 v[74:75], v7 offset:22528
v_mfma_f32_16x16x32_bf16 v[152:155], v[120:123], v[92:95], v[152:155]
ds_read_b64_tr_b16 v[76:77], v8 offset:20480
v_mfma_f32_16x16x32_bf16 v[156:159], v[124:127], v[92:95], v[156:159]
ds_read_b64_tr_b16 v[78:79], v8 offset:22528
s_waitcnt lgkmcnt(0)
s_barrier
v_mfma_f32_16x16x32_bf16 v[128:131], v[48:51], v[32:35], v[128:131]
ds_read_b128 v[80:83], v2 offset:16384
ds_read_b64_tr_b16 v[96:97], v5 offset:24576
v_mfma_f32_16x16x32_bf16 v[132:135], v[52:55], v[32:35], v[132:135]
ds_read_b64_tr_b16 v[98:99], v5 offset:26624
v_mfma_f32_16x16x32_bf16 v[136:139], v[56:59], v[32:35], v[136:139]
ds_read_b64_tr_b16 v[100:101], v6 offset:24576
v_mfma_f32_16x16x32_bf16 v[140:143], v[60:63], v[32:35], v[140:143]
ds_read_b64_tr_b16 v[102:103], v6 offset:26624
v_mfma_f32_16x16x32_bf16 v[144:147], v[48:51], v[36:39], v[144:147]
ds_read_b128 v[84:87], v2 offset:16640
ds_read_b64_tr_b16 v[104:105], v7 offset:24576
v_mfma_f32_16x16x32_bf16 v[148:151], v[52:55], v[36:39], v[148:151]
ds_read_b64_tr_b16 v[106:107], v7 offset:26624
v_mfma_f32_16x16x32_bf16 v[152:155], v[56:59], v[36:39], v[152:155]
ds_read_b64_tr_b16 v[108:109], v8 offset:24576
v_mfma_f32_16x16x32_bf16 v[156:159], v[60:63], v[36:39], v[156:159]
ds_read_b64_tr_b16 v[110:111], v8 offset:26624
v_mfma_f32_16x16x32_bf16 v[128:131], v[64:67], v[40:43], v[128:131]
ds_read_b128 v[88:91], v2 offset:24576
ds_read_b64_tr_b16 v[112:113], v5 offset:28672
v_mfma_f32_16x16x32_bf16 v[132:135], v[68:71], v[40:43], v[132:135]
ds_read_b64_tr_b16 v[114:115], v5 offset:30720
v_mfma_f32_16x16x32_bf16 v[136:139], v[72:75], v[40:43], v[136:139]
ds_read_b64_tr_b16 v[116:117], v6 offset:28672
v_mfma_f32_16x16x32_bf16 v[140:143], v[76:79], v[40:43], v[140:143]
ds_read_b64_tr_b16 v[118:119], v6 offset:30720
v_mfma_f32_16x16x32_bf16 v[144:147], v[64:67], v[44:47], v[144:147]
ds_read_b128 v[92:95], v2 offset:24832
ds_read_b64_tr_b16 v[120:121], v7 offset:28672
v_mfma_f32_16x16x32_bf16 v[148:151], v[68:71], v[44:47], v[148:151]
ds_read_b64_tr_b16 v[122:123], v7 offset:30720
v_mfma_f32_16x16x32_bf16 v[152:155], v[72:75], v[44:47], v[152:155]
ds_read_b64_tr_b16 v[124:125], v8 offset:28672
v_mfma_f32_16x16x32_bf16 v[156:159], v[76:79], v[44:47], v[156:159]
ds_read_b64_tr_b16 v[126:127], v8 offset:30720
s_waitcnt lgkmcnt(0)
s_barrier
v_mfma_f32_16x16x32_bf16 v[128:131], v[96:99], v[80:83], v[128:131]
ds_read_b128 v[32:35], v2 offset:32768
ds_read_b64_tr_b16 v[48:49], v5 offset:32768
v_mfma_f32_16x16x32_bf16 v[132:135], v[100:103], v[80:83], v[132:135]
ds_read_b64_tr_b16 v[50:51], v5 offset:34816
v_mfma_f32_16x16x32_bf16 v[136:139], v[104:107], v[80:83], v[136:139]
ds_read_b64_tr_b16 v[52:53], v6 offset:32768
v_mfma_f32_16x16x32_bf16 v[140:143], v[108:111], v[80:83], v[140:143]
ds_read_b64_tr_b16 v[54:55], v6 offset:34816
v_mfma_f32_16x16x32_bf16 v[144:147], v[96:99], v[84:87], v[144:147]
ds_read_b128 v[36:39], v2 offset:33024
ds_read_b64_tr_b16 v[56:57], v7 offset:32768
v_mfma_f32_16x16x32_bf16 v[148:151], v[100:103], v[84:87], v[148:151]
ds_read_b64_tr_b16 v[58:59], v7 offset:34816
v_mfma_f32_16x16x32_bf16 v[152:155], v[104:107], v[84:87], v[152:155]
ds_read_b64_tr_b16 v[60:61], v8 offset:32768
v_mfma_f32_16x16x32_bf16 v[156:159], v[108:111], v[84:87], v[156:159]
ds_read_b64_tr_b16 v[62:63], v8 offset:34816
v_mfma_f32_16x16x32_bf16 v[128:131], v[112:115], v[88:91], v[128:131]
ds_read_b128 v[40:43], v2 offset:40960
ds_read_b64_tr_b16 v[64:65], v5 offset:36864
v_mfma_f32_16x16x32_bf16 v[132:135], v[116:119], v[88:91], v[132:135]
ds_read_b64_tr_b16 v[66:67], v5 offset:38912
v_mfma_f32_16x16x32_bf16 v[136:139], v[120:123], v[88:91], v[136:139]
ds_read_b64_tr_b16 v[68:69], v6 offset:36864
v_mfma_f32_16x16x32_bf16 v[140:143], v[124:127], v[88:91], v[140:143]
ds_read_b64_tr_b16 v[70:71], v6 offset:38912
v_mfma_f32_16x16x32_bf16 v[144:147], v[112:115], v[92:95], v[144:147]
ds_read_b128 v[44:47], v2 offset:41216
ds_read_b64_tr_b16 v[72:73], v7 offset:36864
v_mfma_f32_16x16x32_bf16 v[148:151], v[116:119], v[92:95], v[148:151]
ds_read_b64_tr_b16 v[74:75], v7 offset:38912
v_mfma_f32_16x16x32_bf16 v[152:155], v[120:123], v[92:95], v[152:155]
ds_read_b64_tr_b16 v[76:77], v8 offset:36864
v_mfma_f32_16x16x32_bf16 v[156:159], v[124:127], v[92:95], v[156:159]
ds_read_b64_tr_b16 v[78:79], v8 offset:38912
s_waitcnt lgkmcnt(0)
s_barrier
v_mfma_f32_16x16x32_bf16 v[128:131], v[48:51], v[32:35], v[128:131]
ds_read_b128 v[80:83], v2 offset:49152
ds_read_b64_tr_b16 v[96:97], v5 offset:40960
v_mfma_f32_16x16x32_bf16 v[132:135], v[52:55], v[32:35], v[132:135]
ds_read_b64_tr_b16 v[98:99], v5 offset:43008
v_mfma_f32_16x16x32_bf16 v[136:139], v[56:59], v[32:35], v[136:139]
ds_read_b64_tr_b16 v[100:101], v6 offset:40960
v_mfma_f32_16x16x32_bf16 v[140:143], v[60:63], v[32:35], v[140:143]
ds_read_b64_tr_b16 v[102:103], v6 offset:43008
v_mfma_f32_16x16x32_bf16 v[144:147], v[48:51], v[36:39], v[144:147]
ds_read_b128 v[84:87], v2 offset:49408
ds_read_b64_tr_b16 v[104:105], v7 offset:40960
v_mfma_f32_16x16x32_bf16 v[148:151], v[52:55], v[36:39], v[148:151]
ds_read_b64_tr_b16 v[106:107], v7 offset:43008
v_mfma_f32_16x16x32_bf16 v[152:155], v[56:59], v[36:39], v[152:155]
ds_read_b64_tr_b16 v[108:109], v8 offset:40960
v_mfma_f32_16x16x32_bf16 v[156:159], v[60:63], v[36:39], v[156:159]
ds_read_b64_tr_b16 v[110:111], v8 offset:43008
v_mfma_f32_16x16x32_bf16 v[128:131], v[64:67], v[40:43], v[128:131]
ds_read_b128 v[88:91], v2 offset:57344
ds_read_b64_tr_b16 v[112:113], v5 offset:45056
v_mfma_f32_16x16x32_bf16 v[132:135], v[68:71], v[40:43], v[132:135]
ds_read_b64_tr_b16 v[114:115], v5 offset:47104
v_mfma_f32_16x16x32_bf16 v[136:139], v[72:75], v[40:43], v[136:139]
ds_read_b64_tr_b16 v[116:117], v6 offset:45056
v_mfma_f32_16x16x32_bf16 v[140:143], v[76:79], v[40:43], v[140:143]
ds_read_b64_tr_b16 v[118:119], v6 offset:47104
v_mfma_f32_16x16x32_bf16 v[144:147], v[64:67], v[44:47], v[144:147]
ds_read_b128 v[92:95], v2 offset:57600
ds_read_b64_tr_b16 v[120:121], v7 offset:45056
v_mfma_f32_16x16x32_bf16 v[148:151], v[68:71], v[44:47], v[148:151]
ds_read_b64_tr_b16 v[122:123], v7 offset:47104
v_mfma_f32_16x16x32_bf16 v[152:155], v[72:75], v[44:47], v[152:155]
ds_read_b64_tr_b16 v[124:125], v8 offset:45056
v_mfma_f32_16x16x32_bf16 v[156:159], v[76:79], v[44:47], v[156:159]
ds_read_b64_tr_b16 v[126:127], v8 offset:47104
s_waitcnt lgkmcnt(0)
s_barrier
v_mfma_f32_16x16x32_bf16 v[128:131], v[96:99], v[80:83], v[128:131]
v_mfma_f32_16x16x32_bf16 v[132:135], v[100:103], v[80:83], v[132:135]
v_mfma_f32_16x16x32_bf16 v[136:139], v[104:107], v[80:83], v[136:139]
v_mfma_f32_16x16x32_bf16 v[140:143], v[108:111], v[80:83], v[140:143]
v_mfma_f32_16x16x32_bf16 v[144:147], v[96:99], v[84:87], v[144:147]
v_mfma_f32_16x16x32_bf16 v[148:151], v[100:103], v[84:87], v[148:151]
v_mfma_f32_16x16x32_bf16 v[152:155], v[104:107], v[84:87], v[152:155]
v_mfma_f32_16x16x32_bf16 v[156:159], v[108:111], v[84:87], v[156:159]
v_mfma_f32_16x16x32_bf16 v[128:131], v[112:115], v[88:91], v[128:131]
v_mfma_f32_16x16x32_bf16 v[132:135], v[116:119], v[88:91], v[132:135]
v_mfma_f32_16x16x32_bf16 v[136:139], v[120:123], v[88:91], v[136:139]
v_mfma_f32_16x16x32_bf16 v[140:143], v[124:127], v[88:91], v[140:143]
v_mfma_f32_16x16x32_bf16 v[144:147], v[112:115], v[92:95], v[144:147]
v_mfma_f32_16x16x32_bf16 v[148:151], v[116:119], v[92:95], v[148:151]
v_mfma_f32_16x16x32_bf16 v[152:155], v[120:123], v[92:95], v[152:155]
v_mfma_f32_16x16x32_bf16 v[156:159], v[124:127], v[92:95], v[156:159]
s_nop 4
v_cvt_pk_bf16_f32 v96, v128, v129
v_cvt_pk_bf16_f32 v97, v130, v131
v_cvt_pk_bf16_f32 v98, v132, v133
v_cvt_pk_bf16_f32 v99, v134, v135
buffer_store_dwordx4 v[96:99], v2, s[20:23], 0 offen offset:0 sc1
ds_write_b128 v4, v[96:99] offset:0
v_cvt_pk_bf16_f32 v100, v136, v137
v_cvt_pk_bf16_f32 v101, v138, v139
v_cvt_pk_bf16_f32 v102, v140, v141
v_cvt_pk_bf16_f32 v103, v142, v143
buffer_store_dwordx4 v[100:103], v2, s[20:23], s50 offen offset:0 sc1
ds_write_b128 v4, v[100:103] offset:8192
v_cvt_pk_bf16_f32 v104, v144, v145
v_cvt_pk_bf16_f32 v105, v146, v147
v_cvt_pk_bf16_f32 v106, v148, v149
v_cvt_pk_bf16_f32 v107, v150, v151
buffer_store_dwordx4 v[104:107], v2, s[20:23], 0 offen offset:256 sc1
ds_write_b128 v4, v[104:107] offset:256
v_cvt_pk_bf16_f32 v108, v152, v153
v_cvt_pk_bf16_f32 v109, v154, v155
v_cvt_pk_bf16_f32 v110, v156, v157
v_cvt_pk_bf16_f32 v111, v158, v159
buffer_store_dwordx4 v[108:111], v2, s[20:23], s50 offen offset:256 sc1
ds_write_b128 v4, v[108:111] offset:8448
v_pk_mul_f32 v[118:119], v[128:129], v[128:129]
v_pk_mul_f32 v[122:123], v[144:145], v[144:145]
v_pk_fma_f32 v[118:119], v[130:131], v[130:131], v[118:119]
v_pk_add_f32 v[116:117], v[130:131], v[128:129]
v_pk_fma_f32 v[122:123], v[146:147], v[146:147], v[122:123]
v_pk_add_f32 v[120:121], v[146:147], v[144:145]
v_pk_fma_f32 v[118:119], v[132:133], v[132:133], v[118:119]
v_pk_add_f32 v[116:117], v[132:133], v[116:117]
v_pk_fma_f32 v[122:123], v[148:149], v[148:149], v[122:123]
v_pk_add_f32 v[120:121], v[148:149], v[120:121]
v_pk_fma_f32 v[118:119], v[134:135], v[134:135], v[118:119]
v_pk_add_f32 v[116:117], v[134:135], v[116:117]
v_pk_fma_f32 v[122:123], v[150:151], v[150:151], v[122:123]
v_pk_add_f32 v[120:121], v[150:151], v[120:121]
v_pk_fma_f32 v[118:119], v[136:137], v[136:137], v[118:119]
v_pk_add_f32 v[116:117], v[136:137], v[116:117]
v_pk_fma_f32 v[122:123], v[152:153], v[152:153], v[122:123]
v_pk_add_f32 v[120:121], v[152:153], v[120:121]
v_pk_fma_f32 v[118:119], v[138:139], v[138:139], v[118:119]
v_pk_add_f32 v[116:117], v[138:139], v[116:117]
v_pk_fma_f32 v[122:123], v[154:155], v[154:155], v[122:123]
v_pk_add_f32 v[120:121], v[154:155], v[120:121]
v_pk_fma_f32 v[118:119], v[140:141], v[140:141], v[118:119]
v_pk_add_f32 v[116:117], v[140:141], v[116:117]
v_pk_fma_f32 v[122:123], v[156:157], v[156:157], v[122:123]
v_pk_add_f32 v[120:121], v[156:157], v[120:121]
v_pk_fma_f32 v[118:119], v[142:143], v[142:143], v[118:119]
v_pk_add_f32 v[116:117], v[142:143], v[116:117]
v_pk_fma_f32 v[122:123], v[158:159], v[158:159], v[122:123]
v_pk_add_f32 v[120:121], v[158:159], v[120:121]
v_add_f32 v112, v116, v117
v_add_f32 v113, v118, v119
v_add_f32 v114, v120, v121
v_add_f32 v115, v122, v123
s_nop 1
v_permlane32_swap_b32 v112, v114
v_permlane32_swap_b32 v113, v115
v_add_f32 v112, v112, v114
v_add_f32 v113, v113, v115
s_nop 1
v_permlane16_swap_b32 v112, v113
v_add_f32 v112, v112, v113
buffer_store_dword v112, v22, s[24:27], 0 offen sc1
s_waitcnt vmcnt(0) lgkmcnt(0)
s_barrier
s_cmp_lg_u32 s36, 0
s_cbranch_scc1 Lsig_25
s_add_u32 s43, s34, 16
s_lshl_b32 s43, s43, 7
v_mov_b32 v19, s43
v_mov_b32 v20, 1
s_mov_b64 exec, 1
buffer_atomic_add v20, v19, s[56:59], 0 offen sc1
s_mov_b64 exec, -1
Lsig_25:
s_lshl_b32 s53, s47, 2
v_lshlrev_b32 v19, 11, v18
v_lshl_add_u32 v19, v17, 4, v19
s_lshl_b32 s43, s46, 10
v_add_u32 v2, s43, v19
v_add_u32 v3, 49152, v2
v_add_u32 v4, 98304, v2
v_lshrrev_b32 v19, 2, v17
v_lshl_add_u32 v20, v18, 2, v19
v_and_b32 v21, 7, v20
v_lshlrev_b32 v20, 8, v20
v_and_b32 v19, 3, v1
v_lshl_add_u32 v20, v19, 3, v20
s_add_u32 s43, s53, 0
v_xor_b32 v19, s43, v21
v_lshl_add_u32 v5, v19, 5, v20
s_add_u32 s43, s53, 1
v_xor_b32 v19, s43, v21
v_lshl_add_u32 v6, v19, 5, v20
s_add_u32 s43, s53, 2
v_xor_b32 v19, s43, v21
v_lshl_add_u32 v7, v19, 5, v20
s_add_u32 s43, s53, 3
v_xor_b32 v19, s43, v21
v_lshl_add_u32 v8, v19, 5, v20
v_add_u32 v9, 49152, v5
v_add_u32 v10, 49152, v6
v_add_u32 v11, 49152, v7
v_add_u32 v12, 49152, v8
v_add_u32 v13, 98304, v5
v_add_u32 v14, 98304, v6
v_add_u32 v15, 98304, v7
v_add_u32 v16, 98304, v8
v_mov_b32 v128, 0
v_mov_b32 v129, 0
v_mov_b32 v130, 0
v_mov_b32 v131, 0
v_mov_b32 v132, 0
v_mov_b32 v133, 0
v_mov_b32 v134, 0
v_mov_b32 v135, 0
v_mov_b32 v136, 0
v_mov_b32 v137, 0
v_mov_b32 v138, 0
v_mov_b32 v139, 0
v_mov_b32 v140, 0
v_mov_b32 v141, 0
v_mov_b32 v142, 0
v_mov_b32 v143, 0
v_mov_b32 v144, 0
v_mov_b32 v145, 0
v_mov_b32 v146, 0
v_mov_b32 v147, 0
v_mov_b32 v148, 0
v_mov_b32 v149, 0
v_mov_b32 v150, 0
v_mov_b32 v151, 0
v_mov_b32 v152, 0
v_mov_b32 v153, 0
v_mov_b32 v154, 0
v_mov_b32 v155, 0
v_mov_b32 v156, 0
v_mov_b32 v157, 0
v_mov_b32 v158, 0
v_mov_b32 v159, 0
v_mov_b32 v160, 0
v_mov_b32 v161, 0
v_mov_b32 v162, 0
v_mov_b32 v163, 0
v_mov_b32 v164, 0
v_mov_b32 v165, 0
v_mov_b32 v166, 0
v_mov_b32 v167, 0
v_mov_b32 v168, 0
v_mov_b32 v169, 0
v_mov_b32 v170, 0
v_mov_b32 v171, 0
v_mov_b32 v172, 0
v_mov_b32 v173, 0
v_mov_b32 v174, 0
v_mov_b32 v175, 0
v_mov_b32 v176, 0
v_mov_b32 v177, 0
v_mov_b32 v178, 0
v_mov_b32 v179, 0
v_mov_b32 v180, 0
v_mov_b32 v181, 0
v_mov_b32 v182, 0
v_mov_b32 v183, 0
v_mov_b32 v184, 0
v_mov_b32 v185, 0
v_mov_b32 v186, 0
v_mov_b32 v187, 0
v_mov_b32 v188, 0
v_mov_b32 v189, 0
v_mov_b32 v190, 0
v_mov_b32 v191, 0
v_mov_b32 v192, 0
v_mov_b32 v193, 0
v_mov_b32 v194, 0
v_mov_b32 v195, 0
v_mov_b32 v196, 0
v_mov_b32 v197, 0
v_mov_b32 v198, 0
v_mov_b32 v199, 0
v_mov_b32 v200, 0
v_mov_b32 v201, 0
v_mov_b32 v202, 0
v_mov_b32 v203, 0
v_mov_b32 v204, 0
v_mov_b32 v205, 0
v_mov_b32 v206, 0
v_mov_b32 v207, 0
v_mov_b32 v208, 0
v_mov_b32 v209, 0
v_mov_b32 v210, 0
v_mov_b32 v211, 0
v_mov_b32 v212, 0
v_mov_b32 v213, 0
v_mov_b32 v214, 0
v_mov_b32 v215, 0
v_mov_b32 v216, 0
v_mov_b32 v217, 0
v_mov_b32 v218, 0
v_mov_b32 v219, 0
v_mov_b32 v220, 0
v_mov_b32 v221, 0
v_mov_b32 v222, 0
v_mov_b32 v223, 0
v_mov_b32 v224, 0
v_mov_b32 v225, 0
v_mov_b32 v226, 0
v_mov_b32 v227, 0
v_mov_b32 v228, 0
v_mov_b32 v229, 0
v_mov_b32 v230, 0
v_mov_b32 v231, 0
v_mov_b32 v232, 0
v_mov_b32 v233, 0
v_mov_b32 v234, 0
v_mov_b32 v235, 0
v_mov_b32 v236, 0
v_mov_b32 v237, 0
v_mov_b32 v238, 0
v_mov_b32 v239, 0
v_mov_b32 v240, 0
v_mov_b32 v241, 0
v_mov_b32 v242, 0
v_mov_b32 v243, 0
v_mov_b32 v244, 0
v_mov_b32 v245, 0
v_mov_b32 v246, 0
v_mov_b32 v247, 0
v_mov_b32 v248, 0
v_mov_b32 v249, 0
v_mov_b32 v250, 0
v_mov_b32 v251, 0
v_mov_b32 v252, 0
v_mov_b32 v253, 0
v_mov_b32 v254, 0
v_mov_b32 v255, 0
s_mul_i32 s43, s49, 192
s_and_b32 s43, s43, 0xffffff80
s_add_u32 s43, s43, 4096
s_cmp_eq_u32 s51, 1
s_cselect_b32 s8, s4, s6
s_cselect_b32 s9, s5, s7
s_sub_u32 s10, 7340032, s43
s_lshl_b32 s44, s34, 18
s_add_u32 s44, s44, 4194304
s_movk_i32 s38, 28672
s_cmp_eq_u32 s51, 0
s_cselect_b32 s8, s32, s8
s_cselect_b32 s9, s33, s9
s_cselect_b32 s10, 262144, s10
s_cselect_b32 s43, s44, s43
s_cselect_b32 s38, 1024, s38
s_cselect_b32 s45, 0, -1
s_add_u32 s8, s8, s43
s_addc_u32 s9, s9, 0
s_mov_b32 s11, 0x20000
s_lshl_b32 s40, s38, 4
s_add_u32 s42, s35, 17
s_lshl_b32 s39, s51, 14
v_lshrrev_b32 v19, 4, v1
v_lshlrev_b32 v20, 5, v19
v_mul_u32_u24 v19, 6912, v19
v_and_b32 v19, s45, v19
v_and_b32 v20, s45, v20
v_lshlrev_b32 v21, 4, v1
v_xor_b32 v21, v21, v20
v_add_u32 v22, v21, v19
s_and_b32 s45, s45, 128
v_xor_b32 v23, s45, v22
s_mul_i32 s43, s34, 917504
s_mul_i32 s44, s35, 16384
s_add_u32 s43, s43, s44
s_add_u32 s43, s43, 8388608
s_add_u32 s24, s32, s43
s_addc_u32 s25, s33, 0
s_mov_b32 s26, 278528
s_mov_b32 s27, 0x20000
s_mov_b32 s53, 262144
s_lshl_b32 s43, s47, 13
s_lshl_b32 s44, s46, 10
s_add_u32 s43, s43, s44
v_lshlrev_b32 v19, 11, v18
v_lshl_add_u32 v19, v17, 4, v19
v_add_u32 v27, s43, v19
s_lshl_b32 s43, s34, 18
s_lshl_b32 s44, s35, 7
s_add_u32 s43, s43, s44
s_add_u32 s16, s62, s43
s_addc_u32 s17, s63, 0
s_mov_b32 s18, 260224
s_mov_b32 s19, 0x20000
s_lshl_b32 s43, s46, 6
v_lshl_add_u32 v19, v17, 1, s43
v_lshlrev_b32 v19, 11, v19
v_and_b32 v20, 1, v18
v_lshl_add_u32 v19, v20, 5, v19
v_lshrrev_b32 v20, 1, v18
v_lshl_add_u32 v19, v20, 4, v19
s_lshl_b32 s43, s47, 6
v_add_u32 v28, s43, v19
s_lshl_b32 s43, s34, 4
s_add_u32 s43, s43, s35
s_xor_b32 s43, s43, 0
s_lshl_b32 s43, s43, 15
s_add_u32 s43, s43, 33554432
s_add_u32 s64, s32, s43
s_addc_u32 s65, s33, 0
s_mov_b32 s66, 32768
s_mov_b32 s67, 0x20000
s_lshl_b32 s43, s34, 4
s_add_u32 s43, s43, s35
s_xor_b32 s43, s43, 1
s_lshl_b32 s43, s43, 15
s_add_u32 s43, s43, 33554432
s_add_u32 s68, s32, s43
s_addc_u32 s69, s33, 0
s_mov_b32 s70, 32768
s_mov_b32 s71, 0x20000
s_lshl_b32 s43, s34, 18
s_add_u32 s12, s32, s43
s_addc_u32 s13, s33, 0
s_add_u32 s12, s12, 4194304
s_addc_u32 s13, s13, 0
s_mov_b32 s14, 262144
s_mov_b32 s15, 0x20000
v_lshlrev_b32 v21, 4, v1
s_lshl_b32 s54, s36, 11
s_add_u32 s43, s35, 1
s_and_b32 s43, s43, 15
s_lshl_b32 s43, s43, 14
s_add_u32 s30, s43, s54
s_add_u32 s43, s35, 2
s_and_b32 s43, s43, 15
s_lshl_b32 s43, s43, 14
s_add_u32 s31, s43, s54
ds_read_b128 v[32:35], v4 offset:0
ds_read_b64_tr_b16 v[48:49], v13 offset:16384
ds_read_b64_tr_b16 v[50:51], v13 offset:20480
ds_read_b128 v[36:39], v4 offset:256
ds_read_b128 v[40:43], v4 offset:512
ds_read_b128 v[44:47], v4 offset:768
ds_read_b64_tr_b16 v[64:65], v13 offset:32768
ds_read_b64_tr_b16 v[66:67], v13 offset:36864
ds_read_b64_tr_b16 v[52:53], v14 offset:16384
ds_read_b64_tr_b16 v[54:55], v14 offset:20480
ds_read_b64_tr_b16 v[68:69], v14 offset:32768
ds_read_b64_tr_b16 v[70:71], v14 offset:36864
ds_read_b64_tr_b16 v[56:57], v15 offset:16384
ds_read_b64_tr_b16 v[58:59], v15 offset:20480
ds_read_b64_tr_b16 v[72:73], v15 offset:32768
ds_read_b64_tr_b16 v[74:75], v15 offset:36864
ds_read_b64_tr_b16 v[60:61], v16 offset:16384
ds_read_b64_tr_b16 v[62:63], v16 offset:20480
ds_read_b64_tr_b16 v[76:77], v16 offset:32768
ds_read_b64_tr_b16 v[78:79], v16 offset:36864
s_waitcnt lgkmcnt(0)
v_mfma_f32_16x16x32_bf16 v[128:131], v[48:51], v[32:35], v[128:131]
ds_read_b128 v[80:83], v4 offset:8192
v_mfma_f32_16x16x32_bf16 v[132:135], v[48:51], v[36:39], v[132:135]
ds_read_b64_tr_b16 v[96:97], v13 offset:24576
v_mfma_f32_16x16x32_bf16 v[136:139], v[48:51], v[40:43], v[136:139]
ds_read_b64_tr_b16 v[98:99], v13 offset:28672
v_mfma_f32_16x16x32_bf16 v[140:143], v[48:51], v[44:47], v[140:143]
ds_read_b128 v[84:87], v4 offset:8448
v_mfma_f32_16x16x32_bf16 v[204:207], v[64:67], v[44:47], v[204:207]
ds_read_b128 v[88:91], v4 offset:8704
v_mfma_f32_16x16x32_bf16 v[200:203], v[64:67], v[40:43], v[200:203]
ds_read_b128 v[92:95], v4 offset:8960
v_mfma_f32_16x16x32_bf16 v[196:199], v[64:67], v[36:39], v[196:199]
ds_read_b64_tr_b16 v[112:113], v13 offset:40960
v_mfma_f32_16x16x32_bf16 v[192:195], v[64:67], v[32:35], v[192:195]
ds_read_b64_tr_b16 v[114:115], v13 offset:45056
v_mfma_f32_16x16x32_bf16 v[144:147], v[52:55], v[32:35], v[144:147]
ds_read_b64_tr_b16 v[100:101], v14 offset:24576
v_mfma_f32_16x16x32_bf16 v[148:151], v[52:55], v[36:39], v[148:151]
ds_read_b64_tr_b16 v[102:103], v14 offset:28672
v_mfma_f32_16x16x32_bf16 v[152:155], v[52:55], v[40:43], v[152:155]
ds_read_b64_tr_b16 v[116:117], v14 offset:40960
v_mfma_f32_16x16x32_bf16 v[156:159], v[52:55], v[44:47], v[156:159]
ds_read_b64_tr_b16 v[118:119], v14 offset:45056
v_mfma_f32_16x16x32_bf16 v[220:223], v[68:71], v[44:47], v[220:223]
ds_read_b64_tr_b16 v[104:105], v15 offset:24576
v_mfma_f32_16x16x32_bf16 v[216:219], v[68:71], v[40:43], v[216:219]
ds_read_b64_tr_b16 v[106:107], v15 offset:28672
v_mfma_f32_16x16x32_bf16 v[212:215], v[68:71], v[36:39], v[212:215]
ds_read_b64_tr_b16 v[120:121], v15 offset:40960
v_mfma_f32_16x16x32_bf16 v[208:211], v[68:71], v[32:35], v[208:211]
ds_read_b64_tr_b16 v[122:123], v15 offset:45056
v_mfma_f32_16x16x32_bf16 v[160:163], v[56:59], v[32:35], v[160:163]
ds_read_b64_tr_b16 v[108:109], v16 offset:24576
v_mfma_f32_16x16x32_bf16 v[164:167], v[56:59], v[36:39], v[164:167]
ds_read_b64_tr_b16 v[110:111], v16 offset:28672
v_mfma_f32_16x16x32_bf16 v[168:171], v[56:59], v[40:43], v[168:171]
ds_read_b64_tr_b16 v[124:125], v16 offset:40960
v_mfma_f32_16x16x32_bf16 v[172:175], v[56:59], v[44:47], v[172:175]
ds_read_b64_tr_b16 v[126:127], v16 offset:45056
v_mfma_f32_16x16x32_bf16 v[236:239], v[72:75], v[44:47], v[236:239]
v_mfma_f32_16x16x32_bf16 v[232:235], v[72:75], v[40:43], v[232:235]
v_mfma_f32_16x16x32_bf16 v[228:231], v[72:75], v[36:39], v[228:231]
v_mfma_f32_16x16x32_bf16 v[224:227], v[72:75], v[32:35], v[224:227]
v_mfma_f32_16x16x32_bf16 v[176:179], v[60:63], v[32:35], v[176:179]
v_mfma_f32_16x16x32_bf16 v[180:183], v[60:63], v[36:39], v[180:183]
v_mfma_f32_16x16x32_bf16 v[184:187], v[60:63], v[40:43], v[184:187]
v_mfma_f32_16x16x32_bf16 v[188:191], v[60:63], v[44:47], v[188:191]
v_mfma_f32_16x16x32_bf16 v[252:255], v[76:79], v[44:47], v[252:255]
v_mfma_f32_16x16x32_bf16 v[248:251], v[76:79], v[40:43], v[248:251]
v_mfma_f32_16x16x32_bf16 v[244:247], v[76:79], v[36:39], v[244:247]
v_mfma_f32_16x16x32_bf16 v[240:243], v[76:79], v[32:35], v[240:243]
s_waitcnt lgkmcnt(0)
v_mfma_f32_16x16x32_bf16 v[128:131], v[96:99], v[80:83], v[128:131]
v_mfma_f32_16x16x32_bf16 v[132:135], v[96:99], v[84:87], v[132:135]
v_mfma_f32_16x16x32_bf16 v[136:139], v[96:99], v[88:91], v[136:139]
v_mfma_f32_16x16x32_bf16 v[140:143], v[96:99], v[92:95], v[140:143]
v_mfma_f32_16x16x32_bf16 v[204:207], v[112:115], v[92:95], v[204:207]
v_mfma_f32_16x16x32_bf16 v[200:203], v[112:115], v[88:91], v[200:203]
v_mfma_f32_16x16x32_bf16 v[196:199], v[112:115], v[84:87], v[196:199]
v_mfma_f32_16x16x32_bf16 v[192:195], v[112:115], v[80:83], v[192:195]
v_mfma_f32_16x16x32_bf16 v[144:147], v[100:103], v[80:83], v[144:147]
v_mfma_f32_16x16x32_bf16 v[148:151], v[100:103], v[84:87], v[148:151]
v_mfma_f32_16x16x32_bf16 v[152:155], v[100:103], v[88:91], v[152:155]
v_mfma_f32_16x16x32_bf16 v[156:159], v[100:103], v[92:95], v[156:159]
v_mfma_f32_16x16x32_bf16 v[220:223], v[116:119], v[92:95], v[220:223]
v_mfma_f32_16x16x32_bf16 v[216:219], v[116:119], v[88:91], v[216:219]
v_mfma_f32_16x16x32_bf16 v[212:215], v[116:119], v[84:87], v[212:215]
v_mfma_f32_16x16x32_bf16 v[208:211], v[116:119], v[80:83], v[208:211]
v_mfma_f32_16x16x32_bf16 v[160:163], v[104:107], v[80:83], v[160:163]
v_mfma_f32_16x16x32_bf16 v[164:167], v[104:107], v[84:87], v[164:167]
v_mfma_f32_16x16x32_bf16 v[168:171], v[104:107], v[88:91], v[168:171]
v_mfma_f32_16x16x32_bf16 v[172:175], v[104:107], v[92:95], v[172:175]
v_mfma_f32_16x16x32_bf16 v[236:239], v[120:123], v[92:95], v[236:239]
v_mfma_f32_16x16x32_bf16 v[232:235], v[120:123], v[88:91], v[232:235]
v_mfma_f32_16x16x32_bf16 v[228:231], v[120:123], v[84:87], v[228:231]
v_mfma_f32_16x16x32_bf16 v[224:227], v[120:123], v[80:83], v[224:227]
v_mfma_f32_16x16x32_bf16 v[176:179], v[108:111], v[80:83], v[176:179]
v_mfma_f32_16x16x32_bf16 v[180:183], v[108:111], v[84:87], v[180:183]
v_mfma_f32_16x16x32_bf16 v[184:187], v[108:111], v[88:91], v[184:187]
v_mfma_f32_16x16x32_bf16 v[188:191], v[108:111], v[92:95], v[188:191]
v_mfma_f32_16x16x32_bf16 v[252:255], v[124:127], v[92:95], v[252:255]
v_mfma_f32_16x16x32_bf16 v[248:251], v[124:127], v[88:91], v[248:251]
v_mfma_f32_16x16x32_bf16 v[244:247], v[124:127], v[84:87], v[244:247]
v_mfma_f32_16x16x32_bf16 v[240:243], v[124:127], v[80:83], v[240:243]
s_barrier
s_add_u32 m0, s54, 0
s_add_u32 s43, s30, 0
buffer_load_dwordx4 v21, s[12:15], s43 offen sc1 lds
s_add_u32 m0, s54, 1024
s_add_u32 s43, s30, 1024
buffer_load_dwordx4 v21, s[12:15], s43 offen sc1 lds
s_add_u32 m0, s54, 49152
s_add_u32 s43, s31, 0
buffer_load_dwordx4 v21, s[12:15], s43 offen sc1 lds
s_add_u32 m0, s54, 50176
s_add_u32 s43, s31, 1024
buffer_load_dwordx4 v21, s[12:15], s43 offen sc1 lds
s_waitcnt vmcnt(2)
s_barrier
s_setprio 1
ds_read_b128 v[32:35], v2 offset:0
ds_read_b64_tr_b16 v[48:49], v5 offset:16384
ds_read_b64_tr_b16 v[50:51], v5 offset:20480
ds_read_b128 v[36:39], v2 offset:256
ds_read_b128 v[40:43], v2 offset:512
ds_read_b128 v[44:47], v2 offset:768
ds_read_b64_tr_b16 v[64:65], v5 offset:32768
ds_read_b64_tr_b16 v[66:67], v5 offset:36864
ds_read_b64_tr_b16 v[52:53], v6 offset:16384
ds_read_b64_tr_b16 v[54:55], v6 offset:20480
ds_read_b64_tr_b16 v[68:69], v6 offset:32768
ds_read_b64_tr_b16 v[70:71], v6 offset:36864
ds_read_b64_tr_b16 v[56:57], v7 offset:16384
ds_read_b64_tr_b16 v[58:59], v7 offset:20480
ds_read_b64_tr_b16 v[72:73], v7 offset:32768
ds_read_b64_tr_b16 v[74:75], v7 offset:36864
ds_read_b64_tr_b16 v[60:61], v8 offset:16384
ds_read_b64_tr_b16 v[62:63], v8 offset:20480
ds_read_b64_tr_b16 v[76:77], v8 offset:32768
ds_read_b64_tr_b16 v[78:79], v8 offset:36864
s_mov_b32 s41, 4
Lk3_26:
s_waitcnt lgkmcnt(0)
v_mfma_f32_16x16x32_bf16 v[128:131], v[48:51], v[32:35], v[128:131]
ds_read_b128 v[80:83], v2 offset:8192
v_mfma_f32_16x16x32_bf16 v[132:135], v[48:51], v[36:39], v[132:135]
ds_read_b64_tr_b16 v[96:97], v5 offset:24576
v_mfma_f32_16x16x32_bf16 v[136:139], v[48:51], v[40:43], v[136:139]
ds_read_b64_tr_b16 v[98:99], v5 offset:28672
v_mfma_f32_16x16x32_bf16 v[140:143], v[48:51], v[44:47], v[140:143]
ds_read_b128 v[84:87], v2 offset:8448
v_mfma_f32_16x16x32_bf16 v[204:207], v[64:67], v[44:47], v[204:207]
ds_read_b128 v[88:91], v2 offset:8704
v_mfma_f32_16x16x32_bf16 v[200:203], v[64:67], v[40:43], v[200:203]
ds_read_b128 v[92:95], v2 offset:8960
v_mfma_f32_16x16x32_bf16 v[196:199], v[64:67], v[36:39], v[196:199]
ds_read_b64_tr_b16 v[112:113], v5 offset:40960
v_mfma_f32_16x16x32_bf16 v[192:195], v[64:67], v[32:35], v[192:195]
ds_read_b64_tr_b16 v[114:115], v5 offset:45056
v_mfma_f32_16x16x32_bf16 v[144:147], v[52:55], v[32:35], v[144:147]
ds_read_b64_tr_b16 v[100:101], v6 offset:24576
v_mfma_f32_16x16x32_bf16 v[148:151], v[52:55], v[36:39], v[148:151]
ds_read_b64_tr_b16 v[102:103], v6 offset:28672
v_mfma_f32_16x16x32_bf16 v[152:155], v[52:55], v[40:43], v[152:155]
ds_read_b64_tr_b16 v[116:117], v6 offset:40960
v_mfma_f32_16x16x32_bf16 v[156:159], v[52:55], v[44:47], v[156:159]
ds_read_b64_tr_b16 v[118:119], v6 offset:45056
v_mfma_f32_16x16x32_bf16 v[220:223], v[68:71], v[44:47], v[220:223]
ds_read_b64_tr_b16 v[104:105], v7 offset:24576
v_mfma_f32_16x16x32_bf16 v[216:219], v[68:71], v[40:43], v[216:219]
ds_read_b64_tr_b16 v[106:107], v7 offset:28672
v_mfma_f32_16x16x32_bf16 v[212:215], v[68:71], v[36:39], v[212:215]
ds_read_b64_tr_b16 v[120:121], v7 offset:40960
v_mfma_f32_16x16x32_bf16 v[208:211], v[68:71], v[32:35], v[208:211]
ds_read_b64_tr_b16 v[122:123], v7 offset:45056
v_mfma_f32_16x16x32_bf16 v[160:163], v[56:59], v[32:35], v[160:163]
ds_read_b64_tr_b16 v[108:109], v8 offset:24576
v_mfma_f32_16x16x32_bf16 v[164:167], v[56:59], v[36:39], v[164:167]
ds_read_b64_tr_b16 v[110:111], v8 offset:28672
v_mfma_f32_16x16x32_bf16 v[168:171], v[56:59], v[40:43], v[168:171]
ds_read_b64_tr_b16 v[124:125], v8 offset:40960
v_mfma_f32_16x16x32_bf16 v[172:175], v[56:59], v[44:47], v[172:175]
ds_read_b64_tr_b16 v[126:127], v8 offset:45056
v_mfma_f32_16x16x32_bf16 v[236:239], v[72:75], v[44:47], v[236:239]
v_mfma_f32_16x16x32_bf16 v[232:235], v[72:75], v[40:43], v[232:235]
v_mfma_f32_16x16x32_bf16 v[228:231], v[72:75], v[36:39], v[228:231]
v_mfma_f32_16x16x32_bf16 v[224:227], v[72:75], v[32:35], v[224:227]
v_mfma_f32_16x16x32_bf16 v[176:179], v[60:63], v[32:35], v[176:179]
v_mfma_f32_16x16x32_bf16 v[180:183], v[60:63], v[36:39], v[180:183]
v_mfma_f32_16x16x32_bf16 v[184:187], v[60:63], v[40:43], v[184:187]
v_mfma_f32_16x16x32_bf16 v[188:191], v[60:63], v[44:47], v[188:191]
v_mfma_f32_16x16x32_bf16 v[252:255], v[76:79], v[44:47], v[252:255]
v_mfma_f32_16x16x32_bf16 v[248:251], v[76:79], v[40:43], v[248:251]
v_mfma_f32_16x16x32_bf16 v[244:247], v[76:79], v[36:39], v[244:247]
v_mfma_f32_16x16x32_bf16 v[240:243], v[76:79], v[32:35], v[240:243]
s_waitcnt vmcnt(0) lgkmcnt(0)
s_barrier
v_mfma_f32_16x16x32_bf16 v[128:131], v[96:99], v[80:83], v[128:131]
ds_read_b128 v[32:35], v3 offset:0
v_mfma_f32_16x16x32_bf16 v[132:135], v[96:99], v[84:87], v[132:135]
ds_read_b64_tr_b16 v[48:49], v9 offset:16384
v_mfma_f32_16x16x32_bf16 v[136:139], v[96:99], v[88:91], v[136:139]
ds_read_b64_tr_b16 v[50:51], v9 offset:20480
v_mfma_f32_16x16x32_bf16 v[140:143], v[96:99], v[92:95], v[140:143]
ds_read_b128 v[36:39], v3 offset:256
v_mfma_f32_16x16x32_bf16 v[204:207], v[112:115], v[92:95], v[204:207]
ds_read_b128 v[40:43], v3 offset:512
v_mfma_f32_16x16x32_bf16 v[200:203], v[112:115], v[88:91], v[200:203]
ds_read_b128 v[44:47], v3 offset:768
v_mfma_f32_16x16x32_bf16 v[196:199], v[112:115], v[84:87], v[196:199]
ds_read_b64_tr_b16 v[64:65], v9 offset:32768
v_mfma_f32_16x16x32_bf16 v[192:195], v[112:115], v[80:83], v[192:195]
ds_read_b64_tr_b16 v[66:67], v9 offset:36864
v_mfma_f32_16x16x32_bf16 v[144:147], v[100:103], v[80:83], v[144:147]
ds_read_b64_tr_b16 v[52:53], v10 offset:16384
v_mfma_f32_16x16x32_bf16 v[148:151], v[100:103], v[84:87], v[148:151]
ds_read_b64_tr_b16 v[54:55], v10 offset:20480
v_mfma_f32_16x16x32_bf16 v[152:155], v[100:103], v[88:91], v[152:155]
ds_read_b64_tr_b16 v[68:69], v10 offset:32768
v_mfma_f32_16x16x32_bf16 v[156:159], v[100:103], v[92:95], v[156:159]
ds_read_b64_tr_b16 v[70:71], v10 offset:36864
v_mfma_f32_16x16x32_bf16 v[220:223], v[116:119], v[92:95], v[220:223]
ds_read_b64_tr_b16 v[56:57], v11 offset:16384
v_mfma_f32_16x16x32_bf16 v[216:219], v[116:119], v[88:91], v[216:219]
ds_read_b64_tr_b16 v[58:59], v11 offset:20480
v_mfma_f32_16x16x32_bf16 v[212:215], v[116:119], v[84:87], v[212:215]
ds_read_b64_tr_b16 v[72:73], v11 offset:32768
v_mfma_f32_16x16x32_bf16 v[208:211], v[116:119], v[80:83], v[208:211]
ds_read_b64_tr_b16 v[74:75], v11 offset:36864
v_mfma_f32_16x16x32_bf16 v[160:163], v[104:107], v[80:83], v[160:163]
ds_read_b64_tr_b16 v[60:61], v12 offset:16384
v_mfma_f32_16x16x32_bf16 v[164:167], v[104:107], v[84:87], v[164:167]
ds_read_b64_tr_b16 v[62:63], v12 offset:20480
v_mfma_f32_16x16x32_bf16 v[168:171], v[104:107], v[88:91], v[168:171]
ds_read_b64_tr_b16 v[76:77], v12 offset:32768
v_mfma_f32_16x16x32_bf16 v[172:175], v[104:107], v[92:95], v[172:175]
ds_read_b64_tr_b16 v[78:79], v12 offset:36864
v_mfma_f32_16x16x32_bf16 v[236:239], v[120:123], v[92:95], v[236:239]
v_mfma_f32_16x16x32_bf16 v[232:235], v[120:123], v[88:91], v[232:235]
v_mfma_f32_16x16x32_bf16 v[228:231], v[120:123], v[84:87], v[228:231]
v_mfma_f32_16x16x32_bf16 v[224:227], v[120:123], v[80:83], v[224:227]
v_mfma_f32_16x16x32_bf16 v[176:179], v[108:111], v[80:83], v[176:179]
v_mfma_f32_16x16x32_bf16 v[180:183], v[108:111], v[84:87], v[180:183]
v_mfma_f32_16x16x32_bf16 v[184:187], v[108:111], v[88:91], v[184:187]
v_mfma_f32_16x16x32_bf16 v[188:191], v[108:111], v[92:95], v[188:191]
v_mfma_f32_16x16x32_bf16 v[252:255], v[124:127], v[92:95], v[252:255]
v_mfma_f32_16x16x32_bf16 v[248:251], v[124:127], v[88:91], v[248:251]
v_mfma_f32_16x16x32_bf16 v[244:247], v[124:127], v[84:87], v[244:247]
v_mfma_f32_16x16x32_bf16 v[240:243], v[124:127], v[80:83], v[240:243]
s_waitcnt lgkmcnt(0)
v_mfma_f32_16x16x32_bf16 v[128:131], v[48:51], v[32:35], v[128:131]
ds_read_b128 v[80:83], v3 offset:8192
v_mfma_f32_16x16x32_bf16 v[132:135], v[48:51], v[36:39], v[132:135]
ds_read_b64_tr_b16 v[96:97], v9 offset:24576
v_mfma_f32_16x16x32_bf16 v[136:139], v[48:51], v[40:43], v[136:139]
ds_read_b64_tr_b16 v[98:99], v9 offset:28672
v_mfma_f32_16x16x32_bf16 v[140:143], v[48:51], v[44:47], v[140:143]
ds_read_b128 v[84:87], v3 offset:8448
v_mfma_f32_16x16x32_bf16 v[204:207], v[64:67], v[44:47], v[204:207]
ds_read_b128 v[88:91], v3 offset:8704
v_mfma_f32_16x16x32_bf16 v[200:203], v[64:67], v[40:43], v[200:203]
ds_read_b128 v[92:95], v3 offset:8960
v_mfma_f32_16x16x32_bf16 v[196:199], v[64:67], v[36:39], v[196:199]
ds_read_b64_tr_b16 v[112:113], v9 offset:40960
v_mfma_f32_16x16x32_bf16 v[192:195], v[64:67], v[32:35], v[192:195]
ds_read_b64_tr_b16 v[114:115], v9 offset:45056
v_mfma_f32_16x16x32_bf16 v[144:147], v[52:55], v[32:35], v[144:147]
ds_read_b64_tr_b16 v[100:101], v10 offset:24576
v_mfma_f32_16x16x32_bf16 v[148:151], v[52:55], v[36:39], v[148:151]
ds_read_b64_tr_b16 v[102:103], v10 offset:28672
v_mfma_f32_16x16x32_bf16 v[152:155], v[52:55], v[40:43], v[152:155]
ds_read_b64_tr_b16 v[116:117], v10 offset:40960
v_mfma_f32_16x16x32_bf16 v[156:159], v[52:55], v[44:47], v[156:159]
ds_read_b64_tr_b16 v[118:119], v10 offset:45056
v_mfma_f32_16x16x32_bf16 v[220:223], v[68:71], v[44:47], v[220:223]
ds_read_b64_tr_b16 v[104:105], v11 offset:24576
v_mfma_f32_16x16x32_bf16 v[216:219], v[68:71], v[40:43], v[216:219]
ds_read_b64_tr_b16 v[106:107], v11 offset:28672
v_mfma_f32_16x16x32_bf16 v[212:215], v[68:71], v[36:39], v[212:215]
ds_read_b64_tr_b16 v[120:121], v11 offset:40960
v_mfma_f32_16x16x32_bf16 v[208:211], v[68:71], v[32:35], v[208:211]
ds_read_b64_tr_b16 v[122:123], v11 offset:45056
v_mfma_f32_16x16x32_bf16 v[160:163], v[56:59], v[32:35], v[160:163]
ds_read_b64_tr_b16 v[108:109], v12 offset:24576
v_mfma_f32_16x16x32_bf16 v[164:167], v[56:59], v[36:39], v[164:167]
ds_read_b64_tr_b16 v[110:111], v12 offset:28672
v_mfma_f32_16x16x32_bf16 v[168:171], v[56:59], v[40:43], v[168:171]
ds_read_b64_tr_b16 v[124:125], v12 offset:40960
v_mfma_f32_16x16x32_bf16 v[172:175], v[56:59], v[44:47], v[172:175]
ds_read_b64_tr_b16 v[126:127], v12 offset:45056
v_mfma_f32_16x16x32_bf16 v[236:239], v[72:75], v[44:47], v[236:239]
v_mfma_f32_16x16x32_bf16 v[232:235], v[72:75], v[40:43], v[232:235]
v_mfma_f32_16x16x32_bf16 v[228:231], v[72:75], v[36:39], v[228:231]
v_mfma_f32_16x16x32_bf16 v[224:227], v[72:75], v[32:35], v[224:227]
v_mfma_f32_16x16x32_bf16 v[176:179], v[60:63], v[32:35], v[176:179]
v_mfma_f32_16x16x32_bf16 v[180:183], v[60:63], v[36:39], v[180:183]
v_mfma_f32_16x16x32_bf16 v[184:187], v[60:63], v[40:43], v[184:187]
v_mfma_f32_16x16x32_bf16 v[188:191], v[60:63], v[44:47], v[188:191]
v_mfma_f32_16x16x32_bf16 v[252:255], v[76:79], v[44:47], v[252:255]
v_mfma_f32_16x16x32_bf16 v[248:251], v[76:79], v[40:43], v[248:251]
v_mfma_f32_16x16x32_bf16 v[244:247], v[76:79], v[36:39], v[244:247]
v_mfma_f32_16x16x32_bf16 v[240:243], v[76:79], v[32:35], v[240:243]
s_waitcnt lgkmcnt(0)
s_barrier
v_mfma_f32_16x16x32_bf16 v[128:131], v[96:99], v[80:83], v[128:131]
ds_read_b128 v[32:35], v4 offset:0
v_mfma_f32_16x16x32_bf16 v[132:135], v[96:99], v[84:87], v[132:135]
ds_read_b64_tr_b16 v[48:49], v13 offset:16384
v_mfma_f32_16x16x32_bf16 v[136:139], v[96:99], v[88:91], v[136:139]
ds_read_b64_tr_b16 v[50:51], v13 offset:20480
v_mfma_f32_16x16x32_bf16 v[140:143], v[96:99], v[92:95], v[140:143]
ds_read_b128 v[36:39], v4 offset:256
v_mfma_f32_16x16x32_bf16 v[204:207], v[112:115], v[92:95], v[204:207]
ds_read_b128 v[40:43], v4 offset:512
v_mfma_f32_16x16x32_bf16 v[200:203], v[112:115], v[88:91], v[200:203]
ds_read_b128 v[44:47], v4 offset:768
v_mfma_f32_16x16x32_bf16 v[196:199], v[112:115], v[84:87], v[196:199]
ds_read_b64_tr_b16 v[64:65], v13 offset:32768
v_mfma_f32_16x16x32_bf16 v[192:195], v[112:115], v[80:83], v[192:195]
ds_read_b64_tr_b16 v[66:67], v13 offset:36864
v_mfma_f32_16x16x32_bf16 v[144:147], v[100:103], v[80:83], v[144:147]
ds_read_b64_tr_b16 v[52:53], v14 offset:16384
v_mfma_f32_16x16x32_bf16 v[148:151], v[100:103], v[84:87], v[148:151]
ds_read_b64_tr_b16 v[54:55], v14 offset:20480
v_mfma_f32_16x16x32_bf16 v[152:155], v[100:103], v[88:91], v[152:155]
ds_read_b64_tr_b16 v[68:69], v14 offset:32768
v_mfma_f32_16x16x32_bf16 v[156:159], v[100:103], v[92:95], v[156:159]
ds_read_b64_tr_b16 v[70:71], v14 offset:36864
v_mfma_f32_16x16x32_bf16 v[220:223], v[116:119], v[92:95], v[220:223]
ds_read_b64_tr_b16 v[56:57], v15 offset:16384
v_mfma_f32_16x16x32_bf16 v[216:219], v[116:119], v[88:91], v[216:219]
ds_read_b64_tr_b16 v[58:59], v15 offset:20480
v_mfma_f32_16x16x32_bf16 v[212:215], v[116:119], v[84:87], v[212:215]
ds_read_b64_tr_b16 v[72:73], v15 offset:32768
v_mfma_f32_16x16x32_bf16 v[208:211], v[116:119], v[80:83], v[208:211]
ds_read_b64_tr_b16 v[74:75], v15 offset:36864
v_mfma_f32_16x16x32_bf16 v[160:163], v[104:107], v[80:83], v[160:163]
ds_read_b64_tr_b16 v[60:61], v16 offset:16384
v_mfma_f32_16x16x32_bf16 v[164:167], v[104:107], v[84:87], v[164:167]
ds_read_b64_tr_b16 v[62:63], v16 offset:20480
v_mfma_f32_16x16x32_bf16 v[168:171], v[104:107], v[88:91], v[168:171]
ds_read_b64_tr_b16 v[76:77], v16 offset:32768
v_mfma_f32_16x16x32_bf16 v[172:175], v[104:107], v[92:95], v[172:175]
ds_read_b64_tr_b16 v[78:79], v16 offset:36864
v_mfma_f32_16x16x32_bf16 v[236:239], v[120:123], v[92:95], v[236:239]
v_mfma_f32_16x16x32_bf16 v[232:235], v[120:123], v[88:91], v[232:235]
v_mfma_f32_16x16x32_bf16 v[228:231], v[120:123], v[84:87], v[228:231]
v_mfma_f32_16x16x32_bf16 v[224:227], v[120:123], v[80:83], v[224:227]
v_mfma_f32_16x16x32_bf16 v[176:179], v[108:111], v[80:83], v[176:179]
v_mfma_f32_16x16x32_bf16 v[180:183], v[108:111], v[84:87], v[180:183]
v_mfma_f32_16x16x32_bf16 v[184:187], v[108:111], v[88:91], v[184:187]
v_mfma_f32_16x16x32_bf16 v[188:191], v[108:111], v[92:95], v[188:191]
v_mfma_f32_16x16x32_bf16 v[252:255], v[124:127], v[92:95], v[252:255]
v_mfma_f32_16x16x32_bf16 v[248:251], v[124:127], v[88:91], v[248:251]
v_mfma_f32_16x16x32_bf16 v[244:247], v[124:127], v[84:87], v[244:247]
v_mfma_f32_16x16x32_bf16 v[240:243], v[124:127], v[80:83], v[240:243]
s_waitcnt lgkmcnt(0)
v_mfma_f32_16x16x32_bf16 v[128:131], v[48:51], v[32:35], v[128:131]
ds_read_b128 v[80:83], v4 offset:8192
v_mfma_f32_16x16x32_bf16 v[132:135], v[48:51], v[36:39], v[132:135]
ds_read_b64_tr_b16 v[96:97], v13 offset:24576
v_mfma_f32_16x16x32_bf16 v[136:139], v[48:51], v[40:43], v[136:139]
ds_read_b64_tr_b16 v[98:99], v13 offset:28672
v_mfma_f32_16x16x32_bf16 v[140:143], v[48:51], v[44:47], v[140:143]
ds_read_b128 v[84:87], v4 offset:8448
v_mfma_f32_16x16x32_bf16 v[204:207], v[64:67], v[44:47], v[204:207]
ds_read_b128 v[88:91], v4 offset:8704
v_mfma_f32_16x16x32_bf16 v[200:203], v[64:67], v[40:43], v[200:203]
ds_read_b128 v[92:95], v4 offset:8960
v_mfma_f32_16x16x32_bf16 v[196:199], v[64:67], v[36:39], v[196:199]
ds_read_b64_tr_b16 v[112:113], v13 offset:40960
v_mfma_f32_16x16x32_bf16 v[192:195], v[64:67], v[32:35], v[192:195]
ds_read_b64_tr_b16 v[114:115], v13 offset:45056
v_mfma_f32_16x16x32_bf16 v[144:147], v[52:55], v[32:35], v[144:147]
ds_read_b64_tr_b16 v[100:101], v14 offset:24576
v_mfma_f32_16x16x32_bf16 v[148:151], v[52:55], v[36:39], v[148:151]
ds_read_b64_tr_b16 v[102:103], v14 offset:28672
v_mfma_f32_16x16x32_bf16 v[152:155], v[52:55], v[40:43], v[152:155]
ds_read_b64_tr_b16 v[116:117], v14 offset:40960
v_mfma_f32_16x16x32_bf16 v[156:159], v[52:55], v[44:47], v[156:159]
ds_read_b64_tr_b16 v[118:119], v14 offset:45056
v_mfma_f32_16x16x32_bf16 v[220:223], v[68:71], v[44:47], v[220:223]
ds_read_b64_tr_b16 v[104:105], v15 offset:24576
v_mfma_f32_16x16x32_bf16 v[216:219], v[68:71], v[40:43], v[216:219]
ds_read_b64_tr_b16 v[106:107], v15 offset:28672
v_mfma_f32_16x16x32_bf16 v[212:215], v[68:71], v[36:39], v[212:215]
ds_read_b64_tr_b16 v[120:121], v15 offset:40960
v_mfma_f32_16x16x32_bf16 v[208:211], v[68:71], v[32:35], v[208:211]
ds_read_b64_tr_b16 v[122:123], v15 offset:45056
v_mfma_f32_16x16x32_bf16 v[160:163], v[56:59], v[32:35], v[160:163]
ds_read_b64_tr_b16 v[108:109], v16 offset:24576
v_mfma_f32_16x16x32_bf16 v[164:167], v[56:59], v[36:39], v[164:167]
ds_read_b64_tr_b16 v[110:111], v16 offset:28672
v_mfma_f32_16x16x32_bf16 v[168:171], v[56:59], v[40:43], v[168:171]
ds_read_b64_tr_b16 v[124:125], v16 offset:40960
v_mfma_f32_16x16x32_bf16 v[172:175], v[56:59], v[44:47], v[172:175]
ds_read_b64_tr_b16 v[126:127], v16 offset:45056
v_mfma_f32_16x16x32_bf16 v[236:239], v[72:75], v[44:47], v[236:239]
v_mfma_f32_16x16x32_bf16 v[232:235], v[72:75], v[40:43], v[232:235]
v_mfma_f32_16x16x32_bf16 v[228:231], v[72:75], v[36:39], v[228:231]
v_mfma_f32_16x16x32_bf16 v[224:227], v[72:75], v[32:35], v[224:227]
v_mfma_f32_16x16x32_bf16 v[176:179], v[60:63], v[32:35], v[176:179]
v_mfma_f32_16x16x32_bf16 v[180:183], v[60:63], v[36:39], v[180:183]
v_mfma_f32_16x16x32_bf16 v[184:187], v[60:63], v[40:43], v[184:187]
v_mfma_f32_16x16x32_bf16 v[188:191], v[60:63], v[44:47], v[188:191]
v_mfma_f32_16x16x32_bf16 v[252:255], v[76:79], v[44:47], v[252:255]
v_mfma_f32_16x16x32_bf16 v[248:251], v[76:79], v[40:43], v[248:251]
v_mfma_f32_16x16x32_bf16 v[244:247], v[76:79], v[36:39], v[244:247]
v_mfma_f32_16x16x32_bf16 v[240:243], v[76:79], v[32:35], v[240:243]
s_waitcnt lgkmcnt(0)
s_barrier
v_mfma_f32_16x16x32_bf16 v[128:131], v[96:99], v[80:83], v[128:131]
ds_read_b128 v[32:35], v2 offset:0
v_mfma_f32_16x16x32_bf16 v[132:135], v[96:99], v[84:87], v[132:135]
ds_read_b64_tr_b16 v[48:49], v5 offset:16384
v_mfma_f32_16x16x32_bf16 v[136:139], v[96:99], v[88:91], v[136:139]
ds_read_b64_tr_b16 v[50:51], v5 offset:20480
v_mfma_f32_16x16x32_bf16 v[140:143], v[96:99], v[92:95], v[140:143]
ds_read_b128 v[36:39], v2 offset:256
v_mfma_f32_16x16x32_bf16 v[204:207], v[112:115], v[92:95], v[204:207]
ds_read_b128 v[40:43], v2 offset:512
v_mfma_f32_16x16x32_bf16 v[200:203], v[112:115], v[88:91], v[200:203]
ds_read_b128 v[44:47], v2 offset:768
v_mfma_f32_16x16x32_bf16 v[196:199], v[112:115], v[84:87], v[196:199]
ds_read_b64_tr_b16 v[64:65], v5 offset:32768
v_mfma_f32_16x16x32_bf16 v[192:195], v[112:115], v[80:83], v[192:195]
ds_read_b64_tr_b16 v[66:67], v5 offset:36864
v_mfma_f32_16x16x32_bf16 v[144:147], v[100:103], v[80:83], v[144:147]
ds_read_b64_tr_b16 v[52:53], v6 offset:16384
v_mfma_f32_16x16x32_bf16 v[148:151], v[100:103], v[84:87], v[148:151]
ds_read_b64_tr_b16 v[54:55], v6 offset:20480
v_mfma_f32_16x16x32_bf16 v[152:155], v[100:103], v[88:91], v[152:155]
ds_read_b64_tr_b16 v[68:69], v6 offset:32768
v_mfma_f32_16x16x32_bf16 v[156:159], v[100:103], v[92:95], v[156:159]
ds_read_b64_tr_b16 v[70:71], v6 offset:36864
v_mfma_f32_16x16x32_bf16 v[220:223], v[116:119], v[92:95], v[220:223]
ds_read_b64_tr_b16 v[56:57], v7 offset:16384
v_mfma_f32_16x16x32_bf16 v[216:219], v[116:119], v[88:91], v[216:219]
ds_read_b64_tr_b16 v[58:59], v7 offset:20480
v_mfma_f32_16x16x32_bf16 v[212:215], v[116:119], v[84:87], v[212:215]
ds_read_b64_tr_b16 v[72:73], v7 offset:32768
v_mfma_f32_16x16x32_bf16 v[208:211], v[116:119], v[80:83], v[208:211]
ds_read_b64_tr_b16 v[74:75], v7 offset:36864
v_mfma_f32_16x16x32_bf16 v[160:163], v[104:107], v[80:83], v[160:163]
ds_read_b64_tr_b16 v[60:61], v8 offset:16384
v_mfma_f32_16x16x32_bf16 v[164:167], v[104:107], v[84:87], v[164:167]
ds_read_b64_tr_b16 v[62:63], v8 offset:20480
v_mfma_f32_16x16x32_bf16 v[168:171], v[104:107], v[88:91], v[168:171]
ds_read_b64_tr_b16 v[76:77], v8 offset:32768
v_mfma_f32_16x16x32_bf16 v[172:175], v[104:107], v[92:95], v[172:175]
ds_read_b64_tr_b16 v[78:79], v8 offset:36864
v_mfma_f32_16x16x32_bf16 v[236:239], v[120:123], v[92:95], v[236:239]
v_mfma_f32_16x16x32_bf16 v[232:235], v[120:123], v[88:91], v[232:235]
v_mfma_f32_16x16x32_bf16 v[228:231], v[120:123], v[84:87], v[228:231]
v_mfma_f32_16x16x32_bf16 v[224:227], v[120:123], v[80:83], v[224:227]
v_mfma_f32_16x16x32_bf16 v[176:179], v[108:111], v[80:83], v[176:179]
v_mfma_f32_16x16x32_bf16 v[180:183], v[108:111], v[84:87], v[180:183]
v_mfma_f32_16x16x32_bf16 v[184:187], v[108:111], v[88:91], v[184:187]
v_mfma_f32_16x16x32_bf16 v[188:191], v[108:111], v[92:95], v[188:191]
v_mfma_f32_16x16x32_bf16 v[252:255], v[124:127], v[92:95], v[252:255]
v_mfma_f32_16x16x32_bf16 v[248:251], v[124:127], v[88:91], v[248:251]
v_mfma_f32_16x16x32_bf16 v[244:247], v[124:127], v[84:87], v[244:247]
v_mfma_f32_16x16x32_bf16 v[240:243], v[124:127], v[80:83], v[240:243]
s_sub_u32 s41, s41, 1
s_cmp_lg_u32 s41, 0
s_cbranch_scc1 Lk3_26
s_waitcnt lgkmcnt(0)
v_mfma_f32_16x16x32_bf16 v[128:131], v[48:51], v[32:35], v[128:131]
ds_read_b128 v[80:83], v2 offset:8192
v_mfma_f32_16x16x32_bf16 v[132:135], v[48:51], v[36:39], v[132:135]
ds_read_b64_tr_b16 v[96:97], v5 offset:24576
v_mfma_f32_16x16x32_bf16 v[136:139], v[48:51], v[40:43], v[136:139]
ds_read_b64_tr_b16 v[98:99], v5 offset:28672
v_mfma_f32_16x16x32_bf16 v[140:143], v[48:51], v[44:47], v[140:143]
ds_read_b128 v[84:87], v2 offset:8448
v_mfma_f32_16x16x32_bf16 v[204:207], v[64:67], v[44:47], v[204:207]
ds_read_b128 v[88:91], v2 offset:8704
v_mfma_f32_16x16x32_bf16 v[200:203], v[64:67], v[40:43], v[200:203]
ds_read_b128 v[92:95], v2 offset:8960
v_mfma_f32_16x16x32_bf16 v[196:199], v[64:67], v[36:39], v[196:199]
ds_read_b64_tr_b16 v[112:113], v5 offset:40960
v_mfma_f32_16x16x32_bf16 v[192:195], v[64:67], v[32:35], v[192:195]
ds_read_b64_tr_b16 v[114:115], v5 offset:45056
v_mfma_f32_16x16x32_bf16 v[144:147], v[52:55], v[32:35], v[144:147]
ds_read_b64_tr_b16 v[100:101], v6 offset:24576
v_mfma_f32_16x16x32_bf16 v[148:151], v[52:55], v[36:39], v[148:151]
ds_read_b64_tr_b16 v[102:103], v6 offset:28672
v_mfma_f32_16x16x32_bf16 v[152:155], v[52:55], v[40:43], v[152:155]
ds_read_b64_tr_b16 v[116:117], v6 offset:40960
v_mfma_f32_16x16x32_bf16 v[156:159], v[52:55], v[44:47], v[156:159]
ds_read_b64_tr_b16 v[118:119], v6 offset:45056
v_mfma_f32_16x16x32_bf16 v[220:223], v[68:71], v[44:47], v[220:223]
ds_read_b64_tr_b16 v[104:105], v7 offset:24576
v_mfma_f32_16x16x32_bf16 v[216:219], v[68:71], v[40:43], v[216:219]
ds_read_b64_tr_b16 v[106:107], v7 offset:28672
v_mfma_f32_16x16x32_bf16 v[212:215], v[68:71], v[36:39], v[212:215]
ds_read_b64_tr_b16 v[120:121], v7 offset:40960
v_mfma_f32_16x16x32_bf16 v[208:211], v[68:71], v[32:35], v[208:211]
ds_read_b64_tr_b16 v[122:123], v7 offset:45056
v_mfma_f32_16x16x32_bf16 v[160:163], v[56:59], v[32:35], v[160:163]
ds_read_b64_tr_b16 v[108:109], v8 offset:24576
v_mfma_f32_16x16x32_bf16 v[164:167], v[56:59], v[36:39], v[164:167]
ds_read_b64_tr_b16 v[110:111], v8 offset:28672
v_mfma_f32_16x16x32_bf16 v[168:171], v[56:59], v[40:43], v[168:171]
ds_read_b64_tr_b16 v[124:125], v8 offset:40960
v_mfma_f32_16x16x32_bf16 v[172:175], v[56:59], v[44:47], v[172:175]
ds_read_b64_tr_b16 v[126:127], v8 offset:45056
v_mfma_f32_16x16x32_bf16 v[236:239], v[72:75], v[44:47], v[236:239]
v_mfma_f32_16x16x32_bf16 v[232:235], v[72:75], v[40:43], v[232:235]
v_mfma_f32_16x16x32_bf16 v[228:231], v[72:75], v[36:39], v[228:231]
v_mfma_f32_16x16x32_bf16 v[224:227], v[72:75], v[32:35], v[224:227]
v_mfma_f32_16x16x32_bf16 v[176:179], v[60:63], v[32:35], v[176:179]
v_mfma_f32_16x16x32_bf16 v[180:183], v[60:63], v[36:39], v[180:183]
v_mfma_f32_16x16x32_bf16 v[184:187], v[60:63], v[40:43], v[184:187]
v_mfma_f32_16x16x32_bf16 v[188:191], v[60:63], v[44:47], v[188:191]
v_mfma_f32_16x16x32_bf16 v[252:255], v[76:79], v[44:47], v[252:255]
v_mfma_f32_16x16x32_bf16 v[248:251], v[76:79], v[40:43], v[248:251]
v_mfma_f32_16x16x32_bf16 v[244:247], v[76:79], v[36:39], v[244:247]
v_mfma_f32_16x16x32_bf16 v[240:243], v[76:79], v[32:35], v[240:243]
s_waitcnt lgkmcnt(0)
s_barrier
v_mfma_f32_16x16x32_bf16 v[128:131], v[96:99], v[80:83], v[128:131]
ds_read_b128 v[32:35], v3 offset:0
v_mfma_f32_16x16x32_bf16 v[132:135], v[96:99], v[84:87], v[132:135]
ds_read_b64_tr_b16 v[48:49], v9 offset:16384
v_mfma_f32_16x16x32_bf16 v[136:139], v[96:99], v[88:91], v[136:139]
ds_read_b64_tr_b16 v[50:51], v9 offset:20480
v_mfma_f32_16x16x32_bf16 v[140:143], v[96:99], v[92:95], v[140:143]
ds_read_b128 v[36:39], v3 offset:256
v_mfma_f32_16x16x32_bf16 v[204:207], v[112:115], v[92:95], v[204:207]
ds_read_b128 v[40:43], v3 offset:512
v_mfma_f32_16x16x32_bf16 v[200:203], v[112:115], v[88:91], v[200:203]
ds_read_b128 v[44:47], v3 offset:768
v_mfma_f32_16x16x32_bf16 v[196:199], v[112:115], v[84:87], v[196:199]
ds_read_b64_tr_b16 v[64:65], v9 offset:32768
v_mfma_f32_16x16x32_bf16 v[192:195], v[112:115], v[80:83], v[192:195]
ds_read_b64_tr_b16 v[66:67], v9 offset:36864
v_mfma_f32_16x16x32_bf16 v[144:147], v[100:103], v[80:83], v[144:147]
ds_read_b64_tr_b16 v[52:53], v10 offset:16384
v_mfma_f32_16x16x32_bf16 v[148:151], v[100:103], v[84:87], v[148:151]
ds_read_b64_tr_b16 v[54:55], v10 offset:20480
v_mfma_f32_16x16x32_bf16 v[152:155], v[100:103], v[88:91], v[152:155]
ds_read_b64_tr_b16 v[68:69], v10 offset:32768
v_mfma_f32_16x16x32_bf16 v[156:159], v[100:103], v[92:95], v[156:159]
ds_read_b64_tr_b16 v[70:71], v10 offset:36864
v_mfma_f32_16x16x32_bf16 v[220:223], v[116:119], v[92:95], v[220:223]
ds_read_b64_tr_b16 v[56:57], v11 offset:16384
v_mfma_f32_16x16x32_bf16 v[216:219], v[116:119], v[88:91], v[216:219]
ds_read_b64_tr_b16 v[58:59], v11 offset:20480
v_mfma_f32_16x16x32_bf16 v[212:215], v[116:119], v[84:87], v[212:215]
ds_read_b64_tr_b16 v[72:73], v11 offset:32768
v_mfma_f32_16x16x32_bf16 v[208:211], v[116:119], v[80:83], v[208:211]
ds_read_b64_tr_b16 v[74:75], v11 offset:36864
v_mfma_f32_16x16x32_bf16 v[160:163], v[104:107], v[80:83], v[160:163]
ds_read_b64_tr_b16 v[60:61], v12 offset:16384
v_mfma_f32_16x16x32_bf16 v[164:167], v[104:107], v[84:87], v[164:167]
ds_read_b64_tr_b16 v[62:63], v12 offset:20480
v_mfma_f32_16x16x32_bf16 v[168:171], v[104:107], v[88:91], v[168:171]
ds_read_b64_tr_b16 v[76:77], v12 offset:32768
v_mfma_f32_16x16x32_bf16 v[172:175], v[104:107], v[92:95], v[172:175]
ds_read_b64_tr_b16 v[78:79], v12 offset:36864
v_mfma_f32_16x16x32_bf16 v[236:239], v[120:123], v[92:95], v[236:239]
v_mfma_f32_16x16x32_bf16 v[232:235], v[120:123], v[88:91], v[232:235]
v_mfma_f32_16x16x32_bf16 v[228:231], v[120:123], v[84:87], v[228:231]
v_mfma_f32_16x16x32_bf16 v[224:227], v[120:123], v[80:83], v[224:227]
v_mfma_f32_16x16x32_bf16 v[176:179], v[108:111], v[80:83], v[176:179]
v_mfma_f32_16x16x32_bf16 v[180:183], v[108:111], v[84:87], v[180:183]
v_mfma_f32_16x16x32_bf16 v[184:187], v[108:111], v[88:91], v[184:187]
v_mfma_f32_16x16x32_bf16 v[188:191], v[108:111], v[92:95], v[188:191]
v_mfma_f32_16x16x32_bf16 v[252:255], v[124:127], v[92:95], v[252:255]
v_mfma_f32_16x16x32_bf16 v[248:251], v[124:127], v[88:91], v[248:251]
v_mfma_f32_16x16x32_bf16 v[244:247], v[124:127], v[84:87], v[244:247]
v_mfma_f32_16x16x32_bf16 v[240:243], v[124:127], v[80:83], v[240:243]
s_waitcnt lgkmcnt(0)
v_mfma_f32_16x16x32_bf16 v[128:131], v[48:51], v[32:35], v[128:131]
ds_read_b128 v[80:83], v3 offset:8192
v_mfma_f32_16x16x32_bf16 v[132:135], v[48:51], v[36:39], v[132:135]
ds_read_b64_tr_b16 v[96:97], v9 offset:24576
v_mfma_f32_16x16x32_bf16 v[136:139], v[48:51], v[40:43], v[136:139]
ds_read_b64_tr_b16 v[98:99], v9 offset:28672
v_mfma_f32_16x16x32_bf16 v[140:143], v[48:51], v[44:47], v[140:143]
ds_read_b128 v[84:87], v3 offset:8448
v_mfma_f32_16x16x32_bf16 v[204:207], v[64:67], v[44:47], v[204:207]
ds_read_b128 v[88:91], v3 offset:8704
v_mfma_f32_16x16x32_bf16 v[200:203], v[64:67], v[40:43], v[200:203]
ds_read_b128 v[92:95], v3 offset:8960
v_mfma_f32_16x16x32_bf16 v[196:199], v[64:67], v[36:39], v[196:199]
ds_read_b64_tr_b16 v[112:113], v9 offset:40960
v_mfma_f32_16x16x32_bf16 v[192:195], v[64:67], v[32:35], v[192:195]
ds_read_b64_tr_b16 v[114:115], v9 offset:45056
v_mfma_f32_16x16x32_bf16 v[144:147], v[52:55], v[32:35], v[144:147]
ds_read_b64_tr_b16 v[100:101], v10 offset:24576
v_mfma_f32_16x16x32_bf16 v[148:151], v[52:55], v[36:39], v[148:151]
ds_read_b64_tr_b16 v[102:103], v10 offset:28672
v_mfma_f32_16x16x32_bf16 v[152:155], v[52:55], v[40:43], v[152:155]
ds_read_b64_tr_b16 v[116:117], v10 offset:40960
v_mfma_f32_16x16x32_bf16 v[156:159], v[52:55], v[44:47], v[156:159]
ds_read_b64_tr_b16 v[118:119], v10 offset:45056
v_mfma_f32_16x16x32_bf16 v[220:223], v[68:71], v[44:47], v[220:223]
ds_read_b64_tr_b16 v[104:105], v11 offset:24576
v_mfma_f32_16x16x32_bf16 v[216:219], v[68:71], v[40:43], v[216:219]
ds_read_b64_tr_b16 v[106:107], v11 offset:28672
v_mfma_f32_16x16x32_bf16 v[212:215], v[68:71], v[36:39], v[212:215]
ds_read_b64_tr_b16 v[120:121], v11 offset:40960
v_mfma_f32_16x16x32_bf16 v[208:211], v[68:71], v[32:35], v[208:211]
ds_read_b64_tr_b16 v[122:123], v11 offset:45056
v_mfma_f32_16x16x32_bf16 v[160:163], v[56:59], v[32:35], v[160:163]
ds_read_b64_tr_b16 v[108:109], v12 offset:24576
v_mfma_f32_16x16x32_bf16 v[164:167], v[56:59], v[36:39], v[164:167]
ds_read_b64_tr_b16 v[110:111], v12 offset:28672
v_mfma_f32_16x16x32_bf16 v[168:171], v[56:59], v[40:43], v[168:171]
ds_read_b64_tr_b16 v[124:125], v12 offset:40960
v_mfma_f32_16x16x32_bf16 v[172:175], v[56:59], v[44:47], v[172:175]
ds_read_b64_tr_b16 v[126:127], v12 offset:45056
v_mfma_f32_16x16x32_bf16 v[236:239], v[72:75], v[44:47], v[236:239]
v_mfma_f32_16x16x32_bf16 v[232:235], v[72:75], v[40:43], v[232:235]
v_mfma_f32_16x16x32_bf16 v[228:231], v[72:75], v[36:39], v[228:231]
v_mfma_f32_16x16x32_bf16 v[224:227], v[72:75], v[32:35], v[224:227]
v_mfma_f32_16x16x32_bf16 v[176:179], v[60:63], v[32:35], v[176:179]
v_mfma_f32_16x16x32_bf16 v[180:183], v[60:63], v[36:39], v[180:183]
v_mfma_f32_16x16x32_bf16 v[184:187], v[60:63], v[40:43], v[184:187]
v_mfma_f32_16x16x32_bf16 v[188:191], v[60:63], v[44:47], v[188:191]
v_mfma_f32_16x16x32_bf16 v[252:255], v[76:79], v[44:47], v[252:255]
v_mfma_f32_16x16x32_bf16 v[248:251], v[76:79], v[40:43], v[248:251]
v_mfma_f32_16x16x32_bf16 v[244:247], v[76:79], v[36:39], v[244:247]
v_mfma_f32_16x16x32_bf16 v[240:243], v[76:79], v[32:35], v[240:243]
s_waitcnt lgkmcnt(0)
s_barrier
v_mfma_f32_16x16x32_bf16 v[128:131], v[96:99], v[80:83], v[128:131]
ds_read_b128 v[32:35], v4 offset:0
v_mfma_f32_16x16x32_bf16 v[132:135], v[96:99], v[84:87], v[132:135]
ds_read_b64_tr_b16 v[48:49], v13 offset:16384
v_mfma_f32_16x16x32_bf16 v[136:139], v[96:99], v[88:91], v[136:139]
ds_read_b64_tr_b16 v[50:51], v13 offset:20480
v_mfma_f32_16x16x32_bf16 v[140:143], v[96:99], v[92:95], v[140:143]
ds_read_b128 v[36:39], v4 offset:256
v_mfma_f32_16x16x32_bf16 v[204:207], v[112:115], v[92:95], v[204:207]
ds_read_b128 v[40:43], v4 offset:512
v_mfma_f32_16x16x32_bf16 v[200:203], v[112:115], v[88:91], v[200:203]
ds_read_b128 v[44:47], v4 offset:768
v_mfma_f32_16x16x32_bf16 v[196:199], v[112:115], v[84:87], v[196:199]
ds_read_b64_tr_b16 v[64:65], v13 offset:32768
v_mfma_f32_16x16x32_bf16 v[192:195], v[112:115], v[80:83], v[192:195]
ds_read_b64_tr_b16 v[66:67], v13 offset:36864
v_mfma_f32_16x16x32_bf16 v[144:147], v[100:103], v[80:83], v[144:147]
ds_read_b64_tr_b16 v[52:53], v14 offset:16384
v_mfma_f32_16x16x32_bf16 v[148:151], v[100:103], v[84:87], v[148:151]
ds_read_b64_tr_b16 v[54:55], v14 offset:20480
v_mfma_f32_16x16x32_bf16 v[152:155], v[100:103], v[88:91], v[152:155]
ds_read_b64_tr_b16 v[68:69], v14 offset:32768
v_mfma_f32_16x16x32_bf16 v[156:159], v[100:103], v[92:95], v[156:159]
ds_read_b64_tr_b16 v[70:71], v14 offset:36864
v_mfma_f32_16x16x32_bf16 v[220:223], v[116:119], v[92:95], v[220:223]
ds_read_b64_tr_b16 v[56:57], v15 offset:16384
v_mfma_f32_16x16x32_bf16 v[216:219], v[116:119], v[88:91], v[216:219]
ds_read_b64_tr_b16 v[58:59], v15 offset:20480
v_mfma_f32_16x16x32_bf16 v[212:215], v[116:119], v[84:87], v[212:215]
ds_read_b64_tr_b16 v[72:73], v15 offset:32768
v_mfma_f32_16x16x32_bf16 v[208:211], v[116:119], v[80:83], v[208:211]
ds_read_b64_tr_b16 v[74:75], v15 offset:36864
v_mfma_f32_16x16x32_bf16 v[160:163], v[104:107], v[80:83], v[160:163]
ds_read_b64_tr_b16 v[60:61], v16 offset:16384
v_mfma_f32_16x16x32_bf16 v[164:167], v[104:107], v[84:87], v[164:167]
ds_read_b64_tr_b16 v[62:63], v16 offset:20480
v_mfma_f32_16x16x32_bf16 v[168:171], v[104:107], v[88:91], v[168:171]
ds_read_b64_tr_b16 v[76:77], v16 offset:32768
v_mfma_f32_16x16x32_bf16 v[172:175], v[104:107], v[92:95], v[172:175]
ds_read_b64_tr_b16 v[78:79], v16 offset:36864
v_mfma_f32_16x16x32_bf16 v[236:239], v[120:123], v[92:95], v[236:239]
v_mfma_f32_16x16x32_bf16 v[232:235], v[120:123], v[88:91], v[232:235]
v_mfma_f32_16x16x32_bf16 v[228:231], v[120:123], v[84:87], v[228:231]
v_mfma_f32_16x16x32_bf16 v[224:227], v[120:123], v[80:83], v[224:227]
v_mfma_f32_16x16x32_bf16 v[176:179], v[108:111], v[80:83], v[176:179]
v_mfma_f32_16x16x32_bf16 v[180:183], v[108:111], v[84:87], v[180:183]
v_mfma_f32_16x16x32_bf16 v[184:187], v[108:111], v[88:91], v[184:187]
v_mfma_f32_16x16x32_bf16 v[188:191], v[108:111], v[92:95], v[188:191]
v_mfma_f32_16x16x32_bf16 v[252:255], v[124:127], v[92:95], v[252:255]
v_mfma_f32_16x16x32_bf16 v[248:251], v[124:127], v[88:91], v[248:251]
v_mfma_f32_16x16x32_bf16 v[244:247], v[124:127], v[84:87], v[244:247]
v_mfma_f32_16x16x32_bf16 v[240:243], v[124:127], v[80:83], v[240:243]
s_waitcnt lgkmcnt(0)
v_mfma_f32_16x16x32_bf16 v[128:131], v[48:51], v[32:35], v[128:131]
ds_read_b128 v[80:83], v4 offset:8192
v_mfma_f32_16x16x32_bf16 v[132:135], v[48:51], v[36:39], v[132:135]
ds_read_b64_tr_b16 v[96:97], v13 offset:24576
v_mfma_f32_16x16x32_bf16 v[136:139], v[48:51], v[40:43], v[136:139]
ds_read_b64_tr_b16 v[98:99], v13 offset:28672
v_mfma_f32_16x16x32_bf16 v[140:143], v[48:51], v[44:47], v[140:143]
ds_read_b128 v[84:87], v4 offset:8448
v_mfma_f32_16x16x32_bf16 v[204:207], v[64:67], v[44:47], v[204:207]
ds_read_b128 v[88:91], v4 offset:8704
v_mfma_f32_16x16x32_bf16 v[200:203], v[64:67], v[40:43], v[200:203]
ds_read_b128 v[92:95], v4 offset:8960
v_mfma_f32_16x16x32_bf16 v[196:199], v[64:67], v[36:39], v[196:199]
ds_read_b64_tr_b16 v[112:113], v13 offset:40960
v_mfma_f32_16x16x32_bf16 v[192:195], v[64:67], v[32:35], v[192:195]
ds_read_b64_tr_b16 v[114:115], v13 offset:45056
v_mfma_f32_16x16x32_bf16 v[144:147], v[52:55], v[32:35], v[144:147]
ds_read_b64_tr_b16 v[100:101], v14 offset:24576
v_mfma_f32_16x16x32_bf16 v[148:151], v[52:55], v[36:39], v[148:151]
ds_read_b64_tr_b16 v[102:103], v14 offset:28672
v_mfma_f32_16x16x32_bf16 v[152:155], v[52:55], v[40:43], v[152:155]
ds_read_b64_tr_b16 v[116:117], v14 offset:40960
v_mfma_f32_16x16x32_bf16 v[156:159], v[52:55], v[44:47], v[156:159]
ds_read_b64_tr_b16 v[118:119], v14 offset:45056
v_mfma_f32_16x16x32_bf16 v[220:223], v[68:71], v[44:47], v[220:223]
ds_read_b64_tr_b16 v[104:105], v15 offset:24576
v_mfma_f32_16x16x32_bf16 v[216:219], v[68:71], v[40:43], v[216:219]
ds_read_b64_tr_b16 v[106:107], v15 offset:28672
v_mfma_f32_16x16x32_bf16 v[212:215], v[68:71], v[36:39], v[212:215]
ds_read_b64_tr_b16 v[120:121], v15 offset:40960
v_mfma_f32_16x16x32_bf16 v[208:211], v[68:71], v[32:35], v[208:211]
ds_read_b64_tr_b16 v[122:123], v15 offset:45056
v_mfma_f32_16x16x32_bf16 v[160:163], v[56:59], v[32:35], v[160:163]
ds_read_b64_tr_b16 v[108:109], v16 offset:24576
v_mfma_f32_16x16x32_bf16 v[164:167], v[56:59], v[36:39], v[164:167]
ds_read_b64_tr_b16 v[110:111], v16 offset:28672
v_mfma_f32_16x16x32_bf16 v[168:171], v[56:59], v[40:43], v[168:171]
ds_read_b64_tr_b16 v[124:125], v16 offset:40960
v_mfma_f32_16x16x32_bf16 v[172:175], v[56:59], v[44:47], v[172:175]
ds_read_b64_tr_b16 v[126:127], v16 offset:45056
v_mfma_f32_16x16x32_bf16 v[236:239], v[72:75], v[44:47], v[236:239]
v_mfma_f32_16x16x32_bf16 v[232:235], v[72:75], v[40:43], v[232:235]
v_mfma_f32_16x16x32_bf16 v[228:231], v[72:75], v[36:39], v[228:231]
v_mfma_f32_16x16x32_bf16 v[224:227], v[72:75], v[32:35], v[224:227]
v_mfma_f32_16x16x32_bf16 v[176:179], v[60:63], v[32:35], v[176:179]
v_mfma_f32_16x16x32_bf16 v[180:183], v[60:63], v[36:39], v[180:183]
v_mfma_f32_16x16x32_bf16 v[184:187], v[60:63], v[40:43], v[184:187]
v_mfma_f32_16x16x32_bf16 v[188:191], v[60:63], v[44:47], v[188:191]
v_mfma_f32_16x16x32_bf16 v[252:255], v[76:79], v[44:47], v[252:255]
v_mfma_f32_16x16x32_bf16 v[248:251], v[76:79], v[40:43], v[248:251]
v_mfma_f32_16x16x32_bf16 v[244:247], v[76:79], v[36:39], v[244:247]
v_mfma_f32_16x16x32_bf16 v[240:243], v[76:79], v[32:35], v[240:243]
s_waitcnt lgkmcnt(0)
s_barrier
s_cmp_eq_u32 s36, 3
s_cbranch_scc1 L3h_27
s_add_u32 s42, s42, 1
s_and_b32 s42, s42, 15
s_add_u32 m0, s39, 98304
s_mul_i32 s37, s42, s40
buffer_load_dwordx4 v22, s[8:11], s37 offen sc1 lds
v_mfma_f32_16x16x32_bf16 v[128:131], v[96:99], v[80:83], v[128:131]
v_mfma_f32_16x16x32_bf16 v[132:135], v[96:99], v[84:87], v[132:135]
s_add_u32 m0, s39, 99328
s_add_u32 s37, s37, s38
buffer_load_dwordx4 v23, s[8:11], s37 offen sc1 lds
v_mfma_f32_16x16x32_bf16 v[136:139], v[96:99], v[88:91], v[136:139]
v_mfma_f32_16x16x32_bf16 v[140:143], v[96:99], v[92:95], v[140:143]
s_add_u32 m0, s39, 100352
s_add_u32 s37, s37, s38
buffer_load_dwordx4 v22, s[8:11], s37 offen sc1 lds
v_mfma_f32_16x16x32_bf16 v[204:207], v[112:115], v[92:95], v[204:207]
v_mfma_f32_16x16x32_bf16 v[200:203], v[112:115], v[88:91], v[200:203]
s_add_u32 m0, s39, 101376
s_add_u32 s37, s37, s38
buffer_load_dwordx4 v23, s[8:11], s37 offen sc1 lds
v_mfma_f32_16x16x32_bf16 v[196:199], v[112:115], v[84:87], v[196:199]
v_mfma_f32_16x16x32_bf16 v[192:195], v[112:115], v[80:83], v[192:195]
s_add_u32 m0, s39, 102400
s_add_u32 s37, s37, s38
buffer_load_dwordx4 v22, s[8:11], s37 offen sc1 lds
v_mfma_f32_16x16x32_bf16 v[144:147], v[100:103], v[80:83], v[144:147]
v_mfma_f32_16x16x32_bf16 v[148:151], v[100:103], v[84:87], v[148:151]
s_add_u32 m0, s39, 103424
s_add_u32 s37, s37, s38
buffer_load_dwordx4 v23, s[8:11], s37 offen sc1 lds
v_mfma_f32_16x16x32_bf16 v[152:155], v[100:103], v[88:91], v[152:155]
v_mfma_f32_16x16x32_bf16 v[156:159], v[100:103], v[92:95], v[156:159]
s_add_u32 m0, s39, 104448
s_add_u32 s37, s37, s38
buffer_load_dwordx4 v22, s[8:11], s37 offen sc1 lds
v_mfma_f32_16x16x32_bf16 v[220:223], v[116:119], v[92:95], v[220:223]
v_mfma_f32_16x16x32_bf16 v[216:219], v[116:119], v[88:91], v[216:219]
s_add_u32 m0, s39, 105472
s_add_u32 s37, s37, s38
buffer_load_dwordx4 v23, s[8:11], s37 offen sc1 lds
v_mfma_f32_16x16x32_bf16 v[212:215], v[116:119], v[84:87], v[212:215]
v_mfma_f32_16x16x32_bf16 v[208:211], v[116:119], v[80:83], v[208:211]
s_add_u32 m0, s39, 106496
s_add_u32 s37, s37, s38
buffer_load_dwordx4 v22, s[8:11], s37 offen sc1 lds
v_mfma_f32_16x16x32_bf16 v[160:163], v[104:107], v[80:83], v[160:163]
v_mfma_f32_16x16x32_bf16 v[164:167], v[104:107], v[84:87], v[164:167]
s_add_u32 m0, s39, 107520
s_add_u32 s37, s37, s38
buffer_load_dwordx4 v23, s[8:11], s37 offen sc1 lds
v_mfma_f32_16x16x32_bf16 v[168:171], v[104:107], v[88:91], v[168:171]
v_mfma_f32_16x16x32_bf16 v[172:175], v[104:107], v[92:95], v[172:175]
s_add_u32 m0, s39, 108544
s_add_u32 s37, s37, s38
buffer_load_dwordx4 v22, s[8:11], s37 offen sc1 lds
v_mfma_f32_16x16x32_bf16 v[236:239], v[120:123], v[92:95], v[236:239]
v_mfma_f32_16x16x32_bf16 v[232:235], v[120:123], v[88:91], v[232:235]
s_add_u32 m0, s39, 109568
s_add_u32 s37, s37, s38
buffer_load_dwordx4 v23, s[8:11], s37 offen sc1 lds
v_mfma_f32_16x16x32_bf16 v[228:231], v[120:123], v[84:87], v[228:231]
v_mfma_f32_16x16x32_bf16 v[224:227], v[120:123], v[80:83], v[224:227]
s_add_u32 m0, s39, 110592
s_add_u32 s37, s37, s38
buffer_load_dwordx4 v22, s[8:11], s37 offen sc1 lds
v_mfma_f32_16x16x32_bf16 v[176:179], v[108:111], v[80:83], v[176:179]
v_mfma_f32_16x16x32_bf16 v[180:183], v[108:111], v[84:87], v[180:183]
s_add_u32 m0, s39, 111616
s_add_u32 s37, s37, s38
buffer_load_dwordx4 v23, s[8:11], s37 offen sc1 lds
v_mfma_f32_16x16x32_bf16 v[184:187], v[108:111], v[88:91], v[184:187]
v_mfma_f32_16x16x32_bf16 v[188:191], v[108:111], v[92:95], v[188:191]
s_add_u32 m0, s39, 112640
s_add_u32 s37, s37, s38
buffer_load_dwordx4 v22, s[8:11], s37 offen sc1 lds
v_mfma_f32_16x16x32_bf16 v[252:255], v[124:127], v[92:95], v[252:255]
v_mfma_f32_16x16x32_bf16 v[248:251], v[124:127], v[88:91], v[248:251]
s_add_u32 m0, s39, 113664
s_add_u32 s37, s37, s38
buffer_load_dwordx4 v23, s[8:11], s37 offen sc1 lds
v_mfma_f32_16x16x32_bf16 v[244:247], v[124:127], v[84:87], v[244:247]
v_mfma_f32_16x16x32_bf16 v[240:243], v[124:127], v[80:83], v[240:243]
s_setprio 0
s_lshl_b32 s43, s46, 9
s_add_u32 s43, s43, 147456
v_lshl_add_u32 v19, v17, 3, s43
ds_read_b64 v[80:81], v19 offset:0
ds_read_b64 v[82:83], v19 offset:128
ds_read_b64 v[84:85], v19 offset:256
ds_read_b64 v[86:87], v19 offset:384
s_mul_i32 s43, s47, 256
s_add_u32 s43, s43, 148480
v_lshl_add_u32 v19, v18, 4, s43
ds_read_b128 v[48:51], v19 offset:0
ds_read_b128 v[52:55], v19 offset:64
ds_read_b128 v[56:59], v19 offset:128
ds_read_b128 v[60:63], v19 offset:192
ds_read_b128 v[64:67], v19 offset:896
ds_read_b128 v[68:71], v19 offset:960
ds_read_b128 v[72:75], v19 offset:1024
ds_read_b128 v[76:79], v19 offset:1088
s_waitcnt lgkmcnt(0)
v_mov_b32 v32, v80
v_mul_f32 v88, v81, v81
v_mul_f32 v36, 0xc0135761, v81
v_mul_f32 v89, 0xbdd2d3e8, v81
v_rcp_f32 v44, v88
v_mul_f32 v40, v89, v88
v_mov_b32 v33, v82
v_mul_f32 v88, v83, v83
v_mul_f32 v37, 0xc0135761, v83
v_mul_f32 v89, 0xbdd2d3e8, v83
v_rcp_f32 v45, v88
v_mul_f32 v41, v89, v88
v_mov_b32 v34, v84
v_mul_f32 v88, v85, v85
v_mul_f32 v38, 0xc0135761, v85
v_mul_f32 v89, 0xbdd2d3e8, v85
v_rcp_f32 v46, v88
v_mul_f32 v42, v89, v88
v_mov_b32 v35, v86
v_mul_f32 v88, v87, v87
v_mul_f32 v39, 0xc0135761, v87
v_mul_f32 v89, 0xbdd2d3e8, v87
v_rcp_f32 v47, v88
v_mul_f32 v43, v89, v88
s_barrier
s_add_u32 s42, s42, 1
s_and_b32 s42, s42, 15
s_add_u32 m0, s39, 0
s_mul_i32 s37, s42, s40
buffer_load_dwordx4 v22, s[8:11], s37 offen sc1 lds
v_fma_f32 v128, -v32, v48, v128
v_fma_f32 v129, -v32, v49, v129
v_fma_f32 v130, -v32, v50, v130
v_fma_f32 v131, -v32, v51, v131
s_add_u32 m0, s39, 1024
s_add_u32 s37, s37, s38
buffer_load_dwordx4 v23, s[8:11], s37 offen sc1 lds
v_fma_f32 v192, -v32, v64, v192
v_fma_f32 v193, -v32, v65, v193
v_fma_f32 v194, -v32, v66, v194
s_add_u32 m0, s39, 2048
s_add_u32 s37, s37, s38
buffer_load_dwordx4 v22, s[8:11], s37 offen sc1 lds
v_fma_f32 v195, -v32, v67, v195
v_mul_f32 v80, v128, v128
v_mul_f32 v81, v129, v129
s_add_u32 m0, s39, 3072
s_add_u32 s37, s37, s38
buffer_load_dwordx4 v23, s[8:11], s37 offen sc1 lds
v_mul_f32 v82, v130, v130
v_mul_f32 v83, v131, v131
v_fma_f32 v80, v80, v40, v36
s_add_u32 m0, s39, 4096
s_add_u32 s37, s37, s38
buffer_load_dwordx4 v22, s[8:11], s37 offen sc1 lds
v_fma_f32 v81, v81, v40, v36
v_fma_f32 v82, v82, v40, v36
v_fma_f32 v83, v83, v40, v36
v_mul_f32 v80, v80, v128
s_add_u32 m0, s39, 5120
s_add_u32 s37, s37, s38
buffer_load_dwordx4 v23, s[8:11], s37 offen sc1 lds
v_mul_f32 v81, v81, v129
v_mul_f32 v82, v82, v130
v_mul_f32 v83, v83, v131
s_add_u32 m0, s39, 6144
s_add_u32 s37, s37, s38
buffer_load_dwordx4 v22, s[8:11], s37 offen sc1 lds
v_exp_f32 v80, v80
v_exp_f32 v81, v81
v_exp_f32 v82, v82
s_add_u32 m0, s39, 7168
s_add_u32 s37, s37, s38
buffer_load_dwordx4 v23, s[8:11], s37 offen sc1 lds
v_exp_f32 v83, v83
v_mul_f32 v192, v128, v192
v_mul_f32 v193, v129, v193
s_add_u32 m0, s39, 8192
s_add_u32 s37, s37, s38
buffer_load_dwordx4 v22, s[8:11], s37 offen sc1 lds
v_mul_f32 v194, v130, v194
v_mul_f32 v195, v131, v195
v_fma_f32 v80, v80, v44, v44
v_fma_f32 v81, v81, v44, v44
s_add_u32 m0, s39, 9216
s_add_u32 s37, s37, s38
buffer_load_dwordx4 v23, s[8:11], s37 offen sc1 lds
v_fma_f32 v82, v82, v44, v44
v_fma_f32 v83, v83, v44, v44
v_rcp_f32 v80, v80
s_add_u32 m0, s39, 10240
s_add_u32 s37, s37, s38
buffer_load_dwordx4 v22, s[8:11], s37 offen sc1 lds
v_rcp_f32 v81, v81
v_rcp_f32 v82, v82
v_rcp_f32 v83, v83
s_add_u32 m0, s39, 11264
s_add_u32 s37, s37, s38
buffer_load_dwordx4 v23, s[8:11], s37 offen sc1 lds
v_mul_f32 v192, v192, v80
v_mul_f32 v193, v193, v81
v_mul_f32 v194, v194, v82
s_add_u32 m0, s39, 12288
s_add_u32 s37, s37, s38
buffer_load_dwordx4 v22, s[8:11], s37 offen sc1 lds
v_mul_f32 v195, v195, v83
v_cvt_pk_bf16_f32 v96, v192, v193
v_cvt_pk_bf16_f32 v97, v194, v195
v_fma_f32 v144, -v32, v52, v144
s_add_u32 m0, s39, 13312
s_add_u32 s37, s37, s38
buffer_load_dwordx4 v23, s[8:11], s37 offen sc1 lds
v_fma_f32 v145, -v32, v53, v145
v_fma_f32 v146, -v32, v54, v146
v_fma_f32 v147, -v32, v55, v147
s_add_u32 m0, s39, 14336
s_add_u32 s37, s37, s38
buffer_load_dwordx4 v22, s[8:11], s37 offen sc1 lds
v_fma_f32 v208, -v32, v68, v208
v_fma_f32 v209, -v32, v69, v209
v_fma_f32 v210, -v32, v70, v210
s_add_u32 m0, s39, 15360
s_add_u32 s37, s37, s38
buffer_load_dwordx4 v23, s[8:11], s37 offen sc1 lds
v_fma_f32 v211, -v32, v71, v211
v_mul_f32 v84, v144, v144
v_mul_f32 v85, v145, v145
s_waitcnt vmcnt(16)
s_barrier
s_add_u32 s42, s42, 1
s_and_b32 s42, s42, 15
s_add_u32 m0, s39, 49152
s_mul_i32 s37, s42, s40
buffer_load_dwordx4 v22, s[8:11], s37 offen sc1 lds
v_mul_f32 v86, v146, v146
v_mul_f32 v87, v147, v147
v_fma_f32 v84, v84, v40, v36
v_fma_f32 v85, v85, v40, v36
v_fma_f32 v86, v86, v40, v36
s_add_u32 m0, s39, 50176
s_add_u32 s37, s37, s38
buffer_load_dwordx4 v23, s[8:11], s37 offen sc1 lds
v_fma_f32 v87, v87, v40, v36
v_mul_f32 v84, v84, v144
v_mul_f32 v85, v85, v145
v_mul_f32 v86, v86, v146
v_mul_f32 v87, v87, v147
s_add_u32 m0, s39, 51200
s_add_u32 s37, s37, s38
buffer_load_dwordx4 v22, s[8:11], s37 offen sc1 lds
v_exp_f32 v84, v84
v_exp_f32 v85, v85
v_exp_f32 v86, v86
v_exp_f32 v87, v87
s_add_u32 m0, s39, 52224
s_add_u32 s37, s37, s38
buffer_load_dwordx4 v23, s[8:11], s37 offen sc1 lds
v_mul_f32 v208, v144, v208
v_mul_f32 v209, v145, v209
v_mul_f32 v210, v146, v210
v_mul_f32 v211, v147, v211
v_fma_f32 v84, v84, v44, v44
s_add_u32 m0, s39, 53248
s_add_u32 s37, s37, s38
buffer_load_dwordx4 v22, s[8:11], s37 offen sc1 lds
v_fma_f32 v85, v85, v44, v44
v_fma_f32 v86, v86, v44, v44
v_fma_f32 v87, v87, v44, v44
v_rcp_f32 v84, v84
v_rcp_f32 v85, v85
s_add_u32 m0, s39, 54272
s_add_u32 s37, s37, s38
buffer_load_dwordx4 v23, s[8:11], s37 offen sc1 lds
v_rcp_f32 v86, v86
v_rcp_f32 v87, v87
v_mul_f32 v208, v208, v84
v_mul_f32 v209, v209, v85
s_add_u32 m0, s39, 55296
s_add_u32 s37, s37, s38
buffer_load_dwordx4 v22, s[8:11], s37 offen sc1 lds
v_mul_f32 v210, v210, v86
v_mul_f32 v211, v211, v87
v_cvt_pk_bf16_f32 v98, v208, v209
v_cvt_pk_bf16_f32 v99, v210, v211
s_add_u32 m0, s39, 56320
s_add_u32 s37, s37, s38
buffer_load_dwordx4 v23, s[8:11], s37 offen sc1 lds
v_fma_f32 v132, -v33, v48, v132
v_fma_f32 v133, -v33, v49, v133
v_fma_f32 v134, -v33, v50, v134
v_fma_f32 v135, -v33, v51, v135
s_add_u32 m0, s39, 57344
s_add_u32 s37, s37, s38
buffer_load_dwordx4 v22, s[8:11], s37 offen sc1 lds
v_fma_f32 v196, -v33, v64, v196
v_fma_f32 v197, -v33, v65, v197
v_fma_f32 v198, -v33, v66, v198
v_fma_f32 v199, -v33, v67, v199
v_mul_f32 v80, v132, v132
s_add_u32 m0, s39, 58368
s_add_u32 s37, s37, s38
buffer_load_dwordx4 v23, s[8:11], s37 offen sc1 lds
v_mul_f32 v81, v133, v133
v_mul_f32 v82, v134, v134
v_mul_f32 v83, v135, v135
v_fma_f32 v80, v80, v41, v37
v_fma_f32 v81, v81, v41, v37
s_add_u32 m0, s39, 59392
s_add_u32 s37, s37, s38
buffer_load_dwordx4 v22, s[8:11], s37 offen sc1 lds
v_fma_f32 v82, v82, v41, v37
v_fma_f32 v83, v83, v41, v37
v_mul_f32 v80, v80, v132
v_mul_f32 v81, v81, v133
s_add_u32 m0, s39, 60416
s_add_u32 s37, s37, s38
buffer_load_dwordx4 v23, s[8:11], s37 offen sc1 lds
v_mul_f32 v82, v82, v134
v_lshlrev_b32 v19, 11, v18
v_lshl_add_u32 v19, v17, 4, v19
s_lshl_b32 s43, s46, 10
v_add_u32 v2, s43, v19
s_add_u32 m0, s39, 61440
s_add_u32 s37, s37, s38
buffer_load_dwordx4 v22, s[8:11], s37 offen sc1 lds
v_add_u32 v3, 0x10000, v2
v_lshrrev_b32 v19, 2, v17
v_lshl_add_u32 v20, v18, 2, v19
v_bfe_u32 v21, v20, 1, 2
s_lshl_b32 s43, s47, 1
s_add_u32 m0, s39, 62464
s_add_u32 s37, s37, s38
buffer_load_dwordx4 v23, s[8:11], s37 offen sc1 lds
v_xor_b32 v21, s43, v21
v_lshlrev_b32 v20, 7, v20
v_lshl_add_u32 v20, v21, 5, v20
v_and_b32 v19, 3, v1
s_add_u32 m0, s39, 63488
s_add_u32 s37, s37, s38
buffer_load_dwordx4 v22, s[8:11], s37 offen sc1 lds
v_lshl_add_u32 v20, v19, 3, v20
v_add_u32 v5, 16384, v20
v_xor_b32 v6, 32, v5
v_add_u32 v7, 0x10000, v5
v_add_u32 v8, 0x10000, v6
s_add_u32 m0, s39, 64512
s_add_u32 s37, s37, s38
buffer_load_dwordx4 v23, s[8:11], s37 offen sc1 lds
s_lshl_b32 s43, s36, 13
v_lshl_add_u32 v9, v1, 4, s43
s_mov_b32 s54, 0x10000
s_movk_i32 s52, 0x1000
buffer_store_dwordx4 v[96:99], v27, s[24:27], 0 offen offset:0 sc1
s_waitcnt vmcnt(17)
s_barrier
s_add_u32 s42, s42, 1
s_and_b32 s42, s42, 15
s_add_u32 m0, s39, 98304
s_mul_i32 s37, s42, s40
buffer_load_dwordx4 v22, s[8:11], s37 offen sc1 lds
v_mul_f32 v83, v83, v135
v_exp_f32 v80, v80
v_exp_f32 v81, v81
v_exp_f32 v82, v82
s_add_u32 m0, s39, 99328
s_add_u32 s37, s37, s38
buffer_load_dwordx4 v23, s[8:11], s37 offen sc1 lds
v_exp_f32 v83, v83
v_mul_f32 v196, v132, v196
v_mul_f32 v197, v133, v197
s_add_u32 m0, s39, 100352
s_add_u32 s37, s37, s38
buffer_load_dwordx4 v22, s[8:11], s37 offen sc1 lds
v_mul_f32 v198, v134, v198
v_mul_f32 v199, v135, v199
v_fma_f32 v80, v80, v45, v45
s_add_u32 m0, s39, 101376
s_add_u32 s37, s37, s38
buffer_load_dwordx4 v23, s[8:11], s37 offen sc1 lds
v_fma_f32 v81, v81, v45, v45
v_fma_f32 v82, v82, v45, v45
v_fma_f32 v83, v83, v45, v45
s_add_u32 m0, s39, 102400
s_add_u32 s37, s37, s38
buffer_load_dwordx4 v22, s[8:11], s37 offen sc1 lds
v_rcp_f32 v80, v80
v_rcp_f32 v81, v81
v_rcp_f32 v82, v82
v_rcp_f32 v83, v83
s_add_u32 m0, s39, 103424
s_add_u32 s37, s37, s38
buffer_load_dwordx4 v23, s[8:11], s37 offen sc1 lds
v_mul_f32 v196, v196, v80
v_mul_f32 v197, v197, v81
v_mul_f32 v198, v198, v82
s_add_u32 m0, s39, 104448
s_add_u32 s37, s37, s38
buffer_load_dwordx4 v22, s[8:11], s37 offen sc1 lds
v_mul_f32 v199, v199, v83
v_cvt_pk_bf16_f32 v100, v196, v197
v_cvt_pk_bf16_f32 v101, v198, v199
s_add_u32 m0, s39, 105472
s_add_u32 s37, s37, s38
buffer_load_dwordx4 v23, s[8:11], s37 offen sc1 lds
v_fma_f32 v148, -v33, v52, v148
v_fma_f32 v149, -v33, v53, v149
v_fma_f32 v150, -v33, v54, v150
s_add_u32 m0, s39, 106496
s_add_u32 s37, s37, s38
buffer_load_dwordx4 v22, s[8:11], s37 offen sc1 lds
v_fma_f32 v151, -v33, v55, v151
v_fma_f32 v212, -v33, v68, v212
v_fma_f32 v213, -v33, v69, v213
v_fma_f32 v214, -v33, v70, v214
s_add_u32 m0, s39, 107520
s_add_u32 s37, s37, s38
buffer_load_dwordx4 v23, s[8:11], s37 offen sc1 lds
v_fma_f32 v215, -v33, v71, v215
v_mul_f32 v84, v148, v148
v_mul_f32 v85, v149, v149
s_add_u32 m0, s39, 108544
s_add_u32 s37, s37, s38
buffer_load_dwordx4 v22, s[8:11], s37 offen sc1 lds
v_mul_f32 v86, v150, v150
v_mul_f32 v87, v151, v151
v_fma_f32 v84, v84, v41, v37
s_add_u32 m0, s39, 109568
s_add_u32 s37, s37, s38
buffer_load_dwordx4 v23, s[8:11], s37 offen sc1 lds
v_fma_f32 v85, v85, v41, v37
v_fma_f32 v86, v86, v41, v37
v_fma_f32 v87, v87, v41, v37
s_add_u32 m0, s39, 110592
s_add_u32 s37, s37, s38
buffer_load_dwordx4 v22, s[8:11], s37 offen sc1 lds
v_mul_f32 v84, v84, v148
v_mul_f32 v85, v85, v149
v_mul_f32 v86, v86, v150
v_mul_f32 v87, v87, v151
s_add_u32 m0, s39, 111616
s_add_u32 s37, s37, s38
buffer_load_dwordx4 v23, s[8:11], s37 offen sc1 lds
v_exp_f32 v84, v84
v_exp_f32 v85, v85
v_exp_f32 v86, v86
s_add_u32 m0, s39, 112640
s_add_u32 s37, s37, s38
buffer_load_dwordx4 v22, s[8:11], s37 offen sc1 lds
v_exp_f32 v87, v87
v_mul_f32 v212, v148, v212
v_mul_f32 v213, v149, v213
s_add_u32 m0, s39, 113664
s_add_u32 s37, s37, s38
buffer_load_dwordx4 v23, s[8:11], s37 offen sc1 lds
v_mul_f32 v214, v150, v214
v_mul_f32 v215, v151, v215
v_fma_f32 v84, v84, v45, v45
s_waitcnt vmcnt(17)
s_barrier
s_add_u32 s42, s42, 1
s_and_b32 s42, s42, 15
s_add_u32 m0, s39, 0
s_mul_i32 s37, s42, s40
buffer_load_dwordx4 v22, s[8:11], s37 offen sc1 lds
v_fma_f32 v85, v85, v45, v45
v_fma_f32 v86, v86, v45, v45
v_fma_f32 v87, v87, v45, v45
v_rcp_f32 v84, v84
s_add_u32 m0, s39, 1024
s_add_u32 s37, s37, s38
buffer_load_dwordx4 v23, s[8:11], s37 offen sc1 lds
v_rcp_f32 v85, v85
v_rcp_f32 v86, v86
v_rcp_f32 v87, v87
s_add_u32 m0, s39, 2048
s_add_u32 s37, s37, s38
buffer_load_dwordx4 v22, s[8:11], s37 offen sc1 lds
v_mul_f32 v212, v212, v84
v_mul_f32 v213, v213, v85
v_mul_f32 v214, v214, v86
s_add_u32 m0, s39, 3072
s_add_u32 s37, s37, s38
buffer_load_dwordx4 v23, s[8:11], s37 offen sc1 lds
v_mul_f32 v215, v215, v87
v_cvt_pk_bf16_f32 v102, v212, v213
v_cvt_pk_bf16_f32 v103, v214, v215
s_add_u32 m0, s39, 4096
s_add_u32 s37, s37, s38
buffer_load_dwordx4 v22, s[8:11], s37 offen sc1 lds
v_fma_f32 v136, -v34, v48, v136
v_fma_f32 v137, -v34, v49, v137
v_fma_f32 v138, -v34, v50, v138
s_add_u32 m0, s39, 5120
s_add_u32 s37, s37, s38
buffer_load_dwordx4 v23, s[8:11], s37 offen sc1 lds
v_fma_f32 v139, -v34, v51, v139
v_fma_f32 v200, -v34, v64, v200
v_fma_f32 v201, -v34, v65, v201
s_add_u32 m0, s39, 6144
s_add_u32 s37, s37, s38
buffer_load_dwordx4 v22, s[8:11], s37 offen sc1 lds
v_fma_f32 v202, -v34, v66, v202
v_fma_f32 v203, -v34, v67, v203
v_mul_f32 v80, v136, v136
v_mul_f32 v81, v137, v137
s_add_u32 m0, s39, 7168
s_add_u32 s37, s37, s38
buffer_load_dwordx4 v23, s[8:11], s37 offen sc1 lds
v_mul_f32 v82, v138, v138
v_mul_f32 v83, v139, v139
v_fma_f32 v80, v80, v42, v38
s_add_u32 m0, s39, 8192
s_add_u32 s37, s37, s38
buffer_load_dwordx4 v22, s[8:11], s37 offen sc1 lds
v_fma_f32 v81, v81, v42, v38
v_fma_f32 v82, v82, v42, v38
v_fma_f32 v83, v83, v42, v38
s_add_u32 m0, s39, 9216
s_add_u32 s37, s37, s38
buffer_load_dwordx4 v23, s[8:11], s37 offen sc1 lds
v_mul_f32 v80, v80, v136
v_mul_f32 v81, v81, v137
v_mul_f32 v82, v82, v138
v_mul_f32 v83, v83, v139
s_add_u32 m0, s39, 10240
s_add_u32 s37, s37, s38
buffer_load_dwordx4 v22, s[8:11], s37 offen sc1 lds
v_exp_f32 v80, v80
v_exp_f32 v81, v81
v_exp_f32 v82, v82
s_add_u32 m0, s39, 11264
s_add_u32 s37, s37, s38
buffer_load_dwordx4 v23, s[8:11], s37 offen sc1 lds
v_exp_f32 v83, v83
v_mul_f32 v200, v136, v200
v_mul_f32 v201, v137, v201
s_add_u32 m0, s39, 12288
s_add_u32 s37, s37, s38
buffer_load_dwordx4 v22, s[8:11], s37 offen sc1 lds
v_mul_f32 v202, v138, v202
v_mul_f32 v203, v139, v203
v_fma_f32 v80, v80, v46, v46
v_fma_f32 v81, v81, v46, v46
s_add_u32 m0, s39, 13312
s_add_u32 s37, s37, s38
buffer_load_dwordx4 v23, s[8:11], s37 offen sc1 lds
v_fma_f32 v82, v82, v46, v46
v_fma_f32 v83, v83, v46, v46
v_rcp_f32 v80, v80
s_add_u32 m0, s39, 14336
s_add_u32 s37, s37, s38
buffer_load_dwordx4 v22, s[8:11], s37 offen sc1 lds
v_rcp_f32 v81, v81
v_rcp_f32 v82, v82
v_rcp_f32 v83, v83
s_add_u32 m0, s39, 15360
s_add_u32 s37, s37, s38
buffer_load_dwordx4 v23, s[8:11], s37 offen sc1 lds
v_mul_f32 v200, v200, v80
v_mul_f32 v201, v201, v81
v_mul_f32 v202, v202, v82
buffer_store_dwordx4 v[100:103], v27, s[24:27], 0 offen offset:256 sc1
s_waitcnt vmcnt(17)
s_barrier
s_add_u32 s42, s42, 1
s_and_b32 s42, s42, 15
s_add_u32 m0, s39, 49152
s_mul_i32 s37, s42, s40
buffer_load_dwordx4 v22, s[8:11], s37 offen sc1 lds
v_mul_f32 v203, v203, v83
v_cvt_pk_bf16_f32 v104, v200, v201
v_cvt_pk_bf16_f32 v105, v202, v203
v_fma_f32 v152, -v34, v52, v152
s_add_u32 m0, s39, 50176
s_add_u32 s37, s37, s38
buffer_load_dwordx4 v23, s[8:11], s37 offen sc1 lds
v_fma_f32 v153, -v34, v53, v153
v_fma_f32 v154, -v34, v54, v154
v_fma_f32 v155, -v34, v55, v155
s_add_u32 m0, s39, 51200
s_add_u32 s37, s37, s38
buffer_load_dwordx4 v22, s[8:11], s37 offen sc1 lds
v_fma_f32 v216, -v34, v68, v216
v_fma_f32 v217, -v34, v69, v217
v_fma_f32 v218, -v34, v70, v218
s_add_u32 m0, s39, 52224
s_add_u32 s37, s37, s38
buffer_load_dwordx4 v23, s[8:11], s37 offen sc1 lds
v_fma_f32 v219, -v34, v71, v219
v_mul_f32 v84, v152, v152
v_mul_f32 v85, v153, v153
s_add_u32 m0, s39, 53248
s_add_u32 s37, s37, s38
buffer_load_dwordx4 v22, s[8:11], s37 offen sc1 lds
v_mul_f32 v86, v154, v154
v_mul_f32 v87, v155, v155
v_fma_f32 v84, v84, v42, v38
v_fma_f32 v85, v85, v42, v38
s_add_u32 m0, s39, 54272
s_add_u32 s37, s37, s38
buffer_load_dwordx4 v23, s[8:11], s37 offen sc1 lds
v_fma_f32 v86, v86, v42, v38
v_fma_f32 v87, v87, v42, v38
v_mul_f32 v84, v84, v152
s_add_u32 m0, s39, 55296
s_add_u32 s37, s37, s38
buffer_load_dwordx4 v22, s[8:11], s37 offen sc1 lds
v_mul_f32 v85, v85, v153
v_mul_f32 v86, v86, v154
v_mul_f32 v87, v87, v155
s_add_u32 m0, s39, 56320
s_add_u32 s37, s37, s38
buffer_load_dwordx4 v23, s[8:11], s37 offen sc1 lds
v_exp_f32 v84, v84
v_exp_f32 v85, v85
v_exp_f32 v86, v86
s_add_u32 m0, s39, 57344
s_add_u32 s37, s37, s38
buffer_load_dwordx4 v22, s[8:11], s37 offen sc1 lds
v_exp_f32 v87, v87
v_mul_f32 v216, v152, v216
v_mul_f32 v217, v153, v217
v_mul_f32 v218, v154, v218
s_add_u32 m0, s39, 58368
s_add_u32 s37, s37, s38
buffer_load_dwordx4 v23, s[8:11], s37 offen sc1 lds
v_mul_f32 v219, v155, v219
v_fma_f32 v84, v84, v46, v46
v_fma_f32 v85, v85, v46, v46
s_add_u32 m0, s39, 59392
s_add_u32 s37, s37, s38
buffer_load_dwordx4 v22, s[8:11], s37 offen sc1 lds
v_fma_f32 v86, v86, v46, v46
v_fma_f32 v87, v87, v46, v46
v_rcp_f32 v84, v84
s_add_u32 m0, s39, 60416
s_add_u32 s37, s37, s38
buffer_load_dwordx4 v23, s[8:11], s37 offen sc1 lds
v_rcp_f32 v85, v85
v_rcp_f32 v86, v86
v_rcp_f32 v87, v87
s_add_u32 m0, s39, 61440
s_add_u32 s37, s37, s38
buffer_load_dwordx4 v22, s[8:11], s37 offen sc1 lds
v_mul_f32 v216, v216, v84
v_mul_f32 v217, v217, v85
v_mul_f32 v218, v218, v86
v_mul_f32 v219, v219, v87
s_add_u32 m0, s39, 62464
s_add_u32 s37, s37, s38
buffer_load_dwordx4 v23, s[8:11], s37 offen sc1 lds
v_cvt_pk_bf16_f32 v106, v216, v217
v_cvt_pk_bf16_f32 v107, v218, v219
s_add_u32 m0, s39, 63488
s_add_u32 s37, s37, s38
buffer_load_dwordx4 v22, s[8:11], s37 offen sc1 lds
v_fma_f32 v140, -v35, v48, v140
v_fma_f32 v141, -v35, v49, v141
v_fma_f32 v142, -v35, v50, v142
s_add_u32 m0, s39, 64512
s_add_u32 s37, s37, s38
buffer_load_dwordx4 v23, s[8:11], s37 offen sc1 lds
v_fma_f32 v143, -v35, v51, v143
v_fma_f32 v204, -v35, v64, v204
v_fma_f32 v205, -v35, v65, v205
buffer_store_dwordx4 v[104:107], v27, s[24:27], 0 offen offset:512 sc1
s_waitcnt vmcnt(18)
s_barrier
s_add_u32 s42, s42, 1
s_and_b32 s42, s42, 15
s_add_u32 m0, s39, 98304
s_mul_i32 s37, s42, s40
buffer_load_dwordx4 v22, s[8:11], s37 offen sc1 lds
v_fma_f32 v206, -v35, v66, v206
v_fma_f32 v207, -v35, v67, v207
v_mul_f32 v80, v140, v140
v_mul_f32 v81, v141, v141
s_add_u32 m0, s39, 99328
s_add_u32 s37, s37, s38
buffer_load_dwordx4 v23, s[8:11], s37 offen sc1 lds
v_mul_f32 v82, v142, v142
v_mul_f32 v83, v143, v143
v_fma_f32 v80, v80, v43, v39
s_add_u32 m0, s39, 100352
s_add_u32 s37, s37, s38
buffer_load_dwordx4 v22, s[8:11], s37 offen sc1 lds
v_fma_f32 v81, v81, v43, v39
v_fma_f32 v82, v82, v43, v39
v_fma_f32 v83, v83, v43, v39
s_add_u32 m0, s39, 101376
s_add_u32 s37, s37, s38
buffer_load_dwordx4 v23, s[8:11], s37 offen sc1 lds
v_mul_f32 v80, v80, v140
v_mul_f32 v81, v81, v141
v_mul_f32 v82, v82, v142
s_add_u32 m0, s39, 102400
s_add_u32 s37, s37, s38
buffer_load_dwordx4 v22, s[8:11], s37 offen sc1 lds
v_mul_f32 v83, v83, v143
v_exp_f32 v80, v80
v_exp_f32 v81, v81
v_exp_f32 v82, v82
s_add_u32 m0, s39, 103424
s_add_u32 s37, s37, s38
buffer_load_dwordx4 v23, s[8:11], s37 offen sc1 lds
v_exp_f32 v83, v83
v_mul_f32 v204, v140, v204
v_mul_f32 v205, v141, v205
s_add_u32 m0, s39, 104448
s_add_u32 s37, s37, s38
buffer_load_dwordx4 v22, s[8:11], s37 offen sc1 lds
v_mul_f32 v206, v142, v206
v_mul_f32 v207, v143, v207
v_fma_f32 v80, v80, v47, v47
s_add_u32 m0, s39, 105472
s_add_u32 s37, s37, s38
buffer_load_dwordx4 v23, s[8:11], s37 offen sc1 lds
v_fma_f32 v81, v81, v47, v47
v_fma_f32 v82, v82, v47, v47
v_fma_f32 v83, v83, v47, v47
s_add_u32 m0, s39, 106496
s_add_u32 s37, s37, s38
buffer_load_dwordx4 v22, s[8:11], s37 offen sc1 lds
v_rcp_f32 v80, v80
v_rcp_f32 v81, v81
v_rcp_f32 v82, v82
v_rcp_f32 v83, v83
s_add_u32 m0, s39, 107520
s_add_u32 s37, s37, s38
buffer_load_dwordx4 v23, s[8:11], s37 offen sc1 lds
v_mul_f32 v204, v204, v80
v_mul_f32 v205, v205, v81
v_mul_f32 v206, v206, v82
s_add_u32 m0, s39, 108544
s_add_u32 s37, s37, s38
buffer_load_dwordx4 v22, s[8:11], s37 offen sc1 lds
v_mul_f32 v207, v207, v83
v_cvt_pk_bf16_f32 v108, v204, v205
v_cvt_pk_bf16_f32 v109, v206, v207
s_add_u32 m0, s39, 109568
s_add_u32 s37, s37, s38
buffer_load_dwordx4 v23, s[8:11], s37 offen sc1 lds
v_fma_f32 v156, -v35, v52, v156
v_fma_f32 v157, -v35, v53, v157
v_fma_f32 v158, -v35, v54, v158
s_add_u32 m0, s39, 110592
s_add_u32 s37, s37, s38
buffer_load_dwordx4 v22, s[8:11], s37 offen sc1 lds
v_fma_f32 v159, -v35, v55, v159
v_fma_f32 v220, -v35, v68, v220
v_fma_f32 v221, -v35, v69, v221
v_fma_f32 v222, -v35, v70, v222
s_add_u32 m0, s39, 111616
s_add_u32 s37, s37, s38
buffer_load_dwordx4 v23, s[8:11], s37 offen sc1 lds
v_fma_f32 v223, -v35, v71, v223
v_mul_f32 v84, v156, v156
v_mul_f32 v85, v157, v157
s_add_u32 m0, s39, 112640
s_add_u32 s37, s37, s38
buffer_load_dwordx4 v22, s[8:11], s37 offen sc1 lds
v_mul_f32 v86, v158, v158
v_mul_f32 v87, v159, v159
v_fma_f32 v84, v84, v43, v39
s_add_u32 m0, s39, 113664
s_add_u32 s37, s37, s38
buffer_load_dwordx4 v23, s[8:11], s37 offen sc1 lds
v_fma_f32 v85, v85, v43, v39
v_fma_f32 v86, v86, v43, v39
v_fma_f32 v87, v87, v43, v39
s_waitcnt vmcnt(17)
s_barrier
s_add_u32 s42, s42, 1
s_and_b32 s42, s42, 15
s_add_u32 m0, s39, 0
s_mul_i32 s37, s42, s40
buffer_load_dwordx4 v22, s[8:11], s37 offen sc1 lds
v_mul_f32 v84, v84, v156
v_mul_f32 v85, v85, v157
v_mul_f32 v86, v86, v158
v_mul_f32 v87, v87, v159
s_add_u32 m0, s39, 1024
s_add_u32 s37, s37, s38
buffer_load_dwordx4 v23, s[8:11], s37 offen sc1 lds
v_exp_f32 v84, v84
v_exp_f32 v85, v85
v_exp_f32 v86, v86
s_add_u32 m0, s39, 2048
s_add_u32 s37, s37, s38
buffer_load_dwordx4 v22, s[8:11], s37 offen sc1 lds
v_exp_f32 v87, v87
v_mul_f32 v220, v156, v220
v_mul_f32 v221, v157, v221
s_add_u32 m0, s39, 3072
s_add_u32 s37, s37, s38
buffer_load_dwordx4 v23, s[8:11], s37 offen sc1 lds
v_mul_f32 v222, v158, v222
v_mul_f32 v223, v159, v223
v_fma_f32 v84, v84, v47, v47
v_fma_f32 v85, v85, v47, v47
s_add_u32 m0, s39, 4096
s_add_u32 s37, s37, s38
buffer_load_dwordx4 v22, s[8:11], s37 offen sc1 lds
v_fma_f32 v86, v86, v47, v47
v_fma_f32 v87, v87, v47, v47
v_rcp_f32 v84, v84
s_add_u32 m0, s39, 5120
s_add_u32 s37, s37, s38
buffer_load_dwordx4 v23, s[8:11], s37 offen sc1 lds
v_rcp_f32 v85, v85
v_rcp_f32 v86, v86
v_rcp_f32 v87, v87
s_add_u32 m0, s39, 6144
s_add_u32 s37, s37, s38
buffer_load_dwordx4 v22, s[8:11], s37 offen sc1 lds
v_mul_f32 v220, v220, v84
v_mul_f32 v221, v221, v85
v_mul_f32 v222, v222, v86
v_mul_f32 v223, v223, v87
s_add_u32 m0, s39, 7168
s_add_u32 s37, s37, s38
buffer_load_dwordx4 v23, s[8:11], s37 offen sc1 lds
v_cvt_pk_bf16_f32 v110, v220, v221
v_cvt_pk_bf16_f32 v111, v222, v223
s_add_u32 m0, s39, 8192
s_add_u32 s37, s37, s38
buffer_load_dwordx4 v22, s[8:11], s37 offen sc1 lds
v_fma_f32 v160, -v32, v56, v160
v_fma_f32 v161, -v32, v57, v161
v_fma_f32 v162, -v32, v58, v162
s_add_u32 m0, s39, 9216
s_add_u32 s37, s37, s38
buffer_load_dwordx4 v23, s[8:11], s37 offen sc1 lds
v_fma_f32 v163, -v32, v59, v163
v_fma_f32 v224, -v32, v72, v224
v_fma_f32 v225, -v32, v73, v225
v_fma_f32 v226, -v32, v74, v226
s_add_u32 m0, s39, 10240
s_add_u32 s37, s37, s38
buffer_load_dwordx4 v22, s[8:11], s37 offen sc1 lds
v_fma_f32 v227, -v32, v75, v227
v_mul_f32 v80, v160, v160
v_mul_f32 v81, v161, v161
s_add_u32 m0, s39, 11264
s_add_u32 s37, s37, s38
buffer_load_dwordx4 v23, s[8:11], s37 offen sc1 lds
v_mul_f32 v82, v162, v162
v_mul_f32 v83, v163, v163
v_fma_f32 v80, v80, v40, v36
s_add_u32 m0, s39, 12288
s_add_u32 s37, s37, s38
buffer_load_dwordx4 v22, s[8:11], s37 offen sc1 lds
v_fma_f32 v81, v81, v40, v36
v_fma_f32 v82, v82, v40, v36
v_fma_f32 v83, v83, v40, v36
v_mul_f32 v80, v80, v160
s_add_u32 m0, s39, 13312
s_add_u32 s37, s37, s38
buffer_load_dwordx4 v23, s[8:11], s37 offen sc1 lds
v_mul_f32 v81, v81, v161
v_mul_f32 v82, v82, v162
v_mul_f32 v83, v83, v163
s_add_u32 m0, s39, 14336
s_add_u32 s37, s37, s38
buffer_load_dwordx4 v22, s[8:11], s37 offen sc1 lds
v_exp_f32 v80, v80
v_exp_f32 v81, v81
v_exp_f32 v82, v82
s_add_u32 m0, s39, 15360
s_add_u32 s37, s37, s38
buffer_load_dwordx4 v23, s[8:11], s37 offen sc1 lds
v_exp_f32 v83, v83
v_mul_f32 v224, v160, v224
v_mul_f32 v225, v161, v225
buffer_store_dwordx4 v[108:111], v27, s[24:27], 0 offen offset:768 sc1
s_waitcnt vmcnt(17)
s_barrier
s_add_u32 s42, s42, 1
s_and_b32 s42, s42, 15
s_add_u32 m0, s39, 49152
s_mul_i32 s37, s42, s40
buffer_load_dwordx4 v22, s[8:11], s37 offen sc1 lds
v_mul_f32 v226, v162, v226
v_mul_f32 v227, v163, v227
v_fma_f32 v80, v80, v44, v44
v_fma_f32 v81, v81, v44, v44
s_add_u32 m0, s39, 50176
s_add_u32 s37, s37, s38
buffer_load_dwordx4 v23, s[8:11], s37 offen sc1 lds
v_fma_f32 v82, v82, v44, v44
v_fma_f32 v83, v83, v44, v44
v_rcp_f32 v80, v80
v_rcp_f32 v81, v81
s_add_u32 m0, s39, 51200
s_add_u32 s37, s37, s38
buffer_load_dwordx4 v22, s[8:11], s37 offen sc1 lds
v_rcp_f32 v82, v82
v_rcp_f32 v83, v83
v_mul_f32 v224, v224, v80
v_mul_f32 v225, v225, v81
s_add_u32 m0, s39, 52224
s_add_u32 s37, s37, s38
buffer_load_dwordx4 v23, s[8:11], s37 offen sc1 lds
v_mul_f32 v226, v226, v82
v_mul_f32 v227, v227, v83
v_cvt_pk_bf16_f32 v96, v224, v225
v_cvt_pk_bf16_f32 v97, v226, v227
s_add_u32 m0, s39, 53248
s_add_u32 s37, s37, s38
buffer_load_dwordx4 v22, s[8:11], s37 offen sc1 lds
v_fma_f32 v176, -v32, v60, v176
v_fma_f32 v177, -v32, v61, v177
v_fma_f32 v178, -v32, v62, v178
v_fma_f32 v179, -v32, v63, v179
s_add_u32 m0, s39, 54272
s_add_u32 s37, s37, s38
buffer_load_dwordx4 v23, s[8:11], s37 offen sc1 lds
v_fma_f32 v240, -v32, v76, v240
v_fma_f32 v241, -v32, v77, v241
v_fma_f32 v242, -v32, v78, v242
v_fma_f32 v243, -v32, v79, v243
s_add_u32 m0, s39, 55296
s_add_u32 s37, s37, s38
buffer_load_dwordx4 v22, s[8:11], s37 offen sc1 lds
v_mul_f32 v84, v176, v176
v_mul_f32 v85, v177, v177
v_mul_f32 v86, v178, v178
v_mul_f32 v87, v179, v179
s_add_u32 m0, s39, 56320
s_add_u32 s37, s37, s38
buffer_load_dwordx4 v23, s[8:11], s37 offen sc1 lds
v_fma_f32 v84, v84, v40, v36
v_fma_f32 v85, v85, v40, v36
v_fma_f32 v86, v86, v40, v36
s_add_u32 m0, s39, 57344
s_add_u32 s37, s37, s38
buffer_load_dwordx4 v22, s[8:11], s37 offen sc1 lds
v_fma_f32 v87, v87, v40, v36
v_mul_f32 v84, v84, v176
v_mul_f32 v85, v85, v177
v_mul_f32 v86, v86, v178
s_add_u32 m0, s39, 58368
s_add_u32 s37, s37, s38
buffer_load_dwordx4 v23, s[8:11], s37 offen sc1 lds
v_mul_f32 v87, v87, v179
v_exp_f32 v84, v84
v_exp_f32 v85, v85
v_exp_f32 v86, v86
s_add_u32 m0, s39, 59392
s_add_u32 s37, s37, s38
buffer_load_dwordx4 v22, s[8:11], s37 offen sc1 lds
v_exp_f32 v87, v87
v_mul_f32 v240, v176, v240
v_mul_f32 v241, v177, v241
v_mul_f32 v242, v178, v242
s_add_u32 m0, s39, 60416
s_add_u32 s37, s37, s38
buffer_load_dwordx4 v23, s[8:11], s37 offen sc1 lds
v_mul_f32 v243, v179, v243
v_fma_f32 v84, v84, v44, v44
v_fma_f32 v85, v85, v44, v44
v_fma_f32 v86, v86, v44, v44
s_add_u32 m0, s39, 61440
s_add_u32 s37, s37, s38
buffer_load_dwordx4 v22, s[8:11], s37 offen sc1 lds
v_fma_f32 v87, v87, v44, v44
v_rcp_f32 v84, v84
v_rcp_f32 v85, v85
v_rcp_f32 v86, v86
s_add_u32 m0, s39, 62464
s_add_u32 s37, s37, s38
buffer_load_dwordx4 v23, s[8:11], s37 offen sc1 lds
v_rcp_f32 v87, v87
v_lshlrev_b32 v19, 11, v18
v_lshl_add_u32 v19, v17, 4, v19
s_lshl_b32 s43, s46, 10
s_add_u32 m0, s39, 63488
s_add_u32 s37, s37, s38
buffer_load_dwordx4 v22, s[8:11], s37 offen sc1 lds
s_lshl_b32 s44, s47, 13
v_add3_u32 v208, v19, s43, 0
v_add_u32 v208, s44, v208
buffer_load_dwordx4 v[192:195], v208, s[20:23], 0 offen offset:0 sc1
s_add_u32 m0, s39, 64512
s_add_u32 s37, s37, s38
buffer_load_dwordx4 v23, s[8:11], s37 offen sc1 lds
buffer_load_dwordx4 v[196:199], v208, s[20:23], 0 offen offset:256 sc1
buffer_load_dwordx4 v[200:203], v208, s[20:23], 0 offen offset:512 sc1
buffer_load_dwordx4 v[204:207], v208, s[20:23], 0 offen offset:768 sc1
s_waitcnt vmcnt(20)
s_barrier
s_add_u32 s42, s42, 1
s_and_b32 s42, s42, 15
s_add_u32 m0, s39, 98304
s_mul_i32 s37, s42, s40
buffer_load_dwordx4 v22, s[8:11], s37 offen sc1 lds
v_mul_f32 v240, v240, v84
v_mul_f32 v241, v241, v85
v_mul_f32 v242, v242, v86
v_mul_f32 v243, v243, v87
s_add_u32 m0, s39, 99328
s_add_u32 s37, s37, s38
buffer_load_dwordx4 v23, s[8:11], s37 offen sc1 lds
v_cvt_pk_bf16_f32 v98, v240, v241
v_cvt_pk_bf16_f32 v99, v242, v243
s_add_u32 m0, s39, 100352
s_add_u32 s37, s37, s38
buffer_load_dwordx4 v22, s[8:11], s37 offen sc1 lds
v_fma_f32 v164, -v33, v56, v164
v_fma_f32 v165, -v33, v57, v165
v_fma_f32 v166, -v33, v58, v166
s_add_u32 m0, s39, 101376
s_add_u32 s37, s37, s38
buffer_load_dwordx4 v23, s[8:11], s37 offen sc1 lds
v_fma_f32 v167, -v33, v59, v167
v_fma_f32 v228, -v33, v72, v228
v_fma_f32 v229, -v33, v73, v229
s_add_u32 m0, s39, 102400
s_add_u32 s37, s37, s38
buffer_load_dwordx4 v22, s[8:11], s37 offen sc1 lds
v_fma_f32 v230, -v33, v74, v230
v_fma_f32 v231, -v33, v75, v231
v_mul_f32 v80, v164, v164
v_mul_f32 v81, v165, v165
s_add_u32 m0, s39, 103424
s_add_u32 s37, s37, s38
buffer_load_dwordx4 v23, s[8:11], s37 offen sc1 lds
v_mul_f32 v82, v166, v166
v_mul_f32 v83, v167, v167
v_fma_f32 v80, v80, v41, v37
s_add_u32 m0, s39, 104448
s_add_u32 s37, s37, s38
buffer_load_dwordx4 v22, s[8:11], s37 offen sc1 lds
v_fma_f32 v81, v81, v41, v37
v_fma_f32 v82, v82, v41, v37
v_fma_f32 v83, v83, v41, v37
s_add_u32 m0, s39, 105472
s_add_u32 s37, s37, s38
buffer_load_dwordx4 v23, s[8:11], s37 offen sc1 lds
v_mul_f32 v80, v80, v164
v_mul_f32 v81, v81, v165
v_mul_f32 v82, v82, v166
s_add_u32 m0, s39, 106496
s_add_u32 s37, s37, s38
buffer_load_dwordx4 v22, s[8:11], s37 offen sc1 lds
v_mul_f32 v83, v83, v167
v_exp_f32 v80, v80
v_exp_f32 v81, v81
v_exp_f32 v82, v82
s_add_u32 m0, s39, 107520
s_add_u32 s37, s37, s38
buffer_load_dwordx4 v23, s[8:11], s37 offen sc1 lds
v_exp_f32 v83, v83
v_mul_f32 v228, v164, v228
v_mul_f32 v229, v165, v229
s_add_u32 m0, s39, 108544
s_add_u32 s37, s37, s38
buffer_load_dwordx4 v22, s[8:11], s37 offen sc1 lds
v_mul_f32 v230, v166, v230
v_mul_f32 v231, v167, v231
v_fma_f32 v80, v80, v45, v45
s_add_u32 m0, s39, 109568
s_add_u32 s37, s37, s38
buffer_load_dwordx4 v23, s[8:11], s37 offen sc1 lds
v_fma_f32 v81, v81, v45, v45
v_fma_f32 v82, v82, v45, v45
v_fma_f32 v83, v83, v45, v45
s_add_u32 m0, s39, 110592
s_add_u32 s37, s37, s38
buffer_load_dwordx4 v22, s[8:11], s37 offen sc1 lds
v_rcp_f32 v80, v80
v_rcp_f32 v81, v81
v_rcp_f32 v82, v82
v_rcp_f32 v83, v83
s_add_u32 m0, s39, 111616
s_add_u32 s37, s37, s38
buffer_load_dwordx4 v23, s[8:11], s37 offen sc1 lds
v_mul_f32 v228, v228, v80
v_mul_f32 v229, v229, v81
v_mul_f32 v230, v230, v82
s_add_u32 m0, s39, 112640
s_add_u32 s37, s37, s38
buffer_load_dwordx4 v22, s[8:11], s37 offen sc1 lds
v_mul_f32 v231, v231, v83
v_cvt_pk_bf16_f32 v100, v228, v229
v_cvt_pk_bf16_f32 v101, v230, v231
s_add_u32 m0, s39, 113664
s_add_u32 s37, s37, s38
buffer_load_dwordx4 v23, s[8:11], s37 offen sc1 lds
v_fma_f32 v180, -v33, v60, v180
v_fma_f32 v181, -v33, v61, v181
v_fma_f32 v182, -v33, v62, v182
buffer_store_dwordx4 v[96:99], v27, s[24:27], s53 offen offset:0 sc1
s_waitcnt vmcnt(20)
s_barrier
s_add_u32 s42, s42, 1
s_and_b32 s42, s42, 15
s_add_u32 m0, s39, 0
s_mul_i32 s37, s42, s40
buffer_load_dwordx4 v22, s[8:11], s37 offen sc1 lds
v_fma_f32 v183, -v33, v63, v183
v_fma_f32 v244, -v33, v76, v244
v_fma_f32 v245, -v33, v77, v245
v_fma_f32 v246, -v33, v78, v246
s_add_u32 m0, s39, 1024
s_add_u32 s37, s37, s38
buffer_load_dwordx4 v23, s[8:11], s37 offen sc1 lds
v_fma_f32 v247, -v33, v79, v247
v_mul_f32 v84, v180, v180
v_mul_f32 v85, v181, v181
s_add_u32 m0, s39, 2048
s_add_u32 s37, s37, s38
buffer_load_dwordx4 v22, s[8:11], s37 offen sc1 lds
v_mul_f32 v86, v182, v182
v_mul_f32 v87, v183, v183
v_fma_f32 v84, v84, v41, v37
s_add_u32 m0, s39, 3072
s_add_u32 s37, s37, s38
buffer_load_dwordx4 v23, s[8:11], s37 offen sc1 lds
v_fma_f32 v85, v85, v41, v37
v_fma_f32 v86, v86, v41, v37
v_fma_f32 v87, v87, v41, v37
v_mul_f32 v84, v84, v180
s_add_u32 m0, s39, 4096
s_add_u32 s37, s37, s38
buffer_load_dwordx4 v22, s[8:11], s37 offen sc1 lds
v_mul_f32 v85, v85, v181
v_mul_f32 v86, v86, v182
v_mul_f32 v87, v87, v183
s_add_u32 m0, s39, 5120
s_add_u32 s37, s37, s38
buffer_load_dwordx4 v23, s[8:11], s37 offen sc1 lds
v_exp_f32 v84, v84
v_exp_f32 v85, v85
v_exp_f32 v86, v86
s_add_u32 m0, s39, 6144
s_add_u32 s37, s37, s38
buffer_load_dwordx4 v22, s[8:11], s37 offen sc1 lds
v_exp_f32 v87, v87
v_mul_f32 v244, v180, v244
v_mul_f32 v245, v181, v245
v_mul_f32 v246, v182, v246
s_add_u32 m0, s39, 7168
s_add_u32 s37, s37, s38
buffer_load_dwordx4 v23, s[8:11], s37 offen sc1 lds
v_mul_f32 v247, v183, v247
v_fma_f32 v84, v84, v45, v45
v_fma_f32 v85, v85, v45, v45
s_add_u32 m0, s39, 8192
s_add_u32 s37, s37, s38
buffer_load_dwordx4 v22, s[8:11], s37 offen sc1 lds
v_fma_f32 v86, v86, v45, v45
v_fma_f32 v87, v87, v45, v45
v_rcp_f32 v84, v84
s_add_u32 m0, s39, 9216
s_add_u32 s37, s37, s38
buffer_load_dwordx4 v23, s[8:11], s37 offen sc1 lds
v_rcp_f32 v85, v85
v_rcp_f32 v86, v86
v_rcp_f32 v87, v87
v_mul_f32 v244, v244, v84
s_add_u32 m0, s39, 10240
s_add_u32 s37, s37, s38
buffer_load_dwordx4 v22, s[8:11], s37 offen sc1 lds
v_mul_f32 v245, v245, v85
v_mul_f32 v246, v246, v86
v_mul_f32 v247, v247, v87
s_add_u32 m0, s39, 11264
s_add_u32 s37, s37, s38
buffer_load_dwordx4 v23, s[8:11], s37 offen sc1 lds
v_cvt_pk_bf16_f32 v102, v244, v245
v_cvt_pk_bf16_f32 v103, v246, v247
s_add_u32 m0, s39, 12288
s_add_u32 s37, s37, s38
buffer_load_dwordx4 v22, s[8:11], s37 offen sc1 lds
v_fma_f32 v168, -v34, v56, v168
v_fma_f32 v169, -v34, v57, v169
v_fma_f32 v170, -v34, v58, v170
v_fma_f32 v171, -v34, v59, v171
s_add_u32 m0, s39, 13312
s_add_u32 s37, s37, s38
buffer_load_dwordx4 v23, s[8:11], s37 offen sc1 lds
v_fma_f32 v232, -v34, v72, v232
v_fma_f32 v233, -v34, v73, v233
v_fma_f32 v234, -v34, v74, v234
s_add_u32 m0, s39, 14336
s_add_u32 s37, s37, s38
buffer_load_dwordx4 v22, s[8:11], s37 offen sc1 lds
v_fma_f32 v235, -v34, v75, v235
v_mul_f32 v80, v168, v168
v_mul_f32 v81, v169, v169
s_add_u32 m0, s39, 15360
s_add_u32 s37, s37, s38
buffer_load_dwordx4 v23, s[8:11], s37 offen sc1 lds
v_mul_f32 v82, v170, v170
v_mul_f32 v83, v171, v171
v_fma_f32 v80, v80, v42, v38
buffer_store_dwordx4 v[100:103], v27, s[24:27], s53 offen offset:256 sc1
s_waitcnt vmcnt(18)
s_barrier
s_add_u32 s42, s42, 1
s_and_b32 s42, s42, 15
s_add_u32 m0, s39, 49152
s_mul_i32 s37, s42, s40
buffer_load_dwordx4 v22, s[8:11], s37 offen sc1 lds
v_fma_f32 v81, v81, v42, v38
v_fma_f32 v82, v82, v42, v38
v_fma_f32 v83, v83, v42, v38
v_mul_f32 v80, v80, v168
s_add_u32 m0, s39, 50176
s_add_u32 s37, s37, s38
buffer_load_dwordx4 v23, s[8:11], s37 offen sc1 lds
v_mul_f32 v81, v81, v169
v_mul_f32 v82, v82, v170
v_mul_f32 v83, v83, v171
s_add_u32 m0, s39, 51200
s_add_u32 s37, s37, s38
buffer_load_dwordx4 v22, s[8:11], s37 offen sc1 lds
v_exp_f32 v80, v80
v_exp_f32 v81, v81
v_exp_f32 v82, v82
s_add_u32 m0, s39, 52224
s_add_u32 s37, s37, s38
buffer_load_dwordx4 v23, s[8:11], s37 offen sc1 lds
v_exp_f32 v83, v83
v_mul_f32 v232, v168, v232
v_mul_f32 v233, v169, v233
s_add_u32 m0, s39, 53248
s_add_u32 s37, s37, s38
buffer_load_dwordx4 v22, s[8:11], s37 offen sc1 lds
v_mul_f32 v234, v170, v234
v_mul_f32 v235, v171, v235
v_fma_f32 v80, v80, v46, v46
v_fma_f32 v81, v81, v46, v46
s_add_u32 m0, s39, 54272
s_add_u32 s37, s37, s38
buffer_load_dwordx4 v23, s[8:11], s37 offen sc1 lds
v_fma_f32 v82, v82, v46, v46
v_fma_f32 v83, v83, v46, v46
v_rcp_f32 v80, v80
s_add_u32 m0, s39, 55296
s_add_u32 s37, s37, s38
buffer_load_dwordx4 v22, s[8:11], s37 offen sc1 lds
v_rcp_f32 v81, v81
v_rcp_f32 v82, v82
v_rcp_f32 v83, v83
s_add_u32 m0, s39, 56320
s_add_u32 s37, s37, s38
buffer_load_dwordx4 v23, s[8:11], s37 offen sc1 lds
v_mul_f32 v232, v232, v80
v_mul_f32 v233, v233, v81
v_mul_f32 v234, v234, v82
s_add_u32 m0, s39, 57344
s_add_u32 s37, s37, s38
buffer_load_dwordx4 v22, s[8:11], s37 offen sc1 lds
v_mul_f32 v235, v235, v83
v_cvt_pk_bf16_f32 v104, v232, v233
v_cvt_pk_bf16_f32 v105, v234, v235
v_fma_f32 v184, -v34, v60, v184
s_add_u32 m0, s39, 58368
s_add_u32 s37, s37, s38
buffer_load_dwordx4 v23, s[8:11], s37 offen sc1 lds
v_fma_f32 v185, -v34, v61, v185
v_fma_f32 v186, -v34, v62, v186
v_fma_f32 v187, -v34, v63, v187
s_add_u32 m0, s39, 59392
s_add_u32 s37, s37, s38
buffer_load_dwordx4 v22, s[8:11], s37 offen sc1 lds
v_fma_f32 v248, -v34, v76, v248
v_fma_f32 v249, -v34, v77, v249
v_fma_f32 v250, -v34, v78, v250
s_add_u32 m0, s39, 60416
s_add_u32 s37, s37, s38
buffer_load_dwordx4 v23, s[8:11], s37 offen sc1 lds
v_fma_f32 v251, -v34, v79, v251
v_mul_f32 v84, v184, v184
v_mul_f32 v85, v185, v185
s_add_u32 m0, s39, 61440
s_add_u32 s37, s37, s38
buffer_load_dwordx4 v22, s[8:11], s37 offen sc1 lds
v_mul_f32 v86, v186, v186
v_mul_f32 v87, v187, v187
v_fma_f32 v84, v84, v42, v38
v_fma_f32 v85, v85, v42, v38
s_add_u32 m0, s39, 62464
s_add_u32 s37, s37, s38
buffer_load_dwordx4 v23, s[8:11], s37 offen sc1 lds
v_fma_f32 v86, v86, v42, v38
v_fma_f32 v87, v87, v42, v38
v_mul_f32 v84, v84, v184
s_add_u32 m0, s39, 63488
s_add_u32 s37, s37, s38
buffer_load_dwordx4 v22, s[8:11], s37 offen sc1 lds
v_mul_f32 v85, v85, v185
v_mul_f32 v86, v86, v186
v_mul_f32 v87, v87, v187
s_add_u32 m0, s39, 64512
s_add_u32 s37, s37, s38
buffer_load_dwordx4 v23, s[8:11], s37 offen sc1 lds
v_exp_f32 v84, v84
v_exp_f32 v85, v85
v_exp_f32 v86, v86
s_waitcnt vmcnt(17)
s_barrier
s_add_u32 s42, s42, 1
s_and_b32 s42, s42, 15
s_add_u32 m0, s39, 98304
s_mul_i32 s37, s42, s40
buffer_load_dwordx4 v22, s[8:11], s37 offen sc1 lds
v_exp_f32 v87, v87
v_mul_f32 v248, v184, v248
v_mul_f32 v249, v185, v249
v_mul_f32 v250, v186, v250
s_add_u32 m0, s39, 99328
s_add_u32 s37, s37, s38
buffer_load_dwordx4 v23, s[8:11], s37 offen sc1 lds
v_mul_f32 v251, v187, v251
v_fma_f32 v84, v84, v46, v46
v_fma_f32 v85, v85, v46, v46
s_add_u32 m0, s39, 100352
s_add_u32 s37, s37, s38
buffer_load_dwordx4 v22, s[8:11], s37 offen sc1 lds
v_fma_f32 v86, v86, v46, v46
v_fma_f32 v87, v87, v46, v46
v_rcp_f32 v84, v84
s_add_u32 m0, s39, 101376
s_add_u32 s37, s37, s38
buffer_load_dwordx4 v23, s[8:11], s37 offen sc1 lds
v_rcp_f32 v85, v85
v_rcp_f32 v86, v86
v_rcp_f32 v87, v87
s_add_u32 m0, s39, 102400
s_add_u32 s37, s37, s38
buffer_load_dwordx4 v22, s[8:11], s37 offen sc1 lds
v_mul_f32 v248, v248, v84
v_mul_f32 v249, v249, v85
v_mul_f32 v250, v250, v86
v_mul_f32 v251, v251, v87
s_add_u32 m0, s39, 103424
s_add_u32 s37, s37, s38
buffer_load_dwordx4 v23, s[8:11], s37 offen sc1 lds
v_cvt_pk_bf16_f32 v106, v248, v249
v_cvt_pk_bf16_f32 v107, v250, v251
s_add_u32 m0, s39, 104448
s_add_u32 s37, s37, s38
buffer_load_dwordx4 v22, s[8:11], s37 offen sc1 lds
v_fma_f32 v172, -v35, v56, v172
v_fma_f32 v173, -v35, v57, v173
v_fma_f32 v174, -v35, v58, v174
s_add_u32 m0, s39, 105472
s_add_u32 s37, s37, s38
buffer_load_dwordx4 v23, s[8:11], s37 offen sc1 lds
v_fma_f32 v175, -v35, v59, v175
v_fma_f32 v236, -v35, v72, v236
v_fma_f32 v237, -v35, v73, v237
s_add_u32 m0, s39, 106496
s_add_u32 s37, s37, s38
buffer_load_dwordx4 v22, s[8:11], s37 offen sc1 lds
v_fma_f32 v238, -v35, v74, v238
v_fma_f32 v239, -v35, v75, v239
v_mul_f32 v80, v172, v172
v_mul_f32 v81, v173, v173
s_add_u32 m0, s39, 107520
s_add_u32 s37, s37, s38
buffer_load_dwordx4 v23, s[8:11], s37 offen sc1 lds
v_mul_f32 v82, v174, v174
v_mul_f32 v83, v175, v175
v_fma_f32 v80, v80, v43, v39
s_add_u32 m0, s39, 108544
s_add_u32 s37, s37, s38
buffer_load_dwordx4 v22, s[8:11], s37 offen sc1 lds
v_fma_f32 v81, v81, v43, v39
v_fma_f32 v82, v82, v43, v39
v_fma_f32 v83, v83, v43, v39
s_add_u32 m0, s39, 109568
s_add_u32 s37, s37, s38
buffer_load_dwordx4 v23, s[8:11], s37 offen sc1 lds
v_mul_f32 v80, v80, v172
v_mul_f32 v81, v81, v173
v_mul_f32 v82, v82, v174
s_add_u32 m0, s39, 110592
s_add_u32 s37, s37, s38
buffer_load_dwordx4 v22, s[8:11], s37 offen sc1 lds
v_mul_f32 v83, v83, v175
v_exp_f32 v80, v80
v_exp_f32 v81, v81
v_exp_f32 v82, v82
s_add_u32 m0, s39, 111616
s_add_u32 s37, s37, s38
buffer_load_dwordx4 v23, s[8:11], s37 offen sc1 lds
v_exp_f32 v83, v83
v_mul_f32 v236, v172, v236
v_mul_f32 v237, v173, v237
s_add_u32 m0, s39, 112640
s_add_u32 s37, s37, s38
buffer_load_dwordx4 v22, s[8:11], s37 offen sc1 lds
v_mul_f32 v238, v174, v238
v_mul_f32 v239, v175, v239
v_fma_f32 v80, v80, v47, v47
s_add_u32 m0, s39, 113664
s_add_u32 s37, s37, s38
buffer_load_dwordx4 v23, s[8:11], s37 offen sc1 lds
v_fma_f32 v81, v81, v47, v47
v_fma_f32 v82, v82, v47, v47
v_fma_f32 v83, v83, v47, v47
buffer_store_dwordx4 v[104:107], v27, s[24:27], s53 offen offset:512 sc1
s_waitcnt vmcnt(17)
s_barrier
s_add_u32 s42, s42, 1
s_and_b32 s42, s42, 15
s_add_u32 m0, s39, 0
s_mul_i32 s37, s42, s40
buffer_load_dwordx4 v22, s[8:11], s37 offen sc1 lds
v_rcp_f32 v80, v80
v_rcp_f32 v81, v81
v_rcp_f32 v82, v82
v_rcp_f32 v83, v83
s_add_u32 m0, s39, 1024
s_add_u32 s37, s37, s38
buffer_load_dwordx4 v23, s[8:11], s37 offen sc1 lds
v_mul_f32 v236, v236, v80
v_mul_f32 v237, v237, v81
v_mul_f32 v238, v238, v82
s_add_u32 m0, s39, 2048
s_add_u32 s37, s37, s38
buffer_load_dwordx4 v22, s[8:11], s37 offen sc1 lds
v_mul_f32 v239, v239, v83
v_cvt_pk_bf16_f32 v108, v236, v237
v_cvt_pk_bf16_f32 v109, v238, v239
s_add_u32 m0, s39, 3072
s_add_u32 s37, s37, s38
buffer_load_dwordx4 v23, s[8:11], s37 offen sc1 lds
v_fma_f32 v188, -v35, v60, v188
v_fma_f32 v189, -v35, v61, v189
v_fma_f32 v190, -v35, v62, v190
v_fma_f32 v191, -v35, v63, v191
s_add_u32 m0, s39, 4096
s_add_u32 s37, s37, s38
buffer_load_dwordx4 v22, s[8:11], s37 offen sc1 lds
v_fma_f32 v252, -v35, v76, v252
v_fma_f32 v253, -v35, v77, v253
v_fma_f32 v254, -v35, v78, v254
s_add_u32 m0, s39, 5120
s_add_u32 s37, s37, s38
buffer_load_dwordx4 v23, s[8:11], s37 offen sc1 lds
v_fma_f32 v255, -v35, v79, v255
v_mul_f32 v84, v188, v188
v_mul_f32 v85, v189, v189
s_add_u32 m0, s39, 6144
s_add_u32 s37, s37, s38
buffer_load_dwordx4 v22, s[8:11], s37 offen sc1 lds
v_mul_f32 v86, v190, v190
v_mul_f32 v87, v191, v191
v_fma_f32 v84, v84, v43, v39
v_fma_f32 v85, v85, v43, v39
s_add_u32 m0, s39, 7168
s_add_u32 s37, s37, s38
buffer_load_dwordx4 v23, s[8:11], s37 offen sc1 lds
v_fma_f32 v86, v86, v43, v39
v_fma_f32 v87, v87, v43, v39
v_mul_f32 v84, v84, v188
s_add_u32 m0, s39, 8192
s_add_u32 s37, s37, s38
buffer_load_dwordx4 v22, s[8:11], s37 offen sc1 lds
v_mul_f32 v85, v85, v189
v_mul_f32 v86, v86, v190
v_mul_f32 v87, v87, v191
s_add_u32 m0, s39, 9216
s_add_u32 s37, s37, s38
buffer_load_dwordx4 v23, s[8:11], s37 offen sc1 lds
v_exp_f32 v84, v84
v_exp_f32 v85, v85
v_exp_f32 v86, v86
v_exp_f32 v87, v87
s_add_u32 m0, s39, 10240
s_add_u32 s37, s37, s38
buffer_load_dwordx4 v22, s[8:11], s37 offen sc1 lds
v_mul_f32 v252, v188, v252
v_mul_f32 v253, v189, v253
v_mul_f32 v254, v190, v254
s_add_u32 m0, s39, 11264
s_add_u32 s37, s37, s38
buffer_load_dwordx4 v23, s[8:11], s37 offen sc1 lds
v_mul_f32 v255, v191, v255
v_fma_f32 v84, v84, v47, v47
v_fma_f32 v85, v85, v47, v47
s_add_u32 m0, s39, 12288
s_add_u32 s37, s37, s38
buffer_load_dwordx4 v22, s[8:11], s37 offen sc1 lds
v_fma_f32 v86, v86, v47, v47
v_fma_f32 v87, v87, v47, v47
v_rcp_f32 v84, v84
v_rcp_f32 v85, v85
s_add_u32 m0, s39, 13312
s_add_u32 s37, s37, s38
buffer_load_dwordx4 v23, s[8:11], s37 offen sc1 lds
v_rcp_f32 v86, v86
v_rcp_f32 v87, v87
v_mul_f32 v252, v252, v84
s_add_u32 m0, s39, 14336
s_add_u32 s37, s37, s38
buffer_load_dwordx4 v22, s[8:11], s37 offen sc1 lds
v_mul_f32 v253, v253, v85
v_mul_f32 v254, v254, v86
v_mul_f32 v255, v255, v87
s_add_u32 m0, s39, 15360
s_add_u32 s37, s37, s38
buffer_load_dwordx4 v23, s[8:11], s37 offen sc1 lds
v_cvt_pk_bf16_f32 v110, v252, v253
v_cvt_pk_bf16_f32 v111, v254, v255
buffer_store_dwordx4 v[108:111], v27, s[24:27], s53 offen offset:768 sc1
s_waitcnt vmcnt(18)
s_barrier
s_mul_i32 s44, s34, 917504
s_lshl_b32 s39, s51, 13
s_add_u32 s44, s44, s39
s_add_u32 s44, s44, 8388608
s_and_b32 s43, s51, 1
s_xor_b32 s43, s43, s35
s_lshl_b32 s43, s43, 7
s_mov_b32 s10, 909312
s_movk_i32 s38, 1024
s_movk_i32 s40, 9216
s_movk_i32 s37, 0x4000
s_cmp_ge_u32 s51, 2
s_cselect_b32 s8, s60, s32
s_cselect_b32 s9, s61, s33
s_cselect_b32 s10, 7338112, s10
s_cselect_b32 s43, s43, s44
s_cselect_b32 s38, 16384, s38
s_cselect_b32 s40, 81920, s40
s_cselect_b32 s55, 81920, s38
s_cselect_b32 s37, 262144, s37
s_cselect_b32 s45, -1, 0
s_add_u32 s8, s8, s43
s_addc_u32 s9, s9, 0
s_mov_b32 s11, 0x20000
s_and_b32 s53, s35, 1
s_mul_i32 s54, s53, 6
s_mul_i32 s54, s54, s37
s_mul_i32 s29, s53, 2
s_add_u32 s29, s29, 6
s_mul_i32 s29, s29, s37
s_and_b32 s43, s45, 4290838528
s_add_u32 s29, s29, s43
s_mul_i32 s37, s37, 0
s_sub_u32 s37, s37, s40
v_lshrrev_b32 v19, 3, v1
v_mul_u32_u24 v19, 1920, v19
v_lshrrev_b32 v20, 4, v1
v_lshlrev_b32 v20, 5, v20
v_and_b32 v19, s45, v19
v_and_b32 v20, s45, v20
v_lshlrev_b32 v21, 4, v1
v_xor_b32 v21, v21, v20
v_add_u32 v21, v21, v19
s_mov_b64 s[72:73], -1
s_add_u32 m0, s39, 65536
s_add_u32 s37, s37, s40
buffer_load_dwordx4 v21, s[8:11], s37 offen sc1 lds
v_lshlrev_b32 v128, 16, v192
v_and_b32 v129, 0xffff0000, v192
v_lshlrev_b32 v130, 16, v193
v_and_b32 v131, 0xffff0000, v193
s_add_u32 m0, s39, 66560
s_add_u32 s37, s37, s38
buffer_load_dwordx4 v21, s[8:11], s37 offen sc1 lds
v_lshlrev_b32 v132, 16, v194
v_and_b32 v133, 0xffff0000, v194
v_lshlrev_b32 v134, 16, v195
v_and_b32 v135, 0xffff0000, v195
s_add_u32 m0, s39, 67584
s_add_u32 s37, s37, s38
buffer_load_dwordx4 v21, s[8:11], s37 offen sc1 lds
v_lshlrev_b32 v136, 16, v196
v_and_b32 v137, 0xffff0000, v196
v_lshlrev_b32 v138, 16, v197
v_and_b32 v139, 0xffff0000, v197
s_add_u32 m0, s39, 68608
s_add_u32 s37, s37, s38
buffer_load_dwordx4 v21, s[8:11], s37 offen sc1 lds
v_lshlrev_b32 v140, 16, v198
v_and_b32 v141, 0xffff0000, v198
v_lshlrev_b32 v142, 16, v199
v_and_b32 v143, 0xffff0000, v199
s_add_u32 m0, s39, 69632
s_add_u32 s37, s37, s55
buffer_load_dwordx4 v21, s[8:11], s37 offen sc1 lds
v_lshlrev_b32 v144, 16, v200
v_and_b32 v145, 0xffff0000, v200
v_lshlrev_b32 v146, 16, v201
v_and_b32 v147, 0xffff0000, v201
s_add_u32 m0, s39, 70656
s_add_u32 s37, s37, s38
buffer_load_dwordx4 v21, s[8:11], s37 offen sc1 lds
v_lshlrev_b32 v148, 16, v202
v_and_b32 v149, 0xffff0000, v202
v_lshlrev_b32 v150, 16, v203
v_and_b32 v151, 0xffff0000, v203
s_add_u32 m0, s39, 71680
s_add_u32 s37, s37, s38
buffer_load_dwordx4 v21, s[8:11], s37 offen sc1 lds
v_lshlrev_b32 v152, 16, v204
v_and_b32 v153, 0xffff0000, v204
v_lshlrev_b32 v154, 16, v205
v_and_b32 v155, 0xffff0000, v205
s_add_u32 m0, s39, 72704
s_add_u32 s37, s37, s38
buffer_load_dwordx4 v21, s[8:11], s37 offen sc1 lds
v_lshlrev_b32 v156, 16, v206
v_and_b32 v157, 0xffff0000, v206
v_lshlrev_b32 v158, 16, v207
v_and_b32 v159, 0xffff0000, v207
s_waitcnt vmcnt(8)
s_barrier
s_add_u32 m0, s39, 98304
s_add_u32 s37, s37, s40
buffer_load_dwordx4 v21, s[8:11], s37 offen sc1 lds
v_mov_b32 v192, 0
v_mov_b32 v193, 0
v_mov_b32 v194, 0
v_mov_b32 v195, 0
s_add_u32 m0, s39, 99328
s_add_u32 s37, s37, s38
buffer_load_dwordx4 v21, s[8:11], s37 offen sc1 lds
v_mov_b32 v196, 0
v_mov_b32 v197, 0
v_mov_b32 v198, 0
v_mov_b32 v199, 0
s_add_u32 m0, s39, 100352
s_add_u32 s37, s37, s38
buffer_load_dwordx4 v21, s[8:11], s37 offen sc1 lds
v_mov_b32 v200, 0
v_mov_b32 v201, 0
v_mov_b32 v202, 0
v_mov_b32 v203, 0
s_add_u32 m0, s39, 101376
s_add_u32 s37, s37, s38
buffer_load_dwordx4 v21, s[8:11], s37 offen sc1 lds
v_mov_b32 v204, 0
v_mov_b32 v205, 0
v_mov_b32 v206, 0
v_mov_b32 v207, 0
s_add_u32 m0, s39, 102400
s_add_u32 s37, s37, s55
buffer_load_dwordx4 v21, s[8:11], s37 offen sc1 lds
v_mov_b32 v208, 0
v_mov_b32 v209, 0
v_mov_b32 v210, 0
v_mov_b32 v211, 0
s_add_u32 m0, s39, 103424
s_add_u32 s37, s37, s38
buffer_load_dwordx4 v21, s[8:11], s37 offen sc1 lds
v_mov_b32 v212, 0
v_mov_b32 v213, 0
v_mov_b32 v214, 0
v_mov_b32 v215, 0
s_add_u32 m0, s39, 104448
s_add_u32 s37, s37, s38
buffer_load_dwordx4 v21, s[8:11], s37 offen sc1 lds
v_mov_b32 v216, 0
v_mov_b32 v217, 0
v_mov_b32 v218, 0
v_mov_b32 v219, 0
s_add_u32 m0, s39, 105472
s_add_u32 s37, s37, s38
buffer_load_dwordx4 v21, s[8:11], s37 offen sc1 lds
v_mov_b32 v220, 0
v_mov_b32 v221, 0
v_mov_b32 v222, 0
v_mov_b32 v223, 0
s_waitcnt vmcnt(8)
s_barrier
s_branch LK4_28
L3h_27:
v_mfma_f32_16x16x32_bf16 v[128:131], v[96:99], v[80:83], v[128:131]
v_mfma_f32_16x16x32_bf16 v[132:135], v[96:99], v[84:87], v[132:135]
v_mfma_f32_16x16x32_bf16 v[136:139], v[96:99], v[88:91], v[136:139]
v_mfma_f32_16x16x32_bf16 v[140:143], v[96:99], v[92:95], v[140:143]
v_mfma_f32_16x16x32_bf16 v[204:207], v[112:115], v[92:95], v[204:207]
v_mfma_f32_16x16x32_bf16 v[200:203], v[112:115], v[88:91], v[200:203]
v_mfma_f32_16x16x32_bf16 v[196:199], v[112:115], v[84:87], v[196:199]
v_mfma_f32_16x16x32_bf16 v[192:195], v[112:115], v[80:83], v[192:195]
v_mfma_f32_16x16x32_bf16 v[144:147], v[100:103], v[80:83], v[144:147]
v_mfma_f32_16x16x32_bf16 v[148:151], v[100:103], v[84:87], v[148:151]
v_mfma_f32_16x16x32_bf16 v[152:155], v[100:103], v[88:91], v[152:155]
v_mfma_f32_16x16x32_bf16 v[156:159], v[100:103], v[92:95], v[156:159]
v_mfma_f32_16x16x32_bf16 v[220:223], v[116:119], v[92:95], v[220:223]
v_mfma_f32_16x16x32_bf16 v[216:219], v[116:119], v[88:91], v[216:219]
v_mfma_f32_16x16x32_bf16 v[212:215], v[116:119], v[84:87], v[212:215]
v_mfma_f32_16x16x32_bf16 v[208:211], v[116:119], v[80:83], v[208:211]
v_mfma_f32_16x16x32_bf16 v[160:163], v[104:107], v[80:83], v[160:163]
v_mfma_f32_16x16x32_bf16 v[164:167], v[104:107], v[84:87], v[164:167]
v_mfma_f32_16x16x32_bf16 v[168:171], v[104:107], v[88:91], v[168:171]
v_mfma_f32_16x16x32_bf16 v[172:175], v[104:107], v[92:95], v[172:175]
v_mfma_f32_16x16x32_bf16 v[236:239], v[120:123], v[92:95], v[236:239]
v_mfma_f32_16x16x32_bf16 v[232:235], v[120:123], v[88:91], v[232:235]
v_mfma_f32_16x16x32_bf16 v[228:231], v[120:123], v[84:87], v[228:231]
v_mfma_f32_16x16x32_bf16 v[224:227], v[120:123], v[80:83], v[224:227]
v_mfma_f32_16x16x32_bf16 v[176:179], v[108:111], v[80:83], v[176:179]
v_mfma_f32_16x16x32_bf16 v[180:183], v[108:111], v[84:87], v[180:183]
v_mfma_f32_16x16x32_bf16 v[184:187], v[108:111], v[88:91], v[184:187]
v_mfma_f32_16x16x32_bf16 v[188:191], v[108:111], v[92:95], v[188:191]
v_mfma_f32_16x16x32_bf16 v[252:255], v[124:127], v[92:95], v[252:255]
v_mfma_f32_16x16x32_bf16 v[248:251], v[124:127], v[88:91], v[248:251]
v_mfma_f32_16x16x32_bf16 v[244:247], v[124:127], v[84:87], v[244:247]
v_mfma_f32_16x16x32_bf16 v[240:243], v[124:127], v[80:83], v[240:243]
s_setprio 0
s_lshl_b32 s43, s46, 9
s_add_u32 s43, s43, 147456
v_lshl_add_u32 v19, v17, 3, s43
ds_read_b64 v[80:81], v19 offset:0
ds_read_b64 v[82:83], v19 offset:128
ds_read_b64 v[84:85], v19 offset:256
ds_read_b64 v[86:87], v19 offset:384
s_mul_i32 s43, s47, 256
s_add_u32 s43, s43, 148480
v_lshl_add_u32 v19, v18, 4, s43
ds_read_b128 v[48:51], v19 offset:0
ds_read_b128 v[52:55], v19 offset:64
ds_read_b128 v[56:59], v19 offset:128
ds_read_b128 v[60:63], v19 offset:192
ds_read_b128 v[64:67], v19 offset:896
ds_read_b128 v[68:71], v19 offset:960
ds_read_b128 v[72:75], v19 offset:1024
ds_read_b128 v[76:79], v19 offset:1088
s_waitcnt lgkmcnt(0)
v_mov_b32 v32, v80
v_mul_f32 v88, v81, v81
v_mul_f32 v36, 0xc0135761, v81
v_mul_f32 v89, 0xbdd2d3e8, v81
v_rcp_f32 v44, v88
v_mul_f32 v40, v89, v88
v_mov_b32 v33, v82
v_mul_f32 v88, v83, v83
v_mul_f32 v37, 0xc0135761, v83
v_mul_f32 v89, 0xbdd2d3e8, v83
v_rcp_f32 v45, v88
v_mul_f32 v41, v89, v88
v_mov_b32 v34, v84
v_mul_f32 v88, v85, v85
v_mul_f32 v38, 0xc0135761, v85
v_mul_f32 v89, 0xbdd2d3e8, v85
v_rcp_f32 v46, v88
v_mul_f32 v42, v89, v88
v_mov_b32 v35, v86
v_mul_f32 v88, v87, v87
v_mul_f32 v39, 0xc0135761, v87
v_mul_f32 v89, 0xbdd2d3e8, v87
v_rcp_f32 v47, v88
v_mul_f32 v43, v89, v88
s_barrier
v_fma_f32 v128, -v32, v48, v128
v_fma_f32 v129, -v32, v49, v129
v_fma_f32 v130, -v32, v50, v130
v_fma_f32 v131, -v32, v51, v131
v_fma_f32 v192, -v32, v64, v192
v_fma_f32 v193, -v32, v65, v193
v_fma_f32 v194, -v32, v66, v194
v_fma_f32 v195, -v32, v67, v195
v_mul_f32 v80, v128, v128
v_mul_f32 v81, v129, v129
v_mul_f32 v82, v130, v130
v_mul_f32 v83, v131, v131
v_fma_f32 v80, v80, v40, v36
v_fma_f32 v81, v81, v40, v36
v_fma_f32 v82, v82, v40, v36
v_fma_f32 v83, v83, v40, v36
v_mul_f32 v80, v80, v128
v_mul_f32 v81, v81, v129
v_mul_f32 v82, v82, v130
v_mul_f32 v83, v83, v131
v_exp_f32 v80, v80
v_exp_f32 v81, v81
v_exp_f32 v82, v82
v_exp_f32 v83, v83
v_mul_f32 v192, v128, v192
v_mul_f32 v193, v129, v193
v_mul_f32 v194, v130, v194
v_mul_f32 v195, v131, v195
v_fma_f32 v80, v80, v44, v44
v_fma_f32 v81, v81, v44, v44
v_fma_f32 v82, v82, v44, v44
v_fma_f32 v83, v83, v44, v44
v_rcp_f32 v80, v80
v_rcp_f32 v81, v81
v_rcp_f32 v82, v82
v_rcp_f32 v83, v83
v_mul_f32 v192, v192, v80
v_mul_f32 v193, v193, v81
v_mul_f32 v194, v194, v82
v_mul_f32 v195, v195, v83
v_cvt_pk_bf16_f32 v96, v192, v193
v_cvt_pk_bf16_f32 v97, v194, v195
v_fma_f32 v144, -v32, v52, v144
v_fma_f32 v145, -v32, v53, v145
v_fma_f32 v146, -v32, v54, v146
v_fma_f32 v147, -v32, v55, v147
v_fma_f32 v208, -v32, v68, v208
v_fma_f32 v209, -v32, v69, v209
v_fma_f32 v210, -v32, v70, v210
v_fma_f32 v211, -v32, v71, v211
v_mul_f32 v84, v144, v144
v_mul_f32 v85, v145, v145
s_barrier
v_mul_f32 v86, v146, v146
v_mul_f32 v87, v147, v147
v_fma_f32 v84, v84, v40, v36
v_fma_f32 v85, v85, v40, v36
v_fma_f32 v86, v86, v40, v36
v_fma_f32 v87, v87, v40, v36
v_mul_f32 v84, v84, v144
v_mul_f32 v85, v85, v145
v_mul_f32 v86, v86, v146
v_mul_f32 v87, v87, v147
v_exp_f32 v84, v84
v_exp_f32 v85, v85
v_exp_f32 v86, v86
v_exp_f32 v87, v87
v_mul_f32 v208, v144, v208
v_mul_f32 v209, v145, v209
v_mul_f32 v210, v146, v210
v_mul_f32 v211, v147, v211
v_fma_f32 v84, v84, v44, v44
v_fma_f32 v85, v85, v44, v44
v_fma_f32 v86, v86, v44, v44
v_fma_f32 v87, v87, v44, v44
v_rcp_f32 v84, v84
v_rcp_f32 v85, v85
v_rcp_f32 v86, v86
v_rcp_f32 v87, v87
v_mul_f32 v208, v208, v84
v_mul_f32 v209, v209, v85
v_mul_f32 v210, v210, v86
v_mul_f32 v211, v211, v87
v_cvt_pk_bf16_f32 v98, v208, v209
v_cvt_pk_bf16_f32 v99, v210, v211
buffer_store_dwordx4 v[96:99], v27, s[24:27], 0 offen offset:0 sc1
v_fma_f32 v132, -v33, v48, v132
v_fma_f32 v133, -v33, v49, v133
v_fma_f32 v134, -v33, v50, v134
v_fma_f32 v135, -v33, v51, v135
v_fma_f32 v196, -v33, v64, v196
v_fma_f32 v197, -v33, v65, v197
v_fma_f32 v198, -v33, v66, v198
v_fma_f32 v199, -v33, v67, v199
v_mul_f32 v80, v132, v132
v_mul_f32 v81, v133, v133
v_mul_f32 v82, v134, v134
v_mul_f32 v83, v135, v135
v_fma_f32 v80, v80, v41, v37
v_fma_f32 v81, v81, v41, v37
v_fma_f32 v82, v82, v41, v37
v_fma_f32 v83, v83, v41, v37
v_mul_f32 v80, v80, v132
v_mul_f32 v81, v81, v133
v_mul_f32 v82, v82, v134
v_lshlrev_b32 v19, 11, v18
v_lshl_add_u32 v19, v17, 4, v19
s_lshl_b32 s43, s46, 10
v_add_u32 v2, s43, v19
v_add_u32 v3, 0x10000, v2
v_lshrrev_b32 v19, 2, v17
v_lshl_add_u32 v20, v18, 2, v19
v_bfe_u32 v21, v20, 1, 2
s_lshl_b32 s43, s47, 1
v_xor_b32 v21, s43, v21
v_lshlrev_b32 v20, 7, v20
v_lshl_add_u32 v20, v21, 5, v20
v_and_b32 v19, 3, v1
v_lshl_add_u32 v20, v19, 3, v20
v_add_u32 v5, 16384, v20
v_xor_b32 v6, 32, v5
v_add_u32 v7, 0x10000, v5
v_add_u32 v8, 0x10000, v6
s_lshl_b32 s43, s36, 13
v_lshl_add_u32 v9, v1, 4, s43
s_mov_b32 s54, 0x10000
s_movk_i32 s52, 0x1000
s_barrier
s_mov_b32 s88, s4
s_mov_b32 s89, s5
s_mov_b32 s90, 7340032
s_mov_b32 s91, 0x20000
s_mov_b32 s92, s6
s_mov_b32 s93, s7
s_mov_b32 s94, 7340032
s_mov_b32 s95, 0x20000
s_lshr_b32 s43, s35, 3
v_and_b32 v19, 1, v1
v_bfe_u32 v23, v1, 2, 3
s_lshl_b32 s44, s43, 1
s_add_u32 s44, s44, 6
v_add_u32 v23, s44, v23
s_lshl_b32 s44, s43, 1
s_add_u32 s44, s44, 1
v_mad_u32_u24 v23, v19, s44, v23
s_lshl_b32 s44, s43, 10
s_lshl_b32 s43, s43, 11
s_sub_u32 s43, 6528, s43
s_lshr_b32 s45, s2, 3
s_mul_i32 s45, s45, 14336
s_add_u32 s43, s43, s45
v_mul_lo_u32 v31, v19, s44
v_bfe_u32 v19, v1, 1, 1
v_mul_u32_u24 v19, 7168, v19
v_add3_u32 v31, v31, v19, s43
v_add_u32 v19, 8, v23
v_and_b32 v19, 15, v19
v_mul_u32_u24 v19, 458752, v19
v_add_u32 v19, v19, v31
buffer_load_dword v30, v19, s[88:91], 0 offen
buffer_load_dword v30, v19, s[92:95], 0 offen
v_mul_f32 v83, v83, v135
v_exp_f32 v80, v80
v_exp_f32 v81, v81
v_exp_f32 v82, v82
v_exp_f32 v83, v83
v_mul_f32 v196, v132, v196
v_mul_f32 v197, v133, v197
v_mul_f32 v198, v134, v198
v_mul_f32 v199, v135, v199
v_fma_f32 v80, v80, v45, v45
v_fma_f32 v81, v81, v45, v45
v_fma_f32 v82, v82, v45, v45
v_fma_f32 v83, v83, v45, v45
v_rcp_f32 v80, v80
v_rcp_f32 v81, v81
v_rcp_f32 v82, v82
v_rcp_f32 v83, v83
v_mul_f32 v196, v196, v80
v_mul_f32 v197, v197, v81
v_mul_f32 v198, v198, v82
v_mul_f32 v199, v199, v83
v_cvt_pk_bf16_f32 v100, v196, v197
v_cvt_pk_bf16_f32 v101, v198, v199
v_fma_f32 v148, -v33, v52, v148
v_fma_f32 v149, -v33, v53, v149
v_fma_f32 v150, -v33, v54, v150
v_fma_f32 v151, -v33, v55, v151
v_fma_f32 v212, -v33, v68, v212
v_fma_f32 v213, -v33, v69, v213
v_fma_f32 v214, -v33, v70, v214
v_fma_f32 v215, -v33, v71, v215
v_mul_f32 v84, v148, v148
v_mul_f32 v85, v149, v149
v_mul_f32 v86, v150, v150
v_mul_f32 v87, v151, v151
v_fma_f32 v84, v84, v41, v37
v_fma_f32 v85, v85, v41, v37
v_fma_f32 v86, v86, v41, v37
v_fma_f32 v87, v87, v41, v37
v_mul_f32 v84, v84, v148
v_mul_f32 v85, v85, v149
v_mul_f32 v86, v86, v150
v_mul_f32 v87, v87, v151
v_exp_f32 v84, v84
v_exp_f32 v85, v85
v_exp_f32 v86, v86
v_exp_f32 v87, v87
v_mul_f32 v212, v148, v212
v_mul_f32 v213, v149, v213
v_mul_f32 v214, v150, v214
v_mul_f32 v215, v151, v215
v_fma_f32 v84, v84, v45, v45
s_barrier
v_fma_f32 v85, v85, v45, v45
v_fma_f32 v86, v86, v45, v45
v_fma_f32 v87, v87, v45, v45
v_rcp_f32 v84, v84
v_rcp_f32 v85, v85
v_rcp_f32 v86, v86
v_rcp_f32 v87, v87
v_mul_f32 v212, v212, v84
v_mul_f32 v213, v213, v85
v_mul_f32 v214, v214, v86
v_mul_f32 v215, v215, v87
v_cvt_pk_bf16_f32 v102, v212, v213
v_cvt_pk_bf16_f32 v103, v214, v215
buffer_store_dwordx4 v[100:103], v27, s[24:27], 0 offen offset:256 sc1
v_fma_f32 v136, -v34, v48, v136
v_fma_f32 v137, -v34, v49, v137
v_fma_f32 v138, -v34, v50, v138
v_fma_f32 v139, -v34, v51, v139
v_fma_f32 v200, -v34, v64, v200
v_fma_f32 v201, -v34, v65, v201
v_fma_f32 v202, -v34, v66, v202
v_fma_f32 v203, -v34, v67, v203
v_mul_f32 v80, v136, v136
v_mul_f32 v81, v137, v137
v_mul_f32 v82, v138, v138
v_mul_f32 v83, v139, v139
v_fma_f32 v80, v80, v42, v38
v_fma_f32 v81, v81, v42, v38
v_fma_f32 v82, v82, v42, v38
v_fma_f32 v83, v83, v42, v38
v_mul_f32 v80, v80, v136
v_mul_f32 v81, v81, v137
v_mul_f32 v82, v82, v138
v_mul_f32 v83, v83, v139
v_exp_f32 v80, v80
v_exp_f32 v81, v81
v_exp_f32 v82, v82
v_exp_f32 v83, v83
v_mul_f32 v200, v136, v200
v_mul_f32 v201, v137, v201
v_mul_f32 v202, v138, v202
v_mul_f32 v203, v139, v203
v_fma_f32 v80, v80, v46, v46
v_fma_f32 v81, v81, v46, v46
v_fma_f32 v82, v82, v46, v46
v_fma_f32 v83, v83, v46, v46
v_rcp_f32 v80, v80
v_rcp_f32 v81, v81
v_rcp_f32 v82, v82
v_rcp_f32 v83, v83
v_mul_f32 v200, v200, v80
v_mul_f32 v201, v201, v81
v_mul_f32 v202, v202, v82
s_barrier
v_mul_f32 v203, v203, v83
v_cvt_pk_bf16_f32 v104, v200, v201
v_cvt_pk_bf16_f32 v105, v202, v203
v_fma_f32 v152, -v34, v52, v152
v_fma_f32 v153, -v34, v53, v153
v_fma_f32 v154, -v34, v54, v154
v_fma_f32 v155, -v34, v55, v155
v_fma_f32 v216, -v34, v68, v216
v_fma_f32 v217, -v34, v69, v217
v_fma_f32 v218, -v34, v70, v218
v_fma_f32 v219, -v34, v71, v219
v_mul_f32 v84, v152, v152
v_mul_f32 v85, v153, v153
v_mul_f32 v86, v154, v154
v_mul_f32 v87, v155, v155
v_fma_f32 v84, v84, v42, v38
v_fma_f32 v85, v85, v42, v38
v_fma_f32 v86, v86, v42, v38
v_fma_f32 v87, v87, v42, v38
v_mul_f32 v84, v84, v152
v_mul_f32 v85, v85, v153
v_mul_f32 v86, v86, v154
v_mul_f32 v87, v87, v155
v_exp_f32 v84, v84
v_exp_f32 v85, v85
v_exp_f32 v86, v86
v_exp_f32 v87, v87
v_mul_f32 v216, v152, v216
v_mul_f32 v217, v153, v217
v_mul_f32 v218, v154, v218
v_mul_f32 v219, v155, v219
v_fma_f32 v84, v84, v46, v46
v_fma_f32 v85, v85, v46, v46
v_fma_f32 v86, v86, v46, v46
v_fma_f32 v87, v87, v46, v46
v_rcp_f32 v84, v84
v_rcp_f32 v85, v85
v_rcp_f32 v86, v86
v_rcp_f32 v87, v87
v_mul_f32 v216, v216, v84
v_mul_f32 v217, v217, v85
v_mul_f32 v218, v218, v86
v_mul_f32 v219, v219, v87
v_cvt_pk_bf16_f32 v106, v216, v217
v_cvt_pk_bf16_f32 v107, v218, v219
buffer_store_dwordx4 v[104:107], v27, s[24:27], 0 offen offset:512 sc1
v_fma_f32 v140, -v35, v48, v140
v_fma_f32 v141, -v35, v49, v141
v_fma_f32 v142, -v35, v50, v142
v_fma_f32 v143, -v35, v51, v143
v_fma_f32 v204, -v35, v64, v204
v_fma_f32 v205, -v35, v65, v205
s_barrier
v_fma_f32 v206, -v35, v66, v206
v_fma_f32 v207, -v35, v67, v207
v_mul_f32 v80, v140, v140
v_mul_f32 v81, v141, v141
v_mul_f32 v82, v142, v142
v_mul_f32 v83, v143, v143
v_fma_f32 v80, v80, v43, v39
v_fma_f32 v81, v81, v43, v39
v_fma_f32 v82, v82, v43, v39
v_fma_f32 v83, v83, v43, v39
v_mul_f32 v80, v80, v140
v_mul_f32 v81, v81, v141
v_mul_f32 v82, v82, v142
v_mul_f32 v83, v83, v143
v_exp_f32 v80, v80
v_exp_f32 v81, v81
v_exp_f32 v82, v82
v_exp_f32 v83, v83
v_mul_f32 v204, v140, v204
v_mul_f32 v205, v141, v205
v_mul_f32 v206, v142, v206
v_mul_f32 v207, v143, v207
v_fma_f32 v80, v80, v47, v47
v_fma_f32 v81, v81, v47, v47
v_fma_f32 v82, v82, v47, v47
v_fma_f32 v83, v83, v47, v47
v_rcp_f32 v80, v80
v_rcp_f32 v81, v81
v_rcp_f32 v82, v82
v_rcp_f32 v83, v83
v_mul_f32 v204, v204, v80
v_mul_f32 v205, v205, v81
v_mul_f32 v206, v206, v82
v_mul_f32 v207, v207, v83
v_cvt_pk_bf16_f32 v108, v204, v205
v_cvt_pk_bf16_f32 v109, v206, v207
v_fma_f32 v156, -v35, v52, v156
v_fma_f32 v157, -v35, v53, v157
v_fma_f32 v158, -v35, v54, v158
v_fma_f32 v159, -v35, v55, v159
v_fma_f32 v220, -v35, v68, v220
v_fma_f32 v221, -v35, v69, v221
v_fma_f32 v222, -v35, v70, v222
v_fma_f32 v223, -v35, v71, v223
v_mul_f32 v84, v156, v156
v_mul_f32 v85, v157, v157
v_mul_f32 v86, v158, v158
v_mul_f32 v87, v159, v159
v_fma_f32 v84, v84, v43, v39
v_fma_f32 v85, v85, v43, v39
v_fma_f32 v86, v86, v43, v39
v_fma_f32 v87, v87, v43, v39
s_barrier
v_mul_f32 v84, v84, v156
v_mul_f32 v85, v85, v157
v_mul_f32 v86, v86, v158
v_mul_f32 v87, v87, v159
v_exp_f32 v84, v84
v_exp_f32 v85, v85
v_exp_f32 v86, v86
v_exp_f32 v87, v87
v_mul_f32 v220, v156, v220
v_mul_f32 v221, v157, v221
v_mul_f32 v222, v158, v222
v_mul_f32 v223, v159, v223
v_fma_f32 v84, v84, v47, v47
v_fma_f32 v85, v85, v47, v47
v_fma_f32 v86, v86, v47, v47
v_fma_f32 v87, v87, v47, v47
v_rcp_f32 v84, v84
v_rcp_f32 v85, v85
v_rcp_f32 v86, v86
v_rcp_f32 v87, v87
v_mul_f32 v220, v220, v84
v_mul_f32 v221, v221, v85
v_mul_f32 v222, v222, v86
v_mul_f32 v223, v223, v87
v_cvt_pk_bf16_f32 v110, v220, v221
v_cvt_pk_bf16_f32 v111, v222, v223
buffer_store_dwordx4 v[108:111], v27, s[24:27], 0 offen offset:768 sc1
v_fma_f32 v160, -v32, v56, v160
v_fma_f32 v161, -v32, v57, v161
v_fma_f32 v162, -v32, v58, v162
v_fma_f32 v163, -v32, v59, v163
v_fma_f32 v224, -v32, v72, v224
v_fma_f32 v225, -v32, v73, v225
v_fma_f32 v226, -v32, v74, v226
v_fma_f32 v227, -v32, v75, v227
v_mul_f32 v80, v160, v160
v_mul_f32 v81, v161, v161
v_mul_f32 v82, v162, v162
v_mul_f32 v83, v163, v163
v_fma_f32 v80, v80, v40, v36
v_fma_f32 v81, v81, v40, v36
v_fma_f32 v82, v82, v40, v36
v_fma_f32 v83, v83, v40, v36
v_mul_f32 v80, v80, v160
v_mul_f32 v81, v81, v161
v_mul_f32 v82, v82, v162
v_mul_f32 v83, v83, v163
v_exp_f32 v80, v80
v_exp_f32 v81, v81
v_exp_f32 v82, v82
v_exp_f32 v83, v83
v_mul_f32 v224, v160, v224
v_mul_f32 v225, v161, v225
s_barrier
v_mul_f32 v226, v162, v226
v_mul_f32 v227, v163, v227
v_fma_f32 v80, v80, v44, v44
v_fma_f32 v81, v81, v44, v44
v_fma_f32 v82, v82, v44, v44
v_fma_f32 v83, v83, v44, v44
v_rcp_f32 v80, v80
v_rcp_f32 v81, v81
v_rcp_f32 v82, v82
v_rcp_f32 v83, v83
v_mul_f32 v224, v224, v80
v_mul_f32 v225, v225, v81
v_mul_f32 v226, v226, v82
v_mul_f32 v227, v227, v83
v_cvt_pk_bf16_f32 v96, v224, v225
v_cvt_pk_bf16_f32 v97, v226, v227
v_fma_f32 v176, -v32, v60, v176
v_fma_f32 v177, -v32, v61, v177
v_fma_f32 v178, -v32, v62, v178
v_fma_f32 v179, -v32, v63, v179
v_fma_f32 v240, -v32, v76, v240
v_fma_f32 v241, -v32, v77, v241
v_fma_f32 v242, -v32, v78, v242
v_fma_f32 v243, -v32, v79, v243
v_mul_f32 v84, v176, v176
v_mul_f32 v85, v177, v177
v_mul_f32 v86, v178, v178
v_mul_f32 v87, v179, v179
v_fma_f32 v84, v84, v40, v36
v_fma_f32 v85, v85, v40, v36
v_fma_f32 v86, v86, v40, v36
v_fma_f32 v87, v87, v40, v36
v_mul_f32 v84, v84, v176
v_mul_f32 v85, v85, v177
v_mul_f32 v86, v86, v178
v_mul_f32 v87, v87, v179
v_exp_f32 v84, v84
v_exp_f32 v85, v85
v_exp_f32 v86, v86
v_exp_f32 v87, v87
v_mul_f32 v240, v176, v240
v_mul_f32 v241, v177, v241
v_mul_f32 v242, v178, v242
v_mul_f32 v243, v179, v243
v_fma_f32 v84, v84, v44, v44
v_fma_f32 v85, v85, v44, v44
v_fma_f32 v86, v86, v44, v44
v_fma_f32 v87, v87, v44, v44
v_rcp_f32 v84, v84
v_rcp_f32 v85, v85
v_rcp_f32 v86, v86
v_rcp_f32 v87, v87
v_lshlrev_b32 v19, 11, v18
v_lshl_add_u32 v19, v17, 4, v19
s_lshl_b32 s43, s46, 10
s_lshl_b32 s44, s47, 13
v_add3_u32 v208, v19, s43, 0
v_add_u32 v208, s44, v208
buffer_load_dwordx4 v[192:195], v208, s[20:23], 0 offen offset:0 sc1
buffer_load_dwordx4 v[196:199], v208, s[20:23], 0 offen offset:256 sc1
buffer_load_dwordx4 v[200:203], v208, s[20:23], 0 offen offset:512 sc1
buffer_load_dwordx4 v[204:207], v208, s[20:23], 0 offen offset:768 sc1
s_waitcnt vmcnt(4)
s_barrier
s_add_u32 s43, s34, 32
s_lshl_b32 s43, s43, 7
v_mov_b32 v21, s43
v_mov_b32 v22, 1
s_mov_b64 exec, 1
buffer_atomic_add v22, v21, s[56:59], 0 offen sc1
s_mov_b64 exec, -1
v_mul_f32 v240, v240, v84
v_mul_f32 v241, v241, v85
v_mul_f32 v242, v242, v86
v_mul_f32 v243, v243, v87
v_cvt_pk_bf16_f32 v98, v240, v241
v_cvt_pk_bf16_f32 v99, v242, v243
buffer_store_dwordx4 v[96:99], v27, s[24:27], s53 offen offset:0 sc1
v_fma_f32 v164, -v33, v56, v164
v_fma_f32 v165, -v33, v57, v165
v_fma_f32 v166, -v33, v58, v166
v_fma_f32 v167, -v33, v59, v167
v_fma_f32 v228, -v33, v72, v228
v_fma_f32 v229, -v33, v73, v229
v_fma_f32 v230, -v33, v74, v230
v_fma_f32 v231, -v33, v75, v231
v_mul_f32 v80, v164, v164
v_mul_f32 v81, v165, v165
v_mul_f32 v82, v166, v166
v_mul_f32 v83, v167, v167
v_fma_f32 v80, v80, v41, v37
v_fma_f32 v81, v81, v41, v37
v_fma_f32 v82, v82, v41, v37
v_fma_f32 v83, v83, v41, v37
v_mul_f32 v80, v80, v164
v_mul_f32 v81, v81, v165
v_mul_f32 v82, v82, v166
v_mul_f32 v83, v83, v167
v_exp_f32 v80, v80
v_exp_f32 v81, v81
v_exp_f32 v82, v82
v_exp_f32 v83, v83
v_mul_f32 v228, v164, v228
v_mul_f32 v229, v165, v229
v_mul_f32 v230, v166, v230
v_mul_f32 v231, v167, v231
v_fma_f32 v80, v80, v45, v45
v_fma_f32 v81, v81, v45, v45
v_fma_f32 v82, v82, v45, v45
v_fma_f32 v83, v83, v45, v45
v_rcp_f32 v80, v80
v_rcp_f32 v81, v81
v_rcp_f32 v82, v82
v_rcp_f32 v83, v83
v_mul_f32 v228, v228, v80
v_mul_f32 v229, v229, v81
v_mul_f32 v230, v230, v82
v_mul_f32 v231, v231, v83
v_cvt_pk_bf16_f32 v100, v228, v229
v_cvt_pk_bf16_f32 v101, v230, v231
v_fma_f32 v180, -v33, v60, v180
v_fma_f32 v181, -v33, v61, v181
v_fma_f32 v182, -v33, v62, v182
s_barrier
s_mov_b32 s80, s60
s_mov_b32 s81, s61
s_mov_b32 s82, 7340032
s_mov_b32 s83, 0x20000
v_and_b32 v29, 31, v1
v_lshlrev_b32 v29, 11, v29
s_and_b32 s43, s35, 8
s_or_b32 s43, s43, 3
s_lshl_b32 s43, s43, 7
v_add_u32 v29, s43, v29
s_lshr_b32 s44, s2, 3
s_lshl_b32 s44, s44, 17
s_add_u32 s43, s44, 0
buffer_load_dword v30, v29, s[80:83], s43 offen
v_fma_f32 v183, -v33, v63, v183
v_fma_f32 v244, -v33, v76, v244
v_fma_f32 v245, -v33, v77, v245
v_fma_f32 v246, -v33, v78, v246
v_fma_f32 v247, -v33, v79, v247
v_mul_f32 v84, v180, v180
v_mul_f32 v85, v181, v181
v_mul_f32 v86, v182, v182
v_mul_f32 v87, v183, v183
v_fma_f32 v84, v84, v41, v37
v_fma_f32 v85, v85, v41, v37
v_fma_f32 v86, v86, v41, v37
v_fma_f32 v87, v87, v41, v37
v_mul_f32 v84, v84, v180
v_mul_f32 v85, v85, v181
v_mul_f32 v86, v86, v182
v_mul_f32 v87, v87, v183
v_exp_f32 v84, v84
v_exp_f32 v85, v85
v_exp_f32 v86, v86
v_exp_f32 v87, v87
v_mul_f32 v244, v180, v244
v_mul_f32 v245, v181, v245
v_mul_f32 v246, v182, v246
v_mul_f32 v247, v183, v247
v_fma_f32 v84, v84, v45, v45
v_fma_f32 v85, v85, v45, v45
v_fma_f32 v86, v86, v45, v45
v_fma_f32 v87, v87, v45, v45
v_rcp_f32 v84, v84
v_rcp_f32 v85, v85
v_rcp_f32 v86, v86
v_rcp_f32 v87, v87
v_mul_f32 v244, v244, v84
v_mul_f32 v245, v245, v85
v_mul_f32 v246, v246, v86
v_mul_f32 v247, v247, v87
v_cvt_pk_bf16_f32 v102, v244, v245
v_cvt_pk_bf16_f32 v103, v246, v247
buffer_store_dwordx4 v[100:103], v27, s[24:27], s53 offen offset:256 sc1
v_fma_f32 v168, -v34, v56, v168
v_fma_f32 v169, -v34, v57, v169
v_fma_f32 v170, -v34, v58, v170
v_fma_f32 v171, -v34, v59, v171
v_fma_f32 v232, -v34, v72, v232
v_fma_f32 v233, -v34, v73, v233
v_fma_f32 v234, -v34, v74, v234
v_fma_f32 v235, -v34, v75, v235
v_mul_f32 v80, v168, v168
v_mul_f32 v81, v169, v169
v_mul_f32 v82, v170, v170
v_mul_f32 v83, v171, v171
v_fma_f32 v80, v80, v42, v38
s_waitcnt vmcnt(2)
s_barrier
v_fma_f32 v81, v81, v42, v38
v_fma_f32 v82, v82, v42, v38
v_fma_f32 v83, v83, v42, v38
v_mul_f32 v80, v80, v168
v_mul_f32 v81, v81, v169
v_mul_f32 v82, v82, v170
v_mul_f32 v83, v83, v171
v_exp_f32 v80, v80
v_exp_f32 v81, v81
v_exp_f32 v82, v82
v_exp_f32 v83, v83
v_mul_f32 v232, v168, v232
v_mul_f32 v233, v169, v233
v_mul_f32 v234, v170, v234
v_mul_f32 v235, v171, v235
v_fma_f32 v80, v80, v46, v46
v_fma_f32 v81, v81, v46, v46
v_fma_f32 v82, v82, v46, v46
v_fma_f32 v83, v83, v46, v46
v_rcp_f32 v80, v80
v_rcp_f32 v81, v81
v_rcp_f32 v82, v82
v_rcp_f32 v83, v83
v_mul_f32 v232, v232, v80
v_mul_f32 v233, v233, v81
v_mul_f32 v234, v234, v82
v_mul_f32 v235, v235, v83
v_cvt_pk_bf16_f32 v104, v232, v233
v_cvt_pk_bf16_f32 v105, v234, v235
v_fma_f32 v184, -v34, v60, v184
v_fma_f32 v185, -v34, v61, v185
v_fma_f32 v186, -v34, v62, v186
v_fma_f32 v187, -v34, v63, v187
v_fma_f32 v248, -v34, v76, v248
v_fma_f32 v249, -v34, v77, v249
v_fma_f32 v250, -v34, v78, v250
v_fma_f32 v251, -v34, v79, v251
v_mul_f32 v84, v184, v184
v_mul_f32 v85, v185, v185
v_mul_f32 v86, v186, v186
v_mul_f32 v87, v187, v187
v_fma_f32 v84, v84, v42, v38
v_fma_f32 v85, v85, v42, v38
v_fma_f32 v86, v86, v42, v38
v_fma_f32 v87, v87, v42, v38
v_mul_f32 v84, v84, v184
v_mul_f32 v85, v85, v185
v_mul_f32 v86, v86, v186
v_mul_f32 v87, v87, v187
v_exp_f32 v84, v84
v_exp_f32 v85, v85
v_exp_f32 v86, v86
s_barrier
v_exp_f32 v87, v87
v_mul_f32 v248, v184, v248
v_mul_f32 v249, v185, v249
v_mul_f32 v250, v186, v250
v_mul_f32 v251, v187, v251
v_fma_f32 v84, v84, v46, v46
v_fma_f32 v85, v85, v46, v46
v_fma_f32 v86, v86, v46, v46
v_fma_f32 v87, v87, v46, v46
v_rcp_f32 v84, v84
v_rcp_f32 v85, v85
v_rcp_f32 v86, v86
v_rcp_f32 v87, v87
v_mul_f32 v248, v248, v84
v_mul_f32 v249, v249, v85
v_mul_f32 v250, v250, v86
v_mul_f32 v251, v251, v87
v_cvt_pk_bf16_f32 v106, v248, v249
v_cvt_pk_bf16_f32 v107, v250, v251
buffer_store_dwordx4 v[104:107], v27, s[24:27], s53 offen offset:512 sc1
v_fma_f32 v172, -v35, v56, v172
v_fma_f32 v173, -v35, v57, v173
v_fma_f32 v174, -v35, v58, v174
v_fma_f32 v175, -v35, v59, v175
v_fma_f32 v236, -v35, v72, v236
v_fma_f32 v237, -v35, v73, v237
v_fma_f32 v238, -v35, v74, v238
v_fma_f32 v239, -v35, v75, v239
v_mul_f32 v80, v172, v172
v_mul_f32 v81, v173, v173
v_mul_f32 v82, v174, v174
v_mul_f32 v83, v175, v175
v_fma_f32 v80, v80, v43, v39
v_fma_f32 v81, v81, v43, v39
v_fma_f32 v82, v82, v43, v39
v_fma_f32 v83, v83, v43, v39
v_mul_f32 v80, v80, v172
v_mul_f32 v81, v81, v173
v_mul_f32 v82, v82, v174
v_mul_f32 v83, v83, v175
v_exp_f32 v80, v80
v_exp_f32 v81, v81
v_exp_f32 v82, v82
v_exp_f32 v83, v83
v_mul_f32 v236, v172, v236
v_mul_f32 v237, v173, v237
v_mul_f32 v238, v174, v238
v_mul_f32 v239, v175, v239
v_fma_f32 v80, v80, v47, v47
v_fma_f32 v81, v81, v47, v47
v_fma_f32 v82, v82, v47, v47
v_fma_f32 v83, v83, v47, v47
s_barrier
s_add_u32 s43, s34, 32
s_lshl_b32 s43, s43, 7
v_mov_b32 v21, s43
v_mov_b32 v23, 16
buffer_load_dword v22, v21, s[56:59], 0 offen sc1
v_rcp_f32 v80, v80
v_rcp_f32 v81, v81
v_rcp_f32 v82, v82
v_rcp_f32 v83, v83
v_mul_f32 v236, v236, v80
v_mul_f32 v237, v237, v81
v_mul_f32 v238, v238, v82
v_mul_f32 v239, v239, v83
v_cvt_pk_bf16_f32 v108, v236, v237
v_cvt_pk_bf16_f32 v109, v238, v239
v_fma_f32 v188, -v35, v60, v188
v_fma_f32 v189, -v35, v61, v189
v_fma_f32 v190, -v35, v62, v190
v_fma_f32 v191, -v35, v63, v191
v_fma_f32 v252, -v35, v76, v252
v_fma_f32 v253, -v35, v77, v253
v_fma_f32 v254, -v35, v78, v254
v_fma_f32 v255, -v35, v79, v255
v_mul_f32 v84, v188, v188
v_mul_f32 v85, v189, v189
v_mul_f32 v86, v190, v190
v_mul_f32 v87, v191, v191
v_fma_f32 v84, v84, v43, v39
v_fma_f32 v85, v85, v43, v39
v_fma_f32 v86, v86, v43, v39
v_fma_f32 v87, v87, v43, v39
v_mul_f32 v84, v84, v188
v_mul_f32 v85, v85, v189
v_mul_f32 v86, v86, v190
v_mul_f32 v87, v87, v191
v_exp_f32 v84, v84
v_exp_f32 v85, v85
v_exp_f32 v86, v86
v_exp_f32 v87, v87
v_mul_f32 v252, v188, v252
v_mul_f32 v253, v189, v253
v_mul_f32 v254, v190, v254
v_mul_f32 v255, v191, v255
v_fma_f32 v84, v84, v47, v47
v_fma_f32 v85, v85, v47, v47
v_fma_f32 v86, v86, v47, v47
v_fma_f32 v87, v87, v47, v47
v_rcp_f32 v84, v84
v_rcp_f32 v85, v85
v_rcp_f32 v86, v86
v_rcp_f32 v87, v87
v_mul_f32 v252, v252, v84
v_mul_f32 v253, v253, v85
v_mul_f32 v254, v254, v86
v_mul_f32 v255, v255, v87
v_cvt_pk_bf16_f32 v110, v252, v253
v_cvt_pk_bf16_f32 v111, v254, v255
buffer_store_dwordx4 v[108:111], v27, s[24:27], s53 offen offset:768 sc1
s_mov_b32 s41, 0x10000
Lpoll_29:
s_waitcnt vmcnt(0)
Lpf_31:
v_cmp_ne_u32 vcc, v23, v22
s_nop 4
s_cbranch_vccz Lpok_30
buffer_load_dword v22, v21, s[56:59], 0 offen sc1
s_sub_u32 s41, s41, 1
s_cmp_lg_u32 s41, 0
s_cbranch_scc1 Lpoll_29
s_waitcnt vmcnt(0)
Lpok_30:
s_barrier
v_lshlrev_b32 v128, 16, v192
v_and_b32 v129, 0xffff0000, v192
v_lshlrev_b32 v130, 16, v193
v_and_b32 v131, 0xffff0000, v193
v_lshlrev_b32 v132, 16, v194
v_and_b32 v133, 0xffff0000, v194
v_lshlrev_b32 v134, 16, v195
v_and_b32 v135, 0xffff0000, v195
v_lshlrev_b32 v136, 16, v196
v_and_b32 v137, 0xffff0000, v196
v_lshlrev_b32 v138, 16, v197
v_and_b32 v139, 0xffff0000, v197
v_lshlrev_b32 v140, 16, v198
v_and_b32 v141, 0xffff0000, v198
v_lshlrev_b32 v142, 16, v199
v_and_b32 v143, 0xffff0000, v199
v_lshlrev_b32 v144, 16, v200
v_and_b32 v145, 0xffff0000, v200
v_lshlrev_b32 v146, 16, v201
v_and_b32 v147, 0xffff0000, v201
v_lshlrev_b32 v148, 16, v202
v_and_b32 v149, 0xffff0000, v202
v_lshlrev_b32 v150, 16, v203
v_and_b32 v151, 0xffff0000, v203
v_lshlrev_b32 v152, 16, v204
v_and_b32 v153, 0xffff0000, v204
v_lshlrev_b32 v154, 16, v205
v_and_b32 v155, 0xffff0000, v205
v_lshlrev_b32 v156, 16, v206
v_and_b32 v157, 0xffff0000, v206
v_lshlrev_b32 v158, 16, v207
v_and_b32 v159, 0xffff0000, v207
s_waitcnt vmcnt(0)
s_barrier
s_add_u32 s43, s34, 48
s_lshl_b32 s43, s43, 7
v_mov_b32 v22, s43
v_mov_b32 v23, 1
s_mov_b64 exec, 1
buffer_atomic_add v23, v22, s[56:59], 0 offen sc1
s_mov_b64 exec, -1
v_mov_b32 v192, 0
v_mov_b32 v193, 0
v_mov_b32 v194, 0
v_mov_b32 v195, 0
v_mov_b32 v196, 0
v_mov_b32 v197, 0
v_mov_b32 v198, 0
v_mov_b32 v199, 0
v_mov_b32 v200, 0
v_mov_b32 v201, 0
v_mov_b32 v202, 0
v_mov_b32 v203, 0
v_mov_b32 v204, 0
v_mov_b32 v205, 0
v_mov_b32 v206, 0
v_mov_b32 v207, 0
v_mov_b32 v208, 0
v_mov_b32 v209, 0
v_mov_b32 v210, 0
v_mov_b32 v211, 0
v_mov_b32 v212, 0
v_mov_b32 v213, 0
v_mov_b32 v214, 0
v_mov_b32 v215, 0
v_mov_b32 v216, 0
v_mov_b32 v217, 0
v_mov_b32 v218, 0
v_mov_b32 v219, 0
v_mov_b32 v220, 0
v_mov_b32 v221, 0
v_mov_b32 v222, 0
v_mov_b32 v223, 0
s_barrier
LK4_28:
s_setprio 1
ds_read_b64_tr_b16 v[64:65], v7 offset:0
ds_read_b128 v[32:35], v3 offset:0
ds_read_b64_tr_b16 v[66:67], v7 offset:2048
ds_read_b128 v[36:39], v3 offset:256
ds_read_b64_tr_b16 v[68:69], v8 offset:0
ds_read_b128 v[40:43], v3 offset:512
ds_read_b64_tr_b16 v[70:71], v8 offset:2048
ds_read_b128 v[44:47], v3 offset:768
ds_read_b64_tr_b16 v[72:73], v7 offset:4096
ds_read_b128 v[48:51], v3 offset:8192
ds_read_b64_tr_b16 v[74:75], v7 offset:6144
ds_read_b128 v[52:55], v3 offset:8448
ds_read_b64_tr_b16 v[76:77], v8 offset:4096
ds_read_b128 v[56:59], v3 offset:8704
ds_read_b64_tr_b16 v[78:79], v8 offset:6144
ds_read_b128 v[60:63], v3 offset:8960
s_waitcnt vmcnt(0) lgkmcnt(0)
s_barrier
v_mfma_f32_16x16x32_bf16 v[128:131], v[64:67], v[32:35], v[128:131]
ds_read_b64_tr_b16 v[160:161], v7 offset:32768
v_mfma_f32_16x16x32_bf16 v[132:135], v[68:71], v[32:35], v[132:135]
ds_read_b128 v[96:99], v3 offset:32768
v_mfma_f32_16x16x32_bf16 v[136:139], v[64:67], v[36:39], v[136:139]
ds_read_b64_tr_b16 v[162:163], v7 offset:34816
v_mfma_f32_16x16x32_bf16 v[140:143], v[68:71], v[36:39], v[140:143]
ds_read_b128 v[100:103], v3 offset:33024
v_mfma_f32_16x16x32_bf16 v[144:147], v[64:67], v[40:43], v[144:147]
ds_read_b64_tr_b16 v[164:165], v8 offset:32768
v_mfma_f32_16x16x32_bf16 v[148:151], v[68:71], v[40:43], v[148:151]
ds_read_b128 v[104:107], v3 offset:33280
v_mfma_f32_16x16x32_bf16 v[152:155], v[64:67], v[44:47], v[152:155]
ds_read_b64_tr_b16 v[166:167], v8 offset:34816
v_mfma_f32_16x16x32_bf16 v[156:159], v[68:71], v[44:47], v[156:159]
ds_read_b128 v[108:111], v3 offset:33536
v_mfma_f32_16x16x32_bf16 v[128:131], v[72:75], v[48:51], v[128:131]
ds_read_b64_tr_b16 v[168:169], v7 offset:36864
v_mfma_f32_16x16x32_bf16 v[132:135], v[76:79], v[48:51], v[132:135]
ds_read_b128 v[112:115], v3 offset:40960
v_mfma_f32_16x16x32_bf16 v[136:139], v[72:75], v[52:55], v[136:139]
ds_read_b64_tr_b16 v[170:171], v7 offset:38912
v_mfma_f32_16x16x32_bf16 v[140:143], v[76:79], v[52:55], v[140:143]
ds_read_b128 v[116:119], v3 offset:41216
v_mfma_f32_16x16x32_bf16 v[144:147], v[72:75], v[56:59], v[144:147]
ds_read_b64_tr_b16 v[172:173], v8 offset:36864
v_mfma_f32_16x16x32_bf16 v[148:151], v[76:79], v[56:59], v[148:151]
ds_read_b128 v[120:123], v3 offset:41472
v_mfma_f32_16x16x32_bf16 v[152:155], v[72:75], v[60:63], v[152:155]
ds_read_b64_tr_b16 v[174:175], v8 offset:38912
v_mfma_f32_16x16x32_bf16 v[156:159], v[76:79], v[60:63], v[156:159]
ds_read_b128 v[124:127], v3 offset:41728
s_waitcnt lgkmcnt(0)
s_barrier
v_mfma_f32_16x16x32_bf16 v[128:131], v[160:163], v[96:99], v[128:131]
ds_read_b64_tr_b16 v[64:65], v5 offset:0
v_mfma_f32_16x16x32_bf16 v[132:135], v[164:167], v[96:99], v[132:135]
ds_read_b128 v[32:35], v2 offset:0
v_mfma_f32_16x16x32_bf16 v[136:139], v[160:163], v[100:103], v[136:139]
ds_read_b64_tr_b16 v[66:67], v5 offset:2048
v_mfma_f32_16x16x32_bf16 v[140:143], v[164:167], v[100:103], v[140:143]
ds_read_b128 v[36:39], v2 offset:256
v_mfma_f32_16x16x32_bf16 v[144:147], v[160:163], v[104:107], v[144:147]
ds_read_b64_tr_b16 v[68:69], v6 offset:0
v_mfma_f32_16x16x32_bf16 v[148:151], v[164:167], v[104:107], v[148:151]
ds_read_b128 v[40:43], v2 offset:512
v_mfma_f32_16x16x32_bf16 v[152:155], v[160:163], v[108:111], v[152:155]
ds_read_b64_tr_b16 v[70:71], v6 offset:2048
v_mfma_f32_16x16x32_bf16 v[156:159], v[164:167], v[108:111], v[156:159]
ds_read_b128 v[44:47], v2 offset:768
v_mfma_f32_16x16x32_bf16 v[128:131], v[168:171], v[112:115], v[128:131]
ds_read_b64_tr_b16 v[72:73], v5 offset:4096
v_mfma_f32_16x16x32_bf16 v[132:135], v[172:175], v[112:115], v[132:135]
ds_read_b128 v[48:51], v2 offset:8192
v_mfma_f32_16x16x32_bf16 v[136:139], v[168:171], v[116:119], v[136:139]
ds_read_b64_tr_b16 v[74:75], v5 offset:6144
v_mfma_f32_16x16x32_bf16 v[140:143], v[172:175], v[116:119], v[140:143]
ds_read_b128 v[52:55], v2 offset:8448
v_mfma_f32_16x16x32_bf16 v[144:147], v[168:171], v[120:123], v[144:147]
ds_read_b64_tr_b16 v[76:77], v6 offset:4096
v_mfma_f32_16x16x32_bf16 v[148:151], v[172:175], v[120:123], v[148:151]
ds_read_b128 v[56:59], v2 offset:8704
v_mfma_f32_16x16x32_bf16 v[152:155], v[168:171], v[124:127], v[152:155]
ds_read_b64_tr_b16 v[78:79], v6 offset:6144
v_mfma_f32_16x16x32_bf16 v[156:159], v[172:175], v[124:127], v[156:159]
ds_read_b128 v[60:63], v2 offset:8960
s_waitcnt lgkmcnt(0)
s_barrier
v_mfma_f32_16x16x32_bf16 v[128:131], v[64:67], v[32:35], v[128:131]
ds_read_b64_tr_b16 v[160:161], v5 offset:32768
v_mfma_f32_16x16x32_bf16 v[132:135], v[68:71], v[32:35], v[132:135]
ds_read_b128 v[96:99], v2 offset:32768
v_mfma_f32_16x16x32_bf16 v[136:139], v[64:67], v[36:39], v[136:139]
ds_read_b64_tr_b16 v[162:163], v5 offset:34816
v_mfma_f32_16x16x32_bf16 v[140:143], v[68:71], v[36:39], v[140:143]
ds_read_b128 v[100:103], v2 offset:33024
v_mfma_f32_16x16x32_bf16 v[144:147], v[64:67], v[40:43], v[144:147]
ds_read_b64_tr_b16 v[164:165], v6 offset:32768
v_mfma_f32_16x16x32_bf16 v[148:151], v[68:71], v[40:43], v[148:151]
ds_read_b128 v[104:107], v2 offset:33280
v_mfma_f32_16x16x32_bf16 v[152:155], v[64:67], v[44:47], v[152:155]
ds_read_b64_tr_b16 v[166:167], v6 offset:34816
v_mfma_f32_16x16x32_bf16 v[156:159], v[68:71], v[44:47], v[156:159]
ds_read_b128 v[108:111], v2 offset:33536
v_mfma_f32_16x16x32_bf16 v[128:131], v[72:75], v[48:51], v[128:131]
ds_read_b64_tr_b16 v[168:169], v5 offset:36864
v_mfma_f32_16x16x32_bf16 v[132:135], v[76:79], v[48:51], v[132:135]
ds_read_b128 v[112:115], v2 offset:40960
v_mfma_f32_16x16x32_bf16 v[136:139], v[72:75], v[52:55], v[136:139]
ds_read_b64_tr_b16 v[170:171], v5 offset:38912
v_mfma_f32_16x16x32_bf16 v[140:143], v[76:79], v[52:55], v[140:143]
ds_read_b128 v[116:119], v2 offset:41216
v_mfma_f32_16x16x32_bf16 v[144:147], v[72:75], v[56:59], v[144:147]
ds_read_b64_tr_b16 v[172:173], v6 offset:36864
v_mfma_f32_16x16x32_bf16 v[148:151], v[76:79], v[56:59], v[148:151]
ds_read_b128 v[120:123], v2 offset:41472
v_mfma_f32_16x16x32_bf16 v[152:155], v[72:75], v[60:63], v[152:155]
ds_read_b64_tr_b16 v[174:175], v6 offset:38912
v_mfma_f32_16x16x32_bf16 v[156:159], v[76:79], v[60:63], v[156:159]
ds_read_b128 v[124:127], v2 offset:41728
s_waitcnt lgkmcnt(0)
s_barrier
v_mfma_f32_16x16x32_bf16 v[128:131], v[160:163], v[96:99], v[128:131]
ds_read_b64_tr_b16 v[64:65], v7 offset:0
v_mfma_f32_16x16x32_bf16 v[132:135], v[164:167], v[96:99], v[132:135]
ds_read_b128 v[32:35], v3 offset:0
v_mfma_f32_16x16x32_bf16 v[136:139], v[160:163], v[100:103], v[136:139]
ds_read_b64_tr_b16 v[66:67], v7 offset:2048
v_mfma_f32_16x16x32_bf16 v[140:143], v[164:167], v[100:103], v[140:143]
ds_read_b128 v[36:39], v3 offset:256
v_mfma_f32_16x16x32_bf16 v[144:147], v[160:163], v[104:107], v[144:147]
ds_read_b64_tr_b16 v[68:69], v8 offset:0
v_mfma_f32_16x16x32_bf16 v[148:151], v[164:167], v[104:107], v[148:151]
ds_read_b128 v[40:43], v3 offset:512
v_mfma_f32_16x16x32_bf16 v[152:155], v[160:163], v[108:111], v[152:155]
ds_read_b64_tr_b16 v[70:71], v8 offset:2048
v_mfma_f32_16x16x32_bf16 v[156:159], v[164:167], v[108:111], v[156:159]
ds_read_b128 v[44:47], v3 offset:768
v_mfma_f32_16x16x32_bf16 v[128:131], v[168:171], v[112:115], v[128:131]
ds_read_b64_tr_b16 v[80:81], v7 offset:8192
v_mfma_f32_16x16x32_bf16 v[132:135], v[172:175], v[112:115], v[132:135]
ds_read_b64_tr_b16 v[82:83], v7 offset:10240
v_mfma_f32_16x16x32_bf16 v[136:139], v[168:171], v[116:119], v[136:139]
ds_read_b64_tr_b16 v[84:85], v8 offset:8192
v_mfma_f32_16x16x32_bf16 v[140:143], v[172:175], v[116:119], v[140:143]
ds_read_b64_tr_b16 v[86:87], v8 offset:10240
v_mfma_f32_16x16x32_bf16 v[144:147], v[168:171], v[120:123], v[144:147]
ds_read_b64_tr_b16 v[72:73], v7 offset:4096
v_mfma_f32_16x16x32_bf16 v[148:151], v[172:175], v[120:123], v[148:151]
ds_read_b128 v[48:51], v3 offset:8192
v_mfma_f32_16x16x32_bf16 v[152:155], v[168:171], v[124:127], v[152:155]
ds_read_b64_tr_b16 v[74:75], v7 offset:6144
v_mfma_f32_16x16x32_bf16 v[156:159], v[172:175], v[124:127], v[156:159]
ds_read_b128 v[52:55], v3 offset:8448
ds_read_b64_tr_b16 v[76:77], v8 offset:4096
ds_read_b128 v[56:59], v3 offset:8704
ds_read_b64_tr_b16 v[78:79], v8 offset:6144
ds_read_b128 v[60:63], v3 offset:8960
ds_read_b64_tr_b16 v[88:89], v7 offset:12288
ds_read_b64_tr_b16 v[90:91], v7 offset:14336
ds_read_b64_tr_b16 v[92:93], v8 offset:12288
ds_read_b64_tr_b16 v[94:95], v8 offset:14336
s_mov_b32 s41, 4
Lk4_32:
s_waitcnt lgkmcnt(0)
s_barrier
v_mfma_f32_16x16x32_bf16 v[128:131], v[64:67], v[32:35], v[128:131]
ds_read_b64_tr_b16 v[160:161], v7 offset:32768
v_mfma_f32_16x16x32_bf16 v[132:135], v[68:71], v[32:35], v[132:135]
ds_read_b128 v[96:99], v3 offset:32768
v_mfma_f32_16x16x32_bf16 v[192:195], v[80:83], v[32:35], v[192:195]
ds_read_b64_tr_b16 v[162:163], v7 offset:34816
v_mfma_f32_16x16x32_bf16 v[196:199], v[84:87], v[32:35], v[196:199]
ds_read_b128 v[100:103], v3 offset:33024
v_mfma_f32_16x16x32_bf16 v[136:139], v[64:67], v[36:39], v[136:139]
ds_read_b64_tr_b16 v[164:165], v8 offset:32768
v_mfma_f32_16x16x32_bf16 v[140:143], v[68:71], v[36:39], v[140:143]
ds_read_b128 v[104:107], v3 offset:33280
v_mfma_f32_16x16x32_bf16 v[200:203], v[80:83], v[36:39], v[200:203]
ds_read_b64_tr_b16 v[166:167], v8 offset:34816
v_mfma_f32_16x16x32_bf16 v[204:207], v[84:87], v[36:39], v[204:207]
ds_read_b128 v[108:111], v3 offset:33536
v_mfma_f32_16x16x32_bf16 v[144:147], v[64:67], v[40:43], v[144:147]
ds_read_b64_tr_b16 v[176:177], v7 offset:40960
v_mfma_f32_16x16x32_bf16 v[148:151], v[68:71], v[40:43], v[148:151]
ds_read_b64_tr_b16 v[178:179], v7 offset:43008
v_mfma_f32_16x16x32_bf16 v[208:211], v[80:83], v[40:43], v[208:211]
ds_read_b64_tr_b16 v[180:181], v8 offset:40960
v_mfma_f32_16x16x32_bf16 v[212:215], v[84:87], v[40:43], v[212:215]
ds_read_b64_tr_b16 v[182:183], v8 offset:43008
v_mfma_f32_16x16x32_bf16 v[152:155], v[64:67], v[44:47], v[152:155]
ds_read_b64_tr_b16 v[168:169], v7 offset:36864
v_mfma_f32_16x16x32_bf16 v[156:159], v[68:71], v[44:47], v[156:159]
ds_read_b128 v[112:115], v3 offset:40960
v_mfma_f32_16x16x32_bf16 v[216:219], v[80:83], v[44:47], v[216:219]
ds_read_b64_tr_b16 v[170:171], v7 offset:38912
v_mfma_f32_16x16x32_bf16 v[220:223], v[84:87], v[44:47], v[220:223]
ds_read_b128 v[116:119], v3 offset:41216
v_mfma_f32_16x16x32_bf16 v[128:131], v[72:75], v[48:51], v[128:131]
ds_read_b64_tr_b16 v[172:173], v8 offset:36864
v_mfma_f32_16x16x32_bf16 v[132:135], v[76:79], v[48:51], v[132:135]
ds_read_b128 v[120:123], v3 offset:41472
v_mfma_f32_16x16x32_bf16 v[192:195], v[88:91], v[48:51], v[192:195]
ds_read_b64_tr_b16 v[174:175], v8 offset:38912
v_mfma_f32_16x16x32_bf16 v[196:199], v[92:95], v[48:51], v[196:199]
ds_read_b128 v[124:127], v3 offset:41728
v_mfma_f32_16x16x32_bf16 v[136:139], v[72:75], v[52:55], v[136:139]
ds_read_b64_tr_b16 v[184:185], v7 offset:45056
v_mfma_f32_16x16x32_bf16 v[140:143], v[76:79], v[52:55], v[140:143]
ds_read_b64_tr_b16 v[186:187], v7 offset:47104
v_mfma_f32_16x16x32_bf16 v[200:203], v[88:91], v[52:55], v[200:203]
ds_read_b64_tr_b16 v[188:189], v8 offset:45056
v_mfma_f32_16x16x32_bf16 v[204:207], v[92:95], v[52:55], v[204:207]
ds_read_b64_tr_b16 v[190:191], v8 offset:47104
v_mfma_f32_16x16x32_bf16 v[144:147], v[72:75], v[56:59], v[144:147]
v_mfma_f32_16x16x32_bf16 v[148:151], v[76:79], v[56:59], v[148:151]
v_mfma_f32_16x16x32_bf16 v[208:211], v[88:91], v[56:59], v[208:211]
v_mfma_f32_16x16x32_bf16 v[212:215], v[92:95], v[56:59], v[212:215]
v_mfma_f32_16x16x32_bf16 v[152:155], v[72:75], v[60:63], v[152:155]
v_mfma_f32_16x16x32_bf16 v[156:159], v[76:79], v[60:63], v[156:159]
v_mfma_f32_16x16x32_bf16 v[216:219], v[88:91], v[60:63], v[216:219]
v_mfma_f32_16x16x32_bf16 v[220:223], v[92:95], v[60:63], v[220:223]
s_waitcnt lgkmcnt(0)
s_barrier
v_mfma_f32_16x16x32_bf16 v[128:131], v[160:163], v[96:99], v[128:131]
ds_read_b64_tr_b16 v[64:65], v5 offset:0
v_mfma_f32_16x16x32_bf16 v[132:135], v[164:167], v[96:99], v[132:135]
ds_read_b128 v[32:35], v2 offset:0
v_mfma_f32_16x16x32_bf16 v[192:195], v[176:179], v[96:99], v[192:195]
ds_read_b64_tr_b16 v[66:67], v5 offset:2048
v_mfma_f32_16x16x32_bf16 v[196:199], v[180:183], v[96:99], v[196:199]
ds_read_b128 v[36:39], v2 offset:256
v_mfma_f32_16x16x32_bf16 v[136:139], v[160:163], v[100:103], v[136:139]
ds_read_b64_tr_b16 v[68:69], v6 offset:0
v_mfma_f32_16x16x32_bf16 v[140:143], v[164:167], v[100:103], v[140:143]
ds_read_b128 v[40:43], v2 offset:512
v_mfma_f32_16x16x32_bf16 v[200:203], v[176:179], v[100:103], v[200:203]
ds_read_b64_tr_b16 v[70:71], v6 offset:2048
v_mfma_f32_16x16x32_bf16 v[204:207], v[180:183], v[100:103], v[204:207]
ds_read_b128 v[44:47], v2 offset:768
v_mfma_f32_16x16x32_bf16 v[144:147], v[160:163], v[104:107], v[144:147]
ds_read_b64_tr_b16 v[80:81], v5 offset:8192
v_mfma_f32_16x16x32_bf16 v[148:151], v[164:167], v[104:107], v[148:151]
ds_read_b64_tr_b16 v[82:83], v5 offset:10240
v_mfma_f32_16x16x32_bf16 v[208:211], v[176:179], v[104:107], v[208:211]
ds_read_b64_tr_b16 v[84:85], v6 offset:8192
v_mfma_f32_16x16x32_bf16 v[212:215], v[180:183], v[104:107], v[212:215]
ds_read_b64_tr_b16 v[86:87], v6 offset:10240
v_mfma_f32_16x16x32_bf16 v[152:155], v[160:163], v[108:111], v[152:155]
ds_read_b64_tr_b16 v[72:73], v5 offset:4096
v_mfma_f32_16x16x32_bf16 v[156:159], v[164:167], v[108:111], v[156:159]
ds_read_b128 v[48:51], v2 offset:8192
v_mfma_f32_16x16x32_bf16 v[216:219], v[176:179], v[108:111], v[216:219]
ds_read_b64_tr_b16 v[74:75], v5 offset:6144
v_mfma_f32_16x16x32_bf16 v[220:223], v[180:183], v[108:111], v[220:223]
ds_read_b128 v[52:55], v2 offset:8448
v_mfma_f32_16x16x32_bf16 v[128:131], v[168:171], v[112:115], v[128:131]
ds_read_b64_tr_b16 v[76:77], v6 offset:4096
v_mfma_f32_16x16x32_bf16 v[132:135], v[172:175], v[112:115], v[132:135]
ds_read_b128 v[56:59], v2 offset:8704
v_mfma_f32_16x16x32_bf16 v[192:195], v[184:187], v[112:115], v[192:195]
ds_read_b64_tr_b16 v[78:79], v6 offset:6144
v_mfma_f32_16x16x32_bf16 v[196:199], v[188:191], v[112:115], v[196:199]
ds_read_b128 v[60:63], v2 offset:8960
v_mfma_f32_16x16x32_bf16 v[136:139], v[168:171], v[116:119], v[136:139]
ds_read_b64_tr_b16 v[88:89], v5 offset:12288
v_mfma_f32_16x16x32_bf16 v[140:143], v[172:175], v[116:119], v[140:143]
ds_read_b64_tr_b16 v[90:91], v5 offset:14336
v_mfma_f32_16x16x32_bf16 v[200:203], v[184:187], v[116:119], v[200:203]
ds_read_b64_tr_b16 v[92:93], v6 offset:12288
v_mfma_f32_16x16x32_bf16 v[204:207], v[188:191], v[116:119], v[204:207]
ds_read_b64_tr_b16 v[94:95], v6 offset:14336
v_mfma_f32_16x16x32_bf16 v[144:147], v[168:171], v[120:123], v[144:147]
v_mfma_f32_16x16x32_bf16 v[148:151], v[172:175], v[120:123], v[148:151]
v_mfma_f32_16x16x32_bf16 v[208:211], v[184:187], v[120:123], v[208:211]
v_mfma_f32_16x16x32_bf16 v[212:215], v[188:191], v[120:123], v[212:215]
v_mfma_f32_16x16x32_bf16 v[152:155], v[168:171], v[124:127], v[152:155]
v_mfma_f32_16x16x32_bf16 v[156:159], v[172:175], v[124:127], v[156:159]
v_mfma_f32_16x16x32_bf16 v[216:219], v[184:187], v[124:127], v[216:219]
v_mfma_f32_16x16x32_bf16 v[220:223], v[188:191], v[124:127], v[220:223]
s_waitcnt lgkmcnt(0)
s_barrier
v_mfma_f32_16x16x32_bf16 v[128:131], v[64:67], v[32:35], v[128:131]
ds_read_b64_tr_b16 v[160:161], v5 offset:32768
v_mfma_f32_16x16x32_bf16 v[132:135], v[68:71], v[32:35], v[132:135]
ds_read_b128 v[96:99], v2 offset:32768
v_mfma_f32_16x16x32_bf16 v[192:195], v[80:83], v[32:35], v[192:195]
ds_read_b64_tr_b16 v[162:163], v5 offset:34816
v_mfma_f32_16x16x32_bf16 v[196:199], v[84:87], v[32:35], v[196:199]
ds_read_b128 v[100:103], v2 offset:33024
v_mfma_f32_16x16x32_bf16 v[136:139], v[64:67], v[36:39], v[136:139]
ds_read_b64_tr_b16 v[164:165], v6 offset:32768
v_mfma_f32_16x16x32_bf16 v[140:143], v[68:71], v[36:39], v[140:143]
ds_read_b128 v[104:107], v2 offset:33280
v_mfma_f32_16x16x32_bf16 v[200:203], v[80:83], v[36:39], v[200:203]
ds_read_b64_tr_b16 v[166:167], v6 offset:34816
v_mfma_f32_16x16x32_bf16 v[204:207], v[84:87], v[36:39], v[204:207]
ds_read_b128 v[108:111], v2 offset:33536
v_mfma_f32_16x16x32_bf16 v[144:147], v[64:67], v[40:43], v[144:147]
ds_read_b64_tr_b16 v[176:177], v5 offset:40960
v_mfma_f32_16x16x32_bf16 v[148:151], v[68:71], v[40:43], v[148:151]
ds_read_b64_tr_b16 v[178:179], v5 offset:43008
v_mfma_f32_16x16x32_bf16 v[208:211], v[80:83], v[40:43], v[208:211]
ds_read_b64_tr_b16 v[180:181], v6 offset:40960
v_mfma_f32_16x16x32_bf16 v[212:215], v[84:87], v[40:43], v[212:215]
ds_read_b64_tr_b16 v[182:183], v6 offset:43008
v_mfma_f32_16x16x32_bf16 v[152:155], v[64:67], v[44:47], v[152:155]
ds_read_b64_tr_b16 v[168:169], v5 offset:36864
v_mfma_f32_16x16x32_bf16 v[156:159], v[68:71], v[44:47], v[156:159]
ds_read_b128 v[112:115], v2 offset:40960
v_mfma_f32_16x16x32_bf16 v[216:219], v[80:83], v[44:47], v[216:219]
ds_read_b64_tr_b16 v[170:171], v5 offset:38912
v_mfma_f32_16x16x32_bf16 v[220:223], v[84:87], v[44:47], v[220:223]
ds_read_b128 v[116:119], v2 offset:41216
v_mfma_f32_16x16x32_bf16 v[128:131], v[72:75], v[48:51], v[128:131]
ds_read_b64_tr_b16 v[172:173], v6 offset:36864
v_mfma_f32_16x16x32_bf16 v[132:135], v[76:79], v[48:51], v[132:135]
ds_read_b128 v[120:123], v2 offset:41472
v_mfma_f32_16x16x32_bf16 v[192:195], v[88:91], v[48:51], v[192:195]
ds_read_b64_tr_b16 v[174:175], v6 offset:38912
v_mfma_f32_16x16x32_bf16 v[196:199], v[92:95], v[48:51], v[196:199]
ds_read_b128 v[124:127], v2 offset:41728
v_mfma_f32_16x16x32_bf16 v[136:139], v[72:75], v[52:55], v[136:139]
ds_read_b64_tr_b16 v[184:185], v5 offset:45056
v_mfma_f32_16x16x32_bf16 v[140:143], v[76:79], v[52:55], v[140:143]
ds_read_b64_tr_b16 v[186:187], v5 offset:47104
v_mfma_f32_16x16x32_bf16 v[200:203], v[88:91], v[52:55], v[200:203]
ds_read_b64_tr_b16 v[188:189], v6 offset:45056
v_mfma_f32_16x16x32_bf16 v[204:207], v[92:95], v[52:55], v[204:207]
ds_read_b64_tr_b16 v[190:191], v6 offset:47104
v_mfma_f32_16x16x32_bf16 v[144:147], v[72:75], v[56:59], v[144:147]
v_mfma_f32_16x16x32_bf16 v[148:151], v[76:79], v[56:59], v[148:151]
v_mfma_f32_16x16x32_bf16 v[208:211], v[88:91], v[56:59], v[208:211]
v_mfma_f32_16x16x32_bf16 v[212:215], v[92:95], v[56:59], v[212:215]
v_mfma_f32_16x16x32_bf16 v[152:155], v[72:75], v[60:63], v[152:155]
v_mfma_f32_16x16x32_bf16 v[156:159], v[76:79], v[60:63], v[156:159]
v_mfma_f32_16x16x32_bf16 v[216:219], v[88:91], v[60:63], v[216:219]
v_mfma_f32_16x16x32_bf16 v[220:223], v[92:95], v[60:63], v[220:223]
s_waitcnt lgkmcnt(0)
s_barrier
v_mfma_f32_16x16x32_bf16 v[128:131], v[160:163], v[96:99], v[128:131]
ds_read_b64_tr_b16 v[64:65], v7 offset:0
v_mfma_f32_16x16x32_bf16 v[132:135], v[164:167], v[96:99], v[132:135]
ds_read_b128 v[32:35], v3 offset:0
v_mfma_f32_16x16x32_bf16 v[192:195], v[176:179], v[96:99], v[192:195]
ds_read_b64_tr_b16 v[66:67], v7 offset:2048
v_mfma_f32_16x16x32_bf16 v[196:199], v[180:183], v[96:99], v[196:199]
ds_read_b128 v[36:39], v3 offset:256
v_mfma_f32_16x16x32_bf16 v[136:139], v[160:163], v[100:103], v[136:139]
ds_read_b64_tr_b16 v[68:69], v8 offset:0
v_mfma_f32_16x16x32_bf16 v[140:143], v[164:167], v[100:103], v[140:143]
ds_read_b128 v[40:43], v3 offset:512
v_mfma_f32_16x16x32_bf16 v[200:203], v[176:179], v[100:103], v[200:203]
ds_read_b64_tr_b16 v[70:71], v8 offset:2048
v_mfma_f32_16x16x32_bf16 v[204:207], v[180:183], v[100:103], v[204:207]
ds_read_b128 v[44:47], v3 offset:768
v_mfma_f32_16x16x32_bf16 v[144:147], v[160:163], v[104:107], v[144:147]
ds_read_b64_tr_b16 v[80:81], v7 offset:8192
v_mfma_f32_16x16x32_bf16 v[148:151], v[164:167], v[104:107], v[148:151]
ds_read_b64_tr_b16 v[82:83], v7 offset:10240
v_mfma_f32_16x16x32_bf16 v[208:211], v[176:179], v[104:107], v[208:211]
ds_read_b64_tr_b16 v[84:85], v8 offset:8192
v_mfma_f32_16x16x32_bf16 v[212:215], v[180:183], v[104:107], v[212:215]
ds_read_b64_tr_b16 v[86:87], v8 offset:10240
v_mfma_f32_16x16x32_bf16 v[152:155], v[160:163], v[108:111], v[152:155]
ds_read_b64_tr_b16 v[72:73], v7 offset:4096
v_mfma_f32_16x16x32_bf16 v[156:159], v[164:167], v[108:111], v[156:159]
ds_read_b128 v[48:51], v3 offset:8192
v_mfma_f32_16x16x32_bf16 v[216:219], v[176:179], v[108:111], v[216:219]
ds_read_b64_tr_b16 v[74:75], v7 offset:6144
v_mfma_f32_16x16x32_bf16 v[220:223], v[180:183], v[108:111], v[220:223]
ds_read_b128 v[52:55], v3 offset:8448
v_mfma_f32_16x16x32_bf16 v[128:131], v[168:171], v[112:115], v[128:131]
ds_read_b64_tr_b16 v[76:77], v8 offset:4096
v_mfma_f32_16x16x32_bf16 v[132:135], v[172:175], v[112:115], v[132:135]
ds_read_b128 v[56:59], v3 offset:8704
v_mfma_f32_16x16x32_bf16 v[192:195], v[184:187], v[112:115], v[192:195]
ds_read_b64_tr_b16 v[78:79], v8 offset:6144
v_mfma_f32_16x16x32_bf16 v[196:199], v[188:191], v[112:115], v[196:199]
ds_read_b128 v[60:63], v3 offset:8960
v_mfma_f32_16x16x32_bf16 v[136:139], v[168:171], v[116:119], v[136:139]
ds_read_b64_tr_b16 v[88:89], v7 offset:12288
v_mfma_f32_16x16x32_bf16 v[140:143], v[172:175], v[116:119], v[140:143]
ds_read_b64_tr_b16 v[90:91], v7 offset:14336
v_mfma_f32_16x16x32_bf16 v[200:203], v[184:187], v[116:119], v[200:203]
ds_read_b64_tr_b16 v[92:93], v8 offset:12288
v_mfma_f32_16x16x32_bf16 v[204:207], v[188:191], v[116:119], v[204:207]
ds_read_b64_tr_b16 v[94:95], v8 offset:14336
v_mfma_f32_16x16x32_bf16 v[144:147], v[168:171], v[120:123], v[144:147]
v_mfma_f32_16x16x32_bf16 v[148:151], v[172:175], v[120:123], v[148:151]
v_mfma_f32_16x16x32_bf16 v[208:211], v[184:187], v[120:123], v[208:211]
v_mfma_f32_16x16x32_bf16 v[212:215], v[188:191], v[120:123], v[212:215]
v_mfma_f32_16x16x32_bf16 v[152:155], v[168:171], v[124:127], v[152:155]
v_mfma_f32_16x16x32_bf16 v[156:159], v[172:175], v[124:127], v[156:159]
v_mfma_f32_16x16x32_bf16 v[216:219], v[184:187], v[124:127], v[216:219]
v_mfma_f32_16x16x32_bf16 v[220:223], v[188:191], v[124:127], v[220:223]
s_sub_u32 s41, s41, 1
s_cmp_lg_u32 s41, 0
s_cbranch_scc1 Lk4_32
s_waitcnt lgkmcnt(0)
s_barrier
v_mfma_f32_16x16x32_bf16 v[128:131], v[64:67], v[32:35], v[128:131]
ds_read_b64_tr_b16 v[160:161], v7 offset:32768
v_mfma_f32_16x16x32_bf16 v[132:135], v[68:71], v[32:35], v[132:135]
ds_read_b128 v[96:99], v3 offset:32768
v_mfma_f32_16x16x32_bf16 v[192:195], v[80:83], v[32:35], v[192:195]
ds_read_b64_tr_b16 v[162:163], v7 offset:34816
v_mfma_f32_16x16x32_bf16 v[196:199], v[84:87], v[32:35], v[196:199]
ds_read_b128 v[100:103], v3 offset:33024
v_mfma_f32_16x16x32_bf16 v[136:139], v[64:67], v[36:39], v[136:139]
ds_read_b64_tr_b16 v[164:165], v8 offset:32768
v_mfma_f32_16x16x32_bf16 v[140:143], v[68:71], v[36:39], v[140:143]
ds_read_b128 v[104:107], v3 offset:33280
v_mfma_f32_16x16x32_bf16 v[200:203], v[80:83], v[36:39], v[200:203]
ds_read_b64_tr_b16 v[166:167], v8 offset:34816
v_mfma_f32_16x16x32_bf16 v[204:207], v[84:87], v[36:39], v[204:207]
ds_read_b128 v[108:111], v3 offset:33536
v_mfma_f32_16x16x32_bf16 v[144:147], v[64:67], v[40:43], v[144:147]
ds_read_b64_tr_b16 v[176:177], v7 offset:40960
v_mfma_f32_16x16x32_bf16 v[148:151], v[68:71], v[40:43], v[148:151]
ds_read_b64_tr_b16 v[178:179], v7 offset:43008
v_mfma_f32_16x16x32_bf16 v[208:211], v[80:83], v[40:43], v[208:211]
ds_read_b64_tr_b16 v[180:181], v8 offset:40960
v_mfma_f32_16x16x32_bf16 v[212:215], v[84:87], v[40:43], v[212:215]
ds_read_b64_tr_b16 v[182:183], v8 offset:43008
v_mfma_f32_16x16x32_bf16 v[152:155], v[64:67], v[44:47], v[152:155]
ds_read_b64_tr_b16 v[168:169], v7 offset:36864
v_mfma_f32_16x16x32_bf16 v[156:159], v[68:71], v[44:47], v[156:159]
ds_read_b128 v[112:115], v3 offset:40960
v_mfma_f32_16x16x32_bf16 v[216:219], v[80:83], v[44:47], v[216:219]
ds_read_b64_tr_b16 v[170:171], v7 offset:38912
v_mfma_f32_16x16x32_bf16 v[220:223], v[84:87], v[44:47], v[220:223]
ds_read_b128 v[116:119], v3 offset:41216
v_mfma_f32_16x16x32_bf16 v[128:131], v[72:75], v[48:51], v[128:131]
ds_read_b64_tr_b16 v[172:173], v8 offset:36864
v_mfma_f32_16x16x32_bf16 v[132:135], v[76:79], v[48:51], v[132:135]
ds_read_b128 v[120:123], v3 offset:41472
v_mfma_f32_16x16x32_bf16 v[192:195], v[88:91], v[48:51], v[192:195]
ds_read_b64_tr_b16 v[174:175], v8 offset:38912
v_mfma_f32_16x16x32_bf16 v[196:199], v[92:95], v[48:51], v[196:199]
ds_read_b128 v[124:127], v3 offset:41728
v_mfma_f32_16x16x32_bf16 v[136:139], v[72:75], v[52:55], v[136:139]
ds_read_b64_tr_b16 v[184:185], v7 offset:45056
v_mfma_f32_16x16x32_bf16 v[140:143], v[76:79], v[52:55], v[140:143]
ds_read_b64_tr_b16 v[186:187], v7 offset:47104
v_mfma_f32_16x16x32_bf16 v[200:203], v[88:91], v[52:55], v[200:203]
ds_read_b64_tr_b16 v[188:189], v8 offset:45056
v_mfma_f32_16x16x32_bf16 v[204:207], v[92:95], v[52:55], v[204:207]
ds_read_b64_tr_b16 v[190:191], v8 offset:47104
v_mfma_f32_16x16x32_bf16 v[144:147], v[72:75], v[56:59], v[144:147]
v_mfma_f32_16x16x32_bf16 v[148:151], v[76:79], v[56:59], v[148:151]
v_mfma_f32_16x16x32_bf16 v[208:211], v[88:91], v[56:59], v[208:211]
v_mfma_f32_16x16x32_bf16 v[212:215], v[92:95], v[56:59], v[212:215]
v_mfma_f32_16x16x32_bf16 v[152:155], v[72:75], v[60:63], v[152:155]
v_mfma_f32_16x16x32_bf16 v[156:159], v[76:79], v[60:63], v[156:159]
v_mfma_f32_16x16x32_bf16 v[216:219], v[88:91], v[60:63], v[216:219]
v_mfma_f32_16x16x32_bf16 v[220:223], v[92:95], v[60:63], v[220:223]
s_waitcnt lgkmcnt(0)
s_barrier
v_mfma_f32_16x16x32_bf16 v[128:131], v[160:163], v[96:99], v[128:131]
ds_read_b64_tr_b16 v[64:65], v5 offset:0
v_mfma_f32_16x16x32_bf16 v[132:135], v[164:167], v[96:99], v[132:135]
ds_read_b128 v[32:35], v2 offset:0
v_mfma_f32_16x16x32_bf16 v[192:195], v[176:179], v[96:99], v[192:195]
ds_read_b64_tr_b16 v[66:67], v5 offset:2048
v_mfma_f32_16x16x32_bf16 v[196:199], v[180:183], v[96:99], v[196:199]
ds_read_b128 v[36:39], v2 offset:256
v_mfma_f32_16x16x32_bf16 v[136:139], v[160:163], v[100:103], v[136:139]
ds_read_b64_tr_b16 v[68:69], v6 offset:0
v_mfma_f32_16x16x32_bf16 v[140:143], v[164:167], v[100:103], v[140:143]
ds_read_b128 v[40:43], v2 offset:512
v_mfma_f32_16x16x32_bf16 v[200:203], v[176:179], v[100:103], v[200:203]
ds_read_b64_tr_b16 v[70:71], v6 offset:2048
v_mfma_f32_16x16x32_bf16 v[204:207], v[180:183], v[100:103], v[204:207]
ds_read_b128 v[44:47], v2 offset:768
v_mfma_f32_16x16x32_bf16 v[144:147], v[160:163], v[104:107], v[144:147]
ds_read_b64_tr_b16 v[80:81], v5 offset:8192
v_mfma_f32_16x16x32_bf16 v[148:151], v[164:167], v[104:107], v[148:151]
ds_read_b64_tr_b16 v[82:83], v5 offset:10240
v_mfma_f32_16x16x32_bf16 v[208:211], v[176:179], v[104:107], v[208:211]
ds_read_b64_tr_b16 v[84:85], v6 offset:8192
v_mfma_f32_16x16x32_bf16 v[212:215], v[180:183], v[104:107], v[212:215]
ds_read_b64_tr_b16 v[86:87], v6 offset:10240
v_mfma_f32_16x16x32_bf16 v[152:155], v[160:163], v[108:111], v[152:155]
ds_read_b64_tr_b16 v[72:73], v5 offset:4096
v_mfma_f32_16x16x32_bf16 v[156:159], v[164:167], v[108:111], v[156:159]
ds_read_b128 v[48:51], v2 offset:8192
v_mfma_f32_16x16x32_bf16 v[216:219], v[176:179], v[108:111], v[216:219]
ds_read_b64_tr_b16 v[74:75], v5 offset:6144
v_mfma_f32_16x16x32_bf16 v[220:223], v[180:183], v[108:111], v[220:223]
ds_read_b128 v[52:55], v2 offset:8448
v_mfma_f32_16x16x32_bf16 v[128:131], v[168:171], v[112:115], v[128:131]
ds_read_b64_tr_b16 v[76:77], v6 offset:4096
v_mfma_f32_16x16x32_bf16 v[132:135], v[172:175], v[112:115], v[132:135]
ds_read_b128 v[56:59], v2 offset:8704
v_mfma_f32_16x16x32_bf16 v[192:195], v[184:187], v[112:115], v[192:195]
ds_read_b64_tr_b16 v[78:79], v6 offset:6144
v_mfma_f32_16x16x32_bf16 v[196:199], v[188:191], v[112:115], v[196:199]
ds_read_b128 v[60:63], v2 offset:8960
v_mfma_f32_16x16x32_bf16 v[136:139], v[168:171], v[116:119], v[136:139]
ds_read_b64_tr_b16 v[88:89], v5 offset:12288
v_mfma_f32_16x16x32_bf16 v[140:143], v[172:175], v[116:119], v[140:143]
ds_read_b64_tr_b16 v[90:91], v5 offset:14336
v_mfma_f32_16x16x32_bf16 v[200:203], v[184:187], v[116:119], v[200:203]
ds_read_b64_tr_b16 v[92:93], v6 offset:12288
v_mfma_f32_16x16x32_bf16 v[204:207], v[188:191], v[116:119], v[204:207]
ds_read_b64_tr_b16 v[94:95], v6 offset:14336
v_mfma_f32_16x16x32_bf16 v[144:147], v[168:171], v[120:123], v[144:147]
v_mfma_f32_16x16x32_bf16 v[148:151], v[172:175], v[120:123], v[148:151]
v_mfma_f32_16x16x32_bf16 v[208:211], v[184:187], v[120:123], v[208:211]
v_mfma_f32_16x16x32_bf16 v[212:215], v[188:191], v[120:123], v[212:215]
v_mfma_f32_16x16x32_bf16 v[152:155], v[168:171], v[124:127], v[152:155]
v_mfma_f32_16x16x32_bf16 v[156:159], v[172:175], v[124:127], v[156:159]
v_mfma_f32_16x16x32_bf16 v[216:219], v[184:187], v[124:127], v[216:219]
v_mfma_f32_16x16x32_bf16 v[220:223], v[188:191], v[124:127], v[220:223]
s_waitcnt lgkmcnt(0)
s_barrier
v_mfma_f32_16x16x32_bf16 v[128:131], v[64:67], v[32:35], v[128:131]
ds_read_b64_tr_b16 v[160:161], v5 offset:32768
v_mfma_f32_16x16x32_bf16 v[132:135], v[68:71], v[32:35], v[132:135]
ds_read_b128 v[96:99], v2 offset:32768
v_mfma_f32_16x16x32_bf16 v[192:195], v[80:83], v[32:35], v[192:195]
ds_read_b64_tr_b16 v[162:163], v5 offset:34816
v_mfma_f32_16x16x32_bf16 v[196:199], v[84:87], v[32:35], v[196:199]
ds_read_b128 v[100:103], v2 offset:33024
v_mfma_f32_16x16x32_bf16 v[136:139], v[64:67], v[36:39], v[136:139]
ds_read_b64_tr_b16 v[164:165], v6 offset:32768
v_mfma_f32_16x16x32_bf16 v[140:143], v[68:71], v[36:39], v[140:143]
ds_read_b128 v[104:107], v2 offset:33280
v_mfma_f32_16x16x32_bf16 v[200:203], v[80:83], v[36:39], v[200:203]
ds_read_b64_tr_b16 v[166:167], v6 offset:34816
v_mfma_f32_16x16x32_bf16 v[204:207], v[84:87], v[36:39], v[204:207]
ds_read_b128 v[108:111], v2 offset:33536
v_mfma_f32_16x16x32_bf16 v[144:147], v[64:67], v[40:43], v[144:147]
ds_read_b64_tr_b16 v[176:177], v5 offset:40960
v_mfma_f32_16x16x32_bf16 v[148:151], v[68:71], v[40:43], v[148:151]
ds_read_b64_tr_b16 v[178:179], v5 offset:43008
v_mfma_f32_16x16x32_bf16 v[208:211], v[80:83], v[40:43], v[208:211]
ds_read_b64_tr_b16 v[180:181], v6 offset:40960
v_mfma_f32_16x16x32_bf16 v[212:215], v[84:87], v[40:43], v[212:215]
ds_read_b64_tr_b16 v[182:183], v6 offset:43008
v_mfma_f32_16x16x32_bf16 v[152:155], v[64:67], v[44:47], v[152:155]
ds_read_b64_tr_b16 v[168:169], v5 offset:36864
v_mfma_f32_16x16x32_bf16 v[156:159], v[68:71], v[44:47], v[156:159]
ds_read_b128 v[112:115], v2 offset:40960
v_mfma_f32_16x16x32_bf16 v[216:219], v[80:83], v[44:47], v[216:219]
ds_read_b64_tr_b16 v[170:171], v5 offset:38912
v_mfma_f32_16x16x32_bf16 v[220:223], v[84:87], v[44:47], v[220:223]
ds_read_b128 v[116:119], v2 offset:41216
v_mfma_f32_16x16x32_bf16 v[128:131], v[72:75], v[48:51], v[128:131]
ds_read_b64_tr_b16 v[172:173], v6 offset:36864
v_mfma_f32_16x16x32_bf16 v[132:135], v[76:79], v[48:51], v[132:135]
ds_read_b128 v[120:123], v2 offset:41472
v_mfma_f32_16x16x32_bf16 v[192:195], v[88:91], v[48:51], v[192:195]
ds_read_b64_tr_b16 v[174:175], v6 offset:38912
v_mfma_f32_16x16x32_bf16 v[196:199], v[92:95], v[48:51], v[196:199]
ds_read_b128 v[124:127], v2 offset:41728
v_mfma_f32_16x16x32_bf16 v[136:139], v[72:75], v[52:55], v[136:139]
ds_read_b64_tr_b16 v[184:185], v5 offset:45056
v_mfma_f32_16x16x32_bf16 v[140:143], v[76:79], v[52:55], v[140:143]
ds_read_b64_tr_b16 v[186:187], v5 offset:47104
v_mfma_f32_16x16x32_bf16 v[200:203], v[88:91], v[52:55], v[200:203]
ds_read_b64_tr_b16 v[188:189], v6 offset:45056
v_mfma_f32_16x16x32_bf16 v[204:207], v[92:95], v[52:55], v[204:207]
ds_read_b64_tr_b16 v[190:191], v6 offset:47104
v_mfma_f32_16x16x32_bf16 v[144:147], v[72:75], v[56:59], v[144:147]
v_mfma_f32_16x16x32_bf16 v[148:151], v[76:79], v[56:59], v[148:151]
v_mfma_f32_16x16x32_bf16 v[208:211], v[88:91], v[56:59], v[208:211]
v_mfma_f32_16x16x32_bf16 v[212:215], v[92:95], v[56:59], v[212:215]
v_mfma_f32_16x16x32_bf16 v[152:155], v[72:75], v[60:63], v[152:155]
v_mfma_f32_16x16x32_bf16 v[156:159], v[76:79], v[60:63], v[156:159]
v_mfma_f32_16x16x32_bf16 v[216:219], v[88:91], v[60:63], v[216:219]
v_mfma_f32_16x16x32_bf16 v[220:223], v[92:95], v[60:63], v[220:223]
s_waitcnt lgkmcnt(0)
s_barrier
v_mfma_f32_16x16x32_bf16 v[128:131], v[160:163], v[96:99], v[128:131]
ds_read_b64_tr_b16 v[64:65], v7 offset:0
v_mfma_f32_16x16x32_bf16 v[132:135], v[164:167], v[96:99], v[132:135]
ds_read_b128 v[32:35], v3 offset:0
v_mfma_f32_16x16x32_bf16 v[192:195], v[176:179], v[96:99], v[192:195]
ds_read_b64_tr_b16 v[66:67], v7 offset:2048
v_mfma_f32_16x16x32_bf16 v[196:199], v[180:183], v[96:99], v[196:199]
ds_read_b128 v[36:39], v3 offset:256
v_mfma_f32_16x16x32_bf16 v[136:139], v[160:163], v[100:103], v[136:139]
ds_read_b64_tr_b16 v[68:69], v8 offset:0
v_mfma_f32_16x16x32_bf16 v[140:143], v[164:167], v[100:103], v[140:143]
ds_read_b128 v[40:43], v3 offset:512
v_mfma_f32_16x16x32_bf16 v[200:203], v[176:179], v[100:103], v[200:203]
ds_read_b64_tr_b16 v[70:71], v8 offset:2048
v_mfma_f32_16x16x32_bf16 v[204:207], v[180:183], v[100:103], v[204:207]
ds_read_b128 v[44:47], v3 offset:768
v_mfma_f32_16x16x32_bf16 v[144:147], v[160:163], v[104:107], v[144:147]
ds_read_b64_tr_b16 v[72:73], v7 offset:4096
v_mfma_f32_16x16x32_bf16 v[148:151], v[164:167], v[104:107], v[148:151]
ds_read_b128 v[48:51], v3 offset:8192
v_mfma_f32_16x16x32_bf16 v[208:211], v[176:179], v[104:107], v[208:211]
ds_read_b64_tr_b16 v[74:75], v7 offset:6144
v_mfma_f32_16x16x32_bf16 v[212:215], v[180:183], v[104:107], v[212:215]
ds_read_b128 v[52:55], v3 offset:8448
v_mfma_f32_16x16x32_bf16 v[152:155], v[160:163], v[108:111], v[152:155]
ds_read_b64_tr_b16 v[76:77], v8 offset:4096
v_mfma_f32_16x16x32_bf16 v[156:159], v[164:167], v[108:111], v[156:159]
ds_read_b128 v[56:59], v3 offset:8704
v_mfma_f32_16x16x32_bf16 v[216:219], v[176:179], v[108:111], v[216:219]
ds_read_b64_tr_b16 v[78:79], v8 offset:6144
v_mfma_f32_16x16x32_bf16 v[220:223], v[180:183], v[108:111], v[220:223]
ds_read_b128 v[60:63], v3 offset:8960
v_mfma_f32_16x16x32_bf16 v[128:131], v[168:171], v[112:115], v[128:131]
v_mfma_f32_16x16x32_bf16 v[132:135], v[172:175], v[112:115], v[132:135]
v_mfma_f32_16x16x32_bf16 v[192:195], v[184:187], v[112:115], v[192:195]
v_mfma_f32_16x16x32_bf16 v[196:199], v[188:191], v[112:115], v[196:199]
v_mfma_f32_16x16x32_bf16 v[136:139], v[168:171], v[116:119], v[136:139]
v_mfma_f32_16x16x32_bf16 v[140:143], v[172:175], v[116:119], v[140:143]
v_mfma_f32_16x16x32_bf16 v[200:203], v[184:187], v[116:119], v[200:203]
v_mfma_f32_16x16x32_bf16 v[204:207], v[188:191], v[116:119], v[204:207]
v_mfma_f32_16x16x32_bf16 v[144:147], v[168:171], v[120:123], v[144:147]
v_mfma_f32_16x16x32_bf16 v[148:151], v[172:175], v[120:123], v[148:151]
v_mfma_f32_16x16x32_bf16 v[208:211], v[184:187], v[120:123], v[208:211]
v_mfma_f32_16x16x32_bf16 v[212:215], v[188:191], v[120:123], v[212:215]
v_mfma_f32_16x16x32_bf16 v[152:155], v[168:171], v[124:127], v[152:155]
v_mfma_f32_16x16x32_bf16 v[156:159], v[172:175], v[124:127], v[156:159]
v_mfma_f32_16x16x32_bf16 v[216:219], v[184:187], v[124:127], v[216:219]
v_mfma_f32_16x16x32_bf16 v[220:223], v[188:191], v[124:127], v[220:223]
s_mov_b32 s54, 0x10000
s_waitcnt lgkmcnt(0)
s_barrier
v_mfma_f32_16x16x32_bf16 v[128:131], v[64:67], v[32:35], v[128:131]
ds_read_b64_tr_b16 v[160:161], v7 offset:32768
v_mfma_f32_16x16x32_bf16 v[132:135], v[68:71], v[32:35], v[132:135]
ds_read_b128 v[96:99], v3 offset:32768
v_mfma_f32_16x16x32_bf16 v[136:139], v[64:67], v[36:39], v[136:139]
ds_read_b64_tr_b16 v[162:163], v7 offset:34816
v_mfma_f32_16x16x32_bf16 v[140:143], v[68:71], v[36:39], v[140:143]
ds_read_b128 v[100:103], v3 offset:33024
v_cvt_pk_bf16_f32 v224, v192, v193
v_mfma_f32_16x16x32_bf16 v[144:147], v[64:67], v[40:43], v[144:147]
ds_read_b64_tr_b16 v[164:165], v8 offset:32768
v_cvt_pk_bf16_f32 v225, v194, v195
v_mfma_f32_16x16x32_bf16 v[148:151], v[68:71], v[40:43], v[148:151]
v_cvt_pk_bf16_f32 v226, v196, v197
ds_read_b128 v[104:107], v3 offset:33280
v_cvt_pk_bf16_f32 v227, v198, v199
v_mfma_f32_16x16x32_bf16 v[152:155], v[64:67], v[44:47], v[152:155]
buffer_store_dwordx4 v[224:227], v9, s[64:67], 0 offen offset:0 sc1
ds_read_b64_tr_b16 v[166:167], v8 offset:34816
v_cvt_pk_bf16_f32 v228, v200, v201
v_mfma_f32_16x16x32_bf16 v[156:159], v[68:71], v[44:47], v[156:159]
ds_read_b128 v[108:111], v3 offset:33536
v_cvt_pk_bf16_f32 v229, v202, v203
v_mfma_f32_16x16x32_bf16 v[128:131], v[72:75], v[48:51], v[128:131]
v_cvt_pk_bf16_f32 v230, v204, v205
ds_read_b64_tr_b16 v[168:169], v7 offset:36864
v_cvt_pk_bf16_f32 v231, v206, v207
v_mfma_f32_16x16x32_bf16 v[132:135], v[76:79], v[48:51], v[132:135]
buffer_store_dwordx4 v[228:231], v9, s[64:67], 0 offen offset:1024 sc1
ds_read_b128 v[112:115], v3 offset:40960
v_cvt_pk_bf16_f32 v232, v208, v209
v_mfma_f32_16x16x32_bf16 v[136:139], v[72:75], v[52:55], v[136:139]
ds_read_b64_tr_b16 v[170:171], v7 offset:38912
v_cvt_pk_bf16_f32 v233, v210, v211
v_mfma_f32_16x16x32_bf16 v[140:143], v[76:79], v[52:55], v[140:143]
v_cvt_pk_bf16_f32 v234, v212, v213
ds_read_b128 v[116:119], v3 offset:41216
v_cvt_pk_bf16_f32 v235, v214, v215
v_mfma_f32_16x16x32_bf16 v[144:147], v[72:75], v[56:59], v[144:147]
buffer_store_dwordx4 v[232:235], v9, s[64:67], 0 offen offset:2048 sc1
ds_read_b64_tr_b16 v[172:173], v8 offset:36864
v_cvt_pk_bf16_f32 v236, v216, v217
v_mfma_f32_16x16x32_bf16 v[148:151], v[76:79], v[56:59], v[148:151]
ds_read_b128 v[120:123], v3 offset:41472
v_cvt_pk_bf16_f32 v237, v218, v219
v_mfma_f32_16x16x32_bf16 v[152:155], v[72:75], v[60:63], v[152:155]
v_cvt_pk_bf16_f32 v238, v220, v221
ds_read_b64_tr_b16 v[174:175], v8 offset:38912
v_cvt_pk_bf16_f32 v239, v222, v223
v_mfma_f32_16x16x32_bf16 v[156:159], v[76:79], v[60:63], v[156:159]
buffer_store_dwordx4 v[236:239], v9, s[64:67], 0 offen offset:3072 sc1
ds_read_b128 v[124:127], v3 offset:41728
s_waitcnt lgkmcnt(0)
s_barrier
v_mfma_f32_16x16x32_bf16 v[128:131], v[160:163], v[96:99], v[128:131]
ds_read_b64_tr_b16 v[64:65], v5 offset:0
v_mfma_f32_16x16x32_bf16 v[132:135], v[164:167], v[96:99], v[132:135]
ds_read_b128 v[32:35], v2 offset:0
v_mfma_f32_16x16x32_bf16 v[136:139], v[160:163], v[100:103], v[136:139]
ds_read_b64_tr_b16 v[66:67], v5 offset:2048
v_mfma_f32_16x16x32_bf16 v[140:143], v[164:167], v[100:103], v[140:143]
ds_read_b128 v[36:39], v2 offset:256
v_mfma_f32_16x16x32_bf16 v[144:147], v[160:163], v[104:107], v[144:147]
ds_read_b64_tr_b16 v[68:69], v6 offset:0
v_mfma_f32_16x16x32_bf16 v[148:151], v[164:167], v[104:107], v[148:151]
ds_read_b128 v[40:43], v2 offset:512
v_mfma_f32_16x16x32_bf16 v[152:155], v[160:163], v[108:111], v[152:155]
ds_read_b64_tr_b16 v[70:71], v6 offset:2048
v_mfma_f32_16x16x32_bf16 v[156:159], v[164:167], v[108:111], v[156:159]
ds_read_b128 v[44:47], v2 offset:768
v_mfma_f32_16x16x32_bf16 v[128:131], v[168:171], v[112:115], v[128:131]
ds_read_b64_tr_b16 v[72:73], v5 offset:4096
v_mfma_f32_16x16x32_bf16 v[132:135], v[172:175], v[112:115], v[132:135]
ds_read_b128 v[48:51], v2 offset:8192
v_mfma_f32_16x16x32_bf16 v[136:139], v[168:171], v[116:119], v[136:139]
ds_read_b64_tr_b16 v[74:75], v5 offset:6144
v_mfma_f32_16x16x32_bf16 v[140:143], v[172:175], v[116:119], v[140:143]
ds_read_b128 v[52:55], v2 offset:8448
v_mfma_f32_16x16x32_bf16 v[144:147], v[168:171], v[120:123], v[144:147]
ds_read_b64_tr_b16 v[76:77], v6 offset:4096
v_mfma_f32_16x16x32_bf16 v[148:151], v[172:175], v[120:123], v[148:151]
ds_read_b128 v[56:59], v2 offset:8704
v_mfma_f32_16x16x32_bf16 v[152:155], v[168:171], v[124:127], v[152:155]
ds_read_b64_tr_b16 v[78:79], v6 offset:6144
v_mfma_f32_16x16x32_bf16 v[156:159], v[172:175], v[124:127], v[156:159]
ds_read_b128 v[60:63], v2 offset:8960
s_waitcnt lgkmcnt(0)
s_barrier
v_mfma_f32_16x16x32_bf16 v[128:131], v[64:67], v[32:35], v[128:131]
ds_read_b64_tr_b16 v[160:161], v5 offset:32768
v_mfma_f32_16x16x32_bf16 v[132:135], v[68:71], v[32:35], v[132:135]
ds_read_b128 v[96:99], v2 offset:32768
v_mfma_f32_16x16x32_bf16 v[136:139], v[64:67], v[36:39], v[136:139]
ds_read_b64_tr_b16 v[162:163], v5 offset:34816
v_mfma_f32_16x16x32_bf16 v[140:143], v[68:71], v[36:39], v[140:143]
ds_read_b128 v[100:103], v2 offset:33024
v_mfma_f32_16x16x32_bf16 v[144:147], v[64:67], v[40:43], v[144:147]
ds_read_b64_tr_b16 v[164:165], v6 offset:32768
v_mfma_f32_16x16x32_bf16 v[148:151], v[68:71], v[40:43], v[148:151]
ds_read_b128 v[104:107], v2 offset:33280
v_mfma_f32_16x16x32_bf16 v[152:155], v[64:67], v[44:47], v[152:155]
ds_read_b64_tr_b16 v[166:167], v6 offset:34816
v_mfma_f32_16x16x32_bf16 v[156:159], v[68:71], v[44:47], v[156:159]
ds_read_b128 v[108:111], v2 offset:33536
v_mfma_f32_16x16x32_bf16 v[128:131], v[72:75], v[48:51], v[128:131]
ds_read_b64_tr_b16 v[168:169], v5 offset:36864
v_mfma_f32_16x16x32_bf16 v[132:135], v[76:79], v[48:51], v[132:135]
ds_read_b128 v[112:115], v2 offset:40960
v_mfma_f32_16x16x32_bf16 v[136:139], v[72:75], v[52:55], v[136:139]
ds_read_b64_tr_b16 v[170:171], v5 offset:38912
v_mfma_f32_16x16x32_bf16 v[140:143], v[76:79], v[52:55], v[140:143]
ds_read_b128 v[116:119], v2 offset:41216
v_mfma_f32_16x16x32_bf16 v[144:147], v[72:75], v[56:59], v[144:147]
ds_read_b64_tr_b16 v[172:173], v6 offset:36864
v_mfma_f32_16x16x32_bf16 v[148:151], v[76:79], v[56:59], v[148:151]
ds_read_b128 v[120:123], v2 offset:41472
v_mfma_f32_16x16x32_bf16 v[152:155], v[72:75], v[60:63], v[152:155]
ds_read_b64_tr_b16 v[174:175], v6 offset:38912
v_mfma_f32_16x16x32_bf16 v[156:159], v[76:79], v[60:63], v[156:159]
ds_read_b128 v[124:127], v2 offset:41728
s_waitcnt vmcnt(0) lgkmcnt(0)
s_barrier
v_mfma_f32_16x16x32_bf16 v[128:131], v[160:163], v[96:99], v[128:131]
ds_read_b64_tr_b16 v[64:65], v7 offset:0
v_mfma_f32_16x16x32_bf16 v[132:135], v[164:167], v[96:99], v[132:135]
ds_read_b128 v[32:35], v3 offset:0
v_mfma_f32_16x16x32_bf16 v[136:139], v[160:163], v[100:103], v[136:139]
ds_read_b64_tr_b16 v[66:67], v7 offset:2048
v_mfma_f32_16x16x32_bf16 v[140:143], v[164:167], v[100:103], v[140:143]
ds_read_b128 v[36:39], v3 offset:256
v_mfma_f32_16x16x32_bf16 v[144:147], v[160:163], v[104:107], v[144:147]
ds_read_b64_tr_b16 v[68:69], v8 offset:0
v_mfma_f32_16x16x32_bf16 v[148:151], v[164:167], v[104:107], v[148:151]
ds_read_b128 v[40:43], v3 offset:512
v_mfma_f32_16x16x32_bf16 v[152:155], v[160:163], v[108:111], v[152:155]
ds_read_b64_tr_b16 v[70:71], v8 offset:2048
v_mfma_f32_16x16x32_bf16 v[156:159], v[164:167], v[108:111], v[156:159]
ds_read_b128 v[44:47], v3 offset:768
v_mfma_f32_16x16x32_bf16 v[128:131], v[168:171], v[112:115], v[128:131]
ds_read_b64_tr_b16 v[72:73], v7 offset:4096
v_mfma_f32_16x16x32_bf16 v[132:135], v[172:175], v[112:115], v[132:135]
ds_read_b128 v[48:51], v3 offset:8192
v_mfma_f32_16x16x32_bf16 v[136:139], v[168:171], v[116:119], v[136:139]
ds_read_b64_tr_b16 v[74:75], v7 offset:6144
v_mfma_f32_16x16x32_bf16 v[140:143], v[172:175], v[116:119], v[140:143]
ds_read_b128 v[52:55], v3 offset:8448
v_mfma_f32_16x16x32_bf16 v[144:147], v[168:171], v[120:123], v[144:147]
ds_read_b64_tr_b16 v[76:77], v8 offset:4096
v_mfma_f32_16x16x32_bf16 v[148:151], v[172:175], v[120:123], v[148:151]
ds_read_b128 v[56:59], v3 offset:8704
v_mfma_f32_16x16x32_bf16 v[152:155], v[168:171], v[124:127], v[152:155]
ds_read_b64_tr_b16 v[78:79], v8 offset:6144
v_mfma_f32_16x16x32_bf16 v[156:159], v[172:175], v[124:127], v[156:159]
ds_read_b128 v[60:63], v3 offset:8960
s_waitcnt lgkmcnt(0)
s_barrier
v_mfma_f32_16x16x32_bf16 v[128:131], v[64:67], v[32:35], v[128:131]
ds_read_b64_tr_b16 v[160:161], v7 offset:32768
v_mfma_f32_16x16x32_bf16 v[132:135], v[68:71], v[32:35], v[132:135]
ds_read_b128 v[96:99], v3 offset:32768
v_mfma_f32_16x16x32_bf16 v[136:139], v[64:67], v[36:39], v[136:139]
ds_read_b64_tr_b16 v[162:163], v7 offset:34816
v_mfma_f32_16x16x32_bf16 v[140:143], v[68:71], v[36:39], v[140:143]
ds_read_b128 v[100:103], v3 offset:33024
v_mfma_f32_16x16x32_bf16 v[144:147], v[64:67], v[40:43], v[144:147]
ds_read_b64_tr_b16 v[164:165], v8 offset:32768
v_mfma_f32_16x16x32_bf16 v[148:151], v[68:71], v[40:43], v[148:151]
ds_read_b128 v[104:107], v3 offset:33280
v_mfma_f32_16x16x32_bf16 v[152:155], v[64:67], v[44:47], v[152:155]
ds_read_b64_tr_b16 v[166:167], v8 offset:34816
v_mfma_f32_16x16x32_bf16 v[156:159], v[68:71], v[44:47], v[156:159]
ds_read_b128 v[108:111], v3 offset:33536
v_mfma_f32_16x16x32_bf16 v[128:131], v[72:75], v[48:51], v[128:131]
ds_read_b64_tr_b16 v[168:169], v7 offset:36864
v_mfma_f32_16x16x32_bf16 v[132:135], v[76:79], v[48:51], v[132:135]
ds_read_b128 v[112:115], v3 offset:40960
v_mfma_f32_16x16x32_bf16 v[136:139], v[72:75], v[52:55], v[136:139]
ds_read_b64_tr_b16 v[170:171], v7 offset:38912
v_mfma_f32_16x16x32_bf16 v[140:143], v[76:79], v[52:55], v[140:143]
ds_read_b128 v[116:119], v3 offset:41216
v_mfma_f32_16x16x32_bf16 v[144:147], v[72:75], v[56:59], v[144:147]
ds_read_b64_tr_b16 v[172:173], v8 offset:36864
v_mfma_f32_16x16x32_bf16 v[148:151], v[76:79], v[56:59], v[148:151]
ds_read_b128 v[120:123], v3 offset:41472
v_mfma_f32_16x16x32_bf16 v[152:155], v[72:75], v[60:63], v[152:155]
ds_read_b64_tr_b16 v[174:175], v8 offset:38912
v_mfma_f32_16x16x32_bf16 v[156:159], v[76:79], v[60:63], v[156:159]
ds_read_b128 v[124:127], v3 offset:41728
s_waitcnt lgkmcnt(0)
s_barrier
v_mfma_f32_16x16x32_bf16 v[128:131], v[160:163], v[96:99], v[128:131]
ds_read_b64_tr_b16 v[64:65], v5 offset:0
v_mfma_f32_16x16x32_bf16 v[132:135], v[164:167], v[96:99], v[132:135]
ds_read_b128 v[32:35], v2 offset:0
v_mfma_f32_16x16x32_bf16 v[136:139], v[160:163], v[100:103], v[136:139]
ds_read_b64_tr_b16 v[66:67], v5 offset:2048
v_mfma_f32_16x16x32_bf16 v[140:143], v[164:167], v[100:103], v[140:143]
ds_read_b128 v[36:39], v2 offset:256
v_mfma_f32_16x16x32_bf16 v[144:147], v[160:163], v[104:107], v[144:147]
ds_read_b64_tr_b16 v[68:69], v6 offset:0
v_mfma_f32_16x16x32_bf16 v[148:151], v[164:167], v[104:107], v[148:151]
ds_read_b128 v[40:43], v2 offset:512
v_mfma_f32_16x16x32_bf16 v[152:155], v[160:163], v[108:111], v[152:155]
ds_read_b64_tr_b16 v[70:71], v6 offset:2048
v_mfma_f32_16x16x32_bf16 v[156:159], v[164:167], v[108:111], v[156:159]
ds_read_b128 v[44:47], v2 offset:768
v_mfma_f32_16x16x32_bf16 v[128:131], v[168:171], v[112:115], v[128:131]
ds_read_b64_tr_b16 v[72:73], v5 offset:4096
v_mfma_f32_16x16x32_bf16 v[132:135], v[172:175], v[112:115], v[132:135]
ds_read_b128 v[48:51], v2 offset:8192
v_mfma_f32_16x16x32_bf16 v[136:139], v[168:171], v[116:119], v[136:139]
ds_read_b64_tr_b16 v[74:75], v5 offset:6144
v_mfma_f32_16x16x32_bf16 v[140:143], v[172:175], v[116:119], v[140:143]
ds_read_b128 v[52:55], v2 offset:8448
v_mfma_f32_16x16x32_bf16 v[144:147], v[168:171], v[120:123], v[144:147]
ds_read_b64_tr_b16 v[76:77], v6 offset:4096
v_mfma_f32_16x16x32_bf16 v[148:151], v[172:175], v[120:123], v[148:151]
ds_read_b128 v[56:59], v2 offset:8704
v_mfma_f32_16x16x32_bf16 v[152:155], v[168:171], v[124:127], v[152:155]
ds_read_b64_tr_b16 v[78:79], v6 offset:6144
v_mfma_f32_16x16x32_bf16 v[156:159], v[172:175], v[124:127], v[156:159]
ds_read_b128 v[60:63], v2 offset:8960
s_waitcnt lgkmcnt(0)
s_barrier
v_mfma_f32_16x16x32_bf16 v[128:131], v[64:67], v[32:35], v[128:131]
ds_read_b64_tr_b16 v[160:161], v5 offset:32768
v_mfma_f32_16x16x32_bf16 v[132:135], v[68:71], v[32:35], v[132:135]
ds_read_b128 v[96:99], v2 offset:32768
v_mfma_f32_16x16x32_bf16 v[136:139], v[64:67], v[36:39], v[136:139]
ds_read_b64_tr_b16 v[162:163], v5 offset:34816
v_mfma_f32_16x16x32_bf16 v[140:143], v[68:71], v[36:39], v[140:143]
ds_read_b128 v[100:103], v2 offset:33024
v_mfma_f32_16x16x32_bf16 v[144:147], v[64:67], v[40:43], v[144:147]
ds_read_b64_tr_b16 v[164:165], v6 offset:32768
v_mfma_f32_16x16x32_bf16 v[148:151], v[68:71], v[40:43], v[148:151]
ds_read_b128 v[104:107], v2 offset:33280
v_mfma_f32_16x16x32_bf16 v[152:155], v[64:67], v[44:47], v[152:155]
ds_read_b64_tr_b16 v[166:167], v6 offset:34816
v_mfma_f32_16x16x32_bf16 v[156:159], v[68:71], v[44:47], v[156:159]
ds_read_b128 v[108:111], v2 offset:33536
v_mfma_f32_16x16x32_bf16 v[128:131], v[72:75], v[48:51], v[128:131]
ds_read_b64_tr_b16 v[168:169], v5 offset:36864
v_mfma_f32_16x16x32_bf16 v[132:135], v[76:79], v[48:51], v[132:135]
ds_read_b128 v[112:115], v2 offset:40960
v_mfma_f32_16x16x32_bf16 v[136:139], v[72:75], v[52:55], v[136:139]
ds_read_b64_tr_b16 v[170:171], v5 offset:38912
v_mfma_f32_16x16x32_bf16 v[140:143], v[76:79], v[52:55], v[140:143]
ds_read_b128 v[116:119], v2 offset:41216
v_mfma_f32_16x16x32_bf16 v[144:147], v[72:75], v[56:59], v[144:147]
ds_read_b64_tr_b16 v[172:173], v6 offset:36864
v_mfma_f32_16x16x32_bf16 v[148:151], v[76:79], v[56:59], v[148:151]
ds_read_b128 v[120:123], v2 offset:41472
v_mfma_f32_16x16x32_bf16 v[152:155], v[72:75], v[60:63], v[152:155]
ds_read_b64_tr_b16 v[174:175], v6 offset:38912
v_mfma_f32_16x16x32_bf16 v[156:159], v[76:79], v[60:63], v[156:159]
ds_read_b128 v[124:127], v2 offset:41728
s_waitcnt lgkmcnt(0)
s_barrier
v_mfma_f32_16x16x32_bf16 v[128:131], v[160:163], v[96:99], v[128:131]
ds_read_b64_tr_b16 v[64:65], v7 offset:0
v_mfma_f32_16x16x32_bf16 v[132:135], v[164:167], v[96:99], v[132:135]
ds_read_b128 v[32:35], v3 offset:0
v_mfma_f32_16x16x32_bf16 v[136:139], v[160:163], v[100:103], v[136:139]
ds_read_b64_tr_b16 v[66:67], v7 offset:2048
v_mfma_f32_16x16x32_bf16 v[140:143], v[164:167], v[100:103], v[140:143]
ds_read_b128 v[36:39], v3 offset:256
v_mfma_f32_16x16x32_bf16 v[144:147], v[160:163], v[104:107], v[144:147]
ds_read_b64_tr_b16 v[68:69], v8 offset:0
v_mfma_f32_16x16x32_bf16 v[148:151], v[164:167], v[104:107], v[148:151]
ds_read_b128 v[40:43], v3 offset:512
v_mfma_f32_16x16x32_bf16 v[152:155], v[160:163], v[108:111], v[152:155]
ds_read_b64_tr_b16 v[70:71], v8 offset:2048
v_mfma_f32_16x16x32_bf16 v[156:159], v[164:167], v[108:111], v[156:159]
ds_read_b128 v[44:47], v3 offset:768
v_mfma_f32_16x16x32_bf16 v[128:131], v[168:171], v[112:115], v[128:131]
ds_read_b64_tr_b16 v[72:73], v7 offset:4096
v_mfma_f32_16x16x32_bf16 v[132:135], v[172:175], v[112:115], v[132:135]
ds_read_b128 v[48:51], v3 offset:8192
v_mfma_f32_16x16x32_bf16 v[136:139], v[168:171], v[116:119], v[136:139]
ds_read_b64_tr_b16 v[74:75], v7 offset:6144
v_mfma_f32_16x16x32_bf16 v[140:143], v[172:175], v[116:119], v[140:143]
ds_read_b128 v[52:55], v3 offset:8448
v_mfma_f32_16x16x32_bf16 v[144:147], v[168:171], v[120:123], v[144:147]
ds_read_b64_tr_b16 v[76:77], v8 offset:4096
v_mfma_f32_16x16x32_bf16 v[148:151], v[172:175], v[120:123], v[148:151]
ds_read_b128 v[56:59], v3 offset:8704
v_mfma_f32_16x16x32_bf16 v[152:155], v[168:171], v[124:127], v[152:155]
ds_read_b64_tr_b16 v[78:79], v8 offset:6144
v_mfma_f32_16x16x32_bf16 v[156:159], v[172:175], v[124:127], v[156:159]
ds_read_b128 v[60:63], v3 offset:8960
s_waitcnt lgkmcnt(0)
s_barrier
v_mfma_f32_16x16x32_bf16 v[128:131], v[64:67], v[32:35], v[128:131]
ds_read_b64_tr_b16 v[160:161], v7 offset:32768
v_mfma_f32_16x16x32_bf16 v[132:135], v[68:71], v[32:35], v[132:135]
ds_read_b128 v[96:99], v3 offset:32768
v_mfma_f32_16x16x32_bf16 v[136:139], v[64:67], v[36:39], v[136:139]
ds_read_b64_tr_b16 v[162:163], v7 offset:34816
v_mfma_f32_16x16x32_bf16 v[140:143], v[68:71], v[36:39], v[140:143]
ds_read_b128 v[100:103], v3 offset:33024
v_mfma_f32_16x16x32_bf16 v[144:147], v[64:67], v[40:43], v[144:147]
ds_read_b64_tr_b16 v[164:165], v8 offset:32768
v_mfma_f32_16x16x32_bf16 v[148:151], v[68:71], v[40:43], v[148:151]
ds_read_b128 v[104:107], v3 offset:33280
v_mfma_f32_16x16x32_bf16 v[152:155], v[64:67], v[44:47], v[152:155]
ds_read_b64_tr_b16 v[166:167], v8 offset:34816
v_mfma_f32_16x16x32_bf16 v[156:159], v[68:71], v[44:47], v[156:159]
ds_read_b128 v[108:111], v3 offset:33536
v_mfma_f32_16x16x32_bf16 v[128:131], v[72:75], v[48:51], v[128:131]
ds_read_b64_tr_b16 v[168:169], v7 offset:36864
v_mfma_f32_16x16x32_bf16 v[132:135], v[76:79], v[48:51], v[132:135]
ds_read_b128 v[112:115], v3 offset:40960
v_mfma_f32_16x16x32_bf16 v[136:139], v[72:75], v[52:55], v[136:139]
ds_read_b64_tr_b16 v[170:171], v7 offset:38912
v_mfma_f32_16x16x32_bf16 v[140:143], v[76:79], v[52:55], v[140:143]
ds_read_b128 v[116:119], v3 offset:41216
v_mfma_f32_16x16x32_bf16 v[144:147], v[72:75], v[56:59], v[144:147]
ds_read_b64_tr_b16 v[172:173], v8 offset:36864
v_mfma_f32_16x16x32_bf16 v[148:151], v[76:79], v[56:59], v[148:151]
ds_read_b128 v[120:123], v3 offset:41472
v_mfma_f32_16x16x32_bf16 v[152:155], v[72:75], v[60:63], v[152:155]
ds_read_b64_tr_b16 v[174:175], v8 offset:38912
v_mfma_f32_16x16x32_bf16 v[156:159], v[76:79], v[60:63], v[156:159]
ds_read_b128 v[124:127], v3 offset:41728
s_waitcnt lgkmcnt(0)
s_barrier
v_mfma_f32_16x16x32_bf16 v[128:131], v[160:163], v[96:99], v[128:131]
ds_read_b64_tr_b16 v[64:65], v5 offset:0
v_mfma_f32_16x16x32_bf16 v[132:135], v[164:167], v[96:99], v[132:135]
ds_read_b128 v[32:35], v2 offset:0
v_mfma_f32_16x16x32_bf16 v[136:139], v[160:163], v[100:103], v[136:139]
ds_read_b64_tr_b16 v[66:67], v5 offset:2048
v_mfma_f32_16x16x32_bf16 v[140:143], v[164:167], v[100:103], v[140:143]
ds_read_b128 v[36:39], v2 offset:256
buffer_load_dwordx4 v[192:195], v9, s[68:71], 0 offen offset:0 sc1
v_mfma_f32_16x16x32_bf16 v[144:147], v[160:163], v[104:107], v[144:147]
ds_read_b64_tr_b16 v[68:69], v6 offset:0
v_mfma_f32_16x16x32_bf16 v[148:151], v[164:167], v[104:107], v[148:151]
ds_read_b128 v[40:43], v2 offset:512
v_mfma_f32_16x16x32_bf16 v[152:155], v[160:163], v[108:111], v[152:155]
ds_read_b64_tr_b16 v[70:71], v6 offset:2048
buffer_load_dwordx4 v[196:199], v9, s[68:71], 0 offen offset:1024 sc1
v_mfma_f32_16x16x32_bf16 v[156:159], v[164:167], v[108:111], v[156:159]
ds_read_b128 v[44:47], v2 offset:768
v_mfma_f32_16x16x32_bf16 v[128:131], v[168:171], v[112:115], v[128:131]
ds_read_b64_tr_b16 v[72:73], v5 offset:4096
v_mfma_f32_16x16x32_bf16 v[132:135], v[172:175], v[112:115], v[132:135]
ds_read_b128 v[48:51], v2 offset:8192
buffer_load_dwordx4 v[200:203], v9, s[68:71], 0 offen offset:2048 sc1
v_mfma_f32_16x16x32_bf16 v[136:139], v[168:171], v[116:119], v[136:139]
ds_read_b64_tr_b16 v[74:75], v5 offset:6144
v_mfma_f32_16x16x32_bf16 v[140:143], v[172:175], v[116:119], v[140:143]
ds_read_b128 v[52:55], v2 offset:8448
v_mfma_f32_16x16x32_bf16 v[144:147], v[168:171], v[120:123], v[144:147]
ds_read_b64_tr_b16 v[76:77], v6 offset:4096
buffer_load_dwordx4 v[204:207], v9, s[68:71], 0 offen offset:3072 sc1
v_mfma_f32_16x16x32_bf16 v[148:151], v[172:175], v[120:123], v[148:151]
ds_read_b128 v[56:59], v2 offset:8704
v_mfma_f32_16x16x32_bf16 v[152:155], v[168:171], v[124:127], v[152:155]
ds_read_b64_tr_b16 v[78:79], v6 offset:6144
v_mfma_f32_16x16x32_bf16 v[156:159], v[172:175], v[124:127], v[156:159]
ds_read_b128 v[60:63], v2 offset:8960
s_waitcnt lgkmcnt(0)
s_barrier
v_mfma_f32_16x16x32_bf16 v[128:131], v[64:67], v[32:35], v[128:131]
ds_read_b64_tr_b16 v[160:161], v5 offset:32768
v_mfma_f32_16x16x32_bf16 v[132:135], v[68:71], v[32:35], v[132:135]
ds_read_b128 v[96:99], v2 offset:32768
v_mfma_f32_16x16x32_bf16 v[136:139], v[64:67], v[36:39], v[136:139]
ds_read_b64_tr_b16 v[162:163], v5 offset:34816
v_mfma_f32_16x16x32_bf16 v[140:143], v[68:71], v[36:39], v[140:143]
ds_read_b128 v[100:103], v2 offset:33024
v_mfma_f32_16x16x32_bf16 v[144:147], v[64:67], v[40:43], v[144:147]
ds_read_b64_tr_b16 v[164:165], v6 offset:32768
v_mfma_f32_16x16x32_bf16 v[148:151], v[68:71], v[40:43], v[148:151]
ds_read_b128 v[104:107], v2 offset:33280
v_mfma_f32_16x16x32_bf16 v[152:155], v[64:67], v[44:47], v[152:155]
ds_read_b64_tr_b16 v[166:167], v6 offset:34816
v_mfma_f32_16x16x32_bf16 v[156:159], v[68:71], v[44:47], v[156:159]
ds_read_b128 v[108:111], v2 offset:33536
v_mfma_f32_16x16x32_bf16 v[128:131], v[72:75], v[48:51], v[128:131]
ds_read_b64_tr_b16 v[168:169], v5 offset:36864
v_mfma_f32_16x16x32_bf16 v[132:135], v[76:79], v[48:51], v[132:135]
ds_read_b128 v[112:115], v2 offset:40960
v_mfma_f32_16x16x32_bf16 v[136:139], v[72:75], v[52:55], v[136:139]
ds_read_b64_tr_b16 v[170:171], v5 offset:38912
v_mfma_f32_16x16x32_bf16 v[140:143], v[76:79], v[52:55], v[140:143]
ds_read_b128 v[116:119], v2 offset:41216
v_mfma_f32_16x16x32_bf16 v[144:147], v[72:75], v[56:59], v[144:147]
ds_read_b64_tr_b16 v[172:173], v6 offset:36864
v_mfma_f32_16x16x32_bf16 v[148:151], v[76:79], v[56:59], v[148:151]
ds_read_b128 v[120:123], v2 offset:41472
v_mfma_f32_16x16x32_bf16 v[152:155], v[72:75], v[60:63], v[152:155]
ds_read_b64_tr_b16 v[174:175], v6 offset:38912
v_mfma_f32_16x16x32_bf16 v[156:159], v[76:79], v[60:63], v[156:159]
ds_read_b128 v[124:127], v2 offset:41728
s_waitcnt lgkmcnt(0)
s_barrier
v_mfma_f32_16x16x32_bf16 v[128:131], v[160:163], v[96:99], v[128:131]
v_mfma_f32_16x16x32_bf16 v[132:135], v[164:167], v[96:99], v[132:135]
v_mfma_f32_16x16x32_bf16 v[136:139], v[160:163], v[100:103], v[136:139]
v_mfma_f32_16x16x32_bf16 v[140:143], v[164:167], v[100:103], v[140:143]
v_mfma_f32_16x16x32_bf16 v[144:147], v[160:163], v[104:107], v[144:147]
v_mfma_f32_16x16x32_bf16 v[148:151], v[164:167], v[104:107], v[148:151]
v_mfma_f32_16x16x32_bf16 v[152:155], v[160:163], v[108:111], v[152:155]
v_mfma_f32_16x16x32_bf16 v[156:159], v[164:167], v[108:111], v[156:159]
s_waitcnt vmcnt(0)
v_mfma_f32_16x16x32_bf16 v[128:131], v[168:171], v[112:115], v[128:131]
v_lshlrev_b32 v224, 16, v192
v_and_b32 v225, 0xffff0000, v192
v_lshlrev_b32 v226, 16, v193
v_and_b32 v227, 0xffff0000, v193
v_mfma_f32_16x16x32_bf16 v[132:135], v[172:175], v[112:115], v[132:135]
v_lshlrev_b32 v228, 16, v194
v_and_b32 v229, 0xffff0000, v194
v_lshlrev_b32 v230, 16, v195
v_and_b32 v231, 0xffff0000, v195
v_mfma_f32_16x16x32_bf16 v[136:139], v[168:171], v[116:119], v[136:139]
v_lshlrev_b32 v232, 16, v196
v_and_b32 v233, 0xffff0000, v196
v_lshlrev_b32 v234, 16, v197
v_and_b32 v235, 0xffff0000, v197
v_mfma_f32_16x16x32_bf16 v[140:143], v[172:175], v[116:119], v[140:143]
v_lshlrev_b32 v236, 16, v198
v_and_b32 v237, 0xffff0000, v198
v_lshlrev_b32 v238, 16, v199
v_and_b32 v239, 0xffff0000, v199
v_mfma_f32_16x16x32_bf16 v[144:147], v[168:171], v[120:123], v[144:147]
v_lshlrev_b32 v240, 16, v200
v_and_b32 v241, 0xffff0000, v200
v_lshlrev_b32 v242, 16, v201
v_and_b32 v243, 0xffff0000, v201
v_mfma_f32_16x16x32_bf16 v[148:151], v[172:175], v[120:123], v[148:151]
v_lshlrev_b32 v244, 16, v202
v_and_b32 v245, 0xffff0000, v202
v_lshlrev_b32 v246, 16, v203
v_and_b32 v247, 0xffff0000, v203
v_mfma_f32_16x16x32_bf16 v[152:155], v[168:171], v[124:127], v[152:155]
v_lshlrev_b32 v248, 16, v204
v_and_b32 v249, 0xffff0000, v204
v_lshlrev_b32 v250, 16, v205
v_and_b32 v251, 0xffff0000, v205
v_mfma_f32_16x16x32_bf16 v[156:159], v[172:175], v[124:127], v[156:159]
v_lshlrev_b32 v252, 16, v206
v_and_b32 v253, 0xffff0000, v206
v_lshlrev_b32 v254, 16, v207
v_and_b32 v255, 0xffff0000, v207
s_waitcnt vmcnt(0)
s_nop 4
v_pk_add_f32 v[128:129], v[128:129], v[224:225]
v_pk_add_f32 v[130:131], v[130:131], v[226:227]
v_pk_add_f32 v[132:133], v[132:133], v[228:229]
v_pk_add_f32 v[134:135], v[134:135], v[230:231]
v_cvt_pk_bf16_f32 v32, v128, v129
v_cvt_pk_bf16_f32 v33, v130, v131
v_cvt_pk_bf16_f32 v34, v132, v133
v_cvt_pk_bf16_f32 v35, v134, v135
v_pk_add_f32 v[136:137], v[136:137], v[232:233]
v_pk_add_f32 v[138:139], v[138:139], v[234:235]
v_pk_add_f32 v[140:141], v[140:141], v[236:237]
v_pk_add_f32 v[142:143], v[142:143], v[238:239]
v_cvt_pk_bf16_f32 v36, v136, v137
v_cvt_pk_bf16_f32 v37, v138, v139
v_cvt_pk_bf16_f32 v38, v140, v141
v_cvt_pk_bf16_f32 v39, v142, v143
v_pk_add_f32 v[144:145], v[144:145], v[240:241]
v_pk_add_f32 v[146:147], v[146:147], v[242:243]
v_pk_add_f32 v[148:149], v[148:149], v[244:245]
v_pk_add_f32 v[150:151], v[150:151], v[246:247]
v_cvt_pk_bf16_f32 v40, v144, v145
v_cvt_pk_bf16_f32 v41, v146, v147
v_cvt_pk_bf16_f32 v42, v148, v149
v_cvt_pk_bf16_f32 v43, v150, v151
v_pk_add_f32 v[152:153], v[152:153], v[248:249]
v_pk_add_f32 v[154:155], v[154:155], v[250:251]
v_pk_add_f32 v[156:157], v[156:157], v[252:253]
v_pk_add_f32 v[158:159], v[158:159], v[254:255]
v_cvt_pk_bf16_f32 v44, v152, v153
v_cvt_pk_bf16_f32 v45, v154, v155
v_cvt_pk_bf16_f32 v46, v156, v157
v_cvt_pk_bf16_f32 v47, v158, v159
v_permlane16_swap_b32 v32, v34
v_permlane16_swap_b32 v33, v35
buffer_store_dwordx4 v[32:35], v28, s[16:19], 0 offen offset:0
v_permlane16_swap_b32 v36, v38
v_permlane16_swap_b32 v37, v39
buffer_store_dwordx4 v[36:39], v28, s[16:19], 0 offen offset:2048
v_permlane16_swap_b32 v40, v42
v_permlane16_swap_b32 v41, v43
buffer_store_dwordx4 v[40:43], v28, s[16:19], s54 offen offset:0
v_permlane16_swap_b32 v44, v46
v_permlane16_swap_b32 v45, v47
buffer_store_dwordx4 v[44:47], v28, s[16:19], s54 offen offset:2048
s_branch Ldone_1
LG1_24:
s_cmp_eq_u32 s36, 7
s_cbranch_scc1 L7_33
s_mul_i32 s44, s34, 262144
s_lshl_b32 s39, s51, 13
s_add_u32 s44, s44, s39
s_add_u32 s44, s44, 0
s_lshl_b32 s43, s35, 7
s_mov_b32 s10, 253952
s_movk_i32 s38, 1024
s_movk_i32 s40, 9216
s_cmp_eq_u32 s51, 2
s_cselect_b32 s8, s28, s32
s_cselect_b32 s9, s29, s33
s_cselect_b32 s10, 2095232, s10
s_cselect_b32 s43, s43, s44
s_cselect_b32 s38, 16384, s38
s_cselect_b32 s40, 16384, s40
s_cselect_b32 s55, 16384, s38
s_cselect_b32 s45, -1, 0
s_add_u32 s8, s8, s43
s_addc_u32 s9, s9, 0
s_mov_b32 s11, 0x20000
s_sub_u32 s37, 0, s40
v_lshrrev_b32 v19, 3, v1
v_mul_u32_u24 v19, 1920, v19
v_lshrrev_b32 v20, 4, v1
v_lshlrev_b32 v20, 5, v20
v_and_b32 v19, s45, v19
v_and_b32 v20, s45, v20
v_lshlrev_b32 v23, 4, v1
v_xor_b32 v23, v23, v20
v_add_u32 v23, v23, v19
s_lshl_b32 s43, s34, 18
s_add_u32 s12, s32, s43
s_addc_u32 s13, s33, 0
s_mov_b32 s14, 262144
s_mov_b32 s15, 0x20000
v_lshlrev_b32 v21, 4, v1
s_lshl_b32 s54, s36, 11
s_add_u32 s43, s35, 1
s_and_b32 s43, s43, 15
s_lshl_b32 s43, s43, 14
s_add_u32 s30, s43, s54
s_add_u32 s43, s35, 2
s_and_b32 s43, s43, 15
s_lshl_b32 s43, s43, 14
s_add_u32 s31, s43, s54
s_cmp_eq_u32 s51, 1
s_cbranch_scc1 Lp_37
s_cmp_eq_u32 s51, 2
s_cbranch_scc1 Lp_38
Lp_36:
s_add_u32 s42, s35, 2
s_waitcnt lgkmcnt(0)
s_barrier
s_add_u32 s43, s34, 0
s_lshl_b32 s43, s43, 7
v_mov_b32 v8, s43
v_mov_b32 v10, 16
buffer_load_dword v9, v8, s[56:59], 0 offen sc1
s_mov_b32 s41, 0x10000
Lpoll_39:
s_waitcnt vmcnt(0)
Lpf_41:
v_cmp_ne_u32 vcc, v10, v9
s_nop 4
s_cbranch_vccz Lpok_40
buffer_load_dword v9, v8, s[56:59], 0 offen sc1
s_sub_u32 s41, s41, 1
s_cmp_lg_u32 s41, 0
s_cbranch_scc1 Lpoll_39
s_waitcnt vmcnt(0)
Lpok_40:
s_barrier
s_add_u32 m0, s54, 16384
s_add_u32 s43, s30, 0
buffer_load_dwordx4 v21, s[12:15], s43 offen sc1 lds
s_add_u32 m0, s54, 17408
s_add_u32 s43, s30, 1024
buffer_load_dwordx4 v21, s[12:15], s43 offen sc1 lds
s_add_u32 m0, s54, 32768
s_add_u32 s43, s31, 0
buffer_load_dwordx4 v21, s[12:15], s43 offen sc1 lds
s_add_u32 m0, s54, 33792
s_add_u32 s43, s31, 1024
buffer_load_dwordx4 v21, s[12:15], s43 offen sc1 lds
s_add_u32 s42, s42, 1
s_and_b32 s42, s42, 15
s_add_u32 m0, s39, 49152
s_lshl_b32 s37, s42, 14
buffer_load_dwordx4 v23, s[8:11], s37 offen sc1 lds
s_add_u32 m0, s39, 50176
s_add_u32 s37, s37, s38
buffer_load_dwordx4 v23, s[8:11], s37 offen sc1 lds
s_add_u32 m0, s39, 51200
s_add_u32 s37, s37, s38
buffer_load_dwordx4 v23, s[8:11], s37 offen sc1 lds
s_add_u32 m0, s39, 52224
s_add_u32 s37, s37, s38
buffer_load_dwordx4 v23, s[8:11], s37 offen sc1 lds
s_add_u32 m0, s39, 53248
s_add_u32 s37, s37, s38
buffer_load_dwordx4 v23, s[8:11], s37 offen sc1 lds
s_add_u32 m0, s39, 54272
s_add_u32 s37, s37, s38
buffer_load_dwordx4 v23, s[8:11], s37 offen sc1 lds
s_add_u32 m0, s39, 55296
s_add_u32 s37, s37, s38
buffer_load_dwordx4 v23, s[8:11], s37 offen sc1 lds
s_add_u32 m0, s39, 56320
s_add_u32 s37, s37, s38
buffer_load_dwordx4 v23, s[8:11], s37 offen sc1 lds
s_add_u32 s42, s42, 1
s_and_b32 s42, s42, 15
s_add_u32 m0, s39, 0
s_lshl_b32 s37, s42, 14
buffer_load_dwordx4 v23, s[8:11], s37 offen sc1 lds
s_add_u32 m0, s39, 1024
s_add_u32 s37, s37, s38
buffer_load_dwordx4 v23, s[8:11], s37 offen sc1 lds
s_add_u32 m0, s39, 2048
s_add_u32 s37, s37, s38
buffer_load_dwordx4 v23, s[8:11], s37 offen sc1 lds
s_add_u32 m0, s39, 3072
s_add_u32 s37, s37, s38
buffer_load_dwordx4 v23, s[8:11], s37 offen sc1 lds
s_add_u32 m0, s39, 4096
s_add_u32 s37, s37, s38
buffer_load_dwordx4 v23, s[8:11], s37 offen sc1 lds
s_add_u32 m0, s39, 5120
s_add_u32 s37, s37, s38
buffer_load_dwordx4 v23, s[8:11], s37 offen sc1 lds
s_add_u32 m0, s39, 6144
s_add_u32 s37, s37, s38
buffer_load_dwordx4 v23, s[8:11], s37 offen sc1 lds
s_add_u32 m0, s39, 7168
s_add_u32 s37, s37, s38
buffer_load_dwordx4 v23, s[8:11], s37 offen sc1 lds
s_waitcnt vmcnt(18)
s_barrier
s_waitcnt vmcnt(16)
s_barrier
s_add_u32 s42, s42, 1
s_and_b32 s42, s42, 15
s_add_u32 m0, s39, 16384
s_lshl_b32 s37, s42, 14
buffer_load_dwordx4 v23, s[8:11], s37 offen sc1 lds
s_add_u32 m0, s39, 17408
s_add_u32 s37, s37, s38
buffer_load_dwordx4 v23, s[8:11], s37 offen sc1 lds
s_add_u32 m0, s39, 18432
s_add_u32 s37, s37, s38
buffer_load_dwordx4 v23, s[8:11], s37 offen sc1 lds
s_add_u32 m0, s39, 19456
s_add_u32 s37, s37, s38
buffer_load_dwordx4 v23, s[8:11], s37 offen sc1 lds
s_add_u32 m0, s39, 20480
s_add_u32 s37, s37, s38
buffer_load_dwordx4 v23, s[8:11], s37 offen sc1 lds
s_add_u32 m0, s39, 21504
s_add_u32 s37, s37, s38
buffer_load_dwordx4 v23, s[8:11], s37 offen sc1 lds
s_add_u32 m0, s39, 22528
s_add_u32 s37, s37, s38
buffer_load_dwordx4 v23, s[8:11], s37 offen sc1 lds
s_add_u32 m0, s39, 23552
s_add_u32 s37, s37, s38
buffer_load_dwordx4 v23, s[8:11], s37 offen sc1 lds
s_waitcnt vmcnt(16)
s_barrier
s_add_u32 s42, s42, 1
s_and_b32 s42, s42, 15
s_add_u32 m0, s39, 32768
s_lshl_b32 s37, s42, 14
buffer_load_dwordx4 v23, s[8:11], s37 offen sc1 lds
s_add_u32 m0, s39, 33792
s_add_u32 s37, s37, s38
buffer_load_dwordx4 v23, s[8:11], s37 offen sc1 lds
s_add_u32 m0, s39, 34816
s_add_u32 s37, s37, s38
buffer_load_dwordx4 v23, s[8:11], s37 offen sc1 lds
s_add_u32 m0, s39, 35840
s_add_u32 s37, s37, s38
buffer_load_dwordx4 v23, s[8:11], s37 offen sc1 lds
s_add_u32 m0, s39, 36864
s_add_u32 s37, s37, s38
buffer_load_dwordx4 v23, s[8:11], s37 offen sc1 lds
s_add_u32 m0, s39, 37888
s_add_u32 s37, s37, s38
buffer_load_dwordx4 v23, s[8:11], s37 offen sc1 lds
s_add_u32 m0, s39, 38912
s_add_u32 s37, s37, s38
buffer_load_dwordx4 v23, s[8:11], s37 offen sc1 lds
s_add_u32 m0, s39, 39936
s_add_u32 s37, s37, s38
buffer_load_dwordx4 v23, s[8:11], s37 offen sc1 lds
s_waitcnt vmcnt(16)
s_barrier
s_add_u32 s42, s42, 1
s_and_b32 s42, s42, 15
s_add_u32 m0, s39, 49152
s_lshl_b32 s37, s42, 14
buffer_load_dwordx4 v23, s[8:11], s37 offen sc1 lds
s_add_u32 m0, s39, 50176
s_add_u32 s37, s37, s38
buffer_load_dwordx4 v23, s[8:11], s37 offen sc1 lds
s_add_u32 m0, s39, 51200
s_add_u32 s37, s37, s38
buffer_load_dwordx4 v23, s[8:11], s37 offen sc1 lds
s_add_u32 m0, s39, 52224
s_add_u32 s37, s37, s38
buffer_load_dwordx4 v23, s[8:11], s37 offen sc1 lds
s_add_u32 m0, s39, 53248
s_add_u32 s37, s37, s38
buffer_load_dwordx4 v23, s[8:11], s37 offen sc1 lds
s_add_u32 m0, s39, 54272
s_add_u32 s37, s37, s38
buffer_load_dwordx4 v23, s[8:11], s37 offen sc1 lds
s_add_u32 m0, s39, 55296
s_add_u32 s37, s37, s38
buffer_load_dwordx4 v23, s[8:11], s37 offen sc1 lds
s_add_u32 m0, s39, 56320
s_add_u32 s37, s37, s38
buffer_load_dwordx4 v23, s[8:11], s37 offen sc1 lds
s_waitcnt vmcnt(16)
s_barrier
s_add_u32 s42, s42, 1
s_and_b32 s42, s42, 15
s_add_u32 m0, s39, 0
s_lshl_b32 s37, s42, 14
buffer_load_dwordx4 v23, s[8:11], s37 offen sc1 lds
s_add_u32 m0, s39, 1024
s_add_u32 s37, s37, s38
buffer_load_dwordx4 v23, s[8:11], s37 offen sc1 lds
s_add_u32 m0, s39, 2048
s_add_u32 s37, s37, s38
buffer_load_dwordx4 v23, s[8:11], s37 offen sc1 lds
s_add_u32 m0, s39, 3072
s_add_u32 s37, s37, s38
buffer_load_dwordx4 v23, s[8:11], s37 offen sc1 lds
s_add_u32 m0, s39, 4096
s_add_u32 s37, s37, s38
buffer_load_dwordx4 v23, s[8:11], s37 offen sc1 lds
s_add_u32 m0, s39, 5120
s_add_u32 s37, s37, s38
buffer_load_dwordx4 v23, s[8:11], s37 offen sc1 lds
s_add_u32 m0, s39, 6144
s_add_u32 s37, s37, s38
buffer_load_dwordx4 v23, s[8:11], s37 offen sc1 lds
s_add_u32 m0, s39, 7168
s_add_u32 s37, s37, s38
buffer_load_dwordx4 v23, s[8:11], s37 offen sc1 lds
s_waitcnt vmcnt(16)
s_barrier
s_add_u32 s42, s42, 1
s_and_b32 s42, s42, 15
s_add_u32 m0, s39, 16384
s_lshl_b32 s37, s42, 14
buffer_load_dwordx4 v23, s[8:11], s37 offen sc1 lds
s_add_u32 m0, s39, 17408
s_add_u32 s37, s37, s38
buffer_load_dwordx4 v23, s[8:11], s37 offen sc1 lds
s_add_u32 m0, s39, 18432
s_add_u32 s37, s37, s38
buffer_load_dwordx4 v23, s[8:11], s37 offen sc1 lds
s_add_u32 m0, s39, 19456
s_add_u32 s37, s37, s38
buffer_load_dwordx4 v23, s[8:11], s37 offen sc1 lds
s_add_u32 m0, s39, 20480
s_add_u32 s37, s37, s38
buffer_load_dwordx4 v23, s[8:11], s37 offen sc1 lds
s_add_u32 m0, s39, 21504
s_add_u32 s37, s37, s38
buffer_load_dwordx4 v23, s[8:11], s37 offen sc1 lds
s_add_u32 m0, s39, 22528
s_add_u32 s37, s37, s38
buffer_load_dwordx4 v23, s[8:11], s37 offen sc1 lds
s_add_u32 m0, s39, 23552
s_add_u32 s37, s37, s38
buffer_load_dwordx4 v23, s[8:11], s37 offen sc1 lds
s_waitcnt vmcnt(16)
s_barrier
s_add_u32 s42, s42, 1
s_and_b32 s42, s42, 15
s_add_u32 m0, s39, 32768
s_lshl_b32 s37, s42, 14
buffer_load_dwordx4 v23, s[8:11], s37 offen sc1 lds
s_add_u32 m0, s39, 33792
s_add_u32 s37, s37, s38
buffer_load_dwordx4 v23, s[8:11], s37 offen sc1 lds
s_add_u32 m0, s39, 34816
s_add_u32 s37, s37, s38
buffer_load_dwordx4 v23, s[8:11], s37 offen sc1 lds
s_add_u32 m0, s39, 35840
s_add_u32 s37, s37, s38
buffer_load_dwordx4 v23, s[8:11], s37 offen sc1 lds
s_add_u32 m0, s39, 36864
s_add_u32 s37, s37, s38
buffer_load_dwordx4 v23, s[8:11], s37 offen sc1 lds
s_add_u32 m0, s39, 37888
s_add_u32 s37, s37, s38
buffer_load_dwordx4 v23, s[8:11], s37 offen sc1 lds
s_add_u32 m0, s39, 38912
s_add_u32 s37, s37, s38
buffer_load_dwordx4 v23, s[8:11], s37 offen sc1 lds
s_add_u32 m0, s39, 39936
s_add_u32 s37, s37, s38
buffer_load_dwordx4 v23, s[8:11], s37 offen sc1 lds
s_waitcnt vmcnt(16)
s_barrier
s_add_u32 s42, s42, 1
s_and_b32 s42, s42, 15
s_add_u32 m0, s39, 49152
s_lshl_b32 s37, s42, 14
buffer_load_dwordx4 v23, s[8:11], s37 offen sc1 lds
s_add_u32 m0, s39, 50176
s_add_u32 s37, s37, s38
buffer_load_dwordx4 v23, s[8:11], s37 offen sc1 lds
s_add_u32 m0, s39, 51200
s_add_u32 s37, s37, s38
buffer_load_dwordx4 v23, s[8:11], s37 offen sc1 lds
s_add_u32 m0, s39, 52224
s_add_u32 s37, s37, s38
buffer_load_dwordx4 v23, s[8:11], s37 offen sc1 lds
s_add_u32 m0, s39, 53248
s_add_u32 s37, s37, s38
buffer_load_dwordx4 v23, s[8:11], s37 offen sc1 lds
s_add_u32 m0, s39, 54272
s_add_u32 s37, s37, s38
buffer_load_dwordx4 v23, s[8:11], s37 offen sc1 lds
s_add_u32 m0, s39, 55296
s_add_u32 s37, s37, s38
buffer_load_dwordx4 v23, s[8:11], s37 offen sc1 lds
s_add_u32 m0, s39, 56320
s_add_u32 s37, s37, s38
buffer_load_dwordx4 v23, s[8:11], s37 offen sc1 lds
s_waitcnt vmcnt(16)
s_barrier
s_add_u32 s42, s42, 1
s_and_b32 s42, s42, 15
s_add_u32 m0, s39, 0
s_lshl_b32 s37, s42, 14
buffer_load_dwordx4 v23, s[8:11], s37 offen sc1 lds
s_add_u32 m0, s39, 1024
s_add_u32 s37, s37, s38
buffer_load_dwordx4 v23, s[8:11], s37 offen sc1 lds
s_add_u32 m0, s39, 2048
s_add_u32 s37, s37, s38
buffer_load_dwordx4 v23, s[8:11], s37 offen sc1 lds
s_add_u32 m0, s39, 3072
s_add_u32 s37, s37, s38
buffer_load_dwordx4 v23, s[8:11], s37 offen sc1 lds
s_add_u32 m0, s39, 4096
s_add_u32 s37, s37, s38
buffer_load_dwordx4 v23, s[8:11], s37 offen sc1 lds
s_add_u32 m0, s39, 5120
s_add_u32 s37, s37, s38
buffer_load_dwordx4 v23, s[8:11], s37 offen sc1 lds
s_add_u32 m0, s39, 6144
s_add_u32 s37, s37, s38
buffer_load_dwordx4 v23, s[8:11], s37 offen sc1 lds
s_add_u32 m0, s39, 7168
s_add_u32 s37, s37, s38
buffer_load_dwordx4 v23, s[8:11], s37 offen sc1 lds
s_waitcnt vmcnt(16)
s_barrier
s_add_u32 s42, s42, 1
s_and_b32 s42, s42, 15
s_add_u32 m0, s39, 16384
s_lshl_b32 s37, s42, 14
buffer_load_dwordx4 v23, s[8:11], s37 offen sc1 lds
s_add_u32 m0, s39, 17408
s_add_u32 s37, s37, s38
buffer_load_dwordx4 v23, s[8:11], s37 offen sc1 lds
s_add_u32 m0, s39, 18432
s_add_u32 s37, s37, s38
buffer_load_dwordx4 v23, s[8:11], s37 offen sc1 lds
s_add_u32 m0, s39, 19456
s_add_u32 s37, s37, s38
buffer_load_dwordx4 v23, s[8:11], s37 offen sc1 lds
s_add_u32 m0, s39, 20480
s_add_u32 s37, s37, s38
buffer_load_dwordx4 v23, s[8:11], s37 offen sc1 lds
s_add_u32 m0, s39, 21504
s_add_u32 s37, s37, s38
buffer_load_dwordx4 v23, s[8:11], s37 offen sc1 lds
s_add_u32 m0, s39, 22528
s_add_u32 s37, s37, s38
buffer_load_dwordx4 v23, s[8:11], s37 offen sc1 lds
s_add_u32 m0, s39, 23552
s_add_u32 s37, s37, s38
buffer_load_dwordx4 v23, s[8:11], s37 offen sc1 lds
s_waitcnt vmcnt(16)
s_barrier
s_add_u32 s42, s42, 1
s_and_b32 s42, s42, 15
s_add_u32 m0, s39, 32768
s_lshl_b32 s37, s42, 14
buffer_load_dwordx4 v23, s[8:11], s37 offen sc1 lds
s_add_u32 m0, s39, 33792
s_add_u32 s37, s37, s38
buffer_load_dwordx4 v23, s[8:11], s37 offen sc1 lds
s_add_u32 m0, s39, 34816
s_add_u32 s37, s37, s38
buffer_load_dwordx4 v23, s[8:11], s37 offen sc1 lds
s_add_u32 m0, s39, 35840
s_add_u32 s37, s37, s38
buffer_load_dwordx4 v23, s[8:11], s37 offen sc1 lds
s_add_u32 m0, s39, 36864
s_add_u32 s37, s37, s38
buffer_load_dwordx4 v23, s[8:11], s37 offen sc1 lds
s_add_u32 m0, s39, 37888
s_add_u32 s37, s37, s38
buffer_load_dwordx4 v23, s[8:11], s37 offen sc1 lds
s_add_u32 m0, s39, 38912
s_add_u32 s37, s37, s38
buffer_load_dwordx4 v23, s[8:11], s37 offen sc1 lds
s_add_u32 m0, s39, 39936
s_add_u32 s37, s37, s38
buffer_load_dwordx4 v23, s[8:11], s37 offen sc1 lds
s_waitcnt vmcnt(16)
s_barrier
s_add_u32 s42, s42, 1
s_and_b32 s42, s42, 15
s_add_u32 m0, s39, 49152
s_lshl_b32 s37, s42, 14
buffer_load_dwordx4 v23, s[8:11], s37 offen sc1 lds
s_add_u32 m0, s39, 50176
s_add_u32 s37, s37, s38
buffer_load_dwordx4 v23, s[8:11], s37 offen sc1 lds
s_add_u32 m0, s39, 51200
s_add_u32 s37, s37, s38
buffer_load_dwordx4 v23, s[8:11], s37 offen sc1 lds
s_add_u32 m0, s39, 52224
s_add_u32 s37, s37, s38
buffer_load_dwordx4 v23, s[8:11], s37 offen sc1 lds
s_add_u32 m0, s39, 53248
s_add_u32 s37, s37, s38
buffer_load_dwordx4 v23, s[8:11], s37 offen sc1 lds
s_add_u32 m0, s39, 54272
s_add_u32 s37, s37, s38
buffer_load_dwordx4 v23, s[8:11], s37 offen sc1 lds
s_add_u32 m0, s39, 55296
s_add_u32 s37, s37, s38
buffer_load_dwordx4 v23, s[8:11], s37 offen sc1 lds
s_add_u32 m0, s39, 56320
s_add_u32 s37, s37, s38
buffer_load_dwordx4 v23, s[8:11], s37 offen sc1 lds
s_lshl_b32 s43, s35, 8
s_cmp_eq_u32 s51, 1
s_cselect_b32 s8, s4, s6
s_cselect_b32 s9, s5, s7
s_sub_u32 s10, 7340032, s43
s_lshl_b32 s44, s34, 18
s_add_u32 s44, s44, 4194304
s_movk_i32 s38, 28672
s_cmp_eq_u32 s51, 0
s_cselect_b32 s8, s32, s8
s_cselect_b32 s9, s33, s9
s_cselect_b32 s10, 262144, s10
s_cselect_b32 s43, s44, s43
s_cselect_b32 s38, 1024, s38
s_cselect_b32 s45, 0, -1
s_add_u32 s8, s8, s43
s_addc_u32 s9, s9, 0
s_mov_b32 s11, 0x20000
s_lshl_b32 s40, s38, 4
s_add_u32 s42, s35, 15
s_lshl_b32 s39, s51, 14
v_lshrrev_b32 v19, 4, v1
v_lshlrev_b32 v20, 5, v19
v_mul_u32_u24 v19, 6912, v19
v_and_b32 v19, s45, v19
v_and_b32 v20, s45, v20
v_lshlrev_b32 v21, 4, v1
v_xor_b32 v21, v21, v20
v_add_u32 v22, v21, v19
s_and_b32 s45, s45, 128
v_xor_b32 v23, s45, v22
s_waitcnt vmcnt(16)
s_barrier
s_waitcnt vmcnt(8)
s_barrier
s_waitcnt vmcnt(0)
s_barrier
s_barrier
s_barrier
s_add_u32 s42, s42, 3
s_add_u32 s43, s34, 16
s_lshl_b32 s43, s43, 7
v_mov_b32 v8, s43
v_mov_b32 v10, 16
buffer_load_dword v9, v8, s[56:59], 0 offen sc1
s_mov_b32 s41, 0x10000
Lpoll_42:
s_waitcnt vmcnt(0)
Lpf_44:
v_cmp_ne_u32 vcc, v10, v9
s_nop 4
s_cbranch_vccz Lpok_43
buffer_load_dword v9, v8, s[56:59], 0 offen sc1
s_sub_u32 s41, s41, 1
s_cmp_lg_u32 s41, 0
s_cbranch_scc1 Lpoll_42
s_waitcnt vmcnt(0)
Lpok_43:
s_branch LP3_35
Lp_37:
s_add_u32 s42, s35, 2
s_waitcnt lgkmcnt(0)
s_barrier
s_barrier
s_add_u32 m0, s54, 16384
s_add_u32 s43, s30, 0
buffer_load_dwordx4 v21, s[12:15], s43 offen sc1 lds
s_add_u32 m0, s54, 17408
s_add_u32 s43, s30, 1024
buffer_load_dwordx4 v21, s[12:15], s43 offen sc1 lds
s_add_u32 m0, s54, 32768
s_add_u32 s43, s31, 0
buffer_load_dwordx4 v21, s[12:15], s43 offen sc1 lds
s_add_u32 m0, s54, 33792
s_add_u32 s43, s31, 1024
buffer_load_dwordx4 v21, s[12:15], s43 offen sc1 lds
s_add_u32 s42, s42, 1
s_and_b32 s42, s42, 15
s_add_u32 m0, s39, 49152
s_lshl_b32 s37, s42, 14
buffer_load_dwordx4 v23, s[8:11], s37 offen sc1 lds
s_add_u32 m0, s39, 50176
s_add_u32 s37, s37, s38
buffer_load_dwordx4 v23, s[8:11], s37 offen sc1 lds
s_add_u32 m0, s39, 51200
s_add_u32 s37, s37, s38
buffer_load_dwordx4 v23, s[8:11], s37 offen sc1 lds
s_add_u32 m0, s39, 52224
s_add_u32 s37, s37, s38
buffer_load_dwordx4 v23, s[8:11], s37 offen sc1 lds
s_add_u32 m0, s39, 53248
s_add_u32 s37, s37, s38
buffer_load_dwordx4 v23, s[8:11], s37 offen sc1 lds
s_add_u32 m0, s39, 54272
s_add_u32 s37, s37, s38
buffer_load_dwordx4 v23, s[8:11], s37 offen sc1 lds
s_add_u32 m0, s39, 55296
s_add_u32 s37, s37, s38
buffer_load_dwordx4 v23, s[8:11], s37 offen sc1 lds
s_add_u32 m0, s39, 56320
s_add_u32 s37, s37, s38
buffer_load_dwordx4 v23, s[8:11], s37 offen sc1 lds
s_add_u32 s42, s42, 1
s_and_b32 s42, s42, 15
s_add_u32 m0, s39, 0
s_lshl_b32 s37, s42, 14
buffer_load_dwordx4 v23, s[8:11], s37 offen sc1 lds
s_add_u32 m0, s39, 1024
s_add_u32 s37, s37, s38
buffer_load_dwordx4 v23, s[8:11], s37 offen sc1 lds
s_add_u32 m0, s39, 2048
s_add_u32 s37, s37, s38
buffer_load_dwordx4 v23, s[8:11], s37 offen sc1 lds
s_add_u32 m0, s39, 3072
s_add_u32 s37, s37, s38
buffer_load_dwordx4 v23, s[8:11], s37 offen sc1 lds
s_add_u32 m0, s39, 4096
s_add_u32 s37, s37, s38
buffer_load_dwordx4 v23, s[8:11], s37 offen sc1 lds
s_add_u32 m0, s39, 5120
s_add_u32 s37, s37, s38
buffer_load_dwordx4 v23, s[8:11], s37 offen sc1 lds
s_add_u32 m0, s39, 6144
s_add_u32 s37, s37, s38
buffer_load_dwordx4 v23, s[8:11], s37 offen sc1 lds
s_add_u32 m0, s39, 7168
s_add_u32 s37, s37, s38
buffer_load_dwordx4 v23, s[8:11], s37 offen sc1 lds
s_waitcnt vmcnt(18)
s_barrier
s_waitcnt vmcnt(16)
s_barrier
s_add_u32 s42, s42, 1
s_and_b32 s42, s42, 15
s_add_u32 m0, s39, 16384
s_lshl_b32 s37, s42, 14
buffer_load_dwordx4 v23, s[8:11], s37 offen sc1 lds
s_add_u32 m0, s39, 17408
s_add_u32 s37, s37, s38
buffer_load_dwordx4 v23, s[8:11], s37 offen sc1 lds
s_add_u32 m0, s39, 18432
s_add_u32 s37, s37, s38
buffer_load_dwordx4 v23, s[8:11], s37 offen sc1 lds
s_add_u32 m0, s39, 19456
s_add_u32 s37, s37, s38
buffer_load_dwordx4 v23, s[8:11], s37 offen sc1 lds
s_add_u32 m0, s39, 20480
s_add_u32 s37, s37, s38
buffer_load_dwordx4 v23, s[8:11], s37 offen sc1 lds
s_add_u32 m0, s39, 21504
s_add_u32 s37, s37, s38
buffer_load_dwordx4 v23, s[8:11], s37 offen sc1 lds
s_add_u32 m0, s39, 22528
s_add_u32 s37, s37, s38
buffer_load_dwordx4 v23, s[8:11], s37 offen sc1 lds
s_add_u32 m0, s39, 23552
s_add_u32 s37, s37, s38
buffer_load_dwordx4 v23, s[8:11], s37 offen sc1 lds
s_waitcnt vmcnt(16)
s_barrier
s_add_u32 s42, s42, 1
s_and_b32 s42, s42, 15
s_add_u32 m0, s39, 32768
s_lshl_b32 s37, s42, 14
buffer_load_dwordx4 v23, s[8:11], s37 offen sc1 lds
s_add_u32 m0, s39, 33792
s_add_u32 s37, s37, s38
buffer_load_dwordx4 v23, s[8:11], s37 offen sc1 lds
s_add_u32 m0, s39, 34816
s_add_u32 s37, s37, s38
buffer_load_dwordx4 v23, s[8:11], s37 offen sc1 lds
s_add_u32 m0, s39, 35840
s_add_u32 s37, s37, s38
buffer_load_dwordx4 v23, s[8:11], s37 offen sc1 lds
s_add_u32 m0, s39, 36864
s_add_u32 s37, s37, s38
buffer_load_dwordx4 v23, s[8:11], s37 offen sc1 lds
s_add_u32 m0, s39, 37888
s_add_u32 s37, s37, s38
buffer_load_dwordx4 v23, s[8:11], s37 offen sc1 lds
s_add_u32 m0, s39, 38912
s_add_u32 s37, s37, s38
buffer_load_dwordx4 v23, s[8:11], s37 offen sc1 lds
s_add_u32 m0, s39, 39936
s_add_u32 s37, s37, s38
buffer_load_dwordx4 v23, s[8:11], s37 offen sc1 lds
s_waitcnt vmcnt(16)
s_barrier
s_add_u32 s42, s42, 1
s_and_b32 s42, s42, 15
s_add_u32 m0, s39, 49152
s_lshl_b32 s37, s42, 14
buffer_load_dwordx4 v23, s[8:11], s37 offen sc1 lds
s_add_u32 m0, s39, 50176
s_add_u32 s37, s37, s38
buffer_load_dwordx4 v23, s[8:11], s37 offen sc1 lds
s_add_u32 m0, s39, 51200
s_add_u32 s37, s37, s38
buffer_load_dwordx4 v23, s[8:11], s37 offen sc1 lds
s_add_u32 m0, s39, 52224
s_add_u32 s37, s37, s38
buffer_load_dwordx4 v23, s[8:11], s37 offen sc1 lds
s_add_u32 m0, s39, 53248
s_add_u32 s37, s37, s38
buffer_load_dwordx4 v23, s[8:11], s37 offen sc1 lds
s_add_u32 m0, s39, 54272
s_add_u32 s37, s37, s38
buffer_load_dwordx4 v23, s[8:11], s37 offen sc1 lds
s_add_u32 m0, s39, 55296
s_add_u32 s37, s37, s38
buffer_load_dwordx4 v23, s[8:11], s37 offen sc1 lds
s_add_u32 m0, s39, 56320
s_add_u32 s37, s37, s38
buffer_load_dwordx4 v23, s[8:11], s37 offen sc1 lds
s_waitcnt vmcnt(16)
s_barrier
s_add_u32 s42, s42, 1
s_and_b32 s42, s42, 15
s_add_u32 m0, s39, 0
s_lshl_b32 s37, s42, 14
buffer_load_dwordx4 v23, s[8:11], s37 offen sc1 lds
s_add_u32 m0, s39, 1024
s_add_u32 s37, s37, s38
buffer_load_dwordx4 v23, s[8:11], s37 offen sc1 lds
s_add_u32 m0, s39, 2048
s_add_u32 s37, s37, s38
buffer_load_dwordx4 v23, s[8:11], s37 offen sc1 lds
s_add_u32 m0, s39, 3072
s_add_u32 s37, s37, s38
buffer_load_dwordx4 v23, s[8:11], s37 offen sc1 lds
s_add_u32 m0, s39, 4096
s_add_u32 s37, s37, s38
buffer_load_dwordx4 v23, s[8:11], s37 offen sc1 lds
s_add_u32 m0, s39, 5120
s_add_u32 s37, s37, s38
buffer_load_dwordx4 v23, s[8:11], s37 offen sc1 lds
s_add_u32 m0, s39, 6144
s_add_u32 s37, s37, s38
buffer_load_dwordx4 v23, s[8:11], s37 offen sc1 lds
s_add_u32 m0, s39, 7168
s_add_u32 s37, s37, s38
buffer_load_dwordx4 v23, s[8:11], s37 offen sc1 lds
s_waitcnt vmcnt(16)
s_barrier
s_add_u32 s42, s42, 1
s_and_b32 s42, s42, 15
s_add_u32 m0, s39, 16384
s_lshl_b32 s37, s42, 14
buffer_load_dwordx4 v23, s[8:11], s37 offen sc1 lds
s_add_u32 m0, s39, 17408
s_add_u32 s37, s37, s38
buffer_load_dwordx4 v23, s[8:11], s37 offen sc1 lds
s_add_u32 m0, s39, 18432
s_add_u32 s37, s37, s38
buffer_load_dwordx4 v23, s[8:11], s37 offen sc1 lds
s_add_u32 m0, s39, 19456
s_add_u32 s37, s37, s38
buffer_load_dwordx4 v23, s[8:11], s37 offen sc1 lds
s_add_u32 m0, s39, 20480
s_add_u32 s37, s37, s38
buffer_load_dwordx4 v23, s[8:11], s37 offen sc1 lds
s_add_u32 m0, s39, 21504
s_add_u32 s37, s37, s38
buffer_load_dwordx4 v23, s[8:11], s37 offen sc1 lds
s_add_u32 m0, s39, 22528
s_add_u32 s37, s37, s38
buffer_load_dwordx4 v23, s[8:11], s37 offen sc1 lds
s_add_u32 m0, s39, 23552
s_add_u32 s37, s37, s38
buffer_load_dwordx4 v23, s[8:11], s37 offen sc1 lds
s_waitcnt vmcnt(16)
s_barrier
s_add_u32 s42, s42, 1
s_and_b32 s42, s42, 15
s_add_u32 m0, s39, 32768
s_lshl_b32 s37, s42, 14
buffer_load_dwordx4 v23, s[8:11], s37 offen sc1 lds
s_add_u32 m0, s39, 33792
s_add_u32 s37, s37, s38
buffer_load_dwordx4 v23, s[8:11], s37 offen sc1 lds
s_add_u32 m0, s39, 34816
s_add_u32 s37, s37, s38
buffer_load_dwordx4 v23, s[8:11], s37 offen sc1 lds
s_add_u32 m0, s39, 35840
s_add_u32 s37, s37, s38
buffer_load_dwordx4 v23, s[8:11], s37 offen sc1 lds
s_add_u32 m0, s39, 36864
s_add_u32 s37, s37, s38
buffer_load_dwordx4 v23, s[8:11], s37 offen sc1 lds
s_add_u32 m0, s39, 37888
s_add_u32 s37, s37, s38
buffer_load_dwordx4 v23, s[8:11], s37 offen sc1 lds
s_add_u32 m0, s39, 38912
s_add_u32 s37, s37, s38
buffer_load_dwordx4 v23, s[8:11], s37 offen sc1 lds
s_add_u32 m0, s39, 39936
s_add_u32 s37, s37, s38
buffer_load_dwordx4 v23, s[8:11], s37 offen sc1 lds
s_waitcnt vmcnt(16)
s_barrier
s_add_u32 s42, s42, 1
s_and_b32 s42, s42, 15
s_add_u32 m0, s39, 49152
s_lshl_b32 s37, s42, 14
buffer_load_dwordx4 v23, s[8:11], s37 offen sc1 lds
s_add_u32 m0, s39, 50176
s_add_u32 s37, s37, s38
buffer_load_dwordx4 v23, s[8:11], s37 offen sc1 lds
s_add_u32 m0, s39, 51200
s_add_u32 s37, s37, s38
buffer_load_dwordx4 v23, s[8:11], s37 offen sc1 lds
s_add_u32 m0, s39, 52224
s_add_u32 s37, s37, s38
buffer_load_dwordx4 v23, s[8:11], s37 offen sc1 lds
s_add_u32 m0, s39, 53248
s_add_u32 s37, s37, s38
buffer_load_dwordx4 v23, s[8:11], s37 offen sc1 lds
s_add_u32 m0, s39, 54272
s_add_u32 s37, s37, s38
buffer_load_dwordx4 v23, s[8:11], s37 offen sc1 lds
s_add_u32 m0, s39, 55296
s_add_u32 s37, s37, s38
buffer_load_dwordx4 v23, s[8:11], s37 offen sc1 lds
s_add_u32 m0, s39, 56320
s_add_u32 s37, s37, s38
buffer_load_dwordx4 v23, s[8:11], s37 offen sc1 lds
s_waitcnt vmcnt(16)
s_barrier
s_add_u32 s42, s42, 1
s_and_b32 s42, s42, 15
s_add_u32 m0, s39, 0
s_lshl_b32 s37, s42, 14
buffer_load_dwordx4 v23, s[8:11], s37 offen sc1 lds
s_add_u32 m0, s39, 1024
s_add_u32 s37, s37, s38
buffer_load_dwordx4 v23, s[8:11], s37 offen sc1 lds
s_add_u32 m0, s39, 2048
s_add_u32 s37, s37, s38
buffer_load_dwordx4 v23, s[8:11], s37 offen sc1 lds
s_add_u32 m0, s39, 3072
s_add_u32 s37, s37, s38
buffer_load_dwordx4 v23, s[8:11], s37 offen sc1 lds
s_add_u32 m0, s39, 4096
s_add_u32 s37, s37, s38
buffer_load_dwordx4 v23, s[8:11], s37 offen sc1 lds
s_add_u32 m0, s39, 5120
s_add_u32 s37, s37, s38
buffer_load_dwordx4 v23, s[8:11], s37 offen sc1 lds
s_add_u32 m0, s39, 6144
s_add_u32 s37, s37, s38
buffer_load_dwordx4 v23, s[8:11], s37 offen sc1 lds
s_add_u32 m0, s39, 7168
s_add_u32 s37, s37, s38
buffer_load_dwordx4 v23, s[8:11], s37 offen sc1 lds
s_waitcnt vmcnt(16)
s_barrier
s_add_u32 s42, s42, 1
s_and_b32 s42, s42, 15
s_add_u32 m0, s39, 16384
s_lshl_b32 s37, s42, 14
buffer_load_dwordx4 v23, s[8:11], s37 offen sc1 lds
s_add_u32 m0, s39, 17408
s_add_u32 s37, s37, s38
buffer_load_dwordx4 v23, s[8:11], s37 offen sc1 lds
s_add_u32 m0, s39, 18432
s_add_u32 s37, s37, s38
buffer_load_dwordx4 v23, s[8:11], s37 offen sc1 lds
s_add_u32 m0, s39, 19456
s_add_u32 s37, s37, s38
buffer_load_dwordx4 v23, s[8:11], s37 offen sc1 lds
s_add_u32 m0, s39, 20480
s_add_u32 s37, s37, s38
buffer_load_dwordx4 v23, s[8:11], s37 offen sc1 lds
s_add_u32 m0, s39, 21504
s_add_u32 s37, s37, s38
buffer_load_dwordx4 v23, s[8:11], s37 offen sc1 lds
s_add_u32 m0, s39, 22528
s_add_u32 s37, s37, s38
buffer_load_dwordx4 v23, s[8:11], s37 offen sc1 lds
s_add_u32 m0, s39, 23552
s_add_u32 s37, s37, s38
buffer_load_dwordx4 v23, s[8:11], s37 offen sc1 lds
s_waitcnt vmcnt(16)
s_barrier
s_add_u32 s42, s42, 1
s_and_b32 s42, s42, 15
s_add_u32 m0, s39, 32768
s_lshl_b32 s37, s42, 14
buffer_load_dwordx4 v23, s[8:11], s37 offen sc1 lds
s_add_u32 m0, s39, 33792
s_add_u32 s37, s37, s38
buffer_load_dwordx4 v23, s[8:11], s37 offen sc1 lds
s_add_u32 m0, s39, 34816
s_add_u32 s37, s37, s38
buffer_load_dwordx4 v23, s[8:11], s37 offen sc1 lds
s_add_u32 m0, s39, 35840
s_add_u32 s37, s37, s38
buffer_load_dwordx4 v23, s[8:11], s37 offen sc1 lds
s_add_u32 m0, s39, 36864
s_add_u32 s37, s37, s38
buffer_load_dwordx4 v23, s[8:11], s37 offen sc1 lds
s_add_u32 m0, s39, 37888
s_add_u32 s37, s37, s38
buffer_load_dwordx4 v23, s[8:11], s37 offen sc1 lds
s_add_u32 m0, s39, 38912
s_add_u32 s37, s37, s38
buffer_load_dwordx4 v23, s[8:11], s37 offen sc1 lds
s_add_u32 m0, s39, 39936
s_add_u32 s37, s37, s38
buffer_load_dwordx4 v23, s[8:11], s37 offen sc1 lds
s_waitcnt vmcnt(16)
s_barrier
s_add_u32 s42, s42, 1
s_and_b32 s42, s42, 15
s_add_u32 m0, s39, 49152
s_lshl_b32 s37, s42, 14
buffer_load_dwordx4 v23, s[8:11], s37 offen sc1 lds
s_add_u32 m0, s39, 50176
s_add_u32 s37, s37, s38
buffer_load_dwordx4 v23, s[8:11], s37 offen sc1 lds
s_add_u32 m0, s39, 51200
s_add_u32 s37, s37, s38
buffer_load_dwordx4 v23, s[8:11], s37 offen sc1 lds
s_add_u32 m0, s39, 52224
s_add_u32 s37, s37, s38
buffer_load_dwordx4 v23, s[8:11], s37 offen sc1 lds
s_add_u32 m0, s39, 53248
s_add_u32 s37, s37, s38
buffer_load_dwordx4 v23, s[8:11], s37 offen sc1 lds
s_add_u32 m0, s39, 54272
s_add_u32 s37, s37, s38
buffer_load_dwordx4 v23, s[8:11], s37 offen sc1 lds
s_add_u32 m0, s39, 55296
s_add_u32 s37, s37, s38
buffer_load_dwordx4 v23, s[8:11], s37 offen sc1 lds
s_add_u32 m0, s39, 56320
s_add_u32 s37, s37, s38
buffer_load_dwordx4 v23, s[8:11], s37 offen sc1 lds
s_lshl_b32 s43, s35, 8
s_cmp_eq_u32 s51, 1
s_cselect_b32 s8, s4, s6
s_cselect_b32 s9, s5, s7
s_sub_u32 s10, 7340032, s43
s_lshl_b32 s44, s34, 18
s_add_u32 s44, s44, 4194304
s_movk_i32 s38, 28672
s_cmp_eq_u32 s51, 0
s_cselect_b32 s8, s32, s8
s_cselect_b32 s9, s33, s9
s_cselect_b32 s10, 262144, s10
s_cselect_b32 s43, s44, s43
s_cselect_b32 s38, 1024, s38
s_cselect_b32 s45, 0, -1
s_add_u32 s8, s8, s43
s_addc_u32 s9, s9, 0
s_mov_b32 s11, 0x20000
s_lshl_b32 s40, s38, 4
s_add_u32 s42, s35, 15
s_lshl_b32 s39, s51, 14
v_lshrrev_b32 v19, 4, v1
v_lshlrev_b32 v20, 5, v19
v_mul_u32_u24 v19, 6912, v19
v_and_b32 v19, s45, v19
v_and_b32 v20, s45, v20
v_lshlrev_b32 v21, 4, v1
v_xor_b32 v21, v21, v20
v_add_u32 v22, v21, v19
s_and_b32 s45, s45, 128
v_xor_b32 v23, s45, v22
s_waitcnt vmcnt(16)
s_barrier
s_add_u32 s42, s42, 1
s_and_b32 s42, s42, 15
s_add_u32 m0, s39, 98304
s_mul_i32 s37, s42, s40
buffer_load_dwordx4 v22, s[8:11], s37 offen sc1 lds
s_add_u32 m0, s39, 99328
s_add_u32 s37, s37, s38
buffer_load_dwordx4 v23, s[8:11], s37 offen sc1 lds
s_add_u32 m0, s39, 100352
s_add_u32 s37, s37, s38
buffer_load_dwordx4 v22, s[8:11], s37 offen sc1 lds
s_add_u32 m0, s39, 101376
s_add_u32 s37, s37, s38
buffer_load_dwordx4 v23, s[8:11], s37 offen sc1 lds
s_add_u32 m0, s39, 102400
s_add_u32 s37, s37, s38
buffer_load_dwordx4 v22, s[8:11], s37 offen sc1 lds
s_add_u32 m0, s39, 103424
s_add_u32 s37, s37, s38
buffer_load_dwordx4 v23, s[8:11], s37 offen sc1 lds
s_add_u32 m0, s39, 104448
s_add_u32 s37, s37, s38
buffer_load_dwordx4 v22, s[8:11], s37 offen sc1 lds
s_add_u32 m0, s39, 105472
s_add_u32 s37, s37, s38
buffer_load_dwordx4 v23, s[8:11], s37 offen sc1 lds
s_add_u32 m0, s39, 106496
s_add_u32 s37, s37, s38
buffer_load_dwordx4 v22, s[8:11], s37 offen sc1 lds
s_add_u32 m0, s39, 107520
s_add_u32 s37, s37, s38
buffer_load_dwordx4 v23, s[8:11], s37 offen sc1 lds
s_add_u32 m0, s39, 108544
s_add_u32 s37, s37, s38
buffer_load_dwordx4 v22, s[8:11], s37 offen sc1 lds
s_add_u32 m0, s39, 109568
s_add_u32 s37, s37, s38
buffer_load_dwordx4 v23, s[8:11], s37 offen sc1 lds
s_add_u32 m0, s39, 110592
s_add_u32 s37, s37, s38
buffer_load_dwordx4 v22, s[8:11], s37 offen sc1 lds
s_add_u32 m0, s39, 111616
s_add_u32 s37, s37, s38
buffer_load_dwordx4 v23, s[8:11], s37 offen sc1 lds
s_add_u32 m0, s39, 112640
s_add_u32 s37, s37, s38
buffer_load_dwordx4 v22, s[8:11], s37 offen sc1 lds
s_add_u32 m0, s39, 113664
s_add_u32 s37, s37, s38
buffer_load_dwordx4 v23, s[8:11], s37 offen sc1 lds
s_waitcnt vmcnt(24)
s_barrier
s_waitcnt vmcnt(16)
s_barrier
s_add_u32 s42, s42, 1
s_and_b32 s42, s42, 15
s_add_u32 m0, s39, 0
s_mul_i32 s37, s42, s40
buffer_load_dwordx4 v22, s[8:11], s37 offen sc1 lds
s_add_u32 m0, s39, 1024
s_add_u32 s37, s37, s38
buffer_load_dwordx4 v23, s[8:11], s37 offen sc1 lds
s_add_u32 m0, s39, 2048
s_add_u32 s37, s37, s38
buffer_load_dwordx4 v22, s[8:11], s37 offen sc1 lds
s_add_u32 m0, s39, 3072
s_add_u32 s37, s37, s38
buffer_load_dwordx4 v23, s[8:11], s37 offen sc1 lds
s_add_u32 m0, s39, 4096
s_add_u32 s37, s37, s38
buffer_load_dwordx4 v22, s[8:11], s37 offen sc1 lds
s_add_u32 m0, s39, 5120
s_add_u32 s37, s37, s38
buffer_load_dwordx4 v23, s[8:11], s37 offen sc1 lds
s_add_u32 m0, s39, 6144
s_add_u32 s37, s37, s38
buffer_load_dwordx4 v22, s[8:11], s37 offen sc1 lds
s_add_u32 m0, s39, 7168
s_add_u32 s37, s37, s38
buffer_load_dwordx4 v23, s[8:11], s37 offen sc1 lds
s_add_u32 m0, s39, 8192
s_add_u32 s37, s37, s38
buffer_load_dwordx4 v22, s[8:11], s37 offen sc1 lds
s_add_u32 m0, s39, 9216
s_add_u32 s37, s37, s38
buffer_load_dwordx4 v23, s[8:11], s37 offen sc1 lds
s_add_u32 m0, s39, 10240
s_add_u32 s37, s37, s38
buffer_load_dwordx4 v22, s[8:11], s37 offen sc1 lds
s_add_u32 m0, s39, 11264
s_add_u32 s37, s37, s38
buffer_load_dwordx4 v23, s[8:11], s37 offen sc1 lds
s_add_u32 m0, s39, 12288
s_add_u32 s37, s37, s38
buffer_load_dwordx4 v22, s[8:11], s37 offen sc1 lds
s_add_u32 m0, s39, 13312
s_add_u32 s37, s37, s38
buffer_load_dwordx4 v23, s[8:11], s37 offen sc1 lds
s_add_u32 m0, s39, 14336
s_add_u32 s37, s37, s38
buffer_load_dwordx4 v22, s[8:11], s37 offen sc1 lds
s_add_u32 m0, s39, 15360
s_add_u32 s37, s37, s38
buffer_load_dwordx4 v23, s[8:11], s37 offen sc1 lds
s_barrier
s_waitcnt vmcnt(16)
s_barrier
s_add_u32 s42, s42, 1
s_and_b32 s42, s42, 15
s_add_u32 m0, s39, 49152
s_mul_i32 s37, s42, s40
buffer_load_dwordx4 v22, s[8:11], s37 offen sc1 lds
s_add_u32 m0, s39, 50176
s_add_u32 s37, s37, s38
buffer_load_dwordx4 v23, s[8:11], s37 offen sc1 lds
s_add_u32 m0, s39, 51200
s_add_u32 s37, s37, s38
buffer_load_dwordx4 v22, s[8:11], s37 offen sc1 lds
s_add_u32 m0, s39, 52224
s_add_u32 s37, s37, s38
buffer_load_dwordx4 v23, s[8:11], s37 offen sc1 lds
s_add_u32 m0, s39, 53248
s_add_u32 s37, s37, s38
buffer_load_dwordx4 v22, s[8:11], s37 offen sc1 lds
s_add_u32 m0, s39, 54272
s_add_u32 s37, s37, s38
buffer_load_dwordx4 v23, s[8:11], s37 offen sc1 lds
s_add_u32 m0, s39, 55296
s_add_u32 s37, s37, s38
buffer_load_dwordx4 v22, s[8:11], s37 offen sc1 lds
s_add_u32 m0, s39, 56320
s_add_u32 s37, s37, s38
buffer_load_dwordx4 v23, s[8:11], s37 offen sc1 lds
s_add_u32 m0, s39, 57344
s_add_u32 s37, s37, s38
buffer_load_dwordx4 v22, s[8:11], s37 offen sc1 lds
s_add_u32 m0, s39, 58368
s_add_u32 s37, s37, s38
buffer_load_dwordx4 v23, s[8:11], s37 offen sc1 lds
s_add_u32 m0, s39, 59392
s_add_u32 s37, s37, s38
buffer_load_dwordx4 v22, s[8:11], s37 offen sc1 lds
s_add_u32 m0, s39, 60416
s_add_u32 s37, s37, s38
buffer_load_dwordx4 v23, s[8:11], s37 offen sc1 lds
s_add_u32 m0, s39, 61440
s_add_u32 s37, s37, s38
buffer_load_dwordx4 v22, s[8:11], s37 offen sc1 lds
s_add_u32 m0, s39, 62464
s_add_u32 s37, s37, s38
buffer_load_dwordx4 v23, s[8:11], s37 offen sc1 lds
s_add_u32 m0, s39, 63488
s_add_u32 s37, s37, s38
buffer_load_dwordx4 v22, s[8:11], s37 offen sc1 lds
s_add_u32 m0, s39, 64512
s_add_u32 s37, s37, s38
buffer_load_dwordx4 v23, s[8:11], s37 offen sc1 lds
s_branch LP3_35
Lp_38:
s_add_u32 s42, s35, 15
s_add_u32 s42, s42, 1
s_and_b32 s42, s42, 15
s_add_u32 m0, s39, 49152
s_lshl_b32 s37, s42, 17
buffer_load_dwordx4 v23, s[8:11], s37 offen sc1 lds
s_add_u32 m0, s39, 50176
s_add_u32 s37, s37, s38
buffer_load_dwordx4 v23, s[8:11], s37 offen sc1 lds
s_add_u32 m0, s39, 51200
s_add_u32 s37, s37, s38
buffer_load_dwordx4 v23, s[8:11], s37 offen sc1 lds
s_add_u32 m0, s39, 52224
s_add_u32 s37, s37, s38
buffer_load_dwordx4 v23, s[8:11], s37 offen sc1 lds
s_add_u32 m0, s39, 53248
s_add_u32 s37, s37, s38
buffer_load_dwordx4 v23, s[8:11], s37 offen sc1 lds
s_add_u32 m0, s39, 54272
s_add_u32 s37, s37, s38
buffer_load_dwordx4 v23, s[8:11], s37 offen sc1 lds
s_add_u32 m0, s39, 55296
s_add_u32 s37, s37, s38
buffer_load_dwordx4 v23, s[8:11], s37 offen sc1 lds
s_add_u32 m0, s39, 56320
s_add_u32 s37, s37, s38
buffer_load_dwordx4 v23, s[8:11], s37 offen sc1 lds
s_add_u32 s42, s42, 1
s_and_b32 s42, s42, 15
s_add_u32 m0, s39, 57344
s_lshl_b32 s37, s42, 17
buffer_load_dwordx4 v23, s[8:11], s37 offen sc1 lds
s_add_u32 m0, s39, 58368
s_add_u32 s37, s37, s38
buffer_load_dwordx4 v23, s[8:11], s37 offen sc1 lds
s_add_u32 m0, s39, 59392
s_add_u32 s37, s37, s38
buffer_load_dwordx4 v23, s[8:11], s37 offen sc1 lds
s_add_u32 m0, s39, 60416
s_add_u32 s37, s37, s38
buffer_load_dwordx4 v23, s[8:11], s37 offen sc1 lds
s_add_u32 m0, s39, 61440
s_add_u32 s37, s37, s38
buffer_load_dwordx4 v23, s[8:11], s37 offen sc1 lds
s_add_u32 m0, s39, 62464
s_add_u32 s37, s37, s38
buffer_load_dwordx4 v23, s[8:11], s37 offen sc1 lds
s_add_u32 m0, s39, 63488
s_add_u32 s37, s37, s38
buffer_load_dwordx4 v23, s[8:11], s37 offen sc1 lds
s_add_u32 m0, s39, 64512
s_add_u32 s37, s37, s38
buffer_load_dwordx4 v23, s[8:11], s37 offen sc1 lds
s_add_u32 s42, s42, 1
s_and_b32 s42, s42, 15
s_add_u32 m0, s39, 65536
s_lshl_b32 s37, s42, 17
buffer_load_dwordx4 v23, s[8:11], s37 offen sc1 lds
s_add_u32 m0, s39, 66560
s_add_u32 s37, s37, s38
buffer_load_dwordx4 v23, s[8:11], s37 offen sc1 lds
s_add_u32 m0, s39, 67584
s_add_u32 s37, s37, s38
buffer_load_dwordx4 v23, s[8:11], s37 offen sc1 lds
s_add_u32 m0, s39, 68608
s_add_u32 s37, s37, s38
buffer_load_dwordx4 v23, s[8:11], s37 offen sc1 lds
s_add_u32 m0, s39, 69632
s_add_u32 s37, s37, s38
buffer_load_dwordx4 v23, s[8:11], s37 offen sc1 lds
s_add_u32 m0, s39, 70656
s_add_u32 s37, s37, s38
buffer_load_dwordx4 v23, s[8:11], s37 offen sc1 lds
s_add_u32 m0, s39, 71680
s_add_u32 s37, s37, s38
buffer_load_dwordx4 v23, s[8:11], s37 offen sc1 lds
s_add_u32 m0, s39, 72704
s_add_u32 s37, s37, s38
buffer_load_dwordx4 v23, s[8:11], s37 offen sc1 lds
s_add_u32 s42, s42, 1
s_and_b32 s42, s42, 15
s_add_u32 m0, s39, 73728
s_lshl_b32 s37, s42, 17
buffer_load_dwordx4 v23, s[8:11], s37 offen sc1 lds
s_add_u32 m0, s39, 74752
s_add_u32 s37, s37, s38
buffer_load_dwordx4 v23, s[8:11], s37 offen sc1 lds
s_add_u32 m0, s39, 75776
s_add_u32 s37, s37, s38
buffer_load_dwordx4 v23, s[8:11], s37 offen sc1 lds
s_add_u32 m0, s39, 76800
s_add_u32 s37, s37, s38
buffer_load_dwordx4 v23, s[8:11], s37 offen sc1 lds
s_add_u32 m0, s39, 77824
s_add_u32 s37, s37, s38
buffer_load_dwordx4 v23, s[8:11], s37 offen sc1 lds
s_add_u32 m0, s39, 78848
s_add_u32 s37, s37, s38
buffer_load_dwordx4 v23, s[8:11], s37 offen sc1 lds
s_add_u32 m0, s39, 79872
s_add_u32 s37, s37, s38
buffer_load_dwordx4 v23, s[8:11], s37 offen sc1 lds
s_add_u32 m0, s39, 80896
s_add_u32 s37, s37, s38
buffer_load_dwordx4 v23, s[8:11], s37 offen sc1 lds
s_add_u32 s42, s42, 1
s_and_b32 s42, s42, 15
s_add_u32 m0, s39, 81920
s_lshl_b32 s37, s42, 17
buffer_load_dwordx4 v23, s[8:11], s37 offen sc1 lds
s_add_u32 m0, s39, 82944
s_add_u32 s37, s37, s38
buffer_load_dwordx4 v23, s[8:11], s37 offen sc1 lds
s_add_u32 m0, s39, 83968
s_add_u32 s37, s37, s38
buffer_load_dwordx4 v23, s[8:11], s37 offen sc1 lds
s_add_u32 m0, s39, 84992
s_add_u32 s37, s37, s38
buffer_load_dwordx4 v23, s[8:11], s37 offen sc1 lds
s_add_u32 m0, s39, 86016
s_add_u32 s37, s37, s38
buffer_load_dwordx4 v23, s[8:11], s37 offen sc1 lds
s_add_u32 m0, s39, 87040
s_add_u32 s37, s37, s38
buffer_load_dwordx4 v23, s[8:11], s37 offen sc1 lds
s_add_u32 m0, s39, 88064
s_add_u32 s37, s37, s38
buffer_load_dwordx4 v23, s[8:11], s37 offen sc1 lds
s_add_u32 m0, s39, 89088
s_add_u32 s37, s37, s38
buffer_load_dwordx4 v23, s[8:11], s37 offen sc1 lds
s_add_u32 s42, s42, 1
s_and_b32 s42, s42, 15
s_add_u32 m0, s39, 90112
s_lshl_b32 s37, s42, 17
buffer_load_dwordx4 v23, s[8:11], s37 offen sc1 lds
s_add_u32 m0, s39, 91136
s_add_u32 s37, s37, s38
buffer_load_dwordx4 v23, s[8:11], s37 offen sc1 lds
s_add_u32 m0, s39, 92160
s_add_u32 s37, s37, s38
buffer_load_dwordx4 v23, s[8:11], s37 offen sc1 lds
s_add_u32 m0, s39, 93184
s_add_u32 s37, s37, s38
buffer_load_dwordx4 v23, s[8:11], s37 offen sc1 lds
s_add_u32 m0, s39, 94208
s_add_u32 s37, s37, s38
buffer_load_dwordx4 v23, s[8:11], s37 offen sc1 lds
s_add_u32 m0, s39, 95232
s_add_u32 s37, s37, s38
buffer_load_dwordx4 v23, s[8:11], s37 offen sc1 lds
s_add_u32 m0, s39, 96256
s_add_u32 s37, s37, s38
buffer_load_dwordx4 v23, s[8:11], s37 offen sc1 lds
s_add_u32 m0, s39, 97280
s_add_u32 s37, s37, s38
buffer_load_dwordx4 v23, s[8:11], s37 offen sc1 lds
s_waitcnt vmcnt(40)
s_waitcnt lgkmcnt(0)
s_barrier
s_barrier
s_add_u32 m0, s54, 16384
s_add_u32 s43, s30, 0
buffer_load_dwordx4 v21, s[12:15], s43 offen sc1 lds
s_add_u32 m0, s54, 17408
s_add_u32 s43, s30, 1024
buffer_load_dwordx4 v21, s[12:15], s43 offen sc1 lds
s_add_u32 m0, s54, 32768
s_add_u32 s43, s31, 0
buffer_load_dwordx4 v21, s[12:15], s43 offen sc1 lds
s_add_u32 m0, s54, 33792
s_add_u32 s43, s31, 1024
buffer_load_dwordx4 v21, s[12:15], s43 offen sc1 lds
s_add_u32 s42, s42, 1
s_and_b32 s42, s42, 15
s_add_u32 m0, s39, 98304
s_lshl_b32 s37, s42, 17
buffer_load_dwordx4 v23, s[8:11], s37 offen sc1 lds
s_add_u32 m0, s39, 99328
s_add_u32 s37, s37, s38
buffer_load_dwordx4 v23, s[8:11], s37 offen sc1 lds
s_add_u32 m0, s39, 100352
s_add_u32 s37, s37, s38
buffer_load_dwordx4 v23, s[8:11], s37 offen sc1 lds
s_add_u32 m0, s39, 101376
s_add_u32 s37, s37, s38
buffer_load_dwordx4 v23, s[8:11], s37 offen sc1 lds
s_add_u32 m0, s39, 102400
s_add_u32 s37, s37, s38
buffer_load_dwordx4 v23, s[8:11], s37 offen sc1 lds
s_add_u32 m0, s39, 103424
s_add_u32 s37, s37, s38
buffer_load_dwordx4 v23, s[8:11], s37 offen sc1 lds
s_add_u32 m0, s39, 104448
s_add_u32 s37, s37, s38
buffer_load_dwordx4 v23, s[8:11], s37 offen sc1 lds
s_add_u32 m0, s39, 105472
s_add_u32 s37, s37, s38
buffer_load_dwordx4 v23, s[8:11], s37 offen sc1 lds
s_waitcnt vmcnt(10)
s_barrier
s_waitcnt vmcnt(8)
s_barrier
s_add_u32 s42, s42, 1
s_and_b32 s42, s42, 15
s_add_u32 m0, s39, 106496
s_lshl_b32 s37, s42, 17
buffer_load_dwordx4 v23, s[8:11], s37 offen sc1 lds
s_add_u32 m0, s39, 107520
s_add_u32 s37, s37, s38
buffer_load_dwordx4 v23, s[8:11], s37 offen sc1 lds
s_add_u32 m0, s39, 108544
s_add_u32 s37, s37, s38
buffer_load_dwordx4 v23, s[8:11], s37 offen sc1 lds
s_add_u32 m0, s39, 109568
s_add_u32 s37, s37, s38
buffer_load_dwordx4 v23, s[8:11], s37 offen sc1 lds
s_add_u32 m0, s39, 110592
s_add_u32 s37, s37, s38
buffer_load_dwordx4 v23, s[8:11], s37 offen sc1 lds
s_add_u32 m0, s39, 111616
s_add_u32 s37, s37, s38
buffer_load_dwordx4 v23, s[8:11], s37 offen sc1 lds
s_add_u32 m0, s39, 112640
s_add_u32 s37, s37, s38
buffer_load_dwordx4 v23, s[8:11], s37 offen sc1 lds
s_add_u32 m0, s39, 113664
s_add_u32 s37, s37, s38
buffer_load_dwordx4 v23, s[8:11], s37 offen sc1 lds
s_waitcnt vmcnt(36)
s_barrier
s_add_u32 s42, s42, 1
s_and_b32 s42, s42, 15
s_add_u32 m0, s39, 114688
s_lshl_b32 s37, s42, 17
buffer_load_dwordx4 v23, s[8:11], s37 offen sc1 lds
s_add_u32 m0, s39, 115712
s_add_u32 s37, s37, s38
buffer_load_dwordx4 v23, s[8:11], s37 offen sc1 lds
s_add_u32 m0, s39, 116736
s_add_u32 s37, s37, s38
buffer_load_dwordx4 v23, s[8:11], s37 offen sc1 lds
s_add_u32 m0, s39, 117760
s_add_u32 s37, s37, s38
buffer_load_dwordx4 v23, s[8:11], s37 offen sc1 lds
s_add_u32 m0, s39, 118784
s_add_u32 s37, s37, s38
buffer_load_dwordx4 v23, s[8:11], s37 offen sc1 lds
s_add_u32 m0, s39, 119808
s_add_u32 s37, s37, s38
buffer_load_dwordx4 v23, s[8:11], s37 offen sc1 lds
s_add_u32 m0, s39, 120832
s_add_u32 s37, s37, s38
buffer_load_dwordx4 v23, s[8:11], s37 offen sc1 lds
s_add_u32 m0, s39, 121856
s_add_u32 s37, s37, s38
buffer_load_dwordx4 v23, s[8:11], s37 offen sc1 lds
s_waitcnt vmcnt(36)
s_barrier
s_add_u32 s42, s42, 1
s_and_b32 s42, s42, 15
s_add_u32 m0, s39, 122880
s_lshl_b32 s37, s42, 17
buffer_load_dwordx4 v23, s[8:11], s37 offen sc1 lds
s_add_u32 m0, s39, 123904
s_add_u32 s37, s37, s38
buffer_load_dwordx4 v23, s[8:11], s37 offen sc1 lds
s_add_u32 m0, s39, 124928
s_add_u32 s37, s37, s38
buffer_load_dwordx4 v23, s[8:11], s37 offen sc1 lds
s_add_u32 m0, s39, 125952
s_add_u32 s37, s37, s38
buffer_load_dwordx4 v23, s[8:11], s37 offen sc1 lds
s_add_u32 m0, s39, 126976
s_add_u32 s37, s37, s38
buffer_load_dwordx4 v23, s[8:11], s37 offen sc1 lds
s_add_u32 m0, s39, 128000
s_add_u32 s37, s37, s38
buffer_load_dwordx4 v23, s[8:11], s37 offen sc1 lds
s_add_u32 m0, s39, 129024
s_add_u32 s37, s37, s38
buffer_load_dwordx4 v23, s[8:11], s37 offen sc1 lds
s_add_u32 m0, s39, 130048
s_add_u32 s37, s37, s38
buffer_load_dwordx4 v23, s[8:11], s37 offen sc1 lds
s_waitcnt vmcnt(36)
s_barrier
s_add_u32 s42, s42, 1
s_and_b32 s42, s42, 15
s_add_u32 m0, s39, 49152
s_lshl_b32 s37, s42, 17
buffer_load_dwordx4 v23, s[8:11], s37 offen sc1 lds
s_add_u32 m0, s39, 50176
s_add_u32 s37, s37, s38
buffer_load_dwordx4 v23, s[8:11], s37 offen sc1 lds
s_add_u32 m0, s39, 51200
s_add_u32 s37, s37, s38
buffer_load_dwordx4 v23, s[8:11], s37 offen sc1 lds
s_add_u32 m0, s39, 52224
s_add_u32 s37, s37, s38
buffer_load_dwordx4 v23, s[8:11], s37 offen sc1 lds
s_add_u32 m0, s39, 53248
s_add_u32 s37, s37, s38
buffer_load_dwordx4 v23, s[8:11], s37 offen sc1 lds
s_add_u32 m0, s39, 54272
s_add_u32 s37, s37, s38
buffer_load_dwordx4 v23, s[8:11], s37 offen sc1 lds
s_add_u32 m0, s39, 55296
s_add_u32 s37, s37, s38
buffer_load_dwordx4 v23, s[8:11], s37 offen sc1 lds
s_add_u32 m0, s39, 56320
s_add_u32 s37, s37, s38
buffer_load_dwordx4 v23, s[8:11], s37 offen sc1 lds
s_waitcnt vmcnt(32)
s_barrier
s_add_u32 s42, s42, 1
s_and_b32 s42, s42, 15
s_add_u32 m0, s39, 57344
s_lshl_b32 s37, s42, 17
buffer_load_dwordx4 v23, s[8:11], s37 offen sc1 lds
s_add_u32 m0, s39, 58368
s_add_u32 s37, s37, s38
buffer_load_dwordx4 v23, s[8:11], s37 offen sc1 lds
s_add_u32 m0, s39, 59392
s_add_u32 s37, s37, s38
buffer_load_dwordx4 v23, s[8:11], s37 offen sc1 lds
s_add_u32 m0, s39, 60416
s_add_u32 s37, s37, s38
buffer_load_dwordx4 v23, s[8:11], s37 offen sc1 lds
s_add_u32 m0, s39, 61440
s_add_u32 s37, s37, s38
buffer_load_dwordx4 v23, s[8:11], s37 offen sc1 lds
s_add_u32 m0, s39, 62464
s_add_u32 s37, s37, s38
buffer_load_dwordx4 v23, s[8:11], s37 offen sc1 lds
s_add_u32 m0, s39, 63488
s_add_u32 s37, s37, s38
buffer_load_dwordx4 v23, s[8:11], s37 offen sc1 lds
s_add_u32 m0, s39, 64512
s_add_u32 s37, s37, s38
buffer_load_dwordx4 v23, s[8:11], s37 offen sc1 lds
s_waitcnt vmcnt(32)
s_barrier
s_add_u32 s42, s42, 1
s_and_b32 s42, s42, 15
s_add_u32 m0, s39, 65536
s_lshl_b32 s37, s42, 17
buffer_load_dwordx4 v23, s[8:11], s37 offen sc1 lds
s_add_u32 m0, s39, 66560
s_add_u32 s37, s37, s38
buffer_load_dwordx4 v23, s[8:11], s37 offen sc1 lds
s_add_u32 m0, s39, 67584
s_add_u32 s37, s37, s38
buffer_load_dwordx4 v23, s[8:11], s37 offen sc1 lds
s_add_u32 m0, s39, 68608
s_add_u32 s37, s37, s38
buffer_load_dwordx4 v23, s[8:11], s37 offen sc1 lds
s_add_u32 m0, s39, 69632
s_add_u32 s37, s37, s38
buffer_load_dwordx4 v23, s[8:11], s37 offen sc1 lds
s_add_u32 m0, s39, 70656
s_add_u32 s37, s37, s38
buffer_load_dwordx4 v23, s[8:11], s37 offen sc1 lds
s_add_u32 m0, s39, 71680
s_add_u32 s37, s37, s38
buffer_load_dwordx4 v23, s[8:11], s37 offen sc1 lds
s_add_u32 m0, s39, 72704
s_add_u32 s37, s37, s38
buffer_load_dwordx4 v23, s[8:11], s37 offen sc1 lds
s_waitcnt vmcnt(32)
s_barrier
s_add_u32 s42, s42, 1
s_and_b32 s42, s42, 15
s_add_u32 m0, s39, 73728
s_lshl_b32 s37, s42, 17
buffer_load_dwordx4 v23, s[8:11], s37 offen sc1 lds
s_add_u32 m0, s39, 74752
s_add_u32 s37, s37, s38
buffer_load_dwordx4 v23, s[8:11], s37 offen sc1 lds
s_add_u32 m0, s39, 75776
s_add_u32 s37, s37, s38
buffer_load_dwordx4 v23, s[8:11], s37 offen sc1 lds
s_add_u32 m0, s39, 76800
s_add_u32 s37, s37, s38
buffer_load_dwordx4 v23, s[8:11], s37 offen sc1 lds
s_add_u32 m0, s39, 77824
s_add_u32 s37, s37, s38
buffer_load_dwordx4 v23, s[8:11], s37 offen sc1 lds
s_add_u32 m0, s39, 78848
s_add_u32 s37, s37, s38
buffer_load_dwordx4 v23, s[8:11], s37 offen sc1 lds
s_add_u32 m0, s39, 79872
s_add_u32 s37, s37, s38
buffer_load_dwordx4 v23, s[8:11], s37 offen sc1 lds
s_add_u32 m0, s39, 80896
s_add_u32 s37, s37, s38
buffer_load_dwordx4 v23, s[8:11], s37 offen sc1 lds
s_waitcnt vmcnt(32)
s_barrier
s_add_u32 s42, s42, 1
s_and_b32 s42, s42, 15
s_add_u32 m0, s39, 81920
s_lshl_b32 s37, s42, 17
buffer_load_dwordx4 v23, s[8:11], s37 offen sc1 lds
s_add_u32 m0, s39, 82944
s_add_u32 s37, s37, s38
buffer_load_dwordx4 v23, s[8:11], s37 offen sc1 lds
s_add_u32 m0, s39, 83968
s_add_u32 s37, s37, s38
buffer_load_dwordx4 v23, s[8:11], s37 offen sc1 lds
s_add_u32 m0, s39, 84992
s_add_u32 s37, s37, s38
buffer_load_dwordx4 v23, s[8:11], s37 offen sc1 lds
s_add_u32 m0, s39, 86016
s_add_u32 s37, s37, s38
buffer_load_dwordx4 v23, s[8:11], s37 offen sc1 lds
s_add_u32 m0, s39, 87040
s_add_u32 s37, s37, s38
buffer_load_dwordx4 v23, s[8:11], s37 offen sc1 lds
s_add_u32 m0, s39, 88064
s_add_u32 s37, s37, s38
buffer_load_dwordx4 v23, s[8:11], s37 offen sc1 lds
s_add_u32 m0, s39, 89088
s_add_u32 s37, s37, s38
buffer_load_dwordx4 v23, s[8:11], s37 offen sc1 lds
s_waitcnt vmcnt(32)
s_barrier
s_add_u32 s42, s42, 1
s_and_b32 s42, s42, 15
s_add_u32 m0, s39, 90112
s_lshl_b32 s37, s42, 17
buffer_load_dwordx4 v23, s[8:11], s37 offen sc1 lds
s_add_u32 m0, s39, 91136
s_add_u32 s37, s37, s38
buffer_load_dwordx4 v23, s[8:11], s37 offen sc1 lds
s_add_u32 m0, s39, 92160
s_add_u32 s37, s37, s38
buffer_load_dwordx4 v23, s[8:11], s37 offen sc1 lds
s_add_u32 m0, s39, 93184
s_add_u32 s37, s37, s38
buffer_load_dwordx4 v23, s[8:11], s37 offen sc1 lds
s_add_u32 m0, s39, 94208
s_add_u32 s37, s37, s38
buffer_load_dwordx4 v23, s[8:11], s37 offen sc1 lds
s_add_u32 m0, s39, 95232
s_add_u32 s37, s37, s38
buffer_load_dwordx4 v23, s[8:11], s37 offen sc1 lds
s_add_u32 m0, s39, 96256
s_add_u32 s37, s37, s38
buffer_load_dwordx4 v23, s[8:11], s37 offen sc1 lds
s_add_u32 m0, s39, 97280
s_add_u32 s37, s37, s38
buffer_load_dwordx4 v23, s[8:11], s37 offen sc1 lds
s_waitcnt vmcnt(32)
s_barrier
s_waitcnt vmcnt(24)
s_barrier
s_lshl_b32 s43, s35, 8
s_cmp_eq_u32 s51, 1
s_cselect_b32 s8, s4, s6
s_cselect_b32 s9, s5, s7
s_sub_u32 s10, 7340032, s43
s_lshl_b32 s44, s34, 18
s_add_u32 s44, s44, 4194304
s_movk_i32 s38, 28672
s_cmp_eq_u32 s51, 0
s_cselect_b32 s8, s32, s8
s_cselect_b32 s9, s33, s9
s_cselect_b32 s10, 262144, s10
s_cselect_b32 s43, s44, s43
s_cselect_b32 s38, 1024, s38
s_cselect_b32 s45, 0, -1
s_add_u32 s8, s8, s43
s_addc_u32 s9, s9, 0
s_mov_b32 s11, 0x20000
s_lshl_b32 s40, s38, 4
s_add_u32 s42, s35, 15
s_lshl_b32 s39, s51, 14
v_lshrrev_b32 v19, 4, v1
v_lshlrev_b32 v20, 5, v19
v_mul_u32_u24 v19, 6912, v19
v_and_b32 v19, s45, v19
v_and_b32 v20, s45, v20
v_lshlrev_b32 v21, 4, v1
v_xor_b32 v21, v21, v20
v_add_u32 v22, v21, v19
s_and_b32 s45, s45, 128
v_xor_b32 v23, s45, v22
s_waitcnt vmcnt(16)
s_barrier
s_add_u32 s42, s42, 1
s_and_b32 s42, s42, 15
s_add_u32 m0, s39, 98304
s_mul_i32 s37, s42, s40
buffer_load_dwordx4 v22, s[8:11], s37 offen sc1 lds
s_add_u32 m0, s39, 99328
s_add_u32 s37, s37, s38
buffer_load_dwordx4 v23, s[8:11], s37 offen sc1 lds
s_add_u32 m0, s39, 100352
s_add_u32 s37, s37, s38
buffer_load_dwordx4 v22, s[8:11], s37 offen sc1 lds
s_add_u32 m0, s39, 101376
s_add_u32 s37, s37, s38
buffer_load_dwordx4 v23, s[8:11], s37 offen sc1 lds
s_add_u32 m0, s39, 102400
s_add_u32 s37, s37, s38
buffer_load_dwordx4 v22, s[8:11], s37 offen sc1 lds
s_add_u32 m0, s39, 103424
s_add_u32 s37, s37, s38
buffer_load_dwordx4 v23, s[8:11], s37 offen sc1 lds
s_add_u32 m0, s39, 104448
s_add_u32 s37, s37, s38
buffer_load_dwordx4 v22, s[8:11], s37 offen sc1 lds
s_add_u32 m0, s39, 105472
s_add_u32 s37, s37, s38
buffer_load_dwordx4 v23, s[8:11], s37 offen sc1 lds
s_add_u32 m0, s39, 106496
s_add_u32 s37, s37, s38
buffer_load_dwordx4 v22, s[8:11], s37 offen sc1 lds
s_add_u32 m0, s39, 107520
s_add_u32 s37, s37, s38
buffer_load_dwordx4 v23, s[8:11], s37 offen sc1 lds
s_add_u32 m0, s39, 108544
s_add_u32 s37, s37, s38
buffer_load_dwordx4 v22, s[8:11], s37 offen sc1 lds
s_add_u32 m0, s39, 109568
s_add_u32 s37, s37, s38
buffer_load_dwordx4 v23, s[8:11], s37 offen sc1 lds
s_add_u32 m0, s39, 110592
s_add_u32 s37, s37, s38
buffer_load_dwordx4 v22, s[8:11], s37 offen sc1 lds
s_add_u32 m0, s39, 111616
s_add_u32 s37, s37, s38
buffer_load_dwordx4 v23, s[8:11], s37 offen sc1 lds
s_add_u32 m0, s39, 112640
s_add_u32 s37, s37, s38
buffer_load_dwordx4 v22, s[8:11], s37 offen sc1 lds
s_add_u32 m0, s39, 113664
s_add_u32 s37, s37, s38
buffer_load_dwordx4 v23, s[8:11], s37 offen sc1 lds
s_waitcnt vmcnt(24)
s_barrier
s_waitcnt vmcnt(16)
s_barrier
s_add_u32 s42, s42, 1
s_and_b32 s42, s42, 15
s_add_u32 m0, s39, 0
s_mul_i32 s37, s42, s40
buffer_load_dwordx4 v22, s[8:11], s37 offen sc1 lds
s_add_u32 m0, s39, 1024
s_add_u32 s37, s37, s38
buffer_load_dwordx4 v23, s[8:11], s37 offen sc1 lds
s_add_u32 m0, s39, 2048
s_add_u32 s37, s37, s38
buffer_load_dwordx4 v22, s[8:11], s37 offen sc1 lds
s_add_u32 m0, s39, 3072
s_add_u32 s37, s37, s38
buffer_load_dwordx4 v23, s[8:11], s37 offen sc1 lds
s_add_u32 m0, s39, 4096
s_add_u32 s37, s37, s38
buffer_load_dwordx4 v22, s[8:11], s37 offen sc1 lds
s_add_u32 m0, s39, 5120
s_add_u32 s37, s37, s38
buffer_load_dwordx4 v23, s[8:11], s37 offen sc1 lds
s_add_u32 m0, s39, 6144
s_add_u32 s37, s37, s38
buffer_load_dwordx4 v22, s[8:11], s37 offen sc1 lds
s_add_u32 m0, s39, 7168
s_add_u32 s37, s37, s38
buffer_load_dwordx4 v23, s[8:11], s37 offen sc1 lds
s_add_u32 m0, s39, 8192
s_add_u32 s37, s37, s38
buffer_load_dwordx4 v22, s[8:11], s37 offen sc1 lds
s_add_u32 m0, s39, 9216
s_add_u32 s37, s37, s38
buffer_load_dwordx4 v23, s[8:11], s37 offen sc1 lds
s_add_u32 m0, s39, 10240
s_add_u32 s37, s37, s38
buffer_load_dwordx4 v22, s[8:11], s37 offen sc1 lds
s_add_u32 m0, s39, 11264
s_add_u32 s37, s37, s38
buffer_load_dwordx4 v23, s[8:11], s37 offen sc1 lds
s_add_u32 m0, s39, 12288
s_add_u32 s37, s37, s38
buffer_load_dwordx4 v22, s[8:11], s37 offen sc1 lds
s_add_u32 m0, s39, 13312
s_add_u32 s37, s37, s38
buffer_load_dwordx4 v23, s[8:11], s37 offen sc1 lds
s_add_u32 m0, s39, 14336
s_add_u32 s37, s37, s38
buffer_load_dwordx4 v22, s[8:11], s37 offen sc1 lds
s_add_u32 m0, s39, 15360
s_add_u32 s37, s37, s38
buffer_load_dwordx4 v23, s[8:11], s37 offen sc1 lds
s_barrier
s_waitcnt vmcnt(16)
s_barrier
s_add_u32 s42, s42, 1
s_and_b32 s42, s42, 15
s_add_u32 m0, s39, 49152
s_mul_i32 s37, s42, s40
buffer_load_dwordx4 v22, s[8:11], s37 offen sc1 lds
s_add_u32 m0, s39, 50176
s_add_u32 s37, s37, s38
buffer_load_dwordx4 v23, s[8:11], s37 offen sc1 lds
s_add_u32 m0, s39, 51200
s_add_u32 s37, s37, s38
buffer_load_dwordx4 v22, s[8:11], s37 offen sc1 lds
s_add_u32 m0, s39, 52224
s_add_u32 s37, s37, s38
buffer_load_dwordx4 v23, s[8:11], s37 offen sc1 lds
s_add_u32 m0, s39, 53248
s_add_u32 s37, s37, s38
buffer_load_dwordx4 v22, s[8:11], s37 offen sc1 lds
s_add_u32 m0, s39, 54272
s_add_u32 s37, s37, s38
buffer_load_dwordx4 v23, s[8:11], s37 offen sc1 lds
s_add_u32 m0, s39, 55296
s_add_u32 s37, s37, s38
buffer_load_dwordx4 v22, s[8:11], s37 offen sc1 lds
s_add_u32 m0, s39, 56320
s_add_u32 s37, s37, s38
buffer_load_dwordx4 v23, s[8:11], s37 offen sc1 lds
s_add_u32 m0, s39, 57344
s_add_u32 s37, s37, s38
buffer_load_dwordx4 v22, s[8:11], s37 offen sc1 lds
s_add_u32 m0, s39, 58368
s_add_u32 s37, s37, s38
buffer_load_dwordx4 v23, s[8:11], s37 offen sc1 lds
s_add_u32 m0, s39, 59392
s_add_u32 s37, s37, s38
buffer_load_dwordx4 v22, s[8:11], s37 offen sc1 lds
s_add_u32 m0, s39, 60416
s_add_u32 s37, s37, s38
buffer_load_dwordx4 v23, s[8:11], s37 offen sc1 lds
s_add_u32 m0, s39, 61440
s_add_u32 s37, s37, s38
buffer_load_dwordx4 v22, s[8:11], s37 offen sc1 lds
s_add_u32 m0, s39, 62464
s_add_u32 s37, s37, s38
buffer_load_dwordx4 v23, s[8:11], s37 offen sc1 lds
s_add_u32 m0, s39, 63488
s_add_u32 s37, s37, s38
buffer_load_dwordx4 v22, s[8:11], s37 offen sc1 lds
s_add_u32 m0, s39, 64512
s_add_u32 s37, s37, s38
buffer_load_dwordx4 v23, s[8:11], s37 offen sc1 lds
LP3_35:
s_mul_i32 s43, s2, 28672
s_mul_i32 s44, s51, 7168
s_add_u32 s43, s43, s44
s_add_u32 s80, s60, s43
s_addc_u32 s81, s61, 0
s_lshl_b32 s43, s34, 18
s_add_u32 s12, s32, s43
s_addc_u32 s13, s33, 0
s_add_u32 s12, s12, 4194304
s_addc_u32 s13, s13, 0
s_mov_b32 s14, 262144
s_mov_b32 s15, 0x20000
v_lshlrev_b32 v21, 4, v1
s_lshl_b32 s54, s36, 11
s_add_u32 s43, s35, 1
s_and_b32 s43, s43, 15
s_lshl_b32 s43, s43, 14
s_add_u32 s30, s43, s54
s_add_u32 s43, s35, 2
s_and_b32 s43, s43, 15
s_lshl_b32 s43, s43, 14
s_add_u32 s31, s43, s54
s_barrier
s_add_u32 m0, s54, 0
s_add_u32 s43, s30, 0
buffer_load_dwordx4 v21, s[12:15], s43 offen sc1 lds
s_add_u32 m0, s54, 1024
s_add_u32 s43, s30, 1024
buffer_load_dwordx4 v21, s[12:15], s43 offen sc1 lds
s_add_u32 m0, s54, 49152
s_add_u32 s43, s31, 0
buffer_load_dwordx4 v21, s[12:15], s43 offen sc1 lds
s_add_u32 m0, s54, 50176
s_add_u32 s43, s31, 1024
buffer_load_dwordx4 v21, s[12:15], s43 offen sc1 lds
s_add_u32 s42, s42, 1
s_and_b32 s42, s42, 15
s_add_u32 m0, s39, 98304
s_mul_i32 s37, s42, s40
buffer_load_dwordx4 v22, s[8:11], s37 offen sc1 lds
s_add_u32 m0, s39, 99328
s_add_u32 s37, s37, s38
buffer_load_dwordx4 v23, s[8:11], s37 offen sc1 lds
s_add_u32 m0, s39, 100352
s_add_u32 s37, s37, s38
buffer_load_dwordx4 v22, s[8:11], s37 offen sc1 lds
s_add_u32 m0, s39, 101376
s_add_u32 s37, s37, s38
buffer_load_dwordx4 v23, s[8:11], s37 offen sc1 lds
s_add_u32 m0, s39, 102400
s_add_u32 s37, s37, s38
buffer_load_dwordx4 v22, s[8:11], s37 offen sc1 lds
s_add_u32 m0, s39, 103424
s_add_u32 s37, s37, s38
buffer_load_dwordx4 v23, s[8:11], s37 offen sc1 lds
s_add_u32 m0, s39, 104448
s_add_u32 s37, s37, s38
buffer_load_dwordx4 v22, s[8:11], s37 offen sc1 lds
s_add_u32 m0, s39, 105472
s_add_u32 s37, s37, s38
buffer_load_dwordx4 v23, s[8:11], s37 offen sc1 lds
s_add_u32 m0, s39, 106496
s_add_u32 s37, s37, s38
buffer_load_dwordx4 v22, s[8:11], s37 offen sc1 lds
s_add_u32 m0, s39, 107520
s_add_u32 s37, s37, s38
buffer_load_dwordx4 v23, s[8:11], s37 offen sc1 lds
s_add_u32 m0, s39, 108544
s_add_u32 s37, s37, s38
buffer_load_dwordx4 v22, s[8:11], s37 offen sc1 lds
s_add_u32 m0, s39, 109568
s_add_u32 s37, s37, s38
buffer_load_dwordx4 v23, s[8:11], s37 offen sc1 lds
s_add_u32 m0, s39, 110592
s_add_u32 s37, s37, s38
buffer_load_dwordx4 v22, s[8:11], s37 offen sc1 lds
s_add_u32 m0, s39, 111616
s_add_u32 s37, s37, s38
buffer_load_dwordx4 v23, s[8:11], s37 offen sc1 lds
s_add_u32 m0, s39, 112640
s_add_u32 s37, s37, s38
buffer_load_dwordx4 v22, s[8:11], s37 offen sc1 lds
s_add_u32 m0, s39, 113664
s_add_u32 s37, s37, s38
buffer_load_dwordx4 v23, s[8:11], s37 offen sc1 lds
s_load_dword s64, s[80:81], 0
s_load_dword s65, s[80:81], 64
s_load_dword s66, s[80:81], 128
s_load_dword s67, s[80:81], 192
s_load_dword s68, s[80:81], 256
s_load_dword s69, s[80:81], 320
s_load_dword s70, s[80:81], 384
s_load_dword s71, s[80:81], 448
s_load_dword s72, s[80:81], 512
s_add_u32 s80, s80, 576
s_addc_u32 s81, s81, 0
s_waitcnt vmcnt(18)
s_barrier
s_waitcnt vmcnt(16)
s_barrier
s_mov_b32 s41, 2
Lp3_45:
s_add_u32 s42, s42, 1
s_and_b32 s42, s42, 15
s_add_u32 m0, s39, 0
s_mul_i32 s37, s42, s40
buffer_load_dwordx4 v22, s[8:11], s37 offen sc1 lds
s_add_u32 m0, s39, 1024
s_add_u32 s37, s37, s38
buffer_load_dwordx4 v23, s[8:11], s37 offen sc1 lds
s_add_u32 m0, s39, 2048
s_add_u32 s37, s37, s38
buffer_load_dwordx4 v22, s[8:11], s37 offen sc1 lds
s_add_u32 m0, s39, 3072
s_add_u32 s37, s37, s38
buffer_load_dwordx4 v23, s[8:11], s37 offen sc1 lds
s_add_u32 m0, s39, 4096
s_add_u32 s37, s37, s38
buffer_load_dwordx4 v22, s[8:11], s37 offen sc1 lds
s_add_u32 m0, s39, 5120
s_add_u32 s37, s37, s38
buffer_load_dwordx4 v23, s[8:11], s37 offen sc1 lds
s_add_u32 m0, s39, 6144
s_add_u32 s37, s37, s38
buffer_load_dwordx4 v22, s[8:11], s37 offen sc1 lds
s_add_u32 m0, s39, 7168
s_add_u32 s37, s37, s38
buffer_load_dwordx4 v23, s[8:11], s37 offen sc1 lds
s_add_u32 m0, s39, 8192
s_add_u32 s37, s37, s38
buffer_load_dwordx4 v22, s[8:11], s37 offen sc1 lds
s_add_u32 m0, s39, 9216
s_add_u32 s37, s37, s38
buffer_load_dwordx4 v23, s[8:11], s37 offen sc1 lds
s_add_u32 m0, s39, 10240
s_add_u32 s37, s37, s38
buffer_load_dwordx4 v22, s[8:11], s37 offen sc1 lds
s_add_u32 m0, s39, 11264
s_add_u32 s37, s37, s38
buffer_load_dwordx4 v23, s[8:11], s37 offen sc1 lds
s_add_u32 m0, s39, 12288
s_add_u32 s37, s37, s38
buffer_load_dwordx4 v22, s[8:11], s37 offen sc1 lds
s_add_u32 m0, s39, 13312
s_add_u32 s37, s37, s38
buffer_load_dwordx4 v23, s[8:11], s37 offen sc1 lds
s_add_u32 m0, s39, 14336
s_add_u32 s37, s37, s38
buffer_load_dwordx4 v22, s[8:11], s37 offen sc1 lds
s_add_u32 m0, s39, 15360
s_add_u32 s37, s37, s38
buffer_load_dwordx4 v23, s[8:11], s37 offen sc1 lds
s_load_dword s64, s[80:81], 0
s_load_dword s65, s[80:81], 64
s_load_dword s66, s[80:81], 128
s_load_dword s67, s[80:81], 192
s_load_dword s68, s[80:81], 256
s_load_dword s69, s[80:81], 320
s_load_dword s70, s[80:81], 384
s_load_dword s71, s[80:81], 448
s_load_dword s72, s[80:81], 512
s_add_u32 s80, s80, 576
s_addc_u32 s81, s81, 0
s_waitcnt vmcnt(16)
s_barrier
s_add_u32 s42, s42, 1
s_and_b32 s42, s42, 15
s_add_u32 m0, s39, 49152
s_mul_i32 s37, s42, s40
buffer_load_dwordx4 v22, s[8:11], s37 offen sc1 lds
s_add_u32 m0, s39, 50176
s_add_u32 s37, s37, s38
buffer_load_dwordx4 v23, s[8:11], s37 offen sc1 lds
s_add_u32 m0, s39, 51200
s_add_u32 s37, s37, s38
buffer_load_dwordx4 v22, s[8:11], s37 offen sc1 lds
s_add_u32 m0, s39, 52224
s_add_u32 s37, s37, s38
buffer_load_dwordx4 v23, s[8:11], s37 offen sc1 lds
s_add_u32 m0, s39, 53248
s_add_u32 s37, s37, s38
buffer_load_dwordx4 v22, s[8:11], s37 offen sc1 lds
s_add_u32 m0, s39, 54272
s_add_u32 s37, s37, s38
buffer_load_dwordx4 v23, s[8:11], s37 offen sc1 lds
s_add_u32 m0, s39, 55296
s_add_u32 s37, s37, s38
buffer_load_dwordx4 v22, s[8:11], s37 offen sc1 lds
s_add_u32 m0, s39, 56320
s_add_u32 s37, s37, s38
buffer_load_dwordx4 v23, s[8:11], s37 offen sc1 lds
s_add_u32 m0, s39, 57344
s_add_u32 s37, s37, s38
buffer_load_dwordx4 v22, s[8:11], s37 offen sc1 lds
s_add_u32 m0, s39, 58368
s_add_u32 s37, s37, s38
buffer_load_dwordx4 v23, s[8:11], s37 offen sc1 lds
s_add_u32 m0, s39, 59392
s_add_u32 s37, s37, s38
buffer_load_dwordx4 v22, s[8:11], s37 offen sc1 lds
s_add_u32 m0, s39, 60416
s_add_u32 s37, s37, s38
buffer_load_dwordx4 v23, s[8:11], s37 offen sc1 lds
s_add_u32 m0, s39, 61440
s_add_u32 s37, s37, s38
buffer_load_dwordx4 v22, s[8:11], s37 offen sc1 lds
s_add_u32 m0, s39, 62464
s_add_u32 s37, s37, s38
buffer_load_dwordx4 v23, s[8:11], s37 offen sc1 lds
s_add_u32 m0, s39, 63488
s_add_u32 s37, s37, s38
buffer_load_dwordx4 v22, s[8:11], s37 offen sc1 lds
s_add_u32 m0, s39, 64512
s_add_u32 s37, s37, s38
buffer_load_dwordx4 v23, s[8:11], s37 offen sc1 lds
s_load_dword s64, s[80:81], 0
s_load_dword s65, s[80:81], 64
s_load_dword s66, s[80:81], 128
s_load_dword s67, s[80:81], 192
s_load_dword s68, s[80:81], 256
s_load_dword s69, s[80:81], 320
s_load_dword s70, s[80:81], 384
s_load_dword s71, s[80:81], 448
s_load_dword s72, s[80:81], 512
s_add_u32 s80, s80, 576
s_addc_u32 s81, s81, 0
s_waitcnt vmcnt(16)
s_barrier
s_add_u32 s42, s42, 1
s_and_b32 s42, s42, 15
s_add_u32 m0, s39, 98304
s_mul_i32 s37, s42, s40
buffer_load_dwordx4 v22, s[8:11], s37 offen sc1 lds
s_add_u32 m0, s39, 99328
s_add_u32 s37, s37, s38
buffer_load_dwordx4 v23, s[8:11], s37 offen sc1 lds
s_add_u32 m0, s39, 100352
s_add_u32 s37, s37, s38
buffer_load_dwordx4 v22, s[8:11], s37 offen sc1 lds
s_add_u32 m0, s39, 101376
s_add_u32 s37, s37, s38
buffer_load_dwordx4 v23, s[8:11], s37 offen sc1 lds
s_add_u32 m0, s39, 102400
s_add_u32 s37, s37, s38
buffer_load_dwordx4 v22, s[8:11], s37 offen sc1 lds
s_add_u32 m0, s39, 103424
s_add_u32 s37, s37, s38
buffer_load_dwordx4 v23, s[8:11], s37 offen sc1 lds
s_add_u32 m0, s39, 104448
s_add_u32 s37, s37, s38
buffer_load_dwordx4 v22, s[8:11], s37 offen sc1 lds
s_add_u32 m0, s39, 105472
s_add_u32 s37, s37, s38
buffer_load_dwordx4 v23, s[8:11], s37 offen sc1 lds
s_add_u32 m0, s39, 106496
s_add_u32 s37, s37, s38
buffer_load_dwordx4 v22, s[8:11], s37 offen sc1 lds
s_add_u32 m0, s39, 107520
s_add_u32 s37, s37, s38
buffer_load_dwordx4 v23, s[8:11], s37 offen sc1 lds
s_add_u32 m0, s39, 108544
s_add_u32 s37, s37, s38
buffer_load_dwordx4 v22, s[8:11], s37 offen sc1 lds
s_add_u32 m0, s39, 109568
s_add_u32 s37, s37, s38
buffer_load_dwordx4 v23, s[8:11], s37 offen sc1 lds
s_add_u32 m0, s39, 110592
s_add_u32 s37, s37, s38
buffer_load_dwordx4 v22, s[8:11], s37 offen sc1 lds
s_add_u32 m0, s39, 111616
s_add_u32 s37, s37, s38
buffer_load_dwordx4 v23, s[8:11], s37 offen sc1 lds
s_add_u32 m0, s39, 112640
s_add_u32 s37, s37, s38
buffer_load_dwordx4 v22, s[8:11], s37 offen sc1 lds
s_add_u32 m0, s39, 113664
s_add_u32 s37, s37, s38
buffer_load_dwordx4 v23, s[8:11], s37 offen sc1 lds
s_load_dword s64, s[80:81], 0
s_load_dword s65, s[80:81], 64
s_load_dword s66, s[80:81], 128
s_load_dword s67, s[80:81], 192
s_load_dword s68, s[80:81], 256
s_load_dword s69, s[80:81], 320
s_load_dword s70, s[80:81], 384
s_load_dword s71, s[80:81], 448
s_load_dword s72, s[80:81], 512
s_add_u32 s80, s80, 576
s_addc_u32 s81, s81, 0
s_waitcnt vmcnt(16)
s_barrier
s_sub_u32 s41, s41, 1
s_cmp_lg_u32 s41, 0
s_cbranch_scc1 Lp3_45
s_add_u32 s42, s42, 1
s_and_b32 s42, s42, 15
s_add_u32 m0, s39, 0
s_mul_i32 s37, s42, s40
buffer_load_dwordx4 v22, s[8:11], s37 offen sc1 lds
s_add_u32 m0, s39, 1024
s_add_u32 s37, s37, s38
buffer_load_dwordx4 v23, s[8:11], s37 offen sc1 lds
s_add_u32 m0, s39, 2048
s_add_u32 s37, s37, s38
buffer_load_dwordx4 v22, s[8:11], s37 offen sc1 lds
s_add_u32 m0, s39, 3072
s_add_u32 s37, s37, s38
buffer_load_dwordx4 v23, s[8:11], s37 offen sc1 lds
s_add_u32 m0, s39, 4096
s_add_u32 s37, s37, s38
buffer_load_dwordx4 v22, s[8:11], s37 offen sc1 lds
s_add_u32 m0, s39, 5120
s_add_u32 s37, s37, s38
buffer_load_dwordx4 v23, s[8:11], s37 offen sc1 lds
s_add_u32 m0, s39, 6144
s_add_u32 s37, s37, s38
buffer_load_dwordx4 v22, s[8:11], s37 offen sc1 lds
s_add_u32 m0, s39, 7168
s_add_u32 s37, s37, s38
buffer_load_dwordx4 v23, s[8:11], s37 offen sc1 lds
s_add_u32 m0, s39, 8192
s_add_u32 s37, s37, s38
buffer_load_dwordx4 v22, s[8:11], s37 offen sc1 lds
s_add_u32 m0, s39, 9216
s_add_u32 s37, s37, s38
buffer_load_dwordx4 v23, s[8:11], s37 offen sc1 lds
s_add_u32 m0, s39, 10240
s_add_u32 s37, s37, s38
buffer_load_dwordx4 v22, s[8:11], s37 offen sc1 lds
s_add_u32 m0, s39, 11264
s_add_u32 s37, s37, s38
buffer_load_dwordx4 v23, s[8:11], s37 offen sc1 lds
s_add_u32 m0, s39, 12288
s_add_u32 s37, s37, s38
buffer_load_dwordx4 v22, s[8:11], s37 offen sc1 lds
s_add_u32 m0, s39, 13312
s_add_u32 s37, s37, s38
buffer_load_dwordx4 v23, s[8:11], s37 offen sc1 lds
s_add_u32 m0, s39, 14336
s_add_u32 s37, s37, s38
buffer_load_dwordx4 v22, s[8:11], s37 offen sc1 lds
s_add_u32 m0, s39, 15360
s_add_u32 s37, s37, s38
buffer_load_dwordx4 v23, s[8:11], s37 offen sc1 lds
s_load_dword s64, s[80:81], 0
s_load_dword s65, s[80:81], 64
s_load_dword s66, s[80:81], 128
s_load_dword s67, s[80:81], 192
s_load_dword s68, s[80:81], 256
s_load_dword s69, s[80:81], 320
s_load_dword s70, s[80:81], 384
s_load_dword s71, s[80:81], 448
s_load_dword s72, s[80:81], 512
s_add_u32 s80, s80, 576
s_addc_u32 s81, s81, 0
s_waitcnt vmcnt(16)
s_barrier
s_add_u32 s42, s42, 1
s_and_b32 s42, s42, 15
s_add_u32 m0, s39, 49152
s_mul_i32 s37, s42, s40
buffer_load_dwordx4 v22, s[8:11], s37 offen sc1 lds
s_add_u32 m0, s39, 50176
s_add_u32 s37, s37, s38
buffer_load_dwordx4 v23, s[8:11], s37 offen sc1 lds
s_add_u32 m0, s39, 51200
s_add_u32 s37, s37, s38
buffer_load_dwordx4 v22, s[8:11], s37 offen sc1 lds
s_add_u32 m0, s39, 52224
s_add_u32 s37, s37, s38
buffer_load_dwordx4 v23, s[8:11], s37 offen sc1 lds
s_add_u32 m0, s39, 53248
s_add_u32 s37, s37, s38
buffer_load_dwordx4 v22, s[8:11], s37 offen sc1 lds
s_add_u32 m0, s39, 54272
s_add_u32 s37, s37, s38
buffer_load_dwordx4 v23, s[8:11], s37 offen sc1 lds
s_add_u32 m0, s39, 55296
s_add_u32 s37, s37, s38
buffer_load_dwordx4 v22, s[8:11], s37 offen sc1 lds
s_add_u32 m0, s39, 56320
s_add_u32 s37, s37, s38
buffer_load_dwordx4 v23, s[8:11], s37 offen sc1 lds
s_add_u32 m0, s39, 57344
s_add_u32 s37, s37, s38
buffer_load_dwordx4 v22, s[8:11], s37 offen sc1 lds
s_add_u32 m0, s39, 58368
s_add_u32 s37, s37, s38
buffer_load_dwordx4 v23, s[8:11], s37 offen sc1 lds
s_add_u32 m0, s39, 59392
s_add_u32 s37, s37, s38
buffer_load_dwordx4 v22, s[8:11], s37 offen sc1 lds
s_add_u32 m0, s39, 60416
s_add_u32 s37, s37, s38
buffer_load_dwordx4 v23, s[8:11], s37 offen sc1 lds
s_add_u32 m0, s39, 61440
s_add_u32 s37, s37, s38
buffer_load_dwordx4 v22, s[8:11], s37 offen sc1 lds
s_add_u32 m0, s39, 62464
s_add_u32 s37, s37, s38
buffer_load_dwordx4 v23, s[8:11], s37 offen sc1 lds
s_add_u32 m0, s39, 63488
s_add_u32 s37, s37, s38
buffer_load_dwordx4 v22, s[8:11], s37 offen sc1 lds
s_add_u32 m0, s39, 64512
s_add_u32 s37, s37, s38
buffer_load_dwordx4 v23, s[8:11], s37 offen sc1 lds
s_load_dword s64, s[80:81], 0
s_load_dword s65, s[80:81], 64
s_load_dword s66, s[80:81], 128
s_load_dword s67, s[80:81], 192
s_load_dword s68, s[80:81], 256
s_load_dword s69, s[80:81], 320
s_load_dword s70, s[80:81], 384
s_load_dword s71, s[80:81], 448
s_load_dword s72, s[80:81], 512
s_add_u32 s80, s80, 576
s_addc_u32 s81, s81, 0
s_waitcnt vmcnt(16)
s_barrier
s_add_u32 s42, s42, 1
s_and_b32 s42, s42, 15
s_add_u32 m0, s39, 98304
s_mul_i32 s37, s42, s40
buffer_load_dwordx4 v22, s[8:11], s37 offen sc1 lds
s_and_b32 s53, s35, 1
s_lshl_b32 s53, s53, 1
s_mul_i32 s43, s47, 3
s_add_u32 m0, s39, 99328
s_add_u32 s37, s37, s38
buffer_load_dwordx4 v23, s[8:11], s37 offen sc1 lds
s_add_u32 s53, s53, s43
v_lshlrev_b32 v19, 11, v18
v_lshl_add_u32 v19, v17, 4, v19
s_add_u32 m0, s39, 100352
s_add_u32 s37, s37, s38
buffer_load_dwordx4 v22, s[8:11], s37 offen sc1 lds
s_lshl_b32 s43, s46, 10
v_add_u32 v2, s43, v19
v_add_u32 v3, 49152, v2
s_add_u32 m0, s39, 101376
s_add_u32 s37, s37, s38
buffer_load_dwordx4 v23, s[8:11], s37 offen sc1 lds
v_add_u32 v4, 98304, v2
v_lshrrev_b32 v19, 2, v17
v_lshl_add_u32 v20, v18, 2, v19
s_add_u32 m0, s39, 102400
s_add_u32 s37, s37, s38
buffer_load_dwordx4 v22, s[8:11], s37 offen sc1 lds
v_and_b32 v21, 7, v20
v_lshlrev_b32 v20, 8, v20
v_and_b32 v19, 3, v1
s_add_u32 m0, s39, 103424
s_add_u32 s37, s37, s38
buffer_load_dwordx4 v23, s[8:11], s37 offen sc1 lds
v_lshl_add_u32 v20, v19, 3, v20
s_add_u32 s43, s53, 0
v_xor_b32 v19, s43, v21
s_add_u32 m0, s39, 104448
s_add_u32 s37, s37, s38
buffer_load_dwordx4 v22, s[8:11], s37 offen sc1 lds
v_lshl_add_u32 v5, v19, 5, v20
s_add_u32 s43, s53, 1
v_xor_b32 v19, s43, v21
s_add_u32 m0, s39, 105472
s_add_u32 s37, s37, s38
buffer_load_dwordx4 v23, s[8:11], s37 offen sc1 lds
v_lshl_add_u32 v6, v19, 5, v20
s_add_u32 s43, s53, 2
v_xor_b32 v19, s43, v21
s_add_u32 m0, s39, 106496
s_add_u32 s37, s37, s38
buffer_load_dwordx4 v22, s[8:11], s37 offen sc1 lds
v_lshl_add_u32 v7, v19, 5, v20
v_add_u32 v9, 49152, v5
v_add_u32 v10, 49152, v6
s_add_u32 m0, s39, 107520
s_add_u32 s37, s37, s38
buffer_load_dwordx4 v23, s[8:11], s37 offen sc1 lds
v_add_u32 v11, 49152, v7
v_add_u32 v13, 98304, v5
v_add_u32 v14, 98304, v6
s_add_u32 m0, s39, 108544
s_add_u32 s37, s37, s38
buffer_load_dwordx4 v22, s[8:11], s37 offen sc1 lds
v_add_u32 v15, 98304, v7
s_lshl_b32 s43, s46, 9
s_add_u32 s43, s43, 147456
s_add_u32 m0, s39, 109568
s_add_u32 s37, s37, s38
buffer_load_dwordx4 v23, s[8:11], s37 offen sc1 lds
v_lshl_add_u32 v19, v17, 3, s43
ds_read_b64 v[80:81], v19 offset:0
ds_read_b64 v[82:83], v19 offset:128
s_add_u32 m0, s39, 110592
s_add_u32 s37, s37, s38
buffer_load_dwordx4 v22, s[8:11], s37 offen sc1 lds
ds_read_b64 v[84:85], v19 offset:256
ds_read_b64 v[86:87], v19 offset:384
s_mul_i32 s43, s47, 192
s_add_u32 m0, s39, 111616
s_add_u32 s37, s37, s38
buffer_load_dwordx4 v23, s[8:11], s37 offen sc1 lds
s_add_u32 s43, s43, 148992
v_lshl_add_u32 v19, v18, 4, s43
ds_read_b128 v[48:51], v19 offset:0
s_add_u32 m0, s39, 112640
s_add_u32 s37, s37, s38
buffer_load_dwordx4 v22, s[8:11], s37 offen sc1 lds
ds_read_b128 v[52:55], v19 offset:64
ds_read_b128 v[56:59], v19 offset:128
ds_read_b128 v[60:63], v19 offset:896
s_add_u32 m0, s39, 113664
s_add_u32 s37, s37, s38
buffer_load_dwordx4 v23, s[8:11], s37 offen sc1 lds
ds_read_b128 v[64:67], v19 offset:960
ds_read_b128 v[68:71], v19 offset:1024
s_waitcnt vmcnt(16)
s_barrier
s_add_u32 s42, s42, 1
s_and_b32 s42, s42, 15
s_add_u32 m0, s39, 0
s_mul_i32 s37, s42, s40
buffer_load_dwordx4 v22, s[8:11], s37 offen sc1 lds
s_waitcnt lgkmcnt(0)
v_mul_f32 v88, v81, v81
s_add_u32 m0, s39, 1024
s_add_u32 s37, s37, s38
buffer_load_dwordx4 v23, s[8:11], s37 offen sc1 lds
v_mul_f32 v228, 0xc0135761, v81
s_add_u32 m0, s39, 2048
s_add_u32 s37, s37, s38
buffer_load_dwordx4 v22, s[8:11], s37 offen sc1 lds
v_mul_f32 v89, 0xbdd2d3e8, v81
s_add_u32 m0, s39, 3072
s_add_u32 s37, s37, s38
buffer_load_dwordx4 v23, s[8:11], s37 offen sc1 lds
v_rcp_f32 v236, v88
v_mul_f32 v232, v89, v88
s_add_u32 m0, s39, 4096
s_add_u32 s37, s37, s38
buffer_load_dwordx4 v22, s[8:11], s37 offen sc1 lds
v_mul_f32 v88, v83, v83
s_add_u32 m0, s39, 5120
s_add_u32 s37, s37, s38
buffer_load_dwordx4 v23, s[8:11], s37 offen sc1 lds
v_mul_f32 v229, 0xc0135761, v83
s_add_u32 m0, s39, 6144
s_add_u32 s37, s37, s38
buffer_load_dwordx4 v22, s[8:11], s37 offen sc1 lds
v_mul_f32 v89, 0xbdd2d3e8, v83
v_rcp_f32 v237, v88
s_add_u32 m0, s39, 7168
s_add_u32 s37, s37, s38
buffer_load_dwordx4 v23, s[8:11], s37 offen sc1 lds
v_mul_f32 v233, v89, v88
s_add_u32 m0, s39, 8192
s_add_u32 s37, s37, s38
buffer_load_dwordx4 v22, s[8:11], s37 offen sc1 lds
v_mul_f32 v88, v85, v85
s_add_u32 m0, s39, 9216
s_add_u32 s37, s37, s38
buffer_load_dwordx4 v23, s[8:11], s37 offen sc1 lds
v_mul_f32 v230, 0xc0135761, v85
v_mul_f32 v89, 0xbdd2d3e8, v85
s_add_u32 m0, s39, 10240
s_add_u32 s37, s37, s38
buffer_load_dwordx4 v22, s[8:11], s37 offen sc1 lds
v_rcp_f32 v238, v88
s_add_u32 m0, s39, 11264
s_add_u32 s37, s37, s38
buffer_load_dwordx4 v23, s[8:11], s37 offen sc1 lds
v_mul_f32 v234, v89, v88
s_add_u32 m0, s39, 12288
s_add_u32 s37, s37, s38
buffer_load_dwordx4 v22, s[8:11], s37 offen sc1 lds
v_mul_f32 v88, v87, v87
v_mul_f32 v231, 0xc0135761, v87
s_add_u32 m0, s39, 13312
s_add_u32 s37, s37, s38
buffer_load_dwordx4 v23, s[8:11], s37 offen sc1 lds
v_mul_f32 v89, 0xbdd2d3e8, v87
s_add_u32 m0, s39, 14336
s_add_u32 s37, s37, s38
buffer_load_dwordx4 v22, s[8:11], s37 offen sc1 lds
v_rcp_f32 v239, v88
s_add_u32 m0, s39, 15360
s_add_u32 s37, s37, s38
buffer_load_dwordx4 v23, s[8:11], s37 offen sc1 lds
v_mul_f32 v235, v89, v88
s_mul_i32 s43, s34, 917504
s_mul_i32 s44, s49, 24576
s_add_u32 s43, s43, s44
s_add_u32 s43, s43, 8912896
s_add_u32 s24, s32, s43
s_addc_u32 s25, s33, 0
s_mov_b32 s26, 24576
s_mov_b32 s27, 0x20000
s_mov_b32 s53, 262144
s_lshl_b32 s43, s47, 13
s_lshl_b32 s44, s46, 10
s_add_u32 s43, s43, s44
v_lshlrev_b32 v19, 11, v18
v_lshl_add_u32 v19, v17, 4, v19
v_add_u32 v27, s43, v19
s_lshl_b32 s43, s47, 12
s_add_u32 s43, s43, s44
s_add_u32 s43, s43, 16384
v_and_b32 v19, 1, v18
v_lshlrev_b32 v19, 11, v19
v_lshrrev_b32 v20, 1, v18
v_lshl_add_u32 v19, v20, 8, v19
v_lshl_add_u32 v19, v17, 4, v19
v_add_u32 v28, s43, v19
s_load_dword s64, s[80:81], 0
s_load_dword s65, s[80:81], 64
s_load_dword s66, s[80:81], 128
s_load_dword s67, s[80:81], 192
s_load_dword s68, s[80:81], 256
s_load_dword s69, s[80:81], 320
s_load_dword s70, s[80:81], 384
s_load_dword s71, s[80:81], 448
s_add_u32 s80, s80, 512
s_addc_u32 s81, s81, 0
s_waitcnt vmcnt(16)
s_barrier
s_add_u32 s42, s42, 1
s_and_b32 s42, s42, 15
s_add_u32 m0, s39, 49152
s_mul_i32 s37, s42, s40
buffer_load_dwordx4 v22, s[8:11], s37 offen sc1 lds
v_mul_f32 v128, -v80, v48
v_mul_f32 v129, -v80, v49
s_add_u32 m0, s39, 50176
s_add_u32 s37, s37, s38
buffer_load_dwordx4 v23, s[8:11], s37 offen sc1 lds
v_mul_f32 v130, -v80, v50
v_mul_f32 v131, -v80, v51
s_add_u32 m0, s39, 51200
s_add_u32 s37, s37, s38
buffer_load_dwordx4 v22, s[8:11], s37 offen sc1 lds
v_mul_f32 v132, -v82, v48
v_mul_f32 v133, -v82, v49
s_add_u32 m0, s39, 52224
s_add_u32 s37, s37, s38
buffer_load_dwordx4 v23, s[8:11], s37 offen sc1 lds
v_mul_f32 v134, -v82, v50
v_mul_f32 v135, -v82, v51
s_add_u32 m0, s39, 53248
s_add_u32 s37, s37, s38
buffer_load_dwordx4 v22, s[8:11], s37 offen sc1 lds
v_mul_f32 v136, -v84, v48
v_mul_f32 v137, -v84, v49
s_add_u32 m0, s39, 54272
s_add_u32 s37, s37, s38
buffer_load_dwordx4 v23, s[8:11], s37 offen sc1 lds
v_mul_f32 v138, -v84, v50
v_mul_f32 v139, -v84, v51
s_add_u32 m0, s39, 55296
s_add_u32 s37, s37, s38
buffer_load_dwordx4 v22, s[8:11], s37 offen sc1 lds
v_mul_f32 v140, -v86, v48
v_mul_f32 v141, -v86, v49
s_add_u32 m0, s39, 56320
s_add_u32 s37, s37, s38
buffer_load_dwordx4 v23, s[8:11], s37 offen sc1 lds
v_mul_f32 v142, -v86, v50
v_mul_f32 v143, -v86, v51
s_add_u32 m0, s39, 57344
s_add_u32 s37, s37, s38
buffer_load_dwordx4 v22, s[8:11], s37 offen sc1 lds
v_mul_f32 v144, -v80, v52
v_mul_f32 v145, -v80, v53
s_add_u32 m0, s39, 58368
s_add_u32 s37, s37, s38
buffer_load_dwordx4 v23, s[8:11], s37 offen sc1 lds
v_mul_f32 v146, -v80, v54
v_mul_f32 v147, -v80, v55
s_add_u32 m0, s39, 59392
s_add_u32 s37, s37, s38
buffer_load_dwordx4 v22, s[8:11], s37 offen sc1 lds
v_mul_f32 v148, -v82, v52
v_mul_f32 v149, -v82, v53
s_add_u32 m0, s39, 60416
s_add_u32 s37, s37, s38
buffer_load_dwordx4 v23, s[8:11], s37 offen sc1 lds
v_mul_f32 v150, -v82, v54
v_mul_f32 v151, -v82, v55
s_add_u32 m0, s39, 61440
s_add_u32 s37, s37, s38
buffer_load_dwordx4 v22, s[8:11], s37 offen sc1 lds
v_mul_f32 v152, -v84, v52
v_mul_f32 v153, -v84, v53
s_add_u32 m0, s39, 62464
s_add_u32 s37, s37, s38
buffer_load_dwordx4 v23, s[8:11], s37 offen sc1 lds
v_mul_f32 v154, -v84, v54
v_mul_f32 v155, -v84, v55
s_add_u32 m0, s39, 63488
s_add_u32 s37, s37, s38
buffer_load_dwordx4 v22, s[8:11], s37 offen sc1 lds
v_mul_f32 v156, -v86, v52
v_mul_f32 v157, -v86, v53
s_add_u32 m0, s39, 64512
s_add_u32 s37, s37, s38
buffer_load_dwordx4 v23, s[8:11], s37 offen sc1 lds
v_mul_f32 v158, -v86, v54
v_mul_f32 v159, -v86, v55
s_load_dword s64, s[80:81], 0
s_load_dword s65, s[80:81], 64
s_load_dword s66, s[80:81], 128
s_load_dword s67, s[80:81], 192
s_load_dword s68, s[80:81], 256
s_load_dword s69, s[80:81], 320
s_load_dword s70, s[80:81], 384
s_load_dword s71, s[80:81], 448
s_add_u32 s80, s80, 512
s_addc_u32 s81, s81, 0
s_waitcnt vmcnt(16)
s_barrier
s_add_u32 s42, s42, 1
s_and_b32 s42, s42, 15
s_add_u32 m0, s39, 98304
s_mul_i32 s37, s42, s40
buffer_load_dwordx4 v22, s[8:11], s37 offen sc1 lds
v_mul_f32 v160, -v80, v56
v_mul_f32 v161, -v80, v57
s_add_u32 m0, s39, 99328
s_add_u32 s37, s37, s38
buffer_load_dwordx4 v23, s[8:11], s37 offen sc1 lds
v_mul_f32 v162, -v80, v58
v_mul_f32 v163, -v80, v59
s_add_u32 m0, s39, 100352
s_add_u32 s37, s37, s38
buffer_load_dwordx4 v22, s[8:11], s37 offen sc1 lds
v_mul_f32 v164, -v82, v56
v_mul_f32 v165, -v82, v57
s_add_u32 m0, s39, 101376
s_add_u32 s37, s37, s38
buffer_load_dwordx4 v23, s[8:11], s37 offen sc1 lds
v_mul_f32 v166, -v82, v58
v_mul_f32 v167, -v82, v59
s_add_u32 m0, s39, 102400
s_add_u32 s37, s37, s38
buffer_load_dwordx4 v22, s[8:11], s37 offen sc1 lds
v_mul_f32 v168, -v84, v56
v_mul_f32 v169, -v84, v57
s_add_u32 m0, s39, 103424
s_add_u32 s37, s37, s38
buffer_load_dwordx4 v23, s[8:11], s37 offen sc1 lds
v_mul_f32 v170, -v84, v58
v_mul_f32 v171, -v84, v59
s_add_u32 m0, s39, 104448
s_add_u32 s37, s37, s38
buffer_load_dwordx4 v22, s[8:11], s37 offen sc1 lds
v_mul_f32 v172, -v86, v56
v_mul_f32 v173, -v86, v57
s_add_u32 m0, s39, 105472
s_add_u32 s37, s37, s38
buffer_load_dwordx4 v23, s[8:11], s37 offen sc1 lds
v_mul_f32 v174, -v86, v58
v_mul_f32 v175, -v86, v59
s_add_u32 m0, s39, 106496
s_add_u32 s37, s37, s38
buffer_load_dwordx4 v22, s[8:11], s37 offen sc1 lds
v_mul_f32 v176, -v80, v60
v_mul_f32 v177, -v80, v61
s_add_u32 m0, s39, 107520
s_add_u32 s37, s37, s38
buffer_load_dwordx4 v23, s[8:11], s37 offen sc1 lds
v_mul_f32 v178, -v80, v62
v_mul_f32 v179, -v80, v63
s_add_u32 m0, s39, 108544
s_add_u32 s37, s37, s38
buffer_load_dwordx4 v22, s[8:11], s37 offen sc1 lds
v_mul_f32 v180, -v82, v60
v_mul_f32 v181, -v82, v61
s_add_u32 m0, s39, 109568
s_add_u32 s37, s37, s38
buffer_load_dwordx4 v23, s[8:11], s37 offen sc1 lds
v_mul_f32 v182, -v82, v62
v_mul_f32 v183, -v82, v63
s_add_u32 m0, s39, 110592
s_add_u32 s37, s37, s38
buffer_load_dwordx4 v22, s[8:11], s37 offen sc1 lds
v_mul_f32 v184, -v84, v60
v_mul_f32 v185, -v84, v61
s_add_u32 m0, s39, 111616
s_add_u32 s37, s37, s38
buffer_load_dwordx4 v23, s[8:11], s37 offen sc1 lds
v_mul_f32 v186, -v84, v62
v_mul_f32 v187, -v84, v63
s_add_u32 m0, s39, 112640
s_add_u32 s37, s37, s38
buffer_load_dwordx4 v22, s[8:11], s37 offen sc1 lds
v_mul_f32 v188, -v86, v60
v_mul_f32 v189, -v86, v61
s_add_u32 m0, s39, 113664
s_add_u32 s37, s37, s38
buffer_load_dwordx4 v23, s[8:11], s37 offen sc1 lds
v_mul_f32 v190, -v86, v62
v_mul_f32 v191, -v86, v63
s_load_dword s64, s[80:81], 0
s_load_dword s65, s[80:81], 64
s_load_dword s66, s[80:81], 128
s_load_dword s67, s[80:81], 192
s_load_dword s68, s[80:81], 256
s_load_dword s69, s[80:81], 320
s_load_dword s70, s[80:81], 384
s_load_dword s71, s[80:81], 448
s_add_u32 s80, s80, 512
s_addc_u32 s81, s81, 0
s_waitcnt vmcnt(16)
s_barrier
s_mul_i32 s43, s49, 192
s_and_b32 s43, s43, 0xffffff80
s_add_u32 s43, s43, 4096
s_cmp_eq_u32 s51, 1
s_cselect_b32 s8, s4, s6
s_cselect_b32 s9, s5, s7
s_sub_u32 s10, 7340032, s43
s_lshl_b32 s44, s34, 18
s_add_u32 s44, s44, 4194304
s_movk_i32 s38, 28672
s_cmp_eq_u32 s51, 0
s_cselect_b32 s8, s32, s8
s_cselect_b32 s9, s33, s9
s_cselect_b32 s10, 262144, s10
s_cselect_b32 s43, s44, s43
s_cselect_b32 s38, 1024, s38
s_cselect_b32 s45, 0, -1
s_add_u32 s8, s8, s43
s_addc_u32 s9, s9, 0
s_mov_b32 s11, 0x20000
s_lshl_b32 s40, s38, 4
s_add_u32 s42, s35, 15
s_lshl_b32 s39, s51, 14
v_lshrrev_b32 v19, 4, v1
v_lshlrev_b32 v20, 5, v19
v_mul_u32_u24 v19, 6912, v19
v_and_b32 v19, s45, v19
v_and_b32 v20, s45, v20
v_lshlrev_b32 v21, 4, v1
v_xor_b32 v21, v21, v20
v_add_u32 v22, v21, v19
s_and_b32 s45, s45, 128
v_xor_b32 v23, s45, v22
s_add_u32 s42, s42, 1
s_and_b32 s42, s42, 15
s_add_u32 m0, s39, 0
s_mul_i32 s37, s42, s40
buffer_load_dwordx4 v22, s[8:11], s37 offen sc1 lds
v_mul_f32 v192, -v80, v64
v_mul_f32 v193, -v80, v65
s_add_u32 m0, s39, 1024
s_add_u32 s37, s37, s38
buffer_load_dwordx4 v23, s[8:11], s37 offen sc1 lds
v_mul_f32 v194, -v80, v66
v_mul_f32 v195, -v80, v67
s_add_u32 m0, s39, 2048
s_add_u32 s37, s37, s38
buffer_load_dwordx4 v22, s[8:11], s37 offen sc1 lds
v_mul_f32 v196, -v82, v64
v_mul_f32 v197, -v82, v65
s_add_u32 m0, s39, 3072
s_add_u32 s37, s37, s38
buffer_load_dwordx4 v23, s[8:11], s37 offen sc1 lds
v_mul_f32 v198, -v82, v66
v_mul_f32 v199, -v82, v67
s_add_u32 m0, s39, 4096
s_add_u32 s37, s37, s38
buffer_load_dwordx4 v22, s[8:11], s37 offen sc1 lds
v_mul_f32 v200, -v84, v64
v_mul_f32 v201, -v84, v65
s_add_u32 m0, s39, 5120
s_add_u32 s37, s37, s38
buffer_load_dwordx4 v23, s[8:11], s37 offen sc1 lds
v_mul_f32 v202, -v84, v66
v_mul_f32 v203, -v84, v67
s_add_u32 m0, s39, 6144
s_add_u32 s37, s37, s38
buffer_load_dwordx4 v22, s[8:11], s37 offen sc1 lds
v_mul_f32 v204, -v86, v64
v_mul_f32 v205, -v86, v65
s_add_u32 m0, s39, 7168
s_add_u32 s37, s37, s38
buffer_load_dwordx4 v23, s[8:11], s37 offen sc1 lds
v_mul_f32 v206, -v86, v66
v_mul_f32 v207, -v86, v67
s_add_u32 m0, s39, 8192
s_add_u32 s37, s37, s38
buffer_load_dwordx4 v22, s[8:11], s37 offen sc1 lds
v_mul_f32 v208, -v80, v68
v_mul_f32 v209, -v80, v69
s_add_u32 m0, s39, 9216
s_add_u32 s37, s37, s38
buffer_load_dwordx4 v23, s[8:11], s37 offen sc1 lds
v_mul_f32 v210, -v80, v70
v_mul_f32 v211, -v80, v71
s_add_u32 m0, s39, 10240
s_add_u32 s37, s37, s38
buffer_load_dwordx4 v22, s[8:11], s37 offen sc1 lds
v_mul_f32 v212, -v82, v68
v_mul_f32 v213, -v82, v69
s_add_u32 m0, s39, 11264
s_add_u32 s37, s37, s38
buffer_load_dwordx4 v23, s[8:11], s37 offen sc1 lds
v_mul_f32 v214, -v82, v70
v_mul_f32 v215, -v82, v71
s_add_u32 m0, s39, 12288
s_add_u32 s37, s37, s38
buffer_load_dwordx4 v22, s[8:11], s37 offen sc1 lds
v_mul_f32 v216, -v84, v68
v_mul_f32 v217, -v84, v69
s_add_u32 m0, s39, 13312
s_add_u32 s37, s37, s38
buffer_load_dwordx4 v23, s[8:11], s37 offen sc1 lds
v_mul_f32 v218, -v84, v70
v_mul_f32 v219, -v84, v71
s_add_u32 m0, s39, 14336
s_add_u32 s37, s37, s38
buffer_load_dwordx4 v22, s[8:11], s37 offen sc1 lds
v_mul_f32 v220, -v86, v68
v_mul_f32 v221, -v86, v69
s_add_u32 m0, s39, 15360
s_add_u32 s37, s37, s38
buffer_load_dwordx4 v23, s[8:11], s37 offen sc1 lds
v_mul_f32 v222, -v86, v70
v_mul_f32 v223, -v86, v71
s_load_dword s64, s[80:81], 0
s_load_dword s65, s[80:81], 64
s_load_dword s66, s[80:81], 128
s_load_dword s67, s[80:81], 192
s_load_dword s68, s[80:81], 256
s_load_dword s69, s[80:81], 320
s_load_dword s70, s[80:81], 384
s_add_u32 s80, s80, 448
s_addc_u32 s81, s81, 0
s_waitcnt vmcnt(16)
s_barrier
s_add_u32 s42, s42, 1
s_and_b32 s42, s42, 15
s_add_u32 m0, s39, 49152
s_mul_i32 s37, s42, s40
buffer_load_dwordx4 v22, s[8:11], s37 offen sc1 lds
s_add_u32 m0, s39, 50176
s_add_u32 s37, s37, s38
buffer_load_dwordx4 v23, s[8:11], s37 offen sc1 lds
s_add_u32 m0, s39, 51200
s_add_u32 s37, s37, s38
buffer_load_dwordx4 v22, s[8:11], s37 offen sc1 lds
s_add_u32 m0, s39, 52224
s_add_u32 s37, s37, s38
buffer_load_dwordx4 v23, s[8:11], s37 offen sc1 lds
s_add_u32 m0, s39, 53248
s_add_u32 s37, s37, s38
buffer_load_dwordx4 v22, s[8:11], s37 offen sc1 lds
s_add_u32 m0, s39, 54272
s_add_u32 s37, s37, s38
buffer_load_dwordx4 v23, s[8:11], s37 offen sc1 lds
s_add_u32 m0, s39, 55296
s_add_u32 s37, s37, s38
buffer_load_dwordx4 v22, s[8:11], s37 offen sc1 lds
s_add_u32 m0, s39, 56320
s_add_u32 s37, s37, s38
buffer_load_dwordx4 v23, s[8:11], s37 offen sc1 lds
s_add_u32 m0, s39, 57344
s_add_u32 s37, s37, s38
buffer_load_dwordx4 v22, s[8:11], s37 offen sc1 lds
s_add_u32 m0, s39, 58368
s_add_u32 s37, s37, s38
buffer_load_dwordx4 v23, s[8:11], s37 offen sc1 lds
s_add_u32 m0, s39, 59392
s_add_u32 s37, s37, s38
buffer_load_dwordx4 v22, s[8:11], s37 offen sc1 lds
s_add_u32 m0, s39, 60416
s_add_u32 s37, s37, s38
buffer_load_dwordx4 v23, s[8:11], s37 offen sc1 lds
s_add_u32 m0, s39, 61440
s_add_u32 s37, s37, s38
buffer_load_dwordx4 v22, s[8:11], s37 offen sc1 lds
s_add_u32 m0, s39, 62464
s_add_u32 s37, s37, s38
buffer_load_dwordx4 v23, s[8:11], s37 offen sc1 lds
s_add_u32 m0, s39, 63488
s_add_u32 s37, s37, s38
buffer_load_dwordx4 v22, s[8:11], s37 offen sc1 lds
s_add_u32 m0, s39, 64512
s_add_u32 s37, s37, s38
buffer_load_dwordx4 v23, s[8:11], s37 offen sc1 lds
s_mul_i32 s44, s34, 917504
s_lshl_b32 s39, s51, 13
s_add_u32 s44, s44, s39
s_add_u32 s44, s44, 8388608
s_and_b32 s43, s51, 1
s_xor_b32 s43, s43, s35
s_lshl_b32 s43, s43, 7
s_mov_b32 s10, 909312
s_movk_i32 s38, 1024
s_movk_i32 s40, 9216
s_movk_i32 s37, 0x4000
s_cmp_ge_u32 s51, 2
s_cselect_b32 s8, s60, s32
s_cselect_b32 s9, s61, s33
s_cselect_b32 s10, 7338112, s10
s_cselect_b32 s43, s43, s44
s_cselect_b32 s38, 16384, s38
s_cselect_b32 s40, 81920, s40
s_cselect_b32 s55, 81920, s38
s_cselect_b32 s37, 262144, s37
s_cselect_b32 s45, -1, 0
s_add_u32 s8, s8, s43
s_addc_u32 s9, s9, 0
s_mov_b32 s11, 0x20000
s_and_b32 s53, s35, 1
s_mul_i32 s54, s53, 6
s_mul_i32 s54, s54, s37
s_mul_i32 s29, s53, 2
s_add_u32 s29, s29, 6
s_mul_i32 s29, s29, s37
s_and_b32 s43, s45, 4290838528
s_add_u32 s29, s29, s43
s_mul_i32 s37, s37, 2
s_sub_u32 s37, s37, s40
v_lshrrev_b32 v19, 3, v1
v_mul_u32_u24 v19, 1920, v19
v_lshrrev_b32 v20, 4, v1
v_lshlrev_b32 v20, 5, v20
v_and_b32 v19, s45, v19
v_and_b32 v20, s45, v20
v_lshlrev_b32 v21, 4, v1
v_xor_b32 v21, v21, v20
v_add_u32 v21, v21, v19
s_waitcnt vmcnt(16)
s_barrier
s_branch LK3b_34
L7_33:
s_lshr_b32 s43, s2, 5
s_cmp_eq_u32 s43, 3
s_cbranch_scc1 Lnojob_46
s_cmp_gt_u32 s43, 3
s_cselect_b32 s43, 32, 0
s_sub_u32 s43, s2, s43
s_lshr_b32 s43, s43, 1
s_and_b32 s44, s2, 1
s_lshl_b32 s45, s44, 3
s_add_u32 s45, s45, 32
s_load_dwordx2 s[68:69], s[0:1], s45
s_mul_i32 s45, s43, 2341
s_lshr_b32 s45, s45, 16
s_mul_i32 s46, s45, 28
s_sub_u32 s46, s43, s46
v_lshrrev_b32 v4, 4, v1
s_lshl_b32 s43, s45, 8
v_add_u32 v4, s43, v4
v_mul_u32_u24 v4, 7168, v4
v_and_b32 v5, 15, v1
v_lshl_add_u32 v4, v5, 4, v4
s_lshl_b32 s43, s46, 8
v_add_u32 v4, s43, v4
s_waitcnt lgkmcnt(0)
s_mov_b32 s64, s68
s_mov_b32 s65, s69
s_mov_b32 s66, 7340032
s_mov_b32 s67, 0x20000
s_lshl_b32 s55, s45, 1
s_add_u32 s55, s55, s44
s_mul_i32 s55, s55, 14336
s_lshl_b32 s45, s46, 9
s_mov_b32 s50, s46
s_add_u32 s55, s55, s45
v_lshl_add_u32 v5, v5, 5, s55
s_add_u32 s72, s32, 27262976
s_addc_u32 s73, s33, 0
s_mov_b32 s74, 114688
s_mov_b32 s75, 0x20000
v_mov_b32 v32, 0
v_mov_b32 v33, 0
v_mov_b32 v34, 0
v_mov_b32 v35, 0
v_mov_b32 v36, 0
v_mov_b32 v37, 0
v_mov_b32 v38, 0
v_mov_b32 v39, 0
v_lshlrev_b32 v40, 16, v128
v_and_b32 v41, 0xffff0000, v128
v_lshlrev_b32 v42, 16, v129
v_and_b32 v43, 0xffff0000, v129
v_lshlrev_b32 v44, 16, v130
v_and_b32 v45, 0xffff0000, v130
v_lshlrev_b32 v46, 16, v131
v_and_b32 v47, 0xffff0000, v131
v_pk_add_f32 v[32:33], v[32:33], v[40:41]
v_pk_add_f32 v[34:35], v[34:35], v[42:43]
v_pk_add_f32 v[36:37], v[36:37], v[44:45]
v_pk_add_f32 v[38:39], v[38:39], v[46:47]
s_mov_b32 s43, 917504
buffer_load_dwordx4 v[128:131], v4, s[64:67], s43 offen
v_lshlrev_b32 v48, 16, v132
v_and_b32 v49, 0xffff0000, v132
v_lshlrev_b32 v50, 16, v133
v_and_b32 v51, 0xffff0000, v133
v_lshlrev_b32 v52, 16, v134
v_and_b32 v53, 0xffff0000, v134
v_lshlrev_b32 v54, 16, v135
v_and_b32 v55, 0xffff0000, v135
v_pk_add_f32 v[32:33], v[32:33], v[48:49]
v_pk_add_f32 v[34:35], v[34:35], v[50:51]
v_pk_add_f32 v[36:37], v[36:37], v[52:53]
v_pk_add_f32 v[38:39], v[38:39], v[54:55]
s_mov_b32 s43, 946176
buffer_load_dwordx4 v[132:135], v4, s[64:67], s43 offen
v_lshlrev_b32 v40, 16, v136
v_and_b32 v41, 0xffff0000, v136
v_lshlrev_b32 v42, 16, v137
v_and_b32 v43, 0xffff0000, v137
v_lshlrev_b32 v44, 16, v138
v_and_b32 v45, 0xffff0000, v138
v_lshlrev_b32 v46, 16, v139
v_and_b32 v47, 0xffff0000, v139
v_pk_add_f32 v[32:33], v[32:33], v[40:41]
v_pk_add_f32 v[34:35], v[34:35], v[42:43]
v_pk_add_f32 v[36:37], v[36:37], v[44:45]
v_pk_add_f32 v[38:39], v[38:39], v[46:47]
s_mov_b32 s43, 974848
buffer_load_dwordx4 v[136:139], v4, s[64:67], s43 offen
v_lshlrev_b32 v48, 16, v140
v_and_b32 v49, 0xffff0000, v140
v_lshlrev_b32 v50, 16, v141
v_and_b32 v51, 0xffff0000, v141
v_lshlrev_b32 v52, 16, v142
v_and_b32 v53, 0xffff0000, v142
v_lshlrev_b32 v54, 16, v143
v_and_b32 v55, 0xffff0000, v143
v_pk_add_f32 v[32:33], v[32:33], v[48:49]
v_pk_add_f32 v[34:35], v[34:35], v[50:51]
v_pk_add_f32 v[36:37], v[36:37], v[52:53]
v_pk_add_f32 v[38:39], v[38:39], v[54:55]
s_mov_b32 s43, 1003520
buffer_load_dwordx4 v[140:143], v4, s[64:67], s43 offen
v_lshlrev_b32 v40, 16, v144
v_and_b32 v41, 0xffff0000, v144
v_lshlrev_b32 v42, 16, v145
v_and_b32 v43, 0xffff0000, v145
v_lshlrev_b32 v44, 16, v146
v_and_b32 v45, 0xffff0000, v146
v_lshlrev_b32 v46, 16, v147
v_and_b32 v47, 0xffff0000, v147
v_pk_add_f32 v[32:33], v[32:33], v[40:41]
v_pk_add_f32 v[34:35], v[34:35], v[42:43]
v_pk_add_f32 v[36:37], v[36:37], v[44:45]
v_pk_add_f32 v[38:39], v[38:39], v[46:47]
s_mov_b32 s43, 1032192
buffer_load_dwordx4 v[144:147], v4, s[64:67], s43 offen
v_lshlrev_b32 v48, 16, v148
v_and_b32 v49, 0xffff0000, v148
v_lshlrev_b32 v50, 16, v149
v_and_b32 v51, 0xffff0000, v149
v_lshlrev_b32 v52, 16, v150
v_and_b32 v53, 0xffff0000, v150
v_lshlrev_b32 v54, 16, v151
v_and_b32 v55, 0xffff0000, v151
v_pk_add_f32 v[32:33], v[32:33], v[48:49]
v_pk_add_f32 v[34:35], v[34:35], v[50:51]
v_pk_add_f32 v[36:37], v[36:37], v[52:53]
v_pk_add_f32 v[38:39], v[38:39], v[54:55]
s_mov_b32 s43, 1060864
buffer_load_dwordx4 v[148:151], v4, s[64:67], s43 offen
v_lshlrev_b32 v40, 16, v152
v_and_b32 v41, 0xffff0000, v152
v_lshlrev_b32 v42, 16, v153
v_and_b32 v43, 0xffff0000, v153
v_lshlrev_b32 v44, 16, v154
v_and_b32 v45, 0xffff0000, v154
v_lshlrev_b32 v46, 16, v155
v_and_b32 v47, 0xffff0000, v155
v_pk_add_f32 v[32:33], v[32:33], v[40:41]
v_pk_add_f32 v[34:35], v[34:35], v[42:43]
v_pk_add_f32 v[36:37], v[36:37], v[44:45]
v_pk_add_f32 v[38:39], v[38:39], v[46:47]
s_mov_b32 s43, 1089536
buffer_load_dwordx4 v[152:155], v4, s[64:67], s43 offen
v_lshlrev_b32 v48, 16, v156
v_and_b32 v49, 0xffff0000, v156
v_lshlrev_b32 v50, 16, v157
v_and_b32 v51, 0xffff0000, v157
v_lshlrev_b32 v52, 16, v158
v_and_b32 v53, 0xffff0000, v158
v_lshlrev_b32 v54, 16, v159
v_and_b32 v55, 0xffff0000, v159
v_pk_add_f32 v[32:33], v[32:33], v[48:49]
v_pk_add_f32 v[34:35], v[34:35], v[50:51]
v_pk_add_f32 v[36:37], v[36:37], v[52:53]
v_pk_add_f32 v[38:39], v[38:39], v[54:55]
s_mov_b32 s43, 1118208
buffer_load_dwordx4 v[156:159], v4, s[64:67], s43 offen
v_lshlrev_b32 v40, 16, v160
v_and_b32 v41, 0xffff0000, v160
v_lshlrev_b32 v42, 16, v161
v_and_b32 v43, 0xffff0000, v161
v_lshlrev_b32 v44, 16, v162
v_and_b32 v45, 0xffff0000, v162
v_lshlrev_b32 v46, 16, v163
v_and_b32 v47, 0xffff0000, v163
v_pk_add_f32 v[32:33], v[32:33], v[40:41]
v_pk_add_f32 v[34:35], v[34:35], v[42:43]
v_pk_add_f32 v[36:37], v[36:37], v[44:45]
v_pk_add_f32 v[38:39], v[38:39], v[46:47]
s_mov_b32 s43, 1146880
buffer_load_dwordx4 v[160:163], v4, s[64:67], s43 offen
v_lshlrev_b32 v48, 16, v164
v_and_b32 v49, 0xffff0000, v164
v_lshlrev_b32 v50, 16, v165
v_and_b32 v51, 0xffff0000, v165
v_lshlrev_b32 v52, 16, v166
v_and_b32 v53, 0xffff0000, v166
v_lshlrev_b32 v54, 16, v167
v_and_b32 v55, 0xffff0000, v167
v_pk_add_f32 v[32:33], v[32:33], v[48:49]
v_pk_add_f32 v[34:35], v[34:35], v[50:51]
v_pk_add_f32 v[36:37], v[36:37], v[52:53]
v_pk_add_f32 v[38:39], v[38:39], v[54:55]
s_mov_b32 s43, 1175552
buffer_load_dwordx4 v[164:167], v4, s[64:67], s43 offen
v_lshlrev_b32 v40, 16, v168
v_and_b32 v41, 0xffff0000, v168
v_lshlrev_b32 v42, 16, v169
v_and_b32 v43, 0xffff0000, v169
v_lshlrev_b32 v44, 16, v170
v_and_b32 v45, 0xffff0000, v170
v_lshlrev_b32 v46, 16, v171
v_and_b32 v47, 0xffff0000, v171
v_pk_add_f32 v[32:33], v[32:33], v[40:41]
v_pk_add_f32 v[34:35], v[34:35], v[42:43]
v_pk_add_f32 v[36:37], v[36:37], v[44:45]
v_pk_add_f32 v[38:39], v[38:39], v[46:47]
s_mov_b32 s43, 1204224
buffer_load_dwordx4 v[168:171], v4, s[64:67], s43 offen
v_lshlrev_b32 v48, 16, v172
v_and_b32 v49, 0xffff0000, v172
v_lshlrev_b32 v50, 16, v173
v_and_b32 v51, 0xffff0000, v173
v_lshlrev_b32 v52, 16, v174
v_and_b32 v53, 0xffff0000, v174
v_lshlrev_b32 v54, 16, v175
v_and_b32 v55, 0xffff0000, v175
v_pk_add_f32 v[32:33], v[32:33], v[48:49]
v_pk_add_f32 v[34:35], v[34:35], v[50:51]
v_pk_add_f32 v[36:37], v[36:37], v[52:53]
v_pk_add_f32 v[38:39], v[38:39], v[54:55]
s_mov_b32 s43, 1232896
buffer_load_dwordx4 v[172:175], v4, s[64:67], s43 offen
v_lshlrev_b32 v40, 16, v176
v_and_b32 v41, 0xffff0000, v176
v_lshlrev_b32 v42, 16, v177
v_and_b32 v43, 0xffff0000, v177
v_lshlrev_b32 v44, 16, v178
v_and_b32 v45, 0xffff0000, v178
v_lshlrev_b32 v46, 16, v179
v_and_b32 v47, 0xffff0000, v179
v_pk_add_f32 v[32:33], v[32:33], v[40:41]
v_pk_add_f32 v[34:35], v[34:35], v[42:43]
v_pk_add_f32 v[36:37], v[36:37], v[44:45]
v_pk_add_f32 v[38:39], v[38:39], v[46:47]
s_mov_b32 s43, 1261568
buffer_load_dwordx4 v[176:179], v4, s[64:67], s43 offen
v_lshlrev_b32 v48, 16, v180
v_and_b32 v49, 0xffff0000, v180
v_lshlrev_b32 v50, 16, v181
v_and_b32 v51, 0xffff0000, v181
v_lshlrev_b32 v52, 16, v182
v_and_b32 v53, 0xffff0000, v182
v_lshlrev_b32 v54, 16, v183
v_and_b32 v55, 0xffff0000, v183
v_pk_add_f32 v[32:33], v[32:33], v[48:49]
v_pk_add_f32 v[34:35], v[34:35], v[50:51]
v_pk_add_f32 v[36:37], v[36:37], v[52:53]
v_pk_add_f32 v[38:39], v[38:39], v[54:55]
s_mov_b32 s43, 1290240
buffer_load_dwordx4 v[180:183], v4, s[64:67], s43 offen
v_lshlrev_b32 v40, 16, v184
v_and_b32 v41, 0xffff0000, v184
v_lshlrev_b32 v42, 16, v185
v_and_b32 v43, 0xffff0000, v185
v_lshlrev_b32 v44, 16, v186
v_and_b32 v45, 0xffff0000, v186
v_lshlrev_b32 v46, 16, v187
v_and_b32 v47, 0xffff0000, v187
v_pk_add_f32 v[32:33], v[32:33], v[40:41]
v_pk_add_f32 v[34:35], v[34:35], v[42:43]
v_pk_add_f32 v[36:37], v[36:37], v[44:45]
v_pk_add_f32 v[38:39], v[38:39], v[46:47]
s_mov_b32 s43, 1318912
buffer_load_dwordx4 v[184:187], v4, s[64:67], s43 offen
v_lshlrev_b32 v48, 16, v188
v_and_b32 v49, 0xffff0000, v188
v_lshlrev_b32 v50, 16, v189
v_and_b32 v51, 0xffff0000, v189
v_lshlrev_b32 v52, 16, v190
v_and_b32 v53, 0xffff0000, v190
v_lshlrev_b32 v54, 16, v191
v_and_b32 v55, 0xffff0000, v191
v_pk_add_f32 v[32:33], v[32:33], v[48:49]
v_pk_add_f32 v[34:35], v[34:35], v[50:51]
v_pk_add_f32 v[36:37], v[36:37], v[52:53]
v_pk_add_f32 v[38:39], v[38:39], v[54:55]
s_mov_b32 s43, 1347584
buffer_load_dwordx4 v[188:191], v4, s[64:67], s43 offen
v_lshlrev_b32 v40, 16, v192
v_and_b32 v41, 0xffff0000, v192
v_lshlrev_b32 v42, 16, v193
v_and_b32 v43, 0xffff0000, v193
v_lshlrev_b32 v44, 16, v194
v_and_b32 v45, 0xffff0000, v194
v_lshlrev_b32 v46, 16, v195
v_and_b32 v47, 0xffff0000, v195
v_pk_add_f32 v[32:33], v[32:33], v[40:41]
v_pk_add_f32 v[34:35], v[34:35], v[42:43]
v_pk_add_f32 v[36:37], v[36:37], v[44:45]
v_pk_add_f32 v[38:39], v[38:39], v[46:47]
s_mov_b32 s43, 1376256
buffer_load_dwordx4 v[192:195], v4, s[64:67], s43 offen
v_lshlrev_b32 v48, 16, v196
v_and_b32 v49, 0xffff0000, v196
v_lshlrev_b32 v50, 16, v197
v_and_b32 v51, 0xffff0000, v197
v_lshlrev_b32 v52, 16, v198
v_and_b32 v53, 0xffff0000, v198
v_lshlrev_b32 v54, 16, v199
v_and_b32 v55, 0xffff0000, v199
v_pk_add_f32 v[32:33], v[32:33], v[48:49]
v_pk_add_f32 v[34:35], v[34:35], v[50:51]
v_pk_add_f32 v[36:37], v[36:37], v[52:53]
v_pk_add_f32 v[38:39], v[38:39], v[54:55]
s_mov_b32 s43, 1404928
buffer_load_dwordx4 v[196:199], v4, s[64:67], s43 offen
v_lshlrev_b32 v40, 16, v200
v_and_b32 v41, 0xffff0000, v200
v_lshlrev_b32 v42, 16, v201
v_and_b32 v43, 0xffff0000, v201
v_lshlrev_b32 v44, 16, v202
v_and_b32 v45, 0xffff0000, v202
v_lshlrev_b32 v46, 16, v203
v_and_b32 v47, 0xffff0000, v203
v_pk_add_f32 v[32:33], v[32:33], v[40:41]
v_pk_add_f32 v[34:35], v[34:35], v[42:43]
v_pk_add_f32 v[36:37], v[36:37], v[44:45]
v_pk_add_f32 v[38:39], v[38:39], v[46:47]
s_mov_b32 s43, 1433600
buffer_load_dwordx4 v[200:203], v4, s[64:67], s43 offen
v_lshlrev_b32 v48, 16, v204
v_and_b32 v49, 0xffff0000, v204
v_lshlrev_b32 v50, 16, v205
v_and_b32 v51, 0xffff0000, v205
v_lshlrev_b32 v52, 16, v206
v_and_b32 v53, 0xffff0000, v206
v_lshlrev_b32 v54, 16, v207
v_and_b32 v55, 0xffff0000, v207
v_pk_add_f32 v[32:33], v[32:33], v[48:49]
v_pk_add_f32 v[34:35], v[34:35], v[50:51]
v_pk_add_f32 v[36:37], v[36:37], v[52:53]
v_pk_add_f32 v[38:39], v[38:39], v[54:55]
s_mov_b32 s43, 1462272
buffer_load_dwordx4 v[204:207], v4, s[64:67], s43 offen
v_lshlrev_b32 v40, 16, v208
v_and_b32 v41, 0xffff0000, v208
v_lshlrev_b32 v42, 16, v209
v_and_b32 v43, 0xffff0000, v209
v_lshlrev_b32 v44, 16, v210
v_and_b32 v45, 0xffff0000, v210
v_lshlrev_b32 v46, 16, v211
v_and_b32 v47, 0xffff0000, v211
v_pk_add_f32 v[32:33], v[32:33], v[40:41]
v_pk_add_f32 v[34:35], v[34:35], v[42:43]
v_pk_add_f32 v[36:37], v[36:37], v[44:45]
v_pk_add_f32 v[38:39], v[38:39], v[46:47]
s_mov_b32 s43, 1490944
buffer_load_dwordx4 v[208:211], v4, s[64:67], s43 offen
v_lshlrev_b32 v48, 16, v212
v_and_b32 v49, 0xffff0000, v212
v_lshlrev_b32 v50, 16, v213
v_and_b32 v51, 0xffff0000, v213
v_lshlrev_b32 v52, 16, v214
v_and_b32 v53, 0xffff0000, v214
v_lshlrev_b32 v54, 16, v215
v_and_b32 v55, 0xffff0000, v215
v_pk_add_f32 v[32:33], v[32:33], v[48:49]
v_pk_add_f32 v[34:35], v[34:35], v[50:51]
v_pk_add_f32 v[36:37], v[36:37], v[52:53]
v_pk_add_f32 v[38:39], v[38:39], v[54:55]
s_mov_b32 s43, 1519616
buffer_load_dwordx4 v[212:215], v4, s[64:67], s43 offen
v_lshlrev_b32 v40, 16, v216
v_and_b32 v41, 0xffff0000, v216
v_lshlrev_b32 v42, 16, v217
v_and_b32 v43, 0xffff0000, v217
v_lshlrev_b32 v44, 16, v218
v_and_b32 v45, 0xffff0000, v218
v_lshlrev_b32 v46, 16, v219
v_and_b32 v47, 0xffff0000, v219
v_pk_add_f32 v[32:33], v[32:33], v[40:41]
v_pk_add_f32 v[34:35], v[34:35], v[42:43]
v_pk_add_f32 v[36:37], v[36:37], v[44:45]
v_pk_add_f32 v[38:39], v[38:39], v[46:47]
s_mov_b32 s43, 1548288
buffer_load_dwordx4 v[216:219], v4, s[64:67], s43 offen
v_lshlrev_b32 v48, 16, v220
v_and_b32 v49, 0xffff0000, v220
v_lshlrev_b32 v50, 16, v221
v_and_b32 v51, 0xffff0000, v221
v_lshlrev_b32 v52, 16, v222
v_and_b32 v53, 0xffff0000, v222
v_lshlrev_b32 v54, 16, v223
v_and_b32 v55, 0xffff0000, v223
v_pk_add_f32 v[32:33], v[32:33], v[48:49]
v_pk_add_f32 v[34:35], v[34:35], v[50:51]
v_pk_add_f32 v[36:37], v[36:37], v[52:53]
v_pk_add_f32 v[38:39], v[38:39], v[54:55]
s_mov_b32 s43, 1576960
buffer_load_dwordx4 v[220:223], v4, s[64:67], s43 offen
v_lshlrev_b32 v40, 16, v224
v_and_b32 v41, 0xffff0000, v224
v_lshlrev_b32 v42, 16, v225
v_and_b32 v43, 0xffff0000, v225
v_lshlrev_b32 v44, 16, v226
v_and_b32 v45, 0xffff0000, v226
v_lshlrev_b32 v46, 16, v227
v_and_b32 v47, 0xffff0000, v227
v_pk_add_f32 v[32:33], v[32:33], v[40:41]
v_pk_add_f32 v[34:35], v[34:35], v[42:43]
v_pk_add_f32 v[36:37], v[36:37], v[44:45]
v_pk_add_f32 v[38:39], v[38:39], v[46:47]
s_mov_b32 s43, 1605632
buffer_load_dwordx4 v[224:227], v4, s[64:67], s43 offen
v_lshlrev_b32 v48, 16, v228
v_and_b32 v49, 0xffff0000, v228
v_lshlrev_b32 v50, 16, v229
v_and_b32 v51, 0xffff0000, v229
v_lshlrev_b32 v52, 16, v230
v_and_b32 v53, 0xffff0000, v230
v_lshlrev_b32 v54, 16, v231
v_and_b32 v55, 0xffff0000, v231
v_pk_add_f32 v[32:33], v[32:33], v[48:49]
v_pk_add_f32 v[34:35], v[34:35], v[50:51]
v_pk_add_f32 v[36:37], v[36:37], v[52:53]
v_pk_add_f32 v[38:39], v[38:39], v[54:55]
s_mov_b32 s43, 1634304
buffer_load_dwordx4 v[228:231], v4, s[64:67], s43 offen
v_lshlrev_b32 v40, 16, v232
v_and_b32 v41, 0xffff0000, v232
v_lshlrev_b32 v42, 16, v233
v_and_b32 v43, 0xffff0000, v233
v_lshlrev_b32 v44, 16, v234
v_and_b32 v45, 0xffff0000, v234
v_lshlrev_b32 v46, 16, v235
v_and_b32 v47, 0xffff0000, v235
v_pk_add_f32 v[32:33], v[32:33], v[40:41]
v_pk_add_f32 v[34:35], v[34:35], v[42:43]
v_pk_add_f32 v[36:37], v[36:37], v[44:45]
v_pk_add_f32 v[38:39], v[38:39], v[46:47]
s_mov_b32 s43, 1662976
buffer_load_dwordx4 v[232:235], v4, s[64:67], s43 offen
v_lshlrev_b32 v48, 16, v236
v_and_b32 v49, 0xffff0000, v236
v_lshlrev_b32 v50, 16, v237
v_and_b32 v51, 0xffff0000, v237
v_lshlrev_b32 v52, 16, v238
v_and_b32 v53, 0xffff0000, v238
v_lshlrev_b32 v54, 16, v239
v_and_b32 v55, 0xffff0000, v239
v_pk_add_f32 v[32:33], v[32:33], v[48:49]
v_pk_add_f32 v[34:35], v[34:35], v[50:51]
v_pk_add_f32 v[36:37], v[36:37], v[52:53]
v_pk_add_f32 v[38:39], v[38:39], v[54:55]
s_mov_b32 s43, 1691648
buffer_load_dwordx4 v[236:239], v4, s[64:67], s43 offen
v_lshlrev_b32 v40, 16, v240
v_and_b32 v41, 0xffff0000, v240
v_lshlrev_b32 v42, 16, v241
v_and_b32 v43, 0xffff0000, v241
v_lshlrev_b32 v44, 16, v242
v_and_b32 v45, 0xffff0000, v242
v_lshlrev_b32 v46, 16, v243
v_and_b32 v47, 0xffff0000, v243
v_pk_add_f32 v[32:33], v[32:33], v[40:41]
v_pk_add_f32 v[34:35], v[34:35], v[42:43]
v_pk_add_f32 v[36:37], v[36:37], v[44:45]
v_pk_add_f32 v[38:39], v[38:39], v[46:47]
s_mov_b32 s43, 1720320
buffer_load_dwordx4 v[240:243], v4, s[64:67], s43 offen
v_lshlrev_b32 v48, 16, v244
v_and_b32 v49, 0xffff0000, v244
v_lshlrev_b32 v50, 16, v245
v_and_b32 v51, 0xffff0000, v245
v_lshlrev_b32 v52, 16, v246
v_and_b32 v53, 0xffff0000, v246
v_lshlrev_b32 v54, 16, v247
v_and_b32 v55, 0xffff0000, v247
v_pk_add_f32 v[32:33], v[32:33], v[48:49]
v_pk_add_f32 v[34:35], v[34:35], v[50:51]
v_pk_add_f32 v[36:37], v[36:37], v[52:53]
v_pk_add_f32 v[38:39], v[38:39], v[54:55]
s_mov_b32 s43, 1748992
buffer_load_dwordx4 v[244:247], v4, s[64:67], s43 offen
v_lshlrev_b32 v40, 16, v248
v_and_b32 v41, 0xffff0000, v248
v_lshlrev_b32 v42, 16, v249
v_and_b32 v43, 0xffff0000, v249
v_lshlrev_b32 v44, 16, v250
v_and_b32 v45, 0xffff0000, v250
v_lshlrev_b32 v46, 16, v251
v_and_b32 v47, 0xffff0000, v251
v_pk_add_f32 v[32:33], v[32:33], v[40:41]
v_pk_add_f32 v[34:35], v[34:35], v[42:43]
v_pk_add_f32 v[36:37], v[36:37], v[44:45]
v_pk_add_f32 v[38:39], v[38:39], v[46:47]
s_mov_b32 s43, 1777664
buffer_load_dwordx4 v[248:251], v4, s[64:67], s43 offen
v_lshlrev_b32 v48, 16, v252
v_and_b32 v49, 0xffff0000, v252
v_lshlrev_b32 v50, 16, v253
v_and_b32 v51, 0xffff0000, v253
v_lshlrev_b32 v52, 16, v254
v_and_b32 v53, 0xffff0000, v254
v_lshlrev_b32 v54, 16, v255
v_and_b32 v55, 0xffff0000, v255
v_pk_add_f32 v[32:33], v[32:33], v[48:49]
v_pk_add_f32 v[34:35], v[34:35], v[50:51]
v_pk_add_f32 v[36:37], v[36:37], v[52:53]
v_pk_add_f32 v[38:39], v[38:39], v[54:55]
s_mov_b32 s43, 1806336
buffer_load_dwordx4 v[252:255], v4, s[64:67], s43 offen
s_barrier
s_lshl_b32 s43, s34, 18
s_add_u32 s12, s32, s43
s_addc_u32 s13, s33, 0
s_mov_b32 s14, 262144
s_mov_b32 s15, 0x20000
v_lshlrev_b32 v21, 4, v1
s_lshl_b32 s54, s36, 11
s_add_u32 s43, s35, 1
s_and_b32 s43, s43, 15
s_lshl_b32 s43, s43, 14
s_add_u32 s30, s43, s54
s_add_u32 s43, s35, 2
s_and_b32 s43, s43, 15
s_lshl_b32 s43, s43, 14
s_add_u32 s31, s43, s54
s_barrier
s_add_u32 m0, s54, 16384
s_add_u32 s43, s30, 0
buffer_load_dwordx4 v21, s[12:15], s43 offen sc1 lds
s_add_u32 m0, s54, 17408
s_add_u32 s43, s30, 1024
buffer_load_dwordx4 v21, s[12:15], s43 offen sc1 lds
s_add_u32 m0, s54, 32768
s_add_u32 s43, s31, 0
buffer_load_dwordx4 v21, s[12:15], s43 offen sc1 lds
s_add_u32 m0, s54, 33792
s_add_u32 s43, s31, 1024
buffer_load_dwordx4 v21, s[12:15], s43 offen sc1 lds
s_waitcnt vmcnt(2)
s_barrier
s_waitcnt vmcnt(0)
s_barrier
v_lshlrev_b32 v40, 16, v128
v_and_b32 v41, 0xffff0000, v128
v_lshlrev_b32 v42, 16, v129
v_and_b32 v43, 0xffff0000, v129
v_lshlrev_b32 v44, 16, v130
v_and_b32 v45, 0xffff0000, v130
v_lshlrev_b32 v46, 16, v131
v_and_b32 v47, 0xffff0000, v131
v_pk_add_f32 v[32:33], v[32:33], v[40:41]
v_pk_add_f32 v[34:35], v[34:35], v[42:43]
v_pk_add_f32 v[36:37], v[36:37], v[44:45]
v_pk_add_f32 v[38:39], v[38:39], v[46:47]
v_lshlrev_b32 v48, 16, v132
v_and_b32 v49, 0xffff0000, v132
v_lshlrev_b32 v50, 16, v133
v_and_b32 v51, 0xffff0000, v133
v_lshlrev_b32 v52, 16, v134
v_and_b32 v53, 0xffff0000, v134
v_lshlrev_b32 v54, 16, v135
v_and_b32 v55, 0xffff0000, v135
v_pk_add_f32 v[32:33], v[32:33], v[48:49]
v_pk_add_f32 v[34:35], v[34:35], v[50:51]
v_pk_add_f32 v[36:37], v[36:37], v[52:53]
v_pk_add_f32 v[38:39], v[38:39], v[54:55]
v_lshlrev_b32 v40, 16, v136
v_and_b32 v41, 0xffff0000, v136
v_lshlrev_b32 v42, 16, v137
v_and_b32 v43, 0xffff0000, v137
v_lshlrev_b32 v44, 16, v138
v_and_b32 v45, 0xffff0000, v138
v_lshlrev_b32 v46, 16, v139
v_and_b32 v47, 0xffff0000, v139
v_pk_add_f32 v[32:33], v[32:33], v[40:41]
v_pk_add_f32 v[34:35], v[34:35], v[42:43]
v_pk_add_f32 v[36:37], v[36:37], v[44:45]
v_pk_add_f32 v[38:39], v[38:39], v[46:47]
v_lshlrev_b32 v48, 16, v140
v_and_b32 v49, 0xffff0000, v140
v_lshlrev_b32 v50, 16, v141
v_and_b32 v51, 0xffff0000, v141
v_lshlrev_b32 v52, 16, v142
v_and_b32 v53, 0xffff0000, v142
v_lshlrev_b32 v54, 16, v143
v_and_b32 v55, 0xffff0000, v143
v_pk_add_f32 v[32:33], v[32:33], v[48:49]
v_pk_add_f32 v[34:35], v[34:35], v[50:51]
v_pk_add_f32 v[36:37], v[36:37], v[52:53]
v_pk_add_f32 v[38:39], v[38:39], v[54:55]
s_barrier
v_lshlrev_b32 v40, 16, v144
v_and_b32 v41, 0xffff0000, v144
v_lshlrev_b32 v42, 16, v145
v_and_b32 v43, 0xffff0000, v145
v_lshlrev_b32 v44, 16, v146
v_and_b32 v45, 0xffff0000, v146
v_lshlrev_b32 v46, 16, v147
v_and_b32 v47, 0xffff0000, v147
v_pk_add_f32 v[32:33], v[32:33], v[40:41]
v_pk_add_f32 v[34:35], v[34:35], v[42:43]
v_pk_add_f32 v[36:37], v[36:37], v[44:45]
v_pk_add_f32 v[38:39], v[38:39], v[46:47]
v_lshlrev_b32 v48, 16, v148
v_and_b32 v49, 0xffff0000, v148
v_lshlrev_b32 v50, 16, v149
v_and_b32 v51, 0xffff0000, v149
v_lshlrev_b32 v52, 16, v150
v_and_b32 v53, 0xffff0000, v150
v_lshlrev_b32 v54, 16, v151
v_and_b32 v55, 0xffff0000, v151
v_pk_add_f32 v[32:33], v[32:33], v[48:49]
v_pk_add_f32 v[34:35], v[34:35], v[50:51]
v_pk_add_f32 v[36:37], v[36:37], v[52:53]
v_pk_add_f32 v[38:39], v[38:39], v[54:55]
v_lshlrev_b32 v40, 16, v152
v_and_b32 v41, 0xffff0000, v152
v_lshlrev_b32 v42, 16, v153
v_and_b32 v43, 0xffff0000, v153
v_lshlrev_b32 v44, 16, v154
v_and_b32 v45, 0xffff0000, v154
v_lshlrev_b32 v46, 16, v155
v_and_b32 v47, 0xffff0000, v155
v_pk_add_f32 v[32:33], v[32:33], v[40:41]
v_pk_add_f32 v[34:35], v[34:35], v[42:43]
v_pk_add_f32 v[36:37], v[36:37], v[44:45]
v_pk_add_f32 v[38:39], v[38:39], v[46:47]
v_lshlrev_b32 v48, 16, v156
v_and_b32 v49, 0xffff0000, v156
v_lshlrev_b32 v50, 16, v157
v_and_b32 v51, 0xffff0000, v157
v_lshlrev_b32 v52, 16, v158
v_and_b32 v53, 0xffff0000, v158
v_lshlrev_b32 v54, 16, v159
v_and_b32 v55, 0xffff0000, v159
v_pk_add_f32 v[32:33], v[32:33], v[48:49]
v_pk_add_f32 v[34:35], v[34:35], v[50:51]
v_pk_add_f32 v[36:37], v[36:37], v[52:53]
v_pk_add_f32 v[38:39], v[38:39], v[54:55]
s_barrier
v_lshlrev_b32 v40, 16, v160
v_and_b32 v41, 0xffff0000, v160
v_lshlrev_b32 v42, 16, v161
v_and_b32 v43, 0xffff0000, v161
v_lshlrev_b32 v44, 16, v162
v_and_b32 v45, 0xffff0000, v162
v_lshlrev_b32 v46, 16, v163
v_and_b32 v47, 0xffff0000, v163
v_pk_add_f32 v[32:33], v[32:33], v[40:41]
v_pk_add_f32 v[34:35], v[34:35], v[42:43]
v_pk_add_f32 v[36:37], v[36:37], v[44:45]
v_pk_add_f32 v[38:39], v[38:39], v[46:47]
v_lshlrev_b32 v48, 16, v164
v_and_b32 v49, 0xffff0000, v164
v_lshlrev_b32 v50, 16, v165
v_and_b32 v51, 0xffff0000, v165
v_lshlrev_b32 v52, 16, v166
v_and_b32 v53, 0xffff0000, v166
v_lshlrev_b32 v54, 16, v167
v_and_b32 v55, 0xffff0000, v167
v_pk_add_f32 v[32:33], v[32:33], v[48:49]
v_pk_add_f32 v[34:35], v[34:35], v[50:51]
v_pk_add_f32 v[36:37], v[36:37], v[52:53]
v_pk_add_f32 v[38:39], v[38:39], v[54:55]
v_lshlrev_b32 v40, 16, v168
v_and_b32 v41, 0xffff0000, v168
v_lshlrev_b32 v42, 16, v169
v_and_b32 v43, 0xffff0000, v169
v_lshlrev_b32 v44, 16, v170
v_and_b32 v45, 0xffff0000, v170
v_lshlrev_b32 v46, 16, v171
v_and_b32 v47, 0xffff0000, v171
v_pk_add_f32 v[32:33], v[32:33], v[40:41]
v_pk_add_f32 v[34:35], v[34:35], v[42:43]
v_pk_add_f32 v[36:37], v[36:37], v[44:45]
v_pk_add_f32 v[38:39], v[38:39], v[46:47]
v_lshlrev_b32 v48, 16, v172
v_and_b32 v49, 0xffff0000, v172
v_lshlrev_b32 v50, 16, v173
v_and_b32 v51, 0xffff0000, v173
v_lshlrev_b32 v52, 16, v174
v_and_b32 v53, 0xffff0000, v174
v_lshlrev_b32 v54, 16, v175
v_and_b32 v55, 0xffff0000, v175
v_pk_add_f32 v[32:33], v[32:33], v[48:49]
v_pk_add_f32 v[34:35], v[34:35], v[50:51]
v_pk_add_f32 v[36:37], v[36:37], v[52:53]
v_pk_add_f32 v[38:39], v[38:39], v[54:55]
s_barrier
v_lshlrev_b32 v40, 16, v176
v_and_b32 v41, 0xffff0000, v176
v_lshlrev_b32 v42, 16, v177
v_and_b32 v43, 0xffff0000, v177
v_lshlrev_b32 v44, 16, v178
v_and_b32 v45, 0xffff0000, v178
v_lshlrev_b32 v46, 16, v179
v_and_b32 v47, 0xffff0000, v179
v_pk_add_f32 v[32:33], v[32:33], v[40:41]
v_pk_add_f32 v[34:35], v[34:35], v[42:43]
v_pk_add_f32 v[36:37], v[36:37], v[44:45]
v_pk_add_f32 v[38:39], v[38:39], v[46:47]
v_lshlrev_b32 v48, 16, v180
v_and_b32 v49, 0xffff0000, v180
v_lshlrev_b32 v50, 16, v181
v_and_b32 v51, 0xffff0000, v181
v_lshlrev_b32 v52, 16, v182
v_and_b32 v53, 0xffff0000, v182
v_lshlrev_b32 v54, 16, v183
v_and_b32 v55, 0xffff0000, v183
v_pk_add_f32 v[32:33], v[32:33], v[48:49]
v_pk_add_f32 v[34:35], v[34:35], v[50:51]
v_pk_add_f32 v[36:37], v[36:37], v[52:53]
v_pk_add_f32 v[38:39], v[38:39], v[54:55]
v_lshlrev_b32 v40, 16, v184
v_and_b32 v41, 0xffff0000, v184
v_lshlrev_b32 v42, 16, v185
v_and_b32 v43, 0xffff0000, v185
v_lshlrev_b32 v44, 16, v186
v_and_b32 v45, 0xffff0000, v186
v_lshlrev_b32 v46, 16, v187
v_and_b32 v47, 0xffff0000, v187
v_pk_add_f32 v[32:33], v[32:33], v[40:41]
v_pk_add_f32 v[34:35], v[34:35], v[42:43]
v_pk_add_f32 v[36:37], v[36:37], v[44:45]
v_pk_add_f32 v[38:39], v[38:39], v[46:47]
v_lshlrev_b32 v48, 16, v188
v_and_b32 v49, 0xffff0000, v188
v_lshlrev_b32 v50, 16, v189
v_and_b32 v51, 0xffff0000, v189
v_lshlrev_b32 v52, 16, v190
v_and_b32 v53, 0xffff0000, v190
v_lshlrev_b32 v54, 16, v191
v_and_b32 v55, 0xffff0000, v191
v_pk_add_f32 v[32:33], v[32:33], v[48:49]
v_pk_add_f32 v[34:35], v[34:35], v[50:51]
v_pk_add_f32 v[36:37], v[36:37], v[52:53]
v_pk_add_f32 v[38:39], v[38:39], v[54:55]
s_barrier
v_lshlrev_b32 v40, 16, v192
v_and_b32 v41, 0xffff0000, v192
v_lshlrev_b32 v42, 16, v193
v_and_b32 v43, 0xffff0000, v193
v_lshlrev_b32 v44, 16, v194
v_and_b32 v45, 0xffff0000, v194
v_lshlrev_b32 v46, 16, v195
v_and_b32 v47, 0xffff0000, v195
v_pk_add_f32 v[32:33], v[32:33], v[40:41]
v_pk_add_f32 v[34:35], v[34:35], v[42:43]
v_pk_add_f32 v[36:37], v[36:37], v[44:45]
v_pk_add_f32 v[38:39], v[38:39], v[46:47]
v_lshlrev_b32 v48, 16, v196
v_and_b32 v49, 0xffff0000, v196
v_lshlrev_b32 v50, 16, v197
v_and_b32 v51, 0xffff0000, v197
v_lshlrev_b32 v52, 16, v198
v_and_b32 v53, 0xffff0000, v198
v_lshlrev_b32 v54, 16, v199
v_and_b32 v55, 0xffff0000, v199
v_pk_add_f32 v[32:33], v[32:33], v[48:49]
v_pk_add_f32 v[34:35], v[34:35], v[50:51]
v_pk_add_f32 v[36:37], v[36:37], v[52:53]
v_pk_add_f32 v[38:39], v[38:39], v[54:55]
v_lshlrev_b32 v40, 16, v200
v_and_b32 v41, 0xffff0000, v200
v_lshlrev_b32 v42, 16, v201
v_and_b32 v43, 0xffff0000, v201
v_lshlrev_b32 v44, 16, v202
v_and_b32 v45, 0xffff0000, v202
v_lshlrev_b32 v46, 16, v203
v_and_b32 v47, 0xffff0000, v203
v_pk_add_f32 v[32:33], v[32:33], v[40:41]
v_pk_add_f32 v[34:35], v[34:35], v[42:43]
v_pk_add_f32 v[36:37], v[36:37], v[44:45]
v_pk_add_f32 v[38:39], v[38:39], v[46:47]
v_lshlrev_b32 v48, 16, v204
v_and_b32 v49, 0xffff0000, v204
v_lshlrev_b32 v50, 16, v205
v_and_b32 v51, 0xffff0000, v205
v_lshlrev_b32 v52, 16, v206
v_and_b32 v53, 0xffff0000, v206
v_lshlrev_b32 v54, 16, v207
v_and_b32 v55, 0xffff0000, v207
v_pk_add_f32 v[32:33], v[32:33], v[48:49]
v_pk_add_f32 v[34:35], v[34:35], v[50:51]
v_pk_add_f32 v[36:37], v[36:37], v[52:53]
v_pk_add_f32 v[38:39], v[38:39], v[54:55]
s_barrier
v_lshlrev_b32 v40, 16, v208
v_and_b32 v41, 0xffff0000, v208
v_lshlrev_b32 v42, 16, v209
v_and_b32 v43, 0xffff0000, v209
v_lshlrev_b32 v44, 16, v210
v_and_b32 v45, 0xffff0000, v210
v_lshlrev_b32 v46, 16, v211
v_and_b32 v47, 0xffff0000, v211
v_pk_add_f32 v[32:33], v[32:33], v[40:41]
v_pk_add_f32 v[34:35], v[34:35], v[42:43]
v_pk_add_f32 v[36:37], v[36:37], v[44:45]
v_pk_add_f32 v[38:39], v[38:39], v[46:47]
v_lshlrev_b32 v48, 16, v212
v_and_b32 v49, 0xffff0000, v212
v_lshlrev_b32 v50, 16, v213
v_and_b32 v51, 0xffff0000, v213
v_lshlrev_b32 v52, 16, v214
v_and_b32 v53, 0xffff0000, v214
v_lshlrev_b32 v54, 16, v215
v_and_b32 v55, 0xffff0000, v215
v_pk_add_f32 v[32:33], v[32:33], v[48:49]
v_pk_add_f32 v[34:35], v[34:35], v[50:51]
v_pk_add_f32 v[36:37], v[36:37], v[52:53]
v_pk_add_f32 v[38:39], v[38:39], v[54:55]
v_lshlrev_b32 v40, 16, v216
v_and_b32 v41, 0xffff0000, v216
v_lshlrev_b32 v42, 16, v217
v_and_b32 v43, 0xffff0000, v217
v_lshlrev_b32 v44, 16, v218
v_and_b32 v45, 0xffff0000, v218
v_lshlrev_b32 v46, 16, v219
v_and_b32 v47, 0xffff0000, v219
v_pk_add_f32 v[32:33], v[32:33], v[40:41]
v_pk_add_f32 v[34:35], v[34:35], v[42:43]
v_pk_add_f32 v[36:37], v[36:37], v[44:45]
v_pk_add_f32 v[38:39], v[38:39], v[46:47]
v_lshlrev_b32 v48, 16, v220
v_and_b32 v49, 0xffff0000, v220
v_lshlrev_b32 v50, 16, v221
v_and_b32 v51, 0xffff0000, v221
v_lshlrev_b32 v52, 16, v222
v_and_b32 v53, 0xffff0000, v222
v_lshlrev_b32 v54, 16, v223
v_and_b32 v55, 0xffff0000, v223
v_pk_add_f32 v[32:33], v[32:33], v[48:49]
v_pk_add_f32 v[34:35], v[34:35], v[50:51]
v_pk_add_f32 v[36:37], v[36:37], v[52:53]
v_pk_add_f32 v[38:39], v[38:39], v[54:55]
s_barrier
v_lshlrev_b32 v40, 16, v224
v_and_b32 v41, 0xffff0000, v224
v_lshlrev_b32 v42, 16, v225
v_and_b32 v43, 0xffff0000, v225
v_lshlrev_b32 v44, 16, v226
v_and_b32 v45, 0xffff0000, v226
v_lshlrev_b32 v46, 16, v227
v_and_b32 v47, 0xffff0000, v227
v_pk_add_f32 v[32:33], v[32:33], v[40:41]
v_pk_add_f32 v[34:35], v[34:35], v[42:43]
v_pk_add_f32 v[36:37], v[36:37], v[44:45]
v_pk_add_f32 v[38:39], v[38:39], v[46:47]
v_lshlrev_b32 v48, 16, v228
v_and_b32 v49, 0xffff0000, v228
v_lshlrev_b32 v50, 16, v229
v_and_b32 v51, 0xffff0000, v229
v_lshlrev_b32 v52, 16, v230
v_and_b32 v53, 0xffff0000, v230
v_lshlrev_b32 v54, 16, v231
v_and_b32 v55, 0xffff0000, v231
v_pk_add_f32 v[32:33], v[32:33], v[48:49]
v_pk_add_f32 v[34:35], v[34:35], v[50:51]
v_pk_add_f32 v[36:37], v[36:37], v[52:53]
v_pk_add_f32 v[38:39], v[38:39], v[54:55]
v_lshlrev_b32 v40, 16, v232
v_and_b32 v41, 0xffff0000, v232
v_lshlrev_b32 v42, 16, v233
v_and_b32 v43, 0xffff0000, v233
v_lshlrev_b32 v44, 16, v234
v_and_b32 v45, 0xffff0000, v234
v_lshlrev_b32 v46, 16, v235
v_and_b32 v47, 0xffff0000, v235
v_pk_add_f32 v[32:33], v[32:33], v[40:41]
v_pk_add_f32 v[34:35], v[34:35], v[42:43]
v_pk_add_f32 v[36:37], v[36:37], v[44:45]
v_pk_add_f32 v[38:39], v[38:39], v[46:47]
v_lshlrev_b32 v48, 16, v236
v_and_b32 v49, 0xffff0000, v236
v_lshlrev_b32 v50, 16, v237
v_and_b32 v51, 0xffff0000, v237
v_lshlrev_b32 v52, 16, v238
v_and_b32 v53, 0xffff0000, v238
v_lshlrev_b32 v54, 16, v239
v_and_b32 v55, 0xffff0000, v239
v_pk_add_f32 v[32:33], v[32:33], v[48:49]
v_pk_add_f32 v[34:35], v[34:35], v[50:51]
v_pk_add_f32 v[36:37], v[36:37], v[52:53]
v_pk_add_f32 v[38:39], v[38:39], v[54:55]
s_barrier
v_lshlrev_b32 v40, 16, v240
v_and_b32 v41, 0xffff0000, v240
v_lshlrev_b32 v42, 16, v241
v_and_b32 v43, 0xffff0000, v241
v_lshlrev_b32 v44, 16, v242
v_and_b32 v45, 0xffff0000, v242
v_lshlrev_b32 v46, 16, v243
v_and_b32 v47, 0xffff0000, v243
v_pk_add_f32 v[32:33], v[32:33], v[40:41]
v_pk_add_f32 v[34:35], v[34:35], v[42:43]
v_pk_add_f32 v[36:37], v[36:37], v[44:45]
v_pk_add_f32 v[38:39], v[38:39], v[46:47]
v_lshlrev_b32 v48, 16, v244
v_and_b32 v49, 0xffff0000, v244
v_lshlrev_b32 v50, 16, v245
v_and_b32 v51, 0xffff0000, v245
v_lshlrev_b32 v52, 16, v246
v_and_b32 v53, 0xffff0000, v246
v_lshlrev_b32 v54, 16, v247
v_and_b32 v55, 0xffff0000, v247
v_pk_add_f32 v[32:33], v[32:33], v[48:49]
v_pk_add_f32 v[34:35], v[34:35], v[50:51]
v_pk_add_f32 v[36:37], v[36:37], v[52:53]
v_pk_add_f32 v[38:39], v[38:39], v[54:55]
v_lshlrev_b32 v40, 16, v248
v_and_b32 v41, 0xffff0000, v248
v_lshlrev_b32 v42, 16, v249
v_and_b32 v43, 0xffff0000, v249
v_lshlrev_b32 v44, 16, v250
v_and_b32 v45, 0xffff0000, v250
v_lshlrev_b32 v46, 16, v251
v_and_b32 v47, 0xffff0000, v251
v_pk_add_f32 v[32:33], v[32:33], v[40:41]
v_pk_add_f32 v[34:35], v[34:35], v[42:43]
v_pk_add_f32 v[36:37], v[36:37], v[44:45]
v_pk_add_f32 v[38:39], v[38:39], v[46:47]
v_lshlrev_b32 v48, 16, v252
v_and_b32 v49, 0xffff0000, v252
v_lshlrev_b32 v50, 16, v253
v_and_b32 v51, 0xffff0000, v253
v_lshlrev_b32 v52, 16, v254
v_and_b32 v53, 0xffff0000, v254
v_lshlrev_b32 v54, 16, v255
v_and_b32 v55, 0xffff0000, v255
v_pk_add_f32 v[32:33], v[32:33], v[48:49]
v_pk_add_f32 v[34:35], v[34:35], v[50:51]
v_pk_add_f32 v[36:37], v[36:37], v[52:53]
v_pk_add_f32 v[38:39], v[38:39], v[54:55]
s_barrier
s_nop 2
v_mov_b32 v40, v32
v_mov_b32 v41, v33
v_mov_b32 v42, v34
v_mov_b32 v43, v35
v_mov_b32 v44, v36
v_mov_b32 v45, v37
v_mov_b32 v46, v38
v_mov_b32 v47, v39
s_nop 0
v_permlane16_swap_b32 v32, v40
v_permlane16_swap_b32 v33, v41
v_permlane16_swap_b32 v34, v42
v_permlane16_swap_b32 v35, v43
v_permlane16_swap_b32 v36, v44
v_permlane16_swap_b32 v37, v45
v_permlane16_swap_b32 v38, v46
v_permlane16_swap_b32 v39, v47
v_add_f32 v32, v32, v40
v_add_f32 v33, v33, v41
v_add_f32 v34, v34, v42
v_add_f32 v35, v35, v43
v_add_f32 v36, v36, v44
v_add_f32 v37, v37, v45
v_add_f32 v38, v38, v46
v_add_f32 v39, v39, v47
v_mov_b32 v40, v32
v_mov_b32 v41, v33
v_mov_b32 v42, v34
v_mov_b32 v43, v35
v_mov_b32 v44, v36
v_mov_b32 v45, v37
v_mov_b32 v46, v38
v_mov_b32 v47, v39
s_nop 0
v_permlane32_swap_b32 v32, v40
v_permlane32_swap_b32 v33, v41
v_permlane32_swap_b32 v34, v42
v_permlane32_swap_b32 v35, v43
v_permlane32_swap_b32 v36, v44
v_permlane32_swap_b32 v37, v45
v_permlane32_swap_b32 v38, v46
v_permlane32_swap_b32 v39, v47
v_add_f32 v32, v32, v40
v_add_f32 v33, v33, v41
v_add_f32 v34, v34, v42
v_add_f32 v35, v35, v43
v_add_f32 v36, v36, v44
v_add_f32 v37, v37, v45
v_add_f32 v38, v38, v46
v_add_f32 v39, v39, v47
s_mov_b64 exec, 0xffff
buffer_store_dwordx4 v[32:35], v5, s[72:75], 0 offen sc1
buffer_store_dwordx4 v[36:39], v5, s[72:75], 0 offen offset:16 sc1
s_mov_b64 exec, -1
s_barrier
s_barrier
s_barrier
s_barrier
s_barrier
s_barrier
s_barrier
s_waitcnt vmcnt(0)
s_add_u32 s43, s50, 96
s_lshl_b32 s43, s43, 7
v_mov_b32 v12, s43
v_mov_b32 v13, 1
s_mov_b64 exec, 1
buffer_atomic_add v13, v12, s[56:59], 0 offen sc1
s_mov_b64 exec, -1
s_branch Lcsd_47
Lnojob_46:
s_barrier
s_lshl_b32 s43, s34, 18
s_add_u32 s12, s32, s43
s_addc_u32 s13, s33, 0
s_mov_b32 s14, 262144
s_mov_b32 s15, 0x20000
v_lshlrev_b32 v21, 4, v1
s_lshl_b32 s54, s36, 11
s_add_u32 s43, s35, 1
s_and_b32 s43, s43, 15
s_lshl_b32 s43, s43, 14
s_add_u32 s30, s43, s54
s_add_u32 s43, s35, 2
s_and_b32 s43, s43, 15
s_lshl_b32 s43, s43, 14
s_add_u32 s31, s43, s54
s_barrier
s_add_u32 m0, s54, 16384
s_add_u32 s43, s30, 0
buffer_load_dwordx4 v21, s[12:15], s43 offen sc1 lds
s_add_u32 m0, s54, 17408
s_add_u32 s43, s30, 1024
buffer_load_dwordx4 v21, s[12:15], s43 offen sc1 lds
s_add_u32 m0, s54, 32768
s_add_u32 s43, s31, 0
buffer_load_dwordx4 v21, s[12:15], s43 offen sc1 lds
s_add_u32 m0, s54, 33792
s_add_u32 s43, s31, 1024
buffer_load_dwordx4 v21, s[12:15], s43 offen sc1 lds
s_waitcnt vmcnt(2)
s_barrier
s_waitcnt vmcnt(0)
s_barrier
s_barrier
s_barrier
s_barrier
s_barrier
s_barrier
s_barrier
s_barrier
s_barrier
s_barrier
s_barrier
s_barrier
s_barrier
s_barrier
s_barrier
s_barrier
Lcsd_47:
s_mov_b32 s46, 1
s_lshl_b32 s43, s34, 18
s_add_u32 s12, s32, s43
s_addc_u32 s13, s33, 0
s_add_u32 s12, s12, 4194304
s_addc_u32 s13, s13, 0
s_mov_b32 s14, 262144
s_mov_b32 s15, 0x20000
v_lshlrev_b32 v21, 4, v1
s_lshl_b32 s54, s36, 11
s_add_u32 s43, s35, 1
s_and_b32 s43, s43, 15
s_lshl_b32 s43, s43, 14
s_add_u32 s30, s43, s54
s_add_u32 s43, s35, 2
s_and_b32 s43, s43, 15
s_lshl_b32 s43, s43, 14
s_add_u32 s31, s43, s54
s_mov_b32 s88, s4
s_mov_b32 s89, s5
s_mov_b32 s90, 7340032
s_mov_b32 s91, 0x20000
s_mov_b32 s92, s6
s_mov_b32 s93, s7
s_mov_b32 s94, 7340032
s_mov_b32 s95, 0x20000
s_lshr_b32 s43, s35, 3
v_and_b32 v19, 1, v1
v_bfe_u32 v23, v1, 2, 3
s_lshl_b32 s44, s43, 3
s_add_u32 s44, s44, 1
v_lshl_add_u32 v23, v19, 2, v23
v_add_u32 v23, s44, v23
s_lshl_b32 s43, s43, 11
s_add_u32 s43, s43, 384
s_movk_i32 s44, 1024
s_lshr_b32 s45, s2, 3
s_mul_i32 s45, s45, 14336
s_add_u32 s43, s43, s45
v_mul_lo_u32 v31, v19, s44
v_bfe_u32 v19, v1, 1, 1
v_mul_u32_u24 v19, 7168, v19
v_add3_u32 v31, v31, v19, s43
v_add_u32 v19, 3, v23
v_and_b32 v19, 15, v19
v_mul_u32_u24 v19, 458752, v19
v_add_u32 v19, v19, v31
buffer_load_dword v30, v19, s[88:91], 0 offen
buffer_load_dword v30, v19, s[92:95], 0 offen
s_lshl_b32 s43, s34, 14
s_add_u32 s64, s32, s43
s_addc_u32 s65, s33, 0
s_add_u32 s64, s64, 25165824
s_addc_u32 s65, s65, 0
s_mov_b32 s66, 16384
s_mov_b32 s67, 0x20000
s_add_u32 s72, s32, 27262976
s_addc_u32 s73, s33, 0
s_mov_b32 s74, 114688
s_mov_b32 s75, 0x20000
s_barrier
s_add_u32 m0, s54, 0
s_add_u32 s43, s30, 0
buffer_load_dwordx4 v21, s[12:15], s43 offen sc1 lds
s_add_u32 m0, s54, 1024
s_add_u32 s43, s30, 1024
buffer_load_dwordx4 v21, s[12:15], s43 offen sc1 lds
s_add_u32 m0, s54, 49152
s_add_u32 s43, s31, 0
buffer_load_dwordx4 v21, s[12:15], s43 offen sc1 lds
s_add_u32 m0, s54, 50176
s_add_u32 s43, s31, 1024
buffer_load_dwordx4 v21, s[12:15], s43 offen sc1 lds
s_waitcnt vmcnt(2)
s_barrier
s_waitcnt vmcnt(0)
s_mul_i32 s43, s2, 28672
s_mul_i32 s44, s51, 7168
s_add_u32 s43, s43, s44
s_add_u32 s80, s60, s43
s_addc_u32 s81, s61, 0
s_load_dword s82, s[80:81], 0
s_load_dword s83, s[80:81], 64
s_load_dword s84, s[80:81], 128
s_load_dword s85, s[80:81], 192
s_load_dword s86, s[80:81], 256
s_load_dword s87, s[80:81], 320
s_load_dword s82, s[80:81], 384
s_load_dword s83, s[80:81], 448
s_load_dword s84, s[80:81], 512
s_load_dword s85, s[80:81], 576
s_load_dword s86, s[80:81], 640
s_add_u32 s80, s80, 704
s_addc_u32 s81, s81, 0
s_barrier
s_mov_b32 s43, 0
buffer_load_dwordx4 v[128:131], v21, s[64:67], s43 offen sc1
s_mov_b32 s43, 1024
buffer_load_dwordx4 v[132:135], v21, s[64:67], s43 offen sc1
s_mov_b32 s43, 2048
buffer_load_dwordx4 v[136:139], v21, s[64:67], s43 offen sc1
s_mov_b32 s43, 3072
buffer_load_dwordx4 v[140:143], v21, s[64:67], s43 offen sc1
s_mov_b32 s43, 4096
buffer_load_dwordx4 v[144:147], v21, s[64:67], s43 offen sc1
s_mov_b32 s43, 5120
buffer_load_dwordx4 v[148:151], v21, s[64:67], s43 offen sc1
s_mov_b32 s43, 6144
buffer_load_dwordx4 v[152:155], v21, s[64:67], s43 offen sc1
s_mov_b32 s43, 7168
buffer_load_dwordx4 v[156:159], v21, s[64:67], s43 offen sc1
s_mov_b32 s43, 8192
buffer_load_dwordx4 v[160:163], v21, s[64:67], s43 offen sc1
s_mov_b32 s43, 9216
buffer_load_dwordx4 v[164:167], v21, s[64:67], s43 offen sc1
s_mov_b32 s43, 10240
buffer_load_dwordx4 v[168:171], v21, s[64:67], s43 offen sc1
s_mov_b32 s43, 11264
buffer_load_dwordx4 v[172:175], v21, s[64:67], s43 offen sc1
s_mov_b32 s43, 12288
buffer_load_dwordx4 v[176:179], v21, s[64:67], s43 offen sc1
s_mov_b32 s43, 13312
buffer_load_dwordx4 v[180:183], v21, s[64:67], s43 offen sc1
s_mov_b32 s43, 14336
buffer_load_dwordx4 v[184:187], v21, s[64:67], s43 offen sc1
s_mov_b32 s43, 15360
buffer_load_dwordx4 v[188:191], v21, s[64:67], s43 offen sc1
s_load_dword s82, s[80:81], 0
s_load_dword s83, s[80:81], 64
s_load_dword s84, s[80:81], 128
s_load_dword s85, s[80:81], 192
s_load_dword s86, s[80:81], 256
s_load_dword s87, s[80:81], 320
s_load_dword s82, s[80:81], 384
s_load_dword s83, s[80:81], 448
s_load_dword s84, s[80:81], 512
s_load_dword s85, s[80:81], 576
s_load_dword s86, s[80:81], 640
s_add_u32 s80, s80, 704
s_addc_u32 s81, s81, 0
s_barrier
s_mul_i32 s43, s49, 96
s_add_u32 s44, s43, 95
s_lshr_b32 s43, s43, 7
s_lshr_b32 s44, s44, 7
s_add_u32 s43, s43, 16
s_add_u32 s44, s44, 16
v_mov_b32 v12, s44
v_writelane_b32 v12, s35, 0
v_writelane_b32 v12, s43, 1
v_add_u32 v12, 96, v12
v_lshlrev_b32 v12, 7, v12
v_mov_b32 v14, 8
buffer_load_dword v13, v12, s[56:59], 0 offen sc1
s_load_dword s82, s[80:81], 0
s_load_dword s83, s[80:81], 64
s_load_dword s84, s[80:81], 128
s_load_dword s85, s[80:81], 192
s_load_dword s86, s[80:81], 256
s_load_dword s87, s[80:81], 320
s_load_dword s82, s[80:81], 384
s_load_dword s83, s[80:81], 448
s_load_dword s84, s[80:81], 512
s_load_dword s85, s[80:81], 576
s_load_dword s86, s[80:81], 640
s_add_u32 s80, s80, 704
s_addc_u32 s81, s81, 0
s_barrier
s_load_dword s82, s[80:81], 0
s_load_dword s83, s[80:81], 64
s_load_dword s84, s[80:81], 128
s_load_dword s85, s[80:81], 192
s_load_dword s86, s[80:81], 256
s_load_dword s87, s[80:81], 320
s_load_dword s82, s[80:81], 384
s_load_dword s83, s[80:81], 448
s_load_dword s84, s[80:81], 512
s_load_dword s85, s[80:81], 576
s_load_dword s86, s[80:81], 640
s_add_u32 s80, s80, 704
s_addc_u32 s81, s81, 0
s_barrier
s_mov_b32 s41, 0x10000
Lpoll_48:
s_waitcnt vmcnt(0)
Lpf_50:
v_cmp_ne_u32 vcc, v14, v13
s_nop 4
s_cbranch_vccz Lpok_49
buffer_load_dword v13, v12, s[56:59], 0 offen sc1
s_sub_u32 s41, s41, 1
s_cmp_lg_u32 s41, 0
s_cbranch_scc1 Lpoll_48
s_waitcnt vmcnt(0)
Lpok_49:
v_min_u32 v12, 55, v1
v_lshlrev_b32 v13, 4, v12
s_lshl_b32 s43, s35, 9
s_mul_i32 s44, s49, 384
s_add_u32 s44, s44, 7680
v_mov_b32 v14, s44
v_mov_b32 v15, s43
v_cmp_gt_u32 vcc, 32, v12
s_nop 1
v_cndmask_b32 v14, v14, v15, vcc
v_add_u32 v14, v14, v13
v_add_u32 v13, 148480, v13
s_mov_b32 s43, 0
buffer_load_dwordx4 v[192:195], v14, s[72:75], s43 offen sc1
s_mov_b32 s43, 28672
buffer_load_dwordx4 v[196:199], v14, s[72:75], s43 offen sc1
s_mov_b32 s43, 57344
buffer_load_dwordx4 v[200:203], v14, s[72:75], s43 offen sc1
s_mov_b32 s43, 86016
buffer_load_dwordx4 v[204:207], v14, s[72:75], s43 offen sc1
s_mov_b32 s43, 14336
buffer_load_dwordx4 v[208:211], v14, s[72:75], s43 offen sc1
s_mov_b32 s43, 43008
buffer_load_dwordx4 v[212:215], v14, s[72:75], s43 offen sc1
s_mov_b32 s43, 71680
buffer_load_dwordx4 v[216:219], v14, s[72:75], s43 offen sc1
s_mov_b32 s43, 100352
buffer_load_dwordx4 v[220:223], v14, s[72:75], s43 offen sc1
s_load_dword s82, s[80:81], 0
s_load_dword s83, s[80:81], 64
s_load_dword s84, s[80:81], 128
s_load_dword s85, s[80:81], 192
s_load_dword s86, s[80:81], 256
s_load_dword s87, s[80:81], 320
s_load_dword s82, s[80:81], 384
s_load_dword s83, s[80:81], 448
s_load_dword s84, s[80:81], 512
s_load_dword s85, s[80:81], 576
s_load_dword s86, s[80:81], 640
s_add_u32 s80, s80, 704
s_addc_u32 s81, s81, 0
s_barrier
v_add_u32 v19, 8, v23
v_and_b32 v19, 15, v19
v_mul_u32_u24 v19, 458752, v19
v_add_u32 v19, v19, v31
buffer_load_dword v30, v19, s[88:91], 0 offen
buffer_load_dword v30, v19, s[92:95], 0 offen
v_add_f32 v128, v128, v132
v_add_f32 v129, v129, v133
v_add_f32 v130, v130, v134
v_add_f32 v131, v131, v135
v_add_f32 v128, v128, v136
v_add_f32 v129, v129, v137
v_add_f32 v130, v130, v138
v_add_f32 v131, v131, v139
v_add_f32 v128, v128, v140
v_add_f32 v129, v129, v141
v_add_f32 v130, v130, v142
v_add_f32 v131, v131, v143
v_add_f32 v128, v128, v144
v_add_f32 v129, v129, v145
v_add_f32 v130, v130, v146
v_add_f32 v131, v131, v147
v_add_f32 v128, v128, v148
v_add_f32 v129, v129, v149
v_add_f32 v130, v130, v150
v_add_f32 v131, v131, v151
v_add_f32 v128, v128, v152
v_add_f32 v129, v129, v153
v_add_f32 v130, v130, v154
v_add_f32 v131, v131, v155
v_add_f32 v128, v128, v156
v_add_f32 v129, v129, v157
v_add_f32 v130, v130, v158
v_add_f32 v131, v131, v159
v_add_f32 v128, v128, v160
v_add_f32 v129, v129, v161
v_add_f32 v130, v130, v162
v_add_f32 v131, v131, v163
v_add_f32 v128, v128, v164
v_add_f32 v129, v129, v165
v_add_f32 v130, v130, v166
v_add_f32 v131, v131, v167
v_add_f32 v128, v128, v168
v_add_f32 v129, v129, v169
v_add_f32 v130, v130, v170
v_add_f32 v131, v131, v171
v_add_f32 v128, v128, v172
v_add_f32 v129, v129, v173
v_add_f32 v130, v130, v174
v_add_f32 v131, v131, v175
v_add_f32 v128, v128, v176
v_add_f32 v129, v129, v177
v_add_f32 v130, v130, v178
v_add_f32 v131, v131, v179
v_add_f32 v128, v128, v180
v_add_f32 v129, v129, v181
v_add_f32 v130, v130, v182
v_add_f32 v131, v131, v183
v_add_f32 v128, v128, v184
v_add_f32 v129, v129, v185
v_add_f32 v130, v130, v186
v_add_f32 v131, v131, v187
v_add_f32 v128, v128, v188
v_add_f32 v129, v129, v189
v_add_f32 v130, v130, v190
v_add_f32 v131, v131, v191
v_mul_f32 v128, 0x3a800000, v128
v_mul_f32 v129, 0x3a800000, v129
v_fma_f32 v129, -v128, v128, v129
v_max_f32 v129, 0, v129
v_add_f32 v129, 0x3727c5ac, v129
v_rsq_f32 v129, v129
v_mul_f32 v130, 0x3a800000, v130
v_mul_f32 v131, 0x3a800000, v131
v_fma_f32 v131, -v130, v130, v131
v_max_f32 v131, 0, v131
v_add_f32 v131, 0x3727c5ac, v131
v_rsq_f32 v131, v131
v_add_u32 v19, 147456, v21
ds_write_b128 v19, v[128:131]
s_load_dword s82, s[80:81], 0
s_load_dword s83, s[80:81], 64
s_load_dword s84, s[80:81], 128
s_load_dword s85, s[80:81], 192
s_load_dword s86, s[80:81], 256
s_load_dword s87, s[80:81], 320
s_load_dword s82, s[80:81], 384
s_load_dword s83, s[80:81], 448
s_load_dword s84, s[80:81], 512
s_load_dword s85, s[80:81], 576
s_load_dword s86, s[80:81], 640
s_add_u32 s80, s80, 704
s_addc_u32 s81, s81, 0
s_barrier
s_barrier
s_waitcnt vmcnt(0)
v_add_f32 v192, v192, v196
v_add_f32 v200, v200, v204
v_add_f32 v193, v193, v197
v_add_f32 v201, v201, v205
v_add_f32 v194, v194, v198
v_add_f32 v202, v202, v206
v_add_f32 v195, v195, v199
v_add_f32 v203, v203, v207
v_add_f32 v192, v192, v200
v_add_f32 v193, v193, v201
v_add_f32 v194, v194, v202
v_add_f32 v195, v195, v203
ds_write_b128 v13, v[192:195] offset:0
v_add_f32 v208, v208, v212
v_add_f32 v216, v216, v220
v_add_f32 v209, v209, v213
v_add_f32 v217, v217, v221
v_add_f32 v210, v210, v214
v_add_f32 v218, v218, v222
v_add_f32 v211, v211, v215
v_add_f32 v219, v219, v223
v_add_f32 v208, v208, v216
v_add_f32 v209, v209, v217
v_add_f32 v210, v210, v218
v_add_f32 v211, v211, v219
ds_write_b128 v13, v[208:211] offset:896
s_waitcnt lgkmcnt(0)
s_load_dword s82, s[80:81], 0
s_load_dword s83, s[80:81], 64
s_load_dword s84, s[80:81], 128
s_load_dword s85, s[80:81], 192
s_load_dword s86, s[80:81], 256
s_load_dword s87, s[80:81], 320
s_load_dword s82, s[80:81], 384
s_load_dword s83, s[80:81], 448
s_load_dword s84, s[80:81], 512
s_load_dword s85, s[80:81], 576
s_load_dword s86, s[80:81], 640
s_add_u32 s80, s80, 704
s_addc_u32 s81, s81, 0
s_barrier
s_load_dword s82, s[80:81], 0
s_load_dword s83, s[80:81], 64
s_load_dword s84, s[80:81], 128
s_load_dword s85, s[80:81], 192
s_load_dword s86, s[80:81], 256
s_load_dword s87, s[80:81], 320
s_load_dword s82, s[80:81], 384
s_load_dword s83, s[80:81], 448
s_load_dword s84, s[80:81], 512
s_load_dword s85, s[80:81], 576
s_load_dword s86, s[80:81], 640
s_add_u32 s80, s80, 704
s_addc_u32 s81, s81, 0
s_barrier
s_and_b32 s53, s35, 1
s_lshl_b32 s53, s53, 1
s_mul_i32 s43, s47, 3
s_add_u32 s53, s53, s43
v_lshlrev_b32 v19, 11, v18
v_lshl_add_u32 v19, v17, 4, v19
s_lshl_b32 s43, s46, 10
v_add_u32 v2, s43, v19
v_add_u32 v3, 49152, v2
v_add_u32 v4, 98304, v2
v_lshrrev_b32 v19, 2, v17
v_lshl_add_u32 v20, v18, 2, v19
v_and_b32 v21, 7, v20
v_lshlrev_b32 v20, 8, v20
v_and_b32 v19, 3, v1
v_lshl_add_u32 v20, v19, 3, v20
s_add_u32 s43, s53, 0
v_xor_b32 v19, s43, v21
v_lshl_add_u32 v5, v19, 5, v20
s_add_u32 s43, s53, 1
v_xor_b32 v19, s43, v21
v_lshl_add_u32 v6, v19, 5, v20
s_add_u32 s43, s53, 2
v_xor_b32 v19, s43, v21
v_lshl_add_u32 v7, v19, 5, v20
v_add_u32 v9, 49152, v5
v_add_u32 v10, 49152, v6
v_add_u32 v11, 49152, v7
v_add_u32 v13, 98304, v5
v_add_u32 v14, 98304, v6
v_add_u32 v15, 98304, v7
s_lshl_b32 s43, s46, 9
s_add_u32 s43, s43, 147456
v_lshl_add_u32 v19, v17, 3, s43
ds_read_b64 v[80:81], v19 offset:0
ds_read_b64 v[82:83], v19 offset:128
ds_read_b64 v[84:85], v19 offset:256
ds_read_b64 v[86:87], v19 offset:384
s_mul_i32 s43, s47, 192
s_add_u32 s43, s43, 148992
v_lshl_add_u32 v19, v18, 4, s43
ds_read_b128 v[48:51], v19 offset:0
ds_read_b128 v[52:55], v19 offset:64
ds_read_b128 v[56:59], v19 offset:128
ds_read_b128 v[60:63], v19 offset:896
ds_read_b128 v[64:67], v19 offset:960
ds_read_b128 v[68:71], v19 offset:1024
s_barrier
s_mov_b32 s88, s4
s_mov_b32 s89, s5
s_mov_b32 s90, 7340032
s_mov_b32 s91, 0x20000
s_mov_b32 s92, s6
s_mov_b32 s93, s7
s_mov_b32 s94, 7340032
s_mov_b32 s95, 0x20000
s_lshr_b32 s43, s35, 3
v_and_b32 v19, 1, v1
v_bfe_u32 v23, v1, 2, 3
s_lshl_b32 s44, s43, 1
s_add_u32 s44, s44, 6
v_add_u32 v23, s44, v23
s_lshl_b32 s44, s43, 1
s_add_u32 s44, s44, 1
v_mad_u32_u24 v23, v19, s44, v23
s_lshl_b32 s44, s43, 10
s_lshl_b32 s43, s43, 11
s_sub_u32 s43, 6528, s43
s_lshr_b32 s45, s2, 3
s_mul_i32 s45, s45, 14336
s_add_u32 s43, s43, s45
v_mul_lo_u32 v31, v19, s44
v_bfe_u32 v19, v1, 1, 1
v_mul_u32_u24 v19, 7168, v19
v_add3_u32 v31, v31, v19, s43
v_add_u32 v19, 0, v23
v_and_b32 v19, 15, v19
v_mul_u32_u24 v19, 458752, v19
v_add_u32 v19, v19, v31
buffer_load_dword v30, v19, s[88:91], 0 offen
buffer_load_dword v30, v19, s[92:95], 0 offen
s_waitcnt lgkmcnt(0)
v_mul_f32 v88, v81, v81
v_mul_f32 v228, 0xc0135761, v81
v_mul_f32 v89, 0xbdd2d3e8, v81
v_rcp_f32 v236, v88
v_mul_f32 v232, v89, v88
v_mul_f32 v88, v83, v83
v_mul_f32 v229, 0xc0135761, v83
v_mul_f32 v89, 0xbdd2d3e8, v83
v_rcp_f32 v237, v88
v_mul_f32 v233, v89, v88
v_mul_f32 v88, v85, v85
v_mul_f32 v230, 0xc0135761, v85
v_mul_f32 v89, 0xbdd2d3e8, v85
v_rcp_f32 v238, v88
v_mul_f32 v234, v89, v88
v_mul_f32 v88, v87, v87
v_mul_f32 v231, 0xc0135761, v87
v_mul_f32 v89, 0xbdd2d3e8, v87
v_rcp_f32 v239, v88
v_mul_f32 v235, v89, v88
s_mul_i32 s43, s34, 917504
s_mul_i32 s44, s49, 24576
s_add_u32 s43, s43, s44
s_add_u32 s43, s43, 8912896
s_add_u32 s24, s32, s43
s_addc_u32 s25, s33, 0
s_mov_b32 s26, 24576
s_mov_b32 s27, 0x20000
s_mov_b32 s53, 262144
s_lshl_b32 s43, s47, 13
s_lshl_b32 s44, s46, 10
s_add_u32 s43, s43, s44
v_lshlrev_b32 v19, 11, v18
v_lshl_add_u32 v19, v17, 4, v19
v_add_u32 v27, s43, v19
s_lshl_b32 s43, s47, 12
s_add_u32 s43, s43, s44
s_add_u32 s43, s43, 16384
v_and_b32 v19, 1, v18
v_lshlrev_b32 v19, 11, v19
v_lshrrev_b32 v20, 1, v18
v_lshl_add_u32 v19, v20, 8, v19
v_lshl_add_u32 v19, v17, 4, v19
v_add_u32 v28, s43, v19
s_load_dword s82, s[80:81], 0
s_load_dword s83, s[80:81], 64
s_load_dword s84, s[80:81], 128
s_load_dword s85, s[80:81], 192
s_load_dword s86, s[80:81], 256
s_load_dword s87, s[80:81], 320
s_load_dword s82, s[80:81], 384
s_load_dword s83, s[80:81], 448
s_add_u32 s80, s80, 512
s_addc_u32 s81, s81, 0
s_barrier
v_mul_f32 v128, -v80, v48
v_mul_f32 v129, -v80, v49
v_mul_f32 v130, -v80, v50
v_mul_f32 v131, -v80, v51
v_mul_f32 v132, -v82, v48
v_mul_f32 v133, -v82, v49
v_mul_f32 v134, -v82, v50
v_mul_f32 v135, -v82, v51
v_mul_f32 v136, -v84, v48
v_mul_f32 v137, -v84, v49
v_mul_f32 v138, -v84, v50
v_mul_f32 v139, -v84, v51
v_mul_f32 v140, -v86, v48
v_mul_f32 v141, -v86, v49
v_mul_f32 v142, -v86, v50
v_mul_f32 v143, -v86, v51
v_mul_f32 v144, -v80, v52
v_mul_f32 v145, -v80, v53
v_mul_f32 v146, -v80, v54
v_mul_f32 v147, -v80, v55
v_mul_f32 v148, -v82, v52
v_mul_f32 v149, -v82, v53
v_mul_f32 v150, -v82, v54
v_mul_f32 v151, -v82, v55
v_mul_f32 v152, -v84, v52
v_mul_f32 v153, -v84, v53
v_mul_f32 v154, -v84, v54
v_mul_f32 v155, -v84, v55
v_mul_f32 v156, -v86, v52
v_mul_f32 v157, -v86, v53
v_mul_f32 v158, -v86, v54
v_mul_f32 v159, -v86, v55
s_load_dword s82, s[80:81], 0
s_load_dword s83, s[80:81], 64
s_load_dword s84, s[80:81], 128
s_load_dword s85, s[80:81], 192
s_load_dword s86, s[80:81], 256
s_load_dword s87, s[80:81], 320
s_load_dword s82, s[80:81], 384
s_load_dword s83, s[80:81], 448
s_add_u32 s80, s80, 512
s_addc_u32 s81, s81, 0
s_barrier
v_mul_f32 v160, -v80, v56
v_mul_f32 v161, -v80, v57
v_mul_f32 v162, -v80, v58
v_mul_f32 v163, -v80, v59
v_mul_f32 v164, -v82, v56
v_mul_f32 v165, -v82, v57
v_mul_f32 v166, -v82, v58
v_mul_f32 v167, -v82, v59
v_mul_f32 v168, -v84, v56
v_mul_f32 v169, -v84, v57
v_mul_f32 v170, -v84, v58
v_mul_f32 v171, -v84, v59
v_mul_f32 v172, -v86, v56
v_mul_f32 v173, -v86, v57
v_mul_f32 v174, -v86, v58
v_mul_f32 v175, -v86, v59
v_mul_f32 v176, -v80, v60
v_mul_f32 v177, -v80, v61
v_mul_f32 v178, -v80, v62
v_mul_f32 v179, -v80, v63
v_mul_f32 v180, -v82, v60
v_mul_f32 v181, -v82, v61
v_mul_f32 v182, -v82, v62
v_mul_f32 v183, -v82, v63
v_mul_f32 v184, -v84, v60
v_mul_f32 v185, -v84, v61
v_mul_f32 v186, -v84, v62
v_mul_f32 v187, -v84, v63
v_mul_f32 v188, -v86, v60
v_mul_f32 v189, -v86, v61
v_mul_f32 v190, -v86, v62
v_mul_f32 v191, -v86, v63
s_load_dword s82, s[80:81], 0
s_load_dword s83, s[80:81], 64
s_load_dword s84, s[80:81], 128
s_load_dword s85, s[80:81], 192
s_load_dword s86, s[80:81], 256
s_load_dword s87, s[80:81], 320
s_load_dword s82, s[80:81], 384
s_load_dword s83, s[80:81], 448
s_add_u32 s80, s80, 512
s_addc_u32 s81, s81, 0
s_barrier
v_mul_f32 v192, -v80, v64
v_mul_f32 v193, -v80, v65
v_mul_f32 v194, -v80, v66
v_mul_f32 v195, -v80, v67
v_mul_f32 v196, -v82, v64
v_mul_f32 v197, -v82, v65
v_mul_f32 v198, -v82, v66
v_mul_f32 v199, -v82, v67
v_mul_f32 v200, -v84, v64
v_mul_f32 v201, -v84, v65
v_mul_f32 v202, -v84, v66
v_mul_f32 v203, -v84, v67
v_mul_f32 v204, -v86, v64
v_mul_f32 v205, -v86, v65
v_mul_f32 v206, -v86, v66
v_mul_f32 v207, -v86, v67
v_mul_f32 v208, -v80, v68
v_mul_f32 v209, -v80, v69
v_mul_f32 v210, -v80, v70
v_mul_f32 v211, -v80, v71
v_mul_f32 v212, -v82, v68
v_mul_f32 v213, -v82, v69
v_mul_f32 v214, -v82, v70
v_mul_f32 v215, -v82, v71
v_mul_f32 v216, -v84, v68
v_mul_f32 v217, -v84, v69
v_mul_f32 v218, -v84, v70
v_mul_f32 v219, -v84, v71
v_mul_f32 v220, -v86, v68
v_mul_f32 v221, -v86, v69
v_mul_f32 v222, -v86, v70
v_mul_f32 v223, -v86, v71
s_barrier
s_mul_i32 s44, s34, 917504
s_lshl_b32 s39, s51, 13
s_add_u32 s44, s44, s39
s_add_u32 s44, s44, 8388608
s_and_b32 s43, s51, 1
s_xor_b32 s43, s43, s35
s_lshl_b32 s43, s43, 7
s_mov_b32 s10, 909312
s_movk_i32 s38, 1024
s_movk_i32 s40, 9216
s_movk_i32 s37, 0x4000
s_cmp_ge_u32 s51, 2
s_cselect_b32 s8, s60, s32
s_cselect_b32 s9, s61, s33
s_cselect_b32 s10, 7338112, s10
s_cselect_b32 s43, s43, s44
s_cselect_b32 s38, 16384, s38
s_cselect_b32 s40, 81920, s40
s_cselect_b32 s55, 81920, s38
s_cselect_b32 s37, 262144, s37
s_cselect_b32 s45, -1, 0
s_add_u32 s8, s8, s43
s_addc_u32 s9, s9, 0
s_mov_b32 s11, 0x20000
s_and_b32 s53, s35, 1
s_mul_i32 s54, s53, 6
s_mul_i32 s54, s54, s37
s_mul_i32 s29, s53, 2
s_add_u32 s29, s29, 6
s_mul_i32 s29, s29, s37
s_and_b32 s43, s45, 4290838528
s_add_u32 s29, s29, s43
s_mul_i32 s37, s37, 2
s_sub_u32 s37, s37, s40
v_lshrrev_b32 v19, 3, v1
v_mul_u32_u24 v19, 1920, v19
v_lshrrev_b32 v20, 4, v1
v_lshlrev_b32 v20, 5, v20
v_and_b32 v19, s45, v19
v_and_b32 v20, s45, v20
v_lshlrev_b32 v21, 4, v1
v_xor_b32 v21, v21, v20
v_add_u32 v21, v21, v19
s_barrier
LK3b_34:
s_setprio 1
ds_read_b128 v[32:35], v2 offset:0
ds_read_b64_tr_b16 v[48:49], v5 offset:16384
ds_read_b64_tr_b16 v[50:51], v5 offset:20480
ds_read_b128 v[36:39], v2 offset:256
ds_read_b128 v[40:43], v2 offset:512
ds_read_b128 v[44:47], v2 offset:768
ds_read_b64_tr_b16 v[60:61], v5 offset:32768
ds_read_b64_tr_b16 v[62:63], v5 offset:36864
ds_read_b64_tr_b16 v[52:53], v6 offset:16384
ds_read_b64_tr_b16 v[54:55], v6 offset:20480
ds_read_b64_tr_b16 v[64:65], v6 offset:32768
ds_read_b64_tr_b16 v[66:67], v6 offset:36864
ds_read_b64_tr_b16 v[56:57], v7 offset:16384
ds_read_b64_tr_b16 v[58:59], v7 offset:20480
ds_read_b64_tr_b16 v[68:69], v7 offset:32768
ds_read_b64_tr_b16 v[70:71], v7 offset:36864
s_mov_b32 s41, 5
Lk3_51:
s_waitcnt lgkmcnt(0)
v_mfma_f32_16x16x32_bf16 v[128:131], v[48:51], v[32:35], v[128:131]
ds_read_b128 v[80:83], v2 offset:8192
v_mfma_f32_16x16x32_bf16 v[132:135], v[48:51], v[36:39], v[132:135]
ds_read_b64_tr_b16 v[96:97], v5 offset:24576
v_mfma_f32_16x16x32_bf16 v[136:139], v[48:51], v[40:43], v[136:139]
ds_read_b64_tr_b16 v[98:99], v5 offset:28672
v_mfma_f32_16x16x32_bf16 v[140:143], v[48:51], v[44:47], v[140:143]
ds_read_b128 v[84:87], v2 offset:8448
v_mfma_f32_16x16x32_bf16 v[188:191], v[60:63], v[44:47], v[188:191]
ds_read_b128 v[88:91], v2 offset:8704
v_mfma_f32_16x16x32_bf16 v[184:187], v[60:63], v[40:43], v[184:187]
ds_read_b128 v[92:95], v2 offset:8960
v_mfma_f32_16x16x32_bf16 v[180:183], v[60:63], v[36:39], v[180:183]
ds_read_b64_tr_b16 v[108:109], v5 offset:40960
v_mfma_f32_16x16x32_bf16 v[176:179], v[60:63], v[32:35], v[176:179]
ds_read_b64_tr_b16 v[110:111], v5 offset:45056
v_mfma_f32_16x16x32_bf16 v[144:147], v[52:55], v[32:35], v[144:147]
ds_read_b64_tr_b16 v[100:101], v6 offset:24576
v_mfma_f32_16x16x32_bf16 v[148:151], v[52:55], v[36:39], v[148:151]
ds_read_b64_tr_b16 v[102:103], v6 offset:28672
v_mfma_f32_16x16x32_bf16 v[152:155], v[52:55], v[40:43], v[152:155]
ds_read_b64_tr_b16 v[112:113], v6 offset:40960
v_mfma_f32_16x16x32_bf16 v[156:159], v[52:55], v[44:47], v[156:159]
ds_read_b64_tr_b16 v[114:115], v6 offset:45056
v_mfma_f32_16x16x32_bf16 v[204:207], v[64:67], v[44:47], v[204:207]
ds_read_b64_tr_b16 v[104:105], v7 offset:24576
v_mfma_f32_16x16x32_bf16 v[200:203], v[64:67], v[40:43], v[200:203]
ds_read_b64_tr_b16 v[106:107], v7 offset:28672
v_mfma_f32_16x16x32_bf16 v[196:199], v[64:67], v[36:39], v[196:199]
ds_read_b64_tr_b16 v[116:117], v7 offset:40960
v_mfma_f32_16x16x32_bf16 v[192:195], v[64:67], v[32:35], v[192:195]
ds_read_b64_tr_b16 v[118:119], v7 offset:45056
v_mfma_f32_16x16x32_bf16 v[160:163], v[56:59], v[32:35], v[160:163]
v_mfma_f32_16x16x32_bf16 v[164:167], v[56:59], v[36:39], v[164:167]
v_mfma_f32_16x16x32_bf16 v[168:171], v[56:59], v[40:43], v[168:171]
v_mfma_f32_16x16x32_bf16 v[172:175], v[56:59], v[44:47], v[172:175]
v_mfma_f32_16x16x32_bf16 v[220:223], v[68:71], v[44:47], v[220:223]
v_mfma_f32_16x16x32_bf16 v[216:219], v[68:71], v[40:43], v[216:219]
v_mfma_f32_16x16x32_bf16 v[212:215], v[68:71], v[36:39], v[212:215]
v_mfma_f32_16x16x32_bf16 v[208:211], v[68:71], v[32:35], v[208:211]
s_waitcnt vmcnt(0) lgkmcnt(0)
s_barrier
v_mfma_f32_16x16x32_bf16 v[128:131], v[96:99], v[80:83], v[128:131]
ds_read_b128 v[32:35], v3 offset:0
v_mfma_f32_16x16x32_bf16 v[132:135], v[96:99], v[84:87], v[132:135]
ds_read_b64_tr_b16 v[48:49], v9 offset:16384
v_mfma_f32_16x16x32_bf16 v[136:139], v[96:99], v[88:91], v[136:139]
ds_read_b64_tr_b16 v[50:51], v9 offset:20480
v_mfma_f32_16x16x32_bf16 v[140:143], v[96:99], v[92:95], v[140:143]
ds_read_b128 v[36:39], v3 offset:256
v_mfma_f32_16x16x32_bf16 v[188:191], v[108:111], v[92:95], v[188:191]
ds_read_b128 v[40:43], v3 offset:512
v_mfma_f32_16x16x32_bf16 v[184:187], v[108:111], v[88:91], v[184:187]
ds_read_b128 v[44:47], v3 offset:768
v_mfma_f32_16x16x32_bf16 v[180:183], v[108:111], v[84:87], v[180:183]
ds_read_b64_tr_b16 v[60:61], v9 offset:32768
v_mfma_f32_16x16x32_bf16 v[176:179], v[108:111], v[80:83], v[176:179]
ds_read_b64_tr_b16 v[62:63], v9 offset:36864
v_mfma_f32_16x16x32_bf16 v[144:147], v[100:103], v[80:83], v[144:147]
ds_read_b64_tr_b16 v[52:53], v10 offset:16384
v_mfma_f32_16x16x32_bf16 v[148:151], v[100:103], v[84:87], v[148:151]
ds_read_b64_tr_b16 v[54:55], v10 offset:20480
v_mfma_f32_16x16x32_bf16 v[152:155], v[100:103], v[88:91], v[152:155]
ds_read_b64_tr_b16 v[64:65], v10 offset:32768
v_mfma_f32_16x16x32_bf16 v[156:159], v[100:103], v[92:95], v[156:159]
ds_read_b64_tr_b16 v[66:67], v10 offset:36864
v_mfma_f32_16x16x32_bf16 v[204:207], v[112:115], v[92:95], v[204:207]
ds_read_b64_tr_b16 v[56:57], v11 offset:16384
v_mfma_f32_16x16x32_bf16 v[200:203], v[112:115], v[88:91], v[200:203]
ds_read_b64_tr_b16 v[58:59], v11 offset:20480
v_mfma_f32_16x16x32_bf16 v[196:199], v[112:115], v[84:87], v[196:199]
ds_read_b64_tr_b16 v[68:69], v11 offset:32768
v_mfma_f32_16x16x32_bf16 v[192:195], v[112:115], v[80:83], v[192:195]
ds_read_b64_tr_b16 v[70:71], v11 offset:36864
v_mfma_f32_16x16x32_bf16 v[160:163], v[104:107], v[80:83], v[160:163]
v_mfma_f32_16x16x32_bf16 v[164:167], v[104:107], v[84:87], v[164:167]
v_mfma_f32_16x16x32_bf16 v[168:171], v[104:107], v[88:91], v[168:171]
v_mfma_f32_16x16x32_bf16 v[172:175], v[104:107], v[92:95], v[172:175]
v_mfma_f32_16x16x32_bf16 v[220:223], v[116:119], v[92:95], v[220:223]
v_mfma_f32_16x16x32_bf16 v[216:219], v[116:119], v[88:91], v[216:219]
v_mfma_f32_16x16x32_bf16 v[212:215], v[116:119], v[84:87], v[212:215]
v_mfma_f32_16x16x32_bf16 v[208:211], v[116:119], v[80:83], v[208:211]
s_waitcnt lgkmcnt(0)
v_mfma_f32_16x16x32_bf16 v[128:131], v[48:51], v[32:35], v[128:131]
ds_read_b128 v[80:83], v3 offset:8192
v_mfma_f32_16x16x32_bf16 v[132:135], v[48:51], v[36:39], v[132:135]
ds_read_b64_tr_b16 v[96:97], v9 offset:24576
v_mfma_f32_16x16x32_bf16 v[136:139], v[48:51], v[40:43], v[136:139]
ds_read_b64_tr_b16 v[98:99], v9 offset:28672
v_mfma_f32_16x16x32_bf16 v[140:143], v[48:51], v[44:47], v[140:143]
ds_read_b128 v[84:87], v3 offset:8448
v_mfma_f32_16x16x32_bf16 v[188:191], v[60:63], v[44:47], v[188:191]
ds_read_b128 v[88:91], v3 offset:8704
v_mfma_f32_16x16x32_bf16 v[184:187], v[60:63], v[40:43], v[184:187]
ds_read_b128 v[92:95], v3 offset:8960
v_mfma_f32_16x16x32_bf16 v[180:183], v[60:63], v[36:39], v[180:183]
ds_read_b64_tr_b16 v[108:109], v9 offset:40960
v_mfma_f32_16x16x32_bf16 v[176:179], v[60:63], v[32:35], v[176:179]
ds_read_b64_tr_b16 v[110:111], v9 offset:45056
v_mfma_f32_16x16x32_bf16 v[144:147], v[52:55], v[32:35], v[144:147]
ds_read_b64_tr_b16 v[100:101], v10 offset:24576
v_mfma_f32_16x16x32_bf16 v[148:151], v[52:55], v[36:39], v[148:151]
ds_read_b64_tr_b16 v[102:103], v10 offset:28672
v_mfma_f32_16x16x32_bf16 v[152:155], v[52:55], v[40:43], v[152:155]
ds_read_b64_tr_b16 v[112:113], v10 offset:40960
v_mfma_f32_16x16x32_bf16 v[156:159], v[52:55], v[44:47], v[156:159]
ds_read_b64_tr_b16 v[114:115], v10 offset:45056
v_mfma_f32_16x16x32_bf16 v[204:207], v[64:67], v[44:47], v[204:207]
ds_read_b64_tr_b16 v[104:105], v11 offset:24576
v_mfma_f32_16x16x32_bf16 v[200:203], v[64:67], v[40:43], v[200:203]
ds_read_b64_tr_b16 v[106:107], v11 offset:28672
v_mfma_f32_16x16x32_bf16 v[196:199], v[64:67], v[36:39], v[196:199]
ds_read_b64_tr_b16 v[116:117], v11 offset:40960
v_mfma_f32_16x16x32_bf16 v[192:195], v[64:67], v[32:35], v[192:195]
ds_read_b64_tr_b16 v[118:119], v11 offset:45056
v_mfma_f32_16x16x32_bf16 v[160:163], v[56:59], v[32:35], v[160:163]
v_mfma_f32_16x16x32_bf16 v[164:167], v[56:59], v[36:39], v[164:167]
v_mfma_f32_16x16x32_bf16 v[168:171], v[56:59], v[40:43], v[168:171]
v_mfma_f32_16x16x32_bf16 v[172:175], v[56:59], v[44:47], v[172:175]
v_mfma_f32_16x16x32_bf16 v[220:223], v[68:71], v[44:47], v[220:223]
v_mfma_f32_16x16x32_bf16 v[216:219], v[68:71], v[40:43], v[216:219]
v_mfma_f32_16x16x32_bf16 v[212:215], v[68:71], v[36:39], v[212:215]
v_mfma_f32_16x16x32_bf16 v[208:211], v[68:71], v[32:35], v[208:211]
s_waitcnt lgkmcnt(0)
s_barrier
v_mfma_f32_16x16x32_bf16 v[128:131], v[96:99], v[80:83], v[128:131]
ds_read_b128 v[32:35], v4 offset:0
v_mfma_f32_16x16x32_bf16 v[132:135], v[96:99], v[84:87], v[132:135]
ds_read_b64_tr_b16 v[48:49], v13 offset:16384
v_mfma_f32_16x16x32_bf16 v[136:139], v[96:99], v[88:91], v[136:139]
ds_read_b64_tr_b16 v[50:51], v13 offset:20480
v_mfma_f32_16x16x32_bf16 v[140:143], v[96:99], v[92:95], v[140:143]
ds_read_b128 v[36:39], v4 offset:256
v_mfma_f32_16x16x32_bf16 v[188:191], v[108:111], v[92:95], v[188:191]
ds_read_b128 v[40:43], v4 offset:512
v_mfma_f32_16x16x32_bf16 v[184:187], v[108:111], v[88:91], v[184:187]
ds_read_b128 v[44:47], v4 offset:768
v_mfma_f32_16x16x32_bf16 v[180:183], v[108:111], v[84:87], v[180:183]
ds_read_b64_tr_b16 v[60:61], v13 offset:32768
v_mfma_f32_16x16x32_bf16 v[176:179], v[108:111], v[80:83], v[176:179]
ds_read_b64_tr_b16 v[62:63], v13 offset:36864
v_mfma_f32_16x16x32_bf16 v[144:147], v[100:103], v[80:83], v[144:147]
ds_read_b64_tr_b16 v[52:53], v14 offset:16384
v_mfma_f32_16x16x32_bf16 v[148:151], v[100:103], v[84:87], v[148:151]
ds_read_b64_tr_b16 v[54:55], v14 offset:20480
v_mfma_f32_16x16x32_bf16 v[152:155], v[100:103], v[88:91], v[152:155]
ds_read_b64_tr_b16 v[64:65], v14 offset:32768
v_mfma_f32_16x16x32_bf16 v[156:159], v[100:103], v[92:95], v[156:159]
ds_read_b64_tr_b16 v[66:67], v14 offset:36864
v_mfma_f32_16x16x32_bf16 v[204:207], v[112:115], v[92:95], v[204:207]
ds_read_b64_tr_b16 v[56:57], v15 offset:16384
v_mfma_f32_16x16x32_bf16 v[200:203], v[112:115], v[88:91], v[200:203]
ds_read_b64_tr_b16 v[58:59], v15 offset:20480
v_mfma_f32_16x16x32_bf16 v[196:199], v[112:115], v[84:87], v[196:199]
ds_read_b64_tr_b16 v[68:69], v15 offset:32768
v_mfma_f32_16x16x32_bf16 v[192:195], v[112:115], v[80:83], v[192:195]
ds_read_b64_tr_b16 v[70:71], v15 offset:36864
v_mfma_f32_16x16x32_bf16 v[160:163], v[104:107], v[80:83], v[160:163]
v_mfma_f32_16x16x32_bf16 v[164:167], v[104:107], v[84:87], v[164:167]
v_mfma_f32_16x16x32_bf16 v[168:171], v[104:107], v[88:91], v[168:171]
v_mfma_f32_16x16x32_bf16 v[172:175], v[104:107], v[92:95], v[172:175]
v_mfma_f32_16x16x32_bf16 v[220:223], v[116:119], v[92:95], v[220:223]
v_mfma_f32_16x16x32_bf16 v[216:219], v[116:119], v[88:91], v[216:219]
v_mfma_f32_16x16x32_bf16 v[212:215], v[116:119], v[84:87], v[212:215]
v_mfma_f32_16x16x32_bf16 v[208:211], v[116:119], v[80:83], v[208:211]
s_waitcnt lgkmcnt(0)
v_mfma_f32_16x16x32_bf16 v[128:131], v[48:51], v[32:35], v[128:131]
ds_read_b128 v[80:83], v4 offset:8192
v_mfma_f32_16x16x32_bf16 v[132:135], v[48:51], v[36:39], v[132:135]
ds_read_b64_tr_b16 v[96:97], v13 offset:24576
v_mfma_f32_16x16x32_bf16 v[136:139], v[48:51], v[40:43], v[136:139]
ds_read_b64_tr_b16 v[98:99], v13 offset:28672
v_mfma_f32_16x16x32_bf16 v[140:143], v[48:51], v[44:47], v[140:143]
ds_read_b128 v[84:87], v4 offset:8448
v_mfma_f32_16x16x32_bf16 v[188:191], v[60:63], v[44:47], v[188:191]
ds_read_b128 v[88:91], v4 offset:8704
v_mfma_f32_16x16x32_bf16 v[184:187], v[60:63], v[40:43], v[184:187]
ds_read_b128 v[92:95], v4 offset:8960
v_mfma_f32_16x16x32_bf16 v[180:183], v[60:63], v[36:39], v[180:183]
ds_read_b64_tr_b16 v[108:109], v13 offset:40960
v_mfma_f32_16x16x32_bf16 v[176:179], v[60:63], v[32:35], v[176:179]
ds_read_b64_tr_b16 v[110:111], v13 offset:45056
v_mfma_f32_16x16x32_bf16 v[144:147], v[52:55], v[32:35], v[144:147]
ds_read_b64_tr_b16 v[100:101], v14 offset:24576
v_mfma_f32_16x16x32_bf16 v[148:151], v[52:55], v[36:39], v[148:151]
ds_read_b64_tr_b16 v[102:103], v14 offset:28672
v_mfma_f32_16x16x32_bf16 v[152:155], v[52:55], v[40:43], v[152:155]
ds_read_b64_tr_b16 v[112:113], v14 offset:40960
v_mfma_f32_16x16x32_bf16 v[156:159], v[52:55], v[44:47], v[156:159]
ds_read_b64_tr_b16 v[114:115], v14 offset:45056
v_mfma_f32_16x16x32_bf16 v[204:207], v[64:67], v[44:47], v[204:207]
ds_read_b64_tr_b16 v[104:105], v15 offset:24576
v_mfma_f32_16x16x32_bf16 v[200:203], v[64:67], v[40:43], v[200:203]
ds_read_b64_tr_b16 v[106:107], v15 offset:28672
v_mfma_f32_16x16x32_bf16 v[196:199], v[64:67], v[36:39], v[196:199]
ds_read_b64_tr_b16 v[116:117], v15 offset:40960
v_mfma_f32_16x16x32_bf16 v[192:195], v[64:67], v[32:35], v[192:195]
ds_read_b64_tr_b16 v[118:119], v15 offset:45056
v_mfma_f32_16x16x32_bf16 v[160:163], v[56:59], v[32:35], v[160:163]
v_mfma_f32_16x16x32_bf16 v[164:167], v[56:59], v[36:39], v[164:167]
v_mfma_f32_16x16x32_bf16 v[168:171], v[56:59], v[40:43], v[168:171]
v_mfma_f32_16x16x32_bf16 v[172:175], v[56:59], v[44:47], v[172:175]
v_mfma_f32_16x16x32_bf16 v[220:223], v[68:71], v[44:47], v[220:223]
v_mfma_f32_16x16x32_bf16 v[216:219], v[68:71], v[40:43], v[216:219]
v_mfma_f32_16x16x32_bf16 v[212:215], v[68:71], v[36:39], v[212:215]
v_mfma_f32_16x16x32_bf16 v[208:211], v[68:71], v[32:35], v[208:211]
s_waitcnt lgkmcnt(0)
s_barrier
v_mfma_f32_16x16x32_bf16 v[128:131], v[96:99], v[80:83], v[128:131]
ds_read_b128 v[32:35], v2 offset:0
v_mfma_f32_16x16x32_bf16 v[132:135], v[96:99], v[84:87], v[132:135]
ds_read_b64_tr_b16 v[48:49], v5 offset:16384
v_mfma_f32_16x16x32_bf16 v[136:139], v[96:99], v[88:91], v[136:139]
ds_read_b64_tr_b16 v[50:51], v5 offset:20480
v_mfma_f32_16x16x32_bf16 v[140:143], v[96:99], v[92:95], v[140:143]
ds_read_b128 v[36:39], v2 offset:256
v_mfma_f32_16x16x32_bf16 v[188:191], v[108:111], v[92:95], v[188:191]
ds_read_b128 v[40:43], v2 offset:512
v_mfma_f32_16x16x32_bf16 v[184:187], v[108:111], v[88:91], v[184:187]
ds_read_b128 v[44:47], v2 offset:768
v_mfma_f32_16x16x32_bf16 v[180:183], v[108:111], v[84:87], v[180:183]
ds_read_b64_tr_b16 v[60:61], v5 offset:32768
v_mfma_f32_16x16x32_bf16 v[176:179], v[108:111], v[80:83], v[176:179]
ds_read_b64_tr_b16 v[62:63], v5 offset:36864
v_mfma_f32_16x16x32_bf16 v[144:147], v[100:103], v[80:83], v[144:147]
ds_read_b64_tr_b16 v[52:53], v6 offset:16384
v_mfma_f32_16x16x32_bf16 v[148:151], v[100:103], v[84:87], v[148:151]
ds_read_b64_tr_b16 v[54:55], v6 offset:20480
v_mfma_f32_16x16x32_bf16 v[152:155], v[100:103], v[88:91], v[152:155]
ds_read_b64_tr_b16 v[64:65], v6 offset:32768
v_mfma_f32_16x16x32_bf16 v[156:159], v[100:103], v[92:95], v[156:159]
ds_read_b64_tr_b16 v[66:67], v6 offset:36864
v_mfma_f32_16x16x32_bf16 v[204:207], v[112:115], v[92:95], v[204:207]
ds_read_b64_tr_b16 v[56:57], v7 offset:16384
v_mfma_f32_16x16x32_bf16 v[200:203], v[112:115], v[88:91], v[200:203]
ds_read_b64_tr_b16 v[58:59], v7 offset:20480
v_mfma_f32_16x16x32_bf16 v[196:199], v[112:115], v[84:87], v[196:199]
ds_read_b64_tr_b16 v[68:69], v7 offset:32768
v_mfma_f32_16x16x32_bf16 v[192:195], v[112:115], v[80:83], v[192:195]
ds_read_b64_tr_b16 v[70:71], v7 offset:36864
v_mfma_f32_16x16x32_bf16 v[160:163], v[104:107], v[80:83], v[160:163]
v_mfma_f32_16x16x32_bf16 v[164:167], v[104:107], v[84:87], v[164:167]
v_mfma_f32_16x16x32_bf16 v[168:171], v[104:107], v[88:91], v[168:171]
v_mfma_f32_16x16x32_bf16 v[172:175], v[104:107], v[92:95], v[172:175]
v_mfma_f32_16x16x32_bf16 v[220:223], v[116:119], v[92:95], v[220:223]
v_mfma_f32_16x16x32_bf16 v[216:219], v[116:119], v[88:91], v[216:219]
v_mfma_f32_16x16x32_bf16 v[212:215], v[116:119], v[84:87], v[212:215]
v_mfma_f32_16x16x32_bf16 v[208:211], v[116:119], v[80:83], v[208:211]
s_sub_u32 s41, s41, 1
s_cmp_lg_u32 s41, 0
s_cbranch_scc1 Lk3_51
s_waitcnt lgkmcnt(0)
v_mfma_f32_16x16x32_bf16 v[128:131], v[48:51], v[32:35], v[128:131]
ds_read_b128 v[80:83], v2 offset:8192
v_mfma_f32_16x16x32_bf16 v[132:135], v[48:51], v[36:39], v[132:135]
ds_read_b64_tr_b16 v[96:97], v5 offset:24576
v_mfma_f32_16x16x32_bf16 v[136:139], v[48:51], v[40:43], v[136:139]
ds_read_b64_tr_b16 v[98:99], v5 offset:28672
v_mfma_f32_16x16x32_bf16 v[140:143], v[48:51], v[44:47], v[140:143]
ds_read_b128 v[84:87], v2 offset:8448
v_mfma_f32_16x16x32_bf16 v[188:191], v[60:63], v[44:47], v[188:191]
ds_read_b128 v[88:91], v2 offset:8704
v_mfma_f32_16x16x32_bf16 v[184:187], v[60:63], v[40:43], v[184:187]
ds_read_b128 v[92:95], v2 offset:8960
v_mfma_f32_16x16x32_bf16 v[180:183], v[60:63], v[36:39], v[180:183]
ds_read_b64_tr_b16 v[108:109], v5 offset:40960
v_mfma_f32_16x16x32_bf16 v[176:179], v[60:63], v[32:35], v[176:179]
ds_read_b64_tr_b16 v[110:111], v5 offset:45056
v_mfma_f32_16x16x32_bf16 v[144:147], v[52:55], v[32:35], v[144:147]
ds_read_b64_tr_b16 v[100:101], v6 offset:24576
v_mfma_f32_16x16x32_bf16 v[148:151], v[52:55], v[36:39], v[148:151]
ds_read_b64_tr_b16 v[102:103], v6 offset:28672
v_mfma_f32_16x16x32_bf16 v[152:155], v[52:55], v[40:43], v[152:155]
ds_read_b64_tr_b16 v[112:113], v6 offset:40960
v_mfma_f32_16x16x32_bf16 v[156:159], v[52:55], v[44:47], v[156:159]
ds_read_b64_tr_b16 v[114:115], v6 offset:45056
v_mfma_f32_16x16x32_bf16 v[204:207], v[64:67], v[44:47], v[204:207]
ds_read_b64_tr_b16 v[104:105], v7 offset:24576
v_mfma_f32_16x16x32_bf16 v[200:203], v[64:67], v[40:43], v[200:203]
ds_read_b64_tr_b16 v[106:107], v7 offset:28672
v_mfma_f32_16x16x32_bf16 v[196:199], v[64:67], v[36:39], v[196:199]
ds_read_b64_tr_b16 v[116:117], v7 offset:40960
v_mfma_f32_16x16x32_bf16 v[192:195], v[64:67], v[32:35], v[192:195]
ds_read_b64_tr_b16 v[118:119], v7 offset:45056
v_mfma_f32_16x16x32_bf16 v[160:163], v[56:59], v[32:35], v[160:163]
v_mfma_f32_16x16x32_bf16 v[164:167], v[56:59], v[36:39], v[164:167]
v_mfma_f32_16x16x32_bf16 v[168:171], v[56:59], v[40:43], v[168:171]
v_mfma_f32_16x16x32_bf16 v[172:175], v[56:59], v[44:47], v[172:175]
v_mfma_f32_16x16x32_bf16 v[220:223], v[68:71], v[44:47], v[220:223]
v_mfma_f32_16x16x32_bf16 v[216:219], v[68:71], v[40:43], v[216:219]
v_mfma_f32_16x16x32_bf16 v[212:215], v[68:71], v[36:39], v[212:215]
v_mfma_f32_16x16x32_bf16 v[208:211], v[68:71], v[32:35], v[208:211]
s_waitcnt lgkmcnt(0)
s_barrier
s_cmp_eq_u32 s36, 7
s_cbranch_scc1 L7b_52
s_add_u32 m0, s39, 0
s_add_u32 s37, s37, s40
buffer_load_dwordx4 v21, s[8:11], s37 offen sc1 lds
v_mfma_f32_16x16x32_bf16 v[128:131], v[96:99], v[80:83], v[128:131]
v_mfma_f32_16x16x32_bf16 v[132:135], v[96:99], v[84:87], v[132:135]
s_add_u32 m0, s39, 1024
s_add_u32 s37, s37, s38
buffer_load_dwordx4 v21, s[8:11], s37 offen sc1 lds
v_mfma_f32_16x16x32_bf16 v[136:139], v[96:99], v[88:91], v[136:139]
s_add_u32 m0, s39, 2048
s_add_u32 s37, s37, s38
buffer_load_dwordx4 v21, s[8:11], s37 offen sc1 lds
v_mfma_f32_16x16x32_bf16 v[140:143], v[96:99], v[92:95], v[140:143]
v_mfma_f32_16x16x32_bf16 v[188:191], v[108:111], v[92:95], v[188:191]
s_add_u32 m0, s39, 3072
s_add_u32 s37, s37, s38
buffer_load_dwordx4 v21, s[8:11], s37 offen sc1 lds
v_mfma_f32_16x16x32_bf16 v[184:187], v[108:111], v[88:91], v[184:187]
s_add_u32 m0, s39, 4096
s_add_u32 s37, s37, s55
buffer_load_dwordx4 v21, s[8:11], s37 offen sc1 lds
v_mfma_f32_16x16x32_bf16 v[180:183], v[108:111], v[84:87], v[180:183]
v_mfma_f32_16x16x32_bf16 v[176:179], v[108:111], v[80:83], v[176:179]
s_add_u32 m0, s39, 5120
s_add_u32 s37, s37, s38
buffer_load_dwordx4 v21, s[8:11], s37 offen sc1 lds
v_mfma_f32_16x16x32_bf16 v[144:147], v[100:103], v[80:83], v[144:147]
s_add_u32 m0, s39, 6144
s_add_u32 s37, s37, s38
buffer_load_dwordx4 v21, s[8:11], s37 offen sc1 lds
v_mfma_f32_16x16x32_bf16 v[148:151], v[100:103], v[84:87], v[148:151]
v_mfma_f32_16x16x32_bf16 v[152:155], v[100:103], v[88:91], v[152:155]
s_add_u32 m0, s39, 7168
s_add_u32 s37, s37, s38
buffer_load_dwordx4 v21, s[8:11], s37 offen sc1 lds
v_mfma_f32_16x16x32_bf16 v[156:159], v[100:103], v[92:95], v[156:159]
s_add_u32 m0, s39, 32768
s_add_u32 s37, s37, s40
buffer_load_dwordx4 v21, s[8:11], s37 offen sc1 lds
v_mfma_f32_16x16x32_bf16 v[204:207], v[112:115], v[92:95], v[204:207]
v_mfma_f32_16x16x32_bf16 v[200:203], v[112:115], v[88:91], v[200:203]
s_add_u32 m0, s39, 33792
s_add_u32 s37, s37, s38
buffer_load_dwordx4 v21, s[8:11], s37 offen sc1 lds
v_mfma_f32_16x16x32_bf16 v[196:199], v[112:115], v[84:87], v[196:199]
s_add_u32 m0, s39, 34816
s_add_u32 s37, s37, s38
buffer_load_dwordx4 v21, s[8:11], s37 offen sc1 lds
v_mfma_f32_16x16x32_bf16 v[192:195], v[112:115], v[80:83], v[192:195]
v_mfma_f32_16x16x32_bf16 v[160:163], v[104:107], v[80:83], v[160:163]
s_add_u32 m0, s39, 35840
s_add_u32 s37, s37, s38
buffer_load_dwordx4 v21, s[8:11], s37 offen sc1 lds
v_mfma_f32_16x16x32_bf16 v[164:167], v[104:107], v[84:87], v[164:167]
s_add_u32 m0, s39, 36864
s_add_u32 s37, s37, s55
buffer_load_dwordx4 v21, s[8:11], s37 offen sc1 lds
v_mfma_f32_16x16x32_bf16 v[168:171], v[104:107], v[88:91], v[168:171]
v_mfma_f32_16x16x32_bf16 v[172:175], v[104:107], v[92:95], v[172:175]
s_add_u32 m0, s39, 37888
s_add_u32 s37, s37, s38
buffer_load_dwordx4 v21, s[8:11], s37 offen sc1 lds
v_mfma_f32_16x16x32_bf16 v[220:223], v[116:119], v[92:95], v[220:223]
s_add_u32 m0, s39, 38912
s_add_u32 s37, s37, s38
buffer_load_dwordx4 v21, s[8:11], s37 offen sc1 lds
v_mfma_f32_16x16x32_bf16 v[216:219], v[116:119], v[88:91], v[216:219]
v_mfma_f32_16x16x32_bf16 v[212:215], v[116:119], v[84:87], v[212:215]
s_add_u32 m0, s39, 39936
s_add_u32 s37, s37, s38
buffer_load_dwordx4 v21, s[8:11], s37 offen sc1 lds
v_mfma_f32_16x16x32_bf16 v[208:211], v[116:119], v[80:83], v[208:211]
s_setprio 0
s_barrier
s_add_u32 s37, s37, s54
s_add_u32 m0, s39, 65536
s_add_u32 s37, s37, s40
buffer_load_dwordx4 v21, s[8:11], s37 offen sc1 lds
v_mul_f32 v80, v128, v128
v_mul_f32 v81, v129, v129
v_mul_f32 v82, v130, v130
v_mul_f32 v83, v131, v131
v_fma_f32 v80, v80, v232, v228
v_fma_f32 v81, v81, v232, v228
v_fma_f32 v82, v82, v232, v228
s_add_u32 m0, s39, 66560
s_add_u32 s37, s37, s38
buffer_load_dwordx4 v21, s[8:11], s37 offen sc1 lds
v_fma_f32 v83, v83, v232, v228
v_mul_f32 v80, v80, v128
v_mul_f32 v81, v81, v129
v_mul_f32 v82, v82, v130
v_mul_f32 v83, v83, v131
v_exp_f32 v80, v80
s_add_u32 m0, s39, 67584
s_add_u32 s37, s37, s38
buffer_load_dwordx4 v21, s[8:11], s37 offen sc1 lds
v_exp_f32 v81, v81
v_exp_f32 v82, v82
v_exp_f32 v83, v83
v_mul_f32 v176, v128, v176
v_mul_f32 v177, v129, v177
v_mul_f32 v178, v130, v178
v_mul_f32 v179, v131, v179
s_add_u32 m0, s39, 68608
s_add_u32 s37, s37, s38
buffer_load_dwordx4 v21, s[8:11], s37 offen sc1 lds
v_fma_f32 v80, v80, v236, v236
v_fma_f32 v81, v81, v236, v236
v_fma_f32 v82, v82, v236, v236
v_fma_f32 v83, v83, v236, v236
v_rcp_f32 v80, v80
v_rcp_f32 v81, v81
s_add_u32 m0, s39, 69632
s_add_u32 s37, s37, s55
buffer_load_dwordx4 v21, s[8:11], s37 offen sc1 lds
v_rcp_f32 v82, v82
v_rcp_f32 v83, v83
v_mul_f32 v176, v176, v80
v_mul_f32 v177, v177, v81
v_mul_f32 v178, v178, v82
v_mul_f32 v179, v179, v83
v_cvt_pk_bf16_f32 v96, v176, v177
s_add_u32 m0, s39, 70656
s_add_u32 s37, s37, s38
buffer_load_dwordx4 v21, s[8:11], s37 offen sc1 lds
v_cvt_pk_bf16_f32 v97, v178, v179
v_mul_f32 v84, v144, v144
v_mul_f32 v85, v145, v145
v_mul_f32 v86, v146, v146
v_mul_f32 v87, v147, v147
v_fma_f32 v84, v84, v232, v228
s_add_u32 m0, s39, 71680
s_add_u32 s37, s37, s38
buffer_load_dwordx4 v21, s[8:11], s37 offen sc1 lds
v_fma_f32 v85, v85, v232, v228
v_fma_f32 v86, v86, v232, v228
v_fma_f32 v87, v87, v232, v228
v_mul_f32 v84, v84, v144
v_mul_f32 v85, v85, v145
v_mul_f32 v86, v86, v146
v_mul_f32 v87, v87, v147
s_add_u32 m0, s39, 72704
s_add_u32 s37, s37, s38
buffer_load_dwordx4 v21, s[8:11], s37 offen sc1 lds
v_exp_f32 v84, v84
v_exp_f32 v85, v85
v_exp_f32 v86, v86
v_exp_f32 v87, v87
v_mul_f32 v192, v144, v192
v_mul_f32 v193, v145, v193
s_waitcnt vmcnt(16)
s_barrier
s_add_u32 m0, s39, 98304
s_add_u32 s37, s37, s40
buffer_load_dwordx4 v21, s[8:11], s37 offen sc1 lds
v_mul_f32 v194, v146, v194
v_mul_f32 v195, v147, v195
v_fma_f32 v84, v84, v236, v236
v_fma_f32 v85, v85, v236, v236
v_fma_f32 v86, v86, v236, v236
v_fma_f32 v87, v87, v236, v236
v_rcp_f32 v84, v84
s_add_u32 m0, s39, 99328
s_add_u32 s37, s37, s38
buffer_load_dwordx4 v21, s[8:11], s37 offen sc1 lds
v_rcp_f32 v85, v85
v_rcp_f32 v86, v86
v_rcp_f32 v87, v87
v_mul_f32 v192, v192, v84
v_mul_f32 v193, v193, v85
v_mul_f32 v194, v194, v86
v_mul_f32 v195, v195, v87
s_add_u32 m0, s39, 100352
s_add_u32 s37, s37, s38
buffer_load_dwordx4 v21, s[8:11], s37 offen sc1 lds
v_cvt_pk_bf16_f32 v98, v192, v193
v_cvt_pk_bf16_f32 v99, v194, v195
v_mul_f32 v80, v160, v160
v_mul_f32 v81, v161, v161
v_mul_f32 v82, v162, v162
s_add_u32 m0, s39, 101376
s_add_u32 s37, s37, s38
buffer_load_dwordx4 v21, s[8:11], s37 offen sc1 lds
v_mul_f32 v83, v163, v163
v_fma_f32 v80, v80, v232, v228
v_fma_f32 v81, v81, v232, v228
v_fma_f32 v82, v82, v232, v228
v_fma_f32 v83, v83, v232, v228
v_mul_f32 v80, v80, v160
v_mul_f32 v81, v81, v161
s_add_u32 m0, s39, 102400
s_add_u32 s37, s37, s55
buffer_load_dwordx4 v21, s[8:11], s37 offen sc1 lds
v_mul_f32 v82, v82, v162
v_mul_f32 v83, v83, v163
v_exp_f32 v80, v80
v_exp_f32 v81, v81
v_exp_f32 v82, v82
v_exp_f32 v83, v83
v_mul_f32 v208, v160, v208
s_add_u32 m0, s39, 103424
s_add_u32 s37, s37, s38
buffer_load_dwordx4 v21, s[8:11], s37 offen sc1 lds
v_mul_f32 v209, v161, v209
v_mul_f32 v210, v162, v210
v_mul_f32 v211, v163, v211
v_fma_f32 v80, v80, v236, v236
v_fma_f32 v81, v81, v236, v236
v_fma_f32 v82, v82, v236, v236
s_add_u32 m0, s39, 104448
s_add_u32 s37, s37, s38
buffer_load_dwordx4 v21, s[8:11], s37 offen sc1 lds
v_fma_f32 v83, v83, v236, v236
v_rcp_f32 v80, v80
v_rcp_f32 v81, v81
v_rcp_f32 v82, v82
v_rcp_f32 v83, v83
v_mul_f32 v208, v208, v80
v_mul_f32 v209, v209, v81
s_add_u32 m0, s39, 105472
s_add_u32 s37, s37, s38
buffer_load_dwordx4 v21, s[8:11], s37 offen sc1 lds
v_mul_f32 v210, v210, v82
v_mul_f32 v211, v211, v83
v_cvt_pk_bf16_f32 v112, v208, v209
v_cvt_pk_bf16_f32 v113, v210, v211
v_mul_f32 v80, v132, v132
v_mul_f32 v81, v133, v133
buffer_store_dwordx4 v[96:99], v27, s[24:27], 0 offen offset:0 sc1
s_waitcnt vmcnt(17)
s_barrier
s_add_u32 m0, s39, 0
s_add_u32 s37, s37, s40
buffer_load_dwordx4 v21, s[8:11], s37 offen sc1 lds
v_mul_f32 v82, v134, v134
v_mul_f32 v83, v135, v135
v_fma_f32 v80, v80, v233, v229
v_fma_f32 v81, v81, v233, v229
v_fma_f32 v82, v82, v233, v229
v_fma_f32 v83, v83, v233, v229
v_mul_f32 v80, v80, v132
s_add_u32 m0, s39, 1024
s_add_u32 s37, s37, s38
buffer_load_dwordx4 v21, s[8:11], s37 offen sc1 lds
v_mul_f32 v81, v81, v133
v_mul_f32 v82, v82, v134
v_mul_f32 v83, v83, v135
v_exp_f32 v80, v80
v_exp_f32 v81, v81
v_exp_f32 v82, v82
s_add_u32 m0, s39, 2048
s_add_u32 s37, s37, s38
buffer_load_dwordx4 v21, s[8:11], s37 offen sc1 lds
v_exp_f32 v83, v83
v_mul_f32 v180, v132, v180
v_mul_f32 v181, v133, v181
v_mul_f32 v182, v134, v182
v_mul_f32 v183, v135, v183
v_fma_f32 v80, v80, v237, v237
v_fma_f32 v81, v81, v237, v237
s_add_u32 m0, s39, 3072
s_add_u32 s37, s37, s38
buffer_load_dwordx4 v21, s[8:11], s37 offen sc1 lds
v_fma_f32 v82, v82, v237, v237
v_fma_f32 v83, v83, v237, v237
v_rcp_f32 v80, v80
v_rcp_f32 v81, v81
v_rcp_f32 v82, v82
v_rcp_f32 v83, v83
s_add_u32 m0, s39, 4096
s_add_u32 s37, s37, s55
buffer_load_dwordx4 v21, s[8:11], s37 offen sc1 lds
v_mul_f32 v180, v180, v80
v_mul_f32 v181, v181, v81
v_mul_f32 v182, v182, v82
v_mul_f32 v183, v183, v83
v_cvt_pk_bf16_f32 v100, v180, v181
v_cvt_pk_bf16_f32 v101, v182, v183
v_mul_f32 v84, v148, v148
s_add_u32 m0, s39, 5120
s_add_u32 s37, s37, s38
buffer_load_dwordx4 v21, s[8:11], s37 offen sc1 lds
v_mul_f32 v85, v149, v149
v_mul_f32 v86, v150, v150
v_mul_f32 v87, v151, v151
v_fma_f32 v84, v84, v233, v229
v_fma_f32 v85, v85, v233, v229
v_fma_f32 v86, v86, v233, v229
s_add_u32 m0, s39, 6144
s_add_u32 s37, s37, s38
buffer_load_dwordx4 v21, s[8:11], s37 offen sc1 lds
v_fma_f32 v87, v87, v233, v229
v_mul_f32 v84, v84, v148
v_mul_f32 v85, v85, v149
v_mul_f32 v86, v86, v150
v_mul_f32 v87, v87, v151
v_exp_f32 v84, v84
v_exp_f32 v85, v85
s_add_u32 m0, s39, 7168
s_add_u32 s37, s37, s38
buffer_load_dwordx4 v21, s[8:11], s37 offen sc1 lds
v_exp_f32 v86, v86
v_exp_f32 v87, v87
v_mul_f32 v196, v148, v196
v_mul_f32 v197, v149, v197
v_mul_f32 v198, v150, v198
v_mul_f32 v199, v151, v199
s_waitcnt vmcnt(17)
s_barrier
s_add_u32 m0, s39, 32768
s_add_u32 s37, s37, s40
buffer_load_dwordx4 v21, s[8:11], s37 offen sc1 lds
v_fma_f32 v84, v84, v237, v237
v_fma_f32 v85, v85, v237, v237
v_fma_f32 v86, v86, v237, v237
v_fma_f32 v87, v87, v237, v237
v_rcp_f32 v84, v84
v_rcp_f32 v85, v85
v_rcp_f32 v86, v86
s_add_u32 m0, s39, 33792
s_add_u32 s37, s37, s38
buffer_load_dwordx4 v21, s[8:11], s37 offen sc1 lds
v_rcp_f32 v87, v87
v_mul_f32 v196, v196, v84
v_mul_f32 v197, v197, v85
v_mul_f32 v198, v198, v86
v_mul_f32 v199, v199, v87
v_cvt_pk_bf16_f32 v102, v196, v197
v_cvt_pk_bf16_f32 v103, v198, v199
s_add_u32 m0, s39, 34816
s_add_u32 s37, s37, s38
buffer_load_dwordx4 v21, s[8:11], s37 offen sc1 lds
v_mul_f32 v80, v164, v164
v_mul_f32 v81, v165, v165
v_mul_f32 v82, v166, v166
v_mul_f32 v83, v167, v167
v_fma_f32 v80, v80, v233, v229
s_add_u32 m0, s39, 35840
s_add_u32 s37, s37, s38
buffer_load_dwordx4 v21, s[8:11], s37 offen sc1 lds
v_fma_f32 v81, v81, v233, v229
v_fma_f32 v82, v82, v233, v229
v_fma_f32 v83, v83, v233, v229
v_mul_f32 v80, v80, v164
v_mul_f32 v81, v81, v165
v_mul_f32 v82, v82, v166
v_mul_f32 v83, v83, v167
s_add_u32 m0, s39, 36864
s_add_u32 s37, s37, s55
buffer_load_dwordx4 v21, s[8:11], s37 offen sc1 lds
v_exp_f32 v80, v80
v_exp_f32 v81, v81
v_exp_f32 v82, v82
v_exp_f32 v83, v83
v_mul_f32 v212, v164, v212
v_mul_f32 v213, v165, v213
v_mul_f32 v214, v166, v214
s_add_u32 m0, s39, 37888
s_add_u32 s37, s37, s38
buffer_load_dwordx4 v21, s[8:11], s37 offen sc1 lds
v_mul_f32 v215, v167, v215
v_fma_f32 v80, v80, v237, v237
v_fma_f32 v81, v81, v237, v237
v_fma_f32 v82, v82, v237, v237
v_fma_f32 v83, v83, v237, v237
v_rcp_f32 v80, v80
s_add_u32 m0, s39, 38912
s_add_u32 s37, s37, s38
buffer_load_dwordx4 v21, s[8:11], s37 offen sc1 lds
v_rcp_f32 v81, v81
v_rcp_f32 v82, v82
v_rcp_f32 v83, v83
v_mul_f32 v212, v212, v80
v_mul_f32 v213, v213, v81
v_mul_f32 v214, v214, v82
v_mul_f32 v215, v215, v83
s_add_u32 m0, s39, 39936
s_add_u32 s37, s37, s38
buffer_load_dwordx4 v21, s[8:11], s37 offen sc1 lds
v_cvt_pk_bf16_f32 v114, v212, v213
v_cvt_pk_bf16_f32 v115, v214, v215
s_nop 1
v_permlane32_swap_b32 v112, v114
v_permlane32_swap_b32 v113, v115
buffer_store_dwordx4 v[100:103], v27, s[24:27], 0 offen offset:256 sc1
buffer_store_dwordx4 v[112:115], v28, s[24:27], 0 offen offset:0 sc1
s_waitcnt vmcnt(19)
s_barrier
s_add_u32 m0, s39, 65536
s_add_u32 s37, s37, s40
buffer_load_dwordx4 v21, s[8:11], s37 offen sc1 lds
v_mul_f32 v80, v136, v136
v_mul_f32 v81, v137, v137
v_mul_f32 v82, v138, v138
v_mul_f32 v83, v139, v139
v_fma_f32 v80, v80, v234, v230
v_fma_f32 v81, v81, v234, v230
v_fma_f32 v82, v82, v234, v230
s_add_u32 m0, s39, 66560
s_add_u32 s37, s37, s38
buffer_load_dwordx4 v21, s[8:11], s37 offen sc1 lds
v_fma_f32 v83, v83, v234, v230
v_mul_f32 v80, v80, v136
v_mul_f32 v81, v81, v137
v_mul_f32 v82, v82, v138
v_mul_f32 v83, v83, v139
v_exp_f32 v80, v80
s_add_u32 m0, s39, 67584
s_add_u32 s37, s37, s38
buffer_load_dwordx4 v21, s[8:11], s37 offen sc1 lds
v_exp_f32 v81, v81
v_exp_f32 v82, v82
v_exp_f32 v83, v83
v_mul_f32 v184, v136, v184
v_mul_f32 v185, v137, v185
v_mul_f32 v186, v138, v186
v_mul_f32 v187, v139, v187
s_add_u32 m0, s39, 68608
s_add_u32 s37, s37, s38
buffer_load_dwordx4 v21, s[8:11], s37 offen sc1 lds
v_fma_f32 v80, v80, v238, v238
v_fma_f32 v81, v81, v238, v238
v_fma_f32 v82, v82, v238, v238
v_fma_f32 v83, v83, v238, v238
v_rcp_f32 v80, v80
v_rcp_f32 v81, v81
s_add_u32 m0, s39, 69632
s_add_u32 s37, s37, s55
buffer_load_dwordx4 v21, s[8:11], s37 offen sc1 lds
v_rcp_f32 v82, v82
v_rcp_f32 v83, v83
v_mul_f32 v184, v184, v80
v_mul_f32 v185, v185, v81
v_mul_f32 v186, v186, v82
v_mul_f32 v187, v187, v83
v_cvt_pk_bf16_f32 v104, v184, v185
s_add_u32 m0, s39, 70656
s_add_u32 s37, s37, s38
buffer_load_dwordx4 v21, s[8:11], s37 offen sc1 lds
v_cvt_pk_bf16_f32 v105, v186, v187
v_mul_f32 v84, v152, v152
v_mul_f32 v85, v153, v153
v_mul_f32 v86, v154, v154
v_mul_f32 v87, v155, v155
v_fma_f32 v84, v84, v234, v230
s_add_u32 m0, s39, 71680
s_add_u32 s37, s37, s38
buffer_load_dwordx4 v21, s[8:11], s37 offen sc1 lds
v_fma_f32 v85, v85, v234, v230
v_fma_f32 v86, v86, v234, v230
v_fma_f32 v87, v87, v234, v230
v_mul_f32 v84, v84, v152
v_mul_f32 v85, v85, v153
v_mul_f32 v86, v86, v154
v_mul_f32 v87, v87, v155
s_add_u32 m0, s39, 72704
s_add_u32 s37, s37, s38
buffer_load_dwordx4 v21, s[8:11], s37 offen sc1 lds
v_exp_f32 v84, v84
v_exp_f32 v85, v85
v_exp_f32 v86, v86
v_exp_f32 v87, v87
v_mul_f32 v200, v152, v200
v_mul_f32 v201, v153, v201
s_waitcnt vmcnt(18)
s_barrier
s_add_u32 m0, s39, 98304
s_add_u32 s37, s37, s40
buffer_load_dwordx4 v21, s[8:11], s37 offen sc1 lds
v_mul_f32 v202, v154, v202
v_mul_f32 v203, v155, v203
v_fma_f32 v84, v84, v238, v238
v_fma_f32 v85, v85, v238, v238
v_fma_f32 v86, v86, v238, v238
v_fma_f32 v87, v87, v238, v238
v_rcp_f32 v84, v84
s_add_u32 m0, s39, 99328
s_add_u32 s37, s37, s38
buffer_load_dwordx4 v21, s[8:11], s37 offen sc1 lds
v_rcp_f32 v85, v85
v_rcp_f32 v86, v86
v_rcp_f32 v87, v87
v_mul_f32 v200, v200, v84
v_mul_f32 v201, v201, v85
v_mul_f32 v202, v202, v86
v_mul_f32 v203, v203, v87
s_add_u32 m0, s39, 100352
s_add_u32 s37, s37, s38
buffer_load_dwordx4 v21, s[8:11], s37 offen sc1 lds
v_cvt_pk_bf16_f32 v106, v200, v201
v_cvt_pk_bf16_f32 v107, v202, v203
v_mul_f32 v80, v168, v168
v_mul_f32 v81, v169, v169
v_mul_f32 v82, v170, v170
s_add_u32 m0, s39, 101376
s_add_u32 s37, s37, s38
buffer_load_dwordx4 v21, s[8:11], s37 offen sc1 lds
v_mul_f32 v83, v171, v171
v_fma_f32 v80, v80, v234, v230
v_fma_f32 v81, v81, v234, v230
v_fma_f32 v82, v82, v234, v230
v_fma_f32 v83, v83, v234, v230
v_mul_f32 v80, v80, v168
v_mul_f32 v81, v81, v169
s_add_u32 m0, s39, 102400
s_add_u32 s37, s37, s55
buffer_load_dwordx4 v21, s[8:11], s37 offen sc1 lds
v_mul_f32 v82, v82, v170
v_mul_f32 v83, v83, v171
v_exp_f32 v80, v80
v_exp_f32 v81, v81
v_exp_f32 v82, v82
v_exp_f32 v83, v83
v_mul_f32 v216, v168, v216
s_add_u32 m0, s39, 103424
s_add_u32 s37, s37, s38
buffer_load_dwordx4 v21, s[8:11], s37 offen sc1 lds
v_mul_f32 v217, v169, v217
v_mul_f32 v218, v170, v218
v_mul_f32 v219, v171, v219
v_fma_f32 v80, v80, v238, v238
v_fma_f32 v81, v81, v238, v238
v_fma_f32 v82, v82, v238, v238
s_add_u32 m0, s39, 104448
s_add_u32 s37, s37, s38
buffer_load_dwordx4 v21, s[8:11], s37 offen sc1 lds
v_fma_f32 v83, v83, v238, v238
v_rcp_f32 v80, v80
v_rcp_f32 v81, v81
v_rcp_f32 v82, v82
v_rcp_f32 v83, v83
v_mul_f32 v216, v216, v80
v_mul_f32 v217, v217, v81
s_add_u32 m0, s39, 105472
s_add_u32 s37, s37, s38
buffer_load_dwordx4 v21, s[8:11], s37 offen sc1 lds
v_mul_f32 v218, v218, v82
v_mul_f32 v219, v219, v83
v_cvt_pk_bf16_f32 v116, v216, v217
v_cvt_pk_bf16_f32 v117, v218, v219
v_mul_f32 v80, v140, v140
v_mul_f32 v81, v141, v141
buffer_store_dwordx4 v[104:107], v27, s[24:27], 0 offen offset:512 sc1
s_waitcnt vmcnt(19)
s_barrier
s_add_u32 s37, s37, s29
s_add_u32 m0, s39, 0
s_add_u32 s37, s37, s40
buffer_load_dwordx4 v21, s[8:11], s37 offen sc1 lds
v_mul_f32 v82, v142, v142
v_mul_f32 v83, v143, v143
v_fma_f32 v80, v80, v235, v231
v_fma_f32 v81, v81, v235, v231
v_fma_f32 v82, v82, v235, v231
v_fma_f32 v83, v83, v235, v231
v_mul_f32 v80, v80, v140
s_add_u32 m0, s39, 1024
s_add_u32 s37, s37, s38
buffer_load_dwordx4 v21, s[8:11], s37 offen sc1 lds
v_mul_f32 v81, v81, v141
v_mul_f32 v82, v82, v142
v_mul_f32 v83, v83, v143
v_exp_f32 v80, v80
v_exp_f32 v81, v81
v_exp_f32 v82, v82
s_add_u32 m0, s39, 2048
s_add_u32 s37, s37, s38
buffer_load_dwordx4 v21, s[8:11], s37 offen sc1 lds
v_exp_f32 v83, v83
v_mul_f32 v188, v140, v188
v_mul_f32 v189, v141, v189
v_mul_f32 v190, v142, v190
v_mul_f32 v191, v143, v191
v_fma_f32 v80, v80, v239, v239
v_fma_f32 v81, v81, v239, v239
s_add_u32 m0, s39, 3072
s_add_u32 s37, s37, s38
buffer_load_dwordx4 v21, s[8:11], s37 offen sc1 lds
v_fma_f32 v82, v82, v239, v239
v_fma_f32 v83, v83, v239, v239
v_rcp_f32 v80, v80
v_rcp_f32 v81, v81
v_rcp_f32 v82, v82
v_rcp_f32 v83, v83
s_add_u32 m0, s39, 4096
s_add_u32 s37, s37, s55
buffer_load_dwordx4 v21, s[8:11], s37 offen sc1 lds
v_mul_f32 v188, v188, v80
v_mul_f32 v189, v189, v81
v_mul_f32 v190, v190, v82
v_mul_f32 v191, v191, v83
v_cvt_pk_bf16_f32 v108, v188, v189
v_cvt_pk_bf16_f32 v109, v190, v191
v_mul_f32 v84, v156, v156
s_add_u32 m0, s39, 5120
s_add_u32 s37, s37, s38
buffer_load_dwordx4 v21, s[8:11], s37 offen sc1 lds
v_mul_f32 v85, v157, v157
v_mul_f32 v86, v158, v158
v_mul_f32 v87, v159, v159
v_fma_f32 v84, v84, v235, v231
v_fma_f32 v85, v85, v235, v231
v_fma_f32 v86, v86, v235, v231
s_add_u32 m0, s39, 6144
s_add_u32 s37, s37, s38
buffer_load_dwordx4 v21, s[8:11], s37 offen sc1 lds
v_fma_f32 v87, v87, v235, v231
v_mul_f32 v84, v84, v156
v_mul_f32 v85, v85, v157
v_mul_f32 v86, v86, v158
v_mul_f32 v87, v87, v159
v_exp_f32 v84, v84
v_exp_f32 v85, v85
s_add_u32 m0, s39, 7168
s_add_u32 s37, s37, s38
buffer_load_dwordx4 v21, s[8:11], s37 offen sc1 lds
v_exp_f32 v86, v86
v_exp_f32 v87, v87
v_mul_f32 v204, v156, v204
v_mul_f32 v205, v157, v205
v_mul_f32 v206, v158, v206
v_mul_f32 v207, v159, v207
s_waitcnt vmcnt(17)
s_barrier
s_add_u32 m0, s39, 32768
s_add_u32 s37, s37, s40
buffer_load_dwordx4 v21, s[8:11], s37 offen sc1 lds
v_fma_f32 v84, v84, v239, v239
v_fma_f32 v85, v85, v239, v239
v_fma_f32 v86, v86, v239, v239
v_fma_f32 v87, v87, v239, v239
v_rcp_f32 v84, v84
v_rcp_f32 v85, v85
v_rcp_f32 v86, v86
s_add_u32 m0, s39, 33792
s_add_u32 s37, s37, s38
buffer_load_dwordx4 v21, s[8:11], s37 offen sc1 lds
v_rcp_f32 v87, v87
v_mul_f32 v204, v204, v84
v_mul_f32 v205, v205, v85
v_mul_f32 v206, v206, v86
v_mul_f32 v207, v207, v87
v_cvt_pk_bf16_f32 v110, v204, v205
v_cvt_pk_bf16_f32 v111, v206, v207
s_add_u32 m0, s39, 34816
s_add_u32 s37, s37, s38
buffer_load_dwordx4 v21, s[8:11], s37 offen sc1 lds
v_mul_f32 v80, v172, v172
v_mul_f32 v81, v173, v173
v_mul_f32 v82, v174, v174
v_mul_f32 v83, v175, v175
v_fma_f32 v80, v80, v235, v231
s_add_u32 m0, s39, 35840
s_add_u32 s37, s37, s38
buffer_load_dwordx4 v21, s[8:11], s37 offen sc1 lds
v_fma_f32 v81, v81, v235, v231
v_fma_f32 v82, v82, v235, v231
v_fma_f32 v83, v83, v235, v231
v_mul_f32 v80, v80, v172
v_mul_f32 v81, v81, v173
v_mul_f32 v82, v82, v174
v_mul_f32 v83, v83, v175
s_add_u32 m0, s39, 36864
s_add_u32 s37, s37, s55
buffer_load_dwordx4 v21, s[8:11], s37 offen sc1 lds
v_exp_f32 v80, v80
v_exp_f32 v81, v81
v_exp_f32 v82, v82
v_exp_f32 v83, v83
v_mul_f32 v220, v172, v220
v_mul_f32 v221, v173, v221
v_mul_f32 v222, v174, v222
s_add_u32 m0, s39, 37888
s_add_u32 s37, s37, s38
buffer_load_dwordx4 v21, s[8:11], s37 offen sc1 lds
v_mul_f32 v223, v175, v223
v_fma_f32 v80, v80, v239, v239
v_fma_f32 v81, v81, v239, v239
v_fma_f32 v82, v82, v239, v239
v_fma_f32 v83, v83, v239, v239
v_rcp_f32 v80, v80
s_add_u32 m0, s39, 38912
s_add_u32 s37, s37, s38
buffer_load_dwordx4 v21, s[8:11], s37 offen sc1 lds
v_rcp_f32 v81, v81
v_rcp_f32 v82, v82
v_rcp_f32 v83, v83
v_mul_f32 v220, v220, v80
v_mul_f32 v221, v221, v81
v_mul_f32 v222, v222, v82
v_mul_f32 v223, v223, v83
s_add_u32 m0, s39, 39936
s_add_u32 s37, s37, s38
buffer_load_dwordx4 v21, s[8:11], s37 offen sc1 lds
v_cvt_pk_bf16_f32 v118, v220, v221
v_cvt_pk_bf16_f32 v119, v222, v223
s_nop 1
v_permlane32_swap_b32 v116, v118
v_permlane32_swap_b32 v117, v119
buffer_store_dwordx4 v[108:111], v27, s[24:27], 0 offen offset:768 sc1
buffer_store_dwordx4 v[116:119], v28, s[24:27], 0 offen offset:512 sc1
s_waitcnt vmcnt(19)
s_barrier
s_add_u32 m0, s39, 65536
s_add_u32 s37, s37, s40
buffer_load_dwordx4 v21, s[8:11], s37 offen sc1 lds
s_add_u32 m0, s39, 66560
s_add_u32 s37, s37, s38
buffer_load_dwordx4 v21, s[8:11], s37 offen sc1 lds
s_add_u32 m0, s39, 67584
s_add_u32 s37, s37, s38
buffer_load_dwordx4 v21, s[8:11], s37 offen sc1 lds
s_add_u32 m0, s39, 68608
s_add_u32 s37, s37, s38
buffer_load_dwordx4 v21, s[8:11], s37 offen sc1 lds
s_add_u32 m0, s39, 69632
s_add_u32 s37, s37, s55
buffer_load_dwordx4 v21, s[8:11], s37 offen sc1 lds
s_add_u32 m0, s39, 70656
s_add_u32 s37, s37, s38
buffer_load_dwordx4 v21, s[8:11], s37 offen sc1 lds
s_add_u32 m0, s39, 71680
s_add_u32 s37, s37, s38
buffer_load_dwordx4 v21, s[8:11], s37 offen sc1 lds
s_add_u32 m0, s39, 72704
s_add_u32 s37, s37, s38
buffer_load_dwordx4 v21, s[8:11], s37 offen sc1 lds
s_waitcnt vmcnt(8)
s_barrier
s_add_u32 m0, s39, 98304
s_add_u32 s37, s37, s40
buffer_load_dwordx4 v21, s[8:11], s37 offen sc1 lds
s_add_u32 m0, s39, 99328
s_add_u32 s37, s37, s38
buffer_load_dwordx4 v21, s[8:11], s37 offen sc1 lds
s_add_u32 m0, s39, 100352
s_add_u32 s37, s37, s38
buffer_load_dwordx4 v21, s[8:11], s37 offen sc1 lds
s_add_u32 m0, s39, 101376
s_add_u32 s37, s37, s38
buffer_load_dwordx4 v21, s[8:11], s37 offen sc1 lds
s_add_u32 m0, s39, 102400
s_add_u32 s37, s37, s55
buffer_load_dwordx4 v21, s[8:11], s37 offen sc1 lds
s_add_u32 m0, s39, 103424
s_add_u32 s37, s37, s38
buffer_load_dwordx4 v21, s[8:11], s37 offen sc1 lds
s_add_u32 m0, s39, 104448
s_add_u32 s37, s37, s38
buffer_load_dwordx4 v21, s[8:11], s37 offen sc1 lds
s_add_u32 m0, s39, 105472
s_add_u32 s37, s37, s38
buffer_load_dwordx4 v21, s[8:11], s37 offen sc1 lds
s_waitcnt vmcnt(18)
s_barrier
s_add_u32 m0, s39, 0
s_add_u32 s37, s37, s40
buffer_load_dwordx4 v21, s[8:11], s37 offen sc1 lds
s_add_u32 m0, s39, 1024
s_add_u32 s37, s37, s38
buffer_load_dwordx4 v21, s[8:11], s37 offen sc1 lds
s_add_u32 m0, s39, 2048
s_add_u32 s37, s37, s38
buffer_load_dwordx4 v21, s[8:11], s37 offen sc1 lds
s_add_u32 m0, s39, 3072
s_add_u32 s37, s37, s38
buffer_load_dwordx4 v21, s[8:11], s37 offen sc1 lds
s_add_u32 m0, s39, 4096
s_add_u32 s37, s37, s55
buffer_load_dwordx4 v21, s[8:11], s37 offen sc1 lds
s_add_u32 m0, s39, 5120
s_add_u32 s37, s37, s38
buffer_load_dwordx4 v21, s[8:11], s37 offen sc1 lds
s_add_u32 m0, s39, 6144
s_add_u32 s37, s37, s38
buffer_load_dwordx4 v21, s[8:11], s37 offen sc1 lds
s_add_u32 m0, s39, 7168
s_add_u32 s37, s37, s38
buffer_load_dwordx4 v21, s[8:11], s37 offen sc1 lds
s_waitcnt vmcnt(16)
s_barrier
s_add_u32 m0, s39, 32768
s_add_u32 s37, s37, s40
buffer_load_dwordx4 v21, s[8:11], s37 offen sc1 lds
s_add_u32 m0, s39, 33792
s_add_u32 s37, s37, s38
buffer_load_dwordx4 v21, s[8:11], s37 offen sc1 lds
s_add_u32 m0, s39, 34816
s_add_u32 s37, s37, s38
buffer_load_dwordx4 v21, s[8:11], s37 offen sc1 lds
s_add_u32 m0, s39, 35840
s_add_u32 s37, s37, s38
buffer_load_dwordx4 v21, s[8:11], s37 offen sc1 lds
s_add_u32 m0, s39, 36864
s_add_u32 s37, s37, s55
buffer_load_dwordx4 v21, s[8:11], s37 offen sc1 lds
s_add_u32 m0, s39, 37888
s_add_u32 s37, s37, s38
buffer_load_dwordx4 v21, s[8:11], s37 offen sc1 lds
s_add_u32 m0, s39, 38912
s_add_u32 s37, s37, s38
buffer_load_dwordx4 v21, s[8:11], s37 offen sc1 lds
s_add_u32 m0, s39, 39936
s_add_u32 s37, s37, s38
buffer_load_dwordx4 v21, s[8:11], s37 offen sc1 lds
s_waitcnt vmcnt(16)
s_barrier
s_add_u32 m0, s39, 65536
s_add_u32 s37, s37, s40
buffer_load_dwordx4 v21, s[8:11], s37 offen sc1 lds
s_add_u32 m0, s39, 66560
s_add_u32 s37, s37, s38
buffer_load_dwordx4 v21, s[8:11], s37 offen sc1 lds
s_add_u32 m0, s39, 67584
s_add_u32 s37, s37, s38
buffer_load_dwordx4 v21, s[8:11], s37 offen sc1 lds
s_add_u32 m0, s39, 68608
s_add_u32 s37, s37, s38
buffer_load_dwordx4 v21, s[8:11], s37 offen sc1 lds
s_add_u32 m0, s39, 69632
s_add_u32 s37, s37, s55
buffer_load_dwordx4 v21, s[8:11], s37 offen sc1 lds
s_add_u32 m0, s39, 70656
s_add_u32 s37, s37, s38
buffer_load_dwordx4 v21, s[8:11], s37 offen sc1 lds
s_add_u32 m0, s39, 71680
s_add_u32 s37, s37, s38
buffer_load_dwordx4 v21, s[8:11], s37 offen sc1 lds
s_add_u32 m0, s39, 72704
s_add_u32 s37, s37, s38
buffer_load_dwordx4 v21, s[8:11], s37 offen sc1 lds
s_waitcnt vmcnt(16)
s_barrier
s_add_u32 m0, s39, 98304
s_add_u32 s37, s37, s40
buffer_load_dwordx4 v21, s[8:11], s37 offen sc1 lds
s_add_u32 m0, s39, 99328
s_add_u32 s37, s37, s38
buffer_load_dwordx4 v21, s[8:11], s37 offen sc1 lds
s_add_u32 m0, s39, 100352
s_add_u32 s37, s37, s38
buffer_load_dwordx4 v21, s[8:11], s37 offen sc1 lds
s_add_u32 m0, s39, 101376
s_add_u32 s37, s37, s38
buffer_load_dwordx4 v21, s[8:11], s37 offen sc1 lds
s_add_u32 m0, s39, 102400
s_add_u32 s37, s37, s55
buffer_load_dwordx4 v21, s[8:11], s37 offen sc1 lds
s_add_u32 m0, s39, 103424
s_add_u32 s37, s37, s38
buffer_load_dwordx4 v21, s[8:11], s37 offen sc1 lds
s_add_u32 m0, s39, 104448
s_add_u32 s37, s37, s38
buffer_load_dwordx4 v21, s[8:11], s37 offen sc1 lds
s_add_u32 m0, s39, 105472
s_add_u32 s37, s37, s38
buffer_load_dwordx4 v21, s[8:11], s37 offen sc1 lds
s_waitcnt vmcnt(16)
s_barrier
s_cmp_eq_u32 s51, 2
s_cbranch_scc1 LW4_53
s_mul_i32 s40, s53, 98304
s_add_u32 m0, s39, 0
s_add_u32 s37, s40, 524288
buffer_load_dwordx4 v21, s[8:11], s37 offen sc1 lds
s_add_u32 m0, s39, 1024
s_add_u32 s37, s40, 525312
buffer_load_dwordx4 v21, s[8:11], s37 offen sc1 lds
s_add_u32 m0, s39, 2048
s_add_u32 s37, s40, 526336
buffer_load_dwordx4 v21, s[8:11], s37 offen sc1 lds
s_add_u32 m0, s39, 3072
s_add_u32 s37, s40, 527360
buffer_load_dwordx4 v21, s[8:11], s37 offen sc1 lds
s_add_u32 m0, s39, 4096
s_add_u32 s37, s40, 528384
buffer_load_dwordx4 v21, s[8:11], s37 offen sc1 lds
s_add_u32 m0, s39, 5120
s_add_u32 s37, s40, 529408
buffer_load_dwordx4 v21, s[8:11], s37 offen sc1 lds
s_add_u32 m0, s39, 6144
s_add_u32 s37, s40, 530432
buffer_load_dwordx4 v21, s[8:11], s37 offen sc1 lds
s_add_u32 m0, s39, 7168
s_add_u32 s37, s40, 531456
buffer_load_dwordx4 v21, s[8:11], s37 offen sc1 lds
s_waitcnt vmcnt(16)
s_barrier
s_add_u32 m0, s39, 32768
s_add_u32 s37, s40, 540672
buffer_load_dwordx4 v21, s[8:11], s37 offen sc1 lds
s_add_u32 m0, s39, 33792
s_add_u32 s37, s40, 541696
buffer_load_dwordx4 v21, s[8:11], s37 offen sc1 lds
s_add_u32 m0, s39, 34816
s_add_u32 s37, s40, 542720
buffer_load_dwordx4 v21, s[8:11], s37 offen sc1 lds
s_add_u32 m0, s39, 35840
s_add_u32 s37, s40, 543744
buffer_load_dwordx4 v21, s[8:11], s37 offen sc1 lds
s_add_u32 m0, s39, 36864
s_add_u32 s37, s40, 544768
buffer_load_dwordx4 v21, s[8:11], s37 offen sc1 lds
s_add_u32 m0, s39, 37888
s_add_u32 s37, s40, 545792
buffer_load_dwordx4 v21, s[8:11], s37 offen sc1 lds
s_add_u32 m0, s39, 38912
s_add_u32 s37, s40, 546816
buffer_load_dwordx4 v21, s[8:11], s37 offen sc1 lds
s_add_u32 m0, s39, 39936
s_add_u32 s37, s40, 547840
buffer_load_dwordx4 v21, s[8:11], s37 offen sc1 lds
s_waitcnt vmcnt(16)
s_barrier
s_add_u32 m0, s39, 65536
s_add_u32 s37, s40, 557056
buffer_load_dwordx4 v21, s[8:11], s37 offen sc1 lds
s_add_u32 m0, s39, 66560
s_add_u32 s37, s40, 558080
buffer_load_dwordx4 v21, s[8:11], s37 offen sc1 lds
s_add_u32 m0, s39, 67584
s_add_u32 s37, s40, 559104
buffer_load_dwordx4 v21, s[8:11], s37 offen sc1 lds
s_add_u32 m0, s39, 68608
s_add_u32 s37, s40, 560128
buffer_load_dwordx4 v21, s[8:11], s37 offen sc1 lds
s_add_u32 m0, s39, 69632
s_add_u32 s37, s40, 561152
buffer_load_dwordx4 v21, s[8:11], s37 offen sc1 lds
s_add_u32 m0, s39, 70656
s_add_u32 s37, s40, 562176
buffer_load_dwordx4 v21, s[8:11], s37 offen sc1 lds
s_add_u32 m0, s39, 71680
s_add_u32 s37, s40, 563200
buffer_load_dwordx4 v21, s[8:11], s37 offen sc1 lds
s_add_u32 m0, s39, 72704
s_add_u32 s37, s40, 564224
buffer_load_dwordx4 v21, s[8:11], s37 offen sc1 lds
s_waitcnt vmcnt(16)
s_barrier
s_add_u32 m0, s39, 98304
s_add_u32 s37, s40, 573440
buffer_load_dwordx4 v21, s[8:11], s37 offen sc1 lds
s_add_u32 m0, s39, 99328
s_add_u32 s37, s40, 574464
buffer_load_dwordx4 v21, s[8:11], s37 offen sc1 lds
s_add_u32 m0, s39, 100352
s_add_u32 s37, s40, 575488
buffer_load_dwordx4 v21, s[8:11], s37 offen sc1 lds
s_add_u32 m0, s39, 101376
s_add_u32 s37, s40, 576512
buffer_load_dwordx4 v21, s[8:11], s37 offen sc1 lds
s_add_u32 m0, s39, 102400
s_add_u32 s37, s40, 577536
buffer_load_dwordx4 v21, s[8:11], s37 offen sc1 lds
s_add_u32 m0, s39, 103424
s_add_u32 s37, s40, 578560
buffer_load_dwordx4 v21, s[8:11], s37 offen sc1 lds
s_add_u32 m0, s39, 104448
s_add_u32 s37, s40, 579584
buffer_load_dwordx4 v21, s[8:11], s37 offen sc1 lds
s_add_u32 m0, s39, 105472
s_add_u32 s37, s40, 580608
buffer_load_dwordx4 v21, s[8:11], s37 offen sc1 lds
s_waitcnt vmcnt(16)
s_barrier
s_add_u32 m0, s39, 0
s_add_u32 s37, s40, 589824
buffer_load_dwordx4 v21, s[8:11], s37 offen sc1 lds
s_add_u32 m0, s39, 1024
s_add_u32 s37, s40, 590848
buffer_load_dwordx4 v21, s[8:11], s37 offen sc1 lds
s_add_u32 m0, s39, 2048
s_add_u32 s37, s40, 591872
buffer_load_dwordx4 v21, s[8:11], s37 offen sc1 lds
s_add_u32 m0, s39, 3072
s_add_u32 s37, s40, 592896
buffer_load_dwordx4 v21, s[8:11], s37 offen sc1 lds
s_add_u32 m0, s39, 4096
s_add_u32 s37, s40, 593920
buffer_load_dwordx4 v21, s[8:11], s37 offen sc1 lds
s_add_u32 m0, s39, 5120
s_add_u32 s37, s40, 594944
buffer_load_dwordx4 v21, s[8:11], s37 offen sc1 lds
s_add_u32 m0, s39, 6144
s_add_u32 s37, s40, 595968
buffer_load_dwordx4 v21, s[8:11], s37 offen sc1 lds
s_add_u32 m0, s39, 7168
s_add_u32 s37, s40, 596992
buffer_load_dwordx4 v21, s[8:11], s37 offen sc1 lds
s_waitcnt vmcnt(16)
s_barrier
s_add_u32 m0, s39, 32768
s_add_u32 s37, s40, 606208
buffer_load_dwordx4 v21, s[8:11], s37 offen sc1 lds
s_add_u32 m0, s39, 33792
s_add_u32 s37, s40, 607232
buffer_load_dwordx4 v21, s[8:11], s37 offen sc1 lds
s_add_u32 m0, s39, 34816
s_add_u32 s37, s40, 608256
buffer_load_dwordx4 v21, s[8:11], s37 offen sc1 lds
s_add_u32 m0, s39, 35840
s_add_u32 s37, s40, 609280
buffer_load_dwordx4 v21, s[8:11], s37 offen sc1 lds
s_add_u32 m0, s39, 36864
s_add_u32 s37, s40, 610304
buffer_load_dwordx4 v21, s[8:11], s37 offen sc1 lds
s_add_u32 m0, s39, 37888
s_add_u32 s37, s40, 611328
buffer_load_dwordx4 v21, s[8:11], s37 offen sc1 lds
s_add_u32 m0, s39, 38912
s_add_u32 s37, s40, 612352
buffer_load_dwordx4 v21, s[8:11], s37 offen sc1 lds
s_add_u32 m0, s39, 39936
s_add_u32 s37, s40, 613376
buffer_load_dwordx4 v21, s[8:11], s37 offen sc1 lds
s_waitcnt vmcnt(16)
s_barrier
s_add_u32 m0, s39, 65536
s_mov_b32 s37, 720896
buffer_load_dwordx4 v21, s[8:11], s37 offen sc1 lds
s_add_u32 m0, s39, 66560
s_mov_b32 s37, 721920
buffer_load_dwordx4 v21, s[8:11], s37 offen sc1 lds
s_add_u32 m0, s39, 67584
s_mov_b32 s37, 722944
buffer_load_dwordx4 v21, s[8:11], s37 offen sc1 lds
s_add_u32 m0, s39, 68608
s_mov_b32 s37, 723968
buffer_load_dwordx4 v21, s[8:11], s37 offen sc1 lds
s_add_u32 m0, s39, 69632
s_mov_b32 s37, 724992
buffer_load_dwordx4 v21, s[8:11], s37 offen sc1 lds
s_add_u32 m0, s39, 70656
s_mov_b32 s37, 726016
buffer_load_dwordx4 v21, s[8:11], s37 offen sc1 lds
s_add_u32 m0, s39, 71680
s_mov_b32 s37, 727040
buffer_load_dwordx4 v21, s[8:11], s37 offen sc1 lds
s_add_u32 m0, s39, 72704
s_mov_b32 s37, 728064
buffer_load_dwordx4 v21, s[8:11], s37 offen sc1 lds
s_waitcnt vmcnt(16)
s_barrier
s_add_u32 m0, s39, 98304
s_mov_b32 s37, 737280
buffer_load_dwordx4 v21, s[8:11], s37 offen sc1 lds
s_add_u32 m0, s39, 99328
s_mov_b32 s37, 738304
buffer_load_dwordx4 v21, s[8:11], s37 offen sc1 lds
s_add_u32 m0, s39, 100352
s_mov_b32 s37, 739328
buffer_load_dwordx4 v21, s[8:11], s37 offen sc1 lds
s_add_u32 m0, s39, 101376
s_mov_b32 s37, 740352
buffer_load_dwordx4 v21, s[8:11], s37 offen sc1 lds
s_add_u32 m0, s39, 102400
s_mov_b32 s37, 741376
buffer_load_dwordx4 v21, s[8:11], s37 offen sc1 lds
s_add_u32 m0, s39, 103424
s_mov_b32 s37, 742400
buffer_load_dwordx4 v21, s[8:11], s37 offen sc1 lds
s_add_u32 m0, s39, 104448
s_mov_b32 s37, 743424
buffer_load_dwordx4 v21, s[8:11], s37 offen sc1 lds
s_add_u32 m0, s39, 105472
s_mov_b32 s37, 744448
buffer_load_dwordx4 v21, s[8:11], s37 offen sc1 lds
s_waitcnt vmcnt(16)
s_barrier
s_add_u32 m0, s39, 0
s_mov_b32 s37, 753664
buffer_load_dwordx4 v21, s[8:11], s37 offen sc1 lds
s_add_u32 m0, s39, 1024
s_mov_b32 s37, 754688
buffer_load_dwordx4 v21, s[8:11], s37 offen sc1 lds
s_add_u32 m0, s39, 2048
s_mov_b32 s37, 755712
buffer_load_dwordx4 v21, s[8:11], s37 offen sc1 lds
s_add_u32 m0, s39, 3072
s_mov_b32 s37, 756736
buffer_load_dwordx4 v21, s[8:11], s37 offen sc1 lds
s_add_u32 m0, s39, 4096
s_mov_b32 s37, 757760
buffer_load_dwordx4 v21, s[8:11], s37 offen sc1 lds
s_add_u32 m0, s39, 5120
s_mov_b32 s37, 758784
buffer_load_dwordx4 v21, s[8:11], s37 offen sc1 lds
s_add_u32 m0, s39, 6144
s_mov_b32 s37, 759808
buffer_load_dwordx4 v21, s[8:11], s37 offen sc1 lds
s_add_u32 m0, s39, 7168
s_mov_b32 s37, 760832
buffer_load_dwordx4 v21, s[8:11], s37 offen sc1 lds
s_waitcnt vmcnt(16)
s_barrier
s_add_u32 m0, s39, 32768
s_mov_b32 s37, 770048
buffer_load_dwordx4 v21, s[8:11], s37 offen sc1 lds
s_add_u32 m0, s39, 33792
s_mov_b32 s37, 771072
buffer_load_dwordx4 v21, s[8:11], s37 offen sc1 lds
s_add_u32 m0, s39, 34816
s_mov_b32 s37, 772096
buffer_load_dwordx4 v21, s[8:11], s37 offen sc1 lds
s_add_u32 m0, s39, 35840
s_mov_b32 s37, 773120
buffer_load_dwordx4 v21, s[8:11], s37 offen sc1 lds
s_add_u32 m0, s39, 36864
s_mov_b32 s37, 774144
buffer_load_dwordx4 v21, s[8:11], s37 offen sc1 lds
s_add_u32 m0, s39, 37888
s_mov_b32 s37, 775168
buffer_load_dwordx4 v21, s[8:11], s37 offen sc1 lds
s_add_u32 m0, s39, 38912
s_mov_b32 s37, 776192
buffer_load_dwordx4 v21, s[8:11], s37 offen sc1 lds
s_add_u32 m0, s39, 39936
s_mov_b32 s37, 777216
buffer_load_dwordx4 v21, s[8:11], s37 offen sc1 lds
s_waitcnt vmcnt(16)
s_barrier
s_add_u32 m0, s39, 65536
s_mov_b32 s37, 786432
buffer_load_dwordx4 v21, s[8:11], s37 offen sc1 lds
s_add_u32 m0, s39, 66560
s_mov_b32 s37, 787456
buffer_load_dwordx4 v21, s[8:11], s37 offen sc1 lds
s_add_u32 m0, s39, 67584
s_mov_b32 s37, 788480
buffer_load_dwordx4 v21, s[8:11], s37 offen sc1 lds
s_add_u32 m0, s39, 68608
s_mov_b32 s37, 789504
buffer_load_dwordx4 v21, s[8:11], s37 offen sc1 lds
s_add_u32 m0, s39, 69632
s_mov_b32 s37, 790528
buffer_load_dwordx4 v21, s[8:11], s37 offen sc1 lds
s_add_u32 m0, s39, 70656
s_mov_b32 s37, 791552
buffer_load_dwordx4 v21, s[8:11], s37 offen sc1 lds
s_add_u32 m0, s39, 71680
s_mov_b32 s37, 792576
buffer_load_dwordx4 v21, s[8:11], s37 offen sc1 lds
s_add_u32 m0, s39, 72704
s_mov_b32 s37, 793600
buffer_load_dwordx4 v21, s[8:11], s37 offen sc1 lds
s_waitcnt vmcnt(16)
s_barrier
s_add_u32 m0, s39, 98304
s_mov_b32 s37, 802816
buffer_load_dwordx4 v21, s[8:11], s37 offen sc1 lds
s_add_u32 m0, s39, 99328
s_mov_b32 s37, 803840
buffer_load_dwordx4 v21, s[8:11], s37 offen sc1 lds
s_add_u32 m0, s39, 100352
s_mov_b32 s37, 804864
buffer_load_dwordx4 v21, s[8:11], s37 offen sc1 lds
s_add_u32 m0, s39, 101376
s_mov_b32 s37, 805888
buffer_load_dwordx4 v21, s[8:11], s37 offen sc1 lds
s_add_u32 m0, s39, 102400
s_mov_b32 s37, 806912
buffer_load_dwordx4 v21, s[8:11], s37 offen sc1 lds
s_add_u32 m0, s39, 103424
s_mov_b32 s37, 807936
buffer_load_dwordx4 v21, s[8:11], s37 offen sc1 lds
s_add_u32 m0, s39, 104448
s_mov_b32 s37, 808960
buffer_load_dwordx4 v21, s[8:11], s37 offen sc1 lds
s_add_u32 m0, s39, 105472
s_mov_b32 s37, 809984
buffer_load_dwordx4 v21, s[8:11], s37 offen sc1 lds
s_waitcnt vmcnt(16)
s_barrier
s_add_u32 m0, s39, 0
s_mov_b32 s37, 819200
buffer_load_dwordx4 v21, s[8:11], s37 offen sc1 lds
s_add_u32 m0, s39, 1024
s_mov_b32 s37, 820224
buffer_load_dwordx4 v21, s[8:11], s37 offen sc1 lds
s_add_u32 m0, s39, 2048
s_mov_b32 s37, 821248
buffer_load_dwordx4 v21, s[8:11], s37 offen sc1 lds
s_add_u32 m0, s39, 3072
s_mov_b32 s37, 822272
buffer_load_dwordx4 v21, s[8:11], s37 offen sc1 lds
s_add_u32 m0, s39, 4096
s_mov_b32 s37, 823296
buffer_load_dwordx4 v21, s[8:11], s37 offen sc1 lds
s_add_u32 m0, s39, 5120
s_mov_b32 s37, 824320
buffer_load_dwordx4 v21, s[8:11], s37 offen sc1 lds
s_add_u32 m0, s39, 6144
s_mov_b32 s37, 825344
buffer_load_dwordx4 v21, s[8:11], s37 offen sc1 lds
s_add_u32 m0, s39, 7168
s_mov_b32 s37, 826368
buffer_load_dwordx4 v21, s[8:11], s37 offen sc1 lds
s_waitcnt vmcnt(16)
s_barrier
s_add_u32 m0, s39, 32768
s_mov_b32 s37, 835584
buffer_load_dwordx4 v21, s[8:11], s37 offen sc1 lds
s_add_u32 m0, s39, 33792
s_mov_b32 s37, 836608
buffer_load_dwordx4 v21, s[8:11], s37 offen sc1 lds
s_add_u32 m0, s39, 34816
s_mov_b32 s37, 837632
buffer_load_dwordx4 v21, s[8:11], s37 offen sc1 lds
s_add_u32 m0, s39, 35840
s_mov_b32 s37, 838656
buffer_load_dwordx4 v21, s[8:11], s37 offen sc1 lds
s_add_u32 m0, s39, 36864
s_mov_b32 s37, 839680
buffer_load_dwordx4 v21, s[8:11], s37 offen sc1 lds
s_add_u32 m0, s39, 37888
s_mov_b32 s37, 840704
buffer_load_dwordx4 v21, s[8:11], s37 offen sc1 lds
s_add_u32 m0, s39, 38912
s_mov_b32 s37, 841728
buffer_load_dwordx4 v21, s[8:11], s37 offen sc1 lds
s_add_u32 m0, s39, 39936
s_mov_b32 s37, 842752
buffer_load_dwordx4 v21, s[8:11], s37 offen sc1 lds
s_waitcnt vmcnt(16)
s_barrier
s_add_u32 m0, s39, 65536
s_mov_b32 s37, 851968
buffer_load_dwordx4 v21, s[8:11], s37 offen sc1 lds
s_add_u32 m0, s39, 66560
s_mov_b32 s37, 852992
buffer_load_dwordx4 v21, s[8:11], s37 offen sc1 lds
s_add_u32 m0, s39, 67584
s_mov_b32 s37, 854016
buffer_load_dwordx4 v21, s[8:11], s37 offen sc1 lds
s_add_u32 m0, s39, 68608
s_mov_b32 s37, 855040
buffer_load_dwordx4 v21, s[8:11], s37 offen sc1 lds
s_add_u32 m0, s39, 69632
s_mov_b32 s37, 856064
buffer_load_dwordx4 v21, s[8:11], s37 offen sc1 lds
s_add_u32 m0, s39, 70656
s_mov_b32 s37, 857088
buffer_load_dwordx4 v21, s[8:11], s37 offen sc1 lds
s_add_u32 m0, s39, 71680
s_mov_b32 s37, 858112
buffer_load_dwordx4 v21, s[8:11], s37 offen sc1 lds
s_add_u32 m0, s39, 72704
s_mov_b32 s37, 859136
buffer_load_dwordx4 v21, s[8:11], s37 offen sc1 lds
s_waitcnt vmcnt(16)
s_barrier
s_add_u32 m0, s39, 98304
s_mov_b32 s37, 868352
buffer_load_dwordx4 v21, s[8:11], s37 offen sc1 lds
s_add_u32 m0, s39, 99328
s_mov_b32 s37, 869376
buffer_load_dwordx4 v21, s[8:11], s37 offen sc1 lds
s_add_u32 m0, s39, 100352
s_mov_b32 s37, 870400
buffer_load_dwordx4 v21, s[8:11], s37 offen sc1 lds
s_add_u32 m0, s39, 101376
s_mov_b32 s37, 871424
buffer_load_dwordx4 v21, s[8:11], s37 offen sc1 lds
s_add_u32 m0, s39, 102400
s_mov_b32 s37, 872448
buffer_load_dwordx4 v21, s[8:11], s37 offen sc1 lds
s_add_u32 m0, s39, 103424
s_mov_b32 s37, 873472
buffer_load_dwordx4 v21, s[8:11], s37 offen sc1 lds
s_add_u32 m0, s39, 104448
s_mov_b32 s37, 874496
buffer_load_dwordx4 v21, s[8:11], s37 offen sc1 lds
s_add_u32 m0, s39, 105472
s_mov_b32 s37, 875520
buffer_load_dwordx4 v21, s[8:11], s37 offen sc1 lds
s_waitcnt vmcnt(16)
s_barrier
s_add_u32 m0, s39, 0
s_mov_b32 s37, 884736
buffer_load_dwordx4 v21, s[8:11], s37 offen sc1 lds
s_add_u32 m0, s39, 1024
s_mov_b32 s37, 885760
buffer_load_dwordx4 v21, s[8:11], s37 offen sc1 lds
s_add_u32 m0, s39, 2048
s_mov_b32 s37, 886784
buffer_load_dwordx4 v21, s[8:11], s37 offen sc1 lds
s_add_u32 m0, s39, 3072
s_mov_b32 s37, 887808
buffer_load_dwordx4 v21, s[8:11], s37 offen sc1 lds
s_add_u32 m0, s39, 4096
s_mov_b32 s37, 888832
buffer_load_dwordx4 v21, s[8:11], s37 offen sc1 lds
s_add_u32 m0, s39, 5120
s_mov_b32 s37, 889856
buffer_load_dwordx4 v21, s[8:11], s37 offen sc1 lds
s_add_u32 m0, s39, 6144
s_mov_b32 s37, 890880
buffer_load_dwordx4 v21, s[8:11], s37 offen sc1 lds
s_add_u32 m0, s39, 7168
s_mov_b32 s37, 891904
buffer_load_dwordx4 v21, s[8:11], s37 offen sc1 lds
s_waitcnt vmcnt(16)
s_barrier
s_add_u32 m0, s39, 32768
s_mov_b32 s37, 901120
buffer_load_dwordx4 v21, s[8:11], s37 offen sc1 lds
s_add_u32 m0, s39, 33792
s_mov_b32 s37, 902144
buffer_load_dwordx4 v21, s[8:11], s37 offen sc1 lds
s_add_u32 m0, s39, 34816
s_mov_b32 s37, 903168
buffer_load_dwordx4 v21, s[8:11], s37 offen sc1 lds
s_add_u32 m0, s39, 35840
s_mov_b32 s37, 904192
buffer_load_dwordx4 v21, s[8:11], s37 offen sc1 lds
s_add_u32 m0, s39, 36864
s_mov_b32 s37, 905216
buffer_load_dwordx4 v21, s[8:11], s37 offen sc1 lds
s_add_u32 m0, s39, 37888
s_mov_b32 s37, 906240
buffer_load_dwordx4 v21, s[8:11], s37 offen sc1 lds
s_add_u32 m0, s39, 38912
s_mov_b32 s37, 907264
buffer_load_dwordx4 v21, s[8:11], s37 offen sc1 lds
s_add_u32 m0, s39, 39936
s_mov_b32 s37, 908288
buffer_load_dwordx4 v21, s[8:11], s37 offen sc1 lds
s_waitcnt vmcnt(16)
s_barrier
s_waitcnt vmcnt(8)
s_barrier
s_waitcnt vmcnt(0)
s_barrier
s_branch Ldone_1
LW4_53:
s_mul_i32 s40, s53, 786432
s_add_u32 m0, s39, 0
s_add_u32 s37, s40, 4194304
buffer_load_dwordx4 v21, s[8:11], s37 offen sc1 lds
s_add_u32 m0, s39, 1024
s_add_u32 s37, s40, 4210688
buffer_load_dwordx4 v21, s[8:11], s37 offen sc1 lds
s_add_u32 m0, s39, 2048
s_add_u32 s37, s40, 4227072
buffer_load_dwordx4 v21, s[8:11], s37 offen sc1 lds
s_add_u32 m0, s39, 3072
s_add_u32 s37, s40, 4243456
buffer_load_dwordx4 v21, s[8:11], s37 offen sc1 lds
s_add_u32 m0, s39, 4096
s_add_u32 s37, s40, 4292608
buffer_load_dwordx4 v21, s[8:11], s37 offen sc1 lds
s_add_u32 m0, s39, 5120
s_add_u32 s37, s40, 4308992
buffer_load_dwordx4 v21, s[8:11], s37 offen sc1 lds
s_add_u32 m0, s39, 6144
s_add_u32 s37, s40, 4325376
buffer_load_dwordx4 v21, s[8:11], s37 offen sc1 lds
s_add_u32 m0, s39, 7168
s_add_u32 s37, s40, 4341760
buffer_load_dwordx4 v21, s[8:11], s37 offen sc1 lds
s_waitcnt vmcnt(16)
s_barrier
s_add_u32 m0, s39, 32768
s_add_u32 s37, s40, 4259840
buffer_load_dwordx4 v21, s[8:11], s37 offen sc1 lds
s_add_u32 m0, s39, 33792
s_add_u32 s37, s40, 4358144
buffer_load_dwordx4 v21, s[8:11], s37 offen sc1 lds
s_add_u32 m0, s39, 34816
s_add_u32 s37, s40, 4276224
buffer_load_dwordx4 v21, s[8:11], s37 offen sc1 lds
s_add_u32 m0, s39, 35840
s_add_u32 s37, s40, 4374528
buffer_load_dwordx4 v21, s[8:11], s37 offen sc1 lds
s_add_u32 m0, s39, 36864
s_add_u32 s37, s40, 4390912
buffer_load_dwordx4 v21, s[8:11], s37 offen sc1 lds
s_add_u32 m0, s39, 37888
s_add_u32 s37, s40, 4407296
buffer_load_dwordx4 v21, s[8:11], s37 offen sc1 lds
s_add_u32 m0, s39, 38912
s_add_u32 s37, s40, 4423680
buffer_load_dwordx4 v21, s[8:11], s37 offen sc1 lds
s_add_u32 m0, s39, 39936
s_add_u32 s37, s40, 4440064
buffer_load_dwordx4 v21, s[8:11], s37 offen sc1 lds
s_waitcnt vmcnt(16)
s_barrier
s_add_u32 m0, s39, 65536
s_add_u32 s37, s40, 4489216
buffer_load_dwordx4 v21, s[8:11], s37 offen sc1 lds
s_add_u32 m0, s39, 66560
s_add_u32 s37, s40, 4505600
buffer_load_dwordx4 v21, s[8:11], s37 offen sc1 lds
s_add_u32 m0, s39, 67584
s_add_u32 s37, s40, 4521984
buffer_load_dwordx4 v21, s[8:11], s37 offen sc1 lds
s_add_u32 m0, s39, 68608
s_add_u32 s37, s40, 4538368
buffer_load_dwordx4 v21, s[8:11], s37 offen sc1 lds
s_add_u32 m0, s39, 69632
s_add_u32 s37, s40, 4456448
buffer_load_dwordx4 v21, s[8:11], s37 offen sc1 lds
s_add_u32 m0, s39, 70656
s_add_u32 s37, s40, 4554752
buffer_load_dwordx4 v21, s[8:11], s37 offen sc1 lds
s_add_u32 m0, s39, 71680
s_add_u32 s37, s40, 4472832
buffer_load_dwordx4 v21, s[8:11], s37 offen sc1 lds
s_add_u32 m0, s39, 72704
s_add_u32 s37, s40, 4571136
buffer_load_dwordx4 v21, s[8:11], s37 offen sc1 lds
s_waitcnt vmcnt(16)
s_barrier
s_add_u32 m0, s39, 98304
s_add_u32 s37, s40, 4587520
buffer_load_dwordx4 v21, s[8:11], s37 offen sc1 lds
s_add_u32 m0, s39, 99328
s_add_u32 s37, s40, 4603904
buffer_load_dwordx4 v21, s[8:11], s37 offen sc1 lds
s_add_u32 m0, s39, 100352
s_add_u32 s37, s40, 4620288
buffer_load_dwordx4 v21, s[8:11], s37 offen sc1 lds
s_add_u32 m0, s39, 101376
s_add_u32 s37, s40, 4636672
buffer_load_dwordx4 v21, s[8:11], s37 offen sc1 lds
s_add_u32 m0, s39, 102400
s_add_u32 s37, s40, 4685824
buffer_load_dwordx4 v21, s[8:11], s37 offen sc1 lds
s_add_u32 m0, s39, 103424
s_add_u32 s37, s40, 4702208
buffer_load_dwordx4 v21, s[8:11], s37 offen sc1 lds
s_add_u32 m0, s39, 104448
s_add_u32 s37, s40, 4718592
buffer_load_dwordx4 v21, s[8:11], s37 offen sc1 lds
s_add_u32 m0, s39, 105472
s_add_u32 s37, s40, 4734976
buffer_load_dwordx4 v21, s[8:11], s37 offen sc1 lds
s_waitcnt vmcnt(16)
s_barrier
s_add_u32 m0, s39, 0
s_add_u32 s37, s40, 4653056
buffer_load_dwordx4 v21, s[8:11], s37 offen sc1 lds
s_add_u32 m0, s39, 1024
s_add_u32 s37, s40, 4751360
buffer_load_dwordx4 v21, s[8:11], s37 offen sc1 lds
s_add_u32 m0, s39, 2048
s_add_u32 s37, s40, 4669440
buffer_load_dwordx4 v21, s[8:11], s37 offen sc1 lds
s_add_u32 m0, s39, 3072
s_add_u32 s37, s40, 4767744
buffer_load_dwordx4 v21, s[8:11], s37 offen sc1 lds
s_add_u32 m0, s39, 4096
s_add_u32 s37, s40, 4784128
buffer_load_dwordx4 v21, s[8:11], s37 offen sc1 lds
s_add_u32 m0, s39, 5120
s_add_u32 s37, s40, 4800512
buffer_load_dwordx4 v21, s[8:11], s37 offen sc1 lds
s_add_u32 m0, s39, 6144
s_add_u32 s37, s40, 4816896
buffer_load_dwordx4 v21, s[8:11], s37 offen sc1 lds
s_add_u32 m0, s39, 7168
s_add_u32 s37, s40, 4833280
buffer_load_dwordx4 v21, s[8:11], s37 offen sc1 lds
s_waitcnt vmcnt(16)
s_barrier
s_add_u32 m0, s39, 32768
s_add_u32 s37, s40, 4882432
buffer_load_dwordx4 v21, s[8:11], s37 offen sc1 lds
s_add_u32 m0, s39, 33792
s_add_u32 s37, s40, 4898816
buffer_load_dwordx4 v21, s[8:11], s37 offen sc1 lds
s_add_u32 m0, s39, 34816
s_add_u32 s37, s40, 4915200
buffer_load_dwordx4 v21, s[8:11], s37 offen sc1 lds
s_add_u32 m0, s39, 35840
s_add_u32 s37, s40, 4931584
buffer_load_dwordx4 v21, s[8:11], s37 offen sc1 lds
s_add_u32 m0, s39, 36864
s_add_u32 s37, s40, 4849664
buffer_load_dwordx4 v21, s[8:11], s37 offen sc1 lds
s_add_u32 m0, s39, 37888
s_add_u32 s37, s40, 4947968
buffer_load_dwordx4 v21, s[8:11], s37 offen sc1 lds
s_add_u32 m0, s39, 38912
s_add_u32 s37, s40, 4866048
buffer_load_dwordx4 v21, s[8:11], s37 offen sc1 lds
s_add_u32 m0, s39, 39936
s_add_u32 s37, s40, 4964352
buffer_load_dwordx4 v21, s[8:11], s37 offen sc1 lds
s_waitcnt vmcnt(16)
s_barrier
s_add_u32 m0, s39, 65536
s_mov_b32 s37, 5767168
buffer_load_dwordx4 v21, s[8:11], s37 offen sc1 lds
s_add_u32 m0, s39, 66560
s_mov_b32 s37, 5783552
buffer_load_dwordx4 v21, s[8:11], s37 offen sc1 lds
s_add_u32 m0, s39, 67584
s_mov_b32 s37, 5799936
buffer_load_dwordx4 v21, s[8:11], s37 offen sc1 lds
s_add_u32 m0, s39, 68608
s_mov_b32 s37, 5816320
buffer_load_dwordx4 v21, s[8:11], s37 offen sc1 lds
s_add_u32 m0, s39, 69632
s_mov_b32 s37, 5865472
buffer_load_dwordx4 v21, s[8:11], s37 offen sc1 lds
s_add_u32 m0, s39, 70656
s_mov_b32 s37, 5881856
buffer_load_dwordx4 v21, s[8:11], s37 offen sc1 lds
s_add_u32 m0, s39, 71680
s_mov_b32 s37, 5898240
buffer_load_dwordx4 v21, s[8:11], s37 offen sc1 lds
s_add_u32 m0, s39, 72704
s_mov_b32 s37, 5914624
buffer_load_dwordx4 v21, s[8:11], s37 offen sc1 lds
s_waitcnt vmcnt(16)
s_barrier
s_add_u32 m0, s39, 98304
s_mov_b32 s37, 5832704
buffer_load_dwordx4 v21, s[8:11], s37 offen sc1 lds
s_add_u32 m0, s39, 99328
s_mov_b32 s37, 5931008
buffer_load_dwordx4 v21, s[8:11], s37 offen sc1 lds
s_add_u32 m0, s39, 100352
s_mov_b32 s37, 5849088
buffer_load_dwordx4 v21, s[8:11], s37 offen sc1 lds
s_add_u32 m0, s39, 101376
s_mov_b32 s37, 5947392
buffer_load_dwordx4 v21, s[8:11], s37 offen sc1 lds
s_add_u32 m0, s39, 102400
s_mov_b32 s37, 5963776
buffer_load_dwordx4 v21, s[8:11], s37 offen sc1 lds
s_add_u32 m0, s39, 103424
s_mov_b32 s37, 5980160
buffer_load_dwordx4 v21, s[8:11], s37 offen sc1 lds
s_add_u32 m0, s39, 104448
s_mov_b32 s37, 5996544
buffer_load_dwordx4 v21, s[8:11], s37 offen sc1 lds
s_add_u32 m0, s39, 105472
s_mov_b32 s37, 6012928
buffer_load_dwordx4 v21, s[8:11], s37 offen sc1 lds
s_waitcnt vmcnt(16)
s_barrier
s_add_u32 m0, s39, 0
s_mov_b32 s37, 6062080
buffer_load_dwordx4 v21, s[8:11], s37 offen sc1 lds
s_add_u32 m0, s39, 1024
s_mov_b32 s37, 6078464
buffer_load_dwordx4 v21, s[8:11], s37 offen sc1 lds
s_add_u32 m0, s39, 2048
s_mov_b32 s37, 6094848
buffer_load_dwordx4 v21, s[8:11], s37 offen sc1 lds
s_add_u32 m0, s39, 3072
s_mov_b32 s37, 6111232
buffer_load_dwordx4 v21, s[8:11], s37 offen sc1 lds
s_add_u32 m0, s39, 4096
s_mov_b32 s37, 6029312
buffer_load_dwordx4 v21, s[8:11], s37 offen sc1 lds
s_add_u32 m0, s39, 5120
s_mov_b32 s37, 6127616
buffer_load_dwordx4 v21, s[8:11], s37 offen sc1 lds
s_add_u32 m0, s39, 6144
s_mov_b32 s37, 6045696
buffer_load_dwordx4 v21, s[8:11], s37 offen sc1 lds
s_add_u32 m0, s39, 7168
s_mov_b32 s37, 6144000
buffer_load_dwordx4 v21, s[8:11], s37 offen sc1 lds
s_waitcnt vmcnt(16)
s_barrier
s_add_u32 m0, s39, 32768
s_mov_b32 s37, 6160384
buffer_load_dwordx4 v21, s[8:11], s37 offen sc1 lds
s_add_u32 m0, s39, 33792
s_mov_b32 s37, 6176768
buffer_load_dwordx4 v21, s[8:11], s37 offen sc1 lds
s_add_u32 m0, s39, 34816
s_mov_b32 s37, 6193152
buffer_load_dwordx4 v21, s[8:11], s37 offen sc1 lds
s_add_u32 m0, s39, 35840
s_mov_b32 s37, 6209536
buffer_load_dwordx4 v21, s[8:11], s37 offen sc1 lds
s_add_u32 m0, s39, 36864
s_mov_b32 s37, 6258688
buffer_load_dwordx4 v21, s[8:11], s37 offen sc1 lds
s_add_u32 m0, s39, 37888
s_mov_b32 s37, 6275072
buffer_load_dwordx4 v21, s[8:11], s37 offen sc1 lds
s_add_u32 m0, s39, 38912
s_mov_b32 s37, 6291456
buffer_load_dwordx4 v21, s[8:11], s37 offen sc1 lds
s_add_u32 m0, s39, 39936
s_mov_b32 s37, 6307840
buffer_load_dwordx4 v21, s[8:11], s37 offen sc1 lds
s_waitcnt vmcnt(16)
s_barrier
s_add_u32 m0, s39, 65536
s_mov_b32 s37, 6225920
buffer_load_dwordx4 v21, s[8:11], s37 offen sc1 lds
s_add_u32 m0, s39, 66560
s_mov_b32 s37, 6324224
buffer_load_dwordx4 v21, s[8:11], s37 offen sc1 lds
s_add_u32 m0, s39, 67584
s_mov_b32 s37, 6242304
buffer_load_dwordx4 v21, s[8:11], s37 offen sc1 lds
s_add_u32 m0, s39, 68608
s_mov_b32 s37, 6340608
buffer_load_dwordx4 v21, s[8:11], s37 offen sc1 lds
s_add_u32 m0, s39, 69632
s_mov_b32 s37, 6356992
buffer_load_dwordx4 v21, s[8:11], s37 offen sc1 lds
s_add_u32 m0, s39, 70656
s_mov_b32 s37, 6373376
buffer_load_dwordx4 v21, s[8:11], s37 offen sc1 lds
s_add_u32 m0, s39, 71680
s_mov_b32 s37, 6389760
buffer_load_dwordx4 v21, s[8:11], s37 offen sc1 lds
s_add_u32 m0, s39, 72704
s_mov_b32 s37, 6406144
buffer_load_dwordx4 v21, s[8:11], s37 offen sc1 lds
s_waitcnt vmcnt(16)
s_barrier
s_add_u32 m0, s39, 98304
s_mov_b32 s37, 6455296
buffer_load_dwordx4 v21, s[8:11], s37 offen sc1 lds
s_add_u32 m0, s39, 99328
s_mov_b32 s37, 6471680
buffer_load_dwordx4 v21, s[8:11], s37 offen sc1 lds
s_add_u32 m0, s39, 100352
s_mov_b32 s37, 6488064
buffer_load_dwordx4 v21, s[8:11], s37 offen sc1 lds
s_add_u32 m0, s39, 101376
s_mov_b32 s37, 6504448
buffer_load_dwordx4 v21, s[8:11], s37 offen sc1 lds
s_add_u32 m0, s39, 102400
s_mov_b32 s37, 6422528
buffer_load_dwordx4 v21, s[8:11], s37 offen sc1 lds
s_add_u32 m0, s39, 103424
s_mov_b32 s37, 6520832
buffer_load_dwordx4 v21, s[8:11], s37 offen sc1 lds
s_add_u32 m0, s39, 104448
s_mov_b32 s37, 6438912
buffer_load_dwordx4 v21, s[8:11], s37 offen sc1 lds
s_add_u32 m0, s39, 105472
s_mov_b32 s37, 6537216
buffer_load_dwordx4 v21, s[8:11], s37 offen sc1 lds
s_waitcnt vmcnt(16)
s_barrier
s_add_u32 m0, s39, 0
s_mov_b32 s37, 6553600
buffer_load_dwordx4 v21, s[8:11], s37 offen sc1 lds
s_add_u32 m0, s39, 1024
s_mov_b32 s37, 6569984
buffer_load_dwordx4 v21, s[8:11], s37 offen sc1 lds
s_add_u32 m0, s39, 2048
s_mov_b32 s37, 6586368
buffer_load_dwordx4 v21, s[8:11], s37 offen sc1 lds
s_add_u32 m0, s39, 3072
s_mov_b32 s37, 6602752
buffer_load_dwordx4 v21, s[8:11], s37 offen sc1 lds
s_add_u32 m0, s39, 4096
s_mov_b32 s37, 6651904
buffer_load_dwordx4 v21, s[8:11], s37 offen sc1 lds
s_add_u32 m0, s39, 5120
s_mov_b32 s37, 6668288
buffer_load_dwordx4 v21, s[8:11], s37 offen sc1 lds
s_add_u32 m0, s39, 6144
s_mov_b32 s37, 6684672
buffer_load_dwordx4 v21, s[8:11], s37 offen sc1 lds
s_add_u32 m0, s39, 7168
s_mov_b32 s37, 6701056
buffer_load_dwordx4 v21, s[8:11], s37 offen sc1 lds
s_waitcnt vmcnt(16)
s_barrier
s_add_u32 m0, s39, 32768
s_mov_b32 s37, 6619136
buffer_load_dwordx4 v21, s[8:11], s37 offen sc1 lds
s_add_u32 m0, s39, 33792
s_mov_b32 s37, 6717440
buffer_load_dwordx4 v21, s[8:11], s37 offen sc1 lds
s_add_u32 m0, s39, 34816
s_mov_b32 s37, 6635520
buffer_load_dwordx4 v21, s[8:11], s37 offen sc1 lds
s_add_u32 m0, s39, 35840
s_mov_b32 s37, 6733824
buffer_load_dwordx4 v21, s[8:11], s37 offen sc1 lds
s_add_u32 m0, s39, 36864
s_mov_b32 s37, 6750208
buffer_load_dwordx4 v21, s[8:11], s37 offen sc1 lds
s_add_u32 m0, s39, 37888
s_mov_b32 s37, 6766592
buffer_load_dwordx4 v21, s[8:11], s37 offen sc1 lds
s_add_u32 m0, s39, 38912
s_mov_b32 s37, 6782976
buffer_load_dwordx4 v21, s[8:11], s37 offen sc1 lds
s_add_u32 m0, s39, 39936
s_mov_b32 s37, 6799360
buffer_load_dwordx4 v21, s[8:11], s37 offen sc1 lds
s_waitcnt vmcnt(16)
s_barrier
s_add_u32 m0, s39, 65536
s_mov_b32 s37, 6848512
buffer_load_dwordx4 v21, s[8:11], s37 offen sc1 lds
s_add_u32 m0, s39, 66560
s_mov_b32 s37, 6864896
buffer_load_dwordx4 v21, s[8:11], s37 offen sc1 lds
s_add_u32 m0, s39, 67584
s_mov_b32 s37, 6881280
buffer_load_dwordx4 v21, s[8:11], s37 offen sc1 lds
s_add_u32 m0, s39, 68608
s_mov_b32 s37, 6897664
buffer_load_dwordx4 v21, s[8:11], s37 offen sc1 lds
s_add_u32 m0, s39, 69632
s_mov_b32 s37, 6815744
buffer_load_dwordx4 v21, s[8:11], s37 offen sc1 lds
s_add_u32 m0, s39, 70656
s_mov_b32 s37, 6914048
buffer_load_dwordx4 v21, s[8:11], s37 offen sc1 lds
s_add_u32 m0, s39, 71680
s_mov_b32 s37, 6832128
buffer_load_dwordx4 v21, s[8:11], s37 offen sc1 lds
s_add_u32 m0, s39, 72704
s_mov_b32 s37, 6930432
buffer_load_dwordx4 v21, s[8:11], s37 offen sc1 lds
s_waitcnt vmcnt(16)
s_barrier
s_add_u32 m0, s39, 98304
s_mov_b32 s37, 6946816
buffer_load_dwordx4 v21, s[8:11], s37 offen sc1 lds
s_add_u32 m0, s39, 99328
s_mov_b32 s37, 6963200
buffer_load_dwordx4 v21, s[8:11], s37 offen sc1 lds
s_add_u32 m0, s39, 100352
s_mov_b32 s37, 6979584
buffer_load_dwordx4 v21, s[8:11], s37 offen sc1 lds
s_add_u32 m0, s39, 101376
s_mov_b32 s37, 6995968
buffer_load_dwordx4 v21, s[8:11], s37 offen sc1 lds
s_add_u32 m0, s39, 102400
s_mov_b32 s37, 7045120
buffer_load_dwordx4 v21, s[8:11], s37 offen sc1 lds
s_add_u32 m0, s39, 103424
s_mov_b32 s37, 7061504
buffer_load_dwordx4 v21, s[8:11], s37 offen sc1 lds
s_add_u32 m0, s39, 104448
s_mov_b32 s37, 7077888
buffer_load_dwordx4 v21, s[8:11], s37 offen sc1 lds
s_add_u32 m0, s39, 105472
s_mov_b32 s37, 7094272
buffer_load_dwordx4 v21, s[8:11], s37 offen sc1 lds
s_waitcnt vmcnt(16)
s_barrier
s_add_u32 m0, s39, 0
s_mov_b32 s37, 7012352
buffer_load_dwordx4 v21, s[8:11], s37 offen sc1 lds
s_add_u32 m0, s39, 1024
s_mov_b32 s37, 7110656
buffer_load_dwordx4 v21, s[8:11], s37 offen sc1 lds
s_add_u32 m0, s39, 2048
s_mov_b32 s37, 7028736
buffer_load_dwordx4 v21, s[8:11], s37 offen sc1 lds
s_add_u32 m0, s39, 3072
s_mov_b32 s37, 7127040
buffer_load_dwordx4 v21, s[8:11], s37 offen sc1 lds
s_add_u32 m0, s39, 4096
s_mov_b32 s37, 7143424
buffer_load_dwordx4 v21, s[8:11], s37 offen sc1 lds
s_add_u32 m0, s39, 5120
s_mov_b32 s37, 7159808
buffer_load_dwordx4 v21, s[8:11], s37 offen sc1 lds
s_add_u32 m0, s39, 6144
s_mov_b32 s37, 7176192
buffer_load_dwordx4 v21, s[8:11], s37 offen sc1 lds
s_add_u32 m0, s39, 7168
s_mov_b32 s37, 7192576
buffer_load_dwordx4 v21, s[8:11], s37 offen sc1 lds
s_waitcnt vmcnt(16)
s_barrier
s_add_u32 m0, s39, 32768
s_mov_b32 s37, 7241728
buffer_load_dwordx4 v21, s[8:11], s37 offen sc1 lds
s_add_u32 m0, s39, 33792
s_mov_b32 s37, 7258112
buffer_load_dwordx4 v21, s[8:11], s37 offen sc1 lds
s_add_u32 m0, s39, 34816
s_mov_b32 s37, 7274496
buffer_load_dwordx4 v21, s[8:11], s37 offen sc1 lds
s_add_u32 m0, s39, 35840
s_mov_b32 s37, 7290880
buffer_load_dwordx4 v21, s[8:11], s37 offen sc1 lds
s_add_u32 m0, s39, 36864
s_mov_b32 s37, 7208960
buffer_load_dwordx4 v21, s[8:11], s37 offen sc1 lds
s_add_u32 m0, s39, 37888
s_mov_b32 s37, 7307264
buffer_load_dwordx4 v21, s[8:11], s37 offen sc1 lds
s_add_u32 m0, s39, 38912
s_mov_b32 s37, 7225344
buffer_load_dwordx4 v21, s[8:11], s37 offen sc1 lds
s_add_u32 m0, s39, 39936
s_mov_b32 s37, 7323648
buffer_load_dwordx4 v21, s[8:11], s37 offen sc1 lds
s_waitcnt vmcnt(16)
s_barrier
s_waitcnt vmcnt(8)
s_barrier
s_waitcnt vmcnt(0)
s_barrier
s_branch Ldone_1
L7b_52:
v_mfma_f32_16x16x32_bf16 v[128:131], v[96:99], v[80:83], v[128:131]
v_mfma_f32_16x16x32_bf16 v[132:135], v[96:99], v[84:87], v[132:135]
v_mfma_f32_16x16x32_bf16 v[136:139], v[96:99], v[88:91], v[136:139]
v_mfma_f32_16x16x32_bf16 v[140:143], v[96:99], v[92:95], v[140:143]
v_mfma_f32_16x16x32_bf16 v[188:191], v[108:111], v[92:95], v[188:191]
v_mfma_f32_16x16x32_bf16 v[184:187], v[108:111], v[88:91], v[184:187]
v_mfma_f32_16x16x32_bf16 v[180:183], v[108:111], v[84:87], v[180:183]
v_mfma_f32_16x16x32_bf16 v[176:179], v[108:111], v[80:83], v[176:179]
v_mfma_f32_16x16x32_bf16 v[144:147], v[100:103], v[80:83], v[144:147]
v_mfma_f32_16x16x32_bf16 v[148:151], v[100:103], v[84:87], v[148:151]
v_mfma_f32_16x16x32_bf16 v[152:155], v[100:103], v[88:91], v[152:155]
v_mfma_f32_16x16x32_bf16 v[156:159], v[100:103], v[92:95], v[156:159]
v_mfma_f32_16x16x32_bf16 v[204:207], v[112:115], v[92:95], v[204:207]
v_mfma_f32_16x16x32_bf16 v[200:203], v[112:115], v[88:91], v[200:203]
v_mfma_f32_16x16x32_bf16 v[196:199], v[112:115], v[84:87], v[196:199]
v_mfma_f32_16x16x32_bf16 v[192:195], v[112:115], v[80:83], v[192:195]
v_mfma_f32_16x16x32_bf16 v[160:163], v[104:107], v[80:83], v[160:163]
v_mfma_f32_16x16x32_bf16 v[164:167], v[104:107], v[84:87], v[164:167]
v_mfma_f32_16x16x32_bf16 v[168:171], v[104:107], v[88:91], v[168:171]
v_mfma_f32_16x16x32_bf16 v[172:175], v[104:107], v[92:95], v[172:175]
v_mfma_f32_16x16x32_bf16 v[220:223], v[116:119], v[92:95], v[220:223]
v_mfma_f32_16x16x32_bf16 v[216:219], v[116:119], v[88:91], v[216:219]
v_mfma_f32_16x16x32_bf16 v[212:215], v[116:119], v[84:87], v[212:215]
v_mfma_f32_16x16x32_bf16 v[208:211], v[116:119], v[80:83], v[208:211]
s_mul_i32 s43, s38, 32
s_add_u32 s37, s37, s43
s_setprio 0
s_barrier
s_mov_b32 s80, s60
s_mov_b32 s81, s61
s_mov_b32 s82, 7340032
s_mov_b32 s83, 0x20000
v_and_b32 v29, 31, v1
v_lshlrev_b32 v29, 11, v29
s_and_b32 s43, s35, 8
s_or_b32 s43, s43, 3
s_lshl_b32 s43, s43, 7
v_add_u32 v29, s43, v29
s_add_u32 s37, s37, s54
s_add_u32 m0, s39, 65536
s_add_u32 s37, s37, s40
buffer_load_dwordx4 v21, s[8:11], s37 offen sc1 lds
v_mul_f32 v80, v128, v128
v_mul_f32 v81, v129, v129
v_mul_f32 v82, v130, v130
v_mul_f32 v83, v131, v131
v_fma_f32 v80, v80, v232, v228
v_fma_f32 v81, v81, v232, v228
v_fma_f32 v82, v82, v232, v228
s_add_u32 m0, s39, 66560
s_add_u32 s37, s37, s38
buffer_load_dwordx4 v21, s[8:11], s37 offen sc1 lds
v_fma_f32 v83, v83, v232, v228
v_mul_f32 v80, v80, v128
v_mul_f32 v81, v81, v129
v_mul_f32 v82, v82, v130
v_mul_f32 v83, v83, v131
v_exp_f32 v80, v80
s_add_u32 m0, s39, 67584
s_add_u32 s37, s37, s38
buffer_load_dwordx4 v21, s[8:11], s37 offen sc1 lds
v_exp_f32 v81, v81
v_exp_f32 v82, v82
v_exp_f32 v83, v83
v_mul_f32 v176, v128, v176
v_mul_f32 v177, v129, v177
v_mul_f32 v178, v130, v178
v_mul_f32 v179, v131, v179
s_add_u32 m0, s39, 68608
s_add_u32 s37, s37, s38
buffer_load_dwordx4 v21, s[8:11], s37 offen sc1 lds
v_fma_f32 v80, v80, v236, v236
v_fma_f32 v81, v81, v236, v236
v_fma_f32 v82, v82, v236, v236
v_fma_f32 v83, v83, v236, v236
v_rcp_f32 v80, v80
v_rcp_f32 v81, v81
s_add_u32 m0, s39, 69632
s_add_u32 s37, s37, s55
buffer_load_dwordx4 v21, s[8:11], s37 offen sc1 lds
v_rcp_f32 v82, v82
v_rcp_f32 v83, v83
v_mul_f32 v176, v176, v80
v_mul_f32 v177, v177, v81
v_mul_f32 v178, v178, v82
v_mul_f32 v179, v179, v83
v_cvt_pk_bf16_f32 v96, v176, v177
s_add_u32 m0, s39, 70656
s_add_u32 s37, s37, s38
buffer_load_dwordx4 v21, s[8:11], s37 offen sc1 lds
v_cvt_pk_bf16_f32 v97, v178, v179
v_mul_f32 v84, v144, v144
v_mul_f32 v85, v145, v145
v_mul_f32 v86, v146, v146
v_mul_f32 v87, v147, v147
v_fma_f32 v84, v84, v232, v228
s_add_u32 m0, s39, 71680
s_add_u32 s37, s37, s38
buffer_load_dwordx4 v21, s[8:11], s37 offen sc1 lds
v_fma_f32 v85, v85, v232, v228
v_fma_f32 v86, v86, v232, v228
v_fma_f32 v87, v87, v232, v228
v_mul_f32 v84, v84, v144
v_mul_f32 v85, v85, v145
v_mul_f32 v86, v86, v146
v_mul_f32 v87, v87, v147
s_add_u32 m0, s39, 72704
s_add_u32 s37, s37, s38
buffer_load_dwordx4 v21, s[8:11], s37 offen sc1 lds
v_exp_f32 v84, v84
v_exp_f32 v85, v85
v_exp_f32 v86, v86
v_exp_f32 v87, v87
v_mul_f32 v192, v144, v192
v_mul_f32 v193, v145, v193
s_barrier
s_lshr_b32 s44, s2, 3
s_lshl_b32 s44, s44, 17
s_add_u32 s43, s44, 65536
buffer_load_dword v30, v29, s[80:83], s43 offen
s_add_u32 m0, s39, 98304
s_add_u32 s37, s37, s40
buffer_load_dwordx4 v21, s[8:11], s37 offen sc1 lds
v_mul_f32 v194, v146, v194
v_mul_f32 v195, v147, v195
v_fma_f32 v84, v84, v236, v236
v_fma_f32 v85, v85, v236, v236
v_fma_f32 v86, v86, v236, v236
v_fma_f32 v87, v87, v236, v236
v_rcp_f32 v84, v84
s_add_u32 m0, s39, 99328
s_add_u32 s37, s37, s38
buffer_load_dwordx4 v21, s[8:11], s37 offen sc1 lds
v_rcp_f32 v85, v85
v_rcp_f32 v86, v86
v_rcp_f32 v87, v87
v_mul_f32 v192, v192, v84
v_mul_f32 v193, v193, v85
v_mul_f32 v194, v194, v86
v_mul_f32 v195, v195, v87
s_add_u32 m0, s39, 100352
s_add_u32 s37, s37, s38
buffer_load_dwordx4 v21, s[8:11], s37 offen sc1 lds
v_cvt_pk_bf16_f32 v98, v192, v193
v_cvt_pk_bf16_f32 v99, v194, v195
v_mul_f32 v80, v160, v160
v_mul_f32 v81, v161, v161
v_mul_f32 v82, v162, v162
s_add_u32 m0, s39, 101376
s_add_u32 s37, s37, s38
buffer_load_dwordx4 v21, s[8:11], s37 offen sc1 lds
v_mul_f32 v83, v163, v163
v_fma_f32 v80, v80, v232, v228
v_fma_f32 v81, v81, v232, v228
v_fma_f32 v82, v82, v232, v228
v_fma_f32 v83, v83, v232, v228
v_mul_f32 v80, v80, v160
v_mul_f32 v81, v81, v161
s_add_u32 m0, s39, 102400
s_add_u32 s37, s37, s55
buffer_load_dwordx4 v21, s[8:11], s37 offen sc1 lds
v_mul_f32 v82, v82, v162
v_mul_f32 v83, v83, v163
v_exp_f32 v80, v80
v_exp_f32 v81, v81
v_exp_f32 v82, v82
v_exp_f32 v83, v83
v_mul_f32 v208, v160, v208
s_add_u32 m0, s39, 103424
s_add_u32 s37, s37, s38
buffer_load_dwordx4 v21, s[8:11], s37 offen sc1 lds
v_mul_f32 v209, v161, v209
v_mul_f32 v210, v162, v210
v_mul_f32 v211, v163, v211
v_fma_f32 v80, v80, v236, v236
v_fma_f32 v81, v81, v236, v236
v_fma_f32 v82, v82, v236, v236
s_add_u32 m0, s39, 104448
s_add_u32 s37, s37, s38
buffer_load_dwordx4 v21, s[8:11], s37 offen sc1 lds
v_fma_f32 v83, v83, v236, v236
v_rcp_f32 v80, v80
v_rcp_f32 v81, v81
v_rcp_f32 v82, v82
v_rcp_f32 v83, v83
v_mul_f32 v208, v208, v80
v_mul_f32 v209, v209, v81
s_add_u32 m0, s39, 105472
s_add_u32 s37, s37, s38
buffer_load_dwordx4 v21, s[8:11], s37 offen sc1 lds
v_mul_f32 v210, v210, v82
v_mul_f32 v211, v211, v83
v_cvt_pk_bf16_f32 v112, v208, v209
v_cvt_pk_bf16_f32 v113, v210, v211
v_mul_f32 v80, v132, v132
v_mul_f32 v81, v133, v133
buffer_store_dwordx4 v[96:99], v27, s[24:27], 0 offen offset:0 sc1
s_barrier
s_add_u32 m0, s39, 0
s_add_u32 s37, s37, s40
buffer_load_dwordx4 v21, s[8:11], s37 offen sc1 lds
v_mul_f32 v82, v134, v134
v_mul_f32 v83, v135, v135
v_fma_f32 v80, v80, v233, v229
v_fma_f32 v81, v81, v233, v229
v_fma_f32 v82, v82, v233, v229
v_fma_f32 v83, v83, v233, v229
v_mul_f32 v80, v80, v132
s_add_u32 m0, s39, 1024
s_add_u32 s37, s37, s38
buffer_load_dwordx4 v21, s[8:11], s37 offen sc1 lds
v_mul_f32 v81, v81, v133
v_mul_f32 v82, v82, v134
v_mul_f32 v83, v83, v135
v_exp_f32 v80, v80
v_exp_f32 v81, v81
v_exp_f32 v82, v82
s_add_u32 m0, s39, 2048
s_add_u32 s37, s37, s38
buffer_load_dwordx4 v21, s[8:11], s37 offen sc1 lds
v_exp_f32 v83, v83
v_mul_f32 v180, v132, v180
v_mul_f32 v181, v133, v181
v_mul_f32 v182, v134, v182
v_mul_f32 v183, v135, v183
v_fma_f32 v80, v80, v237, v237
v_fma_f32 v81, v81, v237, v237
s_add_u32 m0, s39, 3072
s_add_u32 s37, s37, s38
buffer_load_dwordx4 v21, s[8:11], s37 offen sc1 lds
v_fma_f32 v82, v82, v237, v237
v_fma_f32 v83, v83, v237, v237
v_rcp_f32 v80, v80
v_rcp_f32 v81, v81
v_rcp_f32 v82, v82
v_rcp_f32 v83, v83
s_add_u32 m0, s39, 4096
s_add_u32 s37, s37, s55
buffer_load_dwordx4 v21, s[8:11], s37 offen sc1 lds
v_mul_f32 v180, v180, v80
v_mul_f32 v181, v181, v81
v_mul_f32 v182, v182, v82
v_mul_f32 v183, v183, v83
v_cvt_pk_bf16_f32 v100, v180, v181
v_cvt_pk_bf16_f32 v101, v182, v183
v_mul_f32 v84, v148, v148
s_add_u32 m0, s39, 5120
s_add_u32 s37, s37, s38
buffer_load_dwordx4 v21, s[8:11], s37 offen sc1 lds
v_mul_f32 v85, v149, v149
v_mul_f32 v86, v150, v150
v_mul_f32 v87, v151, v151
v_fma_f32 v84, v84, v233, v229
v_fma_f32 v85, v85, v233, v229
v_fma_f32 v86, v86, v233, v229
s_add_u32 m0, s39, 6144
s_add_u32 s37, s37, s38
buffer_load_dwordx4 v21, s[8:11], s37 offen sc1 lds
v_fma_f32 v87, v87, v233, v229
v_mul_f32 v84, v84, v148
v_mul_f32 v85, v85, v149
v_mul_f32 v86, v86, v150
v_mul_f32 v87, v87, v151
v_exp_f32 v84, v84
v_exp_f32 v85, v85
s_add_u32 m0, s39, 7168
s_add_u32 s37, s37, s38
buffer_load_dwordx4 v21, s[8:11], s37 offen sc1 lds
v_exp_f32 v86, v86
v_exp_f32 v87, v87
v_mul_f32 v196, v148, v196
v_mul_f32 v197, v149, v197
v_mul_f32 v198, v150, v198
v_mul_f32 v199, v151, v199
s_waitcnt vmcnt(18)
s_barrier
s_add_u32 s43, s34, 48
s_lshl_b32 s43, s43, 7
v_mov_b32 v10, s43
v_mov_b32 v12, 16
buffer_load_dword v11, v10, s[56:59], 0 offen sc1
s_add_u32 m0, s39, 32768
s_add_u32 s37, s37, s40
buffer_load_dwordx4 v21, s[8:11], s37 offen sc1 lds
v_fma_f32 v84, v84, v237, v237
v_fma_f32 v85, v85, v237, v237
v_fma_f32 v86, v86, v237, v237
v_fma_f32 v87, v87, v237, v237
v_rcp_f32 v84, v84
v_rcp_f32 v85, v85
v_rcp_f32 v86, v86
s_add_u32 m0, s39, 33792
s_add_u32 s37, s37, s38
buffer_load_dwordx4 v21, s[8:11], s37 offen sc1 lds
v_rcp_f32 v87, v87
v_mul_f32 v196, v196, v84
v_mul_f32 v197, v197, v85
v_mul_f32 v198, v198, v86
v_mul_f32 v199, v199, v87
v_cvt_pk_bf16_f32 v102, v196, v197
v_cvt_pk_bf16_f32 v103, v198, v199
s_add_u32 m0, s39, 34816
s_add_u32 s37, s37, s38
buffer_load_dwordx4 v21, s[8:11], s37 offen sc1 lds
v_mul_f32 v80, v164, v164
v_mul_f32 v81, v165, v165
v_mul_f32 v82, v166, v166
v_mul_f32 v83, v167, v167
v_fma_f32 v80, v80, v233, v229
s_add_u32 m0, s39, 35840
s_add_u32 s37, s37, s38
buffer_load_dwordx4 v21, s[8:11], s37 offen sc1 lds
v_fma_f32 v81, v81, v233, v229
v_fma_f32 v82, v82, v233, v229
v_fma_f32 v83, v83, v233, v229
v_mul_f32 v80, v80, v164
v_mul_f32 v81, v81, v165
v_mul_f32 v82, v82, v166
v_mul_f32 v83, v83, v167
s_add_u32 m0, s39, 36864
s_add_u32 s37, s37, s55
buffer_load_dwordx4 v21, s[8:11], s37 offen sc1 lds
v_exp_f32 v80, v80
v_exp_f32 v81, v81
v_exp_f32 v82, v82
v_exp_f32 v83, v83
v_mul_f32 v212, v164, v212
v_mul_f32 v213, v165, v213
v_mul_f32 v214, v166, v214
s_add_u32 m0, s39, 37888
s_add_u32 s37, s37, s38
buffer_load_dwordx4 v21, s[8:11], s37 offen sc1 lds
v_mul_f32 v215, v167, v215
v_fma_f32 v80, v80, v237, v237
v_fma_f32 v81, v81, v237, v237
v_fma_f32 v82, v82, v237, v237
v_fma_f32 v83, v83, v237, v237
v_rcp_f32 v80, v80
s_add_u32 m0, s39, 38912
s_add_u32 s37, s37, s38
buffer_load_dwordx4 v21, s[8:11], s37 offen sc1 lds
v_rcp_f32 v81, v81
v_rcp_f32 v82, v82
v_rcp_f32 v83, v83
v_mul_f32 v212, v212, v80
v_mul_f32 v213, v213, v81
v_mul_f32 v214, v214, v82
v_mul_f32 v215, v215, v83
s_add_u32 m0, s39, 39936
s_add_u32 s37, s37, s38
buffer_load_dwordx4 v21, s[8:11], s37 offen sc1 lds
v_cvt_pk_bf16_f32 v114, v212, v213
v_cvt_pk_bf16_f32 v115, v214, v215
s_nop 1
v_permlane32_swap_b32 v112, v114
v_permlane32_swap_b32 v113, v115
buffer_store_dwordx4 v[100:103], v27, s[24:27], 0 offen offset:256 sc1
buffer_store_dwordx4 v[112:115], v28, s[24:27], 0 offen offset:0 sc1
s_waitcnt vmcnt(20)
s_barrier
s_add_u32 m0, s39, 65536
s_add_u32 s37, s37, s40
buffer_load_dwordx4 v21, s[8:11], s37 offen sc1 lds
v_mul_f32 v80, v136, v136
v_mul_f32 v81, v137, v137
v_mul_f32 v82, v138, v138
v_mul_f32 v83, v139, v139
v_fma_f32 v80, v80, v234, v230
v_fma_f32 v81, v81, v234, v230
v_fma_f32 v82, v82, v234, v230
s_add_u32 m0, s39, 66560
s_add_u32 s37, s37, s38
buffer_load_dwordx4 v21, s[8:11], s37 offen sc1 lds
v_fma_f32 v83, v83, v234, v230
v_mul_f32 v80, v80, v136
v_mul_f32 v81, v81, v137
v_mul_f32 v82, v82, v138
v_mul_f32 v83, v83, v139
v_exp_f32 v80, v80
s_add_u32 m0, s39, 67584
s_add_u32 s37, s37, s38
buffer_load_dwordx4 v21, s[8:11], s37 offen sc1 lds
v_exp_f32 v81, v81
v_exp_f32 v82, v82
v_exp_f32 v83, v83
v_mul_f32 v184, v136, v184
v_mul_f32 v185, v137, v185
v_mul_f32 v186, v138, v186
v_mul_f32 v187, v139, v187
s_add_u32 m0, s39, 68608
s_add_u32 s37, s37, s38
buffer_load_dwordx4 v21, s[8:11], s37 offen sc1 lds
v_fma_f32 v80, v80, v238, v238
v_fma_f32 v81, v81, v238, v238
v_fma_f32 v82, v82, v238, v238
v_fma_f32 v83, v83, v238, v238
v_rcp_f32 v80, v80
v_rcp_f32 v81, v81
s_add_u32 m0, s39, 69632
s_add_u32 s37, s37, s55
buffer_load_dwordx4 v21, s[8:11], s37 offen sc1 lds
v_rcp_f32 v82, v82
v_rcp_f32 v83, v83
v_mul_f32 v184, v184, v80
v_mul_f32 v185, v185, v81
v_mul_f32 v186, v186, v82
v_mul_f32 v187, v187, v83
v_cvt_pk_bf16_f32 v104, v184, v185
s_add_u32 m0, s39, 70656
s_add_u32 s37, s37, s38
buffer_load_dwordx4 v21, s[8:11], s37 offen sc1 lds
v_cvt_pk_bf16_f32 v105, v186, v187
v_mul_f32 v84, v152, v152
v_mul_f32 v85, v153, v153
v_mul_f32 v86, v154, v154
v_mul_f32 v87, v155, v155
v_fma_f32 v84, v84, v234, v230
s_add_u32 m0, s39, 71680
s_add_u32 s37, s37, s38
buffer_load_dwordx4 v21, s[8:11], s37 offen sc1 lds
v_fma_f32 v85, v85, v234, v230
v_fma_f32 v86, v86, v234, v230
v_fma_f32 v87, v87, v234, v230
v_mul_f32 v84, v84, v152
v_mul_f32 v85, v85, v153
v_mul_f32 v86, v86, v154
v_mul_f32 v87, v87, v155
s_add_u32 m0, s39, 72704
s_add_u32 s37, s37, s38
buffer_load_dwordx4 v21, s[8:11], s37 offen sc1 lds
v_exp_f32 v84, v84
v_exp_f32 v85, v85
v_exp_f32 v86, v86
v_exp_f32 v87, v87
v_mul_f32 v200, v152, v200
v_mul_f32 v201, v153, v201
s_waitcnt vmcnt(19)
s_barrier
s_add_u32 m0, s39, 98304
s_add_u32 s37, s37, s40
buffer_load_dwordx4 v21, s[8:11], s37 offen sc1 lds
v_mul_f32 v202, v154, v202
v_mul_f32 v203, v155, v203
v_fma_f32 v84, v84, v238, v238
v_fma_f32 v85, v85, v238, v238
v_fma_f32 v86, v86, v238, v238
v_fma_f32 v87, v87, v238, v238
v_rcp_f32 v84, v84
s_add_u32 m0, s39, 99328
s_add_u32 s37, s37, s38
buffer_load_dwordx4 v21, s[8:11], s37 offen sc1 lds
v_rcp_f32 v85, v85
v_rcp_f32 v86, v86
v_rcp_f32 v87, v87
v_mul_f32 v200, v200, v84
v_mul_f32 v201, v201, v85
v_mul_f32 v202, v202, v86
v_mul_f32 v203, v203, v87
s_add_u32 m0, s39, 100352
s_add_u32 s37, s37, s38
buffer_load_dwordx4 v21, s[8:11], s37 offen sc1 lds
v_cvt_pk_bf16_f32 v106, v200, v201
v_cvt_pk_bf16_f32 v107, v202, v203
v_mul_f32 v80, v168, v168
v_mul_f32 v81, v169, v169
v_mul_f32 v82, v170, v170
s_add_u32 m0, s39, 101376
s_add_u32 s37, s37, s38
buffer_load_dwordx4 v21, s[8:11], s37 offen sc1 lds
v_mul_f32 v83, v171, v171
v_fma_f32 v80, v80, v234, v230
v_fma_f32 v81, v81, v234, v230
v_fma_f32 v82, v82, v234, v230
v_fma_f32 v83, v83, v234, v230
v_mul_f32 v80, v80, v168
v_mul_f32 v81, v81, v169
s_add_u32 m0, s39, 102400
s_add_u32 s37, s37, s55
buffer_load_dwordx4 v21, s[8:11], s37 offen sc1 lds
v_mul_f32 v82, v82, v170
v_mul_f32 v83, v83, v171
v_exp_f32 v80, v80
v_exp_f32 v81, v81
v_exp_f32 v82, v82
v_exp_f32 v83, v83
v_mul_f32 v216, v168, v216
s_add_u32 m0, s39, 103424
s_add_u32 s37, s37, s38
buffer_load_dwordx4 v21, s[8:11], s37 offen sc1 lds
v_mul_f32 v217, v169, v217
v_mul_f32 v218, v170, v218
v_mul_f32 v219, v171, v219
v_fma_f32 v80, v80, v238, v238
v_fma_f32 v81, v81, v238, v238
v_fma_f32 v82, v82, v238, v238
s_add_u32 m0, s39, 104448
s_add_u32 s37, s37, s38
buffer_load_dwordx4 v21, s[8:11], s37 offen sc1 lds
v_fma_f32 v83, v83, v238, v238
v_rcp_f32 v80, v80
v_rcp_f32 v81, v81
v_rcp_f32 v82, v82
v_rcp_f32 v83, v83
v_mul_f32 v216, v216, v80
v_mul_f32 v217, v217, v81
s_add_u32 m0, s39, 105472
s_add_u32 s37, s37, s38
buffer_load_dwordx4 v21, s[8:11], s37 offen sc1 lds
v_mul_f32 v218, v218, v82
v_mul_f32 v219, v219, v83
v_cvt_pk_bf16_f32 v116, v216, v217
v_cvt_pk_bf16_f32 v117, v218, v219
v_mul_f32 v80, v140, v140
v_mul_f32 v81, v141, v141
buffer_store_dwordx4 v[104:107], v27, s[24:27], 0 offen offset:512 sc1
s_waitcnt vmcnt(19)
s_mov_b32 s41, 0x10000
s_waitcnt vmcnt(27)
s_branch Lpf_56
Lpoll_54:
s_waitcnt vmcnt(0)
Lpf_56:
v_cmp_ne_u32 vcc, v12, v11
s_nop 4
s_cbranch_vccz Lpok_55
buffer_load_dword v11, v10, s[56:59], 0 offen sc1
s_sub_u32 s41, s41, 1
s_cmp_lg_u32 s41, 0
s_cbranch_scc1 Lpoll_54
s_waitcnt vmcnt(0)
Lpok_55:
s_barrier
s_add_u32 s37, s37, s29
s_add_u32 m0, s39, 0
s_add_u32 s37, s37, s40
buffer_load_dwordx4 v21, s[8:11], s37 offen sc1 lds
v_mul_f32 v82, v142, v142
v_mul_f32 v83, v143, v143
v_fma_f32 v80, v80, v235, v231
v_fma_f32 v81, v81, v235, v231
v_fma_f32 v82, v82, v235, v231
v_fma_f32 v83, v83, v235, v231
v_mul_f32 v80, v80, v140
s_add_u32 m0, s39, 1024
s_add_u32 s37, s37, s38
buffer_load_dwordx4 v21, s[8:11], s37 offen sc1 lds
v_mul_f32 v81, v81, v141
v_mul_f32 v82, v82, v142
v_mul_f32 v83, v83, v143
v_exp_f32 v80, v80
v_exp_f32 v81, v81
v_exp_f32 v82, v82
s_add_u32 m0, s39, 2048
s_add_u32 s37, s37, s38
buffer_load_dwordx4 v21, s[8:11], s37 offen sc1 lds
v_exp_f32 v83, v83
v_mul_f32 v188, v140, v188
v_mul_f32 v189, v141, v189
v_mul_f32 v190, v142, v190
v_mul_f32 v191, v143, v191
v_fma_f32 v80, v80, v239, v239
v_fma_f32 v81, v81, v239, v239
s_add_u32 m0, s39, 3072
s_add_u32 s37, s37, s38
buffer_load_dwordx4 v21, s[8:11], s37 offen sc1 lds
v_fma_f32 v82, v82, v239, v239
v_fma_f32 v83, v83, v239, v239
v_rcp_f32 v80, v80
v_rcp_f32 v81, v81
v_rcp_f32 v82, v82
v_rcp_f32 v83, v83
s_add_u32 m0, s39, 4096
s_add_u32 s37, s37, s55
buffer_load_dwordx4 v21, s[8:11], s37 offen sc1 lds
v_mul_f32 v188, v188, v80
v_mul_f32 v189, v189, v81
v_mul_f32 v190, v190, v82
v_mul_f32 v191, v191, v83
v_cvt_pk_bf16_f32 v108, v188, v189
v_cvt_pk_bf16_f32 v109, v190, v191
v_mul_f32 v84, v156, v156
s_add_u32 m0, s39, 5120
s_add_u32 s37, s37, s38
buffer_load_dwordx4 v21, s[8:11], s37 offen sc1 lds
v_mul_f32 v85, v157, v157
v_mul_f32 v86, v158, v158
v_mul_f32 v87, v159, v159
v_fma_f32 v84, v84, v235, v231
v_fma_f32 v85, v85, v235, v231
v_fma_f32 v86, v86, v235, v231
s_add_u32 m0, s39, 6144
s_add_u32 s37, s37, s38
buffer_load_dwordx4 v21, s[8:11], s37 offen sc1 lds
v_fma_f32 v87, v87, v235, v231
v_mul_f32 v84, v84, v156
v_mul_f32 v85, v85, v157
v_mul_f32 v86, v86, v158
v_mul_f32 v87, v87, v159
v_exp_f32 v84, v84
v_exp_f32 v85, v85
s_add_u32 m0, s39, 7168
s_add_u32 s37, s37, s38
buffer_load_dwordx4 v21, s[8:11], s37 offen sc1 lds
v_exp_f32 v86, v86
v_exp_f32 v87, v87
v_mul_f32 v204, v156, v204
v_mul_f32 v205, v157, v205
v_mul_f32 v206, v158, v206
v_mul_f32 v207, v159, v207
s_waitcnt vmcnt(17)
s_barrier
s_add_u32 m0, s39, 32768
s_add_u32 s37, s37, s40
buffer_load_dwordx4 v21, s[8:11], s37 offen sc1 lds
v_fma_f32 v84, v84, v239, v239
v_fma_f32 v85, v85, v239, v239
v_fma_f32 v86, v86, v239, v239
v_fma_f32 v87, v87, v239, v239
v_rcp_f32 v84, v84
v_rcp_f32 v85, v85
v_rcp_f32 v86, v86
s_add_u32 m0, s39, 33792
s_add_u32 s37, s37, s38
buffer_load_dwordx4 v21, s[8:11], s37 offen sc1 lds
v_rcp_f32 v87, v87
v_mul_f32 v204, v204, v84
v_mul_f32 v205, v205, v85
v_mul_f32 v206, v206, v86
v_mul_f32 v207, v207, v87
v_cvt_pk_bf16_f32 v110, v204, v205
v_cvt_pk_bf16_f32 v111, v206, v207
s_add_u32 m0, s39, 34816
s_add_u32 s37, s37, s38
buffer_load_dwordx4 v21, s[8:11], s37 offen sc1 lds
v_mul_f32 v80, v172, v172
v_mul_f32 v81, v173, v173
v_mul_f32 v82, v174, v174
v_mul_f32 v83, v175, v175
v_fma_f32 v80, v80, v235, v231
s_add_u32 m0, s39, 35840
s_add_u32 s37, s37, s38
buffer_load_dwordx4 v21, s[8:11], s37 offen sc1 lds
v_fma_f32 v81, v81, v235, v231
v_fma_f32 v82, v82, v235, v231
v_fma_f32 v83, v83, v235, v231
v_mul_f32 v80, v80, v172
v_mul_f32 v81, v81, v173
v_mul_f32 v82, v82, v174
v_mul_f32 v83, v83, v175
s_add_u32 m0, s39, 36864
s_add_u32 s37, s37, s55
buffer_load_dwordx4 v21, s[8:11], s37 offen sc1 lds
v_exp_f32 v80, v80
v_exp_f32 v81, v81
v_exp_f32 v82, v82
v_exp_f32 v83, v83
v_mul_f32 v220, v172, v220
v_mul_f32 v221, v173, v221
v_mul_f32 v222, v174, v222
s_add_u32 m0, s39, 37888
s_add_u32 s37, s37, s38
buffer_load_dwordx4 v21, s[8:11], s37 offen sc1 lds
v_mul_f32 v223, v175, v223
v_fma_f32 v80, v80, v239, v239
v_fma_f32 v81, v81, v239, v239
v_fma_f32 v82, v82, v239, v239
v_fma_f32 v83, v83, v239, v239
v_rcp_f32 v80, v80
s_add_u32 m0, s39, 38912
s_add_u32 s37, s37, s38
buffer_load_dwordx4 v21, s[8:11], s37 offen sc1 lds
v_rcp_f32 v81, v81
v_rcp_f32 v82, v82
v_rcp_f32 v83, v83
v_mul_f32 v220, v220, v80
v_mul_f32 v221, v221, v81
v_mul_f32 v222, v222, v82
v_mul_f32 v223, v223, v83
s_add_u32 m0, s39, 39936
s_add_u32 s37, s37, s38
buffer_load_dwordx4 v21, s[8:11], s37 offen sc1 lds
v_cvt_pk_bf16_f32 v118, v220, v221
v_cvt_pk_bf16_f32 v119, v222, v223
s_nop 1
v_permlane32_swap_b32 v116, v118
v_permlane32_swap_b32 v117, v119
buffer_store_dwordx4 v[108:111], v27, s[24:27], 0 offen offset:768 sc1
buffer_store_dwordx4 v[116:119], v28, s[24:27], 0 offen offset:512 sc1
s_waitcnt vmcnt(19)
s_barrier
s_add_u32 m0, s39, 65536
s_add_u32 s37, s37, s40
buffer_load_dwordx4 v21, s[8:11], s37 offen sc1 lds
s_add_u32 m0, s39, 66560
s_add_u32 s37, s37, s38
buffer_load_dwordx4 v21, s[8:11], s37 offen sc1 lds
s_add_u32 m0, s39, 67584
s_add_u32 s37, s37, s38
buffer_load_dwordx4 v21, s[8:11], s37 offen sc1 lds
s_add_u32 m0, s39, 68608
s_add_u32 s37, s37, s38
buffer_load_dwordx4 v21, s[8:11], s37 offen sc1 lds
s_add_u32 m0, s39, 69632
s_add_u32 s37, s37, s55
buffer_load_dwordx4 v21, s[8:11], s37 offen sc1 lds
s_add_u32 m0, s39, 70656
s_add_u32 s37, s37, s38
buffer_load_dwordx4 v21, s[8:11], s37 offen sc1 lds
s_add_u32 m0, s39, 71680
s_add_u32 s37, s37, s38
buffer_load_dwordx4 v21, s[8:11], s37 offen sc1 lds
s_add_u32 m0, s39, 72704
s_add_u32 s37, s37, s38
buffer_load_dwordx4 v21, s[8:11], s37 offen sc1 lds
s_waitcnt vmcnt(8)
s_barrier
s_add_u32 s43, s34, 64
s_lshl_b32 s43, s43, 7
v_mov_b32 v10, s43
v_mov_b32 v11, 1
s_mov_b64 exec, 1
buffer_atomic_add v11, v10, s[56:59], 0 offen sc1
s_mov_b64 exec, -1
s_add_u32 m0, s39, 98304
s_add_u32 s37, s37, s40
buffer_load_dwordx4 v21, s[8:11], s37 offen sc1 lds
s_add_u32 m0, s39, 99328
s_add_u32 s37, s37, s38
buffer_load_dwordx4 v21, s[8:11], s37 offen sc1 lds
s_add_u32 m0, s39, 100352
s_add_u32 s37, s37, s38
buffer_load_dwordx4 v21, s[8:11], s37 offen sc1 lds
s_add_u32 m0, s39, 101376
s_add_u32 s37, s37, s38
buffer_load_dwordx4 v21, s[8:11], s37 offen sc1 lds
s_add_u32 m0, s39, 102400
s_add_u32 s37, s37, s55
buffer_load_dwordx4 v21, s[8:11], s37 offen sc1 lds
s_add_u32 m0, s39, 103424
s_add_u32 s37, s37, s38
buffer_load_dwordx4 v21, s[8:11], s37 offen sc1 lds
s_add_u32 m0, s39, 104448
s_add_u32 s37, s37, s38
buffer_load_dwordx4 v21, s[8:11], s37 offen sc1 lds
s_add_u32 m0, s39, 105472
s_add_u32 s37, s37, s38
buffer_load_dwordx4 v21, s[8:11], s37 offen sc1 lds
s_waitcnt vmcnt(19)
s_barrier
s_lshr_b32 s44, s2, 3
s_lshl_b32 s44, s44, 16
s_add_u32 s43, s44, 4194304
buffer_load_dword v30, v29, s[80:83], s43 offen
s_add_u32 m0, s39, 0
s_add_u32 s37, s37, s40
buffer_load_dwordx4 v21, s[8:11], s37 offen sc1 lds
s_add_u32 m0, s39, 1024
s_add_u32 s37, s37, s38
buffer_load_dwordx4 v21, s[8:11], s37 offen sc1 lds
s_add_u32 m0, s39, 2048
s_add_u32 s37, s37, s38
buffer_load_dwordx4 v21, s[8:11], s37 offen sc1 lds
s_add_u32 m0, s39, 3072
s_add_u32 s37, s37, s38
buffer_load_dwordx4 v21, s[8:11], s37 offen sc1 lds
s_add_u32 m0, s39, 4096
s_add_u32 s37, s37, s55
buffer_load_dwordx4 v21, s[8:11], s37 offen sc1 lds
s_add_u32 m0, s39, 5120
s_add_u32 s37, s37, s38
buffer_load_dwordx4 v21, s[8:11], s37 offen sc1 lds
s_add_u32 m0, s39, 6144
s_add_u32 s37, s37, s38
buffer_load_dwordx4 v21, s[8:11], s37 offen sc1 lds
s_add_u32 m0, s39, 7168
s_add_u32 s37, s37, s38
buffer_load_dwordx4 v21, s[8:11], s37 offen sc1 lds
s_waitcnt vmcnt(18)
s_barrier
s_add_u32 s43, s34, 64
s_lshl_b32 s43, s43, 7
v_mov_b32 v10, s43
v_mov_b32 v12, 16
buffer_load_dword v11, v10, s[56:59], 0 offen sc1
s_add_u32 m0, s39, 32768
s_add_u32 s37, s37, s40
buffer_load_dwordx4 v21, s[8:11], s37 offen sc1 lds
s_add_u32 m0, s39, 33792
s_add_u32 s37, s37, s38
buffer_load_dwordx4 v21, s[8:11], s37 offen sc1 lds
s_add_u32 m0, s39, 34816
s_add_u32 s37, s37, s38
buffer_load_dwordx4 v21, s[8:11], s37 offen sc1 lds
s_add_u32 m0, s39, 35840
s_add_u32 s37, s37, s38
buffer_load_dwordx4 v21, s[8:11], s37 offen sc1 lds
s_add_u32 m0, s39, 36864
s_add_u32 s37, s37, s55
buffer_load_dwordx4 v21, s[8:11], s37 offen sc1 lds
s_add_u32 m0, s39, 37888
s_add_u32 s37, s37, s38
buffer_load_dwordx4 v21, s[8:11], s37 offen sc1 lds
s_add_u32 m0, s39, 38912
s_add_u32 s37, s37, s38
buffer_load_dwordx4 v21, s[8:11], s37 offen sc1 lds
s_add_u32 m0, s39, 39936
s_add_u32 s37, s37, s38
buffer_load_dwordx4 v21, s[8:11], s37 offen sc1 lds
s_waitcnt vmcnt(18)
s_barrier
s_add_u32 m0, s39, 65536
s_add_u32 s37, s37, s40
buffer_load_dwordx4 v21, s[8:11], s37 offen sc1 lds
s_add_u32 m0, s39, 66560
s_add_u32 s37, s37, s38
buffer_load_dwordx4 v21, s[8:11], s37 offen sc1 lds
s_add_u32 m0, s39, 67584
s_add_u32 s37, s37, s38
buffer_load_dwordx4 v21, s[8:11], s37 offen sc1 lds
s_add_u32 m0, s39, 68608
s_add_u32 s37, s37, s38
buffer_load_dwordx4 v21, s[8:11], s37 offen sc1 lds
s_add_u32 m0, s39, 69632
s_add_u32 s37, s37, s55
buffer_load_dwordx4 v21, s[8:11], s37 offen sc1 lds
s_add_u32 m0, s39, 70656
s_add_u32 s37, s37, s38
buffer_load_dwordx4 v21, s[8:11], s37 offen sc1 lds
s_add_u32 m0, s39, 71680
s_add_u32 s37, s37, s38
buffer_load_dwordx4 v21, s[8:11], s37 offen sc1 lds
s_add_u32 m0, s39, 72704
s_add_u32 s37, s37, s38
buffer_load_dwordx4 v21, s[8:11], s37 offen sc1 lds
s_waitcnt vmcnt(17)
s_barrier
s_add_u32 m0, s39, 98304
s_add_u32 s37, s37, s40
buffer_load_dwordx4 v21, s[8:11], s37 offen sc1 lds
s_add_u32 m0, s39, 99328
s_add_u32 s37, s37, s38
buffer_load_dwordx4 v21, s[8:11], s37 offen sc1 lds
s_add_u32 m0, s39, 100352
s_add_u32 s37, s37, s38
buffer_load_dwordx4 v21, s[8:11], s37 offen sc1 lds
s_add_u32 m0, s39, 101376
s_add_u32 s37, s37, s38
buffer_load_dwordx4 v21, s[8:11], s37 offen sc1 lds
s_add_u32 m0, s39, 102400
s_add_u32 s37, s37, s55
buffer_load_dwordx4 v21, s[8:11], s37 offen sc1 lds
s_add_u32 m0, s39, 103424
s_add_u32 s37, s37, s38
buffer_load_dwordx4 v21, s[8:11], s37 offen sc1 lds
s_add_u32 m0, s39, 104448
s_add_u32 s37, s37, s38
buffer_load_dwordx4 v21, s[8:11], s37 offen sc1 lds
s_add_u32 m0, s39, 105472
s_add_u32 s37, s37, s38
buffer_load_dwordx4 v21, s[8:11], s37 offen sc1 lds
s_waitcnt vmcnt(16)
s_mov_b32 s41, 0x10000
s_waitcnt vmcnt(24)
s_branch Lpf_59
Lpoll_57:
s_waitcnt vmcnt(0)
Lpf_59:
v_cmp_ne_u32 vcc, v12, v11
s_nop 4
s_cbranch_vccz Lpok_58
buffer_load_dword v11, v10, s[56:59], 0 offen sc1
s_sub_u32 s41, s41, 1
s_cmp_lg_u32 s41, 0
s_cbranch_scc1 Lpoll_57
s_waitcnt vmcnt(0)
Lpok_58:
s_barrier
s_mul_i32 s40, s53, 786432
s_add_u32 m0, s39, 0
s_add_u32 s37, s40, 4194304
buffer_load_dwordx4 v21, s[8:11], s37 offen sc1 lds
s_add_u32 m0, s39, 1024
s_add_u32 s37, s40, 4210688
buffer_load_dwordx4 v21, s[8:11], s37 offen sc1 lds
s_add_u32 m0, s39, 2048
s_add_u32 s37, s40, 4227072
buffer_load_dwordx4 v21, s[8:11], s37 offen sc1 lds
s_add_u32 m0, s39, 3072
s_add_u32 s37, s40, 4243456
buffer_load_dwordx4 v21, s[8:11], s37 offen sc1 lds
s_add_u32 m0, s39, 4096
s_add_u32 s37, s40, 4292608
buffer_load_dwordx4 v21, s[8:11], s37 offen sc1 lds
s_add_u32 m0, s39, 5120
s_add_u32 s37, s40, 4308992
buffer_load_dwordx4 v21, s[8:11], s37 offen sc1 lds
s_add_u32 m0, s39, 6144
s_add_u32 s37, s40, 4325376
buffer_load_dwordx4 v21, s[8:11], s37 offen sc1 lds
s_add_u32 m0, s39, 7168
s_add_u32 s37, s40, 4341760
buffer_load_dwordx4 v21, s[8:11], s37 offen sc1 lds
s_waitcnt vmcnt(16)
s_barrier
s_add_u32 m0, s39, 32768
s_add_u32 s37, s40, 4259840
buffer_load_dwordx4 v21, s[8:11], s37 offen sc1 lds
s_add_u32 m0, s39, 33792
s_add_u32 s37, s40, 4358144
buffer_load_dwordx4 v21, s[8:11], s37 offen sc1 lds
s_add_u32 m0, s39, 34816
s_add_u32 s37, s40, 4276224
buffer_load_dwordx4 v21, s[8:11], s37 offen sc1 lds
s_add_u32 m0, s39, 35840
s_add_u32 s37, s40, 4374528
buffer_load_dwordx4 v21, s[8:11], s37 offen sc1 lds
s_add_u32 m0, s39, 36864
s_add_u32 s37, s40, 4390912
buffer_load_dwordx4 v21, s[8:11], s37 offen sc1 lds
s_add_u32 m0, s39, 37888
s_add_u32 s37, s40, 4407296
buffer_load_dwordx4 v21, s[8:11], s37 offen sc1 lds
s_add_u32 m0, s39, 38912
s_add_u32 s37, s40, 4423680
buffer_load_dwordx4 v21, s[8:11], s37 offen sc1 lds
s_add_u32 m0, s39, 39936
s_add_u32 s37, s40, 4440064
buffer_load_dwordx4 v21, s[8:11], s37 offen sc1 lds
s_waitcnt vmcnt(16)
s_barrier
s_add_u32 m0, s39, 65536
s_add_u32 s37, s40, 4489216
buffer_load_dwordx4 v21, s[8:11], s37 offen sc1 lds
s_add_u32 m0, s39, 66560
s_add_u32 s37, s40, 4505600
buffer_load_dwordx4 v21, s[8:11], s37 offen sc1 lds
s_add_u32 m0, s39, 67584
s_add_u32 s37, s40, 4521984
buffer_load_dwordx4 v21, s[8:11], s37 offen sc1 lds
s_add_u32 m0, s39, 68608
s_add_u32 s37, s40, 4538368
buffer_load_dwordx4 v21, s[8:11], s37 offen sc1 lds
s_add_u32 m0, s39, 69632
s_add_u32 s37, s40, 4456448
buffer_load_dwordx4 v21, s[8:11], s37 offen sc1 lds
s_add_u32 m0, s39, 70656
s_add_u32 s37, s40, 4554752
buffer_load_dwordx4 v21, s[8:11], s37 offen sc1 lds
s_add_u32 m0, s39, 71680
s_add_u32 s37, s40, 4472832
buffer_load_dwordx4 v21, s[8:11], s37 offen sc1 lds
s_add_u32 m0, s39, 72704
s_add_u32 s37, s40, 4571136
buffer_load_dwordx4 v21, s[8:11], s37 offen sc1 lds
s_waitcnt vmcnt(16)
s_barrier
s_add_u32 m0, s39, 98304
s_add_u32 s37, s40, 4587520
buffer_load_dwordx4 v21, s[8:11], s37 offen sc1 lds
s_add_u32 m0, s39, 99328
s_add_u32 s37, s40, 4603904
buffer_load_dwordx4 v21, s[8:11], s37 offen sc1 lds
s_add_u32 m0, s39, 100352
s_add_u32 s37, s40, 4620288
buffer_load_dwordx4 v21, s[8:11], s37 offen sc1 lds
s_add_u32 m0, s39, 101376
s_add_u32 s37, s40, 4636672
buffer_load_dwordx4 v21, s[8:11], s37 offen sc1 lds
s_add_u32 m0, s39, 102400
s_add_u32 s37, s40, 4685824
buffer_load_dwordx4 v21, s[8:11], s37 offen sc1 lds
s_add_u32 m0, s39, 103424
s_add_u32 s37, s40, 4702208
buffer_load_dwordx4 v21, s[8:11], s37 offen sc1 lds
s_add_u32 m0, s39, 104448
s_add_u32 s37, s40, 4718592
buffer_load_dwordx4 v21, s[8:11], s37 offen sc1 lds
s_add_u32 m0, s39, 105472
s_add_u32 s37, s40, 4734976
buffer_load_dwordx4 v21, s[8:11], s37 offen sc1 lds
s_waitcnt vmcnt(16)
s_barrier
s_add_u32 m0, s39, 0
s_add_u32 s37, s40, 4653056
buffer_load_dwordx4 v21, s[8:11], s37 offen sc1 lds
s_add_u32 m0, s39, 1024
s_add_u32 s37, s40, 4751360
buffer_load_dwordx4 v21, s[8:11], s37 offen sc1 lds
s_add_u32 m0, s39, 2048
s_add_u32 s37, s40, 4669440
buffer_load_dwordx4 v21, s[8:11], s37 offen sc1 lds
s_add_u32 m0, s39, 3072
s_add_u32 s37, s40, 4767744
buffer_load_dwordx4 v21, s[8:11], s37 offen sc1 lds
s_add_u32 m0, s39, 4096
s_add_u32 s37, s40, 4784128
buffer_load_dwordx4 v21, s[8:11], s37 offen sc1 lds
s_add_u32 m0, s39, 5120
s_add_u32 s37, s40, 4800512
buffer_load_dwordx4 v21, s[8:11], s37 offen sc1 lds
s_add_u32 m0, s39, 6144
s_add_u32 s37, s40, 4816896
buffer_load_dwordx4 v21, s[8:11], s37 offen sc1 lds
s_add_u32 m0, s39, 7168
s_add_u32 s37, s40, 4833280
buffer_load_dwordx4 v21, s[8:11], s37 offen sc1 lds
s_waitcnt vmcnt(16)
s_barrier
s_add_u32 m0, s39, 32768
s_add_u32 s37, s40, 4882432
buffer_load_dwordx4 v21, s[8:11], s37 offen sc1 lds
s_add_u32 m0, s39, 33792
s_add_u32 s37, s40, 4898816
buffer_load_dwordx4 v21, s[8:11], s37 offen sc1 lds
s_add_u32 m0, s39, 34816
s_add_u32 s37, s40, 4915200
buffer_load_dwordx4 v21, s[8:11], s37 offen sc1 lds
s_add_u32 m0, s39, 35840
s_add_u32 s37, s40, 4931584
buffer_load_dwordx4 v21, s[8:11], s37 offen sc1 lds
s_add_u32 m0, s39, 36864
s_add_u32 s37, s40, 4849664
buffer_load_dwordx4 v21, s[8:11], s37 offen sc1 lds
s_add_u32 m0, s39, 37888
s_add_u32 s37, s40, 4947968
buffer_load_dwordx4 v21, s[8:11], s37 offen sc1 lds
s_add_u32 m0, s39, 38912
s_add_u32 s37, s40, 4866048
buffer_load_dwordx4 v21, s[8:11], s37 offen sc1 lds
s_add_u32 m0, s39, 39936
s_add_u32 s37, s40, 4964352
buffer_load_dwordx4 v21, s[8:11], s37 offen sc1 lds
s_waitcnt vmcnt(16)
s_barrier
s_lshr_b32 s44, s2, 3
s_and_b32 s44, s44, 15
s_lshl_b32 s44, s44, 16
s_add_u32 s43, s44, 6291456
buffer_load_dword v30, v29, s[80:83], s43 offen
s_waitcnt vmcnt(9)
s_barrier
s_waitcnt vmcnt(1)
s_barrier
s_barrier
s_barrier
s_barrier
s_barrier
s_barrier
s_lshl_b32 s43, s34, 4
s_add_u32 s43, s43, s35
s_and_b32 s44, s43, 1
s_lshl_b32 s44, s44, 2
s_lshr_b32 s43, s43, 1
s_add_u32 s43, s43, 128
s_lshl_b32 s43, s43, 7
s_add_u32 s43, s43, s44
v_mov_b32 v10, s43
v_mov_b32 v11, 1
s_mov_b64 exec, 1
buffer_store_dword v11, v10, s[56:59], 0 offen sc1
s_mov_b64 exec, -1
s_barrier
s_barrier
s_barrier
s_lshl_b32 s43, s34, 4
s_add_u32 s43, s43, s35
s_xor_b32 s43, s43, 1
s_and_b32 s44, s43, 1
s_lshl_b32 s44, s44, 2
s_lshr_b32 s43, s43, 1
s_add_u32 s43, s43, 128
s_lshl_b32 s43, s43, 7
s_add_u32 s43, s43, s44
v_mov_b32 v10, s43
v_mov_b32 v12, 1
buffer_load_dword v11, v10, s[56:59], 0 offen sc1
s_barrier
s_barrier
s_mov_b32 s41, 0x10000
Lpoll_60:
s_waitcnt vmcnt(0)
Lpf_62:
v_cmp_ne_u32 vcc, v12, v11
s_nop 4
s_cbranch_vccz Lpok_61
buffer_load_dword v11, v10, s[56:59], 0 offen sc1
s_sub_u32 s41, s41, 1
s_cmp_lg_u32 s41, 0
s_cbranch_scc1 Lpoll_60
s_waitcnt vmcnt(0)
Lpok_61:
s_barrier
s_branch Ldone_1
Ldone_1:
s_endpgm
.section .rodata,"a"
.p2align 6
.amdhsa_kernel sequential_preLN__sliding_local_dilated__glu_gated_geglu__prompt_kernel
  .amdhsa_next_free_vgpr 256
  .amdhsa_next_free_sgpr 100
  .amdhsa_accum_offset 256
  .amdhsa_group_segment_fixed_size 0
  .amdhsa_kernarg_size 80
  .amdhsa_user_sgpr_count 2
  .amdhsa_user_sgpr_kernarg_segment_ptr 1
  .amdhsa_system_sgpr_workgroup_id_x 1
  .amdhsa_float_denorm_mode_32 3
  .amdhsa_float_denorm_mode_16_64 3
.end_amdhsa_kernel
```

```asm
; @launch grid=(256,1,1) block=(512,1,1) lds=151552
.amdgcn_target "amdgcn-amd-amdhsa--gfx950"
.text
.globl sequential_preLN__sliding_local_dilated__glu_gated_geglu__prompt_kernel
.p2align 8
.type sequential_preLN__sliding_local_dilated__glu_gated_geglu__prompt_kernel,@function
sequential_preLN__sliding_local_dilated__glu_gated_geglu__prompt_kernel:
s_cmp_ge_u32 s2, 256
s_cbranch_scc1 Ldone_1
s_load_dwordx4 s[4:7], s[0:1], 0
s_load_dwordx2 s[32:33], s[0:1], 72
s_load_dwordx2 s[80:81], s[0:1], 32
s_and_b32 s3, s2, 7
s_lshr_b32 s42, s2, 3
s_and_b32 s48, s42, 3
s_lshr_b32 s49, s42, 2
s_and_b32 s34, s3, 3
s_lshl_b32 s34, s34, 2
s_add_u32 s34, s34, s48
s_lshr_b32 s35, s3, 2
s_lshl_b32 s35, s35, 3
s_add_u32 s35, s35, s49
v_lshrrev_b32 v12, 6, v0
v_and_b32 v1, 63, v0
v_readfirstlane_b32 s36, v12
s_nop 3
s_lshl_b32 s44, s34, 18
s_lshl_b32 s45, s35, 14
s_add_u32 s45, s45, s44
s_lshl_b32 s50, s34, 7
s_sub_u32 s50, s50, 16
s_and_b32 s47, s36, 3
s_lshl_b32 s43, s34, 7
s_lshl_b32 s44, s35, 3
s_add_u32 s43, s43, s44
s_mov_b32 s63, s43
s_lshl_b32 s44, s47, 1
s_add_u32 s51, s43, s44
v_lshlrev_b32 v10, 4, v1
v_lshrrev_b32 v14, 3, v1
v_and_b32 v15, 7, v1
v_and_b32 v16, 2, v14
v_xor_b32 v16, v15, v16
v_lshlrev_b32 v16, 4, v16
v_mul_u32_u24 v17, 6144, v14
s_lshl_b32 s43, s47, 11
v_add3_u32 v2, v17, v16, s43
v_xor_b32 v3, 64, v2
v_lshrrev_b32 v16, 1, v14
v_xor_b32 v16, v15, v16
v_lshlrev_b32 v16, 4, v16
s_lshl_b32 s43, s47, 3
s_add_u32 s43, s43, s50
v_add_u32 v17, s43, v14
s_and_b32 s44, s47, 1
s_lshl_b32 s44, s44, 6
v_add_u32 v18, 0, v17
v_max_i32 v18, 0, v18
v_lshl_add_u32 v18, v18, 11, v16
v_xor_b32 v18, s44, v18
v_mov_b32 v4, v18
v_add_u32 v18, 24, v17
v_max_i32 v18, 0, v18
v_lshl_add_u32 v18, v18, 11, v16
v_xor_b32 v18, s44, v18
v_xor_b32 v5, 64, v18
v_add_u32 v18, 48, v17
v_max_i32 v18, 0, v18
v_lshl_add_u32 v18, v18, 11, v16
v_xor_b32 v18, s44, v18
v_mov_b32 v6, v18
v_add_u32 v18, 72, v17
v_max_i32 v18, 0, v18
v_lshl_add_u32 v18, v18, 11, v16
v_xor_b32 v18, s44, v18
v_xor_b32 v7, 64, v18
v_add_u32 v18, 96, v17
v_max_i32 v18, 0, v18
v_lshl_add_u32 v18, v18, 11, v16
v_xor_b32 v18, s44, v18
v_mov_b32 v8, v18
v_add_u32 v18, 120, v17
v_max_i32 v18, 0, v18
v_lshl_add_u32 v18, v18, 11, v16
v_xor_b32 v18, s44, v18
v_xor_b32 v9, 64, v18
s_lshl_b32 s39, s47, 10
s_lshl_b32 s40, s47, 13
s_add_u32 s40, s40, 18432
s_mov_b32 s37, 0
s_mov_b32 s38, 0
s_bfm_b64 s[60:61], 56, 8
s_cmp_eq_u32 s47, 0
s_cselect_b64 s[60:61], s[60:61], -1
s_mov_b32 s53, 0x3f803f80
v_and_b32 v12, 15, v1
v_lshrrev_b32 v13, 4, v1
s_lshl_b32 s43, s35, 7
s_waitcnt lgkmcnt(0)
s_mov_b32 s8, s4
s_mov_b32 s9, s5
s_mov_b32 s10, 4194304
s_mov_b32 s11, 0x20000
s_add_u32 s12, s6, s43
s_addc_u32 s13, s7, 0
s_mov_b32 s14, 6289536
s_mov_b32 s15, 0x20000
s_add_u32 s16, s32, s45
s_addc_u32 s17, s33, 0
s_mov_b32 s18, 16384
s_mov_b32 s19, 0x20000
s_add_u32 s20, s32, 26214400
s_addc_u32 s21, s33, 0
s_mov_b32 s22, 16384
s_mov_b32 s23, 0x20000
s_cmp_lt_u32 s36, 4
s_cbranch_scc1 Lcons_2
s_cmp_eq_u32 s36, 7
s_cbranch_scc1 Lpf_3
s_add_u32 m0, s39, 0
s_mov_b64 exec, s[60:61]
buffer_load_dwordx4 v4, s[8:11], s37 offen lds
s_mov_b64 exec, -1
s_add_u32 m0, s39, 3072
s_nop 0
buffer_load_dwordx4 v5, s[8:11], s37 offen lds
s_add_u32 m0, s39, 6144
s_nop 0
buffer_load_dwordx4 v6, s[8:11], s37 offen lds
s_add_u32 m0, s39, 9216
s_nop 0
buffer_load_dwordx4 v7, s[8:11], s37 offen lds
s_add_u32 m0, s39, 12288
s_nop 0
buffer_load_dwordx4 v8, s[8:11], s37 offen lds
s_add_u32 m0, s39, 15360
s_nop 0
buffer_load_dwordx4 v9, s[8:11], s37 offen lds
s_add_u32 m0, s40, 0
s_add_u32 s43, s38, 0
buffer_load_dwordx4 v2, s[12:15], s43 offen lds
s_add_u32 m0, s40, 1024
s_add_u32 s43, s38, 49152
buffer_load_dwordx4 v3, s[12:15], s43 offen lds
s_add_u32 m0, s40, 2048
s_add_u32 s43, s38, 98304
buffer_load_dwordx4 v2, s[12:15], s43 offen lds
s_add_u32 m0, s40, 3072
s_add_u32 s43, s38, 147456
buffer_load_dwordx4 v3, s[12:15], s43 offen lds
s_add_u32 m0, s40, 4096
s_add_u32 s43, s38, 196608
buffer_load_dwordx4 v2, s[12:15], s43 offen lds
s_add_u32 m0, s40, 5120
s_add_u32 s43, s38, 245760
buffer_load_dwordx4 v3, s[12:15], s43 offen lds
s_add_u32 m0, s40, 6144
s_add_u32 s43, s38, 294912
buffer_load_dwordx4 v2, s[12:15], s43 offen lds
s_add_u32 m0, s40, 7168
s_add_u32 s43, s38, 344064
buffer_load_dwordx4 v3, s[12:15], s43 offen lds
s_add_u32 s37, s37, 128
s_add_u32 s38, s38, 393216
s_add_u32 m0, s39, 43008
s_mov_b64 exec, s[60:61]
buffer_load_dwordx4 v4, s[8:11], s37 offen lds
s_mov_b64 exec, -1
s_add_u32 m0, s39, 46080
s_nop 0
buffer_load_dwordx4 v5, s[8:11], s37 offen lds
s_add_u32 m0, s39, 49152
s_nop 0
buffer_load_dwordx4 v6, s[8:11], s37 offen lds
s_add_u32 m0, s39, 52224
s_nop 0
buffer_load_dwordx4 v7, s[8:11], s37 offen lds
s_add_u32 m0, s39, 55296
s_nop 0
buffer_load_dwordx4 v8, s[8:11], s37 offen lds
s_add_u32 m0, s39, 58368
s_nop 0
buffer_load_dwordx4 v9, s[8:11], s37 offen lds
s_add_u32 m0, s40, 43008
s_add_u32 s43, s38, 0
buffer_load_dwordx4 v2, s[12:15], s43 offen lds
s_add_u32 m0, s40, 44032
s_add_u32 s43, s38, 49152
buffer_load_dwordx4 v3, s[12:15], s43 offen lds
s_add_u32 m0, s40, 45056
s_add_u32 s43, s38, 98304
buffer_load_dwordx4 v2, s[12:15], s43 offen lds
s_add_u32 m0, s40, 46080
s_add_u32 s43, s38, 147456
buffer_load_dwordx4 v3, s[12:15], s43 offen lds
s_add_u32 m0, s40, 47104
s_add_u32 s43, s38, 196608
buffer_load_dwordx4 v2, s[12:15], s43 offen lds
s_add_u32 m0, s40, 48128
s_add_u32 s43, s38, 245760
buffer_load_dwordx4 v3, s[12:15], s43 offen lds
s_add_u32 m0, s40, 49152
s_add_u32 s43, s38, 294912
buffer_load_dwordx4 v2, s[12:15], s43 offen lds
s_add_u32 m0, s40, 50176
s_add_u32 s43, s38, 344064
buffer_load_dwordx4 v3, s[12:15], s43 offen lds
s_add_u32 s37, s37, 128
s_add_u32 s38, s38, 393216
s_waitcnt vmcnt(14)
s_barrier
s_add_u32 m0, s39, 86016
s_mov_b64 exec, s[60:61]
buffer_load_dwordx4 v4, s[8:11], s37 offen lds
s_mov_b64 exec, -1
s_add_u32 m0, s39, 89088
s_nop 0
buffer_load_dwordx4 v5, s[8:11], s37 offen lds
s_add_u32 m0, s39, 92160
s_nop 0
buffer_load_dwordx4 v6, s[8:11], s37 offen lds
s_add_u32 m0, s39, 95232
s_nop 0
buffer_load_dwordx4 v7, s[8:11], s37 offen lds
s_add_u32 m0, s39, 98304
s_nop 0
buffer_load_dwordx4 v8, s[8:11], s37 offen lds
s_add_u32 m0, s39, 101376
s_nop 0
buffer_load_dwordx4 v9, s[8:11], s37 offen lds
s_add_u32 m0, s40, 86016
s_add_u32 s43, s38, 0
buffer_load_dwordx4 v2, s[12:15], s43 offen lds
s_add_u32 m0, s40, 87040
s_add_u32 s43, s38, 49152
buffer_load_dwordx4 v3, s[12:15], s43 offen lds
s_add_u32 m0, s40, 88064
s_add_u32 s43, s38, 98304
buffer_load_dwordx4 v2, s[12:15], s43 offen lds
s_add_u32 m0, s40, 89088
s_add_u32 s43, s38, 147456
buffer_load_dwordx4 v3, s[12:15], s43 offen lds
s_add_u32 m0, s40, 90112
s_add_u32 s43, s38, 196608
buffer_load_dwordx4 v2, s[12:15], s43 offen lds
s_add_u32 m0, s40, 91136
s_add_u32 s43, s38, 245760
buffer_load_dwordx4 v3, s[12:15], s43 offen lds
s_add_u32 m0, s40, 92160
s_add_u32 s43, s38, 294912
buffer_load_dwordx4 v2, s[12:15], s43 offen lds
s_add_u32 m0, s40, 93184
s_add_u32 s43, s38, 344064
buffer_load_dwordx4 v3, s[12:15], s43 offen lds
s_add_u32 s37, s37, 128
s_add_u32 s38, s38, 393216
s_lshl_b32 s43, s51, 11
buffer_load_dwordx4 v[96:99], v10, s[8:11], s43 offen offset:0
buffer_load_dwordx4 v[100:103], v10, s[8:11], s43 offen offset:1024
buffer_load_dwordx4 v[104:107], v10, s[8:11], s43 offen offset:2048
buffer_load_dwordx4 v[108:111], v10, s[8:11], s43 offen offset:3072
s_lshr_b32 s43, s2, 5
s_cmp_eq_u32 s43, 3
s_cbranch_scc1 Lsj_7
s_cmp_gt_u32 s43, 3
s_cselect_b32 s43, 32, 0
s_sub_u32 s43, s2, s43
s_lshr_b32 s43, s43, 1
s_and_b32 s44, s2, 1
s_lshl_b32 s44, s44, 3
s_add_u32 s44, s44, 32
s_load_dwordx2 s[80:81], s[0:1], s44
s_mul_i32 s45, s43, 2341
s_lshr_b32 s45, s45, 16
s_mul_i32 s46, s45, 28
s_sub_u32 s46, s43, s46
s_lshl_b32 s45, s45, 8
s_mul_i32 s44, s47, 18
s_add_u32 s45, s45, s44
s_add_u32 s45, s45, 184
s_mul_i32 s45, s45, 7168
s_lshl_b32 s46, s46, 8
s_add_u32 s45, s45, s46
s_waitcnt lgkmcnt(0)
s_add_u32 s80, s80, s45
s_addc_u32 s81, s81, 0
Lsj_7:
s_waitcnt vmcnt(18)
s_barrier
s_add_u32 m0, s39, 0
s_mov_b64 exec, s[60:61]
buffer_load_dwordx4 v4, s[8:11], s37 offen lds
s_mov_b64 exec, -1
s_add_u32 m0, s39, 3072
s_nop 0
buffer_load_dwordx4 v5, s[8:11], s37 offen lds
s_add_u32 m0, s39, 6144
s_nop 0
buffer_load_dwordx4 v6, s[8:11], s37 offen lds
s_add_u32 m0, s39, 9216
s_nop 0
buffer_load_dwordx4 v7, s[8:11], s37 offen lds
s_add_u32 m0, s39, 12288
s_nop 0
buffer_load_dwordx4 v8, s[8:11], s37 offen lds
s_add_u32 m0, s39, 15360
s_nop 0
buffer_load_dwordx4 v9, s[8:11], s37 offen lds
s_add_u32 m0, s40, 0
s_add_u32 s43, s38, 0
buffer_load_dwordx4 v2, s[12:15], s43 offen lds
s_add_u32 m0, s40, 1024
s_add_u32 s43, s38, 49152
buffer_load_dwordx4 v3, s[12:15], s43 offen lds
s_add_u32 m0, s40, 2048
s_add_u32 s43, s38, 98304
buffer_load_dwordx4 v2, s[12:15], s43 offen lds
s_add_u32 m0, s40, 3072
s_add_u32 s43, s38, 147456
buffer_load_dwordx4 v3, s[12:15], s43 offen lds
s_add_u32 m0, s40, 4096
s_add_u32 s43, s38, 196608
buffer_load_dwordx4 v2, s[12:15], s43 offen lds
s_add_u32 m0, s40, 5120
s_add_u32 s43, s38, 245760
buffer_load_dwordx4 v3, s[12:15], s43 offen lds
s_add_u32 m0, s40, 6144
s_add_u32 s43, s38, 294912
buffer_load_dwordx4 v2, s[12:15], s43 offen lds
s_add_u32 m0, s40, 7168
s_add_u32 s43, s38, 344064
buffer_load_dwordx4 v3, s[12:15], s43 offen lds
s_add_u32 s37, s37, 128
s_add_u32 s38, s38, 393216
s_waitcnt vmcnt(14)
s_barrier
s_add_u32 m0, s39, 43008
s_mov_b64 exec, s[60:61]
buffer_load_dwordx4 v4, s[8:11], s37 offen lds
s_mov_b64 exec, -1
s_add_u32 m0, s39, 46080
s_nop 0
buffer_load_dwordx4 v5, s[8:11], s37 offen lds
s_add_u32 m0, s39, 49152
s_nop 0
buffer_load_dwordx4 v6, s[8:11], s37 offen lds
s_add_u32 m0, s39, 52224
s_nop 0
buffer_load_dwordx4 v7, s[8:11], s37 offen lds
s_add_u32 m0, s39, 55296
s_nop 0
buffer_load_dwordx4 v8, s[8:11], s37 offen lds
s_add_u32 m0, s39, 58368
s_nop 0
buffer_load_dwordx4 v9, s[8:11], s37 offen lds
s_add_u32 m0, s40, 43008
s_add_u32 s43, s38, 0
buffer_load_dwordx4 v2, s[12:15], s43 offen lds
s_add_u32 m0, s40, 44032
s_add_u32 s43, s38, 49152
buffer_load_dwordx4 v3, s[12:15], s43 offen lds
s_add_u32 m0, s40, 45056
s_add_u32 s43, s38, 98304
buffer_load_dwordx4 v2, s[12:15], s43 offen lds
s_add_u32 m0, s40, 46080
s_add_u32 s43, s38, 147456
buffer_load_dwordx4 v3, s[12:15], s43 offen lds
s_add_u32 m0, s40, 47104
s_add_u32 s43, s38, 196608
buffer_load_dwordx4 v2, s[12:15], s43 offen lds
s_add_u32 m0, s40, 48128
s_add_u32 s43, s38, 245760
buffer_load_dwordx4 v3, s[12:15], s43 offen lds
s_add_u32 m0, s40, 49152
s_add_u32 s43, s38, 294912
buffer_load_dwordx4 v2, s[12:15], s43 offen lds
s_add_u32 m0, s40, 50176
s_add_u32 s43, s38, 344064
buffer_load_dwordx4 v3, s[12:15], s43 offen lds
s_add_u32 s37, s37, 128
s_add_u32 s38, s38, 393216
v_lshlrev_b32 v116, 16, v96
v_and_b32 v117, 0xffff0000, v96
v_mul_f32 v118, v116, v116
v_mul_f32 v119, v117, v117
v_lshlrev_b32 v126, 16, v97
v_and_b32 v127, 0xffff0000, v97
v_add_f32 v116, v116, v126
v_add_f32 v117, v117, v127
v_fmac_f32 v118, v126, v126
v_fmac_f32 v119, v127, v127
v_lshlrev_b32 v124, 16, v98
v_and_b32 v125, 0xffff0000, v98
v_add_f32 v116, v116, v124
v_add_f32 v117, v117, v125
v_fmac_f32 v118, v124, v124
v_fmac_f32 v119, v125, v125
v_lshlrev_b32 v126, 16, v99
v_and_b32 v127, 0xffff0000, v99
v_add_f32 v116, v116, v126
v_add_f32 v117, v117, v127
v_fmac_f32 v118, v126, v126
v_fmac_f32 v119, v127, v127
v_lshlrev_b32 v124, 16, v100
v_and_b32 v125, 0xffff0000, v100
v_add_f32 v116, v116, v124
v_add_f32 v117, v117, v125
v_fmac_f32 v118, v124, v124
v_fmac_f32 v119, v125, v125
v_lshlrev_b32 v126, 16, v101
v_and_b32 v127, 0xffff0000, v101
v_add_f32 v116, v116, v126
v_add_f32 v117, v117, v127
v_fmac_f32 v118, v126, v126
v_fmac_f32 v119, v127, v127
v_lshlrev_b32 v124, 16, v102
v_and_b32 v125, 0xffff0000, v102
v_add_f32 v116, v116, v124
v_add_f32 v117, v117, v125
v_fmac_f32 v118, v124, v124
v_fmac_f32 v119, v125, v125
v_lshlrev_b32 v126, 16, v103
v_and_b32 v127, 0xffff0000, v103
v_add_f32 v116, v116, v126
v_add_f32 v117, v117, v127
v_fmac_f32 v118, v126, v126
v_fmac_f32 v119, v127, v127
v_lshlrev_b32 v120, 16, v104
v_and_b32 v121, 0xffff0000, v104
v_mul_f32 v122, v120, v120
v_mul_f32 v123, v121, v121
s_waitcnt vmcnt(14)
s_barrier
s_add_u32 m0, s39, 86016
s_mov_b64 exec, s[60:61]
buffer_load_dwordx4 v4, s[8:11], s37 offen lds
s_mov_b64 exec, -1
s_add_u32 m0, s39, 89088
s_nop 0
buffer_load_dwordx4 v5, s[8:11], s37 offen lds
s_add_u32 m0, s39, 92160
s_nop 0
buffer_load_dwordx4 v6, s[8:11], s37 offen lds
s_add_u32 m0, s39, 95232
s_nop 0
buffer_load_dwordx4 v7, s[8:11], s37 offen lds
s_add_u32 m0, s39, 98304
s_nop 0
buffer_load_dwordx4 v8, s[8:11], s37 offen lds
s_add_u32 m0, s39, 101376
s_nop 0
buffer_load_dwordx4 v9, s[8:11], s37 offen lds
s_add_u32 m0, s40, 86016
s_add_u32 s43, s38, 0
buffer_load_dwordx4 v2, s[12:15], s43 offen lds
s_add_u32 m0, s40, 87040
s_add_u32 s43, s38, 49152
buffer_load_dwordx4 v3, s[12:15], s43 offen lds
s_add_u32 m0, s40, 88064
s_add_u32 s43, s38, 98304
buffer_load_dwordx4 v2, s[12:15], s43 offen lds
s_add_u32 m0, s40, 89088
s_add_u32 s43, s38, 147456
buffer_load_dwordx4 v3, s[12:15], s43 offen lds
s_add_u32 m0, s40, 90112
s_add_u32 s43, s38, 196608
buffer_load_dwordx4 v2, s[12:15], s43 offen lds
s_add_u32 m0, s40, 91136
s_add_u32 s43, s38, 245760
buffer_load_dwordx4 v3, s[12:15], s43 offen lds
s_add_u32 m0, s40, 92160
s_add_u32 s43, s38, 294912
buffer_load_dwordx4 v2, s[12:15], s43 offen lds
s_add_u32 m0, s40, 93184
s_add_u32 s43, s38, 344064
buffer_load_dwordx4 v3, s[12:15], s43 offen lds
s_add_u32 s37, s37, 128
s_add_u32 s38, s38, 393216
v_lshlrev_b32 v126, 16, v105
v_and_b32 v127, 0xffff0000, v105
v_add_f32 v120, v120, v126
v_add_f32 v121, v121, v127
v_fmac_f32 v122, v126, v126
v_fmac_f32 v123, v127, v127
v_lshlrev_b32 v124, 16, v106
v_and_b32 v125, 0xffff0000, v106
v_add_f32 v120, v120, v124
v_add_f32 v121, v121, v125
v_fmac_f32 v122, v124, v124
v_fmac_f32 v123, v125, v125
v_lshlrev_b32 v126, 16, v107
v_and_b32 v127, 0xffff0000, v107
v_add_f32 v120, v120, v126
v_add_f32 v121, v121, v127
v_fmac_f32 v122, v126, v126
v_fmac_f32 v123, v127, v127
v_lshlrev_b32 v124, 16, v108
v_and_b32 v125, 0xffff0000, v108
v_add_f32 v120, v120, v124
v_add_f32 v121, v121, v125
v_fmac_f32 v122, v124, v124
v_fmac_f32 v123, v125, v125
v_lshlrev_b32 v126, 16, v109
v_and_b32 v127, 0xffff0000, v109
v_add_f32 v120, v120, v126
v_add_f32 v121, v121, v127
v_fmac_f32 v122, v126, v126
v_fmac_f32 v123, v127, v127
v_lshlrev_b32 v124, 16, v110
v_and_b32 v125, 0xffff0000, v110
v_add_f32 v120, v120, v124
v_add_f32 v121, v121, v125
v_fmac_f32 v122, v124, v124
v_fmac_f32 v123, v125, v125
v_lshlrev_b32 v126, 16, v111
v_and_b32 v127, 0xffff0000, v111
v_add_f32 v120, v120, v126
v_add_f32 v121, v121, v127
v_fmac_f32 v122, v126, v126
v_fmac_f32 v123, v127, v127
v_add_f32 v116, v116, v117
v_add_f32 v118, v118, v119
v_add_f32 v120, v120, v121
v_add_f32 v122, v122, v123
v_add_f32_dpp v116, v116, v116 row_ror:8 row_mask:0xf bank_mask:0xf
v_add_f32_dpp v118, v118, v118 row_ror:8 row_mask:0xf bank_mask:0xf
v_add_f32_dpp v120, v120, v120 row_ror:8 row_mask:0xf bank_mask:0xf
v_add_f32_dpp v122, v122, v122 row_ror:8 row_mask:0xf bank_mask:0xf
s_waitcnt vmcnt(14)
s_barrier
s_add_u32 m0, s39, 0
s_mov_b64 exec, s[60:61]
buffer_load_dwordx4 v4, s[8:11], s37 offen lds
s_mov_b64 exec, -1
s_add_u32 m0, s39, 3072
s_nop 0
buffer_load_dwordx4 v5, s[8:11], s37 offen lds
s_add_u32 m0, s39, 6144
s_nop 0
buffer_load_dwordx4 v6, s[8:11], s37 offen lds
s_add_u32 m0, s39, 9216
s_nop 0
buffer_load_dwordx4 v7, s[8:11], s37 offen lds
s_add_u32 m0, s39, 12288
s_nop 0
buffer_load_dwordx4 v8, s[8:11], s37 offen lds
s_add_u32 m0, s39, 15360
s_nop 0
buffer_load_dwordx4 v9, s[8:11], s37 offen lds
s_add_u32 m0, s40, 0
s_add_u32 s43, s38, 0
buffer_load_dwordx4 v2, s[12:15], s43 offen lds
s_add_u32 m0, s40, 1024
s_add_u32 s43, s38, 49152
buffer_load_dwordx4 v3, s[12:15], s43 offen lds
s_add_u32 m0, s40, 2048
s_add_u32 s43, s38, 98304
buffer_load_dwordx4 v2, s[12:15], s43 offen lds
s_add_u32 m0, s40, 3072
s_add_u32 s43, s38, 147456
buffer_load_dwordx4 v3, s[12:15], s43 offen lds
s_add_u32 m0, s40, 4096
s_add_u32 s43, s38, 196608
buffer_load_dwordx4 v2, s[12:15], s43 offen lds
s_add_u32 m0, s40, 5120
s_add_u32 s43, s38, 245760
buffer_load_dwordx4 v3, s[12:15], s43 offen lds
s_add_u32 m0, s40, 6144
s_add_u32 s43, s38, 294912
buffer_load_dwordx4 v2, s[12:15], s43 offen lds
s_add_u32 m0, s40, 7168
s_add_u32 s43, s38, 344064
buffer_load_dwordx4 v3, s[12:15], s43 offen lds
s_add_u32 s37, s37, 128
s_add_u32 s38, s38, 393216
v_add_f32_dpp v116, v116, v116 row_ror:4 row_mask:0xf bank_mask:0xf
v_add_f32_dpp v118, v118, v118 row_ror:4 row_mask:0xf bank_mask:0xf
v_add_f32_dpp v120, v120, v120 row_ror:4 row_mask:0xf bank_mask:0xf
v_add_f32_dpp v122, v122, v122 row_ror:4 row_mask:0xf bank_mask:0xf
v_add_f32_dpp v116, v116, v116 row_ror:2 row_mask:0xf bank_mask:0xf
v_add_f32_dpp v118, v118, v118 row_ror:2 row_mask:0xf bank_mask:0xf
v_add_f32_dpp v120, v120, v120 row_ror:2 row_mask:0xf bank_mask:0xf
v_add_f32_dpp v122, v122, v122 row_ror:2 row_mask:0xf bank_mask:0xf
v_add_f32_dpp v116, v116, v116 row_ror:1 row_mask:0xf bank_mask:0xf
v_add_f32_dpp v118, v118, v118 row_ror:1 row_mask:0xf bank_mask:0xf
v_add_f32_dpp v120, v120, v120 row_ror:1 row_mask:0xf bank_mask:0xf
v_add_f32_dpp v122, v122, v122 row_ror:1 row_mask:0xf bank_mask:0xf
v_mov_b32 v117, v116
v_mov_b32 v119, v118
v_mov_b32 v121, v120
v_mov_b32 v123, v122
s_nop 0
v_permlane16_swap_b32 v116, v117
v_permlane16_swap_b32 v118, v119
v_permlane16_swap_b32 v120, v121
v_permlane16_swap_b32 v122, v123
v_add_f32 v116, v116, v117
v_add_f32 v118, v118, v119
v_add_f32 v120, v120, v121
v_add_f32 v122, v122, v123
v_mov_b32 v117, v116
v_mov_b32 v119, v118
v_mov_b32 v121, v120
v_mov_b32 v123, v122
s_nop 0
v_permlane32_swap_b32 v116, v117
v_permlane32_swap_b32 v118, v119
v_permlane32_swap_b32 v120, v121
v_permlane32_swap_b32 v122, v123
v_add_f32 v116, v116, v117
v_add_f32 v118, v118, v119
v_add_f32 v120, v120, v121
v_add_f32 v122, v122, v123
v_mul_f32 v112, 0x3a800000, v116
v_mul_f32 v113, 0x3a800000, v118
v_fma_f32 v113, -v112, v112, v113
v_max_f32 v113, 0, v113
v_add_f32 v113, 0x3727c5ac, v113
v_rsq_f32 v113, v113
v_mul_f32 v114, 0x3a800000, v120
v_mul_f32 v115, 0x3a800000, v122
v_fma_f32 v115, -v114, v114, v115
v_max_f32 v115, 0, v115
v_add_f32 v115, 0x3727c5ac, v115
v_rsq_f32 v115, v115
s_nop 0
s_lshl_b32 s43, s47, 4
s_add_u32 s43, s43, 130176
v_mov_b32 v11, s43
ds_write_b128 v11, v[112:115]
s_waitcnt lgkmcnt(0)
s_load_dword s64, s[80:81], 0
s_load_dword s65, s[80:81], 64
s_load_dword s66, s[80:81], 128
s_load_dword s67, s[80:81], 192
s_load_dword s68, s[80:81], 7168
s_load_dword s69, s[80:81], 7232
s_load_dword s70, s[80:81], 7296
s_load_dword s71, s[80:81], 7360
s_add_u32 s80, s80, 14336
s_addc_u32 s81, s81, 0
s_waitcnt vmcnt(14)
s_barrier
s_add_u32 m0, s39, 43008
s_mov_b64 exec, s[60:61]
buffer_load_dwordx4 v4, s[8:11], s37 offen lds
s_mov_b64 exec, -1
s_add_u32 m0, s39, 46080
s_nop 0
buffer_load_dwordx4 v5, s[8:11], s37 offen lds
s_add_u32 m0, s39, 49152
s_nop 0
buffer_load_dwordx4 v6, s[8:11], s37 offen lds
s_add_u32 m0, s39, 52224
s_nop 0
buffer_load_dwordx4 v7, s[8:11], s37 offen lds
s_add_u32 m0, s39, 55296
s_nop 0
buffer_load_dwordx4 v8, s[8:11], s37 offen lds
s_add_u32 m0, s39, 58368
s_nop 0
buffer_load_dwordx4 v9, s[8:11], s37 offen lds
s_add_u32 m0, s40, 43008
s_add_u32 s43, s38, 0
buffer_load_dwordx4 v2, s[12:15], s43 offen lds
s_add_u32 m0, s40, 44032
s_add_u32 s43, s38, 49152
buffer_load_dwordx4 v3, s[12:15], s43 offen lds
s_add_u32 m0, s40, 45056
s_add_u32 s43, s38, 98304
buffer_load_dwordx4 v2, s[12:15], s43 offen lds
s_add_u32 m0, s40, 46080
s_add_u32 s43, s38, 147456
buffer_load_dwordx4 v3, s[12:15], s43 offen lds
s_add_u32 m0, s40, 47104
s_add_u32 s43, s38, 196608
buffer_load_dwordx4 v2, s[12:15], s43 offen lds
s_add_u32 m0, s40, 48128
s_add_u32 s43, s38, 245760
buffer_load_dwordx4 v3, s[12:15], s43 offen lds
s_add_u32 m0, s40, 49152
s_add_u32 s43, s38, 294912
buffer_load_dwordx4 v2, s[12:15], s43 offen lds
s_add_u32 m0, s40, 50176
s_add_u32 s43, s38, 344064
buffer_load_dwordx4 v3, s[12:15], s43 offen lds
s_add_u32 s37, s37, 128
s_add_u32 s38, s38, 393216
s_load_dword s64, s[80:81], 0
s_load_dword s65, s[80:81], 64
s_load_dword s66, s[80:81], 128
s_load_dword s67, s[80:81], 192
s_load_dword s68, s[80:81], 7168
s_load_dword s69, s[80:81], 7232
s_load_dword s70, s[80:81], 7296
s_load_dword s71, s[80:81], 7360
s_add_u32 s80, s80, 14336
s_addc_u32 s81, s81, 0
s_waitcnt vmcnt(14)
s_barrier
s_add_u32 m0, s39, 86016
s_mov_b64 exec, s[60:61]
buffer_load_dwordx4 v4, s[8:11], s37 offen lds
s_mov_b64 exec, -1
s_add_u32 m0, s39, 89088
s_nop 0
buffer_load_dwordx4 v5, s[8:11], s37 offen lds
s_add_u32 m0, s39, 92160
s_nop 0
buffer_load_dwordx4 v6, s[8:11], s37 offen lds
s_add_u32 m0, s39, 95232
s_nop 0
buffer_load_dwordx4 v7, s[8:11], s37 offen lds
s_add_u32 m0, s39, 98304
s_nop 0
buffer_load_dwordx4 v8, s[8:11], s37 offen lds
s_add_u32 m0, s39, 101376
s_nop 0
buffer_load_dwordx4 v9, s[8:11], s37 offen lds
s_add_u32 m0, s40, 86016
s_add_u32 s43, s38, 0
buffer_load_dwordx4 v2, s[12:15], s43 offen lds
s_add_u32 m0, s40, 87040
s_add_u32 s43, s38, 49152
buffer_load_dwordx4 v3, s[12:15], s43 offen lds
s_add_u32 m0, s40, 88064
s_add_u32 s43, s38, 98304
buffer_load_dwordx4 v2, s[12:15], s43 offen lds
s_add_u32 m0, s40, 89088
s_add_u32 s43, s38, 147456
buffer_load_dwordx4 v3, s[12:15], s43 offen lds
s_add_u32 m0, s40, 90112
s_add_u32 s43, s38, 196608
buffer_load_dwordx4 v2, s[12:15], s43 offen lds
s_add_u32 m0, s40, 91136
s_add_u32 s43, s38, 245760
buffer_load_dwordx4 v3, s[12:15], s43 offen lds
s_add_u32 m0, s40, 92160
s_add_u32 s43, s38, 294912
buffer_load_dwordx4 v2, s[12:15], s43 offen lds
s_add_u32 m0, s40, 93184
s_add_u32 s43, s38, 344064
buffer_load_dwordx4 v3, s[12:15], s43 offen lds
s_add_u32 s37, s37, 128
s_add_u32 s38, s38, 393216
s_load_dword s64, s[80:81], 0
s_load_dword s65, s[80:81], 64
s_load_dword s66, s[80:81], 128
s_load_dword s67, s[80:81], 192
s_load_dword s68, s[80:81], 7168
s_load_dword s69, s[80:81], 7232
s_load_dword s70, s[80:81], 7296
s_load_dword s71, s[80:81], 7360
s_add_u32 s80, s80, 14336
s_addc_u32 s81, s81, 0
s_waitcnt vmcnt(14)
s_barrier
s_add_u32 m0, s39, 0
s_mov_b64 exec, s[60:61]
buffer_load_dwordx4 v4, s[8:11], s37 offen lds
s_mov_b64 exec, -1
s_add_u32 m0, s39, 3072
s_nop 0
buffer_load_dwordx4 v5, s[8:11], s37 offen lds
s_add_u32 m0, s39, 6144
s_nop 0
buffer_load_dwordx4 v6, s[8:11], s37 offen lds
s_add_u32 m0, s39, 9216
s_nop 0
buffer_load_dwordx4 v7, s[8:11], s37 offen lds
s_add_u32 m0, s39, 12288
s_nop 0
buffer_load_dwordx4 v8, s[8:11], s37 offen lds
s_add_u32 m0, s39, 15360
s_nop 0
buffer_load_dwordx4 v9, s[8:11], s37 offen lds
s_add_u32 m0, s40, 0
s_add_u32 s43, s38, 0
buffer_load_dwordx4 v2, s[12:15], s43 offen lds
s_add_u32 m0, s40, 1024
s_add_u32 s43, s38, 49152
buffer_load_dwordx4 v3, s[12:15], s43 offen lds
s_add_u32 m0, s40, 2048
s_add_u32 s43, s38, 98304
buffer_load_dwordx4 v2, s[12:15], s43 offen lds
s_add_u32 m0, s40, 3072
s_add_u32 s43, s38, 147456
buffer_load_dwordx4 v3, s[12:15], s43 offen lds
s_add_u32 m0, s40, 4096
s_add_u32 s43, s38, 196608
buffer_load_dwordx4 v2, s[12:15], s43 offen lds
s_add_u32 m0, s40, 5120
s_add_u32 s43, s38, 245760
buffer_load_dwordx4 v3, s[12:15], s43 offen lds
s_add_u32 m0, s40, 6144
s_add_u32 s43, s38, 294912
buffer_load_dwordx4 v2, s[12:15], s43 offen lds
s_add_u32 m0, s40, 7168
s_add_u32 s43, s38, 344064
buffer_load_dwordx4 v3, s[12:15], s43 offen lds
s_add_u32 s37, s37, 128
s_add_u32 s38, s38, 393216
s_load_dword s64, s[80:81], 0
s_load_dword s65, s[80:81], 64
s_load_dword s66, s[80:81], 128
s_load_dword s67, s[80:81], 192
s_load_dword s68, s[80:81], 7168
s_load_dword s69, s[80:81], 7232
s_load_dword s70, s[80:81], 7296
s_load_dword s71, s[80:81], 7360
s_add_u32 s80, s80, 14336
s_addc_u32 s81, s81, 0
s_waitcnt vmcnt(14)
s_barrier
s_add_u32 m0, s39, 43008
s_mov_b64 exec, s[60:61]
buffer_load_dwordx4 v4, s[8:11], s37 offen lds
s_mov_b64 exec, -1
s_add_u32 m0, s39, 46080
s_nop 0
buffer_load_dwordx4 v5, s[8:11], s37 offen lds
s_add_u32 m0, s39, 49152
s_nop 0
buffer_load_dwordx4 v6, s[8:11], s37 offen lds
s_add_u32 m0, s39, 52224
s_nop 0
buffer_load_dwordx4 v7, s[8:11], s37 offen lds
s_add_u32 m0, s39, 55296
s_nop 0
buffer_load_dwordx4 v8, s[8:11], s37 offen lds
s_add_u32 m0, s39, 58368
s_nop 0
buffer_load_dwordx4 v9, s[8:11], s37 offen lds
s_add_u32 m0, s40, 43008
s_add_u32 s43, s38, 0
buffer_load_dwordx4 v2, s[12:15], s43 offen lds
s_add_u32 m0, s40, 44032
s_add_u32 s43, s38, 49152
buffer_load_dwordx4 v3, s[12:15], s43 offen lds
s_add_u32 m0, s40, 45056
s_add_u32 s43, s38, 98304
buffer_load_dwordx4 v2, s[12:15], s43 offen lds
s_add_u32 m0, s40, 46080
s_add_u32 s43, s38, 147456
buffer_load_dwordx4 v3, s[12:15], s43 offen lds
s_add_u32 m0, s40, 47104
s_add_u32 s43, s38, 196608
buffer_load_dwordx4 v2, s[12:15], s43 offen lds
s_add_u32 m0, s40, 48128
s_add_u32 s43, s38, 245760
buffer_load_dwordx4 v3, s[12:15], s43 offen lds
s_add_u32 m0, s40, 49152
s_add_u32 s43, s38, 294912
buffer_load_dwordx4 v2, s[12:15], s43 offen lds
s_add_u32 m0, s40, 50176
s_add_u32 s43, s38, 344064
buffer_load_dwordx4 v3, s[12:15], s43 offen lds
s_add_u32 s37, s37, 128
s_add_u32 s38, s38, 393216
s_load_dword s64, s[80:81], 0
s_load_dword s65, s[80:81], 64
s_load_dword s66, s[80:81], 128
s_load_dword s67, s[80:81], 192
s_load_dword s68, s[80:81], 7168
s_load_dword s69, s[80:81], 7232
s_load_dword s70, s[80:81], 7296
s_load_dword s71, s[80:81], 7360
s_add_u32 s80, s80, 14336
s_addc_u32 s81, s81, 0
s_waitcnt vmcnt(14)
s_barrier
s_add_u32 m0, s39, 86016
s_mov_b64 exec, s[60:61]
buffer_load_dwordx4 v4, s[8:11], s37 offen lds
s_mov_b64 exec, -1
s_add_u32 m0, s39, 89088
s_nop 0
buffer_load_dwordx4 v5, s[8:11], s37 offen lds
s_add_u32 m0, s39, 92160
s_nop 0
buffer_load_dwordx4 v6, s[8:11], s37 offen lds
s_add_u32 m0, s39, 95232
s_nop 0
buffer_load_dwordx4 v7, s[8:11], s37 offen lds
s_add_u32 m0, s39, 98304
s_nop 0
buffer_load_dwordx4 v8, s[8:11], s37 offen lds
s_add_u32 m0, s39, 101376
s_nop 0
buffer_load_dwordx4 v9, s[8:11], s37 offen lds
s_add_u32 m0, s40, 86016
s_add_u32 s43, s38, 0
buffer_load_dwordx4 v2, s[12:15], s43 offen lds
s_add_u32 m0, s40, 87040
s_add_u32 s43, s38, 49152
buffer_load_dwordx4 v3, s[12:15], s43 offen lds
s_add_u32 m0, s40, 88064
s_add_u32 s43, s38, 98304
buffer_load_dwordx4 v2, s[12:15], s43 offen lds
s_add_u32 m0, s40, 89088
s_add_u32 s43, s38, 147456
buffer_load_dwordx4 v3, s[12:15], s43 offen lds
s_add_u32 m0, s40, 90112
s_add_u32 s43, s38, 196608
buffer_load_dwordx4 v2, s[12:15], s43 offen lds
s_add_u32 m0, s40, 91136
s_add_u32 s43, s38, 245760
buffer_load_dwordx4 v3, s[12:15], s43 offen lds
s_add_u32 m0, s40, 92160
s_add_u32 s43, s38, 294912
buffer_load_dwordx4 v2, s[12:15], s43 offen lds
s_add_u32 m0, s40, 93184
s_add_u32 s43, s38, 344064
buffer_load_dwordx4 v3, s[12:15], s43 offen lds
s_add_u32 s37, s37, 128
s_add_u32 s38, s38, 393216
s_load_dword s64, s[80:81], 0
s_load_dword s65, s[80:81], 64
s_load_dword s66, s[80:81], 128
s_load_dword s67, s[80:81], 192
s_load_dword s68, s[80:81], 7168
s_load_dword s69, s[80:81], 7232
s_load_dword s70, s[80:81], 7296
s_load_dword s71, s[80:81], 7360
s_add_u32 s80, s80, 14336
s_addc_u32 s81, s81, 0
s_waitcnt vmcnt(14)
s_barrier
s_add_u32 m0, s39, 0
s_mov_b64 exec, s[60:61]
buffer_load_dwordx4 v4, s[8:11], s37 offen lds
s_mov_b64 exec, -1
s_add_u32 m0, s39, 3072
s_nop 0
buffer_load_dwordx4 v5, s[8:11], s37 offen lds
s_add_u32 m0, s39, 6144
s_nop 0
buffer_load_dwordx4 v6, s[8:11], s37 offen lds
s_add_u32 m0, s39, 9216
s_nop 0
buffer_load_dwordx4 v7, s[8:11], s37 offen lds
s_add_u32 m0, s39, 12288
s_nop 0
buffer_load_dwordx4 v8, s[8:11], s37 offen lds
s_add_u32 m0, s39, 15360
s_nop 0
buffer_load_dwordx4 v9, s[8:11], s37 offen lds
s_add_u32 m0, s40, 0
s_add_u32 s43, s38, 0
buffer_load_dwordx4 v2, s[12:15], s43 offen lds
s_add_u32 m0, s40, 1024
s_add_u32 s43, s38, 49152
buffer_load_dwordx4 v3, s[12:15], s43 offen lds
s_add_u32 m0, s40, 2048
s_add_u32 s43, s38, 98304
buffer_load_dwordx4 v2, s[12:15], s43 offen lds
s_add_u32 m0, s40, 3072
s_add_u32 s43, s38, 147456
buffer_load_dwordx4 v3, s[12:15], s43 offen lds
s_add_u32 m0, s40, 4096
s_add_u32 s43, s38, 196608
buffer_load_dwordx4 v2, s[12:15], s43 offen lds
s_add_u32 m0, s40, 5120
s_add_u32 s43, s38, 245760
buffer_load_dwordx4 v3, s[12:15], s43 offen lds
s_add_u32 m0, s40, 6144
s_add_u32 s43, s38, 294912
buffer_load_dwordx4 v2, s[12:15], s43 offen lds
s_add_u32 m0, s40, 7168
s_add_u32 s43, s38, 344064
buffer_load_dwordx4 v3, s[12:15], s43 offen lds
s_add_u32 s37, s37, 128
s_add_u32 s38, s38, 393216
s_load_dword s64, s[80:81], 0
s_load_dword s65, s[80:81], 64
s_load_dword s66, s[80:81], 128
s_load_dword s67, s[80:81], 192
s_load_dword s68, s[80:81], 7168
s_load_dword s69, s[80:81], 7232
s_load_dword s70, s[80:81], 7296
s_load_dword s71, s[80:81], 7360
s_add_u32 s80, s80, 14336
s_addc_u32 s81, s81, 0
s_waitcnt vmcnt(14)
s_barrier
s_add_u32 m0, s39, 43008
s_mov_b64 exec, s[60:61]
buffer_load_dwordx4 v4, s[8:11], s37 offen lds
s_mov_b64 exec, -1
s_add_u32 m0, s39, 46080
s_nop 0
buffer_load_dwordx4 v5, s[8:11], s37 offen lds
s_add_u32 m0, s39, 49152
s_nop 0
buffer_load_dwordx4 v6, s[8:11], s37 offen lds
s_add_u32 m0, s39, 52224
s_nop 0
buffer_load_dwordx4 v7, s[8:11], s37 offen lds
s_add_u32 m0, s39, 55296
s_nop 0
buffer_load_dwordx4 v8, s[8:11], s37 offen lds
s_add_u32 m0, s39, 58368
s_nop 0
buffer_load_dwordx4 v9, s[8:11], s37 offen lds
s_add_u32 m0, s40, 43008
s_add_u32 s43, s38, 0
buffer_load_dwordx4 v2, s[12:15], s43 offen lds
s_add_u32 m0, s40, 44032
s_add_u32 s43, s38, 49152
buffer_load_dwordx4 v3, s[12:15], s43 offen lds
s_add_u32 m0, s40, 45056
s_add_u32 s43, s38, 98304
buffer_load_dwordx4 v2, s[12:15], s43 offen lds
s_add_u32 m0, s40, 46080
s_add_u32 s43, s38, 147456
buffer_load_dwordx4 v3, s[12:15], s43 offen lds
s_add_u32 m0, s40, 47104
s_add_u32 s43, s38, 196608
buffer_load_dwordx4 v2, s[12:15], s43 offen lds
s_add_u32 m0, s40, 48128
s_add_u32 s43, s38, 245760
buffer_load_dwordx4 v3, s[12:15], s43 offen lds
s_add_u32 m0, s40, 49152
s_add_u32 s43, s38, 294912
buffer_load_dwordx4 v2, s[12:15], s43 offen lds
s_add_u32 m0, s40, 50176
s_add_u32 s43, s38, 344064
buffer_load_dwordx4 v3, s[12:15], s43 offen lds
s_add_u32 s37, s37, 128
s_add_u32 s38, s38, 393216
s_load_dword s64, s[80:81], 0
s_load_dword s65, s[80:81], 64
s_load_dword s66, s[80:81], 128
s_load_dword s67, s[80:81], 192
s_load_dword s68, s[80:81], 7168
s_load_dword s69, s[80:81], 7232
s_load_dword s70, s[80:81], 7296
s_load_dword s71, s[80:81], 7360
s_add_u32 s80, s80, 14336
s_addc_u32 s81, s81, 0
s_waitcnt vmcnt(14)
s_barrier
s_add_u32 m0, s39, 86016
s_mov_b64 exec, s[60:61]
buffer_load_dwordx4 v4, s[8:11], s37 offen lds
s_mov_b64 exec, -1
s_add_u32 m0, s39, 89088
s_nop 0
buffer_load_dwordx4 v5, s[8:11], s37 offen lds
s_add_u32 m0, s39, 92160
s_nop 0
buffer_load_dwordx4 v6, s[8:11], s37 offen lds
s_add_u32 m0, s39, 95232
s_nop 0
buffer_load_dwordx4 v7, s[8:11], s37 offen lds
s_add_u32 m0, s39, 98304
s_nop 0
buffer_load_dwordx4 v8, s[8:11], s37 offen lds
s_add_u32 m0, s39, 101376
s_nop 0
buffer_load_dwordx4 v9, s[8:11], s37 offen lds
s_add_u32 m0, s40, 86016
s_add_u32 s43, s38, 0
buffer_load_dwordx4 v2, s[12:15], s43 offen lds
s_add_u32 m0, s40, 87040
s_add_u32 s43, s38, 49152
buffer_load_dwordx4 v3, s[12:15], s43 offen lds
s_add_u32 m0, s40, 88064
s_add_u32 s43, s38, 98304
buffer_load_dwordx4 v2, s[12:15], s43 offen lds
s_add_u32 m0, s40, 89088
s_add_u32 s43, s38, 147456
buffer_load_dwordx4 v3, s[12:15], s43 offen lds
s_add_u32 m0, s40, 90112
s_add_u32 s43, s38, 196608
buffer_load_dwordx4 v2, s[12:15], s43 offen lds
s_add_u32 m0, s40, 91136
s_add_u32 s43, s38, 245760
buffer_load_dwordx4 v3, s[12:15], s43 offen lds
s_add_u32 m0, s40, 92160
s_add_u32 s43, s38, 294912
buffer_load_dwordx4 v2, s[12:15], s43 offen lds
s_add_u32 m0, s40, 93184
s_add_u32 s43, s38, 344064
buffer_load_dwordx4 v3, s[12:15], s43 offen lds
s_add_u32 s37, s37, 128
s_add_u32 s38, s38, 393216
s_load_dword s64, s[80:81], 0
s_load_dword s65, s[80:81], 64
s_load_dword s66, s[80:81], 128
s_load_dword s67, s[80:81], 192
s_load_dword s68, s[80:81], 7168
s_load_dword s69, s[80:81], 7232
s_load_dword s70, s[80:81], 7296
s_load_dword s71, s[80:81], 7360
s_add_u32 s80, s80, 14336
s_addc_u32 s81, s81, 0
s_waitcnt vmcnt(14)
s_barrier
s_add_u32 m0, s39, 0
s_mov_b64 exec, s[60:61]
buffer_load_dwordx4 v4, s[8:11], s37 offen lds
s_mov_b64 exec, -1
s_add_u32 m0, s39, 3072
s_nop 0
buffer_load_dwordx4 v5, s[8:11], s37 offen lds
s_add_u32 m0, s39, 6144
s_nop 0
buffer_load_dwordx4 v6, s[8:11], s37 offen lds
s_add_u32 m0, s39, 9216
s_nop 0
buffer_load_dwordx4 v7, s[8:11], s37 offen lds
s_add_u32 m0, s39, 12288
s_nop 0
buffer_load_dwordx4 v8, s[8:11], s37 offen lds
s_add_u32 m0, s39, 15360
s_nop 0
buffer_load_dwordx4 v9, s[8:11], s37 offen lds
s_add_u32 m0, s40, 0
s_add_u32 s43, s38, 0
buffer_load_dwordx4 v2, s[12:15], s43 offen lds
s_add_u32 m0, s40, 1024
s_add_u32 s43, s38, 49152
buffer_load_dwordx4 v3, s[12:15], s43 offen lds
s_add_u32 m0, s40, 2048
s_add_u32 s43, s38, 98304
buffer_load_dwordx4 v2, s[12:15], s43 offen lds
s_add_u32 m0, s40, 3072
s_add_u32 s43, s38, 147456
buffer_load_dwordx4 v3, s[12:15], s43 offen lds
s_add_u32 m0, s40, 4096
s_add_u32 s43, s38, 196608
buffer_load_dwordx4 v2, s[12:15], s43 offen lds
s_add_u32 m0, s40, 5120
s_add_u32 s43, s38, 245760
buffer_load_dwordx4 v3, s[12:15], s43 offen lds
s_add_u32 m0, s40, 6144
s_add_u32 s43, s38, 294912
buffer_load_dwordx4 v2, s[12:15], s43 offen lds
s_add_u32 m0, s40, 7168
s_add_u32 s43, s38, 344064
buffer_load_dwordx4 v3, s[12:15], s43 offen lds
s_add_u32 s37, s37, 128
s_add_u32 s38, s38, 393216
s_waitcnt vmcnt(14)
s_barrier
s_waitcnt vmcnt(0)
s_barrier
s_barrier
s_waitcnt lgkmcnt(0)
s_and_b32 s43, s36, 1
s_lshr_b32 s44, s36, 1
s_and_b32 s44, s44, 1
s_lshr_b32 s45, s36, 2
v_lshlrev_b32 v14, 2, v13
v_sub_u32 v14, v12, v14
v_subrev_u32 v15, 0, v14
v_cmp_ge_u32 s[52:53], 7, v15
v_add_u32 v15, 16, v15
v_cmp_ge_u32 s[84:85], 7, v15
v_subrev_u32 v15, 1, v14
v_cmp_ge_u32 s[54:55], 7, v15
v_add_u32 v15, 16, v15
v_cmp_ge_u32 s[86:87], 7, v15
v_subrev_u32 v15, 2, v14
v_cmp_ge_u32 s[56:57], 7, v15
v_add_u32 v15, 16, v15
v_cmp_ge_u32 s[88:89], 7, v15
v_subrev_u32 v15, 3, v14
v_cmp_ge_u32 s[58:59], 7, v15
v_add_u32 v15, 16, v15
v_cmp_ge_u32 s[90:91], 7, v15
s_lshl_b32 s46, s45, 6
s_add_u32 s46, s46, s44
s_add_u32 s46, s46, 16
v_lshl_add_u32 v14, v12, 1, s46
s_lshl_b32 s47, s43, 6
v_lshl_add_u32 v15, v13, 4, s47
v_mul_u32_u24 v20, 400, v14
v_add_u32 v20, v20, v15
v_subrev_u32 v16, 32, v14
v_max_i32 v16, 0, v16
v_mul_u32_u24 v21, 400, v16
v_add_u32 v21, v21, v15
v_lshrrev_b32 v16, 2, v12
v_lshl_add_u32 v16, v13, 2, v16
v_lshl_add_u32 v16, v16, 1, s46
v_and_b32 v17, 3, v1
v_lshl_add_u32 v17, v17, 3, s47
v_mul_u32_u24 v22, 400, v16
v_add_u32 v22, v22, v17
v_subrev_u32 v16, 32, v16
v_max_i32 v16, 0, v16
v_mul_u32_u24 v23, 400, v16
v_add_u32 v23, v23, v17
s_lshl_b32 s60, s43, 13
s_lshl_b32 s61, s45, 10
s_add_u32 s60, s60, s61
s_lshl_b32 s61, s44, 8
s_add_u32 s60, s60, s61
v_lshlrev_b32 v27, 11, v13
v_lshl_add_u32 v27, v12, 4, v27
v_add_u32 v27, s60, v27
v_mov_b32 v28, 0xff800000
s_mov_b32 s61, 0x3e8293ee
s_nop 2
s_or_b32 s62, s34, s45
s_cmp_lg_u32 s62, 0
s_cselect_b64 s[64:65], s[84:85], 0
s_cselect_b64 s[66:67], s[86:87], 0
s_cselect_b64 s[68:69], s[88:89], 0
s_cselect_b64 s[70:71], s[90:91], 0
s_branch Latt_4
Lcons_2:
s_cmp_ge_u32 s36, 2
s_cbranch_scc1 Lsp_5
s_mov_b32 s84, s6
s_mov_b32 s85, s7
s_mov_b32 s86, 6291456
s_mov_b32 s87, 0x20000
s_and_b32 s43, s35, 8
s_or_b32 s43, s43, 3
s_lshl_b32 s43, s43, 7
s_lshr_b32 s44, s2, 3
s_mul_i32 s44, s44, 196608
s_add_u32 s43, s43, s44
s_lshl_b32 s44, s36, 6
v_add_u32 v15, s44, v1
v_min_u32 v15, 95, v15
v_mul_u32_u24 v16, 21846, v15
v_lshrrev_b32 v16, 16, v16
v_mul_u32_u24 v17, 3, v16
v_sub_u32 v15, v15, v17
v_mul_u32_u24 v16, 6144, v16
v_lshl_add_u32 v15, v15, 11, v16
buffer_load_dword v31, v15, s[84:87], s43 offen
Lsp_5:
v_lshrrev_b32 v16, 1, v12
v_xor_b32 v15, v13, v16
v_lshlrev_b32 v15, 4, v15
v_lshl_add_u32 v2, v12, 7, v15
v_xor_b32 v3, 64, v2
v_add_u32 v4, 86016, v2
v_add_u32 v5, 86016, v3
v_lshrrev_b32 v15, 2, v12
v_and_b32 v16, 3, v1
v_lshl_add_u32 v19, v13, 3, v15
v_lshlrev_b32 v19, 7, v19
v_and_b32 v15, 2, v15
v_and_b32 v17, 1, v13
v_lshl_add_u32 v15, v17, 2, v15
v_lshrrev_b32 v17, 1, v16
s_lshl_b32 s43, s36, 1
v_add_u32 v17, s43, v17
v_xor_b32 v15, v15, v17
v_lshl_add_u32 v19, v15, 4, v19
v_and_b32 v16, 1, v16
v_lshl_add_u32 v19, v16, 3, v19
v_add_u32 v6, 18432, v19
v_add_u32 v7, 61440, v19
v_add_u32 v8, 104448, v19
v_mov_b32 v128, 0
v_mov_b32 v129, 0
v_mov_b32 v130, 0
v_mov_b32 v131, 0
v_mov_b32 v132, 0
v_mov_b32 v133, 0
v_mov_b32 v134, 0
v_mov_b32 v135, 0
v_mov_b32 v136, 0
v_mov_b32 v137, 0
v_mov_b32 v138, 0
v_mov_b32 v139, 0
v_mov_b32 v140, 0
v_mov_b32 v141, 0
v_mov_b32 v142, 0
v_mov_b32 v143, 0
v_mov_b32 v144, 0
v_mov_b32 v145, 0
v_mov_b32 v146, 0
v_mov_b32 v147, 0
v_mov_b32 v148, 0
v_mov_b32 v149, 0
v_mov_b32 v150, 0
v_mov_b32 v151, 0
v_mov_b32 v152, 0
v_mov_b32 v153, 0
v_mov_b32 v154, 0
v_mov_b32 v155, 0
v_mov_b32 v156, 0
v_mov_b32 v157, 0
v_mov_b32 v158, 0
v_mov_b32 v159, 0
v_mov_b32 v160, 0
v_mov_b32 v161, 0
v_mov_b32 v162, 0
v_mov_b32 v163, 0
v_mov_b32 v164, 0
v_mov_b32 v165, 0
v_mov_b32 v166, 0
v_mov_b32 v167, 0
v_mov_b32 v168, 0
v_mov_b32 v169, 0
v_mov_b32 v170, 0
v_mov_b32 v171, 0
v_mov_b32 v172, 0
v_mov_b32 v173, 0
v_mov_b32 v174, 0
v_mov_b32 v175, 0
v_mov_b32 v176, 0
v_mov_b32 v177, 0
v_mov_b32 v178, 0
v_mov_b32 v179, 0
v_mov_b32 v180, 0
v_mov_b32 v181, 0
v_mov_b32 v182, 0
v_mov_b32 v183, 0
v_mov_b32 v184, 0
v_mov_b32 v185, 0
v_mov_b32 v186, 0
v_mov_b32 v187, 0
v_mov_b32 v188, 0
v_mov_b32 v189, 0
v_mov_b32 v190, 0
v_mov_b32 v191, 0
v_mov_b32 v192, 0
v_mov_b32 v193, 0
v_mov_b32 v194, 0
v_mov_b32 v195, 0
v_mov_b32 v196, 0
v_mov_b32 v197, 0
v_mov_b32 v198, 0
v_mov_b32 v199, 0
v_mov_b32 v200, 0
v_mov_b32 v201, 0
v_mov_b32 v202, 0
v_mov_b32 v203, 0
v_mov_b32 v204, 0
v_mov_b32 v205, 0
v_mov_b32 v206, 0
v_mov_b32 v207, 0
v_mov_b32 v208, 0
v_mov_b32 v209, 0
v_mov_b32 v210, 0
v_mov_b32 v211, 0
v_mov_b32 v212, 0
v_mov_b32 v213, 0
v_mov_b32 v214, 0
v_mov_b32 v215, 0
v_mov_b32 v216, 0
v_mov_b32 v217, 0
v_mov_b32 v218, 0
v_mov_b32 v219, 0
v_mov_b32 v220, 0
v_mov_b32 v221, 0
v_mov_b32 v222, 0
v_mov_b32 v223, 0
v_mov_b32 v224, 0
v_mov_b32 v225, 0
v_mov_b32 v226, 0
v_mov_b32 v227, 0
v_mov_b32 v228, 0
v_mov_b32 v229, 0
v_mov_b32 v230, 0
v_mov_b32 v231, 0
v_mov_b32 v232, 0
v_mov_b32 v233, 0
v_mov_b32 v234, 0
v_mov_b32 v235, 0
s_and_b32 s43, s36, 1
s_lshr_b32 s44, s36, 1
s_and_b32 s44, s44, 1
s_lshr_b32 s45, s36, 2
v_lshlrev_b32 v14, 2, v13
v_sub_u32 v14, v12, v14
v_subrev_u32 v15, 0, v14
v_cmp_ge_u32 s[52:53], 7, v15
v_add_u32 v15, 16, v15
v_cmp_ge_u32 s[84:85], 7, v15
v_subrev_u32 v15, 1, v14
v_cmp_ge_u32 s[54:55], 7, v15
v_add_u32 v15, 16, v15
v_cmp_ge_u32 s[86:87], 7, v15
v_subrev_u32 v15, 2, v14
v_cmp_ge_u32 s[56:57], 7, v15
v_add_u32 v15, 16, v15
v_cmp_ge_u32 s[88:89], 7, v15
v_subrev_u32 v15, 3, v14
v_cmp_ge_u32 s[58:59], 7, v15
v_add_u32 v15, 16, v15
v_cmp_ge_u32 s[90:91], 7, v15
s_lshl_b32 s46, s45, 6
s_add_u32 s46, s46, s44
s_add_u32 s46, s46, 16
v_lshl_add_u32 v14, v12, 1, s46
s_lshl_b32 s47, s43, 6
v_lshl_add_u32 v15, v13, 4, s47
v_mul_u32_u24 v20, 400, v14
v_add_u32 v20, v20, v15
v_subrev_u32 v16, 32, v14
v_max_i32 v16, 0, v16
v_mul_u32_u24 v21, 400, v16
v_add_u32 v21, v21, v15
v_lshrrev_b32 v16, 2, v12
v_lshl_add_u32 v16, v13, 2, v16
v_lshl_add_u32 v16, v16, 1, s46
v_and_b32 v17, 3, v1
v_lshl_add_u32 v17, v17, 3, s47
v_mul_u32_u24 v22, 400, v16
v_add_u32 v22, v22, v17
v_subrev_u32 v16, 32, v16
v_max_i32 v16, 0, v16
v_mul_u32_u24 v23, 400, v16
v_add_u32 v23, v23, v17
s_lshl_b32 s60, s43, 13
s_lshl_b32 s61, s45, 10
s_add_u32 s60, s60, s61
s_lshl_b32 s61, s44, 8
s_add_u32 s60, s60, s61
v_lshlrev_b32 v27, 11, v13
v_lshl_add_u32 v27, v12, 4, v27
v_add_u32 v27, s60, v27
v_mov_b32 v28, 0xff800000
s_mov_b32 s61, 0x3e8293ee
s_nop 2
s_or_b32 s62, s34, s45
s_cmp_lg_u32 s62, 0
s_cselect_b64 s[64:65], s[84:85], 0
s_cselect_b64 s[66:67], s[86:87], 0
s_cselect_b64 s[68:69], s[88:89], 0
s_cselect_b64 s[70:71], s[90:91], 0
v_lshlrev_b32 v9, 3, v12
v_add_u32 v9, 129024, v9
v_mul_u32_u24 v14, 400, v12
v_lshl_add_u32 v14, v13, 3, v14
s_lshl_b32 s43, s36, 5
v_add_u32 v14, s43, v14
s_barrier
ds_read_b128 v[32:35], v2 offset:0
ds_read_b64_tr_b16 v[72:73], v6 offset:8192
ds_read_b64_tr_b16 v[74:75], v6 offset:8704
ds_read_b64_tr_b16 v[76:77], v6 offset:16384
ds_read_b64_tr_b16 v[78:79], v6 offset:16896
ds_read_b64_tr_b16 v[68:69], v6 offset:0
ds_read_b64_tr_b16 v[70:71], v6 offset:512
ds_read_b128 v[36:39], v2 offset:2048
ds_read_b128 v[40:43], v2 offset:4096
ds_read_b128 v[44:47], v2 offset:6144
ds_read_b128 v[48:51], v2 offset:8192
ds_read_b128 v[52:55], v2 offset:10240
ds_read_b128 v[56:59], v2 offset:12288
ds_read_b128 v[60:63], v2 offset:14336
ds_read_b128 v[64:67], v2 offset:16384
s_mov_b32 s41, 5
Lcl_6:
s_waitcnt lgkmcnt(0)
v_mfma_f32_16x16x32_bf16 v[164:167], v[72:75], v[32:35], v[164:167]
ds_read_b128 v[80:83], v3 offset:0
v_mfma_f32_16x16x32_bf16 v[200:203], v[76:79], v[32:35], v[200:203]
ds_read_b64_tr_b16 v[120:121], v6 offset:12288
v_mfma_f32_16x16x32_bf16 v[128:131], v[68:71], v[32:35], v[128:131]
ds_read_b64_tr_b16 v[122:123], v6 offset:12800
v_mfma_f32_16x16x32_bf16 v[168:171], v[72:75], v[36:39], v[168:171]
ds_read_b64_tr_b16 v[124:125], v6 offset:20480
v_mfma_f32_16x16x32_bf16 v[204:207], v[76:79], v[36:39], v[204:207]
ds_read_b64_tr_b16 v[126:127], v6 offset:20992
v_mfma_f32_16x16x32_bf16 v[132:135], v[68:71], v[36:39], v[132:135]
ds_read_b64_tr_b16 v[116:117], v6 offset:4096
v_mfma_f32_16x16x32_bf16 v[172:175], v[72:75], v[40:43], v[172:175]
ds_read_b64_tr_b16 v[118:119], v6 offset:4608
v_mfma_f32_16x16x32_bf16 v[208:211], v[76:79], v[40:43], v[208:211]
ds_read_b128 v[84:87], v3 offset:2048
v_mfma_f32_16x16x32_bf16 v[136:139], v[68:71], v[40:43], v[136:139]
ds_read_b128 v[88:91], v3 offset:4096
v_mfma_f32_16x16x32_bf16 v[176:179], v[72:75], v[44:47], v[176:179]
ds_read_b128 v[92:95], v3 offset:6144
v_mfma_f32_16x16x32_bf16 v[212:215], v[76:79], v[44:47], v[212:215]
ds_read_b128 v[96:99], v3 offset:8192
v_mfma_f32_16x16x32_bf16 v[140:143], v[68:71], v[44:47], v[140:143]
ds_read_b128 v[100:103], v3 offset:10240
v_mfma_f32_16x16x32_bf16 v[180:183], v[72:75], v[48:51], v[180:183]
ds_read_b128 v[104:107], v3 offset:12288
v_mfma_f32_16x16x32_bf16 v[216:219], v[76:79], v[48:51], v[216:219]
ds_read_b128 v[108:111], v3 offset:14336
v_mfma_f32_16x16x32_bf16 v[144:147], v[68:71], v[48:51], v[144:147]
ds_read_b128 v[112:115], v3 offset:16384
v_mfma_f32_16x16x32_bf16 v[184:187], v[72:75], v[52:55], v[184:187]
v_mfma_f32_16x16x32_bf16 v[220:223], v[76:79], v[52:55], v[220:223]
v_mfma_f32_16x16x32_bf16 v[148:151], v[68:71], v[52:55], v[148:151]
v_mfma_f32_16x16x32_bf16 v[188:191], v[72:75], v[56:59], v[188:191]
v_mfma_f32_16x16x32_bf16 v[224:227], v[76:79], v[56:59], v[224:227]
v_mfma_f32_16x16x32_bf16 v[152:155], v[68:71], v[56:59], v[152:155]
v_mfma_f32_16x16x32_bf16 v[192:195], v[72:75], v[60:63], v[192:195]
v_mfma_f32_16x16x32_bf16 v[228:231], v[76:79], v[60:63], v[228:231]
v_mfma_f32_16x16x32_bf16 v[156:159], v[68:71], v[60:63], v[156:159]
v_mfma_f32_16x16x32_bf16 v[196:199], v[72:75], v[64:67], v[196:199]
v_mfma_f32_16x16x32_bf16 v[232:235], v[76:79], v[64:67], v[232:235]
v_mfma_f32_16x16x32_bf16 v[160:163], v[68:71], v[64:67], v[160:163]
s_waitcnt lgkmcnt(0)
s_barrier
v_mfma_f32_16x16x32_bf16 v[164:167], v[120:123], v[80:83], v[164:167]
ds_read_b128 v[32:35], v2 offset:43008
v_mfma_f32_16x16x32_bf16 v[200:203], v[124:127], v[80:83], v[200:203]
ds_read_b64_tr_b16 v[72:73], v7 offset:8192
v_mfma_f32_16x16x32_bf16 v[128:131], v[116:119], v[80:83], v[128:131]
ds_read_b64_tr_b16 v[74:75], v7 offset:8704
v_mfma_f32_16x16x32_bf16 v[168:171], v[120:123], v[84:87], v[168:171]
ds_read_b64_tr_b16 v[76:77], v7 offset:16384
v_mfma_f32_16x16x32_bf16 v[204:207], v[124:127], v[84:87], v[204:207]
ds_read_b64_tr_b16 v[78:79], v7 offset:16896
v_mfma_f32_16x16x32_bf16 v[132:135], v[116:119], v[84:87], v[132:135]
ds_read_b64_tr_b16 v[68:69], v7 offset:0
v_mfma_f32_16x16x32_bf16 v[172:175], v[120:123], v[88:91], v[172:175]
ds_read_b64_tr_b16 v[70:71], v7 offset:512
v_mfma_f32_16x16x32_bf16 v[208:211], v[124:127], v[88:91], v[208:211]
ds_read_b128 v[36:39], v2 offset:45056
v_mfma_f32_16x16x32_bf16 v[136:139], v[116:119], v[88:91], v[136:139]
ds_read_b128 v[40:43], v2 offset:47104
v_mfma_f32_16x16x32_bf16 v[176:179], v[120:123], v[92:95], v[176:179]
ds_read_b128 v[44:47], v2 offset:49152
v_mfma_f32_16x16x32_bf16 v[212:215], v[124:127], v[92:95], v[212:215]
ds_read_b128 v[48:51], v2 offset:51200
v_mfma_f32_16x16x32_bf16 v[140:143], v[116:119], v[92:95], v[140:143]
ds_read_b128 v[52:55], v2 offset:53248
v_mfma_f32_16x16x32_bf16 v[180:183], v[120:123], v[96:99], v[180:183]
ds_read_b128 v[56:59], v2 offset:55296
v_mfma_f32_16x16x32_bf16 v[216:219], v[124:127], v[96:99], v[216:219]
ds_read_b128 v[60:63], v2 offset:57344
v_mfma_f32_16x16x32_bf16 v[144:147], v[116:119], v[96:99], v[144:147]
ds_read_b128 v[64:67], v2 offset:59392
v_mfma_f32_16x16x32_bf16 v[184:187], v[120:123], v[100:103], v[184:187]
v_mfma_f32_16x16x32_bf16 v[220:223], v[124:127], v[100:103], v[220:223]
v_mfma_f32_16x16x32_bf16 v[148:151], v[116:119], v[100:103], v[148:151]
v_mfma_f32_16x16x32_bf16 v[188:191], v[120:123], v[104:107], v[188:191]
v_mfma_f32_16x16x32_bf16 v[224:227], v[124:127], v[104:107], v[224:227]
v_mfma_f32_16x16x32_bf16 v[152:155], v[116:119], v[104:107], v[152:155]
v_mfma_f32_16x16x32_bf16 v[192:195], v[120:123], v[108:111], v[192:195]
v_mfma_f32_16x16x32_bf16 v[228:231], v[124:127], v[108:111], v[228:231]
v_mfma_f32_16x16x32_bf16 v[156:159], v[116:119], v[108:111], v[156:159]
v_mfma_f32_16x16x32_bf16 v[196:199], v[120:123], v[112:115], v[196:199]
v_mfma_f32_16x16x32_bf16 v[232:235], v[124:127], v[112:115], v[232:235]
v_mfma_f32_16x16x32_bf16 v[160:163], v[116:119], v[112:115], v[160:163]
s_waitcnt lgkmcnt(0)
v_mfma_f32_16x16x32_bf16 v[164:167], v[72:75], v[32:35], v[164:167]
ds_read_b128 v[80:83], v3 offset:43008
v_mfma_f32_16x16x32_bf16 v[200:203], v[76:79], v[32:35], v[200:203]
ds_read_b64_tr_b16 v[120:121], v7 offset:12288
v_mfma_f32_16x16x32_bf16 v[128:131], v[68:71], v[32:35], v[128:131]
ds_read_b64_tr_b16 v[122:123], v7 offset:12800
v_mfma_f32_16x16x32_bf16 v[168:171], v[72:75], v[36:39], v[168:171]
ds_read_b64_tr_b16 v[124:125], v7 offset:20480
v_mfma_f32_16x16x32_bf16 v[204:207], v[76:79], v[36:39], v[204:207]
ds_read_b64_tr_b16 v[126:127], v7 offset:20992
v_mfma_f32_16x16x32_bf16 v[132:135], v[68:71], v[36:39], v[132:135]
ds_read_b64_tr_b16 v[116:117], v7 offset:4096
v_mfma_f32_16x16x32_bf16 v[172:175], v[72:75], v[40:43], v[172:175]
ds_read_b64_tr_b16 v[118:119], v7 offset:4608
v_mfma_f32_16x16x32_bf16 v[208:211], v[76:79], v[40:43], v[208:211]
ds_read_b128 v[84:87], v3 offset:45056
v_mfma_f32_16x16x32_bf16 v[136:139], v[68:71], v[40:43], v[136:139]
ds_read_b128 v[88:91], v3 offset:47104
v_mfma_f32_16x16x32_bf16 v[176:179], v[72:75], v[44:47], v[176:179]
ds_read_b128 v[92:95], v3 offset:49152
v_mfma_f32_16x16x32_bf16 v[212:215], v[76:79], v[44:47], v[212:215]
ds_read_b128 v[96:99], v3 offset:51200
v_mfma_f32_16x16x32_bf16 v[140:143], v[68:71], v[44:47], v[140:143]
ds_read_b128 v[100:103], v3 offset:53248
v_mfma_f32_16x16x32_bf16 v[180:183], v[72:75], v[48:51], v[180:183]
ds_read_b128 v[104:107], v3 offset:55296
v_mfma_f32_16x16x32_bf16 v[216:219], v[76:79], v[48:51], v[216:219]
ds_read_b128 v[108:111], v3 offset:57344
v_mfma_f32_16x16x32_bf16 v[144:147], v[68:71], v[48:51], v[144:147]
ds_read_b128 v[112:115], v3 offset:59392
v_mfma_f32_16x16x32_bf16 v[184:187], v[72:75], v[52:55], v[184:187]
v_mfma_f32_16x16x32_bf16 v[220:223], v[76:79], v[52:55], v[220:223]
v_mfma_f32_16x16x32_bf16 v[148:151], v[68:71], v[52:55], v[148:151]
v_mfma_f32_16x16x32_bf16 v[188:191], v[72:75], v[56:59], v[188:191]
v_mfma_f32_16x16x32_bf16 v[224:227], v[76:79], v[56:59], v[224:227]
v_mfma_f32_16x16x32_bf16 v[152:155], v[68:71], v[56:59], v[152:155]
v_mfma_f32_16x16x32_bf16 v[192:195], v[72:75], v[60:63], v[192:195]
v_mfma_f32_16x16x32_bf16 v[228:231], v[76:79], v[60:63], v[228:231]
v_mfma_f32_16x16x32_bf16 v[156:159], v[68:71], v[60:63], v[156:159]
v_mfma_f32_16x16x32_bf16 v[196:199], v[72:75], v[64:67], v[196:199]
v_mfma_f32_16x16x32_bf16 v[232:235], v[76:79], v[64:67], v[232:235]
v_mfma_f32_16x16x32_bf16 v[160:163], v[68:71], v[64:67], v[160:163]
s_waitcnt lgkmcnt(0)
s_barrier
v_mfma_f32_16x16x32_bf16 v[164:167], v[120:123], v[80:83], v[164:167]
ds_read_b128 v[32:35], v4 offset:0
v_mfma_f32_16x16x32_bf16 v[200:203], v[124:127], v[80:83], v[200:203]
ds_read_b64_tr_b16 v[72:73], v8 offset:8192
v_mfma_f32_16x16x32_bf16 v[128:131], v[116:119], v[80:83], v[128:131]
ds_read_b64_tr_b16 v[74:75], v8 offset:8704
v_mfma_f32_16x16x32_bf16 v[168:171], v[120:123], v[84:87], v[168:171]
ds_read_b64_tr_b16 v[76:77], v8 offset:16384
v_mfma_f32_16x16x32_bf16 v[204:207], v[124:127], v[84:87], v[204:207]
ds_read_b64_tr_b16 v[78:79], v8 offset:16896
v_mfma_f32_16x16x32_bf16 v[132:135], v[116:119], v[84:87], v[132:135]
ds_read_b64_tr_b16 v[68:69], v8 offset:0
v_mfma_f32_16x16x32_bf16 v[172:175], v[120:123], v[88:91], v[172:175]
ds_read_b64_tr_b16 v[70:71], v8 offset:512
v_mfma_f32_16x16x32_bf16 v[208:211], v[124:127], v[88:91], v[208:211]
ds_read_b128 v[36:39], v4 offset:2048
v_mfma_f32_16x16x32_bf16 v[136:139], v[116:119], v[88:91], v[136:139]
ds_read_b128 v[40:43], v4 offset:4096
v_mfma_f32_16x16x32_bf16 v[176:179], v[120:123], v[92:95], v[176:179]
ds_read_b128 v[44:47], v4 offset:6144
v_mfma_f32_16x16x32_bf16 v[212:215], v[124:127], v[92:95], v[212:215]
ds_read_b128 v[48:51], v4 offset:8192
v_mfma_f32_16x16x32_bf16 v[140:143], v[116:119], v[92:95], v[140:143]
ds_read_b128 v[52:55], v4 offset:10240
v_mfma_f32_16x16x32_bf16 v[180:183], v[120:123], v[96:99], v[180:183]
ds_read_b128 v[56:59], v4 offset:12288
v_mfma_f32_16x16x32_bf16 v[216:219], v[124:127], v[96:99], v[216:219]
ds_read_b128 v[60:63], v4 offset:14336
v_mfma_f32_16x16x32_bf16 v[144:147], v[116:119], v[96:99], v[144:147]
ds_read_b128 v[64:67], v4 offset:16384
v_mfma_f32_16x16x32_bf16 v[184:187], v[120:123], v[100:103], v[184:187]
v_mfma_f32_16x16x32_bf16 v[220:223], v[124:127], v[100:103], v[220:223]
v_mfma_f32_16x16x32_bf16 v[148:151], v[116:119], v[100:103], v[148:151]
v_mfma_f32_16x16x32_bf16 v[188:191], v[120:123], v[104:107], v[188:191]
v_mfma_f32_16x16x32_bf16 v[224:227], v[124:127], v[104:107], v[224:227]
v_mfma_f32_16x16x32_bf16 v[152:155], v[116:119], v[104:107], v[152:155]
v_mfma_f32_16x16x32_bf16 v[192:195], v[120:123], v[108:111], v[192:195]
v_mfma_f32_16x16x32_bf16 v[228:231], v[124:127], v[108:111], v[228:231]
v_mfma_f32_16x16x32_bf16 v[156:159], v[116:119], v[108:111], v[156:159]
v_mfma_f32_16x16x32_bf16 v[196:199], v[120:123], v[112:115], v[196:199]
v_mfma_f32_16x16x32_bf16 v[232:235], v[124:127], v[112:115], v[232:235]
v_mfma_f32_16x16x32_bf16 v[160:163], v[116:119], v[112:115], v[160:163]
s_waitcnt lgkmcnt(0)
v_mfma_f32_16x16x32_bf16 v[164:167], v[72:75], v[32:35], v[164:167]
ds_read_b128 v[80:83], v5 offset:0
v_mfma_f32_16x16x32_bf16 v[200:203], v[76:79], v[32:35], v[200:203]
ds_read_b64_tr_b16 v[120:121], v8 offset:12288
v_mfma_f32_16x16x32_bf16 v[128:131], v[68:71], v[32:35], v[128:131]
ds_read_b64_tr_b16 v[122:123], v8 offset:12800
v_mfma_f32_16x16x32_bf16 v[168:171], v[72:75], v[36:39], v[168:171]
ds_read_b64_tr_b16 v[124:125], v8 offset:20480
v_mfma_f32_16x16x32_bf16 v[204:207], v[76:79], v[36:39], v[204:207]
ds_read_b64_tr_b16 v[126:127], v8 offset:20992
v_mfma_f32_16x16x32_bf16 v[132:135], v[68:71], v[36:39], v[132:135]
ds_read_b64_tr_b16 v[116:117], v8 offset:4096
v_mfma_f32_16x16x32_bf16 v[172:175], v[72:75], v[40:43], v[172:175]
ds_read_b64_tr_b16 v[118:119], v8 offset:4608
v_mfma_f32_16x16x32_bf16 v[208:211], v[76:79], v[40:43], v[208:211]
ds_read_b128 v[84:87], v5 offset:2048
v_mfma_f32_16x16x32_bf16 v[136:139], v[68:71], v[40:43], v[136:139]
ds_read_b128 v[88:91], v5 offset:4096
v_mfma_f32_16x16x32_bf16 v[176:179], v[72:75], v[44:47], v[176:179]
ds_read_b128 v[92:95], v5 offset:6144
v_mfma_f32_16x16x32_bf16 v[212:215], v[76:79], v[44:47], v[212:215]
ds_read_b128 v[96:99], v5 offset:8192
v_mfma_f32_16x16x32_bf16 v[140:143], v[68:71], v[44:47], v[140:143]
ds_read_b128 v[100:103], v5 offset:10240
v_mfma_f32_16x16x32_bf16 v[180:183], v[72:75], v[48:51], v[180:183]
ds_read_b128 v[104:107], v5 offset:12288
v_mfma_f32_16x16x32_bf16 v[216:219], v[76:79], v[48:51], v[216:219]
ds_read_b128 v[108:111], v5 offset:14336
v_mfma_f32_16x16x32_bf16 v[144:147], v[68:71], v[48:51], v[144:147]
ds_read_b128 v[112:115], v5 offset:16384
v_mfma_f32_16x16x32_bf16 v[184:187], v[72:75], v[52:55], v[184:187]
v_mfma_f32_16x16x32_bf16 v[220:223], v[76:79], v[52:55], v[220:223]
v_mfma_f32_16x16x32_bf16 v[148:151], v[68:71], v[52:55], v[148:151]
v_mfma_f32_16x16x32_bf16 v[188:191], v[72:75], v[56:59], v[188:191]
v_mfma_f32_16x16x32_bf16 v[224:227], v[76:79], v[56:59], v[224:227]
v_mfma_f32_16x16x32_bf16 v[152:155], v[68:71], v[56:59], v[152:155]
v_mfma_f32_16x16x32_bf16 v[192:195], v[72:75], v[60:63], v[192:195]
v_mfma_f32_16x16x32_bf16 v[228:231], v[76:79], v[60:63], v[228:231]
v_mfma_f32_16x16x32_bf16 v[156:159], v[68:71], v[60:63], v[156:159]
v_mfma_f32_16x16x32_bf16 v[196:199], v[72:75], v[64:67], v[196:199]
v_mfma_f32_16x16x32_bf16 v[232:235], v[76:79], v[64:67], v[232:235]
v_mfma_f32_16x16x32_bf16 v[160:163], v[68:71], v[64:67], v[160:163]
s_waitcnt lgkmcnt(0)
s_barrier
v_mfma_f32_16x16x32_bf16 v[164:167], v[120:123], v[80:83], v[164:167]
ds_read_b128 v[32:35], v2 offset:0
v_mfma_f32_16x16x32_bf16 v[200:203], v[124:127], v[80:83], v[200:203]
ds_read_b64_tr_b16 v[72:73], v6 offset:8192
v_mfma_f32_16x16x32_bf16 v[128:131], v[116:119], v[80:83], v[128:131]
ds_read_b64_tr_b16 v[74:75], v6 offset:8704
v_mfma_f32_16x16x32_bf16 v[168:171], v[120:123], v[84:87], v[168:171]
ds_read_b64_tr_b16 v[76:77], v6 offset:16384
v_mfma_f32_16x16x32_bf16 v[204:207], v[124:127], v[84:87], v[204:207]
ds_read_b64_tr_b16 v[78:79], v6 offset:16896
v_mfma_f32_16x16x32_bf16 v[132:135], v[116:119], v[84:87], v[132:135]
ds_read_b64_tr_b16 v[68:69], v6 offset:0
v_mfma_f32_16x16x32_bf16 v[172:175], v[120:123], v[88:91], v[172:175]
ds_read_b64_tr_b16 v[70:71], v6 offset:512
v_mfma_f32_16x16x32_bf16 v[208:211], v[124:127], v[88:91], v[208:211]
ds_read_b128 v[36:39], v2 offset:2048
v_mfma_f32_16x16x32_bf16 v[136:139], v[116:119], v[88:91], v[136:139]
ds_read_b128 v[40:43], v2 offset:4096
v_mfma_f32_16x16x32_bf16 v[176:179], v[120:123], v[92:95], v[176:179]
ds_read_b128 v[44:47], v2 offset:6144
v_mfma_f32_16x16x32_bf16 v[212:215], v[124:127], v[92:95], v[212:215]
ds_read_b128 v[48:51], v2 offset:8192
v_mfma_f32_16x16x32_bf16 v[140:143], v[116:119], v[92:95], v[140:143]
ds_read_b128 v[52:55], v2 offset:10240
v_mfma_f32_16x16x32_bf16 v[180:183], v[120:123], v[96:99], v[180:183]
ds_read_b128 v[56:59], v2 offset:12288
v_mfma_f32_16x16x32_bf16 v[216:219], v[124:127], v[96:99], v[216:219]
ds_read_b128 v[60:63], v2 offset:14336
v_mfma_f32_16x16x32_bf16 v[144:147], v[116:119], v[96:99], v[144:147]
ds_read_b128 v[64:67], v2 offset:16384
v_mfma_f32_16x16x32_bf16 v[184:187], v[120:123], v[100:103], v[184:187]
v_mfma_f32_16x16x32_bf16 v[220:223], v[124:127], v[100:103], v[220:223]
v_mfma_f32_16x16x32_bf16 v[148:151], v[116:119], v[100:103], v[148:151]
v_mfma_f32_16x16x32_bf16 v[188:191], v[120:123], v[104:107], v[188:191]
v_mfma_f32_16x16x32_bf16 v[224:227], v[124:127], v[104:107], v[224:227]
v_mfma_f32_16x16x32_bf16 v[152:155], v[116:119], v[104:107], v[152:155]
v_mfma_f32_16x16x32_bf16 v[192:195], v[120:123], v[108:111], v[192:195]
v_mfma_f32_16x16x32_bf16 v[228:231], v[124:127], v[108:111], v[228:231]
v_mfma_f32_16x16x32_bf16 v[156:159], v[116:119], v[108:111], v[156:159]
v_mfma_f32_16x16x32_bf16 v[196:199], v[120:123], v[112:115], v[196:199]
v_mfma_f32_16x16x32_bf16 v[232:235], v[124:127], v[112:115], v[232:235]
v_mfma_f32_16x16x32_bf16 v[160:163], v[116:119], v[112:115], v[160:163]
s_sub_u32 s41, s41, 1
s_cmp_lg_u32 s41, 0
s_cbranch_scc1 Lcl_6
s_waitcnt lgkmcnt(0)
v_mfma_f32_16x16x32_bf16 v[164:167], v[72:75], v[32:35], v[164:167]
ds_read_b128 v[80:83], v3 offset:0
v_mfma_f32_16x16x32_bf16 v[200:203], v[76:79], v[32:35], v[200:203]
ds_read_b64_tr_b16 v[120:121], v6 offset:12288
v_mfma_f32_16x16x32_bf16 v[128:131], v[68:71], v[32:35], v[128:131]
ds_read_b64_tr_b16 v[122:123], v6 offset:12800
v_mfma_f32_16x16x32_bf16 v[168:171], v[72:75], v[36:39], v[168:171]
ds_read_b64_tr_b16 v[124:125], v6 offset:20480
v_mfma_f32_16x16x32_bf16 v[204:207], v[76:79], v[36:39], v[204:207]
ds_read_b64_tr_b16 v[126:127], v6 offset:20992
v_mfma_f32_16x16x32_bf16 v[132:135], v[68:71], v[36:39], v[132:135]
ds_read_b64_tr_b16 v[116:117], v6 offset:4096
v_mfma_f32_16x16x32_bf16 v[172:175], v[72:75], v[40:43], v[172:175]
ds_read_b64_tr_b16 v[118:119], v6 offset:4608
v_mfma_f32_16x16x32_bf16 v[208:211], v[76:79], v[40:43], v[208:211]
ds_read_b128 v[84:87], v3 offset:2048
v_mfma_f32_16x16x32_bf16 v[136:139], v[68:71], v[40:43], v[136:139]
ds_read_b128 v[88:91], v3 offset:4096
v_mfma_f32_16x16x32_bf16 v[176:179], v[72:75], v[44:47], v[176:179]
ds_read_b128 v[92:95], v3 offset:6144
v_mfma_f32_16x16x32_bf16 v[212:215], v[76:79], v[44:47], v[212:215]
ds_read_b128 v[96:99], v3 offset:8192
v_mfma_f32_16x16x32_bf16 v[140:143], v[68:71], v[44:47], v[140:143]
ds_read_b128 v[100:103], v3 offset:10240
v_mfma_f32_16x16x32_bf16 v[180:183], v[72:75], v[48:51], v[180:183]
ds_read_b128 v[104:107], v3 offset:12288
v_mfma_f32_16x16x32_bf16 v[216:219], v[76:79], v[48:51], v[216:219]
ds_read_b128 v[108:111], v3 offset:14336
v_mfma_f32_16x16x32_bf16 v[144:147], v[68:71], v[48:51], v[144:147]
ds_read_b128 v[112:115], v3 offset:16384
v_mfma_f32_16x16x32_bf16 v[184:187], v[72:75], v[52:55], v[184:187]
v_mfma_f32_16x16x32_bf16 v[220:223], v[76:79], v[52:55], v[220:223]
v_mfma_f32_16x16x32_bf16 v[148:151], v[68:71], v[52:55], v[148:151]
v_mfma_f32_16x16x32_bf16 v[188:191], v[72:75], v[56:59], v[188:191]
v_mfma_f32_16x16x32_bf16 v[224:227], v[76:79], v[56:59], v[224:227]
v_mfma_f32_16x16x32_bf16 v[152:155], v[68:71], v[56:59], v[152:155]
v_mfma_f32_16x16x32_bf16 v[192:195], v[72:75], v[60:63], v[192:195]
v_mfma_f32_16x16x32_bf16 v[228:231], v[76:79], v[60:63], v[228:231]
v_mfma_f32_16x16x32_bf16 v[156:159], v[68:71], v[60:63], v[156:159]
v_mfma_f32_16x16x32_bf16 v[196:199], v[72:75], v[64:67], v[196:199]
v_mfma_f32_16x16x32_bf16 v[232:235], v[76:79], v[64:67], v[232:235]
v_mfma_f32_16x16x32_bf16 v[160:163], v[68:71], v[64:67], v[160:163]
s_waitcnt lgkmcnt(0)
s_barrier
v_mfma_f32_16x16x32_bf16 v[164:167], v[120:123], v[80:83], v[164:167]
ds_read_b64 v[32:33], v9 offset:0
v_mfma_f32_16x16x32_bf16 v[200:203], v[124:127], v[80:83], v[200:203]
ds_read_b64 v[34:35], v9 offset:128
v_mfma_f32_16x16x32_bf16 v[128:131], v[116:119], v[80:83], v[128:131]
ds_read_b64 v[36:37], v9 offset:256
v_mfma_f32_16x16x32_bf16 v[168:171], v[120:123], v[84:87], v[168:171]
ds_read_b64 v[38:39], v9 offset:384
v_mfma_f32_16x16x32_bf16 v[204:207], v[124:127], v[84:87], v[204:207]
ds_read_b64 v[40:41], v9 offset:512
v_mfma_f32_16x16x32_bf16 v[132:135], v[116:119], v[84:87], v[132:135]
ds_read_b64 v[42:43], v9 offset:640
v_mfma_f32_16x16x32_bf16 v[172:175], v[120:123], v[88:91], v[172:175]
ds_read_b64 v[44:45], v9 offset:768
v_mfma_f32_16x16x32_bf16 v[208:211], v[124:127], v[88:91], v[208:211]
ds_read_b64 v[46:47], v9 offset:896
v_mfma_f32_16x16x32_bf16 v[136:139], v[116:119], v[88:91], v[136:139]
ds_read_b64 v[48:49], v9 offset:1024
v_mfma_f32_16x16x32_bf16 v[176:179], v[120:123], v[92:95], v[176:179]
v_mov_b32_dpp v52, v128 row_newbcast:0 row_mask:0xf bank_mask:0xf
v_mov_b32_dpp v53, v129 row_newbcast:0 row_mask:0xf bank_mask:0xf
v_mfma_f32_16x16x32_bf16 v[212:215], v[124:127], v[92:95], v[212:215]
v_mov_b32_dpp v54, v130 row_newbcast:0 row_mask:0xf bank_mask:0xf
v_mov_b32_dpp v55, v131 row_newbcast:0 row_mask:0xf bank_mask:0xf
v_mfma_f32_16x16x32_bf16 v[140:143], v[116:119], v[92:95], v[140:143]
v_mov_b32_dpp v56, v164 row_newbcast:0 row_mask:0xf bank_mask:0xf
v_mov_b32_dpp v57, v165 row_newbcast:0 row_mask:0xf bank_mask:0xf
v_mfma_f32_16x16x32_bf16 v[180:183], v[120:123], v[96:99], v[180:183]
v_mov_b32_dpp v58, v166 row_newbcast:0 row_mask:0xf bank_mask:0xf
v_mov_b32_dpp v59, v167 row_newbcast:0 row_mask:0xf bank_mask:0xf
v_mfma_f32_16x16x32_bf16 v[216:219], v[124:127], v[96:99], v[216:219]
v_mov_b32_dpp v60, v200 row_newbcast:0 row_mask:0xf bank_mask:0xf
v_mov_b32_dpp v61, v201 row_newbcast:0 row_mask:0xf bank_mask:0xf
v_mfma_f32_16x16x32_bf16 v[144:147], v[116:119], v[96:99], v[144:147]
v_mov_b32_dpp v62, v202 row_newbcast:0 row_mask:0xf bank_mask:0xf
v_mov_b32_dpp v63, v203 row_newbcast:0 row_mask:0xf bank_mask:0xf
v_mfma_f32_16x16x32_bf16 v[184:187], v[120:123], v[100:103], v[184:187]
s_waitcnt lgkmcnt(0)
v_fma_f32 v164, -v32, v56, v164
v_mfma_f32_16x16x32_bf16 v[220:223], v[124:127], v[100:103], v[220:223]
v_fma_f32 v165, -v32, v57, v165
v_fma_f32 v166, -v32, v58, v166
v_mfma_f32_16x16x32_bf16 v[148:151], v[116:119], v[100:103], v[148:151]
v_fma_f32 v167, -v32, v59, v167
v_mul_f32 v164, v33, v164
v_mfma_f32_16x16x32_bf16 v[188:191], v[120:123], v[104:107], v[188:191]
v_mul_f32 v165, v33, v165
v_mul_f32 v166, v33, v166
v_mfma_f32_16x16x32_bf16 v[224:227], v[124:127], v[104:107], v[224:227]
v_mul_f32 v167, v33, v167
v_cvt_pk_bf16_f32 v164, v164, v165
v_mfma_f32_16x16x32_bf16 v[152:155], v[116:119], v[104:107], v[152:155]
v_cvt_pk_bf16_f32 v165, v166, v167
ds_write_b64 v14, v[164:165] offset:128
v_mfma_f32_16x16x32_bf16 v[192:195], v[120:123], v[108:111], v[192:195]
v_fma_f32 v200, -v32, v60, v200
v_fma_f32 v201, -v32, v61, v201
v_mfma_f32_16x16x32_bf16 v[228:231], v[124:127], v[108:111], v[228:231]
v_fma_f32 v202, -v32, v62, v202
v_fma_f32 v203, -v32, v63, v203
v_mfma_f32_16x16x32_bf16 v[156:159], v[116:119], v[108:111], v[156:159]
v_mul_f32 v200, v33, v200
v_mul_f32 v201, v33, v201
v_mfma_f32_16x16x32_bf16 v[196:199], v[120:123], v[112:115], v[196:199]
v_mul_f32 v202, v33, v202
v_mul_f32 v203, v33, v203
v_mfma_f32_16x16x32_bf16 v[232:235], v[124:127], v[112:115], v[232:235]
v_cvt_pk_bf16_f32 v200, v200, v201
v_cvt_pk_bf16_f32 v201, v202, v203
v_mfma_f32_16x16x32_bf16 v[160:163], v[116:119], v[112:115], v[160:163]
ds_write_b64 v14, v[200:201] offset:256
v_fma_f32 v132, -v34, v52, v132
v_fma_f32 v133, -v34, v53, v133
v_fma_f32 v134, -v34, v54, v134
v_fma_f32 v135, -v34, v55, v135
v_mul_f32 v132, v35, v132
v_mul_f32 v133, v35, v133
v_mul_f32 v134, v35, v134
v_mul_f32 v135, v35, v135
v_cvt_pk_bf16_f32 v132, v132, v133
v_cvt_pk_bf16_f32 v133, v134, v135
ds_write_b64 v14, v[132:133] offset:6400
v_pk_fma_f32 v[168:169], v[34:35], v[56:57], v[168:169] op_sel_hi:[0,1,1] neg_lo:[1,0,0] neg_hi:[1,0,0]
v_pk_fma_f32 v[170:171], v[34:35], v[58:59], v[170:171] op_sel_hi:[0,1,1] neg_lo:[1,0,0] neg_hi:[1,0,0]
v_pk_mul_f32 v[168:169], v[34:35], v[168:169] op_sel:[1,0] op_sel_hi:[1,1]
v_pk_mul_f32 v[170:171], v[34:35], v[170:171] op_sel:[1,0] op_sel_hi:[1,1]
v_cvt_pk_bf16_f32 v168, v168, v169
v_cvt_pk_bf16_f32 v169, v170, v171
ds_write_b64 v14, v[168:169] offset:6528
v_pk_fma_f32 v[204:205], v[34:35], v[60:61], v[204:205] op_sel_hi:[0,1,1] neg_lo:[1,0,0] neg_hi:[1,0,0]
v_pk_fma_f32 v[206:207], v[34:35], v[62:63], v[206:207] op_sel_hi:[0,1,1] neg_lo:[1,0,0] neg_hi:[1,0,0]
v_pk_mul_f32 v[204:205], v[34:35], v[204:205] op_sel:[1,0] op_sel_hi:[1,1]
v_pk_mul_f32 v[206:207], v[34:35], v[206:207] op_sel:[1,0] op_sel_hi:[1,1]
v_cvt_pk_bf16_f32 v204, v204, v205
v_cvt_pk_bf16_f32 v205, v206, v207
ds_write_b64 v14, v[204:205] offset:6656
v_pk_fma_f32 v[136:137], v[36:37], v[52:53], v[136:137] op_sel_hi:[0,1,1] neg_lo:[1,0,0] neg_hi:[1,0,0]
v_pk_fma_f32 v[138:139], v[36:37], v[54:55], v[138:139] op_sel_hi:[0,1,1] neg_lo:[1,0,0] neg_hi:[1,0,0]
v_pk_mul_f32 v[136:137], v[36:37], v[136:137] op_sel:[1,0] op_sel_hi:[1,1]
v_pk_mul_f32 v[138:139], v[36:37], v[138:139] op_sel:[1,0] op_sel_hi:[1,1]
v_cvt_pk_bf16_f32 v136, v136, v137
v_cvt_pk_bf16_f32 v137, v138, v139
ds_write_b64 v14, v[136:137] offset:12800
v_pk_fma_f32 v[172:173], v[36:37], v[56:57], v[172:173] op_sel_hi:[0,1,1] neg_lo:[1,0,0] neg_hi:[1,0,0]
v_pk_fma_f32 v[174:175], v[36:37], v[58:59], v[174:175] op_sel_hi:[0,1,1] neg_lo:[1,0,0] neg_hi:[1,0,0]
v_pk_mul_f32 v[172:173], v[36:37], v[172:173] op_sel:[1,0] op_sel_hi:[1,1]
v_pk_mul_f32 v[174:175], v[36:37], v[174:175] op_sel:[1,0] op_sel_hi:[1,1]
v_cvt_pk_bf16_f32 v172, v172, v173
v_cvt_pk_bf16_f32 v173, v174, v175
ds_write_b64 v14, v[172:173] offset:12928
v_pk_fma_f32 v[208:209], v[36:37], v[60:61], v[208:209] op_sel_hi:[0,1,1] neg_lo:[1,0,0] neg_hi:[1,0,0]
v_pk_fma_f32 v[210:211], v[36:37], v[62:63], v[210:211] op_sel_hi:[0,1,1] neg_lo:[1,0,0] neg_hi:[1,0,0]
v_pk_mul_f32 v[208:209], v[36:37], v[208:209] op_sel:[1,0] op_sel_hi:[1,1]
v_pk_mul_f32 v[210:211], v[36:37], v[210:211] op_sel:[1,0] op_sel_hi:[1,1]
v_cvt_pk_bf16_f32 v208, v208, v209
v_cvt_pk_bf16_f32 v209, v210, v211
ds_write_b64 v14, v[208:209] offset:13056
v_pk_fma_f32 v[140:141], v[38:39], v[52:53], v[140:141] op_sel_hi:[0,1,1] neg_lo:[1,0,0] neg_hi:[1,0,0]
v_pk_fma_f32 v[142:143], v[38:39], v[54:55], v[142:143] op_sel_hi:[0,1,1] neg_lo:[1,0,0] neg_hi:[1,0,0]
v_pk_mul_f32 v[140:141], v[38:39], v[140:141] op_sel:[1,0] op_sel_hi:[1,1]
v_pk_mul_f32 v[142:143], v[38:39], v[142:143] op_sel:[1,0] op_sel_hi:[1,1]
v_cvt_pk_bf16_f32 v140, v140, v141
v_cvt_pk_bf16_f32 v141, v142, v143
ds_write_b64 v14, v[140:141] offset:19200
v_pk_fma_f32 v[176:177], v[38:39], v[56:57], v[176:177] op_sel_hi:[0,1,1] neg_lo:[1,0,0] neg_hi:[1,0,0]
v_pk_fma_f32 v[178:179], v[38:39], v[58:59], v[178:179] op_sel_hi:[0,1,1] neg_lo:[1,0,0] neg_hi:[1,0,0]
v_pk_mul_f32 v[176:177], v[38:39], v[176:177] op_sel:[1,0] op_sel_hi:[1,1]
v_pk_mul_f32 v[178:179], v[38:39], v[178:179] op_sel:[1,0] op_sel_hi:[1,1]
v_cvt_pk_bf16_f32 v176, v176, v177
v_cvt_pk_bf16_f32 v177, v178, v179
ds_write_b64 v14, v[176:177] offset:19328
v_pk_fma_f32 v[212:213], v[38:39], v[60:61], v[212:213] op_sel_hi:[0,1,1] neg_lo:[1,0,0] neg_hi:[1,0,0]
v_pk_fma_f32 v[214:215], v[38:39], v[62:63], v[214:215] op_sel_hi:[0,1,1] neg_lo:[1,0,0] neg_hi:[1,0,0]
v_pk_mul_f32 v[212:213], v[38:39], v[212:213] op_sel:[1,0] op_sel_hi:[1,1]
v_pk_mul_f32 v[214:215], v[38:39], v[214:215] op_sel:[1,0] op_sel_hi:[1,1]
v_cvt_pk_bf16_f32 v212, v212, v213
v_cvt_pk_bf16_f32 v213, v214, v215
ds_write_b64 v14, v[212:213] offset:19456
v_pk_fma_f32 v[144:145], v[40:41], v[52:53], v[144:145] op_sel_hi:[0,1,1] neg_lo:[1,0,0] neg_hi:[1,0,0]
v_pk_fma_f32 v[146:147], v[40:41], v[54:55], v[146:147] op_sel_hi:[0,1,1] neg_lo:[1,0,0] neg_hi:[1,0,0]
v_pk_mul_f32 v[144:145], v[40:41], v[144:145] op_sel:[1,0] op_sel_hi:[1,1]
v_pk_mul_f32 v[146:147], v[40:41], v[146:147] op_sel:[1,0] op_sel_hi:[1,1]
v_cvt_pk_bf16_f32 v144, v144, v145
v_cvt_pk_bf16_f32 v145, v146, v147
ds_write_b64 v14, v[144:145] offset:25600
v_pk_fma_f32 v[180:181], v[40:41], v[56:57], v[180:181] op_sel_hi:[0,1,1] neg_lo:[1,0,0] neg_hi:[1,0,0]
v_pk_fma_f32 v[182:183], v[40:41], v[58:59], v[182:183] op_sel_hi:[0,1,1] neg_lo:[1,0,0] neg_hi:[1,0,0]
v_pk_mul_f32 v[180:181], v[40:41], v[180:181] op_sel:[1,0] op_sel_hi:[1,1]
v_pk_mul_f32 v[182:183], v[40:41], v[182:183] op_sel:[1,0] op_sel_hi:[1,1]
v_cvt_pk_bf16_f32 v180, v180, v181
v_cvt_pk_bf16_f32 v181, v182, v183
ds_write_b64 v14, v[180:181] offset:25728
v_pk_fma_f32 v[216:217], v[40:41], v[60:61], v[216:217] op_sel_hi:[0,1,1] neg_lo:[1,0,0] neg_hi:[1,0,0]
v_pk_fma_f32 v[218:219], v[40:41], v[62:63], v[218:219] op_sel_hi:[0,1,1] neg_lo:[1,0,0] neg_hi:[1,0,0]
v_pk_mul_f32 v[216:217], v[40:41], v[216:217] op_sel:[1,0] op_sel_hi:[1,1]
v_pk_mul_f32 v[218:219], v[40:41], v[218:219] op_sel:[1,0] op_sel_hi:[1,1]
v_cvt_pk_bf16_f32 v216, v216, v217
v_cvt_pk_bf16_f32 v217, v218, v219
ds_write_b64 v14, v[216:217] offset:25856
v_pk_fma_f32 v[148:149], v[42:43], v[52:53], v[148:149] op_sel_hi:[0,1,1] neg_lo:[1,0,0] neg_hi:[1,0,0]
v_pk_fma_f32 v[150:151], v[42:43], v[54:55], v[150:151] op_sel_hi:[0,1,1] neg_lo:[1,0,0] neg_hi:[1,0,0]
v_pk_mul_f32 v[148:149], v[42:43], v[148:149] op_sel:[1,0] op_sel_hi:[1,1]
v_pk_mul_f32 v[150:151], v[42:43], v[150:151] op_sel:[1,0] op_sel_hi:[1,1]
v_cvt_pk_bf16_f32 v148, v148, v149
v_cvt_pk_bf16_f32 v149, v150, v151
ds_write_b64 v14, v[148:149] offset:32000
v_pk_fma_f32 v[184:185], v[42:43], v[56:57], v[184:185] op_sel_hi:[0,1,1] neg_lo:[1,0,0] neg_hi:[1,0,0]
v_pk_fma_f32 v[186:187], v[42:43], v[58:59], v[186:187] op_sel_hi:[0,1,1] neg_lo:[1,0,0] neg_hi:[1,0,0]
v_pk_mul_f32 v[184:185], v[42:43], v[184:185] op_sel:[1,0] op_sel_hi:[1,1]
v_pk_mul_f32 v[186:187], v[42:43], v[186:187] op_sel:[1,0] op_sel_hi:[1,1]
v_cvt_pk_bf16_f32 v184, v184, v185
v_cvt_pk_bf16_f32 v185, v186, v187
ds_write_b64 v14, v[184:185] offset:32128
v_pk_fma_f32 v[220:221], v[42:43], v[60:61], v[220:221] op_sel_hi:[0,1,1] neg_lo:[1,0,0] neg_hi:[1,0,0]
v_pk_fma_f32 v[222:223], v[42:43], v[62:63], v[222:223] op_sel_hi:[0,1,1] neg_lo:[1,0,0] neg_hi:[1,0,0]
v_pk_mul_f32 v[220:221], v[42:43], v[220:221] op_sel:[1,0] op_sel_hi:[1,1]
v_pk_mul_f32 v[222:223], v[42:43], v[222:223] op_sel:[1,0] op_sel_hi:[1,1]
v_cvt_pk_bf16_f32 v220, v220, v221
v_cvt_pk_bf16_f32 v221, v222, v223
ds_write_b64 v14, v[220:221] offset:32256
v_pk_fma_f32 v[152:153], v[44:45], v[52:53], v[152:153] op_sel_hi:[0,1,1] neg_lo:[1,0,0] neg_hi:[1,0,0]
v_pk_fma_f32 v[154:155], v[44:45], v[54:55], v[154:155] op_sel_hi:[0,1,1] neg_lo:[1,0,0] neg_hi:[1,0,0]
v_pk_mul_f32 v[152:153], v[44:45], v[152:153] op_sel:[1,0] op_sel_hi:[1,1]
v_pk_mul_f32 v[154:155], v[44:45], v[154:155] op_sel:[1,0] op_sel_hi:[1,1]
v_cvt_pk_bf16_f32 v152, v152, v153
v_cvt_pk_bf16_f32 v153, v154, v155
ds_write_b64 v14, v[152:153] offset:38400
v_pk_fma_f32 v[188:189], v[44:45], v[56:57], v[188:189] op_sel_hi:[0,1,1] neg_lo:[1,0,0] neg_hi:[1,0,0]
v_pk_fma_f32 v[190:191], v[44:45], v[58:59], v[190:191] op_sel_hi:[0,1,1] neg_lo:[1,0,0] neg_hi:[1,0,0]
v_pk_mul_f32 v[188:189], v[44:45], v[188:189] op_sel:[1,0] op_sel_hi:[1,1]
v_pk_mul_f32 v[190:191], v[44:45], v[190:191] op_sel:[1,0] op_sel_hi:[1,1]
v_cvt_pk_bf16_f32 v188, v188, v189
v_cvt_pk_bf16_f32 v189, v190, v191
ds_write_b64 v14, v[188:189] offset:38528
v_pk_fma_f32 v[224:225], v[44:45], v[60:61], v[224:225] op_sel_hi:[0,1,1] neg_lo:[1,0,0] neg_hi:[1,0,0]
v_pk_fma_f32 v[226:227], v[44:45], v[62:63], v[226:227] op_sel_hi:[0,1,1] neg_lo:[1,0,0] neg_hi:[1,0,0]
v_pk_mul_f32 v[224:225], v[44:45], v[224:225] op_sel:[1,0] op_sel_hi:[1,1]
v_pk_mul_f32 v[226:227], v[44:45], v[226:227] op_sel:[1,0] op_sel_hi:[1,1]
v_cvt_pk_bf16_f32 v224, v224, v225
v_cvt_pk_bf16_f32 v225, v226, v227
ds_write_b64 v14, v[224:225] offset:38656
v_pk_fma_f32 v[156:157], v[46:47], v[52:53], v[156:157] op_sel_hi:[0,1,1] neg_lo:[1,0,0] neg_hi:[1,0,0]
v_pk_fma_f32 v[158:159], v[46:47], v[54:55], v[158:159] op_sel_hi:[0,1,1] neg_lo:[1,0,0] neg_hi:[1,0,0]
v_pk_mul_f32 v[156:157], v[46:47], v[156:157] op_sel:[1,0] op_sel_hi:[1,1]
v_pk_mul_f32 v[158:159], v[46:47], v[158:159] op_sel:[1,0] op_sel_hi:[1,1]
v_cvt_pk_bf16_f32 v156, v156, v157
v_cvt_pk_bf16_f32 v157, v158, v159
ds_write_b64 v14, v[156:157] offset:44800
v_pk_fma_f32 v[192:193], v[46:47], v[56:57], v[192:193] op_sel_hi:[0,1,1] neg_lo:[1,0,0] neg_hi:[1,0,0]
v_pk_fma_f32 v[194:195], v[46:47], v[58:59], v[194:195] op_sel_hi:[0,1,1] neg_lo:[1,0,0] neg_hi:[1,0,0]
v_pk_mul_f32 v[192:193], v[46:47], v[192:193] op_sel:[1,0] op_sel_hi:[1,1]
v_pk_mul_f32 v[194:195], v[46:47], v[194:195] op_sel:[1,0] op_sel_hi:[1,1]
v_cvt_pk_bf16_f32 v192, v192, v193
v_cvt_pk_bf16_f32 v193, v194, v195
ds_write_b64 v14, v[192:193] offset:44928
v_pk_fma_f32 v[228:229], v[46:47], v[60:61], v[228:229] op_sel_hi:[0,1,1] neg_lo:[1,0,0] neg_hi:[1,0,0]
v_pk_fma_f32 v[230:231], v[46:47], v[62:63], v[230:231] op_sel_hi:[0,1,1] neg_lo:[1,0,0] neg_hi:[1,0,0]
v_pk_mul_f32 v[228:229], v[46:47], v[228:229] op_sel:[1,0] op_sel_hi:[1,1]
v_pk_mul_f32 v[230:231], v[46:47], v[230:231] op_sel:[1,0] op_sel_hi:[1,1]
v_cvt_pk_bf16_f32 v228, v228, v229
v_cvt_pk_bf16_f32 v229, v230, v231
ds_write_b64 v14, v[228:229] offset:45056
v_pk_fma_f32 v[160:161], v[48:49], v[52:53], v[160:161] op_sel_hi:[0,1,1] neg_lo:[1,0,0] neg_hi:[1,0,0]
v_pk_fma_f32 v[162:163], v[48:49], v[54:55], v[162:163] op_sel_hi:[0,1,1] neg_lo:[1,0,0] neg_hi:[1,0,0]
v_pk_mul_f32 v[160:161], v[48:49], v[160:161] op_sel:[1,0] op_sel_hi:[1,1]
v_pk_mul_f32 v[162:163], v[48:49], v[162:163] op_sel:[1,0] op_sel_hi:[1,1]
v_cvt_pk_bf16_f32 v160, v160, v161
v_cvt_pk_bf16_f32 v161, v162, v163
ds_write_b64 v14, v[160:161] offset:51200
v_pk_fma_f32 v[196:197], v[48:49], v[56:57], v[196:197] op_sel_hi:[0,1,1] neg_lo:[1,0,0] neg_hi:[1,0,0]
v_pk_fma_f32 v[198:199], v[48:49], v[58:59], v[198:199] op_sel_hi:[0,1,1] neg_lo:[1,0,0] neg_hi:[1,0,0]
v_pk_mul_f32 v[196:197], v[48:49], v[196:197] op_sel:[1,0] op_sel_hi:[1,1]
v_pk_mul_f32 v[198:199], v[48:49], v[198:199] op_sel:[1,0] op_sel_hi:[1,1]
v_cvt_pk_bf16_f32 v196, v196, v197
v_cvt_pk_bf16_f32 v197, v198, v199
ds_write_b64 v14, v[196:197] offset:51328
v_pk_fma_f32 v[232:233], v[48:49], v[60:61], v[232:233] op_sel_hi:[0,1,1] neg_lo:[1,0,0] neg_hi:[1,0,0]
v_pk_fma_f32 v[234:235], v[48:49], v[62:63], v[234:235] op_sel_hi:[0,1,1] neg_lo:[1,0,0] neg_hi:[1,0,0]
v_pk_mul_f32 v[232:233], v[48:49], v[232:233] op_sel:[1,0] op_sel_hi:[1,1]
v_pk_mul_f32 v[234:235], v[48:49], v[234:235] op_sel:[1,0] op_sel_hi:[1,1]
v_cvt_pk_bf16_f32 v232, v232, v233
v_cvt_pk_bf16_f32 v233, v234, v235
ds_write_b64 v14, v[232:233] offset:51456
s_lshl_b32 s43, s36, 5
v_lshl_add_u32 v15, v12, 1, s43
v_lshlrev_b32 v15, 11, v15
v_and_b32 v16, 1, v13
v_lshl_add_u32 v15, v16, 5, v15
v_lshrrev_b32 v16, 1, v13
v_lshl_add_u32 v15, v16, 4, v15
s_lshl_b32 s43, s34, 18
s_lshl_b32 s44, s35, 7
s_add_u32 s43, s43, s44
s_waitcnt lgkmcnt(0)
buffer_load_dwordx4 v[160:163], v15, s[8:11], s43 offen offset:0
buffer_load_dwordx4 v[164:167], v15, s[8:11], s43 offen offset:64
buffer_load_dwordx4 v[168:171], v15, s[8:11], s43 offen offset:2048
buffer_load_dwordx4 v[172:175], v15, s[8:11], s43 offen offset:2112
s_waitcnt lgkmcnt(0)
s_branch Latt_4
Lpf_3:
s_load_dwordx2 s[26:27], s[0:1], 64
s_or_b32 s43, s34, s35
s_cmp_lg_u32 s43, 0
s_cbranch_scc1 Lz_8
s_add_u32 s84, s32, 28311552
s_addc_u32 s85, s33, 0
s_mov_b32 s86, 32768
s_mov_b32 s87, 0x20000
v_lshlrev_b32 v14, 7, v1
v_mov_b32 v36, 0
v_mov_b32 v37, 0
s_mov_b32 s43, 0
buffer_store_dwordx2 v[36:37], v14, s[84:87], s43 offen sc1
s_mov_b32 s43, 8192
buffer_store_dwordx2 v[36:37], v14, s[84:87], s43 offen sc1
s_mov_b32 s43, 16384
buffer_store_dwordx2 v[36:37], v14, s[84:87], s43 offen sc1
s_mov_b32 s43, 24576
buffer_store_dwordx2 v[36:37], v14, s[84:87], s43 offen sc1
Lz_8:
s_lshl_b32 s43, s51, 11
buffer_load_dwordx4 v[96:99], v10, s[8:11], s43 offen offset:0
buffer_load_dwordx4 v[100:103], v10, s[8:11], s43 offen offset:1024
buffer_load_dwordx4 v[104:107], v10, s[8:11], s43 offen offset:2048
buffer_load_dwordx4 v[108:111], v10, s[8:11], s43 offen offset:3072
v_min_u32 v14, 23, v1
v_lshrrev_b32 v15, 3, v14
v_mul_u32_u24 v15, 43008, v15
v_and_b32 v14, 7, v14
v_lshl_add_u32 v15, v14, 4, v15
v_mov_b32 v32, 0x3f803f80
v_mov_b32 v33, 0x3f803f80
v_mov_b32 v34, 0x3f803f80
v_mov_b32 v35, 0x3f803f80
ds_write_b128 v15, v[32:35]
v_add_u32 v14, 0, v1
v_min_u32 v14, 47, v14
v_mul_u32_u24 v15, 21846, v14
v_lshrrev_b32 v15, 16, v15
v_mul_u32_u24 v16, 3, v15
v_sub_u32 v16, v14, v16
s_mul_i32 s43, s48, 16
v_add_u32 v15, s43, v15
v_mul_u32_u24 v15, 6144, v15
v_lshl_add_u32 v2, v16, 11, v15
s_waitcnt lgkmcnt(0)
s_mov_b32 s56, s26
s_mov_b32 s57, s27
s_mov_b32 s58, 256
s_mov_b32 s59, 0x20000
v_lshlrev_b32 v14, 7, v1
s_barrier
s_cmp_ge_u32 s2, 128
s_cbranch_scc1 Lm_10
s_mov_b32 s84, s6
s_mov_b32 s85, s7
s_mov_b32 s86, 6291456
s_mov_b32 s87, 0x20000
s_mul_i32 s43, s2, 24576
buffer_load_dword v31, v14, s[84:87], s43 offen
s_add_u32 s43, s43, 8192
buffer_load_dword v31, v14, s[84:87], s43 offen
s_add_u32 s43, s43, 8192
buffer_load_dword v31, v14, s[84:87], s43 offen
Lm_10:
s_mov_b32 s84, s6
s_mov_b32 s85, s7
s_mov_b32 s86, 6291456
s_mov_b32 s87, 0x20000
s_lshr_b32 s44, s2, 3
s_lshr_b32 s43, s2, 5
s_cmp_eq_u32 s43, 3
s_cbranch_scc1 Lsj_11
s_cmp_gt_u32 s43, 3
s_cselect_b32 s43, 32, 0
s_sub_u32 s43, s2, s43
s_lshr_b32 s43, s43, 1
s_and_b32 s44, s2, 1
s_lshl_b32 s44, s44, 3
s_add_u32 s44, s44, 32
s_load_dwordx2 s[80:81], s[0:1], s44
s_mul_i32 s45, s43, 2341
s_lshr_b32 s45, s45, 16
s_mul_i32 s46, s45, 28
s_sub_u32 s46, s43, s46
s_lshl_b32 s45, s45, 8
s_mul_i32 s44, s47, 18
s_add_u32 s45, s45, s44
s_add_u32 s45, s45, 184
s_mul_i32 s45, s45, 7168
s_lshl_b32 s46, s46, 8
s_add_u32 s45, s45, s46
s_waitcnt lgkmcnt(0)
s_add_u32 s80, s80, s45
s_addc_u32 s81, s81, 0
Lsj_11:
s_barrier
s_cmp_ge_u32 s2, 128
s_cbranch_scc0 Lm_12
s_mov_b32 s84, s6
s_mov_b32 s85, s7
s_mov_b32 s86, 6291456
s_mov_b32 s87, 0x20000
s_mul_i32 s43, s2, 24576
buffer_load_dword v31, v14, s[84:87], s43 offen
s_add_u32 s43, s43, 8192
buffer_load_dword v31, v14, s[84:87], s43 offen
s_add_u32 s43, s43, 8192
buffer_load_dword v31, v14, s[84:87], s43 offen
Lm_12:
s_barrier
s_getpc_b64 s[88:89]
Lpc_13:
s_sub_u32 s88, s88, Lpc_13-sequential_preLN__sliding_local_dilated__glu_gated_geglu__prompt_kernel
s_subb_u32 s89, s89, 0
s_lshr_b32 s43, s2, 3
s_mul_i32 s43, s43, 3840
v_min_u32 v15, 29, v1
v_lshl_add_u32 v15, v15, 7, s43
v_min_u32 v15, Ldone_1-sequential_preLN__sliding_local_dilated__glu_gated_geglu__prompt_kernel, v15
global_load_dword v31, v15, s[88:89]
s_or_b32 s43, s34, s35
s_cmp_lg_u32 s43, 0
s_cbranch_scc1 Lz_14
s_waitcnt vmcnt(0)
v_mov_b32 v5, 1
v_mov_b32 v6, 0
s_mov_b64 exec, 1
buffer_store_dword v5, v6, s[56:59], 0 offen sc1
s_mov_b64 exec, -1
Lz_14:
s_waitcnt vmcnt(1)
v_lshlrev_b32 v116, 16, v96
v_and_b32 v117, 0xffff0000, v96
v_mul_f32 v118, v116, v116
v_mul_f32 v119, v117, v117
v_lshlrev_b32 v126, 16, v97
v_and_b32 v127, 0xffff0000, v97
v_add_f32 v116, v116, v126
v_add_f32 v117, v117, v127
v_fmac_f32 v118, v126, v126
v_fmac_f32 v119, v127, v127
v_lshlrev_b32 v124, 16, v98
v_and_b32 v125, 0xffff0000, v98
v_add_f32 v116, v116, v124
v_add_f32 v117, v117, v125
v_fmac_f32 v118, v124, v124
v_fmac_f32 v119, v125, v125
v_lshlrev_b32 v126, 16, v99
v_and_b32 v127, 0xffff0000, v99
v_add_f32 v116, v116, v126
v_add_f32 v117, v117, v127
v_fmac_f32 v118, v126, v126
v_fmac_f32 v119, v127, v127
v_lshlrev_b32 v124, 16, v100
v_and_b32 v125, 0xffff0000, v100
v_add_f32 v116, v116, v124
v_add_f32 v117, v117, v125
v_fmac_f32 v118, v124, v124
v_fmac_f32 v119, v125, v125
v_lshlrev_b32 v126, 16, v101
v_and_b32 v127, 0xffff0000, v101
v_add_f32 v116, v116, v126
v_add_f32 v117, v117, v127
v_fmac_f32 v118, v126, v126
v_fmac_f32 v119, v127, v127
v_lshlrev_b32 v124, 16, v102
v_and_b32 v125, 0xffff0000, v102
v_add_f32 v116, v116, v124
v_add_f32 v117, v117, v125
v_fmac_f32 v118, v124, v124
v_fmac_f32 v119, v125, v125
v_lshlrev_b32 v126, 16, v103
v_and_b32 v127, 0xffff0000, v103
v_add_f32 v116, v116, v126
v_add_f32 v117, v117, v127
v_fmac_f32 v118, v126, v126
v_fmac_f32 v119, v127, v127
v_lshlrev_b32 v120, 16, v104
v_and_b32 v121, 0xffff0000, v104
v_mul_f32 v122, v120, v120
v_mul_f32 v123, v121, v121
s_barrier
v_lshlrev_b32 v126, 16, v105
v_and_b32 v127, 0xffff0000, v105
v_add_f32 v120, v120, v126
v_add_f32 v121, v121, v127
v_fmac_f32 v122, v126, v126
v_fmac_f32 v123, v127, v127
v_lshlrev_b32 v124, 16, v106
v_and_b32 v125, 0xffff0000, v106
v_add_f32 v120, v120, v124
v_add_f32 v121, v121, v125
v_fmac_f32 v122, v124, v124
v_fmac_f32 v123, v125, v125
v_lshlrev_b32 v126, 16, v107
v_and_b32 v127, 0xffff0000, v107
v_add_f32 v120, v120, v126
v_add_f32 v121, v121, v127
v_fmac_f32 v122, v126, v126
v_fmac_f32 v123, v127, v127
v_lshlrev_b32 v124, 16, v108
v_and_b32 v125, 0xffff0000, v108
v_add_f32 v120, v120, v124
v_add_f32 v121, v121, v125
v_fmac_f32 v122, v124, v124
v_fmac_f32 v123, v125, v125
v_lshlrev_b32 v126, 16, v109
v_and_b32 v127, 0xffff0000, v109
v_add_f32 v120, v120, v126
v_add_f32 v121, v121, v127
v_fmac_f32 v122, v126, v126
v_fmac_f32 v123, v127, v127
v_lshlrev_b32 v124, 16, v110
v_and_b32 v125, 0xffff0000, v110
v_add_f32 v120, v120, v124
v_add_f32 v121, v121, v125
v_fmac_f32 v122, v124, v124
v_fmac_f32 v123, v125, v125
v_lshlrev_b32 v126, 16, v111
v_and_b32 v127, 0xffff0000, v111
v_add_f32 v120, v120, v126
v_add_f32 v121, v121, v127
v_fmac_f32 v122, v126, v126
v_fmac_f32 v123, v127, v127
v_add_f32 v116, v116, v117
v_add_f32 v118, v118, v119
v_add_f32 v120, v120, v121
v_add_f32 v122, v122, v123
v_add_f32_dpp v116, v116, v116 row_ror:8 row_mask:0xf bank_mask:0xf
v_add_f32_dpp v118, v118, v118 row_ror:8 row_mask:0xf bank_mask:0xf
v_add_f32_dpp v120, v120, v120 row_ror:8 row_mask:0xf bank_mask:0xf
v_add_f32_dpp v122, v122, v122 row_ror:8 row_mask:0xf bank_mask:0xf
s_barrier
v_add_f32_dpp v116, v116, v116 row_ror:4 row_mask:0xf bank_mask:0xf
v_add_f32_dpp v118, v118, v118 row_ror:4 row_mask:0xf bank_mask:0xf
v_add_f32_dpp v120, v120, v120 row_ror:4 row_mask:0xf bank_mask:0xf
v_add_f32_dpp v122, v122, v122 row_ror:4 row_mask:0xf bank_mask:0xf
v_add_f32_dpp v116, v116, v116 row_ror:2 row_mask:0xf bank_mask:0xf
v_add_f32_dpp v118, v118, v118 row_ror:2 row_mask:0xf bank_mask:0xf
v_add_f32_dpp v120, v120, v120 row_ror:2 row_mask:0xf bank_mask:0xf
v_add_f32_dpp v122, v122, v122 row_ror:2 row_mask:0xf bank_mask:0xf
v_add_f32_dpp v116, v116, v116 row_ror:1 row_mask:0xf bank_mask:0xf
v_add_f32_dpp v118, v118, v118 row_ror:1 row_mask:0xf bank_mask:0xf
v_add_f32_dpp v120, v120, v120 row_ror:1 row_mask:0xf bank_mask:0xf
v_add_f32_dpp v122, v122, v122 row_ror:1 row_mask:0xf bank_mask:0xf
v_mov_b32 v117, v116
v_mov_b32 v119, v118
v_mov_b32 v121, v120
v_mov_b32 v123, v122
s_nop 0
v_permlane16_swap_b32 v116, v117
v_permlane16_swap_b32 v118, v119
v_permlane16_swap_b32 v120, v121
v_permlane16_swap_b32 v122, v123
v_add_f32 v116, v116, v117
v_add_f32 v118, v118, v119
v_add_f32 v120, v120, v121
v_add_f32 v122, v122, v123
v_mov_b32 v117, v116
v_mov_b32 v119, v118
v_mov_b32 v121, v120
v_mov_b32 v123, v122
s_nop 0
v_permlane32_swap_b32 v116, v117
v_permlane32_swap_b32 v118, v119
v_permlane32_swap_b32 v120, v121
v_permlane32_swap_b32 v122, v123
v_add_f32 v116, v116, v117
v_add_f32 v118, v118, v119
v_add_f32 v120, v120, v121
v_add_f32 v122, v122, v123
v_mul_f32 v112, 0x3a800000, v116
v_mul_f32 v113, 0x3a800000, v118
v_fma_f32 v113, -v112, v112, v113
v_max_f32 v113, 0, v113
v_add_f32 v113, 0x3727c5ac, v113
v_rsq_f32 v113, v113
v_mul_f32 v114, 0x3a800000, v120
v_mul_f32 v115, 0x3a800000, v122
v_fma_f32 v115, -v114, v114, v115
v_max_f32 v115, 0, v115
v_add_f32 v115, 0x3727c5ac, v115
v_rsq_f32 v115, v115
s_nop 0
s_lshl_b32 s43, s47, 4
s_add_u32 s43, s43, 130176
v_mov_b32 v11, s43
ds_write_b128 v11, v[112:115]
s_waitcnt lgkmcnt(0)
s_barrier
v_lshlrev_b32 v5, 4, v1
v_and_b32 v5, 63, v5
v_add_u32 v6, 130176, v5
ds_read_b128 v[112:115], v6
s_lshl_b32 s43, s63, 3
v_add_u32 v5, s43, v5
s_waitcnt lgkmcnt(0)
s_mov_b64 exec, 15
buffer_store_dwordx4 v[112:115], v5, s[20:23], 0 offen sc1
s_mov_b64 exec, -1
v_mov_b32 v7, 0
v_mov_b32 v9, 1
buffer_load_dword v8, v7, s[56:59], 0 offen sc1
s_load_dword s64, s[80:81], 0
s_load_dword s65, s[80:81], 64
s_load_dword s66, s[80:81], 128
s_load_dword s67, s[80:81], 192
s_load_dword s68, s[80:81], 7168
s_load_dword s69, s[80:81], 7232
s_load_dword s70, s[80:81], 7296
s_load_dword s71, s[80:81], 7360
s_add_u32 s80, s80, 14336
s_addc_u32 s81, s81, 0
s_barrier
s_load_dword s64, s[80:81], 0
s_load_dword s65, s[80:81], 64
s_load_dword s66, s[80:81], 128
s_load_dword s67, s[80:81], 192
s_load_dword s68, s[80:81], 7168
s_load_dword s69, s[80:81], 7232
s_load_dword s70, s[80:81], 7296
s_load_dword s71, s[80:81], 7360
s_add_u32 s80, s80, 14336
s_addc_u32 s81, s81, 0
s_barrier
s_mov_b32 s41, 0x10000
Lpoll_15:
s_waitcnt vmcnt(0)
Lpf_17:
v_cmp_ne_u32 vcc, v9, v8
s_nop 4
s_cbranch_vccz Lpok_16
buffer_load_dword v8, v7, s[56:59], 0 offen sc1
s_sub_u32 s41, s41, 1
s_cmp_lg_u32 s41, 0
s_cbranch_scc1 Lpoll_15
s_waitcnt vmcnt(0)
Lpok_16:
s_add_u32 s56, s32, 28311552
s_addc_u32 s57, s33, 0
s_mov_b32 s58, 32768
s_mov_b32 s59, 0x20000
s_add_u32 s43, s34, 80
s_lshl_b32 s43, s43, 7
v_mov_b32 v5, s43
v_mov_b32 v6, 1
s_mov_b64 exec, 1
buffer_atomic_add v6, v5, s[56:59], 0 offen sc1
s_mov_b64 exec, -1
s_load_dword s64, s[80:81], 0
s_load_dword s65, s[80:81], 64
s_load_dword s66, s[80:81], 128
s_load_dword s67, s[80:81], 192
s_load_dword s68, s[80:81], 7168
s_load_dword s69, s[80:81], 7232
s_load_dword s70, s[80:81], 7296
s_load_dword s71, s[80:81], 7360
s_add_u32 s80, s80, 14336
s_addc_u32 s81, s81, 0
s_barrier
s_load_dword s64, s[80:81], 0
s_load_dword s65, s[80:81], 64
s_load_dword s66, s[80:81], 128
s_load_dword s67, s[80:81], 192
s_load_dword s68, s[80:81], 7168
s_load_dword s69, s[80:81], 7232
s_load_dword s70, s[80:81], 7296
s_load_dword s71, s[80:81], 7360
s_add_u32 s80, s80, 14336
s_addc_u32 s81, s81, 0
s_barrier
s_load_dword s64, s[80:81], 0
s_load_dword s65, s[80:81], 64
s_load_dword s66, s[80:81], 128
s_load_dword s67, s[80:81], 192
s_load_dword s68, s[80:81], 7168
s_load_dword s69, s[80:81], 7232
s_load_dword s70, s[80:81], 7296
s_load_dword s71, s[80:81], 7360
s_add_u32 s80, s80, 14336
s_addc_u32 s81, s81, 0
s_barrier
s_getpc_b64 s[88:89]
Lpc_18:
s_sub_u32 s88, s88, Lpc_18-sequential_preLN__sliding_local_dilated__glu_gated_geglu__prompt_kernel
s_subb_u32 s89, s89, 0
s_lshr_b32 s43, s2, 3
s_mul_i32 s43, s43, 3840
v_min_u32 v15, 29, v1
v_lshl_add_u32 v15, v15, 7, s43
v_min_u32 v15, Ldone_1-sequential_preLN__sliding_local_dilated__glu_gated_geglu__prompt_kernel, v15
global_load_dword v31, v15, s[88:89]
s_sub_u32 s44, s34, 1
s_max_i32 s44, s44, 0
v_mov_b32 v5, s44
v_mov_b32 v6, s34
v_cmp_eq_u32 vcc, 0, v1
s_nop 1
v_cndmask_b32 v5, v5, v6, vcc
v_add_u32 v5, 80, v5
v_lshlrev_b32 v5, 7, v5
buffer_load_dword v6, v5, s[56:59], 0 offen sc1
s_load_dword s64, s[80:81], 0
s_load_dword s65, s[80:81], 64
s_load_dword s66, s[80:81], 128
s_load_dword s67, s[80:81], 192
s_load_dword s68, s[80:81], 7168
s_load_dword s69, s[80:81], 7232
s_load_dword s70, s[80:81], 7296
s_load_dword s71, s[80:81], 7360
s_add_u32 s80, s80, 14336
s_addc_u32 s81, s81, 0
s_barrier
s_load_dword s64, s[80:81], 0
s_load_dword s65, s[80:81], 64
s_load_dword s66, s[80:81], 128
s_load_dword s67, s[80:81], 192
s_load_dword s68, s[80:81], 7168
s_load_dword s69, s[80:81], 7232
s_load_dword s70, s[80:81], 7296
s_load_dword s71, s[80:81], 7360
s_add_u32 s80, s80, 14336
s_addc_u32 s81, s81, 0
s_barrier
s_mov_b32 s41, 200
s_mov_b32 s62, 0
s_waitcnt vmcnt(0)
Lpoll_19:
v_cmp_ne_u32 vcc, 16, v6
s_nop 4
s_cbranch_vccz Lok_20
buffer_load_dword v6, v5, s[56:59], 0 offen sc1
s_waitcnt vmcnt(0)
s_sub_u32 s41, s41, 1
s_cmp_lg_u32 s41, 0
s_cbranch_scc1 Lpoll_19
s_mov_b32 s41, 0
Lfb_21:
s_add_u32 s62, s50, s41
s_max_i32 s62, s62, 0
s_lshl_b32 s43, s62, 11
buffer_load_dwordx4 v[96:99], v10, s[8:11], s43 offen offset:0
buffer_load_dwordx4 v[100:103], v10, s[8:11], s43 offen offset:1024
buffer_load_dwordx4 v[104:107], v10, s[8:11], s43 offen offset:2048
buffer_load_dwordx4 v[108:111], v10, s[8:11], s43 offen offset:3072
s_waitcnt vmcnt(0)
v_lshlrev_b32 v116, 16, v96
v_and_b32 v117, 0xffff0000, v96
v_mul_f32 v118, v116, v116
v_mul_f32 v119, v117, v117
v_lshlrev_b32 v126, 16, v97
v_and_b32 v127, 0xffff0000, v97
v_add_f32 v116, v116, v126
v_add_f32 v117, v117, v127
v_fmac_f32 v118, v126, v126
v_fmac_f32 v119, v127, v127
v_lshlrev_b32 v124, 16, v98
v_and_b32 v125, 0xffff0000, v98
v_add_f32 v116, v116, v124
v_add_f32 v117, v117, v125
v_fmac_f32 v118, v124, v124
v_fmac_f32 v119, v125, v125
v_lshlrev_b32 v126, 16, v99
v_and_b32 v127, 0xffff0000, v99
v_add_f32 v116, v116, v126
v_add_f32 v117, v117, v127
v_fmac_f32 v118, v126, v126
v_fmac_f32 v119, v127, v127
v_lshlrev_b32 v124, 16, v100
v_and_b32 v125, 0xffff0000, v100
v_add_f32 v116, v116, v124
v_add_f32 v117, v117, v125
v_fmac_f32 v118, v124, v124
v_fmac_f32 v119, v125, v125
v_lshlrev_b32 v126, 16, v101
v_and_b32 v127, 0xffff0000, v101
v_add_f32 v116, v116, v126
v_add_f32 v117, v117, v127
v_fmac_f32 v118, v126, v126
v_fmac_f32 v119, v127, v127
v_lshlrev_b32 v124, 16, v102
v_and_b32 v125, 0xffff0000, v102
v_add_f32 v116, v116, v124
v_add_f32 v117, v117, v125
v_fmac_f32 v118, v124, v124
v_fmac_f32 v119, v125, v125
v_lshlrev_b32 v126, 16, v103
v_and_b32 v127, 0xffff0000, v103
v_add_f32 v116, v116, v126
v_add_f32 v117, v117, v127
v_fmac_f32 v118, v126, v126
v_fmac_f32 v119, v127, v127
v_lshlrev_b32 v120, 16, v104
v_and_b32 v121, 0xffff0000, v104
v_mul_f32 v122, v120, v120
v_mul_f32 v123, v121, v121
v_lshlrev_b32 v126, 16, v105
v_and_b32 v127, 0xffff0000, v105
v_add_f32 v120, v120, v126
v_add_f32 v121, v121, v127
v_fmac_f32 v122, v126, v126
v_fmac_f32 v123, v127, v127
v_lshlrev_b32 v124, 16, v106
v_and_b32 v125, 0xffff0000, v106
v_add_f32 v120, v120, v124
v_add_f32 v121, v121, v125
v_fmac_f32 v122, v124, v124
v_fmac_f32 v123, v125, v125
v_lshlrev_b32 v126, 16, v107
v_and_b32 v127, 0xffff0000, v107
v_add_f32 v120, v120, v126
v_add_f32 v121, v121, v127
v_fmac_f32 v122, v126, v126
v_fmac_f32 v123, v127, v127
v_lshlrev_b32 v124, 16, v108
v_and_b32 v125, 0xffff0000, v108
v_add_f32 v120, v120, v124
v_add_f32 v121, v121, v125
v_fmac_f32 v122, v124, v124
v_fmac_f32 v123, v125, v125
v_lshlrev_b32 v126, 16, v109
v_and_b32 v127, 0xffff0000, v109
v_add_f32 v120, v120, v126
v_add_f32 v121, v121, v127
v_fmac_f32 v122, v126, v126
v_fmac_f32 v123, v127, v127
v_lshlrev_b32 v124, 16, v110
v_and_b32 v125, 0xffff0000, v110
v_add_f32 v120, v120, v124
v_add_f32 v121, v121, v125
v_fmac_f32 v122, v124, v124
v_fmac_f32 v123, v125, v125
v_lshlrev_b32 v126, 16, v111
v_and_b32 v127, 0xffff0000, v111
v_add_f32 v120, v120, v126
v_add_f32 v121, v121, v127
v_fmac_f32 v122, v126, v126
v_fmac_f32 v123, v127, v127
v_add_f32 v116, v116, v117
v_add_f32 v118, v118, v119
v_add_f32 v120, v120, v121
v_add_f32 v122, v122, v123
v_add_f32_dpp v116, v116, v116 row_ror:8 row_mask:0xf bank_mask:0xf
v_add_f32_dpp v118, v118, v118 row_ror:8 row_mask:0xf bank_mask:0xf
v_add_f32_dpp v120, v120, v120 row_ror:8 row_mask:0xf bank_mask:0xf
v_add_f32_dpp v122, v122, v122 row_ror:8 row_mask:0xf bank_mask:0xf
v_add_f32_dpp v116, v116, v116 row_ror:4 row_mask:0xf bank_mask:0xf
v_add_f32_dpp v118, v118, v118 row_ror:4 row_mask:0xf bank_mask:0xf
v_add_f32_dpp v120, v120, v120 row_ror:4 row_mask:0xf bank_mask:0xf
v_add_f32_dpp v122, v122, v122 row_ror:4 row_mask:0xf bank_mask:0xf
v_add_f32_dpp v116, v116, v116 row_ror:2 row_mask:0xf bank_mask:0xf
v_add_f32_dpp v118, v118, v118 row_ror:2 row_mask:0xf bank_mask:0xf
v_add_f32_dpp v120, v120, v120 row_ror:2 row_mask:0xf bank_mask:0xf
v_add_f32_dpp v122, v122, v122 row_ror:2 row_mask:0xf bank_mask:0xf
v_add_f32_dpp v116, v116, v116 row_ror:1 row_mask:0xf bank_mask:0xf
v_add_f32_dpp v118, v118, v118 row_ror:1 row_mask:0xf bank_mask:0xf
v_add_f32_dpp v120, v120, v120 row_ror:1 row_mask:0xf bank_mask:0xf
v_add_f32_dpp v122, v122, v122 row_ror:1 row_mask:0xf bank_mask:0xf
v_mov_b32 v117, v116
v_mov_b32 v119, v118
v_mov_b32 v121, v120
v_mov_b32 v123, v122
s_nop 0
v_permlane16_swap_b32 v116, v117
v_permlane16_swap_b32 v118, v119
v_permlane16_swap_b32 v120, v121
v_permlane16_swap_b32 v122, v123
v_add_f32 v116, v116, v117
v_add_f32 v118, v118, v119
v_add_f32 v120, v120, v121
v_add_f32 v122, v122, v123
v_mov_b32 v117, v116
v_mov_b32 v119, v118
v_mov_b32 v121, v120
v_mov_b32 v123, v122
s_nop 0
v_permlane32_swap_b32 v116, v117
v_permlane32_swap_b32 v118, v119
v_permlane32_swap_b32 v120, v121
v_permlane32_swap_b32 v122, v123
v_add_f32 v116, v116, v117
v_add_f32 v118, v118, v119
v_add_f32 v120, v120, v121
v_add_f32 v122, v122, v123
v_mul_f32 v112, 0x3a800000, v116
v_mul_f32 v113, 0x3a800000, v118
v_fma_f32 v113, -v112, v112, v113
v_max_f32 v113, 0, v113
v_add_f32 v113, 0x3727c5ac, v113
v_rsq_f32 v113, v113
v_mul_f32 v114, 0x3a800000, v120
v_mul_f32 v115, 0x3a800000, v122
v_fma_f32 v115, -v114, v114, v115
v_max_f32 v115, 0, v115
v_add_f32 v115, 0x3727c5ac, v115
v_rsq_f32 v115, v115
s_nop 0
s_lshl_b32 s43, s41, 3
s_add_u32 s43, s43, 129024
v_mov_b32 v5, s43
ds_write_b128 v5, v[112:115]
s_add_u32 s41, s41, 2
s_cmp_lt_u32 s41, 144
s_cbranch_scc1 Lfb_21
s_mov_b32 s62, 1
Lok_20:
v_add_u32 v5, 0, v1
v_min_u32 v5, 143, v5
v_lshlrev_b32 v20, 3, v5
v_add_u32 v5, s50, v5
v_max_i32 v5, 0, v5
v_lshlrev_b32 v5, 3, v5
buffer_load_dwordx2 v[32:33], v5, s[20:23], 0 offen sc1
v_add_u32 v5, 64, v1
v_min_u32 v5, 143, v5
v_lshlrev_b32 v21, 3, v5
v_add_u32 v5, s50, v5
v_max_i32 v5, 0, v5
v_lshlrev_b32 v5, 3, v5
buffer_load_dwordx2 v[34:35], v5, s[20:23], 0 offen sc1
v_add_u32 v5, 128, v1
v_min_u32 v5, 143, v5
v_lshlrev_b32 v22, 3, v5
v_add_u32 v5, s50, v5
v_max_i32 v5, 0, v5
v_lshlrev_b32 v5, 3, v5
buffer_load_dwordx2 v[36:37], v5, s[20:23], 0 offen sc1
s_load_dword s64, s[80:81], 0
s_load_dword s65, s[80:81], 64
s_load_dword s66, s[80:81], 128
s_load_dword s67, s[80:81], 192
s_load_dword s68, s[80:81], 7168
s_load_dword s69, s[80:81], 7232
s_load_dword s70, s[80:81], 7296
s_load_dword s71, s[80:81], 7360
s_add_u32 s80, s80, 14336
s_addc_u32 s81, s81, 0
s_barrier
s_load_dwordx2 s[88:89], s[0:1], 16
v_lshlrev_b32 v29, 7, v1
s_lshl_b32 s43, s2, 13
s_waitcnt lgkmcnt(0)
s_mov_b32 s84, s88
s_mov_b32 s85, s89
s_mov_b32 s86, 2097152
s_mov_b32 s87, 0x20000
buffer_load_dword v30, v29, s[84:87], s43 offen
v_and_b32 v29, 31, v1
v_lshlrev_b32 v29, 11, v29
s_and_b32 s43, s35, 8
s_or_b32 s43, s43, 3
s_lshl_b32 s43, s43, 7
s_lshr_b32 s44, s2, 3
s_lshl_b32 s44, s44, 16
s_add_u32 s43, s43, s44
buffer_load_dword v30, v29, s[84:87], s43 offen
s_barrier
s_waitcnt vmcnt(2)
s_cmp_eq_u32 s62, 1
s_cbranch_scc1 Lgd_9
v_add_u32 v20, 129024, v20
ds_write_b64 v20, v[32:33]
v_add_u32 v21, 129024, v21
ds_write_b64 v21, v[34:35]
v_add_u32 v22, 129024, v22
ds_write_b64 v22, v[36:37]
Lgd_9:
s_waitcnt lgkmcnt(0)
s_lshr_b32 s43, s2, 5
s_cmp_eq_u32 s43, 3
s_cbranch_scc1 Lnj_22
s_cmp_gt_u32 s43, 3
s_cselect_b32 s43, 32, 0
s_sub_u32 s43, s2, s43
s_lshr_b32 s43, s43, 1
s_and_b32 s44, s2, 1
s_lshl_b32 s45, s44, 3
s_add_u32 s45, s45, 32
s_load_dwordx2 s[88:89], s[0:1], s45
s_mul_i32 s45, s43, 2341
s_lshr_b32 s45, s45, 16
s_mul_i32 s46, s45, 28
s_sub_u32 s46, s43, s46
v_lshrrev_b32 v28, 4, v1
s_lshl_b32 s43, s45, 8
v_add_u32 v28, s43, v28
v_mul_u32_u24 v28, 7168, v28
v_and_b32 v29, 15, v1
v_lshl_add_u32 v28, v29, 4, v28
s_lshl_b32 s43, s46, 8
v_add_u32 v28, s43, v28
s_waitcnt lgkmcnt(0)
s_mov_b32 s84, s88
s_mov_b32 s85, s89
s_mov_b32 s86, 7340032
s_mov_b32 s87, 0x20000
s_mov_b32 s43, 0
buffer_load_dwordx4 v[128:131], v28, s[84:87], s43 offen
s_mov_b32 s43, 28672
buffer_load_dwordx4 v[132:135], v28, s[84:87], s43 offen
s_mov_b32 s43, 57344
buffer_load_dwordx4 v[136:139], v28, s[84:87], s43 offen
s_mov_b32 s43, 86016
buffer_load_dwordx4 v[140:143], v28, s[84:87], s43 offen
s_mov_b32 s43, 114688
buffer_load_dwordx4 v[144:147], v28, s[84:87], s43 offen
s_mov_b32 s43, 143360
buffer_load_dwordx4 v[148:151], v28, s[84:87], s43 offen
s_mov_b32 s43, 172032
buffer_load_dwordx4 v[152:155], v28, s[84:87], s43 offen
s_mov_b32 s43, 200704
buffer_load_dwordx4 v[156:159], v28, s[84:87], s43 offen
s_mov_b32 s43, 229376
buffer_load_dwordx4 v[160:163], v28, s[84:87], s43 offen
s_mov_b32 s43, 258048
buffer_load_dwordx4 v[164:167], v28, s[84:87], s43 offen
s_mov_b32 s43, 286720
buffer_load_dwordx4 v[168:171], v28, s[84:87], s43 offen
s_mov_b32 s43, 315392
buffer_load_dwordx4 v[172:175], v28, s[84:87], s43 offen
s_mov_b32 s43, 344064
buffer_load_dwordx4 v[176:179], v28, s[84:87], s43 offen
s_mov_b32 s43, 372736
buffer_load_dwordx4 v[180:183], v28, s[84:87], s43 offen
s_mov_b32 s43, 401408
buffer_load_dwordx4 v[184:187], v28, s[84:87], s43 offen
s_mov_b32 s43, 430080
buffer_load_dwordx4 v[188:191], v28, s[84:87], s43 offen
Lnj_22:
s_barrier
s_lshr_b32 s43, s2, 5
s_cmp_eq_u32 s43, 3
s_cbranch_scc1 Lnj_23
s_cmp_gt_u32 s43, 3
s_cselect_b32 s43, 32, 0
s_sub_u32 s43, s2, s43
s_lshr_b32 s43, s43, 1
s_and_b32 s44, s2, 1
s_lshl_b32 s45, s44, 3
s_add_u32 s45, s45, 32
s_load_dwordx2 s[88:89], s[0:1], s45
s_mul_i32 s45, s43, 2341
s_lshr_b32 s45, s45, 16
s_mul_i32 s46, s45, 28
s_sub_u32 s46, s43, s46
v_lshrrev_b32 v28, 4, v1
s_lshl_b32 s43, s45, 8
v_add_u32 v28, s43, v28
v_mul_u32_u24 v28, 7168, v28
v_and_b32 v29, 15, v1
v_lshl_add_u32 v28, v29, 4, v28
s_lshl_b32 s43, s46, 8
v_add_u32 v28, s43, v28
s_waitcnt lgkmcnt(0)
s_mov_b32 s84, s88
s_mov_b32 s85, s89
s_mov_b32 s86, 7340032
s_mov_b32 s87, 0x20000
s_mov_b32 s43, 458752
buffer_load_dwordx4 v[192:195], v28, s[84:87], s43 offen
s_mov_b32 s43, 487424
buffer_load_dwordx4 v[196:199], v28, s[84:87], s43 offen
s_mov_b32 s43, 516096
buffer_load_dwordx4 v[200:203], v28, s[84:87], s43 offen
s_mov_b32 s43, 544768
buffer_load_dwordx4 v[204:207], v28, s[84:87], s43 offen
s_mov_b32 s43, 573440
buffer_load_dwordx4 v[208:211], v28, s[84:87], s43 offen
s_mov_b32 s43, 602112
buffer_load_dwordx4 v[212:215], v28, s[84:87], s43 offen
s_mov_b32 s43, 630784
buffer_load_dwordx4 v[216:219], v28, s[84:87], s43 offen
s_mov_b32 s43, 659456
buffer_load_dwordx4 v[220:223], v28, s[84:87], s43 offen
s_mov_b32 s43, 688128
buffer_load_dwordx4 v[224:227], v28, s[84:87], s43 offen
s_mov_b32 s43, 716800
buffer_load_dwordx4 v[228:231], v28, s[84:87], s43 offen
s_mov_b32 s43, 745472
buffer_load_dwordx4 v[232:235], v28, s[84:87], s43 offen
s_mov_b32 s43, 774144
buffer_load_dwordx4 v[236:239], v28, s[84:87], s43 offen
s_mov_b32 s43, 802816
buffer_load_dwordx4 v[240:243], v28, s[84:87], s43 offen
s_mov_b32 s43, 831488
buffer_load_dwordx4 v[244:247], v28, s[84:87], s43 offen
s_mov_b32 s43, 860160
buffer_load_dwordx4 v[248:251], v28, s[84:87], s43 offen
s_mov_b32 s43, 888832
buffer_load_dwordx4 v[252:255], v28, s[84:87], s43 offen
Lnj_23:
s_barrier
s_waitcnt lgkmcnt(0)
s_and_b32 s43, s36, 1
s_lshr_b32 s44, s36, 1
s_and_b32 s44, s44, 1
s_lshr_b32 s45, s36, 2
v_lshlrev_b32 v14, 2, v13
v_sub_u32 v14, v12, v14
v_subrev_u32 v15, 0, v14
v_cmp_ge_u32 s[52:53], 7, v15
v_add_u32 v15, 16, v15
v_cmp_ge_u32 s[84:85], 7, v15
v_subrev_u32 v15, 1, v14
v_cmp_ge_u32 s[54:55], 7, v15
v_add_u32 v15, 16, v15
v_cmp_ge_u32 s[86:87], 7, v15
v_subrev_u32 v15, 2, v14
v_cmp_ge_u32 s[56:57], 7, v15
v_add_u32 v15, 16, v15
v_cmp_ge_u32 s[88:89], 7, v15
v_subrev_u32 v15, 3, v14
v_cmp_ge_u32 s[58:59], 7, v15
v_add_u32 v15, 16, v15
v_cmp_ge_u32 s[90:91], 7, v15
s_lshl_b32 s46, s45, 6
s_add_u32 s46, s46, s44
s_add_u32 s46, s46, 16
v_lshl_add_u32 v14, v12, 1, s46
s_lshl_b32 s47, s43, 6
v_lshl_add_u32 v15, v13, 4, s47
v_mul_u32_u24 v20, 400, v14
v_add_u32 v20, v20, v15
v_subrev_u32 v16, 32, v14
v_max_i32 v16, 0, v16
v_mul_u32_u24 v21, 400, v16
v_add_u32 v21, v21, v15
v_lshrrev_b32 v16, 2, v12
v_lshl_add_u32 v16, v13, 2, v16
v_lshl_add_u32 v16, v16, 1, s46
v_and_b32 v17, 3, v1
v_lshl_add_u32 v17, v17, 3, s47
v_mul_u32_u24 v22, 400, v16
v_add_u32 v22, v22, v17
v_subrev_u32 v16, 32, v16
v_max_i32 v16, 0, v16
v_mul_u32_u24 v23, 400, v16
v_add_u32 v23, v23, v17
s_lshl_b32 s60, s43, 13
s_lshl_b32 s61, s45, 10
s_add_u32 s60, s60, s61
s_lshl_b32 s61, s44, 8
s_add_u32 s60, s60, s61
v_lshlrev_b32 v27, 11, v13
v_lshl_add_u32 v27, v12, 4, v27
v_add_u32 v27, s60, v27
v_mov_b32 v28, 0xff800000
s_mov_b32 s61, 0x3e8293ee
s_nop 2
s_or_b32 s62, s34, s45
s_cmp_lg_u32 s62, 0
s_cselect_b64 s[64:65], s[84:85], 0
s_cselect_b64 s[66:67], s[86:87], 0
s_cselect_b64 s[68:69], s[88:89], 0
s_cselect_b64 s[70:71], s[90:91], 0
Latt_4:
s_barrier
ds_read_b128 v[32:35], v20 offset:0
ds_read_b128 v[36:39], v20 offset:128
ds_read_b128 v[40:43], v21 offset:128
ds_read_b128 v[80:83], v20 offset:12800
ds_read_b128 v[84:87], v20 offset:12928
ds_read_b128 v[88:91], v20 offset:128
ds_read_b64_tr_b16 v[44:45], v23 offset:256
ds_read_b64_tr_b16 v[46:47], v22 offset:256
ds_read_b64_tr_b16 v[48:49], v23 offset:288
ds_read_b64_tr_b16 v[50:51], v22 offset:288
ds_read_b64_tr_b16 v[92:93], v22 offset:256
ds_read_b64_tr_b16 v[94:95], v22 offset:13056
ds_read_b64_tr_b16 v[96:97], v22 offset:288
ds_read_b64_tr_b16 v[98:99], v22 offset:13088
s_waitcnt lgkmcnt(11)
v_mfma_f32_16x16x32_bf16 v[52:55], v[40:43], v[32:35], 0
v_mfma_f32_16x16x32_bf16 v[56:59], v[36:39], v[32:35], 0
s_waitcnt lgkmcnt(8)
v_mfma_f32_16x16x32_bf16 v[100:103], v[88:91], v[80:83], 0
v_mfma_f32_16x16x32_bf16 v[104:107], v[84:87], v[80:83], 0
s_nop 7
v_cndmask_b32 v52, v28, v52, s[64:65]
v_cndmask_b32 v100, v28, v100, s[84:85]
v_cndmask_b32 v53, v28, v53, s[66:67]
v_cndmask_b32 v101, v28, v101, s[86:87]
v_cndmask_b32 v54, v28, v54, s[68:69]
v_cndmask_b32 v102, v28, v102, s[88:89]
v_cndmask_b32 v55, v28, v55, s[70:71]
v_cndmask_b32 v103, v28, v103, s[90:91]
v_cndmask_b32 v56, v28, v56, s[52:53]
v_cndmask_b32 v104, v28, v104, s[52:53]
v_cndmask_b32 v57, v28, v57, s[54:55]
v_cndmask_b32 v105, v28, v105, s[54:55]
v_cndmask_b32 v58, v28, v58, s[56:57]
v_cndmask_b32 v106, v28, v106, s[56:57]
v_cndmask_b32 v59, v28, v59, s[58:59]
v_cndmask_b32 v107, v28, v107, s[58:59]
v_max3_f32 v60, v52, v53, v54
v_max3_f32 v108, v100, v101, v102
v_max3_f32 v61, v55, v56, v57
v_max3_f32 v109, v103, v104, v105
v_max3_f32 v60, v60, v58, v59
v_max3_f32 v108, v108, v106, v107
v_max_f32 v60, v60, v61
v_max_f32 v108, v108, v109
v_mov_b32 v61, v60
v_mov_b32 v109, v108
s_nop 0
v_permlane32_swap_b32 v60, v61
v_permlane32_swap_b32 v108, v109
v_max_f32 v60, v60, v61
v_max_f32 v108, v108, v109
v_mov_b32 v61, v60
v_mov_b32 v109, v108
s_nop 0
v_permlane16_swap_b32 v60, v61
v_permlane16_swap_b32 v108, v109
v_max_f32 v60, v60, v61
v_max_f32 v108, v108, v109
v_mul_f32 v60, s61, v60
v_mul_f32 v108, s61, v108
v_fma_f32 v52, v52, s61, -v60
v_fma_f32 v100, v100, s61, -v108
v_fma_f32 v53, v53, s61, -v60
v_fma_f32 v101, v101, s61, -v108
v_fma_f32 v54, v54, s61, -v60
v_fma_f32 v102, v102, s61, -v108
v_fma_f32 v55, v55, s61, -v60
v_fma_f32 v103, v103, s61, -v108
v_fma_f32 v56, v56, s61, -v60
v_fma_f32 v104, v104, s61, -v108
v_fma_f32 v57, v57, s61, -v60
v_fma_f32 v105, v105, s61, -v108
v_fma_f32 v58, v58, s61, -v60
v_fma_f32 v106, v106, s61, -v108
v_fma_f32 v59, v59, s61, -v60
v_fma_f32 v107, v107, s61, -v108
v_exp_f32 v52, v52
v_exp_f32 v100, v100
v_exp_f32 v53, v53
v_exp_f32 v101, v101
v_exp_f32 v54, v54
v_exp_f32 v102, v102
v_exp_f32 v55, v55
v_exp_f32 v103, v103
v_exp_f32 v56, v56
v_exp_f32 v104, v104
v_exp_f32 v57, v57
v_exp_f32 v105, v105
v_exp_f32 v58, v58
v_exp_f32 v106, v106
v_exp_f32 v59, v59
v_exp_f32 v107, v107
v_cvt_pk_bf16_f32 v64, v52, v53
v_cvt_pk_bf16_f32 v112, v100, v101
v_cvt_pk_bf16_f32 v65, v54, v55
v_cvt_pk_bf16_f32 v113, v102, v103
v_cvt_pk_bf16_f32 v66, v56, v57
v_cvt_pk_bf16_f32 v114, v104, v105
v_cvt_pk_bf16_f32 v67, v58, v59
v_cvt_pk_bf16_f32 v115, v106, v107
s_waitcnt lgkmcnt(0)
v_mfma_f32_16x16x32_bf16 v[68:71], v[44:47], v[64:67], 0
v_mfma_f32_16x16x32_bf16 v[72:75], v[48:51], v[64:67], 0
v_mfma_f32_16x16x32_bf16 v[116:119], v[92:95], v[112:115], 0
v_mfma_f32_16x16x32_bf16 v[120:123], v[96:99], v[112:115], 0
s_load_dwordx4 s[4:7], s[0:1], 32
s_load_dwordx2 s[28:29], s[0:1], 16
s_load_dwordx4 s[60:63], s[0:1], 48
v_add_f32 v60, v52, v53
v_add_f32 v108, v100, v101
v_add_f32 v61, v54, v55
v_add_f32 v109, v102, v103
v_add_f32 v56, v56, v57
v_add_f32 v104, v104, v105
v_add_f32 v58, v58, v59
v_add_f32 v106, v106, v107
v_add_f32 v60, v60, v61
v_add_f32 v108, v108, v109
v_add_f32 v56, v56, v58
v_add_f32 v104, v104, v106
v_add_f32 v60, v60, v56
v_add_f32 v108, v108, v104
v_mov_b32 v61, v60
v_mov_b32 v109, v108
s_nop 0
v_permlane32_swap_b32 v60, v61
v_permlane32_swap_b32 v108, v109
v_add_f32 v60, v60, v61
v_add_f32 v108, v108, v109
v_mov_b32 v61, v60
v_mov_b32 v109, v108
s_nop 0
v_permlane16_swap_b32 v60, v61
v_permlane16_swap_b32 v108, v109
v_add_f32 v60, v60, v61
v_add_f32 v108, v108, v109
v_rcp_f32 v60, v60
v_rcp_f32 v108, v108
s_nop 0
v_pk_mul_f32 v[68:69], v[60:61], v[68:69] op_sel_hi:[0,1]
v_pk_mul_f32 v[70:71], v[60:61], v[70:71] op_sel_hi:[0,1]
v_pk_mul_f32 v[72:73], v[60:61], v[72:73] op_sel_hi:[0,1]
v_pk_mul_f32 v[74:75], v[60:61], v[74:75] op_sel_hi:[0,1]
v_cvt_pk_bf16_f32 v68, v68, v69
v_cvt_pk_bf16_f32 v69, v70, v71
v_cvt_pk_bf16_f32 v70, v72, v73
v_cvt_pk_bf16_f32 v71, v74, v75
buffer_store_dwordx4 v[68:71], v27, s[16:19], 0 offen offset:0 sc1
v_pk_mul_f32 v[116:117], v[108:109], v[116:117] op_sel_hi:[0,1]
v_pk_mul_f32 v[118:119], v[108:109], v[118:119] op_sel_hi:[0,1]
v_pk_mul_f32 v[120:121], v[108:109], v[120:121] op_sel_hi:[0,1]
v_pk_mul_f32 v[122:123], v[108:109], v[122:123] op_sel_hi:[0,1]
v_cvt_pk_bf16_f32 v116, v116, v117
v_cvt_pk_bf16_f32 v117, v118, v119
v_cvt_pk_bf16_f32 v118, v120, v121
v_cvt_pk_bf16_f32 v119, v122, v123
buffer_store_dwordx4 v[116:119], v27, s[16:19], 0 offen offset:512 sc1
s_add_u32 s56, s32, 28311552
s_addc_u32 s57, s33, 0
s_mov_b32 s58, 32768
s_mov_b32 s59, 0x20000
v_and_b32 v17, 15, v1
v_lshrrev_b32 v18, 4, v1
s_lshr_b32 s46, s36, 1
s_and_b32 s46, s46, 1
s_and_b32 s47, s36, 1
s_and_b32 s51, s36, 3
s_bfe_u32 s49, s35, 0x20001
s_lshl_b32 s49, s49, 2
s_lshr_b32 s43, s35, 3
s_lshl_b32 s43, s43, 1
s_add_u32 s49, s49, s43
s_and_b32 s43, s35, 1
s_add_u32 s49, s49, s43
s_waitcnt lgkmcnt(0)
s_cmp_ge_u32 s36, 4
s_cbranch_scc1 LG1_24
v_lshlrev_b32 v19, 11, v18
v_lshl_add_u32 v19, v17, 4, v19
s_lshl_b32 s43, s36, 9
v_add_u32 v2, s43, v19
v_add_u32 v4, 98304, v2
v_lshrrev_b32 v19, 2, v17
v_lshl_add_u32 v20, v18, 2, v19
v_bfe_u32 v21, v20, 1, 2
v_lshlrev_b32 v20, 7, v20
v_lshl_add_u32 v20, v21, 5, v20
v_and_b32 v19, 3, v1
v_lshl_add_u32 v20, v19, 3, v20
v_add_u32 v5, 0x10000, v20
v_xor_b32 v6, 32, v5
v_xor_b32 v7, 64, v5
v_xor_b32 v8, 96, v5
v_add_u32 v9, 0x10000, v5
v_add_u32 v10, 0x10000, v6
v_add_u32 v11, 0x10000, v7
v_add_u32 v12, 0x10000, v8
s_lshl_b32 s43, s34, 18
s_lshl_b32 s44, s35, 14
s_add_u32 s43, s43, s44
s_add_u32 s20, s32, s43
s_addc_u32 s21, s33, 0
s_add_u32 s20, s20, 4194304
s_addc_u32 s21, s21, 0
s_mov_b32 s22, 16384
s_mov_b32 s23, 0x20000
s_lshl_b32 s43, s34, 14
s_lshl_b32 s44, s35, 10
s_add_u32 s43, s43, s44
s_add_u32 s24, s32, s43
s_addc_u32 s25, s33, 0
s_add_u32 s24, s24, 25165824
s_addc_u32 s25, s25, 0
s_mov_b32 s26, 1024
s_mov_b32 s27, 0x20000
s_movk_i32 s50, 0x2000
v_lshrrev_b32 v19, 1, v18
v_lshl_add_u32 v19, v19, 4, v17
s_lshl_b32 s43, s36, 5
v_add_u32 v19, s43, v19
v_and_b32 v20, 1, v18
v_lshlrev_b32 v20, 2, v20
v_lshl_add_u32 v22, v19, 3, v20
s_lshl_b32 s43, s34, 18
s_add_u32 s12, s32, s43
s_addc_u32 s13, s33, 0
s_mov_b32 s14, 262144
s_mov_b32 s15, 0x20000
v_lshlrev_b32 v21, 4, v1
s_lshl_b32 s54, s36, 11
s_add_u32 s43, s35, 1
s_and_b32 s43, s43, 15
s_lshl_b32 s43, s43, 14
s_add_u32 s30, s43, s54
s_add_u32 s43, s35, 2
s_and_b32 s43, s43, 15
s_lshl_b32 s43, s43, 14
s_add_u32 s31, s43, s54
s_waitcnt vmcnt(0)
s_barrier
ds_write_b128 v27, v[68:71] offset:0
ds_write_b128 v27, v[116:119] offset:512
v_permlane16_swap_b32 v160, v162
v_permlane16_swap_b32 v161, v163
v_permlane16_swap_b32 v164, v166
v_permlane16_swap_b32 v165, v167
v_permlane16_swap_b32 v168, v170
v_permlane16_swap_b32 v169, v171
v_permlane16_swap_b32 v172, v174
v_permlane16_swap_b32 v173, v175
v_lshlrev_b32 v128, 16, v160
v_and_b32 v129, 0xffff0000, v160
v_lshlrev_b32 v130, 16, v161
v_and_b32 v131, 0xffff0000, v161
v_lshlrev_b32 v132, 16, v162
v_and_b32 v133, 0xffff0000, v162
v_lshlrev_b32 v134, 16, v163
v_and_b32 v135, 0xffff0000, v163
v_lshlrev_b32 v136, 16, v164
v_and_b32 v137, 0xffff0000, v164
v_lshlrev_b32 v138, 16, v165
v_and_b32 v139, 0xffff0000, v165
v_lshlrev_b32 v140, 16, v166
v_and_b32 v141, 0xffff0000, v166
v_lshlrev_b32 v142, 16, v167
v_and_b32 v143, 0xffff0000, v167
v_lshlrev_b32 v144, 16, v168
v_and_b32 v145, 0xffff0000, v168
v_lshlrev_b32 v146, 16, v169
v_and_b32 v147, 0xffff0000, v169
v_lshlrev_b32 v148, 16, v170
v_and_b32 v149, 0xffff0000, v170
v_lshlrev_b32 v150, 16, v171
v_and_b32 v151, 0xffff0000, v171
v_lshlrev_b32 v152, 16, v172
v_and_b32 v153, 0xffff0000, v172
v_lshlrev_b32 v154, 16, v173
v_and_b32 v155, 0xffff0000, v173
v_lshlrev_b32 v156, 16, v174
v_and_b32 v157, 0xffff0000, v174
v_lshlrev_b32 v158, 16, v175
v_and_b32 v159, 0xffff0000, v175
s_waitcnt lgkmcnt(0)
s_barrier
s_add_u32 m0, s54, 16384
s_add_u32 s43, s30, 0
buffer_load_dwordx4 v21, s[12:15], s43 offen sc1 lds
s_add_u32 m0, s54, 17408
s_add_u32 s43, s30, 1024
buffer_load_dwordx4 v21, s[12:15], s43 offen sc1 lds
s_add_u32 m0, s54, 32768
s_add_u32 s43, s31, 0
buffer_load_dwordx4 v21, s[12:15], s43 offen sc1 lds
s_add_u32 m0, s54, 33792
s_add_u32 s43, s31, 1024
buffer_load_dwordx4 v21, s[12:15], s43 offen sc1 lds
ds_read_b128 v[32:35], v2 offset:0
ds_read_b64_tr_b16 v[48:49], v5 offset:0
ds_read_b64_tr_b16 v[50:51], v5 offset:2048
ds_read_b64_tr_b16 v[52:53], v6 offset:0
ds_read_b64_tr_b16 v[54:55], v6 offset:2048
ds_read_b128 v[36:39], v2 offset:256
ds_read_b64_tr_b16 v[56:57], v7 offset:0
ds_read_b64_tr_b16 v[58:59], v7 offset:2048
ds_read_b64_tr_b16 v[60:61], v8 offset:0
ds_read_b64_tr_b16 v[62:63], v8 offset:2048
ds_read_b128 v[40:43], v2 offset:8192
ds_read_b64_tr_b16 v[64:65], v5 offset:4096
ds_read_b64_tr_b16 v[66:67], v5 offset:6144
ds_read_b64_tr_b16 v[68:69], v6 offset:4096
ds_read_b64_tr_b16 v[70:71], v6 offset:6144
ds_read_b128 v[44:47], v2 offset:8448
ds_read_b64_tr_b16 v[72:73], v7 offset:4096
ds_read_b64_tr_b16 v[74:75], v7 offset:6144
ds_read_b64_tr_b16 v[76:77], v8 offset:4096
ds_read_b64_tr_b16 v[78:79], v8 offset:6144
s_waitcnt lgkmcnt(0)
v_mfma_f32_16x16x32_bf16 v[128:131], v[48:51], v[32:35], v[128:131]
v_mfma_f32_16x16x32_bf16 v[132:135], v[52:55], v[32:35], v[132:135]
v_mfma_f32_16x16x32_bf16 v[136:139], v[56:59], v[32:35], v[136:139]
v_mfma_f32_16x16x32_bf16 v[140:143], v[60:63], v[32:35], v[140:143]
v_mfma_f32_16x16x32_bf16 v[144:147], v[48:51], v[36:39], v[144:147]
v_mfma_f32_16x16x32_bf16 v[148:151], v[52:55], v[36:39], v[148:151]
v_mfma_f32_16x16x32_bf16 v[152:155], v[56:59], v[36:39], v[152:155]
v_mfma_f32_16x16x32_bf16 v[156:159], v[60:63], v[36:39], v[156:159]
v_mfma_f32_16x16x32_bf16 v[128:131], v[64:67], v[40:43], v[128:131]
v_mfma_f32_16x16x32_bf16 v[132:135], v[68:71], v[40:43], v[132:135]
v_mfma_f32_16x16x32_bf16 v[136:139], v[72:75], v[40:43], v[136:139]
v_mfma_f32_16x16x32_bf16 v[140:143], v[76:79], v[40:43], v[140:143]
v_mfma_f32_16x16x32_bf16 v[144:147], v[64:67], v[44:47], v[144:147]
v_mfma_f32_16x16x32_bf16 v[148:151], v[68:71], v[44:47], v[148:151]
v_mfma_f32_16x16x32_bf16 v[152:155], v[72:75], v[44:47], v[152:155]
v_mfma_f32_16x16x32_bf16 v[156:159], v[76:79], v[44:47], v[156:159]
s_waitcnt vmcnt(2)
s_barrier
ds_read_b128 v[80:83], v2 offset:16384
ds_read_b64_tr_b16 v[96:97], v5 offset:8192
ds_read_b64_tr_b16 v[98:99], v5 offset:10240
ds_read_b64_tr_b16 v[100:101], v6 offset:8192
ds_read_b64_tr_b16 v[102:103], v6 offset:10240
ds_read_b128 v[84:87], v2 offset:16640
ds_read_b64_tr_b16 v[104:105], v7 offset:8192
ds_read_b64_tr_b16 v[106:107], v7 offset:10240
ds_read_b64_tr_b16 v[108:109], v8 offset:8192
ds_read_b64_tr_b16 v[110:111], v8 offset:10240
ds_read_b128 v[88:91], v2 offset:24576
ds_read_b64_tr_b16 v[112:113], v5 offset:12288
ds_read_b64_tr_b16 v[114:115], v5 offset:14336
ds_read_b64_tr_b16 v[116:117], v6 offset:12288
ds_read_b64_tr_b16 v[118:119], v6 offset:14336
ds_read_b128 v[92:95], v2 offset:24832
ds_read_b64_tr_b16 v[120:121], v7 offset:12288
ds_read_b64_tr_b16 v[122:123], v7 offset:14336
ds_read_b64_tr_b16 v[124:125], v8 offset:12288
ds_read_b64_tr_b16 v[126:127], v8 offset:14336
s_waitcnt vmcnt(0) lgkmcnt(0)
s_barrier
v_mfma_f32_16x16x32_bf16 v[128:131], v[96:99], v[80:83], v[128:131]
ds_read_b128 v[32:35], v2 offset:32768
ds_read_b64_tr_b16 v[48:49], v5 offset:16384
v_mfma_f32_16x16x32_bf16 v[132:135], v[100:103], v[80:83], v[132:135]
ds_read_b64_tr_b16 v[50:51], v5 offset:18432
v_mfma_f32_16x16x32_bf16 v[136:139], v[104:107], v[80:83], v[136:139]
ds_read_b64_tr_b16 v[52:53], v6 offset:16384
v_mfma_f32_16x16x32_bf16 v[140:143], v[108:111], v[80:83], v[140:143]
ds_read_b64_tr_b16 v[54:55], v6 offset:18432
v_mfma_f32_16x16x32_bf16 v[144:147], v[96:99], v[84:87], v[144:147]
ds_read_b128 v[36:39], v2 offset:33024
ds_read_b64_tr_b16 v[56:57], v7 offset:16384
v_mfma_f32_16x16x32_bf16 v[148:151], v[100:103], v[84:87], v[148:151]
ds_read_b64_tr_b16 v[58:59], v7 offset:18432
v_mfma_f32_16x16x32_bf16 v[152:155], v[104:107], v[84:87], v[152:155]
ds_read_b64_tr_b16 v[60:61], v8 offset:16384
v_mfma_f32_16x16x32_bf16 v[156:159], v[108:111], v[84:87], v[156:159]
ds_read_b64_tr_b16 v[62:63], v8 offset:18432
v_mfma_f32_16x16x32_bf16 v[128:131], v[112:115], v[88:91], v[128:131]
ds_read_b128 v[40:43], v2 offset:40960
ds_read_b64_tr_b16 v[64:65], v5 offset:20480
v_mfma_f32_16x16x32_bf16 v[132:135], v[116:119], v[88:91], v[132:135]
ds_read_b64_tr_b16 v[66:67], v5 offset:22528
v_mfma_f32_16x16x32_bf16 v[136:139], v[120:123], v[88:91], v[136:139]
ds_read_b64_tr_b16 v[68:69], v6 offset:20480
v_mfma_f32_16x16x32_bf16 v[140:143], v[124:127], v[88:91], v[140:143]
ds_read_b64_tr_b16 v[70:71], v6 offset:22528
v_mfma_f32_16x16x32_bf16 v[144:147], v[112:115], v[92:95], v[144:147]
ds_read_b128 v[44:47], v2 offset:41216
ds_read_b64_tr_b16 v[72:73], v7 offset:20480
v_mfma_f32_16x16x32_bf16 v[148:151], v[116:119], v[92:95], v[148:151]
ds_read_b64_tr_b16 v[74:75], v7 offset:22528
v_mfma_f32_16x16x32_bf16 v[152:155], v[120:123], v[92:95], v[152:155]
ds_read_b64_tr_b16 v[76:77], v8 offset:20480
v_mfma_f32_16x16x32_bf16 v[156:159], v[124:127], v[92:95], v[156:159]
ds_read_b64_tr_b16 v[78:79], v8 offset:22528
s_waitcnt lgkmcnt(0)
s_barrier
v_mfma_f32_16x16x32_bf16 v[128:131], v[48:51], v[32:35], v[128:131]
ds_read_b128 v[80:83], v2 offset:49152
ds_read_b64_tr_b16 v[96:97], v5 offset:24576
v_mfma_f32_16x16x32_bf16 v[132:135], v[52:55], v[32:35], v[132:135]
ds_read_b64_tr_b16 v[98:99], v5 offset:26624
v_mfma_f32_16x16x32_bf16 v[136:139], v[56:59], v[32:35], v[136:139]
ds_read_b64_tr_b16 v[100:101], v6 offset:24576
v_mfma_f32_16x16x32_bf16 v[140:143], v[60:63], v[32:35], v[140:143]
ds_read_b64_tr_b16 v[102:103], v6 offset:26624
v_mfma_f32_16x16x32_bf16 v[144:147], v[48:51], v[36:39], v[144:147]
ds_read_b128 v[84:87], v2 offset:49408
ds_read_b64_tr_b16 v[104:105], v7 offset:24576
v_mfma_f32_16x16x32_bf16 v[148:151], v[52:55], v[36:39], v[148:151]
ds_read_b64_tr_b16 v[106:107], v7 offset:26624
v_mfma_f32_16x16x32_bf16 v[152:155], v[56:59], v[36:39], v[152:155]
ds_read_b64_tr_b16 v[108:109], v8 offset:24576
v_mfma_f32_16x16x32_bf16 v[156:159], v[60:63], v[36:39], v[156:159]
ds_read_b64_tr_b16 v[110:111], v8 offset:26624
v_mfma_f32_16x16x32_bf16 v[128:131], v[64:67], v[40:43], v[128:131]
ds_read_b128 v[88:91], v2 offset:57344
ds_read_b64_tr_b16 v[112:113], v5 offset:28672
v_mfma_f32_16x16x32_bf16 v[132:135], v[68:71], v[40:43], v[132:135]
ds_read_b64_tr_b16 v[114:115], v5 offset:30720
v_mfma_f32_16x16x32_bf16 v[136:139], v[72:75], v[40:43], v[136:139]
ds_read_b64_tr_b16 v[116:117], v6 offset:28672
v_mfma_f32_16x16x32_bf16 v[140:143], v[76:79], v[40:43], v[140:143]
ds_read_b64_tr_b16 v[118:119], v6 offset:30720
v_mfma_f32_16x16x32_bf16 v[144:147], v[64:67], v[44:47], v[144:147]
ds_read_b128 v[92:95], v2 offset:57600
ds_read_b64_tr_b16 v[120:121], v7 offset:28672
v_mfma_f32_16x16x32_bf16 v[148:151], v[68:71], v[44:47], v[148:151]
ds_read_b64_tr_b16 v[122:123], v7 offset:30720
v_mfma_f32_16x16x32_bf16 v[152:155], v[72:75], v[44:47], v[152:155]
ds_read_b64_tr_b16 v[124:125], v8 offset:28672
v_mfma_f32_16x16x32_bf16 v[156:159], v[76:79], v[44:47], v[156:159]
ds_read_b64_tr_b16 v[126:127], v8 offset:30720
s_waitcnt lgkmcnt(0)
s_barrier
v_mfma_f32_16x16x32_bf16 v[128:131], v[96:99], v[80:83], v[128:131]
ds_read_b128 v[32:35], v2 offset:0
ds_read_b64_tr_b16 v[48:49], v5 offset:32768
v_mfma_f32_16x16x32_bf16 v[132:135], v[100:103], v[80:83], v[132:135]
ds_read_b64_tr_b16 v[50:51], v5 offset:34816
v_mfma_f32_16x16x32_bf16 v[136:139], v[104:107], v[80:83], v[136:139]
ds_read_b64_tr_b16 v[52:53], v6 offset:32768
v_mfma_f32_16x16x32_bf16 v[140:143], v[108:111], v[80:83], v[140:143]
ds_read_b64_tr_b16 v[54:55], v6 offset:34816
v_mfma_f32_16x16x32_bf16 v[144:147], v[96:99], v[84:87], v[144:147]
ds_read_b128 v[36:39], v2 offset:256
ds_read_b64_tr_b16 v[56:57], v7 offset:32768
v_mfma_f32_16x16x32_bf16 v[148:151], v[100:103], v[84:87], v[148:151]
ds_read_b64_tr_b16 v[58:59], v7 offset:34816
v_mfma_f32_16x16x32_bf16 v[152:155], v[104:107], v[84:87], v[152:155]
ds_read_b64_tr_b16 v[60:61], v8 offset:32768
v_mfma_f32_16x16x32_bf16 v[156:159], v[108:111], v[84:87], v[156:159]
ds_read_b64_tr_b16 v[62:63], v8 offset:34816
v_mfma_f32_16x16x32_bf16 v[128:131], v[112:115], v[88:91], v[128:131]
ds_read_b128 v[40:43], v2 offset:8192
ds_read_b64_tr_b16 v[64:65], v5 offset:36864
v_mfma_f32_16x16x32_bf16 v[132:135], v[116:119], v[88:91], v[132:135]
ds_read_b64_tr_b16 v[66:67], v5 offset:38912
v_mfma_f32_16x16x32_bf16 v[136:139], v[120:123], v[88:91], v[136:139]
ds_read_b64_tr_b16 v[68:69], v6 offset:36864
v_mfma_f32_16x16x32_bf16 v[140:143], v[124:127], v[88:91], v[140:143]
ds_read_b64_tr_b16 v[70:71], v6 offset:38912
v_mfma_f32_16x16x32_bf16 v[144:147], v[112:115], v[92:95], v[144:147]
ds_read_b128 v[44:47], v2 offset:8448
ds_read_b64_tr_b16 v[72:73], v7 offset:36864
v_mfma_f32_16x16x32_bf16 v[148:151], v[116:119], v[92:95], v[148:151]
ds_read_b64_tr_b16 v[74:75], v7 offset:38912
v_mfma_f32_16x16x32_bf16 v[152:155], v[120:123], v[92:95], v[152:155]
ds_read_b64_tr_b16 v[76:77], v8 offset:36864
v_mfma_f32_16x16x32_bf16 v[156:159], v[124:127], v[92:95], v[156:159]
ds_read_b64_tr_b16 v[78:79], v8 offset:38912
s_waitcnt lgkmcnt(0)
s_barrier
v_mfma_f32_16x16x32_bf16 v[128:131], v[48:51], v[32:35], v[128:131]
ds_read_b128 v[80:83], v2 offset:16384
ds_read_b64_tr_b16 v[96:97], v5 offset:40960
v_mfma_f32_16x16x32_bf16 v[132:135], v[52:55], v[32:35], v[132:135]
ds_read_b64_tr_b16 v[98:99], v5 offset:43008
v_mfma_f32_16x16x32_bf16 v[136:139], v[56:59], v[32:35], v[136:139]
ds_read_b64_tr_b16 v[100:101], v6 offset:40960
v_mfma_f32_16x16x32_bf16 v[140:143], v[60:63], v[32:35], v[140:143]
ds_read_b64_tr_b16 v[102:103], v6 offset:43008
v_mfma_f32_16x16x32_bf16 v[144:147], v[48:51], v[36:39], v[144:147]
ds_read_b128 v[84:87], v2 offset:16640
ds_read_b64_tr_b16 v[104:105], v7 offset:40960
v_mfma_f32_16x16x32_bf16 v[148:151], v[52:55], v[36:39], v[148:151]
ds_read_b64_tr_b16 v[106:107], v7 offset:43008
v_mfma_f32_16x16x32_bf16 v[152:155], v[56:59], v[36:39], v[152:155]
ds_read_b64_tr_b16 v[108:109], v8 offset:40960
v_mfma_f32_16x16x32_bf16 v[156:159], v[60:63], v[36:39], v[156:159]
ds_read_b64_tr_b16 v[110:111], v8 offset:43008
v_mfma_f32_16x16x32_bf16 v[128:131], v[64:67], v[40:43], v[128:131]
ds_read_b128 v[88:91], v2 offset:24576
ds_read_b64_tr_b16 v[112:113], v5 offset:45056
v_mfma_f32_16x16x32_bf16 v[132:135], v[68:71], v[40:43], v[132:135]
ds_read_b64_tr_b16 v[114:115], v5 offset:47104
v_mfma_f32_16x16x32_bf16 v[136:139], v[72:75], v[40:43], v[136:139]
ds_read_b64_tr_b16 v[116:117], v6 offset:45056
v_mfma_f32_16x16x32_bf16 v[140:143], v[76:79], v[40:43], v[140:143]
ds_read_b64_tr_b16 v[118:119], v6 offset:47104
v_mfma_f32_16x16x32_bf16 v[144:147], v[64:67], v[44:47], v[144:147]
ds_read_b128 v[92:95], v2 offset:24832
ds_read_b64_tr_b16 v[120:121], v7 offset:45056
v_mfma_f32_16x16x32_bf16 v[148:151], v[68:71], v[44:47], v[148:151]
ds_read_b64_tr_b16 v[122:123], v7 offset:47104
v_mfma_f32_16x16x32_bf16 v[152:155], v[72:75], v[44:47], v[152:155]
ds_read_b64_tr_b16 v[124:125], v8 offset:45056
v_mfma_f32_16x16x32_bf16 v[156:159], v[76:79], v[44:47], v[156:159]
ds_read_b64_tr_b16 v[126:127], v8 offset:47104
s_waitcnt lgkmcnt(0)
s_barrier
v_mfma_f32_16x16x32_bf16 v[128:131], v[96:99], v[80:83], v[128:131]
ds_read_b128 v[32:35], v2 offset:32768
ds_read_b64_tr_b16 v[48:49], v5 offset:49152
v_mfma_f32_16x16x32_bf16 v[132:135], v[100:103], v[80:83], v[132:135]
ds_read_b64_tr_b16 v[50:51], v5 offset:51200
v_mfma_f32_16x16x32_bf16 v[136:139], v[104:107], v[80:83], v[136:139]
ds_read_b64_tr_b16 v[52:53], v6 offset:49152
v_mfma_f32_16x16x32_bf16 v[140:143], v[108:111], v[80:83], v[140:143]
ds_read_b64_tr_b16 v[54:55], v6 offset:51200
v_mfma_f32_16x16x32_bf16 v[144:147], v[96:99], v[84:87], v[144:147]
ds_read_b128 v[36:39], v2 offset:33024
ds_read_b64_tr_b16 v[56:57], v7 offset:49152
v_mfma_f32_16x16x32_bf16 v[148:151], v[100:103], v[84:87], v[148:151]
ds_read_b64_tr_b16 v[58:59], v7 offset:51200
v_mfma_f32_16x16x32_bf16 v[152:155], v[104:107], v[84:87], v[152:155]
ds_read_b64_tr_b16 v[60:61], v8 offset:49152
v_mfma_f32_16x16x32_bf16 v[156:159], v[108:111], v[84:87], v[156:159]
ds_read_b64_tr_b16 v[62:63], v8 offset:51200
v_mfma_f32_16x16x32_bf16 v[128:131], v[112:115], v[88:91], v[128:131]
ds_read_b128 v[40:43], v2 offset:40960
ds_read_b64_tr_b16 v[64:65], v5 offset:53248
v_mfma_f32_16x16x32_bf16 v[132:135], v[116:119], v[88:91], v[132:135]
ds_read_b64_tr_b16 v[66:67], v5 offset:55296
v_mfma_f32_16x16x32_bf16 v[136:139], v[120:123], v[88:91], v[136:139]
ds_read_b64_tr_b16 v[68:69], v6 offset:53248
v_mfma_f32_16x16x32_bf16 v[140:143], v[124:127], v[88:91], v[140:143]
ds_read_b64_tr_b16 v[70:71], v6 offset:55296
v_mfma_f32_16x16x32_bf16 v[144:147], v[112:115], v[92:95], v[144:147]
ds_read_b128 v[44:47], v2 offset:41216
ds_read_b64_tr_b16 v[72:73], v7 offset:53248
v_mfma_f32_16x16x32_bf16 v[148:151], v[116:119], v[92:95], v[148:151]
ds_read_b64_tr_b16 v[74:75], v7 offset:55296
v_mfma_f32_16x16x32_bf16 v[152:155], v[120:123], v[92:95], v[152:155]
ds_read_b64_tr_b16 v[76:77], v8 offset:53248
v_mfma_f32_16x16x32_bf16 v[156:159], v[124:127], v[92:95], v[156:159]
ds_read_b64_tr_b16 v[78:79], v8 offset:55296
s_waitcnt lgkmcnt(0)
s_barrier
v_mfma_f32_16x16x32_bf16 v[128:131], v[48:51], v[32:35], v[128:131]
ds_read_b128 v[80:83], v2 offset:49152
ds_read_b64_tr_b16 v[96:97], v5 offset:57344
v_mfma_f32_16x16x32_bf16 v[132:135], v[52:55], v[32:35], v[132:135]
ds_read_b64_tr_b16 v[98:99], v5 offset:59392
v_mfma_f32_16x16x32_bf16 v[136:139], v[56:59], v[32:35], v[136:139]
ds_read_b64_tr_b16 v[100:101], v6 offset:57344
v_mfma_f32_16x16x32_bf16 v[140:143], v[60:63], v[32:35], v[140:143]
ds_read_b64_tr_b16 v[102:103], v6 offset:59392
v_mfma_f32_16x16x32_bf16 v[144:147], v[48:51], v[36:39], v[144:147]
ds_read_b128 v[84:87], v2 offset:49408
ds_read_b64_tr_b16 v[104:105], v7 offset:57344
v_mfma_f32_16x16x32_bf16 v[148:151], v[52:55], v[36:39], v[148:151]
ds_read_b64_tr_b16 v[106:107], v7 offset:59392
v_mfma_f32_16x16x32_bf16 v[152:155], v[56:59], v[36:39], v[152:155]
ds_read_b64_tr_b16 v[108:109], v8 offset:57344
v_mfma_f32_16x16x32_bf16 v[156:159], v[60:63], v[36:39], v[156:159]
ds_read_b64_tr_b16 v[110:111], v8 offset:59392
v_mfma_f32_16x16x32_bf16 v[128:131], v[64:67], v[40:43], v[128:131]
ds_read_b128 v[88:91], v2 offset:57344
ds_read_b64_tr_b16 v[112:113], v5 offset:61440
v_mfma_f32_16x16x32_bf16 v[132:135], v[68:71], v[40:43], v[132:135]
ds_read_b64_tr_b16 v[114:115], v5 offset:63488
v_mfma_f32_16x16x32_bf16 v[136:139], v[72:75], v[40:43], v[136:139]
ds_read_b64_tr_b16 v[116:117], v6 offset:61440
v_mfma_f32_16x16x32_bf16 v[140:143], v[76:79], v[40:43], v[140:143]
ds_read_b64_tr_b16 v[118:119], v6 offset:63488
v_mfma_f32_16x16x32_bf16 v[144:147], v[64:67], v[44:47], v[144:147]
ds_read_b128 v[92:95], v2 offset:57600
ds_read_b64_tr_b16 v[120:121], v7 offset:61440
v_mfma_f32_16x16x32_bf16 v[148:151], v[68:71], v[44:47], v[148:151]
ds_read_b64_tr_b16 v[122:123], v7 offset:63488
v_mfma_f32_16x16x32_bf16 v[152:155], v[72:75], v[44:47], v[152:155]
ds_read_b64_tr_b16 v[124:125], v8 offset:61440
v_mfma_f32_16x16x32_bf16 v[156:159], v[76:79], v[44:47], v[156:159]
ds_read_b64_tr_b16 v[126:127], v8 offset:63488
s_waitcnt lgkmcnt(0)
s_barrier
v_mfma_f32_16x16x32_bf16 v[128:131], v[96:99], v[80:83], v[128:131]
ds_read_b128 v[32:35], v2 offset:0
ds_read_b64_tr_b16 v[48:49], v9 offset:0
v_mfma_f32_16x16x32_bf16 v[132:135], v[100:103], v[80:83], v[132:135]
ds_read_b64_tr_b16 v[50:51], v9 offset:2048
v_mfma_f32_16x16x32_bf16 v[136:139], v[104:107], v[80:83], v[136:139]
ds_read_b64_tr_b16 v[52:53], v10 offset:0
v_mfma_f32_16x16x32_bf16 v[140:143], v[108:111], v[80:83], v[140:143]
ds_read_b64_tr_b16 v[54:55], v10 offset:2048
v_mfma_f32_16x16x32_bf16 v[144:147], v[96:99], v[84:87], v[144:147]
ds_read_b128 v[36:39], v2 offset:256
ds_read_b64_tr_b16 v[56:57], v11 offset:0
v_mfma_f32_16x16x32_bf16 v[148:151], v[100:103], v[84:87], v[148:151]
ds_read_b64_tr_b16 v[58:59], v11 offset:2048
v_mfma_f32_16x16x32_bf16 v[152:155], v[104:107], v[84:87], v[152:155]
ds_read_b64_tr_b16 v[60:61], v12 offset:0
v_mfma_f32_16x16x32_bf16 v[156:159], v[108:111], v[84:87], v[156:159]
ds_read_b64_tr_b16 v[62:63], v12 offset:2048
v_mfma_f32_16x16x32_bf16 v[128:131], v[112:115], v[88:91], v[128:131]
ds_read_b128 v[40:43], v2 offset:8192
ds_read_b64_tr_b16 v[64:65], v9 offset:4096
v_mfma_f32_16x16x32_bf16 v[132:135], v[116:119], v[88:91], v[132:135]
ds_read_b64_tr_b16 v[66:67], v9 offset:6144
v_mfma_f32_16x16x32_bf16 v[136:139], v[120:123], v[88:91], v[136:139]
ds_read_b64_tr_b16 v[68:69], v10 offset:4096
v_mfma_f32_16x16x32_bf16 v[140:143], v[124:127], v[88:91], v[140:143]
ds_read_b64_tr_b16 v[70:71], v10 offset:6144
v_mfma_f32_16x16x32_bf16 v[144:147], v[112:115], v[92:95], v[144:147]
ds_read_b128 v[44:47], v2 offset:8448
ds_read_b64_tr_b16 v[72:73], v11 offset:4096
v_mfma_f32_16x16x32_bf16 v[148:151], v[116:119], v[92:95], v[148:151]
ds_read_b64_tr_b16 v[74:75], v11 offset:6144
v_mfma_f32_16x16x32_bf16 v[152:155], v[120:123], v[92:95], v[152:155]
ds_read_b64_tr_b16 v[76:77], v12 offset:4096
v_mfma_f32_16x16x32_bf16 v[156:159], v[124:127], v[92:95], v[156:159]
ds_read_b64_tr_b16 v[78:79], v12 offset:6144
s_waitcnt lgkmcnt(0)
s_barrier
v_mfma_f32_16x16x32_bf16 v[128:131], v[48:51], v[32:35], v[128:131]
ds_read_b128 v[80:83], v2 offset:16384
ds_read_b64_tr_b16 v[96:97], v9 offset:8192
v_mfma_f32_16x16x32_bf16 v[132:135], v[52:55], v[32:35], v[132:135]
ds_read_b64_tr_b16 v[98:99], v9 offset:10240
v_mfma_f32_16x16x32_bf16 v[136:139], v[56:59], v[32:35], v[136:139]
ds_read_b64_tr_b16 v[100:101], v10 offset:8192
v_mfma_f32_16x16x32_bf16 v[140:143], v[60:63], v[32:35], v[140:143]
ds_read_b64_tr_b16 v[102:103], v10 offset:10240
v_mfma_f32_16x16x32_bf16 v[144:147], v[48:51], v[36:39], v[144:147]
ds_read_b128 v[84:87], v2 offset:16640
ds_read_b64_tr_b16 v[104:105], v11 offset:8192
v_mfma_f32_16x16x32_bf16 v[148:151], v[52:55], v[36:39], v[148:151]
ds_read_b64_tr_b16 v[106:107], v11 offset:10240
v_mfma_f32_16x16x32_bf16 v[152:155], v[56:59], v[36:39], v[152:155]
ds_read_b64_tr_b16 v[108:109], v12 offset:8192
v_mfma_f32_16x16x32_bf16 v[156:159], v[60:63], v[36:39], v[156:159]
ds_read_b64_tr_b16 v[110:111], v12 offset:10240
v_mfma_f32_16x16x32_bf16 v[128:131], v[64:67], v[40:43], v[128:131]
ds_read_b128 v[88:91], v2 offset:24576
ds_read_b64_tr_b16 v[112:113], v9 offset:12288
v_mfma_f32_16x16x32_bf16 v[132:135], v[68:71], v[40:43], v[132:135]
ds_read_b64_tr_b16 v[114:115], v9 offset:14336
v_mfma_f32_16x16x32_bf16 v[136:139], v[72:75], v[40:43], v[136:139]
ds_read_b64_tr_b16 v[116:117], v10 offset:12288
v_mfma_f32_16x16x32_bf16 v[140:143], v[76:79], v[40:43], v[140:143]
ds_read_b64_tr_b16 v[118:119], v10 offset:14336
v_mfma_f32_16x16x32_bf16 v[144:147], v[64:67], v[44:47], v[144:147]
ds_read_b128 v[92:95], v2 offset:24832
ds_read_b64_tr_b16 v[120:121], v11 offset:12288
v_mfma_f32_16x16x32_bf16 v[148:151], v[68:71], v[44:47], v[148:151]
ds_read_b64_tr_b16 v[122:123], v11 offset:14336
v_mfma_f32_16x16x32_bf16 v[152:155], v[72:75], v[44:47], v[152:155]
ds_read_b64_tr_b16 v[124:125], v12 offset:12288
v_mfma_f32_16x16x32_bf16 v[156:159], v[76:79], v[44:47], v[156:159]
ds_read_b64_tr_b16 v[126:127], v12 offset:14336
s_waitcnt lgkmcnt(0)
s_barrier
v_mfma_f32_16x16x32_bf16 v[128:131], v[96:99], v[80:83], v[128:131]
ds_read_b128 v[32:35], v2 offset:32768
ds_read_b64_tr_b16 v[48:49], v5 offset:0
v_mfma_f32_16x16x32_bf16 v[132:135], v[100:103], v[80:83], v[132:135]
ds_read_b64_tr_b16 v[50:51], v5 offset:2048
v_mfma_f32_16x16x32_bf16 v[136:139], v[104:107], v[80:83], v[136:139]
ds_read_b64_tr_b16 v[52:53], v6 offset:0
v_mfma_f32_16x16x32_bf16 v[140:143], v[108:111], v[80:83], v[140:143]
ds_read_b64_tr_b16 v[54:55], v6 offset:2048
v_mfma_f32_16x16x32_bf16 v[144:147], v[96:99], v[84:87], v[144:147]
ds_read_b128 v[36:39], v2 offset:33024
ds_read_b64_tr_b16 v[56:57], v7 offset:0
v_mfma_f32_16x16x32_bf16 v[148:151], v[100:103], v[84:87], v[148:151]
ds_read_b64_tr_b16 v[58:59], v7 offset:2048
v_mfma_f32_16x16x32_bf16 v[152:155], v[104:107], v[84:87], v[152:155]
ds_read_b64_tr_b16 v[60:61], v8 offset:0
v_mfma_f32_16x16x32_bf16 v[156:159], v[108:111], v[84:87], v[156:159]
ds_read_b64_tr_b16 v[62:63], v8 offset:2048
v_mfma_f32_16x16x32_bf16 v[128:131], v[112:115], v[88:91], v[128:131]
ds_read_b128 v[40:43], v2 offset:40960
ds_read_b64_tr_b16 v[64:65], v5 offset:4096
v_mfma_f32_16x16x32_bf16 v[132:135], v[116:119], v[88:91], v[132:135]
ds_read_b64_tr_b16 v[66:67], v5 offset:6144
v_mfma_f32_16x16x32_bf16 v[136:139], v[120:123], v[88:91], v[136:139]
ds_read_b64_tr_b16 v[68:69], v6 offset:4096
v_mfma_f32_16x16x32_bf16 v[140:143], v[124:127], v[88:91], v[140:143]
ds_read_b64_tr_b16 v[70:71], v6 offset:6144
v_mfma_f32_16x16x32_bf16 v[144:147], v[112:115], v[92:95], v[144:147]
ds_read_b128 v[44:47], v2 offset:41216
ds_read_b64_tr_b16 v[72:73], v7 offset:4096
v_mfma_f32_16x16x32_bf16 v[148:151], v[116:119], v[92:95], v[148:151]
ds_read_b64_tr_b16 v[74:75], v7 offset:6144
v_mfma_f32_16x16x32_bf16 v[152:155], v[120:123], v[92:95], v[152:155]
ds_read_b64_tr_b16 v[76:77], v8 offset:4096
v_mfma_f32_16x16x32_bf16 v[156:159], v[124:127], v[92:95], v[156:159]
ds_read_b64_tr_b16 v[78:79], v8 offset:6144
s_waitcnt lgkmcnt(0)
s_barrier
v_mfma_f32_16x16x32_bf16 v[128:131], v[48:51], v[32:35], v[128:131]
ds_read_b128 v[80:83], v2 offset:49152
ds_read_b64_tr_b16 v[96:97], v5 offset:8192
v_mfma_f32_16x16x32_bf16 v[132:135], v[52:55], v[32:35], v[132:135]
ds_read_b64_tr_b16 v[98:99], v5 offset:10240
v_mfma_f32_16x16x32_bf16 v[136:139], v[56:59], v[32:35], v[136:139]
ds_read_b64_tr_b16 v[100:101], v6 offset:8192
v_mfma_f32_16x16x32_bf16 v[140:143], v[60:63], v[32:35], v[140:143]
ds_read_b64_tr_b16 v[102:103], v6 offset:10240
v_mfma_f32_16x16x32_bf16 v[144:147], v[48:51], v[36:39], v[144:147]
ds_read_b128 v[84:87], v2 offset:49408
ds_read_b64_tr_b16 v[104:105], v7 offset:8192
v_mfma_f32_16x16x32_bf16 v[148:151], v[52:55], v[36:39], v[148:151]
ds_read_b64_tr_b16 v[106:107], v7 offset:10240
v_mfma_f32_16x16x32_bf16 v[152:155], v[56:59], v[36:39], v[152:155]
ds_read_b64_tr_b16 v[108:109], v8 offset:8192
v_mfma_f32_16x16x32_bf16 v[156:159], v[60:63], v[36:39], v[156:159]
ds_read_b64_tr_b16 v[110:111], v8 offset:10240
v_mfma_f32_16x16x32_bf16 v[128:131], v[64:67], v[40:43], v[128:131]
ds_read_b128 v[88:91], v2 offset:57344
ds_read_b64_tr_b16 v[112:113], v5 offset:12288
v_mfma_f32_16x16x32_bf16 v[132:135], v[68:71], v[40:43], v[132:135]
ds_read_b64_tr_b16 v[114:115], v5 offset:14336
v_mfma_f32_16x16x32_bf16 v[136:139], v[72:75], v[40:43], v[136:139]
ds_read_b64_tr_b16 v[116:117], v6 offset:12288
v_mfma_f32_16x16x32_bf16 v[140:143], v[76:79], v[40:43], v[140:143]
ds_read_b64_tr_b16 v[118:119], v6 offset:14336
v_mfma_f32_16x16x32_bf16 v[144:147], v[64:67], v[44:47], v[144:147]
ds_read_b128 v[92:95], v2 offset:57600
ds_read_b64_tr_b16 v[120:121], v7 offset:12288
v_mfma_f32_16x16x32_bf16 v[148:151], v[68:71], v[44:47], v[148:151]
ds_read_b64_tr_b16 v[122:123], v7 offset:14336
v_mfma_f32_16x16x32_bf16 v[152:155], v[72:75], v[44:47], v[152:155]
ds_read_b64_tr_b16 v[124:125], v8 offset:12288
v_mfma_f32_16x16x32_bf16 v[156:159], v[76:79], v[44:47], v[156:159]
ds_read_b64_tr_b16 v[126:127], v8 offset:14336
s_waitcnt lgkmcnt(0)
s_barrier
v_mfma_f32_16x16x32_bf16 v[128:131], v[96:99], v[80:83], v[128:131]
ds_read_b128 v[32:35], v2 offset:0
ds_read_b64_tr_b16 v[48:49], v5 offset:16384
v_mfma_f32_16x16x32_bf16 v[132:135], v[100:103], v[80:83], v[132:135]
ds_read_b64_tr_b16 v[50:51], v5 offset:18432
v_mfma_f32_16x16x32_bf16 v[136:139], v[104:107], v[80:83], v[136:139]
ds_read_b64_tr_b16 v[52:53], v6 offset:16384
v_mfma_f32_16x16x32_bf16 v[140:143], v[108:111], v[80:83], v[140:143]
ds_read_b64_tr_b16 v[54:55], v6 offset:18432
v_mfma_f32_16x16x32_bf16 v[144:147], v[96:99], v[84:87], v[144:147]
ds_read_b128 v[36:39], v2 offset:256
ds_read_b64_tr_b16 v[56:57], v7 offset:16384
v_mfma_f32_16x16x32_bf16 v[148:151], v[100:103], v[84:87], v[148:151]
ds_read_b64_tr_b16 v[58:59], v7 offset:18432
v_mfma_f32_16x16x32_bf16 v[152:155], v[104:107], v[84:87], v[152:155]
ds_read_b64_tr_b16 v[60:61], v8 offset:16384
v_mfma_f32_16x16x32_bf16 v[156:159], v[108:111], v[84:87], v[156:159]
ds_read_b64_tr_b16 v[62:63], v8 offset:18432
v_mfma_f32_16x16x32_bf16 v[128:131], v[112:115], v[88:91], v[128:131]
ds_read_b128 v[40:43], v2 offset:8192
ds_read_b64_tr_b16 v[64:65], v5 offset:20480
v_mfma_f32_16x16x32_bf16 v[132:135], v[116:119], v[88:91], v[132:135]
ds_read_b64_tr_b16 v[66:67], v5 offset:22528
v_mfma_f32_16x16x32_bf16 v[136:139], v[120:123], v[88:91], v[136:139]
ds_read_b64_tr_b16 v[68:69], v6 offset:20480
v_mfma_f32_16x16x32_bf16 v[140:143], v[124:127], v[88:91], v[140:143]
ds_read_b64_tr_b16 v[70:71], v6 offset:22528
v_mfma_f32_16x16x32_bf16 v[144:147], v[112:115], v[92:95], v[144:147]
ds_read_b128 v[44:47], v2 offset:8448
ds_read_b64_tr_b16 v[72:73], v7 offset:20480
v_mfma_f32_16x16x32_bf16 v[148:151], v[116:119], v[92:95], v[148:151]
ds_read_b64_tr_b16 v[74:75], v7 offset:22528
v_mfma_f32_16x16x32_bf16 v[152:155], v[120:123], v[92:95], v[152:155]
ds_read_b64_tr_b16 v[76:77], v8 offset:20480
v_mfma_f32_16x16x32_bf16 v[156:159], v[124:127], v[92:95], v[156:159]
ds_read_b64_tr_b16 v[78:79], v8 offset:22528
s_waitcnt lgkmcnt(0)
s_barrier
v_mfma_f32_16x16x32_bf16 v[128:131], v[48:51], v[32:35], v[128:131]
ds_read_b128 v[80:83], v2 offset:16384
ds_read_b64_tr_b16 v[96:97], v5 offset:24576
v_mfma_f32_16x16x32_bf16 v[132:135], v[52:55], v[32:35], v[132:135]
ds_read_b64_tr_b16 v[98:99], v5 offset:26624
v_mfma_f32_16x16x32_bf16 v[136:139], v[56:59], v[32:35], v[136:139]
ds_read_b64_tr_b16 v[100:101], v6 offset:24576
v_mfma_f32_16x16x32_bf16 v[140:143], v[60:63], v[32:35], v[140:143]
ds_read_b64_tr_b16 v[102:103], v6 offset:26624
v_mfma_f32_16x16x32_bf16 v[144:147], v[48:51], v[36:39], v[144:147]
ds_read_b128 v[84:87], v2 offset:16640
ds_read_b64_tr_b16 v[104:105], v7 offset:24576
v_mfma_f32_16x16x32_bf16 v[148:151], v[52:55], v[36:39], v[148:151]
ds_read_b64_tr_b16 v[106:107], v7 offset:26624
v_mfma_f32_16x16x32_bf16 v[152:155], v[56:59], v[36:39], v[152:155]
ds_read_b64_tr_b16 v[108:109], v8 offset:24576
v_mfma_f32_16x16x32_bf16 v[156:159], v[60:63], v[36:39], v[156:159]
ds_read_b64_tr_b16 v[110:111], v8 offset:26624
v_mfma_f32_16x16x32_bf16 v[128:131], v[64:67], v[40:43], v[128:131]
ds_read_b128 v[88:91], v2 offset:24576
ds_read_b64_tr_b16 v[112:113], v5 offset:28672
v_mfma_f32_16x16x32_bf16 v[132:135], v[68:71], v[40:43], v[132:135]
ds_read_b64_tr_b16 v[114:115], v5 offset:30720
v_mfma_f32_16x16x32_bf16 v[136:139], v[72:75], v[40:43], v[136:139]
ds_read_b64_tr_b16 v[116:117], v6 offset:28672
v_mfma_f32_16x16x32_bf16 v[140:143], v[76:79], v[40:43], v[140:143]
ds_read_b64_tr_b16 v[118:119], v6 offset:30720
v_mfma_f32_16x16x32_bf16 v[144:147], v[64:67], v[44:47], v[144:147]
ds_read_b128 v[92:95], v2 offset:24832
ds_read_b64_tr_b16 v[120:121], v7 offset:28672
v_mfma_f32_16x16x32_bf16 v[148:151], v[68:71], v[44:47], v[148:151]
ds_read_b64_tr_b16 v[122:123], v7 offset:30720
v_mfma_f32_16x16x32_bf16 v[152:155], v[72:75], v[44:47], v[152:155]
ds_read_b64_tr_b16 v[124:125], v8 offset:28672
v_mfma_f32_16x16x32_bf16 v[156:159], v[76:79], v[44:47], v[156:159]
ds_read_b64_tr_b16 v[126:127], v8 offset:30720
s_waitcnt lgkmcnt(0)
s_barrier
v_mfma_f32_16x16x32_bf16 v[128:131], v[96:99], v[80:83], v[128:131]
ds_read_b128 v[32:35], v2 offset:32768
ds_read_b64_tr_b16 v[48:49], v5 offset:32768
v_mfma_f32_16x16x32_bf16 v[132:135], v[100:103], v[80:83], v[132:135]
ds_read_b64_tr_b16 v[50:51], v5 offset:34816
v_mfma_f32_16x16x32_bf16 v[136:139], v[104:107], v[80:83], v[136:139]
ds_read_b64_tr_b16 v[52:53], v6 offset:32768
v_mfma_f32_16x16x32_bf16 v[140:143], v[108:111], v[80:83], v[140:143]
ds_read_b64_tr_b16 v[54:55], v6 offset:34816
v_mfma_f32_16x16x32_bf16 v[144:147], v[96:99], v[84:87], v[144:147]
ds_read_b128 v[36:39], v2 offset:33024
ds_read_b64_tr_b16 v[56:57], v7 offset:32768
v_mfma_f32_16x16x32_bf16 v[148:151], v[100:103], v[84:87], v[148:151]
ds_read_b64_tr_b16 v[58:59], v7 offset:34816
v_mfma_f32_16x16x32_bf16 v[152:155], v[104:107], v[84:87], v[152:155]
ds_read_b64_tr_b16 v[60:61], v8 offset:32768
v_mfma_f32_16x16x32_bf16 v[156:159], v[108:111], v[84:87], v[156:159]
ds_read_b64_tr_b16 v[62:63], v8 offset:34816
v_mfma_f32_16x16x32_bf16 v[128:131], v[112:115], v[88:91], v[128:131]
ds_read_b128 v[40:43], v2 offset:40960
ds_read_b64_tr_b16 v[64:65], v5 offset:36864
v_mfma_f32_16x16x32_bf16 v[132:135], v[116:119], v[88:91], v[132:135]
ds_read_b64_tr_b16 v[66:67], v5 offset:38912
v_mfma_f32_16x16x32_bf16 v[136:139], v[120:123], v[88:91], v[136:139]
ds_read_b64_tr_b16 v[68:69], v6 offset:36864
v_mfma_f32_16x16x32_bf16 v[140:143], v[124:127], v[88:91], v[140:143]
ds_read_b64_tr_b16 v[70:71], v6 offset:38912
v_mfma_f32_16x16x32_bf16 v[144:147], v[112:115], v[92:95], v[144:147]
ds_read_b128 v[44:47], v2 offset:41216
ds_read_b64_tr_b16 v[72:73], v7 offset:36864
v_mfma_f32_16x16x32_bf16 v[148:151], v[116:119], v[92:95], v[148:151]
ds_read_b64_tr_b16 v[74:75], v7 offset:38912
v_mfma_f32_16x16x32_bf16 v[152:155], v[120:123], v[92:95], v[152:155]
ds_read_b64_tr_b16 v[76:77], v8 offset:36864
v_mfma_f32_16x16x32_bf16 v[156:159], v[124:127], v[92:95], v[156:159]
ds_read_b64_tr_b16 v[78:79], v8 offset:38912
s_waitcnt lgkmcnt(0)
s_barrier
v_mfma_f32_16x16x32_bf16 v[128:131], v[48:51], v[32:35], v[128:131]
ds_read_b128 v[80:83], v2 offset:49152
ds_read_b64_tr_b16 v[96:97], v5 offset:40960
v_mfma_f32_16x16x32_bf16 v[132:135], v[52:55], v[32:35], v[132:135]
ds_read_b64_tr_b16 v[98:99], v5 offset:43008
v_mfma_f32_16x16x32_bf16 v[136:139], v[56:59], v[32:35], v[136:139]
ds_read_b64_tr_b16 v[100:101], v6 offset:40960
v_mfma_f32_16x16x32_bf16 v[140:143], v[60:63], v[32:35], v[140:143]
ds_read_b64_tr_b16 v[102:103], v6 offset:43008
v_mfma_f32_16x16x32_bf16 v[144:147], v[48:51], v[36:39], v[144:147]
ds_read_b128 v[84:87], v2 offset:49408
ds_read_b64_tr_b16 v[104:105], v7 offset:40960
v_mfma_f32_16x16x32_bf16 v[148:151], v[52:55], v[36:39], v[148:151]
ds_read_b64_tr_b16 v[106:107], v7 offset:43008
v_mfma_f32_16x16x32_bf16 v[152:155], v[56:59], v[36:39], v[152:155]
ds_read_b64_tr_b16 v[108:109], v8 offset:40960
v_mfma_f32_16x16x32_bf16 v[156:159], v[60:63], v[36:39], v[156:159]
ds_read_b64_tr_b16 v[110:111], v8 offset:43008
v_mfma_f32_16x16x32_bf16 v[128:131], v[64:67], v[40:43], v[128:131]
ds_read_b128 v[88:91], v2 offset:57344
ds_read_b64_tr_b16 v[112:113], v5 offset:45056
v_mfma_f32_16x16x32_bf16 v[132:135], v[68:71], v[40:43], v[132:135]
ds_read_b64_tr_b16 v[114:115], v5 offset:47104
v_mfma_f32_16x16x32_bf16 v[136:139], v[72:75], v[40:43], v[136:139]
ds_read_b64_tr_b16 v[116:117], v6 offset:45056
v_mfma_f32_16x16x32_bf16 v[140:143], v[76:79], v[40:43], v[140:143]
ds_read_b64_tr_b16 v[118:119], v6 offset:47104
v_mfma_f32_16x16x32_bf16 v[144:147], v[64:67], v[44:47], v[144:147]
ds_read_b128 v[92:95], v2 offset:57600
ds_read_b64_tr_b16 v[120:121], v7 offset:45056
v_mfma_f32_16x16x32_bf16 v[148:151], v[68:71], v[44:47], v[148:151]
ds_read_b64_tr_b16 v[122:123], v7 offset:47104
v_mfma_f32_16x16x32_bf16 v[152:155], v[72:75], v[44:47], v[152:155]
ds_read_b64_tr_b16 v[124:125], v8 offset:45056
v_mfma_f32_16x16x32_bf16 v[156:159], v[76:79], v[44:47], v[156:159]
ds_read_b64_tr_b16 v[126:127], v8 offset:47104
s_waitcnt lgkmcnt(0)
s_barrier
v_mfma_f32_16x16x32_bf16 v[128:131], v[96:99], v[80:83], v[128:131]
v_mfma_f32_16x16x32_bf16 v[132:135], v[100:103], v[80:83], v[132:135]
v_mfma_f32_16x16x32_bf16 v[136:139], v[104:107], v[80:83], v[136:139]
v_mfma_f32_16x16x32_bf16 v[140:143], v[108:111], v[80:83], v[140:143]
v_mfma_f32_16x16x32_bf16 v[144:147], v[96:99], v[84:87], v[144:147]
v_mfma_f32_16x16x32_bf16 v[148:151], v[100:103], v[84:87], v[148:151]
v_mfma_f32_16x16x32_bf16 v[152:155], v[104:107], v[84:87], v[152:155]
v_mfma_f32_16x16x32_bf16 v[156:159], v[108:111], v[84:87], v[156:159]
v_mfma_f32_16x16x32_bf16 v[128:131], v[112:115], v[88:91], v[128:131]
v_mfma_f32_16x16x32_bf16 v[132:135], v[116:119], v[88:91], v[132:135]
v_mfma_f32_16x16x32_bf16 v[136:139], v[120:123], v[88:91], v[136:139]
v_mfma_f32_16x16x32_bf16 v[140:143], v[124:127], v[88:91], v[140:143]
v_mfma_f32_16x16x32_bf16 v[144:147], v[112:115], v[92:95], v[144:147]
v_mfma_f32_16x16x32_bf16 v[148:151], v[116:119], v[92:95], v[148:151]
v_mfma_f32_16x16x32_bf16 v[152:155], v[120:123], v[92:95], v[152:155]
v_mfma_f32_16x16x32_bf16 v[156:159], v[124:127], v[92:95], v[156:159]
s_nop 4
v_cvt_pk_bf16_f32 v96, v128, v129
v_cvt_pk_bf16_f32 v97, v130, v131
v_cvt_pk_bf16_f32 v98, v132, v133
v_cvt_pk_bf16_f32 v99, v134, v135
buffer_store_dwordx4 v[96:99], v2, s[20:23], 0 offen offset:0 sc1
ds_write_b128 v4, v[96:99] offset:0
v_cvt_pk_bf16_f32 v100, v136, v137
v_cvt_pk_bf16_f32 v101, v138, v139
v_cvt_pk_bf16_f32 v102, v140, v141
v_cvt_pk_bf16_f32 v103, v142, v143
buffer_store_dwordx4 v[100:103], v2, s[20:23], s50 offen offset:0 sc1
ds_write_b128 v4, v[100:103] offset:8192
v_cvt_pk_bf16_f32 v104, v144, v145
v_cvt_pk_bf16_f32 v105, v146, v147
v_cvt_pk_bf16_f32 v106, v148, v149
v_cvt_pk_bf16_f32 v107, v150, v151
buffer_store_dwordx4 v[104:107], v2, s[20:23], 0 offen offset:256 sc1
ds_write_b128 v4, v[104:107] offset:256
v_cvt_pk_bf16_f32 v108, v152, v153
v_cvt_pk_bf16_f32 v109, v154, v155
v_cvt_pk_bf16_f32 v110, v156, v157
v_cvt_pk_bf16_f32 v111, v158, v159
buffer_store_dwordx4 v[108:111], v2, s[20:23], s50 offen offset:256 sc1
ds_write_b128 v4, v[108:111] offset:8448
v_pk_mul_f32 v[118:119], v[128:129], v[128:129]
v_pk_mul_f32 v[122:123], v[144:145], v[144:145]
v_pk_fma_f32 v[118:119], v[130:131], v[130:131], v[118:119]
v_pk_add_f32 v[116:117], v[130:131], v[128:129]
v_pk_fma_f32 v[122:123], v[146:147], v[146:147], v[122:123]
v_pk_add_f32 v[120:121], v[146:147], v[144:145]
v_pk_fma_f32 v[118:119], v[132:133], v[132:133], v[118:119]
v_pk_add_f32 v[116:117], v[132:133], v[116:117]
v_pk_fma_f32 v[122:123], v[148:149], v[148:149], v[122:123]
v_pk_add_f32 v[120:121], v[148:149], v[120:121]
v_pk_fma_f32 v[118:119], v[134:135], v[134:135], v[118:119]
v_pk_add_f32 v[116:117], v[134:135], v[116:117]
v_pk_fma_f32 v[122:123], v[150:151], v[150:151], v[122:123]
v_pk_add_f32 v[120:121], v[150:151], v[120:121]
v_pk_fma_f32 v[118:119], v[136:137], v[136:137], v[118:119]
v_pk_add_f32 v[116:117], v[136:137], v[116:117]
v_pk_fma_f32 v[122:123], v[152:153], v[152:153], v[122:123]
v_pk_add_f32 v[120:121], v[152:153], v[120:121]
v_pk_fma_f32 v[118:119], v[138:139], v[138:139], v[118:119]
v_pk_add_f32 v[116:117], v[138:139], v[116:117]
v_pk_fma_f32 v[122:123], v[154:155], v[154:155], v[122:123]
v_pk_add_f32 v[120:121], v[154:155], v[120:121]
v_pk_fma_f32 v[118:119], v[140:141], v[140:141], v[118:119]
v_pk_add_f32 v[116:117], v[140:141], v[116:117]
v_pk_fma_f32 v[122:123], v[156:157], v[156:157], v[122:123]
v_pk_add_f32 v[120:121], v[156:157], v[120:121]
v_pk_fma_f32 v[118:119], v[142:143], v[142:143], v[118:119]
v_pk_add_f32 v[116:117], v[142:143], v[116:117]
v_pk_fma_f32 v[122:123], v[158:159], v[158:159], v[122:123]
v_pk_add_f32 v[120:121], v[158:159], v[120:121]
v_add_f32 v112, v116, v117
v_add_f32 v113, v118, v119
v_add_f32 v114, v120, v121
v_add_f32 v115, v122, v123
s_nop 1
v_permlane32_swap_b32 v112, v114
v_permlane32_swap_b32 v113, v115
v_add_f32 v112, v112, v114
v_add_f32 v113, v113, v115
s_nop 1
v_permlane16_swap_b32 v112, v113
v_add_f32 v112, v112, v113
buffer_store_dword v112, v22, s[24:27], 0 offen sc1
s_waitcnt vmcnt(0) lgkmcnt(0)
s_barrier
s_cmp_lg_u32 s36, 0
s_cbranch_scc1 Lsig_25
s_add_u32 s43, s34, 16
s_lshl_b32 s43, s43, 7
v_mov_b32 v19, s43
v_mov_b32 v20, 1
s_mov_b64 exec, 1
buffer_atomic_add v20, v19, s[56:59], 0 offen sc1
s_mov_b64 exec, -1
Lsig_25:
s_cmp_lt_u32 s36, 2
s_cbranch_scc1 Lopf_26
s_and_b32 s43, s36, 1
s_lshl_b32 s43, s43, 13
v_lshlrev_b32 v19, 7, v1
buffer_load_dword v31, v19, s[20:23], s43 offen sc1
Lopf_26:
s_lshl_b32 s53, s47, 2
v_lshlrev_b32 v19, 11, v18
v_lshl_add_u32 v19, v17, 4, v19
s_lshl_b32 s43, s46, 10
v_add_u32 v2, s43, v19
v_add_u32 v3, 49152, v2
v_add_u32 v4, 98304, v2
v_lshrrev_b32 v19, 2, v17
v_lshl_add_u32 v20, v18, 2, v19
v_and_b32 v21, 7, v20
v_lshlrev_b32 v20, 8, v20
v_and_b32 v19, 3, v1
v_lshl_add_u32 v20, v19, 3, v20
s_add_u32 s43, s53, 0
v_xor_b32 v19, s43, v21
v_lshl_add_u32 v5, v19, 5, v20
s_add_u32 s43, s53, 1
v_xor_b32 v19, s43, v21
v_lshl_add_u32 v6, v19, 5, v20
s_add_u32 s43, s53, 2
v_xor_b32 v19, s43, v21
v_lshl_add_u32 v7, v19, 5, v20
s_add_u32 s43, s53, 3
v_xor_b32 v19, s43, v21
v_lshl_add_u32 v8, v19, 5, v20
v_add_u32 v9, 49152, v5
v_add_u32 v10, 49152, v6
v_add_u32 v11, 49152, v7
v_add_u32 v12, 49152, v8
v_add_u32 v13, 98304, v5
v_add_u32 v14, 98304, v6
v_add_u32 v15, 98304, v7
v_add_u32 v16, 98304, v8
ds_read_b128 v[32:35], v4 offset:0
ds_read_b64_tr_b16 v[48:49], v13 offset:16384
ds_read_b64_tr_b16 v[50:51], v13 offset:20480
ds_read_b128 v[36:39], v4 offset:256
ds_read_b128 v[40:43], v4 offset:512
ds_read_b128 v[44:47], v4 offset:768
ds_read_b64_tr_b16 v[64:65], v13 offset:32768
ds_read_b64_tr_b16 v[66:67], v13 offset:36864
ds_read_b64_tr_b16 v[52:53], v14 offset:16384
ds_read_b64_tr_b16 v[54:55], v14 offset:20480
ds_read_b64_tr_b16 v[68:69], v14 offset:32768
ds_read_b64_tr_b16 v[70:71], v14 offset:36864
ds_read_b64_tr_b16 v[56:57], v15 offset:16384
ds_read_b64_tr_b16 v[58:59], v15 offset:20480
ds_read_b64_tr_b16 v[72:73], v15 offset:32768
ds_read_b64_tr_b16 v[74:75], v15 offset:36864
ds_read_b64_tr_b16 v[60:61], v16 offset:16384
ds_read_b64_tr_b16 v[62:63], v16 offset:20480
ds_read_b64_tr_b16 v[76:77], v16 offset:32768
ds_read_b64_tr_b16 v[78:79], v16 offset:36864
s_waitcnt lgkmcnt(0)
v_mfma_f32_16x16x32_bf16 v[128:131], v[48:51], v[32:35], 0
ds_read_b128 v[80:83], v4 offset:8192
v_mfma_f32_16x16x32_bf16 v[132:135], v[48:51], v[36:39], 0
ds_read_b64_tr_b16 v[96:97], v13 offset:24576
v_mfma_f32_16x16x32_bf16 v[136:139], v[48:51], v[40:43], 0
ds_read_b64_tr_b16 v[98:99], v13 offset:28672
v_mfma_f32_16x16x32_bf16 v[140:143], v[48:51], v[44:47], 0
ds_read_b128 v[84:87], v4 offset:8448
v_mfma_f32_16x16x32_bf16 v[204:207], v[64:67], v[44:47], 0
ds_read_b128 v[88:91], v4 offset:8704
v_mfma_f32_16x16x32_bf16 v[200:203], v[64:67], v[40:43], 0
ds_read_b128 v[92:95], v4 offset:8960
v_mfma_f32_16x16x32_bf16 v[196:199], v[64:67], v[36:39], 0
ds_read_b64_tr_b16 v[112:113], v13 offset:40960
v_mfma_f32_16x16x32_bf16 v[192:195], v[64:67], v[32:35], 0
ds_read_b64_tr_b16 v[114:115], v13 offset:45056
v_mfma_f32_16x16x32_bf16 v[144:147], v[52:55], v[32:35], 0
ds_read_b64_tr_b16 v[100:101], v14 offset:24576
v_mfma_f32_16x16x32_bf16 v[148:151], v[52:55], v[36:39], 0
ds_read_b64_tr_b16 v[102:103], v14 offset:28672
v_mfma_f32_16x16x32_bf16 v[152:155], v[52:55], v[40:43], 0
ds_read_b64_tr_b16 v[116:117], v14 offset:40960
v_mfma_f32_16x16x32_bf16 v[156:159], v[52:55], v[44:47], 0
ds_read_b64_tr_b16 v[118:119], v14 offset:45056
v_mfma_f32_16x16x32_bf16 v[220:223], v[68:71], v[44:47], 0
ds_read_b64_tr_b16 v[104:105], v15 offset:24576
v_mfma_f32_16x16x32_bf16 v[216:219], v[68:71], v[40:43], 0
ds_read_b64_tr_b16 v[106:107], v15 offset:28672
v_mfma_f32_16x16x32_bf16 v[212:215], v[68:71], v[36:39], 0
ds_read_b64_tr_b16 v[120:121], v15 offset:40960
v_mfma_f32_16x16x32_bf16 v[208:211], v[68:71], v[32:35], 0
ds_read_b64_tr_b16 v[122:123], v15 offset:45056
v_mfma_f32_16x16x32_bf16 v[160:163], v[56:59], v[32:35], 0
ds_read_b64_tr_b16 v[108:109], v16 offset:24576
v_mfma_f32_16x16x32_bf16 v[164:167], v[56:59], v[36:39], 0
ds_read_b64_tr_b16 v[110:111], v16 offset:28672
v_mfma_f32_16x16x32_bf16 v[168:171], v[56:59], v[40:43], 0
ds_read_b64_tr_b16 v[124:125], v16 offset:40960
v_mfma_f32_16x16x32_bf16 v[172:175], v[56:59], v[44:47], 0
ds_read_b64_tr_b16 v[126:127], v16 offset:45056
v_mfma_f32_16x16x32_bf16 v[236:239], v[72:75], v[44:47], 0
v_mfma_f32_16x16x32_bf16 v[232:235], v[72:75], v[40:43], 0
v_mfma_f32_16x16x32_bf16 v[228:231], v[72:75], v[36:39], 0
v_mfma_f32_16x16x32_bf16 v[224:227], v[72:75], v[32:35], 0
v_mfma_f32_16x16x32_bf16 v[176:179], v[60:63], v[32:35], 0
v_mfma_f32_16x16x32_bf16 v[180:183], v[60:63], v[36:39], 0
v_mfma_f32_16x16x32_bf16 v[184:187], v[60:63], v[40:43], 0
v_mfma_f32_16x16x32_bf16 v[188:191], v[60:63], v[44:47], 0
v_mfma_f32_16x16x32_bf16 v[252:255], v[76:79], v[44:47], 0
v_mfma_f32_16x16x32_bf16 v[248:251], v[76:79], v[40:43], 0
v_mfma_f32_16x16x32_bf16 v[244:247], v[76:79], v[36:39], 0
v_mfma_f32_16x16x32_bf16 v[240:243], v[76:79], v[32:35], 0
s_waitcnt lgkmcnt(0)
v_mfma_f32_16x16x32_bf16 v[128:131], v[96:99], v[80:83], v[128:131]
v_mfma_f32_16x16x32_bf16 v[132:135], v[96:99], v[84:87], v[132:135]
v_mfma_f32_16x16x32_bf16 v[136:139], v[96:99], v[88:91], v[136:139]
v_mfma_f32_16x16x32_bf16 v[140:143], v[96:99], v[92:95], v[140:143]
v_mfma_f32_16x16x32_bf16 v[204:207], v[112:115], v[92:95], v[204:207]
v_mfma_f32_16x16x32_bf16 v[200:203], v[112:115], v[88:91], v[200:203]
v_mfma_f32_16x16x32_bf16 v[196:199], v[112:115], v[84:87], v[196:199]
v_mfma_f32_16x16x32_bf16 v[192:195], v[112:115], v[80:83], v[192:195]
v_mfma_f32_16x16x32_bf16 v[144:147], v[100:103], v[80:83], v[144:147]
v_mfma_f32_16x16x32_bf16 v[148:151], v[100:103], v[84:87], v[148:151]
v_mfma_f32_16x16x32_bf16 v[152:155], v[100:103], v[88:91], v[152:155]
v_mfma_f32_16x16x32_bf16 v[156:159], v[100:103], v[92:95], v[156:159]
v_mfma_f32_16x16x32_bf16 v[220:223], v[116:119], v[92:95], v[220:223]
v_mfma_f32_16x16x32_bf16 v[216:219], v[116:119], v[88:91], v[216:219]
v_mfma_f32_16x16x32_bf16 v[212:215], v[116:119], v[84:87], v[212:215]
v_mfma_f32_16x16x32_bf16 v[208:211], v[116:119], v[80:83], v[208:211]
v_mfma_f32_16x16x32_bf16 v[160:163], v[104:107], v[80:83], v[160:163]
v_mfma_f32_16x16x32_bf16 v[164:167], v[104:107], v[84:87], v[164:167]
v_mfma_f32_16x16x32_bf16 v[168:171], v[104:107], v[88:91], v[168:171]
v_mfma_f32_16x16x32_bf16 v[172:175], v[104:107], v[92:95], v[172:175]
v_mfma_f32_16x16x32_bf16 v[236:239], v[120:123], v[92:95], v[236:239]
v_mfma_f32_16x16x32_bf16 v[232:235], v[120:123], v[88:91], v[232:235]
v_mfma_f32_16x16x32_bf16 v[228:231], v[120:123], v[84:87], v[228:231]
v_mfma_f32_16x16x32_bf16 v[224:227], v[120:123], v[80:83], v[224:227]
v_mfma_f32_16x16x32_bf16 v[176:179], v[108:111], v[80:83], v[176:179]
v_mfma_f32_16x16x32_bf16 v[180:183], v[108:111], v[84:87], v[180:183]
v_mfma_f32_16x16x32_bf16 v[184:187], v[108:111], v[88:91], v[184:187]
v_mfma_f32_16x16x32_bf16 v[188:191], v[108:111], v[92:95], v[188:191]
v_mfma_f32_16x16x32_bf16 v[252:255], v[124:127], v[92:95], v[252:255]
v_mfma_f32_16x16x32_bf16 v[248:251], v[124:127], v[88:91], v[248:251]
v_mfma_f32_16x16x32_bf16 v[244:247], v[124:127], v[84:87], v[244:247]
v_mfma_f32_16x16x32_bf16 v[240:243], v[124:127], v[80:83], v[240:243]
s_mul_i32 s43, s49, 192
s_and_b32 s43, s43, 0xffffff80
s_add_u32 s43, s43, 4096
s_cmp_eq_u32 s51, 1
s_cselect_b32 s8, s4, s6
s_cselect_b32 s9, s5, s7
s_sub_u32 s10, 7340032, s43
s_lshl_b32 s44, s34, 18
s_add_u32 s44, s44, 4194304
s_movk_i32 s38, 28672
s_cmp_eq_u32 s51, 0
s_cselect_b32 s8, s32, s8
s_cselect_b32 s9, s33, s9
s_cselect_b32 s10, 262144, s10
s_cselect_b32 s43, s44, s43
s_cselect_b32 s38, 1024, s38
s_cselect_b32 s45, 0, -1
s_add_u32 s8, s8, s43
s_addc_u32 s9, s9, 0
s_mov_b32 s11, 0x20000
s_lshl_b32 s40, s38, 4
s_add_u32 s42, s35, 17
s_lshl_b32 s39, s51, 14
v_lshrrev_b32 v19, 4, v1
v_lshlrev_b32 v20, 5, v19
v_mul_u32_u24 v19, 6912, v19
v_and_b32 v19, s45, v19
v_and_b32 v20, s45, v20
v_lshlrev_b32 v21, 4, v1
v_xor_b32 v21, v21, v20
v_add_u32 v22, v21, v19
s_and_b32 s45, s45, 128
v_xor_b32 v23, s45, v22
s_mul_i32 s43, s34, 917504
s_mul_i32 s44, s35, 16384
s_add_u32 s43, s43, s44
s_add_u32 s43, s43, 8388608
s_add_u32 s24, s32, s43
s_addc_u32 s25, s33, 0
s_mov_b32 s26, 278528
s_mov_b32 s27, 0x20000
s_mov_b32 s53, 262144
s_lshl_b32 s43, s47, 13
s_lshl_b32 s44, s46, 10
s_add_u32 s43, s43, s44
v_lshlrev_b32 v19, 11, v18
v_lshl_add_u32 v19, v17, 4, v19
v_add_u32 v27, s43, v19
s_lshl_b32 s43, s34, 18
s_lshl_b32 s44, s35, 7
s_add_u32 s43, s43, s44
s_add_u32 s16, s62, s43
s_addc_u32 s17, s63, 0
s_mov_b32 s18, 260224
s_mov_b32 s19, 0x20000
s_lshl_b32 s43, s46, 6
v_lshl_add_u32 v19, v17, 1, s43
v_lshlrev_b32 v19, 11, v19
v_and_b32 v20, 1, v18
v_lshl_add_u32 v19, v20, 5, v19
v_lshrrev_b32 v20, 1, v18
v_lshl_add_u32 v19, v20, 4, v19
s_lshl_b32 s43, s47, 6
v_add_u32 v28, s43, v19
s_lshl_b32 s43, s34, 4
s_add_u32 s43, s43, s35
s_xor_b32 s43, s43, 0
s_lshl_b32 s43, s43, 15
s_add_u32 s43, s43, 33554432
s_add_u32 s64, s32, s43
s_addc_u32 s65, s33, 0
s_mov_b32 s66, 32768
s_mov_b32 s67, 0x20000
s_lshl_b32 s43, s34, 4
s_add_u32 s43, s43, s35
s_xor_b32 s43, s43, 1
s_lshl_b32 s43, s43, 15
s_add_u32 s43, s43, 33554432
s_add_u32 s68, s32, s43
s_addc_u32 s69, s33, 0
s_mov_b32 s70, 32768
s_mov_b32 s71, 0x20000
s_lshl_b32 s43, s34, 18
s_add_u32 s12, s32, s43
s_addc_u32 s13, s33, 0
s_add_u32 s12, s12, 4194304
s_addc_u32 s13, s13, 0
s_mov_b32 s14, 262144
s_mov_b32 s15, 0x20000
v_lshlrev_b32 v21, 4, v1
s_lshl_b32 s54, s36, 11
s_add_u32 s43, s35, 1
s_and_b32 s43, s43, 15
s_lshl_b32 s43, s43, 14
s_add_u32 s30, s43, s54
s_add_u32 s43, s35, 2
s_and_b32 s43, s43, 15
s_lshl_b32 s43, s43, 14
s_add_u32 s31, s43, s54
s_barrier
s_add_u32 m0, s54, 0
s_add_u32 s43, s30, 0
buffer_load_dwordx4 v21, s[12:15], s43 offen sc1 lds
s_add_u32 m0, s54, 1024
s_add_u32 s43, s30, 1024
buffer_load_dwordx4 v21, s[12:15], s43 offen sc1 lds
s_add_u32 m0, s54, 49152
s_add_u32 s43, s31, 0
buffer_load_dwordx4 v21, s[12:15], s43 offen sc1 lds
s_add_u32 m0, s54, 50176
s_add_u32 s43, s31, 1024
buffer_load_dwordx4 v21, s[12:15], s43 offen sc1 lds
s_waitcnt vmcnt(2)
s_barrier
s_setprio 1
ds_read_b128 v[32:35], v2 offset:0
ds_read_b64_tr_b16 v[48:49], v5 offset:16384
ds_read_b64_tr_b16 v[50:51], v5 offset:20480
ds_read_b128 v[36:39], v2 offset:256
ds_read_b128 v[40:43], v2 offset:512
ds_read_b128 v[44:47], v2 offset:768
ds_read_b64_tr_b16 v[64:65], v5 offset:32768
ds_read_b64_tr_b16 v[66:67], v5 offset:36864
ds_read_b64_tr_b16 v[52:53], v6 offset:16384
ds_read_b64_tr_b16 v[54:55], v6 offset:20480
ds_read_b64_tr_b16 v[68:69], v6 offset:32768
ds_read_b64_tr_b16 v[70:71], v6 offset:36864
ds_read_b64_tr_b16 v[56:57], v7 offset:16384
ds_read_b64_tr_b16 v[58:59], v7 offset:20480
ds_read_b64_tr_b16 v[72:73], v7 offset:32768
ds_read_b64_tr_b16 v[74:75], v7 offset:36864
ds_read_b64_tr_b16 v[60:61], v8 offset:16384
ds_read_b64_tr_b16 v[62:63], v8 offset:20480
ds_read_b64_tr_b16 v[76:77], v8 offset:32768
ds_read_b64_tr_b16 v[78:79], v8 offset:36864
s_mov_b32 s41, 4
Lk3_27:
s_waitcnt lgkmcnt(0)
v_mfma_f32_16x16x32_bf16 v[128:131], v[48:51], v[32:35], v[128:131]
ds_read_b128 v[80:83], v2 offset:8192
v_mfma_f32_16x16x32_bf16 v[132:135], v[48:51], v[36:39], v[132:135]
ds_read_b64_tr_b16 v[96:97], v5 offset:24576
v_mfma_f32_16x16x32_bf16 v[136:139], v[48:51], v[40:43], v[136:139]
ds_read_b64_tr_b16 v[98:99], v5 offset:28672
v_mfma_f32_16x16x32_bf16 v[140:143], v[48:51], v[44:47], v[140:143]
ds_read_b128 v[84:87], v2 offset:8448
v_mfma_f32_16x16x32_bf16 v[204:207], v[64:67], v[44:47], v[204:207]
ds_read_b128 v[88:91], v2 offset:8704
v_mfma_f32_16x16x32_bf16 v[200:203], v[64:67], v[40:43], v[200:203]
ds_read_b128 v[92:95], v2 offset:8960
v_mfma_f32_16x16x32_bf16 v[196:199], v[64:67], v[36:39], v[196:199]
ds_read_b64_tr_b16 v[112:113], v5 offset:40960
v_mfma_f32_16x16x32_bf16 v[192:195], v[64:67], v[32:35], v[192:195]
ds_read_b64_tr_b16 v[114:115], v5 offset:45056
v_mfma_f32_16x16x32_bf16 v[144:147], v[52:55], v[32:35], v[144:147]
ds_read_b64_tr_b16 v[100:101], v6 offset:24576
v_mfma_f32_16x16x32_bf16 v[148:151], v[52:55], v[36:39], v[148:151]
ds_read_b64_tr_b16 v[102:103], v6 offset:28672
v_mfma_f32_16x16x32_bf16 v[152:155], v[52:55], v[40:43], v[152:155]
ds_read_b64_tr_b16 v[116:117], v6 offset:40960
v_mfma_f32_16x16x32_bf16 v[156:159], v[52:55], v[44:47], v[156:159]
ds_read_b64_tr_b16 v[118:119], v6 offset:45056
v_mfma_f32_16x16x32_bf16 v[220:223], v[68:71], v[44:47], v[220:223]
ds_read_b64_tr_b16 v[104:105], v7 offset:24576
v_mfma_f32_16x16x32_bf16 v[216:219], v[68:71], v[40:43], v[216:219]
ds_read_b64_tr_b16 v[106:107], v7 offset:28672
v_mfma_f32_16x16x32_bf16 v[212:215], v[68:71], v[36:39], v[212:215]
ds_read_b64_tr_b16 v[120:121], v7 offset:40960
v_mfma_f32_16x16x32_bf16 v[208:211], v[68:71], v[32:35], v[208:211]
ds_read_b64_tr_b16 v[122:123], v7 offset:45056
v_mfma_f32_16x16x32_bf16 v[160:163], v[56:59], v[32:35], v[160:163]
ds_read_b64_tr_b16 v[108:109], v8 offset:24576
v_mfma_f32_16x16x32_bf16 v[164:167], v[56:59], v[36:39], v[164:167]
ds_read_b64_tr_b16 v[110:111], v8 offset:28672
v_mfma_f32_16x16x32_bf16 v[168:171], v[56:59], v[40:43], v[168:171]
ds_read_b64_tr_b16 v[124:125], v8 offset:40960
v_mfma_f32_16x16x32_bf16 v[172:175], v[56:59], v[44:47], v[172:175]
ds_read_b64_tr_b16 v[126:127], v8 offset:45056
v_mfma_f32_16x16x32_bf16 v[236:239], v[72:75], v[44:47], v[236:239]
v_mfma_f32_16x16x32_bf16 v[232:235], v[72:75], v[40:43], v[232:235]
v_mfma_f32_16x16x32_bf16 v[228:231], v[72:75], v[36:39], v[228:231]
v_mfma_f32_16x16x32_bf16 v[224:227], v[72:75], v[32:35], v[224:227]
v_mfma_f32_16x16x32_bf16 v[176:179], v[60:63], v[32:35], v[176:179]
v_mfma_f32_16x16x32_bf16 v[180:183], v[60:63], v[36:39], v[180:183]
v_mfma_f32_16x16x32_bf16 v[184:187], v[60:63], v[40:43], v[184:187]
v_mfma_f32_16x16x32_bf16 v[188:191], v[60:63], v[44:47], v[188:191]
v_mfma_f32_16x16x32_bf16 v[252:255], v[76:79], v[44:47], v[252:255]
v_mfma_f32_16x16x32_bf16 v[248:251], v[76:79], v[40:43], v[248:251]
v_mfma_f32_16x16x32_bf16 v[244:247], v[76:79], v[36:39], v[244:247]
v_mfma_f32_16x16x32_bf16 v[240:243], v[76:79], v[32:35], v[240:243]
s_waitcnt vmcnt(0) lgkmcnt(0)
s_barrier
v_mfma_f32_16x16x32_bf16 v[128:131], v[96:99], v[80:83], v[128:131]
ds_read_b128 v[32:35], v3 offset:0
v_mfma_f32_16x16x32_bf16 v[132:135], v[96:99], v[84:87], v[132:135]
ds_read_b64_tr_b16 v[48:49], v9 offset:16384
v_mfma_f32_16x16x32_bf16 v[136:139], v[96:99], v[88:91], v[136:139]
ds_read_b64_tr_b16 v[50:51], v9 offset:20480
v_mfma_f32_16x16x32_bf16 v[140:143], v[96:99], v[92:95], v[140:143]
ds_read_b128 v[36:39], v3 offset:256
v_mfma_f32_16x16x32_bf16 v[204:207], v[112:115], v[92:95], v[204:207]
ds_read_b128 v[40:43], v3 offset:512
v_mfma_f32_16x16x32_bf16 v[200:203], v[112:115], v[88:91], v[200:203]
ds_read_b128 v[44:47], v3 offset:768
v_mfma_f32_16x16x32_bf16 v[196:199], v[112:115], v[84:87], v[196:199]
ds_read_b64_tr_b16 v[64:65], v9 offset:32768
v_mfma_f32_16x16x32_bf16 v[192:195], v[112:115], v[80:83], v[192:195]
ds_read_b64_tr_b16 v[66:67], v9 offset:36864
v_mfma_f32_16x16x32_bf16 v[144:147], v[100:103], v[80:83], v[144:147]
ds_read_b64_tr_b16 v[52:53], v10 offset:16384
v_mfma_f32_16x16x32_bf16 v[148:151], v[100:103], v[84:87], v[148:151]
ds_read_b64_tr_b16 v[54:55], v10 offset:20480
v_mfma_f32_16x16x32_bf16 v[152:155], v[100:103], v[88:91], v[152:155]
ds_read_b64_tr_b16 v[68:69], v10 offset:32768
v_mfma_f32_16x16x32_bf16 v[156:159], v[100:103], v[92:95], v[156:159]
ds_read_b64_tr_b16 v[70:71], v10 offset:36864
v_mfma_f32_16x16x32_bf16 v[220:223], v[116:119], v[92:95], v[220:223]
ds_read_b64_tr_b16 v[56:57], v11 offset:16384
v_mfma_f32_16x16x32_bf16 v[216:219], v[116:119], v[88:91], v[216:219]
ds_read_b64_tr_b16 v[58:59], v11 offset:20480
v_mfma_f32_16x16x32_bf16 v[212:215], v[116:119], v[84:87], v[212:215]
ds_read_b64_tr_b16 v[72:73], v11 offset:32768
v_mfma_f32_16x16x32_bf16 v[208:211], v[116:119], v[80:83], v[208:211]
ds_read_b64_tr_b16 v[74:75], v11 offset:36864
v_mfma_f32_16x16x32_bf16 v[160:163], v[104:107], v[80:83], v[160:163]
ds_read_b64_tr_b16 v[60:61], v12 offset:16384
v_mfma_f32_16x16x32_bf16 v[164:167], v[104:107], v[84:87], v[164:167]
ds_read_b64_tr_b16 v[62:63], v12 offset:20480
v_mfma_f32_16x16x32_bf16 v[168:171], v[104:107], v[88:91], v[168:171]
ds_read_b64_tr_b16 v[76:77], v12 offset:32768
v_mfma_f32_16x16x32_bf16 v[172:175], v[104:107], v[92:95], v[172:175]
ds_read_b64_tr_b16 v[78:79], v12 offset:36864
v_mfma_f32_16x16x32_bf16 v[236:239], v[120:123], v[92:95], v[236:239]
v_mfma_f32_16x16x32_bf16 v[232:235], v[120:123], v[88:91], v[232:235]
v_mfma_f32_16x16x32_bf16 v[228:231], v[120:123], v[84:87], v[228:231]
v_mfma_f32_16x16x32_bf16 v[224:227], v[120:123], v[80:83], v[224:227]
v_mfma_f32_16x16x32_bf16 v[176:179], v[108:111], v[80:83], v[176:179]
v_mfma_f32_16x16x32_bf16 v[180:183], v[108:111], v[84:87], v[180:183]
v_mfma_f32_16x16x32_bf16 v[184:187], v[108:111], v[88:91], v[184:187]
v_mfma_f32_16x16x32_bf16 v[188:191], v[108:111], v[92:95], v[188:191]
v_mfma_f32_16x16x32_bf16 v[252:255], v[124:127], v[92:95], v[252:255]
v_mfma_f32_16x16x32_bf16 v[248:251], v[124:127], v[88:91], v[248:251]
v_mfma_f32_16x16x32_bf16 v[244:247], v[124:127], v[84:87], v[244:247]
v_mfma_f32_16x16x32_bf16 v[240:243], v[124:127], v[80:83], v[240:243]
s_waitcnt lgkmcnt(0)
v_mfma_f32_16x16x32_bf16 v[128:131], v[48:51], v[32:35], v[128:131]
ds_read_b128 v[80:83], v3 offset:8192
v_mfma_f32_16x16x32_bf16 v[132:135], v[48:51], v[36:39], v[132:135]
ds_read_b64_tr_b16 v[96:97], v9 offset:24576
v_mfma_f32_16x16x32_bf16 v[136:139], v[48:51], v[40:43], v[136:139]
ds_read_b64_tr_b16 v[98:99], v9 offset:28672
v_mfma_f32_16x16x32_bf16 v[140:143], v[48:51], v[44:47], v[140:143]
ds_read_b128 v[84:87], v3 offset:8448
v_mfma_f32_16x16x32_bf16 v[204:207], v[64:67], v[44:47], v[204:207]
ds_read_b128 v[88:91], v3 offset:8704
v_mfma_f32_16x16x32_bf16 v[200:203], v[64:67], v[40:43], v[200:203]
ds_read_b128 v[92:95], v3 offset:8960
v_mfma_f32_16x16x32_bf16 v[196:199], v[64:67], v[36:39], v[196:199]
ds_read_b64_tr_b16 v[112:113], v9 offset:40960
v_mfma_f32_16x16x32_bf16 v[192:195], v[64:67], v[32:35], v[192:195]
ds_read_b64_tr_b16 v[114:115], v9 offset:45056
v_mfma_f32_16x16x32_bf16 v[144:147], v[52:55], v[32:35], v[144:147]
ds_read_b64_tr_b16 v[100:101], v10 offset:24576
v_mfma_f32_16x16x32_bf16 v[148:151], v[52:55], v[36:39], v[148:151]
ds_read_b64_tr_b16 v[102:103], v10 offset:28672
v_mfma_f32_16x16x32_bf16 v[152:155], v[52:55], v[40:43], v[152:155]
ds_read_b64_tr_b16 v[116:117], v10 offset:40960
v_mfma_f32_16x16x32_bf16 v[156:159], v[52:55], v[44:47], v[156:159]
ds_read_b64_tr_b16 v[118:119], v10 offset:45056
v_mfma_f32_16x16x32_bf16 v[220:223], v[68:71], v[44:47], v[220:223]
ds_read_b64_tr_b16 v[104:105], v11 offset:24576
v_mfma_f32_16x16x32_bf16 v[216:219], v[68:71], v[40:43], v[216:219]
ds_read_b64_tr_b16 v[106:107], v11 offset:28672
v_mfma_f32_16x16x32_bf16 v[212:215], v[68:71], v[36:39], v[212:215]
ds_read_b64_tr_b16 v[120:121], v11 offset:40960
v_mfma_f32_16x16x32_bf16 v[208:211], v[68:71], v[32:35], v[208:211]
ds_read_b64_tr_b16 v[122:123], v11 offset:45056
v_mfma_f32_16x16x32_bf16 v[160:163], v[56:59], v[32:35], v[160:163]
ds_read_b64_tr_b16 v[108:109], v12 offset:24576
v_mfma_f32_16x16x32_bf16 v[164:167], v[56:59], v[36:39], v[164:167]
ds_read_b64_tr_b16 v[110:111], v12 offset:28672
v_mfma_f32_16x16x32_bf16 v[168:171], v[56:59], v[40:43], v[168:171]
ds_read_b64_tr_b16 v[124:125], v12 offset:40960
v_mfma_f32_16x16x32_bf16 v[172:175], v[56:59], v[44:47], v[172:175]
ds_read_b64_tr_b16 v[126:127], v12 offset:45056
v_mfma_f32_16x16x32_bf16 v[236:239], v[72:75], v[44:47], v[236:239]
v_mfma_f32_16x16x32_bf16 v[232:235], v[72:75], v[40:43], v[232:235]
v_mfma_f32_16x16x32_bf16 v[228:231], v[72:75], v[36:39], v[228:231]
v_mfma_f32_16x16x32_bf16 v[224:227], v[72:75], v[32:35], v[224:227]
v_mfma_f32_16x16x32_bf16 v[176:179], v[60:63], v[32:35], v[176:179]
v_mfma_f32_16x16x32_bf16 v[180:183], v[60:63], v[36:39], v[180:183]
v_mfma_f32_16x16x32_bf16 v[184:187], v[60:63], v[40:43], v[184:187]
v_mfma_f32_16x16x32_bf16 v[188:191], v[60:63], v[44:47], v[188:191]
v_mfma_f32_16x16x32_bf16 v[252:255], v[76:79], v[44:47], v[252:255]
v_mfma_f32_16x16x32_bf16 v[248:251], v[76:79], v[40:43], v[248:251]
v_mfma_f32_16x16x32_bf16 v[244:247], v[76:79], v[36:39], v[244:247]
v_mfma_f32_16x16x32_bf16 v[240:243], v[76:79], v[32:35], v[240:243]
s_waitcnt lgkmcnt(0)
s_barrier
v_mfma_f32_16x16x32_bf16 v[128:131], v[96:99], v[80:83], v[128:131]
ds_read_b128 v[32:35], v4 offset:0
v_mfma_f32_16x16x32_bf16 v[132:135], v[96:99], v[84:87], v[132:135]
ds_read_b64_tr_b16 v[48:49], v13 offset:16384
v_mfma_f32_16x16x32_bf16 v[136:139], v[96:99], v[88:91], v[136:139]
ds_read_b64_tr_b16 v[50:51], v13 offset:20480
v_mfma_f32_16x16x32_bf16 v[140:143], v[96:99], v[92:95], v[140:143]
ds_read_b128 v[36:39], v4 offset:256
v_mfma_f32_16x16x32_bf16 v[204:207], v[112:115], v[92:95], v[204:207]
ds_read_b128 v[40:43], v4 offset:512
v_mfma_f32_16x16x32_bf16 v[200:203], v[112:115], v[88:91], v[200:203]
ds_read_b128 v[44:47], v4 offset:768
v_mfma_f32_16x16x32_bf16 v[196:199], v[112:115], v[84:87], v[196:199]
ds_read_b64_tr_b16 v[64:65], v13 offset:32768
v_mfma_f32_16x16x32_bf16 v[192:195], v[112:115], v[80:83], v[192:195]
ds_read_b64_tr_b16 v[66:67], v13 offset:36864
v_mfma_f32_16x16x32_bf16 v[144:147], v[100:103], v[80:83], v[144:147]
ds_read_b64_tr_b16 v[52:53], v14 offset:16384
v_mfma_f32_16x16x32_bf16 v[148:151], v[100:103], v[84:87], v[148:151]
ds_read_b64_tr_b16 v[54:55], v14 offset:20480
v_mfma_f32_16x16x32_bf16 v[152:155], v[100:103], v[88:91], v[152:155]
ds_read_b64_tr_b16 v[68:69], v14 offset:32768
v_mfma_f32_16x16x32_bf16 v[156:159], v[100:103], v[92:95], v[156:159]
ds_read_b64_tr_b16 v[70:71], v14 offset:36864
v_mfma_f32_16x16x32_bf16 v[220:223], v[116:119], v[92:95], v[220:223]
ds_read_b64_tr_b16 v[56:57], v15 offset:16384
v_mfma_f32_16x16x32_bf16 v[216:219], v[116:119], v[88:91], v[216:219]
ds_read_b64_tr_b16 v[58:59], v15 offset:20480
v_mfma_f32_16x16x32_bf16 v[212:215], v[116:119], v[84:87], v[212:215]
ds_read_b64_tr_b16 v[72:73], v15 offset:32768
v_mfma_f32_16x16x32_bf16 v[208:211], v[116:119], v[80:83], v[208:211]
ds_read_b64_tr_b16 v[74:75], v15 offset:36864
v_mfma_f32_16x16x32_bf16 v[160:163], v[104:107], v[80:83], v[160:163]
ds_read_b64_tr_b16 v[60:61], v16 offset:16384
v_mfma_f32_16x16x32_bf16 v[164:167], v[104:107], v[84:87], v[164:167]
ds_read_b64_tr_b16 v[62:63], v16 offset:20480
v_mfma_f32_16x16x32_bf16 v[168:171], v[104:107], v[88:91], v[168:171]
ds_read_b64_tr_b16 v[76:77], v16 offset:32768
v_mfma_f32_16x16x32_bf16 v[172:175], v[104:107], v[92:95], v[172:175]
ds_read_b64_tr_b16 v[78:79], v16 offset:36864
v_mfma_f32_16x16x32_bf16 v[236:239], v[120:123], v[92:95], v[236:239]
v_mfma_f32_16x16x32_bf16 v[232:235], v[120:123], v[88:91], v[232:235]
v_mfma_f32_16x16x32_bf16 v[228:231], v[120:123], v[84:87], v[228:231]
v_mfma_f32_16x16x32_bf16 v[224:227], v[120:123], v[80:83], v[224:227]
v_mfma_f32_16x16x32_bf16 v[176:179], v[108:111], v[80:83], v[176:179]
v_mfma_f32_16x16x32_bf16 v[180:183], v[108:111], v[84:87], v[180:183]
v_mfma_f32_16x16x32_bf16 v[184:187], v[108:111], v[88:91], v[184:187]
v_mfma_f32_16x16x32_bf16 v[188:191], v[108:111], v[92:95], v[188:191]
v_mfma_f32_16x16x32_bf16 v[252:255], v[124:127], v[92:95], v[252:255]
v_mfma_f32_16x16x32_bf16 v[248:251], v[124:127], v[88:91], v[248:251]
v_mfma_f32_16x16x32_bf16 v[244:247], v[124:127], v[84:87], v[244:247]
v_mfma_f32_16x16x32_bf16 v[240:243], v[124:127], v[80:83], v[240:243]
s_waitcnt lgkmcnt(0)
v_mfma_f32_16x16x32_bf16 v[128:131], v[48:51], v[32:35], v[128:131]
ds_read_b128 v[80:83], v4 offset:8192
v_mfma_f32_16x16x32_bf16 v[132:135], v[48:51], v[36:39], v[132:135]
ds_read_b64_tr_b16 v[96:97], v13 offset:24576
v_mfma_f32_16x16x32_bf16 v[136:139], v[48:51], v[40:43], v[136:139]
ds_read_b64_tr_b16 v[98:99], v13 offset:28672
v_mfma_f32_16x16x32_bf16 v[140:143], v[48:51], v[44:47], v[140:143]
ds_read_b128 v[84:87], v4 offset:8448
v_mfma_f32_16x16x32_bf16 v[204:207], v[64:67], v[44:47], v[204:207]
ds_read_b128 v[88:91], v4 offset:8704
v_mfma_f32_16x16x32_bf16 v[200:203], v[64:67], v[40:43], v[200:203]
ds_read_b128 v[92:95], v4 offset:8960
v_mfma_f32_16x16x32_bf16 v[196:199], v[64:67], v[36:39], v[196:199]
ds_read_b64_tr_b16 v[112:113], v13 offset:40960
v_mfma_f32_16x16x32_bf16 v[192:195], v[64:67], v[32:35], v[192:195]
ds_read_b64_tr_b16 v[114:115], v13 offset:45056
v_mfma_f32_16x16x32_bf16 v[144:147], v[52:55], v[32:35], v[144:147]
ds_read_b64_tr_b16 v[100:101], v14 offset:24576
v_mfma_f32_16x16x32_bf16 v[148:151], v[52:55], v[36:39], v[148:151]
ds_read_b64_tr_b16 v[102:103], v14 offset:28672
v_mfma_f32_16x16x32_bf16 v[152:155], v[52:55], v[40:43], v[152:155]
ds_read_b64_tr_b16 v[116:117], v14 offset:40960
v_mfma_f32_16x16x32_bf16 v[156:159], v[52:55], v[44:47], v[156:159]
ds_read_b64_tr_b16 v[118:119], v14 offset:45056
v_mfma_f32_16x16x32_bf16 v[220:223], v[68:71], v[44:47], v[220:223]
ds_read_b64_tr_b16 v[104:105], v15 offset:24576
v_mfma_f32_16x16x32_bf16 v[216:219], v[68:71], v[40:43], v[216:219]
ds_read_b64_tr_b16 v[106:107], v15 offset:28672
v_mfma_f32_16x16x32_bf16 v[212:215], v[68:71], v[36:39], v[212:215]
ds_read_b64_tr_b16 v[120:121], v15 offset:40960
v_mfma_f32_16x16x32_bf16 v[208:211], v[68:71], v[32:35], v[208:211]
ds_read_b64_tr_b16 v[122:123], v15 offset:45056
v_mfma_f32_16x16x32_bf16 v[160:163], v[56:59], v[32:35], v[160:163]
ds_read_b64_tr_b16 v[108:109], v16 offset:24576
v_mfma_f32_16x16x32_bf16 v[164:167], v[56:59], v[36:39], v[164:167]
ds_read_b64_tr_b16 v[110:111], v16 offset:28672
v_mfma_f32_16x16x32_bf16 v[168:171], v[56:59], v[40:43], v[168:171]
ds_read_b64_tr_b16 v[124:125], v16 offset:40960
v_mfma_f32_16x16x32_bf16 v[172:175], v[56:59], v[44:47], v[172:175]
ds_read_b64_tr_b16 v[126:127], v16 offset:45056
v_mfma_f32_16x16x32_bf16 v[236:239], v[72:75], v[44:47], v[236:239]
v_mfma_f32_16x16x32_bf16 v[232:235], v[72:75], v[40:43], v[232:235]
v_mfma_f32_16x16x32_bf16 v[228:231], v[72:75], v[36:39], v[228:231]
v_mfma_f32_16x16x32_bf16 v[224:227], v[72:75], v[32:35], v[224:227]
v_mfma_f32_16x16x32_bf16 v[176:179], v[60:63], v[32:35], v[176:179]
v_mfma_f32_16x16x32_bf16 v[180:183], v[60:63], v[36:39], v[180:183]
v_mfma_f32_16x16x32_bf16 v[184:187], v[60:63], v[40:43], v[184:187]
v_mfma_f32_16x16x32_bf16 v[188:191], v[60:63], v[44:47], v[188:191]
v_mfma_f32_16x16x32_bf16 v[252:255], v[76:79], v[44:47], v[252:255]
v_mfma_f32_16x16x32_bf16 v[248:251], v[76:79], v[40:43], v[248:251]
v_mfma_f32_16x16x32_bf16 v[244:247], v[76:79], v[36:39], v[244:247]
v_mfma_f32_16x16x32_bf16 v[240:243], v[76:79], v[32:35], v[240:243]
s_waitcnt lgkmcnt(0)
s_barrier
v_mfma_f32_16x16x32_bf16 v[128:131], v[96:99], v[80:83], v[128:131]
ds_read_b128 v[32:35], v2 offset:0
v_mfma_f32_16x16x32_bf16 v[132:135], v[96:99], v[84:87], v[132:135]
ds_read_b64_tr_b16 v[48:49], v5 offset:16384
v_mfma_f32_16x16x32_bf16 v[136:139], v[96:99], v[88:91], v[136:139]
ds_read_b64_tr_b16 v[50:51], v5 offset:20480
v_mfma_f32_16x16x32_bf16 v[140:143], v[96:99], v[92:95], v[140:143]
ds_read_b128 v[36:39], v2 offset:256
v_mfma_f32_16x16x32_bf16 v[204:207], v[112:115], v[92:95], v[204:207]
ds_read_b128 v[40:43], v2 offset:512
v_mfma_f32_16x16x32_bf16 v[200:203], v[112:115], v[88:91], v[200:203]
ds_read_b128 v[44:47], v2 offset:768
v_mfma_f32_16x16x32_bf16 v[196:199], v[112:115], v[84:87], v[196:199]
ds_read_b64_tr_b16 v[64:65], v5 offset:32768
v_mfma_f32_16x16x32_bf16 v[192:195], v[112:115], v[80:83], v[192:195]
ds_read_b64_tr_b16 v[66:67], v5 offset:36864
v_mfma_f32_16x16x32_bf16 v[144:147], v[100:103], v[80:83], v[144:147]
ds_read_b64_tr_b16 v[52:53], v6 offset:16384
v_mfma_f32_16x16x32_bf16 v[148:151], v[100:103], v[84:87], v[148:151]
ds_read_b64_tr_b16 v[54:55], v6 offset:20480
v_mfma_f32_16x16x32_bf16 v[152:155], v[100:103], v[88:91], v[152:155]
ds_read_b64_tr_b16 v[68:69], v6 offset:32768
v_mfma_f32_16x16x32_bf16 v[156:159], v[100:103], v[92:95], v[156:159]
ds_read_b64_tr_b16 v[70:71], v6 offset:36864
v_mfma_f32_16x16x32_bf16 v[220:223], v[116:119], v[92:95], v[220:223]
ds_read_b64_tr_b16 v[56:57], v7 offset:16384
v_mfma_f32_16x16x32_bf16 v[216:219], v[116:119], v[88:91], v[216:219]
ds_read_b64_tr_b16 v[58:59], v7 offset:20480
v_mfma_f32_16x16x32_bf16 v[212:215], v[116:119], v[84:87], v[212:215]
ds_read_b64_tr_b16 v[72:73], v7 offset:32768
v_mfma_f32_16x16x32_bf16 v[208:211], v[116:119], v[80:83], v[208:211]
ds_read_b64_tr_b16 v[74:75], v7 offset:36864
v_mfma_f32_16x16x32_bf16 v[160:163], v[104:107], v[80:83], v[160:163]
ds_read_b64_tr_b16 v[60:61], v8 offset:16384
v_mfma_f32_16x16x32_bf16 v[164:167], v[104:107], v[84:87], v[164:167]
ds_read_b64_tr_b16 v[62:63], v8 offset:20480
v_mfma_f32_16x16x32_bf16 v[168:171], v[104:107], v[88:91], v[168:171]
ds_read_b64_tr_b16 v[76:77], v8 offset:32768
v_mfma_f32_16x16x32_bf16 v[172:175], v[104:107], v[92:95], v[172:175]
ds_read_b64_tr_b16 v[78:79], v8 offset:36864
v_mfma_f32_16x16x32_bf16 v[236:239], v[120:123], v[92:95], v[236:239]
v_mfma_f32_16x16x32_bf16 v[232:235], v[120:123], v[88:91], v[232:235]
v_mfma_f32_16x16x32_bf16 v[228:231], v[120:123], v[84:87], v[228:231]
v_mfma_f32_16x16x32_bf16 v[224:227], v[120:123], v[80:83], v[224:227]
v_mfma_f32_16x16x32_bf16 v[176:179], v[108:111], v[80:83], v[176:179]
v_mfma_f32_16x16x32_bf16 v[180:183], v[108:111], v[84:87], v[180:183]
v_mfma_f32_16x16x32_bf16 v[184:187], v[108:111], v[88:91], v[184:187]
v_mfma_f32_16x16x32_bf16 v[188:191], v[108:111], v[92:95], v[188:191]
v_mfma_f32_16x16x32_bf16 v[252:255], v[124:127], v[92:95], v[252:255]
v_mfma_f32_16x16x32_bf16 v[248:251], v[124:127], v[88:91], v[248:251]
v_mfma_f32_16x16x32_bf16 v[244:247], v[124:127], v[84:87], v[244:247]
v_mfma_f32_16x16x32_bf16 v[240:243], v[124:127], v[80:83], v[240:243]
s_sub_u32 s41, s41, 1
s_cmp_lg_u32 s41, 0
s_cbranch_scc1 Lk3_27
s_waitcnt lgkmcnt(0)
v_mfma_f32_16x16x32_bf16 v[128:131], v[48:51], v[32:35], v[128:131]
ds_read_b128 v[80:83], v2 offset:8192
v_mfma_f32_16x16x32_bf16 v[132:135], v[48:51], v[36:39], v[132:135]
ds_read_b64_tr_b16 v[96:97], v5 offset:24576
v_mfma_f32_16x16x32_bf16 v[136:139], v[48:51], v[40:43], v[136:139]
ds_read_b64_tr_b16 v[98:99], v5 offset:28672
v_mfma_f32_16x16x32_bf16 v[140:143], v[48:51], v[44:47], v[140:143]
ds_read_b128 v[84:87], v2 offset:8448
v_mfma_f32_16x16x32_bf16 v[204:207], v[64:67], v[44:47], v[204:207]
ds_read_b128 v[88:91], v2 offset:8704
v_mfma_f32_16x16x32_bf16 v[200:203], v[64:67], v[40:43], v[200:203]
ds_read_b128 v[92:95], v2 offset:8960
v_mfma_f32_16x16x32_bf16 v[196:199], v[64:67], v[36:39], v[196:199]
ds_read_b64_tr_b16 v[112:113], v5 offset:40960
v_mfma_f32_16x16x32_bf16 v[192:195], v[64:67], v[32:35], v[192:195]
ds_read_b64_tr_b16 v[114:115], v5 offset:45056
v_mfma_f32_16x16x32_bf16 v[144:147], v[52:55], v[32:35], v[144:147]
ds_read_b64_tr_b16 v[100:101], v6 offset:24576
v_mfma_f32_16x16x32_bf16 v[148:151], v[52:55], v[36:39], v[148:151]
ds_read_b64_tr_b16 v[102:103], v6 offset:28672
v_mfma_f32_16x16x32_bf16 v[152:155], v[52:55], v[40:43], v[152:155]
ds_read_b64_tr_b16 v[116:117], v6 offset:40960
v_mfma_f32_16x16x32_bf16 v[156:159], v[52:55], v[44:47], v[156:159]
ds_read_b64_tr_b16 v[118:119], v6 offset:45056
v_mfma_f32_16x16x32_bf16 v[220:223], v[68:71], v[44:47], v[220:223]
ds_read_b64_tr_b16 v[104:105], v7 offset:24576
v_mfma_f32_16x16x32_bf16 v[216:219], v[68:71], v[40:43], v[216:219]
ds_read_b64_tr_b16 v[106:107], v7 offset:28672
v_mfma_f32_16x16x32_bf16 v[212:215], v[68:71], v[36:39], v[212:215]
ds_read_b64_tr_b16 v[120:121], v7 offset:40960
v_mfma_f32_16x16x32_bf16 v[208:211], v[68:71], v[32:35], v[208:211]
ds_read_b64_tr_b16 v[122:123], v7 offset:45056
v_mfma_f32_16x16x32_bf16 v[160:163], v[56:59], v[32:35], v[160:163]
ds_read_b64_tr_b16 v[108:109], v8 offset:24576
v_mfma_f32_16x16x32_bf16 v[164:167], v[56:59], v[36:39], v[164:167]
ds_read_b64_tr_b16 v[110:111], v8 offset:28672
v_mfma_f32_16x16x32_bf16 v[168:171], v[56:59], v[40:43], v[168:171]
ds_read_b64_tr_b16 v[124:125], v8 offset:40960
v_mfma_f32_16x16x32_bf16 v[172:175], v[56:59], v[44:47], v[172:175]
ds_read_b64_tr_b16 v[126:127], v8 offset:45056
v_mfma_f32_16x16x32_bf16 v[236:239], v[72:75], v[44:47], v[236:239]
v_mfma_f32_16x16x32_bf16 v[232:235], v[72:75], v[40:43], v[232:235]
v_mfma_f32_16x16x32_bf16 v[228:231], v[72:75], v[36:39], v[228:231]
v_mfma_f32_16x16x32_bf16 v[224:227], v[72:75], v[32:35], v[224:227]
v_mfma_f32_16x16x32_bf16 v[176:179], v[60:63], v[32:35], v[176:179]
v_mfma_f32_16x16x32_bf16 v[180:183], v[60:63], v[36:39], v[180:183]
v_mfma_f32_16x16x32_bf16 v[184:187], v[60:63], v[40:43], v[184:187]
v_mfma_f32_16x16x32_bf16 v[188:191], v[60:63], v[44:47], v[188:191]
v_mfma_f32_16x16x32_bf16 v[252:255], v[76:79], v[44:47], v[252:255]
v_mfma_f32_16x16x32_bf16 v[248:251], v[76:79], v[40:43], v[248:251]
v_mfma_f32_16x16x32_bf16 v[244:247], v[76:79], v[36:39], v[244:247]
v_mfma_f32_16x16x32_bf16 v[240:243], v[76:79], v[32:35], v[240:243]
s_waitcnt lgkmcnt(0)
s_barrier
v_mfma_f32_16x16x32_bf16 v[128:131], v[96:99], v[80:83], v[128:131]
ds_read_b128 v[32:35], v3 offset:0
v_mfma_f32_16x16x32_bf16 v[132:135], v[96:99], v[84:87], v[132:135]
ds_read_b64_tr_b16 v[48:49], v9 offset:16384
v_mfma_f32_16x16x32_bf16 v[136:139], v[96:99], v[88:91], v[136:139]
ds_read_b64_tr_b16 v[50:51], v9 offset:20480
v_mfma_f32_16x16x32_bf16 v[140:143], v[96:99], v[92:95], v[140:143]
ds_read_b128 v[36:39], v3 offset:256
v_mfma_f32_16x16x32_bf16 v[204:207], v[112:115], v[92:95], v[204:207]
ds_read_b128 v[40:43], v3 offset:512
v_mfma_f32_16x16x32_bf16 v[200:203], v[112:115], v[88:91], v[200:203]
ds_read_b128 v[44:47], v3 offset:768
v_mfma_f32_16x16x32_bf16 v[196:199], v[112:115], v[84:87], v[196:199]
ds_read_b64_tr_b16 v[64:65], v9 offset:32768
v_mfma_f32_16x16x32_bf16 v[192:195], v[112:115], v[80:83], v[192:195]
ds_read_b64_tr_b16 v[66:67], v9 offset:36864
v_mfma_f32_16x16x32_bf16 v[144:147], v[100:103], v[80:83], v[144:147]
ds_read_b64_tr_b16 v[52:53], v10 offset:16384
v_mfma_f32_16x16x32_bf16 v[148:151], v[100:103], v[84:87], v[148:151]
ds_read_b64_tr_b16 v[54:55], v10 offset:20480
v_mfma_f32_16x16x32_bf16 v[152:155], v[100:103], v[88:91], v[152:155]
ds_read_b64_tr_b16 v[68:69], v10 offset:32768
v_mfma_f32_16x16x32_bf16 v[156:159], v[100:103], v[92:95], v[156:159]
ds_read_b64_tr_b16 v[70:71], v10 offset:36864
v_mfma_f32_16x16x32_bf16 v[220:223], v[116:119], v[92:95], v[220:223]
ds_read_b64_tr_b16 v[56:57], v11 offset:16384
v_mfma_f32_16x16x32_bf16 v[216:219], v[116:119], v[88:91], v[216:219]
ds_read_b64_tr_b16 v[58:59], v11 offset:20480
v_mfma_f32_16x16x32_bf16 v[212:215], v[116:119], v[84:87], v[212:215]
ds_read_b64_tr_b16 v[72:73], v11 offset:32768
v_mfma_f32_16x16x32_bf16 v[208:211], v[116:119], v[80:83], v[208:211]
ds_read_b64_tr_b16 v[74:75], v11 offset:36864
v_mfma_f32_16x16x32_bf16 v[160:163], v[104:107], v[80:83], v[160:163]
ds_read_b64_tr_b16 v[60:61], v12 offset:16384
v_mfma_f32_16x16x32_bf16 v[164:167], v[104:107], v[84:87], v[164:167]
ds_read_b64_tr_b16 v[62:63], v12 offset:20480
v_mfma_f32_16x16x32_bf16 v[168:171], v[104:107], v[88:91], v[168:171]
ds_read_b64_tr_b16 v[76:77], v12 offset:32768
v_mfma_f32_16x16x32_bf16 v[172:175], v[104:107], v[92:95], v[172:175]
ds_read_b64_tr_b16 v[78:79], v12 offset:36864
v_mfma_f32_16x16x32_bf16 v[236:239], v[120:123], v[92:95], v[236:239]
v_mfma_f32_16x16x32_bf16 v[232:235], v[120:123], v[88:91], v[232:235]
v_mfma_f32_16x16x32_bf16 v[228:231], v[120:123], v[84:87], v[228:231]
v_mfma_f32_16x16x32_bf16 v[224:227], v[120:123], v[80:83], v[224:227]
v_mfma_f32_16x16x32_bf16 v[176:179], v[108:111], v[80:83], v[176:179]
v_mfma_f32_16x16x32_bf16 v[180:183], v[108:111], v[84:87], v[180:183]
v_mfma_f32_16x16x32_bf16 v[184:187], v[108:111], v[88:91], v[184:187]
v_mfma_f32_16x16x32_bf16 v[188:191], v[108:111], v[92:95], v[188:191]
v_mfma_f32_16x16x32_bf16 v[252:255], v[124:127], v[92:95], v[252:255]
v_mfma_f32_16x16x32_bf16 v[248:251], v[124:127], v[88:91], v[248:251]
v_mfma_f32_16x16x32_bf16 v[244:247], v[124:127], v[84:87], v[244:247]
v_mfma_f32_16x16x32_bf16 v[240:243], v[124:127], v[80:83], v[240:243]
s_waitcnt lgkmcnt(0)
v_mfma_f32_16x16x32_bf16 v[128:131], v[48:51], v[32:35], v[128:131]
ds_read_b128 v[80:83], v3 offset:8192
v_mfma_f32_16x16x32_bf16 v[132:135], v[48:51], v[36:39], v[132:135]
ds_read_b64_tr_b16 v[96:97], v9 offset:24576
v_mfma_f32_16x16x32_bf16 v[136:139], v[48:51], v[40:43], v[136:139]
ds_read_b64_tr_b16 v[98:99], v9 offset:28672
v_mfma_f32_16x16x32_bf16 v[140:143], v[48:51], v[44:47], v[140:143]
ds_read_b128 v[84:87], v3 offset:8448
v_mfma_f32_16x16x32_bf16 v[204:207], v[64:67], v[44:47], v[204:207]
ds_read_b128 v[88:91], v3 offset:8704
v_mfma_f32_16x16x32_bf16 v[200:203], v[64:67], v[40:43], v[200:203]
ds_read_b128 v[92:95], v3 offset:8960
v_mfma_f32_16x16x32_bf16 v[196:199], v[64:67], v[36:39], v[196:199]
ds_read_b64_tr_b16 v[112:113], v9 offset:40960
v_mfma_f32_16x16x32_bf16 v[192:195], v[64:67], v[32:35], v[192:195]
ds_read_b64_tr_b16 v[114:115], v9 offset:45056
v_mfma_f32_16x16x32_bf16 v[144:147], v[52:55], v[32:35], v[144:147]
ds_read_b64_tr_b16 v[100:101], v10 offset:24576
v_mfma_f32_16x16x32_bf16 v[148:151], v[52:55], v[36:39], v[148:151]
ds_read_b64_tr_b16 v[102:103], v10 offset:28672
v_mfma_f32_16x16x32_bf16 v[152:155], v[52:55], v[40:43], v[152:155]
ds_read_b64_tr_b16 v[116:117], v10 offset:40960
v_mfma_f32_16x16x32_bf16 v[156:159], v[52:55], v[44:47], v[156:159]
ds_read_b64_tr_b16 v[118:119], v10 offset:45056
v_mfma_f32_16x16x32_bf16 v[220:223], v[68:71], v[44:47], v[220:223]
ds_read_b64_tr_b16 v[104:105], v11 offset:24576
v_mfma_f32_16x16x32_bf16 v[216:219], v[68:71], v[40:43], v[216:219]
ds_read_b64_tr_b16 v[106:107], v11 offset:28672
v_mfma_f32_16x16x32_bf16 v[212:215], v[68:71], v[36:39], v[212:215]
ds_read_b64_tr_b16 v[120:121], v11 offset:40960
v_mfma_f32_16x16x32_bf16 v[208:211], v[68:71], v[32:35], v[208:211]
ds_read_b64_tr_b16 v[122:123], v11 offset:45056
v_mfma_f32_16x16x32_bf16 v[160:163], v[56:59], v[32:35], v[160:163]
ds_read_b64_tr_b16 v[108:109], v12 offset:24576
v_mfma_f32_16x16x32_bf16 v[164:167], v[56:59], v[36:39], v[164:167]
ds_read_b64_tr_b16 v[110:111], v12 offset:28672
v_mfma_f32_16x16x32_bf16 v[168:171], v[56:59], v[40:43], v[168:171]
ds_read_b64_tr_b16 v[124:125], v12 offset:40960
v_mfma_f32_16x16x32_bf16 v[172:175], v[56:59], v[44:47], v[172:175]
ds_read_b64_tr_b16 v[126:127], v12 offset:45056
v_mfma_f32_16x16x32_bf16 v[236:239], v[72:75], v[44:47], v[236:239]
v_mfma_f32_16x16x32_bf16 v[232:235], v[72:75], v[40:43], v[232:235]
v_mfma_f32_16x16x32_bf16 v[228:231], v[72:75], v[36:39], v[228:231]
v_mfma_f32_16x16x32_bf16 v[224:227], v[72:75], v[32:35], v[224:227]
v_mfma_f32_16x16x32_bf16 v[176:179], v[60:63], v[32:35], v[176:179]
v_mfma_f32_16x16x32_bf16 v[180:183], v[60:63], v[36:39], v[180:183]
v_mfma_f32_16x16x32_bf16 v[184:187], v[60:63], v[40:43], v[184:187]
v_mfma_f32_16x16x32_bf16 v[188:191], v[60:63], v[44:47], v[188:191]
v_mfma_f32_16x16x32_bf16 v[252:255], v[76:79], v[44:47], v[252:255]
v_mfma_f32_16x16x32_bf16 v[248:251], v[76:79], v[40:43], v[248:251]
v_mfma_f32_16x16x32_bf16 v[244:247], v[76:79], v[36:39], v[244:247]
v_mfma_f32_16x16x32_bf16 v[240:243], v[76:79], v[32:35], v[240:243]
s_waitcnt lgkmcnt(0)
s_barrier
v_mfma_f32_16x16x32_bf16 v[128:131], v[96:99], v[80:83], v[128:131]
ds_read_b128 v[32:35], v4 offset:0
v_mfma_f32_16x16x32_bf16 v[132:135], v[96:99], v[84:87], v[132:135]
ds_read_b64_tr_b16 v[48:49], v13 offset:16384
v_mfma_f32_16x16x32_bf16 v[136:139], v[96:99], v[88:91], v[136:139]
ds_read_b64_tr_b16 v[50:51], v13 offset:20480
v_mfma_f32_16x16x32_bf16 v[140:143], v[96:99], v[92:95], v[140:143]
ds_read_b128 v[36:39], v4 offset:256
v_mfma_f32_16x16x32_bf16 v[204:207], v[112:115], v[92:95], v[204:207]
ds_read_b128 v[40:43], v4 offset:512
v_mfma_f32_16x16x32_bf16 v[200:203], v[112:115], v[88:91], v[200:203]
ds_read_b128 v[44:47], v4 offset:768
v_mfma_f32_16x16x32_bf16 v[196:199], v[112:115], v[84:87], v[196:199]
ds_read_b64_tr_b16 v[64:65], v13 offset:32768
v_mfma_f32_16x16x32_bf16 v[192:195], v[112:115], v[80:83], v[192:195]
ds_read_b64_tr_b16 v[66:67], v13 offset:36864
v_mfma_f32_16x16x32_bf16 v[144:147], v[100:103], v[80:83], v[144:147]
ds_read_b64_tr_b16 v[52:53], v14 offset:16384
v_mfma_f32_16x16x32_bf16 v[148:151], v[100:103], v[84:87], v[148:151]
ds_read_b64_tr_b16 v[54:55], v14 offset:20480
v_mfma_f32_16x16x32_bf16 v[152:155], v[100:103], v[88:91], v[152:155]
ds_read_b64_tr_b16 v[68:69], v14 offset:32768
v_mfma_f32_16x16x32_bf16 v[156:159], v[100:103], v[92:95], v[156:159]
ds_read_b64_tr_b16 v[70:71], v14 offset:36864
v_mfma_f32_16x16x32_bf16 v[220:223], v[116:119], v[92:95], v[220:223]
ds_read_b64_tr_b16 v[56:57], v15 offset:16384
v_mfma_f32_16x16x32_bf16 v[216:219], v[116:119], v[88:91], v[216:219]
ds_read_b64_tr_b16 v[58:59], v15 offset:20480
v_mfma_f32_16x16x32_bf16 v[212:215], v[116:119], v[84:87], v[212:215]
ds_read_b64_tr_b16 v[72:73], v15 offset:32768
v_mfma_f32_16x16x32_bf16 v[208:211], v[116:119], v[80:83], v[208:211]
ds_read_b64_tr_b16 v[74:75], v15 offset:36864
v_mfma_f32_16x16x32_bf16 v[160:163], v[104:107], v[80:83], v[160:163]
ds_read_b64_tr_b16 v[60:61], v16 offset:16384
v_mfma_f32_16x16x32_bf16 v[164:167], v[104:107], v[84:87], v[164:167]
ds_read_b64_tr_b16 v[62:63], v16 offset:20480
v_mfma_f32_16x16x32_bf16 v[168:171], v[104:107], v[88:91], v[168:171]
ds_read_b64_tr_b16 v[76:77], v16 offset:32768
v_mfma_f32_16x16x32_bf16 v[172:175], v[104:107], v[92:95], v[172:175]
ds_read_b64_tr_b16 v[78:79], v16 offset:36864
v_mfma_f32_16x16x32_bf16 v[236:239], v[120:123], v[92:95], v[236:239]
v_mfma_f32_16x16x32_bf16 v[232:235], v[120:123], v[88:91], v[232:235]
v_mfma_f32_16x16x32_bf16 v[228:231], v[120:123], v[84:87], v[228:231]
v_mfma_f32_16x16x32_bf16 v[224:227], v[120:123], v[80:83], v[224:227]
v_mfma_f32_16x16x32_bf16 v[176:179], v[108:111], v[80:83], v[176:179]
v_mfma_f32_16x16x32_bf16 v[180:183], v[108:111], v[84:87], v[180:183]
v_mfma_f32_16x16x32_bf16 v[184:187], v[108:111], v[88:91], v[184:187]
v_mfma_f32_16x16x32_bf16 v[188:191], v[108:111], v[92:95], v[188:191]
v_mfma_f32_16x16x32_bf16 v[252:255], v[124:127], v[92:95], v[252:255]
v_mfma_f32_16x16x32_bf16 v[248:251], v[124:127], v[88:91], v[248:251]
v_mfma_f32_16x16x32_bf16 v[244:247], v[124:127], v[84:87], v[244:247]
v_mfma_f32_16x16x32_bf16 v[240:243], v[124:127], v[80:83], v[240:243]
s_waitcnt lgkmcnt(0)
v_mfma_f32_16x16x32_bf16 v[128:131], v[48:51], v[32:35], v[128:131]
ds_read_b128 v[80:83], v4 offset:8192
v_mfma_f32_16x16x32_bf16 v[132:135], v[48:51], v[36:39], v[132:135]
ds_read_b64_tr_b16 v[96:97], v13 offset:24576
v_mfma_f32_16x16x32_bf16 v[136:139], v[48:51], v[40:43], v[136:139]
ds_read_b64_tr_b16 v[98:99], v13 offset:28672
v_mfma_f32_16x16x32_bf16 v[140:143], v[48:51], v[44:47], v[140:143]
ds_read_b128 v[84:87], v4 offset:8448
v_mfma_f32_16x16x32_bf16 v[204:207], v[64:67], v[44:47], v[204:207]
ds_read_b128 v[88:91], v4 offset:8704
v_mfma_f32_16x16x32_bf16 v[200:203], v[64:67], v[40:43], v[200:203]
ds_read_b128 v[92:95], v4 offset:8960
v_mfma_f32_16x16x32_bf16 v[196:199], v[64:67], v[36:39], v[196:199]
ds_read_b64_tr_b16 v[112:113], v13 offset:40960
v_mfma_f32_16x16x32_bf16 v[192:195], v[64:67], v[32:35], v[192:195]
ds_read_b64_tr_b16 v[114:115], v13 offset:45056
v_mfma_f32_16x16x32_bf16 v[144:147], v[52:55], v[32:35], v[144:147]
ds_read_b64_tr_b16 v[100:101], v14 offset:24576
v_mfma_f32_16x16x32_bf16 v[148:151], v[52:55], v[36:39], v[148:151]
ds_read_b64_tr_b16 v[102:103], v14 offset:28672
v_mfma_f32_16x16x32_bf16 v[152:155], v[52:55], v[40:43], v[152:155]
ds_read_b64_tr_b16 v[116:117], v14 offset:40960
v_mfma_f32_16x16x32_bf16 v[156:159], v[52:55], v[44:47], v[156:159]
ds_read_b64_tr_b16 v[118:119], v14 offset:45056
v_mfma_f32_16x16x32_bf16 v[220:223], v[68:71], v[44:47], v[220:223]
ds_read_b64_tr_b16 v[104:105], v15 offset:24576
v_mfma_f32_16x16x32_bf16 v[216:219], v[68:71], v[40:43], v[216:219]
ds_read_b64_tr_b16 v[106:107], v15 offset:28672
v_mfma_f32_16x16x32_bf16 v[212:215], v[68:71], v[36:39], v[212:215]
ds_read_b64_tr_b16 v[120:121], v15 offset:40960
v_mfma_f32_16x16x32_bf16 v[208:211], v[68:71], v[32:35], v[208:211]
ds_read_b64_tr_b16 v[122:123], v15 offset:45056
v_mfma_f32_16x16x32_bf16 v[160:163], v[56:59], v[32:35], v[160:163]
ds_read_b64_tr_b16 v[108:109], v16 offset:24576
v_mfma_f32_16x16x32_bf16 v[164:167], v[56:59], v[36:39], v[164:167]
ds_read_b64_tr_b16 v[110:111], v16 offset:28672
v_mfma_f32_16x16x32_bf16 v[168:171], v[56:59], v[40:43], v[168:171]
ds_read_b64_tr_b16 v[124:125], v16 offset:40960
v_mfma_f32_16x16x32_bf16 v[172:175], v[56:59], v[44:47], v[172:175]
ds_read_b64_tr_b16 v[126:127], v16 offset:45056
v_mfma_f32_16x16x32_bf16 v[236:239], v[72:75], v[44:47], v[236:239]
v_mfma_f32_16x16x32_bf16 v[232:235], v[72:75], v[40:43], v[232:235]
v_mfma_f32_16x16x32_bf16 v[228:231], v[72:75], v[36:39], v[228:231]
v_mfma_f32_16x16x32_bf16 v[224:227], v[72:75], v[32:35], v[224:227]
v_mfma_f32_16x16x32_bf16 v[176:179], v[60:63], v[32:35], v[176:179]
v_mfma_f32_16x16x32_bf16 v[180:183], v[60:63], v[36:39], v[180:183]
v_mfma_f32_16x16x32_bf16 v[184:187], v[60:63], v[40:43], v[184:187]
v_mfma_f32_16x16x32_bf16 v[188:191], v[60:63], v[44:47], v[188:191]
v_mfma_f32_16x16x32_bf16 v[252:255], v[76:79], v[44:47], v[252:255]
v_mfma_f32_16x16x32_bf16 v[248:251], v[76:79], v[40:43], v[248:251]
v_mfma_f32_16x16x32_bf16 v[244:247], v[76:79], v[36:39], v[244:247]
v_mfma_f32_16x16x32_bf16 v[240:243], v[76:79], v[32:35], v[240:243]
s_waitcnt lgkmcnt(0)
s_barrier
s_cmp_eq_u32 s36, 3
s_cbranch_scc1 L3h_28
s_add_u32 s42, s42, 1
s_and_b32 s42, s42, 15
s_add_u32 m0, s39, 98304
s_mul_i32 s37, s42, s40
buffer_load_dwordx4 v22, s[8:11], s37 offen sc1 lds
v_mfma_f32_16x16x32_bf16 v[128:131], v[96:99], v[80:83], v[128:131]
s_lshl_b32 s43, s46, 9
v_mfma_f32_16x16x32_bf16 v[132:135], v[96:99], v[84:87], v[132:135]
s_add_u32 s43, s43, 147456
s_add_u32 m0, s39, 99328
s_add_u32 s37, s37, s38
buffer_load_dwordx4 v23, s[8:11], s37 offen sc1 lds
v_mfma_f32_16x16x32_bf16 v[136:139], v[96:99], v[88:91], v[136:139]
v_lshl_add_u32 v19, v17, 3, s43
v_mfma_f32_16x16x32_bf16 v[140:143], v[96:99], v[92:95], v[140:143]
s_add_u32 m0, s39, 100352
s_add_u32 s37, s37, s38
buffer_load_dwordx4 v22, s[8:11], s37 offen sc1 lds
ds_read_b64 v[2:3], v19 offset:0
v_mfma_f32_16x16x32_bf16 v[204:207], v[112:115], v[92:95], v[204:207]
ds_read_b64 v[4:5], v19 offset:128
s_add_u32 m0, s39, 101376
s_add_u32 s37, s37, s38
buffer_load_dwordx4 v23, s[8:11], s37 offen sc1 lds
v_mfma_f32_16x16x32_bf16 v[200:203], v[112:115], v[88:91], v[200:203]
ds_read_b64 v[6:7], v19 offset:256
v_mfma_f32_16x16x32_bf16 v[196:199], v[112:115], v[84:87], v[196:199]
s_add_u32 m0, s39, 102400
s_add_u32 s37, s37, s38
buffer_load_dwordx4 v22, s[8:11], s37 offen sc1 lds
ds_read_b64 v[8:9], v19 offset:384
v_mfma_f32_16x16x32_bf16 v[192:195], v[112:115], v[80:83], v[192:195]
s_mul_i32 s43, s47, 256
s_add_u32 m0, s39, 103424
s_add_u32 s37, s37, s38
buffer_load_dwordx4 v23, s[8:11], s37 offen sc1 lds
v_mfma_f32_16x16x32_bf16 v[144:147], v[100:103], v[80:83], v[144:147]
s_add_u32 s43, s43, 148480
v_mfma_f32_16x16x32_bf16 v[148:151], v[100:103], v[84:87], v[148:151]
s_add_u32 m0, s39, 104448
s_add_u32 s37, s37, s38
buffer_load_dwordx4 v22, s[8:11], s37 offen sc1 lds
v_lshl_add_u32 v19, v18, 4, s43
v_mfma_f32_16x16x32_bf16 v[152:155], v[100:103], v[88:91], v[152:155]
ds_read_b128 v[48:51], v19 offset:0
s_add_u32 m0, s39, 105472
s_add_u32 s37, s37, s38
buffer_load_dwordx4 v23, s[8:11], s37 offen sc1 lds
v_mfma_f32_16x16x32_bf16 v[156:159], v[100:103], v[92:95], v[156:159]
ds_read_b128 v[52:55], v19 offset:64
v_mfma_f32_16x16x32_bf16 v[220:223], v[116:119], v[92:95], v[220:223]
s_add_u32 m0, s39, 106496
s_add_u32 s37, s37, s38
buffer_load_dwordx4 v22, s[8:11], s37 offen sc1 lds
ds_read_b128 v[56:59], v19 offset:128
v_mfma_f32_16x16x32_bf16 v[216:219], v[116:119], v[88:91], v[216:219]
ds_read_b128 v[60:63], v19 offset:192
v_mfma_f32_16x16x32_bf16 v[212:215], v[116:119], v[84:87], v[212:215]
s_add_u32 m0, s39, 107520
s_add_u32 s37, s37, s38
buffer_load_dwordx4 v23, s[8:11], s37 offen sc1 lds
ds_read_b128 v[64:67], v19 offset:896
v_mfma_f32_16x16x32_bf16 v[208:211], v[116:119], v[80:83], v[208:211]
ds_read_b128 v[68:71], v19 offset:960
s_add_u32 m0, s39, 108544
s_add_u32 s37, s37, s38
buffer_load_dwordx4 v22, s[8:11], s37 offen sc1 lds
v_mfma_f32_16x16x32_bf16 v[160:163], v[104:107], v[80:83], v[160:163]
ds_read_b128 v[72:75], v19 offset:1024
v_mfma_f32_16x16x32_bf16 v[164:167], v[104:107], v[84:87], v[164:167]
s_add_u32 m0, s39, 109568
s_add_u32 s37, s37, s38
buffer_load_dwordx4 v23, s[8:11], s37 offen sc1 lds
ds_read_b128 v[76:79], v19 offset:1088
v_mfma_f32_16x16x32_bf16 v[168:171], v[104:107], v[88:91], v[168:171]
v_mfma_f32_16x16x32_bf16 v[172:175], v[104:107], v[92:95], v[172:175]
s_add_u32 m0, s39, 110592
s_add_u32 s37, s37, s38
buffer_load_dwordx4 v22, s[8:11], s37 offen sc1 lds
v_mfma_f32_16x16x32_bf16 v[236:239], v[120:123], v[92:95], v[236:239]
v_mfma_f32_16x16x32_bf16 v[232:235], v[120:123], v[88:91], v[232:235]
v_mfma_f32_16x16x32_bf16 v[228:231], v[120:123], v[84:87], v[228:231]
s_add_u32 m0, s39, 111616
s_add_u32 s37, s37, s38
buffer_load_dwordx4 v23, s[8:11], s37 offen sc1 lds
v_mfma_f32_16x16x32_bf16 v[224:227], v[120:123], v[80:83], v[224:227]
v_mfma_f32_16x16x32_bf16 v[176:179], v[108:111], v[80:83], v[176:179]
v_mfma_f32_16x16x32_bf16 v[180:183], v[108:111], v[84:87], v[180:183]
s_add_u32 m0, s39, 112640
s_add_u32 s37, s37, s38
buffer_load_dwordx4 v22, s[8:11], s37 offen sc1 lds
v_mfma_f32_16x16x32_bf16 v[184:187], v[108:111], v[88:91], v[184:187]
v_mfma_f32_16x16x32_bf16 v[188:191], v[108:111], v[92:95], v[188:191]
v_mfma_f32_16x16x32_bf16 v[252:255], v[124:127], v[92:95], v[252:255]
s_add_u32 m0, s39, 113664
s_add_u32 s37, s37, s38
buffer_load_dwordx4 v23, s[8:11], s37 offen sc1 lds
v_mfma_f32_16x16x32_bf16 v[248:251], v[124:127], v[88:91], v[248:251]
v_mfma_f32_16x16x32_bf16 v[244:247], v[124:127], v[84:87], v[244:247]
v_mfma_f32_16x16x32_bf16 v[240:243], v[124:127], v[80:83], v[240:243]
s_setprio 0
s_waitcnt lgkmcnt(0)
v_mov_b32 v32, v2
v_mul_f32 v88, v3, v3
v_mul_f32 v36, 0xc0135761, v3
v_mul_f32 v89, 0xbdd2d3e8, v3
v_rcp_f32 v44, v88
v_mul_f32 v40, v89, v88
v_mov_b32 v33, v4
v_mul_f32 v88, v5, v5
v_mul_f32 v37, 0xc0135761, v5
v_mul_f32 v89, 0xbdd2d3e8, v5
v_rcp_f32 v45, v88
v_mul_f32 v41, v89, v88
v_mov_b32 v34, v6
v_mul_f32 v88, v7, v7
v_mul_f32 v38, 0xc0135761, v7
v_mul_f32 v89, 0xbdd2d3e8, v7
v_rcp_f32 v46, v88
v_mul_f32 v42, v89, v88
v_mov_b32 v35, v8
v_mul_f32 v88, v9, v9
v_mul_f32 v39, 0xc0135761, v9
v_mul_f32 v89, 0xbdd2d3e8, v9
v_rcp_f32 v47, v88
v_mul_f32 v43, v89, v88
s_barrier
s_add_u32 s42, s42, 1
s_and_b32 s42, s42, 15
s_add_u32 m0, s39, 0
s_mul_i32 s37, s42, s40
buffer_load_dwordx4 v22, s[8:11], s37 offen sc1 lds
v_fma_f32 v128, -v32, v48, v128
v_fma_f32 v129, -v32, v49, v129
v_fma_f32 v130, -v32, v50, v130
v_fma_f32 v131, -v32, v51, v131
s_add_u32 m0, s39, 1024
s_add_u32 s37, s37, s38
buffer_load_dwordx4 v23, s[8:11], s37 offen sc1 lds
v_fma_f32 v192, -v32, v64, v192
v_fma_f32 v193, -v32, v65, v193
v_fma_f32 v194, -v32, v66, v194
s_add_u32 m0, s39, 2048
s_add_u32 s37, s37, s38
buffer_load_dwordx4 v22, s[8:11], s37 offen sc1 lds
v_fma_f32 v195, -v32, v67, v195
v_mul_f32 v80, v128, v128
v_mul_f32 v81, v129, v129
s_add_u32 m0, s39, 3072
s_add_u32 s37, s37, s38
buffer_load_dwordx4 v23, s[8:11], s37 offen sc1 lds
v_mul_f32 v82, v130, v130
v_mul_f32 v83, v131, v131
v_fma_f32 v80, v80, v40, v36
s_add_u32 m0, s39, 4096
s_add_u32 s37, s37, s38
buffer_load_dwordx4 v22, s[8:11], s37 offen sc1 lds
v_fma_f32 v81, v81, v40, v36
v_fma_f32 v82, v82, v40, v36
v_fma_f32 v83, v83, v40, v36
v_mul_f32 v80, v80, v128
s_add_u32 m0, s39, 5120
s_add_u32 s37, s37, s38
buffer_load_dwordx4 v23, s[8:11], s37 offen sc1 lds
v_mul_f32 v81, v81, v129
v_mul_f32 v82, v82, v130
v_mul_f32 v83, v83, v131
s_add_u32 m0, s39, 6144
s_add_u32 s37, s37, s38
buffer_load_dwordx4 v22, s[8:11], s37 offen sc1 lds
v_exp_f32 v80, v80
v_exp_f32 v81, v81
v_exp_f32 v82, v82
s_add_u32 m0, s39, 7168
s_add_u32 s37, s37, s38
buffer_load_dwordx4 v23, s[8:11], s37 offen sc1 lds
v_exp_f32 v83, v83
v_mul_f32 v192, v128, v192
v_mul_f32 v193, v129, v193
s_add_u32 m0, s39, 8192
s_add_u32 s37, s37, s38
buffer_load_dwordx4 v22, s[8:11], s37 offen sc1 lds
v_mul_f32 v194, v130, v194
v_mul_f32 v195, v131, v195
v_fma_f32 v80, v80, v44, v44
v_fma_f32 v81, v81, v44, v44
s_add_u32 m0, s39, 9216
s_add_u32 s37, s37, s38
buffer_load_dwordx4 v23, s[8:11], s37 offen sc1 lds
v_fma_f32 v82, v82, v44, v44
v_fma_f32 v83, v83, v44, v44
v_rcp_f32 v80, v80
s_add_u32 m0, s39, 10240
s_add_u32 s37, s37, s38
buffer_load_dwordx4 v22, s[8:11], s37 offen sc1 lds
v_rcp_f32 v81, v81
v_rcp_f32 v82, v82
v_rcp_f32 v83, v83
s_add_u32 m0, s39, 11264
s_add_u32 s37, s37, s38
buffer_load_dwordx4 v23, s[8:11], s37 offen sc1 lds
v_mul_f32 v192, v192, v80
v_mul_f32 v193, v193, v81
v_mul_f32 v194, v194, v82
s_add_u32 m0, s39, 12288
s_add_u32 s37, s37, s38
buffer_load_dwordx4 v22, s[8:11], s37 offen sc1 lds
v_mul_f32 v195, v195, v83
v_cvt_pk_bf16_f32 v96, v192, v193
v_cvt_pk_bf16_f32 v97, v194, v195
v_fma_f32 v144, -v32, v52, v144
s_add_u32 m0, s39, 13312
s_add_u32 s37, s37, s38
buffer_load_dwordx4 v23, s[8:11], s37 offen sc1 lds
v_fma_f32 v145, -v32, v53, v145
v_fma_f32 v146, -v32, v54, v146
v_fma_f32 v147, -v32, v55, v147
s_add_u32 m0, s39, 14336
s_add_u32 s37, s37, s38
buffer_load_dwordx4 v22, s[8:11], s37 offen sc1 lds
v_fma_f32 v208, -v32, v68, v208
v_fma_f32 v209, -v32, v69, v209
v_fma_f32 v210, -v32, v70, v210
s_add_u32 m0, s39, 15360
s_add_u32 s37, s37, s38
buffer_load_dwordx4 v23, s[8:11], s37 offen sc1 lds
v_fma_f32 v211, -v32, v71, v211
v_mul_f32 v84, v144, v144
v_mul_f32 v85, v145, v145
s_waitcnt vmcnt(16)
s_barrier
s_add_u32 s42, s42, 1
s_and_b32 s42, s42, 15
s_add_u32 m0, s39, 49152
s_mul_i32 s37, s42, s40
buffer_load_dwordx4 v22, s[8:11], s37 offen sc1 lds
v_mul_f32 v86, v146, v146
v_mul_f32 v87, v147, v147
v_fma_f32 v84, v84, v40, v36
v_fma_f32 v85, v85, v40, v36
v_fma_f32 v86, v86, v40, v36
s_add_u32 m0, s39, 50176
s_add_u32 s37, s37, s38
buffer_load_dwordx4 v23, s[8:11], s37 offen sc1 lds
v_fma_f32 v87, v87, v40, v36
v_mul_f32 v84, v84, v144
v_mul_f32 v85, v85, v145
v_mul_f32 v86, v86, v146
v_mul_f32 v87, v87, v147
s_add_u32 m0, s39, 51200
s_add_u32 s37, s37, s38
buffer_load_dwordx4 v22, s[8:11], s37 offen sc1 lds
v_exp_f32 v84, v84
v_exp_f32 v85, v85
v_exp_f32 v86, v86
v_exp_f32 v87, v87
s_add_u32 m0, s39, 52224
s_add_u32 s37, s37, s38
buffer_load_dwordx4 v23, s[8:11], s37 offen sc1 lds
v_mul_f32 v208, v144, v208
v_mul_f32 v209, v145, v209
v_mul_f32 v210, v146, v210
v_mul_f32 v211, v147, v211
v_fma_f32 v84, v84, v44, v44
s_add_u32 m0, s39, 53248
s_add_u32 s37, s37, s38
buffer_load_dwordx4 v22, s[8:11], s37 offen sc1 lds
v_fma_f32 v85, v85, v44, v44
v_fma_f32 v86, v86, v44, v44
v_fma_f32 v87, v87, v44, v44
v_rcp_f32 v84, v84
v_rcp_f32 v85, v85
s_add_u32 m0, s39, 54272
s_add_u32 s37, s37, s38
buffer_load_dwordx4 v23, s[8:11], s37 offen sc1 lds
v_rcp_f32 v86, v86
v_rcp_f32 v87, v87
v_mul_f32 v208, v208, v84
v_mul_f32 v209, v209, v85
s_add_u32 m0, s39, 55296
s_add_u32 s37, s37, s38
buffer_load_dwordx4 v22, s[8:11], s37 offen sc1 lds
v_mul_f32 v210, v210, v86
v_mul_f32 v211, v211, v87
v_cvt_pk_bf16_f32 v98, v208, v209
v_cvt_pk_bf16_f32 v99, v210, v211
s_add_u32 m0, s39, 56320
s_add_u32 s37, s37, s38
buffer_load_dwordx4 v23, s[8:11], s37 offen sc1 lds
v_fma_f32 v132, -v33, v48, v132
v_fma_f32 v133, -v33, v49, v133
v_fma_f32 v134, -v33, v50, v134
v_fma_f32 v135, -v33, v51, v135
s_add_u32 m0, s39, 57344
s_add_u32 s37, s37, s38
buffer_load_dwordx4 v22, s[8:11], s37 offen sc1 lds
v_fma_f32 v196, -v33, v64, v196
v_fma_f32 v197, -v33, v65, v197
v_fma_f32 v198, -v33, v66, v198
v_fma_f32 v199, -v33, v67, v199
v_mul_f32 v80, v132, v132
s_add_u32 m0, s39, 58368
s_add_u32 s37, s37, s38
buffer_load_dwordx4 v23, s[8:11], s37 offen sc1 lds
v_mul_f32 v81, v133, v133
v_mul_f32 v82, v134, v134
v_mul_f32 v83, v135, v135
v_fma_f32 v80, v80, v41, v37
v_fma_f32 v81, v81, v41, v37
s_add_u32 m0, s39, 59392
s_add_u32 s37, s37, s38
buffer_load_dwordx4 v22, s[8:11], s37 offen sc1 lds
v_fma_f32 v82, v82, v41, v37
v_fma_f32 v83, v83, v41, v37
v_mul_f32 v80, v80, v132
v_mul_f32 v81, v81, v133
s_add_u32 m0, s39, 60416
s_add_u32 s37, s37, s38
buffer_load_dwordx4 v23, s[8:11], s37 offen sc1 lds
v_mul_f32 v82, v82, v134
v_lshlrev_b32 v19, 11, v18
v_lshl_add_u32 v19, v17, 4, v19
s_lshl_b32 s43, s46, 10
v_add_u32 v2, s43, v19
s_add_u32 m0, s39, 61440
s_add_u32 s37, s37, s38
buffer_load_dwordx4 v22, s[8:11], s37 offen sc1 lds
v_add_u32 v3, 0x10000, v2
v_lshrrev_b32 v19, 2, v17
v_lshl_add_u32 v20, v18, 2, v19
v_bfe_u32 v21, v20, 1, 2
s_lshl_b32 s43, s47, 1
s_add_u32 m0, s39, 62464
s_add_u32 s37, s37, s38
buffer_load_dwordx4 v23, s[8:11], s37 offen sc1 lds
v_xor_b32 v21, s43, v21
v_lshlrev_b32 v20, 7, v20
v_lshl_add_u32 v20, v21, 5, v20
v_and_b32 v19, 3, v1
s_add_u32 m0, s39, 63488
s_add_u32 s37, s37, s38
buffer_load_dwordx4 v22, s[8:11], s37 offen sc1 lds
v_lshl_add_u32 v20, v19, 3, v20
v_add_u32 v5, 16384, v20
v_xor_b32 v6, 32, v5
v_add_u32 v7, 0x10000, v5
v_add_u32 v8, 0x10000, v6
s_add_u32 m0, s39, 64512
s_add_u32 s37, s37, s38
buffer_load_dwordx4 v23, s[8:11], s37 offen sc1 lds
s_lshl_b32 s43, s36, 13
v_lshl_add_u32 v9, v1, 4, s43
s_mov_b32 s54, 0x10000
s_movk_i32 s52, 0x1000
buffer_store_dwordx4 v[96:99], v27, s[24:27], 0 offen offset:0 sc1
s_waitcnt vmcnt(17)
s_barrier
s_add_u32 s42, s42, 1
s_and_b32 s42, s42, 15
s_add_u32 m0, s39, 98304
s_mul_i32 s37, s42, s40
buffer_load_dwordx4 v22, s[8:11], s37 offen sc1 lds
v_mul_f32 v83, v83, v135
v_exp_f32 v80, v80
v_exp_f32 v81, v81
v_exp_f32 v82, v82
s_add_u32 m0, s39, 99328
s_add_u32 s37, s37, s38
buffer_load_dwordx4 v23, s[8:11], s37 offen sc1 lds
v_exp_f32 v83, v83
v_mul_f32 v196, v132, v196
v_mul_f32 v197, v133, v197
s_add_u32 m0, s39, 100352
s_add_u32 s37, s37, s38
buffer_load_dwordx4 v22, s[8:11], s37 offen sc1 lds
v_mul_f32 v198, v134, v198
v_mul_f32 v199, v135, v199
v_fma_f32 v80, v80, v45, v45
s_add_u32 m0, s39, 101376
s_add_u32 s37, s37, s38
buffer_load_dwordx4 v23, s[8:11], s37 offen sc1 lds
v_fma_f32 v81, v81, v45, v45
v_fma_f32 v82, v82, v45, v45
v_fma_f32 v83, v83, v45, v45
s_add_u32 m0, s39, 102400
s_add_u32 s37, s37, s38
buffer_load_dwordx4 v22, s[8:11], s37 offen sc1 lds
v_rcp_f32 v80, v80
v_rcp_f32 v81, v81
v_rcp_f32 v82, v82
v_rcp_f32 v83, v83
s_add_u32 m0, s39, 103424
s_add_u32 s37, s37, s38
buffer_load_dwordx4 v23, s[8:11], s37 offen sc1 lds
v_mul_f32 v196, v196, v80
v_mul_f32 v197, v197, v81
v_mul_f32 v198, v198, v82
s_add_u32 m0, s39, 104448
s_add_u32 s37, s37, s38
buffer_load_dwordx4 v22, s[8:11], s37 offen sc1 lds
v_mul_f32 v199, v199, v83
v_cvt_pk_bf16_f32 v100, v196, v197
v_cvt_pk_bf16_f32 v101, v198, v199
s_add_u32 m0, s39, 105472
s_add_u32 s37, s37, s38
buffer_load_dwordx4 v23, s[8:11], s37 offen sc1 lds
v_fma_f32 v148, -v33, v52, v148
v_fma_f32 v149, -v33, v53, v149
v_fma_f32 v150, -v33, v54, v150
s_add_u32 m0, s39, 106496
s_add_u32 s37, s37, s38
buffer_load_dwordx4 v22, s[8:11], s37 offen sc1 lds
v_fma_f32 v151, -v33, v55, v151
v_fma_f32 v212, -v33, v68, v212
v_fma_f32 v213, -v33, v69, v213
v_fma_f32 v214, -v33, v70, v214
s_add_u32 m0, s39, 107520
s_add_u32 s37, s37, s38
buffer_load_dwordx4 v23, s[8:11], s37 offen sc1 lds
v_fma_f32 v215, -v33, v71, v215
v_mul_f32 v84, v148, v148
v_mul_f32 v85, v149, v149
s_add_u32 m0, s39, 108544
s_add_u32 s37, s37, s38
buffer_load_dwordx4 v22, s[8:11], s37 offen sc1 lds
v_mul_f32 v86, v150, v150
v_mul_f32 v87, v151, v151
v_fma_f32 v84, v84, v41, v37
s_add_u32 m0, s39, 109568
s_add_u32 s37, s37, s38
buffer_load_dwordx4 v23, s[8:11], s37 offen sc1 lds
v_fma_f32 v85, v85, v41, v37
v_fma_f32 v86, v86, v41, v37
v_fma_f32 v87, v87, v41, v37
s_add_u32 m0, s39, 110592
s_add_u32 s37, s37, s38
buffer_load_dwordx4 v22, s[8:11], s37 offen sc1 lds
v_mul_f32 v84, v84, v148
v_mul_f32 v85, v85, v149
v_mul_f32 v86, v86, v150
v_mul_f32 v87, v87, v151
s_add_u32 m0, s39, 111616
s_add_u32 s37, s37, s38
buffer_load_dwordx4 v23, s[8:11], s37 offen sc1 lds
v_exp_f32 v84, v84
v_exp_f32 v85, v85
v_exp_f32 v86, v86
s_add_u32 m0, s39, 112640
s_add_u32 s37, s37, s38
buffer_load_dwordx4 v22, s[8:11], s37 offen sc1 lds
v_exp_f32 v87, v87
v_mul_f32 v212, v148, v212
v_mul_f32 v213, v149, v213
s_add_u32 m0, s39, 113664
s_add_u32 s37, s37, s38
buffer_load_dwordx4 v23, s[8:11], s37 offen sc1 lds
v_mul_f32 v214, v150, v214
v_mul_f32 v215, v151, v215
v_fma_f32 v84, v84, v45, v45
s_waitcnt vmcnt(17)
s_barrier
s_add_u32 s42, s42, 1
s_and_b32 s42, s42, 15
s_add_u32 m0, s39, 0
s_mul_i32 s37, s42, s40
buffer_load_dwordx4 v22, s[8:11], s37 offen sc1 lds
v_fma_f32 v85, v85, v45, v45
v_fma_f32 v86, v86, v45, v45
v_fma_f32 v87, v87, v45, v45
v_rcp_f32 v84, v84
s_add_u32 m0, s39, 1024
s_add_u32 s37, s37, s38
buffer_load_dwordx4 v23, s[8:11], s37 offen sc1 lds
v_rcp_f32 v85, v85
v_rcp_f32 v86, v86
v_rcp_f32 v87, v87
s_add_u32 m0, s39, 2048
s_add_u32 s37, s37, s38
buffer_load_dwordx4 v22, s[8:11], s37 offen sc1 lds
v_mul_f32 v212, v212, v84
v_mul_f32 v213, v213, v85
v_mul_f32 v214, v214, v86
s_add_u32 m0, s39, 3072
s_add_u32 s37, s37, s38
buffer_load_dwordx4 v23, s[8:11], s37 offen sc1 lds
v_mul_f32 v215, v215, v87
v_cvt_pk_bf16_f32 v102, v212, v213
v_cvt_pk_bf16_f32 v103, v214, v215
s_add_u32 m0, s39, 4096
s_add_u32 s37, s37, s38
buffer_load_dwordx4 v22, s[8:11], s37 offen sc1 lds
v_fma_f32 v136, -v34, v48, v136
v_fma_f32 v137, -v34, v49, v137
v_fma_f32 v138, -v34, v50, v138
s_add_u32 m0, s39, 5120
s_add_u32 s37, s37, s38
buffer_load_dwordx4 v23, s[8:11], s37 offen sc1 lds
v_fma_f32 v139, -v34, v51, v139
v_fma_f32 v200, -v34, v64, v200
v_fma_f32 v201, -v34, v65, v201
s_add_u32 m0, s39, 6144
s_add_u32 s37, s37, s38
buffer_load_dwordx4 v22, s[8:11], s37 offen sc1 lds
v_fma_f32 v202, -v34, v66, v202
v_fma_f32 v203, -v34, v67, v203
v_mul_f32 v80, v136, v136
v_mul_f32 v81, v137, v137
s_add_u32 m0, s39, 7168
s_add_u32 s37, s37, s38
buffer_load_dwordx4 v23, s[8:11], s37 offen sc1 lds
v_mul_f32 v82, v138, v138
v_mul_f32 v83, v139, v139
v_fma_f32 v80, v80, v42, v38
s_add_u32 m0, s39, 8192
s_add_u32 s37, s37, s38
buffer_load_dwordx4 v22, s[8:11], s37 offen sc1 lds
v_fma_f32 v81, v81, v42, v38
v_fma_f32 v82, v82, v42, v38
v_fma_f32 v83, v83, v42, v38
s_add_u32 m0, s39, 9216
s_add_u32 s37, s37, s38
buffer_load_dwordx4 v23, s[8:11], s37 offen sc1 lds
v_mul_f32 v80, v80, v136
v_mul_f32 v81, v81, v137
v_mul_f32 v82, v82, v138
v_mul_f32 v83, v83, v139
s_add_u32 m0, s39, 10240
s_add_u32 s37, s37, s38
buffer_load_dwordx4 v22, s[8:11], s37 offen sc1 lds
v_exp_f32 v80, v80
v_exp_f32 v81, v81
v_exp_f32 v82, v82
s_add_u32 m0, s39, 11264
s_add_u32 s37, s37, s38
buffer_load_dwordx4 v23, s[8:11], s37 offen sc1 lds
v_exp_f32 v83, v83
v_mul_f32 v200, v136, v200
v_mul_f32 v201, v137, v201
s_add_u32 m0, s39, 12288
s_add_u32 s37, s37, s38
buffer_load_dwordx4 v22, s[8:11], s37 offen sc1 lds
v_mul_f32 v202, v138, v202
v_mul_f32 v203, v139, v203
v_fma_f32 v80, v80, v46, v46
v_fma_f32 v81, v81, v46, v46
s_add_u32 m0, s39, 13312
s_add_u32 s37, s37, s38
buffer_load_dwordx4 v23, s[8:11], s37 offen sc1 lds
v_fma_f32 v82, v82, v46, v46
v_fma_f32 v83, v83, v46, v46
v_rcp_f32 v80, v80
s_add_u32 m0, s39, 14336
s_add_u32 s37, s37, s38
buffer_load_dwordx4 v22, s[8:11], s37 offen sc1 lds
v_rcp_f32 v81, v81
v_rcp_f32 v82, v82
v_rcp_f32 v83, v83
s_add_u32 m0, s39, 15360
s_add_u32 s37, s37, s38
buffer_load_dwordx4 v23, s[8:11], s37 offen sc1 lds
v_mul_f32 v200, v200, v80
v_mul_f32 v201, v201, v81
v_mul_f32 v202, v202, v82
buffer_store_dwordx4 v[100:103], v27, s[24:27], 0 offen offset:256 sc1
s_waitcnt vmcnt(17)
s_barrier
s_add_u32 s42, s42, 1
s_and_b32 s42, s42, 15
s_add_u32 m0, s39, 49152
s_mul_i32 s37, s42, s40
buffer_load_dwordx4 v22, s[8:11], s37 offen sc1 lds
v_mul_f32 v203, v203, v83
v_cvt_pk_bf16_f32 v104, v200, v201
v_cvt_pk_bf16_f32 v105, v202, v203
v_fma_f32 v152, -v34, v52, v152
s_add_u32 m0, s39, 50176
s_add_u32 s37, s37, s38
buffer_load_dwordx4 v23, s[8:11], s37 offen sc1 lds
v_fma_f32 v153, -v34, v53, v153
v_fma_f32 v154, -v34, v54, v154
v_fma_f32 v155, -v34, v55, v155
s_add_u32 m0, s39, 51200
s_add_u32 s37, s37, s38
buffer_load_dwordx4 v22, s[8:11], s37 offen sc1 lds
v_fma_f32 v216, -v34, v68, v216
v_fma_f32 v217, -v34, v69, v217
v_fma_f32 v218, -v34, v70, v218
s_add_u32 m0, s39, 52224
s_add_u32 s37, s37, s38
buffer_load_dwordx4 v23, s[8:11], s37 offen sc1 lds
v_fma_f32 v219, -v34, v71, v219
v_mul_f32 v84, v152, v152
v_mul_f32 v85, v153, v153
s_add_u32 m0, s39, 53248
s_add_u32 s37, s37, s38
buffer_load_dwordx4 v22, s[8:11], s37 offen sc1 lds
v_mul_f32 v86, v154, v154
v_mul_f32 v87, v155, v155
v_fma_f32 v84, v84, v42, v38
v_fma_f32 v85, v85, v42, v38
s_add_u32 m0, s39, 54272
s_add_u32 s37, s37, s38
buffer_load_dwordx4 v23, s[8:11], s37 offen sc1 lds
v_fma_f32 v86, v86, v42, v38
v_fma_f32 v87, v87, v42, v38
v_mul_f32 v84, v84, v152
s_add_u32 m0, s39, 55296
s_add_u32 s37, s37, s38
buffer_load_dwordx4 v22, s[8:11], s37 offen sc1 lds
v_mul_f32 v85, v85, v153
v_mul_f32 v86, v86, v154
v_mul_f32 v87, v87, v155
s_add_u32 m0, s39, 56320
s_add_u32 s37, s37, s38
buffer_load_dwordx4 v23, s[8:11], s37 offen sc1 lds
v_exp_f32 v84, v84
v_exp_f32 v85, v85
v_exp_f32 v86, v86
s_add_u32 m0, s39, 57344
s_add_u32 s37, s37, s38
buffer_load_dwordx4 v22, s[8:11], s37 offen sc1 lds
v_exp_f32 v87, v87
v_mul_f32 v216, v152, v216
v_mul_f32 v217, v153, v217
v_mul_f32 v218, v154, v218
s_add_u32 m0, s39, 58368
s_add_u32 s37, s37, s38
buffer_load_dwordx4 v23, s[8:11], s37 offen sc1 lds
v_mul_f32 v219, v155, v219
v_fma_f32 v84, v84, v46, v46
v_fma_f32 v85, v85, v46, v46
s_add_u32 m0, s39, 59392
s_add_u32 s37, s37, s38
buffer_load_dwordx4 v22, s[8:11], s37 offen sc1 lds
v_fma_f32 v86, v86, v46, v46
v_fma_f32 v87, v87, v46, v46
v_rcp_f32 v84, v84
s_add_u32 m0, s39, 60416
s_add_u32 s37, s37, s38
buffer_load_dwordx4 v23, s[8:11], s37 offen sc1 lds
v_rcp_f32 v85, v85
v_rcp_f32 v86, v86
v_rcp_f32 v87, v87
s_add_u32 m0, s39, 61440
s_add_u32 s37, s37, s38
buffer_load_dwordx4 v22, s[8:11], s37 offen sc1 lds
v_mul_f32 v216, v216, v84
v_mul_f32 v217, v217, v85
v_mul_f32 v218, v218, v86
v_mul_f32 v219, v219, v87
s_add_u32 m0, s39, 62464
s_add_u32 s37, s37, s38
buffer_load_dwordx4 v23, s[8:11], s37 offen sc1 lds
v_cvt_pk_bf16_f32 v106, v216, v217
v_cvt_pk_bf16_f32 v107, v218, v219
s_add_u32 m0, s39, 63488
s_add_u32 s37, s37, s38
buffer_load_dwordx4 v22, s[8:11], s37 offen sc1 lds
v_fma_f32 v140, -v35, v48, v140
v_fma_f32 v141, -v35, v49, v141
v_fma_f32 v142, -v35, v50, v142
s_add_u32 m0, s39, 64512
s_add_u32 s37, s37, s38
buffer_load_dwordx4 v23, s[8:11], s37 offen sc1 lds
v_fma_f32 v143, -v35, v51, v143
v_fma_f32 v204, -v35, v64, v204
v_fma_f32 v205, -v35, v65, v205
buffer_store_dwordx4 v[104:107], v27, s[24:27], 0 offen offset:512 sc1
s_waitcnt vmcnt(18)
s_barrier
s_add_u32 s42, s42, 1
s_and_b32 s42, s42, 15
s_add_u32 m0, s39, 98304
s_mul_i32 s37, s42, s40
buffer_load_dwordx4 v22, s[8:11], s37 offen sc1 lds
v_fma_f32 v206, -v35, v66, v206
v_fma_f32 v207, -v35, v67, v207
v_mul_f32 v80, v140, v140
v_mul_f32 v81, v141, v141
s_add_u32 m0, s39, 99328
s_add_u32 s37, s37, s38
buffer_load_dwordx4 v23, s[8:11], s37 offen sc1 lds
v_mul_f32 v82, v142, v142
v_mul_f32 v83, v143, v143
v_fma_f32 v80, v80, v43, v39
s_add_u32 m0, s39, 100352
s_add_u32 s37, s37, s38
buffer_load_dwordx4 v22, s[8:11], s37 offen sc1 lds
v_fma_f32 v81, v81, v43, v39
v_fma_f32 v82, v82, v43, v39
v_fma_f32 v83, v83, v43, v39
s_add_u32 m0, s39, 101376
s_add_u32 s37, s37, s38
buffer_load_dwordx4 v23, s[8:11], s37 offen sc1 lds
v_mul_f32 v80, v80, v140
v_mul_f32 v81, v81, v141
v_mul_f32 v82, v82, v142
s_add_u32 m0, s39, 102400
s_add_u32 s37, s37, s38
buffer_load_dwordx4 v22, s[8:11], s37 offen sc1 lds
v_mul_f32 v83, v83, v143
v_exp_f32 v80, v80
v_exp_f32 v81, v81
v_exp_f32 v82, v82
s_add_u32 m0, s39, 103424
s_add_u32 s37, s37, s38
buffer_load_dwordx4 v23, s[8:11], s37 offen sc1 lds
v_exp_f32 v83, v83
v_mul_f32 v204, v140, v204
v_mul_f32 v205, v141, v205
s_add_u32 m0, s39, 104448
s_add_u32 s37, s37, s38
buffer_load_dwordx4 v22, s[8:11], s37 offen sc1 lds
v_mul_f32 v206, v142, v206
v_mul_f32 v207, v143, v207
v_fma_f32 v80, v80, v47, v47
s_add_u32 m0, s39, 105472
s_add_u32 s37, s37, s38
buffer_load_dwordx4 v23, s[8:11], s37 offen sc1 lds
v_fma_f32 v81, v81, v47, v47
v_fma_f32 v82, v82, v47, v47
v_fma_f32 v83, v83, v47, v47
s_add_u32 m0, s39, 106496
s_add_u32 s37, s37, s38
buffer_load_dwordx4 v22, s[8:11], s37 offen sc1 lds
v_rcp_f32 v80, v80
v_rcp_f32 v81, v81
v_rcp_f32 v82, v82
v_rcp_f32 v83, v83
s_add_u32 m0, s39, 107520
s_add_u32 s37, s37, s38
buffer_load_dwordx4 v23, s[8:11], s37 offen sc1 lds
v_mul_f32 v204, v204, v80
v_mul_f32 v205, v205, v81
v_mul_f32 v206, v206, v82
s_add_u32 m0, s39, 108544
s_add_u32 s37, s37, s38
buffer_load_dwordx4 v22, s[8:11], s37 offen sc1 lds
v_mul_f32 v207, v207, v83
v_cvt_pk_bf16_f32 v108, v204, v205
v_cvt_pk_bf16_f32 v109, v206, v207
s_add_u32 m0, s39, 109568
s_add_u32 s37, s37, s38
buffer_load_dwordx4 v23, s[8:11], s37 offen sc1 lds
v_fma_f32 v156, -v35, v52, v156
v_fma_f32 v157, -v35, v53, v157
v_fma_f32 v158, -v35, v54, v158
s_add_u32 m0, s39, 110592
s_add_u32 s37, s37, s38
buffer_load_dwordx4 v22, s[8:11], s37 offen sc1 lds
v_fma_f32 v159, -v35, v55, v159
v_fma_f32 v220, -v35, v68, v220
v_fma_f32 v221, -v35, v69, v221
v_fma_f32 v222, -v35, v70, v222
s_add_u32 m0, s39, 111616
s_add_u32 s37, s37, s38
buffer_load_dwordx4 v23, s[8:11], s37 offen sc1 lds
v_fma_f32 v223, -v35, v71, v223
v_mul_f32 v84, v156, v156
v_mul_f32 v85, v157, v157
s_add_u32 m0, s39, 112640
s_add_u32 s37, s37, s38
buffer_load_dwordx4 v22, s[8:11], s37 offen sc1 lds
v_mul_f32 v86, v158, v158
v_mul_f32 v87, v159, v159
v_fma_f32 v84, v84, v43, v39
s_add_u32 m0, s39, 113664
s_add_u32 s37, s37, s38
buffer_load_dwordx4 v23, s[8:11], s37 offen sc1 lds
v_fma_f32 v85, v85, v43, v39
v_fma_f32 v86, v86, v43, v39
v_fma_f32 v87, v87, v43, v39
s_waitcnt vmcnt(17)
s_barrier
s_add_u32 s42, s42, 1
s_and_b32 s42, s42, 15
s_add_u32 m0, s39, 0
s_mul_i32 s37, s42, s40
buffer_load_dwordx4 v22, s[8:11], s37 offen sc1 lds
v_mul_f32 v84, v84, v156
v_mul_f32 v85, v85, v157
v_mul_f32 v86, v86, v158
v_mul_f32 v87, v87, v159
s_add_u32 m0, s39, 1024
s_add_u32 s37, s37, s38
buffer_load_dwordx4 v23, s[8:11], s37 offen sc1 lds
v_exp_f32 v84, v84
v_exp_f32 v85, v85
v_exp_f32 v86, v86
s_add_u32 m0, s39, 2048
s_add_u32 s37, s37, s38
buffer_load_dwordx4 v22, s[8:11], s37 offen sc1 lds
v_exp_f32 v87, v87
v_mul_f32 v220, v156, v220
v_mul_f32 v221, v157, v221
s_add_u32 m0, s39, 3072
s_add_u32 s37, s37, s38
buffer_load_dwordx4 v23, s[8:11], s37 offen sc1 lds
v_mul_f32 v222, v158, v222
v_mul_f32 v223, v159, v223
v_fma_f32 v84, v84, v47, v47
v_fma_f32 v85, v85, v47, v47
s_add_u32 m0, s39, 4096
s_add_u32 s37, s37, s38
buffer_load_dwordx4 v22, s[8:11], s37 offen sc1 lds
v_fma_f32 v86, v86, v47, v47
v_fma_f32 v87, v87, v47, v47
v_rcp_f32 v84, v84
s_add_u32 m0, s39, 5120
s_add_u32 s37, s37, s38
buffer_load_dwordx4 v23, s[8:11], s37 offen sc1 lds
v_rcp_f32 v85, v85
v_rcp_f32 v86, v86
v_rcp_f32 v87, v87
s_add_u32 m0, s39, 6144
s_add_u32 s37, s37, s38
buffer_load_dwordx4 v22, s[8:11], s37 offen sc1 lds
v_mul_f32 v220, v220, v84
v_mul_f32 v221, v221, v85
v_mul_f32 v222, v222, v86
v_mul_f32 v223, v223, v87
s_add_u32 m0, s39, 7168
s_add_u32 s37, s37, s38
buffer_load_dwordx4 v23, s[8:11], s37 offen sc1 lds
v_cvt_pk_bf16_f32 v110, v220, v221
v_cvt_pk_bf16_f32 v111, v222, v223
s_add_u32 m0, s39, 8192
s_add_u32 s37, s37, s38
buffer_load_dwordx4 v22, s[8:11], s37 offen sc1 lds
v_fma_f32 v160, -v32, v56, v160
v_fma_f32 v161, -v32, v57, v161
v_fma_f32 v162, -v32, v58, v162
s_add_u32 m0, s39, 9216
s_add_u32 s37, s37, s38
buffer_load_dwordx4 v23, s[8:11], s37 offen sc1 lds
v_fma_f32 v163, -v32, v59, v163
v_fma_f32 v224, -v32, v72, v224
v_fma_f32 v225, -v32, v73, v225
v_fma_f32 v226, -v32, v74, v226
s_add_u32 m0, s39, 10240
s_add_u32 s37, s37, s38
buffer_load_dwordx4 v22, s[8:11], s37 offen sc1 lds
v_fma_f32 v227, -v32, v75, v227
v_mul_f32 v80, v160, v160
v_mul_f32 v81, v161, v161
s_add_u32 m0, s39, 11264
s_add_u32 s37, s37, s38
buffer_load_dwordx4 v23, s[8:11], s37 offen sc1 lds
v_mul_f32 v82, v162, v162
v_mul_f32 v83, v163, v163
v_fma_f32 v80, v80, v40, v36
s_add_u32 m0, s39, 12288
s_add_u32 s37, s37, s38
buffer_load_dwordx4 v22, s[8:11], s37 offen sc1 lds
v_fma_f32 v81, v81, v40, v36
v_fma_f32 v82, v82, v40, v36
v_fma_f32 v83, v83, v40, v36
v_mul_f32 v80, v80, v160
s_add_u32 m0, s39, 13312
s_add_u32 s37, s37, s38
buffer_load_dwordx4 v23, s[8:11], s37 offen sc1 lds
v_mul_f32 v81, v81, v161
v_mul_f32 v82, v82, v162
v_mul_f32 v83, v83, v163
s_add_u32 m0, s39, 14336
s_add_u32 s37, s37, s38
buffer_load_dwordx4 v22, s[8:11], s37 offen sc1 lds
v_exp_f32 v80, v80
v_exp_f32 v81, v81
v_exp_f32 v82, v82
s_add_u32 m0, s39, 15360
s_add_u32 s37, s37, s38
buffer_load_dwordx4 v23, s[8:11], s37 offen sc1 lds
v_exp_f32 v83, v83
v_mul_f32 v224, v160, v224
v_mul_f32 v225, v161, v225
buffer_store_dwordx4 v[108:111], v27, s[24:27], 0 offen offset:768 sc1
s_waitcnt vmcnt(17)
s_barrier
s_add_u32 s42, s42, 1
s_and_b32 s42, s42, 15
s_add_u32 m0, s39, 49152
s_mul_i32 s37, s42, s40
buffer_load_dwordx4 v22, s[8:11], s37 offen sc1 lds
v_mul_f32 v226, v162, v226
v_mul_f32 v227, v163, v227
v_fma_f32 v80, v80, v44, v44
v_fma_f32 v81, v81, v44, v44
s_add_u32 m0, s39, 50176
s_add_u32 s37, s37, s38
buffer_load_dwordx4 v23, s[8:11], s37 offen sc1 lds
v_fma_f32 v82, v82, v44, v44
v_fma_f32 v83, v83, v44, v44
v_rcp_f32 v80, v80
v_rcp_f32 v81, v81
s_add_u32 m0, s39, 51200
s_add_u32 s37, s37, s38
buffer_load_dwordx4 v22, s[8:11], s37 offen sc1 lds
v_rcp_f32 v82, v82
v_rcp_f32 v83, v83
v_mul_f32 v224, v224, v80
v_mul_f32 v225, v225, v81
s_add_u32 m0, s39, 52224
s_add_u32 s37, s37, s38
buffer_load_dwordx4 v23, s[8:11], s37 offen sc1 lds
v_mul_f32 v226, v226, v82
v_mul_f32 v227, v227, v83
v_cvt_pk_bf16_f32 v96, v224, v225
v_cvt_pk_bf16_f32 v97, v226, v227
s_add_u32 m0, s39, 53248
s_add_u32 s37, s37, s38
buffer_load_dwordx4 v22, s[8:11], s37 offen sc1 lds
v_fma_f32 v176, -v32, v60, v176
v_fma_f32 v177, -v32, v61, v177
v_fma_f32 v178, -v32, v62, v178
v_fma_f32 v179, -v32, v63, v179
s_add_u32 m0, s39, 54272
s_add_u32 s37, s37, s38
buffer_load_dwordx4 v23, s[8:11], s37 offen sc1 lds
v_fma_f32 v240, -v32, v76, v240
v_fma_f32 v241, -v32, v77, v241
v_fma_f32 v242, -v32, v78, v242
v_fma_f32 v243, -v32, v79, v243
s_add_u32 m0, s39, 55296
s_add_u32 s37, s37, s38
buffer_load_dwordx4 v22, s[8:11], s37 offen sc1 lds
v_mul_f32 v84, v176, v176
v_mul_f32 v85, v177, v177
v_mul_f32 v86, v178, v178
v_mul_f32 v87, v179, v179
s_add_u32 m0, s39, 56320
s_add_u32 s37, s37, s38
buffer_load_dwordx4 v23, s[8:11], s37 offen sc1 lds
v_fma_f32 v84, v84, v40, v36
v_fma_f32 v85, v85, v40, v36
v_fma_f32 v86, v86, v40, v36
s_add_u32 m0, s39, 57344
s_add_u32 s37, s37, s38
buffer_load_dwordx4 v22, s[8:11], s37 offen sc1 lds
v_fma_f32 v87, v87, v40, v36
v_mul_f32 v84, v84, v176
v_mul_f32 v85, v85, v177
v_mul_f32 v86, v86, v178
s_add_u32 m0, s39, 58368
s_add_u32 s37, s37, s38
buffer_load_dwordx4 v23, s[8:11], s37 offen sc1 lds
v_mul_f32 v87, v87, v179
v_exp_f32 v84, v84
v_exp_f32 v85, v85
v_exp_f32 v86, v86
s_add_u32 m0, s39, 59392
s_add_u32 s37, s37, s38
buffer_load_dwordx4 v22, s[8:11], s37 offen sc1 lds
v_exp_f32 v87, v87
v_mul_f32 v240, v176, v240
v_mul_f32 v241, v177, v241
v_mul_f32 v242, v178, v242
s_add_u32 m0, s39, 60416
s_add_u32 s37, s37, s38
buffer_load_dwordx4 v23, s[8:11], s37 offen sc1 lds
v_mul_f32 v243, v179, v243
v_fma_f32 v84, v84, v44, v44
v_fma_f32 v85, v85, v44, v44
v_fma_f32 v86, v86, v44, v44
s_add_u32 m0, s39, 61440
s_add_u32 s37, s37, s38
buffer_load_dwordx4 v22, s[8:11], s37 offen sc1 lds
v_fma_f32 v87, v87, v44, v44
v_rcp_f32 v84, v84
v_rcp_f32 v85, v85
v_rcp_f32 v86, v86
s_add_u32 m0, s39, 62464
s_add_u32 s37, s37, s38
buffer_load_dwordx4 v23, s[8:11], s37 offen sc1 lds
v_rcp_f32 v87, v87
v_lshlrev_b32 v19, 11, v18
v_lshl_add_u32 v19, v17, 4, v19
s_lshl_b32 s43, s46, 10
s_add_u32 m0, s39, 63488
s_add_u32 s37, s37, s38
buffer_load_dwordx4 v22, s[8:11], s37 offen sc1 lds
s_lshl_b32 s44, s47, 13
v_add3_u32 v208, v19, s43, 0
v_add_u32 v208, s44, v208
buffer_load_dwordx4 v[192:195], v208, s[20:23], 0 offen offset:0 sc1
s_add_u32 m0, s39, 64512
s_add_u32 s37, s37, s38
buffer_load_dwordx4 v23, s[8:11], s37 offen sc1 lds
buffer_load_dwordx4 v[196:199], v208, s[20:23], 0 offen offset:256 sc1
buffer_load_dwordx4 v[200:203], v208, s[20:23], 0 offen offset:512 sc1
buffer_load_dwordx4 v[204:207], v208, s[20:23], 0 offen offset:768 sc1
s_waitcnt vmcnt(20)
s_barrier
s_add_u32 s42, s42, 1
s_and_b32 s42, s42, 15
s_add_u32 m0, s39, 98304
s_mul_i32 s37, s42, s40
buffer_load_dwordx4 v22, s[8:11], s37 offen sc1 lds
v_mul_f32 v240, v240, v84
v_mul_f32 v241, v241, v85
v_mul_f32 v242, v242, v86
v_mul_f32 v243, v243, v87
s_add_u32 m0, s39, 99328
s_add_u32 s37, s37, s38
buffer_load_dwordx4 v23, s[8:11], s37 offen sc1 lds
v_cvt_pk_bf16_f32 v98, v240, v241
v_cvt_pk_bf16_f32 v99, v242, v243
s_add_u32 m0, s39, 100352
s_add_u32 s37, s37, s38
buffer_load_dwordx4 v22, s[8:11], s37 offen sc1 lds
v_fma_f32 v164, -v33, v56, v164
v_fma_f32 v165, -v33, v57, v165
v_fma_f32 v166, -v33, v58, v166
s_add_u32 m0, s39, 101376
s_add_u32 s37, s37, s38
buffer_load_dwordx4 v23, s[8:11], s37 offen sc1 lds
v_fma_f32 v167, -v33, v59, v167
v_fma_f32 v228, -v33, v72, v228
v_fma_f32 v229, -v33, v73, v229
s_add_u32 m0, s39, 102400
s_add_u32 s37, s37, s38
buffer_load_dwordx4 v22, s[8:11], s37 offen sc1 lds
v_fma_f32 v230, -v33, v74, v230
v_fma_f32 v231, -v33, v75, v231
v_mul_f32 v80, v164, v164
v_mul_f32 v81, v165, v165
s_add_u32 m0, s39, 103424
s_add_u32 s37, s37, s38
buffer_load_dwordx4 v23, s[8:11], s37 offen sc1 lds
v_mul_f32 v82, v166, v166
v_mul_f32 v83, v167, v167
v_fma_f32 v80, v80, v41, v37
s_add_u32 m0, s39, 104448
s_add_u32 s37, s37, s38
buffer_load_dwordx4 v22, s[8:11], s37 offen sc1 lds
v_fma_f32 v81, v81, v41, v37
v_fma_f32 v82, v82, v41, v37
v_fma_f32 v83, v83, v41, v37
s_add_u32 m0, s39, 105472
s_add_u32 s37, s37, s38
buffer_load_dwordx4 v23, s[8:11], s37 offen sc1 lds
v_mul_f32 v80, v80, v164
v_mul_f32 v81, v81, v165
v_mul_f32 v82, v82, v166
s_add_u32 m0, s39, 106496
s_add_u32 s37, s37, s38
buffer_load_dwordx4 v22, s[8:11], s37 offen sc1 lds
v_mul_f32 v83, v83, v167
v_exp_f32 v80, v80
v_exp_f32 v81, v81
v_exp_f32 v82, v82
s_add_u32 m0, s39, 107520
s_add_u32 s37, s37, s38
buffer_load_dwordx4 v23, s[8:11], s37 offen sc1 lds
v_exp_f32 v83, v83
v_mul_f32 v228, v164, v228
v_mul_f32 v229, v165, v229
s_add_u32 m0, s39, 108544
s_add_u32 s37, s37, s38
buffer_load_dwordx4 v22, s[8:11], s37 offen sc1 lds
v_mul_f32 v230, v166, v230
v_mul_f32 v231, v167, v231
v_fma_f32 v80, v80, v45, v45
s_add_u32 m0, s39, 109568
s_add_u32 s37, s37, s38
buffer_load_dwordx4 v23, s[8:11], s37 offen sc1 lds
v_fma_f32 v81, v81, v45, v45
v_fma_f32 v82, v82, v45, v45
v_fma_f32 v83, v83, v45, v45
s_add_u32 m0, s39, 110592
s_add_u32 s37, s37, s38
buffer_load_dwordx4 v22, s[8:11], s37 offen sc1 lds
v_rcp_f32 v80, v80
v_rcp_f32 v81, v81
v_rcp_f32 v82, v82
v_rcp_f32 v83, v83
s_add_u32 m0, s39, 111616
s_add_u32 s37, s37, s38
buffer_load_dwordx4 v23, s[8:11], s37 offen sc1 lds
v_mul_f32 v228, v228, v80
v_mul_f32 v229, v229, v81
v_mul_f32 v230, v230, v82
s_add_u32 m0, s39, 112640
s_add_u32 s37, s37, s38
buffer_load_dwordx4 v22, s[8:11], s37 offen sc1 lds
v_mul_f32 v231, v231, v83
v_cvt_pk_bf16_f32 v100, v228, v229
v_cvt_pk_bf16_f32 v101, v230, v231
s_add_u32 m0, s39, 113664
s_add_u32 s37, s37, s38
buffer_load_dwordx4 v23, s[8:11], s37 offen sc1 lds
v_fma_f32 v180, -v33, v60, v180
v_fma_f32 v181, -v33, v61, v181
v_fma_f32 v182, -v33, v62, v182
buffer_store_dwordx4 v[96:99], v27, s[24:27], s53 offen offset:0 sc1
s_waitcnt vmcnt(20)
s_barrier
s_add_u32 s42, s42, 1
s_and_b32 s42, s42, 15
s_add_u32 m0, s39, 0
s_mul_i32 s37, s42, s40
buffer_load_dwordx4 v22, s[8:11], s37 offen sc1 lds
v_fma_f32 v183, -v33, v63, v183
v_fma_f32 v244, -v33, v76, v244
v_fma_f32 v245, -v33, v77, v245
v_fma_f32 v246, -v33, v78, v246
s_add_u32 m0, s39, 1024
s_add_u32 s37, s37, s38
buffer_load_dwordx4 v23, s[8:11], s37 offen sc1 lds
v_fma_f32 v247, -v33, v79, v247
v_mul_f32 v84, v180, v180
v_mul_f32 v85, v181, v181
s_add_u32 m0, s39, 2048
s_add_u32 s37, s37, s38
buffer_load_dwordx4 v22, s[8:11], s37 offen sc1 lds
v_mul_f32 v86, v182, v182
v_mul_f32 v87, v183, v183
v_fma_f32 v84, v84, v41, v37
s_add_u32 m0, s39, 3072
s_add_u32 s37, s37, s38
buffer_load_dwordx4 v23, s[8:11], s37 offen sc1 lds
v_fma_f32 v85, v85, v41, v37
v_fma_f32 v86, v86, v41, v37
v_fma_f32 v87, v87, v41, v37
v_mul_f32 v84, v84, v180
s_add_u32 m0, s39, 4096
s_add_u32 s37, s37, s38
buffer_load_dwordx4 v22, s[8:11], s37 offen sc1 lds
v_mul_f32 v85, v85, v181
v_mul_f32 v86, v86, v182
v_mul_f32 v87, v87, v183
s_add_u32 m0, s39, 5120
s_add_u32 s37, s37, s38
buffer_load_dwordx4 v23, s[8:11], s37 offen sc1 lds
v_exp_f32 v84, v84
v_exp_f32 v85, v85
v_exp_f32 v86, v86
s_add_u32 m0, s39, 6144
s_add_u32 s37, s37, s38
buffer_load_dwordx4 v22, s[8:11], s37 offen sc1 lds
v_exp_f32 v87, v87
v_mul_f32 v244, v180, v244
v_mul_f32 v245, v181, v245
v_mul_f32 v246, v182, v246
s_add_u32 m0, s39, 7168
s_add_u32 s37, s37, s38
buffer_load_dwordx4 v23, s[8:11], s37 offen sc1 lds
v_mul_f32 v247, v183, v247
v_fma_f32 v84, v84, v45, v45
v_fma_f32 v85, v85, v45, v45
s_add_u32 m0, s39, 8192
s_add_u32 s37, s37, s38
buffer_load_dwordx4 v22, s[8:11], s37 offen sc1 lds
v_fma_f32 v86, v86, v45, v45
v_fma_f32 v87, v87, v45, v45
v_rcp_f32 v84, v84
s_add_u32 m0, s39, 9216
s_add_u32 s37, s37, s38
buffer_load_dwordx4 v23, s[8:11], s37 offen sc1 lds
v_rcp_f32 v85, v85
v_rcp_f32 v86, v86
v_rcp_f32 v87, v87
v_mul_f32 v244, v244, v84
s_add_u32 m0, s39, 10240
s_add_u32 s37, s37, s38
buffer_load_dwordx4 v22, s[8:11], s37 offen sc1 lds
v_mul_f32 v245, v245, v85
v_mul_f32 v246, v246, v86
v_mul_f32 v247, v247, v87
s_add_u32 m0, s39, 11264
s_add_u32 s37, s37, s38
buffer_load_dwordx4 v23, s[8:11], s37 offen sc1 lds
v_cvt_pk_bf16_f32 v102, v244, v245
v_cvt_pk_bf16_f32 v103, v246, v247
s_add_u32 m0, s39, 12288
s_add_u32 s37, s37, s38
buffer_load_dwordx4 v22, s[8:11], s37 offen sc1 lds
v_fma_f32 v168, -v34, v56, v168
v_fma_f32 v169, -v34, v57, v169
v_fma_f32 v170, -v34, v58, v170
v_fma_f32 v171, -v34, v59, v171
s_add_u32 m0, s39, 13312
s_add_u32 s37, s37, s38
buffer_load_dwordx4 v23, s[8:11], s37 offen sc1 lds
v_fma_f32 v232, -v34, v72, v232
v_fma_f32 v233, -v34, v73, v233
v_fma_f32 v234, -v34, v74, v234
s_add_u32 m0, s39, 14336
s_add_u32 s37, s37, s38
buffer_load_dwordx4 v22, s[8:11], s37 offen sc1 lds
v_fma_f32 v235, -v34, v75, v235
v_mul_f32 v80, v168, v168
v_mul_f32 v81, v169, v169
s_add_u32 m0, s39, 15360
s_add_u32 s37, s37, s38
buffer_load_dwordx4 v23, s[8:11], s37 offen sc1 lds
v_mul_f32 v82, v170, v170
v_mul_f32 v83, v171, v171
v_fma_f32 v80, v80, v42, v38
buffer_store_dwordx4 v[100:103], v27, s[24:27], s53 offen offset:256 sc1
s_waitcnt vmcnt(18)
s_barrier
s_add_u32 s42, s42, 1
s_and_b32 s42, s42, 15
s_add_u32 m0, s39, 49152
s_mul_i32 s37, s42, s40
buffer_load_dwordx4 v22, s[8:11], s37 offen sc1 lds
v_fma_f32 v81, v81, v42, v38
v_fma_f32 v82, v82, v42, v38
v_fma_f32 v83, v83, v42, v38
v_mul_f32 v80, v80, v168
s_add_u32 m0, s39, 50176
s_add_u32 s37, s37, s38
buffer_load_dwordx4 v23, s[8:11], s37 offen sc1 lds
v_mul_f32 v81, v81, v169
v_mul_f32 v82, v82, v170
v_mul_f32 v83, v83, v171
s_add_u32 m0, s39, 51200
s_add_u32 s37, s37, s38
buffer_load_dwordx4 v22, s[8:11], s37 offen sc1 lds
v_exp_f32 v80, v80
v_exp_f32 v81, v81
v_exp_f32 v82, v82
s_add_u32 m0, s39, 52224
s_add_u32 s37, s37, s38
buffer_load_dwordx4 v23, s[8:11], s37 offen sc1 lds
v_exp_f32 v83, v83
v_mul_f32 v232, v168, v232
v_mul_f32 v233, v169, v233
s_add_u32 m0, s39, 53248
s_add_u32 s37, s37, s38
buffer_load_dwordx4 v22, s[8:11], s37 offen sc1 lds
v_mul_f32 v234, v170, v234
v_mul_f32 v235, v171, v235
v_fma_f32 v80, v80, v46, v46
v_fma_f32 v81, v81, v46, v46
s_add_u32 m0, s39, 54272
s_add_u32 s37, s37, s38
buffer_load_dwordx4 v23, s[8:11], s37 offen sc1 lds
v_fma_f32 v82, v82, v46, v46
v_fma_f32 v83, v83, v46, v46
v_rcp_f32 v80, v80
s_add_u32 m0, s39, 55296
s_add_u32 s37, s37, s38
buffer_load_dwordx4 v22, s[8:11], s37 offen sc1 lds
v_rcp_f32 v81, v81
v_rcp_f32 v82, v82
v_rcp_f32 v83, v83
s_add_u32 m0, s39, 56320
s_add_u32 s37, s37, s38
buffer_load_dwordx4 v23, s[8:11], s37 offen sc1 lds
v_mul_f32 v232, v232, v80
v_mul_f32 v233, v233, v81
v_mul_f32 v234, v234, v82
s_add_u32 m0, s39, 57344
s_add_u32 s37, s37, s38
buffer_load_dwordx4 v22, s[8:11], s37 offen sc1 lds
v_mul_f32 v235, v235, v83
v_cvt_pk_bf16_f32 v104, v232, v233
v_cvt_pk_bf16_f32 v105, v234, v235
v_fma_f32 v184, -v34, v60, v184
s_add_u32 m0, s39, 58368
s_add_u32 s37, s37, s38
buffer_load_dwordx4 v23, s[8:11], s37 offen sc1 lds
v_fma_f32 v185, -v34, v61, v185
v_fma_f32 v186, -v34, v62, v186
v_fma_f32 v187, -v34, v63, v187
s_add_u32 m0, s39, 59392
s_add_u32 s37, s37, s38
buffer_load_dwordx4 v22, s[8:11], s37 offen sc1 lds
v_fma_f32 v248, -v34, v76, v248
v_fma_f32 v249, -v34, v77, v249
v_fma_f32 v250, -v34, v78, v250
s_add_u32 m0, s39, 60416
s_add_u32 s37, s37, s38
buffer_load_dwordx4 v23, s[8:11], s37 offen sc1 lds
v_fma_f32 v251, -v34, v79, v251
v_mul_f32 v84, v184, v184
v_mul_f32 v85, v185, v185
s_add_u32 m0, s39, 61440
s_add_u32 s37, s37, s38
buffer_load_dwordx4 v22, s[8:11], s37 offen sc1 lds
v_mul_f32 v86, v186, v186
v_mul_f32 v87, v187, v187
v_fma_f32 v84, v84, v42, v38
v_fma_f32 v85, v85, v42, v38
s_add_u32 m0, s39, 62464
s_add_u32 s37, s37, s38
buffer_load_dwordx4 v23, s[8:11], s37 offen sc1 lds
v_fma_f32 v86, v86, v42, v38
v_fma_f32 v87, v87, v42, v38
v_mul_f32 v84, v84, v184
s_add_u32 m0, s39, 63488
s_add_u32 s37, s37, s38
buffer_load_dwordx4 v22, s[8:11], s37 offen sc1 lds
v_mul_f32 v85, v85, v185
v_mul_f32 v86, v86, v186
v_mul_f32 v87, v87, v187
s_add_u32 m0, s39, 64512
s_add_u32 s37, s37, s38
buffer_load_dwordx4 v23, s[8:11], s37 offen sc1 lds
v_exp_f32 v84, v84
v_exp_f32 v85, v85
v_exp_f32 v86, v86
s_waitcnt vmcnt(17)
s_barrier
s_add_u32 s42, s42, 1
s_and_b32 s42, s42, 15
s_add_u32 m0, s39, 98304
s_mul_i32 s37, s42, s40
buffer_load_dwordx4 v22, s[8:11], s37 offen sc1 lds
v_exp_f32 v87, v87
v_mul_f32 v248, v184, v248
v_mul_f32 v249, v185, v249
v_mul_f32 v250, v186, v250
s_add_u32 m0, s39, 99328
s_add_u32 s37, s37, s38
buffer_load_dwordx4 v23, s[8:11], s37 offen sc1 lds
v_mul_f32 v251, v187, v251
v_fma_f32 v84, v84, v46, v46
v_fma_f32 v85, v85, v46, v46
s_add_u32 m0, s39, 100352
s_add_u32 s37, s37, s38
buffer_load_dwordx4 v22, s[8:11], s37 offen sc1 lds
v_fma_f32 v86, v86, v46, v46
v_fma_f32 v87, v87, v46, v46
v_rcp_f32 v84, v84
s_add_u32 m0, s39, 101376
s_add_u32 s37, s37, s38
buffer_load_dwordx4 v23, s[8:11], s37 offen sc1 lds
v_rcp_f32 v85, v85
v_rcp_f32 v86, v86
v_rcp_f32 v87, v87
s_add_u32 m0, s39, 102400
s_add_u32 s37, s37, s38
buffer_load_dwordx4 v22, s[8:11], s37 offen sc1 lds
v_mul_f32 v248, v248, v84
v_mul_f32 v249, v249, v85
v_mul_f32 v250, v250, v86
v_mul_f32 v251, v251, v87
s_add_u32 m0, s39, 103424
s_add_u32 s37, s37, s38
buffer_load_dwordx4 v23, s[8:11], s37 offen sc1 lds
v_cvt_pk_bf16_f32 v106, v248, v249
v_cvt_pk_bf16_f32 v107, v250, v251
s_add_u32 m0, s39, 104448
s_add_u32 s37, s37, s38
buffer_load_dwordx4 v22, s[8:11], s37 offen sc1 lds
v_fma_f32 v172, -v35, v56, v172
v_fma_f32 v173, -v35, v57, v173
v_fma_f32 v174, -v35, v58, v174
s_add_u32 m0, s39, 105472
s_add_u32 s37, s37, s38
buffer_load_dwordx4 v23, s[8:11], s37 offen sc1 lds
v_fma_f32 v175, -v35, v59, v175
v_fma_f32 v236, -v35, v72, v236
v_fma_f32 v237, -v35, v73, v237
s_add_u32 m0, s39, 106496
s_add_u32 s37, s37, s38
buffer_load_dwordx4 v22, s[8:11], s37 offen sc1 lds
v_fma_f32 v238, -v35, v74, v238
v_fma_f32 v239, -v35, v75, v239
v_mul_f32 v80, v172, v172
v_mul_f32 v81, v173, v173
s_add_u32 m0, s39, 107520
s_add_u32 s37, s37, s38
buffer_load_dwordx4 v23, s[8:11], s37 offen sc1 lds
v_mul_f32 v82, v174, v174
v_mul_f32 v83, v175, v175
v_fma_f32 v80, v80, v43, v39
s_add_u32 m0, s39, 108544
s_add_u32 s37, s37, s38
buffer_load_dwordx4 v22, s[8:11], s37 offen sc1 lds
v_fma_f32 v81, v81, v43, v39
v_fma_f32 v82, v82, v43, v39
v_fma_f32 v83, v83, v43, v39
s_add_u32 m0, s39, 109568
s_add_u32 s37, s37, s38
buffer_load_dwordx4 v23, s[8:11], s37 offen sc1 lds
v_mul_f32 v80, v80, v172
v_mul_f32 v81, v81, v173
v_mul_f32 v82, v82, v174
s_add_u32 m0, s39, 110592
s_add_u32 s37, s37, s38
buffer_load_dwordx4 v22, s[8:11], s37 offen sc1 lds
v_mul_f32 v83, v83, v175
v_exp_f32 v80, v80
v_exp_f32 v81, v81
v_exp_f32 v82, v82
s_add_u32 m0, s39, 111616
s_add_u32 s37, s37, s38
buffer_load_dwordx4 v23, s[8:11], s37 offen sc1 lds
v_exp_f32 v83, v83
v_mul_f32 v236, v172, v236
v_mul_f32 v237, v173, v237
s_add_u32 m0, s39, 112640
s_add_u32 s37, s37, s38
buffer_load_dwordx4 v22, s[8:11], s37 offen sc1 lds
v_mul_f32 v238, v174, v238
v_mul_f32 v239, v175, v239
v_fma_f32 v80, v80, v47, v47
s_add_u32 m0, s39, 113664
s_add_u32 s37, s37, s38
buffer_load_dwordx4 v23, s[8:11], s37 offen sc1 lds
v_fma_f32 v81, v81, v47, v47
v_fma_f32 v82, v82, v47, v47
v_fma_f32 v83, v83, v47, v47
buffer_store_dwordx4 v[104:107], v27, s[24:27], s53 offen offset:512 sc1
s_waitcnt vmcnt(17)
s_barrier
s_add_u32 s42, s42, 1
s_and_b32 s42, s42, 15
s_add_u32 m0, s39, 0
s_mul_i32 s37, s42, s40
buffer_load_dwordx4 v22, s[8:11], s37 offen sc1 lds
v_rcp_f32 v80, v80
v_rcp_f32 v81, v81
v_rcp_f32 v82, v82
v_rcp_f32 v83, v83
s_add_u32 m0, s39, 1024
s_add_u32 s37, s37, s38
buffer_load_dwordx4 v23, s[8:11], s37 offen sc1 lds
v_mul_f32 v236, v236, v80
v_mul_f32 v237, v237, v81
v_mul_f32 v238, v238, v82
s_add_u32 m0, s39, 2048
s_add_u32 s37, s37, s38
buffer_load_dwordx4 v22, s[8:11], s37 offen sc1 lds
v_mul_f32 v239, v239, v83
v_cvt_pk_bf16_f32 v108, v236, v237
v_cvt_pk_bf16_f32 v109, v238, v239
s_add_u32 m0, s39, 3072
s_add_u32 s37, s37, s38
buffer_load_dwordx4 v23, s[8:11], s37 offen sc1 lds
v_fma_f32 v188, -v35, v60, v188
v_fma_f32 v189, -v35, v61, v189
v_fma_f32 v190, -v35, v62, v190
v_fma_f32 v191, -v35, v63, v191
s_add_u32 m0, s39, 4096
s_add_u32 s37, s37, s38
buffer_load_dwordx4 v22, s[8:11], s37 offen sc1 lds
v_fma_f32 v252, -v35, v76, v252
v_fma_f32 v253, -v35, v77, v253
v_fma_f32 v254, -v35, v78, v254
s_add_u32 m0, s39, 5120
s_add_u32 s37, s37, s38
buffer_load_dwordx4 v23, s[8:11], s37 offen sc1 lds
v_fma_f32 v255, -v35, v79, v255
v_mul_f32 v84, v188, v188
v_mul_f32 v85, v189, v189
s_add_u32 m0, s39, 6144
s_add_u32 s37, s37, s38
buffer_load_dwordx4 v22, s[8:11], s37 offen sc1 lds
v_mul_f32 v86, v190, v190
v_mul_f32 v87, v191, v191
v_fma_f32 v84, v84, v43, v39
v_fma_f32 v85, v85, v43, v39
s_add_u32 m0, s39, 7168
s_add_u32 s37, s37, s38
buffer_load_dwordx4 v23, s[8:11], s37 offen sc1 lds
v_fma_f32 v86, v86, v43, v39
v_fma_f32 v87, v87, v43, v39
v_mul_f32 v84, v84, v188
s_add_u32 m0, s39, 8192
s_add_u32 s37, s37, s38
buffer_load_dwordx4 v22, s[8:11], s37 offen sc1 lds
v_mul_f32 v85, v85, v189
v_mul_f32 v86, v86, v190
v_mul_f32 v87, v87, v191
s_add_u32 m0, s39, 9216
s_add_u32 s37, s37, s38
buffer_load_dwordx4 v23, s[8:11], s37 offen sc1 lds
v_exp_f32 v84, v84
v_exp_f32 v85, v85
v_exp_f32 v86, v86
v_exp_f32 v87, v87
s_add_u32 m0, s39, 10240
s_add_u32 s37, s37, s38
buffer_load_dwordx4 v22, s[8:11], s37 offen sc1 lds
v_mul_f32 v252, v188, v252
v_mul_f32 v253, v189, v253
v_mul_f32 v254, v190, v254
s_add_u32 m0, s39, 11264
s_add_u32 s37, s37, s38
buffer_load_dwordx4 v23, s[8:11], s37 offen sc1 lds
v_mul_f32 v255, v191, v255
v_fma_f32 v84, v84, v47, v47
v_fma_f32 v85, v85, v47, v47
s_add_u32 m0, s39, 12288
s_add_u32 s37, s37, s38
buffer_load_dwordx4 v22, s[8:11], s37 offen sc1 lds
v_fma_f32 v86, v86, v47, v47
v_fma_f32 v87, v87, v47, v47
v_rcp_f32 v84, v84
v_rcp_f32 v85, v85
s_add_u32 m0, s39, 13312
s_add_u32 s37, s37, s38
buffer_load_dwordx4 v23, s[8:11], s37 offen sc1 lds
v_rcp_f32 v86, v86
v_rcp_f32 v87, v87
v_mul_f32 v252, v252, v84
s_add_u32 m0, s39, 14336
s_add_u32 s37, s37, s38
buffer_load_dwordx4 v22, s[8:11], s37 offen sc1 lds
v_mul_f32 v253, v253, v85
v_mul_f32 v254, v254, v86
v_mul_f32 v255, v255, v87
s_add_u32 m0, s39, 15360
s_add_u32 s37, s37, s38
buffer_load_dwordx4 v23, s[8:11], s37 offen sc1 lds
v_cvt_pk_bf16_f32 v110, v252, v253
v_cvt_pk_bf16_f32 v111, v254, v255
buffer_store_dwordx4 v[108:111], v27, s[24:27], s53 offen offset:768 sc1
s_waitcnt vmcnt(18)
s_barrier
s_mul_i32 s44, s34, 917504
s_lshl_b32 s39, s51, 13
s_add_u32 s44, s44, s39
s_add_u32 s44, s44, 8388608
s_and_b32 s43, s51, 1
s_xor_b32 s43, s43, s35
s_lshl_b32 s43, s43, 7
s_mov_b32 s10, 909312
s_movk_i32 s38, 1024
s_movk_i32 s40, 9216
s_movk_i32 s37, 0x4000
s_cmp_ge_u32 s51, 2
s_cselect_b32 s8, s60, s32
s_cselect_b32 s9, s61, s33
s_cselect_b32 s10, 7338112, s10
s_cselect_b32 s43, s43, s44
s_cselect_b32 s38, 16384, s38
s_cselect_b32 s40, 81920, s40
s_cselect_b32 s55, 81920, s38
s_cselect_b32 s37, 262144, s37
s_cselect_b32 s45, -1, 0
s_add_u32 s8, s8, s43
s_addc_u32 s9, s9, 0
s_mov_b32 s11, 0x20000
s_and_b32 s53, s35, 1
s_mul_i32 s54, s53, 6
s_mul_i32 s54, s54, s37
s_mul_i32 s29, s53, 2
s_add_u32 s29, s29, 6
s_mul_i32 s29, s29, s37
s_and_b32 s43, s45, 4290838528
s_add_u32 s29, s29, s43
s_mul_i32 s37, s37, 0
s_sub_u32 s37, s37, s40
v_lshrrev_b32 v19, 3, v1
v_mul_u32_u24 v19, 1920, v19
v_lshrrev_b32 v20, 4, v1
v_lshlrev_b32 v20, 5, v20
v_and_b32 v19, s45, v19
v_and_b32 v20, s45, v20
v_lshlrev_b32 v21, 4, v1
v_xor_b32 v21, v21, v20
v_add_u32 v21, v21, v19
s_mov_b64 s[72:73], -1
s_add_u32 m0, s39, 65536
s_add_u32 s37, s37, s40
buffer_load_dwordx4 v21, s[8:11], s37 offen sc1 lds
v_lshlrev_b32 v128, 16, v192
v_and_b32 v129, 0xffff0000, v192
v_lshlrev_b32 v130, 16, v193
v_and_b32 v131, 0xffff0000, v193
s_add_u32 m0, s39, 66560
s_add_u32 s37, s37, s38
buffer_load_dwordx4 v21, s[8:11], s37 offen sc1 lds
v_lshlrev_b32 v132, 16, v194
v_and_b32 v133, 0xffff0000, v194
v_lshlrev_b32 v134, 16, v195
v_and_b32 v135, 0xffff0000, v195
s_add_u32 m0, s39, 67584
s_add_u32 s37, s37, s38
buffer_load_dwordx4 v21, s[8:11], s37 offen sc1 lds
v_lshlrev_b32 v136, 16, v196
v_and_b32 v137, 0xffff0000, v196
v_lshlrev_b32 v138, 16, v197
v_and_b32 v139, 0xffff0000, v197
s_add_u32 m0, s39, 68608
s_add_u32 s37, s37, s38
buffer_load_dwordx4 v21, s[8:11], s37 offen sc1 lds
v_lshlrev_b32 v140, 16, v198
v_and_b32 v141, 0xffff0000, v198
v_lshlrev_b32 v142, 16, v199
v_and_b32 v143, 0xffff0000, v199
s_add_u32 m0, s39, 69632
s_add_u32 s37, s37, s55
buffer_load_dwordx4 v21, s[8:11], s37 offen sc1 lds
v_lshlrev_b32 v144, 16, v200
v_and_b32 v145, 0xffff0000, v200
v_lshlrev_b32 v146, 16, v201
v_and_b32 v147, 0xffff0000, v201
s_add_u32 m0, s39, 70656
s_add_u32 s37, s37, s38
buffer_load_dwordx4 v21, s[8:11], s37 offen sc1 lds
v_lshlrev_b32 v148, 16, v202
v_and_b32 v149, 0xffff0000, v202
v_lshlrev_b32 v150, 16, v203
v_and_b32 v151, 0xffff0000, v203
s_add_u32 m0, s39, 71680
s_add_u32 s37, s37, s38
buffer_load_dwordx4 v21, s[8:11], s37 offen sc1 lds
v_lshlrev_b32 v152, 16, v204
v_and_b32 v153, 0xffff0000, v204
v_lshlrev_b32 v154, 16, v205
v_and_b32 v155, 0xffff0000, v205
s_add_u32 m0, s39, 72704
s_add_u32 s37, s37, s38
buffer_load_dwordx4 v21, s[8:11], s37 offen sc1 lds
v_lshlrev_b32 v156, 16, v206
v_and_b32 v157, 0xffff0000, v206
v_lshlrev_b32 v158, 16, v207
v_and_b32 v159, 0xffff0000, v207
s_waitcnt vmcnt(8)
s_barrier
s_add_u32 m0, s39, 98304
s_add_u32 s37, s37, s40
buffer_load_dwordx4 v21, s[8:11], s37 offen sc1 lds
v_mov_b32 v192, 0
v_mov_b32 v193, 0
v_mov_b32 v194, 0
v_mov_b32 v195, 0
s_add_u32 m0, s39, 99328
s_add_u32 s37, s37, s38
buffer_load_dwordx4 v21, s[8:11], s37 offen sc1 lds
v_mov_b32 v196, 0
v_mov_b32 v197, 0
v_mov_b32 v198, 0
v_mov_b32 v199, 0
s_add_u32 m0, s39, 100352
s_add_u32 s37, s37, s38
buffer_load_dwordx4 v21, s[8:11], s37 offen sc1 lds
v_mov_b32 v200, 0
v_mov_b32 v201, 0
v_mov_b32 v202, 0
v_mov_b32 v203, 0
s_add_u32 m0, s39, 101376
s_add_u32 s37, s37, s38
buffer_load_dwordx4 v21, s[8:11], s37 offen sc1 lds
v_mov_b32 v204, 0
v_mov_b32 v205, 0
v_mov_b32 v206, 0
v_mov_b32 v207, 0
s_add_u32 m0, s39, 102400
s_add_u32 s37, s37, s55
buffer_load_dwordx4 v21, s[8:11], s37 offen sc1 lds
v_mov_b32 v208, 0
v_mov_b32 v209, 0
v_mov_b32 v210, 0
v_mov_b32 v211, 0
s_add_u32 m0, s39, 103424
s_add_u32 s37, s37, s38
buffer_load_dwordx4 v21, s[8:11], s37 offen sc1 lds
v_mov_b32 v212, 0
v_mov_b32 v213, 0
v_mov_b32 v214, 0
v_mov_b32 v215, 0
s_add_u32 m0, s39, 104448
s_add_u32 s37, s37, s38
buffer_load_dwordx4 v21, s[8:11], s37 offen sc1 lds
v_mov_b32 v216, 0
v_mov_b32 v217, 0
v_mov_b32 v218, 0
v_mov_b32 v219, 0
s_add_u32 m0, s39, 105472
s_add_u32 s37, s37, s38
buffer_load_dwordx4 v21, s[8:11], s37 offen sc1 lds
v_mov_b32 v220, 0
v_mov_b32 v221, 0
v_mov_b32 v222, 0
v_mov_b32 v223, 0
s_waitcnt vmcnt(8)
s_barrier
s_branch LK4_29
L3h_28:
v_mfma_f32_16x16x32_bf16 v[128:131], v[96:99], v[80:83], v[128:131]
s_lshl_b32 s43, s46, 9
v_mfma_f32_16x16x32_bf16 v[132:135], v[96:99], v[84:87], v[132:135]
s_add_u32 s43, s43, 147456
v_mfma_f32_16x16x32_bf16 v[136:139], v[96:99], v[88:91], v[136:139]
v_lshl_add_u32 v19, v17, 3, s43
v_mfma_f32_16x16x32_bf16 v[140:143], v[96:99], v[92:95], v[140:143]
ds_read_b64 v[2:3], v19 offset:0
v_mfma_f32_16x16x32_bf16 v[204:207], v[112:115], v[92:95], v[204:207]
ds_read_b64 v[4:5], v19 offset:128
v_mfma_f32_16x16x32_bf16 v[200:203], v[112:115], v[88:91], v[200:203]
ds_read_b64 v[6:7], v19 offset:256
v_mfma_f32_16x16x32_bf16 v[196:199], v[112:115], v[84:87], v[196:199]
ds_read_b64 v[8:9], v19 offset:384
v_mfma_f32_16x16x32_bf16 v[192:195], v[112:115], v[80:83], v[192:195]
s_mul_i32 s43, s47, 256
v_mfma_f32_16x16x32_bf16 v[144:147], v[100:103], v[80:83], v[144:147]
s_add_u32 s43, s43, 148480
v_mfma_f32_16x16x32_bf16 v[148:151], v[100:103], v[84:87], v[148:151]
v_lshl_add_u32 v19, v18, 4, s43
v_mfma_f32_16x16x32_bf16 v[152:155], v[100:103], v[88:91], v[152:155]
ds_read_b128 v[48:51], v19 offset:0
v_mfma_f32_16x16x32_bf16 v[156:159], v[100:103], v[92:95], v[156:159]
ds_read_b128 v[52:55], v19 offset:64
v_mfma_f32_16x16x32_bf16 v[220:223], v[116:119], v[92:95], v[220:223]
ds_read_b128 v[56:59], v19 offset:128
v_mfma_f32_16x16x32_bf16 v[216:219], v[116:119], v[88:91], v[216:219]
ds_read_b128 v[60:63], v19 offset:192
v_mfma_f32_16x16x32_bf16 v[212:215], v[116:119], v[84:87], v[212:215]
ds_read_b128 v[64:67], v19 offset:896
v_mfma_f32_16x16x32_bf16 v[208:211], v[116:119], v[80:83], v[208:211]
ds_read_b128 v[68:71], v19 offset:960
v_mfma_f32_16x16x32_bf16 v[160:163], v[104:107], v[80:83], v[160:163]
ds_read_b128 v[72:75], v19 offset:1024
v_mfma_f32_16x16x32_bf16 v[164:167], v[104:107], v[84:87], v[164:167]
ds_read_b128 v[76:79], v19 offset:1088
v_mfma_f32_16x16x32_bf16 v[168:171], v[104:107], v[88:91], v[168:171]
v_mfma_f32_16x16x32_bf16 v[172:175], v[104:107], v[92:95], v[172:175]
v_mfma_f32_16x16x32_bf16 v[236:239], v[120:123], v[92:95], v[236:239]
v_mfma_f32_16x16x32_bf16 v[232:235], v[120:123], v[88:91], v[232:235]
v_mfma_f32_16x16x32_bf16 v[228:231], v[120:123], v[84:87], v[228:231]
v_mfma_f32_16x16x32_bf16 v[224:227], v[120:123], v[80:83], v[224:227]
v_mfma_f32_16x16x32_bf16 v[176:179], v[108:111], v[80:83], v[176:179]
v_mfma_f32_16x16x32_bf16 v[180:183], v[108:111], v[84:87], v[180:183]
v_mfma_f32_16x16x32_bf16 v[184:187], v[108:111], v[88:91], v[184:187]
v_mfma_f32_16x16x32_bf16 v[188:191], v[108:111], v[92:95], v[188:191]
v_mfma_f32_16x16x32_bf16 v[252:255], v[124:127], v[92:95], v[252:255]
v_mfma_f32_16x16x32_bf16 v[248:251], v[124:127], v[88:91], v[248:251]
v_mfma_f32_16x16x32_bf16 v[244:247], v[124:127], v[84:87], v[244:247]
v_mfma_f32_16x16x32_bf16 v[240:243], v[124:127], v[80:83], v[240:243]
s_setprio 0
s_waitcnt lgkmcnt(0)
v_mov_b32 v32, v2
v_mul_f32 v88, v3, v3
v_mul_f32 v36, 0xc0135761, v3
v_mul_f32 v89, 0xbdd2d3e8, v3
v_rcp_f32 v44, v88
v_mul_f32 v40, v89, v88
v_mov_b32 v33, v4
v_mul_f32 v88, v5, v5
v_mul_f32 v37, 0xc0135761, v5
v_mul_f32 v89, 0xbdd2d3e8, v5
v_rcp_f32 v45, v88
v_mul_f32 v41, v89, v88
v_mov_b32 v34, v6
v_mul_f32 v88, v7, v7
v_mul_f32 v38, 0xc0135761, v7
v_mul_f32 v89, 0xbdd2d3e8, v7
v_rcp_f32 v46, v88
v_mul_f32 v42, v89, v88
v_mov_b32 v35, v8
v_mul_f32 v88, v9, v9
v_mul_f32 v39, 0xc0135761, v9
v_mul_f32 v89, 0xbdd2d3e8, v9
v_rcp_f32 v47, v88
v_mul_f32 v43, v89, v88
s_barrier
v_fma_f32 v128, -v32, v48, v128
v_fma_f32 v129, -v32, v49, v129
v_fma_f32 v130, -v32, v50, v130
v_fma_f32 v131, -v32, v51, v131
v_fma_f32 v192, -v32, v64, v192
v_fma_f32 v193, -v32, v65, v193
v_fma_f32 v194, -v32, v66, v194
v_fma_f32 v195, -v32, v67, v195
v_mul_f32 v80, v128, v128
v_mul_f32 v81, v129, v129
v_mul_f32 v82, v130, v130
v_mul_f32 v83, v131, v131
v_fma_f32 v80, v80, v40, v36
v_fma_f32 v81, v81, v40, v36
v_fma_f32 v82, v82, v40, v36
v_fma_f32 v83, v83, v40, v36
v_mul_f32 v80, v80, v128
v_mul_f32 v81, v81, v129
v_mul_f32 v82, v82, v130
v_mul_f32 v83, v83, v131
v_exp_f32 v80, v80
v_exp_f32 v81, v81
v_exp_f32 v82, v82
v_exp_f32 v83, v83
v_mul_f32 v192, v128, v192
v_mul_f32 v193, v129, v193
v_mul_f32 v194, v130, v194
v_mul_f32 v195, v131, v195
v_fma_f32 v80, v80, v44, v44
v_fma_f32 v81, v81, v44, v44
v_fma_f32 v82, v82, v44, v44
v_fma_f32 v83, v83, v44, v44
v_rcp_f32 v80, v80
v_rcp_f32 v81, v81
v_rcp_f32 v82, v82
v_rcp_f32 v83, v83
v_mul_f32 v192, v192, v80
v_mul_f32 v193, v193, v81
v_mul_f32 v194, v194, v82
v_mul_f32 v195, v195, v83
v_cvt_pk_bf16_f32 v96, v192, v193
v_cvt_pk_bf16_f32 v97, v194, v195
v_fma_f32 v144, -v32, v52, v144
v_fma_f32 v145, -v32, v53, v145
v_fma_f32 v146, -v32, v54, v146
v_fma_f32 v147, -v32, v55, v147
v_fma_f32 v208, -v32, v68, v208
v_fma_f32 v209, -v32, v69, v209
v_fma_f32 v210, -v32, v70, v210
v_fma_f32 v211, -v32, v71, v211
v_mul_f32 v84, v144, v144
v_mul_f32 v85, v145, v145
s_barrier
v_mul_f32 v86, v146, v146
v_mul_f32 v87, v147, v147
v_fma_f32 v84, v84, v40, v36
v_fma_f32 v85, v85, v40, v36
v_fma_f32 v86, v86, v40, v36
v_fma_f32 v87, v87, v40, v36
v_mul_f32 v84, v84, v144
v_mul_f32 v85, v85, v145
v_mul_f32 v86, v86, v146
v_mul_f32 v87, v87, v147
v_exp_f32 v84, v84
v_exp_f32 v85, v85
v_exp_f32 v86, v86
v_exp_f32 v87, v87
v_mul_f32 v208, v144, v208
v_mul_f32 v209, v145, v209
v_mul_f32 v210, v146, v210
v_mul_f32 v211, v147, v211
v_fma_f32 v84, v84, v44, v44
v_fma_f32 v85, v85, v44, v44
v_fma_f32 v86, v86, v44, v44
v_fma_f32 v87, v87, v44, v44
v_rcp_f32 v84, v84
v_rcp_f32 v85, v85
v_rcp_f32 v86, v86
v_rcp_f32 v87, v87
v_mul_f32 v208, v208, v84
v_mul_f32 v209, v209, v85
v_mul_f32 v210, v210, v86
v_mul_f32 v211, v211, v87
v_cvt_pk_bf16_f32 v98, v208, v209
v_cvt_pk_bf16_f32 v99, v210, v211
buffer_store_dwordx4 v[96:99], v27, s[24:27], 0 offen offset:0 sc1
v_fma_f32 v132, -v33, v48, v132
v_fma_f32 v133, -v33, v49, v133
v_fma_f32 v134, -v33, v50, v134
v_fma_f32 v135, -v33, v51, v135
v_fma_f32 v196, -v33, v64, v196
v_fma_f32 v197, -v33, v65, v197
v_fma_f32 v198, -v33, v66, v198
v_fma_f32 v199, -v33, v67, v199
v_mul_f32 v80, v132, v132
v_mul_f32 v81, v133, v133
v_mul_f32 v82, v134, v134
v_mul_f32 v83, v135, v135
v_fma_f32 v80, v80, v41, v37
v_fma_f32 v81, v81, v41, v37
v_fma_f32 v82, v82, v41, v37
v_fma_f32 v83, v83, v41, v37
v_mul_f32 v80, v80, v132
v_mul_f32 v81, v81, v133
v_mul_f32 v82, v82, v134
v_lshlrev_b32 v19, 11, v18
v_lshl_add_u32 v19, v17, 4, v19
s_lshl_b32 s43, s46, 10
v_add_u32 v2, s43, v19
v_add_u32 v3, 0x10000, v2
v_lshrrev_b32 v19, 2, v17
v_lshl_add_u32 v20, v18, 2, v19
v_bfe_u32 v21, v20, 1, 2
s_lshl_b32 s43, s47, 1
v_xor_b32 v21, s43, v21
v_lshlrev_b32 v20, 7, v20
v_lshl_add_u32 v20, v21, 5, v20
v_and_b32 v19, 3, v1
v_lshl_add_u32 v20, v19, 3, v20
v_add_u32 v5, 16384, v20
v_xor_b32 v6, 32, v5
v_add_u32 v7, 0x10000, v5
v_add_u32 v8, 0x10000, v6
s_lshl_b32 s43, s36, 13
v_lshl_add_u32 v9, v1, 4, s43
s_mov_b32 s54, 0x10000
s_movk_i32 s52, 0x1000
s_barrier
s_mov_b32 s88, s4
s_mov_b32 s89, s5
s_mov_b32 s90, 7340032
s_mov_b32 s91, 0x20000
s_mov_b32 s92, s6
s_mov_b32 s93, s7
s_mov_b32 s94, 7340032
s_mov_b32 s95, 0x20000
s_lshr_b32 s43, s35, 3
v_and_b32 v19, 1, v1
v_bfe_u32 v23, v1, 2, 3
s_lshl_b32 s44, s43, 1
s_add_u32 s44, s44, 6
v_add_u32 v23, s44, v23
s_lshl_b32 s44, s43, 1
s_add_u32 s44, s44, 1
v_mad_u32_u24 v23, v19, s44, v23
s_lshl_b32 s44, s43, 10
s_lshl_b32 s43, s43, 11
s_sub_u32 s43, 6528, s43
s_lshr_b32 s45, s2, 3
s_mul_i32 s45, s45, 14336
s_add_u32 s43, s43, s45
v_mul_lo_u32 v31, v19, s44
v_bfe_u32 v19, v1, 1, 1
v_mul_u32_u24 v19, 7168, v19
v_add3_u32 v31, v31, v19, s43
v_add_u32 v19, 8, v23
v_and_b32 v19, 15, v19
v_mul_u32_u24 v19, 458752, v19
v_add_u32 v19, v19, v31
buffer_load_dword v30, v19, s[88:91], 0 offen
buffer_load_dword v30, v19, s[92:95], 0 offen
v_mul_f32 v83, v83, v135
v_exp_f32 v80, v80
v_exp_f32 v81, v81
v_exp_f32 v82, v82
v_exp_f32 v83, v83
v_mul_f32 v196, v132, v196
v_mul_f32 v197, v133, v197
v_mul_f32 v198, v134, v198
v_mul_f32 v199, v135, v199
v_fma_f32 v80, v80, v45, v45
v_fma_f32 v81, v81, v45, v45
v_fma_f32 v82, v82, v45, v45
v_fma_f32 v83, v83, v45, v45
v_rcp_f32 v80, v80
v_rcp_f32 v81, v81
v_rcp_f32 v82, v82
v_rcp_f32 v83, v83
v_mul_f32 v196, v196, v80
v_mul_f32 v197, v197, v81
v_mul_f32 v198, v198, v82
v_mul_f32 v199, v199, v83
v_cvt_pk_bf16_f32 v100, v196, v197
v_cvt_pk_bf16_f32 v101, v198, v199
v_fma_f32 v148, -v33, v52, v148
v_fma_f32 v149, -v33, v53, v149
v_fma_f32 v150, -v33, v54, v150
v_fma_f32 v151, -v33, v55, v151
v_fma_f32 v212, -v33, v68, v212
v_fma_f32 v213, -v33, v69, v213
v_fma_f32 v214, -v33, v70, v214
v_fma_f32 v215, -v33, v71, v215
v_mul_f32 v84, v148, v148
v_mul_f32 v85, v149, v149
v_mul_f32 v86, v150, v150
v_mul_f32 v87, v151, v151
v_fma_f32 v84, v84, v41, v37
v_fma_f32 v85, v85, v41, v37
v_fma_f32 v86, v86, v41, v37
v_fma_f32 v87, v87, v41, v37
v_mul_f32 v84, v84, v148
v_mul_f32 v85, v85, v149
v_mul_f32 v86, v86, v150
v_mul_f32 v87, v87, v151
v_exp_f32 v84, v84
v_exp_f32 v85, v85
v_exp_f32 v86, v86
v_exp_f32 v87, v87
v_mul_f32 v212, v148, v212
v_mul_f32 v213, v149, v213
v_mul_f32 v214, v150, v214
v_mul_f32 v215, v151, v215
v_fma_f32 v84, v84, v45, v45
s_barrier
v_fma_f32 v85, v85, v45, v45
v_fma_f32 v86, v86, v45, v45
v_fma_f32 v87, v87, v45, v45
v_rcp_f32 v84, v84
v_rcp_f32 v85, v85
v_rcp_f32 v86, v86
v_rcp_f32 v87, v87
v_mul_f32 v212, v212, v84
v_mul_f32 v213, v213, v85
v_mul_f32 v214, v214, v86
v_mul_f32 v215, v215, v87
v_cvt_pk_bf16_f32 v102, v212, v213
v_cvt_pk_bf16_f32 v103, v214, v215
buffer_store_dwordx4 v[100:103], v27, s[24:27], 0 offen offset:256 sc1
v_fma_f32 v136, -v34, v48, v136
v_fma_f32 v137, -v34, v49, v137
v_fma_f32 v138, -v34, v50, v138
v_fma_f32 v139, -v34, v51, v139
v_fma_f32 v200, -v34, v64, v200
v_fma_f32 v201, -v34, v65, v201
v_fma_f32 v202, -v34, v66, v202
v_fma_f32 v203, -v34, v67, v203
v_mul_f32 v80, v136, v136
v_mul_f32 v81, v137, v137
v_mul_f32 v82, v138, v138
v_mul_f32 v83, v139, v139
v_fma_f32 v80, v80, v42, v38
v_fma_f32 v81, v81, v42, v38
v_fma_f32 v82, v82, v42, v38
v_fma_f32 v83, v83, v42, v38
v_mul_f32 v80, v80, v136
v_mul_f32 v81, v81, v137
v_mul_f32 v82, v82, v138
v_mul_f32 v83, v83, v139
v_exp_f32 v80, v80
v_exp_f32 v81, v81
v_exp_f32 v82, v82
v_exp_f32 v83, v83
v_mul_f32 v200, v136, v200
v_mul_f32 v201, v137, v201
v_mul_f32 v202, v138, v202
v_mul_f32 v203, v139, v203
v_fma_f32 v80, v80, v46, v46
v_fma_f32 v81, v81, v46, v46
v_fma_f32 v82, v82, v46, v46
v_fma_f32 v83, v83, v46, v46
v_rcp_f32 v80, v80
v_rcp_f32 v81, v81
v_rcp_f32 v82, v82
v_rcp_f32 v83, v83
v_mul_f32 v200, v200, v80
v_mul_f32 v201, v201, v81
v_mul_f32 v202, v202, v82
s_barrier
v_mul_f32 v203, v203, v83
v_cvt_pk_bf16_f32 v104, v200, v201
v_cvt_pk_bf16_f32 v105, v202, v203
v_fma_f32 v152, -v34, v52, v152
v_fma_f32 v153, -v34, v53, v153
v_fma_f32 v154, -v34, v54, v154
v_fma_f32 v155, -v34, v55, v155
v_fma_f32 v216, -v34, v68, v216
v_fma_f32 v217, -v34, v69, v217
v_fma_f32 v218, -v34, v70, v218
v_fma_f32 v219, -v34, v71, v219
v_mul_f32 v84, v152, v152
v_mul_f32 v85, v153, v153
v_mul_f32 v86, v154, v154
v_mul_f32 v87, v155, v155
v_fma_f32 v84, v84, v42, v38
v_fma_f32 v85, v85, v42, v38
v_fma_f32 v86, v86, v42, v38
v_fma_f32 v87, v87, v42, v38
v_mul_f32 v84, v84, v152
v_mul_f32 v85, v85, v153
v_mul_f32 v86, v86, v154
v_mul_f32 v87, v87, v155
v_exp_f32 v84, v84
v_exp_f32 v85, v85
v_exp_f32 v86, v86
v_exp_f32 v87, v87
v_mul_f32 v216, v152, v216
v_mul_f32 v217, v153, v217
v_mul_f32 v218, v154, v218
v_mul_f32 v219, v155, v219
v_fma_f32 v84, v84, v46, v46
v_fma_f32 v85, v85, v46, v46
v_fma_f32 v86, v86, v46, v46
v_fma_f32 v87, v87, v46, v46
v_rcp_f32 v84, v84
v_rcp_f32 v85, v85
v_rcp_f32 v86, v86
v_rcp_f32 v87, v87
v_mul_f32 v216, v216, v84
v_mul_f32 v217, v217, v85
v_mul_f32 v218, v218, v86
v_mul_f32 v219, v219, v87
v_cvt_pk_bf16_f32 v106, v216, v217
v_cvt_pk_bf16_f32 v107, v218, v219
buffer_store_dwordx4 v[104:107], v27, s[24:27], 0 offen offset:512 sc1
v_fma_f32 v140, -v35, v48, v140
v_fma_f32 v141, -v35, v49, v141
v_fma_f32 v142, -v35, v50, v142
v_fma_f32 v143, -v35, v51, v143
v_fma_f32 v204, -v35, v64, v204
v_fma_f32 v205, -v35, v65, v205
s_barrier
v_fma_f32 v206, -v35, v66, v206
v_fma_f32 v207, -v35, v67, v207
v_mul_f32 v80, v140, v140
v_mul_f32 v81, v141, v141
v_mul_f32 v82, v142, v142
v_mul_f32 v83, v143, v143
v_fma_f32 v80, v80, v43, v39
v_fma_f32 v81, v81, v43, v39
v_fma_f32 v82, v82, v43, v39
v_fma_f32 v83, v83, v43, v39
v_mul_f32 v80, v80, v140
v_mul_f32 v81, v81, v141
v_mul_f32 v82, v82, v142
v_mul_f32 v83, v83, v143
v_exp_f32 v80, v80
v_exp_f32 v81, v81
v_exp_f32 v82, v82
v_exp_f32 v83, v83
v_mul_f32 v204, v140, v204
v_mul_f32 v205, v141, v205
v_mul_f32 v206, v142, v206
v_mul_f32 v207, v143, v207
v_fma_f32 v80, v80, v47, v47
v_fma_f32 v81, v81, v47, v47
v_fma_f32 v82, v82, v47, v47
v_fma_f32 v83, v83, v47, v47
v_rcp_f32 v80, v80
v_rcp_f32 v81, v81
v_rcp_f32 v82, v82
v_rcp_f32 v83, v83
v_mul_f32 v204, v204, v80
v_mul_f32 v205, v205, v81
v_mul_f32 v206, v206, v82
v_mul_f32 v207, v207, v83
v_cvt_pk_bf16_f32 v108, v204, v205
v_cvt_pk_bf16_f32 v109, v206, v207
v_fma_f32 v156, -v35, v52, v156
v_fma_f32 v157, -v35, v53, v157
v_fma_f32 v158, -v35, v54, v158
v_fma_f32 v159, -v35, v55, v159
v_fma_f32 v220, -v35, v68, v220
v_fma_f32 v221, -v35, v69, v221
v_fma_f32 v222, -v35, v70, v222
v_fma_f32 v223, -v35, v71, v223
v_mul_f32 v84, v156, v156
v_mul_f32 v85, v157, v157
v_mul_f32 v86, v158, v158
v_mul_f32 v87, v159, v159
v_fma_f32 v84, v84, v43, v39
v_fma_f32 v85, v85, v43, v39
v_fma_f32 v86, v86, v43, v39
v_fma_f32 v87, v87, v43, v39
s_barrier
s_getpc_b64 s[78:79]
Lpc_30:
s_sub_u32 s78, s78, Lpc_30-sequential_preLN__sliding_local_dilated__glu_gated_geglu__prompt_kernel
s_subb_u32 s79, s79, 0
s_lshr_b32 s43, s2, 3
s_mul_i32 s43, s43, 3840
v_min_u32 v19, 29, v1
v_lshl_add_u32 v19, v19, 7, s43
v_min_u32 v19, Ldone_1-sequential_preLN__sliding_local_dilated__glu_gated_geglu__prompt_kernel, v19
global_load_dword v30, v19, s[78:79]
v_mul_f32 v84, v84, v156
v_mul_f32 v85, v85, v157
v_mul_f32 v86, v86, v158
v_mul_f32 v87, v87, v159
v_exp_f32 v84, v84
v_exp_f32 v85, v85
v_exp_f32 v86, v86
v_exp_f32 v87, v87
v_mul_f32 v220, v156, v220
v_mul_f32 v221, v157, v221
v_mul_f32 v222, v158, v222
v_mul_f32 v223, v159, v223
v_fma_f32 v84, v84, v47, v47
v_fma_f32 v85, v85, v47, v47
v_fma_f32 v86, v86, v47, v47
v_fma_f32 v87, v87, v47, v47
v_rcp_f32 v84, v84
v_rcp_f32 v85, v85
v_rcp_f32 v86, v86
v_rcp_f32 v87, v87
v_mul_f32 v220, v220, v84
v_mul_f32 v221, v221, v85
v_mul_f32 v222, v222, v86
v_mul_f32 v223, v223, v87
v_cvt_pk_bf16_f32 v110, v220, v221
v_cvt_pk_bf16_f32 v111, v222, v223
buffer_store_dwordx4 v[108:111], v27, s[24:27], 0 offen offset:768 sc1
v_fma_f32 v160, -v32, v56, v160
v_fma_f32 v161, -v32, v57, v161
v_fma_f32 v162, -v32, v58, v162
v_fma_f32 v163, -v32, v59, v163
v_fma_f32 v224, -v32, v72, v224
v_fma_f32 v225, -v32, v73, v225
v_fma_f32 v226, -v32, v74, v226
v_fma_f32 v227, -v32, v75, v227
v_mul_f32 v80, v160, v160
v_mul_f32 v81, v161, v161
v_mul_f32 v82, v162, v162
v_mul_f32 v83, v163, v163
v_fma_f32 v80, v80, v40, v36
v_fma_f32 v81, v81, v40, v36
v_fma_f32 v82, v82, v40, v36
v_fma_f32 v83, v83, v40, v36
v_mul_f32 v80, v80, v160
v_mul_f32 v81, v81, v161
v_mul_f32 v82, v82, v162
v_mul_f32 v83, v83, v163
v_exp_f32 v80, v80
v_exp_f32 v81, v81
v_exp_f32 v82, v82
v_exp_f32 v83, v83
v_mul_f32 v224, v160, v224
v_mul_f32 v225, v161, v225
s_barrier
v_mul_f32 v226, v162, v226
v_mul_f32 v227, v163, v227
v_fma_f32 v80, v80, v44, v44
v_fma_f32 v81, v81, v44, v44
v_fma_f32 v82, v82, v44, v44
v_fma_f32 v83, v83, v44, v44
v_rcp_f32 v80, v80
v_rcp_f32 v81, v81
v_rcp_f32 v82, v82
v_rcp_f32 v83, v83
v_mul_f32 v224, v224, v80
v_mul_f32 v225, v225, v81
v_mul_f32 v226, v226, v82
v_mul_f32 v227, v227, v83
v_cvt_pk_bf16_f32 v96, v224, v225
v_cvt_pk_bf16_f32 v97, v226, v227
v_fma_f32 v176, -v32, v60, v176
v_fma_f32 v177, -v32, v61, v177
v_fma_f32 v178, -v32, v62, v178
v_fma_f32 v179, -v32, v63, v179
v_fma_f32 v240, -v32, v76, v240
v_fma_f32 v241, -v32, v77, v241
v_fma_f32 v242, -v32, v78, v242
v_fma_f32 v243, -v32, v79, v243
v_mul_f32 v84, v176, v176
v_mul_f32 v85, v177, v177
v_mul_f32 v86, v178, v178
v_mul_f32 v87, v179, v179
v_fma_f32 v84, v84, v40, v36
v_fma_f32 v85, v85, v40, v36
v_fma_f32 v86, v86, v40, v36
v_fma_f32 v87, v87, v40, v36
v_mul_f32 v84, v84, v176
v_mul_f32 v85, v85, v177
v_mul_f32 v86, v86, v178
v_mul_f32 v87, v87, v179
v_exp_f32 v84, v84
v_exp_f32 v85, v85
v_exp_f32 v86, v86
v_exp_f32 v87, v87
v_mul_f32 v240, v176, v240
v_mul_f32 v241, v177, v241
v_mul_f32 v242, v178, v242
v_mul_f32 v243, v179, v243
v_fma_f32 v84, v84, v44, v44
v_fma_f32 v85, v85, v44, v44
v_fma_f32 v86, v86, v44, v44
v_fma_f32 v87, v87, v44, v44
v_rcp_f32 v84, v84
v_rcp_f32 v85, v85
v_rcp_f32 v86, v86
v_rcp_f32 v87, v87
v_lshlrev_b32 v19, 11, v18
v_lshl_add_u32 v19, v17, 4, v19
s_lshl_b32 s43, s46, 10
s_lshl_b32 s44, s47, 13
v_add3_u32 v208, v19, s43, 0
v_add_u32 v208, s44, v208
buffer_load_dwordx4 v[192:195], v208, s[20:23], 0 offen offset:0 sc1
buffer_load_dwordx4 v[196:199], v208, s[20:23], 0 offen offset:256 sc1
buffer_load_dwordx4 v[200:203], v208, s[20:23], 0 offen offset:512 sc1
buffer_load_dwordx4 v[204:207], v208, s[20:23], 0 offen offset:768 sc1
s_waitcnt vmcnt(4)
s_barrier
s_add_u32 s43, s34, 32
s_lshl_b32 s43, s43, 7
v_mov_b32 v21, s43
v_mov_b32 v22, 1
s_mov_b64 exec, 1
buffer_atomic_add v22, v21, s[56:59], 0 offen sc1
s_mov_b64 exec, -1
v_mul_f32 v240, v240, v84
v_mul_f32 v241, v241, v85
v_mul_f32 v242, v242, v86
v_mul_f32 v243, v243, v87
v_cvt_pk_bf16_f32 v98, v240, v241
v_cvt_pk_bf16_f32 v99, v242, v243
buffer_store_dwordx4 v[96:99], v27, s[24:27], s53 offen offset:0 sc1
v_fma_f32 v164, -v33, v56, v164
v_fma_f32 v165, -v33, v57, v165
v_fma_f32 v166, -v33, v58, v166
v_fma_f32 v167, -v33, v59, v167
v_fma_f32 v228, -v33, v72, v228
v_fma_f32 v229, -v33, v73, v229
v_fma_f32 v230, -v33, v74, v230
v_fma_f32 v231, -v33, v75, v231
v_mul_f32 v80, v164, v164
v_mul_f32 v81, v165, v165
v_mul_f32 v82, v166, v166
v_mul_f32 v83, v167, v167
v_fma_f32 v80, v80, v41, v37
v_fma_f32 v81, v81, v41, v37
v_fma_f32 v82, v82, v41, v37
v_fma_f32 v83, v83, v41, v37
v_mul_f32 v80, v80, v164
v_mul_f32 v81, v81, v165
v_mul_f32 v82, v82, v166
v_mul_f32 v83, v83, v167
v_exp_f32 v80, v80
v_exp_f32 v81, v81
v_exp_f32 v82, v82
v_exp_f32 v83, v83
v_mul_f32 v228, v164, v228
v_mul_f32 v229, v165, v229
v_mul_f32 v230, v166, v230
v_mul_f32 v231, v167, v231
v_fma_f32 v80, v80, v45, v45
v_fma_f32 v81, v81, v45, v45
v_fma_f32 v82, v82, v45, v45
v_fma_f32 v83, v83, v45, v45
v_rcp_f32 v80, v80
v_rcp_f32 v81, v81
v_rcp_f32 v82, v82
v_rcp_f32 v83, v83
v_mul_f32 v228, v228, v80
v_mul_f32 v229, v229, v81
v_mul_f32 v230, v230, v82
v_mul_f32 v231, v231, v83
v_cvt_pk_bf16_f32 v100, v228, v229
v_cvt_pk_bf16_f32 v101, v230, v231
v_fma_f32 v180, -v33, v60, v180
v_fma_f32 v181, -v33, v61, v181
v_fma_f32 v182, -v33, v62, v182
s_barrier
s_mov_b32 s80, s60
s_mov_b32 s81, s61
s_mov_b32 s82, 7340032
s_mov_b32 s83, 0x20000
v_and_b32 v29, 31, v1
v_lshlrev_b32 v29, 11, v29
s_and_b32 s43, s35, 8
s_or_b32 s43, s43, 3
s_lshl_b32 s43, s43, 7
v_add_u32 v29, s43, v29
s_lshr_b32 s44, s2, 3
s_lshl_b32 s44, s44, 17
s_add_u32 s43, s44, 0
buffer_load_dword v30, v29, s[80:83], s43 offen
v_fma_f32 v183, -v33, v63, v183
v_fma_f32 v244, -v33, v76, v244
v_fma_f32 v245, -v33, v77, v245
v_fma_f32 v246, -v33, v78, v246
v_fma_f32 v247, -v33, v79, v247
v_mul_f32 v84, v180, v180
v_mul_f32 v85, v181, v181
v_mul_f32 v86, v182, v182
v_mul_f32 v87, v183, v183
v_fma_f32 v84, v84, v41, v37
v_fma_f32 v85, v85, v41, v37
v_fma_f32 v86, v86, v41, v37
v_fma_f32 v87, v87, v41, v37
v_mul_f32 v84, v84, v180
v_mul_f32 v85, v85, v181
v_mul_f32 v86, v86, v182
v_mul_f32 v87, v87, v183
v_exp_f32 v84, v84
v_exp_f32 v85, v85
v_exp_f32 v86, v86
v_exp_f32 v87, v87
v_mul_f32 v244, v180, v244
v_mul_f32 v245, v181, v245
v_mul_f32 v246, v182, v246
v_mul_f32 v247, v183, v247
v_fma_f32 v84, v84, v45, v45
v_fma_f32 v85, v85, v45, v45
v_fma_f32 v86, v86, v45, v45
v_fma_f32 v87, v87, v45, v45
v_rcp_f32 v84, v84
v_rcp_f32 v85, v85
v_rcp_f32 v86, v86
v_rcp_f32 v87, v87
v_mul_f32 v244, v244, v84
v_mul_f32 v245, v245, v85
v_mul_f32 v246, v246, v86
v_mul_f32 v247, v247, v87
v_cvt_pk_bf16_f32 v102, v244, v245
v_cvt_pk_bf16_f32 v103, v246, v247
buffer_store_dwordx4 v[100:103], v27, s[24:27], s53 offen offset:256 sc1
v_fma_f32 v168, -v34, v56, v168
v_fma_f32 v169, -v34, v57, v169
v_fma_f32 v170, -v34, v58, v170
v_fma_f32 v171, -v34, v59, v171
v_fma_f32 v232, -v34, v72, v232
v_fma_f32 v233, -v34, v73, v233
v_fma_f32 v234, -v34, v74, v234
v_fma_f32 v235, -v34, v75, v235
v_mul_f32 v80, v168, v168
v_mul_f32 v81, v169, v169
v_mul_f32 v82, v170, v170
v_mul_f32 v83, v171, v171
v_fma_f32 v80, v80, v42, v38
s_waitcnt vmcnt(2)
s_barrier
v_fma_f32 v81, v81, v42, v38
v_fma_f32 v82, v82, v42, v38
v_fma_f32 v83, v83, v42, v38
v_mul_f32 v80, v80, v168
v_mul_f32 v81, v81, v169
v_mul_f32 v82, v82, v170
v_mul_f32 v83, v83, v171
v_exp_f32 v80, v80
v_exp_f32 v81, v81
v_exp_f32 v82, v82
v_exp_f32 v83, v83
v_mul_f32 v232, v168, v232
v_mul_f32 v233, v169, v233
v_mul_f32 v234, v170, v234
v_mul_f32 v235, v171, v235
v_fma_f32 v80, v80, v46, v46
v_fma_f32 v81, v81, v46, v46
v_fma_f32 v82, v82, v46, v46
v_fma_f32 v83, v83, v46, v46
v_rcp_f32 v80, v80
v_rcp_f32 v81, v81
v_rcp_f32 v82, v82
v_rcp_f32 v83, v83
v_mul_f32 v232, v232, v80
v_mul_f32 v233, v233, v81
v_mul_f32 v234, v234, v82
v_mul_f32 v235, v235, v83
v_cvt_pk_bf16_f32 v104, v232, v233
v_cvt_pk_bf16_f32 v105, v234, v235
v_fma_f32 v184, -v34, v60, v184
v_fma_f32 v185, -v34, v61, v185
v_fma_f32 v186, -v34, v62, v186
v_fma_f32 v187, -v34, v63, v187
v_fma_f32 v248, -v34, v76, v248
v_fma_f32 v249, -v34, v77, v249
v_fma_f32 v250, -v34, v78, v250
v_fma_f32 v251, -v34, v79, v251
v_mul_f32 v84, v184, v184
v_mul_f32 v85, v185, v185
v_mul_f32 v86, v186, v186
v_mul_f32 v87, v187, v187
v_fma_f32 v84, v84, v42, v38
v_fma_f32 v85, v85, v42, v38
v_fma_f32 v86, v86, v42, v38
v_fma_f32 v87, v87, v42, v38
v_mul_f32 v84, v84, v184
v_mul_f32 v85, v85, v185
v_mul_f32 v86, v86, v186
v_mul_f32 v87, v87, v187
v_exp_f32 v84, v84
v_exp_f32 v85, v85
v_exp_f32 v86, v86
s_barrier
s_add_u32 s43, s34, 32
s_lshl_b32 s43, s43, 7
v_mov_b32 v21, s43
v_mov_b32 v23, 16
buffer_load_dword v22, v21, s[56:59], 0 offen sc1
v_exp_f32 v87, v87
v_mul_f32 v248, v184, v248
v_mul_f32 v249, v185, v249
v_mul_f32 v250, v186, v250
v_mul_f32 v251, v187, v251
v_fma_f32 v84, v84, v46, v46
v_fma_f32 v85, v85, v46, v46
v_fma_f32 v86, v86, v46, v46
v_fma_f32 v87, v87, v46, v46
v_rcp_f32 v84, v84
v_rcp_f32 v85, v85
v_rcp_f32 v86, v86
v_rcp_f32 v87, v87
v_mul_f32 v248, v248, v84
v_mul_f32 v249, v249, v85
v_mul_f32 v250, v250, v86
v_mul_f32 v251, v251, v87
v_cvt_pk_bf16_f32 v106, v248, v249
v_cvt_pk_bf16_f32 v107, v250, v251
buffer_store_dwordx4 v[104:107], v27, s[24:27], s53 offen offset:512 sc1
v_fma_f32 v172, -v35, v56, v172
v_fma_f32 v173, -v35, v57, v173
v_fma_f32 v174, -v35, v58, v174
v_fma_f32 v175, -v35, v59, v175
v_fma_f32 v236, -v35, v72, v236
v_fma_f32 v237, -v35, v73, v237
v_fma_f32 v238, -v35, v74, v238
v_fma_f32 v239, -v35, v75, v239
v_mul_f32 v80, v172, v172
v_mul_f32 v81, v173, v173
v_mul_f32 v82, v174, v174
v_mul_f32 v83, v175, v175
v_fma_f32 v80, v80, v43, v39
v_fma_f32 v81, v81, v43, v39
v_fma_f32 v82, v82, v43, v39
v_fma_f32 v83, v83, v43, v39
v_mul_f32 v80, v80, v172
v_mul_f32 v81, v81, v173
v_mul_f32 v82, v82, v174
v_mul_f32 v83, v83, v175
v_exp_f32 v80, v80
v_exp_f32 v81, v81
v_exp_f32 v82, v82
v_exp_f32 v83, v83
v_mul_f32 v236, v172, v236
v_mul_f32 v237, v173, v237
v_mul_f32 v238, v174, v238
v_mul_f32 v239, v175, v239
v_fma_f32 v80, v80, v47, v47
v_fma_f32 v81, v81, v47, v47
v_fma_f32 v82, v82, v47, v47
v_fma_f32 v83, v83, v47, v47
s_barrier
v_rcp_f32 v80, v80
v_rcp_f32 v81, v81
v_rcp_f32 v82, v82
v_rcp_f32 v83, v83
v_mul_f32 v236, v236, v80
v_mul_f32 v237, v237, v81
v_mul_f32 v238, v238, v82
v_mul_f32 v239, v239, v83
v_cvt_pk_bf16_f32 v108, v236, v237
v_cvt_pk_bf16_f32 v109, v238, v239
v_fma_f32 v188, -v35, v60, v188
v_fma_f32 v189, -v35, v61, v189
v_fma_f32 v190, -v35, v62, v190
v_fma_f32 v191, -v35, v63, v191
v_fma_f32 v252, -v35, v76, v252
v_fma_f32 v253, -v35, v77, v253
v_fma_f32 v254, -v35, v78, v254
v_fma_f32 v255, -v35, v79, v255
v_mul_f32 v84, v188, v188
v_mul_f32 v85, v189, v189
v_mul_f32 v86, v190, v190
v_mul_f32 v87, v191, v191
v_fma_f32 v84, v84, v43, v39
v_fma_f32 v85, v85, v43, v39
v_fma_f32 v86, v86, v43, v39
v_fma_f32 v87, v87, v43, v39
v_mul_f32 v84, v84, v188
v_mul_f32 v85, v85, v189
v_mul_f32 v86, v86, v190
v_mul_f32 v87, v87, v191
v_exp_f32 v84, v84
v_exp_f32 v85, v85
v_exp_f32 v86, v86
v_exp_f32 v87, v87
v_mul_f32 v252, v188, v252
v_mul_f32 v253, v189, v253
v_mul_f32 v254, v190, v254
v_mul_f32 v255, v191, v255
v_fma_f32 v84, v84, v47, v47
v_fma_f32 v85, v85, v47, v47
v_fma_f32 v86, v86, v47, v47
v_fma_f32 v87, v87, v47, v47
v_rcp_f32 v84, v84
v_rcp_f32 v85, v85
v_rcp_f32 v86, v86
v_rcp_f32 v87, v87
v_mul_f32 v252, v252, v84
v_mul_f32 v253, v253, v85
v_mul_f32 v254, v254, v86
v_mul_f32 v255, v255, v87
v_cvt_pk_bf16_f32 v110, v252, v253
v_cvt_pk_bf16_f32 v111, v254, v255
buffer_store_dwordx4 v[108:111], v27, s[24:27], s53 offen offset:768 sc1
s_mov_b32 s41, 0x10000
s_waitcnt vmcnt(2)
s_branch Lpf_33
Lpoll_31:
s_waitcnt vmcnt(0)
Lpf_33:
v_cmp_ne_u32 vcc, v23, v22
s_nop 4
s_cbranch_vccz Lpok_32
buffer_load_dword v22, v21, s[56:59], 0 offen sc1
s_sub_u32 s41, s41, 1
s_cmp_lg_u32 s41, 0
s_cbranch_scc1 Lpoll_31
s_waitcnt vmcnt(0)
Lpok_32:
s_barrier
v_lshlrev_b32 v128, 16, v192
v_and_b32 v129, 0xffff0000, v192
v_lshlrev_b32 v130, 16, v193
v_and_b32 v131, 0xffff0000, v193
v_lshlrev_b32 v132, 16, v194
v_and_b32 v133, 0xffff0000, v194
v_lshlrev_b32 v134, 16, v195
v_and_b32 v135, 0xffff0000, v195
v_lshlrev_b32 v136, 16, v196
v_and_b32 v137, 0xffff0000, v196
v_lshlrev_b32 v138, 16, v197
v_and_b32 v139, 0xffff0000, v197
v_lshlrev_b32 v140, 16, v198
v_and_b32 v141, 0xffff0000, v198
v_lshlrev_b32 v142, 16, v199
v_and_b32 v143, 0xffff0000, v199
v_lshlrev_b32 v144, 16, v200
v_and_b32 v145, 0xffff0000, v200
v_lshlrev_b32 v146, 16, v201
v_and_b32 v147, 0xffff0000, v201
v_lshlrev_b32 v148, 16, v202
v_and_b32 v149, 0xffff0000, v202
v_lshlrev_b32 v150, 16, v203
v_and_b32 v151, 0xffff0000, v203
v_lshlrev_b32 v152, 16, v204
v_and_b32 v153, 0xffff0000, v204
v_lshlrev_b32 v154, 16, v205
v_and_b32 v155, 0xffff0000, v205
v_lshlrev_b32 v156, 16, v206
v_and_b32 v157, 0xffff0000, v206
v_lshlrev_b32 v158, 16, v207
v_and_b32 v159, 0xffff0000, v207
s_waitcnt vmcnt(0)
s_barrier
s_add_u32 s43, s34, 48
s_lshl_b32 s43, s43, 7
v_mov_b32 v22, s43
v_mov_b32 v23, 1
s_mov_b64 exec, 1
buffer_atomic_add v23, v22, s[56:59], 0 offen sc1
s_mov_b64 exec, -1
v_mov_b32 v192, 0
v_mov_b32 v193, 0
v_mov_b32 v194, 0
v_mov_b32 v195, 0
v_mov_b32 v196, 0
v_mov_b32 v197, 0
v_mov_b32 v198, 0
v_mov_b32 v199, 0
v_mov_b32 v200, 0
v_mov_b32 v201, 0
v_mov_b32 v202, 0
v_mov_b32 v203, 0
v_mov_b32 v204, 0
v_mov_b32 v205, 0
v_mov_b32 v206, 0
v_mov_b32 v207, 0
v_mov_b32 v208, 0
v_mov_b32 v209, 0
v_mov_b32 v210, 0
v_mov_b32 v211, 0
v_mov_b32 v212, 0
v_mov_b32 v213, 0
v_mov_b32 v214, 0
v_mov_b32 v215, 0
v_mov_b32 v216, 0
v_mov_b32 v217, 0
v_mov_b32 v218, 0
v_mov_b32 v219, 0
v_mov_b32 v220, 0
v_mov_b32 v221, 0
v_mov_b32 v222, 0
v_mov_b32 v223, 0
s_barrier
LK4_29:
s_setprio 1
ds_read_b64_tr_b16 v[64:65], v7 offset:0
ds_read_b128 v[32:35], v3 offset:0
ds_read_b64_tr_b16 v[66:67], v7 offset:2048
ds_read_b128 v[36:39], v3 offset:256
ds_read_b64_tr_b16 v[68:69], v8 offset:0
ds_read_b128 v[40:43], v3 offset:512
ds_read_b64_tr_b16 v[70:71], v8 offset:2048
ds_read_b128 v[44:47], v3 offset:768
ds_read_b64_tr_b16 v[72:73], v7 offset:4096
ds_read_b128 v[48:51], v3 offset:8192
ds_read_b64_tr_b16 v[74:75], v7 offset:6144
ds_read_b128 v[52:55], v3 offset:8448
ds_read_b64_tr_b16 v[76:77], v8 offset:4096
ds_read_b128 v[56:59], v3 offset:8704
ds_read_b64_tr_b16 v[78:79], v8 offset:6144
ds_read_b128 v[60:63], v3 offset:8960
s_waitcnt vmcnt(0) lgkmcnt(0)
s_barrier
v_mfma_f32_16x16x32_bf16 v[128:131], v[64:67], v[32:35], v[128:131]
ds_read_b64_tr_b16 v[160:161], v7 offset:32768
v_mfma_f32_16x16x32_bf16 v[132:135], v[68:71], v[32:35], v[132:135]
ds_read_b128 v[96:99], v3 offset:32768
v_mfma_f32_16x16x32_bf16 v[136:139], v[64:67], v[36:39], v[136:139]
ds_read_b64_tr_b16 v[162:163], v7 offset:34816
v_mfma_f32_16x16x32_bf16 v[140:143], v[68:71], v[36:39], v[140:143]
ds_read_b128 v[100:103], v3 offset:33024
v_mfma_f32_16x16x32_bf16 v[144:147], v[64:67], v[40:43], v[144:147]
ds_read_b64_tr_b16 v[164:165], v8 offset:32768
v_mfma_f32_16x16x32_bf16 v[148:151], v[68:71], v[40:43], v[148:151]
ds_read_b128 v[104:107], v3 offset:33280
v_mfma_f32_16x16x32_bf16 v[152:155], v[64:67], v[44:47], v[152:155]
ds_read_b64_tr_b16 v[166:167], v8 offset:34816
v_mfma_f32_16x16x32_bf16 v[156:159], v[68:71], v[44:47], v[156:159]
ds_read_b128 v[108:111], v3 offset:33536
v_mfma_f32_16x16x32_bf16 v[128:131], v[72:75], v[48:51], v[128:131]
ds_read_b64_tr_b16 v[168:169], v7 offset:36864
v_mfma_f32_16x16x32_bf16 v[132:135], v[76:79], v[48:51], v[132:135]
ds_read_b128 v[112:115], v3 offset:40960
v_mfma_f32_16x16x32_bf16 v[136:139], v[72:75], v[52:55], v[136:139]
ds_read_b64_tr_b16 v[170:171], v7 offset:38912
v_mfma_f32_16x16x32_bf16 v[140:143], v[76:79], v[52:55], v[140:143]
ds_read_b128 v[116:119], v3 offset:41216
v_mfma_f32_16x16x32_bf16 v[144:147], v[72:75], v[56:59], v[144:147]
ds_read_b64_tr_b16 v[172:173], v8 offset:36864
v_mfma_f32_16x16x32_bf16 v[148:151], v[76:79], v[56:59], v[148:151]
ds_read_b128 v[120:123], v3 offset:41472
v_mfma_f32_16x16x32_bf16 v[152:155], v[72:75], v[60:63], v[152:155]
ds_read_b64_tr_b16 v[174:175], v8 offset:38912
v_mfma_f32_16x16x32_bf16 v[156:159], v[76:79], v[60:63], v[156:159]
ds_read_b128 v[124:127], v3 offset:41728
s_waitcnt lgkmcnt(0)
s_barrier
v_mfma_f32_16x16x32_bf16 v[128:131], v[160:163], v[96:99], v[128:131]
ds_read_b64_tr_b16 v[64:65], v5 offset:0
v_mfma_f32_16x16x32_bf16 v[132:135], v[164:167], v[96:99], v[132:135]
ds_read_b128 v[32:35], v2 offset:0
v_mfma_f32_16x16x32_bf16 v[136:139], v[160:163], v[100:103], v[136:139]
ds_read_b64_tr_b16 v[66:67], v5 offset:2048
v_mfma_f32_16x16x32_bf16 v[140:143], v[164:167], v[100:103], v[140:143]
ds_read_b128 v[36:39], v2 offset:256
v_mfma_f32_16x16x32_bf16 v[144:147], v[160:163], v[104:107], v[144:147]
ds_read_b64_tr_b16 v[68:69], v6 offset:0
v_mfma_f32_16x16x32_bf16 v[148:151], v[164:167], v[104:107], v[148:151]
ds_read_b128 v[40:43], v2 offset:512
v_mfma_f32_16x16x32_bf16 v[152:155], v[160:163], v[108:111], v[152:155]
ds_read_b64_tr_b16 v[70:71], v6 offset:2048
v_mfma_f32_16x16x32_bf16 v[156:159], v[164:167], v[108:111], v[156:159]
ds_read_b128 v[44:47], v2 offset:768
v_mfma_f32_16x16x32_bf16 v[128:131], v[168:171], v[112:115], v[128:131]
ds_read_b64_tr_b16 v[72:73], v5 offset:4096
v_mfma_f32_16x16x32_bf16 v[132:135], v[172:175], v[112:115], v[132:135]
ds_read_b128 v[48:51], v2 offset:8192
v_mfma_f32_16x16x32_bf16 v[136:139], v[168:171], v[116:119], v[136:139]
ds_read_b64_tr_b16 v[74:75], v5 offset:6144
v_mfma_f32_16x16x32_bf16 v[140:143], v[172:175], v[116:119], v[140:143]
ds_read_b128 v[52:55], v2 offset:8448
v_mfma_f32_16x16x32_bf16 v[144:147], v[168:171], v[120:123], v[144:147]
ds_read_b64_tr_b16 v[76:77], v6 offset:4096
v_mfma_f32_16x16x32_bf16 v[148:151], v[172:175], v[120:123], v[148:151]
ds_read_b128 v[56:59], v2 offset:8704
v_mfma_f32_16x16x32_bf16 v[152:155], v[168:171], v[124:127], v[152:155]
ds_read_b64_tr_b16 v[78:79], v6 offset:6144
v_mfma_f32_16x16x32_bf16 v[156:159], v[172:175], v[124:127], v[156:159]
ds_read_b128 v[60:63], v2 offset:8960
s_waitcnt lgkmcnt(0)
s_barrier
v_mfma_f32_16x16x32_bf16 v[128:131], v[64:67], v[32:35], v[128:131]
ds_read_b64_tr_b16 v[160:161], v5 offset:32768
v_mfma_f32_16x16x32_bf16 v[132:135], v[68:71], v[32:35], v[132:135]
ds_read_b128 v[96:99], v2 offset:32768
v_mfma_f32_16x16x32_bf16 v[136:139], v[64:67], v[36:39], v[136:139]
ds_read_b64_tr_b16 v[162:163], v5 offset:34816
v_mfma_f32_16x16x32_bf16 v[140:143], v[68:71], v[36:39], v[140:143]
ds_read_b128 v[100:103], v2 offset:33024
v_mfma_f32_16x16x32_bf16 v[144:147], v[64:67], v[40:43], v[144:147]
ds_read_b64_tr_b16 v[164:165], v6 offset:32768
v_mfma_f32_16x16x32_bf16 v[148:151], v[68:71], v[40:43], v[148:151]
ds_read_b128 v[104:107], v2 offset:33280
v_mfma_f32_16x16x32_bf16 v[152:155], v[64:67], v[44:47], v[152:155]
ds_read_b64_tr_b16 v[166:167], v6 offset:34816
v_mfma_f32_16x16x32_bf16 v[156:159], v[68:71], v[44:47], v[156:159]
ds_read_b128 v[108:111], v2 offset:33536
v_mfma_f32_16x16x32_bf16 v[128:131], v[72:75], v[48:51], v[128:131]
ds_read_b64_tr_b16 v[168:169], v5 offset:36864
v_mfma_f32_16x16x32_bf16 v[132:135], v[76:79], v[48:51], v[132:135]
ds_read_b128 v[112:115], v2 offset:40960
v_mfma_f32_16x16x32_bf16 v[136:139], v[72:75], v[52:55], v[136:139]
ds_read_b64_tr_b16 v[170:171], v5 offset:38912
v_mfma_f32_16x16x32_bf16 v[140:143], v[76:79], v[52:55], v[140:143]
ds_read_b128 v[116:119], v2 offset:41216
v_mfma_f32_16x16x32_bf16 v[144:147], v[72:75], v[56:59], v[144:147]
ds_read_b64_tr_b16 v[172:173], v6 offset:36864
v_mfma_f32_16x16x32_bf16 v[148:151], v[76:79], v[56:59], v[148:151]
ds_read_b128 v[120:123], v2 offset:41472
v_mfma_f32_16x16x32_bf16 v[152:155], v[72:75], v[60:63], v[152:155]
ds_read_b64_tr_b16 v[174:175], v6 offset:38912
v_mfma_f32_16x16x32_bf16 v[156:159], v[76:79], v[60:63], v[156:159]
ds_read_b128 v[124:127], v2 offset:41728
s_waitcnt lgkmcnt(0)
s_barrier
v_mfma_f32_16x16x32_bf16 v[128:131], v[160:163], v[96:99], v[128:131]
ds_read_b64_tr_b16 v[64:65], v7 offset:0
v_mfma_f32_16x16x32_bf16 v[132:135], v[164:167], v[96:99], v[132:135]
ds_read_b128 v[32:35], v3 offset:0
v_mfma_f32_16x16x32_bf16 v[136:139], v[160:163], v[100:103], v[136:139]
ds_read_b64_tr_b16 v[66:67], v7 offset:2048
v_mfma_f32_16x16x32_bf16 v[140:143], v[164:167], v[100:103], v[140:143]
ds_read_b128 v[36:39], v3 offset:256
v_mfma_f32_16x16x32_bf16 v[144:147], v[160:163], v[104:107], v[144:147]
ds_read_b64_tr_b16 v[68:69], v8 offset:0
v_mfma_f32_16x16x32_bf16 v[148:151], v[164:167], v[104:107], v[148:151]
ds_read_b128 v[40:43], v3 offset:512
v_mfma_f32_16x16x32_bf16 v[152:155], v[160:163], v[108:111], v[152:155]
ds_read_b64_tr_b16 v[70:71], v8 offset:2048
v_mfma_f32_16x16x32_bf16 v[156:159], v[164:167], v[108:111], v[156:159]
ds_read_b128 v[44:47], v3 offset:768
v_mfma_f32_16x16x32_bf16 v[128:131], v[168:171], v[112:115], v[128:131]
ds_read_b64_tr_b16 v[80:81], v7 offset:8192
v_mfma_f32_16x16x32_bf16 v[132:135], v[172:175], v[112:115], v[132:135]
ds_read_b64_tr_b16 v[82:83], v7 offset:10240
v_mfma_f32_16x16x32_bf16 v[136:139], v[168:171], v[116:119], v[136:139]
ds_read_b64_tr_b16 v[84:85], v8 offset:8192
v_mfma_f32_16x16x32_bf16 v[140:143], v[172:175], v[116:119], v[140:143]
ds_read_b64_tr_b16 v[86:87], v8 offset:10240
v_mfma_f32_16x16x32_bf16 v[144:147], v[168:171], v[120:123], v[144:147]
ds_read_b64_tr_b16 v[72:73], v7 offset:4096
v_mfma_f32_16x16x32_bf16 v[148:151], v[172:175], v[120:123], v[148:151]
ds_read_b128 v[48:51], v3 offset:8192
v_mfma_f32_16x16x32_bf16 v[152:155], v[168:171], v[124:127], v[152:155]
ds_read_b64_tr_b16 v[74:75], v7 offset:6144
v_mfma_f32_16x16x32_bf16 v[156:159], v[172:175], v[124:127], v[156:159]
ds_read_b128 v[52:55], v3 offset:8448
ds_read_b64_tr_b16 v[76:77], v8 offset:4096
ds_read_b128 v[56:59], v3 offset:8704
ds_read_b64_tr_b16 v[78:79], v8 offset:6144
ds_read_b128 v[60:63], v3 offset:8960
ds_read_b64_tr_b16 v[88:89], v7 offset:12288
ds_read_b64_tr_b16 v[90:91], v7 offset:14336
ds_read_b64_tr_b16 v[92:93], v8 offset:12288
ds_read_b64_tr_b16 v[94:95], v8 offset:14336
s_mov_b32 s41, 4
Lk4_34:
s_waitcnt lgkmcnt(0)
s_barrier
v_mfma_f32_16x16x32_bf16 v[128:131], v[64:67], v[32:35], v[128:131]
ds_read_b64_tr_b16 v[160:161], v7 offset:32768
v_mfma_f32_16x16x32_bf16 v[132:135], v[68:71], v[32:35], v[132:135]
ds_read_b128 v[96:99], v3 offset:32768
v_mfma_f32_16x16x32_bf16 v[192:195], v[80:83], v[32:35], v[192:195]
ds_read_b64_tr_b16 v[162:163], v7 offset:34816
v_mfma_f32_16x16x32_bf16 v[196:199], v[84:87], v[32:35], v[196:199]
ds_read_b128 v[100:103], v3 offset:33024
v_mfma_f32_16x16x32_bf16 v[136:139], v[64:67], v[36:39], v[136:139]
ds_read_b64_tr_b16 v[164:165], v8 offset:32768
v_mfma_f32_16x16x32_bf16 v[140:143], v[68:71], v[36:39], v[140:143]
ds_read_b128 v[104:107], v3 offset:33280
v_mfma_f32_16x16x32_bf16 v[200:203], v[80:83], v[36:39], v[200:203]
ds_read_b64_tr_b16 v[166:167], v8 offset:34816
v_mfma_f32_16x16x32_bf16 v[204:207], v[84:87], v[36:39], v[204:207]
ds_read_b128 v[108:111], v3 offset:33536
v_mfma_f32_16x16x32_bf16 v[144:147], v[64:67], v[40:43], v[144:147]
ds_read_b64_tr_b16 v[176:177], v7 offset:40960
v_mfma_f32_16x16x32_bf16 v[148:151], v[68:71], v[40:43], v[148:151]
ds_read_b64_tr_b16 v[178:179], v7 offset:43008
v_mfma_f32_16x16x32_bf16 v[208:211], v[80:83], v[40:43], v[208:211]
ds_read_b64_tr_b16 v[180:181], v8 offset:40960
v_mfma_f32_16x16x32_bf16 v[212:215], v[84:87], v[40:43], v[212:215]
ds_read_b64_tr_b16 v[182:183], v8 offset:43008
v_mfma_f32_16x16x32_bf16 v[152:155], v[64:67], v[44:47], v[152:155]
ds_read_b64_tr_b16 v[168:169], v7 offset:36864
v_mfma_f32_16x16x32_bf16 v[156:159], v[68:71], v[44:47], v[156:159]
ds_read_b128 v[112:115], v3 offset:40960
v_mfma_f32_16x16x32_bf16 v[216:219], v[80:83], v[44:47], v[216:219]
ds_read_b64_tr_b16 v[170:171], v7 offset:38912
v_mfma_f32_16x16x32_bf16 v[220:223], v[84:87], v[44:47], v[220:223]
ds_read_b128 v[116:119], v3 offset:41216
v_mfma_f32_16x16x32_bf16 v[128:131], v[72:75], v[48:51], v[128:131]
ds_read_b64_tr_b16 v[172:173], v8 offset:36864
v_mfma_f32_16x16x32_bf16 v[132:135], v[76:79], v[48:51], v[132:135]
ds_read_b128 v[120:123], v3 offset:41472
v_mfma_f32_16x16x32_bf16 v[192:195], v[88:91], v[48:51], v[192:195]
ds_read_b64_tr_b16 v[174:175], v8 offset:38912
v_mfma_f32_16x16x32_bf16 v[196:199], v[92:95], v[48:51], v[196:199]
ds_read_b128 v[124:127], v3 offset:41728
v_mfma_f32_16x16x32_bf16 v[136:139], v[72:75], v[52:55], v[136:139]
ds_read_b64_tr_b16 v[184:185], v7 offset:45056
v_mfma_f32_16x16x32_bf16 v[140:143], v[76:79], v[52:55], v[140:143]
ds_read_b64_tr_b16 v[186:187], v7 offset:47104
v_mfma_f32_16x16x32_bf16 v[200:203], v[88:91], v[52:55], v[200:203]
ds_read_b64_tr_b16 v[188:189], v8 offset:45056
v_mfma_f32_16x16x32_bf16 v[204:207], v[92:95], v[52:55], v[204:207]
ds_read_b64_tr_b16 v[190:191], v8 offset:47104
v_mfma_f32_16x16x32_bf16 v[144:147], v[72:75], v[56:59], v[144:147]
v_mfma_f32_16x16x32_bf16 v[148:151], v[76:79], v[56:59], v[148:151]
v_mfma_f32_16x16x32_bf16 v[208:211], v[88:91], v[56:59], v[208:211]
v_mfma_f32_16x16x32_bf16 v[212:215], v[92:95], v[56:59], v[212:215]
v_mfma_f32_16x16x32_bf16 v[152:155], v[72:75], v[60:63], v[152:155]
v_mfma_f32_16x16x32_bf16 v[156:159], v[76:79], v[60:63], v[156:159]
v_mfma_f32_16x16x32_bf16 v[216:219], v[88:91], v[60:63], v[216:219]
v_mfma_f32_16x16x32_bf16 v[220:223], v[92:95], v[60:63], v[220:223]
s_waitcnt lgkmcnt(0)
s_barrier
v_mfma_f32_16x16x32_bf16 v[128:131], v[160:163], v[96:99], v[128:131]
ds_read_b64_tr_b16 v[64:65], v5 offset:0
v_mfma_f32_16x16x32_bf16 v[132:135], v[164:167], v[96:99], v[132:135]
ds_read_b128 v[32:35], v2 offset:0
v_mfma_f32_16x16x32_bf16 v[192:195], v[176:179], v[96:99], v[192:195]
ds_read_b64_tr_b16 v[66:67], v5 offset:2048
v_mfma_f32_16x16x32_bf16 v[196:199], v[180:183], v[96:99], v[196:199]
ds_read_b128 v[36:39], v2 offset:256
v_mfma_f32_16x16x32_bf16 v[136:139], v[160:163], v[100:103], v[136:139]
ds_read_b64_tr_b16 v[68:69], v6 offset:0
v_mfma_f32_16x16x32_bf16 v[140:143], v[164:167], v[100:103], v[140:143]
ds_read_b128 v[40:43], v2 offset:512
v_mfma_f32_16x16x32_bf16 v[200:203], v[176:179], v[100:103], v[200:203]
ds_read_b64_tr_b16 v[70:71], v6 offset:2048
v_mfma_f32_16x16x32_bf16 v[204:207], v[180:183], v[100:103], v[204:207]
ds_read_b128 v[44:47], v2 offset:768
v_mfma_f32_16x16x32_bf16 v[144:147], v[160:163], v[104:107], v[144:147]
ds_read_b64_tr_b16 v[80:81], v5 offset:8192
v_mfma_f32_16x16x32_bf16 v[148:151], v[164:167], v[104:107], v[148:151]
ds_read_b64_tr_b16 v[82:83], v5 offset:10240
v_mfma_f32_16x16x32_bf16 v[208:211], v[176:179], v[104:107], v[208:211]
ds_read_b64_tr_b16 v[84:85], v6 offset:8192
v_mfma_f32_16x16x32_bf16 v[212:215], v[180:183], v[104:107], v[212:215]
ds_read_b64_tr_b16 v[86:87], v6 offset:10240
v_mfma_f32_16x16x32_bf16 v[152:155], v[160:163], v[108:111], v[152:155]
ds_read_b64_tr_b16 v[72:73], v5 offset:4096
v_mfma_f32_16x16x32_bf16 v[156:159], v[164:167], v[108:111], v[156:159]
ds_read_b128 v[48:51], v2 offset:8192
v_mfma_f32_16x16x32_bf16 v[216:219], v[176:179], v[108:111], v[216:219]
ds_read_b64_tr_b16 v[74:75], v5 offset:6144
v_mfma_f32_16x16x32_bf16 v[220:223], v[180:183], v[108:111], v[220:223]
ds_read_b128 v[52:55], v2 offset:8448
v_mfma_f32_16x16x32_bf16 v[128:131], v[168:171], v[112:115], v[128:131]
ds_read_b64_tr_b16 v[76:77], v6 offset:4096
v_mfma_f32_16x16x32_bf16 v[132:135], v[172:175], v[112:115], v[132:135]
ds_read_b128 v[56:59], v2 offset:8704
v_mfma_f32_16x16x32_bf16 v[192:195], v[184:187], v[112:115], v[192:195]
ds_read_b64_tr_b16 v[78:79], v6 offset:6144
v_mfma_f32_16x16x32_bf16 v[196:199], v[188:191], v[112:115], v[196:199]
ds_read_b128 v[60:63], v2 offset:8960
v_mfma_f32_16x16x32_bf16 v[136:139], v[168:171], v[116:119], v[136:139]
ds_read_b64_tr_b16 v[88:89], v5 offset:12288
v_mfma_f32_16x16x32_bf16 v[140:143], v[172:175], v[116:119], v[140:143]
ds_read_b64_tr_b16 v[90:91], v5 offset:14336
v_mfma_f32_16x16x32_bf16 v[200:203], v[184:187], v[116:119], v[200:203]
ds_read_b64_tr_b16 v[92:93], v6 offset:12288
v_mfma_f32_16x16x32_bf16 v[204:207], v[188:191], v[116:119], v[204:207]
ds_read_b64_tr_b16 v[94:95], v6 offset:14336
v_mfma_f32_16x16x32_bf16 v[144:147], v[168:171], v[120:123], v[144:147]
v_mfma_f32_16x16x32_bf16 v[148:151], v[172:175], v[120:123], v[148:151]
v_mfma_f32_16x16x32_bf16 v[208:211], v[184:187], v[120:123], v[208:211]
v_mfma_f32_16x16x32_bf16 v[212:215], v[188:191], v[120:123], v[212:215]
v_mfma_f32_16x16x32_bf16 v[152:155], v[168:171], v[124:127], v[152:155]
v_mfma_f32_16x16x32_bf16 v[156:159], v[172:175], v[124:127], v[156:159]
v_mfma_f32_16x16x32_bf16 v[216:219], v[184:187], v[124:127], v[216:219]
v_mfma_f32_16x16x32_bf16 v[220:223], v[188:191], v[124:127], v[220:223]
s_waitcnt lgkmcnt(0)
s_barrier
v_mfma_f32_16x16x32_bf16 v[128:131], v[64:67], v[32:35], v[128:131]
ds_read_b64_tr_b16 v[160:161], v5 offset:32768
v_mfma_f32_16x16x32_bf16 v[132:135], v[68:71], v[32:35], v[132:135]
ds_read_b128 v[96:99], v2 offset:32768
v_mfma_f32_16x16x32_bf16 v[192:195], v[80:83], v[32:35], v[192:195]
ds_read_b64_tr_b16 v[162:163], v5 offset:34816
v_mfma_f32_16x16x32_bf16 v[196:199], v[84:87], v[32:35], v[196:199]
ds_read_b128 v[100:103], v2 offset:33024
v_mfma_f32_16x16x32_bf16 v[136:139], v[64:67], v[36:39], v[136:139]
ds_read_b64_tr_b16 v[164:165], v6 offset:32768
v_mfma_f32_16x16x32_bf16 v[140:143], v[68:71], v[36:39], v[140:143]
ds_read_b128 v[104:107], v2 offset:33280
v_mfma_f32_16x16x32_bf16 v[200:203], v[80:83], v[36:39], v[200:203]
ds_read_b64_tr_b16 v[166:167], v6 offset:34816
v_mfma_f32_16x16x32_bf16 v[204:207], v[84:87], v[36:39], v[204:207]
ds_read_b128 v[108:111], v2 offset:33536
v_mfma_f32_16x16x32_bf16 v[144:147], v[64:67], v[40:43], v[144:147]
ds_read_b64_tr_b16 v[176:177], v5 offset:40960
v_mfma_f32_16x16x32_bf16 v[148:151], v[68:71], v[40:43], v[148:151]
ds_read_b64_tr_b16 v[178:179], v5 offset:43008
v_mfma_f32_16x16x32_bf16 v[208:211], v[80:83], v[40:43], v[208:211]
ds_read_b64_tr_b16 v[180:181], v6 offset:40960
v_mfma_f32_16x16x32_bf16 v[212:215], v[84:87], v[40:43], v[212:215]
ds_read_b64_tr_b16 v[182:183], v6 offset:43008
v_mfma_f32_16x16x32_bf16 v[152:155], v[64:67], v[44:47], v[152:155]
ds_read_b64_tr_b16 v[168:169], v5 offset:36864
v_mfma_f32_16x16x32_bf16 v[156:159], v[68:71], v[44:47], v[156:159]
ds_read_b128 v[112:115], v2 offset:40960
v_mfma_f32_16x16x32_bf16 v[216:219], v[80:83], v[44:47], v[216:219]
ds_read_b64_tr_b16 v[170:171], v5 offset:38912
v_mfma_f32_16x16x32_bf16 v[220:223], v[84:87], v[44:47], v[220:223]
ds_read_b128 v[116:119], v2 offset:41216
v_mfma_f32_16x16x32_bf16 v[128:131], v[72:75], v[48:51], v[128:131]
ds_read_b64_tr_b16 v[172:173], v6 offset:36864
v_mfma_f32_16x16x32_bf16 v[132:135], v[76:79], v[48:51], v[132:135]
ds_read_b128 v[120:123], v2 offset:41472
v_mfma_f32_16x16x32_bf16 v[192:195], v[88:91], v[48:51], v[192:195]
ds_read_b64_tr_b16 v[174:175], v6 offset:38912
v_mfma_f32_16x16x32_bf16 v[196:199], v[92:95], v[48:51], v[196:199]
ds_read_b128 v[124:127], v2 offset:41728
v_mfma_f32_16x16x32_bf16 v[136:139], v[72:75], v[52:55], v[136:139]
ds_read_b64_tr_b16 v[184:185], v5 offset:45056
v_mfma_f32_16x16x32_bf16 v[140:143], v[76:79], v[52:55], v[140:143]
ds_read_b64_tr_b16 v[186:187], v5 offset:47104
v_mfma_f32_16x16x32_bf16 v[200:203], v[88:91], v[52:55], v[200:203]
ds_read_b64_tr_b16 v[188:189], v6 offset:45056
v_mfma_f32_16x16x32_bf16 v[204:207], v[92:95], v[52:55], v[204:207]
ds_read_b64_tr_b16 v[190:191], v6 offset:47104
v_mfma_f32_16x16x32_bf16 v[144:147], v[72:75], v[56:59], v[144:147]
v_mfma_f32_16x16x32_bf16 v[148:151], v[76:79], v[56:59], v[148:151]
v_mfma_f32_16x16x32_bf16 v[208:211], v[88:91], v[56:59], v[208:211]
v_mfma_f32_16x16x32_bf16 v[212:215], v[92:95], v[56:59], v[212:215]
v_mfma_f32_16x16x32_bf16 v[152:155], v[72:75], v[60:63], v[152:155]
v_mfma_f32_16x16x32_bf16 v[156:159], v[76:79], v[60:63], v[156:159]
v_mfma_f32_16x16x32_bf16 v[216:219], v[88:91], v[60:63], v[216:219]
v_mfma_f32_16x16x32_bf16 v[220:223], v[92:95], v[60:63], v[220:223]
s_waitcnt lgkmcnt(0)
s_barrier
v_mfma_f32_16x16x32_bf16 v[128:131], v[160:163], v[96:99], v[128:131]
ds_read_b64_tr_b16 v[64:65], v7 offset:0
v_mfma_f32_16x16x32_bf16 v[132:135], v[164:167], v[96:99], v[132:135]
ds_read_b128 v[32:35], v3 offset:0
v_mfma_f32_16x16x32_bf16 v[192:195], v[176:179], v[96:99], v[192:195]
ds_read_b64_tr_b16 v[66:67], v7 offset:2048
v_mfma_f32_16x16x32_bf16 v[196:199], v[180:183], v[96:99], v[196:199]
ds_read_b128 v[36:39], v3 offset:256
v_mfma_f32_16x16x32_bf16 v[136:139], v[160:163], v[100:103], v[136:139]
ds_read_b64_tr_b16 v[68:69], v8 offset:0
v_mfma_f32_16x16x32_bf16 v[140:143], v[164:167], v[100:103], v[140:143]
ds_read_b128 v[40:43], v3 offset:512
v_mfma_f32_16x16x32_bf16 v[200:203], v[176:179], v[100:103], v[200:203]
ds_read_b64_tr_b16 v[70:71], v8 offset:2048
v_mfma_f32_16x16x32_bf16 v[204:207], v[180:183], v[100:103], v[204:207]
ds_read_b128 v[44:47], v3 offset:768
v_mfma_f32_16x16x32_bf16 v[144:147], v[160:163], v[104:107], v[144:147]
ds_read_b64_tr_b16 v[80:81], v7 offset:8192
v_mfma_f32_16x16x32_bf16 v[148:151], v[164:167], v[104:107], v[148:151]
ds_read_b64_tr_b16 v[82:83], v7 offset:10240
v_mfma_f32_16x16x32_bf16 v[208:211], v[176:179], v[104:107], v[208:211]
ds_read_b64_tr_b16 v[84:85], v8 offset:8192
v_mfma_f32_16x16x32_bf16 v[212:215], v[180:183], v[104:107], v[212:215]
ds_read_b64_tr_b16 v[86:87], v8 offset:10240
v_mfma_f32_16x16x32_bf16 v[152:155], v[160:163], v[108:111], v[152:155]
ds_read_b64_tr_b16 v[72:73], v7 offset:4096
v_mfma_f32_16x16x32_bf16 v[156:159], v[164:167], v[108:111], v[156:159]
ds_read_b128 v[48:51], v3 offset:8192
v_mfma_f32_16x16x32_bf16 v[216:219], v[176:179], v[108:111], v[216:219]
ds_read_b64_tr_b16 v[74:75], v7 offset:6144
v_mfma_f32_16x16x32_bf16 v[220:223], v[180:183], v[108:111], v[220:223]
ds_read_b128 v[52:55], v3 offset:8448
v_mfma_f32_16x16x32_bf16 v[128:131], v[168:171], v[112:115], v[128:131]
ds_read_b64_tr_b16 v[76:77], v8 offset:4096
v_mfma_f32_16x16x32_bf16 v[132:135], v[172:175], v[112:115], v[132:135]
ds_read_b128 v[56:59], v3 offset:8704
v_mfma_f32_16x16x32_bf16 v[192:195], v[184:187], v[112:115], v[192:195]
ds_read_b64_tr_b16 v[78:79], v8 offset:6144
v_mfma_f32_16x16x32_bf16 v[196:199], v[188:191], v[112:115], v[196:199]
ds_read_b128 v[60:63], v3 offset:8960
v_mfma_f32_16x16x32_bf16 v[136:139], v[168:171], v[116:119], v[136:139]
ds_read_b64_tr_b16 v[88:89], v7 offset:12288
v_mfma_f32_16x16x32_bf16 v[140:143], v[172:175], v[116:119], v[140:143]
ds_read_b64_tr_b16 v[90:91], v7 offset:14336
v_mfma_f32_16x16x32_bf16 v[200:203], v[184:187], v[116:119], v[200:203]
ds_read_b64_tr_b16 v[92:93], v8 offset:12288
v_mfma_f32_16x16x32_bf16 v[204:207], v[188:191], v[116:119], v[204:207]
ds_read_b64_tr_b16 v[94:95], v8 offset:14336
v_mfma_f32_16x16x32_bf16 v[144:147], v[168:171], v[120:123], v[144:147]
v_mfma_f32_16x16x32_bf16 v[148:151], v[172:175], v[120:123], v[148:151]
v_mfma_f32_16x16x32_bf16 v[208:211], v[184:187], v[120:123], v[208:211]
v_mfma_f32_16x16x32_bf16 v[212:215], v[188:191], v[120:123], v[212:215]
v_mfma_f32_16x16x32_bf16 v[152:155], v[168:171], v[124:127], v[152:155]
v_mfma_f32_16x16x32_bf16 v[156:159], v[172:175], v[124:127], v[156:159]
v_mfma_f32_16x16x32_bf16 v[216:219], v[184:187], v[124:127], v[216:219]
v_mfma_f32_16x16x32_bf16 v[220:223], v[188:191], v[124:127], v[220:223]
s_sub_u32 s41, s41, 1
s_cmp_lg_u32 s41, 0
s_cbranch_scc1 Lk4_34
s_waitcnt lgkmcnt(0)
s_barrier
v_mfma_f32_16x16x32_bf16 v[128:131], v[64:67], v[32:35], v[128:131]
ds_read_b64_tr_b16 v[160:161], v7 offset:32768
v_mfma_f32_16x16x32_bf16 v[132:135], v[68:71], v[32:35], v[132:135]
ds_read_b128 v[96:99], v3 offset:32768
v_mfma_f32_16x16x32_bf16 v[192:195], v[80:83], v[32:35], v[192:195]
ds_read_b64_tr_b16 v[162:163], v7 offset:34816
v_mfma_f32_16x16x32_bf16 v[196:199], v[84:87], v[32:35], v[196:199]
ds_read_b128 v[100:103], v3 offset:33024
v_mfma_f32_16x16x32_bf16 v[136:139], v[64:67], v[36:39], v[136:139]
ds_read_b64_tr_b16 v[164:165], v8 offset:32768
v_mfma_f32_16x16x32_bf16 v[140:143], v[68:71], v[36:39], v[140:143]
ds_read_b128 v[104:107], v3 offset:33280
v_mfma_f32_16x16x32_bf16 v[200:203], v[80:83], v[36:39], v[200:203]
ds_read_b64_tr_b16 v[166:167], v8 offset:34816
v_mfma_f32_16x16x32_bf16 v[204:207], v[84:87], v[36:39], v[204:207]
ds_read_b128 v[108:111], v3 offset:33536
v_mfma_f32_16x16x32_bf16 v[144:147], v[64:67], v[40:43], v[144:147]
ds_read_b64_tr_b16 v[176:177], v7 offset:40960
v_mfma_f32_16x16x32_bf16 v[148:151], v[68:71], v[40:43], v[148:151]
ds_read_b64_tr_b16 v[178:179], v7 offset:43008
v_mfma_f32_16x16x32_bf16 v[208:211], v[80:83], v[40:43], v[208:211]
ds_read_b64_tr_b16 v[180:181], v8 offset:40960
v_mfma_f32_16x16x32_bf16 v[212:215], v[84:87], v[40:43], v[212:215]
ds_read_b64_tr_b16 v[182:183], v8 offset:43008
v_mfma_f32_16x16x32_bf16 v[152:155], v[64:67], v[44:47], v[152:155]
ds_read_b64_tr_b16 v[168:169], v7 offset:36864
v_mfma_f32_16x16x32_bf16 v[156:159], v[68:71], v[44:47], v[156:159]
ds_read_b128 v[112:115], v3 offset:40960
v_mfma_f32_16x16x32_bf16 v[216:219], v[80:83], v[44:47], v[216:219]
ds_read_b64_tr_b16 v[170:171], v7 offset:38912
v_mfma_f32_16x16x32_bf16 v[220:223], v[84:87], v[44:47], v[220:223]
ds_read_b128 v[116:119], v3 offset:41216
v_mfma_f32_16x16x32_bf16 v[128:131], v[72:75], v[48:51], v[128:131]
ds_read_b64_tr_b16 v[172:173], v8 offset:36864
v_mfma_f32_16x16x32_bf16 v[132:135], v[76:79], v[48:51], v[132:135]
ds_read_b128 v[120:123], v3 offset:41472
v_mfma_f32_16x16x32_bf16 v[192:195], v[88:91], v[48:51], v[192:195]
ds_read_b64_tr_b16 v[174:175], v8 offset:38912
v_mfma_f32_16x16x32_bf16 v[196:199], v[92:95], v[48:51], v[196:199]
ds_read_b128 v[124:127], v3 offset:41728
v_mfma_f32_16x16x32_bf16 v[136:139], v[72:75], v[52:55], v[136:139]
ds_read_b64_tr_b16 v[184:185], v7 offset:45056
v_mfma_f32_16x16x32_bf16 v[140:143], v[76:79], v[52:55], v[140:143]
ds_read_b64_tr_b16 v[186:187], v7 offset:47104
v_mfma_f32_16x16x32_bf16 v[200:203], v[88:91], v[52:55], v[200:203]
ds_read_b64_tr_b16 v[188:189], v8 offset:45056
v_mfma_f32_16x16x32_bf16 v[204:207], v[92:95], v[52:55], v[204:207]
ds_read_b64_tr_b16 v[190:191], v8 offset:47104
v_mfma_f32_16x16x32_bf16 v[144:147], v[72:75], v[56:59], v[144:147]
v_mfma_f32_16x16x32_bf16 v[148:151], v[76:79], v[56:59], v[148:151]
v_mfma_f32_16x16x32_bf16 v[208:211], v[88:91], v[56:59], v[208:211]
v_mfma_f32_16x16x32_bf16 v[212:215], v[92:95], v[56:59], v[212:215]
v_mfma_f32_16x16x32_bf16 v[152:155], v[72:75], v[60:63], v[152:155]
v_mfma_f32_16x16x32_bf16 v[156:159], v[76:79], v[60:63], v[156:159]
v_mfma_f32_16x16x32_bf16 v[216:219], v[88:91], v[60:63], v[216:219]
v_mfma_f32_16x16x32_bf16 v[220:223], v[92:95], v[60:63], v[220:223]
s_waitcnt lgkmcnt(0)
s_barrier
v_mfma_f32_16x16x32_bf16 v[128:131], v[160:163], v[96:99], v[128:131]
ds_read_b64_tr_b16 v[64:65], v5 offset:0
v_mfma_f32_16x16x32_bf16 v[132:135], v[164:167], v[96:99], v[132:135]
ds_read_b128 v[32:35], v2 offset:0
v_mfma_f32_16x16x32_bf16 v[192:195], v[176:179], v[96:99], v[192:195]
ds_read_b64_tr_b16 v[66:67], v5 offset:2048
v_mfma_f32_16x16x32_bf16 v[196:199], v[180:183], v[96:99], v[196:199]
ds_read_b128 v[36:39], v2 offset:256
v_mfma_f32_16x16x32_bf16 v[136:139], v[160:163], v[100:103], v[136:139]
ds_read_b64_tr_b16 v[68:69], v6 offset:0
v_mfma_f32_16x16x32_bf16 v[140:143], v[164:167], v[100:103], v[140:143]
ds_read_b128 v[40:43], v2 offset:512
v_mfma_f32_16x16x32_bf16 v[200:203], v[176:179], v[100:103], v[200:203]
ds_read_b64_tr_b16 v[70:71], v6 offset:2048
v_mfma_f32_16x16x32_bf16 v[204:207], v[180:183], v[100:103], v[204:207]
ds_read_b128 v[44:47], v2 offset:768
v_mfma_f32_16x16x32_bf16 v[144:147], v[160:163], v[104:107], v[144:147]
ds_read_b64_tr_b16 v[80:81], v5 offset:8192
v_mfma_f32_16x16x32_bf16 v[148:151], v[164:167], v[104:107], v[148:151]
ds_read_b64_tr_b16 v[82:83], v5 offset:10240
v_mfma_f32_16x16x32_bf16 v[208:211], v[176:179], v[104:107], v[208:211]
ds_read_b64_tr_b16 v[84:85], v6 offset:8192
v_mfma_f32_16x16x32_bf16 v[212:215], v[180:183], v[104:107], v[212:215]
ds_read_b64_tr_b16 v[86:87], v6 offset:10240
v_mfma_f32_16x16x32_bf16 v[152:155], v[160:163], v[108:111], v[152:155]
ds_read_b64_tr_b16 v[72:73], v5 offset:4096
v_mfma_f32_16x16x32_bf16 v[156:159], v[164:167], v[108:111], v[156:159]
ds_read_b128 v[48:51], v2 offset:8192
v_mfma_f32_16x16x32_bf16 v[216:219], v[176:179], v[108:111], v[216:219]
ds_read_b64_tr_b16 v[74:75], v5 offset:6144
v_mfma_f32_16x16x32_bf16 v[220:223], v[180:183], v[108:111], v[220:223]
ds_read_b128 v[52:55], v2 offset:8448
v_mfma_f32_16x16x32_bf16 v[128:131], v[168:171], v[112:115], v[128:131]
ds_read_b64_tr_b16 v[76:77], v6 offset:4096
v_mfma_f32_16x16x32_bf16 v[132:135], v[172:175], v[112:115], v[132:135]
ds_read_b128 v[56:59], v2 offset:8704
v_mfma_f32_16x16x32_bf16 v[192:195], v[184:187], v[112:115], v[192:195]
ds_read_b64_tr_b16 v[78:79], v6 offset:6144
v_mfma_f32_16x16x32_bf16 v[196:199], v[188:191], v[112:115], v[196:199]
ds_read_b128 v[60:63], v2 offset:8960
v_mfma_f32_16x16x32_bf16 v[136:139], v[168:171], v[116:119], v[136:139]
ds_read_b64_tr_b16 v[88:89], v5 offset:12288
v_mfma_f32_16x16x32_bf16 v[140:143], v[172:175], v[116:119], v[140:143]
ds_read_b64_tr_b16 v[90:91], v5 offset:14336
v_mfma_f32_16x16x32_bf16 v[200:203], v[184:187], v[116:119], v[200:203]
ds_read_b64_tr_b16 v[92:93], v6 offset:12288
v_mfma_f32_16x16x32_bf16 v[204:207], v[188:191], v[116:119], v[204:207]
ds_read_b64_tr_b16 v[94:95], v6 offset:14336
v_mfma_f32_16x16x32_bf16 v[144:147], v[168:171], v[120:123], v[144:147]
v_mfma_f32_16x16x32_bf16 v[148:151], v[172:175], v[120:123], v[148:151]
v_mfma_f32_16x16x32_bf16 v[208:211], v[184:187], v[120:123], v[208:211]
v_mfma_f32_16x16x32_bf16 v[212:215], v[188:191], v[120:123], v[212:215]
v_mfma_f32_16x16x32_bf16 v[152:155], v[168:171], v[124:127], v[152:155]
v_mfma_f32_16x16x32_bf16 v[156:159], v[172:175], v[124:127], v[156:159]
v_mfma_f32_16x16x32_bf16 v[216:219], v[184:187], v[124:127], v[216:219]
v_mfma_f32_16x16x32_bf16 v[220:223], v[188:191], v[124:127], v[220:223]
s_waitcnt lgkmcnt(0)
s_barrier
v_mfma_f32_16x16x32_bf16 v[128:131], v[64:67], v[32:35], v[128:131]
ds_read_b64_tr_b16 v[160:161], v5 offset:32768
v_mfma_f32_16x16x32_bf16 v[132:135], v[68:71], v[32:35], v[132:135]
ds_read_b128 v[96:99], v2 offset:32768
v_mfma_f32_16x16x32_bf16 v[192:195], v[80:83], v[32:35], v[192:195]
ds_read_b64_tr_b16 v[162:163], v5 offset:34816
v_mfma_f32_16x16x32_bf16 v[196:199], v[84:87], v[32:35], v[196:199]
ds_read_b128 v[100:103], v2 offset:33024
v_mfma_f32_16x16x32_bf16 v[136:139], v[64:67], v[36:39], v[136:139]
ds_read_b64_tr_b16 v[164:165], v6 offset:32768
v_mfma_f32_16x16x32_bf16 v[140:143], v[68:71], v[36:39], v[140:143]
ds_read_b128 v[104:107], v2 offset:33280
v_mfma_f32_16x16x32_bf16 v[200:203], v[80:83], v[36:39], v[200:203]
ds_read_b64_tr_b16 v[166:167], v6 offset:34816
v_mfma_f32_16x16x32_bf16 v[204:207], v[84:87], v[36:39], v[204:207]
ds_read_b128 v[108:111], v2 offset:33536
v_mfma_f32_16x16x32_bf16 v[144:147], v[64:67], v[40:43], v[144:147]
ds_read_b64_tr_b16 v[176:177], v5 offset:40960
v_mfma_f32_16x16x32_bf16 v[148:151], v[68:71], v[40:43], v[148:151]
ds_read_b64_tr_b16 v[178:179], v5 offset:43008
v_mfma_f32_16x16x32_bf16 v[208:211], v[80:83], v[40:43], v[208:211]
ds_read_b64_tr_b16 v[180:181], v6 offset:40960
v_mfma_f32_16x16x32_bf16 v[212:215], v[84:87], v[40:43], v[212:215]
ds_read_b64_tr_b16 v[182:183], v6 offset:43008
v_mfma_f32_16x16x32_bf16 v[152:155], v[64:67], v[44:47], v[152:155]
ds_read_b64_tr_b16 v[168:169], v5 offset:36864
v_mfma_f32_16x16x32_bf16 v[156:159], v[68:71], v[44:47], v[156:159]
ds_read_b128 v[112:115], v2 offset:40960
v_mfma_f32_16x16x32_bf16 v[216:219], v[80:83], v[44:47], v[216:219]
ds_read_b64_tr_b16 v[170:171], v5 offset:38912
v_mfma_f32_16x16x32_bf16 v[220:223], v[84:87], v[44:47], v[220:223]
ds_read_b128 v[116:119], v2 offset:41216
v_mfma_f32_16x16x32_bf16 v[128:131], v[72:75], v[48:51], v[128:131]
ds_read_b64_tr_b16 v[172:173], v6 offset:36864
v_mfma_f32_16x16x32_bf16 v[132:135], v[76:79], v[48:51], v[132:135]
ds_read_b128 v[120:123], v2 offset:41472
v_mfma_f32_16x16x32_bf16 v[192:195], v[88:91], v[48:51], v[192:195]
ds_read_b64_tr_b16 v[174:175], v6 offset:38912
v_mfma_f32_16x16x32_bf16 v[196:199], v[92:95], v[48:51], v[196:199]
ds_read_b128 v[124:127], v2 offset:41728
v_mfma_f32_16x16x32_bf16 v[136:139], v[72:75], v[52:55], v[136:139]
ds_read_b64_tr_b16 v[184:185], v5 offset:45056
v_mfma_f32_16x16x32_bf16 v[140:143], v[76:79], v[52:55], v[140:143]
ds_read_b64_tr_b16 v[186:187], v5 offset:47104
v_mfma_f32_16x16x32_bf16 v[200:203], v[88:91], v[52:55], v[200:203]
ds_read_b64_tr_b16 v[188:189], v6 offset:45056
v_mfma_f32_16x16x32_bf16 v[204:207], v[92:95], v[52:55], v[204:207]
ds_read_b64_tr_b16 v[190:191], v6 offset:47104
v_mfma_f32_16x16x32_bf16 v[144:147], v[72:75], v[56:59], v[144:147]
v_mfma_f32_16x16x32_bf16 v[148:151], v[76:79], v[56:59], v[148:151]
v_mfma_f32_16x16x32_bf16 v[208:211], v[88:91], v[56:59], v[208:211]
v_mfma_f32_16x16x32_bf16 v[212:215], v[92:95], v[56:59], v[212:215]
v_mfma_f32_16x16x32_bf16 v[152:155], v[72:75], v[60:63], v[152:155]
v_mfma_f32_16x16x32_bf16 v[156:159], v[76:79], v[60:63], v[156:159]
v_mfma_f32_16x16x32_bf16 v[216:219], v[88:91], v[60:63], v[216:219]
v_mfma_f32_16x16x32_bf16 v[220:223], v[92:95], v[60:63], v[220:223]
s_waitcnt lgkmcnt(0)
s_barrier
v_mfma_f32_16x16x32_bf16 v[128:131], v[160:163], v[96:99], v[128:131]
ds_read_b64_tr_b16 v[64:65], v7 offset:0
v_mfma_f32_16x16x32_bf16 v[132:135], v[164:167], v[96:99], v[132:135]
ds_read_b128 v[32:35], v3 offset:0
v_mfma_f32_16x16x32_bf16 v[192:195], v[176:179], v[96:99], v[192:195]
ds_read_b64_tr_b16 v[66:67], v7 offset:2048
v_mfma_f32_16x16x32_bf16 v[196:199], v[180:183], v[96:99], v[196:199]
ds_read_b128 v[36:39], v3 offset:256
v_mfma_f32_16x16x32_bf16 v[136:139], v[160:163], v[100:103], v[136:139]
ds_read_b64_tr_b16 v[68:69], v8 offset:0
v_mfma_f32_16x16x32_bf16 v[140:143], v[164:167], v[100:103], v[140:143]
ds_read_b128 v[40:43], v3 offset:512
v_mfma_f32_16x16x32_bf16 v[200:203], v[176:179], v[100:103], v[200:203]
ds_read_b64_tr_b16 v[70:71], v8 offset:2048
v_mfma_f32_16x16x32_bf16 v[204:207], v[180:183], v[100:103], v[204:207]
ds_read_b128 v[44:47], v3 offset:768
v_mfma_f32_16x16x32_bf16 v[144:147], v[160:163], v[104:107], v[144:147]
ds_read_b64_tr_b16 v[72:73], v7 offset:4096
v_mfma_f32_16x16x32_bf16 v[148:151], v[164:167], v[104:107], v[148:151]
ds_read_b128 v[48:51], v3 offset:8192
v_mfma_f32_16x16x32_bf16 v[208:211], v[176:179], v[104:107], v[208:211]
ds_read_b64_tr_b16 v[74:75], v7 offset:6144
v_mfma_f32_16x16x32_bf16 v[212:215], v[180:183], v[104:107], v[212:215]
ds_read_b128 v[52:55], v3 offset:8448
v_mfma_f32_16x16x32_bf16 v[152:155], v[160:163], v[108:111], v[152:155]
ds_read_b64_tr_b16 v[76:77], v8 offset:4096
v_mfma_f32_16x16x32_bf16 v[156:159], v[164:167], v[108:111], v[156:159]
ds_read_b128 v[56:59], v3 offset:8704
v_mfma_f32_16x16x32_bf16 v[216:219], v[176:179], v[108:111], v[216:219]
ds_read_b64_tr_b16 v[78:79], v8 offset:6144
v_mfma_f32_16x16x32_bf16 v[220:223], v[180:183], v[108:111], v[220:223]
ds_read_b128 v[60:63], v3 offset:8960
v_mfma_f32_16x16x32_bf16 v[128:131], v[168:171], v[112:115], v[128:131]
v_mfma_f32_16x16x32_bf16 v[132:135], v[172:175], v[112:115], v[132:135]
v_mfma_f32_16x16x32_bf16 v[192:195], v[184:187], v[112:115], v[192:195]
v_mfma_f32_16x16x32_bf16 v[196:199], v[188:191], v[112:115], v[196:199]
v_mfma_f32_16x16x32_bf16 v[136:139], v[168:171], v[116:119], v[136:139]
v_mfma_f32_16x16x32_bf16 v[140:143], v[172:175], v[116:119], v[140:143]
v_mfma_f32_16x16x32_bf16 v[200:203], v[184:187], v[116:119], v[200:203]
v_mfma_f32_16x16x32_bf16 v[204:207], v[188:191], v[116:119], v[204:207]
v_mfma_f32_16x16x32_bf16 v[144:147], v[168:171], v[120:123], v[144:147]
v_mfma_f32_16x16x32_bf16 v[148:151], v[172:175], v[120:123], v[148:151]
v_mfma_f32_16x16x32_bf16 v[208:211], v[184:187], v[120:123], v[208:211]
v_mfma_f32_16x16x32_bf16 v[212:215], v[188:191], v[120:123], v[212:215]
v_mfma_f32_16x16x32_bf16 v[152:155], v[168:171], v[124:127], v[152:155]
v_mfma_f32_16x16x32_bf16 v[156:159], v[172:175], v[124:127], v[156:159]
v_mfma_f32_16x16x32_bf16 v[216:219], v[184:187], v[124:127], v[216:219]
v_mfma_f32_16x16x32_bf16 v[220:223], v[188:191], v[124:127], v[220:223]
s_mov_b32 s54, 0x10000
s_waitcnt lgkmcnt(0)
s_barrier
v_mfma_f32_16x16x32_bf16 v[128:131], v[64:67], v[32:35], v[128:131]
ds_read_b64_tr_b16 v[160:161], v7 offset:32768
v_mfma_f32_16x16x32_bf16 v[132:135], v[68:71], v[32:35], v[132:135]
ds_read_b128 v[96:99], v3 offset:32768
v_mfma_f32_16x16x32_bf16 v[136:139], v[64:67], v[36:39], v[136:139]
ds_read_b64_tr_b16 v[162:163], v7 offset:34816
v_mfma_f32_16x16x32_bf16 v[140:143], v[68:71], v[36:39], v[140:143]
ds_read_b128 v[100:103], v3 offset:33024
v_cvt_pk_bf16_f32 v224, v192, v193
v_mfma_f32_16x16x32_bf16 v[144:147], v[64:67], v[40:43], v[144:147]
ds_read_b64_tr_b16 v[164:165], v8 offset:32768
v_cvt_pk_bf16_f32 v225, v194, v195
v_mfma_f32_16x16x32_bf16 v[148:151], v[68:71], v[40:43], v[148:151]
v_cvt_pk_bf16_f32 v226, v196, v197
ds_read_b128 v[104:107], v3 offset:33280
v_cvt_pk_bf16_f32 v227, v198, v199
v_mfma_f32_16x16x32_bf16 v[152:155], v[64:67], v[44:47], v[152:155]
buffer_store_dwordx4 v[224:227], v9, s[64:67], 0 offen offset:0 sc1
ds_read_b64_tr_b16 v[166:167], v8 offset:34816
v_cvt_pk_bf16_f32 v228, v200, v201
v_mfma_f32_16x16x32_bf16 v[156:159], v[68:71], v[44:47], v[156:159]
ds_read_b128 v[108:111], v3 offset:33536
v_cvt_pk_bf16_f32 v229, v202, v203
v_mfma_f32_16x16x32_bf16 v[128:131], v[72:75], v[48:51], v[128:131]
v_cvt_pk_bf16_f32 v230, v204, v205
ds_read_b64_tr_b16 v[168:169], v7 offset:36864
v_cvt_pk_bf16_f32 v231, v206, v207
v_mfma_f32_16x16x32_bf16 v[132:135], v[76:79], v[48:51], v[132:135]
buffer_store_dwordx4 v[228:231], v9, s[64:67], 0 offen offset:1024 sc1
ds_read_b128 v[112:115], v3 offset:40960
v_cvt_pk_bf16_f32 v232, v208, v209
v_mfma_f32_16x16x32_bf16 v[136:139], v[72:75], v[52:55], v[136:139]
ds_read_b64_tr_b16 v[170:171], v7 offset:38912
v_cvt_pk_bf16_f32 v233, v210, v211
v_mfma_f32_16x16x32_bf16 v[140:143], v[76:79], v[52:55], v[140:143]
v_cvt_pk_bf16_f32 v234, v212, v213
ds_read_b128 v[116:119], v3 offset:41216
v_cvt_pk_bf16_f32 v235, v214, v215
v_mfma_f32_16x16x32_bf16 v[144:147], v[72:75], v[56:59], v[144:147]
buffer_store_dwordx4 v[232:235], v9, s[64:67], 0 offen offset:2048 sc1
ds_read_b64_tr_b16 v[172:173], v8 offset:36864
v_cvt_pk_bf16_f32 v236, v216, v217
v_mfma_f32_16x16x32_bf16 v[148:151], v[76:79], v[56:59], v[148:151]
ds_read_b128 v[120:123], v3 offset:41472
v_cvt_pk_bf16_f32 v237, v218, v219
v_mfma_f32_16x16x32_bf16 v[152:155], v[72:75], v[60:63], v[152:155]
v_cvt_pk_bf16_f32 v238, v220, v221
ds_read_b64_tr_b16 v[174:175], v8 offset:38912
v_cvt_pk_bf16_f32 v239, v222, v223
v_mfma_f32_16x16x32_bf16 v[156:159], v[76:79], v[60:63], v[156:159]
buffer_store_dwordx4 v[236:239], v9, s[64:67], 0 offen offset:3072 sc1
ds_read_b128 v[124:127], v3 offset:41728
s_waitcnt lgkmcnt(0)
s_barrier
v_mfma_f32_16x16x32_bf16 v[128:131], v[160:163], v[96:99], v[128:131]
ds_read_b64_tr_b16 v[64:65], v5 offset:0
v_mfma_f32_16x16x32_bf16 v[132:135], v[164:167], v[96:99], v[132:135]
ds_read_b128 v[32:35], v2 offset:0
v_mfma_f32_16x16x32_bf16 v[136:139], v[160:163], v[100:103], v[136:139]
ds_read_b64_tr_b16 v[66:67], v5 offset:2048
v_mfma_f32_16x16x32_bf16 v[140:143], v[164:167], v[100:103], v[140:143]
ds_read_b128 v[36:39], v2 offset:256
v_mfma_f32_16x16x32_bf16 v[144:147], v[160:163], v[104:107], v[144:147]
ds_read_b64_tr_b16 v[68:69], v6 offset:0
v_mfma_f32_16x16x32_bf16 v[148:151], v[164:167], v[104:107], v[148:151]
ds_read_b128 v[40:43], v2 offset:512
v_mfma_f32_16x16x32_bf16 v[152:155], v[160:163], v[108:111], v[152:155]
ds_read_b64_tr_b16 v[70:71], v6 offset:2048
v_mfma_f32_16x16x32_bf16 v[156:159], v[164:167], v[108:111], v[156:159]
ds_read_b128 v[44:47], v2 offset:768
v_mfma_f32_16x16x32_bf16 v[128:131], v[168:171], v[112:115], v[128:131]
ds_read_b64_tr_b16 v[72:73], v5 offset:4096
v_mfma_f32_16x16x32_bf16 v[132:135], v[172:175], v[112:115], v[132:135]
ds_read_b128 v[48:51], v2 offset:8192
v_mfma_f32_16x16x32_bf16 v[136:139], v[168:171], v[116:119], v[136:139]
ds_read_b64_tr_b16 v[74:75], v5 offset:6144
v_mfma_f32_16x16x32_bf16 v[140:143], v[172:175], v[116:119], v[140:143]
ds_read_b128 v[52:55], v2 offset:8448
v_mfma_f32_16x16x32_bf16 v[144:147], v[168:171], v[120:123], v[144:147]
ds_read_b64_tr_b16 v[76:77], v6 offset:4096
v_mfma_f32_16x16x32_bf16 v[148:151], v[172:175], v[120:123], v[148:151]
ds_read_b128 v[56:59], v2 offset:8704
v_mfma_f32_16x16x32_bf16 v[152:155], v[168:171], v[124:127], v[152:155]
ds_read_b64_tr_b16 v[78:79], v6 offset:6144
v_mfma_f32_16x16x32_bf16 v[156:159], v[172:175], v[124:127], v[156:159]
ds_read_b128 v[60:63], v2 offset:8960
s_waitcnt lgkmcnt(0)
s_barrier
v_mfma_f32_16x16x32_bf16 v[128:131], v[64:67], v[32:35], v[128:131]
ds_read_b64_tr_b16 v[160:161], v5 offset:32768
v_mfma_f32_16x16x32_bf16 v[132:135], v[68:71], v[32:35], v[132:135]
ds_read_b128 v[96:99], v2 offset:32768
v_mfma_f32_16x16x32_bf16 v[136:139], v[64:67], v[36:39], v[136:139]
ds_read_b64_tr_b16 v[162:163], v5 offset:34816
v_mfma_f32_16x16x32_bf16 v[140:143], v[68:71], v[36:39], v[140:143]
ds_read_b128 v[100:103], v2 offset:33024
v_mfma_f32_16x16x32_bf16 v[144:147], v[64:67], v[40:43], v[144:147]
ds_read_b64_tr_b16 v[164:165], v6 offset:32768
v_mfma_f32_16x16x32_bf16 v[148:151], v[68:71], v[40:43], v[148:151]
ds_read_b128 v[104:107], v2 offset:33280
v_mfma_f32_16x16x32_bf16 v[152:155], v[64:67], v[44:47], v[152:155]
ds_read_b64_tr_b16 v[166:167], v6 offset:34816
v_mfma_f32_16x16x32_bf16 v[156:159], v[68:71], v[44:47], v[156:159]
ds_read_b128 v[108:111], v2 offset:33536
v_mfma_f32_16x16x32_bf16 v[128:131], v[72:75], v[48:51], v[128:131]
ds_read_b64_tr_b16 v[168:169], v5 offset:36864
v_mfma_f32_16x16x32_bf16 v[132:135], v[76:79], v[48:51], v[132:135]
ds_read_b128 v[112:115], v2 offset:40960
v_mfma_f32_16x16x32_bf16 v[136:139], v[72:75], v[52:55], v[136:139]
ds_read_b64_tr_b16 v[170:171], v5 offset:38912
v_mfma_f32_16x16x32_bf16 v[140:143], v[76:79], v[52:55], v[140:143]
ds_read_b128 v[116:119], v2 offset:41216
v_mfma_f32_16x16x32_bf16 v[144:147], v[72:75], v[56:59], v[144:147]
ds_read_b64_tr_b16 v[172:173], v6 offset:36864
v_mfma_f32_16x16x32_bf16 v[148:151], v[76:79], v[56:59], v[148:151]
ds_read_b128 v[120:123], v2 offset:41472
v_mfma_f32_16x16x32_bf16 v[152:155], v[72:75], v[60:63], v[152:155]
ds_read_b64_tr_b16 v[174:175], v6 offset:38912
v_mfma_f32_16x16x32_bf16 v[156:159], v[76:79], v[60:63], v[156:159]
ds_read_b128 v[124:127], v2 offset:41728
s_waitcnt vmcnt(0) lgkmcnt(0)
s_barrier
v_mfma_f32_16x16x32_bf16 v[128:131], v[160:163], v[96:99], v[128:131]
ds_read_b64_tr_b16 v[64:65], v7 offset:0
v_mfma_f32_16x16x32_bf16 v[132:135], v[164:167], v[96:99], v[132:135]
ds_read_b128 v[32:35], v3 offset:0
v_mfma_f32_16x16x32_bf16 v[136:139], v[160:163], v[100:103], v[136:139]
ds_read_b64_tr_b16 v[66:67], v7 offset:2048
v_mfma_f32_16x16x32_bf16 v[140:143], v[164:167], v[100:103], v[140:143]
ds_read_b128 v[36:39], v3 offset:256
v_mfma_f32_16x16x32_bf16 v[144:147], v[160:163], v[104:107], v[144:147]
ds_read_b64_tr_b16 v[68:69], v8 offset:0
v_mfma_f32_16x16x32_bf16 v[148:151], v[164:167], v[104:107], v[148:151]
ds_read_b128 v[40:43], v3 offset:512
v_mfma_f32_16x16x32_bf16 v[152:155], v[160:163], v[108:111], v[152:155]
ds_read_b64_tr_b16 v[70:71], v8 offset:2048
v_mfma_f32_16x16x32_bf16 v[156:159], v[164:167], v[108:111], v[156:159]
ds_read_b128 v[44:47], v3 offset:768
v_mfma_f32_16x16x32_bf16 v[128:131], v[168:171], v[112:115], v[128:131]
ds_read_b64_tr_b16 v[72:73], v7 offset:4096
v_mfma_f32_16x16x32_bf16 v[132:135], v[172:175], v[112:115], v[132:135]
ds_read_b128 v[48:51], v3 offset:8192
v_mfma_f32_16x16x32_bf16 v[136:139], v[168:171], v[116:119], v[136:139]
ds_read_b64_tr_b16 v[74:75], v7 offset:6144
v_mfma_f32_16x16x32_bf16 v[140:143], v[172:175], v[116:119], v[140:143]
ds_read_b128 v[52:55], v3 offset:8448
v_mfma_f32_16x16x32_bf16 v[144:147], v[168:171], v[120:123], v[144:147]
ds_read_b64_tr_b16 v[76:77], v8 offset:4096
v_mfma_f32_16x16x32_bf16 v[148:151], v[172:175], v[120:123], v[148:151]
ds_read_b128 v[56:59], v3 offset:8704
v_mfma_f32_16x16x32_bf16 v[152:155], v[168:171], v[124:127], v[152:155]
ds_read_b64_tr_b16 v[78:79], v8 offset:6144
v_mfma_f32_16x16x32_bf16 v[156:159], v[172:175], v[124:127], v[156:159]
ds_read_b128 v[60:63], v3 offset:8960
s_waitcnt lgkmcnt(0)
s_barrier
v_mfma_f32_16x16x32_bf16 v[128:131], v[64:67], v[32:35], v[128:131]
ds_read_b64_tr_b16 v[160:161], v7 offset:32768
v_mfma_f32_16x16x32_bf16 v[132:135], v[68:71], v[32:35], v[132:135]
ds_read_b128 v[96:99], v3 offset:32768
v_mfma_f32_16x16x32_bf16 v[136:139], v[64:67], v[36:39], v[136:139]
ds_read_b64_tr_b16 v[162:163], v7 offset:34816
v_mfma_f32_16x16x32_bf16 v[140:143], v[68:71], v[36:39], v[140:143]
ds_read_b128 v[100:103], v3 offset:33024
v_mfma_f32_16x16x32_bf16 v[144:147], v[64:67], v[40:43], v[144:147]
ds_read_b64_tr_b16 v[164:165], v8 offset:32768
v_mfma_f32_16x16x32_bf16 v[148:151], v[68:71], v[40:43], v[148:151]
ds_read_b128 v[104:107], v3 offset:33280
v_mfma_f32_16x16x32_bf16 v[152:155], v[64:67], v[44:47], v[152:155]
ds_read_b64_tr_b16 v[166:167], v8 offset:34816
v_mfma_f32_16x16x32_bf16 v[156:159], v[68:71], v[44:47], v[156:159]
ds_read_b128 v[108:111], v3 offset:33536
v_mfma_f32_16x16x32_bf16 v[128:131], v[72:75], v[48:51], v[128:131]
ds_read_b64_tr_b16 v[168:169], v7 offset:36864
v_mfma_f32_16x16x32_bf16 v[132:135], v[76:79], v[48:51], v[132:135]
ds_read_b128 v[112:115], v3 offset:40960
v_mfma_f32_16x16x32_bf16 v[136:139], v[72:75], v[52:55], v[136:139]
ds_read_b64_tr_b16 v[170:171], v7 offset:38912
v_mfma_f32_16x16x32_bf16 v[140:143], v[76:79], v[52:55], v[140:143]
ds_read_b128 v[116:119], v3 offset:41216
v_mfma_f32_16x16x32_bf16 v[144:147], v[72:75], v[56:59], v[144:147]
ds_read_b64_tr_b16 v[172:173], v8 offset:36864
v_mfma_f32_16x16x32_bf16 v[148:151], v[76:79], v[56:59], v[148:151]
ds_read_b128 v[120:123], v3 offset:41472
v_mfma_f32_16x16x32_bf16 v[152:155], v[72:75], v[60:63], v[152:155]
ds_read_b64_tr_b16 v[174:175], v8 offset:38912
v_mfma_f32_16x16x32_bf16 v[156:159], v[76:79], v[60:63], v[156:159]
ds_read_b128 v[124:127], v3 offset:41728
s_waitcnt lgkmcnt(0)
s_barrier
v_mfma_f32_16x16x32_bf16 v[128:131], v[160:163], v[96:99], v[128:131]
ds_read_b64_tr_b16 v[64:65], v5 offset:0
v_mfma_f32_16x16x32_bf16 v[132:135], v[164:167], v[96:99], v[132:135]
ds_read_b128 v[32:35], v2 offset:0
v_mfma_f32_16x16x32_bf16 v[136:139], v[160:163], v[100:103], v[136:139]
ds_read_b64_tr_b16 v[66:67], v5 offset:2048
v_mfma_f32_16x16x32_bf16 v[140:143], v[164:167], v[100:103], v[140:143]
ds_read_b128 v[36:39], v2 offset:256
v_mfma_f32_16x16x32_bf16 v[144:147], v[160:163], v[104:107], v[144:147]
ds_read_b64_tr_b16 v[68:69], v6 offset:0
v_mfma_f32_16x16x32_bf16 v[148:151], v[164:167], v[104:107], v[148:151]
ds_read_b128 v[40:43], v2 offset:512
v_mfma_f32_16x16x32_bf16 v[152:155], v[160:163], v[108:111], v[152:155]
ds_read_b64_tr_b16 v[70:71], v6 offset:2048
v_mfma_f32_16x16x32_bf16 v[156:159], v[164:167], v[108:111], v[156:159]
ds_read_b128 v[44:47], v2 offset:768
v_mfma_f32_16x16x32_bf16 v[128:131], v[168:171], v[112:115], v[128:131]
ds_read_b64_tr_b16 v[72:73], v5 offset:4096
v_mfma_f32_16x16x32_bf16 v[132:135], v[172:175], v[112:115], v[132:135]
ds_read_b128 v[48:51], v2 offset:8192
v_mfma_f32_16x16x32_bf16 v[136:139], v[168:171], v[116:119], v[136:139]
ds_read_b64_tr_b16 v[74:75], v5 offset:6144
v_mfma_f32_16x16x32_bf16 v[140:143], v[172:175], v[116:119], v[140:143]
ds_read_b128 v[52:55], v2 offset:8448
v_mfma_f32_16x16x32_bf16 v[144:147], v[168:171], v[120:123], v[144:147]
ds_read_b64_tr_b16 v[76:77], v6 offset:4096
v_mfma_f32_16x16x32_bf16 v[148:151], v[172:175], v[120:123], v[148:151]
ds_read_b128 v[56:59], v2 offset:8704
v_mfma_f32_16x16x32_bf16 v[152:155], v[168:171], v[124:127], v[152:155]
ds_read_b64_tr_b16 v[78:79], v6 offset:6144
v_mfma_f32_16x16x32_bf16 v[156:159], v[172:175], v[124:127], v[156:159]
ds_read_b128 v[60:63], v2 offset:8960
s_waitcnt lgkmcnt(0)
s_barrier
v_mfma_f32_16x16x32_bf16 v[128:131], v[64:67], v[32:35], v[128:131]
ds_read_b64_tr_b16 v[160:161], v5 offset:32768
v_mfma_f32_16x16x32_bf16 v[132:135], v[68:71], v[32:35], v[132:135]
ds_read_b128 v[96:99], v2 offset:32768
v_mfma_f32_16x16x32_bf16 v[136:139], v[64:67], v[36:39], v[136:139]
ds_read_b64_tr_b16 v[162:163], v5 offset:34816
v_mfma_f32_16x16x32_bf16 v[140:143], v[68:71], v[36:39], v[140:143]
ds_read_b128 v[100:103], v2 offset:33024
v_mfma_f32_16x16x32_bf16 v[144:147], v[64:67], v[40:43], v[144:147]
ds_read_b64_tr_b16 v[164:165], v6 offset:32768
v_mfma_f32_16x16x32_bf16 v[148:151], v[68:71], v[40:43], v[148:151]
ds_read_b128 v[104:107], v2 offset:33280
v_mfma_f32_16x16x32_bf16 v[152:155], v[64:67], v[44:47], v[152:155]
ds_read_b64_tr_b16 v[166:167], v6 offset:34816
v_mfma_f32_16x16x32_bf16 v[156:159], v[68:71], v[44:47], v[156:159]
ds_read_b128 v[108:111], v2 offset:33536
v_mfma_f32_16x16x32_bf16 v[128:131], v[72:75], v[48:51], v[128:131]
ds_read_b64_tr_b16 v[168:169], v5 offset:36864
v_mfma_f32_16x16x32_bf16 v[132:135], v[76:79], v[48:51], v[132:135]
ds_read_b128 v[112:115], v2 offset:40960
v_mfma_f32_16x16x32_bf16 v[136:139], v[72:75], v[52:55], v[136:139]
ds_read_b64_tr_b16 v[170:171], v5 offset:38912
v_mfma_f32_16x16x32_bf16 v[140:143], v[76:79], v[52:55], v[140:143]
ds_read_b128 v[116:119], v2 offset:41216
v_mfma_f32_16x16x32_bf16 v[144:147], v[72:75], v[56:59], v[144:147]
ds_read_b64_tr_b16 v[172:173], v6 offset:36864
v_mfma_f32_16x16x32_bf16 v[148:151], v[76:79], v[56:59], v[148:151]
ds_read_b128 v[120:123], v2 offset:41472
v_mfma_f32_16x16x32_bf16 v[152:155], v[72:75], v[60:63], v[152:155]
ds_read_b64_tr_b16 v[174:175], v6 offset:38912
v_mfma_f32_16x16x32_bf16 v[156:159], v[76:79], v[60:63], v[156:159]
ds_read_b128 v[124:127], v2 offset:41728
s_waitcnt lgkmcnt(0)
s_barrier
v_mfma_f32_16x16x32_bf16 v[128:131], v[160:163], v[96:99], v[128:131]
ds_read_b64_tr_b16 v[64:65], v7 offset:0
v_mfma_f32_16x16x32_bf16 v[132:135], v[164:167], v[96:99], v[132:135]
ds_read_b128 v[32:35], v3 offset:0
v_mfma_f32_16x16x32_bf16 v[136:139], v[160:163], v[100:103], v[136:139]
ds_read_b64_tr_b16 v[66:67], v7 offset:2048
v_mfma_f32_16x16x32_bf16 v[140:143], v[164:167], v[100:103], v[140:143]
ds_read_b128 v[36:39], v3 offset:256
v_mfma_f32_16x16x32_bf16 v[144:147], v[160:163], v[104:107], v[144:147]
ds_read_b64_tr_b16 v[68:69], v8 offset:0
v_mfma_f32_16x16x32_bf16 v[148:151], v[164:167], v[104:107], v[148:151]
ds_read_b128 v[40:43], v3 offset:512
v_mfma_f32_16x16x32_bf16 v[152:155], v[160:163], v[108:111], v[152:155]
ds_read_b64_tr_b16 v[70:71], v8 offset:2048
v_mfma_f32_16x16x32_bf16 v[156:159], v[164:167], v[108:111], v[156:159]
ds_read_b128 v[44:47], v3 offset:768
v_mfma_f32_16x16x32_bf16 v[128:131], v[168:171], v[112:115], v[128:131]
ds_read_b64_tr_b16 v[72:73], v7 offset:4096
v_mfma_f32_16x16x32_bf16 v[132:135], v[172:175], v[112:115], v[132:135]
ds_read_b128 v[48:51], v3 offset:8192
v_mfma_f32_16x16x32_bf16 v[136:139], v[168:171], v[116:119], v[136:139]
ds_read_b64_tr_b16 v[74:75], v7 offset:6144
v_mfma_f32_16x16x32_bf16 v[140:143], v[172:175], v[116:119], v[140:143]
ds_read_b128 v[52:55], v3 offset:8448
v_mfma_f32_16x16x32_bf16 v[144:147], v[168:171], v[120:123], v[144:147]
ds_read_b64_tr_b16 v[76:77], v8 offset:4096
v_mfma_f32_16x16x32_bf16 v[148:151], v[172:175], v[120:123], v[148:151]
ds_read_b128 v[56:59], v3 offset:8704
v_mfma_f32_16x16x32_bf16 v[152:155], v[168:171], v[124:127], v[152:155]
ds_read_b64_tr_b16 v[78:79], v8 offset:6144
v_mfma_f32_16x16x32_bf16 v[156:159], v[172:175], v[124:127], v[156:159]
ds_read_b128 v[60:63], v3 offset:8960
s_waitcnt lgkmcnt(0)
s_barrier
v_mfma_f32_16x16x32_bf16 v[128:131], v[64:67], v[32:35], v[128:131]
ds_read_b64_tr_b16 v[160:161], v7 offset:32768
v_mfma_f32_16x16x32_bf16 v[132:135], v[68:71], v[32:35], v[132:135]
ds_read_b128 v[96:99], v3 offset:32768
v_mfma_f32_16x16x32_bf16 v[136:139], v[64:67], v[36:39], v[136:139]
ds_read_b64_tr_b16 v[162:163], v7 offset:34816
v_mfma_f32_16x16x32_bf16 v[140:143], v[68:71], v[36:39], v[140:143]
ds_read_b128 v[100:103], v3 offset:33024
v_mfma_f32_16x16x32_bf16 v[144:147], v[64:67], v[40:43], v[144:147]
ds_read_b64_tr_b16 v[164:165], v8 offset:32768
v_mfma_f32_16x16x32_bf16 v[148:151], v[68:71], v[40:43], v[148:151]
ds_read_b128 v[104:107], v3 offset:33280
v_mfma_f32_16x16x32_bf16 v[152:155], v[64:67], v[44:47], v[152:155]
ds_read_b64_tr_b16 v[166:167], v8 offset:34816
v_mfma_f32_16x16x32_bf16 v[156:159], v[68:71], v[44:47], v[156:159]
ds_read_b128 v[108:111], v3 offset:33536
v_mfma_f32_16x16x32_bf16 v[128:131], v[72:75], v[48:51], v[128:131]
ds_read_b64_tr_b16 v[168:169], v7 offset:36864
v_mfma_f32_16x16x32_bf16 v[132:135], v[76:79], v[48:51], v[132:135]
ds_read_b128 v[112:115], v3 offset:40960
v_mfma_f32_16x16x32_bf16 v[136:139], v[72:75], v[52:55], v[136:139]
ds_read_b64_tr_b16 v[170:171], v7 offset:38912
v_mfma_f32_16x16x32_bf16 v[140:143], v[76:79], v[52:55], v[140:143]
ds_read_b128 v[116:119], v3 offset:41216
v_mfma_f32_16x16x32_bf16 v[144:147], v[72:75], v[56:59], v[144:147]
ds_read_b64_tr_b16 v[172:173], v8 offset:36864
v_mfma_f32_16x16x32_bf16 v[148:151], v[76:79], v[56:59], v[148:151]
ds_read_b128 v[120:123], v3 offset:41472
v_mfma_f32_16x16x32_bf16 v[152:155], v[72:75], v[60:63], v[152:155]
ds_read_b64_tr_b16 v[174:175], v8 offset:38912
v_mfma_f32_16x16x32_bf16 v[156:159], v[76:79], v[60:63], v[156:159]
ds_read_b128 v[124:127], v3 offset:41728
s_waitcnt lgkmcnt(0)
s_barrier
v_mfma_f32_16x16x32_bf16 v[128:131], v[160:163], v[96:99], v[128:131]
ds_read_b64_tr_b16 v[64:65], v5 offset:0
v_mfma_f32_16x16x32_bf16 v[132:135], v[164:167], v[96:99], v[132:135]
ds_read_b128 v[32:35], v2 offset:0
v_mfma_f32_16x16x32_bf16 v[136:139], v[160:163], v[100:103], v[136:139]
ds_read_b64_tr_b16 v[66:67], v5 offset:2048
v_mfma_f32_16x16x32_bf16 v[140:143], v[164:167], v[100:103], v[140:143]
ds_read_b128 v[36:39], v2 offset:256
buffer_load_dwordx4 v[192:195], v9, s[68:71], 0 offen offset:0 sc1
v_mfma_f32_16x16x32_bf16 v[144:147], v[160:163], v[104:107], v[144:147]
ds_read_b64_tr_b16 v[68:69], v6 offset:0
v_mfma_f32_16x16x32_bf16 v[148:151], v[164:167], v[104:107], v[148:151]
ds_read_b128 v[40:43], v2 offset:512
v_mfma_f32_16x16x32_bf16 v[152:155], v[160:163], v[108:111], v[152:155]
ds_read_b64_tr_b16 v[70:71], v6 offset:2048
buffer_load_dwordx4 v[196:199], v9, s[68:71], 0 offen offset:1024 sc1
v_mfma_f32_16x16x32_bf16 v[156:159], v[164:167], v[108:111], v[156:159]
ds_read_b128 v[44:47], v2 offset:768
v_mfma_f32_16x16x32_bf16 v[128:131], v[168:171], v[112:115], v[128:131]
ds_read_b64_tr_b16 v[72:73], v5 offset:4096
v_mfma_f32_16x16x32_bf16 v[132:135], v[172:175], v[112:115], v[132:135]
ds_read_b128 v[48:51], v2 offset:8192
buffer_load_dwordx4 v[200:203], v9, s[68:71], 0 offen offset:2048 sc1
v_mfma_f32_16x16x32_bf16 v[136:139], v[168:171], v[116:119], v[136:139]
ds_read_b64_tr_b16 v[74:75], v5 offset:6144
v_mfma_f32_16x16x32_bf16 v[140:143], v[172:175], v[116:119], v[140:143]
ds_read_b128 v[52:55], v2 offset:8448
v_mfma_f32_16x16x32_bf16 v[144:147], v[168:171], v[120:123], v[144:147]
ds_read_b64_tr_b16 v[76:77], v6 offset:4096
buffer_load_dwordx4 v[204:207], v9, s[68:71], 0 offen offset:3072 sc1
v_mfma_f32_16x16x32_bf16 v[148:151], v[172:175], v[120:123], v[148:151]
ds_read_b128 v[56:59], v2 offset:8704
v_mfma_f32_16x16x32_bf16 v[152:155], v[168:171], v[124:127], v[152:155]
ds_read_b64_tr_b16 v[78:79], v6 offset:6144
v_mfma_f32_16x16x32_bf16 v[156:159], v[172:175], v[124:127], v[156:159]
ds_read_b128 v[60:63], v2 offset:8960
s_waitcnt lgkmcnt(0)
s_barrier
v_mfma_f32_16x16x32_bf16 v[128:131], v[64:67], v[32:35], v[128:131]
ds_read_b64_tr_b16 v[160:161], v5 offset:32768
v_mfma_f32_16x16x32_bf16 v[132:135], v[68:71], v[32:35], v[132:135]
ds_read_b128 v[96:99], v2 offset:32768
v_mfma_f32_16x16x32_bf16 v[136:139], v[64:67], v[36:39], v[136:139]
ds_read_b64_tr_b16 v[162:163], v5 offset:34816
v_mfma_f32_16x16x32_bf16 v[140:143], v[68:71], v[36:39], v[140:143]
ds_read_b128 v[100:103], v2 offset:33024
v_mfma_f32_16x16x32_bf16 v[144:147], v[64:67], v[40:43], v[144:147]
ds_read_b64_tr_b16 v[164:165], v6 offset:32768
v_mfma_f32_16x16x32_bf16 v[148:151], v[68:71], v[40:43], v[148:151]
ds_read_b128 v[104:107], v2 offset:33280
v_mfma_f32_16x16x32_bf16 v[152:155], v[64:67], v[44:47], v[152:155]
ds_read_b64_tr_b16 v[166:167], v6 offset:34816
v_mfma_f32_16x16x32_bf16 v[156:159], v[68:71], v[44:47], v[156:159]
ds_read_b128 v[108:111], v2 offset:33536
v_mfma_f32_16x16x32_bf16 v[128:131], v[72:75], v[48:51], v[128:131]
ds_read_b64_tr_b16 v[168:169], v5 offset:36864
v_mfma_f32_16x16x32_bf16 v[132:135], v[76:79], v[48:51], v[132:135]
ds_read_b128 v[112:115], v2 offset:40960
v_mfma_f32_16x16x32_bf16 v[136:139], v[72:75], v[52:55], v[136:139]
ds_read_b64_tr_b16 v[170:171], v5 offset:38912
v_mfma_f32_16x16x32_bf16 v[140:143], v[76:79], v[52:55], v[140:143]
ds_read_b128 v[116:119], v2 offset:41216
v_mfma_f32_16x16x32_bf16 v[144:147], v[72:75], v[56:59], v[144:147]
ds_read_b64_tr_b16 v[172:173], v6 offset:36864
v_mfma_f32_16x16x32_bf16 v[148:151], v[76:79], v[56:59], v[148:151]
ds_read_b128 v[120:123], v2 offset:41472
v_mfma_f32_16x16x32_bf16 v[152:155], v[72:75], v[60:63], v[152:155]
ds_read_b64_tr_b16 v[174:175], v6 offset:38912
v_mfma_f32_16x16x32_bf16 v[156:159], v[76:79], v[60:63], v[156:159]
ds_read_b128 v[124:127], v2 offset:41728
s_waitcnt lgkmcnt(0)
s_barrier
v_mfma_f32_16x16x32_bf16 v[128:131], v[160:163], v[96:99], v[128:131]
v_mfma_f32_16x16x32_bf16 v[132:135], v[164:167], v[96:99], v[132:135]
v_mfma_f32_16x16x32_bf16 v[136:139], v[160:163], v[100:103], v[136:139]
v_mfma_f32_16x16x32_bf16 v[140:143], v[164:167], v[100:103], v[140:143]
v_mfma_f32_16x16x32_bf16 v[144:147], v[160:163], v[104:107], v[144:147]
v_mfma_f32_16x16x32_bf16 v[148:151], v[164:167], v[104:107], v[148:151]
v_mfma_f32_16x16x32_bf16 v[152:155], v[160:163], v[108:111], v[152:155]
v_mfma_f32_16x16x32_bf16 v[156:159], v[164:167], v[108:111], v[156:159]
s_waitcnt vmcnt(0)
v_mfma_f32_16x16x32_bf16 v[128:131], v[168:171], v[112:115], v[128:131]
v_lshlrev_b32 v224, 16, v192
v_and_b32 v225, 0xffff0000, v192
v_lshlrev_b32 v226, 16, v193
v_and_b32 v227, 0xffff0000, v193
v_mfma_f32_16x16x32_bf16 v[132:135], v[172:175], v[112:115], v[132:135]
v_lshlrev_b32 v228, 16, v194
v_and_b32 v229, 0xffff0000, v194
v_lshlrev_b32 v230, 16, v195
v_and_b32 v231, 0xffff0000, v195
v_mfma_f32_16x16x32_bf16 v[136:139], v[168:171], v[116:119], v[136:139]
v_lshlrev_b32 v232, 16, v196
v_and_b32 v233, 0xffff0000, v196
v_lshlrev_b32 v234, 16, v197
v_and_b32 v235, 0xffff0000, v197
v_mfma_f32_16x16x32_bf16 v[140:143], v[172:175], v[116:119], v[140:143]
v_lshlrev_b32 v236, 16, v198
v_and_b32 v237, 0xffff0000, v198
v_lshlrev_b32 v238, 16, v199
v_and_b32 v239, 0xffff0000, v199
v_mfma_f32_16x16x32_bf16 v[144:147], v[168:171], v[120:123], v[144:147]
v_lshlrev_b32 v240, 16, v200
v_and_b32 v241, 0xffff0000, v200
v_lshlrev_b32 v242, 16, v201
v_and_b32 v243, 0xffff0000, v201
v_mfma_f32_16x16x32_bf16 v[148:151], v[172:175], v[120:123], v[148:151]
v_lshlrev_b32 v244, 16, v202
v_and_b32 v245, 0xffff0000, v202
v_lshlrev_b32 v246, 16, v203
v_and_b32 v247, 0xffff0000, v203
v_mfma_f32_16x16x32_bf16 v[152:155], v[168:171], v[124:127], v[152:155]
v_lshlrev_b32 v248, 16, v204
v_and_b32 v249, 0xffff0000, v204
v_lshlrev_b32 v250, 16, v205
v_and_b32 v251, 0xffff0000, v205
v_mfma_f32_16x16x32_bf16 v[156:159], v[172:175], v[124:127], v[156:159]
v_lshlrev_b32 v252, 16, v206
v_and_b32 v253, 0xffff0000, v206
v_lshlrev_b32 v254, 16, v207
v_and_b32 v255, 0xffff0000, v207
s_waitcnt vmcnt(0)
s_nop 4
v_pk_add_f32 v[128:129], v[128:129], v[224:225]
v_pk_add_f32 v[130:131], v[130:131], v[226:227]
v_pk_add_f32 v[132:133], v[132:133], v[228:229]
v_pk_add_f32 v[134:135], v[134:135], v[230:231]
v_cvt_pk_bf16_f32 v32, v128, v129
v_cvt_pk_bf16_f32 v33, v130, v131
v_cvt_pk_bf16_f32 v34, v132, v133
v_cvt_pk_bf16_f32 v35, v134, v135
v_pk_add_f32 v[136:137], v[136:137], v[232:233]
v_pk_add_f32 v[138:139], v[138:139], v[234:235]
v_pk_add_f32 v[140:141], v[140:141], v[236:237]
v_pk_add_f32 v[142:143], v[142:143], v[238:239]
v_cvt_pk_bf16_f32 v36, v136, v137
v_cvt_pk_bf16_f32 v37, v138, v139
v_cvt_pk_bf16_f32 v38, v140, v141
v_cvt_pk_bf16_f32 v39, v142, v143
v_pk_add_f32 v[144:145], v[144:145], v[240:241]
v_pk_add_f32 v[146:147], v[146:147], v[242:243]
v_pk_add_f32 v[148:149], v[148:149], v[244:245]
v_pk_add_f32 v[150:151], v[150:151], v[246:247]
v_cvt_pk_bf16_f32 v40, v144, v145
v_cvt_pk_bf16_f32 v41, v146, v147
v_cvt_pk_bf16_f32 v42, v148, v149
v_cvt_pk_bf16_f32 v43, v150, v151
v_pk_add_f32 v[152:153], v[152:153], v[248:249]
v_pk_add_f32 v[154:155], v[154:155], v[250:251]
v_pk_add_f32 v[156:157], v[156:157], v[252:253]
v_pk_add_f32 v[158:159], v[158:159], v[254:255]
v_cvt_pk_bf16_f32 v44, v152, v153
v_cvt_pk_bf16_f32 v45, v154, v155
v_cvt_pk_bf16_f32 v46, v156, v157
v_cvt_pk_bf16_f32 v47, v158, v159
v_permlane16_swap_b32 v32, v34
v_permlane16_swap_b32 v33, v35
buffer_store_dwordx4 v[32:35], v28, s[16:19], 0 offen offset:0
v_permlane16_swap_b32 v36, v38
v_permlane16_swap_b32 v37, v39
buffer_store_dwordx4 v[36:39], v28, s[16:19], 0 offen offset:2048
v_permlane16_swap_b32 v40, v42
v_permlane16_swap_b32 v41, v43
buffer_store_dwordx4 v[40:43], v28, s[16:19], s54 offen offset:0
v_permlane16_swap_b32 v44, v46
v_permlane16_swap_b32 v45, v47
buffer_store_dwordx4 v[44:47], v28, s[16:19], s54 offen offset:2048
s_branch Ldone_1
LG1_24:
s_cmp_eq_u32 s36, 7
s_cbranch_scc1 L7_35
s_mul_i32 s44, s34, 262144
s_lshl_b32 s39, s51, 13
s_add_u32 s44, s44, s39
s_add_u32 s44, s44, 0
s_lshl_b32 s43, s35, 7
s_mov_b32 s10, 253952
s_movk_i32 s38, 1024
s_movk_i32 s40, 9216
s_cmp_eq_u32 s51, 2
s_cselect_b32 s8, s28, s32
s_cselect_b32 s9, s29, s33
s_cselect_b32 s10, 2095232, s10
s_cselect_b32 s43, s43, s44
s_cselect_b32 s38, 16384, s38
s_cselect_b32 s40, 16384, s40
s_cselect_b32 s55, 16384, s38
s_cselect_b32 s45, -1, 0
s_add_u32 s8, s8, s43
s_addc_u32 s9, s9, 0
s_mov_b32 s11, 0x20000
s_sub_u32 s37, 0, s40
v_lshrrev_b32 v19, 3, v1
v_mul_u32_u24 v19, 1920, v19
v_lshrrev_b32 v20, 4, v1
v_lshlrev_b32 v20, 5, v20
v_and_b32 v19, s45, v19
v_and_b32 v20, s45, v20
v_lshlrev_b32 v23, 4, v1
v_xor_b32 v23, v23, v20
v_add_u32 v23, v23, v19
s_lshl_b32 s43, s34, 18
s_add_u32 s12, s32, s43
s_addc_u32 s13, s33, 0
s_mov_b32 s14, 262144
s_mov_b32 s15, 0x20000
v_lshlrev_b32 v21, 4, v1
s_lshl_b32 s54, s36, 11
s_add_u32 s43, s35, 1
s_and_b32 s43, s43, 15
s_lshl_b32 s43, s43, 14
s_add_u32 s30, s43, s54
s_add_u32 s43, s35, 2
s_and_b32 s43, s43, 15
s_lshl_b32 s43, s43, 14
s_add_u32 s31, s43, s54
s_cmp_eq_u32 s51, 1
s_cbranch_scc1 Lp_39
s_cmp_eq_u32 s51, 2
s_cbranch_scc1 Lp_40
Lp_38:
s_add_u32 s42, s35, 2
s_waitcnt vmcnt(0)
s_barrier
ds_write_b128 v27, v[68:71] offset:0
ds_write_b128 v27, v[116:119] offset:512
s_add_u32 s43, s34, 0
s_lshl_b32 s43, s43, 7
v_mov_b32 v8, s43
v_mov_b32 v10, 16
buffer_load_dword v9, v8, s[56:59], 0 offen sc1
s_mov_b32 s41, 0x10000
Lpoll_41:
s_waitcnt vmcnt(0)
Lpf_43:
v_cmp_ne_u32 vcc, v10, v9
s_nop 4
s_cbranch_vccz Lpok_42
buffer_load_dword v9, v8, s[56:59], 0 offen sc1
s_sub_u32 s41, s41, 1
s_cmp_lg_u32 s41, 0
s_cbranch_scc1 Lpoll_41
s_waitcnt vmcnt(0)
Lpok_42:
s_waitcnt lgkmcnt(0)
s_barrier
s_add_u32 m0, s54, 16384
s_add_u32 s43, s30, 0
buffer_load_dwordx4 v21, s[12:15], s43 offen sc1 lds
s_add_u32 m0, s54, 17408
s_add_u32 s43, s30, 1024
buffer_load_dwordx4 v21, s[12:15], s43 offen sc1 lds
s_add_u32 m0, s54, 32768
s_add_u32 s43, s31, 0
buffer_load_dwordx4 v21, s[12:15], s43 offen sc1 lds
s_add_u32 m0, s54, 33792
s_add_u32 s43, s31, 1024
buffer_load_dwordx4 v21, s[12:15], s43 offen sc1 lds
s_add_u32 s42, s42, 1
s_and_b32 s42, s42, 15
s_add_u32 m0, s39, 49152
s_lshl_b32 s37, s42, 14
buffer_load_dwordx4 v23, s[8:11], s37 offen sc1 lds
s_add_u32 m0, s39, 50176
s_add_u32 s37, s37, s38
buffer_load_dwordx4 v23, s[8:11], s37 offen sc1 lds
s_add_u32 m0, s39, 51200
s_add_u32 s37, s37, s38
buffer_load_dwordx4 v23, s[8:11], s37 offen sc1 lds
s_add_u32 m0, s39, 52224
s_add_u32 s37, s37, s38
buffer_load_dwordx4 v23, s[8:11], s37 offen sc1 lds
s_add_u32 m0, s39, 53248
s_add_u32 s37, s37, s38
buffer_load_dwordx4 v23, s[8:11], s37 offen sc1 lds
s_add_u32 m0, s39, 54272
s_add_u32 s37, s37, s38
buffer_load_dwordx4 v23, s[8:11], s37 offen sc1 lds
s_add_u32 m0, s39, 55296
s_add_u32 s37, s37, s38
buffer_load_dwordx4 v23, s[8:11], s37 offen sc1 lds
s_add_u32 m0, s39, 56320
s_add_u32 s37, s37, s38
buffer_load_dwordx4 v23, s[8:11], s37 offen sc1 lds
s_waitcnt vmcnt(10)
s_barrier
s_add_u32 s42, s42, 1
s_and_b32 s42, s42, 15
s_add_u32 m0, s39, 0
s_lshl_b32 s37, s42, 14
buffer_load_dwordx4 v23, s[8:11], s37 offen sc1 lds
s_add_u32 m0, s39, 1024
s_add_u32 s37, s37, s38
buffer_load_dwordx4 v23, s[8:11], s37 offen sc1 lds
s_add_u32 m0, s39, 2048
s_add_u32 s37, s37, s38
buffer_load_dwordx4 v23, s[8:11], s37 offen sc1 lds
s_add_u32 m0, s39, 3072
s_add_u32 s37, s37, s38
buffer_load_dwordx4 v23, s[8:11], s37 offen sc1 lds
s_add_u32 m0, s39, 4096
s_add_u32 s37, s37, s38
buffer_load_dwordx4 v23, s[8:11], s37 offen sc1 lds
s_add_u32 m0, s39, 5120
s_add_u32 s37, s37, s38
buffer_load_dwordx4 v23, s[8:11], s37 offen sc1 lds
s_add_u32 m0, s39, 6144
s_add_u32 s37, s37, s38
buffer_load_dwordx4 v23, s[8:11], s37 offen sc1 lds
s_add_u32 m0, s39, 7168
s_add_u32 s37, s37, s38
buffer_load_dwordx4 v23, s[8:11], s37 offen sc1 lds
s_waitcnt vmcnt(16)
s_barrier
s_add_u32 s42, s42, 1
s_and_b32 s42, s42, 15
s_add_u32 m0, s39, 16384
s_lshl_b32 s37, s42, 14
buffer_load_dwordx4 v23, s[8:11], s37 offen sc1 lds
s_add_u32 m0, s39, 17408
s_add_u32 s37, s37, s38
buffer_load_dwordx4 v23, s[8:11], s37 offen sc1 lds
s_add_u32 m0, s39, 18432
s_add_u32 s37, s37, s38
buffer_load_dwordx4 v23, s[8:11], s37 offen sc1 lds
s_add_u32 m0, s39, 19456
s_add_u32 s37, s37, s38
buffer_load_dwordx4 v23, s[8:11], s37 offen sc1 lds
s_add_u32 m0, s39, 20480
s_add_u32 s37, s37, s38
buffer_load_dwordx4 v23, s[8:11], s37 offen sc1 lds
s_add_u32 m0, s39, 21504
s_add_u32 s37, s37, s38
buffer_load_dwordx4 v23, s[8:11], s37 offen sc1 lds
s_add_u32 m0, s39, 22528
s_add_u32 s37, s37, s38
buffer_load_dwordx4 v23, s[8:11], s37 offen sc1 lds
s_add_u32 m0, s39, 23552
s_add_u32 s37, s37, s38
buffer_load_dwordx4 v23, s[8:11], s37 offen sc1 lds
s_waitcnt vmcnt(16)
s_barrier
s_add_u32 s42, s42, 1
s_and_b32 s42, s42, 15
s_add_u32 m0, s39, 32768
s_lshl_b32 s37, s42, 14
buffer_load_dwordx4 v23, s[8:11], s37 offen sc1 lds
s_add_u32 m0, s39, 33792
s_add_u32 s37, s37, s38
buffer_load_dwordx4 v23, s[8:11], s37 offen sc1 lds
s_add_u32 m0, s39, 34816
s_add_u32 s37, s37, s38
buffer_load_dwordx4 v23, s[8:11], s37 offen sc1 lds
s_add_u32 m0, s39, 35840
s_add_u32 s37, s37, s38
buffer_load_dwordx4 v23, s[8:11], s37 offen sc1 lds
s_add_u32 m0, s39, 36864
s_add_u32 s37, s37, s38
buffer_load_dwordx4 v23, s[8:11], s37 offen sc1 lds
s_add_u32 m0, s39, 37888
s_add_u32 s37, s37, s38
buffer_load_dwordx4 v23, s[8:11], s37 offen sc1 lds
s_add_u32 m0, s39, 38912
s_add_u32 s37, s37, s38
buffer_load_dwordx4 v23, s[8:11], s37 offen sc1 lds
s_add_u32 m0, s39, 39936
s_add_u32 s37, s37, s38
buffer_load_dwordx4 v23, s[8:11], s37 offen sc1 lds
s_waitcnt vmcnt(16)
s_barrier
s_add_u32 s42, s42, 1
s_and_b32 s42, s42, 15
s_add_u32 m0, s39, 49152
s_lshl_b32 s37, s42, 14
buffer_load_dwordx4 v23, s[8:11], s37 offen sc1 lds
s_add_u32 m0, s39, 50176
s_add_u32 s37, s37, s38
buffer_load_dwordx4 v23, s[8:11], s37 offen sc1 lds
s_add_u32 m0, s39, 51200
s_add_u32 s37, s37, s38
buffer_load_dwordx4 v23, s[8:11], s37 offen sc1 lds
s_add_u32 m0, s39, 52224
s_add_u32 s37, s37, s38
buffer_load_dwordx4 v23, s[8:11], s37 offen sc1 lds
s_add_u32 m0, s39, 53248
s_add_u32 s37, s37, s38
buffer_load_dwordx4 v23, s[8:11], s37 offen sc1 lds
s_add_u32 m0, s39, 54272
s_add_u32 s37, s37, s38
buffer_load_dwordx4 v23, s[8:11], s37 offen sc1 lds
s_add_u32 m0, s39, 55296
s_add_u32 s37, s37, s38
buffer_load_dwordx4 v23, s[8:11], s37 offen sc1 lds
s_add_u32 m0, s39, 56320
s_add_u32 s37, s37, s38
buffer_load_dwordx4 v23, s[8:11], s37 offen sc1 lds
s_waitcnt vmcnt(16)
s_barrier
s_add_u32 s42, s42, 1
s_and_b32 s42, s42, 15
s_add_u32 m0, s39, 0
s_lshl_b32 s37, s42, 14
buffer_load_dwordx4 v23, s[8:11], s37 offen sc1 lds
s_add_u32 m0, s39, 1024
s_add_u32 s37, s37, s38
buffer_load_dwordx4 v23, s[8:11], s37 offen sc1 lds
s_add_u32 m0, s39, 2048
s_add_u32 s37, s37, s38
buffer_load_dwordx4 v23, s[8:11], s37 offen sc1 lds
s_add_u32 m0, s39, 3072
s_add_u32 s37, s37, s38
buffer_load_dwordx4 v23, s[8:11], s37 offen sc1 lds
s_add_u32 m0, s39, 4096
s_add_u32 s37, s37, s38
buffer_load_dwordx4 v23, s[8:11], s37 offen sc1 lds
s_add_u32 m0, s39, 5120
s_add_u32 s37, s37, s38
buffer_load_dwordx4 v23, s[8:11], s37 offen sc1 lds
s_add_u32 m0, s39, 6144
s_add_u32 s37, s37, s38
buffer_load_dwordx4 v23, s[8:11], s37 offen sc1 lds
s_add_u32 m0, s39, 7168
s_add_u32 s37, s37, s38
buffer_load_dwordx4 v23, s[8:11], s37 offen sc1 lds
s_waitcnt vmcnt(16)
s_barrier
s_add_u32 s42, s42, 1
s_and_b32 s42, s42, 15
s_add_u32 m0, s39, 16384
s_lshl_b32 s37, s42, 14
buffer_load_dwordx4 v23, s[8:11], s37 offen sc1 lds
s_add_u32 m0, s39, 17408
s_add_u32 s37, s37, s38
buffer_load_dwordx4 v23, s[8:11], s37 offen sc1 lds
s_add_u32 m0, s39, 18432
s_add_u32 s37, s37, s38
buffer_load_dwordx4 v23, s[8:11], s37 offen sc1 lds
s_add_u32 m0, s39, 19456
s_add_u32 s37, s37, s38
buffer_load_dwordx4 v23, s[8:11], s37 offen sc1 lds
s_add_u32 m0, s39, 20480
s_add_u32 s37, s37, s38
buffer_load_dwordx4 v23, s[8:11], s37 offen sc1 lds
s_add_u32 m0, s39, 21504
s_add_u32 s37, s37, s38
buffer_load_dwordx4 v23, s[8:11], s37 offen sc1 lds
s_add_u32 m0, s39, 22528
s_add_u32 s37, s37, s38
buffer_load_dwordx4 v23, s[8:11], s37 offen sc1 lds
s_add_u32 m0, s39, 23552
s_add_u32 s37, s37, s38
buffer_load_dwordx4 v23, s[8:11], s37 offen sc1 lds
s_waitcnt vmcnt(16)
s_barrier
s_add_u32 s42, s42, 1
s_and_b32 s42, s42, 15
s_add_u32 m0, s39, 32768
s_lshl_b32 s37, s42, 14
buffer_load_dwordx4 v23, s[8:11], s37 offen sc1 lds
s_add_u32 m0, s39, 33792
s_add_u32 s37, s37, s38
buffer_load_dwordx4 v23, s[8:11], s37 offen sc1 lds
s_add_u32 m0, s39, 34816
s_add_u32 s37, s37, s38
buffer_load_dwordx4 v23, s[8:11], s37 offen sc1 lds
s_add_u32 m0, s39, 35840
s_add_u32 s37, s37, s38
buffer_load_dwordx4 v23, s[8:11], s37 offen sc1 lds
s_add_u32 m0, s39, 36864
s_add_u32 s37, s37, s38
buffer_load_dwordx4 v23, s[8:11], s37 offen sc1 lds
s_add_u32 m0, s39, 37888
s_add_u32 s37, s37, s38
buffer_load_dwordx4 v23, s[8:11], s37 offen sc1 lds
s_add_u32 m0, s39, 38912
s_add_u32 s37, s37, s38
buffer_load_dwordx4 v23, s[8:11], s37 offen sc1 lds
s_add_u32 m0, s39, 39936
s_add_u32 s37, s37, s38
buffer_load_dwordx4 v23, s[8:11], s37 offen sc1 lds
s_waitcnt vmcnt(16)
s_barrier
s_add_u32 s42, s42, 1
s_and_b32 s42, s42, 15
s_add_u32 m0, s39, 49152
s_lshl_b32 s37, s42, 14
buffer_load_dwordx4 v23, s[8:11], s37 offen sc1 lds
s_add_u32 m0, s39, 50176
s_add_u32 s37, s37, s38
buffer_load_dwordx4 v23, s[8:11], s37 offen sc1 lds
s_add_u32 m0, s39, 51200
s_add_u32 s37, s37, s38
buffer_load_dwordx4 v23, s[8:11], s37 offen sc1 lds
s_add_u32 m0, s39, 52224
s_add_u32 s37, s37, s38
buffer_load_dwordx4 v23, s[8:11], s37 offen sc1 lds
s_add_u32 m0, s39, 53248
s_add_u32 s37, s37, s38
buffer_load_dwordx4 v23, s[8:11], s37 offen sc1 lds
s_add_u32 m0, s39, 54272
s_add_u32 s37, s37, s38
buffer_load_dwordx4 v23, s[8:11], s37 offen sc1 lds
s_add_u32 m0, s39, 55296
s_add_u32 s37, s37, s38
buffer_load_dwordx4 v23, s[8:11], s37 offen sc1 lds
s_add_u32 m0, s39, 56320
s_add_u32 s37, s37, s38
buffer_load_dwordx4 v23, s[8:11], s37 offen sc1 lds
s_waitcnt vmcnt(16)
s_barrier
s_add_u32 s42, s42, 1
s_and_b32 s42, s42, 15
s_add_u32 m0, s39, 0
s_lshl_b32 s37, s42, 14
buffer_load_dwordx4 v23, s[8:11], s37 offen sc1 lds
s_add_u32 m0, s39, 1024
s_add_u32 s37, s37, s38
buffer_load_dwordx4 v23, s[8:11], s37 offen sc1 lds
s_add_u32 m0, s39, 2048
s_add_u32 s37, s37, s38
buffer_load_dwordx4 v23, s[8:11], s37 offen sc1 lds
s_add_u32 m0, s39, 3072
s_add_u32 s37, s37, s38
buffer_load_dwordx4 v23, s[8:11], s37 offen sc1 lds
s_add_u32 m0, s39, 4096
s_add_u32 s37, s37, s38
buffer_load_dwordx4 v23, s[8:11], s37 offen sc1 lds
s_add_u32 m0, s39, 5120
s_add_u32 s37, s37, s38
buffer_load_dwordx4 v23, s[8:11], s37 offen sc1 lds
s_add_u32 m0, s39, 6144
s_add_u32 s37, s37, s38
buffer_load_dwordx4 v23, s[8:11], s37 offen sc1 lds
s_add_u32 m0, s39, 7168
s_add_u32 s37, s37, s38
buffer_load_dwordx4 v23, s[8:11], s37 offen sc1 lds
s_waitcnt vmcnt(16)
s_barrier
s_add_u32 s42, s42, 1
s_and_b32 s42, s42, 15
s_add_u32 m0, s39, 16384
s_lshl_b32 s37, s42, 14
buffer_load_dwordx4 v23, s[8:11], s37 offen sc1 lds
s_add_u32 m0, s39, 17408
s_add_u32 s37, s37, s38
buffer_load_dwordx4 v23, s[8:11], s37 offen sc1 lds
s_add_u32 m0, s39, 18432
s_add_u32 s37, s37, s38
buffer_load_dwordx4 v23, s[8:11], s37 offen sc1 lds
s_add_u32 m0, s39, 19456
s_add_u32 s37, s37, s38
buffer_load_dwordx4 v23, s[8:11], s37 offen sc1 lds
s_add_u32 m0, s39, 20480
s_add_u32 s37, s37, s38
buffer_load_dwordx4 v23, s[8:11], s37 offen sc1 lds
s_add_u32 m0, s39, 21504
s_add_u32 s37, s37, s38
buffer_load_dwordx4 v23, s[8:11], s37 offen sc1 lds
s_add_u32 m0, s39, 22528
s_add_u32 s37, s37, s38
buffer_load_dwordx4 v23, s[8:11], s37 offen sc1 lds
s_add_u32 m0, s39, 23552
s_add_u32 s37, s37, s38
buffer_load_dwordx4 v23, s[8:11], s37 offen sc1 lds
s_waitcnt vmcnt(16)
s_barrier
s_add_u32 s42, s42, 1
s_and_b32 s42, s42, 15
s_add_u32 m0, s39, 32768
s_lshl_b32 s37, s42, 14
buffer_load_dwordx4 v23, s[8:11], s37 offen sc1 lds
s_add_u32 m0, s39, 33792
s_add_u32 s37, s37, s38
buffer_load_dwordx4 v23, s[8:11], s37 offen sc1 lds
s_add_u32 m0, s39, 34816
s_add_u32 s37, s37, s38
buffer_load_dwordx4 v23, s[8:11], s37 offen sc1 lds
s_add_u32 m0, s39, 35840
s_add_u32 s37, s37, s38
buffer_load_dwordx4 v23, s[8:11], s37 offen sc1 lds
s_add_u32 m0, s39, 36864
s_add_u32 s37, s37, s38
buffer_load_dwordx4 v23, s[8:11], s37 offen sc1 lds
s_add_u32 m0, s39, 37888
s_add_u32 s37, s37, s38
buffer_load_dwordx4 v23, s[8:11], s37 offen sc1 lds
s_add_u32 m0, s39, 38912
s_add_u32 s37, s37, s38
buffer_load_dwordx4 v23, s[8:11], s37 offen sc1 lds
s_add_u32 m0, s39, 39936
s_add_u32 s37, s37, s38
buffer_load_dwordx4 v23, s[8:11], s37 offen sc1 lds
s_waitcnt vmcnt(16)
s_barrier
s_add_u32 s42, s42, 1
s_and_b32 s42, s42, 15
s_add_u32 m0, s39, 49152
s_lshl_b32 s37, s42, 14
buffer_load_dwordx4 v23, s[8:11], s37 offen sc1 lds
s_add_u32 m0, s39, 50176
s_add_u32 s37, s37, s38
buffer_load_dwordx4 v23, s[8:11], s37 offen sc1 lds
s_add_u32 m0, s39, 51200
s_add_u32 s37, s37, s38
buffer_load_dwordx4 v23, s[8:11], s37 offen sc1 lds
s_add_u32 m0, s39, 52224
s_add_u32 s37, s37, s38
buffer_load_dwordx4 v23, s[8:11], s37 offen sc1 lds
s_add_u32 m0, s39, 53248
s_add_u32 s37, s37, s38
buffer_load_dwordx4 v23, s[8:11], s37 offen sc1 lds
s_add_u32 m0, s39, 54272
s_add_u32 s37, s37, s38
buffer_load_dwordx4 v23, s[8:11], s37 offen sc1 lds
s_add_u32 m0, s39, 55296
s_add_u32 s37, s37, s38
buffer_load_dwordx4 v23, s[8:11], s37 offen sc1 lds
s_add_u32 m0, s39, 56320
s_add_u32 s37, s37, s38
buffer_load_dwordx4 v23, s[8:11], s37 offen sc1 lds
s_lshl_b32 s43, s35, 8
s_cmp_eq_u32 s51, 1
s_cselect_b32 s8, s4, s6
s_cselect_b32 s9, s5, s7
s_sub_u32 s10, 7340032, s43
s_lshl_b32 s44, s34, 18
s_add_u32 s44, s44, 4194304
s_movk_i32 s38, 28672
s_cmp_eq_u32 s51, 0
s_cselect_b32 s8, s32, s8
s_cselect_b32 s9, s33, s9
s_cselect_b32 s10, 262144, s10
s_cselect_b32 s43, s44, s43
s_cselect_b32 s38, 1024, s38
s_cselect_b32 s45, 0, -1
s_add_u32 s8, s8, s43
s_addc_u32 s9, s9, 0
s_mov_b32 s11, 0x20000
s_lshl_b32 s40, s38, 4
s_add_u32 s42, s35, 15
s_lshl_b32 s39, s51, 14
v_lshrrev_b32 v19, 4, v1
v_lshlrev_b32 v20, 5, v19
v_mul_u32_u24 v19, 6912, v19
v_and_b32 v19, s45, v19
v_and_b32 v20, s45, v20
v_lshlrev_b32 v21, 4, v1
v_xor_b32 v21, v21, v20
v_add_u32 v22, v21, v19
s_and_b32 s45, s45, 128
v_xor_b32 v23, s45, v22
s_waitcnt vmcnt(16)
s_barrier
s_waitcnt vmcnt(8)
s_barrier
s_waitcnt vmcnt(0)
s_barrier
s_barrier
s_barrier
s_add_u32 s42, s42, 3
s_add_u32 s43, s34, 16
s_lshl_b32 s43, s43, 7
v_mov_b32 v8, s43
v_mov_b32 v10, 16
buffer_load_dword v9, v8, s[56:59], 0 offen sc1
s_mov_b32 s41, 0x10000
Lpoll_44:
s_waitcnt vmcnt(0)
Lpf_46:
v_cmp_ne_u32 vcc, v10, v9
s_nop 4
s_cbranch_vccz Lpok_45
buffer_load_dword v9, v8, s[56:59], 0 offen sc1
s_sub_u32 s41, s41, 1
s_cmp_lg_u32 s41, 0
s_cbranch_scc1 Lpoll_44
s_waitcnt vmcnt(0)
Lpok_45:
s_branch LP3_37
Lp_39:
s_add_u32 s42, s35, 2
s_waitcnt vmcnt(0)
s_barrier
s_add_u32 s43, s34, 0
s_lshl_b32 s43, s43, 7
v_mov_b32 v13, s43
v_mov_b32 v14, 1
s_mov_b64 exec, 1
buffer_atomic_add v14, v13, s[56:59], 0 offen sc1
s_mov_b64 exec, -1
ds_write_b128 v27, v[68:71] offset:0
ds_write_b128 v27, v[116:119] offset:512
s_waitcnt lgkmcnt(0)
s_barrier
s_add_u32 m0, s54, 16384
s_add_u32 s43, s30, 0
buffer_load_dwordx4 v21, s[12:15], s43 offen sc1 lds
s_add_u32 m0, s54, 17408
s_add_u32 s43, s30, 1024
buffer_load_dwordx4 v21, s[12:15], s43 offen sc1 lds
s_add_u32 m0, s54, 32768
s_add_u32 s43, s31, 0
buffer_load_dwordx4 v21, s[12:15], s43 offen sc1 lds
s_add_u32 m0, s54, 33792
s_add_u32 s43, s31, 1024
buffer_load_dwordx4 v21, s[12:15], s43 offen sc1 lds
s_add_u32 s42, s42, 1
s_and_b32 s42, s42, 15
s_add_u32 m0, s39, 49152
s_lshl_b32 s37, s42, 14
buffer_load_dwordx4 v23, s[8:11], s37 offen sc1 lds
s_add_u32 m0, s39, 50176
s_add_u32 s37, s37, s38
buffer_load_dwordx4 v23, s[8:11], s37 offen sc1 lds
s_add_u32 m0, s39, 51200
s_add_u32 s37, s37, s38
buffer_load_dwordx4 v23, s[8:11], s37 offen sc1 lds
s_add_u32 m0, s39, 52224
s_add_u32 s37, s37, s38
buffer_load_dwordx4 v23, s[8:11], s37 offen sc1 lds
s_add_u32 m0, s39, 53248
s_add_u32 s37, s37, s38
buffer_load_dwordx4 v23, s[8:11], s37 offen sc1 lds
s_add_u32 m0, s39, 54272
s_add_u32 s37, s37, s38
buffer_load_dwordx4 v23, s[8:11], s37 offen sc1 lds
s_add_u32 m0, s39, 55296
s_add_u32 s37, s37, s38
buffer_load_dwordx4 v23, s[8:11], s37 offen sc1 lds
s_add_u32 m0, s39, 56320
s_add_u32 s37, s37, s38
buffer_load_dwordx4 v23, s[8:11], s37 offen sc1 lds
s_waitcnt vmcnt(10)
s_barrier
s_add_u32 s42, s42, 1
s_and_b32 s42, s42, 15
s_add_u32 m0, s39, 0
s_lshl_b32 s37, s42, 14
buffer_load_dwordx4 v23, s[8:11], s37 offen sc1 lds
s_add_u32 m0, s39, 1024
s_add_u32 s37, s37, s38
buffer_load_dwordx4 v23, s[8:11], s37 offen sc1 lds
s_add_u32 m0, s39, 2048
s_add_u32 s37, s37, s38
buffer_load_dwordx4 v23, s[8:11], s37 offen sc1 lds
s_add_u32 m0, s39, 3072
s_add_u32 s37, s37, s38
buffer_load_dwordx4 v23, s[8:11], s37 offen sc1 lds
s_add_u32 m0, s39, 4096
s_add_u32 s37, s37, s38
buffer_load_dwordx4 v23, s[8:11], s37 offen sc1 lds
s_add_u32 m0, s39, 5120
s_add_u32 s37, s37, s38
buffer_load_dwordx4 v23, s[8:11], s37 offen sc1 lds
s_add_u32 m0, s39, 6144
s_add_u32 s37, s37, s38
buffer_load_dwordx4 v23, s[8:11], s37 offen sc1 lds
s_add_u32 m0, s39, 7168
s_add_u32 s37, s37, s38
buffer_load_dwordx4 v23, s[8:11], s37 offen sc1 lds
s_waitcnt vmcnt(16)
s_barrier
s_add_u32 s42, s42, 1
s_and_b32 s42, s42, 15
s_add_u32 m0, s39, 16384
s_lshl_b32 s37, s42, 14
buffer_load_dwordx4 v23, s[8:11], s37 offen sc1 lds
s_add_u32 m0, s39, 17408
s_add_u32 s37, s37, s38
buffer_load_dwordx4 v23, s[8:11], s37 offen sc1 lds
s_add_u32 m0, s39, 18432
s_add_u32 s37, s37, s38
buffer_load_dwordx4 v23, s[8:11], s37 offen sc1 lds
s_add_u32 m0, s39, 19456
s_add_u32 s37, s37, s38
buffer_load_dwordx4 v23, s[8:11], s37 offen sc1 lds
s_add_u32 m0, s39, 20480
s_add_u32 s37, s37, s38
buffer_load_dwordx4 v23, s[8:11], s37 offen sc1 lds
s_add_u32 m0, s39, 21504
s_add_u32 s37, s37, s38
buffer_load_dwordx4 v23, s[8:11], s37 offen sc1 lds
s_add_u32 m0, s39, 22528
s_add_u32 s37, s37, s38
buffer_load_dwordx4 v23, s[8:11], s37 offen sc1 lds
s_add_u32 m0, s39, 23552
s_add_u32 s37, s37, s38
buffer_load_dwordx4 v23, s[8:11], s37 offen sc1 lds
s_waitcnt vmcnt(16)
s_barrier
s_add_u32 s42, s42, 1
s_and_b32 s42, s42, 15
s_add_u32 m0, s39, 32768
s_lshl_b32 s37, s42, 14
buffer_load_dwordx4 v23, s[8:11], s37 offen sc1 lds
s_add_u32 m0, s39, 33792
s_add_u32 s37, s37, s38
buffer_load_dwordx4 v23, s[8:11], s37 offen sc1 lds
s_add_u32 m0, s39, 34816
s_add_u32 s37, s37, s38
buffer_load_dwordx4 v23, s[8:11], s37 offen sc1 lds
s_add_u32 m0, s39, 35840
s_add_u32 s37, s37, s38
buffer_load_dwordx4 v23, s[8:11], s37 offen sc1 lds
s_add_u32 m0, s39, 36864
s_add_u32 s37, s37, s38
buffer_load_dwordx4 v23, s[8:11], s37 offen sc1 lds
s_add_u32 m0, s39, 37888
s_add_u32 s37, s37, s38
buffer_load_dwordx4 v23, s[8:11], s37 offen sc1 lds
s_add_u32 m0, s39, 38912
s_add_u32 s37, s37, s38
buffer_load_dwordx4 v23, s[8:11], s37 offen sc1 lds
s_add_u32 m0, s39, 39936
s_add_u32 s37, s37, s38
buffer_load_dwordx4 v23, s[8:11], s37 offen sc1 lds
s_waitcnt vmcnt(16)
s_barrier
s_add_u32 s42, s42, 1
s_and_b32 s42, s42, 15
s_add_u32 m0, s39, 49152
s_lshl_b32 s37, s42, 14
buffer_load_dwordx4 v23, s[8:11], s37 offen sc1 lds
s_add_u32 m0, s39, 50176
s_add_u32 s37, s37, s38
buffer_load_dwordx4 v23, s[8:11], s37 offen sc1 lds
s_add_u32 m0, s39, 51200
s_add_u32 s37, s37, s38
buffer_load_dwordx4 v23, s[8:11], s37 offen sc1 lds
s_add_u32 m0, s39, 52224
s_add_u32 s37, s37, s38
buffer_load_dwordx4 v23, s[8:11], s37 offen sc1 lds
s_add_u32 m0, s39, 53248
s_add_u32 s37, s37, s38
buffer_load_dwordx4 v23, s[8:11], s37 offen sc1 lds
s_add_u32 m0, s39, 54272
s_add_u32 s37, s37, s38
buffer_load_dwordx4 v23, s[8:11], s37 offen sc1 lds
s_add_u32 m0, s39, 55296
s_add_u32 s37, s37, s38
buffer_load_dwordx4 v23, s[8:11], s37 offen sc1 lds
s_add_u32 m0, s39, 56320
s_add_u32 s37, s37, s38
buffer_load_dwordx4 v23, s[8:11], s37 offen sc1 lds
s_waitcnt vmcnt(16)
s_barrier
s_add_u32 s42, s42, 1
s_and_b32 s42, s42, 15
s_add_u32 m0, s39, 0
s_lshl_b32 s37, s42, 14
buffer_load_dwordx4 v23, s[8:11], s37 offen sc1 lds
s_add_u32 m0, s39, 1024
s_add_u32 s37, s37, s38
buffer_load_dwordx4 v23, s[8:11], s37 offen sc1 lds
s_add_u32 m0, s39, 2048
s_add_u32 s37, s37, s38
buffer_load_dwordx4 v23, s[8:11], s37 offen sc1 lds
s_add_u32 m0, s39, 3072
s_add_u32 s37, s37, s38
buffer_load_dwordx4 v23, s[8:11], s37 offen sc1 lds
s_add_u32 m0, s39, 4096
s_add_u32 s37, s37, s38
buffer_load_dwordx4 v23, s[8:11], s37 offen sc1 lds
s_add_u32 m0, s39, 5120
s_add_u32 s37, s37, s38
buffer_load_dwordx4 v23, s[8:11], s37 offen sc1 lds
s_add_u32 m0, s39, 6144
s_add_u32 s37, s37, s38
buffer_load_dwordx4 v23, s[8:11], s37 offen sc1 lds
s_add_u32 m0, s39, 7168
s_add_u32 s37, s37, s38
buffer_load_dwordx4 v23, s[8:11], s37 offen sc1 lds
s_waitcnt vmcnt(16)
s_barrier
s_add_u32 s42, s42, 1
s_and_b32 s42, s42, 15
s_add_u32 m0, s39, 16384
s_lshl_b32 s37, s42, 14
buffer_load_dwordx4 v23, s[8:11], s37 offen sc1 lds
s_add_u32 m0, s39, 17408
s_add_u32 s37, s37, s38
buffer_load_dwordx4 v23, s[8:11], s37 offen sc1 lds
s_add_u32 m0, s39, 18432
s_add_u32 s37, s37, s38
buffer_load_dwordx4 v23, s[8:11], s37 offen sc1 lds
s_add_u32 m0, s39, 19456
s_add_u32 s37, s37, s38
buffer_load_dwordx4 v23, s[8:11], s37 offen sc1 lds
s_add_u32 m0, s39, 20480
s_add_u32 s37, s37, s38
buffer_load_dwordx4 v23, s[8:11], s37 offen sc1 lds
s_add_u32 m0, s39, 21504
s_add_u32 s37, s37, s38
buffer_load_dwordx4 v23, s[8:11], s37 offen sc1 lds
s_add_u32 m0, s39, 22528
s_add_u32 s37, s37, s38
buffer_load_dwordx4 v23, s[8:11], s37 offen sc1 lds
s_add_u32 m0, s39, 23552
s_add_u32 s37, s37, s38
buffer_load_dwordx4 v23, s[8:11], s37 offen sc1 lds
s_waitcnt vmcnt(16)
s_barrier
s_add_u32 s42, s42, 1
s_and_b32 s42, s42, 15
s_add_u32 m0, s39, 32768
s_lshl_b32 s37, s42, 14
buffer_load_dwordx4 v23, s[8:11], s37 offen sc1 lds
s_add_u32 m0, s39, 33792
s_add_u32 s37, s37, s38
buffer_load_dwordx4 v23, s[8:11], s37 offen sc1 lds
s_add_u32 m0, s39, 34816
s_add_u32 s37, s37, s38
buffer_load_dwordx4 v23, s[8:11], s37 offen sc1 lds
s_add_u32 m0, s39, 35840
s_add_u32 s37, s37, s38
buffer_load_dwordx4 v23, s[8:11], s37 offen sc1 lds
s_add_u32 m0, s39, 36864
s_add_u32 s37, s37, s38
buffer_load_dwordx4 v23, s[8:11], s37 offen sc1 lds
s_add_u32 m0, s39, 37888
s_add_u32 s37, s37, s38
buffer_load_dwordx4 v23, s[8:11], s37 offen sc1 lds
s_add_u32 m0, s39, 38912
s_add_u32 s37, s37, s38
buffer_load_dwordx4 v23, s[8:11], s37 offen sc1 lds
s_add_u32 m0, s39, 39936
s_add_u32 s37, s37, s38
buffer_load_dwordx4 v23, s[8:11], s37 offen sc1 lds
s_waitcnt vmcnt(16)
s_barrier
s_add_u32 s42, s42, 1
s_and_b32 s42, s42, 15
s_add_u32 m0, s39, 49152
s_lshl_b32 s37, s42, 14
buffer_load_dwordx4 v23, s[8:11], s37 offen sc1 lds
s_add_u32 m0, s39, 50176
s_add_u32 s37, s37, s38
buffer_load_dwordx4 v23, s[8:11], s37 offen sc1 lds
s_add_u32 m0, s39, 51200
s_add_u32 s37, s37, s38
buffer_load_dwordx4 v23, s[8:11], s37 offen sc1 lds
s_add_u32 m0, s39, 52224
s_add_u32 s37, s37, s38
buffer_load_dwordx4 v23, s[8:11], s37 offen sc1 lds
s_add_u32 m0, s39, 53248
s_add_u32 s37, s37, s38
buffer_load_dwordx4 v23, s[8:11], s37 offen sc1 lds
s_add_u32 m0, s39, 54272
s_add_u32 s37, s37, s38
buffer_load_dwordx4 v23, s[8:11], s37 offen sc1 lds
s_add_u32 m0, s39, 55296
s_add_u32 s37, s37, s38
buffer_load_dwordx4 v23, s[8:11], s37 offen sc1 lds
s_add_u32 m0, s39, 56320
s_add_u32 s37, s37, s38
buffer_load_dwordx4 v23, s[8:11], s37 offen sc1 lds
s_waitcnt vmcnt(16)
s_barrier
s_add_u32 s42, s42, 1
s_and_b32 s42, s42, 15
s_add_u32 m0, s39, 0
s_lshl_b32 s37, s42, 14
buffer_load_dwordx4 v23, s[8:11], s37 offen sc1 lds
s_add_u32 m0, s39, 1024
s_add_u32 s37, s37, s38
buffer_load_dwordx4 v23, s[8:11], s37 offen sc1 lds
s_add_u32 m0, s39, 2048
s_add_u32 s37, s37, s38
buffer_load_dwordx4 v23, s[8:11], s37 offen sc1 lds
s_add_u32 m0, s39, 3072
s_add_u32 s37, s37, s38
buffer_load_dwordx4 v23, s[8:11], s37 offen sc1 lds
s_add_u32 m0, s39, 4096
s_add_u32 s37, s37, s38
buffer_load_dwordx4 v23, s[8:11], s37 offen sc1 lds
s_add_u32 m0, s39, 5120
s_add_u32 s37, s37, s38
buffer_load_dwordx4 v23, s[8:11], s37 offen sc1 lds
s_add_u32 m0, s39, 6144
s_add_u32 s37, s37, s38
buffer_load_dwordx4 v23, s[8:11], s37 offen sc1 lds
s_add_u32 m0, s39, 7168
s_add_u32 s37, s37, s38
buffer_load_dwordx4 v23, s[8:11], s37 offen sc1 lds
s_waitcnt vmcnt(16)
s_barrier
s_add_u32 s42, s42, 1
s_and_b32 s42, s42, 15
s_add_u32 m0, s39, 16384
s_lshl_b32 s37, s42, 14
buffer_load_dwordx4 v23, s[8:11], s37 offen sc1 lds
s_add_u32 m0, s39, 17408
s_add_u32 s37, s37, s38
buffer_load_dwordx4 v23, s[8:11], s37 offen sc1 lds
s_add_u32 m0, s39, 18432
s_add_u32 s37, s37, s38
buffer_load_dwordx4 v23, s[8:11], s37 offen sc1 lds
s_add_u32 m0, s39, 19456
s_add_u32 s37, s37, s38
buffer_load_dwordx4 v23, s[8:11], s37 offen sc1 lds
s_add_u32 m0, s39, 20480
s_add_u32 s37, s37, s38
buffer_load_dwordx4 v23, s[8:11], s37 offen sc1 lds
s_add_u32 m0, s39, 21504
s_add_u32 s37, s37, s38
buffer_load_dwordx4 v23, s[8:11], s37 offen sc1 lds
s_add_u32 m0, s39, 22528
s_add_u32 s37, s37, s38
buffer_load_dwordx4 v23, s[8:11], s37 offen sc1 lds
s_add_u32 m0, s39, 23552
s_add_u32 s37, s37, s38
buffer_load_dwordx4 v23, s[8:11], s37 offen sc1 lds
s_waitcnt vmcnt(16)
s_barrier
s_add_u32 s42, s42, 1
s_and_b32 s42, s42, 15
s_add_u32 m0, s39, 32768
s_lshl_b32 s37, s42, 14
buffer_load_dwordx4 v23, s[8:11], s37 offen sc1 lds
s_add_u32 m0, s39, 33792
s_add_u32 s37, s37, s38
buffer_load_dwordx4 v23, s[8:11], s37 offen sc1 lds
s_add_u32 m0, s39, 34816
s_add_u32 s37, s37, s38
buffer_load_dwordx4 v23, s[8:11], s37 offen sc1 lds
s_add_u32 m0, s39, 35840
s_add_u32 s37, s37, s38
buffer_load_dwordx4 v23, s[8:11], s37 offen sc1 lds
s_add_u32 m0, s39, 36864
s_add_u32 s37, s37, s38
buffer_load_dwordx4 v23, s[8:11], s37 offen sc1 lds
s_add_u32 m0, s39, 37888
s_add_u32 s37, s37, s38
buffer_load_dwordx4 v23, s[8:11], s37 offen sc1 lds
s_add_u32 m0, s39, 38912
s_add_u32 s37, s37, s38
buffer_load_dwordx4 v23, s[8:11], s37 offen sc1 lds
s_add_u32 m0, s39, 39936
s_add_u32 s37, s37, s38
buffer_load_dwordx4 v23, s[8:11], s37 offen sc1 lds
s_waitcnt vmcnt(16)
s_barrier
s_add_u32 s42, s42, 1
s_and_b32 s42, s42, 15
s_add_u32 m0, s39, 49152
s_lshl_b32 s37, s42, 14
buffer_load_dwordx4 v23, s[8:11], s37 offen sc1 lds
s_add_u32 m0, s39, 50176
s_add_u32 s37, s37, s38
buffer_load_dwordx4 v23, s[8:11], s37 offen sc1 lds
s_add_u32 m0, s39, 51200
s_add_u32 s37, s37, s38
buffer_load_dwordx4 v23, s[8:11], s37 offen sc1 lds
s_add_u32 m0, s39, 52224
s_add_u32 s37, s37, s38
buffer_load_dwordx4 v23, s[8:11], s37 offen sc1 lds
s_add_u32 m0, s39, 53248
s_add_u32 s37, s37, s38
buffer_load_dwordx4 v23, s[8:11], s37 offen sc1 lds
s_add_u32 m0, s39, 54272
s_add_u32 s37, s37, s38
buffer_load_dwordx4 v23, s[8:11], s37 offen sc1 lds
s_add_u32 m0, s39, 55296
s_add_u32 s37, s37, s38
buffer_load_dwordx4 v23, s[8:11], s37 offen sc1 lds
s_add_u32 m0, s39, 56320
s_add_u32 s37, s37, s38
buffer_load_dwordx4 v23, s[8:11], s37 offen sc1 lds
s_lshl_b32 s43, s35, 8
s_cmp_eq_u32 s51, 1
s_cselect_b32 s8, s4, s6
s_cselect_b32 s9, s5, s7
s_sub_u32 s10, 7340032, s43
s_lshl_b32 s44, s34, 18
s_add_u32 s44, s44, 4194304
s_movk_i32 s38, 28672
s_cmp_eq_u32 s51, 0
s_cselect_b32 s8, s32, s8
s_cselect_b32 s9, s33, s9
s_cselect_b32 s10, 262144, s10
s_cselect_b32 s43, s44, s43
s_cselect_b32 s38, 1024, s38
s_cselect_b32 s45, 0, -1
s_add_u32 s8, s8, s43
s_addc_u32 s9, s9, 0
s_mov_b32 s11, 0x20000
s_lshl_b32 s40, s38, 4
s_add_u32 s42, s35, 15
s_lshl_b32 s39, s51, 14
v_lshrrev_b32 v19, 4, v1
v_lshlrev_b32 v20, 5, v19
v_mul_u32_u24 v19, 6912, v19
v_and_b32 v19, s45, v19
v_and_b32 v20, s45, v20
v_lshlrev_b32 v21, 4, v1
v_xor_b32 v21, v21, v20
v_add_u32 v22, v21, v19
s_and_b32 s45, s45, 128
v_xor_b32 v23, s45, v22
s_waitcnt vmcnt(16)
s_barrier
s_add_u32 s42, s42, 1
s_and_b32 s42, s42, 15
s_add_u32 m0, s39, 98304
s_mul_i32 s37, s42, s40
buffer_load_dwordx4 v22, s[8:11], s37 offen sc1 lds
s_add_u32 m0, s39, 99328
s_add_u32 s37, s37, s38
buffer_load_dwordx4 v23, s[8:11], s37 offen sc1 lds
s_add_u32 m0, s39, 100352
s_add_u32 s37, s37, s38
buffer_load_dwordx4 v22, s[8:11], s37 offen sc1 lds
s_add_u32 m0, s39, 101376
s_add_u32 s37, s37, s38
buffer_load_dwordx4 v23, s[8:11], s37 offen sc1 lds
s_add_u32 m0, s39, 102400
s_add_u32 s37, s37, s38
buffer_load_dwordx4 v22, s[8:11], s37 offen sc1 lds
s_add_u32 m0, s39, 103424
s_add_u32 s37, s37, s38
buffer_load_dwordx4 v23, s[8:11], s37 offen sc1 lds
s_add_u32 m0, s39, 104448
s_add_u32 s37, s37, s38
buffer_load_dwordx4 v22, s[8:11], s37 offen sc1 lds
s_add_u32 m0, s39, 105472
s_add_u32 s37, s37, s38
buffer_load_dwordx4 v23, s[8:11], s37 offen sc1 lds
s_add_u32 m0, s39, 106496
s_add_u32 s37, s37, s38
buffer_load_dwordx4 v22, s[8:11], s37 offen sc1 lds
s_add_u32 m0, s39, 107520
s_add_u32 s37, s37, s38
buffer_load_dwordx4 v23, s[8:11], s37 offen sc1 lds
s_add_u32 m0, s39, 108544
s_add_u32 s37, s37, s38
buffer_load_dwordx4 v22, s[8:11], s37 offen sc1 lds
s_add_u32 m0, s39, 109568
s_add_u32 s37, s37, s38
buffer_load_dwordx4 v23, s[8:11], s37 offen sc1 lds
s_add_u32 m0, s39, 110592
s_add_u32 s37, s37, s38
buffer_load_dwordx4 v22, s[8:11], s37 offen sc1 lds
s_add_u32 m0, s39, 111616
s_add_u32 s37, s37, s38
buffer_load_dwordx4 v23, s[8:11], s37 offen sc1 lds
s_add_u32 m0, s39, 112640
s_add_u32 s37, s37, s38
buffer_load_dwordx4 v22, s[8:11], s37 offen sc1 lds
s_add_u32 m0, s39, 113664
s_add_u32 s37, s37, s38
buffer_load_dwordx4 v23, s[8:11], s37 offen sc1 lds
s_waitcnt vmcnt(24)
s_barrier
s_waitcnt vmcnt(16)
s_barrier
s_add_u32 s42, s42, 1
s_and_b32 s42, s42, 15
s_add_u32 m0, s39, 0
s_mul_i32 s37, s42, s40
buffer_load_dwordx4 v22, s[8:11], s37 offen sc1 lds
s_add_u32 m0, s39, 1024
s_add_u32 s37, s37, s38
buffer_load_dwordx4 v23, s[8:11], s37 offen sc1 lds
s_add_u32 m0, s39, 2048
s_add_u32 s37, s37, s38
buffer_load_dwordx4 v22, s[8:11], s37 offen sc1 lds
s_add_u32 m0, s39, 3072
s_add_u32 s37, s37, s38
buffer_load_dwordx4 v23, s[8:11], s37 offen sc1 lds
s_add_u32 m0, s39, 4096
s_add_u32 s37, s37, s38
buffer_load_dwordx4 v22, s[8:11], s37 offen sc1 lds
s_add_u32 m0, s39, 5120
s_add_u32 s37, s37, s38
buffer_load_dwordx4 v23, s[8:11], s37 offen sc1 lds
s_add_u32 m0, s39, 6144
s_add_u32 s37, s37, s38
buffer_load_dwordx4 v22, s[8:11], s37 offen sc1 lds
s_add_u32 m0, s39, 7168
s_add_u32 s37, s37, s38
buffer_load_dwordx4 v23, s[8:11], s37 offen sc1 lds
s_add_u32 m0, s39, 8192
s_add_u32 s37, s37, s38
buffer_load_dwordx4 v22, s[8:11], s37 offen sc1 lds
s_add_u32 m0, s39, 9216
s_add_u32 s37, s37, s38
buffer_load_dwordx4 v23, s[8:11], s37 offen sc1 lds
s_add_u32 m0, s39, 10240
s_add_u32 s37, s37, s38
buffer_load_dwordx4 v22, s[8:11], s37 offen sc1 lds
s_add_u32 m0, s39, 11264
s_add_u32 s37, s37, s38
buffer_load_dwordx4 v23, s[8:11], s37 offen sc1 lds
s_add_u32 m0, s39, 12288
s_add_u32 s37, s37, s38
buffer_load_dwordx4 v22, s[8:11], s37 offen sc1 lds
s_add_u32 m0, s39, 13312
s_add_u32 s37, s37, s38
buffer_load_dwordx4 v23, s[8:11], s37 offen sc1 lds
s_add_u32 m0, s39, 14336
s_add_u32 s37, s37, s38
buffer_load_dwordx4 v22, s[8:11], s37 offen sc1 lds
s_add_u32 m0, s39, 15360
s_add_u32 s37, s37, s38
buffer_load_dwordx4 v23, s[8:11], s37 offen sc1 lds
s_barrier
s_waitcnt vmcnt(16)
s_barrier
s_add_u32 s42, s42, 1
s_and_b32 s42, s42, 15
s_add_u32 m0, s39, 49152
s_mul_i32 s37, s42, s40
buffer_load_dwordx4 v22, s[8:11], s37 offen sc1 lds
s_add_u32 m0, s39, 50176
s_add_u32 s37, s37, s38
buffer_load_dwordx4 v23, s[8:11], s37 offen sc1 lds
s_add_u32 m0, s39, 51200
s_add_u32 s37, s37, s38
buffer_load_dwordx4 v22, s[8:11], s37 offen sc1 lds
s_add_u32 m0, s39, 52224
s_add_u32 s37, s37, s38
buffer_load_dwordx4 v23, s[8:11], s37 offen sc1 lds
s_add_u32 m0, s39, 53248
s_add_u32 s37, s37, s38
buffer_load_dwordx4 v22, s[8:11], s37 offen sc1 lds
s_add_u32 m0, s39, 54272
s_add_u32 s37, s37, s38
buffer_load_dwordx4 v23, s[8:11], s37 offen sc1 lds
s_add_u32 m0, s39, 55296
s_add_u32 s37, s37, s38
buffer_load_dwordx4 v22, s[8:11], s37 offen sc1 lds
s_add_u32 m0, s39, 56320
s_add_u32 s37, s37, s38
buffer_load_dwordx4 v23, s[8:11], s37 offen sc1 lds
s_add_u32 m0, s39, 57344
s_add_u32 s37, s37, s38
buffer_load_dwordx4 v22, s[8:11], s37 offen sc1 lds
s_add_u32 m0, s39, 58368
s_add_u32 s37, s37, s38
buffer_load_dwordx4 v23, s[8:11], s37 offen sc1 lds
s_add_u32 m0, s39, 59392
s_add_u32 s37, s37, s38
buffer_load_dwordx4 v22, s[8:11], s37 offen sc1 lds
s_add_u32 m0, s39, 60416
s_add_u32 s37, s37, s38
buffer_load_dwordx4 v23, s[8:11], s37 offen sc1 lds
s_add_u32 m0, s39, 61440
s_add_u32 s37, s37, s38
buffer_load_dwordx4 v22, s[8:11], s37 offen sc1 lds
s_add_u32 m0, s39, 62464
s_add_u32 s37, s37, s38
buffer_load_dwordx4 v23, s[8:11], s37 offen sc1 lds
s_add_u32 m0, s39, 63488
s_add_u32 s37, s37, s38
buffer_load_dwordx4 v22, s[8:11], s37 offen sc1 lds
s_add_u32 m0, s39, 64512
s_add_u32 s37, s37, s38
buffer_load_dwordx4 v23, s[8:11], s37 offen sc1 lds
s_branch LP3_37
Lp_40:
s_add_u32 s42, s35, 15
s_waitcnt vmcnt(0)
s_barrier
ds_write_b128 v27, v[68:71] offset:0
ds_write_b128 v27, v[116:119] offset:512
s_add_u32 s42, s42, 1
s_and_b32 s42, s42, 15
s_add_u32 m0, s39, 49152
s_lshl_b32 s37, s42, 17
buffer_load_dwordx4 v23, s[8:11], s37 offen sc1 lds
s_add_u32 m0, s39, 50176
s_add_u32 s37, s37, s38
buffer_load_dwordx4 v23, s[8:11], s37 offen sc1 lds
s_add_u32 m0, s39, 51200
s_add_u32 s37, s37, s38
buffer_load_dwordx4 v23, s[8:11], s37 offen sc1 lds
s_add_u32 m0, s39, 52224
s_add_u32 s37, s37, s38
buffer_load_dwordx4 v23, s[8:11], s37 offen sc1 lds
s_add_u32 m0, s39, 53248
s_add_u32 s37, s37, s38
buffer_load_dwordx4 v23, s[8:11], s37 offen sc1 lds
s_add_u32 m0, s39, 54272
s_add_u32 s37, s37, s38
buffer_load_dwordx4 v23, s[8:11], s37 offen sc1 lds
s_add_u32 m0, s39, 55296
s_add_u32 s37, s37, s38
buffer_load_dwordx4 v23, s[8:11], s37 offen sc1 lds
s_add_u32 m0, s39, 56320
s_add_u32 s37, s37, s38
buffer_load_dwordx4 v23, s[8:11], s37 offen sc1 lds
s_add_u32 s42, s42, 1
s_and_b32 s42, s42, 15
s_add_u32 m0, s39, 57344
s_lshl_b32 s37, s42, 17
buffer_load_dwordx4 v23, s[8:11], s37 offen sc1 lds
s_add_u32 m0, s39, 58368
s_add_u32 s37, s37, s38
buffer_load_dwordx4 v23, s[8:11], s37 offen sc1 lds
s_add_u32 m0, s39, 59392
s_add_u32 s37, s37, s38
buffer_load_dwordx4 v23, s[8:11], s37 offen sc1 lds
s_add_u32 m0, s39, 60416
s_add_u32 s37, s37, s38
buffer_load_dwordx4 v23, s[8:11], s37 offen sc1 lds
s_add_u32 m0, s39, 61440
s_add_u32 s37, s37, s38
buffer_load_dwordx4 v23, s[8:11], s37 offen sc1 lds
s_add_u32 m0, s39, 62464
s_add_u32 s37, s37, s38
buffer_load_dwordx4 v23, s[8:11], s37 offen sc1 lds
s_add_u32 m0, s39, 63488
s_add_u32 s37, s37, s38
buffer_load_dwordx4 v23, s[8:11], s37 offen sc1 lds
s_add_u32 m0, s39, 64512
s_add_u32 s37, s37, s38
buffer_load_dwordx4 v23, s[8:11], s37 offen sc1 lds
s_add_u32 s42, s42, 1
s_and_b32 s42, s42, 15
s_add_u32 m0, s39, 65536
s_lshl_b32 s37, s42, 17
buffer_load_dwordx4 v23, s[8:11], s37 offen sc1 lds
s_add_u32 m0, s39, 66560
s_add_u32 s37, s37, s38
buffer_load_dwordx4 v23, s[8:11], s37 offen sc1 lds
s_add_u32 m0, s39, 67584
s_add_u32 s37, s37, s38
buffer_load_dwordx4 v23, s[8:11], s37 offen sc1 lds
s_add_u32 m0, s39, 68608
s_add_u32 s37, s37, s38
buffer_load_dwordx4 v23, s[8:11], s37 offen sc1 lds
s_add_u32 m0, s39, 69632
s_add_u32 s37, s37, s38
buffer_load_dwordx4 v23, s[8:11], s37 offen sc1 lds
s_add_u32 m0, s39, 70656
s_add_u32 s37, s37, s38
buffer_load_dwordx4 v23, s[8:11], s37 offen sc1 lds
s_add_u32 m0, s39, 71680
s_add_u32 s37, s37, s38
buffer_load_dwordx4 v23, s[8:11], s37 offen sc1 lds
s_add_u32 m0, s39, 72704
s_add_u32 s37, s37, s38
buffer_load_dwordx4 v23, s[8:11], s37 offen sc1 lds
s_add_u32 s42, s42, 1
s_and_b32 s42, s42, 15
s_add_u32 m0, s39, 73728
s_lshl_b32 s37, s42, 17
buffer_load_dwordx4 v23, s[8:11], s37 offen sc1 lds
s_add_u32 m0, s39, 74752
s_add_u32 s37, s37, s38
buffer_load_dwordx4 v23, s[8:11], s37 offen sc1 lds
s_add_u32 m0, s39, 75776
s_add_u32 s37, s37, s38
buffer_load_dwordx4 v23, s[8:11], s37 offen sc1 lds
s_add_u32 m0, s39, 76800
s_add_u32 s37, s37, s38
buffer_load_dwordx4 v23, s[8:11], s37 offen sc1 lds
s_add_u32 m0, s39, 77824
s_add_u32 s37, s37, s38
buffer_load_dwordx4 v23, s[8:11], s37 offen sc1 lds
s_add_u32 m0, s39, 78848
s_add_u32 s37, s37, s38
buffer_load_dwordx4 v23, s[8:11], s37 offen sc1 lds
s_add_u32 m0, s39, 79872
s_add_u32 s37, s37, s38
buffer_load_dwordx4 v23, s[8:11], s37 offen sc1 lds
s_add_u32 m0, s39, 80896
s_add_u32 s37, s37, s38
buffer_load_dwordx4 v23, s[8:11], s37 offen sc1 lds
s_waitcnt vmcnt(24)
s_waitcnt lgkmcnt(0)
s_barrier
s_add_u32 m0, s54, 16384
s_add_u32 s43, s30, 0
buffer_load_dwordx4 v21, s[12:15], s43 offen sc1 lds
s_add_u32 m0, s54, 17408
s_add_u32 s43, s30, 1024
buffer_load_dwordx4 v21, s[12:15], s43 offen sc1 lds
s_add_u32 m0, s54, 32768
s_add_u32 s43, s31, 0
buffer_load_dwordx4 v21, s[12:15], s43 offen sc1 lds
s_add_u32 m0, s54, 33792
s_add_u32 s43, s31, 1024
buffer_load_dwordx4 v21, s[12:15], s43 offen sc1 lds
s_add_u32 s42, s42, 1
s_and_b32 s42, s42, 15
s_add_u32 m0, s39, 81920
s_lshl_b32 s37, s42, 17
buffer_load_dwordx4 v23, s[8:11], s37 offen sc1 lds
s_add_u32 m0, s39, 82944
s_add_u32 s37, s37, s38
buffer_load_dwordx4 v23, s[8:11], s37 offen sc1 lds
s_add_u32 m0, s39, 83968
s_add_u32 s37, s37, s38
buffer_load_dwordx4 v23, s[8:11], s37 offen sc1 lds
s_add_u32 m0, s39, 84992
s_add_u32 s37, s37, s38
buffer_load_dwordx4 v23, s[8:11], s37 offen sc1 lds
s_add_u32 m0, s39, 86016
s_add_u32 s37, s37, s38
buffer_load_dwordx4 v23, s[8:11], s37 offen sc1 lds
s_add_u32 m0, s39, 87040
s_add_u32 s37, s37, s38
buffer_load_dwordx4 v23, s[8:11], s37 offen sc1 lds
s_add_u32 m0, s39, 88064
s_add_u32 s37, s37, s38
buffer_load_dwordx4 v23, s[8:11], s37 offen sc1 lds
s_add_u32 m0, s39, 89088
s_add_u32 s37, s37, s38
buffer_load_dwordx4 v23, s[8:11], s37 offen sc1 lds
s_waitcnt vmcnt(10)
s_barrier
s_add_u32 s42, s42, 1
s_and_b32 s42, s42, 15
s_add_u32 m0, s39, 90112
s_lshl_b32 s37, s42, 17
buffer_load_dwordx4 v23, s[8:11], s37 offen sc1 lds
s_add_u32 m0, s39, 91136
s_add_u32 s37, s37, s38
buffer_load_dwordx4 v23, s[8:11], s37 offen sc1 lds
s_add_u32 m0, s39, 92160
s_add_u32 s37, s37, s38
buffer_load_dwordx4 v23, s[8:11], s37 offen sc1 lds
s_add_u32 m0, s39, 93184
s_add_u32 s37, s37, s38
buffer_load_dwordx4 v23, s[8:11], s37 offen sc1 lds
s_add_u32 m0, s39, 94208
s_add_u32 s37, s37, s38
buffer_load_dwordx4 v23, s[8:11], s37 offen sc1 lds
s_add_u32 m0, s39, 95232
s_add_u32 s37, s37, s38
buffer_load_dwordx4 v23, s[8:11], s37 offen sc1 lds
s_add_u32 m0, s39, 96256
s_add_u32 s37, s37, s38
buffer_load_dwordx4 v23, s[8:11], s37 offen sc1 lds
s_add_u32 m0, s39, 97280
s_add_u32 s37, s37, s38
buffer_load_dwordx4 v23, s[8:11], s37 offen sc1 lds
s_waitcnt vmcnt(16)
s_barrier
s_add_u32 s42, s42, 1
s_and_b32 s42, s42, 15
s_add_u32 m0, s39, 98304
s_lshl_b32 s37, s42, 17
buffer_load_dwordx4 v23, s[8:11], s37 offen sc1 lds
s_add_u32 m0, s39, 99328
s_add_u32 s37, s37, s38
buffer_load_dwordx4 v23, s[8:11], s37 offen sc1 lds
s_add_u32 m0, s39, 100352
s_add_u32 s37, s37, s38
buffer_load_dwordx4 v23, s[8:11], s37 offen sc1 lds
s_add_u32 m0, s39, 101376
s_add_u32 s37, s37, s38
buffer_load_dwordx4 v23, s[8:11], s37 offen sc1 lds
s_add_u32 m0, s39, 102400
s_add_u32 s37, s37, s38
buffer_load_dwordx4 v23, s[8:11], s37 offen sc1 lds
s_add_u32 m0, s39, 103424
s_add_u32 s37, s37, s38
buffer_load_dwordx4 v23, s[8:11], s37 offen sc1 lds
s_add_u32 m0, s39, 104448
s_add_u32 s37, s37, s38
buffer_load_dwordx4 v23, s[8:11], s37 offen sc1 lds
s_add_u32 m0, s39, 105472
s_add_u32 s37, s37, s38
buffer_load_dwordx4 v23, s[8:11], s37 offen sc1 lds
s_waitcnt vmcnt(28)
s_barrier
s_add_u32 s42, s42, 1
s_and_b32 s42, s42, 15
s_add_u32 m0, s39, 106496
s_lshl_b32 s37, s42, 17
buffer_load_dwordx4 v23, s[8:11], s37 offen sc1 lds
s_add_u32 m0, s39, 107520
s_add_u32 s37, s37, s38
buffer_load_dwordx4 v23, s[8:11], s37 offen sc1 lds
s_add_u32 m0, s39, 108544
s_add_u32 s37, s37, s38
buffer_load_dwordx4 v23, s[8:11], s37 offen sc1 lds
s_add_u32 m0, s39, 109568
s_add_u32 s37, s37, s38
buffer_load_dwordx4 v23, s[8:11], s37 offen sc1 lds
s_add_u32 m0, s39, 110592
s_add_u32 s37, s37, s38
buffer_load_dwordx4 v23, s[8:11], s37 offen sc1 lds
s_add_u32 m0, s39, 111616
s_add_u32 s37, s37, s38
buffer_load_dwordx4 v23, s[8:11], s37 offen sc1 lds
s_add_u32 m0, s39, 112640
s_add_u32 s37, s37, s38
buffer_load_dwordx4 v23, s[8:11], s37 offen sc1 lds
s_add_u32 m0, s39, 113664
s_add_u32 s37, s37, s38
buffer_load_dwordx4 v23, s[8:11], s37 offen sc1 lds
s_waitcnt vmcnt(24)
s_barrier
s_add_u32 s42, s42, 1
s_and_b32 s42, s42, 15
s_add_u32 m0, s39, 114688
s_lshl_b32 s37, s42, 17
buffer_load_dwordx4 v23, s[8:11], s37 offen sc1 lds
s_add_u32 m0, s39, 115712
s_add_u32 s37, s37, s38
buffer_load_dwordx4 v23, s[8:11], s37 offen sc1 lds
s_add_u32 m0, s39, 116736
s_add_u32 s37, s37, s38
buffer_load_dwordx4 v23, s[8:11], s37 offen sc1 lds
s_add_u32 m0, s39, 117760
s_add_u32 s37, s37, s38
buffer_load_dwordx4 v23, s[8:11], s37 offen sc1 lds
s_add_u32 m0, s39, 118784
s_add_u32 s37, s37, s38
buffer_load_dwordx4 v23, s[8:11], s37 offen sc1 lds
s_add_u32 m0, s39, 119808
s_add_u32 s37, s37, s38
buffer_load_dwordx4 v23, s[8:11], s37 offen sc1 lds
s_add_u32 m0, s39, 120832
s_add_u32 s37, s37, s38
buffer_load_dwordx4 v23, s[8:11], s37 offen sc1 lds
s_add_u32 m0, s39, 121856
s_add_u32 s37, s37, s38
buffer_load_dwordx4 v23, s[8:11], s37 offen sc1 lds
s_waitcnt vmcnt(24)
s_barrier
s_add_u32 s42, s42, 1
s_and_b32 s42, s42, 15
s_add_u32 m0, s39, 122880
s_lshl_b32 s37, s42, 17
buffer_load_dwordx4 v23, s[8:11], s37 offen sc1 lds
s_add_u32 m0, s39, 123904
s_add_u32 s37, s37, s38
buffer_load_dwordx4 v23, s[8:11], s37 offen sc1 lds
s_add_u32 m0, s39, 124928
s_add_u32 s37, s37, s38
buffer_load_dwordx4 v23, s[8:11], s37 offen sc1 lds
s_add_u32 m0, s39, 125952
s_add_u32 s37, s37, s38
buffer_load_dwordx4 v23, s[8:11], s37 offen sc1 lds
s_add_u32 m0, s39, 126976
s_add_u32 s37, s37, s38
buffer_load_dwordx4 v23, s[8:11], s37 offen sc1 lds
s_add_u32 m0, s39, 128000
s_add_u32 s37, s37, s38
buffer_load_dwordx4 v23, s[8:11], s37 offen sc1 lds
s_add_u32 m0, s39, 129024
s_add_u32 s37, s37, s38
buffer_load_dwordx4 v23, s[8:11], s37 offen sc1 lds
s_add_u32 m0, s39, 130048
s_add_u32 s37, s37, s38
buffer_load_dwordx4 v23, s[8:11], s37 offen sc1 lds
s_waitcnt vmcnt(24)
s_barrier
s_add_u32 s42, s42, 1
s_and_b32 s42, s42, 15
s_add_u32 m0, s39, 49152
s_lshl_b32 s37, s42, 17
buffer_load_dwordx4 v23, s[8:11], s37 offen sc1 lds
s_add_u32 m0, s39, 50176
s_add_u32 s37, s37, s38
buffer_load_dwordx4 v23, s[8:11], s37 offen sc1 lds
s_add_u32 m0, s39, 51200
s_add_u32 s37, s37, s38
buffer_load_dwordx4 v23, s[8:11], s37 offen sc1 lds
s_add_u32 m0, s39, 52224
s_add_u32 s37, s37, s38
buffer_load_dwordx4 v23, s[8:11], s37 offen sc1 lds
s_add_u32 m0, s39, 53248
s_add_u32 s37, s37, s38
buffer_load_dwordx4 v23, s[8:11], s37 offen sc1 lds
s_add_u32 m0, s39, 54272
s_add_u32 s37, s37, s38
buffer_load_dwordx4 v23, s[8:11], s37 offen sc1 lds
s_add_u32 m0, s39, 55296
s_add_u32 s37, s37, s38
buffer_load_dwordx4 v23, s[8:11], s37 offen sc1 lds
s_add_u32 m0, s39, 56320
s_add_u32 s37, s37, s38
buffer_load_dwordx4 v23, s[8:11], s37 offen sc1 lds
s_waitcnt vmcnt(24)
s_barrier
s_add_u32 s42, s42, 1
s_and_b32 s42, s42, 15
s_add_u32 m0, s39, 57344
s_lshl_b32 s37, s42, 17
buffer_load_dwordx4 v23, s[8:11], s37 offen sc1 lds
s_add_u32 m0, s39, 58368
s_add_u32 s37, s37, s38
buffer_load_dwordx4 v23, s[8:11], s37 offen sc1 lds
s_add_u32 m0, s39, 59392
s_add_u32 s37, s37, s38
buffer_load_dwordx4 v23, s[8:11], s37 offen sc1 lds
s_add_u32 m0, s39, 60416
s_add_u32 s37, s37, s38
buffer_load_dwordx4 v23, s[8:11], s37 offen sc1 lds
s_add_u32 m0, s39, 61440
s_add_u32 s37, s37, s38
buffer_load_dwordx4 v23, s[8:11], s37 offen sc1 lds
s_add_u32 m0, s39, 62464
s_add_u32 s37, s37, s38
buffer_load_dwordx4 v23, s[8:11], s37 offen sc1 lds
s_add_u32 m0, s39, 63488
s_add_u32 s37, s37, s38
buffer_load_dwordx4 v23, s[8:11], s37 offen sc1 lds
s_add_u32 m0, s39, 64512
s_add_u32 s37, s37, s38
buffer_load_dwordx4 v23, s[8:11], s37 offen sc1 lds
s_waitcnt vmcnt(24)
s_barrier
s_add_u32 s42, s42, 1
s_and_b32 s42, s42, 15
s_add_u32 m0, s39, 65536
s_lshl_b32 s37, s42, 17
buffer_load_dwordx4 v23, s[8:11], s37 offen sc1 lds
s_add_u32 m0, s39, 66560
s_add_u32 s37, s37, s38
buffer_load_dwordx4 v23, s[8:11], s37 offen sc1 lds
s_add_u32 m0, s39, 67584
s_add_u32 s37, s37, s38
buffer_load_dwordx4 v23, s[8:11], s37 offen sc1 lds
s_add_u32 m0, s39, 68608
s_add_u32 s37, s37, s38
buffer_load_dwordx4 v23, s[8:11], s37 offen sc1 lds
s_add_u32 m0, s39, 69632
s_add_u32 s37, s37, s38
buffer_load_dwordx4 v23, s[8:11], s37 offen sc1 lds
s_add_u32 m0, s39, 70656
s_add_u32 s37, s37, s38
buffer_load_dwordx4 v23, s[8:11], s37 offen sc1 lds
s_add_u32 m0, s39, 71680
s_add_u32 s37, s37, s38
buffer_load_dwordx4 v23, s[8:11], s37 offen sc1 lds
s_add_u32 m0, s39, 72704
s_add_u32 s37, s37, s38
buffer_load_dwordx4 v23, s[8:11], s37 offen sc1 lds
s_waitcnt vmcnt(24)
s_barrier
s_add_u32 s42, s42, 1
s_and_b32 s42, s42, 15
s_add_u32 m0, s39, 73728
s_lshl_b32 s37, s42, 17
buffer_load_dwordx4 v23, s[8:11], s37 offen sc1 lds
s_add_u32 m0, s39, 74752
s_add_u32 s37, s37, s38
buffer_load_dwordx4 v23, s[8:11], s37 offen sc1 lds
s_add_u32 m0, s39, 75776
s_add_u32 s37, s37, s38
buffer_load_dwordx4 v23, s[8:11], s37 offen sc1 lds
s_add_u32 m0, s39, 76800
s_add_u32 s37, s37, s38
buffer_load_dwordx4 v23, s[8:11], s37 offen sc1 lds
s_add_u32 m0, s39, 77824
s_add_u32 s37, s37, s38
buffer_load_dwordx4 v23, s[8:11], s37 offen sc1 lds
s_add_u32 m0, s39, 78848
s_add_u32 s37, s37, s38
buffer_load_dwordx4 v23, s[8:11], s37 offen sc1 lds
s_add_u32 m0, s39, 79872
s_add_u32 s37, s37, s38
buffer_load_dwordx4 v23, s[8:11], s37 offen sc1 lds
s_add_u32 m0, s39, 80896
s_add_u32 s37, s37, s38
buffer_load_dwordx4 v23, s[8:11], s37 offen sc1 lds
s_waitcnt vmcnt(24)
s_barrier
s_add_u32 s42, s42, 1
s_and_b32 s42, s42, 15
s_add_u32 m0, s39, 81920
s_lshl_b32 s37, s42, 17
buffer_load_dwordx4 v23, s[8:11], s37 offen sc1 lds
s_add_u32 m0, s39, 82944
s_add_u32 s37, s37, s38
buffer_load_dwordx4 v23, s[8:11], s37 offen sc1 lds
s_add_u32 m0, s39, 83968
s_add_u32 s37, s37, s38
buffer_load_dwordx4 v23, s[8:11], s37 offen sc1 lds
s_add_u32 m0, s39, 84992
s_add_u32 s37, s37, s38
buffer_load_dwordx4 v23, s[8:11], s37 offen sc1 lds
s_add_u32 m0, s39, 86016
s_add_u32 s37, s37, s38
buffer_load_dwordx4 v23, s[8:11], s37 offen sc1 lds
s_add_u32 m0, s39, 87040
s_add_u32 s37, s37, s38
buffer_load_dwordx4 v23, s[8:11], s37 offen sc1 lds
s_add_u32 m0, s39, 88064
s_add_u32 s37, s37, s38
buffer_load_dwordx4 v23, s[8:11], s37 offen sc1 lds
s_add_u32 m0, s39, 89088
s_add_u32 s37, s37, s38
buffer_load_dwordx4 v23, s[8:11], s37 offen sc1 lds
s_waitcnt vmcnt(24)
s_barrier
s_add_u32 s42, s42, 1
s_and_b32 s42, s42, 15
s_add_u32 m0, s39, 90112
s_lshl_b32 s37, s42, 17
buffer_load_dwordx4 v23, s[8:11], s37 offen sc1 lds
s_add_u32 m0, s39, 91136
s_add_u32 s37, s37, s38
buffer_load_dwordx4 v23, s[8:11], s37 offen sc1 lds
s_add_u32 m0, s39, 92160
s_add_u32 s37, s37, s38
buffer_load_dwordx4 v23, s[8:11], s37 offen sc1 lds
s_add_u32 m0, s39, 93184
s_add_u32 s37, s37, s38
buffer_load_dwordx4 v23, s[8:11], s37 offen sc1 lds
s_add_u32 m0, s39, 94208
s_add_u32 s37, s37, s38
buffer_load_dwordx4 v23, s[8:11], s37 offen sc1 lds
s_add_u32 m0, s39, 95232
s_add_u32 s37, s37, s38
buffer_load_dwordx4 v23, s[8:11], s37 offen sc1 lds
s_add_u32 m0, s39, 96256
s_add_u32 s37, s37, s38
buffer_load_dwordx4 v23, s[8:11], s37 offen sc1 lds
s_add_u32 m0, s39, 97280
s_add_u32 s37, s37, s38
buffer_load_dwordx4 v23, s[8:11], s37 offen sc1 lds
s_waitcnt vmcnt(24)
s_barrier
s_lshl_b32 s43, s35, 8
s_cmp_eq_u32 s51, 1
s_cselect_b32 s8, s4, s6
s_cselect_b32 s9, s5, s7
s_sub_u32 s10, 7340032, s43
s_lshl_b32 s44, s34, 18
s_add_u32 s44, s44, 4194304
s_movk_i32 s38, 28672
s_cmp_eq_u32 s51, 0
s_cselect_b32 s8, s32, s8
s_cselect_b32 s9, s33, s9
s_cselect_b32 s10, 262144, s10
s_cselect_b32 s43, s44, s43
s_cselect_b32 s38, 1024, s38
s_cselect_b32 s45, 0, -1
s_add_u32 s8, s8, s43
s_addc_u32 s9, s9, 0
s_mov_b32 s11, 0x20000
s_lshl_b32 s40, s38, 4
s_add_u32 s42, s35, 15
s_lshl_b32 s39, s51, 14
v_lshrrev_b32 v19, 4, v1
v_lshlrev_b32 v20, 5, v19
v_mul_u32_u24 v19, 6912, v19
v_and_b32 v19, s45, v19
v_and_b32 v20, s45, v20
v_lshlrev_b32 v21, 4, v1
v_xor_b32 v21, v21, v20
v_add_u32 v22, v21, v19
s_and_b32 s45, s45, 128
v_xor_b32 v23, s45, v22
s_waitcnt vmcnt(16)
s_barrier
s_add_u32 s42, s42, 1
s_and_b32 s42, s42, 15
s_add_u32 m0, s39, 98304
s_mul_i32 s37, s42, s40
buffer_load_dwordx4 v22, s[8:11], s37 offen sc1 lds
s_add_u32 m0, s39, 99328
s_add_u32 s37, s37, s38
buffer_load_dwordx4 v23, s[8:11], s37 offen sc1 lds
s_add_u32 m0, s39, 100352
s_add_u32 s37, s37, s38
buffer_load_dwordx4 v22, s[8:11], s37 offen sc1 lds
s_add_u32 m0, s39, 101376
s_add_u32 s37, s37, s38
buffer_load_dwordx4 v23, s[8:11], s37 offen sc1 lds
s_add_u32 m0, s39, 102400
s_add_u32 s37, s37, s38
buffer_load_dwordx4 v22, s[8:11], s37 offen sc1 lds
s_add_u32 m0, s39, 103424
s_add_u32 s37, s37, s38
buffer_load_dwordx4 v23, s[8:11], s37 offen sc1 lds
s_add_u32 m0, s39, 104448
s_add_u32 s37, s37, s38
buffer_load_dwordx4 v22, s[8:11], s37 offen sc1 lds
s_add_u32 m0, s39, 105472
s_add_u32 s37, s37, s38
buffer_load_dwordx4 v23, s[8:11], s37 offen sc1 lds
s_add_u32 m0, s39, 106496
s_add_u32 s37, s37, s38
buffer_load_dwordx4 v22, s[8:11], s37 offen sc1 lds
s_add_u32 m0, s39, 107520
s_add_u32 s37, s37, s38
buffer_load_dwordx4 v23, s[8:11], s37 offen sc1 lds
s_add_u32 m0, s39, 108544
s_add_u32 s37, s37, s38
buffer_load_dwordx4 v22, s[8:11], s37 offen sc1 lds
s_add_u32 m0, s39, 109568
s_add_u32 s37, s37, s38
buffer_load_dwordx4 v23, s[8:11], s37 offen sc1 lds
s_add_u32 m0, s39, 110592
s_add_u32 s37, s37, s38
buffer_load_dwordx4 v22, s[8:11], s37 offen sc1 lds
s_add_u32 m0, s39, 111616
s_add_u32 s37, s37, s38
buffer_load_dwordx4 v23, s[8:11], s37 offen sc1 lds
s_add_u32 m0, s39, 112640
s_add_u32 s37, s37, s38
buffer_load_dwordx4 v22, s[8:11], s37 offen sc1 lds
s_add_u32 m0, s39, 113664
s_add_u32 s37, s37, s38
buffer_load_dwordx4 v23, s[8:11], s37 offen sc1 lds
s_waitcnt vmcnt(24)
s_barrier
s_waitcnt vmcnt(16)
s_barrier
s_add_u32 s42, s42, 1
s_and_b32 s42, s42, 15
s_add_u32 m0, s39, 0
s_mul_i32 s37, s42, s40
buffer_load_dwordx4 v22, s[8:11], s37 offen sc1 lds
s_add_u32 m0, s39, 1024
s_add_u32 s37, s37, s38
buffer_load_dwordx4 v23, s[8:11], s37 offen sc1 lds
s_add_u32 m0, s39, 2048
s_add_u32 s37, s37, s38
buffer_load_dwordx4 v22, s[8:11], s37 offen sc1 lds
s_add_u32 m0, s39, 3072
s_add_u32 s37, s37, s38
buffer_load_dwordx4 v23, s[8:11], s37 offen sc1 lds
s_add_u32 m0, s39, 4096
s_add_u32 s37, s37, s38
buffer_load_dwordx4 v22, s[8:11], s37 offen sc1 lds
s_add_u32 m0, s39, 5120
s_add_u32 s37, s37, s38
buffer_load_dwordx4 v23, s[8:11], s37 offen sc1 lds
s_add_u32 m0, s39, 6144
s_add_u32 s37, s37, s38
buffer_load_dwordx4 v22, s[8:11], s37 offen sc1 lds
s_add_u32 m0, s39, 7168
s_add_u32 s37, s37, s38
buffer_load_dwordx4 v23, s[8:11], s37 offen sc1 lds
s_add_u32 m0, s39, 8192
s_add_u32 s37, s37, s38
buffer_load_dwordx4 v22, s[8:11], s37 offen sc1 lds
s_add_u32 m0, s39, 9216
s_add_u32 s37, s37, s38
buffer_load_dwordx4 v23, s[8:11], s37 offen sc1 lds
s_add_u32 m0, s39, 10240
s_add_u32 s37, s37, s38
buffer_load_dwordx4 v22, s[8:11], s37 offen sc1 lds
s_add_u32 m0, s39, 11264
s_add_u32 s37, s37, s38
buffer_load_dwordx4 v23, s[8:11], s37 offen sc1 lds
s_add_u32 m0, s39, 12288
s_add_u32 s37, s37, s38
buffer_load_dwordx4 v22, s[8:11], s37 offen sc1 lds
s_add_u32 m0, s39, 13312
s_add_u32 s37, s37, s38
buffer_load_dwordx4 v23, s[8:11], s37 offen sc1 lds
s_add_u32 m0, s39, 14336
s_add_u32 s37, s37, s38
buffer_load_dwordx4 v22, s[8:11], s37 offen sc1 lds
s_add_u32 m0, s39, 15360
s_add_u32 s37, s37, s38
buffer_load_dwordx4 v23, s[8:11], s37 offen sc1 lds
s_barrier
s_waitcnt vmcnt(16)
s_barrier
s_add_u32 s42, s42, 1
s_and_b32 s42, s42, 15
s_add_u32 m0, s39, 49152
s_mul_i32 s37, s42, s40
buffer_load_dwordx4 v22, s[8:11], s37 offen sc1 lds
s_add_u32 m0, s39, 50176
s_add_u32 s37, s37, s38
buffer_load_dwordx4 v23, s[8:11], s37 offen sc1 lds
s_add_u32 m0, s39, 51200
s_add_u32 s37, s37, s38
buffer_load_dwordx4 v22, s[8:11], s37 offen sc1 lds
s_add_u32 m0, s39, 52224
s_add_u32 s37, s37, s38
buffer_load_dwordx4 v23, s[8:11], s37 offen sc1 lds
s_add_u32 m0, s39, 53248
s_add_u32 s37, s37, s38
buffer_load_dwordx4 v22, s[8:11], s37 offen sc1 lds
s_add_u32 m0, s39, 54272
s_add_u32 s37, s37, s38
buffer_load_dwordx4 v23, s[8:11], s37 offen sc1 lds
s_add_u32 m0, s39, 55296
s_add_u32 s37, s37, s38
buffer_load_dwordx4 v22, s[8:11], s37 offen sc1 lds
s_add_u32 m0, s39, 56320
s_add_u32 s37, s37, s38
buffer_load_dwordx4 v23, s[8:11], s37 offen sc1 lds
s_add_u32 m0, s39, 57344
s_add_u32 s37, s37, s38
buffer_load_dwordx4 v22, s[8:11], s37 offen sc1 lds
s_add_u32 m0, s39, 58368
s_add_u32 s37, s37, s38
buffer_load_dwordx4 v23, s[8:11], s37 offen sc1 lds
s_add_u32 m0, s39, 59392
s_add_u32 s37, s37, s38
buffer_load_dwordx4 v22, s[8:11], s37 offen sc1 lds
s_add_u32 m0, s39, 60416
s_add_u32 s37, s37, s38
buffer_load_dwordx4 v23, s[8:11], s37 offen sc1 lds
s_add_u32 m0, s39, 61440
s_add_u32 s37, s37, s38
buffer_load_dwordx4 v22, s[8:11], s37 offen sc1 lds
s_add_u32 m0, s39, 62464
s_add_u32 s37, s37, s38
buffer_load_dwordx4 v23, s[8:11], s37 offen sc1 lds
s_add_u32 m0, s39, 63488
s_add_u32 s37, s37, s38
buffer_load_dwordx4 v22, s[8:11], s37 offen sc1 lds
s_add_u32 m0, s39, 64512
s_add_u32 s37, s37, s38
buffer_load_dwordx4 v23, s[8:11], s37 offen sc1 lds
LP3_37:
s_mul_i32 s43, s2, 28672
s_mul_i32 s44, s51, 7168
s_add_u32 s43, s43, s44
s_add_u32 s80, s60, s43
s_addc_u32 s81, s61, 0
s_lshl_b32 s43, s34, 18
s_add_u32 s12, s32, s43
s_addc_u32 s13, s33, 0
s_add_u32 s12, s12, 4194304
s_addc_u32 s13, s13, 0
s_mov_b32 s14, 262144
s_mov_b32 s15, 0x20000
v_lshlrev_b32 v21, 4, v1
s_lshl_b32 s54, s36, 11
s_add_u32 s43, s35, 1
s_and_b32 s43, s43, 15
s_lshl_b32 s43, s43, 14
s_add_u32 s30, s43, s54
s_add_u32 s43, s35, 2
s_and_b32 s43, s43, 15
s_lshl_b32 s43, s43, 14
s_add_u32 s31, s43, s54
s_barrier
s_add_u32 m0, s54, 0
s_add_u32 s43, s30, 0
buffer_load_dwordx4 v21, s[12:15], s43 offen sc1 lds
s_add_u32 m0, s54, 1024
s_add_u32 s43, s30, 1024
buffer_load_dwordx4 v21, s[12:15], s43 offen sc1 lds
s_add_u32 m0, s54, 49152
s_add_u32 s43, s31, 0
buffer_load_dwordx4 v21, s[12:15], s43 offen sc1 lds
s_add_u32 m0, s54, 50176
s_add_u32 s43, s31, 1024
buffer_load_dwordx4 v21, s[12:15], s43 offen sc1 lds
s_add_u32 s42, s42, 1
s_and_b32 s42, s42, 15
s_add_u32 m0, s39, 98304
s_mul_i32 s37, s42, s40
buffer_load_dwordx4 v22, s[8:11], s37 offen sc1 lds
s_add_u32 m0, s39, 99328
s_add_u32 s37, s37, s38
buffer_load_dwordx4 v23, s[8:11], s37 offen sc1 lds
s_add_u32 m0, s39, 100352
s_add_u32 s37, s37, s38
buffer_load_dwordx4 v22, s[8:11], s37 offen sc1 lds
s_add_u32 m0, s39, 101376
s_add_u32 s37, s37, s38
buffer_load_dwordx4 v23, s[8:11], s37 offen sc1 lds
s_add_u32 m0, s39, 102400
s_add_u32 s37, s37, s38
buffer_load_dwordx4 v22, s[8:11], s37 offen sc1 lds
s_add_u32 m0, s39, 103424
s_add_u32 s37, s37, s38
buffer_load_dwordx4 v23, s[8:11], s37 offen sc1 lds
s_add_u32 m0, s39, 104448
s_add_u32 s37, s37, s38
buffer_load_dwordx4 v22, s[8:11], s37 offen sc1 lds
s_add_u32 m0, s39, 105472
s_add_u32 s37, s37, s38
buffer_load_dwordx4 v23, s[8:11], s37 offen sc1 lds
s_add_u32 m0, s39, 106496
s_add_u32 s37, s37, s38
buffer_load_dwordx4 v22, s[8:11], s37 offen sc1 lds
s_add_u32 m0, s39, 107520
s_add_u32 s37, s37, s38
buffer_load_dwordx4 v23, s[8:11], s37 offen sc1 lds
s_add_u32 m0, s39, 108544
s_add_u32 s37, s37, s38
buffer_load_dwordx4 v22, s[8:11], s37 offen sc1 lds
s_add_u32 m0, s39, 109568
s_add_u32 s37, s37, s38
buffer_load_dwordx4 v23, s[8:11], s37 offen sc1 lds
s_add_u32 m0, s39, 110592
s_add_u32 s37, s37, s38
buffer_load_dwordx4 v22, s[8:11], s37 offen sc1 lds
s_add_u32 m0, s39, 111616
s_add_u32 s37, s37, s38
buffer_load_dwordx4 v23, s[8:11], s37 offen sc1 lds
s_add_u32 m0, s39, 112640
s_add_u32 s37, s37, s38
buffer_load_dwordx4 v22, s[8:11], s37 offen sc1 lds
s_add_u32 m0, s39, 113664
s_add_u32 s37, s37, s38
buffer_load_dwordx4 v23, s[8:11], s37 offen sc1 lds
s_load_dword s64, s[80:81], 0
s_load_dword s65, s[80:81], 64
s_load_dword s66, s[80:81], 128
s_load_dword s67, s[80:81], 192
s_load_dword s68, s[80:81], 256
s_load_dword s69, s[80:81], 320
s_load_dword s70, s[80:81], 384
s_load_dword s71, s[80:81], 448
s_load_dword s72, s[80:81], 512
s_add_u32 s80, s80, 576
s_addc_u32 s81, s81, 0
s_waitcnt vmcnt(18)
s_barrier
s_waitcnt vmcnt(16)
s_barrier
s_mov_b32 s41, 2
Lp3_47:
s_add_u32 s42, s42, 1
s_and_b32 s42, s42, 15
s_add_u32 m0, s39, 0
s_mul_i32 s37, s42, s40
buffer_load_dwordx4 v22, s[8:11], s37 offen sc1 lds
s_add_u32 m0, s39, 1024
s_add_u32 s37, s37, s38
buffer_load_dwordx4 v23, s[8:11], s37 offen sc1 lds
s_add_u32 m0, s39, 2048
s_add_u32 s37, s37, s38
buffer_load_dwordx4 v22, s[8:11], s37 offen sc1 lds
s_add_u32 m0, s39, 3072
s_add_u32 s37, s37, s38
buffer_load_dwordx4 v23, s[8:11], s37 offen sc1 lds
s_add_u32 m0, s39, 4096
s_add_u32 s37, s37, s38
buffer_load_dwordx4 v22, s[8:11], s37 offen sc1 lds
s_add_u32 m0, s39, 5120
s_add_u32 s37, s37, s38
buffer_load_dwordx4 v23, s[8:11], s37 offen sc1 lds
s_add_u32 m0, s39, 6144
s_add_u32 s37, s37, s38
buffer_load_dwordx4 v22, s[8:11], s37 offen sc1 lds
s_add_u32 m0, s39, 7168
s_add_u32 s37, s37, s38
buffer_load_dwordx4 v23, s[8:11], s37 offen sc1 lds
s_add_u32 m0, s39, 8192
s_add_u32 s37, s37, s38
buffer_load_dwordx4 v22, s[8:11], s37 offen sc1 lds
s_add_u32 m0, s39, 9216
s_add_u32 s37, s37, s38
buffer_load_dwordx4 v23, s[8:11], s37 offen sc1 lds
s_add_u32 m0, s39, 10240
s_add_u32 s37, s37, s38
buffer_load_dwordx4 v22, s[8:11], s37 offen sc1 lds
s_add_u32 m0, s39, 11264
s_add_u32 s37, s37, s38
buffer_load_dwordx4 v23, s[8:11], s37 offen sc1 lds
s_add_u32 m0, s39, 12288
s_add_u32 s37, s37, s38
buffer_load_dwordx4 v22, s[8:11], s37 offen sc1 lds
s_add_u32 m0, s39, 13312
s_add_u32 s37, s37, s38
buffer_load_dwordx4 v23, s[8:11], s37 offen sc1 lds
s_add_u32 m0, s39, 14336
s_add_u32 s37, s37, s38
buffer_load_dwordx4 v22, s[8:11], s37 offen sc1 lds
s_add_u32 m0, s39, 15360
s_add_u32 s37, s37, s38
buffer_load_dwordx4 v23, s[8:11], s37 offen sc1 lds
s_load_dword s64, s[80:81], 0
s_load_dword s65, s[80:81], 64
s_load_dword s66, s[80:81], 128
s_load_dword s67, s[80:81], 192
s_load_dword s68, s[80:81], 256
s_load_dword s69, s[80:81], 320
s_load_dword s70, s[80:81], 384
s_load_dword s71, s[80:81], 448
s_load_dword s72, s[80:81], 512
s_add_u32 s80, s80, 576
s_addc_u32 s81, s81, 0
s_waitcnt vmcnt(16)
s_barrier
s_add_u32 s42, s42, 1
s_and_b32 s42, s42, 15
s_add_u32 m0, s39, 49152
s_mul_i32 s37, s42, s40
buffer_load_dwordx4 v22, s[8:11], s37 offen sc1 lds
s_add_u32 m0, s39, 50176
s_add_u32 s37, s37, s38
buffer_load_dwordx4 v23, s[8:11], s37 offen sc1 lds
s_add_u32 m0, s39, 51200
s_add_u32 s37, s37, s38
buffer_load_dwordx4 v22, s[8:11], s37 offen sc1 lds
s_add_u32 m0, s39, 52224
s_add_u32 s37, s37, s38
buffer_load_dwordx4 v23, s[8:11], s37 offen sc1 lds
s_add_u32 m0, s39, 53248
s_add_u32 s37, s37, s38
buffer_load_dwordx4 v22, s[8:11], s37 offen sc1 lds
s_add_u32 m0, s39, 54272
s_add_u32 s37, s37, s38
buffer_load_dwordx4 v23, s[8:11], s37 offen sc1 lds
s_add_u32 m0, s39, 55296
s_add_u32 s37, s37, s38
buffer_load_dwordx4 v22, s[8:11], s37 offen sc1 lds
s_add_u32 m0, s39, 56320
s_add_u32 s37, s37, s38
buffer_load_dwordx4 v23, s[8:11], s37 offen sc1 lds
s_add_u32 m0, s39, 57344
s_add_u32 s37, s37, s38
buffer_load_dwordx4 v22, s[8:11], s37 offen sc1 lds
s_add_u32 m0, s39, 58368
s_add_u32 s37, s37, s38
buffer_load_dwordx4 v23, s[8:11], s37 offen sc1 lds
s_add_u32 m0, s39, 59392
s_add_u32 s37, s37, s38
buffer_load_dwordx4 v22, s[8:11], s37 offen sc1 lds
s_add_u32 m0, s39, 60416
s_add_u32 s37, s37, s38
buffer_load_dwordx4 v23, s[8:11], s37 offen sc1 lds
s_add_u32 m0, s39, 61440
s_add_u32 s37, s37, s38
buffer_load_dwordx4 v22, s[8:11], s37 offen sc1 lds
s_add_u32 m0, s39, 62464
s_add_u32 s37, s37, s38
buffer_load_dwordx4 v23, s[8:11], s37 offen sc1 lds
s_add_u32 m0, s39, 63488
s_add_u32 s37, s37, s38
buffer_load_dwordx4 v22, s[8:11], s37 offen sc1 lds
s_add_u32 m0, s39, 64512
s_add_u32 s37, s37, s38
buffer_load_dwordx4 v23, s[8:11], s37 offen sc1 lds
s_load_dword s64, s[80:81], 0
s_load_dword s65, s[80:81], 64
s_load_dword s66, s[80:81], 128
s_load_dword s67, s[80:81], 192
s_load_dword s68, s[80:81], 256
s_load_dword s69, s[80:81], 320
s_load_dword s70, s[80:81], 384
s_load_dword s71, s[80:81], 448
s_load_dword s72, s[80:81], 512
s_add_u32 s80, s80, 576
s_addc_u32 s81, s81, 0
s_waitcnt vmcnt(16)
s_barrier
s_add_u32 s42, s42, 1
s_and_b32 s42, s42, 15
s_add_u32 m0, s39, 98304
s_mul_i32 s37, s42, s40
buffer_load_dwordx4 v22, s[8:11], s37 offen sc1 lds
s_add_u32 m0, s39, 99328
s_add_u32 s37, s37, s38
buffer_load_dwordx4 v23, s[8:11], s37 offen sc1 lds
s_add_u32 m0, s39, 100352
s_add_u32 s37, s37, s38
buffer_load_dwordx4 v22, s[8:11], s37 offen sc1 lds
s_add_u32 m0, s39, 101376
s_add_u32 s37, s37, s38
buffer_load_dwordx4 v23, s[8:11], s37 offen sc1 lds
s_add_u32 m0, s39, 102400
s_add_u32 s37, s37, s38
buffer_load_dwordx4 v22, s[8:11], s37 offen sc1 lds
s_add_u32 m0, s39, 103424
s_add_u32 s37, s37, s38
buffer_load_dwordx4 v23, s[8:11], s37 offen sc1 lds
s_add_u32 m0, s39, 104448
s_add_u32 s37, s37, s38
buffer_load_dwordx4 v22, s[8:11], s37 offen sc1 lds
s_add_u32 m0, s39, 105472
s_add_u32 s37, s37, s38
buffer_load_dwordx4 v23, s[8:11], s37 offen sc1 lds
s_add_u32 m0, s39, 106496
s_add_u32 s37, s37, s38
buffer_load_dwordx4 v22, s[8:11], s37 offen sc1 lds
s_add_u32 m0, s39, 107520
s_add_u32 s37, s37, s38
buffer_load_dwordx4 v23, s[8:11], s37 offen sc1 lds
s_add_u32 m0, s39, 108544
s_add_u32 s37, s37, s38
buffer_load_dwordx4 v22, s[8:11], s37 offen sc1 lds
s_add_u32 m0, s39, 109568
s_add_u32 s37, s37, s38
buffer_load_dwordx4 v23, s[8:11], s37 offen sc1 lds
s_add_u32 m0, s39, 110592
s_add_u32 s37, s37, s38
buffer_load_dwordx4 v22, s[8:11], s37 offen sc1 lds
s_add_u32 m0, s39, 111616
s_add_u32 s37, s37, s38
buffer_load_dwordx4 v23, s[8:11], s37 offen sc1 lds
s_add_u32 m0, s39, 112640
s_add_u32 s37, s37, s38
buffer_load_dwordx4 v22, s[8:11], s37 offen sc1 lds
s_add_u32 m0, s39, 113664
s_add_u32 s37, s37, s38
buffer_load_dwordx4 v23, s[8:11], s37 offen sc1 lds
s_load_dword s64, s[80:81], 0
s_load_dword s65, s[80:81], 64
s_load_dword s66, s[80:81], 128
s_load_dword s67, s[80:81], 192
s_load_dword s68, s[80:81], 256
s_load_dword s69, s[80:81], 320
s_load_dword s70, s[80:81], 384
s_load_dword s71, s[80:81], 448
s_load_dword s72, s[80:81], 512
s_add_u32 s80, s80, 576
s_addc_u32 s81, s81, 0
s_waitcnt vmcnt(16)
s_barrier
s_sub_u32 s41, s41, 1
s_cmp_lg_u32 s41, 0
s_cbranch_scc1 Lp3_47
s_add_u32 s42, s42, 1
s_and_b32 s42, s42, 15
s_add_u32 m0, s39, 0
s_mul_i32 s37, s42, s40
buffer_load_dwordx4 v22, s[8:11], s37 offen sc1 lds
s_add_u32 m0, s39, 1024
s_add_u32 s37, s37, s38
buffer_load_dwordx4 v23, s[8:11], s37 offen sc1 lds
s_add_u32 m0, s39, 2048
s_add_u32 s37, s37, s38
buffer_load_dwordx4 v22, s[8:11], s37 offen sc1 lds
s_add_u32 m0, s39, 3072
s_add_u32 s37, s37, s38
buffer_load_dwordx4 v23, s[8:11], s37 offen sc1 lds
s_add_u32 m0, s39, 4096
s_add_u32 s37, s37, s38
buffer_load_dwordx4 v22, s[8:11], s37 offen sc1 lds
s_add_u32 m0, s39, 5120
s_add_u32 s37, s37, s38
buffer_load_dwordx4 v23, s[8:11], s37 offen sc1 lds
s_add_u32 m0, s39, 6144
s_add_u32 s37, s37, s38
buffer_load_dwordx4 v22, s[8:11], s37 offen sc1 lds
s_add_u32 m0, s39, 7168
s_add_u32 s37, s37, s38
buffer_load_dwordx4 v23, s[8:11], s37 offen sc1 lds
s_add_u32 m0, s39, 8192
s_add_u32 s37, s37, s38
buffer_load_dwordx4 v22, s[8:11], s37 offen sc1 lds
s_add_u32 m0, s39, 9216
s_add_u32 s37, s37, s38
buffer_load_dwordx4 v23, s[8:11], s37 offen sc1 lds
s_add_u32 m0, s39, 10240
s_add_u32 s37, s37, s38
buffer_load_dwordx4 v22, s[8:11], s37 offen sc1 lds
s_add_u32 m0, s39, 11264
s_add_u32 s37, s37, s38
buffer_load_dwordx4 v23, s[8:11], s37 offen sc1 lds
s_add_u32 m0, s39, 12288
s_add_u32 s37, s37, s38
buffer_load_dwordx4 v22, s[8:11], s37 offen sc1 lds
s_add_u32 m0, s39, 13312
s_add_u32 s37, s37, s38
buffer_load_dwordx4 v23, s[8:11], s37 offen sc1 lds
s_add_u32 m0, s39, 14336
s_add_u32 s37, s37, s38
buffer_load_dwordx4 v22, s[8:11], s37 offen sc1 lds
s_add_u32 m0, s39, 15360
s_add_u32 s37, s37, s38
buffer_load_dwordx4 v23, s[8:11], s37 offen sc1 lds
s_load_dword s64, s[80:81], 0
s_load_dword s65, s[80:81], 64
s_load_dword s66, s[80:81], 128
s_load_dword s67, s[80:81], 192
s_load_dword s68, s[80:81], 256
s_load_dword s69, s[80:81], 320
s_load_dword s70, s[80:81], 384
s_load_dword s71, s[80:81], 448
s_load_dword s72, s[80:81], 512
s_add_u32 s80, s80, 576
s_addc_u32 s81, s81, 0
s_waitcnt vmcnt(16)
s_barrier
s_add_u32 s42, s42, 1
s_and_b32 s42, s42, 15
s_add_u32 m0, s39, 49152
s_mul_i32 s37, s42, s40
buffer_load_dwordx4 v22, s[8:11], s37 offen sc1 lds
s_add_u32 m0, s39, 50176
s_add_u32 s37, s37, s38
buffer_load_dwordx4 v23, s[8:11], s37 offen sc1 lds
s_add_u32 m0, s39, 51200
s_add_u32 s37, s37, s38
buffer_load_dwordx4 v22, s[8:11], s37 offen sc1 lds
s_add_u32 m0, s39, 52224
s_add_u32 s37, s37, s38
buffer_load_dwordx4 v23, s[8:11], s37 offen sc1 lds
s_add_u32 m0, s39, 53248
s_add_u32 s37, s37, s38
buffer_load_dwordx4 v22, s[8:11], s37 offen sc1 lds
s_add_u32 m0, s39, 54272
s_add_u32 s37, s37, s38
buffer_load_dwordx4 v23, s[8:11], s37 offen sc1 lds
s_add_u32 m0, s39, 55296
s_add_u32 s37, s37, s38
buffer_load_dwordx4 v22, s[8:11], s37 offen sc1 lds
s_add_u32 m0, s39, 56320
s_add_u32 s37, s37, s38
buffer_load_dwordx4 v23, s[8:11], s37 offen sc1 lds
s_add_u32 m0, s39, 57344
s_add_u32 s37, s37, s38
buffer_load_dwordx4 v22, s[8:11], s37 offen sc1 lds
s_add_u32 m0, s39, 58368
s_add_u32 s37, s37, s38
buffer_load_dwordx4 v23, s[8:11], s37 offen sc1 lds
s_add_u32 m0, s39, 59392
s_add_u32 s37, s37, s38
buffer_load_dwordx4 v22, s[8:11], s37 offen sc1 lds
s_add_u32 m0, s39, 60416
s_add_u32 s37, s37, s38
buffer_load_dwordx4 v23, s[8:11], s37 offen sc1 lds
s_add_u32 m0, s39, 61440
s_add_u32 s37, s37, s38
buffer_load_dwordx4 v22, s[8:11], s37 offen sc1 lds
s_add_u32 m0, s39, 62464
s_add_u32 s37, s37, s38
buffer_load_dwordx4 v23, s[8:11], s37 offen sc1 lds
s_add_u32 m0, s39, 63488
s_add_u32 s37, s37, s38
buffer_load_dwordx4 v22, s[8:11], s37 offen sc1 lds
s_add_u32 m0, s39, 64512
s_add_u32 s37, s37, s38
buffer_load_dwordx4 v23, s[8:11], s37 offen sc1 lds
s_load_dword s64, s[80:81], 0
s_load_dword s65, s[80:81], 64
s_load_dword s66, s[80:81], 128
s_load_dword s67, s[80:81], 192
s_load_dword s68, s[80:81], 256
s_load_dword s69, s[80:81], 320
s_load_dword s70, s[80:81], 384
s_load_dword s71, s[80:81], 448
s_load_dword s72, s[80:81], 512
s_add_u32 s80, s80, 576
s_addc_u32 s81, s81, 0
s_waitcnt vmcnt(16)
s_barrier
s_add_u32 s42, s42, 1
s_and_b32 s42, s42, 15
s_add_u32 m0, s39, 98304
s_mul_i32 s37, s42, s40
buffer_load_dwordx4 v22, s[8:11], s37 offen sc1 lds
s_and_b32 s53, s35, 1
s_lshl_b32 s53, s53, 1
s_mul_i32 s43, s47, 3
s_add_u32 m0, s39, 99328
s_add_u32 s37, s37, s38
buffer_load_dwordx4 v23, s[8:11], s37 offen sc1 lds
s_add_u32 s53, s53, s43
v_lshlrev_b32 v19, 11, v18
v_lshl_add_u32 v19, v17, 4, v19
s_add_u32 m0, s39, 100352
s_add_u32 s37, s37, s38
buffer_load_dwordx4 v22, s[8:11], s37 offen sc1 lds
s_lshl_b32 s43, s46, 10
v_add_u32 v2, s43, v19
v_add_u32 v3, 49152, v2
s_add_u32 m0, s39, 101376
s_add_u32 s37, s37, s38
buffer_load_dwordx4 v23, s[8:11], s37 offen sc1 lds
v_add_u32 v4, 98304, v2
v_lshrrev_b32 v19, 2, v17
v_lshl_add_u32 v20, v18, 2, v19
s_add_u32 m0, s39, 102400
s_add_u32 s37, s37, s38
buffer_load_dwordx4 v22, s[8:11], s37 offen sc1 lds
v_and_b32 v21, 7, v20
v_lshlrev_b32 v20, 8, v20
v_and_b32 v19, 3, v1
s_add_u32 m0, s39, 103424
s_add_u32 s37, s37, s38
buffer_load_dwordx4 v23, s[8:11], s37 offen sc1 lds
v_lshl_add_u32 v20, v19, 3, v20
s_add_u32 s43, s53, 0
v_xor_b32 v19, s43, v21
s_add_u32 m0, s39, 104448
s_add_u32 s37, s37, s38
buffer_load_dwordx4 v22, s[8:11], s37 offen sc1 lds
v_lshl_add_u32 v5, v19, 5, v20
s_add_u32 s43, s53, 1
v_xor_b32 v19, s43, v21
s_add_u32 m0, s39, 105472
s_add_u32 s37, s37, s38
buffer_load_dwordx4 v23, s[8:11], s37 offen sc1 lds
v_lshl_add_u32 v6, v19, 5, v20
s_add_u32 s43, s53, 2
v_xor_b32 v19, s43, v21
s_add_u32 m0, s39, 106496
s_add_u32 s37, s37, s38
buffer_load_dwordx4 v22, s[8:11], s37 offen sc1 lds
v_lshl_add_u32 v7, v19, 5, v20
v_add_u32 v9, 49152, v5
v_add_u32 v10, 49152, v6
s_add_u32 m0, s39, 107520
s_add_u32 s37, s37, s38
buffer_load_dwordx4 v23, s[8:11], s37 offen sc1 lds
v_add_u32 v11, 49152, v7
v_add_u32 v13, 98304, v5
v_add_u32 v14, 98304, v6
s_add_u32 m0, s39, 108544
s_add_u32 s37, s37, s38
buffer_load_dwordx4 v22, s[8:11], s37 offen sc1 lds
v_add_u32 v15, 98304, v7
s_lshl_b32 s43, s46, 9
s_add_u32 s43, s43, 147456
s_add_u32 m0, s39, 109568
s_add_u32 s37, s37, s38
buffer_load_dwordx4 v23, s[8:11], s37 offen sc1 lds
v_lshl_add_u32 v19, v17, 3, s43
ds_read_b64 v[80:81], v19 offset:0
ds_read_b64 v[82:83], v19 offset:128
s_add_u32 m0, s39, 110592
s_add_u32 s37, s37, s38
buffer_load_dwordx4 v22, s[8:11], s37 offen sc1 lds
ds_read_b64 v[84:85], v19 offset:256
ds_read_b64 v[86:87], v19 offset:384
s_mul_i32 s43, s47, 192
s_add_u32 m0, s39, 111616
s_add_u32 s37, s37, s38
buffer_load_dwordx4 v23, s[8:11], s37 offen sc1 lds
s_add_u32 s43, s43, 148992
v_lshl_add_u32 v19, v18, 4, s43
ds_read_b128 v[48:51], v19 offset:0
s_add_u32 m0, s39, 112640
s_add_u32 s37, s37, s38
buffer_load_dwordx4 v22, s[8:11], s37 offen sc1 lds
ds_read_b128 v[52:55], v19 offset:64
ds_read_b128 v[56:59], v19 offset:128
ds_read_b128 v[60:63], v19 offset:896
s_add_u32 m0, s39, 113664
s_add_u32 s37, s37, s38
buffer_load_dwordx4 v23, s[8:11], s37 offen sc1 lds
ds_read_b128 v[64:67], v19 offset:960
ds_read_b128 v[68:71], v19 offset:1024
s_waitcnt vmcnt(16)
s_barrier
s_add_u32 s42, s42, 1
s_and_b32 s42, s42, 15
s_add_u32 m0, s39, 0
s_mul_i32 s37, s42, s40
buffer_load_dwordx4 v22, s[8:11], s37 offen sc1 lds
s_waitcnt lgkmcnt(0)
v_mul_f32 v88, v81, v81
s_add_u32 m0, s39, 1024
s_add_u32 s37, s37, s38
buffer_load_dwordx4 v23, s[8:11], s37 offen sc1 lds
v_mul_f32 v228, 0xc0135761, v81
s_add_u32 m0, s39, 2048
s_add_u32 s37, s37, s38
buffer_load_dwordx4 v22, s[8:11], s37 offen sc1 lds
v_mul_f32 v89, 0xbdd2d3e8, v81
s_add_u32 m0, s39, 3072
s_add_u32 s37, s37, s38
buffer_load_dwordx4 v23, s[8:11], s37 offen sc1 lds
v_rcp_f32 v236, v88
v_mul_f32 v232, v89, v88
s_add_u32 m0, s39, 4096
s_add_u32 s37, s37, s38
buffer_load_dwordx4 v22, s[8:11], s37 offen sc1 lds
v_mul_f32 v88, v83, v83
s_add_u32 m0, s39, 5120
s_add_u32 s37, s37, s38
buffer_load_dwordx4 v23, s[8:11], s37 offen sc1 lds
v_mul_f32 v229, 0xc0135761, v83
s_add_u32 m0, s39, 6144
s_add_u32 s37, s37, s38
buffer_load_dwordx4 v22, s[8:11], s37 offen sc1 lds
v_mul_f32 v89, 0xbdd2d3e8, v83
v_rcp_f32 v237, v88
s_add_u32 m0, s39, 7168
s_add_u32 s37, s37, s38
buffer_load_dwordx4 v23, s[8:11], s37 offen sc1 lds
v_mul_f32 v233, v89, v88
s_add_u32 m0, s39, 8192
s_add_u32 s37, s37, s38
buffer_load_dwordx4 v22, s[8:11], s37 offen sc1 lds
v_mul_f32 v88, v85, v85
s_add_u32 m0, s39, 9216
s_add_u32 s37, s37, s38
buffer_load_dwordx4 v23, s[8:11], s37 offen sc1 lds
v_mul_f32 v230, 0xc0135761, v85
v_mul_f32 v89, 0xbdd2d3e8, v85
s_add_u32 m0, s39, 10240
s_add_u32 s37, s37, s38
buffer_load_dwordx4 v22, s[8:11], s37 offen sc1 lds
v_rcp_f32 v238, v88
s_add_u32 m0, s39, 11264
s_add_u32 s37, s37, s38
buffer_load_dwordx4 v23, s[8:11], s37 offen sc1 lds
v_mul_f32 v234, v89, v88
s_add_u32 m0, s39, 12288
s_add_u32 s37, s37, s38
buffer_load_dwordx4 v22, s[8:11], s37 offen sc1 lds
v_mul_f32 v88, v87, v87
v_mul_f32 v231, 0xc0135761, v87
s_add_u32 m0, s39, 13312
s_add_u32 s37, s37, s38
buffer_load_dwordx4 v23, s[8:11], s37 offen sc1 lds
v_mul_f32 v89, 0xbdd2d3e8, v87
s_add_u32 m0, s39, 14336
s_add_u32 s37, s37, s38
buffer_load_dwordx4 v22, s[8:11], s37 offen sc1 lds
v_rcp_f32 v239, v88
s_add_u32 m0, s39, 15360
s_add_u32 s37, s37, s38
buffer_load_dwordx4 v23, s[8:11], s37 offen sc1 lds
v_mul_f32 v235, v89, v88
s_mul_i32 s43, s34, 917504
s_mul_i32 s44, s49, 24576
s_add_u32 s43, s43, s44
s_add_u32 s43, s43, 8912896
s_add_u32 s24, s32, s43
s_addc_u32 s25, s33, 0
s_mov_b32 s26, 24576
s_mov_b32 s27, 0x20000
s_mov_b32 s53, 262144
s_lshl_b32 s43, s47, 13
s_lshl_b32 s44, s46, 10
s_add_u32 s43, s43, s44
v_lshlrev_b32 v19, 11, v18
v_lshl_add_u32 v19, v17, 4, v19
v_add_u32 v27, s43, v19
s_lshl_b32 s43, s47, 12
s_add_u32 s43, s43, s44
s_add_u32 s43, s43, 16384
v_and_b32 v19, 1, v18
v_lshlrev_b32 v19, 11, v19
v_lshrrev_b32 v20, 1, v18
v_lshl_add_u32 v19, v20, 8, v19
v_lshl_add_u32 v19, v17, 4, v19
v_add_u32 v28, s43, v19
s_load_dword s64, s[80:81], 0
s_load_dword s65, s[80:81], 64
s_load_dword s66, s[80:81], 128
s_load_dword s67, s[80:81], 192
s_load_dword s68, s[80:81], 256
s_load_dword s69, s[80:81], 320
s_load_dword s70, s[80:81], 384
s_load_dword s71, s[80:81], 448
s_add_u32 s80, s80, 512
s_addc_u32 s81, s81, 0
s_waitcnt vmcnt(16)
s_barrier
s_add_u32 s42, s42, 1
s_and_b32 s42, s42, 15
s_add_u32 m0, s39, 49152
s_mul_i32 s37, s42, s40
buffer_load_dwordx4 v22, s[8:11], s37 offen sc1 lds
v_mul_f32 v128, -v80, v48
v_mul_f32 v129, -v80, v49
s_add_u32 m0, s39, 50176
s_add_u32 s37, s37, s38
buffer_load_dwordx4 v23, s[8:11], s37 offen sc1 lds
v_mul_f32 v130, -v80, v50
v_mul_f32 v131, -v80, v51
s_add_u32 m0, s39, 51200
s_add_u32 s37, s37, s38
buffer_load_dwordx4 v22, s[8:11], s37 offen sc1 lds
v_mul_f32 v132, -v82, v48
v_mul_f32 v133, -v82, v49
s_add_u32 m0, s39, 52224
s_add_u32 s37, s37, s38
buffer_load_dwordx4 v23, s[8:11], s37 offen sc1 lds
v_mul_f32 v134, -v82, v50
v_mul_f32 v135, -v82, v51
s_add_u32 m0, s39, 53248
s_add_u32 s37, s37, s38
buffer_load_dwordx4 v22, s[8:11], s37 offen sc1 lds
v_mul_f32 v136, -v84, v48
v_mul_f32 v137, -v84, v49
s_add_u32 m0, s39, 54272
s_add_u32 s37, s37, s38
buffer_load_dwordx4 v23, s[8:11], s37 offen sc1 lds
v_mul_f32 v138, -v84, v50
v_mul_f32 v139, -v84, v51
s_add_u32 m0, s39, 55296
s_add_u32 s37, s37, s38
buffer_load_dwordx4 v22, s[8:11], s37 offen sc1 lds
v_mul_f32 v140, -v86, v48
v_mul_f32 v141, -v86, v49
s_add_u32 m0, s39, 56320
s_add_u32 s37, s37, s38
buffer_load_dwordx4 v23, s[8:11], s37 offen sc1 lds
v_mul_f32 v142, -v86, v50
v_mul_f32 v143, -v86, v51
s_add_u32 m0, s39, 57344
s_add_u32 s37, s37, s38
buffer_load_dwordx4 v22, s[8:11], s37 offen sc1 lds
v_mul_f32 v144, -v80, v52
v_mul_f32 v145, -v80, v53
s_add_u32 m0, s39, 58368
s_add_u32 s37, s37, s38
buffer_load_dwordx4 v23, s[8:11], s37 offen sc1 lds
v_mul_f32 v146, -v80, v54
v_mul_f32 v147, -v80, v55
s_add_u32 m0, s39, 59392
s_add_u32 s37, s37, s38
buffer_load_dwordx4 v22, s[8:11], s37 offen sc1 lds
v_mul_f32 v148, -v82, v52
v_mul_f32 v149, -v82, v53
s_add_u32 m0, s39, 60416
s_add_u32 s37, s37, s38
buffer_load_dwordx4 v23, s[8:11], s37 offen sc1 lds
v_mul_f32 v150, -v82, v54
v_mul_f32 v151, -v82, v55
s_add_u32 m0, s39, 61440
s_add_u32 s37, s37, s38
buffer_load_dwordx4 v22, s[8:11], s37 offen sc1 lds
v_mul_f32 v152, -v84, v52
v_mul_f32 v153, -v84, v53
s_add_u32 m0, s39, 62464
s_add_u32 s37, s37, s38
buffer_load_dwordx4 v23, s[8:11], s37 offen sc1 lds
v_mul_f32 v154, -v84, v54
v_mul_f32 v155, -v84, v55
s_add_u32 m0, s39, 63488
s_add_u32 s37, s37, s38
buffer_load_dwordx4 v22, s[8:11], s37 offen sc1 lds
v_mul_f32 v156, -v86, v52
v_mul_f32 v157, -v86, v53
s_add_u32 m0, s39, 64512
s_add_u32 s37, s37, s38
buffer_load_dwordx4 v23, s[8:11], s37 offen sc1 lds
v_mul_f32 v158, -v86, v54
v_mul_f32 v159, -v86, v55
s_load_dword s64, s[80:81], 0
s_load_dword s65, s[80:81], 64
s_load_dword s66, s[80:81], 128
s_load_dword s67, s[80:81], 192
s_load_dword s68, s[80:81], 256
s_load_dword s69, s[80:81], 320
s_load_dword s70, s[80:81], 384
s_load_dword s71, s[80:81], 448
s_add_u32 s80, s80, 512
s_addc_u32 s81, s81, 0
s_waitcnt vmcnt(16)
s_barrier
s_add_u32 s42, s42, 1
s_and_b32 s42, s42, 15
s_add_u32 m0, s39, 98304
s_mul_i32 s37, s42, s40
buffer_load_dwordx4 v22, s[8:11], s37 offen sc1 lds
v_mul_f32 v160, -v80, v56
v_mul_f32 v161, -v80, v57
s_add_u32 m0, s39, 99328
s_add_u32 s37, s37, s38
buffer_load_dwordx4 v23, s[8:11], s37 offen sc1 lds
v_mul_f32 v162, -v80, v58
v_mul_f32 v163, -v80, v59
s_add_u32 m0, s39, 100352
s_add_u32 s37, s37, s38
buffer_load_dwordx4 v22, s[8:11], s37 offen sc1 lds
v_mul_f32 v164, -v82, v56
v_mul_f32 v165, -v82, v57
s_add_u32 m0, s39, 101376
s_add_u32 s37, s37, s38
buffer_load_dwordx4 v23, s[8:11], s37 offen sc1 lds
v_mul_f32 v166, -v82, v58
v_mul_f32 v167, -v82, v59
s_add_u32 m0, s39, 102400
s_add_u32 s37, s37, s38
buffer_load_dwordx4 v22, s[8:11], s37 offen sc1 lds
v_mul_f32 v168, -v84, v56
v_mul_f32 v169, -v84, v57
s_add_u32 m0, s39, 103424
s_add_u32 s37, s37, s38
buffer_load_dwordx4 v23, s[8:11], s37 offen sc1 lds
v_mul_f32 v170, -v84, v58
v_mul_f32 v171, -v84, v59
s_add_u32 m0, s39, 104448
s_add_u32 s37, s37, s38
buffer_load_dwordx4 v22, s[8:11], s37 offen sc1 lds
v_mul_f32 v172, -v86, v56
v_mul_f32 v173, -v86, v57
s_add_u32 m0, s39, 105472
s_add_u32 s37, s37, s38
buffer_load_dwordx4 v23, s[8:11], s37 offen sc1 lds
v_mul_f32 v174, -v86, v58
v_mul_f32 v175, -v86, v59
s_add_u32 m0, s39, 106496
s_add_u32 s37, s37, s38
buffer_load_dwordx4 v22, s[8:11], s37 offen sc1 lds
v_mul_f32 v176, -v80, v60
v_mul_f32 v177, -v80, v61
s_add_u32 m0, s39, 107520
s_add_u32 s37, s37, s38
buffer_load_dwordx4 v23, s[8:11], s37 offen sc1 lds
v_mul_f32 v178, -v80, v62
v_mul_f32 v179, -v80, v63
s_add_u32 m0, s39, 108544
s_add_u32 s37, s37, s38
buffer_load_dwordx4 v22, s[8:11], s37 offen sc1 lds
v_mul_f32 v180, -v82, v60
v_mul_f32 v181, -v82, v61
s_add_u32 m0, s39, 109568
s_add_u32 s37, s37, s38
buffer_load_dwordx4 v23, s[8:11], s37 offen sc1 lds
v_mul_f32 v182, -v82, v62
v_mul_f32 v183, -v82, v63
s_add_u32 m0, s39, 110592
s_add_u32 s37, s37, s38
buffer_load_dwordx4 v22, s[8:11], s37 offen sc1 lds
v_mul_f32 v184, -v84, v60
v_mul_f32 v185, -v84, v61
s_add_u32 m0, s39, 111616
s_add_u32 s37, s37, s38
buffer_load_dwordx4 v23, s[8:11], s37 offen sc1 lds
v_mul_f32 v186, -v84, v62
v_mul_f32 v187, -v84, v63
s_add_u32 m0, s39, 112640
s_add_u32 s37, s37, s38
buffer_load_dwordx4 v22, s[8:11], s37 offen sc1 lds
v_mul_f32 v188, -v86, v60
v_mul_f32 v189, -v86, v61
s_add_u32 m0, s39, 113664
s_add_u32 s37, s37, s38
buffer_load_dwordx4 v23, s[8:11], s37 offen sc1 lds
v_mul_f32 v190, -v86, v62
v_mul_f32 v191, -v86, v63
s_load_dword s64, s[80:81], 0
s_load_dword s65, s[80:81], 64
s_load_dword s66, s[80:81], 128
s_load_dword s67, s[80:81], 192
s_load_dword s68, s[80:81], 256
s_load_dword s69, s[80:81], 320
s_load_dword s70, s[80:81], 384
s_load_dword s71, s[80:81], 448
s_add_u32 s80, s80, 512
s_addc_u32 s81, s81, 0
s_waitcnt vmcnt(16)
s_barrier
s_mul_i32 s43, s49, 192
s_and_b32 s43, s43, 0xffffff80
s_add_u32 s43, s43, 4096
s_cmp_eq_u32 s51, 1
s_cselect_b32 s8, s4, s6
s_cselect_b32 s9, s5, s7
s_sub_u32 s10, 7340032, s43
s_lshl_b32 s44, s34, 18
s_add_u32 s44, s44, 4194304
s_movk_i32 s38, 28672
s_cmp_eq_u32 s51, 0
s_cselect_b32 s8, s32, s8
s_cselect_b32 s9, s33, s9
s_cselect_b32 s10, 262144, s10
s_cselect_b32 s43, s44, s43
s_cselect_b32 s38, 1024, s38
s_cselect_b32 s45, 0, -1
s_add_u32 s8, s8, s43
s_addc_u32 s9, s9, 0
s_mov_b32 s11, 0x20000
s_lshl_b32 s40, s38, 4
s_add_u32 s42, s35, 15
s_lshl_b32 s39, s51, 14
v_lshrrev_b32 v19, 4, v1
v_lshlrev_b32 v20, 5, v19
v_mul_u32_u24 v19, 6912, v19
v_and_b32 v19, s45, v19
v_and_b32 v20, s45, v20
v_lshlrev_b32 v21, 4, v1
v_xor_b32 v21, v21, v20
v_add_u32 v22, v21, v19
s_and_b32 s45, s45, 128
v_xor_b32 v23, s45, v22
s_add_u32 s42, s42, 1
s_and_b32 s42, s42, 15
s_add_u32 m0, s39, 0
s_mul_i32 s37, s42, s40
buffer_load_dwordx4 v22, s[8:11], s37 offen sc1 lds
v_mul_f32 v192, -v80, v64
v_mul_f32 v193, -v80, v65
s_add_u32 m0, s39, 1024
s_add_u32 s37, s37, s38
buffer_load_dwordx4 v23, s[8:11], s37 offen sc1 lds
v_mul_f32 v194, -v80, v66
v_mul_f32 v195, -v80, v67
s_add_u32 m0, s39, 2048
s_add_u32 s37, s37, s38
buffer_load_dwordx4 v22, s[8:11], s37 offen sc1 lds
v_mul_f32 v196, -v82, v64
v_mul_f32 v197, -v82, v65
s_add_u32 m0, s39, 3072
s_add_u32 s37, s37, s38
buffer_load_dwordx4 v23, s[8:11], s37 offen sc1 lds
v_mul_f32 v198, -v82, v66
v_mul_f32 v199, -v82, v67
s_add_u32 m0, s39, 4096
s_add_u32 s37, s37, s38
buffer_load_dwordx4 v22, s[8:11], s37 offen sc1 lds
v_mul_f32 v200, -v84, v64
v_mul_f32 v201, -v84, v65
s_add_u32 m0, s39, 5120
s_add_u32 s37, s37, s38
buffer_load_dwordx4 v23, s[8:11], s37 offen sc1 lds
v_mul_f32 v202, -v84, v66
v_mul_f32 v203, -v84, v67
s_add_u32 m0, s39, 6144
s_add_u32 s37, s37, s38
buffer_load_dwordx4 v22, s[8:11], s37 offen sc1 lds
v_mul_f32 v204, -v86, v64
v_mul_f32 v205, -v86, v65
s_add_u32 m0, s39, 7168
s_add_u32 s37, s37, s38
buffer_load_dwordx4 v23, s[8:11], s37 offen sc1 lds
v_mul_f32 v206, -v86, v66
v_mul_f32 v207, -v86, v67
s_add_u32 m0, s39, 8192
s_add_u32 s37, s37, s38
buffer_load_dwordx4 v22, s[8:11], s37 offen sc1 lds
v_mul_f32 v208, -v80, v68
v_mul_f32 v209, -v80, v69
s_add_u32 m0, s39, 9216
s_add_u32 s37, s37, s38
buffer_load_dwordx4 v23, s[8:11], s37 offen sc1 lds
v_mul_f32 v210, -v80, v70
v_mul_f32 v211, -v80, v71
s_add_u32 m0, s39, 10240
s_add_u32 s37, s37, s38
buffer_load_dwordx4 v22, s[8:11], s37 offen sc1 lds
v_mul_f32 v212, -v82, v68
v_mul_f32 v213, -v82, v69
s_add_u32 m0, s39, 11264
s_add_u32 s37, s37, s38
buffer_load_dwordx4 v23, s[8:11], s37 offen sc1 lds
v_mul_f32 v214, -v82, v70
v_mul_f32 v215, -v82, v71
s_add_u32 m0, s39, 12288
s_add_u32 s37, s37, s38
buffer_load_dwordx4 v22, s[8:11], s37 offen sc1 lds
v_mul_f32 v216, -v84, v68
v_mul_f32 v217, -v84, v69
s_add_u32 m0, s39, 13312
s_add_u32 s37, s37, s38
buffer_load_dwordx4 v23, s[8:11], s37 offen sc1 lds
v_mul_f32 v218, -v84, v70
v_mul_f32 v219, -v84, v71
s_add_u32 m0, s39, 14336
s_add_u32 s37, s37, s38
buffer_load_dwordx4 v22, s[8:11], s37 offen sc1 lds
v_mul_f32 v220, -v86, v68
v_mul_f32 v221, -v86, v69
s_add_u32 m0, s39, 15360
s_add_u32 s37, s37, s38
buffer_load_dwordx4 v23, s[8:11], s37 offen sc1 lds
v_mul_f32 v222, -v86, v70
v_mul_f32 v223, -v86, v71
s_load_dword s64, s[80:81], 0
s_load_dword s65, s[80:81], 64
s_load_dword s66, s[80:81], 128
s_load_dword s67, s[80:81], 192
s_load_dword s68, s[80:81], 256
s_load_dword s69, s[80:81], 320
s_load_dword s70, s[80:81], 384
s_add_u32 s80, s80, 448
s_addc_u32 s81, s81, 0
s_waitcnt vmcnt(16)
s_barrier
s_add_u32 s42, s42, 1
s_and_b32 s42, s42, 15
s_add_u32 m0, s39, 49152
s_mul_i32 s37, s42, s40
buffer_load_dwordx4 v22, s[8:11], s37 offen sc1 lds
s_add_u32 m0, s39, 50176
s_add_u32 s37, s37, s38
buffer_load_dwordx4 v23, s[8:11], s37 offen sc1 lds
s_add_u32 m0, s39, 51200
s_add_u32 s37, s37, s38
buffer_load_dwordx4 v22, s[8:11], s37 offen sc1 lds
s_add_u32 m0, s39, 52224
s_add_u32 s37, s37, s38
buffer_load_dwordx4 v23, s[8:11], s37 offen sc1 lds
s_add_u32 m0, s39, 53248
s_add_u32 s37, s37, s38
buffer_load_dwordx4 v22, s[8:11], s37 offen sc1 lds
s_add_u32 m0, s39, 54272
s_add_u32 s37, s37, s38
buffer_load_dwordx4 v23, s[8:11], s37 offen sc1 lds
s_add_u32 m0, s39, 55296
s_add_u32 s37, s37, s38
buffer_load_dwordx4 v22, s[8:11], s37 offen sc1 lds
s_add_u32 m0, s39, 56320
s_add_u32 s37, s37, s38
buffer_load_dwordx4 v23, s[8:11], s37 offen sc1 lds
s_add_u32 m0, s39, 57344
s_add_u32 s37, s37, s38
buffer_load_dwordx4 v22, s[8:11], s37 offen sc1 lds
s_add_u32 m0, s39, 58368
s_add_u32 s37, s37, s38
buffer_load_dwordx4 v23, s[8:11], s37 offen sc1 lds
s_add_u32 m0, s39, 59392
s_add_u32 s37, s37, s38
buffer_load_dwordx4 v22, s[8:11], s37 offen sc1 lds
s_add_u32 m0, s39, 60416
s_add_u32 s37, s37, s38
buffer_load_dwordx4 v23, s[8:11], s37 offen sc1 lds
s_add_u32 m0, s39, 61440
s_add_u32 s37, s37, s38
buffer_load_dwordx4 v22, s[8:11], s37 offen sc1 lds
s_add_u32 m0, s39, 62464
s_add_u32 s37, s37, s38
buffer_load_dwordx4 v23, s[8:11], s37 offen sc1 lds
s_add_u32 m0, s39, 63488
s_add_u32 s37, s37, s38
buffer_load_dwordx4 v22, s[8:11], s37 offen sc1 lds
s_add_u32 m0, s39, 64512
s_add_u32 s37, s37, s38
buffer_load_dwordx4 v23, s[8:11], s37 offen sc1 lds
s_mul_i32 s44, s34, 917504
s_lshl_b32 s39, s51, 13
s_add_u32 s44, s44, s39
s_add_u32 s44, s44, 8388608
s_and_b32 s43, s51, 1
s_xor_b32 s43, s43, s35
s_lshl_b32 s43, s43, 7
s_mov_b32 s10, 909312
s_movk_i32 s38, 1024
s_movk_i32 s40, 9216
s_movk_i32 s37, 0x4000
s_cmp_ge_u32 s51, 2
s_cselect_b32 s8, s60, s32
s_cselect_b32 s9, s61, s33
s_cselect_b32 s10, 7338112, s10
s_cselect_b32 s43, s43, s44
s_cselect_b32 s38, 16384, s38
s_cselect_b32 s40, 81920, s40
s_cselect_b32 s55, 81920, s38
s_cselect_b32 s37, 262144, s37
s_cselect_b32 s45, -1, 0
s_add_u32 s8, s8, s43
s_addc_u32 s9, s9, 0
s_mov_b32 s11, 0x20000
s_and_b32 s53, s35, 1
s_mul_i32 s54, s53, 6
s_mul_i32 s54, s54, s37
s_mul_i32 s29, s53, 2
s_add_u32 s29, s29, 6
s_mul_i32 s29, s29, s37
s_and_b32 s43, s45, 4290838528
s_add_u32 s29, s29, s43
s_mul_i32 s37, s37, 2
s_sub_u32 s37, s37, s40
v_lshrrev_b32 v19, 3, v1
v_mul_u32_u24 v19, 1920, v19
v_lshrrev_b32 v20, 4, v1
v_lshlrev_b32 v20, 5, v20
v_and_b32 v19, s45, v19
v_and_b32 v20, s45, v20
v_lshlrev_b32 v21, 4, v1
v_xor_b32 v21, v21, v20
v_add_u32 v21, v21, v19
s_waitcnt vmcnt(16)
s_barrier
s_branch LK3b_36
L7_35:
s_lshr_b32 s43, s2, 5
s_cmp_eq_u32 s43, 3
s_cbranch_scc1 Lnojob_48
s_cmp_gt_u32 s43, 3
s_cselect_b32 s43, 32, 0
s_sub_u32 s43, s2, s43
s_lshr_b32 s43, s43, 1
s_and_b32 s44, s2, 1
s_cmp_eq_u32 s44, 0
s_cselect_b32 s68, s4, s6
s_cselect_b32 s69, s5, s7
s_mul_i32 s45, s43, 2341
s_lshr_b32 s45, s45, 16
s_mul_i32 s46, s45, 28
s_sub_u32 s46, s43, s46
v_lshrrev_b32 v4, 4, v1
s_lshl_b32 s43, s45, 8
v_add_u32 v4, s43, v4
v_mul_u32_u24 v4, 7168, v4
v_and_b32 v5, 15, v1
v_lshl_add_u32 v4, v5, 4, v4
s_lshl_b32 s43, s46, 8
v_add_u32 v4, s43, v4
s_mov_b32 s64, s68
s_mov_b32 s65, s69
s_mov_b32 s66, 7340032
s_mov_b32 s67, 0x20000
s_lshl_b32 s55, s45, 1
s_add_u32 s55, s55, s44
s_mul_i32 s55, s55, 14336
s_lshl_b32 s45, s46, 9
s_mov_b32 s50, s46
s_add_u32 s55, s55, s45
v_lshl_add_u32 v5, v5, 5, s55
s_add_u32 s72, s32, 27262976
s_addc_u32 s73, s33, 0
s_mov_b32 s74, 114688
s_mov_b32 s75, 0x20000
v_mov_b32 v32, 0
v_mov_b32 v33, 0
v_mov_b32 v34, 0
v_mov_b32 v35, 0
v_mov_b32 v36, 0
v_mov_b32 v37, 0
v_mov_b32 v38, 0
v_mov_b32 v39, 0
s_lshl_b32 s43, s34, 18
s_add_u32 s12, s32, s43
s_addc_u32 s13, s33, 0
s_mov_b32 s14, 262144
s_mov_b32 s15, 0x20000
v_lshlrev_b32 v21, 4, v1
s_lshl_b32 s54, s36, 11
s_add_u32 s43, s35, 1
s_and_b32 s43, s43, 15
s_lshl_b32 s43, s43, 14
s_add_u32 s30, s43, s54
s_add_u32 s43, s35, 2
s_and_b32 s43, s43, 15
s_lshl_b32 s43, s43, 14
s_add_u32 s31, s43, s54
s_waitcnt vmcnt(0)
s_barrier
ds_write_b128 v27, v[68:71] offset:0
ds_write_b128 v27, v[116:119] offset:512
s_mov_b32 s43, 917504
buffer_load_dwordx4 v[56:59], v4, s[64:67], s43 offen
s_mov_b32 s43, 946176
buffer_load_dwordx4 v[60:63], v4, s[64:67], s43 offen
s_mov_b32 s43, 974848
buffer_load_dwordx4 v[64:67], v4, s[64:67], s43 offen
s_mov_b32 s43, 1003520
buffer_load_dwordx4 v[72:75], v4, s[64:67], s43 offen
s_mov_b32 s43, 1032192
buffer_load_dwordx4 v[76:79], v4, s[64:67], s43 offen
s_mov_b32 s43, 1060864
buffer_load_dwordx4 v[80:83], v4, s[64:67], s43 offen
s_mov_b32 s43, 1089536
buffer_load_dwordx4 v[84:87], v4, s[64:67], s43 offen
s_mov_b32 s43, 1118208
buffer_load_dwordx4 v[88:91], v4, s[64:67], s43 offen
s_mov_b32 s43, 1146880
buffer_load_dwordx4 v[92:95], v4, s[64:67], s43 offen
s_mov_b32 s43, 1175552
buffer_load_dwordx4 v[96:99], v4, s[64:67], s43 offen
s_mov_b32 s43, 1204224
buffer_load_dwordx4 v[100:103], v4, s[64:67], s43 offen
s_mov_b32 s43, 1232896
buffer_load_dwordx4 v[104:107], v4, s[64:67], s43 offen
s_mov_b32 s43, 1261568
buffer_load_dwordx4 v[108:111], v4, s[64:67], s43 offen
s_mov_b32 s43, 1290240
buffer_load_dwordx4 v[112:115], v4, s[64:67], s43 offen
s_mov_b32 s43, 1318912
buffer_load_dwordx4 v[120:123], v4, s[64:67], s43 offen
s_mov_b32 s43, 1347584
buffer_load_dwordx4 v[124:127], v4, s[64:67], s43 offen
v_lshlrev_b32 v40, 16, v128
v_and_b32 v41, 0xffff0000, v128
v_lshlrev_b32 v42, 16, v129
v_and_b32 v43, 0xffff0000, v129
v_lshlrev_b32 v44, 16, v130
v_and_b32 v45, 0xffff0000, v130
v_lshlrev_b32 v46, 16, v131
v_and_b32 v47, 0xffff0000, v131
v_pk_add_f32 v[32:33], v[32:33], v[40:41]
v_pk_add_f32 v[34:35], v[34:35], v[42:43]
v_pk_add_f32 v[36:37], v[36:37], v[44:45]
v_pk_add_f32 v[38:39], v[38:39], v[46:47]
v_lshlrev_b32 v48, 16, v132
v_and_b32 v49, 0xffff0000, v132
v_lshlrev_b32 v50, 16, v133
v_and_b32 v51, 0xffff0000, v133
v_lshlrev_b32 v52, 16, v134
v_and_b32 v53, 0xffff0000, v134
v_lshlrev_b32 v54, 16, v135
v_and_b32 v55, 0xffff0000, v135
v_pk_add_f32 v[32:33], v[32:33], v[48:49]
v_pk_add_f32 v[34:35], v[34:35], v[50:51]
v_pk_add_f32 v[36:37], v[36:37], v[52:53]
v_pk_add_f32 v[38:39], v[38:39], v[54:55]
v_lshlrev_b32 v40, 16, v136
v_and_b32 v41, 0xffff0000, v136
v_lshlrev_b32 v42, 16, v137
v_and_b32 v43, 0xffff0000, v137
v_lshlrev_b32 v44, 16, v138
v_and_b32 v45, 0xffff0000, v138
v_lshlrev_b32 v46, 16, v139
v_and_b32 v47, 0xffff0000, v139
v_pk_add_f32 v[32:33], v[32:33], v[40:41]
v_pk_add_f32 v[34:35], v[34:35], v[42:43]
v_pk_add_f32 v[36:37], v[36:37], v[44:45]
v_pk_add_f32 v[38:39], v[38:39], v[46:47]
v_lshlrev_b32 v48, 16, v140
v_and_b32 v49, 0xffff0000, v140
v_lshlrev_b32 v50, 16, v141
v_and_b32 v51, 0xffff0000, v141
v_lshlrev_b32 v52, 16, v142
v_and_b32 v53, 0xffff0000, v142
v_lshlrev_b32 v54, 16, v143
v_and_b32 v55, 0xffff0000, v143
v_pk_add_f32 v[32:33], v[32:33], v[48:49]
v_pk_add_f32 v[34:35], v[34:35], v[50:51]
v_pk_add_f32 v[36:37], v[36:37], v[52:53]
v_pk_add_f32 v[38:39], v[38:39], v[54:55]
v_lshlrev_b32 v40, 16, v144
v_and_b32 v41, 0xffff0000, v144
v_lshlrev_b32 v42, 16, v145
v_and_b32 v43, 0xffff0000, v145
v_lshlrev_b32 v44, 16, v146
v_and_b32 v45, 0xffff0000, v146
v_lshlrev_b32 v46, 16, v147
v_and_b32 v47, 0xffff0000, v147
v_pk_add_f32 v[32:33], v[32:33], v[40:41]
v_pk_add_f32 v[34:35], v[34:35], v[42:43]
v_pk_add_f32 v[36:37], v[36:37], v[44:45]
v_pk_add_f32 v[38:39], v[38:39], v[46:47]
v_lshlrev_b32 v48, 16, v148
v_and_b32 v49, 0xffff0000, v148
v_lshlrev_b32 v50, 16, v149
v_and_b32 v51, 0xffff0000, v149
v_lshlrev_b32 v52, 16, v150
v_and_b32 v53, 0xffff0000, v150
v_lshlrev_b32 v54, 16, v151
v_and_b32 v55, 0xffff0000, v151
v_pk_add_f32 v[32:33], v[32:33], v[48:49]
v_pk_add_f32 v[34:35], v[34:35], v[50:51]
v_pk_add_f32 v[36:37], v[36:37], v[52:53]
v_pk_add_f32 v[38:39], v[38:39], v[54:55]
v_lshlrev_b32 v40, 16, v152
v_and_b32 v41, 0xffff0000, v152
v_lshlrev_b32 v42, 16, v153
v_and_b32 v43, 0xffff0000, v153
v_lshlrev_b32 v44, 16, v154
v_and_b32 v45, 0xffff0000, v154
v_lshlrev_b32 v46, 16, v155
v_and_b32 v47, 0xffff0000, v155
v_pk_add_f32 v[32:33], v[32:33], v[40:41]
v_pk_add_f32 v[34:35], v[34:35], v[42:43]
v_pk_add_f32 v[36:37], v[36:37], v[44:45]
v_pk_add_f32 v[38:39], v[38:39], v[46:47]
v_lshlrev_b32 v48, 16, v156
v_and_b32 v49, 0xffff0000, v156
v_lshlrev_b32 v50, 16, v157
v_and_b32 v51, 0xffff0000, v157
v_lshlrev_b32 v52, 16, v158
v_and_b32 v53, 0xffff0000, v158
v_lshlrev_b32 v54, 16, v159
v_and_b32 v55, 0xffff0000, v159
v_pk_add_f32 v[32:33], v[32:33], v[48:49]
v_pk_add_f32 v[34:35], v[34:35], v[50:51]
v_pk_add_f32 v[36:37], v[36:37], v[52:53]
v_pk_add_f32 v[38:39], v[38:39], v[54:55]
s_waitcnt lgkmcnt(0)
s_barrier
s_add_u32 m0, s54, 16384
s_add_u32 s43, s30, 0
buffer_load_dwordx4 v21, s[12:15], s43 offen sc1 lds
s_add_u32 m0, s54, 17408
s_add_u32 s43, s30, 1024
buffer_load_dwordx4 v21, s[12:15], s43 offen sc1 lds
s_add_u32 m0, s54, 32768
s_add_u32 s43, s31, 0
buffer_load_dwordx4 v21, s[12:15], s43 offen sc1 lds
s_add_u32 m0, s54, 33792
s_add_u32 s43, s31, 1024
buffer_load_dwordx4 v21, s[12:15], s43 offen sc1 lds
s_waitcnt vmcnt(2)
s_barrier
s_waitcnt vmcnt(0)
s_barrier
v_lshlrev_b32 v40, 16, v160
v_and_b32 v41, 0xffff0000, v160
v_lshlrev_b32 v42, 16, v161
v_and_b32 v43, 0xffff0000, v161
v_lshlrev_b32 v44, 16, v162
v_and_b32 v45, 0xffff0000, v162
v_lshlrev_b32 v46, 16, v163
v_and_b32 v47, 0xffff0000, v163
v_pk_add_f32 v[32:33], v[32:33], v[40:41]
v_pk_add_f32 v[34:35], v[34:35], v[42:43]
v_pk_add_f32 v[36:37], v[36:37], v[44:45]
v_pk_add_f32 v[38:39], v[38:39], v[46:47]
v_lshlrev_b32 v48, 16, v164
v_and_b32 v49, 0xffff0000, v164
v_lshlrev_b32 v50, 16, v165
v_and_b32 v51, 0xffff0000, v165
v_lshlrev_b32 v52, 16, v166
v_and_b32 v53, 0xffff0000, v166
v_lshlrev_b32 v54, 16, v167
v_and_b32 v55, 0xffff0000, v167
v_pk_add_f32 v[32:33], v[32:33], v[48:49]
v_pk_add_f32 v[34:35], v[34:35], v[50:51]
v_pk_add_f32 v[36:37], v[36:37], v[52:53]
v_pk_add_f32 v[38:39], v[38:39], v[54:55]
v_lshlrev_b32 v40, 16, v168
v_and_b32 v41, 0xffff0000, v168
v_lshlrev_b32 v42, 16, v169
v_and_b32 v43, 0xffff0000, v169
v_lshlrev_b32 v44, 16, v170
v_and_b32 v45, 0xffff0000, v170
v_lshlrev_b32 v46, 16, v171
v_and_b32 v47, 0xffff0000, v171
v_pk_add_f32 v[32:33], v[32:33], v[40:41]
v_pk_add_f32 v[34:35], v[34:35], v[42:43]
v_pk_add_f32 v[36:37], v[36:37], v[44:45]
v_pk_add_f32 v[38:39], v[38:39], v[46:47]
v_lshlrev_b32 v48, 16, v172
v_and_b32 v49, 0xffff0000, v172
v_lshlrev_b32 v50, 16, v173
v_and_b32 v51, 0xffff0000, v173
v_lshlrev_b32 v52, 16, v174
v_and_b32 v53, 0xffff0000, v174
v_lshlrev_b32 v54, 16, v175
v_and_b32 v55, 0xffff0000, v175
v_pk_add_f32 v[32:33], v[32:33], v[48:49]
v_pk_add_f32 v[34:35], v[34:35], v[50:51]
v_pk_add_f32 v[36:37], v[36:37], v[52:53]
v_pk_add_f32 v[38:39], v[38:39], v[54:55]
s_barrier
v_lshlrev_b32 v40, 16, v176
v_and_b32 v41, 0xffff0000, v176
v_lshlrev_b32 v42, 16, v177
v_and_b32 v43, 0xffff0000, v177
v_lshlrev_b32 v44, 16, v178
v_and_b32 v45, 0xffff0000, v178
v_lshlrev_b32 v46, 16, v179
v_and_b32 v47, 0xffff0000, v179
v_pk_add_f32 v[32:33], v[32:33], v[40:41]
v_pk_add_f32 v[34:35], v[34:35], v[42:43]
v_pk_add_f32 v[36:37], v[36:37], v[44:45]
v_pk_add_f32 v[38:39], v[38:39], v[46:47]
v_lshlrev_b32 v48, 16, v180
v_and_b32 v49, 0xffff0000, v180
v_lshlrev_b32 v50, 16, v181
v_and_b32 v51, 0xffff0000, v181
v_lshlrev_b32 v52, 16, v182
v_and_b32 v53, 0xffff0000, v182
v_lshlrev_b32 v54, 16, v183
v_and_b32 v55, 0xffff0000, v183
v_pk_add_f32 v[32:33], v[32:33], v[48:49]
v_pk_add_f32 v[34:35], v[34:35], v[50:51]
v_pk_add_f32 v[36:37], v[36:37], v[52:53]
v_pk_add_f32 v[38:39], v[38:39], v[54:55]
v_lshlrev_b32 v40, 16, v184
v_and_b32 v41, 0xffff0000, v184
v_lshlrev_b32 v42, 16, v185
v_and_b32 v43, 0xffff0000, v185
v_lshlrev_b32 v44, 16, v186
v_and_b32 v45, 0xffff0000, v186
v_lshlrev_b32 v46, 16, v187
v_and_b32 v47, 0xffff0000, v187
v_pk_add_f32 v[32:33], v[32:33], v[40:41]
v_pk_add_f32 v[34:35], v[34:35], v[42:43]
v_pk_add_f32 v[36:37], v[36:37], v[44:45]
v_pk_add_f32 v[38:39], v[38:39], v[46:47]
v_lshlrev_b32 v48, 16, v188
v_and_b32 v49, 0xffff0000, v188
v_lshlrev_b32 v50, 16, v189
v_and_b32 v51, 0xffff0000, v189
v_lshlrev_b32 v52, 16, v190
v_and_b32 v53, 0xffff0000, v190
v_lshlrev_b32 v54, 16, v191
v_and_b32 v55, 0xffff0000, v191
v_pk_add_f32 v[32:33], v[32:33], v[48:49]
v_pk_add_f32 v[34:35], v[34:35], v[50:51]
v_pk_add_f32 v[36:37], v[36:37], v[52:53]
v_pk_add_f32 v[38:39], v[38:39], v[54:55]
s_barrier
v_lshlrev_b32 v40, 16, v192
v_and_b32 v41, 0xffff0000, v192
v_lshlrev_b32 v42, 16, v193
v_and_b32 v43, 0xffff0000, v193
v_lshlrev_b32 v44, 16, v194
v_and_b32 v45, 0xffff0000, v194
v_lshlrev_b32 v46, 16, v195
v_and_b32 v47, 0xffff0000, v195
v_pk_add_f32 v[32:33], v[32:33], v[40:41]
v_pk_add_f32 v[34:35], v[34:35], v[42:43]
v_pk_add_f32 v[36:37], v[36:37], v[44:45]
v_pk_add_f32 v[38:39], v[38:39], v[46:47]
v_lshlrev_b32 v48, 16, v196
v_and_b32 v49, 0xffff0000, v196
v_lshlrev_b32 v50, 16, v197
v_and_b32 v51, 0xffff0000, v197
v_lshlrev_b32 v52, 16, v198
v_and_b32 v53, 0xffff0000, v198
v_lshlrev_b32 v54, 16, v199
v_and_b32 v55, 0xffff0000, v199
v_pk_add_f32 v[32:33], v[32:33], v[48:49]
v_pk_add_f32 v[34:35], v[34:35], v[50:51]
v_pk_add_f32 v[36:37], v[36:37], v[52:53]
v_pk_add_f32 v[38:39], v[38:39], v[54:55]
v_lshlrev_b32 v40, 16, v200
v_and_b32 v41, 0xffff0000, v200
v_lshlrev_b32 v42, 16, v201
v_and_b32 v43, 0xffff0000, v201
v_lshlrev_b32 v44, 16, v202
v_and_b32 v45, 0xffff0000, v202
v_lshlrev_b32 v46, 16, v203
v_and_b32 v47, 0xffff0000, v203
v_pk_add_f32 v[32:33], v[32:33], v[40:41]
v_pk_add_f32 v[34:35], v[34:35], v[42:43]
v_pk_add_f32 v[36:37], v[36:37], v[44:45]
v_pk_add_f32 v[38:39], v[38:39], v[46:47]
v_lshlrev_b32 v48, 16, v204
v_and_b32 v49, 0xffff0000, v204
v_lshlrev_b32 v50, 16, v205
v_and_b32 v51, 0xffff0000, v205
v_lshlrev_b32 v52, 16, v206
v_and_b32 v53, 0xffff0000, v206
v_lshlrev_b32 v54, 16, v207
v_and_b32 v55, 0xffff0000, v207
v_pk_add_f32 v[32:33], v[32:33], v[48:49]
v_pk_add_f32 v[34:35], v[34:35], v[50:51]
v_pk_add_f32 v[36:37], v[36:37], v[52:53]
v_pk_add_f32 v[38:39], v[38:39], v[54:55]
s_barrier
v_lshlrev_b32 v40, 16, v208
v_and_b32 v41, 0xffff0000, v208
v_lshlrev_b32 v42, 16, v209
v_and_b32 v43, 0xffff0000, v209
v_lshlrev_b32 v44, 16, v210
v_and_b32 v45, 0xffff0000, v210
v_lshlrev_b32 v46, 16, v211
v_and_b32 v47, 0xffff0000, v211
v_pk_add_f32 v[32:33], v[32:33], v[40:41]
v_pk_add_f32 v[34:35], v[34:35], v[42:43]
v_pk_add_f32 v[36:37], v[36:37], v[44:45]
v_pk_add_f32 v[38:39], v[38:39], v[46:47]
v_lshlrev_b32 v48, 16, v212
v_and_b32 v49, 0xffff0000, v212
v_lshlrev_b32 v50, 16, v213
v_and_b32 v51, 0xffff0000, v213
v_lshlrev_b32 v52, 16, v214
v_and_b32 v53, 0xffff0000, v214
v_lshlrev_b32 v54, 16, v215
v_and_b32 v55, 0xffff0000, v215
v_pk_add_f32 v[32:33], v[32:33], v[48:49]
v_pk_add_f32 v[34:35], v[34:35], v[50:51]
v_pk_add_f32 v[36:37], v[36:37], v[52:53]
v_pk_add_f32 v[38:39], v[38:39], v[54:55]
v_lshlrev_b32 v40, 16, v216
v_and_b32 v41, 0xffff0000, v216
v_lshlrev_b32 v42, 16, v217
v_and_b32 v43, 0xffff0000, v217
v_lshlrev_b32 v44, 16, v218
v_and_b32 v45, 0xffff0000, v218
v_lshlrev_b32 v46, 16, v219
v_and_b32 v47, 0xffff0000, v219
v_pk_add_f32 v[32:33], v[32:33], v[40:41]
v_pk_add_f32 v[34:35], v[34:35], v[42:43]
v_pk_add_f32 v[36:37], v[36:37], v[44:45]
v_pk_add_f32 v[38:39], v[38:39], v[46:47]
v_lshlrev_b32 v48, 16, v220
v_and_b32 v49, 0xffff0000, v220
v_lshlrev_b32 v50, 16, v221
v_and_b32 v51, 0xffff0000, v221
v_lshlrev_b32 v52, 16, v222
v_and_b32 v53, 0xffff0000, v222
v_lshlrev_b32 v54, 16, v223
v_and_b32 v55, 0xffff0000, v223
v_pk_add_f32 v[32:33], v[32:33], v[48:49]
v_pk_add_f32 v[34:35], v[34:35], v[50:51]
v_pk_add_f32 v[36:37], v[36:37], v[52:53]
v_pk_add_f32 v[38:39], v[38:39], v[54:55]
s_barrier
v_lshlrev_b32 v40, 16, v224
v_and_b32 v41, 0xffff0000, v224
v_lshlrev_b32 v42, 16, v225
v_and_b32 v43, 0xffff0000, v225
v_lshlrev_b32 v44, 16, v226
v_and_b32 v45, 0xffff0000, v226
v_lshlrev_b32 v46, 16, v227
v_and_b32 v47, 0xffff0000, v227
v_pk_add_f32 v[32:33], v[32:33], v[40:41]
v_pk_add_f32 v[34:35], v[34:35], v[42:43]
v_pk_add_f32 v[36:37], v[36:37], v[44:45]
v_pk_add_f32 v[38:39], v[38:39], v[46:47]
v_lshlrev_b32 v48, 16, v228
v_and_b32 v49, 0xffff0000, v228
v_lshlrev_b32 v50, 16, v229
v_and_b32 v51, 0xffff0000, v229
v_lshlrev_b32 v52, 16, v230
v_and_b32 v53, 0xffff0000, v230
v_lshlrev_b32 v54, 16, v231
v_and_b32 v55, 0xffff0000, v231
v_pk_add_f32 v[32:33], v[32:33], v[48:49]
v_pk_add_f32 v[34:35], v[34:35], v[50:51]
v_pk_add_f32 v[36:37], v[36:37], v[52:53]
v_pk_add_f32 v[38:39], v[38:39], v[54:55]
v_lshlrev_b32 v40, 16, v232
v_and_b32 v41, 0xffff0000, v232
v_lshlrev_b32 v42, 16, v233
v_and_b32 v43, 0xffff0000, v233
v_lshlrev_b32 v44, 16, v234
v_and_b32 v45, 0xffff0000, v234
v_lshlrev_b32 v46, 16, v235
v_and_b32 v47, 0xffff0000, v235
v_pk_add_f32 v[32:33], v[32:33], v[40:41]
v_pk_add_f32 v[34:35], v[34:35], v[42:43]
v_pk_add_f32 v[36:37], v[36:37], v[44:45]
v_pk_add_f32 v[38:39], v[38:39], v[46:47]
v_lshlrev_b32 v48, 16, v236
v_and_b32 v49, 0xffff0000, v236
v_lshlrev_b32 v50, 16, v237
v_and_b32 v51, 0xffff0000, v237
v_lshlrev_b32 v52, 16, v238
v_and_b32 v53, 0xffff0000, v238
v_lshlrev_b32 v54, 16, v239
v_and_b32 v55, 0xffff0000, v239
v_pk_add_f32 v[32:33], v[32:33], v[48:49]
v_pk_add_f32 v[34:35], v[34:35], v[50:51]
v_pk_add_f32 v[36:37], v[36:37], v[52:53]
v_pk_add_f32 v[38:39], v[38:39], v[54:55]
s_barrier
v_lshlrev_b32 v40, 16, v240
v_and_b32 v41, 0xffff0000, v240
v_lshlrev_b32 v42, 16, v241
v_and_b32 v43, 0xffff0000, v241
v_lshlrev_b32 v44, 16, v242
v_and_b32 v45, 0xffff0000, v242
v_lshlrev_b32 v46, 16, v243
v_and_b32 v47, 0xffff0000, v243
v_pk_add_f32 v[32:33], v[32:33], v[40:41]
v_pk_add_f32 v[34:35], v[34:35], v[42:43]
v_pk_add_f32 v[36:37], v[36:37], v[44:45]
v_pk_add_f32 v[38:39], v[38:39], v[46:47]
v_lshlrev_b32 v48, 16, v244
v_and_b32 v49, 0xffff0000, v244
v_lshlrev_b32 v50, 16, v245
v_and_b32 v51, 0xffff0000, v245
v_lshlrev_b32 v52, 16, v246
v_and_b32 v53, 0xffff0000, v246
v_lshlrev_b32 v54, 16, v247
v_and_b32 v55, 0xffff0000, v247
v_pk_add_f32 v[32:33], v[32:33], v[48:49]
v_pk_add_f32 v[34:35], v[34:35], v[50:51]
v_pk_add_f32 v[36:37], v[36:37], v[52:53]
v_pk_add_f32 v[38:39], v[38:39], v[54:55]
v_lshlrev_b32 v40, 16, v248
v_and_b32 v41, 0xffff0000, v248
v_lshlrev_b32 v42, 16, v249
v_and_b32 v43, 0xffff0000, v249
v_lshlrev_b32 v44, 16, v250
v_and_b32 v45, 0xffff0000, v250
v_lshlrev_b32 v46, 16, v251
v_and_b32 v47, 0xffff0000, v251
v_pk_add_f32 v[32:33], v[32:33], v[40:41]
v_pk_add_f32 v[34:35], v[34:35], v[42:43]
v_pk_add_f32 v[36:37], v[36:37], v[44:45]
v_pk_add_f32 v[38:39], v[38:39], v[46:47]
v_lshlrev_b32 v48, 16, v252
v_and_b32 v49, 0xffff0000, v252
v_lshlrev_b32 v50, 16, v253
v_and_b32 v51, 0xffff0000, v253
v_lshlrev_b32 v52, 16, v254
v_and_b32 v53, 0xffff0000, v254
v_lshlrev_b32 v54, 16, v255
v_and_b32 v55, 0xffff0000, v255
v_pk_add_f32 v[32:33], v[32:33], v[48:49]
v_pk_add_f32 v[34:35], v[34:35], v[50:51]
v_pk_add_f32 v[36:37], v[36:37], v[52:53]
v_pk_add_f32 v[38:39], v[38:39], v[54:55]
s_barrier
s_mov_b32 s43, 1376256
buffer_load_dwordx4 v[128:131], v4, s[64:67], s43 offen
s_mov_b32 s43, 1404928
buffer_load_dwordx4 v[132:135], v4, s[64:67], s43 offen
s_mov_b32 s43, 1433600
buffer_load_dwordx4 v[136:139], v4, s[64:67], s43 offen
s_mov_b32 s43, 1462272
buffer_load_dwordx4 v[140:143], v4, s[64:67], s43 offen
s_mov_b32 s43, 1490944
buffer_load_dwordx4 v[144:147], v4, s[64:67], s43 offen
s_mov_b32 s43, 1519616
buffer_load_dwordx4 v[148:151], v4, s[64:67], s43 offen
s_mov_b32 s43, 1548288
buffer_load_dwordx4 v[152:155], v4, s[64:67], s43 offen
s_mov_b32 s43, 1576960
buffer_load_dwordx4 v[156:159], v4, s[64:67], s43 offen
s_mov_b32 s43, 1605632
buffer_load_dwordx4 v[160:163], v4, s[64:67], s43 offen
s_mov_b32 s43, 1634304
buffer_load_dwordx4 v[164:167], v4, s[64:67], s43 offen
s_mov_b32 s43, 1662976
buffer_load_dwordx4 v[168:171], v4, s[64:67], s43 offen
s_mov_b32 s43, 1691648
buffer_load_dwordx4 v[172:175], v4, s[64:67], s43 offen
s_mov_b32 s43, 1720320
buffer_load_dwordx4 v[176:179], v4, s[64:67], s43 offen
s_mov_b32 s43, 1748992
buffer_load_dwordx4 v[180:183], v4, s[64:67], s43 offen
s_mov_b32 s43, 1777664
buffer_load_dwordx4 v[184:187], v4, s[64:67], s43 offen
s_mov_b32 s43, 1806336
buffer_load_dwordx4 v[188:191], v4, s[64:67], s43 offen
s_barrier
v_lshlrev_b32 v40, 16, v56
v_and_b32 v41, 0xffff0000, v56
v_lshlrev_b32 v42, 16, v57
v_and_b32 v43, 0xffff0000, v57
v_lshlrev_b32 v44, 16, v58
v_and_b32 v45, 0xffff0000, v58
v_lshlrev_b32 v46, 16, v59
v_and_b32 v47, 0xffff0000, v59
v_pk_add_f32 v[32:33], v[32:33], v[40:41]
v_pk_add_f32 v[34:35], v[34:35], v[42:43]
v_pk_add_f32 v[36:37], v[36:37], v[44:45]
v_pk_add_f32 v[38:39], v[38:39], v[46:47]
v_lshlrev_b32 v48, 16, v60
v_and_b32 v49, 0xffff0000, v60
v_lshlrev_b32 v50, 16, v61
v_and_b32 v51, 0xffff0000, v61
v_lshlrev_b32 v52, 16, v62
v_and_b32 v53, 0xffff0000, v62
v_lshlrev_b32 v54, 16, v63
v_and_b32 v55, 0xffff0000, v63
v_pk_add_f32 v[32:33], v[32:33], v[48:49]
v_pk_add_f32 v[34:35], v[34:35], v[50:51]
v_pk_add_f32 v[36:37], v[36:37], v[52:53]
v_pk_add_f32 v[38:39], v[38:39], v[54:55]
v_lshlrev_b32 v40, 16, v64
v_and_b32 v41, 0xffff0000, v64
v_lshlrev_b32 v42, 16, v65
v_and_b32 v43, 0xffff0000, v65
v_lshlrev_b32 v44, 16, v66
v_and_b32 v45, 0xffff0000, v66
v_lshlrev_b32 v46, 16, v67
v_and_b32 v47, 0xffff0000, v67
v_pk_add_f32 v[32:33], v[32:33], v[40:41]
v_pk_add_f32 v[34:35], v[34:35], v[42:43]
v_pk_add_f32 v[36:37], v[36:37], v[44:45]
v_pk_add_f32 v[38:39], v[38:39], v[46:47]
v_lshlrev_b32 v48, 16, v72
v_and_b32 v49, 0xffff0000, v72
v_lshlrev_b32 v50, 16, v73
v_and_b32 v51, 0xffff0000, v73
v_lshlrev_b32 v52, 16, v74
v_and_b32 v53, 0xffff0000, v74
v_lshlrev_b32 v54, 16, v75
v_and_b32 v55, 0xffff0000, v75
v_pk_add_f32 v[32:33], v[32:33], v[48:49]
v_pk_add_f32 v[34:35], v[34:35], v[50:51]
v_pk_add_f32 v[36:37], v[36:37], v[52:53]
v_pk_add_f32 v[38:39], v[38:39], v[54:55]
s_barrier
v_lshlrev_b32 v40, 16, v76
v_and_b32 v41, 0xffff0000, v76
v_lshlrev_b32 v42, 16, v77
v_and_b32 v43, 0xffff0000, v77
v_lshlrev_b32 v44, 16, v78
v_and_b32 v45, 0xffff0000, v78
v_lshlrev_b32 v46, 16, v79
v_and_b32 v47, 0xffff0000, v79
v_pk_add_f32 v[32:33], v[32:33], v[40:41]
v_pk_add_f32 v[34:35], v[34:35], v[42:43]
v_pk_add_f32 v[36:37], v[36:37], v[44:45]
v_pk_add_f32 v[38:39], v[38:39], v[46:47]
v_lshlrev_b32 v48, 16, v80
v_and_b32 v49, 0xffff0000, v80
v_lshlrev_b32 v50, 16, v81
v_and_b32 v51, 0xffff0000, v81
v_lshlrev_b32 v52, 16, v82
v_and_b32 v53, 0xffff0000, v82
v_lshlrev_b32 v54, 16, v83
v_and_b32 v55, 0xffff0000, v83
v_pk_add_f32 v[32:33], v[32:33], v[48:49]
v_pk_add_f32 v[34:35], v[34:35], v[50:51]
v_pk_add_f32 v[36:37], v[36:37], v[52:53]
v_pk_add_f32 v[38:39], v[38:39], v[54:55]
v_lshlrev_b32 v40, 16, v84
v_and_b32 v41, 0xffff0000, v84
v_lshlrev_b32 v42, 16, v85
v_and_b32 v43, 0xffff0000, v85
v_lshlrev_b32 v44, 16, v86
v_and_b32 v45, 0xffff0000, v86
v_lshlrev_b32 v46, 16, v87
v_and_b32 v47, 0xffff0000, v87
v_pk_add_f32 v[32:33], v[32:33], v[40:41]
v_pk_add_f32 v[34:35], v[34:35], v[42:43]
v_pk_add_f32 v[36:37], v[36:37], v[44:45]
v_pk_add_f32 v[38:39], v[38:39], v[46:47]
v_lshlrev_b32 v48, 16, v88
v_and_b32 v49, 0xffff0000, v88
v_lshlrev_b32 v50, 16, v89
v_and_b32 v51, 0xffff0000, v89
v_lshlrev_b32 v52, 16, v90
v_and_b32 v53, 0xffff0000, v90
v_lshlrev_b32 v54, 16, v91
v_and_b32 v55, 0xffff0000, v91
v_pk_add_f32 v[32:33], v[32:33], v[48:49]
v_pk_add_f32 v[34:35], v[34:35], v[50:51]
v_pk_add_f32 v[36:37], v[36:37], v[52:53]
v_pk_add_f32 v[38:39], v[38:39], v[54:55]
s_barrier
v_lshlrev_b32 v40, 16, v92
v_and_b32 v41, 0xffff0000, v92
v_lshlrev_b32 v42, 16, v93
v_and_b32 v43, 0xffff0000, v93
v_lshlrev_b32 v44, 16, v94
v_and_b32 v45, 0xffff0000, v94
v_lshlrev_b32 v46, 16, v95
v_and_b32 v47, 0xffff0000, v95
v_pk_add_f32 v[32:33], v[32:33], v[40:41]
v_pk_add_f32 v[34:35], v[34:35], v[42:43]
v_pk_add_f32 v[36:37], v[36:37], v[44:45]
v_pk_add_f32 v[38:39], v[38:39], v[46:47]
v_lshlrev_b32 v48, 16, v96
v_and_b32 v49, 0xffff0000, v96
v_lshlrev_b32 v50, 16, v97
v_and_b32 v51, 0xffff0000, v97
v_lshlrev_b32 v52, 16, v98
v_and_b32 v53, 0xffff0000, v98
v_lshlrev_b32 v54, 16, v99
v_and_b32 v55, 0xffff0000, v99
v_pk_add_f32 v[32:33], v[32:33], v[48:49]
v_pk_add_f32 v[34:35], v[34:35], v[50:51]
v_pk_add_f32 v[36:37], v[36:37], v[52:53]
v_pk_add_f32 v[38:39], v[38:39], v[54:55]
v_lshlrev_b32 v40, 16, v100
v_and_b32 v41, 0xffff0000, v100
v_lshlrev_b32 v42, 16, v101
v_and_b32 v43, 0xffff0000, v101
v_lshlrev_b32 v44, 16, v102
v_and_b32 v45, 0xffff0000, v102
v_lshlrev_b32 v46, 16, v103
v_and_b32 v47, 0xffff0000, v103
v_pk_add_f32 v[32:33], v[32:33], v[40:41]
v_pk_add_f32 v[34:35], v[34:35], v[42:43]
v_pk_add_f32 v[36:37], v[36:37], v[44:45]
v_pk_add_f32 v[38:39], v[38:39], v[46:47]
v_lshlrev_b32 v48, 16, v104
v_and_b32 v49, 0xffff0000, v104
v_lshlrev_b32 v50, 16, v105
v_and_b32 v51, 0xffff0000, v105
v_lshlrev_b32 v52, 16, v106
v_and_b32 v53, 0xffff0000, v106
v_lshlrev_b32 v54, 16, v107
v_and_b32 v55, 0xffff0000, v107
v_pk_add_f32 v[32:33], v[32:33], v[48:49]
v_pk_add_f32 v[34:35], v[34:35], v[50:51]
v_pk_add_f32 v[36:37], v[36:37], v[52:53]
v_pk_add_f32 v[38:39], v[38:39], v[54:55]
s_barrier
v_lshlrev_b32 v40, 16, v108
v_and_b32 v41, 0xffff0000, v108
v_lshlrev_b32 v42, 16, v109
v_and_b32 v43, 0xffff0000, v109
v_lshlrev_b32 v44, 16, v110
v_and_b32 v45, 0xffff0000, v110
v_lshlrev_b32 v46, 16, v111
v_and_b32 v47, 0xffff0000, v111
v_pk_add_f32 v[32:33], v[32:33], v[40:41]
v_pk_add_f32 v[34:35], v[34:35], v[42:43]
v_pk_add_f32 v[36:37], v[36:37], v[44:45]
v_pk_add_f32 v[38:39], v[38:39], v[46:47]
v_lshlrev_b32 v48, 16, v112
v_and_b32 v49, 0xffff0000, v112
v_lshlrev_b32 v50, 16, v113
v_and_b32 v51, 0xffff0000, v113
v_lshlrev_b32 v52, 16, v114
v_and_b32 v53, 0xffff0000, v114
v_lshlrev_b32 v54, 16, v115
v_and_b32 v55, 0xffff0000, v115
v_pk_add_f32 v[32:33], v[32:33], v[48:49]
v_pk_add_f32 v[34:35], v[34:35], v[50:51]
v_pk_add_f32 v[36:37], v[36:37], v[52:53]
v_pk_add_f32 v[38:39], v[38:39], v[54:55]
v_lshlrev_b32 v40, 16, v120
v_and_b32 v41, 0xffff0000, v120
v_lshlrev_b32 v42, 16, v121
v_and_b32 v43, 0xffff0000, v121
v_lshlrev_b32 v44, 16, v122
v_and_b32 v45, 0xffff0000, v122
v_lshlrev_b32 v46, 16, v123
v_and_b32 v47, 0xffff0000, v123
v_pk_add_f32 v[32:33], v[32:33], v[40:41]
v_pk_add_f32 v[34:35], v[34:35], v[42:43]
v_pk_add_f32 v[36:37], v[36:37], v[44:45]
v_pk_add_f32 v[38:39], v[38:39], v[46:47]
v_lshlrev_b32 v48, 16, v124
v_and_b32 v49, 0xffff0000, v124
v_lshlrev_b32 v50, 16, v125
v_and_b32 v51, 0xffff0000, v125
v_lshlrev_b32 v52, 16, v126
v_and_b32 v53, 0xffff0000, v126
v_lshlrev_b32 v54, 16, v127
v_and_b32 v55, 0xffff0000, v127
v_pk_add_f32 v[32:33], v[32:33], v[48:49]
v_pk_add_f32 v[34:35], v[34:35], v[50:51]
v_pk_add_f32 v[36:37], v[36:37], v[52:53]
v_pk_add_f32 v[38:39], v[38:39], v[54:55]
s_barrier
s_waitcnt vmcnt(0)
v_lshlrev_b32 v40, 16, v128
v_and_b32 v41, 0xffff0000, v128
v_lshlrev_b32 v42, 16, v129
v_and_b32 v43, 0xffff0000, v129
v_lshlrev_b32 v44, 16, v130
v_and_b32 v45, 0xffff0000, v130
v_lshlrev_b32 v46, 16, v131
v_and_b32 v47, 0xffff0000, v131
v_pk_add_f32 v[32:33], v[32:33], v[40:41]
v_pk_add_f32 v[34:35], v[34:35], v[42:43]
v_pk_add_f32 v[36:37], v[36:37], v[44:45]
v_pk_add_f32 v[38:39], v[38:39], v[46:47]
v_lshlrev_b32 v48, 16, v132
v_and_b32 v49, 0xffff0000, v132
v_lshlrev_b32 v50, 16, v133
v_and_b32 v51, 0xffff0000, v133
v_lshlrev_b32 v52, 16, v134
v_and_b32 v53, 0xffff0000, v134
v_lshlrev_b32 v54, 16, v135
v_and_b32 v55, 0xffff0000, v135
v_pk_add_f32 v[32:33], v[32:33], v[48:49]
v_pk_add_f32 v[34:35], v[34:35], v[50:51]
v_pk_add_f32 v[36:37], v[36:37], v[52:53]
v_pk_add_f32 v[38:39], v[38:39], v[54:55]
v_lshlrev_b32 v40, 16, v136
v_and_b32 v41, 0xffff0000, v136
v_lshlrev_b32 v42, 16, v137
v_and_b32 v43, 0xffff0000, v137
v_lshlrev_b32 v44, 16, v138
v_and_b32 v45, 0xffff0000, v138
v_lshlrev_b32 v46, 16, v139
v_and_b32 v47, 0xffff0000, v139
v_pk_add_f32 v[32:33], v[32:33], v[40:41]
v_pk_add_f32 v[34:35], v[34:35], v[42:43]
v_pk_add_f32 v[36:37], v[36:37], v[44:45]
v_pk_add_f32 v[38:39], v[38:39], v[46:47]
v_lshlrev_b32 v48, 16, v140
v_and_b32 v49, 0xffff0000, v140
v_lshlrev_b32 v50, 16, v141
v_and_b32 v51, 0xffff0000, v141
v_lshlrev_b32 v52, 16, v142
v_and_b32 v53, 0xffff0000, v142
v_lshlrev_b32 v54, 16, v143
v_and_b32 v55, 0xffff0000, v143
v_pk_add_f32 v[32:33], v[32:33], v[48:49]
v_pk_add_f32 v[34:35], v[34:35], v[50:51]
v_pk_add_f32 v[36:37], v[36:37], v[52:53]
v_pk_add_f32 v[38:39], v[38:39], v[54:55]
s_barrier
v_lshlrev_b32 v40, 16, v144
v_and_b32 v41, 0xffff0000, v144
v_lshlrev_b32 v42, 16, v145
v_and_b32 v43, 0xffff0000, v145
v_lshlrev_b32 v44, 16, v146
v_and_b32 v45, 0xffff0000, v146
v_lshlrev_b32 v46, 16, v147
v_and_b32 v47, 0xffff0000, v147
v_pk_add_f32 v[32:33], v[32:33], v[40:41]
v_pk_add_f32 v[34:35], v[34:35], v[42:43]
v_pk_add_f32 v[36:37], v[36:37], v[44:45]
v_pk_add_f32 v[38:39], v[38:39], v[46:47]
v_lshlrev_b32 v48, 16, v148
v_and_b32 v49, 0xffff0000, v148
v_lshlrev_b32 v50, 16, v149
v_and_b32 v51, 0xffff0000, v149
v_lshlrev_b32 v52, 16, v150
v_and_b32 v53, 0xffff0000, v150
v_lshlrev_b32 v54, 16, v151
v_and_b32 v55, 0xffff0000, v151
v_pk_add_f32 v[32:33], v[32:33], v[48:49]
v_pk_add_f32 v[34:35], v[34:35], v[50:51]
v_pk_add_f32 v[36:37], v[36:37], v[52:53]
v_pk_add_f32 v[38:39], v[38:39], v[54:55]
v_lshlrev_b32 v40, 16, v152
v_and_b32 v41, 0xffff0000, v152
v_lshlrev_b32 v42, 16, v153
v_and_b32 v43, 0xffff0000, v153
v_lshlrev_b32 v44, 16, v154
v_and_b32 v45, 0xffff0000, v154
v_lshlrev_b32 v46, 16, v155
v_and_b32 v47, 0xffff0000, v155
v_pk_add_f32 v[32:33], v[32:33], v[40:41]
v_pk_add_f32 v[34:35], v[34:35], v[42:43]
v_pk_add_f32 v[36:37], v[36:37], v[44:45]
v_pk_add_f32 v[38:39], v[38:39], v[46:47]
v_lshlrev_b32 v48, 16, v156
v_and_b32 v49, 0xffff0000, v156
v_lshlrev_b32 v50, 16, v157
v_and_b32 v51, 0xffff0000, v157
v_lshlrev_b32 v52, 16, v158
v_and_b32 v53, 0xffff0000, v158
v_lshlrev_b32 v54, 16, v159
v_and_b32 v55, 0xffff0000, v159
v_pk_add_f32 v[32:33], v[32:33], v[48:49]
v_pk_add_f32 v[34:35], v[34:35], v[50:51]
v_pk_add_f32 v[36:37], v[36:37], v[52:53]
v_pk_add_f32 v[38:39], v[38:39], v[54:55]
s_barrier
v_lshlrev_b32 v40, 16, v160
v_and_b32 v41, 0xffff0000, v160
v_lshlrev_b32 v42, 16, v161
v_and_b32 v43, 0xffff0000, v161
v_lshlrev_b32 v44, 16, v162
v_and_b32 v45, 0xffff0000, v162
v_lshlrev_b32 v46, 16, v163
v_and_b32 v47, 0xffff0000, v163
v_pk_add_f32 v[32:33], v[32:33], v[40:41]
v_pk_add_f32 v[34:35], v[34:35], v[42:43]
v_pk_add_f32 v[36:37], v[36:37], v[44:45]
v_pk_add_f32 v[38:39], v[38:39], v[46:47]
v_lshlrev_b32 v48, 16, v164
v_and_b32 v49, 0xffff0000, v164
v_lshlrev_b32 v50, 16, v165
v_and_b32 v51, 0xffff0000, v165
v_lshlrev_b32 v52, 16, v166
v_and_b32 v53, 0xffff0000, v166
v_lshlrev_b32 v54, 16, v167
v_and_b32 v55, 0xffff0000, v167
v_pk_add_f32 v[32:33], v[32:33], v[48:49]
v_pk_add_f32 v[34:35], v[34:35], v[50:51]
v_pk_add_f32 v[36:37], v[36:37], v[52:53]
v_pk_add_f32 v[38:39], v[38:39], v[54:55]
v_lshlrev_b32 v40, 16, v168
v_and_b32 v41, 0xffff0000, v168
v_lshlrev_b32 v42, 16, v169
v_and_b32 v43, 0xffff0000, v169
v_lshlrev_b32 v44, 16, v170
v_and_b32 v45, 0xffff0000, v170
v_lshlrev_b32 v46, 16, v171
v_and_b32 v47, 0xffff0000, v171
v_pk_add_f32 v[32:33], v[32:33], v[40:41]
v_pk_add_f32 v[34:35], v[34:35], v[42:43]
v_pk_add_f32 v[36:37], v[36:37], v[44:45]
v_pk_add_f32 v[38:39], v[38:39], v[46:47]
v_lshlrev_b32 v48, 16, v172
v_and_b32 v49, 0xffff0000, v172
v_lshlrev_b32 v50, 16, v173
v_and_b32 v51, 0xffff0000, v173
v_lshlrev_b32 v52, 16, v174
v_and_b32 v53, 0xffff0000, v174
v_lshlrev_b32 v54, 16, v175
v_and_b32 v55, 0xffff0000, v175
v_pk_add_f32 v[32:33], v[32:33], v[48:49]
v_pk_add_f32 v[34:35], v[34:35], v[50:51]
v_pk_add_f32 v[36:37], v[36:37], v[52:53]
v_pk_add_f32 v[38:39], v[38:39], v[54:55]
s_barrier
v_lshlrev_b32 v40, 16, v176
v_and_b32 v41, 0xffff0000, v176
v_lshlrev_b32 v42, 16, v177
v_and_b32 v43, 0xffff0000, v177
v_lshlrev_b32 v44, 16, v178
v_and_b32 v45, 0xffff0000, v178
v_lshlrev_b32 v46, 16, v179
v_and_b32 v47, 0xffff0000, v179
v_pk_add_f32 v[32:33], v[32:33], v[40:41]
v_pk_add_f32 v[34:35], v[34:35], v[42:43]
v_pk_add_f32 v[36:37], v[36:37], v[44:45]
v_pk_add_f32 v[38:39], v[38:39], v[46:47]
v_lshlrev_b32 v48, 16, v180
v_and_b32 v49, 0xffff0000, v180
v_lshlrev_b32 v50, 16, v181
v_and_b32 v51, 0xffff0000, v181
v_lshlrev_b32 v52, 16, v182
v_and_b32 v53, 0xffff0000, v182
v_lshlrev_b32 v54, 16, v183
v_and_b32 v55, 0xffff0000, v183
v_pk_add_f32 v[32:33], v[32:33], v[48:49]
v_pk_add_f32 v[34:35], v[34:35], v[50:51]
v_pk_add_f32 v[36:37], v[36:37], v[52:53]
v_pk_add_f32 v[38:39], v[38:39], v[54:55]
v_lshlrev_b32 v40, 16, v184
v_and_b32 v41, 0xffff0000, v184
v_lshlrev_b32 v42, 16, v185
v_and_b32 v43, 0xffff0000, v185
v_lshlrev_b32 v44, 16, v186
v_and_b32 v45, 0xffff0000, v186
v_lshlrev_b32 v46, 16, v187
v_and_b32 v47, 0xffff0000, v187
v_pk_add_f32 v[32:33], v[32:33], v[40:41]
v_pk_add_f32 v[34:35], v[34:35], v[42:43]
v_pk_add_f32 v[36:37], v[36:37], v[44:45]
v_pk_add_f32 v[38:39], v[38:39], v[46:47]
v_lshlrev_b32 v48, 16, v188
v_and_b32 v49, 0xffff0000, v188
v_lshlrev_b32 v50, 16, v189
v_and_b32 v51, 0xffff0000, v189
v_lshlrev_b32 v52, 16, v190
v_and_b32 v53, 0xffff0000, v190
v_lshlrev_b32 v54, 16, v191
v_and_b32 v55, 0xffff0000, v191
v_pk_add_f32 v[32:33], v[32:33], v[48:49]
v_pk_add_f32 v[34:35], v[34:35], v[50:51]
v_pk_add_f32 v[36:37], v[36:37], v[52:53]
v_pk_add_f32 v[38:39], v[38:39], v[54:55]
s_barrier
s_nop 2
v_mov_b32 v40, v32
v_mov_b32 v41, v33
v_mov_b32 v42, v34
v_mov_b32 v43, v35
v_mov_b32 v44, v36
v_mov_b32 v45, v37
v_mov_b32 v46, v38
v_mov_b32 v47, v39
s_nop 0
v_permlane16_swap_b32 v32, v40
v_permlane16_swap_b32 v33, v41
v_permlane16_swap_b32 v34, v42
v_permlane16_swap_b32 v35, v43
v_permlane16_swap_b32 v36, v44
v_permlane16_swap_b32 v37, v45
v_permlane16_swap_b32 v38, v46
v_permlane16_swap_b32 v39, v47
v_add_f32 v32, v32, v40
v_add_f32 v33, v33, v41
v_add_f32 v34, v34, v42
v_add_f32 v35, v35, v43
v_add_f32 v36, v36, v44
v_add_f32 v37, v37, v45
v_add_f32 v38, v38, v46
v_add_f32 v39, v39, v47
v_mov_b32 v40, v32
v_mov_b32 v41, v33
v_mov_b32 v42, v34
v_mov_b32 v43, v35
v_mov_b32 v44, v36
v_mov_b32 v45, v37
v_mov_b32 v46, v38
v_mov_b32 v47, v39
s_nop 0
v_permlane32_swap_b32 v32, v40
v_permlane32_swap_b32 v33, v41
v_permlane32_swap_b32 v34, v42
v_permlane32_swap_b32 v35, v43
v_permlane32_swap_b32 v36, v44
v_permlane32_swap_b32 v37, v45
v_permlane32_swap_b32 v38, v46
v_permlane32_swap_b32 v39, v47
v_add_f32 v32, v32, v40
v_add_f32 v33, v33, v41
v_add_f32 v34, v34, v42
v_add_f32 v35, v35, v43
v_add_f32 v36, v36, v44
v_add_f32 v37, v37, v45
v_add_f32 v38, v38, v46
v_add_f32 v39, v39, v47
s_mov_b64 exec, 0xffff
buffer_store_dwordx4 v[32:35], v5, s[72:75], 0 offen sc1
buffer_store_dwordx4 v[36:39], v5, s[72:75], 0 offen offset:16 sc1
s_mov_b64 exec, -1
s_waitcnt vmcnt(0)
s_add_u32 s43, s50, 96
s_lshl_b32 s43, s43, 7
v_mov_b32 v12, s43
v_mov_b32 v13, 1
s_mov_b64 exec, 1
buffer_atomic_add v13, v12, s[56:59], 0 offen sc1
s_mov_b64 exec, -1
s_branch Lcsd_49
Lnojob_48:
s_lshl_b32 s43, s34, 18
s_add_u32 s12, s32, s43
s_addc_u32 s13, s33, 0
s_mov_b32 s14, 262144
s_mov_b32 s15, 0x20000
v_lshlrev_b32 v21, 4, v1
s_lshl_b32 s54, s36, 11
s_add_u32 s43, s35, 1
s_and_b32 s43, s43, 15
s_lshl_b32 s43, s43, 14
s_add_u32 s30, s43, s54
s_add_u32 s43, s35, 2
s_and_b32 s43, s43, 15
s_lshl_b32 s43, s43, 14
s_add_u32 s31, s43, s54
s_waitcnt vmcnt(0)
s_barrier
ds_write_b128 v27, v[68:71] offset:0
ds_write_b128 v27, v[116:119] offset:512
s_waitcnt lgkmcnt(0)
s_barrier
s_add_u32 m0, s54, 16384
s_add_u32 s43, s30, 0
buffer_load_dwordx4 v21, s[12:15], s43 offen sc1 lds
s_add_u32 m0, s54, 17408
s_add_u32 s43, s30, 1024
buffer_load_dwordx4 v21, s[12:15], s43 offen sc1 lds
s_add_u32 m0, s54, 32768
s_add_u32 s43, s31, 0
buffer_load_dwordx4 v21, s[12:15], s43 offen sc1 lds
s_add_u32 m0, s54, 33792
s_add_u32 s43, s31, 1024
buffer_load_dwordx4 v21, s[12:15], s43 offen sc1 lds
s_waitcnt vmcnt(2)
s_barrier
s_waitcnt vmcnt(0)
s_barrier
s_barrier
s_barrier
s_barrier
s_barrier
s_barrier
s_barrier
s_barrier
s_barrier
s_barrier
s_barrier
s_barrier
s_barrier
s_barrier
s_barrier
s_barrier
Lcsd_49:
s_mov_b32 s46, 1
s_lshl_b32 s43, s34, 18
s_add_u32 s12, s32, s43
s_addc_u32 s13, s33, 0
s_add_u32 s12, s12, 4194304
s_addc_u32 s13, s13, 0
s_mov_b32 s14, 262144
s_mov_b32 s15, 0x20000
v_lshlrev_b32 v21, 4, v1
s_lshl_b32 s54, s36, 11
s_add_u32 s43, s35, 1
s_and_b32 s43, s43, 15
s_lshl_b32 s43, s43, 14
s_add_u32 s30, s43, s54
s_add_u32 s43, s35, 2
s_and_b32 s43, s43, 15
s_lshl_b32 s43, s43, 14
s_add_u32 s31, s43, s54
s_mov_b32 s88, s4
s_mov_b32 s89, s5
s_mov_b32 s90, 7340032
s_mov_b32 s91, 0x20000
s_mov_b32 s92, s6
s_mov_b32 s93, s7
s_mov_b32 s94, 7340032
s_mov_b32 s95, 0x20000
s_lshr_b32 s43, s35, 3
v_and_b32 v19, 1, v1
v_bfe_u32 v23, v1, 2, 3
s_lshl_b32 s44, s43, 3
s_add_u32 s44, s44, 1
v_lshl_add_u32 v23, v19, 2, v23
v_add_u32 v23, s44, v23
s_lshl_b32 s43, s43, 11
s_add_u32 s43, s43, 384
s_movk_i32 s44, 1024
s_lshr_b32 s45, s2, 3
s_mul_i32 s45, s45, 14336
s_add_u32 s43, s43, s45
v_mul_lo_u32 v31, v19, s44
v_bfe_u32 v19, v1, 1, 1
v_mul_u32_u24 v19, 7168, v19
v_add3_u32 v31, v31, v19, s43
v_add_u32 v19, 3, v23
v_and_b32 v19, 15, v19
v_mul_u32_u24 v19, 458752, v19
v_add_u32 v19, v19, v31
buffer_load_dword v30, v19, s[88:91], 0 offen
buffer_load_dword v30, v19, s[92:95], 0 offen
s_lshl_b32 s43, s34, 14
s_add_u32 s64, s32, s43
s_addc_u32 s65, s33, 0
s_add_u32 s64, s64, 25165824
s_addc_u32 s65, s65, 0
s_mov_b32 s66, 16384
s_mov_b32 s67, 0x20000
s_add_u32 s72, s32, 27262976
s_addc_u32 s73, s33, 0
s_mov_b32 s74, 114688
s_mov_b32 s75, 0x20000
s_barrier
s_add_u32 m0, s54, 0
s_add_u32 s43, s30, 0
buffer_load_dwordx4 v21, s[12:15], s43 offen sc1 lds
s_add_u32 m0, s54, 1024
s_add_u32 s43, s30, 1024
buffer_load_dwordx4 v21, s[12:15], s43 offen sc1 lds
s_add_u32 m0, s54, 49152
s_add_u32 s43, s31, 0
buffer_load_dwordx4 v21, s[12:15], s43 offen sc1 lds
s_add_u32 m0, s54, 50176
s_add_u32 s43, s31, 1024
buffer_load_dwordx4 v21, s[12:15], s43 offen sc1 lds
s_waitcnt vmcnt(2)
s_barrier
s_waitcnt vmcnt(0)
s_mul_i32 s43, s2, 28672
s_mul_i32 s44, s51, 7168
s_add_u32 s43, s43, s44
s_add_u32 s80, s60, s43
s_addc_u32 s81, s61, 0
s_load_dword s82, s[80:81], 0
s_load_dword s83, s[80:81], 64
s_load_dword s84, s[80:81], 128
s_load_dword s85, s[80:81], 192
s_load_dword s86, s[80:81], 256
s_load_dword s87, s[80:81], 320
s_load_dword s82, s[80:81], 384
s_load_dword s83, s[80:81], 448
s_load_dword s84, s[80:81], 512
s_load_dword s85, s[80:81], 576
s_load_dword s86, s[80:81], 640
s_add_u32 s80, s80, 704
s_addc_u32 s81, s81, 0
s_barrier
s_mov_b32 s43, 0
buffer_load_dwordx4 v[128:131], v21, s[64:67], s43 offen sc1
s_mov_b32 s43, 1024
buffer_load_dwordx4 v[132:135], v21, s[64:67], s43 offen sc1
s_mov_b32 s43, 2048
buffer_load_dwordx4 v[136:139], v21, s[64:67], s43 offen sc1
s_mov_b32 s43, 3072
buffer_load_dwordx4 v[140:143], v21, s[64:67], s43 offen sc1
s_mov_b32 s43, 4096
buffer_load_dwordx4 v[144:147], v21, s[64:67], s43 offen sc1
s_mov_b32 s43, 5120
buffer_load_dwordx4 v[148:151], v21, s[64:67], s43 offen sc1
s_mov_b32 s43, 6144
buffer_load_dwordx4 v[152:155], v21, s[64:67], s43 offen sc1
s_mov_b32 s43, 7168
buffer_load_dwordx4 v[156:159], v21, s[64:67], s43 offen sc1
s_mov_b32 s43, 8192
buffer_load_dwordx4 v[160:163], v21, s[64:67], s43 offen sc1
s_mov_b32 s43, 9216
buffer_load_dwordx4 v[164:167], v21, s[64:67], s43 offen sc1
s_mov_b32 s43, 10240
buffer_load_dwordx4 v[168:171], v21, s[64:67], s43 offen sc1
s_mov_b32 s43, 11264
buffer_load_dwordx4 v[172:175], v21, s[64:67], s43 offen sc1
s_mov_b32 s43, 12288
buffer_load_dwordx4 v[176:179], v21, s[64:67], s43 offen sc1
s_mov_b32 s43, 13312
buffer_load_dwordx4 v[180:183], v21, s[64:67], s43 offen sc1
s_mov_b32 s43, 14336
buffer_load_dwordx4 v[184:187], v21, s[64:67], s43 offen sc1
s_mov_b32 s43, 15360
buffer_load_dwordx4 v[188:191], v21, s[64:67], s43 offen sc1
s_load_dword s82, s[80:81], 0
s_load_dword s83, s[80:81], 64
s_load_dword s84, s[80:81], 128
s_load_dword s85, s[80:81], 192
s_load_dword s86, s[80:81], 256
s_load_dword s87, s[80:81], 320
s_load_dword s82, s[80:81], 384
s_load_dword s83, s[80:81], 448
s_load_dword s84, s[80:81], 512
s_load_dword s85, s[80:81], 576
s_load_dword s86, s[80:81], 640
s_add_u32 s80, s80, 704
s_addc_u32 s81, s81, 0
s_barrier
s_mul_i32 s43, s49, 96
s_add_u32 s44, s43, 95
s_lshr_b32 s43, s43, 7
s_lshr_b32 s44, s44, 7
s_add_u32 s43, s43, 16
s_add_u32 s44, s44, 16
v_mov_b32 v12, s44
v_writelane_b32 v12, s35, 0
v_writelane_b32 v12, s43, 1
v_add_u32 v12, 96, v12
v_lshlrev_b32 v12, 7, v12
v_mov_b32 v14, 8
buffer_load_dword v13, v12, s[56:59], 0 offen sc1
s_load_dword s82, s[80:81], 0
s_load_dword s83, s[80:81], 64
s_load_dword s84, s[80:81], 128
s_load_dword s85, s[80:81], 192
s_load_dword s86, s[80:81], 256
s_load_dword s87, s[80:81], 320
s_load_dword s82, s[80:81], 384
s_load_dword s83, s[80:81], 448
s_load_dword s84, s[80:81], 512
s_load_dword s85, s[80:81], 576
s_load_dword s86, s[80:81], 640
s_add_u32 s80, s80, 704
s_addc_u32 s81, s81, 0
s_barrier
s_load_dword s82, s[80:81], 0
s_load_dword s83, s[80:81], 64
s_load_dword s84, s[80:81], 128
s_load_dword s85, s[80:81], 192
s_load_dword s86, s[80:81], 256
s_load_dword s87, s[80:81], 320
s_load_dword s82, s[80:81], 384
s_load_dword s83, s[80:81], 448
s_load_dword s84, s[80:81], 512
s_load_dword s85, s[80:81], 576
s_load_dword s86, s[80:81], 640
s_add_u32 s80, s80, 704
s_addc_u32 s81, s81, 0
s_barrier
s_mov_b32 s41, 0x10000
Lpoll_50:
s_waitcnt vmcnt(0)
Lpf_52:
v_cmp_ne_u32 vcc, v14, v13
s_nop 4
s_cbranch_vccz Lpok_51
buffer_load_dword v13, v12, s[56:59], 0 offen sc1
s_sub_u32 s41, s41, 1
s_cmp_lg_u32 s41, 0
s_cbranch_scc1 Lpoll_50
s_waitcnt vmcnt(0)
Lpok_51:
v_min_u32 v12, 55, v1
v_lshlrev_b32 v13, 4, v12
s_lshl_b32 s43, s35, 9
s_mul_i32 s44, s49, 384
s_add_u32 s44, s44, 7680
v_mov_b32 v14, s44
v_mov_b32 v15, s43
v_cmp_gt_u32 vcc, 32, v12
s_nop 1
v_cndmask_b32 v14, v14, v15, vcc
v_add_u32 v14, v14, v13
v_add_u32 v13, 148480, v13
s_mov_b32 s43, 0
buffer_load_dwordx4 v[192:195], v14, s[72:75], s43 offen sc1
s_mov_b32 s43, 28672
buffer_load_dwordx4 v[196:199], v14, s[72:75], s43 offen sc1
s_mov_b32 s43, 57344
buffer_load_dwordx4 v[200:203], v14, s[72:75], s43 offen sc1
s_mov_b32 s43, 86016
buffer_load_dwordx4 v[204:207], v14, s[72:75], s43 offen sc1
s_mov_b32 s43, 14336
buffer_load_dwordx4 v[208:211], v14, s[72:75], s43 offen sc1
s_mov_b32 s43, 43008
buffer_load_dwordx4 v[212:215], v14, s[72:75], s43 offen sc1
s_mov_b32 s43, 71680
buffer_load_dwordx4 v[216:219], v14, s[72:75], s43 offen sc1
s_mov_b32 s43, 100352
buffer_load_dwordx4 v[220:223], v14, s[72:75], s43 offen sc1
s_load_dword s82, s[80:81], 0
s_load_dword s83, s[80:81], 64
s_load_dword s84, s[80:81], 128
s_load_dword s85, s[80:81], 192
s_load_dword s86, s[80:81], 256
s_load_dword s87, s[80:81], 320
s_load_dword s82, s[80:81], 384
s_load_dword s83, s[80:81], 448
s_load_dword s84, s[80:81], 512
s_load_dword s85, s[80:81], 576
s_load_dword s86, s[80:81], 640
s_add_u32 s80, s80, 704
s_addc_u32 s81, s81, 0
s_barrier
s_getpc_b64 s[78:79]
Lpc_53:
s_sub_u32 s78, s78, Lpc_53-sequential_preLN__sliding_local_dilated__glu_gated_geglu__prompt_kernel
s_subb_u32 s79, s79, 0
s_lshr_b32 s43, s2, 3
s_mul_i32 s43, s43, 3840
v_min_u32 v19, 29, v1
v_lshl_add_u32 v19, v19, 7, s43
v_min_u32 v19, Ldone_1-sequential_preLN__sliding_local_dilated__glu_gated_geglu__prompt_kernel, v19
global_load_dword v30, v19, s[78:79]
v_add_u32 v19, 8, v23
v_and_b32 v19, 15, v19
v_mul_u32_u24 v19, 458752, v19
v_add_u32 v19, v19, v31
buffer_load_dword v30, v19, s[88:91], 0 offen
buffer_load_dword v30, v19, s[92:95], 0 offen
v_add_f32 v128, v128, v132
v_add_f32 v129, v129, v133
v_add_f32 v130, v130, v134
v_add_f32 v131, v131, v135
v_add_f32 v128, v128, v136
v_add_f32 v129, v129, v137
v_add_f32 v130, v130, v138
v_add_f32 v131, v131, v139
v_add_f32 v128, v128, v140
v_add_f32 v129, v129, v141
v_add_f32 v130, v130, v142
v_add_f32 v131, v131, v143
v_add_f32 v128, v128, v144
v_add_f32 v129, v129, v145
v_add_f32 v130, v130, v146
v_add_f32 v131, v131, v147
v_add_f32 v128, v128, v148
v_add_f32 v129, v129, v149
v_add_f32 v130, v130, v150
v_add_f32 v131, v131, v151
v_add_f32 v128, v128, v152
v_add_f32 v129, v129, v153
v_add_f32 v130, v130, v154
v_add_f32 v131, v131, v155
v_add_f32 v128, v128, v156
v_add_f32 v129, v129, v157
v_add_f32 v130, v130, v158
v_add_f32 v131, v131, v159
v_add_f32 v128, v128, v160
v_add_f32 v129, v129, v161
v_add_f32 v130, v130, v162
v_add_f32 v131, v131, v163
v_add_f32 v128, v128, v164
v_add_f32 v129, v129, v165
v_add_f32 v130, v130, v166
v_add_f32 v131, v131, v167
v_add_f32 v128, v128, v168
v_add_f32 v129, v129, v169
v_add_f32 v130, v130, v170
v_add_f32 v131, v131, v171
v_add_f32 v128, v128, v172
v_add_f32 v129, v129, v173
v_add_f32 v130, v130, v174
v_add_f32 v131, v131, v175
v_add_f32 v128, v128, v176
v_add_f32 v129, v129, v177
v_add_f32 v130, v130, v178
v_add_f32 v131, v131, v179
v_add_f32 v128, v128, v180
v_add_f32 v129, v129, v181
v_add_f32 v130, v130, v182
v_add_f32 v131, v131, v183
v_add_f32 v128, v128, v184
v_add_f32 v129, v129, v185
v_add_f32 v130, v130, v186
v_add_f32 v131, v131, v187
v_add_f32 v128, v128, v188
v_add_f32 v129, v129, v189
v_add_f32 v130, v130, v190
v_add_f32 v131, v131, v191
v_mul_f32 v128, 0x3a800000, v128
v_mul_f32 v129, 0x3a800000, v129
v_fma_f32 v129, -v128, v128, v129
v_max_f32 v129, 0, v129
v_add_f32 v129, 0x3727c5ac, v129
v_rsq_f32 v129, v129
v_mul_f32 v130, 0x3a800000, v130
v_mul_f32 v131, 0x3a800000, v131
v_fma_f32 v131, -v130, v130, v131
v_max_f32 v131, 0, v131
v_add_f32 v131, 0x3727c5ac, v131
v_rsq_f32 v131, v131
v_add_u32 v19, 147456, v21
ds_write_b128 v19, v[128:131]
s_load_dword s82, s[80:81], 0
s_load_dword s83, s[80:81], 64
s_load_dword s84, s[80:81], 128
s_load_dword s85, s[80:81], 192
s_load_dword s86, s[80:81], 256
s_load_dword s87, s[80:81], 320
s_load_dword s82, s[80:81], 384
s_load_dword s83, s[80:81], 448
s_load_dword s84, s[80:81], 512
s_load_dword s85, s[80:81], 576
s_load_dword s86, s[80:81], 640
s_add_u32 s80, s80, 704
s_addc_u32 s81, s81, 0
s_barrier
s_barrier
s_waitcnt vmcnt(0)
v_add_f32 v192, v192, v196
v_add_f32 v200, v200, v204
v_add_f32 v193, v193, v197
v_add_f32 v201, v201, v205
v_add_f32 v194, v194, v198
v_add_f32 v202, v202, v206
v_add_f32 v195, v195, v199
v_add_f32 v203, v203, v207
v_add_f32 v192, v192, v200
v_add_f32 v193, v193, v201
v_add_f32 v194, v194, v202
v_add_f32 v195, v195, v203
ds_write_b128 v13, v[192:195] offset:0
v_add_f32 v208, v208, v212
v_add_f32 v216, v216, v220
v_add_f32 v209, v209, v213
v_add_f32 v217, v217, v221
v_add_f32 v210, v210, v214
v_add_f32 v218, v218, v222
v_add_f32 v211, v211, v215
v_add_f32 v219, v219, v223
v_add_f32 v208, v208, v216
v_add_f32 v209, v209, v217
v_add_f32 v210, v210, v218
v_add_f32 v211, v211, v219
ds_write_b128 v13, v[208:211] offset:896
s_waitcnt lgkmcnt(0)
s_load_dword s82, s[80:81], 0
s_load_dword s83, s[80:81], 64
s_load_dword s84, s[80:81], 128
s_load_dword s85, s[80:81], 192
s_load_dword s86, s[80:81], 256
s_load_dword s87, s[80:81], 320
s_load_dword s82, s[80:81], 384
s_load_dword s83, s[80:81], 448
s_load_dword s84, s[80:81], 512
s_load_dword s85, s[80:81], 576
s_load_dword s86, s[80:81], 640
s_add_u32 s80, s80, 704
s_addc_u32 s81, s81, 0
s_barrier
s_load_dword s82, s[80:81], 0
s_load_dword s83, s[80:81], 64
s_load_dword s84, s[80:81], 128
s_load_dword s85, s[80:81], 192
s_load_dword s86, s[80:81], 256
s_load_dword s87, s[80:81], 320
s_load_dword s82, s[80:81], 384
s_load_dword s83, s[80:81], 448
s_load_dword s84, s[80:81], 512
s_load_dword s85, s[80:81], 576
s_load_dword s86, s[80:81], 640
s_add_u32 s80, s80, 704
s_addc_u32 s81, s81, 0
s_barrier
s_and_b32 s53, s35, 1
s_lshl_b32 s53, s53, 1
s_mul_i32 s43, s47, 3
s_add_u32 s53, s53, s43
v_lshlrev_b32 v19, 11, v18
v_lshl_add_u32 v19, v17, 4, v19
s_lshl_b32 s43, s46, 10
v_add_u32 v2, s43, v19
v_add_u32 v3, 49152, v2
v_add_u32 v4, 98304, v2
v_lshrrev_b32 v19, 2, v17
v_lshl_add_u32 v20, v18, 2, v19
v_and_b32 v21, 7, v20
v_lshlrev_b32 v20, 8, v20
v_and_b32 v19, 3, v1
v_lshl_add_u32 v20, v19, 3, v20
s_add_u32 s43, s53, 0
v_xor_b32 v19, s43, v21
v_lshl_add_u32 v5, v19, 5, v20
s_add_u32 s43, s53, 1
v_xor_b32 v19, s43, v21
v_lshl_add_u32 v6, v19, 5, v20
s_add_u32 s43, s53, 2
v_xor_b32 v19, s43, v21
v_lshl_add_u32 v7, v19, 5, v20
v_add_u32 v9, 49152, v5
v_add_u32 v10, 49152, v6
v_add_u32 v11, 49152, v7
v_add_u32 v13, 98304, v5
v_add_u32 v14, 98304, v6
v_add_u32 v15, 98304, v7
s_lshl_b32 s43, s46, 9
s_add_u32 s43, s43, 147456
v_lshl_add_u32 v19, v17, 3, s43
ds_read_b64 v[80:81], v19 offset:0
ds_read_b64 v[82:83], v19 offset:128
ds_read_b64 v[84:85], v19 offset:256
ds_read_b64 v[86:87], v19 offset:384
s_mul_i32 s43, s47, 192
s_add_u32 s43, s43, 148992
v_lshl_add_u32 v19, v18, 4, s43
ds_read_b128 v[48:51], v19 offset:0
ds_read_b128 v[52:55], v19 offset:64
ds_read_b128 v[56:59], v19 offset:128
ds_read_b128 v[60:63], v19 offset:896
ds_read_b128 v[64:67], v19 offset:960
ds_read_b128 v[68:71], v19 offset:1024
s_barrier
s_mov_b32 s88, s4
s_mov_b32 s89, s5
s_mov_b32 s90, 7340032
s_mov_b32 s91, 0x20000
s_mov_b32 s92, s6
s_mov_b32 s93, s7
s_mov_b32 s94, 7340032
s_mov_b32 s95, 0x20000
s_lshr_b32 s43, s35, 3
v_and_b32 v19, 1, v1
v_bfe_u32 v23, v1, 2, 3
s_lshl_b32 s44, s43, 1
s_add_u32 s44, s44, 6
v_add_u32 v23, s44, v23
s_lshl_b32 s44, s43, 1
s_add_u32 s44, s44, 1
v_mad_u32_u24 v23, v19, s44, v23
s_lshl_b32 s44, s43, 10
s_lshl_b32 s43, s43, 11
s_sub_u32 s43, 6528, s43
s_lshr_b32 s45, s2, 3
s_mul_i32 s45, s45, 14336
s_add_u32 s43, s43, s45
v_mul_lo_u32 v31, v19, s44
v_bfe_u32 v19, v1, 1, 1
v_mul_u32_u24 v19, 7168, v19
v_add3_u32 v31, v31, v19, s43
v_add_u32 v19, 0, v23
v_and_b32 v19, 15, v19
v_mul_u32_u24 v19, 458752, v19
v_add_u32 v19, v19, v31
buffer_load_dword v30, v19, s[88:91], 0 offen
buffer_load_dword v30, v19, s[92:95], 0 offen
s_waitcnt lgkmcnt(0)
v_mul_f32 v88, v81, v81
v_mul_f32 v228, 0xc0135761, v81
v_mul_f32 v89, 0xbdd2d3e8, v81
v_rcp_f32 v236, v88
v_mul_f32 v232, v89, v88
v_mul_f32 v88, v83, v83
v_mul_f32 v229, 0xc0135761, v83
v_mul_f32 v89, 0xbdd2d3e8, v83
v_rcp_f32 v237, v88
v_mul_f32 v233, v89, v88
v_mul_f32 v88, v85, v85
v_mul_f32 v230, 0xc0135761, v85
v_mul_f32 v89, 0xbdd2d3e8, v85
v_rcp_f32 v238, v88
v_mul_f32 v234, v89, v88
v_mul_f32 v88, v87, v87
v_mul_f32 v231, 0xc0135761, v87
v_mul_f32 v89, 0xbdd2d3e8, v87
v_rcp_f32 v239, v88
v_mul_f32 v235, v89, v88
s_mul_i32 s43, s34, 917504
s_mul_i32 s44, s49, 24576
s_add_u32 s43, s43, s44
s_add_u32 s43, s43, 8912896
s_add_u32 s24, s32, s43
s_addc_u32 s25, s33, 0
s_mov_b32 s26, 24576
s_mov_b32 s27, 0x20000
s_mov_b32 s53, 262144
s_lshl_b32 s43, s47, 13
s_lshl_b32 s44, s46, 10
s_add_u32 s43, s43, s44
v_lshlrev_b32 v19, 11, v18
v_lshl_add_u32 v19, v17, 4, v19
v_add_u32 v27, s43, v19
s_lshl_b32 s43, s47, 12
s_add_u32 s43, s43, s44
s_add_u32 s43, s43, 16384
v_and_b32 v19, 1, v18
v_lshlrev_b32 v19, 11, v19
v_lshrrev_b32 v20, 1, v18
v_lshl_add_u32 v19, v20, 8, v19
v_lshl_add_u32 v19, v17, 4, v19
v_add_u32 v28, s43, v19
s_load_dword s82, s[80:81], 0
s_load_dword s83, s[80:81], 64
s_load_dword s84, s[80:81], 128
s_load_dword s85, s[80:81], 192
s_load_dword s86, s[80:81], 256
s_load_dword s87, s[80:81], 320
s_load_dword s82, s[80:81], 384
s_load_dword s83, s[80:81], 448
s_add_u32 s80, s80, 512
s_addc_u32 s81, s81, 0
s_barrier
v_mul_f32 v128, -v80, v48
v_mul_f32 v129, -v80, v49
v_mul_f32 v130, -v80, v50
v_mul_f32 v131, -v80, v51
v_mul_f32 v132, -v82, v48
v_mul_f32 v133, -v82, v49
v_mul_f32 v134, -v82, v50
v_mul_f32 v135, -v82, v51
v_mul_f32 v136, -v84, v48
v_mul_f32 v137, -v84, v49
v_mul_f32 v138, -v84, v50
v_mul_f32 v139, -v84, v51
v_mul_f32 v140, -v86, v48
v_mul_f32 v141, -v86, v49
v_mul_f32 v142, -v86, v50
v_mul_f32 v143, -v86, v51
v_mul_f32 v144, -v80, v52
v_mul_f32 v145, -v80, v53
v_mul_f32 v146, -v80, v54
v_mul_f32 v147, -v80, v55
v_mul_f32 v148, -v82, v52
v_mul_f32 v149, -v82, v53
v_mul_f32 v150, -v82, v54
v_mul_f32 v151, -v82, v55
v_mul_f32 v152, -v84, v52
v_mul_f32 v153, -v84, v53
v_mul_f32 v154, -v84, v54
v_mul_f32 v155, -v84, v55
v_mul_f32 v156, -v86, v52
v_mul_f32 v157, -v86, v53
v_mul_f32 v158, -v86, v54
v_mul_f32 v159, -v86, v55
s_load_dword s82, s[80:81], 0
s_load_dword s83, s[80:81], 64
s_load_dword s84, s[80:81], 128
s_load_dword s85, s[80:81], 192
s_load_dword s86, s[80:81], 256
s_load_dword s87, s[80:81], 320
s_load_dword s82, s[80:81], 384
s_load_dword s83, s[80:81], 448
s_add_u32 s80, s80, 512
s_addc_u32 s81, s81, 0
s_barrier
v_mul_f32 v160, -v80, v56
v_mul_f32 v161, -v80, v57
v_mul_f32 v162, -v80, v58
v_mul_f32 v163, -v80, v59
v_mul_f32 v164, -v82, v56
v_mul_f32 v165, -v82, v57
v_mul_f32 v166, -v82, v58
v_mul_f32 v167, -v82, v59
v_mul_f32 v168, -v84, v56
v_mul_f32 v169, -v84, v57
v_mul_f32 v170, -v84, v58
v_mul_f32 v171, -v84, v59
v_mul_f32 v172, -v86, v56
v_mul_f32 v173, -v86, v57
v_mul_f32 v174, -v86, v58
v_mul_f32 v175, -v86, v59
v_mul_f32 v176, -v80, v60
v_mul_f32 v177, -v80, v61
v_mul_f32 v178, -v80, v62
v_mul_f32 v179, -v80, v63
v_mul_f32 v180, -v82, v60
v_mul_f32 v181, -v82, v61
v_mul_f32 v182, -v82, v62
v_mul_f32 v183, -v82, v63
v_mul_f32 v184, -v84, v60
v_mul_f32 v185, -v84, v61
v_mul_f32 v186, -v84, v62
v_mul_f32 v187, -v84, v63
v_mul_f32 v188, -v86, v60
v_mul_f32 v189, -v86, v61
v_mul_f32 v190, -v86, v62
v_mul_f32 v191, -v86, v63
s_load_dword s82, s[80:81], 0
s_load_dword s83, s[80:81], 64
s_load_dword s84, s[80:81], 128
s_load_dword s85, s[80:81], 192
s_load_dword s86, s[80:81], 256
s_load_dword s87, s[80:81], 320
s_load_dword s82, s[80:81], 384
s_load_dword s83, s[80:81], 448
s_add_u32 s80, s80, 512
s_addc_u32 s81, s81, 0
s_barrier
v_mul_f32 v192, -v80, v64
v_mul_f32 v193, -v80, v65
v_mul_f32 v194, -v80, v66
v_mul_f32 v195, -v80, v67
v_mul_f32 v196, -v82, v64
v_mul_f32 v197, -v82, v65
v_mul_f32 v198, -v82, v66
v_mul_f32 v199, -v82, v67
v_mul_f32 v200, -v84, v64
v_mul_f32 v201, -v84, v65
v_mul_f32 v202, -v84, v66
v_mul_f32 v203, -v84, v67
v_mul_f32 v204, -v86, v64
v_mul_f32 v205, -v86, v65
v_mul_f32 v206, -v86, v66
v_mul_f32 v207, -v86, v67
v_mul_f32 v208, -v80, v68
v_mul_f32 v209, -v80, v69
v_mul_f32 v210, -v80, v70
v_mul_f32 v211, -v80, v71
v_mul_f32 v212, -v82, v68
v_mul_f32 v213, -v82, v69
v_mul_f32 v214, -v82, v70
v_mul_f32 v215, -v82, v71
v_mul_f32 v216, -v84, v68
v_mul_f32 v217, -v84, v69
v_mul_f32 v218, -v84, v70
v_mul_f32 v219, -v84, v71
v_mul_f32 v220, -v86, v68
v_mul_f32 v221, -v86, v69
v_mul_f32 v222, -v86, v70
v_mul_f32 v223, -v86, v71
s_barrier
s_mul_i32 s44, s34, 917504
s_lshl_b32 s39, s51, 13
s_add_u32 s44, s44, s39
s_add_u32 s44, s44, 8388608
s_and_b32 s43, s51, 1
s_xor_b32 s43, s43, s35
s_lshl_b32 s43, s43, 7
s_mov_b32 s10, 909312
s_movk_i32 s38, 1024
s_movk_i32 s40, 9216
s_movk_i32 s37, 0x4000
s_cmp_ge_u32 s51, 2
s_cselect_b32 s8, s60, s32
s_cselect_b32 s9, s61, s33
s_cselect_b32 s10, 7338112, s10
s_cselect_b32 s43, s43, s44
s_cselect_b32 s38, 16384, s38
s_cselect_b32 s40, 81920, s40
s_cselect_b32 s55, 81920, s38
s_cselect_b32 s37, 262144, s37
s_cselect_b32 s45, -1, 0
s_add_u32 s8, s8, s43
s_addc_u32 s9, s9, 0
s_mov_b32 s11, 0x20000
s_and_b32 s53, s35, 1
s_mul_i32 s54, s53, 6
s_mul_i32 s54, s54, s37
s_mul_i32 s29, s53, 2
s_add_u32 s29, s29, 6
s_mul_i32 s29, s29, s37
s_and_b32 s43, s45, 4290838528
s_add_u32 s29, s29, s43
s_mul_i32 s37, s37, 2
s_sub_u32 s37, s37, s40
v_lshrrev_b32 v19, 3, v1
v_mul_u32_u24 v19, 1920, v19
v_lshrrev_b32 v20, 4, v1
v_lshlrev_b32 v20, 5, v20
v_and_b32 v19, s45, v19
v_and_b32 v20, s45, v20
v_lshlrev_b32 v21, 4, v1
v_xor_b32 v21, v21, v20
v_add_u32 v21, v21, v19
s_barrier
LK3b_36:
s_setprio 1
ds_read_b128 v[32:35], v2 offset:0
ds_read_b64_tr_b16 v[48:49], v5 offset:16384
ds_read_b64_tr_b16 v[50:51], v5 offset:20480
ds_read_b128 v[36:39], v2 offset:256
ds_read_b128 v[40:43], v2 offset:512
ds_read_b128 v[44:47], v2 offset:768
ds_read_b64_tr_b16 v[60:61], v5 offset:32768
ds_read_b64_tr_b16 v[62:63], v5 offset:36864
ds_read_b64_tr_b16 v[52:53], v6 offset:16384
ds_read_b64_tr_b16 v[54:55], v6 offset:20480
ds_read_b64_tr_b16 v[64:65], v6 offset:32768
ds_read_b64_tr_b16 v[66:67], v6 offset:36864
ds_read_b64_tr_b16 v[56:57], v7 offset:16384
ds_read_b64_tr_b16 v[58:59], v7 offset:20480
ds_read_b64_tr_b16 v[68:69], v7 offset:32768
ds_read_b64_tr_b16 v[70:71], v7 offset:36864
s_mov_b32 s41, 5
Lk3_54:
s_waitcnt lgkmcnt(0)
v_mfma_f32_16x16x32_bf16 v[128:131], v[48:51], v[32:35], v[128:131]
ds_read_b128 v[80:83], v2 offset:8192
v_mfma_f32_16x16x32_bf16 v[132:135], v[48:51], v[36:39], v[132:135]
ds_read_b64_tr_b16 v[96:97], v5 offset:24576
v_mfma_f32_16x16x32_bf16 v[136:139], v[48:51], v[40:43], v[136:139]
ds_read_b64_tr_b16 v[98:99], v5 offset:28672
v_mfma_f32_16x16x32_bf16 v[140:143], v[48:51], v[44:47], v[140:143]
ds_read_b128 v[84:87], v2 offset:8448
v_mfma_f32_16x16x32_bf16 v[188:191], v[60:63], v[44:47], v[188:191]
ds_read_b128 v[88:91], v2 offset:8704
v_mfma_f32_16x16x32_bf16 v[184:187], v[60:63], v[40:43], v[184:187]
ds_read_b128 v[92:95], v2 offset:8960
v_mfma_f32_16x16x32_bf16 v[180:183], v[60:63], v[36:39], v[180:183]
ds_read_b64_tr_b16 v[108:109], v5 offset:40960
v_mfma_f32_16x16x32_bf16 v[176:179], v[60:63], v[32:35], v[176:179]
ds_read_b64_tr_b16 v[110:111], v5 offset:45056
v_mfma_f32_16x16x32_bf16 v[144:147], v[52:55], v[32:35], v[144:147]
ds_read_b64_tr_b16 v[100:101], v6 offset:24576
v_mfma_f32_16x16x32_bf16 v[148:151], v[52:55], v[36:39], v[148:151]
ds_read_b64_tr_b16 v[102:103], v6 offset:28672
v_mfma_f32_16x16x32_bf16 v[152:155], v[52:55], v[40:43], v[152:155]
ds_read_b64_tr_b16 v[112:113], v6 offset:40960
v_mfma_f32_16x16x32_bf16 v[156:159], v[52:55], v[44:47], v[156:159]
ds_read_b64_tr_b16 v[114:115], v6 offset:45056
v_mfma_f32_16x16x32_bf16 v[204:207], v[64:67], v[44:47], v[204:207]
ds_read_b64_tr_b16 v[104:105], v7 offset:24576
v_mfma_f32_16x16x32_bf16 v[200:203], v[64:67], v[40:43], v[200:203]
ds_read_b64_tr_b16 v[106:107], v7 offset:28672
v_mfma_f32_16x16x32_bf16 v[196:199], v[64:67], v[36:39], v[196:199]
ds_read_b64_tr_b16 v[116:117], v7 offset:40960
v_mfma_f32_16x16x32_bf16 v[192:195], v[64:67], v[32:35], v[192:195]
ds_read_b64_tr_b16 v[118:119], v7 offset:45056
v_mfma_f32_16x16x32_bf16 v[160:163], v[56:59], v[32:35], v[160:163]
v_mfma_f32_16x16x32_bf16 v[164:167], v[56:59], v[36:39], v[164:167]
v_mfma_f32_16x16x32_bf16 v[168:171], v[56:59], v[40:43], v[168:171]
v_mfma_f32_16x16x32_bf16 v[172:175], v[56:59], v[44:47], v[172:175]
v_mfma_f32_16x16x32_bf16 v[220:223], v[68:71], v[44:47], v[220:223]
v_mfma_f32_16x16x32_bf16 v[216:219], v[68:71], v[40:43], v[216:219]
v_mfma_f32_16x16x32_bf16 v[212:215], v[68:71], v[36:39], v[212:215]
v_mfma_f32_16x16x32_bf16 v[208:211], v[68:71], v[32:35], v[208:211]
s_waitcnt vmcnt(0) lgkmcnt(0)
s_barrier
v_mfma_f32_16x16x32_bf16 v[128:131], v[96:99], v[80:83], v[128:131]
ds_read_b128 v[32:35], v3 offset:0
v_mfma_f32_16x16x32_bf16 v[132:135], v[96:99], v[84:87], v[132:135]
ds_read_b64_tr_b16 v[48:49], v9 offset:16384
v_mfma_f32_16x16x32_bf16 v[136:139], v[96:99], v[88:91], v[136:139]
ds_read_b64_tr_b16 v[50:51], v9 offset:20480
v_mfma_f32_16x16x32_bf16 v[140:143], v[96:99], v[92:95], v[140:143]
ds_read_b128 v[36:39], v3 offset:256
v_mfma_f32_16x16x32_bf16 v[188:191], v[108:111], v[92:95], v[188:191]
ds_read_b128 v[40:43], v3 offset:512
v_mfma_f32_16x16x32_bf16 v[184:187], v[108:111], v[88:91], v[184:187]
ds_read_b128 v[44:47], v3 offset:768
v_mfma_f32_16x16x32_bf16 v[180:183], v[108:111], v[84:87], v[180:183]
ds_read_b64_tr_b16 v[60:61], v9 offset:32768
v_mfma_f32_16x16x32_bf16 v[176:179], v[108:111], v[80:83], v[176:179]
ds_read_b64_tr_b16 v[62:63], v9 offset:36864
v_mfma_f32_16x16x32_bf16 v[144:147], v[100:103], v[80:83], v[144:147]
ds_read_b64_tr_b16 v[52:53], v10 offset:16384
v_mfma_f32_16x16x32_bf16 v[148:151], v[100:103], v[84:87], v[148:151]
ds_read_b64_tr_b16 v[54:55], v10 offset:20480
v_mfma_f32_16x16x32_bf16 v[152:155], v[100:103], v[88:91], v[152:155]
ds_read_b64_tr_b16 v[64:65], v10 offset:32768
v_mfma_f32_16x16x32_bf16 v[156:159], v[100:103], v[92:95], v[156:159]
ds_read_b64_tr_b16 v[66:67], v10 offset:36864
v_mfma_f32_16x16x32_bf16 v[204:207], v[112:115], v[92:95], v[204:207]
ds_read_b64_tr_b16 v[56:57], v11 offset:16384
v_mfma_f32_16x16x32_bf16 v[200:203], v[112:115], v[88:91], v[200:203]
ds_read_b64_tr_b16 v[58:59], v11 offset:20480
v_mfma_f32_16x16x32_bf16 v[196:199], v[112:115], v[84:87], v[196:199]
ds_read_b64_tr_b16 v[68:69], v11 offset:32768
v_mfma_f32_16x16x32_bf16 v[192:195], v[112:115], v[80:83], v[192:195]
ds_read_b64_tr_b16 v[70:71], v11 offset:36864
v_mfma_f32_16x16x32_bf16 v[160:163], v[104:107], v[80:83], v[160:163]
v_mfma_f32_16x16x32_bf16 v[164:167], v[104:107], v[84:87], v[164:167]
v_mfma_f32_16x16x32_bf16 v[168:171], v[104:107], v[88:91], v[168:171]
v_mfma_f32_16x16x32_bf16 v[172:175], v[104:107], v[92:95], v[172:175]
v_mfma_f32_16x16x32_bf16 v[220:223], v[116:119], v[92:95], v[220:223]
v_mfma_f32_16x16x32_bf16 v[216:219], v[116:119], v[88:91], v[216:219]
v_mfma_f32_16x16x32_bf16 v[212:215], v[116:119], v[84:87], v[212:215]
v_mfma_f32_16x16x32_bf16 v[208:211], v[116:119], v[80:83], v[208:211]
s_waitcnt lgkmcnt(0)
v_mfma_f32_16x16x32_bf16 v[128:131], v[48:51], v[32:35], v[128:131]
ds_read_b128 v[80:83], v3 offset:8192
v_mfma_f32_16x16x32_bf16 v[132:135], v[48:51], v[36:39], v[132:135]
ds_read_b64_tr_b16 v[96:97], v9 offset:24576
v_mfma_f32_16x16x32_bf16 v[136:139], v[48:51], v[40:43], v[136:139]
ds_read_b64_tr_b16 v[98:99], v9 offset:28672
v_mfma_f32_16x16x32_bf16 v[140:143], v[48:51], v[44:47], v[140:143]
ds_read_b128 v[84:87], v3 offset:8448
v_mfma_f32_16x16x32_bf16 v[188:191], v[60:63], v[44:47], v[188:191]
ds_read_b128 v[88:91], v3 offset:8704
v_mfma_f32_16x16x32_bf16 v[184:187], v[60:63], v[40:43], v[184:187]
ds_read_b128 v[92:95], v3 offset:8960
v_mfma_f32_16x16x32_bf16 v[180:183], v[60:63], v[36:39], v[180:183]
ds_read_b64_tr_b16 v[108:109], v9 offset:40960
v_mfma_f32_16x16x32_bf16 v[176:179], v[60:63], v[32:35], v[176:179]
ds_read_b64_tr_b16 v[110:111], v9 offset:45056
v_mfma_f32_16x16x32_bf16 v[144:147], v[52:55], v[32:35], v[144:147]
ds_read_b64_tr_b16 v[100:101], v10 offset:24576
v_mfma_f32_16x16x32_bf16 v[148:151], v[52:55], v[36:39], v[148:151]
ds_read_b64_tr_b16 v[102:103], v10 offset:28672
v_mfma_f32_16x16x32_bf16 v[152:155], v[52:55], v[40:43], v[152:155]
ds_read_b64_tr_b16 v[112:113], v10 offset:40960
v_mfma_f32_16x16x32_bf16 v[156:159], v[52:55], v[44:47], v[156:159]
ds_read_b64_tr_b16 v[114:115], v10 offset:45056
v_mfma_f32_16x16x32_bf16 v[204:207], v[64:67], v[44:47], v[204:207]
ds_read_b64_tr_b16 v[104:105], v11 offset:24576
v_mfma_f32_16x16x32_bf16 v[200:203], v[64:67], v[40:43], v[200:203]
ds_read_b64_tr_b16 v[106:107], v11 offset:28672
v_mfma_f32_16x16x32_bf16 v[196:199], v[64:67], v[36:39], v[196:199]
ds_read_b64_tr_b16 v[116:117], v11 offset:40960
v_mfma_f32_16x16x32_bf16 v[192:195], v[64:67], v[32:35], v[192:195]
ds_read_b64_tr_b16 v[118:119], v11 offset:45056
v_mfma_f32_16x16x32_bf16 v[160:163], v[56:59], v[32:35], v[160:163]
v_mfma_f32_16x16x32_bf16 v[164:167], v[56:59], v[36:39], v[164:167]
v_mfma_f32_16x16x32_bf16 v[168:171], v[56:59], v[40:43], v[168:171]
v_mfma_f32_16x16x32_bf16 v[172:175], v[56:59], v[44:47], v[172:175]
v_mfma_f32_16x16x32_bf16 v[220:223], v[68:71], v[44:47], v[220:223]
v_mfma_f32_16x16x32_bf16 v[216:219], v[68:71], v[40:43], v[216:219]
v_mfma_f32_16x16x32_bf16 v[212:215], v[68:71], v[36:39], v[212:215]
v_mfma_f32_16x16x32_bf16 v[208:211], v[68:71], v[32:35], v[208:211]
s_waitcnt lgkmcnt(0)
s_barrier
v_mfma_f32_16x16x32_bf16 v[128:131], v[96:99], v[80:83], v[128:131]
ds_read_b128 v[32:35], v4 offset:0
v_mfma_f32_16x16x32_bf16 v[132:135], v[96:99], v[84:87], v[132:135]
ds_read_b64_tr_b16 v[48:49], v13 offset:16384
v_mfma_f32_16x16x32_bf16 v[136:139], v[96:99], v[88:91], v[136:139]
ds_read_b64_tr_b16 v[50:51], v13 offset:20480
v_mfma_f32_16x16x32_bf16 v[140:143], v[96:99], v[92:95], v[140:143]
ds_read_b128 v[36:39], v4 offset:256
v_mfma_f32_16x16x32_bf16 v[188:191], v[108:111], v[92:95], v[188:191]
ds_read_b128 v[40:43], v4 offset:512
v_mfma_f32_16x16x32_bf16 v[184:187], v[108:111], v[88:91], v[184:187]
ds_read_b128 v[44:47], v4 offset:768
v_mfma_f32_16x16x32_bf16 v[180:183], v[108:111], v[84:87], v[180:183]
ds_read_b64_tr_b16 v[60:61], v13 offset:32768
v_mfma_f32_16x16x32_bf16 v[176:179], v[108:111], v[80:83], v[176:179]
ds_read_b64_tr_b16 v[62:63], v13 offset:36864
v_mfma_f32_16x16x32_bf16 v[144:147], v[100:103], v[80:83], v[144:147]
ds_read_b64_tr_b16 v[52:53], v14 offset:16384
v_mfma_f32_16x16x32_bf16 v[148:151], v[100:103], v[84:87], v[148:151]
ds_read_b64_tr_b16 v[54:55], v14 offset:20480
v_mfma_f32_16x16x32_bf16 v[152:155], v[100:103], v[88:91], v[152:155]
ds_read_b64_tr_b16 v[64:65], v14 offset:32768
v_mfma_f32_16x16x32_bf16 v[156:159], v[100:103], v[92:95], v[156:159]
ds_read_b64_tr_b16 v[66:67], v14 offset:36864
v_mfma_f32_16x16x32_bf16 v[204:207], v[112:115], v[92:95], v[204:207]
ds_read_b64_tr_b16 v[56:57], v15 offset:16384
v_mfma_f32_16x16x32_bf16 v[200:203], v[112:115], v[88:91], v[200:203]
ds_read_b64_tr_b16 v[58:59], v15 offset:20480
v_mfma_f32_16x16x32_bf16 v[196:199], v[112:115], v[84:87], v[196:199]
ds_read_b64_tr_b16 v[68:69], v15 offset:32768
v_mfma_f32_16x16x32_bf16 v[192:195], v[112:115], v[80:83], v[192:195]
ds_read_b64_tr_b16 v[70:71], v15 offset:36864
v_mfma_f32_16x16x32_bf16 v[160:163], v[104:107], v[80:83], v[160:163]
v_mfma_f32_16x16x32_bf16 v[164:167], v[104:107], v[84:87], v[164:167]
v_mfma_f32_16x16x32_bf16 v[168:171], v[104:107], v[88:91], v[168:171]
v_mfma_f32_16x16x32_bf16 v[172:175], v[104:107], v[92:95], v[172:175]
v_mfma_f32_16x16x32_bf16 v[220:223], v[116:119], v[92:95], v[220:223]
v_mfma_f32_16x16x32_bf16 v[216:219], v[116:119], v[88:91], v[216:219]
v_mfma_f32_16x16x32_bf16 v[212:215], v[116:119], v[84:87], v[212:215]
v_mfma_f32_16x16x32_bf16 v[208:211], v[116:119], v[80:83], v[208:211]
s_waitcnt lgkmcnt(0)
v_mfma_f32_16x16x32_bf16 v[128:131], v[48:51], v[32:35], v[128:131]
ds_read_b128 v[80:83], v4 offset:8192
v_mfma_f32_16x16x32_bf16 v[132:135], v[48:51], v[36:39], v[132:135]
ds_read_b64_tr_b16 v[96:97], v13 offset:24576
v_mfma_f32_16x16x32_bf16 v[136:139], v[48:51], v[40:43], v[136:139]
ds_read_b64_tr_b16 v[98:99], v13 offset:28672
v_mfma_f32_16x16x32_bf16 v[140:143], v[48:51], v[44:47], v[140:143]
ds_read_b128 v[84:87], v4 offset:8448
v_mfma_f32_16x16x32_bf16 v[188:191], v[60:63], v[44:47], v[188:191]
ds_read_b128 v[88:91], v4 offset:8704
v_mfma_f32_16x16x32_bf16 v[184:187], v[60:63], v[40:43], v[184:187]
ds_read_b128 v[92:95], v4 offset:8960
v_mfma_f32_16x16x32_bf16 v[180:183], v[60:63], v[36:39], v[180:183]
ds_read_b64_tr_b16 v[108:109], v13 offset:40960
v_mfma_f32_16x16x32_bf16 v[176:179], v[60:63], v[32:35], v[176:179]
ds_read_b64_tr_b16 v[110:111], v13 offset:45056
v_mfma_f32_16x16x32_bf16 v[144:147], v[52:55], v[32:35], v[144:147]
ds_read_b64_tr_b16 v[100:101], v14 offset:24576
v_mfma_f32_16x16x32_bf16 v[148:151], v[52:55], v[36:39], v[148:151]
ds_read_b64_tr_b16 v[102:103], v14 offset:28672
v_mfma_f32_16x16x32_bf16 v[152:155], v[52:55], v[40:43], v[152:155]
ds_read_b64_tr_b16 v[112:113], v14 offset:40960
v_mfma_f32_16x16x32_bf16 v[156:159], v[52:55], v[44:47], v[156:159]
ds_read_b64_tr_b16 v[114:115], v14 offset:45056
v_mfma_f32_16x16x32_bf16 v[204:207], v[64:67], v[44:47], v[204:207]
ds_read_b64_tr_b16 v[104:105], v15 offset:24576
v_mfma_f32_16x16x32_bf16 v[200:203], v[64:67], v[40:43], v[200:203]
ds_read_b64_tr_b16 v[106:107], v15 offset:28672
v_mfma_f32_16x16x32_bf16 v[196:199], v[64:67], v[36:39], v[196:199]
ds_read_b64_tr_b16 v[116:117], v15 offset:40960
v_mfma_f32_16x16x32_bf16 v[192:195], v[64:67], v[32:35], v[192:195]
ds_read_b64_tr_b16 v[118:119], v15 offset:45056
v_mfma_f32_16x16x32_bf16 v[160:163], v[56:59], v[32:35], v[160:163]
v_mfma_f32_16x16x32_bf16 v[164:167], v[56:59], v[36:39], v[164:167]
v_mfma_f32_16x16x32_bf16 v[168:171], v[56:59], v[40:43], v[168:171]
v_mfma_f32_16x16x32_bf16 v[172:175], v[56:59], v[44:47], v[172:175]
v_mfma_f32_16x16x32_bf16 v[220:223], v[68:71], v[44:47], v[220:223]
v_mfma_f32_16x16x32_bf16 v[216:219], v[68:71], v[40:43], v[216:219]
v_mfma_f32_16x16x32_bf16 v[212:215], v[68:71], v[36:39], v[212:215]
v_mfma_f32_16x16x32_bf16 v[208:211], v[68:71], v[32:35], v[208:211]
s_waitcnt lgkmcnt(0)
s_barrier
v_mfma_f32_16x16x32_bf16 v[128:131], v[96:99], v[80:83], v[128:131]
ds_read_b128 v[32:35], v2 offset:0
v_mfma_f32_16x16x32_bf16 v[132:135], v[96:99], v[84:87], v[132:135]
ds_read_b64_tr_b16 v[48:49], v5 offset:16384
v_mfma_f32_16x16x32_bf16 v[136:139], v[96:99], v[88:91], v[136:139]
ds_read_b64_tr_b16 v[50:51], v5 offset:20480
v_mfma_f32_16x16x32_bf16 v[140:143], v[96:99], v[92:95], v[140:143]
ds_read_b128 v[36:39], v2 offset:256
v_mfma_f32_16x16x32_bf16 v[188:191], v[108:111], v[92:95], v[188:191]
ds_read_b128 v[40:43], v2 offset:512
v_mfma_f32_16x16x32_bf16 v[184:187], v[108:111], v[88:91], v[184:187]
ds_read_b128 v[44:47], v2 offset:768
v_mfma_f32_16x16x32_bf16 v[180:183], v[108:111], v[84:87], v[180:183]
ds_read_b64_tr_b16 v[60:61], v5 offset:32768
v_mfma_f32_16x16x32_bf16 v[176:179], v[108:111], v[80:83], v[176:179]
ds_read_b64_tr_b16 v[62:63], v5 offset:36864
v_mfma_f32_16x16x32_bf16 v[144:147], v[100:103], v[80:83], v[144:147]
ds_read_b64_tr_b16 v[52:53], v6 offset:16384
v_mfma_f32_16x16x32_bf16 v[148:151], v[100:103], v[84:87], v[148:151]
ds_read_b64_tr_b16 v[54:55], v6 offset:20480
v_mfma_f32_16x16x32_bf16 v[152:155], v[100:103], v[88:91], v[152:155]
ds_read_b64_tr_b16 v[64:65], v6 offset:32768
v_mfma_f32_16x16x32_bf16 v[156:159], v[100:103], v[92:95], v[156:159]
ds_read_b64_tr_b16 v[66:67], v6 offset:36864
v_mfma_f32_16x16x32_bf16 v[204:207], v[112:115], v[92:95], v[204:207]
ds_read_b64_tr_b16 v[56:57], v7 offset:16384
v_mfma_f32_16x16x32_bf16 v[200:203], v[112:115], v[88:91], v[200:203]
ds_read_b64_tr_b16 v[58:59], v7 offset:20480
v_mfma_f32_16x16x32_bf16 v[196:199], v[112:115], v[84:87], v[196:199]
ds_read_b64_tr_b16 v[68:69], v7 offset:32768
v_mfma_f32_16x16x32_bf16 v[192:195], v[112:115], v[80:83], v[192:195]
ds_read_b64_tr_b16 v[70:71], v7 offset:36864
v_mfma_f32_16x16x32_bf16 v[160:163], v[104:107], v[80:83], v[160:163]
v_mfma_f32_16x16x32_bf16 v[164:167], v[104:107], v[84:87], v[164:167]
v_mfma_f32_16x16x32_bf16 v[168:171], v[104:107], v[88:91], v[168:171]
v_mfma_f32_16x16x32_bf16 v[172:175], v[104:107], v[92:95], v[172:175]
v_mfma_f32_16x16x32_bf16 v[220:223], v[116:119], v[92:95], v[220:223]
v_mfma_f32_16x16x32_bf16 v[216:219], v[116:119], v[88:91], v[216:219]
v_mfma_f32_16x16x32_bf16 v[212:215], v[116:119], v[84:87], v[212:215]
v_mfma_f32_16x16x32_bf16 v[208:211], v[116:119], v[80:83], v[208:211]
s_sub_u32 s41, s41, 1
s_cmp_lg_u32 s41, 0
s_cbranch_scc1 Lk3_54
s_waitcnt lgkmcnt(0)
v_mfma_f32_16x16x32_bf16 v[128:131], v[48:51], v[32:35], v[128:131]
ds_read_b128 v[80:83], v2 offset:8192
v_mfma_f32_16x16x32_bf16 v[132:135], v[48:51], v[36:39], v[132:135]
ds_read_b64_tr_b16 v[96:97], v5 offset:24576
v_mfma_f32_16x16x32_bf16 v[136:139], v[48:51], v[40:43], v[136:139]
ds_read_b64_tr_b16 v[98:99], v5 offset:28672
v_mfma_f32_16x16x32_bf16 v[140:143], v[48:51], v[44:47], v[140:143]
ds_read_b128 v[84:87], v2 offset:8448
v_mfma_f32_16x16x32_bf16 v[188:191], v[60:63], v[44:47], v[188:191]
ds_read_b128 v[88:91], v2 offset:8704
v_mfma_f32_16x16x32_bf16 v[184:187], v[60:63], v[40:43], v[184:187]
ds_read_b128 v[92:95], v2 offset:8960
v_mfma_f32_16x16x32_bf16 v[180:183], v[60:63], v[36:39], v[180:183]
ds_read_b64_tr_b16 v[108:109], v5 offset:40960
v_mfma_f32_16x16x32_bf16 v[176:179], v[60:63], v[32:35], v[176:179]
ds_read_b64_tr_b16 v[110:111], v5 offset:45056
v_mfma_f32_16x16x32_bf16 v[144:147], v[52:55], v[32:35], v[144:147]
ds_read_b64_tr_b16 v[100:101], v6 offset:24576
v_mfma_f32_16x16x32_bf16 v[148:151], v[52:55], v[36:39], v[148:151]
ds_read_b64_tr_b16 v[102:103], v6 offset:28672
v_mfma_f32_16x16x32_bf16 v[152:155], v[52:55], v[40:43], v[152:155]
ds_read_b64_tr_b16 v[112:113], v6 offset:40960
v_mfma_f32_16x16x32_bf16 v[156:159], v[52:55], v[44:47], v[156:159]
ds_read_b64_tr_b16 v[114:115], v6 offset:45056
v_mfma_f32_16x16x32_bf16 v[204:207], v[64:67], v[44:47], v[204:207]
ds_read_b64_tr_b16 v[104:105], v7 offset:24576
v_mfma_f32_16x16x32_bf16 v[200:203], v[64:67], v[40:43], v[200:203]
ds_read_b64_tr_b16 v[106:107], v7 offset:28672
v_mfma_f32_16x16x32_bf16 v[196:199], v[64:67], v[36:39], v[196:199]
ds_read_b64_tr_b16 v[116:117], v7 offset:40960
v_mfma_f32_16x16x32_bf16 v[192:195], v[64:67], v[32:35], v[192:195]
ds_read_b64_tr_b16 v[118:119], v7 offset:45056
v_mfma_f32_16x16x32_bf16 v[160:163], v[56:59], v[32:35], v[160:163]
v_mfma_f32_16x16x32_bf16 v[164:167], v[56:59], v[36:39], v[164:167]
v_mfma_f32_16x16x32_bf16 v[168:171], v[56:59], v[40:43], v[168:171]
v_mfma_f32_16x16x32_bf16 v[172:175], v[56:59], v[44:47], v[172:175]
v_mfma_f32_16x16x32_bf16 v[220:223], v[68:71], v[44:47], v[220:223]
v_mfma_f32_16x16x32_bf16 v[216:219], v[68:71], v[40:43], v[216:219]
v_mfma_f32_16x16x32_bf16 v[212:215], v[68:71], v[36:39], v[212:215]
v_mfma_f32_16x16x32_bf16 v[208:211], v[68:71], v[32:35], v[208:211]
s_waitcnt lgkmcnt(0)
s_barrier
s_cmp_eq_u32 s36, 7
s_cbranch_scc1 L7b_55
s_add_u32 m0, s39, 0
s_add_u32 s37, s37, s40
buffer_load_dwordx4 v21, s[8:11], s37 offen sc1 lds
v_mfma_f32_16x16x32_bf16 v[128:131], v[96:99], v[80:83], v[128:131]
v_mfma_f32_16x16x32_bf16 v[132:135], v[96:99], v[84:87], v[132:135]
s_add_u32 m0, s39, 1024
s_add_u32 s37, s37, s38
buffer_load_dwordx4 v21, s[8:11], s37 offen sc1 lds
v_mfma_f32_16x16x32_bf16 v[136:139], v[96:99], v[88:91], v[136:139]
s_add_u32 m0, s39, 2048
s_add_u32 s37, s37, s38
buffer_load_dwordx4 v21, s[8:11], s37 offen sc1 lds
v_mfma_f32_16x16x32_bf16 v[140:143], v[96:99], v[92:95], v[140:143]
v_mfma_f32_16x16x32_bf16 v[188:191], v[108:111], v[92:95], v[188:191]
s_add_u32 m0, s39, 3072
s_add_u32 s37, s37, s38
buffer_load_dwordx4 v21, s[8:11], s37 offen sc1 lds
v_mfma_f32_16x16x32_bf16 v[184:187], v[108:111], v[88:91], v[184:187]
s_add_u32 m0, s39, 4096
s_add_u32 s37, s37, s55
buffer_load_dwordx4 v21, s[8:11], s37 offen sc1 lds
v_mfma_f32_16x16x32_bf16 v[180:183], v[108:111], v[84:87], v[180:183]
v_mfma_f32_16x16x32_bf16 v[176:179], v[108:111], v[80:83], v[176:179]
s_add_u32 m0, s39, 5120
s_add_u32 s37, s37, s38
buffer_load_dwordx4 v21, s[8:11], s37 offen sc1 lds
v_mfma_f32_16x16x32_bf16 v[144:147], v[100:103], v[80:83], v[144:147]
s_add_u32 m0, s39, 6144
s_add_u32 s37, s37, s38
buffer_load_dwordx4 v21, s[8:11], s37 offen sc1 lds
v_mfma_f32_16x16x32_bf16 v[148:151], v[100:103], v[84:87], v[148:151]
v_mfma_f32_16x16x32_bf16 v[152:155], v[100:103], v[88:91], v[152:155]
s_add_u32 m0, s39, 7168
s_add_u32 s37, s37, s38
buffer_load_dwordx4 v21, s[8:11], s37 offen sc1 lds
v_mfma_f32_16x16x32_bf16 v[156:159], v[100:103], v[92:95], v[156:159]
s_add_u32 m0, s39, 32768
s_add_u32 s37, s37, s40
buffer_load_dwordx4 v21, s[8:11], s37 offen sc1 lds
v_mfma_f32_16x16x32_bf16 v[204:207], v[112:115], v[92:95], v[204:207]
v_mfma_f32_16x16x32_bf16 v[200:203], v[112:115], v[88:91], v[200:203]
s_add_u32 m0, s39, 33792
s_add_u32 s37, s37, s38
buffer_load_dwordx4 v21, s[8:11], s37 offen sc1 lds
v_mfma_f32_16x16x32_bf16 v[196:199], v[112:115], v[84:87], v[196:199]
s_add_u32 m0, s39, 34816
s_add_u32 s37, s37, s38
buffer_load_dwordx4 v21, s[8:11], s37 offen sc1 lds
v_mfma_f32_16x16x32_bf16 v[192:195], v[112:115], v[80:83], v[192:195]
v_mfma_f32_16x16x32_bf16 v[160:163], v[104:107], v[80:83], v[160:163]
s_add_u32 m0, s39, 35840
s_add_u32 s37, s37, s38
buffer_load_dwordx4 v21, s[8:11], s37 offen sc1 lds
v_mfma_f32_16x16x32_bf16 v[164:167], v[104:107], v[84:87], v[164:167]
s_add_u32 m0, s39, 36864
s_add_u32 s37, s37, s55
buffer_load_dwordx4 v21, s[8:11], s37 offen sc1 lds
v_mfma_f32_16x16x32_bf16 v[168:171], v[104:107], v[88:91], v[168:171]
v_mfma_f32_16x16x32_bf16 v[172:175], v[104:107], v[92:95], v[172:175]
s_add_u32 m0, s39, 37888
s_add_u32 s37, s37, s38
buffer_load_dwordx4 v21, s[8:11], s37 offen sc1 lds
v_mfma_f32_16x16x32_bf16 v[220:223], v[116:119], v[92:95], v[220:223]
s_add_u32 m0, s39, 38912
s_add_u32 s37, s37, s38
buffer_load_dwordx4 v21, s[8:11], s37 offen sc1 lds
v_mfma_f32_16x16x32_bf16 v[216:219], v[116:119], v[88:91], v[216:219]
v_mfma_f32_16x16x32_bf16 v[212:215], v[116:119], v[84:87], v[212:215]
s_add_u32 m0, s39, 39936
s_add_u32 s37, s37, s38
buffer_load_dwordx4 v21, s[8:11], s37 offen sc1 lds
v_mfma_f32_16x16x32_bf16 v[208:211], v[116:119], v[80:83], v[208:211]
s_setprio 0
s_barrier
s_add_u32 s37, s37, s54
s_add_u32 m0, s39, 65536
s_add_u32 s37, s37, s40
buffer_load_dwordx4 v21, s[8:11], s37 offen sc1 lds
v_mul_f32 v80, v128, v128
v_mul_f32 v81, v129, v129
v_mul_f32 v82, v130, v130
v_mul_f32 v83, v131, v131
v_fma_f32 v80, v80, v232, v228
v_fma_f32 v81, v81, v232, v228
v_fma_f32 v82, v82, v232, v228
s_add_u32 m0, s39, 66560
s_add_u32 s37, s37, s38
buffer_load_dwordx4 v21, s[8:11], s37 offen sc1 lds
v_fma_f32 v83, v83, v232, v228
v_mul_f32 v80, v80, v128
v_mul_f32 v81, v81, v129
v_mul_f32 v82, v82, v130
v_mul_f32 v83, v83, v131
v_exp_f32 v80, v80
s_add_u32 m0, s39, 67584
s_add_u32 s37, s37, s38
buffer_load_dwordx4 v21, s[8:11], s37 offen sc1 lds
v_exp_f32 v81, v81
v_exp_f32 v82, v82
v_exp_f32 v83, v83
v_mul_f32 v176, v128, v176
v_mul_f32 v177, v129, v177
v_mul_f32 v178, v130, v178
v_mul_f32 v179, v131, v179
s_add_u32 m0, s39, 68608
s_add_u32 s37, s37, s38
buffer_load_dwordx4 v21, s[8:11], s37 offen sc1 lds
v_fma_f32 v80, v80, v236, v236
v_fma_f32 v81, v81, v236, v236
v_fma_f32 v82, v82, v236, v236
v_fma_f32 v83, v83, v236, v236
v_rcp_f32 v80, v80
v_rcp_f32 v81, v81
s_add_u32 m0, s39, 69632
s_add_u32 s37, s37, s55
buffer_load_dwordx4 v21, s[8:11], s37 offen sc1 lds
v_rcp_f32 v82, v82
v_rcp_f32 v83, v83
v_mul_f32 v176, v176, v80
v_mul_f32 v177, v177, v81
v_mul_f32 v178, v178, v82
v_mul_f32 v179, v179, v83
v_cvt_pk_bf16_f32 v96, v176, v177
s_add_u32 m0, s39, 70656
s_add_u32 s37, s37, s38
buffer_load_dwordx4 v21, s[8:11], s37 offen sc1 lds
v_cvt_pk_bf16_f32 v97, v178, v179
v_mul_f32 v84, v144, v144
v_mul_f32 v85, v145, v145
v_mul_f32 v86, v146, v146
v_mul_f32 v87, v147, v147
v_fma_f32 v84, v84, v232, v228
s_add_u32 m0, s39, 71680
s_add_u32 s37, s37, s38
buffer_load_dwordx4 v21, s[8:11], s37 offen sc1 lds
v_fma_f32 v85, v85, v232, v228
v_fma_f32 v86, v86, v232, v228
v_fma_f32 v87, v87, v232, v228
v_mul_f32 v84, v84, v144
v_mul_f32 v85, v85, v145
v_mul_f32 v86, v86, v146
v_mul_f32 v87, v87, v147
s_add_u32 m0, s39, 72704
s_add_u32 s37, s37, s38
buffer_load_dwordx4 v21, s[8:11], s37 offen sc1 lds
v_exp_f32 v84, v84
v_exp_f32 v85, v85
v_exp_f32 v86, v86
v_exp_f32 v87, v87
v_mul_f32 v192, v144, v192
v_mul_f32 v193, v145, v193
s_waitcnt vmcnt(16)
s_barrier
s_add_u32 m0, s39, 98304
s_add_u32 s37, s37, s40
buffer_load_dwordx4 v21, s[8:11], s37 offen sc1 lds
v_mul_f32 v194, v146, v194
v_mul_f32 v195, v147, v195
v_fma_f32 v84, v84, v236, v236
v_fma_f32 v85, v85, v236, v236
v_fma_f32 v86, v86, v236, v236
v_fma_f32 v87, v87, v236, v236
v_rcp_f32 v84, v84
s_add_u32 m0, s39, 99328
s_add_u32 s37, s37, s38
buffer_load_dwordx4 v21, s[8:11], s37 offen sc1 lds
v_rcp_f32 v85, v85
v_rcp_f32 v86, v86
v_rcp_f32 v87, v87
v_mul_f32 v192, v192, v84
v_mul_f32 v193, v193, v85
v_mul_f32 v194, v194, v86
v_mul_f32 v195, v195, v87
s_add_u32 m0, s39, 100352
s_add_u32 s37, s37, s38
buffer_load_dwordx4 v21, s[8:11], s37 offen sc1 lds
v_cvt_pk_bf16_f32 v98, v192, v193
v_cvt_pk_bf16_f32 v99, v194, v195
v_mul_f32 v80, v160, v160
v_mul_f32 v81, v161, v161
v_mul_f32 v82, v162, v162
s_add_u32 m0, s39, 101376
s_add_u32 s37, s37, s38
buffer_load_dwordx4 v21, s[8:11], s37 offen sc1 lds
v_mul_f32 v83, v163, v163
v_fma_f32 v80, v80, v232, v228
v_fma_f32 v81, v81, v232, v228
v_fma_f32 v82, v82, v232, v228
v_fma_f32 v83, v83, v232, v228
v_mul_f32 v80, v80, v160
v_mul_f32 v81, v81, v161
s_add_u32 m0, s39, 102400
s_add_u32 s37, s37, s55
buffer_load_dwordx4 v21, s[8:11], s37 offen sc1 lds
v_mul_f32 v82, v82, v162
v_mul_f32 v83, v83, v163
v_exp_f32 v80, v80
v_exp_f32 v81, v81
v_exp_f32 v82, v82
v_exp_f32 v83, v83
v_mul_f32 v208, v160, v208
s_add_u32 m0, s39, 103424
s_add_u32 s37, s37, s38
buffer_load_dwordx4 v21, s[8:11], s37 offen sc1 lds
v_mul_f32 v209, v161, v209
v_mul_f32 v210, v162, v210
v_mul_f32 v211, v163, v211
v_fma_f32 v80, v80, v236, v236
v_fma_f32 v81, v81, v236, v236
v_fma_f32 v82, v82, v236, v236
s_add_u32 m0, s39, 104448
s_add_u32 s37, s37, s38
buffer_load_dwordx4 v21, s[8:11], s37 offen sc1 lds
v_fma_f32 v83, v83, v236, v236
v_rcp_f32 v80, v80
v_rcp_f32 v81, v81
v_rcp_f32 v82, v82
v_rcp_f32 v83, v83
v_mul_f32 v208, v208, v80
v_mul_f32 v209, v209, v81
s_add_u32 m0, s39, 105472
s_add_u32 s37, s37, s38
buffer_load_dwordx4 v21, s[8:11], s37 offen sc1 lds
v_mul_f32 v210, v210, v82
v_mul_f32 v211, v211, v83
v_cvt_pk_bf16_f32 v112, v208, v209
v_cvt_pk_bf16_f32 v113, v210, v211
v_mul_f32 v80, v132, v132
v_mul_f32 v81, v133, v133
buffer_store_dwordx4 v[96:99], v27, s[24:27], 0 offen offset:0 sc1
s_waitcnt vmcnt(17)
s_barrier
s_add_u32 m0, s39, 0
s_add_u32 s37, s37, s40
buffer_load_dwordx4 v21, s[8:11], s37 offen sc1 lds
v_mul_f32 v82, v134, v134
v_mul_f32 v83, v135, v135
v_fma_f32 v80, v80, v233, v229
v_fma_f32 v81, v81, v233, v229
v_fma_f32 v82, v82, v233, v229
v_fma_f32 v83, v83, v233, v229
v_mul_f32 v80, v80, v132
s_add_u32 m0, s39, 1024
s_add_u32 s37, s37, s38
buffer_load_dwordx4 v21, s[8:11], s37 offen sc1 lds
v_mul_f32 v81, v81, v133
v_mul_f32 v82, v82, v134
v_mul_f32 v83, v83, v135
v_exp_f32 v80, v80
v_exp_f32 v81, v81
v_exp_f32 v82, v82
s_add_u32 m0, s39, 2048
s_add_u32 s37, s37, s38
buffer_load_dwordx4 v21, s[8:11], s37 offen sc1 lds
v_exp_f32 v83, v83
v_mul_f32 v180, v132, v180
v_mul_f32 v181, v133, v181
v_mul_f32 v182, v134, v182
v_mul_f32 v183, v135, v183
v_fma_f32 v80, v80, v237, v237
v_fma_f32 v81, v81, v237, v237
s_add_u32 m0, s39, 3072
s_add_u32 s37, s37, s38
buffer_load_dwordx4 v21, s[8:11], s37 offen sc1 lds
v_fma_f32 v82, v82, v237, v237
v_fma_f32 v83, v83, v237, v237
v_rcp_f32 v80, v80
v_rcp_f32 v81, v81
v_rcp_f32 v82, v82
v_rcp_f32 v83, v83
s_add_u32 m0, s39, 4096
s_add_u32 s37, s37, s55
buffer_load_dwordx4 v21, s[8:11], s37 offen sc1 lds
v_mul_f32 v180, v180, v80
v_mul_f32 v181, v181, v81
v_mul_f32 v182, v182, v82
v_mul_f32 v183, v183, v83
v_cvt_pk_bf16_f32 v100, v180, v181
v_cvt_pk_bf16_f32 v101, v182, v183
v_mul_f32 v84, v148, v148
s_add_u32 m0, s39, 5120
s_add_u32 s37, s37, s38
buffer_load_dwordx4 v21, s[8:11], s37 offen sc1 lds
v_mul_f32 v85, v149, v149
v_mul_f32 v86, v150, v150
v_mul_f32 v87, v151, v151
v_fma_f32 v84, v84, v233, v229
v_fma_f32 v85, v85, v233, v229
v_fma_f32 v86, v86, v233, v229
s_add_u32 m0, s39, 6144
s_add_u32 s37, s37, s38
buffer_load_dwordx4 v21, s[8:11], s37 offen sc1 lds
v_fma_f32 v87, v87, v233, v229
v_mul_f32 v84, v84, v148
v_mul_f32 v85, v85, v149
v_mul_f32 v86, v86, v150
v_mul_f32 v87, v87, v151
v_exp_f32 v84, v84
v_exp_f32 v85, v85
s_add_u32 m0, s39, 7168
s_add_u32 s37, s37, s38
buffer_load_dwordx4 v21, s[8:11], s37 offen sc1 lds
v_exp_f32 v86, v86
v_exp_f32 v87, v87
v_mul_f32 v196, v148, v196
v_mul_f32 v197, v149, v197
v_mul_f32 v198, v150, v198
v_mul_f32 v199, v151, v199
s_waitcnt vmcnt(17)
s_barrier
s_add_u32 m0, s39, 32768
s_add_u32 s37, s37, s40
buffer_load_dwordx4 v21, s[8:11], s37 offen sc1 lds
v_fma_f32 v84, v84, v237, v237
v_fma_f32 v85, v85, v237, v237
v_fma_f32 v86, v86, v237, v237
v_fma_f32 v87, v87, v237, v237
v_rcp_f32 v84, v84
v_rcp_f32 v85, v85
v_rcp_f32 v86, v86
s_add_u32 m0, s39, 33792
s_add_u32 s37, s37, s38
buffer_load_dwordx4 v21, s[8:11], s37 offen sc1 lds
v_rcp_f32 v87, v87
v_mul_f32 v196, v196, v84
v_mul_f32 v197, v197, v85
v_mul_f32 v198, v198, v86
v_mul_f32 v199, v199, v87
v_cvt_pk_bf16_f32 v102, v196, v197
v_cvt_pk_bf16_f32 v103, v198, v199
s_add_u32 m0, s39, 34816
s_add_u32 s37, s37, s38
buffer_load_dwordx4 v21, s[8:11], s37 offen sc1 lds
v_mul_f32 v80, v164, v164
v_mul_f32 v81, v165, v165
v_mul_f32 v82, v166, v166
v_mul_f32 v83, v167, v167
v_fma_f32 v80, v80, v233, v229
s_add_u32 m0, s39, 35840
s_add_u32 s37, s37, s38
buffer_load_dwordx4 v21, s[8:11], s37 offen sc1 lds
v_fma_f32 v81, v81, v233, v229
v_fma_f32 v82, v82, v233, v229
v_fma_f32 v83, v83, v233, v229
v_mul_f32 v80, v80, v164
v_mul_f32 v81, v81, v165
v_mul_f32 v82, v82, v166
v_mul_f32 v83, v83, v167
s_add_u32 m0, s39, 36864
s_add_u32 s37, s37, s55
buffer_load_dwordx4 v21, s[8:11], s37 offen sc1 lds
v_exp_f32 v80, v80
v_exp_f32 v81, v81
v_exp_f32 v82, v82
v_exp_f32 v83, v83
v_mul_f32 v212, v164, v212
v_mul_f32 v213, v165, v213
v_mul_f32 v214, v166, v214
s_add_u32 m0, s39, 37888
s_add_u32 s37, s37, s38
buffer_load_dwordx4 v21, s[8:11], s37 offen sc1 lds
v_mul_f32 v215, v167, v215
v_fma_f32 v80, v80, v237, v237
v_fma_f32 v81, v81, v237, v237
v_fma_f32 v82, v82, v237, v237
v_fma_f32 v83, v83, v237, v237
v_rcp_f32 v80, v80
s_add_u32 m0, s39, 38912
s_add_u32 s37, s37, s38
buffer_load_dwordx4 v21, s[8:11], s37 offen sc1 lds
v_rcp_f32 v81, v81
v_rcp_f32 v82, v82
v_rcp_f32 v83, v83
v_mul_f32 v212, v212, v80
v_mul_f32 v213, v213, v81
v_mul_f32 v214, v214, v82
v_mul_f32 v215, v215, v83
s_add_u32 m0, s39, 39936
s_add_u32 s37, s37, s38
buffer_load_dwordx4 v21, s[8:11], s37 offen sc1 lds
v_cvt_pk_bf16_f32 v114, v212, v213
v_cvt_pk_bf16_f32 v115, v214, v215
s_nop 1
v_permlane32_swap_b32 v112, v114
v_permlane32_swap_b32 v113, v115
buffer_store_dwordx4 v[100:103], v27, s[24:27], 0 offen offset:256 sc1
buffer_store_dwordx4 v[112:115], v28, s[24:27], 0 offen offset:0 sc1
s_waitcnt vmcnt(19)
s_barrier
s_add_u32 m0, s39, 65536
s_add_u32 s37, s37, s40
buffer_load_dwordx4 v21, s[8:11], s37 offen sc1 lds
v_mul_f32 v80, v136, v136
v_mul_f32 v81, v137, v137
v_mul_f32 v82, v138, v138
v_mul_f32 v83, v139, v139
v_fma_f32 v80, v80, v234, v230
v_fma_f32 v81, v81, v234, v230
v_fma_f32 v82, v82, v234, v230
s_add_u32 m0, s39, 66560
s_add_u32 s37, s37, s38
buffer_load_dwordx4 v21, s[8:11], s37 offen sc1 lds
v_fma_f32 v83, v83, v234, v230
v_mul_f32 v80, v80, v136
v_mul_f32 v81, v81, v137
v_mul_f32 v82, v82, v138
v_mul_f32 v83, v83, v139
v_exp_f32 v80, v80
s_add_u32 m0, s39, 67584
s_add_u32 s37, s37, s38
buffer_load_dwordx4 v21, s[8:11], s37 offen sc1 lds
v_exp_f32 v81, v81
v_exp_f32 v82, v82
v_exp_f32 v83, v83
v_mul_f32 v184, v136, v184
v_mul_f32 v185, v137, v185
v_mul_f32 v186, v138, v186
v_mul_f32 v187, v139, v187
s_add_u32 m0, s39, 68608
s_add_u32 s37, s37, s38
buffer_load_dwordx4 v21, s[8:11], s37 offen sc1 lds
v_fma_f32 v80, v80, v238, v238
v_fma_f32 v81, v81, v238, v238
v_fma_f32 v82, v82, v238, v238
v_fma_f32 v83, v83, v238, v238
v_rcp_f32 v80, v80
v_rcp_f32 v81, v81
s_add_u32 m0, s39, 69632
s_add_u32 s37, s37, s55
buffer_load_dwordx4 v21, s[8:11], s37 offen sc1 lds
v_rcp_f32 v82, v82
v_rcp_f32 v83, v83
v_mul_f32 v184, v184, v80
v_mul_f32 v185, v185, v81
v_mul_f32 v186, v186, v82
v_mul_f32 v187, v187, v83
v_cvt_pk_bf16_f32 v104, v184, v185
s_add_u32 m0, s39, 70656
s_add_u32 s37, s37, s38
buffer_load_dwordx4 v21, s[8:11], s37 offen sc1 lds
v_cvt_pk_bf16_f32 v105, v186, v187
v_mul_f32 v84, v152, v152
v_mul_f32 v85, v153, v153
v_mul_f32 v86, v154, v154
v_mul_f32 v87, v155, v155
v_fma_f32 v84, v84, v234, v230
s_add_u32 m0, s39, 71680
s_add_u32 s37, s37, s38
buffer_load_dwordx4 v21, s[8:11], s37 offen sc1 lds
v_fma_f32 v85, v85, v234, v230
v_fma_f32 v86, v86, v234, v230
v_fma_f32 v87, v87, v234, v230
v_mul_f32 v84, v84, v152
v_mul_f32 v85, v85, v153
v_mul_f32 v86, v86, v154
v_mul_f32 v87, v87, v155
s_add_u32 m0, s39, 72704
s_add_u32 s37, s37, s38
buffer_load_dwordx4 v21, s[8:11], s37 offen sc1 lds
v_exp_f32 v84, v84
v_exp_f32 v85, v85
v_exp_f32 v86, v86
v_exp_f32 v87, v87
v_mul_f32 v200, v152, v200
v_mul_f32 v201, v153, v201
s_waitcnt vmcnt(18)
s_barrier
s_add_u32 m0, s39, 98304
s_add_u32 s37, s37, s40
buffer_load_dwordx4 v21, s[8:11], s37 offen sc1 lds
v_mul_f32 v202, v154, v202
v_mul_f32 v203, v155, v203
v_fma_f32 v84, v84, v238, v238
v_fma_f32 v85, v85, v238, v238
v_fma_f32 v86, v86, v238, v238
v_fma_f32 v87, v87, v238, v238
v_rcp_f32 v84, v84
s_add_u32 m0, s39, 99328
s_add_u32 s37, s37, s38
buffer_load_dwordx4 v21, s[8:11], s37 offen sc1 lds
v_rcp_f32 v85, v85
v_rcp_f32 v86, v86
v_rcp_f32 v87, v87
v_mul_f32 v200, v200, v84
v_mul_f32 v201, v201, v85
v_mul_f32 v202, v202, v86
v_mul_f32 v203, v203, v87
s_add_u32 m0, s39, 100352
s_add_u32 s37, s37, s38
buffer_load_dwordx4 v21, s[8:11], s37 offen sc1 lds
v_cvt_pk_bf16_f32 v106, v200, v201
v_cvt_pk_bf16_f32 v107, v202, v203
v_mul_f32 v80, v168, v168
v_mul_f32 v81, v169, v169
v_mul_f32 v82, v170, v170
s_add_u32 m0, s39, 101376
s_add_u32 s37, s37, s38
buffer_load_dwordx4 v21, s[8:11], s37 offen sc1 lds
v_mul_f32 v83, v171, v171
v_fma_f32 v80, v80, v234, v230
v_fma_f32 v81, v81, v234, v230
v_fma_f32 v82, v82, v234, v230
v_fma_f32 v83, v83, v234, v230
v_mul_f32 v80, v80, v168
v_mul_f32 v81, v81, v169
s_add_u32 m0, s39, 102400
s_add_u32 s37, s37, s55
buffer_load_dwordx4 v21, s[8:11], s37 offen sc1 lds
v_mul_f32 v82, v82, v170
v_mul_f32 v83, v83, v171
v_exp_f32 v80, v80
v_exp_f32 v81, v81
v_exp_f32 v82, v82
v_exp_f32 v83, v83
v_mul_f32 v216, v168, v216
s_add_u32 m0, s39, 103424
s_add_u32 s37, s37, s38
buffer_load_dwordx4 v21, s[8:11], s37 offen sc1 lds
v_mul_f32 v217, v169, v217
v_mul_f32 v218, v170, v218
v_mul_f32 v219, v171, v219
v_fma_f32 v80, v80, v238, v238
v_fma_f32 v81, v81, v238, v238
v_fma_f32 v82, v82, v238, v238
s_add_u32 m0, s39, 104448
s_add_u32 s37, s37, s38
buffer_load_dwordx4 v21, s[8:11], s37 offen sc1 lds
v_fma_f32 v83, v83, v238, v238
v_rcp_f32 v80, v80
v_rcp_f32 v81, v81
v_rcp_f32 v82, v82
v_rcp_f32 v83, v83
v_mul_f32 v216, v216, v80
v_mul_f32 v217, v217, v81
s_add_u32 m0, s39, 105472
s_add_u32 s37, s37, s38
buffer_load_dwordx4 v21, s[8:11], s37 offen sc1 lds
v_mul_f32 v218, v218, v82
v_mul_f32 v219, v219, v83
v_cvt_pk_bf16_f32 v116, v216, v217
v_cvt_pk_bf16_f32 v117, v218, v219
v_mul_f32 v80, v140, v140
v_mul_f32 v81, v141, v141
buffer_store_dwordx4 v[104:107], v27, s[24:27], 0 offen offset:512 sc1
s_waitcnt vmcnt(19)
s_barrier
s_add_u32 s37, s37, s29
s_add_u32 m0, s39, 0
s_add_u32 s37, s37, s40
buffer_load_dwordx4 v21, s[8:11], s37 offen sc1 lds
v_mul_f32 v82, v142, v142
v_mul_f32 v83, v143, v143
v_fma_f32 v80, v80, v235, v231
v_fma_f32 v81, v81, v235, v231
v_fma_f32 v82, v82, v235, v231
v_fma_f32 v83, v83, v235, v231
v_mul_f32 v80, v80, v140
s_add_u32 m0, s39, 1024
s_add_u32 s37, s37, s38
buffer_load_dwordx4 v21, s[8:11], s37 offen sc1 lds
v_mul_f32 v81, v81, v141
v_mul_f32 v82, v82, v142
v_mul_f32 v83, v83, v143
v_exp_f32 v80, v80
v_exp_f32 v81, v81
v_exp_f32 v82, v82
s_add_u32 m0, s39, 2048
s_add_u32 s37, s37, s38
buffer_load_dwordx4 v21, s[8:11], s37 offen sc1 lds
v_exp_f32 v83, v83
v_mul_f32 v188, v140, v188
v_mul_f32 v189, v141, v189
v_mul_f32 v190, v142, v190
v_mul_f32 v191, v143, v191
v_fma_f32 v80, v80, v239, v239
v_fma_f32 v81, v81, v239, v239
s_add_u32 m0, s39, 3072
s_add_u32 s37, s37, s38
buffer_load_dwordx4 v21, s[8:11], s37 offen sc1 lds
v_fma_f32 v82, v82, v239, v239
v_fma_f32 v83, v83, v239, v239
v_rcp_f32 v80, v80
v_rcp_f32 v81, v81
v_rcp_f32 v82, v82
v_rcp_f32 v83, v83
s_add_u32 m0, s39, 4096
s_add_u32 s37, s37, s55
buffer_load_dwordx4 v21, s[8:11], s37 offen sc1 lds
v_mul_f32 v188, v188, v80
v_mul_f32 v189, v189, v81
v_mul_f32 v190, v190, v82
v_mul_f32 v191, v191, v83
v_cvt_pk_bf16_f32 v108, v188, v189
v_cvt_pk_bf16_f32 v109, v190, v191
v_mul_f32 v84, v156, v156
s_add_u32 m0, s39, 5120
s_add_u32 s37, s37, s38
buffer_load_dwordx4 v21, s[8:11], s37 offen sc1 lds
v_mul_f32 v85, v157, v157
v_mul_f32 v86, v158, v158
v_mul_f32 v87, v159, v159
v_fma_f32 v84, v84, v235, v231
v_fma_f32 v85, v85, v235, v231
v_fma_f32 v86, v86, v235, v231
s_add_u32 m0, s39, 6144
s_add_u32 s37, s37, s38
buffer_load_dwordx4 v21, s[8:11], s37 offen sc1 lds
v_fma_f32 v87, v87, v235, v231
v_mul_f32 v84, v84, v156
v_mul_f32 v85, v85, v157
v_mul_f32 v86, v86, v158
v_mul_f32 v87, v87, v159
v_exp_f32 v84, v84
v_exp_f32 v85, v85
s_add_u32 m0, s39, 7168
s_add_u32 s37, s37, s38
buffer_load_dwordx4 v21, s[8:11], s37 offen sc1 lds
v_exp_f32 v86, v86
v_exp_f32 v87, v87
v_mul_f32 v204, v156, v204
v_mul_f32 v205, v157, v205
v_mul_f32 v206, v158, v206
v_mul_f32 v207, v159, v207
s_waitcnt vmcnt(17)
s_barrier
s_add_u32 m0, s39, 32768
s_add_u32 s37, s37, s40
buffer_load_dwordx4 v21, s[8:11], s37 offen sc1 lds
v_fma_f32 v84, v84, v239, v239
v_fma_f32 v85, v85, v239, v239
v_fma_f32 v86, v86, v239, v239
v_fma_f32 v87, v87, v239, v239
v_rcp_f32 v84, v84
v_rcp_f32 v85, v85
v_rcp_f32 v86, v86
s_add_u32 m0, s39, 33792
s_add_u32 s37, s37, s38
buffer_load_dwordx4 v21, s[8:11], s37 offen sc1 lds
v_rcp_f32 v87, v87
v_mul_f32 v204, v204, v84
v_mul_f32 v205, v205, v85
v_mul_f32 v206, v206, v86
v_mul_f32 v207, v207, v87
v_cvt_pk_bf16_f32 v110, v204, v205
v_cvt_pk_bf16_f32 v111, v206, v207
s_add_u32 m0, s39, 34816
s_add_u32 s37, s37, s38
buffer_load_dwordx4 v21, s[8:11], s37 offen sc1 lds
v_mul_f32 v80, v172, v172
v_mul_f32 v81, v173, v173
v_mul_f32 v82, v174, v174
v_mul_f32 v83, v175, v175
v_fma_f32 v80, v80, v235, v231
s_add_u32 m0, s39, 35840
s_add_u32 s37, s37, s38
buffer_load_dwordx4 v21, s[8:11], s37 offen sc1 lds
v_fma_f32 v81, v81, v235, v231
v_fma_f32 v82, v82, v235, v231
v_fma_f32 v83, v83, v235, v231
v_mul_f32 v80, v80, v172
v_mul_f32 v81, v81, v173
v_mul_f32 v82, v82, v174
v_mul_f32 v83, v83, v175
s_add_u32 m0, s39, 36864
s_add_u32 s37, s37, s55
buffer_load_dwordx4 v21, s[8:11], s37 offen sc1 lds
v_exp_f32 v80, v80
v_exp_f32 v81, v81
v_exp_f32 v82, v82
v_exp_f32 v83, v83
v_mul_f32 v220, v172, v220
v_mul_f32 v221, v173, v221
v_mul_f32 v222, v174, v222
s_add_u32 m0, s39, 37888
s_add_u32 s37, s37, s38
buffer_load_dwordx4 v21, s[8:11], s37 offen sc1 lds
v_mul_f32 v223, v175, v223
v_fma_f32 v80, v80, v239, v239
v_fma_f32 v81, v81, v239, v239
v_fma_f32 v82, v82, v239, v239
v_fma_f32 v83, v83, v239, v239
v_rcp_f32 v80, v80
s_add_u32 m0, s39, 38912
s_add_u32 s37, s37, s38
buffer_load_dwordx4 v21, s[8:11], s37 offen sc1 lds
v_rcp_f32 v81, v81
v_rcp_f32 v82, v82
v_rcp_f32 v83, v83
v_mul_f32 v220, v220, v80
v_mul_f32 v221, v221, v81
v_mul_f32 v222, v222, v82
v_mul_f32 v223, v223, v83
s_add_u32 m0, s39, 39936
s_add_u32 s37, s37, s38
buffer_load_dwordx4 v21, s[8:11], s37 offen sc1 lds
v_cvt_pk_bf16_f32 v118, v220, v221
v_cvt_pk_bf16_f32 v119, v222, v223
s_nop 1
v_permlane32_swap_b32 v116, v118
v_permlane32_swap_b32 v117, v119
buffer_store_dwordx4 v[108:111], v27, s[24:27], 0 offen offset:768 sc1
buffer_store_dwordx4 v[116:119], v28, s[24:27], 0 offen offset:512 sc1
s_waitcnt vmcnt(19)
s_barrier
s_add_u32 m0, s39, 65536
s_add_u32 s37, s37, s40
buffer_load_dwordx4 v21, s[8:11], s37 offen sc1 lds
s_add_u32 m0, s39, 66560
s_add_u32 s37, s37, s38
buffer_load_dwordx4 v21, s[8:11], s37 offen sc1 lds
s_add_u32 m0, s39, 67584
s_add_u32 s37, s37, s38
buffer_load_dwordx4 v21, s[8:11], s37 offen sc1 lds
s_add_u32 m0, s39, 68608
s_add_u32 s37, s37, s38
buffer_load_dwordx4 v21, s[8:11], s37 offen sc1 lds
s_add_u32 m0, s39, 69632
s_add_u32 s37, s37, s55
buffer_load_dwordx4 v21, s[8:11], s37 offen sc1 lds
s_add_u32 m0, s39, 70656
s_add_u32 s37, s37, s38
buffer_load_dwordx4 v21, s[8:11], s37 offen sc1 lds
s_add_u32 m0, s39, 71680
s_add_u32 s37, s37, s38
buffer_load_dwordx4 v21, s[8:11], s37 offen sc1 lds
s_add_u32 m0, s39, 72704
s_add_u32 s37, s37, s38
buffer_load_dwordx4 v21, s[8:11], s37 offen sc1 lds
s_waitcnt vmcnt(8)
s_barrier
s_add_u32 m0, s39, 98304
s_add_u32 s37, s37, s40
buffer_load_dwordx4 v21, s[8:11], s37 offen sc1 lds
s_add_u32 m0, s39, 99328
s_add_u32 s37, s37, s38
buffer_load_dwordx4 v21, s[8:11], s37 offen sc1 lds
s_add_u32 m0, s39, 100352
s_add_u32 s37, s37, s38
buffer_load_dwordx4 v21, s[8:11], s37 offen sc1 lds
s_add_u32 m0, s39, 101376
s_add_u32 s37, s37, s38
buffer_load_dwordx4 v21, s[8:11], s37 offen sc1 lds
s_add_u32 m0, s39, 102400
s_add_u32 s37, s37, s55
buffer_load_dwordx4 v21, s[8:11], s37 offen sc1 lds
s_add_u32 m0, s39, 103424
s_add_u32 s37, s37, s38
buffer_load_dwordx4 v21, s[8:11], s37 offen sc1 lds
s_add_u32 m0, s39, 104448
s_add_u32 s37, s37, s38
buffer_load_dwordx4 v21, s[8:11], s37 offen sc1 lds
s_add_u32 m0, s39, 105472
s_add_u32 s37, s37, s38
buffer_load_dwordx4 v21, s[8:11], s37 offen sc1 lds
s_waitcnt vmcnt(18)
s_barrier
s_add_u32 m0, s39, 0
s_add_u32 s37, s37, s40
buffer_load_dwordx4 v21, s[8:11], s37 offen sc1 lds
s_add_u32 m0, s39, 1024
s_add_u32 s37, s37, s38
buffer_load_dwordx4 v21, s[8:11], s37 offen sc1 lds
s_add_u32 m0, s39, 2048
s_add_u32 s37, s37, s38
buffer_load_dwordx4 v21, s[8:11], s37 offen sc1 lds
s_add_u32 m0, s39, 3072
s_add_u32 s37, s37, s38
buffer_load_dwordx4 v21, s[8:11], s37 offen sc1 lds
s_add_u32 m0, s39, 4096
s_add_u32 s37, s37, s55
buffer_load_dwordx4 v21, s[8:11], s37 offen sc1 lds
s_add_u32 m0, s39, 5120
s_add_u32 s37, s37, s38
buffer_load_dwordx4 v21, s[8:11], s37 offen sc1 lds
s_add_u32 m0, s39, 6144
s_add_u32 s37, s37, s38
buffer_load_dwordx4 v21, s[8:11], s37 offen sc1 lds
s_add_u32 m0, s39, 7168
s_add_u32 s37, s37, s38
buffer_load_dwordx4 v21, s[8:11], s37 offen sc1 lds
s_waitcnt vmcnt(16)
s_barrier
s_add_u32 m0, s39, 32768
s_add_u32 s37, s37, s40
buffer_load_dwordx4 v21, s[8:11], s37 offen sc1 lds
s_add_u32 m0, s39, 33792
s_add_u32 s37, s37, s38
buffer_load_dwordx4 v21, s[8:11], s37 offen sc1 lds
s_add_u32 m0, s39, 34816
s_add_u32 s37, s37, s38
buffer_load_dwordx4 v21, s[8:11], s37 offen sc1 lds
s_add_u32 m0, s39, 35840
s_add_u32 s37, s37, s38
buffer_load_dwordx4 v21, s[8:11], s37 offen sc1 lds
s_add_u32 m0, s39, 36864
s_add_u32 s37, s37, s55
buffer_load_dwordx4 v21, s[8:11], s37 offen sc1 lds
s_add_u32 m0, s39, 37888
s_add_u32 s37, s37, s38
buffer_load_dwordx4 v21, s[8:11], s37 offen sc1 lds
s_add_u32 m0, s39, 38912
s_add_u32 s37, s37, s38
buffer_load_dwordx4 v21, s[8:11], s37 offen sc1 lds
s_add_u32 m0, s39, 39936
s_add_u32 s37, s37, s38
buffer_load_dwordx4 v21, s[8:11], s37 offen sc1 lds
s_waitcnt vmcnt(16)
s_barrier
s_add_u32 m0, s39, 65536
s_add_u32 s37, s37, s40
buffer_load_dwordx4 v21, s[8:11], s37 offen sc1 lds
s_add_u32 m0, s39, 66560
s_add_u32 s37, s37, s38
buffer_load_dwordx4 v21, s[8:11], s37 offen sc1 lds
s_add_u32 m0, s39, 67584
s_add_u32 s37, s37, s38
buffer_load_dwordx4 v21, s[8:11], s37 offen sc1 lds
s_add_u32 m0, s39, 68608
s_add_u32 s37, s37, s38
buffer_load_dwordx4 v21, s[8:11], s37 offen sc1 lds
s_add_u32 m0, s39, 69632
s_add_u32 s37, s37, s55
buffer_load_dwordx4 v21, s[8:11], s37 offen sc1 lds
s_add_u32 m0, s39, 70656
s_add_u32 s37, s37, s38
buffer_load_dwordx4 v21, s[8:11], s37 offen sc1 lds
s_add_u32 m0, s39, 71680
s_add_u32 s37, s37, s38
buffer_load_dwordx4 v21, s[8:11], s37 offen sc1 lds
s_add_u32 m0, s39, 72704
s_add_u32 s37, s37, s38
buffer_load_dwordx4 v21, s[8:11], s37 offen sc1 lds
s_waitcnt vmcnt(16)
s_barrier
s_add_u32 m0, s39, 98304
s_add_u32 s37, s37, s40
buffer_load_dwordx4 v21, s[8:11], s37 offen sc1 lds
s_add_u32 m0, s39, 99328
s_add_u32 s37, s37, s38
buffer_load_dwordx4 v21, s[8:11], s37 offen sc1 lds
s_add_u32 m0, s39, 100352
s_add_u32 s37, s37, s38
buffer_load_dwordx4 v21, s[8:11], s37 offen sc1 lds
s_add_u32 m0, s39, 101376
s_add_u32 s37, s37, s38
buffer_load_dwordx4 v21, s[8:11], s37 offen sc1 lds
s_add_u32 m0, s39, 102400
s_add_u32 s37, s37, s55
buffer_load_dwordx4 v21, s[8:11], s37 offen sc1 lds
s_add_u32 m0, s39, 103424
s_add_u32 s37, s37, s38
buffer_load_dwordx4 v21, s[8:11], s37 offen sc1 lds
s_add_u32 m0, s39, 104448
s_add_u32 s37, s37, s38
buffer_load_dwordx4 v21, s[8:11], s37 offen sc1 lds
s_add_u32 m0, s39, 105472
s_add_u32 s37, s37, s38
buffer_load_dwordx4 v21, s[8:11], s37 offen sc1 lds
s_waitcnt vmcnt(16)
s_barrier
s_cmp_eq_u32 s51, 2
s_cbranch_scc1 LW4_56
s_mul_i32 s40, s53, 98304
s_add_u32 m0, s39, 0
s_add_u32 s37, s40, 524288
buffer_load_dwordx4 v21, s[8:11], s37 offen sc1 lds
s_add_u32 m0, s39, 1024
s_add_u32 s37, s40, 525312
buffer_load_dwordx4 v21, s[8:11], s37 offen sc1 lds
s_add_u32 m0, s39, 2048
s_add_u32 s37, s40, 526336
buffer_load_dwordx4 v21, s[8:11], s37 offen sc1 lds
s_add_u32 m0, s39, 3072
s_add_u32 s37, s40, 527360
buffer_load_dwordx4 v21, s[8:11], s37 offen sc1 lds
s_add_u32 m0, s39, 4096
s_add_u32 s37, s40, 528384
buffer_load_dwordx4 v21, s[8:11], s37 offen sc1 lds
s_add_u32 m0, s39, 5120
s_add_u32 s37, s40, 529408
buffer_load_dwordx4 v21, s[8:11], s37 offen sc1 lds
s_add_u32 m0, s39, 6144
s_add_u32 s37, s40, 530432
buffer_load_dwordx4 v21, s[8:11], s37 offen sc1 lds
s_add_u32 m0, s39, 7168
s_add_u32 s37, s40, 531456
buffer_load_dwordx4 v21, s[8:11], s37 offen sc1 lds
s_waitcnt vmcnt(16)
s_barrier
s_add_u32 m0, s39, 32768
s_add_u32 s37, s40, 540672
buffer_load_dwordx4 v21, s[8:11], s37 offen sc1 lds
s_add_u32 m0, s39, 33792
s_add_u32 s37, s40, 541696
buffer_load_dwordx4 v21, s[8:11], s37 offen sc1 lds
s_add_u32 m0, s39, 34816
s_add_u32 s37, s40, 542720
buffer_load_dwordx4 v21, s[8:11], s37 offen sc1 lds
s_add_u32 m0, s39, 35840
s_add_u32 s37, s40, 543744
buffer_load_dwordx4 v21, s[8:11], s37 offen sc1 lds
s_add_u32 m0, s39, 36864
s_add_u32 s37, s40, 544768
buffer_load_dwordx4 v21, s[8:11], s37 offen sc1 lds
s_add_u32 m0, s39, 37888
s_add_u32 s37, s40, 545792
buffer_load_dwordx4 v21, s[8:11], s37 offen sc1 lds
s_add_u32 m0, s39, 38912
s_add_u32 s37, s40, 546816
buffer_load_dwordx4 v21, s[8:11], s37 offen sc1 lds
s_add_u32 m0, s39, 39936
s_add_u32 s37, s40, 547840
buffer_load_dwordx4 v21, s[8:11], s37 offen sc1 lds
s_waitcnt vmcnt(16)
s_barrier
s_add_u32 m0, s39, 65536
s_add_u32 s37, s40, 557056
buffer_load_dwordx4 v21, s[8:11], s37 offen sc1 lds
s_add_u32 m0, s39, 66560
s_add_u32 s37, s40, 558080
buffer_load_dwordx4 v21, s[8:11], s37 offen sc1 lds
s_add_u32 m0, s39, 67584
s_add_u32 s37, s40, 559104
buffer_load_dwordx4 v21, s[8:11], s37 offen sc1 lds
s_add_u32 m0, s39, 68608
s_add_u32 s37, s40, 560128
buffer_load_dwordx4 v21, s[8:11], s37 offen sc1 lds
s_add_u32 m0, s39, 69632
s_add_u32 s37, s40, 561152
buffer_load_dwordx4 v21, s[8:11], s37 offen sc1 lds
s_add_u32 m0, s39, 70656
s_add_u32 s37, s40, 562176
buffer_load_dwordx4 v21, s[8:11], s37 offen sc1 lds
s_add_u32 m0, s39, 71680
s_add_u32 s37, s40, 563200
buffer_load_dwordx4 v21, s[8:11], s37 offen sc1 lds
s_add_u32 m0, s39, 72704
s_add_u32 s37, s40, 564224
buffer_load_dwordx4 v21, s[8:11], s37 offen sc1 lds
s_waitcnt vmcnt(16)
s_barrier
s_add_u32 m0, s39, 98304
s_add_u32 s37, s40, 573440
buffer_load_dwordx4 v21, s[8:11], s37 offen sc1 lds
s_add_u32 m0, s39, 99328
s_add_u32 s37, s40, 574464
buffer_load_dwordx4 v21, s[8:11], s37 offen sc1 lds
s_add_u32 m0, s39, 100352
s_add_u32 s37, s40, 575488
buffer_load_dwordx4 v21, s[8:11], s37 offen sc1 lds
s_add_u32 m0, s39, 101376
s_add_u32 s37, s40, 576512
buffer_load_dwordx4 v21, s[8:11], s37 offen sc1 lds
s_add_u32 m0, s39, 102400
s_add_u32 s37, s40, 577536
buffer_load_dwordx4 v21, s[8:11], s37 offen sc1 lds
s_add_u32 m0, s39, 103424
s_add_u32 s37, s40, 578560
buffer_load_dwordx4 v21, s[8:11], s37 offen sc1 lds
s_add_u32 m0, s39, 104448
s_add_u32 s37, s40, 579584
buffer_load_dwordx4 v21, s[8:11], s37 offen sc1 lds
s_add_u32 m0, s39, 105472
s_add_u32 s37, s40, 580608
buffer_load_dwordx4 v21, s[8:11], s37 offen sc1 lds
s_waitcnt vmcnt(16)
s_barrier
s_add_u32 m0, s39, 0
s_add_u32 s37, s40, 589824
buffer_load_dwordx4 v21, s[8:11], s37 offen sc1 lds
s_add_u32 m0, s39, 1024
s_add_u32 s37, s40, 590848
buffer_load_dwordx4 v21, s[8:11], s37 offen sc1 lds
s_add_u32 m0, s39, 2048
s_add_u32 s37, s40, 591872
buffer_load_dwordx4 v21, s[8:11], s37 offen sc1 lds
s_add_u32 m0, s39, 3072
s_add_u32 s37, s40, 592896
buffer_load_dwordx4 v21, s[8:11], s37 offen sc1 lds
s_add_u32 m0, s39, 4096
s_add_u32 s37, s40, 593920
buffer_load_dwordx4 v21, s[8:11], s37 offen sc1 lds
s_add_u32 m0, s39, 5120
s_add_u32 s37, s40, 594944
buffer_load_dwordx4 v21, s[8:11], s37 offen sc1 lds
s_add_u32 m0, s39, 6144
s_add_u32 s37, s40, 595968
buffer_load_dwordx4 v21, s[8:11], s37 offen sc1 lds
s_add_u32 m0, s39, 7168
s_add_u32 s37, s40, 596992
buffer_load_dwordx4 v21, s[8:11], s37 offen sc1 lds
s_waitcnt vmcnt(16)
s_barrier
s_add_u32 m0, s39, 32768
s_add_u32 s37, s40, 606208
buffer_load_dwordx4 v21, s[8:11], s37 offen sc1 lds
s_add_u32 m0, s39, 33792
s_add_u32 s37, s40, 607232
buffer_load_dwordx4 v21, s[8:11], s37 offen sc1 lds
s_add_u32 m0, s39, 34816
s_add_u32 s37, s40, 608256
buffer_load_dwordx4 v21, s[8:11], s37 offen sc1 lds
s_add_u32 m0, s39, 35840
s_add_u32 s37, s40, 609280
buffer_load_dwordx4 v21, s[8:11], s37 offen sc1 lds
s_add_u32 m0, s39, 36864
s_add_u32 s37, s40, 610304
buffer_load_dwordx4 v21, s[8:11], s37 offen sc1 lds
s_add_u32 m0, s39, 37888
s_add_u32 s37, s40, 611328
buffer_load_dwordx4 v21, s[8:11], s37 offen sc1 lds
s_add_u32 m0, s39, 38912
s_add_u32 s37, s40, 612352
buffer_load_dwordx4 v21, s[8:11], s37 offen sc1 lds
s_add_u32 m0, s39, 39936
s_add_u32 s37, s40, 613376
buffer_load_dwordx4 v21, s[8:11], s37 offen sc1 lds
s_waitcnt vmcnt(16)
s_barrier
s_add_u32 m0, s39, 65536
s_mov_b32 s37, 720896
buffer_load_dwordx4 v21, s[8:11], s37 offen sc1 lds
s_add_u32 m0, s39, 66560
s_mov_b32 s37, 721920
buffer_load_dwordx4 v21, s[8:11], s37 offen sc1 lds
s_add_u32 m0, s39, 67584
s_mov_b32 s37, 722944
buffer_load_dwordx4 v21, s[8:11], s37 offen sc1 lds
s_add_u32 m0, s39, 68608
s_mov_b32 s37, 723968
buffer_load_dwordx4 v21, s[8:11], s37 offen sc1 lds
s_add_u32 m0, s39, 69632
s_mov_b32 s37, 724992
buffer_load_dwordx4 v21, s[8:11], s37 offen sc1 lds
s_add_u32 m0, s39, 70656
s_mov_b32 s37, 726016
buffer_load_dwordx4 v21, s[8:11], s37 offen sc1 lds
s_add_u32 m0, s39, 71680
s_mov_b32 s37, 727040
buffer_load_dwordx4 v21, s[8:11], s37 offen sc1 lds
s_add_u32 m0, s39, 72704
s_mov_b32 s37, 728064
buffer_load_dwordx4 v21, s[8:11], s37 offen sc1 lds
s_waitcnt vmcnt(16)
s_barrier
s_add_u32 m0, s39, 98304
s_mov_b32 s37, 737280
buffer_load_dwordx4 v21, s[8:11], s37 offen sc1 lds
s_add_u32 m0, s39, 99328
s_mov_b32 s37, 738304
buffer_load_dwordx4 v21, s[8:11], s37 offen sc1 lds
s_add_u32 m0, s39, 100352
s_mov_b32 s37, 739328
buffer_load_dwordx4 v21, s[8:11], s37 offen sc1 lds
s_add_u32 m0, s39, 101376
s_mov_b32 s37, 740352
buffer_load_dwordx4 v21, s[8:11], s37 offen sc1 lds
s_add_u32 m0, s39, 102400
s_mov_b32 s37, 741376
buffer_load_dwordx4 v21, s[8:11], s37 offen sc1 lds
s_add_u32 m0, s39, 103424
s_mov_b32 s37, 742400
buffer_load_dwordx4 v21, s[8:11], s37 offen sc1 lds
s_add_u32 m0, s39, 104448
s_mov_b32 s37, 743424
buffer_load_dwordx4 v21, s[8:11], s37 offen sc1 lds
s_add_u32 m0, s39, 105472
s_mov_b32 s37, 744448
buffer_load_dwordx4 v21, s[8:11], s37 offen sc1 lds
s_waitcnt vmcnt(16)
s_barrier
s_add_u32 m0, s39, 0
s_mov_b32 s37, 753664
buffer_load_dwordx4 v21, s[8:11], s37 offen sc1 lds
s_add_u32 m0, s39, 1024
s_mov_b32 s37, 754688
buffer_load_dwordx4 v21, s[8:11], s37 offen sc1 lds
s_add_u32 m0, s39, 2048
s_mov_b32 s37, 755712
buffer_load_dwordx4 v21, s[8:11], s37 offen sc1 lds
s_add_u32 m0, s39, 3072
s_mov_b32 s37, 756736
buffer_load_dwordx4 v21, s[8:11], s37 offen sc1 lds
s_add_u32 m0, s39, 4096
s_mov_b32 s37, 757760
buffer_load_dwordx4 v21, s[8:11], s37 offen sc1 lds
s_add_u32 m0, s39, 5120
s_mov_b32 s37, 758784
buffer_load_dwordx4 v21, s[8:11], s37 offen sc1 lds
s_add_u32 m0, s39, 6144
s_mov_b32 s37, 759808
buffer_load_dwordx4 v21, s[8:11], s37 offen sc1 lds
s_add_u32 m0, s39, 7168
s_mov_b32 s37, 760832
buffer_load_dwordx4 v21, s[8:11], s37 offen sc1 lds
s_waitcnt vmcnt(16)
s_barrier
s_add_u32 m0, s39, 32768
s_mov_b32 s37, 770048
buffer_load_dwordx4 v21, s[8:11], s37 offen sc1 lds
s_add_u32 m0, s39, 33792
s_mov_b32 s37, 771072
buffer_load_dwordx4 v21, s[8:11], s37 offen sc1 lds
s_add_u32 m0, s39, 34816
s_mov_b32 s37, 772096
buffer_load_dwordx4 v21, s[8:11], s37 offen sc1 lds
s_add_u32 m0, s39, 35840
s_mov_b32 s37, 773120
buffer_load_dwordx4 v21, s[8:11], s37 offen sc1 lds
s_add_u32 m0, s39, 36864
s_mov_b32 s37, 774144
buffer_load_dwordx4 v21, s[8:11], s37 offen sc1 lds
s_add_u32 m0, s39, 37888
s_mov_b32 s37, 775168
buffer_load_dwordx4 v21, s[8:11], s37 offen sc1 lds
s_add_u32 m0, s39, 38912
s_mov_b32 s37, 776192
buffer_load_dwordx4 v21, s[8:11], s37 offen sc1 lds
s_add_u32 m0, s39, 39936
s_mov_b32 s37, 777216
buffer_load_dwordx4 v21, s[8:11], s37 offen sc1 lds
s_waitcnt vmcnt(16)
s_barrier
s_add_u32 m0, s39, 65536
s_mov_b32 s37, 786432
buffer_load_dwordx4 v21, s[8:11], s37 offen sc1 lds
s_add_u32 m0, s39, 66560
s_mov_b32 s37, 787456
buffer_load_dwordx4 v21, s[8:11], s37 offen sc1 lds
s_add_u32 m0, s39, 67584
s_mov_b32 s37, 788480
buffer_load_dwordx4 v21, s[8:11], s37 offen sc1 lds
s_add_u32 m0, s39, 68608
s_mov_b32 s37, 789504
buffer_load_dwordx4 v21, s[8:11], s37 offen sc1 lds
s_add_u32 m0, s39, 69632
s_mov_b32 s37, 790528
buffer_load_dwordx4 v21, s[8:11], s37 offen sc1 lds
s_add_u32 m0, s39, 70656
s_mov_b32 s37, 791552
buffer_load_dwordx4 v21, s[8:11], s37 offen sc1 lds
s_add_u32 m0, s39, 71680
s_mov_b32 s37, 792576
buffer_load_dwordx4 v21, s[8:11], s37 offen sc1 lds
s_add_u32 m0, s39, 72704
s_mov_b32 s37, 793600
buffer_load_dwordx4 v21, s[8:11], s37 offen sc1 lds
s_waitcnt vmcnt(16)
s_barrier
s_add_u32 m0, s39, 98304
s_mov_b32 s37, 802816
buffer_load_dwordx4 v21, s[8:11], s37 offen sc1 lds
s_add_u32 m0, s39, 99328
s_mov_b32 s37, 803840
buffer_load_dwordx4 v21, s[8:11], s37 offen sc1 lds
s_add_u32 m0, s39, 100352
s_mov_b32 s37, 804864
buffer_load_dwordx4 v21, s[8:11], s37 offen sc1 lds
s_add_u32 m0, s39, 101376
s_mov_b32 s37, 805888
buffer_load_dwordx4 v21, s[8:11], s37 offen sc1 lds
s_add_u32 m0, s39, 102400
s_mov_b32 s37, 806912
buffer_load_dwordx4 v21, s[8:11], s37 offen sc1 lds
s_add_u32 m0, s39, 103424
s_mov_b32 s37, 807936
buffer_load_dwordx4 v21, s[8:11], s37 offen sc1 lds
s_add_u32 m0, s39, 104448
s_mov_b32 s37, 808960
buffer_load_dwordx4 v21, s[8:11], s37 offen sc1 lds
s_add_u32 m0, s39, 105472
s_mov_b32 s37, 809984
buffer_load_dwordx4 v21, s[8:11], s37 offen sc1 lds
s_waitcnt vmcnt(16)
s_barrier
s_add_u32 m0, s39, 0
s_mov_b32 s37, 819200
buffer_load_dwordx4 v21, s[8:11], s37 offen sc1 lds
s_add_u32 m0, s39, 1024
s_mov_b32 s37, 820224
buffer_load_dwordx4 v21, s[8:11], s37 offen sc1 lds
s_add_u32 m0, s39, 2048
s_mov_b32 s37, 821248
buffer_load_dwordx4 v21, s[8:11], s37 offen sc1 lds
s_add_u32 m0, s39, 3072
s_mov_b32 s37, 822272
buffer_load_dwordx4 v21, s[8:11], s37 offen sc1 lds
s_add_u32 m0, s39, 4096
s_mov_b32 s37, 823296
buffer_load_dwordx4 v21, s[8:11], s37 offen sc1 lds
s_add_u32 m0, s39, 5120
s_mov_b32 s37, 824320
buffer_load_dwordx4 v21, s[8:11], s37 offen sc1 lds
s_add_u32 m0, s39, 6144
s_mov_b32 s37, 825344
buffer_load_dwordx4 v21, s[8:11], s37 offen sc1 lds
s_add_u32 m0, s39, 7168
s_mov_b32 s37, 826368
buffer_load_dwordx4 v21, s[8:11], s37 offen sc1 lds
s_waitcnt vmcnt(16)
s_barrier
s_add_u32 m0, s39, 32768
s_mov_b32 s37, 835584
buffer_load_dwordx4 v21, s[8:11], s37 offen sc1 lds
s_add_u32 m0, s39, 33792
s_mov_b32 s37, 836608
buffer_load_dwordx4 v21, s[8:11], s37 offen sc1 lds
s_add_u32 m0, s39, 34816
s_mov_b32 s37, 837632
buffer_load_dwordx4 v21, s[8:11], s37 offen sc1 lds
s_add_u32 m0, s39, 35840
s_mov_b32 s37, 838656
buffer_load_dwordx4 v21, s[8:11], s37 offen sc1 lds
s_add_u32 m0, s39, 36864
s_mov_b32 s37, 839680
buffer_load_dwordx4 v21, s[8:11], s37 offen sc1 lds
s_add_u32 m0, s39, 37888
s_mov_b32 s37, 840704
buffer_load_dwordx4 v21, s[8:11], s37 offen sc1 lds
s_add_u32 m0, s39, 38912
s_mov_b32 s37, 841728
buffer_load_dwordx4 v21, s[8:11], s37 offen sc1 lds
s_add_u32 m0, s39, 39936
s_mov_b32 s37, 842752
buffer_load_dwordx4 v21, s[8:11], s37 offen sc1 lds
s_waitcnt vmcnt(16)
s_barrier
s_add_u32 m0, s39, 65536
s_mov_b32 s37, 851968
buffer_load_dwordx4 v21, s[8:11], s37 offen sc1 lds
s_add_u32 m0, s39, 66560
s_mov_b32 s37, 852992
buffer_load_dwordx4 v21, s[8:11], s37 offen sc1 lds
s_add_u32 m0, s39, 67584
s_mov_b32 s37, 854016
buffer_load_dwordx4 v21, s[8:11], s37 offen sc1 lds
s_add_u32 m0, s39, 68608
s_mov_b32 s37, 855040
buffer_load_dwordx4 v21, s[8:11], s37 offen sc1 lds
s_add_u32 m0, s39, 69632
s_mov_b32 s37, 856064
buffer_load_dwordx4 v21, s[8:11], s37 offen sc1 lds
s_add_u32 m0, s39, 70656
s_mov_b32 s37, 857088
buffer_load_dwordx4 v21, s[8:11], s37 offen sc1 lds
s_add_u32 m0, s39, 71680
s_mov_b32 s37, 858112
buffer_load_dwordx4 v21, s[8:11], s37 offen sc1 lds
s_add_u32 m0, s39, 72704
s_mov_b32 s37, 859136
buffer_load_dwordx4 v21, s[8:11], s37 offen sc1 lds
s_waitcnt vmcnt(16)
s_barrier
s_add_u32 m0, s39, 98304
s_mov_b32 s37, 868352
buffer_load_dwordx4 v21, s[8:11], s37 offen sc1 lds
s_add_u32 m0, s39, 99328
s_mov_b32 s37, 869376
buffer_load_dwordx4 v21, s[8:11], s37 offen sc1 lds
s_add_u32 m0, s39, 100352
s_mov_b32 s37, 870400
buffer_load_dwordx4 v21, s[8:11], s37 offen sc1 lds
s_add_u32 m0, s39, 101376
s_mov_b32 s37, 871424
buffer_load_dwordx4 v21, s[8:11], s37 offen sc1 lds
s_add_u32 m0, s39, 102400
s_mov_b32 s37, 872448
buffer_load_dwordx4 v21, s[8:11], s37 offen sc1 lds
s_add_u32 m0, s39, 103424
s_mov_b32 s37, 873472
buffer_load_dwordx4 v21, s[8:11], s37 offen sc1 lds
s_add_u32 m0, s39, 104448
s_mov_b32 s37, 874496
buffer_load_dwordx4 v21, s[8:11], s37 offen sc1 lds
s_add_u32 m0, s39, 105472
s_mov_b32 s37, 875520
buffer_load_dwordx4 v21, s[8:11], s37 offen sc1 lds
s_waitcnt vmcnt(16)
s_barrier
s_add_u32 m0, s39, 0
s_mov_b32 s37, 884736
buffer_load_dwordx4 v21, s[8:11], s37 offen sc1 lds
s_add_u32 m0, s39, 1024
s_mov_b32 s37, 885760
buffer_load_dwordx4 v21, s[8:11], s37 offen sc1 lds
s_add_u32 m0, s39, 2048
s_mov_b32 s37, 886784
buffer_load_dwordx4 v21, s[8:11], s37 offen sc1 lds
s_add_u32 m0, s39, 3072
s_mov_b32 s37, 887808
buffer_load_dwordx4 v21, s[8:11], s37 offen sc1 lds
s_add_u32 m0, s39, 4096
s_mov_b32 s37, 888832
buffer_load_dwordx4 v21, s[8:11], s37 offen sc1 lds
s_add_u32 m0, s39, 5120
s_mov_b32 s37, 889856
buffer_load_dwordx4 v21, s[8:11], s37 offen sc1 lds
s_add_u32 m0, s39, 6144
s_mov_b32 s37, 890880
buffer_load_dwordx4 v21, s[8:11], s37 offen sc1 lds
s_add_u32 m0, s39, 7168
s_mov_b32 s37, 891904
buffer_load_dwordx4 v21, s[8:11], s37 offen sc1 lds
s_waitcnt vmcnt(16)
s_barrier
s_add_u32 m0, s39, 32768
s_mov_b32 s37, 901120
buffer_load_dwordx4 v21, s[8:11], s37 offen sc1 lds
s_add_u32 m0, s39, 33792
s_mov_b32 s37, 902144
buffer_load_dwordx4 v21, s[8:11], s37 offen sc1 lds
s_add_u32 m0, s39, 34816
s_mov_b32 s37, 903168
buffer_load_dwordx4 v21, s[8:11], s37 offen sc1 lds
s_add_u32 m0, s39, 35840
s_mov_b32 s37, 904192
buffer_load_dwordx4 v21, s[8:11], s37 offen sc1 lds
s_add_u32 m0, s39, 36864
s_mov_b32 s37, 905216
buffer_load_dwordx4 v21, s[8:11], s37 offen sc1 lds
s_add_u32 m0, s39, 37888
s_mov_b32 s37, 906240
buffer_load_dwordx4 v21, s[8:11], s37 offen sc1 lds
s_add_u32 m0, s39, 38912
s_mov_b32 s37, 907264
buffer_load_dwordx4 v21, s[8:11], s37 offen sc1 lds
s_add_u32 m0, s39, 39936
s_mov_b32 s37, 908288
buffer_load_dwordx4 v21, s[8:11], s37 offen sc1 lds
s_waitcnt vmcnt(16)
s_barrier
s_waitcnt vmcnt(8)
s_barrier
s_waitcnt vmcnt(0)
s_barrier
s_branch Ldone_1
LW4_56:
s_mul_i32 s40, s53, 786432
s_add_u32 m0, s39, 0
s_add_u32 s37, s40, 4194304
buffer_load_dwordx4 v21, s[8:11], s37 offen sc1 lds
s_add_u32 m0, s39, 1024
s_add_u32 s37, s40, 4210688
buffer_load_dwordx4 v21, s[8:11], s37 offen sc1 lds
s_add_u32 m0, s39, 2048
s_add_u32 s37, s40, 4227072
buffer_load_dwordx4 v21, s[8:11], s37 offen sc1 lds
s_add_u32 m0, s39, 3072
s_add_u32 s37, s40, 4243456
buffer_load_dwordx4 v21, s[8:11], s37 offen sc1 lds
s_add_u32 m0, s39, 4096
s_add_u32 s37, s40, 4292608
buffer_load_dwordx4 v21, s[8:11], s37 offen sc1 lds
s_add_u32 m0, s39, 5120
s_add_u32 s37, s40, 4308992
buffer_load_dwordx4 v21, s[8:11], s37 offen sc1 lds
s_add_u32 m0, s39, 6144
s_add_u32 s37, s40, 4325376
buffer_load_dwordx4 v21, s[8:11], s37 offen sc1 lds
s_add_u32 m0, s39, 7168
s_add_u32 s37, s40, 4341760
buffer_load_dwordx4 v21, s[8:11], s37 offen sc1 lds
s_waitcnt vmcnt(16)
s_barrier
s_add_u32 m0, s39, 32768
s_add_u32 s37, s40, 4259840
buffer_load_dwordx4 v21, s[8:11], s37 offen sc1 lds
s_add_u32 m0, s39, 33792
s_add_u32 s37, s40, 4358144
buffer_load_dwordx4 v21, s[8:11], s37 offen sc1 lds
s_add_u32 m0, s39, 34816
s_add_u32 s37, s40, 4276224
buffer_load_dwordx4 v21, s[8:11], s37 offen sc1 lds
s_add_u32 m0, s39, 35840
s_add_u32 s37, s40, 4374528
buffer_load_dwordx4 v21, s[8:11], s37 offen sc1 lds
s_add_u32 m0, s39, 36864
s_add_u32 s37, s40, 4390912
buffer_load_dwordx4 v21, s[8:11], s37 offen sc1 lds
s_add_u32 m0, s39, 37888
s_add_u32 s37, s40, 4407296
buffer_load_dwordx4 v21, s[8:11], s37 offen sc1 lds
s_add_u32 m0, s39, 38912
s_add_u32 s37, s40, 4423680
buffer_load_dwordx4 v21, s[8:11], s37 offen sc1 lds
s_add_u32 m0, s39, 39936
s_add_u32 s37, s40, 4440064
buffer_load_dwordx4 v21, s[8:11], s37 offen sc1 lds
s_waitcnt vmcnt(16)
s_barrier
s_add_u32 m0, s39, 65536
s_add_u32 s37, s40, 4489216
buffer_load_dwordx4 v21, s[8:11], s37 offen sc1 lds
s_add_u32 m0, s39, 66560
s_add_u32 s37, s40, 4505600
buffer_load_dwordx4 v21, s[8:11], s37 offen sc1 lds
s_add_u32 m0, s39, 67584
s_add_u32 s37, s40, 4521984
buffer_load_dwordx4 v21, s[8:11], s37 offen sc1 lds
s_add_u32 m0, s39, 68608
s_add_u32 s37, s40, 4538368
buffer_load_dwordx4 v21, s[8:11], s37 offen sc1 lds
s_add_u32 m0, s39, 69632
s_add_u32 s37, s40, 4456448
buffer_load_dwordx4 v21, s[8:11], s37 offen sc1 lds
s_add_u32 m0, s39, 70656
s_add_u32 s37, s40, 4554752
buffer_load_dwordx4 v21, s[8:11], s37 offen sc1 lds
s_add_u32 m0, s39, 71680
s_add_u32 s37, s40, 4472832
buffer_load_dwordx4 v21, s[8:11], s37 offen sc1 lds
s_add_u32 m0, s39, 72704
s_add_u32 s37, s40, 4571136
buffer_load_dwordx4 v21, s[8:11], s37 offen sc1 lds
s_waitcnt vmcnt(16)
s_barrier
s_add_u32 m0, s39, 98304
s_add_u32 s37, s40, 4587520
buffer_load_dwordx4 v21, s[8:11], s37 offen sc1 lds
s_add_u32 m0, s39, 99328
s_add_u32 s37, s40, 4603904
buffer_load_dwordx4 v21, s[8:11], s37 offen sc1 lds
s_add_u32 m0, s39, 100352
s_add_u32 s37, s40, 4620288
buffer_load_dwordx4 v21, s[8:11], s37 offen sc1 lds
s_add_u32 m0, s39, 101376
s_add_u32 s37, s40, 4636672
buffer_load_dwordx4 v21, s[8:11], s37 offen sc1 lds
s_add_u32 m0, s39, 102400
s_add_u32 s37, s40, 4685824
buffer_load_dwordx4 v21, s[8:11], s37 offen sc1 lds
s_add_u32 m0, s39, 103424
s_add_u32 s37, s40, 4702208
buffer_load_dwordx4 v21, s[8:11], s37 offen sc1 lds
s_add_u32 m0, s39, 104448
s_add_u32 s37, s40, 4718592
buffer_load_dwordx4 v21, s[8:11], s37 offen sc1 lds
s_add_u32 m0, s39, 105472
s_add_u32 s37, s40, 4734976
buffer_load_dwordx4 v21, s[8:11], s37 offen sc1 lds
s_waitcnt vmcnt(16)
s_barrier
s_add_u32 m0, s39, 0
s_add_u32 s37, s40, 4653056
buffer_load_dwordx4 v21, s[8:11], s37 offen sc1 lds
s_add_u32 m0, s39, 1024
s_add_u32 s37, s40, 4751360
buffer_load_dwordx4 v21, s[8:11], s37 offen sc1 lds
s_add_u32 m0, s39, 2048
s_add_u32 s37, s40, 4669440
buffer_load_dwordx4 v21, s[8:11], s37 offen sc1 lds
s_add_u32 m0, s39, 3072
s_add_u32 s37, s40, 4767744
buffer_load_dwordx4 v21, s[8:11], s37 offen sc1 lds
s_add_u32 m0, s39, 4096
s_add_u32 s37, s40, 4784128
buffer_load_dwordx4 v21, s[8:11], s37 offen sc1 lds
s_add_u32 m0, s39, 5120
s_add_u32 s37, s40, 4800512
buffer_load_dwordx4 v21, s[8:11], s37 offen sc1 lds
s_add_u32 m0, s39, 6144
s_add_u32 s37, s40, 4816896
buffer_load_dwordx4 v21, s[8:11], s37 offen sc1 lds
s_add_u32 m0, s39, 7168
s_add_u32 s37, s40, 4833280
buffer_load_dwordx4 v21, s[8:11], s37 offen sc1 lds
s_waitcnt vmcnt(16)
s_barrier
s_add_u32 m0, s39, 32768
s_add_u32 s37, s40, 4882432
buffer_load_dwordx4 v21, s[8:11], s37 offen sc1 lds
s_add_u32 m0, s39, 33792
s_add_u32 s37, s40, 4898816
buffer_load_dwordx4 v21, s[8:11], s37 offen sc1 lds
s_add_u32 m0, s39, 34816
s_add_u32 s37, s40, 4915200
buffer_load_dwordx4 v21, s[8:11], s37 offen sc1 lds
s_add_u32 m0, s39, 35840
s_add_u32 s37, s40, 4931584
buffer_load_dwordx4 v21, s[8:11], s37 offen sc1 lds
s_add_u32 m0, s39, 36864
s_add_u32 s37, s40, 4849664
buffer_load_dwordx4 v21, s[8:11], s37 offen sc1 lds
s_add_u32 m0, s39, 37888
s_add_u32 s37, s40, 4947968
buffer_load_dwordx4 v21, s[8:11], s37 offen sc1 lds
s_add_u32 m0, s39, 38912
s_add_u32 s37, s40, 4866048
buffer_load_dwordx4 v21, s[8:11], s37 offen sc1 lds
s_add_u32 m0, s39, 39936
s_add_u32 s37, s40, 4964352
buffer_load_dwordx4 v21, s[8:11], s37 offen sc1 lds
s_waitcnt vmcnt(16)
s_barrier
s_add_u32 m0, s39, 65536
s_mov_b32 s37, 5767168
buffer_load_dwordx4 v21, s[8:11], s37 offen sc1 lds
s_add_u32 m0, s39, 66560
s_mov_b32 s37, 5783552
buffer_load_dwordx4 v21, s[8:11], s37 offen sc1 lds
s_add_u32 m0, s39, 67584
s_mov_b32 s37, 5799936
buffer_load_dwordx4 v21, s[8:11], s37 offen sc1 lds
s_add_u32 m0, s39, 68608
s_mov_b32 s37, 5816320
buffer_load_dwordx4 v21, s[8:11], s37 offen sc1 lds
s_add_u32 m0, s39, 69632
s_mov_b32 s37, 5865472
buffer_load_dwordx4 v21, s[8:11], s37 offen sc1 lds
s_add_u32 m0, s39, 70656
s_mov_b32 s37, 5881856
buffer_load_dwordx4 v21, s[8:11], s37 offen sc1 lds
s_add_u32 m0, s39, 71680
s_mov_b32 s37, 5898240
buffer_load_dwordx4 v21, s[8:11], s37 offen sc1 lds
s_add_u32 m0, s39, 72704
s_mov_b32 s37, 5914624
buffer_load_dwordx4 v21, s[8:11], s37 offen sc1 lds
s_waitcnt vmcnt(16)
s_barrier
s_add_u32 m0, s39, 98304
s_mov_b32 s37, 5832704
buffer_load_dwordx4 v21, s[8:11], s37 offen sc1 lds
s_add_u32 m0, s39, 99328
s_mov_b32 s37, 5931008
buffer_load_dwordx4 v21, s[8:11], s37 offen sc1 lds
s_add_u32 m0, s39, 100352
s_mov_b32 s37, 5849088
buffer_load_dwordx4 v21, s[8:11], s37 offen sc1 lds
s_add_u32 m0, s39, 101376
s_mov_b32 s37, 5947392
buffer_load_dwordx4 v21, s[8:11], s37 offen sc1 lds
s_add_u32 m0, s39, 102400
s_mov_b32 s37, 5963776
buffer_load_dwordx4 v21, s[8:11], s37 offen sc1 lds
s_add_u32 m0, s39, 103424
s_mov_b32 s37, 5980160
buffer_load_dwordx4 v21, s[8:11], s37 offen sc1 lds
s_add_u32 m0, s39, 104448
s_mov_b32 s37, 5996544
buffer_load_dwordx4 v21, s[8:11], s37 offen sc1 lds
s_add_u32 m0, s39, 105472
s_mov_b32 s37, 6012928
buffer_load_dwordx4 v21, s[8:11], s37 offen sc1 lds
s_waitcnt vmcnt(16)
s_barrier
s_add_u32 m0, s39, 0
s_mov_b32 s37, 6062080
buffer_load_dwordx4 v21, s[8:11], s37 offen sc1 lds
s_add_u32 m0, s39, 1024
s_mov_b32 s37, 6078464
buffer_load_dwordx4 v21, s[8:11], s37 offen sc1 lds
s_add_u32 m0, s39, 2048
s_mov_b32 s37, 6094848
buffer_load_dwordx4 v21, s[8:11], s37 offen sc1 lds
s_add_u32 m0, s39, 3072
s_mov_b32 s37, 6111232
buffer_load_dwordx4 v21, s[8:11], s37 offen sc1 lds
s_add_u32 m0, s39, 4096
s_mov_b32 s37, 6029312
buffer_load_dwordx4 v21, s[8:11], s37 offen sc1 lds
s_add_u32 m0, s39, 5120
s_mov_b32 s37, 6127616
buffer_load_dwordx4 v21, s[8:11], s37 offen sc1 lds
s_add_u32 m0, s39, 6144
s_mov_b32 s37, 6045696
buffer_load_dwordx4 v21, s[8:11], s37 offen sc1 lds
s_add_u32 m0, s39, 7168
s_mov_b32 s37, 6144000
buffer_load_dwordx4 v21, s[8:11], s37 offen sc1 lds
s_waitcnt vmcnt(16)
s_barrier
s_add_u32 m0, s39, 32768
s_mov_b32 s37, 6160384
buffer_load_dwordx4 v21, s[8:11], s37 offen sc1 lds
s_add_u32 m0, s39, 33792
s_mov_b32 s37, 6176768
buffer_load_dwordx4 v21, s[8:11], s37 offen sc1 lds
s_add_u32 m0, s39, 34816
s_mov_b32 s37, 6193152
buffer_load_dwordx4 v21, s[8:11], s37 offen sc1 lds
s_add_u32 m0, s39, 35840
s_mov_b32 s37, 6209536
buffer_load_dwordx4 v21, s[8:11], s37 offen sc1 lds
s_add_u32 m0, s39, 36864
s_mov_b32 s37, 6258688
buffer_load_dwordx4 v21, s[8:11], s37 offen sc1 lds
s_add_u32 m0, s39, 37888
s_mov_b32 s37, 6275072
buffer_load_dwordx4 v21, s[8:11], s37 offen sc1 lds
s_add_u32 m0, s39, 38912
s_mov_b32 s37, 6291456
buffer_load_dwordx4 v21, s[8:11], s37 offen sc1 lds
s_add_u32 m0, s39, 39936
s_mov_b32 s37, 6307840
buffer_load_dwordx4 v21, s[8:11], s37 offen sc1 lds
s_waitcnt vmcnt(16)
s_barrier
s_add_u32 m0, s39, 65536
s_mov_b32 s37, 6225920
buffer_load_dwordx4 v21, s[8:11], s37 offen sc1 lds
s_add_u32 m0, s39, 66560
s_mov_b32 s37, 6324224
buffer_load_dwordx4 v21, s[8:11], s37 offen sc1 lds
s_add_u32 m0, s39, 67584
s_mov_b32 s37, 6242304
buffer_load_dwordx4 v21, s[8:11], s37 offen sc1 lds
s_add_u32 m0, s39, 68608
s_mov_b32 s37, 6340608
buffer_load_dwordx4 v21, s[8:11], s37 offen sc1 lds
s_add_u32 m0, s39, 69632
s_mov_b32 s37, 6356992
buffer_load_dwordx4 v21, s[8:11], s37 offen sc1 lds
s_add_u32 m0, s39, 70656
s_mov_b32 s37, 6373376
buffer_load_dwordx4 v21, s[8:11], s37 offen sc1 lds
s_add_u32 m0, s39, 71680
s_mov_b32 s37, 6389760
buffer_load_dwordx4 v21, s[8:11], s37 offen sc1 lds
s_add_u32 m0, s39, 72704
s_mov_b32 s37, 6406144
buffer_load_dwordx4 v21, s[8:11], s37 offen sc1 lds
s_waitcnt vmcnt(16)
s_barrier
s_add_u32 m0, s39, 98304
s_mov_b32 s37, 6455296
buffer_load_dwordx4 v21, s[8:11], s37 offen sc1 lds
s_add_u32 m0, s39, 99328
s_mov_b32 s37, 6471680
buffer_load_dwordx4 v21, s[8:11], s37 offen sc1 lds
s_add_u32 m0, s39, 100352
s_mov_b32 s37, 6488064
buffer_load_dwordx4 v21, s[8:11], s37 offen sc1 lds
s_add_u32 m0, s39, 101376
s_mov_b32 s37, 6504448
buffer_load_dwordx4 v21, s[8:11], s37 offen sc1 lds
s_add_u32 m0, s39, 102400
s_mov_b32 s37, 6422528
buffer_load_dwordx4 v21, s[8:11], s37 offen sc1 lds
s_add_u32 m0, s39, 103424
s_mov_b32 s37, 6520832
buffer_load_dwordx4 v21, s[8:11], s37 offen sc1 lds
s_add_u32 m0, s39, 104448
s_mov_b32 s37, 6438912
buffer_load_dwordx4 v21, s[8:11], s37 offen sc1 lds
s_add_u32 m0, s39, 105472
s_mov_b32 s37, 6537216
buffer_load_dwordx4 v21, s[8:11], s37 offen sc1 lds
s_waitcnt vmcnt(16)
s_barrier
s_add_u32 m0, s39, 0
s_mov_b32 s37, 6553600
buffer_load_dwordx4 v21, s[8:11], s37 offen sc1 lds
s_add_u32 m0, s39, 1024
s_mov_b32 s37, 6569984
buffer_load_dwordx4 v21, s[8:11], s37 offen sc1 lds
s_add_u32 m0, s39, 2048
s_mov_b32 s37, 6586368
buffer_load_dwordx4 v21, s[8:11], s37 offen sc1 lds
s_add_u32 m0, s39, 3072
s_mov_b32 s37, 6602752
buffer_load_dwordx4 v21, s[8:11], s37 offen sc1 lds
s_add_u32 m0, s39, 4096
s_mov_b32 s37, 6651904
buffer_load_dwordx4 v21, s[8:11], s37 offen sc1 lds
s_add_u32 m0, s39, 5120
s_mov_b32 s37, 6668288
buffer_load_dwordx4 v21, s[8:11], s37 offen sc1 lds
s_add_u32 m0, s39, 6144
s_mov_b32 s37, 6684672
buffer_load_dwordx4 v21, s[8:11], s37 offen sc1 lds
s_add_u32 m0, s39, 7168
s_mov_b32 s37, 6701056
buffer_load_dwordx4 v21, s[8:11], s37 offen sc1 lds
s_waitcnt vmcnt(16)
s_barrier
s_add_u32 m0, s39, 32768
s_mov_b32 s37, 6619136
buffer_load_dwordx4 v21, s[8:11], s37 offen sc1 lds
s_add_u32 m0, s39, 33792
s_mov_b32 s37, 6717440
buffer_load_dwordx4 v21, s[8:11], s37 offen sc1 lds
s_add_u32 m0, s39, 34816
s_mov_b32 s37, 6635520
buffer_load_dwordx4 v21, s[8:11], s37 offen sc1 lds
s_add_u32 m0, s39, 35840
s_mov_b32 s37, 6733824
buffer_load_dwordx4 v21, s[8:11], s37 offen sc1 lds
s_add_u32 m0, s39, 36864
s_mov_b32 s37, 6750208
buffer_load_dwordx4 v21, s[8:11], s37 offen sc1 lds
s_add_u32 m0, s39, 37888
s_mov_b32 s37, 6766592
buffer_load_dwordx4 v21, s[8:11], s37 offen sc1 lds
s_add_u32 m0, s39, 38912
s_mov_b32 s37, 6782976
buffer_load_dwordx4 v21, s[8:11], s37 offen sc1 lds
s_add_u32 m0, s39, 39936
s_mov_b32 s37, 6799360
buffer_load_dwordx4 v21, s[8:11], s37 offen sc1 lds
s_waitcnt vmcnt(16)
s_barrier
s_add_u32 m0, s39, 65536
s_mov_b32 s37, 6848512
buffer_load_dwordx4 v21, s[8:11], s37 offen sc1 lds
s_add_u32 m0, s39, 66560
s_mov_b32 s37, 6864896
buffer_load_dwordx4 v21, s[8:11], s37 offen sc1 lds
s_add_u32 m0, s39, 67584
s_mov_b32 s37, 6881280
buffer_load_dwordx4 v21, s[8:11], s37 offen sc1 lds
s_add_u32 m0, s39, 68608
s_mov_b32 s37, 6897664
buffer_load_dwordx4 v21, s[8:11], s37 offen sc1 lds
s_add_u32 m0, s39, 69632
s_mov_b32 s37, 6815744
buffer_load_dwordx4 v21, s[8:11], s37 offen sc1 lds
s_add_u32 m0, s39, 70656
s_mov_b32 s37, 6914048
buffer_load_dwordx4 v21, s[8:11], s37 offen sc1 lds
s_add_u32 m0, s39, 71680
s_mov_b32 s37, 6832128
buffer_load_dwordx4 v21, s[8:11], s37 offen sc1 lds
s_add_u32 m0, s39, 72704
s_mov_b32 s37, 6930432
buffer_load_dwordx4 v21, s[8:11], s37 offen sc1 lds
s_waitcnt vmcnt(16)
s_barrier
s_add_u32 m0, s39, 98304
s_mov_b32 s37, 6946816
buffer_load_dwordx4 v21, s[8:11], s37 offen sc1 lds
s_add_u32 m0, s39, 99328
s_mov_b32 s37, 6963200
buffer_load_dwordx4 v21, s[8:11], s37 offen sc1 lds
s_add_u32 m0, s39, 100352
s_mov_b32 s37, 6979584
buffer_load_dwordx4 v21, s[8:11], s37 offen sc1 lds
s_add_u32 m0, s39, 101376
s_mov_b32 s37, 6995968
buffer_load_dwordx4 v21, s[8:11], s37 offen sc1 lds
s_add_u32 m0, s39, 102400
s_mov_b32 s37, 7045120
buffer_load_dwordx4 v21, s[8:11], s37 offen sc1 lds
s_add_u32 m0, s39, 103424
s_mov_b32 s37, 7061504
buffer_load_dwordx4 v21, s[8:11], s37 offen sc1 lds
s_add_u32 m0, s39, 104448
s_mov_b32 s37, 7077888
buffer_load_dwordx4 v21, s[8:11], s37 offen sc1 lds
s_add_u32 m0, s39, 105472
s_mov_b32 s37, 7094272
buffer_load_dwordx4 v21, s[8:11], s37 offen sc1 lds
s_waitcnt vmcnt(16)
s_barrier
s_add_u32 m0, s39, 0
s_mov_b32 s37, 7012352
buffer_load_dwordx4 v21, s[8:11], s37 offen sc1 lds
s_add_u32 m0, s39, 1024
s_mov_b32 s37, 7110656
buffer_load_dwordx4 v21, s[8:11], s37 offen sc1 lds
s_add_u32 m0, s39, 2048
s_mov_b32 s37, 7028736
buffer_load_dwordx4 v21, s[8:11], s37 offen sc1 lds
s_add_u32 m0, s39, 3072
s_mov_b32 s37, 7127040
buffer_load_dwordx4 v21, s[8:11], s37 offen sc1 lds
s_add_u32 m0, s39, 4096
s_mov_b32 s37, 7143424
buffer_load_dwordx4 v21, s[8:11], s37 offen sc1 lds
s_add_u32 m0, s39, 5120
s_mov_b32 s37, 7159808
buffer_load_dwordx4 v21, s[8:11], s37 offen sc1 lds
s_add_u32 m0, s39, 6144
s_mov_b32 s37, 7176192
buffer_load_dwordx4 v21, s[8:11], s37 offen sc1 lds
s_add_u32 m0, s39, 7168
s_mov_b32 s37, 7192576
buffer_load_dwordx4 v21, s[8:11], s37 offen sc1 lds
s_waitcnt vmcnt(16)
s_barrier
s_add_u32 m0, s39, 32768
s_mov_b32 s37, 7241728
buffer_load_dwordx4 v21, s[8:11], s37 offen sc1 lds
s_add_u32 m0, s39, 33792
s_mov_b32 s37, 7258112
buffer_load_dwordx4 v21, s[8:11], s37 offen sc1 lds
s_add_u32 m0, s39, 34816
s_mov_b32 s37, 7274496
buffer_load_dwordx4 v21, s[8:11], s37 offen sc1 lds
s_add_u32 m0, s39, 35840
s_mov_b32 s37, 7290880
buffer_load_dwordx4 v21, s[8:11], s37 offen sc1 lds
s_add_u32 m0, s39, 36864
s_mov_b32 s37, 7208960
buffer_load_dwordx4 v21, s[8:11], s37 offen sc1 lds
s_add_u32 m0, s39, 37888
s_mov_b32 s37, 7307264
buffer_load_dwordx4 v21, s[8:11], s37 offen sc1 lds
s_add_u32 m0, s39, 38912
s_mov_b32 s37, 7225344
buffer_load_dwordx4 v21, s[8:11], s37 offen sc1 lds
s_add_u32 m0, s39, 39936
s_mov_b32 s37, 7323648
buffer_load_dwordx4 v21, s[8:11], s37 offen sc1 lds
s_waitcnt vmcnt(16)
s_barrier
s_waitcnt vmcnt(8)
s_barrier
s_waitcnt vmcnt(0)
s_barrier
s_branch Ldone_1
L7b_55:
v_mfma_f32_16x16x32_bf16 v[128:131], v[96:99], v[80:83], v[128:131]
v_mfma_f32_16x16x32_bf16 v[132:135], v[96:99], v[84:87], v[132:135]
v_mfma_f32_16x16x32_bf16 v[136:139], v[96:99], v[88:91], v[136:139]
v_mfma_f32_16x16x32_bf16 v[140:143], v[96:99], v[92:95], v[140:143]
v_mfma_f32_16x16x32_bf16 v[188:191], v[108:111], v[92:95], v[188:191]
v_mfma_f32_16x16x32_bf16 v[184:187], v[108:111], v[88:91], v[184:187]
v_mfma_f32_16x16x32_bf16 v[180:183], v[108:111], v[84:87], v[180:183]
v_mfma_f32_16x16x32_bf16 v[176:179], v[108:111], v[80:83], v[176:179]
v_mfma_f32_16x16x32_bf16 v[144:147], v[100:103], v[80:83], v[144:147]
v_mfma_f32_16x16x32_bf16 v[148:151], v[100:103], v[84:87], v[148:151]
v_mfma_f32_16x16x32_bf16 v[152:155], v[100:103], v[88:91], v[152:155]
v_mfma_f32_16x16x32_bf16 v[156:159], v[100:103], v[92:95], v[156:159]
v_mfma_f32_16x16x32_bf16 v[204:207], v[112:115], v[92:95], v[204:207]
v_mfma_f32_16x16x32_bf16 v[200:203], v[112:115], v[88:91], v[200:203]
v_mfma_f32_16x16x32_bf16 v[196:199], v[112:115], v[84:87], v[196:199]
v_mfma_f32_16x16x32_bf16 v[192:195], v[112:115], v[80:83], v[192:195]
v_mfma_f32_16x16x32_bf16 v[160:163], v[104:107], v[80:83], v[160:163]
v_mfma_f32_16x16x32_bf16 v[164:167], v[104:107], v[84:87], v[164:167]
v_mfma_f32_16x16x32_bf16 v[168:171], v[104:107], v[88:91], v[168:171]
v_mfma_f32_16x16x32_bf16 v[172:175], v[104:107], v[92:95], v[172:175]
v_mfma_f32_16x16x32_bf16 v[220:223], v[116:119], v[92:95], v[220:223]
v_mfma_f32_16x16x32_bf16 v[216:219], v[116:119], v[88:91], v[216:219]
v_mfma_f32_16x16x32_bf16 v[212:215], v[116:119], v[84:87], v[212:215]
v_mfma_f32_16x16x32_bf16 v[208:211], v[116:119], v[80:83], v[208:211]
s_mul_i32 s43, s38, 32
s_add_u32 s37, s37, s43
s_setprio 0
s_barrier
s_mov_b32 s80, s60
s_mov_b32 s81, s61
s_mov_b32 s82, 7340032
s_mov_b32 s83, 0x20000
v_and_b32 v29, 31, v1
v_lshlrev_b32 v29, 11, v29
s_and_b32 s43, s35, 8
s_or_b32 s43, s43, 3
s_lshl_b32 s43, s43, 7
v_add_u32 v29, s43, v29
s_add_u32 s37, s37, s54
s_add_u32 m0, s39, 65536
s_add_u32 s37, s37, s40
buffer_load_dwordx4 v21, s[8:11], s37 offen sc1 lds
v_mul_f32 v80, v128, v128
v_mul_f32 v81, v129, v129
v_mul_f32 v82, v130, v130
v_mul_f32 v83, v131, v131
v_fma_f32 v80, v80, v232, v228
v_fma_f32 v81, v81, v232, v228
v_fma_f32 v82, v82, v232, v228
s_add_u32 m0, s39, 66560
s_add_u32 s37, s37, s38
buffer_load_dwordx4 v21, s[8:11], s37 offen sc1 lds
v_fma_f32 v83, v83, v232, v228
v_mul_f32 v80, v80, v128
v_mul_f32 v81, v81, v129
v_mul_f32 v82, v82, v130
v_mul_f32 v83, v83, v131
v_exp_f32 v80, v80
s_add_u32 m0, s39, 67584
s_add_u32 s37, s37, s38
buffer_load_dwordx4 v21, s[8:11], s37 offen sc1 lds
v_exp_f32 v81, v81
v_exp_f32 v82, v82
v_exp_f32 v83, v83
v_mul_f32 v176, v128, v176
v_mul_f32 v177, v129, v177
v_mul_f32 v178, v130, v178
v_mul_f32 v179, v131, v179
s_add_u32 m0, s39, 68608
s_add_u32 s37, s37, s38
buffer_load_dwordx4 v21, s[8:11], s37 offen sc1 lds
v_fma_f32 v80, v80, v236, v236
v_fma_f32 v81, v81, v236, v236
v_fma_f32 v82, v82, v236, v236
v_fma_f32 v83, v83, v236, v236
v_rcp_f32 v80, v80
v_rcp_f32 v81, v81
s_add_u32 m0, s39, 69632
s_add_u32 s37, s37, s55
buffer_load_dwordx4 v21, s[8:11], s37 offen sc1 lds
v_rcp_f32 v82, v82
v_rcp_f32 v83, v83
v_mul_f32 v176, v176, v80
v_mul_f32 v177, v177, v81
v_mul_f32 v178, v178, v82
v_mul_f32 v179, v179, v83
v_cvt_pk_bf16_f32 v96, v176, v177
s_add_u32 m0, s39, 70656
s_add_u32 s37, s37, s38
buffer_load_dwordx4 v21, s[8:11], s37 offen sc1 lds
v_cvt_pk_bf16_f32 v97, v178, v179
v_mul_f32 v84, v144, v144
v_mul_f32 v85, v145, v145
v_mul_f32 v86, v146, v146
v_mul_f32 v87, v147, v147
v_fma_f32 v84, v84, v232, v228
s_add_u32 m0, s39, 71680
s_add_u32 s37, s37, s38
buffer_load_dwordx4 v21, s[8:11], s37 offen sc1 lds
v_fma_f32 v85, v85, v232, v228
v_fma_f32 v86, v86, v232, v228
v_fma_f32 v87, v87, v232, v228
v_mul_f32 v84, v84, v144
v_mul_f32 v85, v85, v145
v_mul_f32 v86, v86, v146
v_mul_f32 v87, v87, v147
s_add_u32 m0, s39, 72704
s_add_u32 s37, s37, s38
buffer_load_dwordx4 v21, s[8:11], s37 offen sc1 lds
v_exp_f32 v84, v84
v_exp_f32 v85, v85
v_exp_f32 v86, v86
v_exp_f32 v87, v87
v_mul_f32 v192, v144, v192
v_mul_f32 v193, v145, v193
s_barrier
s_lshr_b32 s44, s2, 3
s_lshl_b32 s44, s44, 17
s_add_u32 s43, s44, 65536
buffer_load_dword v30, v29, s[80:83], s43 offen
s_add_u32 m0, s39, 98304
s_add_u32 s37, s37, s40
buffer_load_dwordx4 v21, s[8:11], s37 offen sc1 lds
v_mul_f32 v194, v146, v194
v_mul_f32 v195, v147, v195
v_fma_f32 v84, v84, v236, v236
v_fma_f32 v85, v85, v236, v236
v_fma_f32 v86, v86, v236, v236
v_fma_f32 v87, v87, v236, v236
v_rcp_f32 v84, v84
s_add_u32 m0, s39, 99328
s_add_u32 s37, s37, s38
buffer_load_dwordx4 v21, s[8:11], s37 offen sc1 lds
v_rcp_f32 v85, v85
v_rcp_f32 v86, v86
v_rcp_f32 v87, v87
v_mul_f32 v192, v192, v84
v_mul_f32 v193, v193, v85
v_mul_f32 v194, v194, v86
v_mul_f32 v195, v195, v87
s_add_u32 m0, s39, 100352
s_add_u32 s37, s37, s38
buffer_load_dwordx4 v21, s[8:11], s37 offen sc1 lds
v_cvt_pk_bf16_f32 v98, v192, v193
v_cvt_pk_bf16_f32 v99, v194, v195
v_mul_f32 v80, v160, v160
v_mul_f32 v81, v161, v161
v_mul_f32 v82, v162, v162
s_add_u32 m0, s39, 101376
s_add_u32 s37, s37, s38
buffer_load_dwordx4 v21, s[8:11], s37 offen sc1 lds
v_mul_f32 v83, v163, v163
v_fma_f32 v80, v80, v232, v228
v_fma_f32 v81, v81, v232, v228
v_fma_f32 v82, v82, v232, v228
v_fma_f32 v83, v83, v232, v228
v_mul_f32 v80, v80, v160
v_mul_f32 v81, v81, v161
s_add_u32 m0, s39, 102400
s_add_u32 s37, s37, s55
buffer_load_dwordx4 v21, s[8:11], s37 offen sc1 lds
v_mul_f32 v82, v82, v162
v_mul_f32 v83, v83, v163
v_exp_f32 v80, v80
v_exp_f32 v81, v81
v_exp_f32 v82, v82
v_exp_f32 v83, v83
v_mul_f32 v208, v160, v208
s_add_u32 m0, s39, 103424
s_add_u32 s37, s37, s38
buffer_load_dwordx4 v21, s[8:11], s37 offen sc1 lds
v_mul_f32 v209, v161, v209
v_mul_f32 v210, v162, v210
v_mul_f32 v211, v163, v211
v_fma_f32 v80, v80, v236, v236
v_fma_f32 v81, v81, v236, v236
v_fma_f32 v82, v82, v236, v236
s_add_u32 m0, s39, 104448
s_add_u32 s37, s37, s38
buffer_load_dwordx4 v21, s[8:11], s37 offen sc1 lds
v_fma_f32 v83, v83, v236, v236
v_rcp_f32 v80, v80
v_rcp_f32 v81, v81
v_rcp_f32 v82, v82
v_rcp_f32 v83, v83
v_mul_f32 v208, v208, v80
v_mul_f32 v209, v209, v81
s_add_u32 m0, s39, 105472
s_add_u32 s37, s37, s38
buffer_load_dwordx4 v21, s[8:11], s37 offen sc1 lds
v_mul_f32 v210, v210, v82
v_mul_f32 v211, v211, v83
v_cvt_pk_bf16_f32 v112, v208, v209
v_cvt_pk_bf16_f32 v113, v210, v211
v_mul_f32 v80, v132, v132
v_mul_f32 v81, v133, v133
buffer_store_dwordx4 v[96:99], v27, s[24:27], 0 offen offset:0 sc1
s_barrier
s_add_u32 m0, s39, 0
s_add_u32 s37, s37, s40
buffer_load_dwordx4 v21, s[8:11], s37 offen sc1 lds
v_mul_f32 v82, v134, v134
v_mul_f32 v83, v135, v135
v_fma_f32 v80, v80, v233, v229
v_fma_f32 v81, v81, v233, v229
v_fma_f32 v82, v82, v233, v229
v_fma_f32 v83, v83, v233, v229
v_mul_f32 v80, v80, v132
s_add_u32 m0, s39, 1024
s_add_u32 s37, s37, s38
buffer_load_dwordx4 v21, s[8:11], s37 offen sc1 lds
v_mul_f32 v81, v81, v133
v_mul_f32 v82, v82, v134
v_mul_f32 v83, v83, v135
v_exp_f32 v80, v80
v_exp_f32 v81, v81
v_exp_f32 v82, v82
s_add_u32 m0, s39, 2048
s_add_u32 s37, s37, s38
buffer_load_dwordx4 v21, s[8:11], s37 offen sc1 lds
v_exp_f32 v83, v83
v_mul_f32 v180, v132, v180
v_mul_f32 v181, v133, v181
v_mul_f32 v182, v134, v182
v_mul_f32 v183, v135, v183
v_fma_f32 v80, v80, v237, v237
v_fma_f32 v81, v81, v237, v237
s_add_u32 m0, s39, 3072
s_add_u32 s37, s37, s38
buffer_load_dwordx4 v21, s[8:11], s37 offen sc1 lds
v_fma_f32 v82, v82, v237, v237
v_fma_f32 v83, v83, v237, v237
v_rcp_f32 v80, v80
v_rcp_f32 v81, v81
v_rcp_f32 v82, v82
v_rcp_f32 v83, v83
s_add_u32 m0, s39, 4096
s_add_u32 s37, s37, s55
buffer_load_dwordx4 v21, s[8:11], s37 offen sc1 lds
v_mul_f32 v180, v180, v80
v_mul_f32 v181, v181, v81
v_mul_f32 v182, v182, v82
v_mul_f32 v183, v183, v83
v_cvt_pk_bf16_f32 v100, v180, v181
v_cvt_pk_bf16_f32 v101, v182, v183
v_mul_f32 v84, v148, v148
s_add_u32 m0, s39, 5120
s_add_u32 s37, s37, s38
buffer_load_dwordx4 v21, s[8:11], s37 offen sc1 lds
v_mul_f32 v85, v149, v149
v_mul_f32 v86, v150, v150
v_mul_f32 v87, v151, v151
v_fma_f32 v84, v84, v233, v229
v_fma_f32 v85, v85, v233, v229
v_fma_f32 v86, v86, v233, v229
s_add_u32 m0, s39, 6144
s_add_u32 s37, s37, s38
buffer_load_dwordx4 v21, s[8:11], s37 offen sc1 lds
v_fma_f32 v87, v87, v233, v229
v_mul_f32 v84, v84, v148
v_mul_f32 v85, v85, v149
v_mul_f32 v86, v86, v150
v_mul_f32 v87, v87, v151
v_exp_f32 v84, v84
v_exp_f32 v85, v85
s_add_u32 m0, s39, 7168
s_add_u32 s37, s37, s38
buffer_load_dwordx4 v21, s[8:11], s37 offen sc1 lds
v_exp_f32 v86, v86
v_exp_f32 v87, v87
v_mul_f32 v196, v148, v196
v_mul_f32 v197, v149, v197
v_mul_f32 v198, v150, v198
v_mul_f32 v199, v151, v199
s_waitcnt vmcnt(18)
s_barrier
s_add_u32 s43, s34, 48
s_lshl_b32 s43, s43, 7
v_mov_b32 v10, s43
v_mov_b32 v12, 16
buffer_load_dword v11, v10, s[56:59], 0 offen sc1
s_add_u32 m0, s39, 32768
s_add_u32 s37, s37, s40
buffer_load_dwordx4 v21, s[8:11], s37 offen sc1 lds
v_fma_f32 v84, v84, v237, v237
v_fma_f32 v85, v85, v237, v237
v_fma_f32 v86, v86, v237, v237
v_fma_f32 v87, v87, v237, v237
v_rcp_f32 v84, v84
v_rcp_f32 v85, v85
v_rcp_f32 v86, v86
s_add_u32 m0, s39, 33792
s_add_u32 s37, s37, s38
buffer_load_dwordx4 v21, s[8:11], s37 offen sc1 lds
v_rcp_f32 v87, v87
v_mul_f32 v196, v196, v84
v_mul_f32 v197, v197, v85
v_mul_f32 v198, v198, v86
v_mul_f32 v199, v199, v87
v_cvt_pk_bf16_f32 v102, v196, v197
v_cvt_pk_bf16_f32 v103, v198, v199
s_add_u32 m0, s39, 34816
s_add_u32 s37, s37, s38
buffer_load_dwordx4 v21, s[8:11], s37 offen sc1 lds
v_mul_f32 v80, v164, v164
v_mul_f32 v81, v165, v165
v_mul_f32 v82, v166, v166
v_mul_f32 v83, v167, v167
v_fma_f32 v80, v80, v233, v229
s_add_u32 m0, s39, 35840
s_add_u32 s37, s37, s38
buffer_load_dwordx4 v21, s[8:11], s37 offen sc1 lds
v_fma_f32 v81, v81, v233, v229
v_fma_f32 v82, v82, v233, v229
v_fma_f32 v83, v83, v233, v229
v_mul_f32 v80, v80, v164
v_mul_f32 v81, v81, v165
v_mul_f32 v82, v82, v166
v_mul_f32 v83, v83, v167
s_add_u32 m0, s39, 36864
s_add_u32 s37, s37, s55
buffer_load_dwordx4 v21, s[8:11], s37 offen sc1 lds
v_exp_f32 v80, v80
v_exp_f32 v81, v81
v_exp_f32 v82, v82
v_exp_f32 v83, v83
v_mul_f32 v212, v164, v212
v_mul_f32 v213, v165, v213
v_mul_f32 v214, v166, v214
s_add_u32 m0, s39, 37888
s_add_u32 s37, s37, s38
buffer_load_dwordx4 v21, s[8:11], s37 offen sc1 lds
v_mul_f32 v215, v167, v215
v_fma_f32 v80, v80, v237, v237
v_fma_f32 v81, v81, v237, v237
v_fma_f32 v82, v82, v237, v237
v_fma_f32 v83, v83, v237, v237
v_rcp_f32 v80, v80
s_add_u32 m0, s39, 38912
s_add_u32 s37, s37, s38
buffer_load_dwordx4 v21, s[8:11], s37 offen sc1 lds
v_rcp_f32 v81, v81
v_rcp_f32 v82, v82
v_rcp_f32 v83, v83
v_mul_f32 v212, v212, v80
v_mul_f32 v213, v213, v81
v_mul_f32 v214, v214, v82
v_mul_f32 v215, v215, v83
s_add_u32 m0, s39, 39936
s_add_u32 s37, s37, s38
buffer_load_dwordx4 v21, s[8:11], s37 offen sc1 lds
v_cvt_pk_bf16_f32 v114, v212, v213
v_cvt_pk_bf16_f32 v115, v214, v215
s_nop 1
v_permlane32_swap_b32 v112, v114
v_permlane32_swap_b32 v113, v115
buffer_store_dwordx4 v[100:103], v27, s[24:27], 0 offen offset:256 sc1
buffer_store_dwordx4 v[112:115], v28, s[24:27], 0 offen offset:0 sc1
s_waitcnt vmcnt(20)
s_barrier
s_add_u32 m0, s39, 65536
s_add_u32 s37, s37, s40
buffer_load_dwordx4 v21, s[8:11], s37 offen sc1 lds
v_mul_f32 v80, v136, v136
v_mul_f32 v81, v137, v137
v_mul_f32 v82, v138, v138
v_mul_f32 v83, v139, v139
v_fma_f32 v80, v80, v234, v230
v_fma_f32 v81, v81, v234, v230
v_fma_f32 v82, v82, v234, v230
s_add_u32 m0, s39, 66560
s_add_u32 s37, s37, s38
buffer_load_dwordx4 v21, s[8:11], s37 offen sc1 lds
v_fma_f32 v83, v83, v234, v230
v_mul_f32 v80, v80, v136
v_mul_f32 v81, v81, v137
v_mul_f32 v82, v82, v138
v_mul_f32 v83, v83, v139
v_exp_f32 v80, v80
s_add_u32 m0, s39, 67584
s_add_u32 s37, s37, s38
buffer_load_dwordx4 v21, s[8:11], s37 offen sc1 lds
v_exp_f32 v81, v81
v_exp_f32 v82, v82
v_exp_f32 v83, v83
v_mul_f32 v184, v136, v184
v_mul_f32 v185, v137, v185
v_mul_f32 v186, v138, v186
v_mul_f32 v187, v139, v187
s_add_u32 m0, s39, 68608
s_add_u32 s37, s37, s38
buffer_load_dwordx4 v21, s[8:11], s37 offen sc1 lds
v_fma_f32 v80, v80, v238, v238
v_fma_f32 v81, v81, v238, v238
v_fma_f32 v82, v82, v238, v238
v_fma_f32 v83, v83, v238, v238
v_rcp_f32 v80, v80
v_rcp_f32 v81, v81
s_add_u32 m0, s39, 69632
s_add_u32 s37, s37, s55
buffer_load_dwordx4 v21, s[8:11], s37 offen sc1 lds
v_rcp_f32 v82, v82
v_rcp_f32 v83, v83
v_mul_f32 v184, v184, v80
v_mul_f32 v185, v185, v81
v_mul_f32 v186, v186, v82
v_mul_f32 v187, v187, v83
v_cvt_pk_bf16_f32 v104, v184, v185
s_add_u32 m0, s39, 70656
s_add_u32 s37, s37, s38
buffer_load_dwordx4 v21, s[8:11], s37 offen sc1 lds
v_cvt_pk_bf16_f32 v105, v186, v187
v_mul_f32 v84, v152, v152
v_mul_f32 v85, v153, v153
v_mul_f32 v86, v154, v154
v_mul_f32 v87, v155, v155
v_fma_f32 v84, v84, v234, v230
s_add_u32 m0, s39, 71680
s_add_u32 s37, s37, s38
buffer_load_dwordx4 v21, s[8:11], s37 offen sc1 lds
v_fma_f32 v85, v85, v234, v230
v_fma_f32 v86, v86, v234, v230
v_fma_f32 v87, v87, v234, v230
v_mul_f32 v84, v84, v152
v_mul_f32 v85, v85, v153
v_mul_f32 v86, v86, v154
v_mul_f32 v87, v87, v155
s_add_u32 m0, s39, 72704
s_add_u32 s37, s37, s38
buffer_load_dwordx4 v21, s[8:11], s37 offen sc1 lds
v_exp_f32 v84, v84
v_exp_f32 v85, v85
v_exp_f32 v86, v86
v_exp_f32 v87, v87
v_mul_f32 v200, v152, v200
v_mul_f32 v201, v153, v201
s_waitcnt vmcnt(19)
s_barrier
s_add_u32 m0, s39, 98304
s_add_u32 s37, s37, s40
buffer_load_dwordx4 v21, s[8:11], s37 offen sc1 lds
v_mul_f32 v202, v154, v202
v_mul_f32 v203, v155, v203
v_fma_f32 v84, v84, v238, v238
v_fma_f32 v85, v85, v238, v238
v_fma_f32 v86, v86, v238, v238
v_fma_f32 v87, v87, v238, v238
v_rcp_f32 v84, v84
s_add_u32 m0, s39, 99328
s_add_u32 s37, s37, s38
buffer_load_dwordx4 v21, s[8:11], s37 offen sc1 lds
v_rcp_f32 v85, v85
v_rcp_f32 v86, v86
v_rcp_f32 v87, v87
v_mul_f32 v200, v200, v84
v_mul_f32 v201, v201, v85
v_mul_f32 v202, v202, v86
v_mul_f32 v203, v203, v87
s_add_u32 m0, s39, 100352
s_add_u32 s37, s37, s38
buffer_load_dwordx4 v21, s[8:11], s37 offen sc1 lds
v_cvt_pk_bf16_f32 v106, v200, v201
v_cvt_pk_bf16_f32 v107, v202, v203
v_mul_f32 v80, v168, v168
v_mul_f32 v81, v169, v169
v_mul_f32 v82, v170, v170
s_add_u32 m0, s39, 101376
s_add_u32 s37, s37, s38
buffer_load_dwordx4 v21, s[8:11], s37 offen sc1 lds
v_mul_f32 v83, v171, v171
v_fma_f32 v80, v80, v234, v230
v_fma_f32 v81, v81, v234, v230
v_fma_f32 v82, v82, v234, v230
v_fma_f32 v83, v83, v234, v230
v_mul_f32 v80, v80, v168
v_mul_f32 v81, v81, v169
s_add_u32 m0, s39, 102400
s_add_u32 s37, s37, s55
buffer_load_dwordx4 v21, s[8:11], s37 offen sc1 lds
v_mul_f32 v82, v82, v170
v_mul_f32 v83, v83, v171
v_exp_f32 v80, v80
v_exp_f32 v81, v81
v_exp_f32 v82, v82
v_exp_f32 v83, v83
v_mul_f32 v216, v168, v216
s_add_u32 m0, s39, 103424
s_add_u32 s37, s37, s38
buffer_load_dwordx4 v21, s[8:11], s37 offen sc1 lds
v_mul_f32 v217, v169, v217
v_mul_f32 v218, v170, v218
v_mul_f32 v219, v171, v219
v_fma_f32 v80, v80, v238, v238
v_fma_f32 v81, v81, v238, v238
v_fma_f32 v82, v82, v238, v238
s_add_u32 m0, s39, 104448
s_add_u32 s37, s37, s38
buffer_load_dwordx4 v21, s[8:11], s37 offen sc1 lds
v_fma_f32 v83, v83, v238, v238
v_rcp_f32 v80, v80
v_rcp_f32 v81, v81
v_rcp_f32 v82, v82
v_rcp_f32 v83, v83
v_mul_f32 v216, v216, v80
v_mul_f32 v217, v217, v81
s_add_u32 m0, s39, 105472
s_add_u32 s37, s37, s38
buffer_load_dwordx4 v21, s[8:11], s37 offen sc1 lds
v_mul_f32 v218, v218, v82
v_mul_f32 v219, v219, v83
v_cvt_pk_bf16_f32 v116, v216, v217
v_cvt_pk_bf16_f32 v117, v218, v219
v_mul_f32 v80, v140, v140
v_mul_f32 v81, v141, v141
buffer_store_dwordx4 v[104:107], v27, s[24:27], 0 offen offset:512 sc1
s_waitcnt vmcnt(19)
s_mov_b32 s41, 0x10000
s_waitcnt vmcnt(27)
s_branch Lpf_59
Lpoll_57:
s_waitcnt vmcnt(0)
Lpf_59:
v_cmp_ne_u32 vcc, v12, v11
s_nop 4
s_cbranch_vccz Lpok_58
buffer_load_dword v11, v10, s[56:59], 0 offen sc1
s_sub_u32 s41, s41, 1
s_cmp_lg_u32 s41, 0
s_cbranch_scc1 Lpoll_57
s_waitcnt vmcnt(0)
Lpok_58:
s_barrier
s_add_u32 s37, s37, s29
s_add_u32 m0, s39, 0
s_add_u32 s37, s37, s40
buffer_load_dwordx4 v21, s[8:11], s37 offen sc1 lds
v_mul_f32 v82, v142, v142
v_mul_f32 v83, v143, v143
v_fma_f32 v80, v80, v235, v231
v_fma_f32 v81, v81, v235, v231
v_fma_f32 v82, v82, v235, v231
v_fma_f32 v83, v83, v235, v231
v_mul_f32 v80, v80, v140
s_add_u32 m0, s39, 1024
s_add_u32 s37, s37, s38
buffer_load_dwordx4 v21, s[8:11], s37 offen sc1 lds
v_mul_f32 v81, v81, v141
v_mul_f32 v82, v82, v142
v_mul_f32 v83, v83, v143
v_exp_f32 v80, v80
v_exp_f32 v81, v81
v_exp_f32 v82, v82
s_add_u32 m0, s39, 2048
s_add_u32 s37, s37, s38
buffer_load_dwordx4 v21, s[8:11], s37 offen sc1 lds
v_exp_f32 v83, v83
v_mul_f32 v188, v140, v188
v_mul_f32 v189, v141, v189
v_mul_f32 v190, v142, v190
v_mul_f32 v191, v143, v191
v_fma_f32 v80, v80, v239, v239
v_fma_f32 v81, v81, v239, v239
s_add_u32 m0, s39, 3072
s_add_u32 s37, s37, s38
buffer_load_dwordx4 v21, s[8:11], s37 offen sc1 lds
v_fma_f32 v82, v82, v239, v239
v_fma_f32 v83, v83, v239, v239
v_rcp_f32 v80, v80
v_rcp_f32 v81, v81
v_rcp_f32 v82, v82
v_rcp_f32 v83, v83
s_add_u32 m0, s39, 4096
s_add_u32 s37, s37, s55
buffer_load_dwordx4 v21, s[8:11], s37 offen sc1 lds
v_mul_f32 v188, v188, v80
v_mul_f32 v189, v189, v81
v_mul_f32 v190, v190, v82
v_mul_f32 v191, v191, v83
v_cvt_pk_bf16_f32 v108, v188, v189
v_cvt_pk_bf16_f32 v109, v190, v191
v_mul_f32 v84, v156, v156
s_add_u32 m0, s39, 5120
s_add_u32 s37, s37, s38
buffer_load_dwordx4 v21, s[8:11], s37 offen sc1 lds
v_mul_f32 v85, v157, v157
v_mul_f32 v86, v158, v158
v_mul_f32 v87, v159, v159
v_fma_f32 v84, v84, v235, v231
v_fma_f32 v85, v85, v235, v231
v_fma_f32 v86, v86, v235, v231
s_add_u32 m0, s39, 6144
s_add_u32 s37, s37, s38
buffer_load_dwordx4 v21, s[8:11], s37 offen sc1 lds
v_fma_f32 v87, v87, v235, v231
v_mul_f32 v84, v84, v156
v_mul_f32 v85, v85, v157
v_mul_f32 v86, v86, v158
v_mul_f32 v87, v87, v159
v_exp_f32 v84, v84
v_exp_f32 v85, v85
s_add_u32 m0, s39, 7168
s_add_u32 s37, s37, s38
buffer_load_dwordx4 v21, s[8:11], s37 offen sc1 lds
v_exp_f32 v86, v86
v_exp_f32 v87, v87
v_mul_f32 v204, v156, v204
v_mul_f32 v205, v157, v205
v_mul_f32 v206, v158, v206
v_mul_f32 v207, v159, v207
s_waitcnt vmcnt(17)
s_barrier
s_add_u32 m0, s39, 32768
s_add_u32 s37, s37, s40
buffer_load_dwordx4 v21, s[8:11], s37 offen sc1 lds
v_fma_f32 v84, v84, v239, v239
v_fma_f32 v85, v85, v239, v239
v_fma_f32 v86, v86, v239, v239
v_fma_f32 v87, v87, v239, v239
v_rcp_f32 v84, v84
v_rcp_f32 v85, v85
v_rcp_f32 v86, v86
s_add_u32 m0, s39, 33792
s_add_u32 s37, s37, s38
buffer_load_dwordx4 v21, s[8:11], s37 offen sc1 lds
v_rcp_f32 v87, v87
v_mul_f32 v204, v204, v84
v_mul_f32 v205, v205, v85
v_mul_f32 v206, v206, v86
v_mul_f32 v207, v207, v87
v_cvt_pk_bf16_f32 v110, v204, v205
v_cvt_pk_bf16_f32 v111, v206, v207
s_add_u32 m0, s39, 34816
s_add_u32 s37, s37, s38
buffer_load_dwordx4 v21, s[8:11], s37 offen sc1 lds
v_mul_f32 v80, v172, v172
v_mul_f32 v81, v173, v173
v_mul_f32 v82, v174, v174
v_mul_f32 v83, v175, v175
v_fma_f32 v80, v80, v235, v231
s_add_u32 m0, s39, 35840
s_add_u32 s37, s37, s38
buffer_load_dwordx4 v21, s[8:11], s37 offen sc1 lds
v_fma_f32 v81, v81, v235, v231
v_fma_f32 v82, v82, v235, v231
v_fma_f32 v83, v83, v235, v231
v_mul_f32 v80, v80, v172
v_mul_f32 v81, v81, v173
v_mul_f32 v82, v82, v174
v_mul_f32 v83, v83, v175
s_add_u32 m0, s39, 36864
s_add_u32 s37, s37, s55
buffer_load_dwordx4 v21, s[8:11], s37 offen sc1 lds
v_exp_f32 v80, v80
v_exp_f32 v81, v81
v_exp_f32 v82, v82
v_exp_f32 v83, v83
v_mul_f32 v220, v172, v220
v_mul_f32 v221, v173, v221
v_mul_f32 v222, v174, v222
s_add_u32 m0, s39, 37888
s_add_u32 s37, s37, s38
buffer_load_dwordx4 v21, s[8:11], s37 offen sc1 lds
v_mul_f32 v223, v175, v223
v_fma_f32 v80, v80, v239, v239
v_fma_f32 v81, v81, v239, v239
v_fma_f32 v82, v82, v239, v239
v_fma_f32 v83, v83, v239, v239
v_rcp_f32 v80, v80
s_add_u32 m0, s39, 38912
s_add_u32 s37, s37, s38
buffer_load_dwordx4 v21, s[8:11], s37 offen sc1 lds
v_rcp_f32 v81, v81
v_rcp_f32 v82, v82
v_rcp_f32 v83, v83
v_mul_f32 v220, v220, v80
v_mul_f32 v221, v221, v81
v_mul_f32 v222, v222, v82
v_mul_f32 v223, v223, v83
s_add_u32 m0, s39, 39936
s_add_u32 s37, s37, s38
buffer_load_dwordx4 v21, s[8:11], s37 offen sc1 lds
v_cvt_pk_bf16_f32 v118, v220, v221
v_cvt_pk_bf16_f32 v119, v222, v223
s_nop 1
v_permlane32_swap_b32 v116, v118
v_permlane32_swap_b32 v117, v119
buffer_store_dwordx4 v[108:111], v27, s[24:27], 0 offen offset:768 sc1
buffer_store_dwordx4 v[116:119], v28, s[24:27], 0 offen offset:512 sc1
s_waitcnt vmcnt(19)
s_barrier
s_add_u32 m0, s39, 65536
s_add_u32 s37, s37, s40
buffer_load_dwordx4 v21, s[8:11], s37 offen sc1 lds
s_add_u32 m0, s39, 66560
s_add_u32 s37, s37, s38
buffer_load_dwordx4 v21, s[8:11], s37 offen sc1 lds
s_add_u32 m0, s39, 67584
s_add_u32 s37, s37, s38
buffer_load_dwordx4 v21, s[8:11], s37 offen sc1 lds
s_add_u32 m0, s39, 68608
s_add_u32 s37, s37, s38
buffer_load_dwordx4 v21, s[8:11], s37 offen sc1 lds
s_add_u32 m0, s39, 69632
s_add_u32 s37, s37, s55
buffer_load_dwordx4 v21, s[8:11], s37 offen sc1 lds
s_add_u32 m0, s39, 70656
s_add_u32 s37, s37, s38
buffer_load_dwordx4 v21, s[8:11], s37 offen sc1 lds
s_add_u32 m0, s39, 71680
s_add_u32 s37, s37, s38
buffer_load_dwordx4 v21, s[8:11], s37 offen sc1 lds
s_add_u32 m0, s39, 72704
s_add_u32 s37, s37, s38
buffer_load_dwordx4 v21, s[8:11], s37 offen sc1 lds
s_waitcnt vmcnt(8)
s_barrier
s_add_u32 s43, s34, 64
s_lshl_b32 s43, s43, 7
v_mov_b32 v10, s43
v_mov_b32 v11, 1
s_mov_b64 exec, 1
buffer_atomic_add v11, v10, s[56:59], 0 offen sc1
s_mov_b64 exec, -1
s_add_u32 m0, s39, 98304
s_add_u32 s37, s37, s40
buffer_load_dwordx4 v21, s[8:11], s37 offen sc1 lds
s_add_u32 m0, s39, 99328
s_add_u32 s37, s37, s38
buffer_load_dwordx4 v21, s[8:11], s37 offen sc1 lds
s_add_u32 m0, s39, 100352
s_add_u32 s37, s37, s38
buffer_load_dwordx4 v21, s[8:11], s37 offen sc1 lds
s_add_u32 m0, s39, 101376
s_add_u32 s37, s37, s38
buffer_load_dwordx4 v21, s[8:11], s37 offen sc1 lds
s_add_u32 m0, s39, 102400
s_add_u32 s37, s37, s55
buffer_load_dwordx4 v21, s[8:11], s37 offen sc1 lds
s_add_u32 m0, s39, 103424
s_add_u32 s37, s37, s38
buffer_load_dwordx4 v21, s[8:11], s37 offen sc1 lds
s_add_u32 m0, s39, 104448
s_add_u32 s37, s37, s38
buffer_load_dwordx4 v21, s[8:11], s37 offen sc1 lds
s_add_u32 m0, s39, 105472
s_add_u32 s37, s37, s38
buffer_load_dwordx4 v21, s[8:11], s37 offen sc1 lds
s_waitcnt vmcnt(19)
s_barrier
s_lshr_b32 s44, s2, 3
s_lshl_b32 s44, s44, 16
s_add_u32 s43, s44, 4194304
buffer_load_dword v30, v29, s[80:83], s43 offen
s_add_u32 m0, s39, 0
s_add_u32 s37, s37, s40
buffer_load_dwordx4 v21, s[8:11], s37 offen sc1 lds
s_add_u32 m0, s39, 1024
s_add_u32 s37, s37, s38
buffer_load_dwordx4 v21, s[8:11], s37 offen sc1 lds
s_add_u32 m0, s39, 2048
s_add_u32 s37, s37, s38
buffer_load_dwordx4 v21, s[8:11], s37 offen sc1 lds
s_add_u32 m0, s39, 3072
s_add_u32 s37, s37, s38
buffer_load_dwordx4 v21, s[8:11], s37 offen sc1 lds
s_add_u32 m0, s39, 4096
s_add_u32 s37, s37, s55
buffer_load_dwordx4 v21, s[8:11], s37 offen sc1 lds
s_add_u32 m0, s39, 5120
s_add_u32 s37, s37, s38
buffer_load_dwordx4 v21, s[8:11], s37 offen sc1 lds
s_add_u32 m0, s39, 6144
s_add_u32 s37, s37, s38
buffer_load_dwordx4 v21, s[8:11], s37 offen sc1 lds
s_add_u32 m0, s39, 7168
s_add_u32 s37, s37, s38
buffer_load_dwordx4 v21, s[8:11], s37 offen sc1 lds
s_waitcnt vmcnt(18)
s_barrier
s_add_u32 s43, s34, 64
s_lshl_b32 s43, s43, 7
v_mov_b32 v10, s43
v_mov_b32 v12, 16
buffer_load_dword v11, v10, s[56:59], 0 offen sc1
s_add_u32 m0, s39, 32768
s_add_u32 s37, s37, s40
buffer_load_dwordx4 v21, s[8:11], s37 offen sc1 lds
s_add_u32 m0, s39, 33792
s_add_u32 s37, s37, s38
buffer_load_dwordx4 v21, s[8:11], s37 offen sc1 lds
s_add_u32 m0, s39, 34816
s_add_u32 s37, s37, s38
buffer_load_dwordx4 v21, s[8:11], s37 offen sc1 lds
s_add_u32 m0, s39, 35840
s_add_u32 s37, s37, s38
buffer_load_dwordx4 v21, s[8:11], s37 offen sc1 lds
s_add_u32 m0, s39, 36864
s_add_u32 s37, s37, s55
buffer_load_dwordx4 v21, s[8:11], s37 offen sc1 lds
s_add_u32 m0, s39, 37888
s_add_u32 s37, s37, s38
buffer_load_dwordx4 v21, s[8:11], s37 offen sc1 lds
s_add_u32 m0, s39, 38912
s_add_u32 s37, s37, s38
buffer_load_dwordx4 v21, s[8:11], s37 offen sc1 lds
s_add_u32 m0, s39, 39936
s_add_u32 s37, s37, s38
buffer_load_dwordx4 v21, s[8:11], s37 offen sc1 lds
s_waitcnt vmcnt(18)
s_barrier
s_add_u32 m0, s39, 65536
s_add_u32 s37, s37, s40
buffer_load_dwordx4 v21, s[8:11], s37 offen sc1 lds
s_add_u32 m0, s39, 66560
s_add_u32 s37, s37, s38
buffer_load_dwordx4 v21, s[8:11], s37 offen sc1 lds
s_add_u32 m0, s39, 67584
s_add_u32 s37, s37, s38
buffer_load_dwordx4 v21, s[8:11], s37 offen sc1 lds
s_add_u32 m0, s39, 68608
s_add_u32 s37, s37, s38
buffer_load_dwordx4 v21, s[8:11], s37 offen sc1 lds
s_add_u32 m0, s39, 69632
s_add_u32 s37, s37, s55
buffer_load_dwordx4 v21, s[8:11], s37 offen sc1 lds
s_add_u32 m0, s39, 70656
s_add_u32 s37, s37, s38
buffer_load_dwordx4 v21, s[8:11], s37 offen sc1 lds
s_add_u32 m0, s39, 71680
s_add_u32 s37, s37, s38
buffer_load_dwordx4 v21, s[8:11], s37 offen sc1 lds
s_add_u32 m0, s39, 72704
s_add_u32 s37, s37, s38
buffer_load_dwordx4 v21, s[8:11], s37 offen sc1 lds
s_waitcnt vmcnt(17)
s_barrier
s_add_u32 m0, s39, 98304
s_add_u32 s37, s37, s40
buffer_load_dwordx4 v21, s[8:11], s37 offen sc1 lds
s_add_u32 m0, s39, 99328
s_add_u32 s37, s37, s38
buffer_load_dwordx4 v21, s[8:11], s37 offen sc1 lds
s_add_u32 m0, s39, 100352
s_add_u32 s37, s37, s38
buffer_load_dwordx4 v21, s[8:11], s37 offen sc1 lds
s_add_u32 m0, s39, 101376
s_add_u32 s37, s37, s38
buffer_load_dwordx4 v21, s[8:11], s37 offen sc1 lds
s_add_u32 m0, s39, 102400
s_add_u32 s37, s37, s55
buffer_load_dwordx4 v21, s[8:11], s37 offen sc1 lds
s_add_u32 m0, s39, 103424
s_add_u32 s37, s37, s38
buffer_load_dwordx4 v21, s[8:11], s37 offen sc1 lds
s_add_u32 m0, s39, 104448
s_add_u32 s37, s37, s38
buffer_load_dwordx4 v21, s[8:11], s37 offen sc1 lds
s_add_u32 m0, s39, 105472
s_add_u32 s37, s37, s38
buffer_load_dwordx4 v21, s[8:11], s37 offen sc1 lds
s_waitcnt vmcnt(16)
s_mov_b32 s41, 0x10000
s_waitcnt vmcnt(24)
s_branch Lpf_62
Lpoll_60:
s_waitcnt vmcnt(0)
Lpf_62:
v_cmp_ne_u32 vcc, v12, v11
s_nop 4
s_cbranch_vccz Lpok_61
buffer_load_dword v11, v10, s[56:59], 0 offen sc1
s_sub_u32 s41, s41, 1
s_cmp_lg_u32 s41, 0
s_cbranch_scc1 Lpoll_60
s_waitcnt vmcnt(0)
Lpok_61:
s_barrier
s_mul_i32 s40, s53, 786432
s_add_u32 m0, s39, 0
s_add_u32 s37, s40, 4194304
buffer_load_dwordx4 v21, s[8:11], s37 offen sc1 lds
s_add_u32 m0, s39, 1024
s_add_u32 s37, s40, 4210688
buffer_load_dwordx4 v21, s[8:11], s37 offen sc1 lds
s_add_u32 m0, s39, 2048
s_add_u32 s37, s40, 4227072
buffer_load_dwordx4 v21, s[8:11], s37 offen sc1 lds
s_add_u32 m0, s39, 3072
s_add_u32 s37, s40, 4243456
buffer_load_dwordx4 v21, s[8:11], s37 offen sc1 lds
s_add_u32 m0, s39, 4096
s_add_u32 s37, s40, 4292608
buffer_load_dwordx4 v21, s[8:11], s37 offen sc1 lds
s_add_u32 m0, s39, 5120
s_add_u32 s37, s40, 4308992
buffer_load_dwordx4 v21, s[8:11], s37 offen sc1 lds
s_add_u32 m0, s39, 6144
s_add_u32 s37, s40, 4325376
buffer_load_dwordx4 v21, s[8:11], s37 offen sc1 lds
s_add_u32 m0, s39, 7168
s_add_u32 s37, s40, 4341760
buffer_load_dwordx4 v21, s[8:11], s37 offen sc1 lds
s_waitcnt vmcnt(16)
s_barrier
s_add_u32 m0, s39, 32768
s_add_u32 s37, s40, 4259840
buffer_load_dwordx4 v21, s[8:11], s37 offen sc1 lds
s_add_u32 m0, s39, 33792
s_add_u32 s37, s40, 4358144
buffer_load_dwordx4 v21, s[8:11], s37 offen sc1 lds
s_add_u32 m0, s39, 34816
s_add_u32 s37, s40, 4276224
buffer_load_dwordx4 v21, s[8:11], s37 offen sc1 lds
s_add_u32 m0, s39, 35840
s_add_u32 s37, s40, 4374528
buffer_load_dwordx4 v21, s[8:11], s37 offen sc1 lds
s_add_u32 m0, s39, 36864
s_add_u32 s37, s40, 4390912
buffer_load_dwordx4 v21, s[8:11], s37 offen sc1 lds
s_add_u32 m0, s39, 37888
s_add_u32 s37, s40, 4407296
buffer_load_dwordx4 v21, s[8:11], s37 offen sc1 lds
s_add_u32 m0, s39, 38912
s_add_u32 s37, s40, 4423680
buffer_load_dwordx4 v21, s[8:11], s37 offen sc1 lds
s_add_u32 m0, s39, 39936
s_add_u32 s37, s40, 4440064
buffer_load_dwordx4 v21, s[8:11], s37 offen sc1 lds
s_waitcnt vmcnt(16)
s_barrier
s_add_u32 m0, s39, 65536
s_add_u32 s37, s40, 4489216
buffer_load_dwordx4 v21, s[8:11], s37 offen sc1 lds
s_add_u32 m0, s39, 66560
s_add_u32 s37, s40, 4505600
buffer_load_dwordx4 v21, s[8:11], s37 offen sc1 lds
s_add_u32 m0, s39, 67584
s_add_u32 s37, s40, 4521984
buffer_load_dwordx4 v21, s[8:11], s37 offen sc1 lds
s_add_u32 m0, s39, 68608
s_add_u32 s37, s40, 4538368
buffer_load_dwordx4 v21, s[8:11], s37 offen sc1 lds
s_add_u32 m0, s39, 69632
s_add_u32 s37, s40, 4456448
buffer_load_dwordx4 v21, s[8:11], s37 offen sc1 lds
s_add_u32 m0, s39, 70656
s_add_u32 s37, s40, 4554752
buffer_load_dwordx4 v21, s[8:11], s37 offen sc1 lds
s_add_u32 m0, s39, 71680
s_add_u32 s37, s40, 4472832
buffer_load_dwordx4 v21, s[8:11], s37 offen sc1 lds
s_add_u32 m0, s39, 72704
s_add_u32 s37, s40, 4571136
buffer_load_dwordx4 v21, s[8:11], s37 offen sc1 lds
s_waitcnt vmcnt(16)
s_barrier
s_add_u32 m0, s39, 98304
s_add_u32 s37, s40, 4587520
buffer_load_dwordx4 v21, s[8:11], s37 offen sc1 lds
s_add_u32 m0, s39, 99328
s_add_u32 s37, s40, 4603904
buffer_load_dwordx4 v21, s[8:11], s37 offen sc1 lds
s_add_u32 m0, s39, 100352
s_add_u32 s37, s40, 4620288
buffer_load_dwordx4 v21, s[8:11], s37 offen sc1 lds
s_add_u32 m0, s39, 101376
s_add_u32 s37, s40, 4636672
buffer_load_dwordx4 v21, s[8:11], s37 offen sc1 lds
s_add_u32 m0, s39, 102400
s_add_u32 s37, s40, 4685824
buffer_load_dwordx4 v21, s[8:11], s37 offen sc1 lds
s_add_u32 m0, s39, 103424
s_add_u32 s37, s40, 4702208
buffer_load_dwordx4 v21, s[8:11], s37 offen sc1 lds
s_add_u32 m0, s39, 104448
s_add_u32 s37, s40, 4718592
buffer_load_dwordx4 v21, s[8:11], s37 offen sc1 lds
s_add_u32 m0, s39, 105472
s_add_u32 s37, s40, 4734976
buffer_load_dwordx4 v21, s[8:11], s37 offen sc1 lds
s_waitcnt vmcnt(16)
s_barrier
s_add_u32 m0, s39, 0
s_add_u32 s37, s40, 4653056
buffer_load_dwordx4 v21, s[8:11], s37 offen sc1 lds
s_add_u32 m0, s39, 1024
s_add_u32 s37, s40, 4751360
buffer_load_dwordx4 v21, s[8:11], s37 offen sc1 lds
s_add_u32 m0, s39, 2048
s_add_u32 s37, s40, 4669440
buffer_load_dwordx4 v21, s[8:11], s37 offen sc1 lds
s_add_u32 m0, s39, 3072
s_add_u32 s37, s40, 4767744
buffer_load_dwordx4 v21, s[8:11], s37 offen sc1 lds
s_add_u32 m0, s39, 4096
s_add_u32 s37, s40, 4784128
buffer_load_dwordx4 v21, s[8:11], s37 offen sc1 lds
s_add_u32 m0, s39, 5120
s_add_u32 s37, s40, 4800512
buffer_load_dwordx4 v21, s[8:11], s37 offen sc1 lds
s_add_u32 m0, s39, 6144
s_add_u32 s37, s40, 4816896
buffer_load_dwordx4 v21, s[8:11], s37 offen sc1 lds
s_add_u32 m0, s39, 7168
s_add_u32 s37, s40, 4833280
buffer_load_dwordx4 v21, s[8:11], s37 offen sc1 lds
s_waitcnt vmcnt(16)
s_barrier
s_add_u32 m0, s39, 32768
s_add_u32 s37, s40, 4882432
buffer_load_dwordx4 v21, s[8:11], s37 offen sc1 lds
s_add_u32 m0, s39, 33792
s_add_u32 s37, s40, 4898816
buffer_load_dwordx4 v21, s[8:11], s37 offen sc1 lds
s_add_u32 m0, s39, 34816
s_add_u32 s37, s40, 4915200
buffer_load_dwordx4 v21, s[8:11], s37 offen sc1 lds
s_add_u32 m0, s39, 35840
s_add_u32 s37, s40, 4931584
buffer_load_dwordx4 v21, s[8:11], s37 offen sc1 lds
s_add_u32 m0, s39, 36864
s_add_u32 s37, s40, 4849664
buffer_load_dwordx4 v21, s[8:11], s37 offen sc1 lds
s_add_u32 m0, s39, 37888
s_add_u32 s37, s40, 4947968
buffer_load_dwordx4 v21, s[8:11], s37 offen sc1 lds
s_add_u32 m0, s39, 38912
s_add_u32 s37, s40, 4866048
buffer_load_dwordx4 v21, s[8:11], s37 offen sc1 lds
s_add_u32 m0, s39, 39936
s_add_u32 s37, s40, 4964352
buffer_load_dwordx4 v21, s[8:11], s37 offen sc1 lds
s_waitcnt vmcnt(16)
s_barrier
s_lshr_b32 s44, s2, 3
s_and_b32 s44, s44, 15
s_lshl_b32 s44, s44, 16
s_add_u32 s43, s44, 6291456
buffer_load_dword v30, v29, s[80:83], s43 offen
s_waitcnt vmcnt(9)
s_barrier
s_waitcnt vmcnt(1)
s_barrier
s_barrier
s_barrier
s_barrier
s_barrier
s_barrier
s_lshl_b32 s43, s34, 4
s_add_u32 s43, s43, s35
s_and_b32 s44, s43, 1
s_lshl_b32 s44, s44, 2
s_lshr_b32 s43, s43, 1
s_add_u32 s43, s43, 128
s_lshl_b32 s43, s43, 7
s_add_u32 s43, s43, s44
v_mov_b32 v10, s43
v_mov_b32 v11, 1
s_mov_b64 exec, 1
buffer_store_dword v11, v10, s[56:59], 0 offen sc1
s_mov_b64 exec, -1
s_barrier
s_barrier
s_barrier
s_lshl_b32 s43, s34, 4
s_add_u32 s43, s43, s35
s_xor_b32 s43, s43, 1
s_and_b32 s44, s43, 1
s_lshl_b32 s44, s44, 2
s_lshr_b32 s43, s43, 1
s_add_u32 s43, s43, 128
s_lshl_b32 s43, s43, 7
s_add_u32 s43, s43, s44
v_mov_b32 v10, s43
v_mov_b32 v12, 1
buffer_load_dword v11, v10, s[56:59], 0 offen sc1
s_barrier
s_barrier
s_mov_b32 s41, 0x10000
Lpoll_63:
s_waitcnt vmcnt(0)
Lpf_65:
v_cmp_ne_u32 vcc, v12, v11
s_nop 4
s_cbranch_vccz Lpok_64
buffer_load_dword v11, v10, s[56:59], 0 offen sc1
s_sub_u32 s41, s41, 1
s_cmp_lg_u32 s41, 0
s_cbranch_scc1 Lpoll_63
s_waitcnt vmcnt(0)
Lpok_64:
s_barrier
s_branch Ldone_1
Ldone_1:
s_endpgm
.section .rodata,"a"
.p2align 6
.amdhsa_kernel sequential_preLN__sliding_local_dilated__glu_gated_geglu__prompt_kernel
  .amdhsa_next_free_vgpr 256
  .amdhsa_next_free_sgpr 100
  .amdhsa_accum_offset 256
  .amdhsa_group_segment_fixed_size 0
  .amdhsa_kernarg_size 80
  .amdhsa_user_sgpr_count 2
  .amdhsa_user_sgpr_kernarg_segment_ptr 1
  .amdhsa_system_sgpr_workgroup_id_x 1
  .amdhsa_float_denorm_mode_32 3
  .amdhsa_float_denorm_mode_16_64 3
.end_amdhsa_kernel
```

```asm
; @launch grid=(256,1,1) block=(512,1,1) lds=151552
.amdgcn_target "amdgcn-amd-amdhsa--gfx950"
.text
.globl sequential_preLN__sliding_local_dilated__glu_gated_geglu__prompt_kernel
.p2align 8
.type sequential_preLN__sliding_local_dilated__glu_gated_geglu__prompt_kernel,@function
sequential_preLN__sliding_local_dilated__glu_gated_geglu__prompt_kernel:
s_cmp_ge_u32 s2, 256
s_cbranch_scc1 Ldone_1
s_load_dwordx4 s[4:7], s[0:1], 0
s_load_dwordx2 s[32:33], s[0:1], 72
s_load_dwordx2 s[80:81], s[0:1], 32
s_and_b32 s3, s2, 7
s_lshr_b32 s42, s2, 3
s_and_b32 s48, s42, 3
s_lshr_b32 s49, s42, 2
s_and_b32 s34, s3, 3
s_lshl_b32 s34, s34, 2
s_add_u32 s34, s34, s48
s_lshr_b32 s35, s3, 2
s_lshl_b32 s35, s35, 3
s_add_u32 s35, s35, s49
v_lshrrev_b32 v12, 6, v0
v_and_b32 v1, 63, v0
v_readfirstlane_b32 s36, v12
s_nop 3
s_lshl_b32 s44, s34, 18
s_lshl_b32 s45, s35, 14
s_add_u32 s45, s45, s44
s_lshl_b32 s50, s34, 7
s_sub_u32 s50, s50, 16
s_and_b32 s47, s36, 3
s_lshl_b32 s43, s34, 7
s_lshl_b32 s44, s35, 3
s_add_u32 s43, s43, s44
s_mov_b32 s63, s43
s_lshl_b32 s44, s47, 1
s_add_u32 s51, s43, s44
v_lshlrev_b32 v10, 4, v1
v_lshrrev_b32 v14, 3, v1
v_and_b32 v15, 7, v1
v_and_b32 v16, 2, v14
v_xor_b32 v16, v15, v16
v_lshlrev_b32 v16, 4, v16
v_mul_u32_u24 v17, 6144, v14
s_lshl_b32 s43, s47, 11
v_add3_u32 v2, v17, v16, s43
v_xor_b32 v3, 64, v2
v_lshrrev_b32 v16, 1, v14
v_xor_b32 v16, v15, v16
v_lshlrev_b32 v16, 4, v16
s_lshl_b32 s43, s47, 3
s_add_u32 s43, s43, s50
v_add_u32 v17, s43, v14
s_and_b32 s44, s47, 1
s_lshl_b32 s44, s44, 6
v_add_u32 v18, 0, v17
v_max_i32 v18, 0, v18
v_lshl_add_u32 v18, v18, 11, v16
v_xor_b32 v18, s44, v18
v_mov_b32 v4, v18
v_add_u32 v18, 24, v17
v_max_i32 v18, 0, v18
v_lshl_add_u32 v18, v18, 11, v16
v_xor_b32 v18, s44, v18
v_xor_b32 v5, 64, v18
v_add_u32 v18, 48, v17
v_max_i32 v18, 0, v18
v_lshl_add_u32 v18, v18, 11, v16
v_xor_b32 v18, s44, v18
v_mov_b32 v6, v18
v_add_u32 v18, 72, v17
v_max_i32 v18, 0, v18
v_lshl_add_u32 v18, v18, 11, v16
v_xor_b32 v18, s44, v18
v_xor_b32 v7, 64, v18
v_add_u32 v18, 96, v17
v_max_i32 v18, 0, v18
v_lshl_add_u32 v18, v18, 11, v16
v_xor_b32 v18, s44, v18
v_mov_b32 v8, v18
v_add_u32 v18, 120, v17
v_max_i32 v18, 0, v18
v_lshl_add_u32 v18, v18, 11, v16
v_xor_b32 v18, s44, v18
v_xor_b32 v9, 64, v18
s_lshl_b32 s39, s47, 10
s_lshl_b32 s40, s47, 13
s_add_u32 s40, s40, 18432
s_mov_b32 s37, 0
s_mov_b32 s38, 0
s_bfm_b64 s[60:61], 56, 8
s_cmp_eq_u32 s47, 0
s_cselect_b64 s[60:61], s[60:61], -1
s_mov_b32 s53, 0x3f803f80
v_and_b32 v12, 15, v1
v_lshrrev_b32 v13, 4, v1
s_lshl_b32 s43, s35, 7
s_waitcnt lgkmcnt(0)
s_mov_b32 s8, s4
s_mov_b32 s9, s5
s_mov_b32 s10, 4194304
s_mov_b32 s11, 0x20000
s_add_u32 s12, s6, s43
s_addc_u32 s13, s7, 0
s_mov_b32 s14, 6289536
s_mov_b32 s15, 0x20000
s_add_u32 s16, s32, s45
s_addc_u32 s17, s33, 0
s_mov_b32 s18, 16384
s_mov_b32 s19, 0x20000
s_add_u32 s20, s32, 26214400
s_addc_u32 s21, s33, 0
s_mov_b32 s22, 16384
s_mov_b32 s23, 0x20000
s_cmp_lt_u32 s36, 4
s_cbranch_scc1 Lcons_2
s_cmp_eq_u32 s36, 7
s_cbranch_scc1 Lpf_3
s_add_u32 m0, s39, 0
s_mov_b64 exec, s[60:61]
buffer_load_dwordx4 v4, s[8:11], s37 offen lds
s_mov_b64 exec, -1
s_add_u32 m0, s39, 3072
s_nop 0
buffer_load_dwordx4 v5, s[8:11], s37 offen lds
s_add_u32 m0, s39, 6144
s_nop 0
buffer_load_dwordx4 v6, s[8:11], s37 offen lds
s_add_u32 m0, s39, 9216
s_nop 0
buffer_load_dwordx4 v7, s[8:11], s37 offen lds
s_add_u32 m0, s39, 12288
s_nop 0
buffer_load_dwordx4 v8, s[8:11], s37 offen lds
s_add_u32 m0, s39, 15360
s_nop 0
buffer_load_dwordx4 v9, s[8:11], s37 offen lds
s_add_u32 m0, s40, 0
s_add_u32 s43, s38, 0
buffer_load_dwordx4 v2, s[12:15], s43 offen lds
s_add_u32 m0, s40, 1024
s_add_u32 s43, s38, 49152
buffer_load_dwordx4 v3, s[12:15], s43 offen lds
s_add_u32 m0, s40, 2048
s_add_u32 s43, s38, 98304
buffer_load_dwordx4 v2, s[12:15], s43 offen lds
s_add_u32 m0, s40, 3072
s_add_u32 s43, s38, 147456
buffer_load_dwordx4 v3, s[12:15], s43 offen lds
s_add_u32 m0, s40, 4096
s_add_u32 s43, s38, 196608
buffer_load_dwordx4 v2, s[12:15], s43 offen lds
s_add_u32 m0, s40, 5120
s_add_u32 s43, s38, 245760
buffer_load_dwordx4 v3, s[12:15], s43 offen lds
s_add_u32 m0, s40, 6144
s_add_u32 s43, s38, 294912
buffer_load_dwordx4 v2, s[12:15], s43 offen lds
s_add_u32 m0, s40, 7168
s_add_u32 s43, s38, 344064
buffer_load_dwordx4 v3, s[12:15], s43 offen lds
s_add_u32 s37, s37, 128
s_add_u32 s38, s38, 393216
s_add_u32 m0, s39, 43008
s_mov_b64 exec, s[60:61]
buffer_load_dwordx4 v4, s[8:11], s37 offen lds
s_mov_b64 exec, -1
s_add_u32 m0, s39, 46080
s_nop 0
buffer_load_dwordx4 v5, s[8:11], s37 offen lds
s_add_u32 m0, s39, 49152
s_nop 0
buffer_load_dwordx4 v6, s[8:11], s37 offen lds
s_add_u32 m0, s39, 52224
s_nop 0
buffer_load_dwordx4 v7, s[8:11], s37 offen lds
s_add_u32 m0, s39, 55296
s_nop 0
buffer_load_dwordx4 v8, s[8:11], s37 offen lds
s_add_u32 m0, s39, 58368
s_nop 0
buffer_load_dwordx4 v9, s[8:11], s37 offen lds
s_add_u32 m0, s40, 43008
s_add_u32 s43, s38, 0
buffer_load_dwordx4 v2, s[12:15], s43 offen lds
s_add_u32 m0, s40, 44032
s_add_u32 s43, s38, 49152
buffer_load_dwordx4 v3, s[12:15], s43 offen lds
s_add_u32 m0, s40, 45056
s_add_u32 s43, s38, 98304
buffer_load_dwordx4 v2, s[12:15], s43 offen lds
s_add_u32 m0, s40, 46080
s_add_u32 s43, s38, 147456
buffer_load_dwordx4 v3, s[12:15], s43 offen lds
s_add_u32 m0, s40, 47104
s_add_u32 s43, s38, 196608
buffer_load_dwordx4 v2, s[12:15], s43 offen lds
s_add_u32 m0, s40, 48128
s_add_u32 s43, s38, 245760
buffer_load_dwordx4 v3, s[12:15], s43 offen lds
s_add_u32 m0, s40, 49152
s_add_u32 s43, s38, 294912
buffer_load_dwordx4 v2, s[12:15], s43 offen lds
s_add_u32 m0, s40, 50176
s_add_u32 s43, s38, 344064
buffer_load_dwordx4 v3, s[12:15], s43 offen lds
s_add_u32 s37, s37, 128
s_add_u32 s38, s38, 393216
s_waitcnt vmcnt(14)
s_barrier
s_add_u32 m0, s39, 86016
s_mov_b64 exec, s[60:61]
buffer_load_dwordx4 v4, s[8:11], s37 offen lds
s_mov_b64 exec, -1
s_add_u32 m0, s39, 89088
s_nop 0
buffer_load_dwordx4 v5, s[8:11], s37 offen lds
s_add_u32 m0, s39, 92160
s_nop 0
buffer_load_dwordx4 v6, s[8:11], s37 offen lds
s_add_u32 m0, s39, 95232
s_nop 0
buffer_load_dwordx4 v7, s[8:11], s37 offen lds
s_add_u32 m0, s39, 98304
s_nop 0
buffer_load_dwordx4 v8, s[8:11], s37 offen lds
s_add_u32 m0, s39, 101376
s_nop 0
buffer_load_dwordx4 v9, s[8:11], s37 offen lds
s_add_u32 m0, s40, 86016
s_add_u32 s43, s38, 0
buffer_load_dwordx4 v2, s[12:15], s43 offen lds
s_add_u32 m0, s40, 87040
s_add_u32 s43, s38, 49152
buffer_load_dwordx4 v3, s[12:15], s43 offen lds
s_add_u32 m0, s40, 88064
s_add_u32 s43, s38, 98304
buffer_load_dwordx4 v2, s[12:15], s43 offen lds
s_add_u32 m0, s40, 89088
s_add_u32 s43, s38, 147456
buffer_load_dwordx4 v3, s[12:15], s43 offen lds
s_add_u32 m0, s40, 90112
s_add_u32 s43, s38, 196608
buffer_load_dwordx4 v2, s[12:15], s43 offen lds
s_add_u32 m0, s40, 91136
s_add_u32 s43, s38, 245760
buffer_load_dwordx4 v3, s[12:15], s43 offen lds
s_add_u32 m0, s40, 92160
s_add_u32 s43, s38, 294912
buffer_load_dwordx4 v2, s[12:15], s43 offen lds
s_add_u32 m0, s40, 93184
s_add_u32 s43, s38, 344064
buffer_load_dwordx4 v3, s[12:15], s43 offen lds
s_add_u32 s37, s37, 128
s_add_u32 s38, s38, 393216
s_lshl_b32 s43, s51, 11
buffer_load_dwordx4 v[96:99], v10, s[8:11], s43 offen offset:0
buffer_load_dwordx4 v[100:103], v10, s[8:11], s43 offen offset:1024
buffer_load_dwordx4 v[104:107], v10, s[8:11], s43 offen offset:2048
buffer_load_dwordx4 v[108:111], v10, s[8:11], s43 offen offset:3072
s_lshr_b32 s43, s2, 5
s_cmp_eq_u32 s43, 3
s_cbranch_scc1 Lsj_11
s_cmp_gt_u32 s43, 3
s_cselect_b32 s43, 32, 0
s_sub_u32 s43, s2, s43
s_lshr_b32 s43, s43, 1
s_and_b32 s44, s2, 1
s_lshl_b32 s44, s44, 3
s_add_u32 s44, s44, 32
s_load_dwordx2 s[80:81], s[0:1], s44
s_mul_i32 s45, s43, 2341
s_lshr_b32 s45, s45, 16
s_mul_i32 s46, s45, 28
s_sub_u32 s46, s43, s46
s_lshl_b32 s45, s45, 8
s_mul_i32 s44, s47, 18
s_add_u32 s45, s45, s44
s_add_u32 s45, s45, 184
s_mul_i32 s45, s45, 7168
s_lshl_b32 s46, s46, 8
s_add_u32 s45, s45, s46
s_waitcnt lgkmcnt(0)
s_add_u32 s80, s80, s45
s_addc_u32 s81, s81, 0
Lsj_11:
s_waitcnt vmcnt(18)
s_barrier
s_add_u32 m0, s39, 0
s_mov_b64 exec, s[60:61]
buffer_load_dwordx4 v4, s[8:11], s37 offen lds
s_mov_b64 exec, -1
s_add_u32 m0, s39, 3072
s_nop 0
buffer_load_dwordx4 v5, s[8:11], s37 offen lds
s_add_u32 m0, s39, 6144
s_nop 0
buffer_load_dwordx4 v6, s[8:11], s37 offen lds
s_add_u32 m0, s39, 9216
s_nop 0
buffer_load_dwordx4 v7, s[8:11], s37 offen lds
s_add_u32 m0, s39, 12288
s_nop 0
buffer_load_dwordx4 v8, s[8:11], s37 offen lds
s_add_u32 m0, s39, 15360
s_nop 0
buffer_load_dwordx4 v9, s[8:11], s37 offen lds
s_add_u32 m0, s40, 0
s_add_u32 s43, s38, 0
buffer_load_dwordx4 v2, s[12:15], s43 offen lds
s_add_u32 m0, s40, 1024
s_add_u32 s43, s38, 49152
buffer_load_dwordx4 v3, s[12:15], s43 offen lds
s_add_u32 m0, s40, 2048
s_add_u32 s43, s38, 98304
buffer_load_dwordx4 v2, s[12:15], s43 offen lds
s_add_u32 m0, s40, 3072
s_add_u32 s43, s38, 147456
buffer_load_dwordx4 v3, s[12:15], s43 offen lds
s_add_u32 m0, s40, 4096
s_add_u32 s43, s38, 196608
buffer_load_dwordx4 v2, s[12:15], s43 offen lds
s_add_u32 m0, s40, 5120
s_add_u32 s43, s38, 245760
buffer_load_dwordx4 v3, s[12:15], s43 offen lds
s_add_u32 m0, s40, 6144
s_add_u32 s43, s38, 294912
buffer_load_dwordx4 v2, s[12:15], s43 offen lds
s_add_u32 m0, s40, 7168
s_add_u32 s43, s38, 344064
buffer_load_dwordx4 v3, s[12:15], s43 offen lds
s_add_u32 s37, s37, 128
s_add_u32 s38, s38, 393216
s_waitcnt vmcnt(14)
s_barrier
s_add_u32 m0, s39, 43008
s_mov_b64 exec, s[60:61]
buffer_load_dwordx4 v4, s[8:11], s37 offen lds
s_mov_b64 exec, -1
s_add_u32 m0, s39, 46080
s_nop 0
buffer_load_dwordx4 v5, s[8:11], s37 offen lds
s_add_u32 m0, s39, 49152
s_nop 0
buffer_load_dwordx4 v6, s[8:11], s37 offen lds
s_add_u32 m0, s39, 52224
s_nop 0
buffer_load_dwordx4 v7, s[8:11], s37 offen lds
s_add_u32 m0, s39, 55296
s_nop 0
buffer_load_dwordx4 v8, s[8:11], s37 offen lds
s_add_u32 m0, s39, 58368
s_nop 0
buffer_load_dwordx4 v9, s[8:11], s37 offen lds
s_add_u32 m0, s40, 43008
s_add_u32 s43, s38, 0
buffer_load_dwordx4 v2, s[12:15], s43 offen lds
s_add_u32 m0, s40, 44032
s_add_u32 s43, s38, 49152
buffer_load_dwordx4 v3, s[12:15], s43 offen lds
s_add_u32 m0, s40, 45056
s_add_u32 s43, s38, 98304
buffer_load_dwordx4 v2, s[12:15], s43 offen lds
s_add_u32 m0, s40, 46080
s_add_u32 s43, s38, 147456
buffer_load_dwordx4 v3, s[12:15], s43 offen lds
s_add_u32 m0, s40, 47104
s_add_u32 s43, s38, 196608
buffer_load_dwordx4 v2, s[12:15], s43 offen lds
s_add_u32 m0, s40, 48128
s_add_u32 s43, s38, 245760
buffer_load_dwordx4 v3, s[12:15], s43 offen lds
s_add_u32 m0, s40, 49152
s_add_u32 s43, s38, 294912
buffer_load_dwordx4 v2, s[12:15], s43 offen lds
s_add_u32 m0, s40, 50176
s_add_u32 s43, s38, 344064
buffer_load_dwordx4 v3, s[12:15], s43 offen lds
s_add_u32 s37, s37, 128
s_add_u32 s38, s38, 393216
v_lshlrev_b32 v116, 16, v96
v_and_b32 v117, 0xffff0000, v96
v_mul_f32 v118, v116, v116
v_mul_f32 v119, v117, v117
v_lshlrev_b32 v126, 16, v97
v_and_b32 v127, 0xffff0000, v97
v_add_f32 v116, v116, v126
v_add_f32 v117, v117, v127
v_fmac_f32 v118, v126, v126
v_fmac_f32 v119, v127, v127
v_lshlrev_b32 v124, 16, v98
v_and_b32 v125, 0xffff0000, v98
v_add_f32 v116, v116, v124
v_add_f32 v117, v117, v125
v_fmac_f32 v118, v124, v124
v_fmac_f32 v119, v125, v125
v_lshlrev_b32 v126, 16, v99
v_and_b32 v127, 0xffff0000, v99
v_add_f32 v116, v116, v126
v_add_f32 v117, v117, v127
v_fmac_f32 v118, v126, v126
v_fmac_f32 v119, v127, v127
v_lshlrev_b32 v124, 16, v100
v_and_b32 v125, 0xffff0000, v100
v_add_f32 v116, v116, v124
v_add_f32 v117, v117, v125
v_fmac_f32 v118, v124, v124
v_fmac_f32 v119, v125, v125
v_lshlrev_b32 v126, 16, v101
v_and_b32 v127, 0xffff0000, v101
v_add_f32 v116, v116, v126
v_add_f32 v117, v117, v127
v_fmac_f32 v118, v126, v126
v_fmac_f32 v119, v127, v127
v_lshlrev_b32 v124, 16, v102
v_and_b32 v125, 0xffff0000, v102
v_add_f32 v116, v116, v124
v_add_f32 v117, v117, v125
v_fmac_f32 v118, v124, v124
v_fmac_f32 v119, v125, v125
v_lshlrev_b32 v126, 16, v103
v_and_b32 v127, 0xffff0000, v103
v_add_f32 v116, v116, v126
v_add_f32 v117, v117, v127
v_fmac_f32 v118, v126, v126
v_fmac_f32 v119, v127, v127
v_lshlrev_b32 v120, 16, v104
v_and_b32 v121, 0xffff0000, v104
v_mul_f32 v122, v120, v120
v_mul_f32 v123, v121, v121
s_waitcnt vmcnt(14)
s_barrier
s_add_u32 m0, s39, 86016
s_mov_b64 exec, s[60:61]
buffer_load_dwordx4 v4, s[8:11], s37 offen lds
s_mov_b64 exec, -1
s_add_u32 m0, s39, 89088
s_nop 0
buffer_load_dwordx4 v5, s[8:11], s37 offen lds
s_add_u32 m0, s39, 92160
s_nop 0
buffer_load_dwordx4 v6, s[8:11], s37 offen lds
s_add_u32 m0, s39, 95232
s_nop 0
buffer_load_dwordx4 v7, s[8:11], s37 offen lds
s_add_u32 m0, s39, 98304
s_nop 0
buffer_load_dwordx4 v8, s[8:11], s37 offen lds
s_add_u32 m0, s39, 101376
s_nop 0
buffer_load_dwordx4 v9, s[8:11], s37 offen lds
s_add_u32 m0, s40, 86016
s_add_u32 s43, s38, 0
buffer_load_dwordx4 v2, s[12:15], s43 offen lds
s_add_u32 m0, s40, 87040
s_add_u32 s43, s38, 49152
buffer_load_dwordx4 v3, s[12:15], s43 offen lds
s_add_u32 m0, s40, 88064
s_add_u32 s43, s38, 98304
buffer_load_dwordx4 v2, s[12:15], s43 offen lds
s_add_u32 m0, s40, 89088
s_add_u32 s43, s38, 147456
buffer_load_dwordx4 v3, s[12:15], s43 offen lds
s_add_u32 m0, s40, 90112
s_add_u32 s43, s38, 196608
buffer_load_dwordx4 v2, s[12:15], s43 offen lds
s_add_u32 m0, s40, 91136
s_add_u32 s43, s38, 245760
buffer_load_dwordx4 v3, s[12:15], s43 offen lds
s_add_u32 m0, s40, 92160
s_add_u32 s43, s38, 294912
buffer_load_dwordx4 v2, s[12:15], s43 offen lds
s_add_u32 m0, s40, 93184
s_add_u32 s43, s38, 344064
buffer_load_dwordx4 v3, s[12:15], s43 offen lds
s_add_u32 s37, s37, 128
s_add_u32 s38, s38, 393216
v_lshlrev_b32 v126, 16, v105
v_and_b32 v127, 0xffff0000, v105
v_add_f32 v120, v120, v126
v_add_f32 v121, v121, v127
v_fmac_f32 v122, v126, v126
v_fmac_f32 v123, v127, v127
v_lshlrev_b32 v124, 16, v106
v_and_b32 v125, 0xffff0000, v106
v_add_f32 v120, v120, v124
v_add_f32 v121, v121, v125
v_fmac_f32 v122, v124, v124
v_fmac_f32 v123, v125, v125
v_lshlrev_b32 v126, 16, v107
v_and_b32 v127, 0xffff0000, v107
v_add_f32 v120, v120, v126
v_add_f32 v121, v121, v127
v_fmac_f32 v122, v126, v126
v_fmac_f32 v123, v127, v127
v_lshlrev_b32 v124, 16, v108
v_and_b32 v125, 0xffff0000, v108
v_add_f32 v120, v120, v124
v_add_f32 v121, v121, v125
v_fmac_f32 v122, v124, v124
v_fmac_f32 v123, v125, v125
v_lshlrev_b32 v126, 16, v109
v_and_b32 v127, 0xffff0000, v109
v_add_f32 v120, v120, v126
v_add_f32 v121, v121, v127
v_fmac_f32 v122, v126, v126
v_fmac_f32 v123, v127, v127
v_lshlrev_b32 v124, 16, v110
v_and_b32 v125, 0xffff0000, v110
v_add_f32 v120, v120, v124
v_add_f32 v121, v121, v125
v_fmac_f32 v122, v124, v124
v_fmac_f32 v123, v125, v125
v_lshlrev_b32 v126, 16, v111
v_and_b32 v127, 0xffff0000, v111
v_add_f32 v120, v120, v126
v_add_f32 v121, v121, v127
v_fmac_f32 v122, v126, v126
v_fmac_f32 v123, v127, v127
v_add_f32 v116, v116, v117
v_add_f32 v118, v118, v119
v_add_f32 v120, v120, v121
v_add_f32 v122, v122, v123
v_add_f32_dpp v116, v116, v116 row_ror:8 row_mask:0xf bank_mask:0xf
v_add_f32_dpp v118, v118, v118 row_ror:8 row_mask:0xf bank_mask:0xf
v_add_f32_dpp v120, v120, v120 row_ror:8 row_mask:0xf bank_mask:0xf
v_add_f32_dpp v122, v122, v122 row_ror:8 row_mask:0xf bank_mask:0xf
s_waitcnt vmcnt(14)
s_barrier
s_add_u32 m0, s39, 0
s_mov_b64 exec, s[60:61]
buffer_load_dwordx4 v4, s[8:11], s37 offen lds
s_mov_b64 exec, -1
s_add_u32 m0, s39, 3072
s_nop 0
buffer_load_dwordx4 v5, s[8:11], s37 offen lds
s_add_u32 m0, s39, 6144
s_nop 0
buffer_load_dwordx4 v6, s[8:11], s37 offen lds
s_add_u32 m0, s39, 9216
s_nop 0
buffer_load_dwordx4 v7, s[8:11], s37 offen lds
s_add_u32 m0, s39, 12288
s_nop 0
buffer_load_dwordx4 v8, s[8:11], s37 offen lds
s_add_u32 m0, s39, 15360
s_nop 0
buffer_load_dwordx4 v9, s[8:11], s37 offen lds
s_add_u32 m0, s40, 0
s_add_u32 s43, s38, 0
buffer_load_dwordx4 v2, s[12:15], s43 offen lds
s_add_u32 m0, s40, 1024
s_add_u32 s43, s38, 49152
buffer_load_dwordx4 v3, s[12:15], s43 offen lds
s_add_u32 m0, s40, 2048
s_add_u32 s43, s38, 98304
buffer_load_dwordx4 v2, s[12:15], s43 offen lds
s_add_u32 m0, s40, 3072
s_add_u32 s43, s38, 147456
buffer_load_dwordx4 v3, s[12:15], s43 offen lds
s_add_u32 m0, s40, 4096
s_add_u32 s43, s38, 196608
buffer_load_dwordx4 v2, s[12:15], s43 offen lds
s_add_u32 m0, s40, 5120
s_add_u32 s43, s38, 245760
buffer_load_dwordx4 v3, s[12:15], s43 offen lds
s_add_u32 m0, s40, 6144
s_add_u32 s43, s38, 294912
buffer_load_dwordx4 v2, s[12:15], s43 offen lds
s_add_u32 m0, s40, 7168
s_add_u32 s43, s38, 344064
buffer_load_dwordx4 v3, s[12:15], s43 offen lds
s_add_u32 s37, s37, 128
s_add_u32 s38, s38, 393216
v_add_f32_dpp v116, v116, v116 row_ror:4 row_mask:0xf bank_mask:0xf
v_add_f32_dpp v118, v118, v118 row_ror:4 row_mask:0xf bank_mask:0xf
v_add_f32_dpp v120, v120, v120 row_ror:4 row_mask:0xf bank_mask:0xf
v_add_f32_dpp v122, v122, v122 row_ror:4 row_mask:0xf bank_mask:0xf
v_add_f32_dpp v116, v116, v116 row_ror:2 row_mask:0xf bank_mask:0xf
v_add_f32_dpp v118, v118, v118 row_ror:2 row_mask:0xf bank_mask:0xf
v_add_f32_dpp v120, v120, v120 row_ror:2 row_mask:0xf bank_mask:0xf
v_add_f32_dpp v122, v122, v122 row_ror:2 row_mask:0xf bank_mask:0xf
v_add_f32_dpp v116, v116, v116 row_ror:1 row_mask:0xf bank_mask:0xf
v_add_f32_dpp v118, v118, v118 row_ror:1 row_mask:0xf bank_mask:0xf
v_add_f32_dpp v120, v120, v120 row_ror:1 row_mask:0xf bank_mask:0xf
v_add_f32_dpp v122, v122, v122 row_ror:1 row_mask:0xf bank_mask:0xf
v_mov_b32 v117, v116
v_mov_b32 v119, v118
v_mov_b32 v121, v120
v_mov_b32 v123, v122
s_nop 0
v_permlane16_swap_b32 v116, v117
v_permlane16_swap_b32 v118, v119
v_permlane16_swap_b32 v120, v121
v_permlane16_swap_b32 v122, v123
v_add_f32 v116, v116, v117
v_add_f32 v118, v118, v119
v_add_f32 v120, v120, v121
v_add_f32 v122, v122, v123
v_mov_b32 v117, v116
v_mov_b32 v119, v118
v_mov_b32 v121, v120
v_mov_b32 v123, v122
s_nop 0
v_permlane32_swap_b32 v116, v117
v_permlane32_swap_b32 v118, v119
v_permlane32_swap_b32 v120, v121
v_permlane32_swap_b32 v122, v123
v_add_f32 v116, v116, v117
v_add_f32 v118, v118, v119
v_add_f32 v120, v120, v121
v_add_f32 v122, v122, v123
v_mul_f32 v112, 0x3a800000, v116
v_mul_f32 v113, 0x3a800000, v118
v_fma_f32 v113, -v112, v112, v113
v_max_f32 v113, 0, v113
v_add_f32 v113, 0x3727c5ac, v113
v_rsq_f32 v113, v113
v_mul_f32 v114, 0x3a800000, v120
v_mul_f32 v115, 0x3a800000, v122
v_fma_f32 v115, -v114, v114, v115
v_max_f32 v115, 0, v115
v_add_f32 v115, 0x3727c5ac, v115
v_rsq_f32 v115, v115
s_nop 0
s_lshl_b32 s43, s47, 4
s_add_u32 s43, s43, 130176
v_mov_b32 v11, s43
ds_write_b128 v11, v[112:115]
s_waitcnt lgkmcnt(0)
s_load_dword s64, s[80:81], 0
s_load_dword s65, s[80:81], 64
s_load_dword s66, s[80:81], 128
s_load_dword s67, s[80:81], 192
s_load_dword s68, s[80:81], 7168
s_load_dword s69, s[80:81], 7232
s_load_dword s70, s[80:81], 7296
s_load_dword s71, s[80:81], 7360
s_add_u32 s80, s80, 14336
s_addc_u32 s81, s81, 0
s_waitcnt vmcnt(14)
s_barrier
s_add_u32 m0, s39, 43008
s_mov_b64 exec, s[60:61]
buffer_load_dwordx4 v4, s[8:11], s37 offen lds
s_mov_b64 exec, -1
s_add_u32 m0, s39, 46080
s_nop 0
buffer_load_dwordx4 v5, s[8:11], s37 offen lds
s_add_u32 m0, s39, 49152
s_nop 0
buffer_load_dwordx4 v6, s[8:11], s37 offen lds
s_add_u32 m0, s39, 52224
s_nop 0
buffer_load_dwordx4 v7, s[8:11], s37 offen lds
s_add_u32 m0, s39, 55296
s_nop 0
buffer_load_dwordx4 v8, s[8:11], s37 offen lds
s_add_u32 m0, s39, 58368
s_nop 0
buffer_load_dwordx4 v9, s[8:11], s37 offen lds
s_add_u32 m0, s40, 43008
s_add_u32 s43, s38, 0
buffer_load_dwordx4 v2, s[12:15], s43 offen lds
s_add_u32 m0, s40, 44032
s_add_u32 s43, s38, 49152
buffer_load_dwordx4 v3, s[12:15], s43 offen lds
s_add_u32 m0, s40, 45056
s_add_u32 s43, s38, 98304
buffer_load_dwordx4 v2, s[12:15], s43 offen lds
s_add_u32 m0, s40, 46080
s_add_u32 s43, s38, 147456
buffer_load_dwordx4 v3, s[12:15], s43 offen lds
s_add_u32 m0, s40, 47104
s_add_u32 s43, s38, 196608
buffer_load_dwordx4 v2, s[12:15], s43 offen lds
s_add_u32 m0, s40, 48128
s_add_u32 s43, s38, 245760
buffer_load_dwordx4 v3, s[12:15], s43 offen lds
s_add_u32 m0, s40, 49152
s_add_u32 s43, s38, 294912
buffer_load_dwordx4 v2, s[12:15], s43 offen lds
s_add_u32 m0, s40, 50176
s_add_u32 s43, s38, 344064
buffer_load_dwordx4 v3, s[12:15], s43 offen lds
s_add_u32 s37, s37, 128
s_add_u32 s38, s38, 393216
s_load_dword s64, s[80:81], 0
s_load_dword s65, s[80:81], 64
s_load_dword s66, s[80:81], 128
s_load_dword s67, s[80:81], 192
s_load_dword s68, s[80:81], 7168
s_load_dword s69, s[80:81], 7232
s_load_dword s70, s[80:81], 7296
s_load_dword s71, s[80:81], 7360
s_add_u32 s80, s80, 14336
s_addc_u32 s81, s81, 0
s_waitcnt vmcnt(14)
s_barrier
s_add_u32 m0, s39, 86016
s_mov_b64 exec, s[60:61]
buffer_load_dwordx4 v4, s[8:11], s37 offen lds
s_mov_b64 exec, -1
s_add_u32 m0, s39, 89088
s_nop 0
buffer_load_dwordx4 v5, s[8:11], s37 offen lds
s_add_u32 m0, s39, 92160
s_nop 0
buffer_load_dwordx4 v6, s[8:11], s37 offen lds
s_add_u32 m0, s39, 95232
s_nop 0
buffer_load_dwordx4 v7, s[8:11], s37 offen lds
s_add_u32 m0, s39, 98304
s_nop 0
buffer_load_dwordx4 v8, s[8:11], s37 offen lds
s_add_u32 m0, s39, 101376
s_nop 0
buffer_load_dwordx4 v9, s[8:11], s37 offen lds
s_add_u32 m0, s40, 86016
s_add_u32 s43, s38, 0
buffer_load_dwordx4 v2, s[12:15], s43 offen lds
s_add_u32 m0, s40, 87040
s_add_u32 s43, s38, 49152
buffer_load_dwordx4 v3, s[12:15], s43 offen lds
s_add_u32 m0, s40, 88064
s_add_u32 s43, s38, 98304
buffer_load_dwordx4 v2, s[12:15], s43 offen lds
s_add_u32 m0, s40, 89088
s_add_u32 s43, s38, 147456
buffer_load_dwordx4 v3, s[12:15], s43 offen lds
s_add_u32 m0, s40, 90112
s_add_u32 s43, s38, 196608
buffer_load_dwordx4 v2, s[12:15], s43 offen lds
s_add_u32 m0, s40, 91136
s_add_u32 s43, s38, 245760
buffer_load_dwordx4 v3, s[12:15], s43 offen lds
s_add_u32 m0, s40, 92160
s_add_u32 s43, s38, 294912
buffer_load_dwordx4 v2, s[12:15], s43 offen lds
s_add_u32 m0, s40, 93184
s_add_u32 s43, s38, 344064
buffer_load_dwordx4 v3, s[12:15], s43 offen lds
s_add_u32 s37, s37, 128
s_add_u32 s38, s38, 393216
s_add_u32 s24, s16, 4194304
s_addc_u32 s25, s17, 0
s_mov_b32 s26, 16384
s_mov_b32 s27, 0x20000
v_mov_b32 v128, -1
v_mov_b32 v129, -1
v_mov_b32 v130, -1
v_mov_b32 v131, -1
s_mul_i32 s28, s47, 5120
buffer_store_dwordx4 v[128:131], v10, s[24:27], s28 offen sc1
s_add_u32 s28, s28, 1024
s_load_dword s64, s[80:81], 0
s_load_dword s65, s[80:81], 64
s_load_dword s66, s[80:81], 128
s_load_dword s67, s[80:81], 192
s_load_dword s68, s[80:81], 7168
s_load_dword s69, s[80:81], 7232
s_load_dword s70, s[80:81], 7296
s_load_dword s71, s[80:81], 7360
s_add_u32 s80, s80, 14336
s_addc_u32 s81, s81, 0
s_waitcnt vmcnt(15)
s_barrier
s_add_u32 m0, s39, 0
s_mov_b64 exec, s[60:61]
buffer_load_dwordx4 v4, s[8:11], s37 offen lds
s_mov_b64 exec, -1
s_add_u32 m0, s39, 3072
s_nop 0
buffer_load_dwordx4 v5, s[8:11], s37 offen lds
s_add_u32 m0, s39, 6144
s_nop 0
buffer_load_dwordx4 v6, s[8:11], s37 offen lds
s_add_u32 m0, s39, 9216
s_nop 0
buffer_load_dwordx4 v7, s[8:11], s37 offen lds
s_add_u32 m0, s39, 12288
s_nop 0
buffer_load_dwordx4 v8, s[8:11], s37 offen lds
s_add_u32 m0, s39, 15360
s_nop 0
buffer_load_dwordx4 v9, s[8:11], s37 offen lds
s_add_u32 m0, s40, 0
s_add_u32 s43, s38, 0
buffer_load_dwordx4 v2, s[12:15], s43 offen lds
s_add_u32 m0, s40, 1024
s_add_u32 s43, s38, 49152
buffer_load_dwordx4 v3, s[12:15], s43 offen lds
s_add_u32 m0, s40, 2048
s_add_u32 s43, s38, 98304
buffer_load_dwordx4 v2, s[12:15], s43 offen lds
s_add_u32 m0, s40, 3072
s_add_u32 s43, s38, 147456
buffer_load_dwordx4 v3, s[12:15], s43 offen lds
s_add_u32 m0, s40, 4096
s_add_u32 s43, s38, 196608
buffer_load_dwordx4 v2, s[12:15], s43 offen lds
s_add_u32 m0, s40, 5120
s_add_u32 s43, s38, 245760
buffer_load_dwordx4 v3, s[12:15], s43 offen lds
s_add_u32 m0, s40, 6144
s_add_u32 s43, s38, 294912
buffer_load_dwordx4 v2, s[12:15], s43 offen lds
s_add_u32 m0, s40, 7168
s_add_u32 s43, s38, 344064
buffer_load_dwordx4 v3, s[12:15], s43 offen lds
s_add_u32 s37, s37, 128
s_add_u32 s38, s38, 393216
buffer_store_dwordx4 v[128:131], v10, s[24:27], s28 offen sc1
s_add_u32 s28, s28, 1024
s_load_dword s64, s[80:81], 0
s_load_dword s65, s[80:81], 64
s_load_dword s66, s[80:81], 128
s_load_dword s67, s[80:81], 192
s_load_dword s68, s[80:81], 7168
s_load_dword s69, s[80:81], 7232
s_load_dword s70, s[80:81], 7296
s_load_dword s71, s[80:81], 7360
s_add_u32 s80, s80, 14336
s_addc_u32 s81, s81, 0
s_waitcnt vmcnt(16)
s_barrier
s_add_u32 m0, s39, 43008
s_mov_b64 exec, s[60:61]
buffer_load_dwordx4 v4, s[8:11], s37 offen lds
s_mov_b64 exec, -1
s_add_u32 m0, s39, 46080
s_nop 0
buffer_load_dwordx4 v5, s[8:11], s37 offen lds
s_add_u32 m0, s39, 49152
s_nop 0
buffer_load_dwordx4 v6, s[8:11], s37 offen lds
s_add_u32 m0, s39, 52224
s_nop 0
buffer_load_dwordx4 v7, s[8:11], s37 offen lds
s_add_u32 m0, s39, 55296
s_nop 0
buffer_load_dwordx4 v8, s[8:11], s37 offen lds
s_add_u32 m0, s39, 58368
s_nop 0
buffer_load_dwordx4 v9, s[8:11], s37 offen lds
s_add_u32 m0, s40, 43008
s_add_u32 s43, s38, 0
buffer_load_dwordx4 v2, s[12:15], s43 offen lds
s_add_u32 m0, s40, 44032
s_add_u32 s43, s38, 49152
buffer_load_dwordx4 v3, s[12:15], s43 offen lds
s_add_u32 m0, s40, 45056
s_add_u32 s43, s38, 98304
buffer_load_dwordx4 v2, s[12:15], s43 offen lds
s_add_u32 m0, s40, 46080
s_add_u32 s43, s38, 147456
buffer_load_dwordx4 v3, s[12:15], s43 offen lds
s_add_u32 m0, s40, 47104
s_add_u32 s43, s38, 196608
buffer_load_dwordx4 v2, s[12:15], s43 offen lds
s_add_u32 m0, s40, 48128
s_add_u32 s43, s38, 245760
buffer_load_dwordx4 v3, s[12:15], s43 offen lds
s_add_u32 m0, s40, 49152
s_add_u32 s43, s38, 294912
buffer_load_dwordx4 v2, s[12:15], s43 offen lds
s_add_u32 m0, s40, 50176
s_add_u32 s43, s38, 344064
buffer_load_dwordx4 v3, s[12:15], s43 offen lds
s_add_u32 s37, s37, 128
s_add_u32 s38, s38, 393216
buffer_store_dwordx4 v[128:131], v10, s[24:27], s28 offen sc1
s_add_u32 s28, s28, 1024
s_load_dword s64, s[80:81], 0
s_load_dword s65, s[80:81], 64
s_load_dword s66, s[80:81], 128
s_load_dword s67, s[80:81], 192
s_load_dword s68, s[80:81], 7168
s_load_dword s69, s[80:81], 7232
s_load_dword s70, s[80:81], 7296
s_load_dword s71, s[80:81], 7360
s_add_u32 s80, s80, 14336
s_addc_u32 s81, s81, 0
s_waitcnt vmcnt(16)
s_barrier
s_add_u32 m0, s39, 86016
s_mov_b64 exec, s[60:61]
buffer_load_dwordx4 v4, s[8:11], s37 offen lds
s_mov_b64 exec, -1
s_add_u32 m0, s39, 89088
s_nop 0
buffer_load_dwordx4 v5, s[8:11], s37 offen lds
s_add_u32 m0, s39, 92160
s_nop 0
buffer_load_dwordx4 v6, s[8:11], s37 offen lds
s_add_u32 m0, s39, 95232
s_nop 0
buffer_load_dwordx4 v7, s[8:11], s37 offen lds
s_add_u32 m0, s39, 98304
s_nop 0
buffer_load_dwordx4 v8, s[8:11], s37 offen lds
s_add_u32 m0, s39, 101376
s_nop 0
buffer_load_dwordx4 v9, s[8:11], s37 offen lds
s_add_u32 m0, s40, 86016
s_add_u32 s43, s38, 0
buffer_load_dwordx4 v2, s[12:15], s43 offen lds
s_add_u32 m0, s40, 87040
s_add_u32 s43, s38, 49152
buffer_load_dwordx4 v3, s[12:15], s43 offen lds
s_add_u32 m0, s40, 88064
s_add_u32 s43, s38, 98304
buffer_load_dwordx4 v2, s[12:15], s43 offen lds
s_add_u32 m0, s40, 89088
s_add_u32 s43, s38, 147456
buffer_load_dwordx4 v3, s[12:15], s43 offen lds
s_add_u32 m0, s40, 90112
s_add_u32 s43, s38, 196608
buffer_load_dwordx4 v2, s[12:15], s43 offen lds
s_add_u32 m0, s40, 91136
s_add_u32 s43, s38, 245760
buffer_load_dwordx4 v3, s[12:15], s43 offen lds
s_add_u32 m0, s40, 92160
s_add_u32 s43, s38, 294912
buffer_load_dwordx4 v2, s[12:15], s43 offen lds
s_add_u32 m0, s40, 93184
s_add_u32 s43, s38, 344064
buffer_load_dwordx4 v3, s[12:15], s43 offen lds
s_add_u32 s37, s37, 128
s_add_u32 s38, s38, 393216
buffer_store_dwordx4 v[128:131], v10, s[24:27], s28 offen sc1
s_add_u32 s28, s28, 1024
s_load_dword s64, s[80:81], 0
s_load_dword s65, s[80:81], 64
s_load_dword s66, s[80:81], 128
s_load_dword s67, s[80:81], 192
s_load_dword s68, s[80:81], 7168
s_load_dword s69, s[80:81], 7232
s_load_dword s70, s[80:81], 7296
s_load_dword s71, s[80:81], 7360
s_add_u32 s80, s80, 14336
s_addc_u32 s81, s81, 0
s_waitcnt vmcnt(16)
s_barrier
s_add_u32 m0, s39, 0
s_mov_b64 exec, s[60:61]
buffer_load_dwordx4 v4, s[8:11], s37 offen lds
s_mov_b64 exec, -1
s_add_u32 m0, s39, 3072
s_nop 0
buffer_load_dwordx4 v5, s[8:11], s37 offen lds
s_add_u32 m0, s39, 6144
s_nop 0
buffer_load_dwordx4 v6, s[8:11], s37 offen lds
s_add_u32 m0, s39, 9216
s_nop 0
buffer_load_dwordx4 v7, s[8:11], s37 offen lds
s_add_u32 m0, s39, 12288
s_nop 0
buffer_load_dwordx4 v8, s[8:11], s37 offen lds
s_add_u32 m0, s39, 15360
s_nop 0
buffer_load_dwordx4 v9, s[8:11], s37 offen lds
s_add_u32 m0, s40, 0
s_add_u32 s43, s38, 0
buffer_load_dwordx4 v2, s[12:15], s43 offen lds
s_add_u32 m0, s40, 1024
s_add_u32 s43, s38, 49152
buffer_load_dwordx4 v3, s[12:15], s43 offen lds
s_add_u32 m0, s40, 2048
s_add_u32 s43, s38, 98304
buffer_load_dwordx4 v2, s[12:15], s43 offen lds
s_add_u32 m0, s40, 3072
s_add_u32 s43, s38, 147456
buffer_load_dwordx4 v3, s[12:15], s43 offen lds
s_add_u32 m0, s40, 4096
s_add_u32 s43, s38, 196608
buffer_load_dwordx4 v2, s[12:15], s43 offen lds
s_add_u32 m0, s40, 5120
s_add_u32 s43, s38, 245760
buffer_load_dwordx4 v3, s[12:15], s43 offen lds
s_add_u32 m0, s40, 6144
s_add_u32 s43, s38, 294912
buffer_load_dwordx4 v2, s[12:15], s43 offen lds
s_add_u32 m0, s40, 7168
s_add_u32 s43, s38, 344064
buffer_load_dwordx4 v3, s[12:15], s43 offen lds
s_add_u32 s37, s37, 128
s_add_u32 s38, s38, 393216
buffer_store_dwordx4 v[128:131], v10, s[24:27], s28 offen sc1
s_add_u32 s28, s28, 1024
s_load_dword s64, s[80:81], 0
s_load_dword s65, s[80:81], 64
s_load_dword s66, s[80:81], 128
s_load_dword s67, s[80:81], 192
s_load_dword s68, s[80:81], 7168
s_load_dword s69, s[80:81], 7232
s_load_dword s70, s[80:81], 7296
s_load_dword s71, s[80:81], 7360
s_add_u32 s80, s80, 14336
s_addc_u32 s81, s81, 0
s_waitcnt vmcnt(16)
s_barrier
s_add_u32 m0, s39, 43008
s_mov_b64 exec, s[60:61]
buffer_load_dwordx4 v4, s[8:11], s37 offen lds
s_mov_b64 exec, -1
s_add_u32 m0, s39, 46080
s_nop 0
buffer_load_dwordx4 v5, s[8:11], s37 offen lds
s_add_u32 m0, s39, 49152
s_nop 0
buffer_load_dwordx4 v6, s[8:11], s37 offen lds
s_add_u32 m0, s39, 52224
s_nop 0
buffer_load_dwordx4 v7, s[8:11], s37 offen lds
s_add_u32 m0, s39, 55296
s_nop 0
buffer_load_dwordx4 v8, s[8:11], s37 offen lds
s_add_u32 m0, s39, 58368
s_nop 0
buffer_load_dwordx4 v9, s[8:11], s37 offen lds
s_add_u32 m0, s40, 43008
s_add_u32 s43, s38, 0
buffer_load_dwordx4 v2, s[12:15], s43 offen lds
s_add_u32 m0, s40, 44032
s_add_u32 s43, s38, 49152
buffer_load_dwordx4 v3, s[12:15], s43 offen lds
s_add_u32 m0, s40, 45056
s_add_u32 s43, s38, 98304
buffer_load_dwordx4 v2, s[12:15], s43 offen lds
s_add_u32 m0, s40, 46080
s_add_u32 s43, s38, 147456
buffer_load_dwordx4 v3, s[12:15], s43 offen lds
s_add_u32 m0, s40, 47104
s_add_u32 s43, s38, 196608
buffer_load_dwordx4 v2, s[12:15], s43 offen lds
s_add_u32 m0, s40, 48128
s_add_u32 s43, s38, 245760
buffer_load_dwordx4 v3, s[12:15], s43 offen lds
s_add_u32 m0, s40, 49152
s_add_u32 s43, s38, 294912
buffer_load_dwordx4 v2, s[12:15], s43 offen lds
s_add_u32 m0, s40, 50176
s_add_u32 s43, s38, 344064
buffer_load_dwordx4 v3, s[12:15], s43 offen lds
s_add_u32 s37, s37, 128
s_add_u32 s38, s38, 393216
buffer_store_dwordx4 v[128:131], v10, s[24:27], s28 offen sc1
s_add_u32 s28, s28, 1024
s_load_dword s64, s[80:81], 0
s_load_dword s65, s[80:81], 64
s_load_dword s66, s[80:81], 128
s_load_dword s67, s[80:81], 192
s_load_dword s68, s[80:81], 7168
s_load_dword s69, s[80:81], 7232
s_load_dword s70, s[80:81], 7296
s_load_dword s71, s[80:81], 7360
s_add_u32 s80, s80, 14336
s_addc_u32 s81, s81, 0
s_waitcnt vmcnt(16)
s_barrier
s_add_u32 m0, s39, 86016
s_mov_b64 exec, s[60:61]
buffer_load_dwordx4 v4, s[8:11], s37 offen lds
s_mov_b64 exec, -1
s_add_u32 m0, s39, 89088
s_nop 0
buffer_load_dwordx4 v5, s[8:11], s37 offen lds
s_add_u32 m0, s39, 92160
s_nop 0
buffer_load_dwordx4 v6, s[8:11], s37 offen lds
s_add_u32 m0, s39, 95232
s_nop 0
buffer_load_dwordx4 v7, s[8:11], s37 offen lds
s_add_u32 m0, s39, 98304
s_nop 0
buffer_load_dwordx4 v8, s[8:11], s37 offen lds
s_add_u32 m0, s39, 101376
s_nop 0
buffer_load_dwordx4 v9, s[8:11], s37 offen lds
s_add_u32 m0, s40, 86016
s_add_u32 s43, s38, 0
buffer_load_dwordx4 v2, s[12:15], s43 offen lds
s_add_u32 m0, s40, 87040
s_add_u32 s43, s38, 49152
buffer_load_dwordx4 v3, s[12:15], s43 offen lds
s_add_u32 m0, s40, 88064
s_add_u32 s43, s38, 98304
buffer_load_dwordx4 v2, s[12:15], s43 offen lds
s_add_u32 m0, s40, 89088
s_add_u32 s43, s38, 147456
buffer_load_dwordx4 v3, s[12:15], s43 offen lds
s_add_u32 m0, s40, 90112
s_add_u32 s43, s38, 196608
buffer_load_dwordx4 v2, s[12:15], s43 offen lds
s_add_u32 m0, s40, 91136
s_add_u32 s43, s38, 245760
buffer_load_dwordx4 v3, s[12:15], s43 offen lds
s_add_u32 m0, s40, 92160
s_add_u32 s43, s38, 294912
buffer_load_dwordx4 v2, s[12:15], s43 offen lds
s_add_u32 m0, s40, 93184
s_add_u32 s43, s38, 344064
buffer_load_dwordx4 v3, s[12:15], s43 offen lds
s_add_u32 s37, s37, 128
s_add_u32 s38, s38, 393216
s_load_dword s64, s[80:81], 0
s_load_dword s65, s[80:81], 64
s_load_dword s66, s[80:81], 128
s_load_dword s67, s[80:81], 192
s_load_dword s68, s[80:81], 7168
s_load_dword s69, s[80:81], 7232
s_load_dword s70, s[80:81], 7296
s_load_dword s71, s[80:81], 7360
s_add_u32 s80, s80, 14336
s_addc_u32 s81, s81, 0
s_waitcnt vmcnt(15)
s_barrier
s_add_u32 m0, s39, 0
s_mov_b64 exec, s[60:61]
buffer_load_dwordx4 v4, s[8:11], s37 offen lds
s_mov_b64 exec, -1
s_add_u32 m0, s39, 3072
s_nop 0
buffer_load_dwordx4 v5, s[8:11], s37 offen lds
s_add_u32 m0, s39, 6144
s_nop 0
buffer_load_dwordx4 v6, s[8:11], s37 offen lds
s_add_u32 m0, s39, 9216
s_nop 0
buffer_load_dwordx4 v7, s[8:11], s37 offen lds
s_add_u32 m0, s39, 12288
s_nop 0
buffer_load_dwordx4 v8, s[8:11], s37 offen lds
s_add_u32 m0, s39, 15360
s_nop 0
buffer_load_dwordx4 v9, s[8:11], s37 offen lds
s_add_u32 m0, s40, 0
s_add_u32 s43, s38, 0
buffer_load_dwordx4 v2, s[12:15], s43 offen lds
s_add_u32 m0, s40, 1024
s_add_u32 s43, s38, 49152
buffer_load_dwordx4 v3, s[12:15], s43 offen lds
s_add_u32 m0, s40, 2048
s_add_u32 s43, s38, 98304
buffer_load_dwordx4 v2, s[12:15], s43 offen lds
s_add_u32 m0, s40, 3072
s_add_u32 s43, s38, 147456
buffer_load_dwordx4 v3, s[12:15], s43 offen lds
s_add_u32 m0, s40, 4096
s_add_u32 s43, s38, 196608
buffer_load_dwordx4 v2, s[12:15], s43 offen lds
s_add_u32 m0, s40, 5120
s_add_u32 s43, s38, 245760
buffer_load_dwordx4 v3, s[12:15], s43 offen lds
s_add_u32 m0, s40, 6144
s_add_u32 s43, s38, 294912
buffer_load_dwordx4 v2, s[12:15], s43 offen lds
s_add_u32 m0, s40, 7168
s_add_u32 s43, s38, 344064
buffer_load_dwordx4 v3, s[12:15], s43 offen lds
s_add_u32 s37, s37, 128
s_add_u32 s38, s38, 393216
s_waitcnt vmcnt(14)
s_barrier
s_waitcnt vmcnt(0)
s_barrier
s_barrier
s_cmp_eq_u32 s47, 0
s_cbranch_scc1 Lx_12
s_cmp_eq_u32 s47, 1
s_cbranch_scc1 Lx_13
s_branch Lw_15
Lr_16:
s_branch Lx_14
Lx_13:
s_branch Lw_17
Lr_18:
s_branch Lx_14
Lx_12:
s_branch Lw_19
Lr_20:
Lx_14:
s_waitcnt lgkmcnt(0)
s_and_b32 s43, s36, 1
s_lshr_b32 s44, s36, 1
s_and_b32 s44, s44, 1
s_lshr_b32 s45, s36, 2
v_lshlrev_b32 v14, 2, v13
v_sub_u32 v14, v12, v14
v_subrev_u32 v15, 0, v14
v_cmp_ge_u32 s[52:53], 7, v15
v_add_u32 v15, 16, v15
v_cmp_ge_u32 s[84:85], 7, v15
v_subrev_u32 v15, 1, v14
v_cmp_ge_u32 s[54:55], 7, v15
v_add_u32 v15, 16, v15
v_cmp_ge_u32 s[86:87], 7, v15
v_subrev_u32 v15, 2, v14
v_cmp_ge_u32 s[56:57], 7, v15
v_add_u32 v15, 16, v15
v_cmp_ge_u32 s[88:89], 7, v15
v_subrev_u32 v15, 3, v14
v_cmp_ge_u32 s[58:59], 7, v15
v_add_u32 v15, 16, v15
v_cmp_ge_u32 s[90:91], 7, v15
s_lshl_b32 s46, s45, 6
s_add_u32 s46, s46, s44
s_add_u32 s46, s46, 16
v_lshl_add_u32 v14, v12, 1, s46
s_lshl_b32 s47, s43, 6
v_lshl_add_u32 v15, v13, 4, s47
v_mul_u32_u24 v20, 400, v14
v_add_u32 v20, v20, v15
v_subrev_u32 v16, 32, v14
v_max_i32 v16, 0, v16
v_mul_u32_u24 v21, 400, v16
v_add_u32 v21, v21, v15
v_lshrrev_b32 v16, 2, v12
v_lshl_add_u32 v16, v13, 2, v16
v_lshl_add_u32 v16, v16, 1, s46
v_and_b32 v17, 3, v1
v_lshl_add_u32 v17, v17, 3, s47
v_mul_u32_u24 v22, 400, v16
v_add_u32 v22, v22, v17
v_subrev_u32 v16, 32, v16
v_max_i32 v16, 0, v16
v_mul_u32_u24 v23, 400, v16
v_add_u32 v23, v23, v17
s_lshl_b32 s60, s43, 13
s_lshl_b32 s61, s45, 10
s_add_u32 s60, s60, s61
s_lshl_b32 s61, s44, 8
s_add_u32 s60, s60, s61
v_lshlrev_b32 v27, 11, v13
v_lshl_add_u32 v27, v12, 4, v27
v_add_u32 v27, s60, v27
v_mov_b32 v28, 0xff800000
s_mov_b32 s61, 0x3e8293ee
s_nop 2
s_or_b32 s62, s34, s45
s_cmp_lg_u32 s62, 0
s_cselect_b64 s[64:65], s[84:85], 0
s_cselect_b64 s[66:67], s[86:87], 0
s_cselect_b64 s[68:69], s[88:89], 0
s_cselect_b64 s[70:71], s[90:91], 0
s_branch Latt_4
.p2align 3
Lcons_2:
s_cmp_ge_u32 s36, 2
s_cbranch_scc1 Lsp_5
s_cmp_ge_u32 s2, 128
s_cbranch_scc1 Lsp_5
s_mov_b32 s84, s6
s_mov_b32 s85, s7
s_mov_b32 s86, 6291456
s_mov_b32 s87, 0x20000
s_and_b32 s43, s35, 8
s_or_b32 s43, s43, 3
s_lshl_b32 s43, s43, 7
s_lshr_b32 s44, s2, 3
s_mul_i32 s44, s44, 196608
s_add_u32 s43, s43, s44
s_lshl_b32 s44, s36, 6
v_add_u32 v15, s44, v1
v_min_u32 v15, 95, v15
v_mul_u32_u24 v16, 21846, v15
v_lshrrev_b32 v16, 16, v16
v_mul_u32_u24 v17, 3, v16
v_sub_u32 v15, v15, v17
v_mul_u32_u24 v16, 6144, v16
v_lshl_add_u32 v15, v15, 11, v16
buffer_load_dword v31, v15, s[84:87], s43 offen
Lsp_5:
v_lshrrev_b32 v16, 1, v12
v_xor_b32 v15, v13, v16
v_lshlrev_b32 v15, 4, v15
v_lshl_add_u32 v2, v12, 7, v15
v_xor_b32 v3, 64, v2
v_add_u32 v4, 86016, v2
v_add_u32 v5, 86016, v3
v_lshrrev_b32 v15, 2, v12
v_and_b32 v16, 3, v1
v_lshl_add_u32 v19, v13, 3, v15
v_lshlrev_b32 v19, 7, v19
v_and_b32 v15, 2, v15
v_and_b32 v17, 1, v13
v_lshl_add_u32 v15, v17, 2, v15
v_lshrrev_b32 v17, 1, v16
s_lshl_b32 s43, s36, 1
v_add_u32 v17, s43, v17
v_xor_b32 v15, v15, v17
v_lshl_add_u32 v19, v15, 4, v19
v_and_b32 v16, 1, v16
v_lshl_add_u32 v19, v16, 3, v19
v_add_u32 v6, 18432, v19
v_add_u32 v7, 61440, v19
v_add_u32 v8, 104448, v19
v_mov_b32 v128, 0
v_mov_b32 v129, 0
v_mov_b32 v130, 0
v_mov_b32 v131, 0
v_mov_b32 v132, 0
v_mov_b32 v133, 0
v_mov_b32 v134, 0
v_mov_b32 v135, 0
v_mov_b32 v136, 0
v_mov_b32 v137, 0
v_mov_b32 v138, 0
v_mov_b32 v139, 0
v_mov_b32 v140, 0
v_mov_b32 v141, 0
v_mov_b32 v142, 0
v_mov_b32 v143, 0
v_mov_b32 v144, 0
v_mov_b32 v145, 0
v_mov_b32 v146, 0
v_mov_b32 v147, 0
v_mov_b32 v148, 0
v_mov_b32 v149, 0
v_mov_b32 v150, 0
v_mov_b32 v151, 0
v_mov_b32 v152, 0
v_mov_b32 v153, 0
v_mov_b32 v154, 0
v_mov_b32 v155, 0
v_mov_b32 v156, 0
v_mov_b32 v157, 0
v_mov_b32 v158, 0
v_mov_b32 v159, 0
v_mov_b32 v160, 0
v_mov_b32 v161, 0
v_mov_b32 v162, 0
v_mov_b32 v163, 0
v_mov_b32 v164, 0
v_mov_b32 v165, 0
v_mov_b32 v166, 0
v_mov_b32 v167, 0
v_mov_b32 v168, 0
v_mov_b32 v169, 0
v_mov_b32 v170, 0
v_mov_b32 v171, 0
v_mov_b32 v172, 0
v_mov_b32 v173, 0
v_mov_b32 v174, 0
v_mov_b32 v175, 0
v_mov_b32 v176, 0
v_mov_b32 v177, 0
v_mov_b32 v178, 0
v_mov_b32 v179, 0
v_mov_b32 v180, 0
v_mov_b32 v181, 0
v_mov_b32 v182, 0
v_mov_b32 v183, 0
v_mov_b32 v184, 0
v_mov_b32 v185, 0
v_mov_b32 v186, 0
v_mov_b32 v187, 0
v_mov_b32 v188, 0
v_mov_b32 v189, 0
v_mov_b32 v190, 0
v_mov_b32 v191, 0
v_mov_b32 v192, 0
v_mov_b32 v193, 0
v_mov_b32 v194, 0
v_mov_b32 v195, 0
v_mov_b32 v196, 0
v_mov_b32 v197, 0
v_mov_b32 v198, 0
v_mov_b32 v199, 0
v_mov_b32 v200, 0
v_mov_b32 v201, 0
v_mov_b32 v202, 0
v_mov_b32 v203, 0
v_mov_b32 v204, 0
v_mov_b32 v205, 0
v_mov_b32 v206, 0
v_mov_b32 v207, 0
v_mov_b32 v208, 0
v_mov_b32 v209, 0
v_mov_b32 v210, 0
v_mov_b32 v211, 0
v_mov_b32 v212, 0
v_mov_b32 v213, 0
v_mov_b32 v214, 0
v_mov_b32 v215, 0
v_mov_b32 v216, 0
v_mov_b32 v217, 0
v_mov_b32 v218, 0
v_mov_b32 v219, 0
v_mov_b32 v220, 0
v_mov_b32 v221, 0
v_mov_b32 v222, 0
v_mov_b32 v223, 0
v_mov_b32 v224, 0
v_mov_b32 v225, 0
v_mov_b32 v226, 0
v_mov_b32 v227, 0
v_mov_b32 v228, 0
v_mov_b32 v229, 0
v_mov_b32 v230, 0
v_mov_b32 v231, 0
v_mov_b32 v232, 0
v_mov_b32 v233, 0
v_mov_b32 v234, 0
v_mov_b32 v235, 0
s_and_b32 s43, s36, 1
s_lshr_b32 s44, s36, 1
s_and_b32 s44, s44, 1
s_lshr_b32 s45, s36, 2
v_lshlrev_b32 v14, 2, v13
v_sub_u32 v14, v12, v14
v_subrev_u32 v15, 0, v14
v_cmp_ge_u32 s[52:53], 7, v15
v_add_u32 v15, 16, v15
v_cmp_ge_u32 s[84:85], 7, v15
v_subrev_u32 v15, 1, v14
v_cmp_ge_u32 s[54:55], 7, v15
v_add_u32 v15, 16, v15
v_cmp_ge_u32 s[86:87], 7, v15
v_subrev_u32 v15, 2, v14
v_cmp_ge_u32 s[56:57], 7, v15
v_add_u32 v15, 16, v15
v_cmp_ge_u32 s[88:89], 7, v15
v_subrev_u32 v15, 3, v14
v_cmp_ge_u32 s[58:59], 7, v15
v_add_u32 v15, 16, v15
v_cmp_ge_u32 s[90:91], 7, v15
s_lshl_b32 s46, s45, 6
s_add_u32 s46, s46, s44
s_add_u32 s46, s46, 16
v_lshl_add_u32 v14, v12, 1, s46
s_lshl_b32 s47, s43, 6
v_lshl_add_u32 v15, v13, 4, s47
v_mul_u32_u24 v20, 400, v14
v_add_u32 v20, v20, v15
v_subrev_u32 v16, 32, v14
v_max_i32 v16, 0, v16
v_mul_u32_u24 v21, 400, v16
v_add_u32 v21, v21, v15
v_lshrrev_b32 v16, 2, v12
v_lshl_add_u32 v16, v13, 2, v16
v_lshl_add_u32 v16, v16, 1, s46
v_and_b32 v17, 3, v1
v_lshl_add_u32 v17, v17, 3, s47
v_mul_u32_u24 v22, 400, v16
v_add_u32 v22, v22, v17
v_subrev_u32 v16, 32, v16
v_max_i32 v16, 0, v16
v_mul_u32_u24 v23, 400, v16
v_add_u32 v23, v23, v17
s_lshl_b32 s60, s43, 13
s_lshl_b32 s61, s45, 10
s_add_u32 s60, s60, s61
s_lshl_b32 s61, s44, 8
s_add_u32 s60, s60, s61
v_lshlrev_b32 v27, 11, v13
v_lshl_add_u32 v27, v12, 4, v27
v_add_u32 v27, s60, v27
v_mov_b32 v28, 0xff800000
s_mov_b32 s61, 0x3e8293ee
s_nop 2
s_or_b32 s62, s34, s45
s_cmp_lg_u32 s62, 0
s_cselect_b64 s[64:65], s[84:85], 0
s_cselect_b64 s[66:67], s[86:87], 0
s_cselect_b64 s[68:69], s[88:89], 0
s_cselect_b64 s[70:71], s[90:91], 0
s_lshl_b32 s43, s36, 5
s_add_u32 s43, s43, 16
v_lshl_add_u32 v10, v12, 1, s43
v_lshlrev_b32 v10, 7, v10
v_and_b32 v16, 1, v13
v_lshlrev_b32 v16, 1, v16
v_lshrrev_b32 v17, 1, v13
v_add_u32 v16, v16, v17
v_and_b32 v17, 7, v12
v_xor_b32 v16, v16, v17
v_lshl_add_u32 v10, v16, 4, v10
s_mov_b32 s42, s35
v_lshlrev_b32 v9, 3, v12
v_add_u32 v9, 129024, v9
v_mul_u32_u24 v14, 400, v12
v_lshl_add_u32 v14, v13, 3, v14
s_lshl_b32 s43, s36, 5
v_add_u32 v14, s43, v14
s_barrier
ds_read_b128 v[32:35], v2 offset:0
ds_read_b64_tr_b16 v[72:73], v6 offset:8192
ds_read_b64_tr_b16 v[74:75], v6 offset:8704
ds_read_b64_tr_b16 v[76:77], v6 offset:16384
ds_read_b64_tr_b16 v[78:79], v6 offset:16896
ds_read_b64_tr_b16 v[68:69], v6 offset:0
ds_read_b64_tr_b16 v[70:71], v6 offset:512
ds_read_b128 v[36:39], v2 offset:2048
ds_read_b128 v[40:43], v2 offset:4096
ds_read_b128 v[44:47], v2 offset:6144
ds_read_b128 v[48:51], v2 offset:8192
ds_read_b128 v[52:55], v2 offset:10240
ds_read_b128 v[56:59], v2 offset:12288
ds_read_b128 v[60:63], v2 offset:14336
ds_read_b128 v[64:67], v2 offset:16384
s_mov_b32 s41, 5
.p2align 3
Lcl_6:
s_sub_u32 s42, s42, 1
s_cbranch_scc0 Lxr_7
v_add_u32 v15, 0, v10
v_xor_b32 v16, 64, v15
ds_read_b128 v[240:243], v15 offset:0
ds_read_b128 v[244:247], v16 offset:0
ds_read_b128 v[248:251], v15 offset:128
ds_read_b128 v[252:255], v16 offset:128
Lxr_7:
s_waitcnt lgkmcnt(0)
v_mfma_f32_16x16x32_bf16 v[164:167], v[72:75], v[32:35], v[164:167]
ds_read_b128 v[80:83], v3 offset:0
v_mfma_f32_16x16x32_bf16 v[200:203], v[76:79], v[32:35], v[200:203]
ds_read_b64_tr_b16 v[120:121], v6 offset:12288
v_mfma_f32_16x16x32_bf16 v[128:131], v[68:71], v[32:35], v[128:131]
ds_read_b64_tr_b16 v[122:123], v6 offset:12800
v_mfma_f32_16x16x32_bf16 v[168:171], v[72:75], v[36:39], v[168:171]
ds_read_b64_tr_b16 v[124:125], v6 offset:20480
v_mfma_f32_16x16x32_bf16 v[204:207], v[76:79], v[36:39], v[204:207]
ds_read_b64_tr_b16 v[126:127], v6 offset:20992
v_mfma_f32_16x16x32_bf16 v[132:135], v[68:71], v[36:39], v[132:135]
ds_read_b64_tr_b16 v[116:117], v6 offset:4096
v_mfma_f32_16x16x32_bf16 v[172:175], v[72:75], v[40:43], v[172:175]
ds_read_b64_tr_b16 v[118:119], v6 offset:4608
v_mfma_f32_16x16x32_bf16 v[208:211], v[76:79], v[40:43], v[208:211]
ds_read_b128 v[84:87], v3 offset:2048
v_mfma_f32_16x16x32_bf16 v[136:139], v[68:71], v[40:43], v[136:139]
ds_read_b128 v[88:91], v3 offset:4096
v_mfma_f32_16x16x32_bf16 v[176:179], v[72:75], v[44:47], v[176:179]
ds_read_b128 v[92:95], v3 offset:6144
v_mfma_f32_16x16x32_bf16 v[212:215], v[76:79], v[44:47], v[212:215]
ds_read_b128 v[96:99], v3 offset:8192
v_mfma_f32_16x16x32_bf16 v[140:143], v[68:71], v[44:47], v[140:143]
ds_read_b128 v[100:103], v3 offset:10240
v_mfma_f32_16x16x32_bf16 v[180:183], v[72:75], v[48:51], v[180:183]
ds_read_b128 v[104:107], v3 offset:12288
v_mfma_f32_16x16x32_bf16 v[216:219], v[76:79], v[48:51], v[216:219]
ds_read_b128 v[108:111], v3 offset:14336
v_mfma_f32_16x16x32_bf16 v[144:147], v[68:71], v[48:51], v[144:147]
ds_read_b128 v[112:115], v3 offset:16384
v_mfma_f32_16x16x32_bf16 v[184:187], v[72:75], v[52:55], v[184:187]
v_mfma_f32_16x16x32_bf16 v[220:223], v[76:79], v[52:55], v[220:223]
v_mfma_f32_16x16x32_bf16 v[148:151], v[68:71], v[52:55], v[148:151]
v_mfma_f32_16x16x32_bf16 v[188:191], v[72:75], v[56:59], v[188:191]
v_mfma_f32_16x16x32_bf16 v[224:227], v[76:79], v[56:59], v[224:227]
v_mfma_f32_16x16x32_bf16 v[152:155], v[68:71], v[56:59], v[152:155]
v_mfma_f32_16x16x32_bf16 v[192:195], v[72:75], v[60:63], v[192:195]
v_mfma_f32_16x16x32_bf16 v[228:231], v[76:79], v[60:63], v[228:231]
v_mfma_f32_16x16x32_bf16 v[156:159], v[68:71], v[60:63], v[156:159]
v_mfma_f32_16x16x32_bf16 v[196:199], v[72:75], v[64:67], v[196:199]
v_mfma_f32_16x16x32_bf16 v[232:235], v[76:79], v[64:67], v[232:235]
v_mfma_f32_16x16x32_bf16 v[160:163], v[68:71], v[64:67], v[160:163]
s_waitcnt lgkmcnt(0)
s_barrier
v_mfma_f32_16x16x32_bf16 v[164:167], v[120:123], v[80:83], v[164:167]
ds_read_b128 v[32:35], v2 offset:43008
v_mfma_f32_16x16x32_bf16 v[200:203], v[124:127], v[80:83], v[200:203]
ds_read_b64_tr_b16 v[72:73], v7 offset:8192
v_mfma_f32_16x16x32_bf16 v[128:131], v[116:119], v[80:83], v[128:131]
ds_read_b64_tr_b16 v[74:75], v7 offset:8704
v_mfma_f32_16x16x32_bf16 v[168:171], v[120:123], v[84:87], v[168:171]
ds_read_b64_tr_b16 v[76:77], v7 offset:16384
v_mfma_f32_16x16x32_bf16 v[204:207], v[124:127], v[84:87], v[204:207]
ds_read_b64_tr_b16 v[78:79], v7 offset:16896
v_mfma_f32_16x16x32_bf16 v[132:135], v[116:119], v[84:87], v[132:135]
ds_read_b64_tr_b16 v[68:69], v7 offset:0
v_mfma_f32_16x16x32_bf16 v[172:175], v[120:123], v[88:91], v[172:175]
ds_read_b64_tr_b16 v[70:71], v7 offset:512
v_mfma_f32_16x16x32_bf16 v[208:211], v[124:127], v[88:91], v[208:211]
ds_read_b128 v[36:39], v2 offset:45056
v_mfma_f32_16x16x32_bf16 v[136:139], v[116:119], v[88:91], v[136:139]
ds_read_b128 v[40:43], v2 offset:47104
v_mfma_f32_16x16x32_bf16 v[176:179], v[120:123], v[92:95], v[176:179]
ds_read_b128 v[44:47], v2 offset:49152
v_mfma_f32_16x16x32_bf16 v[212:215], v[124:127], v[92:95], v[212:215]
ds_read_b128 v[48:51], v2 offset:51200
v_mfma_f32_16x16x32_bf16 v[140:143], v[116:119], v[92:95], v[140:143]
ds_read_b128 v[52:55], v2 offset:53248
v_mfma_f32_16x16x32_bf16 v[180:183], v[120:123], v[96:99], v[180:183]
ds_read_b128 v[56:59], v2 offset:55296
v_mfma_f32_16x16x32_bf16 v[216:219], v[124:127], v[96:99], v[216:219]
ds_read_b128 v[60:63], v2 offset:57344
v_mfma_f32_16x16x32_bf16 v[144:147], v[116:119], v[96:99], v[144:147]
ds_read_b128 v[64:67], v2 offset:59392
v_mfma_f32_16x16x32_bf16 v[184:187], v[120:123], v[100:103], v[184:187]
v_mfma_f32_16x16x32_bf16 v[220:223], v[124:127], v[100:103], v[220:223]
v_mfma_f32_16x16x32_bf16 v[148:151], v[116:119], v[100:103], v[148:151]
v_mfma_f32_16x16x32_bf16 v[188:191], v[120:123], v[104:107], v[188:191]
v_mfma_f32_16x16x32_bf16 v[224:227], v[124:127], v[104:107], v[224:227]
v_mfma_f32_16x16x32_bf16 v[152:155], v[116:119], v[104:107], v[152:155]
v_mfma_f32_16x16x32_bf16 v[192:195], v[120:123], v[108:111], v[192:195]
v_mfma_f32_16x16x32_bf16 v[228:231], v[124:127], v[108:111], v[228:231]
v_mfma_f32_16x16x32_bf16 v[156:159], v[116:119], v[108:111], v[156:159]
v_mfma_f32_16x16x32_bf16 v[196:199], v[120:123], v[112:115], v[196:199]
v_mfma_f32_16x16x32_bf16 v[232:235], v[124:127], v[112:115], v[232:235]
v_mfma_f32_16x16x32_bf16 v[160:163], v[116:119], v[112:115], v[160:163]
s_sub_u32 s42, s42, 1
s_cbranch_scc0 Lxr_8
v_add_u32 v15, 43008, v10
v_xor_b32 v16, 64, v15
ds_read_b128 v[240:243], v15 offset:0
ds_read_b128 v[244:247], v16 offset:0
ds_read_b128 v[248:251], v15 offset:128
ds_read_b128 v[252:255], v16 offset:128
Lxr_8:
s_waitcnt lgkmcnt(0)
v_mfma_f32_16x16x32_bf16 v[164:167], v[72:75], v[32:35], v[164:167]
ds_read_b128 v[80:83], v3 offset:43008
v_mfma_f32_16x16x32_bf16 v[200:203], v[76:79], v[32:35], v[200:203]
ds_read_b64_tr_b16 v[120:121], v7 offset:12288
v_mfma_f32_16x16x32_bf16 v[128:131], v[68:71], v[32:35], v[128:131]
ds_read_b64_tr_b16 v[122:123], v7 offset:12800
v_mfma_f32_16x16x32_bf16 v[168:171], v[72:75], v[36:39], v[168:171]
ds_read_b64_tr_b16 v[124:125], v7 offset:20480
v_mfma_f32_16x16x32_bf16 v[204:207], v[76:79], v[36:39], v[204:207]
ds_read_b64_tr_b16 v[126:127], v7 offset:20992
v_mfma_f32_16x16x32_bf16 v[132:135], v[68:71], v[36:39], v[132:135]
ds_read_b64_tr_b16 v[116:117], v7 offset:4096
v_mfma_f32_16x16x32_bf16 v[172:175], v[72:75], v[40:43], v[172:175]
ds_read_b64_tr_b16 v[118:119], v7 offset:4608
v_mfma_f32_16x16x32_bf16 v[208:211], v[76:79], v[40:43], v[208:211]
ds_read_b128 v[84:87], v3 offset:45056
v_mfma_f32_16x16x32_bf16 v[136:139], v[68:71], v[40:43], v[136:139]
ds_read_b128 v[88:91], v3 offset:47104
v_mfma_f32_16x16x32_bf16 v[176:179], v[72:75], v[44:47], v[176:179]
ds_read_b128 v[92:95], v3 offset:49152
v_mfma_f32_16x16x32_bf16 v[212:215], v[76:79], v[44:47], v[212:215]
ds_read_b128 v[96:99], v3 offset:51200
v_mfma_f32_16x16x32_bf16 v[140:143], v[68:71], v[44:47], v[140:143]
ds_read_b128 v[100:103], v3 offset:53248
v_mfma_f32_16x16x32_bf16 v[180:183], v[72:75], v[48:51], v[180:183]
ds_read_b128 v[104:107], v3 offset:55296
v_mfma_f32_16x16x32_bf16 v[216:219], v[76:79], v[48:51], v[216:219]
ds_read_b128 v[108:111], v3 offset:57344
v_mfma_f32_16x16x32_bf16 v[144:147], v[68:71], v[48:51], v[144:147]
ds_read_b128 v[112:115], v3 offset:59392
v_mfma_f32_16x16x32_bf16 v[184:187], v[72:75], v[52:55], v[184:187]
v_mfma_f32_16x16x32_bf16 v[220:223], v[76:79], v[52:55], v[220:223]
v_mfma_f32_16x16x32_bf16 v[148:151], v[68:71], v[52:55], v[148:151]
v_mfma_f32_16x16x32_bf16 v[188:191], v[72:75], v[56:59], v[188:191]
v_mfma_f32_16x16x32_bf16 v[224:227], v[76:79], v[56:59], v[224:227]
v_mfma_f32_16x16x32_bf16 v[152:155], v[68:71], v[56:59], v[152:155]
v_mfma_f32_16x16x32_bf16 v[192:195], v[72:75], v[60:63], v[192:195]
v_mfma_f32_16x16x32_bf16 v[228:231], v[76:79], v[60:63], v[228:231]
v_mfma_f32_16x16x32_bf16 v[156:159], v[68:71], v[60:63], v[156:159]
v_mfma_f32_16x16x32_bf16 v[196:199], v[72:75], v[64:67], v[196:199]
v_mfma_f32_16x16x32_bf16 v[232:235], v[76:79], v[64:67], v[232:235]
v_mfma_f32_16x16x32_bf16 v[160:163], v[68:71], v[64:67], v[160:163]
s_waitcnt lgkmcnt(0)
s_barrier
v_mfma_f32_16x16x32_bf16 v[164:167], v[120:123], v[80:83], v[164:167]
ds_read_b128 v[32:35], v4 offset:0
v_mfma_f32_16x16x32_bf16 v[200:203], v[124:127], v[80:83], v[200:203]
ds_read_b64_tr_b16 v[72:73], v8 offset:8192
v_mfma_f32_16x16x32_bf16 v[128:131], v[116:119], v[80:83], v[128:131]
ds_read_b64_tr_b16 v[74:75], v8 offset:8704
v_mfma_f32_16x16x32_bf16 v[168:171], v[120:123], v[84:87], v[168:171]
ds_read_b64_tr_b16 v[76:77], v8 offset:16384
v_mfma_f32_16x16x32_bf16 v[204:207], v[124:127], v[84:87], v[204:207]
ds_read_b64_tr_b16 v[78:79], v8 offset:16896
v_mfma_f32_16x16x32_bf16 v[132:135], v[116:119], v[84:87], v[132:135]
ds_read_b64_tr_b16 v[68:69], v8 offset:0
v_mfma_f32_16x16x32_bf16 v[172:175], v[120:123], v[88:91], v[172:175]
ds_read_b64_tr_b16 v[70:71], v8 offset:512
v_mfma_f32_16x16x32_bf16 v[208:211], v[124:127], v[88:91], v[208:211]
ds_read_b128 v[36:39], v4 offset:2048
v_mfma_f32_16x16x32_bf16 v[136:139], v[116:119], v[88:91], v[136:139]
ds_read_b128 v[40:43], v4 offset:4096
v_mfma_f32_16x16x32_bf16 v[176:179], v[120:123], v[92:95], v[176:179]
ds_read_b128 v[44:47], v4 offset:6144
v_mfma_f32_16x16x32_bf16 v[212:215], v[124:127], v[92:95], v[212:215]
ds_read_b128 v[48:51], v4 offset:8192
v_mfma_f32_16x16x32_bf16 v[140:143], v[116:119], v[92:95], v[140:143]
ds_read_b128 v[52:55], v4 offset:10240
v_mfma_f32_16x16x32_bf16 v[180:183], v[120:123], v[96:99], v[180:183]
ds_read_b128 v[56:59], v4 offset:12288
v_mfma_f32_16x16x32_bf16 v[216:219], v[124:127], v[96:99], v[216:219]
ds_read_b128 v[60:63], v4 offset:14336
v_mfma_f32_16x16x32_bf16 v[144:147], v[116:119], v[96:99], v[144:147]
ds_read_b128 v[64:67], v4 offset:16384
v_mfma_f32_16x16x32_bf16 v[184:187], v[120:123], v[100:103], v[184:187]
v_mfma_f32_16x16x32_bf16 v[220:223], v[124:127], v[100:103], v[220:223]
v_mfma_f32_16x16x32_bf16 v[148:151], v[116:119], v[100:103], v[148:151]
v_mfma_f32_16x16x32_bf16 v[188:191], v[120:123], v[104:107], v[188:191]
v_mfma_f32_16x16x32_bf16 v[224:227], v[124:127], v[104:107], v[224:227]
v_mfma_f32_16x16x32_bf16 v[152:155], v[116:119], v[104:107], v[152:155]
v_mfma_f32_16x16x32_bf16 v[192:195], v[120:123], v[108:111], v[192:195]
v_mfma_f32_16x16x32_bf16 v[228:231], v[124:127], v[108:111], v[228:231]
v_mfma_f32_16x16x32_bf16 v[156:159], v[116:119], v[108:111], v[156:159]
v_mfma_f32_16x16x32_bf16 v[196:199], v[120:123], v[112:115], v[196:199]
v_mfma_f32_16x16x32_bf16 v[232:235], v[124:127], v[112:115], v[232:235]
v_mfma_f32_16x16x32_bf16 v[160:163], v[116:119], v[112:115], v[160:163]
s_sub_u32 s42, s42, 1
s_cbranch_scc0 Lxr_9
v_add_u32 v15, 86016, v10
v_xor_b32 v16, 64, v15
ds_read_b128 v[240:243], v15 offset:0
ds_read_b128 v[244:247], v16 offset:0
ds_read_b128 v[248:251], v15 offset:128
ds_read_b128 v[252:255], v16 offset:128
Lxr_9:
s_waitcnt lgkmcnt(0)
v_mfma_f32_16x16x32_bf16 v[164:167], v[72:75], v[32:35], v[164:167]
ds_read_b128 v[80:83], v5 offset:0
v_mfma_f32_16x16x32_bf16 v[200:203], v[76:79], v[32:35], v[200:203]
ds_read_b64_tr_b16 v[120:121], v8 offset:12288
v_mfma_f32_16x16x32_bf16 v[128:131], v[68:71], v[32:35], v[128:131]
ds_read_b64_tr_b16 v[122:123], v8 offset:12800
v_mfma_f32_16x16x32_bf16 v[168:171], v[72:75], v[36:39], v[168:171]
ds_read_b64_tr_b16 v[124:125], v8 offset:20480
v_mfma_f32_16x16x32_bf16 v[204:207], v[76:79], v[36:39], v[204:207]
ds_read_b64_tr_b16 v[126:127], v8 offset:20992
v_mfma_f32_16x16x32_bf16 v[132:135], v[68:71], v[36:39], v[132:135]
ds_read_b64_tr_b16 v[116:117], v8 offset:4096
v_mfma_f32_16x16x32_bf16 v[172:175], v[72:75], v[40:43], v[172:175]
ds_read_b64_tr_b16 v[118:119], v8 offset:4608
v_mfma_f32_16x16x32_bf16 v[208:211], v[76:79], v[40:43], v[208:211]
ds_read_b128 v[84:87], v5 offset:2048
v_mfma_f32_16x16x32_bf16 v[136:139], v[68:71], v[40:43], v[136:139]
ds_read_b128 v[88:91], v5 offset:4096
v_mfma_f32_16x16x32_bf16 v[176:179], v[72:75], v[44:47], v[176:179]
ds_read_b128 v[92:95], v5 offset:6144
v_mfma_f32_16x16x32_bf16 v[212:215], v[76:79], v[44:47], v[212:215]
ds_read_b128 v[96:99], v5 offset:8192
v_mfma_f32_16x16x32_bf16 v[140:143], v[68:71], v[44:47], v[140:143]
ds_read_b128 v[100:103], v5 offset:10240
v_mfma_f32_16x16x32_bf16 v[180:183], v[72:75], v[48:51], v[180:183]
ds_read_b128 v[104:107], v5 offset:12288
v_mfma_f32_16x16x32_bf16 v[216:219], v[76:79], v[48:51], v[216:219]
ds_read_b128 v[108:111], v5 offset:14336
v_mfma_f32_16x16x32_bf16 v[144:147], v[68:71], v[48:51], v[144:147]
ds_read_b128 v[112:115], v5 offset:16384
v_mfma_f32_16x16x32_bf16 v[184:187], v[72:75], v[52:55], v[184:187]
v_mfma_f32_16x16x32_bf16 v[220:223], v[76:79], v[52:55], v[220:223]
v_mfma_f32_16x16x32_bf16 v[148:151], v[68:71], v[52:55], v[148:151]
v_mfma_f32_16x16x32_bf16 v[188:191], v[72:75], v[56:59], v[188:191]
v_mfma_f32_16x16x32_bf16 v[224:227], v[76:79], v[56:59], v[224:227]
v_mfma_f32_16x16x32_bf16 v[152:155], v[68:71], v[56:59], v[152:155]
v_mfma_f32_16x16x32_bf16 v[192:195], v[72:75], v[60:63], v[192:195]
v_mfma_f32_16x16x32_bf16 v[228:231], v[76:79], v[60:63], v[228:231]
v_mfma_f32_16x16x32_bf16 v[156:159], v[68:71], v[60:63], v[156:159]
v_mfma_f32_16x16x32_bf16 v[196:199], v[72:75], v[64:67], v[196:199]
v_mfma_f32_16x16x32_bf16 v[232:235], v[76:79], v[64:67], v[232:235]
v_mfma_f32_16x16x32_bf16 v[160:163], v[68:71], v[64:67], v[160:163]
s_waitcnt lgkmcnt(0)
s_barrier
v_mfma_f32_16x16x32_bf16 v[164:167], v[120:123], v[80:83], v[164:167]
ds_read_b128 v[32:35], v2 offset:0
v_mfma_f32_16x16x32_bf16 v[200:203], v[124:127], v[80:83], v[200:203]
ds_read_b64_tr_b16 v[72:73], v6 offset:8192
v_mfma_f32_16x16x32_bf16 v[128:131], v[116:119], v[80:83], v[128:131]
ds_read_b64_tr_b16 v[74:75], v6 offset:8704
v_mfma_f32_16x16x32_bf16 v[168:171], v[120:123], v[84:87], v[168:171]
ds_read_b64_tr_b16 v[76:77], v6 offset:16384
v_mfma_f32_16x16x32_bf16 v[204:207], v[124:127], v[84:87], v[204:207]
ds_read_b64_tr_b16 v[78:79], v6 offset:16896
v_mfma_f32_16x16x32_bf16 v[132:135], v[116:119], v[84:87], v[132:135]
ds_read_b64_tr_b16 v[68:69], v6 offset:0
v_mfma_f32_16x16x32_bf16 v[172:175], v[120:123], v[88:91], v[172:175]
ds_read_b64_tr_b16 v[70:71], v6 offset:512
v_mfma_f32_16x16x32_bf16 v[208:211], v[124:127], v[88:91], v[208:211]
ds_read_b128 v[36:39], v2 offset:2048
v_mfma_f32_16x16x32_bf16 v[136:139], v[116:119], v[88:91], v[136:139]
ds_read_b128 v[40:43], v2 offset:4096
v_mfma_f32_16x16x32_bf16 v[176:179], v[120:123], v[92:95], v[176:179]
ds_read_b128 v[44:47], v2 offset:6144
v_mfma_f32_16x16x32_bf16 v[212:215], v[124:127], v[92:95], v[212:215]
ds_read_b128 v[48:51], v2 offset:8192
v_mfma_f32_16x16x32_bf16 v[140:143], v[116:119], v[92:95], v[140:143]
ds_read_b128 v[52:55], v2 offset:10240
v_mfma_f32_16x16x32_bf16 v[180:183], v[120:123], v[96:99], v[180:183]
ds_read_b128 v[56:59], v2 offset:12288
v_mfma_f32_16x16x32_bf16 v[216:219], v[124:127], v[96:99], v[216:219]
ds_read_b128 v[60:63], v2 offset:14336
v_mfma_f32_16x16x32_bf16 v[144:147], v[116:119], v[96:99], v[144:147]
ds_read_b128 v[64:67], v2 offset:16384
v_mfma_f32_16x16x32_bf16 v[184:187], v[120:123], v[100:103], v[184:187]
v_mfma_f32_16x16x32_bf16 v[220:223], v[124:127], v[100:103], v[220:223]
v_mfma_f32_16x16x32_bf16 v[148:151], v[116:119], v[100:103], v[148:151]
v_mfma_f32_16x16x32_bf16 v[188:191], v[120:123], v[104:107], v[188:191]
v_mfma_f32_16x16x32_bf16 v[224:227], v[124:127], v[104:107], v[224:227]
v_mfma_f32_16x16x32_bf16 v[152:155], v[116:119], v[104:107], v[152:155]
v_mfma_f32_16x16x32_bf16 v[192:195], v[120:123], v[108:111], v[192:195]
v_mfma_f32_16x16x32_bf16 v[228:231], v[124:127], v[108:111], v[228:231]
v_mfma_f32_16x16x32_bf16 v[156:159], v[116:119], v[108:111], v[156:159]
v_mfma_f32_16x16x32_bf16 v[196:199], v[120:123], v[112:115], v[196:199]
v_mfma_f32_16x16x32_bf16 v[232:235], v[124:127], v[112:115], v[232:235]
v_mfma_f32_16x16x32_bf16 v[160:163], v[116:119], v[112:115], v[160:163]
s_sub_u32 s41, s41, 1
s_cmp_lg_u32 s41, 0
s_cbranch_scc1 Lcl_6
s_sub_u32 s42, s42, 1
s_cbranch_scc0 Lxr_10
v_add_u32 v15, 0, v10
v_xor_b32 v16, 64, v15
ds_read_b128 v[240:243], v15 offset:0
ds_read_b128 v[244:247], v16 offset:0
ds_read_b128 v[248:251], v15 offset:128
ds_read_b128 v[252:255], v16 offset:128
Lxr_10:
s_waitcnt lgkmcnt(0)
v_mfma_f32_16x16x32_bf16 v[164:167], v[72:75], v[32:35], v[164:167]
ds_read_b128 v[80:83], v3 offset:0
v_mfma_f32_16x16x32_bf16 v[200:203], v[76:79], v[32:35], v[200:203]
ds_read_b64_tr_b16 v[120:121], v6 offset:12288
v_mfma_f32_16x16x32_bf16 v[128:131], v[68:71], v[32:35], v[128:131]
ds_read_b64_tr_b16 v[122:123], v6 offset:12800
v_mfma_f32_16x16x32_bf16 v[168:171], v[72:75], v[36:39], v[168:171]
ds_read_b64_tr_b16 v[124:125], v6 offset:20480
v_mfma_f32_16x16x32_bf16 v[204:207], v[76:79], v[36:39], v[204:207]
ds_read_b64_tr_b16 v[126:127], v6 offset:20992
v_mfma_f32_16x16x32_bf16 v[132:135], v[68:71], v[36:39], v[132:135]
ds_read_b64_tr_b16 v[116:117], v6 offset:4096
v_mfma_f32_16x16x32_bf16 v[172:175], v[72:75], v[40:43], v[172:175]
ds_read_b64_tr_b16 v[118:119], v6 offset:4608
v_mfma_f32_16x16x32_bf16 v[208:211], v[76:79], v[40:43], v[208:211]
ds_read_b128 v[84:87], v3 offset:2048
v_mfma_f32_16x16x32_bf16 v[136:139], v[68:71], v[40:43], v[136:139]
ds_read_b128 v[88:91], v3 offset:4096
v_mfma_f32_16x16x32_bf16 v[176:179], v[72:75], v[44:47], v[176:179]
ds_read_b128 v[92:95], v3 offset:6144
v_mfma_f32_16x16x32_bf16 v[212:215], v[76:79], v[44:47], v[212:215]
ds_read_b128 v[96:99], v3 offset:8192
v_mfma_f32_16x16x32_bf16 v[140:143], v[68:71], v[44:47], v[140:143]
ds_read_b128 v[100:103], v3 offset:10240
v_mfma_f32_16x16x32_bf16 v[180:183], v[72:75], v[48:51], v[180:183]
ds_read_b128 v[104:107], v3 offset:12288
v_mfma_f32_16x16x32_bf16 v[216:219], v[76:79], v[48:51], v[216:219]
ds_read_b128 v[108:111], v3 offset:14336
v_mfma_f32_16x16x32_bf16 v[144:147], v[68:71], v[48:51], v[144:147]
ds_read_b128 v[112:115], v3 offset:16384
v_mfma_f32_16x16x32_bf16 v[184:187], v[72:75], v[52:55], v[184:187]
v_mfma_f32_16x16x32_bf16 v[220:223], v[76:79], v[52:55], v[220:223]
v_mfma_f32_16x16x32_bf16 v[148:151], v[68:71], v[52:55], v[148:151]
v_mfma_f32_16x16x32_bf16 v[188:191], v[72:75], v[56:59], v[188:191]
v_mfma_f32_16x16x32_bf16 v[224:227], v[76:79], v[56:59], v[224:227]
v_mfma_f32_16x16x32_bf16 v[152:155], v[68:71], v[56:59], v[152:155]
v_mfma_f32_16x16x32_bf16 v[192:195], v[72:75], v[60:63], v[192:195]
v_mfma_f32_16x16x32_bf16 v[228:231], v[76:79], v[60:63], v[228:231]
v_mfma_f32_16x16x32_bf16 v[156:159], v[68:71], v[60:63], v[156:159]
v_mfma_f32_16x16x32_bf16 v[196:199], v[72:75], v[64:67], v[196:199]
v_mfma_f32_16x16x32_bf16 v[232:235], v[76:79], v[64:67], v[232:235]
v_mfma_f32_16x16x32_bf16 v[160:163], v[68:71], v[64:67], v[160:163]
s_waitcnt lgkmcnt(0)
s_barrier
v_mfma_f32_16x16x32_bf16 v[164:167], v[120:123], v[80:83], v[164:167]
ds_read_b64 v[32:33], v9 offset:0
v_mfma_f32_16x16x32_bf16 v[200:203], v[124:127], v[80:83], v[200:203]
ds_read_b64 v[34:35], v9 offset:128
v_mfma_f32_16x16x32_bf16 v[128:131], v[116:119], v[80:83], v[128:131]
ds_read_b64 v[36:37], v9 offset:256
v_mfma_f32_16x16x32_bf16 v[168:171], v[120:123], v[84:87], v[168:171]
ds_read_b64 v[38:39], v9 offset:384
v_mfma_f32_16x16x32_bf16 v[204:207], v[124:127], v[84:87], v[204:207]
ds_read_b64 v[40:41], v9 offset:512
v_mfma_f32_16x16x32_bf16 v[132:135], v[116:119], v[84:87], v[132:135]
ds_read_b64 v[42:43], v9 offset:640
v_mfma_f32_16x16x32_bf16 v[172:175], v[120:123], v[88:91], v[172:175]
ds_read_b64 v[44:45], v9 offset:768
v_mfma_f32_16x16x32_bf16 v[208:211], v[124:127], v[88:91], v[208:211]
ds_read_b64 v[46:47], v9 offset:896
v_mfma_f32_16x16x32_bf16 v[136:139], v[116:119], v[88:91], v[136:139]
ds_read_b64 v[48:49], v9 offset:1024
v_mfma_f32_16x16x32_bf16 v[176:179], v[120:123], v[92:95], v[176:179]
v_mov_b32_dpp v52, v128 row_newbcast:0 row_mask:0xf bank_mask:0xf
v_mov_b32_dpp v53, v129 row_newbcast:0 row_mask:0xf bank_mask:0xf
v_mfma_f32_16x16x32_bf16 v[212:215], v[124:127], v[92:95], v[212:215]
v_mov_b32_dpp v54, v130 row_newbcast:0 row_mask:0xf bank_mask:0xf
v_mov_b32_dpp v55, v131 row_newbcast:0 row_mask:0xf bank_mask:0xf
v_mfma_f32_16x16x32_bf16 v[140:143], v[116:119], v[92:95], v[140:143]
v_mov_b32_dpp v56, v164 row_newbcast:0 row_mask:0xf bank_mask:0xf
v_mov_b32_dpp v57, v165 row_newbcast:0 row_mask:0xf bank_mask:0xf
v_mfma_f32_16x16x32_bf16 v[180:183], v[120:123], v[96:99], v[180:183]
v_mov_b32_dpp v58, v166 row_newbcast:0 row_mask:0xf bank_mask:0xf
v_mov_b32_dpp v59, v167 row_newbcast:0 row_mask:0xf bank_mask:0xf
v_mfma_f32_16x16x32_bf16 v[216:219], v[124:127], v[96:99], v[216:219]
v_mov_b32_dpp v60, v200 row_newbcast:0 row_mask:0xf bank_mask:0xf
v_mov_b32_dpp v61, v201 row_newbcast:0 row_mask:0xf bank_mask:0xf
v_mfma_f32_16x16x32_bf16 v[144:147], v[116:119], v[96:99], v[144:147]
v_mov_b32_dpp v62, v202 row_newbcast:0 row_mask:0xf bank_mask:0xf
v_mov_b32_dpp v63, v203 row_newbcast:0 row_mask:0xf bank_mask:0xf
v_mfma_f32_16x16x32_bf16 v[184:187], v[120:123], v[100:103], v[184:187]
s_waitcnt lgkmcnt(0)
v_fma_f32 v164, -v32, v56, v164
v_mfma_f32_16x16x32_bf16 v[220:223], v[124:127], v[100:103], v[220:223]
v_fma_f32 v165, -v32, v57, v165
v_fma_f32 v166, -v32, v58, v166
v_mfma_f32_16x16x32_bf16 v[148:151], v[116:119], v[100:103], v[148:151]
v_fma_f32 v167, -v32, v59, v167
v_mul_f32 v164, v33, v164
v_mfma_f32_16x16x32_bf16 v[188:191], v[120:123], v[104:107], v[188:191]
v_mul_f32 v165, v33, v165
v_mul_f32 v166, v33, v166
v_mfma_f32_16x16x32_bf16 v[224:227], v[124:127], v[104:107], v[224:227]
v_mul_f32 v167, v33, v167
v_cvt_pk_bf16_f32 v164, v164, v165
v_mfma_f32_16x16x32_bf16 v[152:155], v[116:119], v[104:107], v[152:155]
v_cvt_pk_bf16_f32 v165, v166, v167
ds_write_b64 v14, v[164:165] offset:128
v_mfma_f32_16x16x32_bf16 v[192:195], v[120:123], v[108:111], v[192:195]
v_fma_f32 v200, -v32, v60, v200
v_fma_f32 v201, -v32, v61, v201
v_mfma_f32_16x16x32_bf16 v[228:231], v[124:127], v[108:111], v[228:231]
v_fma_f32 v202, -v32, v62, v202
v_fma_f32 v203, -v32, v63, v203
v_mfma_f32_16x16x32_bf16 v[156:159], v[116:119], v[108:111], v[156:159]
v_mul_f32 v200, v33, v200
v_mul_f32 v201, v33, v201
v_mfma_f32_16x16x32_bf16 v[196:199], v[120:123], v[112:115], v[196:199]
v_mul_f32 v202, v33, v202
v_mul_f32 v203, v33, v203
v_mfma_f32_16x16x32_bf16 v[232:235], v[124:127], v[112:115], v[232:235]
v_cvt_pk_bf16_f32 v200, v200, v201
v_cvt_pk_bf16_f32 v201, v202, v203
v_mfma_f32_16x16x32_bf16 v[160:163], v[116:119], v[112:115], v[160:163]
ds_write_b64 v14, v[200:201] offset:256
v_fma_f32 v132, -v34, v52, v132
v_fma_f32 v133, -v34, v53, v133
v_fma_f32 v134, -v34, v54, v134
v_fma_f32 v135, -v34, v55, v135
v_mul_f32 v132, v35, v132
v_mul_f32 v133, v35, v133
v_mul_f32 v134, v35, v134
v_mul_f32 v135, v35, v135
v_cvt_pk_bf16_f32 v132, v132, v133
v_cvt_pk_bf16_f32 v133, v134, v135
ds_write_b64 v14, v[132:133] offset:6400
v_pk_fma_f32 v[168:169], v[34:35], v[56:57], v[168:169] op_sel_hi:[0,1,1] neg_lo:[1,0,0] neg_hi:[1,0,0]
v_pk_fma_f32 v[170:171], v[34:35], v[58:59], v[170:171] op_sel_hi:[0,1,1] neg_lo:[1,0,0] neg_hi:[1,0,0]
v_pk_mul_f32 v[168:169], v[34:35], v[168:169] op_sel:[1,0] op_sel_hi:[1,1]
v_pk_mul_f32 v[170:171], v[34:35], v[170:171] op_sel:[1,0] op_sel_hi:[1,1]
v_cvt_pk_bf16_f32 v168, v168, v169
v_cvt_pk_bf16_f32 v169, v170, v171
ds_write_b64 v14, v[168:169] offset:6528
v_pk_fma_f32 v[204:205], v[34:35], v[60:61], v[204:205] op_sel_hi:[0,1,1] neg_lo:[1,0,0] neg_hi:[1,0,0]
v_pk_fma_f32 v[206:207], v[34:35], v[62:63], v[206:207] op_sel_hi:[0,1,1] neg_lo:[1,0,0] neg_hi:[1,0,0]
v_pk_mul_f32 v[204:205], v[34:35], v[204:205] op_sel:[1,0] op_sel_hi:[1,1]
v_pk_mul_f32 v[206:207], v[34:35], v[206:207] op_sel:[1,0] op_sel_hi:[1,1]
v_cvt_pk_bf16_f32 v204, v204, v205
v_cvt_pk_bf16_f32 v205, v206, v207
ds_write_b64 v14, v[204:205] offset:6656
v_pk_fma_f32 v[136:137], v[36:37], v[52:53], v[136:137] op_sel_hi:[0,1,1] neg_lo:[1,0,0] neg_hi:[1,0,0]
v_pk_fma_f32 v[138:139], v[36:37], v[54:55], v[138:139] op_sel_hi:[0,1,1] neg_lo:[1,0,0] neg_hi:[1,0,0]
v_pk_mul_f32 v[136:137], v[36:37], v[136:137] op_sel:[1,0] op_sel_hi:[1,1]
v_pk_mul_f32 v[138:139], v[36:37], v[138:139] op_sel:[1,0] op_sel_hi:[1,1]
v_cvt_pk_bf16_f32 v136, v136, v137
v_cvt_pk_bf16_f32 v137, v138, v139
ds_write_b64 v14, v[136:137] offset:12800
v_pk_fma_f32 v[172:173], v[36:37], v[56:57], v[172:173] op_sel_hi:[0,1,1] neg_lo:[1,0,0] neg_hi:[1,0,0]
v_pk_fma_f32 v[174:175], v[36:37], v[58:59], v[174:175] op_sel_hi:[0,1,1] neg_lo:[1,0,0] neg_hi:[1,0,0]
v_pk_mul_f32 v[172:173], v[36:37], v[172:173] op_sel:[1,0] op_sel_hi:[1,1]
v_pk_mul_f32 v[174:175], v[36:37], v[174:175] op_sel:[1,0] op_sel_hi:[1,1]
v_cvt_pk_bf16_f32 v172, v172, v173
v_cvt_pk_bf16_f32 v173, v174, v175
ds_write_b64 v14, v[172:173] offset:12928
v_pk_fma_f32 v[208:209], v[36:37], v[60:61], v[208:209] op_sel_hi:[0,1,1] neg_lo:[1,0,0] neg_hi:[1,0,0]
v_pk_fma_f32 v[210:211], v[36:37], v[62:63], v[210:211] op_sel_hi:[0,1,1] neg_lo:[1,0,0] neg_hi:[1,0,0]
v_pk_mul_f32 v[208:209], v[36:37], v[208:209] op_sel:[1,0] op_sel_hi:[1,1]
v_pk_mul_f32 v[210:211], v[36:37], v[210:211] op_sel:[1,0] op_sel_hi:[1,1]
v_cvt_pk_bf16_f32 v208, v208, v209
v_cvt_pk_bf16_f32 v209, v210, v211
ds_write_b64 v14, v[208:209] offset:13056
v_pk_fma_f32 v[140:141], v[38:39], v[52:53], v[140:141] op_sel_hi:[0,1,1] neg_lo:[1,0,0] neg_hi:[1,0,0]
v_pk_fma_f32 v[142:143], v[38:39], v[54:55], v[142:143] op_sel_hi:[0,1,1] neg_lo:[1,0,0] neg_hi:[1,0,0]
v_pk_mul_f32 v[140:141], v[38:39], v[140:141] op_sel:[1,0] op_sel_hi:[1,1]
v_pk_mul_f32 v[142:143], v[38:39], v[142:143] op_sel:[1,0] op_sel_hi:[1,1]
v_cvt_pk_bf16_f32 v140, v140, v141
v_cvt_pk_bf16_f32 v141, v142, v143
ds_write_b64 v14, v[140:141] offset:19200
v_pk_fma_f32 v[176:177], v[38:39], v[56:57], v[176:177] op_sel_hi:[0,1,1] neg_lo:[1,0,0] neg_hi:[1,0,0]
v_pk_fma_f32 v[178:179], v[38:39], v[58:59], v[178:179] op_sel_hi:[0,1,1] neg_lo:[1,0,0] neg_hi:[1,0,0]
v_pk_mul_f32 v[176:177], v[38:39], v[176:177] op_sel:[1,0] op_sel_hi:[1,1]
v_pk_mul_f32 v[178:179], v[38:39], v[178:179] op_sel:[1,0] op_sel_hi:[1,1]
v_cvt_pk_bf16_f32 v176, v176, v177
v_cvt_pk_bf16_f32 v177, v178, v179
ds_write_b64 v14, v[176:177] offset:19328
v_pk_fma_f32 v[212:213], v[38:39], v[60:61], v[212:213] op_sel_hi:[0,1,1] neg_lo:[1,0,0] neg_hi:[1,0,0]
v_pk_fma_f32 v[214:215], v[38:39], v[62:63], v[214:215] op_sel_hi:[0,1,1] neg_lo:[1,0,0] neg_hi:[1,0,0]
v_pk_mul_f32 v[212:213], v[38:39], v[212:213] op_sel:[1,0] op_sel_hi:[1,1]
v_pk_mul_f32 v[214:215], v[38:39], v[214:215] op_sel:[1,0] op_sel_hi:[1,1]
v_cvt_pk_bf16_f32 v212, v212, v213
v_cvt_pk_bf16_f32 v213, v214, v215
ds_write_b64 v14, v[212:213] offset:19456
v_pk_fma_f32 v[144:145], v[40:41], v[52:53], v[144:145] op_sel_hi:[0,1,1] neg_lo:[1,0,0] neg_hi:[1,0,0]
v_pk_fma_f32 v[146:147], v[40:41], v[54:55], v[146:147] op_sel_hi:[0,1,1] neg_lo:[1,0,0] neg_hi:[1,0,0]
v_pk_mul_f32 v[144:145], v[40:41], v[144:145] op_sel:[1,0] op_sel_hi:[1,1]
v_pk_mul_f32 v[146:147], v[40:41], v[146:147] op_sel:[1,0] op_sel_hi:[1,1]
v_cvt_pk_bf16_f32 v144, v144, v145
v_cvt_pk_bf16_f32 v145, v146, v147
ds_write_b64 v14, v[144:145] offset:25600
v_pk_fma_f32 v[180:181], v[40:41], v[56:57], v[180:181] op_sel_hi:[0,1,1] neg_lo:[1,0,0] neg_hi:[1,0,0]
v_pk_fma_f32 v[182:183], v[40:41], v[58:59], v[182:183] op_sel_hi:[0,1,1] neg_lo:[1,0,0] neg_hi:[1,0,0]
v_pk_mul_f32 v[180:181], v[40:41], v[180:181] op_sel:[1,0] op_sel_hi:[1,1]
v_pk_mul_f32 v[182:183], v[40:41], v[182:183] op_sel:[1,0] op_sel_hi:[1,1]
v_cvt_pk_bf16_f32 v180, v180, v181
v_cvt_pk_bf16_f32 v181, v182, v183
ds_write_b64 v14, v[180:181] offset:25728
v_pk_fma_f32 v[216:217], v[40:41], v[60:61], v[216:217] op_sel_hi:[0,1,1] neg_lo:[1,0,0] neg_hi:[1,0,0]
v_pk_fma_f32 v[218:219], v[40:41], v[62:63], v[218:219] op_sel_hi:[0,1,1] neg_lo:[1,0,0] neg_hi:[1,0,0]
v_pk_mul_f32 v[216:217], v[40:41], v[216:217] op_sel:[1,0] op_sel_hi:[1,1]
v_pk_mul_f32 v[218:219], v[40:41], v[218:219] op_sel:[1,0] op_sel_hi:[1,1]
v_cvt_pk_bf16_f32 v216, v216, v217
v_cvt_pk_bf16_f32 v217, v218, v219
ds_write_b64 v14, v[216:217] offset:25856
v_pk_fma_f32 v[148:149], v[42:43], v[52:53], v[148:149] op_sel_hi:[0,1,1] neg_lo:[1,0,0] neg_hi:[1,0,0]
v_pk_fma_f32 v[150:151], v[42:43], v[54:55], v[150:151] op_sel_hi:[0,1,1] neg_lo:[1,0,0] neg_hi:[1,0,0]
v_pk_mul_f32 v[148:149], v[42:43], v[148:149] op_sel:[1,0] op_sel_hi:[1,1]
v_pk_mul_f32 v[150:151], v[42:43], v[150:151] op_sel:[1,0] op_sel_hi:[1,1]
v_cvt_pk_bf16_f32 v148, v148, v149
v_cvt_pk_bf16_f32 v149, v150, v151
ds_write_b64 v14, v[148:149] offset:32000
v_pk_fma_f32 v[184:185], v[42:43], v[56:57], v[184:185] op_sel_hi:[0,1,1] neg_lo:[1,0,0] neg_hi:[1,0,0]
v_pk_fma_f32 v[186:187], v[42:43], v[58:59], v[186:187] op_sel_hi:[0,1,1] neg_lo:[1,0,0] neg_hi:[1,0,0]
v_pk_mul_f32 v[184:185], v[42:43], v[184:185] op_sel:[1,0] op_sel_hi:[1,1]
v_pk_mul_f32 v[186:187], v[42:43], v[186:187] op_sel:[1,0] op_sel_hi:[1,1]
v_cvt_pk_bf16_f32 v184, v184, v185
v_cvt_pk_bf16_f32 v185, v186, v187
ds_write_b64 v14, v[184:185] offset:32128
v_pk_fma_f32 v[220:221], v[42:43], v[60:61], v[220:221] op_sel_hi:[0,1,1] neg_lo:[1,0,0] neg_hi:[1,0,0]
v_pk_fma_f32 v[222:223], v[42:43], v[62:63], v[222:223] op_sel_hi:[0,1,1] neg_lo:[1,0,0] neg_hi:[1,0,0]
v_pk_mul_f32 v[220:221], v[42:43], v[220:221] op_sel:[1,0] op_sel_hi:[1,1]
v_pk_mul_f32 v[222:223], v[42:43], v[222:223] op_sel:[1,0] op_sel_hi:[1,1]
v_cvt_pk_bf16_f32 v220, v220, v221
v_cvt_pk_bf16_f32 v221, v222, v223
ds_write_b64 v14, v[220:221] offset:32256
v_pk_fma_f32 v[152:153], v[44:45], v[52:53], v[152:153] op_sel_hi:[0,1,1] neg_lo:[1,0,0] neg_hi:[1,0,0]
v_pk_fma_f32 v[154:155], v[44:45], v[54:55], v[154:155] op_sel_hi:[0,1,1] neg_lo:[1,0,0] neg_hi:[1,0,0]
v_pk_mul_f32 v[152:153], v[44:45], v[152:153] op_sel:[1,0] op_sel_hi:[1,1]
v_pk_mul_f32 v[154:155], v[44:45], v[154:155] op_sel:[1,0] op_sel_hi:[1,1]
v_cvt_pk_bf16_f32 v152, v152, v153
v_cvt_pk_bf16_f32 v153, v154, v155
ds_write_b64 v14, v[152:153] offset:38400
v_pk_fma_f32 v[188:189], v[44:45], v[56:57], v[188:189] op_sel_hi:[0,1,1] neg_lo:[1,0,0] neg_hi:[1,0,0]
v_pk_fma_f32 v[190:191], v[44:45], v[58:59], v[190:191] op_sel_hi:[0,1,1] neg_lo:[1,0,0] neg_hi:[1,0,0]
v_pk_mul_f32 v[188:189], v[44:45], v[188:189] op_sel:[1,0] op_sel_hi:[1,1]
v_pk_mul_f32 v[190:191], v[44:45], v[190:191] op_sel:[1,0] op_sel_hi:[1,1]
v_cvt_pk_bf16_f32 v188, v188, v189
v_cvt_pk_bf16_f32 v189, v190, v191
ds_write_b64 v14, v[188:189] offset:38528
v_pk_fma_f32 v[224:225], v[44:45], v[60:61], v[224:225] op_sel_hi:[0,1,1] neg_lo:[1,0,0] neg_hi:[1,0,0]
v_pk_fma_f32 v[226:227], v[44:45], v[62:63], v[226:227] op_sel_hi:[0,1,1] neg_lo:[1,0,0] neg_hi:[1,0,0]
v_pk_mul_f32 v[224:225], v[44:45], v[224:225] op_sel:[1,0] op_sel_hi:[1,1]
v_pk_mul_f32 v[226:227], v[44:45], v[226:227] op_sel:[1,0] op_sel_hi:[1,1]
v_cvt_pk_bf16_f32 v224, v224, v225
v_cvt_pk_bf16_f32 v225, v226, v227
ds_write_b64 v14, v[224:225] offset:38656
v_pk_fma_f32 v[156:157], v[46:47], v[52:53], v[156:157] op_sel_hi:[0,1,1] neg_lo:[1,0,0] neg_hi:[1,0,0]
v_pk_fma_f32 v[158:159], v[46:47], v[54:55], v[158:159] op_sel_hi:[0,1,1] neg_lo:[1,0,0] neg_hi:[1,0,0]
v_pk_mul_f32 v[156:157], v[46:47], v[156:157] op_sel:[1,0] op_sel_hi:[1,1]
v_pk_mul_f32 v[158:159], v[46:47], v[158:159] op_sel:[1,0] op_sel_hi:[1,1]
v_cvt_pk_bf16_f32 v156, v156, v157
v_cvt_pk_bf16_f32 v157, v158, v159
ds_write_b64 v14, v[156:157] offset:44800
v_pk_fma_f32 v[192:193], v[46:47], v[56:57], v[192:193] op_sel_hi:[0,1,1] neg_lo:[1,0,0] neg_hi:[1,0,0]
v_pk_fma_f32 v[194:195], v[46:47], v[58:59], v[194:195] op_sel_hi:[0,1,1] neg_lo:[1,0,0] neg_hi:[1,0,0]
v_pk_mul_f32 v[192:193], v[46:47], v[192:193] op_sel:[1,0] op_sel_hi:[1,1]
v_pk_mul_f32 v[194:195], v[46:47], v[194:195] op_sel:[1,0] op_sel_hi:[1,1]
v_cvt_pk_bf16_f32 v192, v192, v193
v_cvt_pk_bf16_f32 v193, v194, v195
ds_write_b64 v14, v[192:193] offset:44928
v_pk_fma_f32 v[228:229], v[46:47], v[60:61], v[228:229] op_sel_hi:[0,1,1] neg_lo:[1,0,0] neg_hi:[1,0,0]
v_pk_fma_f32 v[230:231], v[46:47], v[62:63], v[230:231] op_sel_hi:[0,1,1] neg_lo:[1,0,0] neg_hi:[1,0,0]
v_pk_mul_f32 v[228:229], v[46:47], v[228:229] op_sel:[1,0] op_sel_hi:[1,1]
v_pk_mul_f32 v[230:231], v[46:47], v[230:231] op_sel:[1,0] op_sel_hi:[1,1]
v_cvt_pk_bf16_f32 v228, v228, v229
v_cvt_pk_bf16_f32 v229, v230, v231
ds_write_b64 v14, v[228:229] offset:45056
v_pk_fma_f32 v[160:161], v[48:49], v[52:53], v[160:161] op_sel_hi:[0,1,1] neg_lo:[1,0,0] neg_hi:[1,0,0]
v_pk_fma_f32 v[162:163], v[48:49], v[54:55], v[162:163] op_sel_hi:[0,1,1] neg_lo:[1,0,0] neg_hi:[1,0,0]
v_pk_mul_f32 v[160:161], v[48:49], v[160:161] op_sel:[1,0] op_sel_hi:[1,1]
v_pk_mul_f32 v[162:163], v[48:49], v[162:163] op_sel:[1,0] op_sel_hi:[1,1]
v_cvt_pk_bf16_f32 v160, v160, v161
v_cvt_pk_bf16_f32 v161, v162, v163
ds_write_b64 v14, v[160:161] offset:51200
v_pk_fma_f32 v[196:197], v[48:49], v[56:57], v[196:197] op_sel_hi:[0,1,1] neg_lo:[1,0,0] neg_hi:[1,0,0]
v_pk_fma_f32 v[198:199], v[48:49], v[58:59], v[198:199] op_sel_hi:[0,1,1] neg_lo:[1,0,0] neg_hi:[1,0,0]
v_pk_mul_f32 v[196:197], v[48:49], v[196:197] op_sel:[1,0] op_sel_hi:[1,1]
v_pk_mul_f32 v[198:199], v[48:49], v[198:199] op_sel:[1,0] op_sel_hi:[1,1]
v_cvt_pk_bf16_f32 v196, v196, v197
v_cvt_pk_bf16_f32 v197, v198, v199
ds_write_b64 v14, v[196:197] offset:51328
v_pk_fma_f32 v[232:233], v[48:49], v[60:61], v[232:233] op_sel_hi:[0,1,1] neg_lo:[1,0,0] neg_hi:[1,0,0]
v_pk_fma_f32 v[234:235], v[48:49], v[62:63], v[234:235] op_sel_hi:[0,1,1] neg_lo:[1,0,0] neg_hi:[1,0,0]
v_pk_mul_f32 v[232:233], v[48:49], v[232:233] op_sel:[1,0] op_sel_hi:[1,1]
v_pk_mul_f32 v[234:235], v[48:49], v[234:235] op_sel:[1,0] op_sel_hi:[1,1]
v_cvt_pk_bf16_f32 v232, v232, v233
v_cvt_pk_bf16_f32 v233, v234, v235
ds_write_b64 v14, v[232:233] offset:51456
s_waitcnt lgkmcnt(0)
s_branch Latt_4
Lpf_3:
s_load_dwordx2 s[26:27], s[0:1], 64
s_or_b32 s43, s34, s35
s_cmp_lg_u32 s43, 0
s_cbranch_scc1 Lz_21
s_add_u32 s84, s32, 28311552
s_addc_u32 s85, s33, 0
s_mov_b32 s86, 32768
s_mov_b32 s87, 0x20000
v_lshlrev_b32 v14, 7, v1
v_mov_b32 v36, 0
v_mov_b32 v37, 0
s_mov_b32 s43, 0
buffer_store_dwordx2 v[36:37], v14, s[84:87], s43 offen sc1
s_mov_b32 s43, 8192
buffer_store_dwordx2 v[36:37], v14, s[84:87], s43 offen sc1
s_mov_b32 s43, 16384
buffer_store_dwordx2 v[36:37], v14, s[84:87], s43 offen sc1
s_mov_b32 s43, 24576
buffer_store_dwordx2 v[36:37], v14, s[84:87], s43 offen sc1
Lz_21:
s_lshl_b32 s43, s51, 11
buffer_load_dwordx4 v[96:99], v10, s[8:11], s43 offen offset:0
buffer_load_dwordx4 v[100:103], v10, s[8:11], s43 offen offset:1024
buffer_load_dwordx4 v[104:107], v10, s[8:11], s43 offen offset:2048
buffer_load_dwordx4 v[108:111], v10, s[8:11], s43 offen offset:3072
v_min_u32 v14, 23, v1
v_lshrrev_b32 v15, 3, v14
v_mul_u32_u24 v15, 43008, v15
v_and_b32 v14, 7, v14
v_lshl_add_u32 v15, v14, 4, v15
v_mov_b32 v32, 0x3f803f80
v_mov_b32 v33, 0x3f803f80
v_mov_b32 v34, 0x3f803f80
v_mov_b32 v35, 0x3f803f80
ds_write_b128 v15, v[32:35]
v_add_u32 v14, 0, v1
v_min_u32 v14, 47, v14
v_mul_u32_u24 v15, 21846, v14
v_lshrrev_b32 v15, 16, v15
v_mul_u32_u24 v16, 3, v15
v_sub_u32 v16, v14, v16
s_mul_i32 s43, s48, 16
v_add_u32 v15, s43, v15
v_mul_u32_u24 v15, 6144, v15
v_lshl_add_u32 v2, v16, 11, v15
s_waitcnt lgkmcnt(0)
s_mov_b32 s56, s26
s_mov_b32 s57, s27
s_mov_b32 s58, 256
s_mov_b32 s59, 0x20000
v_lshlrev_b32 v14, 7, v1
s_barrier
s_cmp_ge_u32 s2, 128
s_cbranch_scc1 Lm_23
s_mov_b32 s84, s6
s_mov_b32 s85, s7
s_mov_b32 s86, 6291456
s_mov_b32 s87, 0x20000
s_mul_i32 s43, s2, 24576
buffer_load_dword v31, v14, s[84:87], s43 offen
s_add_u32 s43, s43, 8192
buffer_load_dword v31, v14, s[84:87], s43 offen
s_add_u32 s43, s43, 8192
buffer_load_dword v31, v14, s[84:87], s43 offen
Lm_23:
s_mov_b32 s84, s6
s_mov_b32 s85, s7
s_mov_b32 s86, 6291456
s_mov_b32 s87, 0x20000
s_lshr_b32 s44, s2, 3
s_lshr_b32 s43, s2, 5
s_cmp_eq_u32 s43, 3
s_cbranch_scc1 Lsj_24
s_cmp_gt_u32 s43, 3
s_cselect_b32 s43, 32, 0
s_sub_u32 s43, s2, s43
s_lshr_b32 s43, s43, 1
s_and_b32 s44, s2, 1
s_lshl_b32 s44, s44, 3
s_add_u32 s44, s44, 32
s_load_dwordx2 s[80:81], s[0:1], s44
s_mul_i32 s45, s43, 2341
s_lshr_b32 s45, s45, 16
s_mul_i32 s46, s45, 28
s_sub_u32 s46, s43, s46
s_lshl_b32 s45, s45, 8
s_mul_i32 s44, s47, 18
s_add_u32 s45, s45, s44
s_add_u32 s45, s45, 184
s_mul_i32 s45, s45, 7168
s_lshl_b32 s46, s46, 8
s_add_u32 s45, s45, s46
s_waitcnt lgkmcnt(0)
s_add_u32 s80, s80, s45
s_addc_u32 s81, s81, 0
Lsj_24:
s_barrier
s_cmp_ge_u32 s2, 128
s_cbranch_scc0 Lm_25
s_mov_b32 s84, s6
s_mov_b32 s85, s7
s_mov_b32 s86, 6291456
s_mov_b32 s87, 0x20000
s_mul_i32 s43, s2, 24576
buffer_load_dword v31, v14, s[84:87], s43 offen
s_add_u32 s43, s43, 8192
buffer_load_dword v31, v14, s[84:87], s43 offen
s_add_u32 s43, s43, 8192
buffer_load_dword v31, v14, s[84:87], s43 offen
Lm_25:
s_barrier
s_getpc_b64 s[88:89]
Lpc_26:
s_sub_u32 s88, s88, Lpc_26-sequential_preLN__sliding_local_dilated__glu_gated_geglu__prompt_kernel
s_subb_u32 s89, s89, 0
s_lshr_b32 s43, s2, 3
s_mul_i32 s43, s43, 3840
v_min_u32 v15, 29, v1
v_lshl_add_u32 v15, v15, 7, s43
v_min_u32 v15, Ldone_1-sequential_preLN__sliding_local_dilated__glu_gated_geglu__prompt_kernel, v15
global_load_dword v31, v15, s[88:89]
s_or_b32 s43, s34, s35
s_cmp_lg_u32 s43, 0
s_cbranch_scc1 Lz_27
s_waitcnt vmcnt(0)
v_mov_b32 v5, 1
v_mov_b32 v6, 0
s_mov_b64 exec, 1
buffer_store_dword v5, v6, s[56:59], 0 offen sc1
s_mov_b64 exec, -1
Lz_27:
s_waitcnt vmcnt(1)
v_lshlrev_b32 v116, 16, v96
v_and_b32 v117, 0xffff0000, v96
v_mul_f32 v118, v116, v116
v_mul_f32 v119, v117, v117
v_lshlrev_b32 v126, 16, v97
v_and_b32 v127, 0xffff0000, v97
v_add_f32 v116, v116, v126
v_add_f32 v117, v117, v127
v_fmac_f32 v118, v126, v126
v_fmac_f32 v119, v127, v127
v_lshlrev_b32 v124, 16, v98
v_and_b32 v125, 0xffff0000, v98
v_add_f32 v116, v116, v124
v_add_f32 v117, v117, v125
v_fmac_f32 v118, v124, v124
v_fmac_f32 v119, v125, v125
v_lshlrev_b32 v126, 16, v99
v_and_b32 v127, 0xffff0000, v99
v_add_f32 v116, v116, v126
v_add_f32 v117, v117, v127
v_fmac_f32 v118, v126, v126
v_fmac_f32 v119, v127, v127
v_lshlrev_b32 v124, 16, v100
v_and_b32 v125, 0xffff0000, v100
v_add_f32 v116, v116, v124
v_add_f32 v117, v117, v125
v_fmac_f32 v118, v124, v124
v_fmac_f32 v119, v125, v125
v_lshlrev_b32 v126, 16, v101
v_and_b32 v127, 0xffff0000, v101
v_add_f32 v116, v116, v126
v_add_f32 v117, v117, v127
v_fmac_f32 v118, v126, v126
v_fmac_f32 v119, v127, v127
v_lshlrev_b32 v124, 16, v102
v_and_b32 v125, 0xffff0000, v102
v_add_f32 v116, v116, v124
v_add_f32 v117, v117, v125
v_fmac_f32 v118, v124, v124
v_fmac_f32 v119, v125, v125
v_lshlrev_b32 v126, 16, v103
v_and_b32 v127, 0xffff0000, v103
v_add_f32 v116, v116, v126
v_add_f32 v117, v117, v127
v_fmac_f32 v118, v126, v126
v_fmac_f32 v119, v127, v127
v_lshlrev_b32 v120, 16, v104
v_and_b32 v121, 0xffff0000, v104
v_mul_f32 v122, v120, v120
v_mul_f32 v123, v121, v121
s_barrier
s_cmp_lt_u32 s2, 128
s_cbranch_scc1 Lm_28
s_mov_b32 s84, s6
s_mov_b32 s85, s7
s_mov_b32 s86, 6291456
s_mov_b32 s87, 0x20000
s_lshr_b32 s44, s2, 3
s_and_b32 s43, s35, 8
s_or_b32 s43, s43, 3
s_lshl_b32 s43, s43, 7
s_mul_i32 s45, s44, 196608
s_add_u32 s43, s43, s45
v_add_u32 v15, 0, v1
v_min_u32 v15, 95, v15
v_mul_u32_u24 v16, 21846, v15
v_lshrrev_b32 v16, 16, v16
v_mul_u32_u24 v17, 3, v16
v_sub_u32 v15, v15, v17
v_mul_u32_u24 v16, 6144, v16
v_lshl_add_u32 v15, v15, 11, v16
buffer_load_dword v31, v15, s[84:87], s43 offen
v_add_u32 v15, 64, v1
v_min_u32 v15, 95, v15
v_mul_u32_u24 v16, 21846, v15
v_lshrrev_b32 v16, 16, v16
v_mul_u32_u24 v17, 3, v16
v_sub_u32 v15, v15, v17
v_mul_u32_u24 v16, 6144, v16
v_lshl_add_u32 v15, v15, 11, v16
buffer_load_dword v31, v15, s[84:87], s43 offen
Lm_28:
v_lshlrev_b32 v126, 16, v105
v_and_b32 v127, 0xffff0000, v105
v_add_f32 v120, v120, v126
v_add_f32 v121, v121, v127
v_fmac_f32 v122, v126, v126
v_fmac_f32 v123, v127, v127
v_lshlrev_b32 v124, 16, v106
v_and_b32 v125, 0xffff0000, v106
v_add_f32 v120, v120, v124
v_add_f32 v121, v121, v125
v_fmac_f32 v122, v124, v124
v_fmac_f32 v123, v125, v125
v_lshlrev_b32 v126, 16, v107
v_and_b32 v127, 0xffff0000, v107
v_add_f32 v120, v120, v126
v_add_f32 v121, v121, v127
v_fmac_f32 v122, v126, v126
v_fmac_f32 v123, v127, v127
v_lshlrev_b32 v124, 16, v108
v_and_b32 v125, 0xffff0000, v108
v_add_f32 v120, v120, v124
v_add_f32 v121, v121, v125
v_fmac_f32 v122, v124, v124
v_fmac_f32 v123, v125, v125
v_lshlrev_b32 v126, 16, v109
v_and_b32 v127, 0xffff0000, v109
v_add_f32 v120, v120, v126
v_add_f32 v121, v121, v127
v_fmac_f32 v122, v126, v126
v_fmac_f32 v123, v127, v127
v_lshlrev_b32 v124, 16, v110
v_and_b32 v125, 0xffff0000, v110
v_add_f32 v120, v120, v124
v_add_f32 v121, v121, v125
v_fmac_f32 v122, v124, v124
v_fmac_f32 v123, v125, v125
v_lshlrev_b32 v126, 16, v111
v_and_b32 v127, 0xffff0000, v111
v_add_f32 v120, v120, v126
v_add_f32 v121, v121, v127
v_fmac_f32 v122, v126, v126
v_fmac_f32 v123, v127, v127
v_add_f32 v116, v116, v117
v_add_f32 v118, v118, v119
v_add_f32 v120, v120, v121
v_add_f32 v122, v122, v123
v_add_f32_dpp v116, v116, v116 row_ror:8 row_mask:0xf bank_mask:0xf
v_add_f32_dpp v118, v118, v118 row_ror:8 row_mask:0xf bank_mask:0xf
v_add_f32_dpp v120, v120, v120 row_ror:8 row_mask:0xf bank_mask:0xf
v_add_f32_dpp v122, v122, v122 row_ror:8 row_mask:0xf bank_mask:0xf
s_barrier
v_add_f32_dpp v116, v116, v116 row_ror:4 row_mask:0xf bank_mask:0xf
v_add_f32_dpp v118, v118, v118 row_ror:4 row_mask:0xf bank_mask:0xf
v_add_f32_dpp v120, v120, v120 row_ror:4 row_mask:0xf bank_mask:0xf
v_add_f32_dpp v122, v122, v122 row_ror:4 row_mask:0xf bank_mask:0xf
v_add_f32_dpp v116, v116, v116 row_ror:2 row_mask:0xf bank_mask:0xf
v_add_f32_dpp v118, v118, v118 row_ror:2 row_mask:0xf bank_mask:0xf
v_add_f32_dpp v120, v120, v120 row_ror:2 row_mask:0xf bank_mask:0xf
v_add_f32_dpp v122, v122, v122 row_ror:2 row_mask:0xf bank_mask:0xf
v_add_f32_dpp v116, v116, v116 row_ror:1 row_mask:0xf bank_mask:0xf
v_add_f32_dpp v118, v118, v118 row_ror:1 row_mask:0xf bank_mask:0xf
v_add_f32_dpp v120, v120, v120 row_ror:1 row_mask:0xf bank_mask:0xf
v_add_f32_dpp v122, v122, v122 row_ror:1 row_mask:0xf bank_mask:0xf
v_mov_b32 v117, v116
v_mov_b32 v119, v118
v_mov_b32 v121, v120
v_mov_b32 v123, v122
s_nop 0
v_permlane16_swap_b32 v116, v117
v_permlane16_swap_b32 v118, v119
v_permlane16_swap_b32 v120, v121
v_permlane16_swap_b32 v122, v123
v_add_f32 v116, v116, v117
v_add_f32 v118, v118, v119
v_add_f32 v120, v120, v121
v_add_f32 v122, v122, v123
v_mov_b32 v117, v116
v_mov_b32 v119, v118
v_mov_b32 v121, v120
v_mov_b32 v123, v122
s_nop 0
v_permlane32_swap_b32 v116, v117
v_permlane32_swap_b32 v118, v119
v_permlane32_swap_b32 v120, v121
v_permlane32_swap_b32 v122, v123
v_add_f32 v116, v116, v117
v_add_f32 v118, v118, v119
v_add_f32 v120, v120, v121
v_add_f32 v122, v122, v123
v_mul_f32 v112, 0x3a800000, v116
v_mul_f32 v113, 0x3a800000, v118
v_fma_f32 v113, -v112, v112, v113
v_max_f32 v113, 0, v113
v_add_f32 v113, 0x3727c5ac, v113
v_rsq_f32 v113, v113
v_mul_f32 v114, 0x3a800000, v120
v_mul_f32 v115, 0x3a800000, v122
v_fma_f32 v115, -v114, v114, v115
v_max_f32 v115, 0, v115
v_add_f32 v115, 0x3727c5ac, v115
v_rsq_f32 v115, v115
s_nop 0
s_lshl_b32 s43, s47, 4
s_add_u32 s43, s43, 130176
v_mov_b32 v11, s43
ds_write_b128 v11, v[112:115]
s_waitcnt lgkmcnt(0)
s_barrier
v_lshlrev_b32 v5, 4, v1
v_and_b32 v5, 63, v5
v_add_u32 v6, 130176, v5
ds_read_b128 v[112:115], v6
s_lshl_b32 s43, s63, 3
v_add_u32 v5, s43, v5
s_waitcnt lgkmcnt(0)
s_mov_b64 exec, 15
buffer_store_dwordx4 v[112:115], v5, s[20:23], 0 offen sc1
s_mov_b64 exec, -1
v_mov_b32 v7, 0
v_mov_b32 v9, 1
buffer_load_dword v8, v7, s[56:59], 0 offen sc1
s_load_dword s64, s[80:81], 0
s_load_dword s65, s[80:81], 64
s_load_dword s66, s[80:81], 128
s_load_dword s67, s[80:81], 192
s_load_dword s68, s[80:81], 7168
s_load_dword s69, s[80:81], 7232
s_load_dword s70, s[80:81], 7296
s_load_dword s71, s[80:81], 7360
s_add_u32 s80, s80, 14336
s_addc_u32 s81, s81, 0
s_barrier
s_load_dword s64, s[80:81], 0
s_load_dword s65, s[80:81], 64
s_load_dword s66, s[80:81], 128
s_load_dword s67, s[80:81], 192
s_load_dword s68, s[80:81], 7168
s_load_dword s69, s[80:81], 7232
s_load_dword s70, s[80:81], 7296
s_load_dword s71, s[80:81], 7360
s_add_u32 s80, s80, 14336
s_addc_u32 s81, s81, 0
s_barrier
s_mov_b32 s41, 0x10000
Lpoll_29:
s_waitcnt vmcnt(0)
Lpf_31:
v_cmp_ne_u32 vcc, v9, v8
s_nop 4
s_cbranch_vccz Lpok_30
buffer_load_dword v8, v7, s[56:59], 0 offen sc1
s_sub_u32 s41, s41, 1
s_cmp_lg_u32 s41, 0
s_cbranch_scc1 Lpoll_29
s_waitcnt vmcnt(0)
Lpok_30:
s_add_u32 s56, s32, 28311552
s_addc_u32 s57, s33, 0
s_mov_b32 s58, 32768
s_mov_b32 s59, 0x20000
s_add_u32 s43, s34, 80
s_lshl_b32 s43, s43, 7
v_mov_b32 v5, s43
v_mov_b32 v6, 1
s_mov_b64 exec, 1
buffer_atomic_add v6, v5, s[56:59], 0 offen sc1
s_mov_b64 exec, -1
s_load_dword s64, s[80:81], 0
s_load_dword s65, s[80:81], 64
s_load_dword s66, s[80:81], 128
s_load_dword s67, s[80:81], 192
s_load_dword s68, s[80:81], 7168
s_load_dword s69, s[80:81], 7232
s_load_dword s70, s[80:81], 7296
s_load_dword s71, s[80:81], 7360
s_add_u32 s80, s80, 14336
s_addc_u32 s81, s81, 0
s_barrier
s_load_dword s64, s[80:81], 0
s_load_dword s65, s[80:81], 64
s_load_dword s66, s[80:81], 128
s_load_dword s67, s[80:81], 192
s_load_dword s68, s[80:81], 7168
s_load_dword s69, s[80:81], 7232
s_load_dword s70, s[80:81], 7296
s_load_dword s71, s[80:81], 7360
s_add_u32 s80, s80, 14336
s_addc_u32 s81, s81, 0
s_barrier
s_load_dword s64, s[80:81], 0
s_load_dword s65, s[80:81], 64
s_load_dword s66, s[80:81], 128
s_load_dword s67, s[80:81], 192
s_load_dword s68, s[80:81], 7168
s_load_dword s69, s[80:81], 7232
s_load_dword s70, s[80:81], 7296
s_load_dword s71, s[80:81], 7360
s_add_u32 s80, s80, 14336
s_addc_u32 s81, s81, 0
s_barrier
s_getpc_b64 s[88:89]
Lpc_32:
s_sub_u32 s88, s88, Lpc_32-sequential_preLN__sliding_local_dilated__glu_gated_geglu__prompt_kernel
s_subb_u32 s89, s89, 0
s_lshr_b32 s43, s2, 3
s_mul_i32 s43, s43, 3840
v_min_u32 v15, 29, v1
v_lshl_add_u32 v15, v15, 7, s43
v_min_u32 v15, Ldone_1-sequential_preLN__sliding_local_dilated__glu_gated_geglu__prompt_kernel, v15
global_load_dword v31, v15, s[88:89]
s_sub_u32 s44, s34, 1
s_max_i32 s44, s44, 0
v_mov_b32 v5, s44
v_mov_b32 v6, s34
v_cmp_eq_u32 vcc, 0, v1
s_nop 1
v_cndmask_b32 v5, v5, v6, vcc
v_add_u32 v5, 80, v5
v_lshlrev_b32 v5, 7, v5
buffer_load_dword v6, v5, s[56:59], 0 offen sc1
s_load_dword s64, s[80:81], 0
s_load_dword s65, s[80:81], 64
s_load_dword s66, s[80:81], 128
s_load_dword s67, s[80:81], 192
s_load_dword s68, s[80:81], 7168
s_load_dword s69, s[80:81], 7232
s_load_dword s70, s[80:81], 7296
s_load_dword s71, s[80:81], 7360
s_add_u32 s80, s80, 14336
s_addc_u32 s81, s81, 0
s_barrier
s_load_dword s64, s[80:81], 0
s_load_dword s65, s[80:81], 64
s_load_dword s66, s[80:81], 128
s_load_dword s67, s[80:81], 192
s_load_dword s68, s[80:81], 7168
s_load_dword s69, s[80:81], 7232
s_load_dword s70, s[80:81], 7296
s_load_dword s71, s[80:81], 7360
s_add_u32 s80, s80, 14336
s_addc_u32 s81, s81, 0
s_barrier
s_mov_b32 s41, 200
s_mov_b32 s62, 0
s_waitcnt vmcnt(0)
Lpoll_33:
v_cmp_ne_u32 vcc, 16, v6
s_nop 4
s_cbranch_vccz Lok_34
buffer_load_dword v6, v5, s[56:59], 0 offen sc1
s_waitcnt vmcnt(0)
s_sub_u32 s41, s41, 1
s_cmp_lg_u32 s41, 0
s_cbranch_scc1 Lpoll_33
s_mov_b32 s41, 0
Lfb_35:
s_add_u32 s62, s50, s41
s_max_i32 s62, s62, 0
s_lshl_b32 s43, s62, 11
buffer_load_dwordx4 v[96:99], v10, s[8:11], s43 offen offset:0
buffer_load_dwordx4 v[100:103], v10, s[8:11], s43 offen offset:1024
buffer_load_dwordx4 v[104:107], v10, s[8:11], s43 offen offset:2048
buffer_load_dwordx4 v[108:111], v10, s[8:11], s43 offen offset:3072
s_waitcnt vmcnt(0)
v_lshlrev_b32 v116, 16, v96
v_and_b32 v117, 0xffff0000, v96
v_mul_f32 v118, v116, v116
v_mul_f32 v119, v117, v117
v_lshlrev_b32 v126, 16, v97
v_and_b32 v127, 0xffff0000, v97
v_add_f32 v116, v116, v126
v_add_f32 v117, v117, v127
v_fmac_f32 v118, v126, v126
v_fmac_f32 v119, v127, v127
v_lshlrev_b32 v124, 16, v98
v_and_b32 v125, 0xffff0000, v98
v_add_f32 v116, v116, v124
v_add_f32 v117, v117, v125
v_fmac_f32 v118, v124, v124
v_fmac_f32 v119, v125, v125
v_lshlrev_b32 v126, 16, v99
v_and_b32 v127, 0xffff0000, v99
v_add_f32 v116, v116, v126
v_add_f32 v117, v117, v127
v_fmac_f32 v118, v126, v126
v_fmac_f32 v119, v127, v127
v_lshlrev_b32 v124, 16, v100
v_and_b32 v125, 0xffff0000, v100
v_add_f32 v116, v116, v124
v_add_f32 v117, v117, v125
v_fmac_f32 v118, v124, v124
v_fmac_f32 v119, v125, v125
v_lshlrev_b32 v126, 16, v101
v_and_b32 v127, 0xffff0000, v101
v_add_f32 v116, v116, v126
v_add_f32 v117, v117, v127
v_fmac_f32 v118, v126, v126
v_fmac_f32 v119, v127, v127
v_lshlrev_b32 v124, 16, v102
v_and_b32 v125, 0xffff0000, v102
v_add_f32 v116, v116, v124
v_add_f32 v117, v117, v125
v_fmac_f32 v118, v124, v124
v_fmac_f32 v119, v125, v125
v_lshlrev_b32 v126, 16, v103
v_and_b32 v127, 0xffff0000, v103
v_add_f32 v116, v116, v126
v_add_f32 v117, v117, v127
v_fmac_f32 v118, v126, v126
v_fmac_f32 v119, v127, v127
v_lshlrev_b32 v120, 16, v104
v_and_b32 v121, 0xffff0000, v104
v_mul_f32 v122, v120, v120
v_mul_f32 v123, v121, v121
v_lshlrev_b32 v126, 16, v105
v_and_b32 v127, 0xffff0000, v105
v_add_f32 v120, v120, v126
v_add_f32 v121, v121, v127
v_fmac_f32 v122, v126, v126
v_fmac_f32 v123, v127, v127
v_lshlrev_b32 v124, 16, v106
v_and_b32 v125, 0xffff0000, v106
v_add_f32 v120, v120, v124
v_add_f32 v121, v121, v125
v_fmac_f32 v122, v124, v124
v_fmac_f32 v123, v125, v125
v_lshlrev_b32 v126, 16, v107
v_and_b32 v127, 0xffff0000, v107
v_add_f32 v120, v120, v126
v_add_f32 v121, v121, v127
v_fmac_f32 v122, v126, v126
v_fmac_f32 v123, v127, v127
v_lshlrev_b32 v124, 16, v108
v_and_b32 v125, 0xffff0000, v108
v_add_f32 v120, v120, v124
v_add_f32 v121, v121, v125
v_fmac_f32 v122, v124, v124
v_fmac_f32 v123, v125, v125
v_lshlrev_b32 v126, 16, v109
v_and_b32 v127, 0xffff0000, v109
v_add_f32 v120, v120, v126
v_add_f32 v121, v121, v127
v_fmac_f32 v122, v126, v126
v_fmac_f32 v123, v127, v127
v_lshlrev_b32 v124, 16, v110
v_and_b32 v125, 0xffff0000, v110
v_add_f32 v120, v120, v124
v_add_f32 v121, v121, v125
v_fmac_f32 v122, v124, v124
v_fmac_f32 v123, v125, v125
v_lshlrev_b32 v126, 16, v111
v_and_b32 v127, 0xffff0000, v111
v_add_f32 v120, v120, v126
v_add_f32 v121, v121, v127
v_fmac_f32 v122, v126, v126
v_fmac_f32 v123, v127, v127
v_add_f32 v116, v116, v117
v_add_f32 v118, v118, v119
v_add_f32 v120, v120, v121
v_add_f32 v122, v122, v123
v_add_f32_dpp v116, v116, v116 row_ror:8 row_mask:0xf bank_mask:0xf
v_add_f32_dpp v118, v118, v118 row_ror:8 row_mask:0xf bank_mask:0xf
v_add_f32_dpp v120, v120, v120 row_ror:8 row_mask:0xf bank_mask:0xf
v_add_f32_dpp v122, v122, v122 row_ror:8 row_mask:0xf bank_mask:0xf
v_add_f32_dpp v116, v116, v116 row_ror:4 row_mask:0xf bank_mask:0xf
v_add_f32_dpp v118, v118, v118 row_ror:4 row_mask:0xf bank_mask:0xf
v_add_f32_dpp v120, v120, v120 row_ror:4 row_mask:0xf bank_mask:0xf
v_add_f32_dpp v122, v122, v122 row_ror:4 row_mask:0xf bank_mask:0xf
v_add_f32_dpp v116, v116, v116 row_ror:2 row_mask:0xf bank_mask:0xf
v_add_f32_dpp v118, v118, v118 row_ror:2 row_mask:0xf bank_mask:0xf
v_add_f32_dpp v120, v120, v120 row_ror:2 row_mask:0xf bank_mask:0xf
v_add_f32_dpp v122, v122, v122 row_ror:2 row_mask:0xf bank_mask:0xf
v_add_f32_dpp v116, v116, v116 row_ror:1 row_mask:0xf bank_mask:0xf
v_add_f32_dpp v118, v118, v118 row_ror:1 row_mask:0xf bank_mask:0xf
v_add_f32_dpp v120, v120, v120 row_ror:1 row_mask:0xf bank_mask:0xf
v_add_f32_dpp v122, v122, v122 row_ror:1 row_mask:0xf bank_mask:0xf
v_mov_b32 v117, v116
v_mov_b32 v119, v118
v_mov_b32 v121, v120
v_mov_b32 v123, v122
s_nop 0
v_permlane16_swap_b32 v116, v117
v_permlane16_swap_b32 v118, v119
v_permlane16_swap_b32 v120, v121
v_permlane16_swap_b32 v122, v123
v_add_f32 v116, v116, v117
v_add_f32 v118, v118, v119
v_add_f32 v120, v120, v121
v_add_f32 v122, v122, v123
v_mov_b32 v117, v116
v_mov_b32 v119, v118
v_mov_b32 v121, v120
v_mov_b32 v123, v122
s_nop 0
v_permlane32_swap_b32 v116, v117
v_permlane32_swap_b32 v118, v119
v_permlane32_swap_b32 v120, v121
v_permlane32_swap_b32 v122, v123
v_add_f32 v116, v116, v117
v_add_f32 v118, v118, v119
v_add_f32 v120, v120, v121
v_add_f32 v122, v122, v123
v_mul_f32 v112, 0x3a800000, v116
v_mul_f32 v113, 0x3a800000, v118
v_fma_f32 v113, -v112, v112, v113
v_max_f32 v113, 0, v113
v_add_f32 v113, 0x3727c5ac, v113
v_rsq_f32 v113, v113
v_mul_f32 v114, 0x3a800000, v120
v_mul_f32 v115, 0x3a800000, v122
v_fma_f32 v115, -v114, v114, v115
v_max_f32 v115, 0, v115
v_add_f32 v115, 0x3727c5ac, v115
v_rsq_f32 v115, v115
s_nop 0
s_lshl_b32 s43, s41, 3
s_add_u32 s43, s43, 129024
v_mov_b32 v5, s43
ds_write_b128 v5, v[112:115]
s_add_u32 s41, s41, 2
s_cmp_lt_u32 s41, 144
s_cbranch_scc1 Lfb_35
s_mov_b32 s62, 1
Lok_34:
v_add_u32 v5, 0, v1
v_min_u32 v5, 143, v5
v_lshlrev_b32 v20, 3, v5
v_add_u32 v5, s50, v5
v_max_i32 v5, 0, v5
v_lshlrev_b32 v5, 3, v5
buffer_load_dwordx2 v[32:33], v5, s[20:23], 0 offen sc1
v_add_u32 v5, 64, v1
v_min_u32 v5, 143, v5
v_lshlrev_b32 v21, 3, v5
v_add_u32 v5, s50, v5
v_max_i32 v5, 0, v5
v_lshlrev_b32 v5, 3, v5
buffer_load_dwordx2 v[34:35], v5, s[20:23], 0 offen sc1
v_add_u32 v5, 128, v1
v_min_u32 v5, 143, v5
v_lshlrev_b32 v22, 3, v5
v_add_u32 v5, s50, v5
v_max_i32 v5, 0, v5
v_lshlrev_b32 v5, 3, v5
buffer_load_dwordx2 v[36:37], v5, s[20:23], 0 offen sc1
s_load_dword s64, s[80:81], 0
s_load_dword s65, s[80:81], 64
s_load_dword s66, s[80:81], 128
s_load_dword s67, s[80:81], 192
s_load_dword s68, s[80:81], 7168
s_load_dword s69, s[80:81], 7232
s_load_dword s70, s[80:81], 7296
s_load_dword s71, s[80:81], 7360
s_add_u32 s80, s80, 14336
s_addc_u32 s81, s81, 0
s_barrier
s_load_dwordx2 s[88:89], s[0:1], 16
v_lshlrev_b32 v29, 7, v1
s_lshl_b32 s43, s2, 13
s_waitcnt lgkmcnt(0)
s_mov_b32 s84, s88
s_mov_b32 s85, s89
s_mov_b32 s86, 2097152
s_mov_b32 s87, 0x20000
buffer_load_dword v30, v29, s[84:87], s43 offen
v_and_b32 v29, 31, v1
v_lshlrev_b32 v29, 11, v29
s_and_b32 s43, s35, 8
s_or_b32 s43, s43, 3
s_lshl_b32 s43, s43, 7
s_lshr_b32 s44, s2, 3
s_lshl_b32 s44, s44, 16
s_add_u32 s43, s43, s44
buffer_load_dword v30, v29, s[84:87], s43 offen
s_barrier
s_waitcnt vmcnt(2)
s_cmp_eq_u32 s62, 1
s_cbranch_scc1 Lgd_22
v_add_u32 v20, 129024, v20
ds_write_b64 v20, v[32:33]
v_add_u32 v21, 129024, v21
ds_write_b64 v21, v[34:35]
v_add_u32 v22, 129024, v22
ds_write_b64 v22, v[36:37]
Lgd_22:
s_waitcnt lgkmcnt(0)
s_lshr_b32 s43, s2, 5
s_cmp_eq_u32 s43, 3
s_cbranch_scc1 Lnj_36
s_cmp_gt_u32 s43, 3
s_cselect_b32 s43, 32, 0
s_sub_u32 s43, s2, s43
s_lshr_b32 s43, s43, 1
s_and_b32 s44, s2, 1
s_lshl_b32 s45, s44, 3
s_add_u32 s45, s45, 32
s_load_dwordx2 s[88:89], s[0:1], s45
s_mul_i32 s45, s43, 2341
s_lshr_b32 s45, s45, 16
s_mul_i32 s46, s45, 28
s_sub_u32 s46, s43, s46
v_lshrrev_b32 v28, 4, v1
s_lshl_b32 s43, s45, 8
v_add_u32 v28, s43, v28
v_mul_u32_u24 v28, 7168, v28
v_and_b32 v29, 15, v1
v_lshl_add_u32 v28, v29, 4, v28
s_lshl_b32 s43, s46, 8
v_add_u32 v28, s43, v28
s_waitcnt lgkmcnt(0)
s_mov_b32 s84, s88
s_mov_b32 s85, s89
s_mov_b32 s86, 7340032
s_mov_b32 s87, 0x20000
s_mov_b32 s43, 0
buffer_load_dwordx4 v[128:131], v28, s[84:87], s43 offen
s_mov_b32 s43, 28672
buffer_load_dwordx4 v[132:135], v28, s[84:87], s43 offen
s_mov_b32 s43, 57344
buffer_load_dwordx4 v[136:139], v28, s[84:87], s43 offen
s_mov_b32 s43, 86016
buffer_load_dwordx4 v[140:143], v28, s[84:87], s43 offen
s_mov_b32 s43, 114688
buffer_load_dwordx4 v[144:147], v28, s[84:87], s43 offen
s_mov_b32 s43, 143360
buffer_load_dwordx4 v[148:151], v28, s[84:87], s43 offen
s_mov_b32 s43, 172032
buffer_load_dwordx4 v[152:155], v28, s[84:87], s43 offen
s_mov_b32 s43, 200704
buffer_load_dwordx4 v[156:159], v28, s[84:87], s43 offen
s_mov_b32 s43, 229376
buffer_load_dwordx4 v[160:163], v28, s[84:87], s43 offen
s_mov_b32 s43, 258048
buffer_load_dwordx4 v[164:167], v28, s[84:87], s43 offen
s_mov_b32 s43, 286720
buffer_load_dwordx4 v[168:171], v28, s[84:87], s43 offen
s_mov_b32 s43, 315392
buffer_load_dwordx4 v[172:175], v28, s[84:87], s43 offen
s_mov_b32 s43, 344064
buffer_load_dwordx4 v[176:179], v28, s[84:87], s43 offen
s_mov_b32 s43, 372736
buffer_load_dwordx4 v[180:183], v28, s[84:87], s43 offen
s_mov_b32 s43, 401408
buffer_load_dwordx4 v[184:187], v28, s[84:87], s43 offen
s_mov_b32 s43, 430080
buffer_load_dwordx4 v[188:191], v28, s[84:87], s43 offen
Lnj_36:
s_barrier
s_lshr_b32 s43, s2, 5
s_cmp_eq_u32 s43, 3
s_cbranch_scc1 Lnj_37
s_cmp_gt_u32 s43, 3
s_cselect_b32 s43, 32, 0
s_sub_u32 s43, s2, s43
s_lshr_b32 s43, s43, 1
s_and_b32 s44, s2, 1
s_lshl_b32 s45, s44, 3
s_add_u32 s45, s45, 32
s_load_dwordx2 s[88:89], s[0:1], s45
s_mul_i32 s45, s43, 2341
s_lshr_b32 s45, s45, 16
s_mul_i32 s46, s45, 28
s_sub_u32 s46, s43, s46
v_lshrrev_b32 v28, 4, v1
s_lshl_b32 s43, s45, 8
v_add_u32 v28, s43, v28
v_mul_u32_u24 v28, 7168, v28
v_and_b32 v29, 15, v1
v_lshl_add_u32 v28, v29, 4, v28
s_lshl_b32 s43, s46, 8
v_add_u32 v28, s43, v28
s_waitcnt lgkmcnt(0)
s_mov_b32 s84, s88
s_mov_b32 s85, s89
s_mov_b32 s86, 7340032
s_mov_b32 s87, 0x20000
s_mov_b32 s43, 458752
buffer_load_dwordx4 v[192:195], v28, s[84:87], s43 offen
s_mov_b32 s43, 487424
buffer_load_dwordx4 v[196:199], v28, s[84:87], s43 offen
s_mov_b32 s43, 516096
buffer_load_dwordx4 v[200:203], v28, s[84:87], s43 offen
s_mov_b32 s43, 544768
buffer_load_dwordx4 v[204:207], v28, s[84:87], s43 offen
s_mov_b32 s43, 573440
buffer_load_dwordx4 v[208:211], v28, s[84:87], s43 offen
s_mov_b32 s43, 602112
buffer_load_dwordx4 v[212:215], v28, s[84:87], s43 offen
s_mov_b32 s43, 630784
buffer_load_dwordx4 v[216:219], v28, s[84:87], s43 offen
s_mov_b32 s43, 659456
buffer_load_dwordx4 v[220:223], v28, s[84:87], s43 offen
s_mov_b32 s43, 688128
buffer_load_dwordx4 v[224:227], v28, s[84:87], s43 offen
s_mov_b32 s43, 716800
buffer_load_dwordx4 v[228:231], v28, s[84:87], s43 offen
s_mov_b32 s43, 745472
buffer_load_dwordx4 v[232:235], v28, s[84:87], s43 offen
s_mov_b32 s43, 774144
buffer_load_dwordx4 v[236:239], v28, s[84:87], s43 offen
s_mov_b32 s43, 802816
buffer_load_dwordx4 v[240:243], v28, s[84:87], s43 offen
s_mov_b32 s43, 831488
buffer_load_dwordx4 v[244:247], v28, s[84:87], s43 offen
s_mov_b32 s43, 860160
buffer_load_dwordx4 v[248:251], v28, s[84:87], s43 offen
s_mov_b32 s43, 888832
buffer_load_dwordx4 v[252:255], v28, s[84:87], s43 offen
Lnj_37:
s_barrier
s_branch Lw_38
Lr_39:
s_branch Lw_40
Lr_41:
s_waitcnt lgkmcnt(0)
s_and_b32 s43, s36, 1
s_lshr_b32 s44, s36, 1
s_and_b32 s44, s44, 1
s_lshr_b32 s45, s36, 2
v_lshlrev_b32 v14, 2, v13
v_sub_u32 v14, v12, v14
v_subrev_u32 v15, 0, v14
v_cmp_ge_u32 s[52:53], 7, v15
v_add_u32 v15, 16, v15
v_cmp_ge_u32 s[84:85], 7, v15
v_subrev_u32 v15, 1, v14
v_cmp_ge_u32 s[54:55], 7, v15
v_add_u32 v15, 16, v15
v_cmp_ge_u32 s[86:87], 7, v15
v_subrev_u32 v15, 2, v14
v_cmp_ge_u32 s[56:57], 7, v15
v_add_u32 v15, 16, v15
v_cmp_ge_u32 s[88:89], 7, v15
v_subrev_u32 v15, 3, v14
v_cmp_ge_u32 s[58:59], 7, v15
v_add_u32 v15, 16, v15
v_cmp_ge_u32 s[90:91], 7, v15
s_lshl_b32 s46, s45, 6
s_add_u32 s46, s46, s44
s_add_u32 s46, s46, 16
v_lshl_add_u32 v14, v12, 1, s46
s_lshl_b32 s47, s43, 6
v_lshl_add_u32 v15, v13, 4, s47
v_mul_u32_u24 v20, 400, v14
v_add_u32 v20, v20, v15
v_subrev_u32 v16, 32, v14
v_max_i32 v16, 0, v16
v_mul_u32_u24 v21, 400, v16
v_add_u32 v21, v21, v15
v_lshrrev_b32 v16, 2, v12
v_lshl_add_u32 v16, v13, 2, v16
v_lshl_add_u32 v16, v16, 1, s46
v_and_b32 v17, 3, v1
v_lshl_add_u32 v17, v17, 3, s47
v_mul_u32_u24 v22, 400, v16
v_add_u32 v22, v22, v17
v_subrev_u32 v16, 32, v16
v_max_i32 v16, 0, v16
v_mul_u32_u24 v23, 400, v16
v_add_u32 v23, v23, v17
s_lshl_b32 s60, s43, 13
s_lshl_b32 s61, s45, 10
s_add_u32 s60, s60, s61
s_lshl_b32 s61, s44, 8
s_add_u32 s60, s60, s61
v_lshlrev_b32 v27, 11, v13
v_lshl_add_u32 v27, v12, 4, v27
v_add_u32 v27, s60, v27
v_mov_b32 v28, 0xff800000
s_mov_b32 s61, 0x3e8293ee
s_nop 2
s_or_b32 s62, s34, s45
s_cmp_lg_u32 s62, 0
s_cselect_b64 s[64:65], s[84:85], 0
s_cselect_b64 s[66:67], s[86:87], 0
s_cselect_b64 s[68:69], s[88:89], 0
s_cselect_b64 s[70:71], s[90:91], 0
.p2align 3
Latt_4:
s_barrier
ds_read_b128 v[32:35], v20 offset:0
ds_read_b128 v[36:39], v20 offset:128
ds_read_b128 v[40:43], v21 offset:128
ds_read_b128 v[80:83], v20 offset:12800
ds_read_b128 v[84:87], v20 offset:12928
ds_read_b128 v[88:91], v20 offset:128
ds_read_b64_tr_b16 v[44:45], v23 offset:256
ds_read_b64_tr_b16 v[46:47], v22 offset:256
ds_read_b64_tr_b16 v[48:49], v23 offset:288
ds_read_b64_tr_b16 v[50:51], v22 offset:288
ds_read_b64_tr_b16 v[92:93], v22 offset:256
ds_read_b64_tr_b16 v[94:95], v22 offset:13056
ds_read_b64_tr_b16 v[96:97], v22 offset:288
ds_read_b64_tr_b16 v[98:99], v22 offset:13088
s_waitcnt lgkmcnt(11)
v_mfma_f32_16x16x32_bf16 v[52:55], v[40:43], v[32:35], 0
v_mfma_f32_16x16x32_bf16 v[56:59], v[36:39], v[32:35], 0
s_waitcnt lgkmcnt(8)
v_mfma_f32_16x16x32_bf16 v[100:103], v[88:91], v[80:83], 0
v_mfma_f32_16x16x32_bf16 v[104:107], v[84:87], v[80:83], 0
s_nop 7
v_cndmask_b32 v52, v28, v52, s[64:65]
v_cndmask_b32 v100, v28, v100, s[84:85]
v_cndmask_b32 v53, v28, v53, s[66:67]
v_cndmask_b32 v101, v28, v101, s[86:87]
v_cndmask_b32 v54, v28, v54, s[68:69]
v_cndmask_b32 v102, v28, v102, s[88:89]
v_cndmask_b32 v55, v28, v55, s[70:71]
v_cndmask_b32 v103, v28, v103, s[90:91]
v_cndmask_b32 v56, v28, v56, s[52:53]
v_cndmask_b32 v104, v28, v104, s[52:53]
v_cndmask_b32 v57, v28, v57, s[54:55]
v_cndmask_b32 v105, v28, v105, s[54:55]
v_cndmask_b32 v58, v28, v58, s[56:57]
v_cndmask_b32 v106, v28, v106, s[56:57]
v_cndmask_b32 v59, v28, v59, s[58:59]
v_cndmask_b32 v107, v28, v107, s[58:59]
v_max3_f32 v60, v52, v53, v54
v_max3_f32 v108, v100, v101, v102
v_max3_f32 v61, v55, v56, v57
v_max3_f32 v109, v103, v104, v105
v_max3_f32 v60, v60, v58, v59
v_max3_f32 v108, v108, v106, v107
v_max_f32 v60, v60, v61
v_max_f32 v108, v108, v109
v_mov_b32 v61, v60
v_mov_b32 v109, v108
s_nop 0
v_permlane32_swap_b32 v60, v61
v_permlane32_swap_b32 v108, v109
v_max_f32 v60, v60, v61
v_max_f32 v108, v108, v109
v_mov_b32 v61, v60
v_mov_b32 v109, v108
s_nop 0
v_permlane16_swap_b32 v60, v61
v_permlane16_swap_b32 v108, v109
v_max_f32 v60, v60, v61
v_max_f32 v108, v108, v109
v_mul_f32 v60, s61, v60
v_mul_f32 v108, s61, v108
v_fma_f32 v52, v52, s61, -v60
v_fma_f32 v100, v100, s61, -v108
v_fma_f32 v53, v53, s61, -v60
v_fma_f32 v101, v101, s61, -v108
v_fma_f32 v54, v54, s61, -v60
v_fma_f32 v102, v102, s61, -v108
v_fma_f32 v55, v55, s61, -v60
v_fma_f32 v103, v103, s61, -v108
v_fma_f32 v56, v56, s61, -v60
v_fma_f32 v104, v104, s61, -v108
v_fma_f32 v57, v57, s61, -v60
v_fma_f32 v105, v105, s61, -v108
v_fma_f32 v58, v58, s61, -v60
v_fma_f32 v106, v106, s61, -v108
v_fma_f32 v59, v59, s61, -v60
v_fma_f32 v107, v107, s61, -v108
v_exp_f32 v52, v52
v_exp_f32 v100, v100
v_exp_f32 v53, v53
v_exp_f32 v101, v101
v_exp_f32 v54, v54
v_exp_f32 v102, v102
v_exp_f32 v55, v55
v_exp_f32 v103, v103
v_exp_f32 v56, v56
v_exp_f32 v104, v104
v_exp_f32 v57, v57
v_exp_f32 v105, v105
v_exp_f32 v58, v58
v_exp_f32 v106, v106
v_exp_f32 v59, v59
v_exp_f32 v107, v107
v_cvt_pk_bf16_f32 v64, v52, v53
v_cvt_pk_bf16_f32 v112, v100, v101
v_cvt_pk_bf16_f32 v65, v54, v55
v_cvt_pk_bf16_f32 v113, v102, v103
v_cvt_pk_bf16_f32 v66, v56, v57
v_cvt_pk_bf16_f32 v114, v104, v105
v_cvt_pk_bf16_f32 v67, v58, v59
v_cvt_pk_bf16_f32 v115, v106, v107
s_waitcnt lgkmcnt(0)
v_mfma_f32_16x16x32_bf16 v[68:71], v[44:47], v[64:67], 0
v_mfma_f32_16x16x32_bf16 v[72:75], v[48:51], v[64:67], 0
v_mfma_f32_16x16x32_bf16 v[116:119], v[92:95], v[112:115], 0
v_mfma_f32_16x16x32_bf16 v[120:123], v[96:99], v[112:115], 0
s_load_dwordx4 s[4:7], s[0:1], 32
s_load_dwordx2 s[28:29], s[0:1], 16
s_load_dwordx4 s[60:63], s[0:1], 48
v_add_f32 v60, v52, v53
v_add_f32 v108, v100, v101
v_add_f32 v61, v54, v55
v_add_f32 v109, v102, v103
v_add_f32 v56, v56, v57
v_add_f32 v104, v104, v105
v_add_f32 v58, v58, v59
v_add_f32 v106, v106, v107
v_add_f32 v60, v60, v61
v_add_f32 v108, v108, v109
v_add_f32 v56, v56, v58
v_add_f32 v104, v104, v106
v_add_f32 v60, v60, v56
v_add_f32 v108, v108, v104
v_mov_b32 v61, v60
v_mov_b32 v109, v108
s_nop 0
v_permlane32_swap_b32 v60, v61
v_permlane32_swap_b32 v108, v109
v_add_f32 v60, v60, v61
v_add_f32 v108, v108, v109
v_mov_b32 v61, v60
v_mov_b32 v109, v108
s_nop 0
v_permlane16_swap_b32 v60, v61
v_permlane16_swap_b32 v108, v109
v_add_f32 v60, v60, v61
v_add_f32 v108, v108, v109
v_rcp_f32 v60, v60
v_rcp_f32 v108, v108
s_nop 0
v_pk_mul_f32 v[68:69], v[60:61], v[68:69] op_sel_hi:[0,1]
v_pk_mul_f32 v[70:71], v[60:61], v[70:71] op_sel_hi:[0,1]
v_pk_mul_f32 v[72:73], v[60:61], v[72:73] op_sel_hi:[0,1]
v_pk_mul_f32 v[74:75], v[60:61], v[74:75] op_sel_hi:[0,1]
v_cvt_pk_bf16_f32 v68, v68, v69
v_cvt_pk_bf16_f32 v69, v70, v71
v_cvt_pk_bf16_f32 v70, v72, v73
v_cvt_pk_bf16_f32 v71, v74, v75
buffer_store_dwordx4 v[68:71], v27, s[16:19], 0 offen offset:0 sc1
v_pk_mul_f32 v[116:117], v[108:109], v[116:117] op_sel_hi:[0,1]
v_pk_mul_f32 v[118:119], v[108:109], v[118:119] op_sel_hi:[0,1]
v_pk_mul_f32 v[120:121], v[108:109], v[120:121] op_sel_hi:[0,1]
v_pk_mul_f32 v[122:123], v[108:109], v[122:123] op_sel_hi:[0,1]
v_cvt_pk_bf16_f32 v116, v116, v117
v_cvt_pk_bf16_f32 v117, v118, v119
v_cvt_pk_bf16_f32 v118, v120, v121
v_cvt_pk_bf16_f32 v119, v122, v123
buffer_store_dwordx4 v[116:119], v27, s[16:19], 0 offen offset:512 sc1
s_add_u32 s56, s32, 28311552
s_addc_u32 s57, s33, 0
s_mov_b32 s58, 32768
s_mov_b32 s59, 0x20000
v_and_b32 v17, 15, v1
v_lshrrev_b32 v18, 4, v1
s_lshr_b32 s46, s36, 1
s_and_b32 s46, s46, 1
s_and_b32 s47, s36, 1
s_and_b32 s51, s36, 3
s_bfe_u32 s49, s35, 0x20001
s_sub_u32 s43, 0, s49
s_and_b32 s43, s43, 3
s_cmp_ge_u32 s35, 8
s_cselect_b32 s49, s43, s49
s_lshl_b32 s49, s49, 2
s_lshr_b32 s43, s35, 3
s_lshl_b32 s43, s43, 1
s_add_u32 s49, s49, s43
s_and_b32 s43, s35, 1
s_add_u32 s49, s49, s43
s_waitcnt lgkmcnt(0)
s_cmp_ge_u32 s36, 4
s_cbranch_scc1 LG1_42
v_lshlrev_b32 v19, 11, v18
v_lshl_add_u32 v19, v17, 4, v19
s_lshl_b32 s43, s36, 9
v_add_u32 v2, s43, v19
v_add_u32 v4, 98304, v2
v_lshrrev_b32 v19, 2, v17
v_lshl_add_u32 v20, v18, 2, v19
v_bfe_u32 v21, v20, 1, 2
v_lshlrev_b32 v20, 7, v20
v_lshl_add_u32 v20, v21, 5, v20
v_and_b32 v19, 3, v1
v_lshl_add_u32 v20, v19, 3, v20
v_add_u32 v5, 0x10000, v20
v_xor_b32 v6, 32, v5
v_xor_b32 v7, 64, v5
v_xor_b32 v8, 96, v5
v_add_u32 v9, 0x10000, v5
v_add_u32 v10, 0x10000, v6
v_add_u32 v11, 0x10000, v7
v_add_u32 v12, 0x10000, v8
s_lshl_b32 s43, s34, 18
s_lshl_b32 s44, s35, 14
s_add_u32 s43, s43, s44
s_add_u32 s20, s32, s43
s_addc_u32 s21, s33, 0
s_add_u32 s20, s20, 4194304
s_addc_u32 s21, s21, 0
s_mov_b32 s22, 16384
s_mov_b32 s23, 0x20000
s_lshl_b32 s43, s34, 14
s_lshl_b32 s44, s35, 10
s_add_u32 s43, s43, s44
s_add_u32 s24, s32, s43
s_addc_u32 s25, s33, 0
s_add_u32 s24, s24, 25165824
s_addc_u32 s25, s25, 0
s_mov_b32 s26, 1024
s_mov_b32 s27, 0x20000
s_movk_i32 s50, 0x2000
v_lshrrev_b32 v19, 1, v18
v_lshl_add_u32 v19, v19, 4, v17
s_lshl_b32 s43, s36, 5
v_add_u32 v19, s43, v19
v_and_b32 v20, 1, v18
v_lshlrev_b32 v20, 2, v20
v_lshl_add_u32 v22, v19, 3, v20
s_lshl_b32 s43, s34, 18
s_add_u32 s12, s32, s43
s_addc_u32 s13, s33, 0
s_mov_b32 s14, 262144
s_mov_b32 s15, 0x20000
v_lshlrev_b32 v21, 4, v1
s_lshl_b32 s54, s36, 11
s_add_u32 s43, s35, 1
s_and_b32 s43, s43, 15
s_lshl_b32 s43, s43, 14
s_add_u32 s30, s43, s54
s_add_u32 s43, s35, 2
s_and_b32 s43, s43, 15
s_lshl_b32 s43, s43, 14
s_add_u32 s31, s43, s54
s_waitcnt vmcnt(0)
s_barrier
ds_write_b128 v27, v[68:71] offset:0
ds_write_b128 v27, v[116:119] offset:512
v_permlane16_swap_b32 v240, v242
v_permlane16_swap_b32 v241, v243
v_permlane16_swap_b32 v244, v246
v_permlane16_swap_b32 v245, v247
v_permlane16_swap_b32 v248, v250
v_permlane16_swap_b32 v249, v251
v_permlane16_swap_b32 v252, v254
v_permlane16_swap_b32 v253, v255
v_lshlrev_b32 v128, 16, v240
v_and_b32 v129, 0xffff0000, v240
v_lshlrev_b32 v130, 16, v241
v_and_b32 v131, 0xffff0000, v241
v_lshlrev_b32 v132, 16, v242
v_and_b32 v133, 0xffff0000, v242
v_lshlrev_b32 v134, 16, v243
v_and_b32 v135, 0xffff0000, v243
v_lshlrev_b32 v136, 16, v244
v_and_b32 v137, 0xffff0000, v244
v_lshlrev_b32 v138, 16, v245
v_and_b32 v139, 0xffff0000, v245
v_lshlrev_b32 v140, 16, v246
v_and_b32 v141, 0xffff0000, v246
v_lshlrev_b32 v142, 16, v247
v_and_b32 v143, 0xffff0000, v247
v_lshlrev_b32 v144, 16, v248
v_and_b32 v145, 0xffff0000, v248
v_lshlrev_b32 v146, 16, v249
v_and_b32 v147, 0xffff0000, v249
v_lshlrev_b32 v148, 16, v250
v_and_b32 v149, 0xffff0000, v250
v_lshlrev_b32 v150, 16, v251
v_and_b32 v151, 0xffff0000, v251
v_lshlrev_b32 v152, 16, v252
v_and_b32 v153, 0xffff0000, v252
v_lshlrev_b32 v154, 16, v253
v_and_b32 v155, 0xffff0000, v253
v_lshlrev_b32 v156, 16, v254
v_and_b32 v157, 0xffff0000, v254
v_lshlrev_b32 v158, 16, v255
v_and_b32 v159, 0xffff0000, v255
s_waitcnt lgkmcnt(0)
s_barrier
s_add_u32 m0, s54, 16384
s_add_u32 s43, s30, 0
buffer_load_dwordx4 v21, s[12:15], s43 offen sc1 lds
s_add_u32 m0, s54, 17408
s_add_u32 s43, s30, 1024
buffer_load_dwordx4 v21, s[12:15], s43 offen sc1 lds
s_add_u32 m0, s54, 32768
s_add_u32 s43, s31, 0
buffer_load_dwordx4 v21, s[12:15], s43 offen sc1 lds
s_add_u32 m0, s54, 33792
s_add_u32 s43, s31, 1024
buffer_load_dwordx4 v21, s[12:15], s43 offen sc1 lds
ds_read_b128 v[32:35], v2 offset:0
ds_read_b64_tr_b16 v[48:49], v5 offset:0
ds_read_b64_tr_b16 v[50:51], v5 offset:2048
ds_read_b64_tr_b16 v[52:53], v6 offset:0
ds_read_b64_tr_b16 v[54:55], v6 offset:2048
ds_read_b128 v[36:39], v2 offset:256
ds_read_b64_tr_b16 v[56:57], v7 offset:0
ds_read_b64_tr_b16 v[58:59], v7 offset:2048
ds_read_b64_tr_b16 v[60:61], v8 offset:0
ds_read_b64_tr_b16 v[62:63], v8 offset:2048
ds_read_b128 v[40:43], v2 offset:8192
ds_read_b64_tr_b16 v[64:65], v5 offset:4096
ds_read_b64_tr_b16 v[66:67], v5 offset:6144
ds_read_b64_tr_b16 v[68:69], v6 offset:4096
ds_read_b64_tr_b16 v[70:71], v6 offset:6144
ds_read_b128 v[44:47], v2 offset:8448
ds_read_b64_tr_b16 v[72:73], v7 offset:4096
ds_read_b64_tr_b16 v[74:75], v7 offset:6144
ds_read_b64_tr_b16 v[76:77], v8 offset:4096
ds_read_b64_tr_b16 v[78:79], v8 offset:6144
s_waitcnt lgkmcnt(0)
v_mfma_f32_16x16x32_bf16 v[128:131], v[48:51], v[32:35], v[128:131]
v_mfma_f32_16x16x32_bf16 v[132:135], v[52:55], v[32:35], v[132:135]
v_mfma_f32_16x16x32_bf16 v[136:139], v[56:59], v[32:35], v[136:139]
v_mfma_f32_16x16x32_bf16 v[140:143], v[60:63], v[32:35], v[140:143]
v_mfma_f32_16x16x32_bf16 v[144:147], v[48:51], v[36:39], v[144:147]
v_mfma_f32_16x16x32_bf16 v[148:151], v[52:55], v[36:39], v[148:151]
v_mfma_f32_16x16x32_bf16 v[152:155], v[56:59], v[36:39], v[152:155]
v_mfma_f32_16x16x32_bf16 v[156:159], v[60:63], v[36:39], v[156:159]
v_mfma_f32_16x16x32_bf16 v[128:131], v[64:67], v[40:43], v[128:131]
v_mfma_f32_16x16x32_bf16 v[132:135], v[68:71], v[40:43], v[132:135]
v_mfma_f32_16x16x32_bf16 v[136:139], v[72:75], v[40:43], v[136:139]
v_mfma_f32_16x16x32_bf16 v[140:143], v[76:79], v[40:43], v[140:143]
v_mfma_f32_16x16x32_bf16 v[144:147], v[64:67], v[44:47], v[144:147]
v_mfma_f32_16x16x32_bf16 v[148:151], v[68:71], v[44:47], v[148:151]
v_mfma_f32_16x16x32_bf16 v[152:155], v[72:75], v[44:47], v[152:155]
v_mfma_f32_16x16x32_bf16 v[156:159], v[76:79], v[44:47], v[156:159]
s_waitcnt vmcnt(2)
s_barrier
ds_read_b128 v[80:83], v2 offset:16384
ds_read_b64_tr_b16 v[96:97], v5 offset:8192
ds_read_b64_tr_b16 v[98:99], v5 offset:10240
ds_read_b64_tr_b16 v[100:101], v6 offset:8192
ds_read_b64_tr_b16 v[102:103], v6 offset:10240
ds_read_b128 v[84:87], v2 offset:16640
ds_read_b64_tr_b16 v[104:105], v7 offset:8192
ds_read_b64_tr_b16 v[106:107], v7 offset:10240
ds_read_b64_tr_b16 v[108:109], v8 offset:8192
ds_read_b64_tr_b16 v[110:111], v8 offset:10240
ds_read_b128 v[88:91], v2 offset:24576
ds_read_b64_tr_b16 v[112:113], v5 offset:12288
ds_read_b64_tr_b16 v[114:115], v5 offset:14336
ds_read_b64_tr_b16 v[116:117], v6 offset:12288
ds_read_b64_tr_b16 v[118:119], v6 offset:14336
ds_read_b128 v[92:95], v2 offset:24832
ds_read_b64_tr_b16 v[120:121], v7 offset:12288
ds_read_b64_tr_b16 v[122:123], v7 offset:14336
ds_read_b64_tr_b16 v[124:125], v8 offset:12288
ds_read_b64_tr_b16 v[126:127], v8 offset:14336
s_waitcnt vmcnt(0) lgkmcnt(0)
s_barrier
v_mfma_f32_16x16x32_bf16 v[128:131], v[96:99], v[80:83], v[128:131]
ds_read_b128 v[32:35], v2 offset:32768
ds_read_b64_tr_b16 v[48:49], v5 offset:16384
v_mfma_f32_16x16x32_bf16 v[132:135], v[100:103], v[80:83], v[132:135]
ds_read_b64_tr_b16 v[50:51], v5 offset:18432
v_mfma_f32_16x16x32_bf16 v[136:139], v[104:107], v[80:83], v[136:139]
ds_read_b64_tr_b16 v[52:53], v6 offset:16384
v_mfma_f32_16x16x32_bf16 v[140:143], v[108:111], v[80:83], v[140:143]
ds_read_b64_tr_b16 v[54:55], v6 offset:18432
v_mfma_f32_16x16x32_bf16 v[144:147], v[96:99], v[84:87], v[144:147]
ds_read_b128 v[36:39], v2 offset:33024
ds_read_b64_tr_b16 v[56:57], v7 offset:16384
v_mfma_f32_16x16x32_bf16 v[148:151], v[100:103], v[84:87], v[148:151]
ds_read_b64_tr_b16 v[58:59], v7 offset:18432
v_mfma_f32_16x16x32_bf16 v[152:155], v[104:107], v[84:87], v[152:155]
ds_read_b64_tr_b16 v[60:61], v8 offset:16384
v_mfma_f32_16x16x32_bf16 v[156:159], v[108:111], v[84:87], v[156:159]
ds_read_b64_tr_b16 v[62:63], v8 offset:18432
v_mfma_f32_16x16x32_bf16 v[128:131], v[112:115], v[88:91], v[128:131]
ds_read_b128 v[40:43], v2 offset:40960
ds_read_b64_tr_b16 v[64:65], v5 offset:20480
v_mfma_f32_16x16x32_bf16 v[132:135], v[116:119], v[88:91], v[132:135]
ds_read_b64_tr_b16 v[66:67], v5 offset:22528
v_mfma_f32_16x16x32_bf16 v[136:139], v[120:123], v[88:91], v[136:139]
ds_read_b64_tr_b16 v[68:69], v6 offset:20480
v_mfma_f32_16x16x32_bf16 v[140:143], v[124:127], v[88:91], v[140:143]
ds_read_b64_tr_b16 v[70:71], v6 offset:22528
v_mfma_f32_16x16x32_bf16 v[144:147], v[112:115], v[92:95], v[144:147]
ds_read_b128 v[44:47], v2 offset:41216
ds_read_b64_tr_b16 v[72:73], v7 offset:20480
v_mfma_f32_16x16x32_bf16 v[148:151], v[116:119], v[92:95], v[148:151]
ds_read_b64_tr_b16 v[74:75], v7 offset:22528
v_mfma_f32_16x16x32_bf16 v[152:155], v[120:123], v[92:95], v[152:155]
ds_read_b64_tr_b16 v[76:77], v8 offset:20480
v_mfma_f32_16x16x32_bf16 v[156:159], v[124:127], v[92:95], v[156:159]
ds_read_b64_tr_b16 v[78:79], v8 offset:22528
s_waitcnt lgkmcnt(0)
s_barrier
v_mfma_f32_16x16x32_bf16 v[128:131], v[48:51], v[32:35], v[128:131]
ds_read_b128 v[80:83], v2 offset:49152
ds_read_b64_tr_b16 v[96:97], v5 offset:24576
v_mfma_f32_16x16x32_bf16 v[132:135], v[52:55], v[32:35], v[132:135]
ds_read_b64_tr_b16 v[98:99], v5 offset:26624
v_mfma_f32_16x16x32_bf16 v[136:139], v[56:59], v[32:35], v[136:139]
ds_read_b64_tr_b16 v[100:101], v6 offset:24576
v_mfma_f32_16x16x32_bf16 v[140:143], v[60:63], v[32:35], v[140:143]
ds_read_b64_tr_b16 v[102:103], v6 offset:26624
v_mfma_f32_16x16x32_bf16 v[144:147], v[48:51], v[36:39], v[144:147]
ds_read_b128 v[84:87], v2 offset:49408
ds_read_b64_tr_b16 v[104:105], v7 offset:24576
v_mfma_f32_16x16x32_bf16 v[148:151], v[52:55], v[36:39], v[148:151]
ds_read_b64_tr_b16 v[106:107], v7 offset:26624
v_mfma_f32_16x16x32_bf16 v[152:155], v[56:59], v[36:39], v[152:155]
ds_read_b64_tr_b16 v[108:109], v8 offset:24576
v_mfma_f32_16x16x32_bf16 v[156:159], v[60:63], v[36:39], v[156:159]
ds_read_b64_tr_b16 v[110:111], v8 offset:26624
v_mfma_f32_16x16x32_bf16 v[128:131], v[64:67], v[40:43], v[128:131]
ds_read_b128 v[88:91], v2 offset:57344
ds_read_b64_tr_b16 v[112:113], v5 offset:28672
v_mfma_f32_16x16x32_bf16 v[132:135], v[68:71], v[40:43], v[132:135]
ds_read_b64_tr_b16 v[114:115], v5 offset:30720
v_mfma_f32_16x16x32_bf16 v[136:139], v[72:75], v[40:43], v[136:139]
ds_read_b64_tr_b16 v[116:117], v6 offset:28672
v_mfma_f32_16x16x32_bf16 v[140:143], v[76:79], v[40:43], v[140:143]
ds_read_b64_tr_b16 v[118:119], v6 offset:30720
v_mfma_f32_16x16x32_bf16 v[144:147], v[64:67], v[44:47], v[144:147]
ds_read_b128 v[92:95], v2 offset:57600
ds_read_b64_tr_b16 v[120:121], v7 offset:28672
v_mfma_f32_16x16x32_bf16 v[148:151], v[68:71], v[44:47], v[148:151]
ds_read_b64_tr_b16 v[122:123], v7 offset:30720
v_mfma_f32_16x16x32_bf16 v[152:155], v[72:75], v[44:47], v[152:155]
ds_read_b64_tr_b16 v[124:125], v8 offset:28672
v_mfma_f32_16x16x32_bf16 v[156:159], v[76:79], v[44:47], v[156:159]
ds_read_b64_tr_b16 v[126:127], v8 offset:30720
s_waitcnt lgkmcnt(0)
s_barrier
v_mfma_f32_16x16x32_bf16 v[128:131], v[96:99], v[80:83], v[128:131]
ds_read_b128 v[32:35], v2 offset:0
ds_read_b64_tr_b16 v[48:49], v5 offset:32768
v_mfma_f32_16x16x32_bf16 v[132:135], v[100:103], v[80:83], v[132:135]
ds_read_b64_tr_b16 v[50:51], v5 offset:34816
v_mfma_f32_16x16x32_bf16 v[136:139], v[104:107], v[80:83], v[136:139]
ds_read_b64_tr_b16 v[52:53], v6 offset:32768
v_mfma_f32_16x16x32_bf16 v[140:143], v[108:111], v[80:83], v[140:143]
ds_read_b64_tr_b16 v[54:55], v6 offset:34816
v_mfma_f32_16x16x32_bf16 v[144:147], v[96:99], v[84:87], v[144:147]
ds_read_b128 v[36:39], v2 offset:256
ds_read_b64_tr_b16 v[56:57], v7 offset:32768
v_mfma_f32_16x16x32_bf16 v[148:151], v[100:103], v[84:87], v[148:151]
ds_read_b64_tr_b16 v[58:59], v7 offset:34816
v_mfma_f32_16x16x32_bf16 v[152:155], v[104:107], v[84:87], v[152:155]
ds_read_b64_tr_b16 v[60:61], v8 offset:32768
v_mfma_f32_16x16x32_bf16 v[156:159], v[108:111], v[84:87], v[156:159]
ds_read_b64_tr_b16 v[62:63], v8 offset:34816
v_mfma_f32_16x16x32_bf16 v[128:131], v[112:115], v[88:91], v[128:131]
ds_read_b128 v[40:43], v2 offset:8192
ds_read_b64_tr_b16 v[64:65], v5 offset:36864
v_mfma_f32_16x16x32_bf16 v[132:135], v[116:119], v[88:91], v[132:135]
ds_read_b64_tr_b16 v[66:67], v5 offset:38912
v_mfma_f32_16x16x32_bf16 v[136:139], v[120:123], v[88:91], v[136:139]
ds_read_b64_tr_b16 v[68:69], v6 offset:36864
v_mfma_f32_16x16x32_bf16 v[140:143], v[124:127], v[88:91], v[140:143]
ds_read_b64_tr_b16 v[70:71], v6 offset:38912
v_mfma_f32_16x16x32_bf16 v[144:147], v[112:115], v[92:95], v[144:147]
ds_read_b128 v[44:47], v2 offset:8448
ds_read_b64_tr_b16 v[72:73], v7 offset:36864
v_mfma_f32_16x16x32_bf16 v[148:151], v[116:119], v[92:95], v[148:151]
ds_read_b64_tr_b16 v[74:75], v7 offset:38912
v_mfma_f32_16x16x32_bf16 v[152:155], v[120:123], v[92:95], v[152:155]
ds_read_b64_tr_b16 v[76:77], v8 offset:36864
v_mfma_f32_16x16x32_bf16 v[156:159], v[124:127], v[92:95], v[156:159]
ds_read_b64_tr_b16 v[78:79], v8 offset:38912
s_waitcnt lgkmcnt(0)
s_barrier
v_mfma_f32_16x16x32_bf16 v[128:131], v[48:51], v[32:35], v[128:131]
ds_read_b128 v[80:83], v2 offset:16384
ds_read_b64_tr_b16 v[96:97], v5 offset:40960
v_mfma_f32_16x16x32_bf16 v[132:135], v[52:55], v[32:35], v[132:135]
ds_read_b64_tr_b16 v[98:99], v5 offset:43008
v_mfma_f32_16x16x32_bf16 v[136:139], v[56:59], v[32:35], v[136:139]
ds_read_b64_tr_b16 v[100:101], v6 offset:40960
v_mfma_f32_16x16x32_bf16 v[140:143], v[60:63], v[32:35], v[140:143]
ds_read_b64_tr_b16 v[102:103], v6 offset:43008
v_mfma_f32_16x16x32_bf16 v[144:147], v[48:51], v[36:39], v[144:147]
ds_read_b128 v[84:87], v2 offset:16640
ds_read_b64_tr_b16 v[104:105], v7 offset:40960
v_mfma_f32_16x16x32_bf16 v[148:151], v[52:55], v[36:39], v[148:151]
ds_read_b64_tr_b16 v[106:107], v7 offset:43008
v_mfma_f32_16x16x32_bf16 v[152:155], v[56:59], v[36:39], v[152:155]
ds_read_b64_tr_b16 v[108:109], v8 offset:40960
v_mfma_f32_16x16x32_bf16 v[156:159], v[60:63], v[36:39], v[156:159]
ds_read_b64_tr_b16 v[110:111], v8 offset:43008
v_mfma_f32_16x16x32_bf16 v[128:131], v[64:67], v[40:43], v[128:131]
ds_read_b128 v[88:91], v2 offset:24576
ds_read_b64_tr_b16 v[112:113], v5 offset:45056
v_mfma_f32_16x16x32_bf16 v[132:135], v[68:71], v[40:43], v[132:135]
ds_read_b64_tr_b16 v[114:115], v5 offset:47104
v_mfma_f32_16x16x32_bf16 v[136:139], v[72:75], v[40:43], v[136:139]
ds_read_b64_tr_b16 v[116:117], v6 offset:45056
v_mfma_f32_16x16x32_bf16 v[140:143], v[76:79], v[40:43], v[140:143]
ds_read_b64_tr_b16 v[118:119], v6 offset:47104
v_mfma_f32_16x16x32_bf16 v[144:147], v[64:67], v[44:47], v[144:147]
ds_read_b128 v[92:95], v2 offset:24832
ds_read_b64_tr_b16 v[120:121], v7 offset:45056
v_mfma_f32_16x16x32_bf16 v[148:151], v[68:71], v[44:47], v[148:151]
ds_read_b64_tr_b16 v[122:123], v7 offset:47104
v_mfma_f32_16x16x32_bf16 v[152:155], v[72:75], v[44:47], v[152:155]
ds_read_b64_tr_b16 v[124:125], v8 offset:45056
v_mfma_f32_16x16x32_bf16 v[156:159], v[76:79], v[44:47], v[156:159]
ds_read_b64_tr_b16 v[126:127], v8 offset:47104
s_waitcnt lgkmcnt(0)
s_barrier
v_mfma_f32_16x16x32_bf16 v[128:131], v[96:99], v[80:83], v[128:131]
ds_read_b128 v[32:35], v2 offset:32768
ds_read_b64_tr_b16 v[48:49], v5 offset:49152
v_mfma_f32_16x16x32_bf16 v[132:135], v[100:103], v[80:83], v[132:135]
ds_read_b64_tr_b16 v[50:51], v5 offset:51200
v_mfma_f32_16x16x32_bf16 v[136:139], v[104:107], v[80:83], v[136:139]
ds_read_b64_tr_b16 v[52:53], v6 offset:49152
v_mfma_f32_16x16x32_bf16 v[140:143], v[108:111], v[80:83], v[140:143]
ds_read_b64_tr_b16 v[54:55], v6 offset:51200
v_mfma_f32_16x16x32_bf16 v[144:147], v[96:99], v[84:87], v[144:147]
ds_read_b128 v[36:39], v2 offset:33024
ds_read_b64_tr_b16 v[56:57], v7 offset:49152
v_mfma_f32_16x16x32_bf16 v[148:151], v[100:103], v[84:87], v[148:151]
ds_read_b64_tr_b16 v[58:59], v7 offset:51200
v_mfma_f32_16x16x32_bf16 v[152:155], v[104:107], v[84:87], v[152:155]
ds_read_b64_tr_b16 v[60:61], v8 offset:49152
v_mfma_f32_16x16x32_bf16 v[156:159], v[108:111], v[84:87], v[156:159]
ds_read_b64_tr_b16 v[62:63], v8 offset:51200
v_mfma_f32_16x16x32_bf16 v[128:131], v[112:115], v[88:91], v[128:131]
ds_read_b128 v[40:43], v2 offset:40960
ds_read_b64_tr_b16 v[64:65], v5 offset:53248
v_mfma_f32_16x16x32_bf16 v[132:135], v[116:119], v[88:91], v[132:135]
ds_read_b64_tr_b16 v[66:67], v5 offset:55296
v_mfma_f32_16x16x32_bf16 v[136:139], v[120:123], v[88:91], v[136:139]
ds_read_b64_tr_b16 v[68:69], v6 offset:53248
v_mfma_f32_16x16x32_bf16 v[140:143], v[124:127], v[88:91], v[140:143]
ds_read_b64_tr_b16 v[70:71], v6 offset:55296
v_mfma_f32_16x16x32_bf16 v[144:147], v[112:115], v[92:95], v[144:147]
ds_read_b128 v[44:47], v2 offset:41216
ds_read_b64_tr_b16 v[72:73], v7 offset:53248
v_mfma_f32_16x16x32_bf16 v[148:151], v[116:119], v[92:95], v[148:151]
ds_read_b64_tr_b16 v[74:75], v7 offset:55296
v_mfma_f32_16x16x32_bf16 v[152:155], v[120:123], v[92:95], v[152:155]
ds_read_b64_tr_b16 v[76:77], v8 offset:53248
v_mfma_f32_16x16x32_bf16 v[156:159], v[124:127], v[92:95], v[156:159]
ds_read_b64_tr_b16 v[78:79], v8 offset:55296
s_waitcnt lgkmcnt(0)
s_barrier
v_mfma_f32_16x16x32_bf16 v[128:131], v[48:51], v[32:35], v[128:131]
ds_read_b128 v[80:83], v2 offset:49152
ds_read_b64_tr_b16 v[96:97], v5 offset:57344
v_mfma_f32_16x16x32_bf16 v[132:135], v[52:55], v[32:35], v[132:135]
ds_read_b64_tr_b16 v[98:99], v5 offset:59392
v_mfma_f32_16x16x32_bf16 v[136:139], v[56:59], v[32:35], v[136:139]
ds_read_b64_tr_b16 v[100:101], v6 offset:57344
v_mfma_f32_16x16x32_bf16 v[140:143], v[60:63], v[32:35], v[140:143]
ds_read_b64_tr_b16 v[102:103], v6 offset:59392
v_mfma_f32_16x16x32_bf16 v[144:147], v[48:51], v[36:39], v[144:147]
ds_read_b128 v[84:87], v2 offset:49408
ds_read_b64_tr_b16 v[104:105], v7 offset:57344
v_mfma_f32_16x16x32_bf16 v[148:151], v[52:55], v[36:39], v[148:151]
ds_read_b64_tr_b16 v[106:107], v7 offset:59392
v_mfma_f32_16x16x32_bf16 v[152:155], v[56:59], v[36:39], v[152:155]
ds_read_b64_tr_b16 v[108:109], v8 offset:57344
v_mfma_f32_16x16x32_bf16 v[156:159], v[60:63], v[36:39], v[156:159]
ds_read_b64_tr_b16 v[110:111], v8 offset:59392
v_mfma_f32_16x16x32_bf16 v[128:131], v[64:67], v[40:43], v[128:131]
ds_read_b128 v[88:91], v2 offset:57344
ds_read_b64_tr_b16 v[112:113], v5 offset:61440
v_mfma_f32_16x16x32_bf16 v[132:135], v[68:71], v[40:43], v[132:135]
ds_read_b64_tr_b16 v[114:115], v5 offset:63488
v_mfma_f32_16x16x32_bf16 v[136:139], v[72:75], v[40:43], v[136:139]
ds_read_b64_tr_b16 v[116:117], v6 offset:61440
v_mfma_f32_16x16x32_bf16 v[140:143], v[76:79], v[40:43], v[140:143]
ds_read_b64_tr_b16 v[118:119], v6 offset:63488
v_mfma_f32_16x16x32_bf16 v[144:147], v[64:67], v[44:47], v[144:147]
ds_read_b128 v[92:95], v2 offset:57600
ds_read_b64_tr_b16 v[120:121], v7 offset:61440
v_mfma_f32_16x16x32_bf16 v[148:151], v[68:71], v[44:47], v[148:151]
ds_read_b64_tr_b16 v[122:123], v7 offset:63488
v_mfma_f32_16x16x32_bf16 v[152:155], v[72:75], v[44:47], v[152:155]
ds_read_b64_tr_b16 v[124:125], v8 offset:61440
v_mfma_f32_16x16x32_bf16 v[156:159], v[76:79], v[44:47], v[156:159]
ds_read_b64_tr_b16 v[126:127], v8 offset:63488
s_waitcnt lgkmcnt(0)
s_barrier
v_mfma_f32_16x16x32_bf16 v[128:131], v[96:99], v[80:83], v[128:131]
ds_read_b128 v[32:35], v2 offset:0
ds_read_b64_tr_b16 v[48:49], v9 offset:0
v_mfma_f32_16x16x32_bf16 v[132:135], v[100:103], v[80:83], v[132:135]
ds_read_b64_tr_b16 v[50:51], v9 offset:2048
v_mfma_f32_16x16x32_bf16 v[136:139], v[104:107], v[80:83], v[136:139]
ds_read_b64_tr_b16 v[52:53], v10 offset:0
v_mfma_f32_16x16x32_bf16 v[140:143], v[108:111], v[80:83], v[140:143]
ds_read_b64_tr_b16 v[54:55], v10 offset:2048
v_mfma_f32_16x16x32_bf16 v[144:147], v[96:99], v[84:87], v[144:147]
ds_read_b128 v[36:39], v2 offset:256
ds_read_b64_tr_b16 v[56:57], v11 offset:0
v_mfma_f32_16x16x32_bf16 v[148:151], v[100:103], v[84:87], v[148:151]
ds_read_b64_tr_b16 v[58:59], v11 offset:2048
v_mfma_f32_16x16x32_bf16 v[152:155], v[104:107], v[84:87], v[152:155]
ds_read_b64_tr_b16 v[60:61], v12 offset:0
v_mfma_f32_16x16x32_bf16 v[156:159], v[108:111], v[84:87], v[156:159]
ds_read_b64_tr_b16 v[62:63], v12 offset:2048
v_mfma_f32_16x16x32_bf16 v[128:131], v[112:115], v[88:91], v[128:131]
ds_read_b128 v[40:43], v2 offset:8192
ds_read_b64_tr_b16 v[64:65], v9 offset:4096
v_mfma_f32_16x16x32_bf16 v[132:135], v[116:119], v[88:91], v[132:135]
ds_read_b64_tr_b16 v[66:67], v9 offset:6144
v_mfma_f32_16x16x32_bf16 v[136:139], v[120:123], v[88:91], v[136:139]
ds_read_b64_tr_b16 v[68:69], v10 offset:4096
v_mfma_f32_16x16x32_bf16 v[140:143], v[124:127], v[88:91], v[140:143]
ds_read_b64_tr_b16 v[70:71], v10 offset:6144
v_mfma_f32_16x16x32_bf16 v[144:147], v[112:115], v[92:95], v[144:147]
ds_read_b128 v[44:47], v2 offset:8448
ds_read_b64_tr_b16 v[72:73], v11 offset:4096
v_mfma_f32_16x16x32_bf16 v[148:151], v[116:119], v[92:95], v[148:151]
ds_read_b64_tr_b16 v[74:75], v11 offset:6144
v_mfma_f32_16x16x32_bf16 v[152:155], v[120:123], v[92:95], v[152:155]
ds_read_b64_tr_b16 v[76:77], v12 offset:4096
v_mfma_f32_16x16x32_bf16 v[156:159], v[124:127], v[92:95], v[156:159]
ds_read_b64_tr_b16 v[78:79], v12 offset:6144
s_waitcnt lgkmcnt(0)
s_barrier
v_mfma_f32_16x16x32_bf16 v[128:131], v[48:51], v[32:35], v[128:131]
ds_read_b128 v[80:83], v2 offset:16384
ds_read_b64_tr_b16 v[96:97], v9 offset:8192
v_mfma_f32_16x16x32_bf16 v[132:135], v[52:55], v[32:35], v[132:135]
ds_read_b64_tr_b16 v[98:99], v9 offset:10240
v_mfma_f32_16x16x32_bf16 v[136:139], v[56:59], v[32:35], v[136:139]
ds_read_b64_tr_b16 v[100:101], v10 offset:8192
v_mfma_f32_16x16x32_bf16 v[140:143], v[60:63], v[32:35], v[140:143]
ds_read_b64_tr_b16 v[102:103], v10 offset:10240
v_mfma_f32_16x16x32_bf16 v[144:147], v[48:51], v[36:39], v[144:147]
ds_read_b128 v[84:87], v2 offset:16640
ds_read_b64_tr_b16 v[104:105], v11 offset:8192
v_mfma_f32_16x16x32_bf16 v[148:151], v[52:55], v[36:39], v[148:151]
ds_read_b64_tr_b16 v[106:107], v11 offset:10240
v_mfma_f32_16x16x32_bf16 v[152:155], v[56:59], v[36:39], v[152:155]
ds_read_b64_tr_b16 v[108:109], v12 offset:8192
v_mfma_f32_16x16x32_bf16 v[156:159], v[60:63], v[36:39], v[156:159]
ds_read_b64_tr_b16 v[110:111], v12 offset:10240
v_mfma_f32_16x16x32_bf16 v[128:131], v[64:67], v[40:43], v[128:131]
ds_read_b128 v[88:91], v2 offset:24576
ds_read_b64_tr_b16 v[112:113], v9 offset:12288
v_mfma_f32_16x16x32_bf16 v[132:135], v[68:71], v[40:43], v[132:135]
ds_read_b64_tr_b16 v[114:115], v9 offset:14336
v_mfma_f32_16x16x32_bf16 v[136:139], v[72:75], v[40:43], v[136:139]
ds_read_b64_tr_b16 v[116:117], v10 offset:12288
v_mfma_f32_16x16x32_bf16 v[140:143], v[76:79], v[40:43], v[140:143]
ds_read_b64_tr_b16 v[118:119], v10 offset:14336
v_mfma_f32_16x16x32_bf16 v[144:147], v[64:67], v[44:47], v[144:147]
ds_read_b128 v[92:95], v2 offset:24832
ds_read_b64_tr_b16 v[120:121], v11 offset:12288
v_mfma_f32_16x16x32_bf16 v[148:151], v[68:71], v[44:47], v[148:151]
ds_read_b64_tr_b16 v[122:123], v11 offset:14336
v_mfma_f32_16x16x32_bf16 v[152:155], v[72:75], v[44:47], v[152:155]
ds_read_b64_tr_b16 v[124:125], v12 offset:12288
v_mfma_f32_16x16x32_bf16 v[156:159], v[76:79], v[44:47], v[156:159]
ds_read_b64_tr_b16 v[126:127], v12 offset:14336
s_waitcnt lgkmcnt(0)
s_barrier
v_mfma_f32_16x16x32_bf16 v[128:131], v[96:99], v[80:83], v[128:131]
ds_read_b128 v[32:35], v2 offset:32768
ds_read_b64_tr_b16 v[48:49], v5 offset:0
v_mfma_f32_16x16x32_bf16 v[132:135], v[100:103], v[80:83], v[132:135]
ds_read_b64_tr_b16 v[50:51], v5 offset:2048
v_mfma_f32_16x16x32_bf16 v[136:139], v[104:107], v[80:83], v[136:139]
ds_read_b64_tr_b16 v[52:53], v6 offset:0
v_mfma_f32_16x16x32_bf16 v[140:143], v[108:111], v[80:83], v[140:143]
ds_read_b64_tr_b16 v[54:55], v6 offset:2048
v_mfma_f32_16x16x32_bf16 v[144:147], v[96:99], v[84:87], v[144:147]
ds_read_b128 v[36:39], v2 offset:33024
ds_read_b64_tr_b16 v[56:57], v7 offset:0
v_mfma_f32_16x16x32_bf16 v[148:151], v[100:103], v[84:87], v[148:151]
ds_read_b64_tr_b16 v[58:59], v7 offset:2048
v_mfma_f32_16x16x32_bf16 v[152:155], v[104:107], v[84:87], v[152:155]
ds_read_b64_tr_b16 v[60:61], v8 offset:0
v_mfma_f32_16x16x32_bf16 v[156:159], v[108:111], v[84:87], v[156:159]
ds_read_b64_tr_b16 v[62:63], v8 offset:2048
v_mfma_f32_16x16x32_bf16 v[128:131], v[112:115], v[88:91], v[128:131]
ds_read_b128 v[40:43], v2 offset:40960
ds_read_b64_tr_b16 v[64:65], v5 offset:4096
v_mfma_f32_16x16x32_bf16 v[132:135], v[116:119], v[88:91], v[132:135]
ds_read_b64_tr_b16 v[66:67], v5 offset:6144
v_mfma_f32_16x16x32_bf16 v[136:139], v[120:123], v[88:91], v[136:139]
ds_read_b64_tr_b16 v[68:69], v6 offset:4096
v_mfma_f32_16x16x32_bf16 v[140:143], v[124:127], v[88:91], v[140:143]
ds_read_b64_tr_b16 v[70:71], v6 offset:6144
v_mfma_f32_16x16x32_bf16 v[144:147], v[112:115], v[92:95], v[144:147]
ds_read_b128 v[44:47], v2 offset:41216
ds_read_b64_tr_b16 v[72:73], v7 offset:4096
v_mfma_f32_16x16x32_bf16 v[148:151], v[116:119], v[92:95], v[148:151]
ds_read_b64_tr_b16 v[74:75], v7 offset:6144
v_mfma_f32_16x16x32_bf16 v[152:155], v[120:123], v[92:95], v[152:155]
ds_read_b64_tr_b16 v[76:77], v8 offset:4096
v_mfma_f32_16x16x32_bf16 v[156:159], v[124:127], v[92:95], v[156:159]
ds_read_b64_tr_b16 v[78:79], v8 offset:6144
s_waitcnt lgkmcnt(0)
s_barrier
v_mfma_f32_16x16x32_bf16 v[128:131], v[48:51], v[32:35], v[128:131]
ds_read_b128 v[80:83], v2 offset:49152
ds_read_b64_tr_b16 v[96:97], v5 offset:8192
v_mfma_f32_16x16x32_bf16 v[132:135], v[52:55], v[32:35], v[132:135]
ds_read_b64_tr_b16 v[98:99], v5 offset:10240
v_mfma_f32_16x16x32_bf16 v[136:139], v[56:59], v[32:35], v[136:139]
ds_read_b64_tr_b16 v[100:101], v6 offset:8192
v_mfma_f32_16x16x32_bf16 v[140:143], v[60:63], v[32:35], v[140:143]
ds_read_b64_tr_b16 v[102:103], v6 offset:10240
v_mfma_f32_16x16x32_bf16 v[144:147], v[48:51], v[36:39], v[144:147]
ds_read_b128 v[84:87], v2 offset:49408
ds_read_b64_tr_b16 v[104:105], v7 offset:8192
v_mfma_f32_16x16x32_bf16 v[148:151], v[52:55], v[36:39], v[148:151]
ds_read_b64_tr_b16 v[106:107], v7 offset:10240
v_mfma_f32_16x16x32_bf16 v[152:155], v[56:59], v[36:39], v[152:155]
ds_read_b64_tr_b16 v[108:109], v8 offset:8192
v_mfma_f32_16x16x32_bf16 v[156:159], v[60:63], v[36:39], v[156:159]
ds_read_b64_tr_b16 v[110:111], v8 offset:10240
v_mfma_f32_16x16x32_bf16 v[128:131], v[64:67], v[40:43], v[128:131]
ds_read_b128 v[88:91], v2 offset:57344
ds_read_b64_tr_b16 v[112:113], v5 offset:12288
v_mfma_f32_16x16x32_bf16 v[132:135], v[68:71], v[40:43], v[132:135]
ds_read_b64_tr_b16 v[114:115], v5 offset:14336
v_mfma_f32_16x16x32_bf16 v[136:139], v[72:75], v[40:43], v[136:139]
ds_read_b64_tr_b16 v[116:117], v6 offset:12288
v_mfma_f32_16x16x32_bf16 v[140:143], v[76:79], v[40:43], v[140:143]
ds_read_b64_tr_b16 v[118:119], v6 offset:14336
v_mfma_f32_16x16x32_bf16 v[144:147], v[64:67], v[44:47], v[144:147]
ds_read_b128 v[92:95], v2 offset:57600
ds_read_b64_tr_b16 v[120:121], v7 offset:12288
v_mfma_f32_16x16x32_bf16 v[148:151], v[68:71], v[44:47], v[148:151]
ds_read_b64_tr_b16 v[122:123], v7 offset:14336
v_mfma_f32_16x16x32_bf16 v[152:155], v[72:75], v[44:47], v[152:155]
ds_read_b64_tr_b16 v[124:125], v8 offset:12288
v_mfma_f32_16x16x32_bf16 v[156:159], v[76:79], v[44:47], v[156:159]
ds_read_b64_tr_b16 v[126:127], v8 offset:14336
s_waitcnt lgkmcnt(0)
s_barrier
v_mfma_f32_16x16x32_bf16 v[128:131], v[96:99], v[80:83], v[128:131]
ds_read_b128 v[32:35], v2 offset:0
ds_read_b64_tr_b16 v[48:49], v5 offset:16384
v_mfma_f32_16x16x32_bf16 v[132:135], v[100:103], v[80:83], v[132:135]
ds_read_b64_tr_b16 v[50:51], v5 offset:18432
v_mfma_f32_16x16x32_bf16 v[136:139], v[104:107], v[80:83], v[136:139]
ds_read_b64_tr_b16 v[52:53], v6 offset:16384
v_mfma_f32_16x16x32_bf16 v[140:143], v[108:111], v[80:83], v[140:143]
ds_read_b64_tr_b16 v[54:55], v6 offset:18432
v_mfma_f32_16x16x32_bf16 v[144:147], v[96:99], v[84:87], v[144:147]
ds_read_b128 v[36:39], v2 offset:256
ds_read_b64_tr_b16 v[56:57], v7 offset:16384
v_mfma_f32_16x16x32_bf16 v[148:151], v[100:103], v[84:87], v[148:151]
ds_read_b64_tr_b16 v[58:59], v7 offset:18432
v_mfma_f32_16x16x32_bf16 v[152:155], v[104:107], v[84:87], v[152:155]
ds_read_b64_tr_b16 v[60:61], v8 offset:16384
v_mfma_f32_16x16x32_bf16 v[156:159], v[108:111], v[84:87], v[156:159]
ds_read_b64_tr_b16 v[62:63], v8 offset:18432
v_mfma_f32_16x16x32_bf16 v[128:131], v[112:115], v[88:91], v[128:131]
ds_read_b128 v[40:43], v2 offset:8192
ds_read_b64_tr_b16 v[64:65], v5 offset:20480
v_mfma_f32_16x16x32_bf16 v[132:135], v[116:119], v[88:91], v[132:135]
ds_read_b64_tr_b16 v[66:67], v5 offset:22528
v_mfma_f32_16x16x32_bf16 v[136:139], v[120:123], v[88:91], v[136:139]
ds_read_b64_tr_b16 v[68:69], v6 offset:20480
v_mfma_f32_16x16x32_bf16 v[140:143], v[124:127], v[88:91], v[140:143]
ds_read_b64_tr_b16 v[70:71], v6 offset:22528
v_mfma_f32_16x16x32_bf16 v[144:147], v[112:115], v[92:95], v[144:147]
ds_read_b128 v[44:47], v2 offset:8448
ds_read_b64_tr_b16 v[72:73], v7 offset:20480
v_mfma_f32_16x16x32_bf16 v[148:151], v[116:119], v[92:95], v[148:151]
ds_read_b64_tr_b16 v[74:75], v7 offset:22528
v_mfma_f32_16x16x32_bf16 v[152:155], v[120:123], v[92:95], v[152:155]
ds_read_b64_tr_b16 v[76:77], v8 offset:20480
v_mfma_f32_16x16x32_bf16 v[156:159], v[124:127], v[92:95], v[156:159]
ds_read_b64_tr_b16 v[78:79], v8 offset:22528
s_waitcnt lgkmcnt(0)
s_barrier
v_mfma_f32_16x16x32_bf16 v[128:131], v[48:51], v[32:35], v[128:131]
ds_read_b128 v[80:83], v2 offset:16384
ds_read_b64_tr_b16 v[96:97], v5 offset:24576
v_mfma_f32_16x16x32_bf16 v[132:135], v[52:55], v[32:35], v[132:135]
ds_read_b64_tr_b16 v[98:99], v5 offset:26624
v_mfma_f32_16x16x32_bf16 v[136:139], v[56:59], v[32:35], v[136:139]
ds_read_b64_tr_b16 v[100:101], v6 offset:24576
v_mfma_f32_16x16x32_bf16 v[140:143], v[60:63], v[32:35], v[140:143]
ds_read_b64_tr_b16 v[102:103], v6 offset:26624
v_mfma_f32_16x16x32_bf16 v[144:147], v[48:51], v[36:39], v[144:147]
ds_read_b128 v[84:87], v2 offset:16640
ds_read_b64_tr_b16 v[104:105], v7 offset:24576
v_mfma_f32_16x16x32_bf16 v[148:151], v[52:55], v[36:39], v[148:151]
ds_read_b64_tr_b16 v[106:107], v7 offset:26624
v_mfma_f32_16x16x32_bf16 v[152:155], v[56:59], v[36:39], v[152:155]
ds_read_b64_tr_b16 v[108:109], v8 offset:24576
v_mfma_f32_16x16x32_bf16 v[156:159], v[60:63], v[36:39], v[156:159]
ds_read_b64_tr_b16 v[110:111], v8 offset:26624
v_mfma_f32_16x16x32_bf16 v[128:131], v[64:67], v[40:43], v[128:131]
ds_read_b128 v[88:91], v2 offset:24576
ds_read_b64_tr_b16 v[112:113], v5 offset:28672
v_mfma_f32_16x16x32_bf16 v[132:135], v[68:71], v[40:43], v[132:135]
ds_read_b64_tr_b16 v[114:115], v5 offset:30720
v_mfma_f32_16x16x32_bf16 v[136:139], v[72:75], v[40:43], v[136:139]
ds_read_b64_tr_b16 v[116:117], v6 offset:28672
v_mfma_f32_16x16x32_bf16 v[140:143], v[76:79], v[40:43], v[140:143]
ds_read_b64_tr_b16 v[118:119], v6 offset:30720
v_mfma_f32_16x16x32_bf16 v[144:147], v[64:67], v[44:47], v[144:147]
ds_read_b128 v[92:95], v2 offset:24832
ds_read_b64_tr_b16 v[120:121], v7 offset:28672
v_mfma_f32_16x16x32_bf16 v[148:151], v[68:71], v[44:47], v[148:151]
ds_read_b64_tr_b16 v[122:123], v7 offset:30720
v_mfma_f32_16x16x32_bf16 v[152:155], v[72:75], v[44:47], v[152:155]
ds_read_b64_tr_b16 v[124:125], v8 offset:28672
v_mfma_f32_16x16x32_bf16 v[156:159], v[76:79], v[44:47], v[156:159]
ds_read_b64_tr_b16 v[126:127], v8 offset:30720
s_waitcnt lgkmcnt(0)
s_barrier
v_mfma_f32_16x16x32_bf16 v[128:131], v[96:99], v[80:83], v[128:131]
ds_read_b128 v[32:35], v2 offset:32768
ds_read_b64_tr_b16 v[48:49], v5 offset:32768
v_mfma_f32_16x16x32_bf16 v[132:135], v[100:103], v[80:83], v[132:135]
ds_read_b64_tr_b16 v[50:51], v5 offset:34816
v_mfma_f32_16x16x32_bf16 v[136:139], v[104:107], v[80:83], v[136:139]
ds_read_b64_tr_b16 v[52:53], v6 offset:32768
v_mfma_f32_16x16x32_bf16 v[140:143], v[108:111], v[80:83], v[140:143]
ds_read_b64_tr_b16 v[54:55], v6 offset:34816
v_mfma_f32_16x16x32_bf16 v[144:147], v[96:99], v[84:87], v[144:147]
ds_read_b128 v[36:39], v2 offset:33024
ds_read_b64_tr_b16 v[56:57], v7 offset:32768
v_mfma_f32_16x16x32_bf16 v[148:151], v[100:103], v[84:87], v[148:151]
ds_read_b64_tr_b16 v[58:59], v7 offset:34816
v_mfma_f32_16x16x32_bf16 v[152:155], v[104:107], v[84:87], v[152:155]
ds_read_b64_tr_b16 v[60:61], v8 offset:32768
v_mfma_f32_16x16x32_bf16 v[156:159], v[108:111], v[84:87], v[156:159]
ds_read_b64_tr_b16 v[62:63], v8 offset:34816
v_mfma_f32_16x16x32_bf16 v[128:131], v[112:115], v[88:91], v[128:131]
ds_read_b128 v[40:43], v2 offset:40960
ds_read_b64_tr_b16 v[64:65], v5 offset:36864
v_mfma_f32_16x16x32_bf16 v[132:135], v[116:119], v[88:91], v[132:135]
ds_read_b64_tr_b16 v[66:67], v5 offset:38912
v_mfma_f32_16x16x32_bf16 v[136:139], v[120:123], v[88:91], v[136:139]
ds_read_b64_tr_b16 v[68:69], v6 offset:36864
v_mfma_f32_16x16x32_bf16 v[140:143], v[124:127], v[88:91], v[140:143]
ds_read_b64_tr_b16 v[70:71], v6 offset:38912
v_mfma_f32_16x16x32_bf16 v[144:147], v[112:115], v[92:95], v[144:147]
ds_read_b128 v[44:47], v2 offset:41216
ds_read_b64_tr_b16 v[72:73], v7 offset:36864
v_mfma_f32_16x16x32_bf16 v[148:151], v[116:119], v[92:95], v[148:151]
ds_read_b64_tr_b16 v[74:75], v7 offset:38912
v_mfma_f32_16x16x32_bf16 v[152:155], v[120:123], v[92:95], v[152:155]
ds_read_b64_tr_b16 v[76:77], v8 offset:36864
v_mfma_f32_16x16x32_bf16 v[156:159], v[124:127], v[92:95], v[156:159]
ds_read_b64_tr_b16 v[78:79], v8 offset:38912
s_waitcnt lgkmcnt(0)
s_barrier
v_mfma_f32_16x16x32_bf16 v[128:131], v[48:51], v[32:35], v[128:131]
ds_read_b128 v[80:83], v2 offset:49152
ds_read_b64_tr_b16 v[96:97], v5 offset:40960
v_mfma_f32_16x16x32_bf16 v[132:135], v[52:55], v[32:35], v[132:135]
ds_read_b64_tr_b16 v[98:99], v5 offset:43008
v_mfma_f32_16x16x32_bf16 v[136:139], v[56:59], v[32:35], v[136:139]
ds_read_b64_tr_b16 v[100:101], v6 offset:40960
v_mfma_f32_16x16x32_bf16 v[140:143], v[60:63], v[32:35], v[140:143]
ds_read_b64_tr_b16 v[102:103], v6 offset:43008
v_mfma_f32_16x16x32_bf16 v[144:147], v[48:51], v[36:39], v[144:147]
ds_read_b128 v[84:87], v2 offset:49408
ds_read_b64_tr_b16 v[104:105], v7 offset:40960
v_mfma_f32_16x16x32_bf16 v[148:151], v[52:55], v[36:39], v[148:151]
ds_read_b64_tr_b16 v[106:107], v7 offset:43008
v_mfma_f32_16x16x32_bf16 v[152:155], v[56:59], v[36:39], v[152:155]
ds_read_b64_tr_b16 v[108:109], v8 offset:40960
v_mfma_f32_16x16x32_bf16 v[156:159], v[60:63], v[36:39], v[156:159]
ds_read_b64_tr_b16 v[110:111], v8 offset:43008
v_mfma_f32_16x16x32_bf16 v[128:131], v[64:67], v[40:43], v[128:131]
ds_read_b128 v[88:91], v2 offset:57344
ds_read_b64_tr_b16 v[112:113], v5 offset:45056
v_mfma_f32_16x16x32_bf16 v[132:135], v[68:71], v[40:43], v[132:135]
ds_read_b64_tr_b16 v[114:115], v5 offset:47104
v_mfma_f32_16x16x32_bf16 v[136:139], v[72:75], v[40:43], v[136:139]
ds_read_b64_tr_b16 v[116:117], v6 offset:45056
v_mfma_f32_16x16x32_bf16 v[140:143], v[76:79], v[40:43], v[140:143]
ds_read_b64_tr_b16 v[118:119], v6 offset:47104
v_mfma_f32_16x16x32_bf16 v[144:147], v[64:67], v[44:47], v[144:147]
ds_read_b128 v[92:95], v2 offset:57600
ds_read_b64_tr_b16 v[120:121], v7 offset:45056
v_mfma_f32_16x16x32_bf16 v[148:151], v[68:71], v[44:47], v[148:151]
ds_read_b64_tr_b16 v[122:123], v7 offset:47104
v_mfma_f32_16x16x32_bf16 v[152:155], v[72:75], v[44:47], v[152:155]
ds_read_b64_tr_b16 v[124:125], v8 offset:45056
v_mfma_f32_16x16x32_bf16 v[156:159], v[76:79], v[44:47], v[156:159]
ds_read_b64_tr_b16 v[126:127], v8 offset:47104
s_waitcnt lgkmcnt(0)
s_barrier
v_mfma_f32_16x16x32_bf16 v[128:131], v[96:99], v[80:83], v[128:131]
v_mfma_f32_16x16x32_bf16 v[132:135], v[100:103], v[80:83], v[132:135]
v_mfma_f32_16x16x32_bf16 v[136:139], v[104:107], v[80:83], v[136:139]
v_mfma_f32_16x16x32_bf16 v[140:143], v[108:111], v[80:83], v[140:143]
v_mfma_f32_16x16x32_bf16 v[144:147], v[96:99], v[84:87], v[144:147]
v_mfma_f32_16x16x32_bf16 v[148:151], v[100:103], v[84:87], v[148:151]
v_mfma_f32_16x16x32_bf16 v[152:155], v[104:107], v[84:87], v[152:155]
v_mfma_f32_16x16x32_bf16 v[156:159], v[108:111], v[84:87], v[156:159]
v_mfma_f32_16x16x32_bf16 v[128:131], v[112:115], v[88:91], v[128:131]
v_mfma_f32_16x16x32_bf16 v[132:135], v[116:119], v[88:91], v[132:135]
v_mfma_f32_16x16x32_bf16 v[136:139], v[120:123], v[88:91], v[136:139]
v_mfma_f32_16x16x32_bf16 v[140:143], v[124:127], v[88:91], v[140:143]
v_mfma_f32_16x16x32_bf16 v[144:147], v[112:115], v[92:95], v[144:147]
v_mfma_f32_16x16x32_bf16 v[148:151], v[116:119], v[92:95], v[148:151]
v_mfma_f32_16x16x32_bf16 v[152:155], v[120:123], v[92:95], v[152:155]
v_mfma_f32_16x16x32_bf16 v[156:159], v[124:127], v[92:95], v[156:159]
s_nop 4
v_cvt_pk_bf16_f32 v96, v128, v129
v_cvt_pk_bf16_f32 v97, v130, v131
v_cvt_pk_bf16_f32 v98, v132, v133
v_cvt_pk_bf16_f32 v99, v134, v135
buffer_store_dwordx4 v[96:99], v2, s[20:23], 0 offen offset:0 sc1
ds_write_b128 v4, v[96:99] offset:0
v_cvt_pk_bf16_f32 v100, v136, v137
v_cvt_pk_bf16_f32 v101, v138, v139
v_cvt_pk_bf16_f32 v102, v140, v141
v_cvt_pk_bf16_f32 v103, v142, v143
buffer_store_dwordx4 v[100:103], v2, s[20:23], s50 offen offset:0 sc1
ds_write_b128 v4, v[100:103] offset:8192
v_cvt_pk_bf16_f32 v104, v144, v145
v_cvt_pk_bf16_f32 v105, v146, v147
v_cvt_pk_bf16_f32 v106, v148, v149
v_cvt_pk_bf16_f32 v107, v150, v151
buffer_store_dwordx4 v[104:107], v2, s[20:23], 0 offen offset:256 sc1
ds_write_b128 v4, v[104:107] offset:256
v_cvt_pk_bf16_f32 v108, v152, v153
v_cvt_pk_bf16_f32 v109, v154, v155
v_cvt_pk_bf16_f32 v110, v156, v157
v_cvt_pk_bf16_f32 v111, v158, v159
buffer_store_dwordx4 v[108:111], v2, s[20:23], s50 offen offset:256 sc1
ds_write_b128 v4, v[108:111] offset:8448
v_pk_mul_f32 v[118:119], v[128:129], v[128:129]
v_pk_mul_f32 v[122:123], v[144:145], v[144:145]
v_pk_fma_f32 v[118:119], v[130:131], v[130:131], v[118:119]
v_pk_add_f32 v[116:117], v[130:131], v[128:129]
v_pk_fma_f32 v[122:123], v[146:147], v[146:147], v[122:123]
v_pk_add_f32 v[120:121], v[146:147], v[144:145]
v_pk_fma_f32 v[118:119], v[132:133], v[132:133], v[118:119]
v_pk_add_f32 v[116:117], v[132:133], v[116:117]
v_pk_fma_f32 v[122:123], v[148:149], v[148:149], v[122:123]
v_pk_add_f32 v[120:121], v[148:149], v[120:121]
v_pk_fma_f32 v[118:119], v[134:135], v[134:135], v[118:119]
v_pk_add_f32 v[116:117], v[134:135], v[116:117]
v_pk_fma_f32 v[122:123], v[150:151], v[150:151], v[122:123]
v_pk_add_f32 v[120:121], v[150:151], v[120:121]
v_pk_fma_f32 v[118:119], v[136:137], v[136:137], v[118:119]
v_pk_add_f32 v[116:117], v[136:137], v[116:117]
v_pk_fma_f32 v[122:123], v[152:153], v[152:153], v[122:123]
v_pk_add_f32 v[120:121], v[152:153], v[120:121]
v_pk_fma_f32 v[118:119], v[138:139], v[138:139], v[118:119]
v_pk_add_f32 v[116:117], v[138:139], v[116:117]
v_pk_fma_f32 v[122:123], v[154:155], v[154:155], v[122:123]
v_pk_add_f32 v[120:121], v[154:155], v[120:121]
v_pk_fma_f32 v[118:119], v[140:141], v[140:141], v[118:119]
v_pk_add_f32 v[116:117], v[140:141], v[116:117]
v_pk_fma_f32 v[122:123], v[156:157], v[156:157], v[122:123]
v_pk_add_f32 v[120:121], v[156:157], v[120:121]
v_pk_fma_f32 v[118:119], v[142:143], v[142:143], v[118:119]
v_pk_add_f32 v[116:117], v[142:143], v[116:117]
v_pk_fma_f32 v[122:123], v[158:159], v[158:159], v[122:123]
v_pk_add_f32 v[120:121], v[158:159], v[120:121]
v_add_f32 v112, v116, v117
v_add_f32 v113, v118, v119
v_add_f32 v114, v120, v121
v_add_f32 v115, v122, v123
s_nop 1
v_permlane32_swap_b32 v112, v114
v_permlane32_swap_b32 v113, v115
v_add_f32 v112, v112, v114
v_add_f32 v113, v113, v115
s_nop 1
v_permlane16_swap_b32 v112, v113
v_add_f32 v112, v112, v113
buffer_store_dword v112, v22, s[24:27], 0 offen sc1
s_waitcnt lgkmcnt(0)
s_barrier
s_lshl_b32 s53, s47, 2
v_lshlrev_b32 v19, 11, v18
v_lshl_add_u32 v19, v17, 4, v19
s_lshl_b32 s43, s46, 10
v_add_u32 v2, s43, v19
v_add_u32 v3, 49152, v2
v_add_u32 v4, 98304, v2
v_lshrrev_b32 v19, 2, v17
v_lshl_add_u32 v20, v18, 2, v19
v_and_b32 v21, 7, v20
v_lshlrev_b32 v20, 8, v20
v_and_b32 v19, 3, v1
v_lshl_add_u32 v20, v19, 3, v20
s_add_u32 s43, s53, 0
v_xor_b32 v19, s43, v21
v_lshl_add_u32 v5, v19, 5, v20
s_add_u32 s43, s53, 1
v_xor_b32 v19, s43, v21
v_lshl_add_u32 v6, v19, 5, v20
s_add_u32 s43, s53, 2
v_xor_b32 v19, s43, v21
v_lshl_add_u32 v7, v19, 5, v20
s_add_u32 s43, s53, 3
v_xor_b32 v19, s43, v21
v_lshl_add_u32 v8, v19, 5, v20
v_add_u32 v9, 49152, v5
v_add_u32 v10, 49152, v6
v_add_u32 v11, 49152, v7
v_add_u32 v12, 49152, v8
v_add_u32 v13, 98304, v5
v_add_u32 v14, 98304, v6
v_add_u32 v15, 98304, v7
v_add_u32 v16, 98304, v8
ds_read_b128 v[32:35], v4 offset:0
ds_read_b64_tr_b16 v[48:49], v13 offset:16384
ds_read_b64_tr_b16 v[50:51], v13 offset:20480
ds_read_b128 v[36:39], v4 offset:256
ds_read_b128 v[40:43], v4 offset:512
ds_read_b128 v[44:47], v4 offset:768
ds_read_b64_tr_b16 v[64:65], v13 offset:32768
ds_read_b64_tr_b16 v[66:67], v13 offset:36864
ds_read_b64_tr_b16 v[52:53], v14 offset:16384
ds_read_b64_tr_b16 v[54:55], v14 offset:20480
ds_read_b64_tr_b16 v[68:69], v14 offset:32768
ds_read_b64_tr_b16 v[70:71], v14 offset:36864
ds_read_b64_tr_b16 v[56:57], v15 offset:16384
ds_read_b64_tr_b16 v[58:59], v15 offset:20480
ds_read_b64_tr_b16 v[72:73], v15 offset:32768
ds_read_b64_tr_b16 v[74:75], v15 offset:36864
ds_read_b64_tr_b16 v[60:61], v16 offset:16384
ds_read_b64_tr_b16 v[62:63], v16 offset:20480
ds_read_b64_tr_b16 v[76:77], v16 offset:32768
ds_read_b64_tr_b16 v[78:79], v16 offset:36864
s_waitcnt lgkmcnt(0)
v_mfma_f32_16x16x32_bf16 v[128:131], v[48:51], v[32:35], 0
ds_read_b128 v[80:83], v4 offset:8192
v_mfma_f32_16x16x32_bf16 v[132:135], v[48:51], v[36:39], 0
ds_read_b64_tr_b16 v[96:97], v13 offset:24576
v_mfma_f32_16x16x32_bf16 v[136:139], v[48:51], v[40:43], 0
ds_read_b64_tr_b16 v[98:99], v13 offset:28672
v_mfma_f32_16x16x32_bf16 v[140:143], v[48:51], v[44:47], 0
ds_read_b128 v[84:87], v4 offset:8448
v_mfma_f32_16x16x32_bf16 v[204:207], v[64:67], v[44:47], 0
ds_read_b128 v[88:91], v4 offset:8704
v_mfma_f32_16x16x32_bf16 v[200:203], v[64:67], v[40:43], 0
ds_read_b128 v[92:95], v4 offset:8960
v_mfma_f32_16x16x32_bf16 v[196:199], v[64:67], v[36:39], 0
ds_read_b64_tr_b16 v[112:113], v13 offset:40960
v_mfma_f32_16x16x32_bf16 v[192:195], v[64:67], v[32:35], 0
ds_read_b64_tr_b16 v[114:115], v13 offset:45056
v_mfma_f32_16x16x32_bf16 v[144:147], v[52:55], v[32:35], 0
ds_read_b64_tr_b16 v[100:101], v14 offset:24576
v_mfma_f32_16x16x32_bf16 v[148:151], v[52:55], v[36:39], 0
ds_read_b64_tr_b16 v[102:103], v14 offset:28672
v_mfma_f32_16x16x32_bf16 v[152:155], v[52:55], v[40:43], 0
ds_read_b64_tr_b16 v[116:117], v14 offset:40960
v_mfma_f32_16x16x32_bf16 v[156:159], v[52:55], v[44:47], 0
ds_read_b64_tr_b16 v[118:119], v14 offset:45056
v_mfma_f32_16x16x32_bf16 v[220:223], v[68:71], v[44:47], 0
ds_read_b64_tr_b16 v[104:105], v15 offset:24576
v_mfma_f32_16x16x32_bf16 v[216:219], v[68:71], v[40:43], 0
ds_read_b64_tr_b16 v[106:107], v15 offset:28672
v_mfma_f32_16x16x32_bf16 v[212:215], v[68:71], v[36:39], 0
ds_read_b64_tr_b16 v[120:121], v15 offset:40960
v_mfma_f32_16x16x32_bf16 v[208:211], v[68:71], v[32:35], 0
ds_read_b64_tr_b16 v[122:123], v15 offset:45056
v_mfma_f32_16x16x32_bf16 v[160:163], v[56:59], v[32:35], 0
ds_read_b64_tr_b16 v[108:109], v16 offset:24576
v_mfma_f32_16x16x32_bf16 v[164:167], v[56:59], v[36:39], 0
ds_read_b64_tr_b16 v[110:111], v16 offset:28672
v_mfma_f32_16x16x32_bf16 v[168:171], v[56:59], v[40:43], 0
ds_read_b64_tr_b16 v[124:125], v16 offset:40960
v_mfma_f32_16x16x32_bf16 v[172:175], v[56:59], v[44:47], 0
ds_read_b64_tr_b16 v[126:127], v16 offset:45056
v_mfma_f32_16x16x32_bf16 v[236:239], v[72:75], v[44:47], 0
v_mfma_f32_16x16x32_bf16 v[232:235], v[72:75], v[40:43], 0
v_mfma_f32_16x16x32_bf16 v[228:231], v[72:75], v[36:39], 0
v_mfma_f32_16x16x32_bf16 v[224:227], v[72:75], v[32:35], 0
v_mfma_f32_16x16x32_bf16 v[176:179], v[60:63], v[32:35], 0
v_mfma_f32_16x16x32_bf16 v[180:183], v[60:63], v[36:39], 0
v_mfma_f32_16x16x32_bf16 v[184:187], v[60:63], v[40:43], 0
v_mfma_f32_16x16x32_bf16 v[188:191], v[60:63], v[44:47], 0
v_mfma_f32_16x16x32_bf16 v[252:255], v[76:79], v[44:47], 0
v_mfma_f32_16x16x32_bf16 v[248:251], v[76:79], v[40:43], 0
v_mfma_f32_16x16x32_bf16 v[244:247], v[76:79], v[36:39], 0
v_mfma_f32_16x16x32_bf16 v[240:243], v[76:79], v[32:35], 0
s_waitcnt lgkmcnt(0)
v_mfma_f32_16x16x32_bf16 v[128:131], v[96:99], v[80:83], v[128:131]
v_mfma_f32_16x16x32_bf16 v[132:135], v[96:99], v[84:87], v[132:135]
v_mfma_f32_16x16x32_bf16 v[136:139], v[96:99], v[88:91], v[136:139]
v_mfma_f32_16x16x32_bf16 v[140:143], v[96:99], v[92:95], v[140:143]
v_mfma_f32_16x16x32_bf16 v[204:207], v[112:115], v[92:95], v[204:207]
v_mfma_f32_16x16x32_bf16 v[200:203], v[112:115], v[88:91], v[200:203]
v_mfma_f32_16x16x32_bf16 v[196:199], v[112:115], v[84:87], v[196:199]
v_mfma_f32_16x16x32_bf16 v[192:195], v[112:115], v[80:83], v[192:195]
v_mfma_f32_16x16x32_bf16 v[144:147], v[100:103], v[80:83], v[144:147]
v_mfma_f32_16x16x32_bf16 v[148:151], v[100:103], v[84:87], v[148:151]
v_mfma_f32_16x16x32_bf16 v[152:155], v[100:103], v[88:91], v[152:155]
v_mfma_f32_16x16x32_bf16 v[156:159], v[100:103], v[92:95], v[156:159]
v_mfma_f32_16x16x32_bf16 v[220:223], v[116:119], v[92:95], v[220:223]
v_mfma_f32_16x16x32_bf16 v[216:219], v[116:119], v[88:91], v[216:219]
v_mfma_f32_16x16x32_bf16 v[212:215], v[116:119], v[84:87], v[212:215]
v_mfma_f32_16x16x32_bf16 v[208:211], v[116:119], v[80:83], v[208:211]
v_mfma_f32_16x16x32_bf16 v[160:163], v[104:107], v[80:83], v[160:163]
v_mfma_f32_16x16x32_bf16 v[164:167], v[104:107], v[84:87], v[164:167]
v_mfma_f32_16x16x32_bf16 v[168:171], v[104:107], v[88:91], v[168:171]
v_mfma_f32_16x16x32_bf16 v[172:175], v[104:107], v[92:95], v[172:175]
v_mfma_f32_16x16x32_bf16 v[236:239], v[120:123], v[92:95], v[236:239]
v_mfma_f32_16x16x32_bf16 v[232:235], v[120:123], v[88:91], v[232:235]
v_mfma_f32_16x16x32_bf16 v[228:231], v[120:123], v[84:87], v[228:231]
v_mfma_f32_16x16x32_bf16 v[224:227], v[120:123], v[80:83], v[224:227]
v_mfma_f32_16x16x32_bf16 v[176:179], v[108:111], v[80:83], v[176:179]
v_mfma_f32_16x16x32_bf16 v[180:183], v[108:111], v[84:87], v[180:183]
v_mfma_f32_16x16x32_bf16 v[184:187], v[108:111], v[88:91], v[184:187]
v_mfma_f32_16x16x32_bf16 v[188:191], v[108:111], v[92:95], v[188:191]
v_mfma_f32_16x16x32_bf16 v[252:255], v[124:127], v[92:95], v[252:255]
v_mfma_f32_16x16x32_bf16 v[248:251], v[124:127], v[88:91], v[248:251]
v_mfma_f32_16x16x32_bf16 v[244:247], v[124:127], v[84:87], v[244:247]
v_mfma_f32_16x16x32_bf16 v[240:243], v[124:127], v[80:83], v[240:243]
s_mul_i32 s43, s49, 192
s_and_b32 s43, s43, 0xffffff80
s_add_u32 s43, s43, 4096
s_cmp_eq_u32 s51, 1
s_cselect_b32 s8, s4, s6
s_cselect_b32 s9, s5, s7
s_sub_u32 s10, 7340032, s43
s_lshl_b32 s44, s34, 18
s_add_u32 s44, s44, 4194304
s_movk_i32 s38, 28672
s_cmp_eq_u32 s51, 0
s_cselect_b32 s8, s32, s8
s_cselect_b32 s9, s33, s9
s_cselect_b32 s10, 262144, s10
s_cselect_b32 s43, s44, s43
s_cselect_b32 s38, 1024, s38
s_cselect_b32 s45, 0, -1
s_add_u32 s8, s8, s43
s_addc_u32 s9, s9, 0
s_mov_b32 s11, 0x20000
s_lshl_b32 s40, s38, 4
s_add_u32 s42, s35, 17
s_lshl_b32 s39, s51, 14
v_lshrrev_b32 v19, 4, v1
v_lshlrev_b32 v20, 5, v19
v_mul_u32_u24 v19, 6912, v19
v_and_b32 v19, s45, v19
v_and_b32 v20, s45, v20
v_lshlrev_b32 v21, 4, v1
v_xor_b32 v21, v21, v20
v_add_u32 v22, v21, v19
s_and_b32 s45, s45, 128
v_xor_b32 v23, s45, v22
s_mul_i32 s43, s34, 917504
s_mul_i32 s44, s35, 16384
s_add_u32 s43, s43, s44
s_add_u32 s43, s43, 8388608
s_add_u32 s24, s32, s43
s_addc_u32 s25, s33, 0
s_mov_b32 s26, 278528
s_mov_b32 s27, 0x20000
s_mov_b32 s53, 262144
s_lshl_b32 s43, s47, 13
s_lshl_b32 s44, s46, 10
s_add_u32 s43, s43, s44
v_lshlrev_b32 v19, 11, v18
v_lshl_add_u32 v19, v17, 4, v19
v_add_u32 v27, s43, v19
s_lshl_b32 s43, s34, 18
s_lshl_b32 s44, s35, 7
s_add_u32 s43, s43, s44
s_add_u32 s16, s62, s43
s_addc_u32 s17, s63, 0
s_mov_b32 s18, 260224
s_mov_b32 s19, 0x20000
s_lshl_b32 s43, s46, 6
v_lshl_add_u32 v19, v17, 1, s43
v_lshlrev_b32 v19, 11, v19
v_and_b32 v20, 1, v18
v_lshl_add_u32 v19, v20, 5, v19
v_lshrrev_b32 v20, 1, v18
v_lshl_add_u32 v19, v20, 4, v19
s_lshl_b32 s43, s47, 6
v_add_u32 v28, s43, v19
s_lshl_b32 s43, s34, 4
s_add_u32 s43, s43, s35
s_xor_b32 s43, s43, 0
s_lshl_b32 s43, s43, 15
s_add_u32 s43, s43, 33554432
s_add_u32 s64, s32, s43
s_addc_u32 s65, s33, 0
s_mov_b32 s66, 32768
s_mov_b32 s67, 0x20000
s_lshl_b32 s43, s34, 4
s_add_u32 s43, s43, s35
s_xor_b32 s43, s43, 1
s_lshl_b32 s43, s43, 15
s_add_u32 s43, s43, 33554432
s_add_u32 s68, s32, s43
s_addc_u32 s69, s33, 0
s_mov_b32 s70, 32768
s_mov_b32 s71, 0x20000
s_lshl_b32 s43, s34, 18
s_add_u32 s12, s32, s43
s_addc_u32 s13, s33, 0
s_add_u32 s12, s12, 4194304
s_addc_u32 s13, s13, 0
s_mov_b32 s14, 262144
s_mov_b32 s15, 0x20000
v_lshlrev_b32 v21, 4, v1
s_lshl_b32 s54, s36, 11
s_add_u32 s43, s35, 1
s_and_b32 s43, s43, 15
s_lshl_b32 s43, s43, 14
s_add_u32 s30, s43, s54
s_add_u32 s43, s35, 2
s_and_b32 s43, s43, 15
s_lshl_b32 s43, s43, 14
s_add_u32 s31, s43, s54
s_waitcnt vmcnt(0)
s_barrier
s_setprio 1
ds_read_b128 v[32:35], v2 offset:0
ds_read_b64_tr_b16 v[48:49], v5 offset:16384
ds_read_b64_tr_b16 v[50:51], v5 offset:20480
ds_read_b128 v[36:39], v2 offset:256
ds_read_b128 v[40:43], v2 offset:512
ds_read_b128 v[44:47], v2 offset:768
ds_read_b64_tr_b16 v[64:65], v5 offset:32768
ds_read_b64_tr_b16 v[66:67], v5 offset:36864
ds_read_b64_tr_b16 v[52:53], v6 offset:16384
ds_read_b64_tr_b16 v[54:55], v6 offset:20480
ds_read_b64_tr_b16 v[68:69], v6 offset:32768
ds_read_b64_tr_b16 v[70:71], v6 offset:36864
ds_read_b64_tr_b16 v[56:57], v7 offset:16384
ds_read_b64_tr_b16 v[58:59], v7 offset:20480
ds_read_b64_tr_b16 v[72:73], v7 offset:32768
ds_read_b64_tr_b16 v[74:75], v7 offset:36864
ds_read_b64_tr_b16 v[60:61], v8 offset:16384
ds_read_b64_tr_b16 v[62:63], v8 offset:20480
ds_read_b64_tr_b16 v[76:77], v8 offset:32768
ds_read_b64_tr_b16 v[78:79], v8 offset:36864
s_waitcnt lgkmcnt(14)
v_max3_u32 v19, v32, v33, v34
v_max3_u32 v19, v19, v35, v36
v_max3_u32 v19, v19, v37, v38
v_max3_u32 v19, v19, v39, v40
v_max3_u32 v19, v19, v41, v42
v_max3_u32 v19, v19, v43, v44
v_max3_u32 v19, v19, v45, v46
v_max_u32 v19, v19, v47
v_cmp_eq_u32 vcc, -1, v19
s_nop 4
s_cbranch_vccz Lok_43
s_add_u32 s44, s35, 1
s_and_b32 s44, s44, 15
s_lshl_b32 s44, s44, 14
s_add_u32 s44, s44, 0
s_mov_b32 s45, 0x20000
Lre_44:
buffer_load_dwordx4 v[32:35], v2, s[12:15], s44 offen offset:0 sc1
buffer_load_dwordx4 v[36:39], v2, s[12:15], s44 offen offset:256 sc1
buffer_load_dwordx4 v[40:43], v2, s[12:15], s44 offen offset:512 sc1
buffer_load_dwordx4 v[44:47], v2, s[12:15], s44 offen offset:768 sc1
s_waitcnt vmcnt(0)
v_max3_u32 v19, v32, v33, v34
v_max3_u32 v19, v19, v35, v36
v_max3_u32 v19, v19, v37, v38
v_max3_u32 v19, v19, v39, v40
v_max3_u32 v19, v19, v41, v42
v_max3_u32 v19, v19, v43, v44
v_max3_u32 v19, v19, v45, v46
v_max_u32 v19, v19, v47
v_cmp_eq_u32 vcc, -1, v19
s_sub_u32 s45, s45, 1
s_cmp_eq_u32 s45, 0
s_cbranch_scc1 Lok_43
s_nop 2
s_cbranch_vccnz Lre_44
Lok_43:
s_waitcnt lgkmcnt(0)
v_mfma_f32_16x16x32_bf16 v[128:131], v[48:51], v[32:35], v[128:131]
ds_read_b128 v[80:83], v2 offset:8192
v_mfma_f32_16x16x32_bf16 v[132:135], v[48:51], v[36:39], v[132:135]
ds_read_b64_tr_b16 v[96:97], v5 offset:24576
v_mfma_f32_16x16x32_bf16 v[136:139], v[48:51], v[40:43], v[136:139]
ds_read_b64_tr_b16 v[98:99], v5 offset:28672
v_mfma_f32_16x16x32_bf16 v[140:143], v[48:51], v[44:47], v[140:143]
ds_read_b128 v[84:87], v2 offset:8448
v_mfma_f32_16x16x32_bf16 v[204:207], v[64:67], v[44:47], v[204:207]
ds_read_b128 v[88:91], v2 offset:8704
v_mfma_f32_16x16x32_bf16 v[200:203], v[64:67], v[40:43], v[200:203]
ds_read_b128 v[92:95], v2 offset:8960
v_mfma_f32_16x16x32_bf16 v[196:199], v[64:67], v[36:39], v[196:199]
ds_read_b64_tr_b16 v[112:113], v5 offset:40960
v_mfma_f32_16x16x32_bf16 v[192:195], v[64:67], v[32:35], v[192:195]
ds_read_b64_tr_b16 v[114:115], v5 offset:45056
v_mfma_f32_16x16x32_bf16 v[144:147], v[52:55], v[32:35], v[144:147]
ds_read_b64_tr_b16 v[100:101], v6 offset:24576
v_mfma_f32_16x16x32_bf16 v[148:151], v[52:55], v[36:39], v[148:151]
ds_read_b64_tr_b16 v[102:103], v6 offset:28672
v_mfma_f32_16x16x32_bf16 v[152:155], v[52:55], v[40:43], v[152:155]
ds_read_b64_tr_b16 v[116:117], v6 offset:40960
v_mfma_f32_16x16x32_bf16 v[156:159], v[52:55], v[44:47], v[156:159]
ds_read_b64_tr_b16 v[118:119], v6 offset:45056
v_mfma_f32_16x16x32_bf16 v[220:223], v[68:71], v[44:47], v[220:223]
ds_read_b64_tr_b16 v[104:105], v7 offset:24576
v_mfma_f32_16x16x32_bf16 v[216:219], v[68:71], v[40:43], v[216:219]
ds_read_b64_tr_b16 v[106:107], v7 offset:28672
v_mfma_f32_16x16x32_bf16 v[212:215], v[68:71], v[36:39], v[212:215]
ds_read_b64_tr_b16 v[120:121], v7 offset:40960
v_mfma_f32_16x16x32_bf16 v[208:211], v[68:71], v[32:35], v[208:211]
ds_read_b64_tr_b16 v[122:123], v7 offset:45056
v_mfma_f32_16x16x32_bf16 v[160:163], v[56:59], v[32:35], v[160:163]
ds_read_b64_tr_b16 v[108:109], v8 offset:24576
v_mfma_f32_16x16x32_bf16 v[164:167], v[56:59], v[36:39], v[164:167]
ds_read_b64_tr_b16 v[110:111], v8 offset:28672
v_mfma_f32_16x16x32_bf16 v[168:171], v[56:59], v[40:43], v[168:171]
ds_read_b64_tr_b16 v[124:125], v8 offset:40960
v_mfma_f32_16x16x32_bf16 v[172:175], v[56:59], v[44:47], v[172:175]
ds_read_b64_tr_b16 v[126:127], v8 offset:45056
s_waitcnt lgkmcnt(14)
v_mfma_f32_16x16x32_bf16 v[236:239], v[72:75], v[44:47], v[236:239]
v_max3_u32 v19, v80, v81, v82
v_mfma_f32_16x16x32_bf16 v[232:235], v[72:75], v[40:43], v[232:235]
v_max3_u32 v19, v19, v83, v84
v_mfma_f32_16x16x32_bf16 v[228:231], v[72:75], v[36:39], v[228:231]
v_max3_u32 v19, v19, v85, v86
v_mfma_f32_16x16x32_bf16 v[224:227], v[72:75], v[32:35], v[224:227]
v_max3_u32 v19, v19, v87, v88
v_mfma_f32_16x16x32_bf16 v[176:179], v[60:63], v[32:35], v[176:179]
v_max3_u32 v19, v19, v89, v90
v_mfma_f32_16x16x32_bf16 v[180:183], v[60:63], v[36:39], v[180:183]
v_max3_u32 v19, v19, v91, v92
v_mfma_f32_16x16x32_bf16 v[184:187], v[60:63], v[40:43], v[184:187]
v_max3_u32 v19, v19, v93, v94
v_mfma_f32_16x16x32_bf16 v[188:191], v[60:63], v[44:47], v[188:191]
v_max_u32 v19, v19, v95
v_mfma_f32_16x16x32_bf16 v[252:255], v[76:79], v[44:47], v[252:255]
v_cmp_eq_u32 vcc, -1, v19
v_mfma_f32_16x16x32_bf16 v[248:251], v[76:79], v[40:43], v[248:251]
v_mfma_f32_16x16x32_bf16 v[244:247], v[76:79], v[36:39], v[244:247]
v_mfma_f32_16x16x32_bf16 v[240:243], v[76:79], v[32:35], v[240:243]
s_nop 1
s_cbranch_vccz Lok_45
s_add_u32 s44, s35, 1
s_and_b32 s44, s44, 15
s_lshl_b32 s44, s44, 14
s_add_u32 s44, s44, 8192
s_mov_b32 s45, 0x20000
Lre_46:
buffer_load_dwordx4 v[80:83], v2, s[12:15], s44 offen offset:0 sc1
buffer_load_dwordx4 v[84:87], v2, s[12:15], s44 offen offset:256 sc1
buffer_load_dwordx4 v[88:91], v2, s[12:15], s44 offen offset:512 sc1
buffer_load_dwordx4 v[92:95], v2, s[12:15], s44 offen offset:768 sc1
s_waitcnt vmcnt(0)
v_max3_u32 v19, v80, v81, v82
v_max3_u32 v19, v19, v83, v84
v_max3_u32 v19, v19, v85, v86
v_max3_u32 v19, v19, v87, v88
v_max3_u32 v19, v19, v89, v90
v_max3_u32 v19, v19, v91, v92
v_max3_u32 v19, v19, v93, v94
v_max_u32 v19, v19, v95
v_cmp_eq_u32 vcc, -1, v19
s_sub_u32 s45, s45, 1
s_cmp_eq_u32 s45, 0
s_cbranch_scc1 Lok_45
s_nop 2
s_cbranch_vccnz Lre_46
Lok_45:
s_waitcnt lgkmcnt(0)
s_barrier
v_mfma_f32_16x16x32_bf16 v[128:131], v[96:99], v[80:83], v[128:131]
ds_read_b128 v[32:35], v3 offset:0
v_mfma_f32_16x16x32_bf16 v[132:135], v[96:99], v[84:87], v[132:135]
ds_read_b64_tr_b16 v[48:49], v9 offset:16384
v_mfma_f32_16x16x32_bf16 v[136:139], v[96:99], v[88:91], v[136:139]
ds_read_b64_tr_b16 v[50:51], v9 offset:20480
v_mfma_f32_16x16x32_bf16 v[140:143], v[96:99], v[92:95], v[140:143]
ds_read_b128 v[36:39], v3 offset:256
v_mfma_f32_16x16x32_bf16 v[204:207], v[112:115], v[92:95], v[204:207]
ds_read_b128 v[40:43], v3 offset:512
v_mfma_f32_16x16x32_bf16 v[200:203], v[112:115], v[88:91], v[200:203]
ds_read_b128 v[44:47], v3 offset:768
v_mfma_f32_16x16x32_bf16 v[196:199], v[112:115], v[84:87], v[196:199]
ds_read_b64_tr_b16 v[64:65], v9 offset:32768
v_mfma_f32_16x16x32_bf16 v[192:195], v[112:115], v[80:83], v[192:195]
ds_read_b64_tr_b16 v[66:67], v9 offset:36864
v_mfma_f32_16x16x32_bf16 v[144:147], v[100:103], v[80:83], v[144:147]
ds_read_b64_tr_b16 v[52:53], v10 offset:16384
v_mfma_f32_16x16x32_bf16 v[148:151], v[100:103], v[84:87], v[148:151]
ds_read_b64_tr_b16 v[54:55], v10 offset:20480
v_mfma_f32_16x16x32_bf16 v[152:155], v[100:103], v[88:91], v[152:155]
ds_read_b64_tr_b16 v[68:69], v10 offset:32768
v_mfma_f32_16x16x32_bf16 v[156:159], v[100:103], v[92:95], v[156:159]
ds_read_b64_tr_b16 v[70:71], v10 offset:36864
v_mfma_f32_16x16x32_bf16 v[220:223], v[116:119], v[92:95], v[220:223]
ds_read_b64_tr_b16 v[56:57], v11 offset:16384
v_mfma_f32_16x16x32_bf16 v[216:219], v[116:119], v[88:91], v[216:219]
ds_read_b64_tr_b16 v[58:59], v11 offset:20480
v_mfma_f32_16x16x32_bf16 v[212:215], v[116:119], v[84:87], v[212:215]
ds_read_b64_tr_b16 v[72:73], v11 offset:32768
v_mfma_f32_16x16x32_bf16 v[208:211], v[116:119], v[80:83], v[208:211]
ds_read_b64_tr_b16 v[74:75], v11 offset:36864
v_mfma_f32_16x16x32_bf16 v[160:163], v[104:107], v[80:83], v[160:163]
ds_read_b64_tr_b16 v[60:61], v12 offset:16384
v_mfma_f32_16x16x32_bf16 v[164:167], v[104:107], v[84:87], v[164:167]
ds_read_b64_tr_b16 v[62:63], v12 offset:20480
v_mfma_f32_16x16x32_bf16 v[168:171], v[104:107], v[88:91], v[168:171]
ds_read_b64_tr_b16 v[76:77], v12 offset:32768
v_mfma_f32_16x16x32_bf16 v[172:175], v[104:107], v[92:95], v[172:175]
ds_read_b64_tr_b16 v[78:79], v12 offset:36864
s_waitcnt lgkmcnt(14)
v_mfma_f32_16x16x32_bf16 v[236:239], v[120:123], v[92:95], v[236:239]
v_max3_u32 v19, v32, v33, v34
v_mfma_f32_16x16x32_bf16 v[232:235], v[120:123], v[88:91], v[232:235]
v_max3_u32 v19, v19, v35, v36
v_mfma_f32_16x16x32_bf16 v[228:231], v[120:123], v[84:87], v[228:231]
v_max3_u32 v19, v19, v37, v38
v_mfma_f32_16x16x32_bf16 v[224:227], v[120:123], v[80:83], v[224:227]
v_max3_u32 v19, v19, v39, v40
v_mfma_f32_16x16x32_bf16 v[176:179], v[108:111], v[80:83], v[176:179]
v_max3_u32 v19, v19, v41, v42
v_mfma_f32_16x16x32_bf16 v[180:183], v[108:111], v[84:87], v[180:183]
v_max3_u32 v19, v19, v43, v44
v_mfma_f32_16x16x32_bf16 v[184:187], v[108:111], v[88:91], v[184:187]
v_max3_u32 v19, v19, v45, v46
v_mfma_f32_16x16x32_bf16 v[188:191], v[108:111], v[92:95], v[188:191]
v_max_u32 v19, v19, v47
v_mfma_f32_16x16x32_bf16 v[252:255], v[124:127], v[92:95], v[252:255]
v_cmp_eq_u32 vcc, -1, v19
v_mfma_f32_16x16x32_bf16 v[248:251], v[124:127], v[88:91], v[248:251]
v_mfma_f32_16x16x32_bf16 v[244:247], v[124:127], v[84:87], v[244:247]
v_mfma_f32_16x16x32_bf16 v[240:243], v[124:127], v[80:83], v[240:243]
s_nop 1
s_cbranch_vccz Lok_47
s_add_u32 s44, s35, 2
s_and_b32 s44, s44, 15
s_lshl_b32 s44, s44, 14
s_add_u32 s44, s44, 0
s_mov_b32 s45, 0x20000
Lre_48:
buffer_load_dwordx4 v[32:35], v2, s[12:15], s44 offen offset:0 sc1
buffer_load_dwordx4 v[36:39], v2, s[12:15], s44 offen offset:256 sc1
buffer_load_dwordx4 v[40:43], v2, s[12:15], s44 offen offset:512 sc1
buffer_load_dwordx4 v[44:47], v2, s[12:15], s44 offen offset:768 sc1
s_waitcnt vmcnt(0)
v_max3_u32 v19, v32, v33, v34
v_max3_u32 v19, v19, v35, v36
v_max3_u32 v19, v19, v37, v38
v_max3_u32 v19, v19, v39, v40
v_max3_u32 v19, v19, v41, v42
v_max3_u32 v19, v19, v43, v44
v_max3_u32 v19, v19, v45, v46
v_max_u32 v19, v19, v47
v_cmp_eq_u32 vcc, -1, v19
s_sub_u32 s45, s45, 1
s_cmp_eq_u32 s45, 0
s_cbranch_scc1 Lok_47
s_nop 2
s_cbranch_vccnz Lre_48
Lok_47:
s_waitcnt lgkmcnt(0)
v_mfma_f32_16x16x32_bf16 v[128:131], v[48:51], v[32:35], v[128:131]
ds_read_b128 v[80:83], v3 offset:8192
v_mfma_f32_16x16x32_bf16 v[132:135], v[48:51], v[36:39], v[132:135]
ds_read_b64_tr_b16 v[96:97], v9 offset:24576
v_mfma_f32_16x16x32_bf16 v[136:139], v[48:51], v[40:43], v[136:139]
ds_read_b64_tr_b16 v[98:99], v9 offset:28672
v_mfma_f32_16x16x32_bf16 v[140:143], v[48:51], v[44:47], v[140:143]
ds_read_b128 v[84:87], v3 offset:8448
v_mfma_f32_16x16x32_bf16 v[204:207], v[64:67], v[44:47], v[204:207]
ds_read_b128 v[88:91], v3 offset:8704
v_mfma_f32_16x16x32_bf16 v[200:203], v[64:67], v[40:43], v[200:203]
ds_read_b128 v[92:95], v3 offset:8960
v_mfma_f32_16x16x32_bf16 v[196:199], v[64:67], v[36:39], v[196:199]
ds_read_b64_tr_b16 v[112:113], v9 offset:40960
v_mfma_f32_16x16x32_bf16 v[192:195], v[64:67], v[32:35], v[192:195]
ds_read_b64_tr_b16 v[114:115], v9 offset:45056
v_mfma_f32_16x16x32_bf16 v[144:147], v[52:55], v[32:35], v[144:147]
ds_read_b64_tr_b16 v[100:101], v10 offset:24576
v_mfma_f32_16x16x32_bf16 v[148:151], v[52:55], v[36:39], v[148:151]
ds_read_b64_tr_b16 v[102:103], v10 offset:28672
v_mfma_f32_16x16x32_bf16 v[152:155], v[52:55], v[40:43], v[152:155]
ds_read_b64_tr_b16 v[116:117], v10 offset:40960
v_mfma_f32_16x16x32_bf16 v[156:159], v[52:55], v[44:47], v[156:159]
ds_read_b64_tr_b16 v[118:119], v10 offset:45056
v_mfma_f32_16x16x32_bf16 v[220:223], v[68:71], v[44:47], v[220:223]
ds_read_b64_tr_b16 v[104:105], v11 offset:24576
v_mfma_f32_16x16x32_bf16 v[216:219], v[68:71], v[40:43], v[216:219]
ds_read_b64_tr_b16 v[106:107], v11 offset:28672
v_mfma_f32_16x16x32_bf16 v[212:215], v[68:71], v[36:39], v[212:215]
ds_read_b64_tr_b16 v[120:121], v11 offset:40960
v_mfma_f32_16x16x32_bf16 v[208:211], v[68:71], v[32:35], v[208:211]
ds_read_b64_tr_b16 v[122:123], v11 offset:45056
v_mfma_f32_16x16x32_bf16 v[160:163], v[56:59], v[32:35], v[160:163]
ds_read_b64_tr_b16 v[108:109], v12 offset:24576
v_mfma_f32_16x16x32_bf16 v[164:167], v[56:59], v[36:39], v[164:167]
ds_read_b64_tr_b16 v[110:111], v12 offset:28672
v_mfma_f32_16x16x32_bf16 v[168:171], v[56:59], v[40:43], v[168:171]
ds_read_b64_tr_b16 v[124:125], v12 offset:40960
v_mfma_f32_16x16x32_bf16 v[172:175], v[56:59], v[44:47], v[172:175]
ds_read_b64_tr_b16 v[126:127], v12 offset:45056
s_waitcnt lgkmcnt(14)
v_mfma_f32_16x16x32_bf16 v[236:239], v[72:75], v[44:47], v[236:239]
v_max3_u32 v19, v80, v81, v82
v_mfma_f32_16x16x32_bf16 v[232:235], v[72:75], v[40:43], v[232:235]
v_max3_u32 v19, v19, v83, v84
v_mfma_f32_16x16x32_bf16 v[228:231], v[72:75], v[36:39], v[228:231]
v_max3_u32 v19, v19, v85, v86
v_mfma_f32_16x16x32_bf16 v[224:227], v[72:75], v[32:35], v[224:227]
v_max3_u32 v19, v19, v87, v88
v_mfma_f32_16x16x32_bf16 v[176:179], v[60:63], v[32:35], v[176:179]
v_max3_u32 v19, v19, v89, v90
v_mfma_f32_16x16x32_bf16 v[180:183], v[60:63], v[36:39], v[180:183]
v_max3_u32 v19, v19, v91, v92
v_mfma_f32_16x16x32_bf16 v[184:187], v[60:63], v[40:43], v[184:187]
v_max3_u32 v19, v19, v93, v94
v_mfma_f32_16x16x32_bf16 v[188:191], v[60:63], v[44:47], v[188:191]
v_max_u32 v19, v19, v95
v_mfma_f32_16x16x32_bf16 v[252:255], v[76:79], v[44:47], v[252:255]
v_cmp_eq_u32 vcc, -1, v19
v_mfma_f32_16x16x32_bf16 v[248:251], v[76:79], v[40:43], v[248:251]
v_mfma_f32_16x16x32_bf16 v[244:247], v[76:79], v[36:39], v[244:247]
v_mfma_f32_16x16x32_bf16 v[240:243], v[76:79], v[32:35], v[240:243]
s_nop 1
s_cbranch_vccz Lok_49
s_add_u32 s44, s35, 2
s_and_b32 s44, s44, 15
s_lshl_b32 s44, s44, 14
s_add_u32 s44, s44, 8192
s_mov_b32 s45, 0x20000
Lre_50:
buffer_load_dwordx4 v[80:83], v2, s[12:15], s44 offen offset:0 sc1
buffer_load_dwordx4 v[84:87], v2, s[12:15], s44 offen offset:256 sc1
buffer_load_dwordx4 v[88:91], v2, s[12:15], s44 offen offset:512 sc1
buffer_load_dwordx4 v[92:95], v2, s[12:15], s44 offen offset:768 sc1
s_waitcnt vmcnt(0)
v_max3_u32 v19, v80, v81, v82
v_max3_u32 v19, v19, v83, v84
v_max3_u32 v19, v19, v85, v86
v_max3_u32 v19, v19, v87, v88
v_max3_u32 v19, v19, v89, v90
v_max3_u32 v19, v19, v91, v92
v_max3_u32 v19, v19, v93, v94
v_max_u32 v19, v19, v95
v_cmp_eq_u32 vcc, -1, v19
s_sub_u32 s45, s45, 1
s_cmp_eq_u32 s45, 0
s_cbranch_scc1 Lok_49
s_nop 2
s_cbranch_vccnz Lre_50
Lok_49:
s_waitcnt lgkmcnt(0)
s_barrier
v_mfma_f32_16x16x32_bf16 v[128:131], v[96:99], v[80:83], v[128:131]
ds_read_b128 v[32:35], v4 offset:0
v_mfma_f32_16x16x32_bf16 v[132:135], v[96:99], v[84:87], v[132:135]
ds_read_b64_tr_b16 v[48:49], v13 offset:16384
v_mfma_f32_16x16x32_bf16 v[136:139], v[96:99], v[88:91], v[136:139]
ds_read_b64_tr_b16 v[50:51], v13 offset:20480
v_mfma_f32_16x16x32_bf16 v[140:143], v[96:99], v[92:95], v[140:143]
ds_read_b128 v[36:39], v4 offset:256
v_mfma_f32_16x16x32_bf16 v[204:207], v[112:115], v[92:95], v[204:207]
ds_read_b128 v[40:43], v4 offset:512
v_mfma_f32_16x16x32_bf16 v[200:203], v[112:115], v[88:91], v[200:203]
ds_read_b128 v[44:47], v4 offset:768
v_mfma_f32_16x16x32_bf16 v[196:199], v[112:115], v[84:87], v[196:199]
ds_read_b64_tr_b16 v[64:65], v13 offset:32768
v_mfma_f32_16x16x32_bf16 v[192:195], v[112:115], v[80:83], v[192:195]
ds_read_b64_tr_b16 v[66:67], v13 offset:36864
v_mfma_f32_16x16x32_bf16 v[144:147], v[100:103], v[80:83], v[144:147]
ds_read_b64_tr_b16 v[52:53], v14 offset:16384
v_mfma_f32_16x16x32_bf16 v[148:151], v[100:103], v[84:87], v[148:151]
ds_read_b64_tr_b16 v[54:55], v14 offset:20480
v_mfma_f32_16x16x32_bf16 v[152:155], v[100:103], v[88:91], v[152:155]
ds_read_b64_tr_b16 v[68:69], v14 offset:32768
v_mfma_f32_16x16x32_bf16 v[156:159], v[100:103], v[92:95], v[156:159]
ds_read_b64_tr_b16 v[70:71], v14 offset:36864
v_mfma_f32_16x16x32_bf16 v[220:223], v[116:119], v[92:95], v[220:223]
ds_read_b64_tr_b16 v[56:57], v15 offset:16384
v_mfma_f32_16x16x32_bf16 v[216:219], v[116:119], v[88:91], v[216:219]
ds_read_b64_tr_b16 v[58:59], v15 offset:20480
v_mfma_f32_16x16x32_bf16 v[212:215], v[116:119], v[84:87], v[212:215]
ds_read_b64_tr_b16 v[72:73], v15 offset:32768
v_mfma_f32_16x16x32_bf16 v[208:211], v[116:119], v[80:83], v[208:211]
ds_read_b64_tr_b16 v[74:75], v15 offset:36864
v_mfma_f32_16x16x32_bf16 v[160:163], v[104:107], v[80:83], v[160:163]
ds_read_b64_tr_b16 v[60:61], v16 offset:16384
v_mfma_f32_16x16x32_bf16 v[164:167], v[104:107], v[84:87], v[164:167]
ds_read_b64_tr_b16 v[62:63], v16 offset:20480
v_mfma_f32_16x16x32_bf16 v[168:171], v[104:107], v[88:91], v[168:171]
ds_read_b64_tr_b16 v[76:77], v16 offset:32768
v_mfma_f32_16x16x32_bf16 v[172:175], v[104:107], v[92:95], v[172:175]
ds_read_b64_tr_b16 v[78:79], v16 offset:36864
s_waitcnt lgkmcnt(14)
v_mfma_f32_16x16x32_bf16 v[236:239], v[120:123], v[92:95], v[236:239]
v_max3_u32 v19, v32, v33, v34
v_mfma_f32_16x16x32_bf16 v[232:235], v[120:123], v[88:91], v[232:235]
v_max3_u32 v19, v19, v35, v36
v_mfma_f32_16x16x32_bf16 v[228:231], v[120:123], v[84:87], v[228:231]
v_max3_u32 v19, v19, v37, v38
v_mfma_f32_16x16x32_bf16 v[224:227], v[120:123], v[80:83], v[224:227]
v_max3_u32 v19, v19, v39, v40
v_mfma_f32_16x16x32_bf16 v[176:179], v[108:111], v[80:83], v[176:179]
v_max3_u32 v19, v19, v41, v42
v_mfma_f32_16x16x32_bf16 v[180:183], v[108:111], v[84:87], v[180:183]
v_max3_u32 v19, v19, v43, v44
v_mfma_f32_16x16x32_bf16 v[184:187], v[108:111], v[88:91], v[184:187]
v_max3_u32 v19, v19, v45, v46
v_mfma_f32_16x16x32_bf16 v[188:191], v[108:111], v[92:95], v[188:191]
v_max_u32 v19, v19, v47
v_mfma_f32_16x16x32_bf16 v[252:255], v[124:127], v[92:95], v[252:255]
v_cmp_eq_u32 vcc, -1, v19
v_mfma_f32_16x16x32_bf16 v[248:251], v[124:127], v[88:91], v[248:251]
v_mfma_f32_16x16x32_bf16 v[244:247], v[124:127], v[84:87], v[244:247]
v_mfma_f32_16x16x32_bf16 v[240:243], v[124:127], v[80:83], v[240:243]
s_nop 1
s_cbranch_vccz Lok_51
s_add_u32 s44, s35, 3
s_and_b32 s44, s44, 15
s_lshl_b32 s44, s44, 14
s_add_u32 s44, s44, 0
s_mov_b32 s45, 0x20000
Lre_52:
buffer_load_dwordx4 v[32:35], v2, s[12:15], s44 offen offset:0 sc1
buffer_load_dwordx4 v[36:39], v2, s[12:15], s44 offen offset:256 sc1
buffer_load_dwordx4 v[40:43], v2, s[12:15], s44 offen offset:512 sc1
buffer_load_dwordx4 v[44:47], v2, s[12:15], s44 offen offset:768 sc1
s_waitcnt vmcnt(0)
v_max3_u32 v19, v32, v33, v34
v_max3_u32 v19, v19, v35, v36
v_max3_u32 v19, v19, v37, v38
v_max3_u32 v19, v19, v39, v40
v_max3_u32 v19, v19, v41, v42
v_max3_u32 v19, v19, v43, v44
v_max3_u32 v19, v19, v45, v46
v_max_u32 v19, v19, v47
v_cmp_eq_u32 vcc, -1, v19
s_sub_u32 s45, s45, 1
s_cmp_eq_u32 s45, 0
s_cbranch_scc1 Lok_51
s_nop 2
s_cbranch_vccnz Lre_52
Lok_51:
s_waitcnt lgkmcnt(0)
v_mfma_f32_16x16x32_bf16 v[128:131], v[48:51], v[32:35], v[128:131]
ds_read_b128 v[80:83], v4 offset:8192
v_mfma_f32_16x16x32_bf16 v[132:135], v[48:51], v[36:39], v[132:135]
ds_read_b64_tr_b16 v[96:97], v13 offset:24576
v_mfma_f32_16x16x32_bf16 v[136:139], v[48:51], v[40:43], v[136:139]
ds_read_b64_tr_b16 v[98:99], v13 offset:28672
v_mfma_f32_16x16x32_bf16 v[140:143], v[48:51], v[44:47], v[140:143]
ds_read_b128 v[84:87], v4 offset:8448
v_mfma_f32_16x16x32_bf16 v[204:207], v[64:67], v[44:47], v[204:207]
ds_read_b128 v[88:91], v4 offset:8704
v_mfma_f32_16x16x32_bf16 v[200:203], v[64:67], v[40:43], v[200:203]
ds_read_b128 v[92:95], v4 offset:8960
v_mfma_f32_16x16x32_bf16 v[196:199], v[64:67], v[36:39], v[196:199]
ds_read_b64_tr_b16 v[112:113], v13 offset:40960
v_mfma_f32_16x16x32_bf16 v[192:195], v[64:67], v[32:35], v[192:195]
ds_read_b64_tr_b16 v[114:115], v13 offset:45056
v_mfma_f32_16x16x32_bf16 v[144:147], v[52:55], v[32:35], v[144:147]
ds_read_b64_tr_b16 v[100:101], v14 offset:24576
v_mfma_f32_16x16x32_bf16 v[148:151], v[52:55], v[36:39], v[148:151]
ds_read_b64_tr_b16 v[102:103], v14 offset:28672
v_mfma_f32_16x16x32_bf16 v[152:155], v[52:55], v[40:43], v[152:155]
ds_read_b64_tr_b16 v[116:117], v14 offset:40960
v_mfma_f32_16x16x32_bf16 v[156:159], v[52:55], v[44:47], v[156:159]
ds_read_b64_tr_b16 v[118:119], v14 offset:45056
v_mfma_f32_16x16x32_bf16 v[220:223], v[68:71], v[44:47], v[220:223]
ds_read_b64_tr_b16 v[104:105], v15 offset:24576
v_mfma_f32_16x16x32_bf16 v[216:219], v[68:71], v[40:43], v[216:219]
ds_read_b64_tr_b16 v[106:107], v15 offset:28672
v_mfma_f32_16x16x32_bf16 v[212:215], v[68:71], v[36:39], v[212:215]
ds_read_b64_tr_b16 v[120:121], v15 offset:40960
v_mfma_f32_16x16x32_bf16 v[208:211], v[68:71], v[32:35], v[208:211]
ds_read_b64_tr_b16 v[122:123], v15 offset:45056
v_mfma_f32_16x16x32_bf16 v[160:163], v[56:59], v[32:35], v[160:163]
ds_read_b64_tr_b16 v[108:109], v16 offset:24576
v_mfma_f32_16x16x32_bf16 v[164:167], v[56:59], v[36:39], v[164:167]
ds_read_b64_tr_b16 v[110:111], v16 offset:28672
v_mfma_f32_16x16x32_bf16 v[168:171], v[56:59], v[40:43], v[168:171]
ds_read_b64_tr_b16 v[124:125], v16 offset:40960
v_mfma_f32_16x16x32_bf16 v[172:175], v[56:59], v[44:47], v[172:175]
ds_read_b64_tr_b16 v[126:127], v16 offset:45056
s_waitcnt lgkmcnt(14)
v_mfma_f32_16x16x32_bf16 v[236:239], v[72:75], v[44:47], v[236:239]
v_max3_u32 v19, v80, v81, v82
v_mfma_f32_16x16x32_bf16 v[232:235], v[72:75], v[40:43], v[232:235]
v_max3_u32 v19, v19, v83, v84
v_mfma_f32_16x16x32_bf16 v[228:231], v[72:75], v[36:39], v[228:231]
v_max3_u32 v19, v19, v85, v86
v_mfma_f32_16x16x32_bf16 v[224:227], v[72:75], v[32:35], v[224:227]
v_max3_u32 v19, v19, v87, v88
v_mfma_f32_16x16x32_bf16 v[176:179], v[60:63], v[32:35], v[176:179]
v_max3_u32 v19, v19, v89, v90
v_mfma_f32_16x16x32_bf16 v[180:183], v[60:63], v[36:39], v[180:183]
v_max3_u32 v19, v19, v91, v92
v_mfma_f32_16x16x32_bf16 v[184:187], v[60:63], v[40:43], v[184:187]
v_max3_u32 v19, v19, v93, v94
v_mfma_f32_16x16x32_bf16 v[188:191], v[60:63], v[44:47], v[188:191]
v_max_u32 v19, v19, v95
v_mfma_f32_16x16x32_bf16 v[252:255], v[76:79], v[44:47], v[252:255]
v_cmp_eq_u32 vcc, -1, v19
v_mfma_f32_16x16x32_bf16 v[248:251], v[76:79], v[40:43], v[248:251]
v_mfma_f32_16x16x32_bf16 v[244:247], v[76:79], v[36:39], v[244:247]
v_mfma_f32_16x16x32_bf16 v[240:243], v[76:79], v[32:35], v[240:243]
s_nop 1
s_cbranch_vccz Lok_53
s_add_u32 s44, s35, 3
s_and_b32 s44, s44, 15
s_lshl_b32 s44, s44, 14
s_add_u32 s44, s44, 8192
s_mov_b32 s45, 0x20000
Lre_54:
buffer_load_dwordx4 v[80:83], v2, s[12:15], s44 offen offset:0 sc1
buffer_load_dwordx4 v[84:87], v2, s[12:15], s44 offen offset:256 sc1
buffer_load_dwordx4 v[88:91], v2, s[12:15], s44 offen offset:512 sc1
buffer_load_dwordx4 v[92:95], v2, s[12:15], s44 offen offset:768 sc1
s_waitcnt vmcnt(0)
v_max3_u32 v19, v80, v81, v82
v_max3_u32 v19, v19, v83, v84
v_max3_u32 v19, v19, v85, v86
v_max3_u32 v19, v19, v87, v88
v_max3_u32 v19, v19, v89, v90
v_max3_u32 v19, v19, v91, v92
v_max3_u32 v19, v19, v93, v94
v_max_u32 v19, v19, v95
v_cmp_eq_u32 vcc, -1, v19
s_sub_u32 s45, s45, 1
s_cmp_eq_u32 s45, 0
s_cbranch_scc1 Lok_53
s_nop 2
s_cbranch_vccnz Lre_54
Lok_53:
s_waitcnt lgkmcnt(0)
s_barrier
v_mfma_f32_16x16x32_bf16 v[128:131], v[96:99], v[80:83], v[128:131]
ds_read_b128 v[32:35], v2 offset:0
v_mfma_f32_16x16x32_bf16 v[132:135], v[96:99], v[84:87], v[132:135]
ds_read_b64_tr_b16 v[48:49], v5 offset:16384
v_mfma_f32_16x16x32_bf16 v[136:139], v[96:99], v[88:91], v[136:139]
ds_read_b64_tr_b16 v[50:51], v5 offset:20480
v_mfma_f32_16x16x32_bf16 v[140:143], v[96:99], v[92:95], v[140:143]
ds_read_b128 v[36:39], v2 offset:256
v_mfma_f32_16x16x32_bf16 v[204:207], v[112:115], v[92:95], v[204:207]
ds_read_b128 v[40:43], v2 offset:512
v_mfma_f32_16x16x32_bf16 v[200:203], v[112:115], v[88:91], v[200:203]
ds_read_b128 v[44:47], v2 offset:768
v_mfma_f32_16x16x32_bf16 v[196:199], v[112:115], v[84:87], v[196:199]
ds_read_b64_tr_b16 v[64:65], v5 offset:32768
v_mfma_f32_16x16x32_bf16 v[192:195], v[112:115], v[80:83], v[192:195]
ds_read_b64_tr_b16 v[66:67], v5 offset:36864
v_mfma_f32_16x16x32_bf16 v[144:147], v[100:103], v[80:83], v[144:147]
ds_read_b64_tr_b16 v[52:53], v6 offset:16384
v_mfma_f32_16x16x32_bf16 v[148:151], v[100:103], v[84:87], v[148:151]
ds_read_b64_tr_b16 v[54:55], v6 offset:20480
v_mfma_f32_16x16x32_bf16 v[152:155], v[100:103], v[88:91], v[152:155]
ds_read_b64_tr_b16 v[68:69], v6 offset:32768
v_mfma_f32_16x16x32_bf16 v[156:159], v[100:103], v[92:95], v[156:159]
ds_read_b64_tr_b16 v[70:71], v6 offset:36864
v_mfma_f32_16x16x32_bf16 v[220:223], v[116:119], v[92:95], v[220:223]
ds_read_b64_tr_b16 v[56:57], v7 offset:16384
v_mfma_f32_16x16x32_bf16 v[216:219], v[116:119], v[88:91], v[216:219]
ds_read_b64_tr_b16 v[58:59], v7 offset:20480
v_mfma_f32_16x16x32_bf16 v[212:215], v[116:119], v[84:87], v[212:215]
ds_read_b64_tr_b16 v[72:73], v7 offset:32768
v_mfma_f32_16x16x32_bf16 v[208:211], v[116:119], v[80:83], v[208:211]
ds_read_b64_tr_b16 v[74:75], v7 offset:36864
v_mfma_f32_16x16x32_bf16 v[160:163], v[104:107], v[80:83], v[160:163]
ds_read_b64_tr_b16 v[60:61], v8 offset:16384
v_mfma_f32_16x16x32_bf16 v[164:167], v[104:107], v[84:87], v[164:167]
ds_read_b64_tr_b16 v[62:63], v8 offset:20480
v_mfma_f32_16x16x32_bf16 v[168:171], v[104:107], v[88:91], v[168:171]
ds_read_b64_tr_b16 v[76:77], v8 offset:32768
v_mfma_f32_16x16x32_bf16 v[172:175], v[104:107], v[92:95], v[172:175]
ds_read_b64_tr_b16 v[78:79], v8 offset:36864
s_waitcnt lgkmcnt(14)
v_mfma_f32_16x16x32_bf16 v[236:239], v[120:123], v[92:95], v[236:239]
v_max3_u32 v19, v32, v33, v34
v_mfma_f32_16x16x32_bf16 v[232:235], v[120:123], v[88:91], v[232:235]
v_max3_u32 v19, v19, v35, v36
v_mfma_f32_16x16x32_bf16 v[228:231], v[120:123], v[84:87], v[228:231]
v_max3_u32 v19, v19, v37, v38
v_mfma_f32_16x16x32_bf16 v[224:227], v[120:123], v[80:83], v[224:227]
v_max3_u32 v19, v19, v39, v40
v_mfma_f32_16x16x32_bf16 v[176:179], v[108:111], v[80:83], v[176:179]
v_max3_u32 v19, v19, v41, v42
v_mfma_f32_16x16x32_bf16 v[180:183], v[108:111], v[84:87], v[180:183]
v_max3_u32 v19, v19, v43, v44
v_mfma_f32_16x16x32_bf16 v[184:187], v[108:111], v[88:91], v[184:187]
v_max3_u32 v19, v19, v45, v46
v_mfma_f32_16x16x32_bf16 v[188:191], v[108:111], v[92:95], v[188:191]
v_max_u32 v19, v19, v47
v_mfma_f32_16x16x32_bf16 v[252:255], v[124:127], v[92:95], v[252:255]
v_cmp_eq_u32 vcc, -1, v19
v_mfma_f32_16x16x32_bf16 v[248:251], v[124:127], v[88:91], v[248:251]
v_mfma_f32_16x16x32_bf16 v[244:247], v[124:127], v[84:87], v[244:247]
v_mfma_f32_16x16x32_bf16 v[240:243], v[124:127], v[80:83], v[240:243]
s_nop 1
s_cbranch_vccz Lok_55
s_add_u32 s44, s35, 4
s_and_b32 s44, s44, 15
s_lshl_b32 s44, s44, 14
s_add_u32 s44, s44, 0
s_mov_b32 s45, 0x20000
Lre_56:
buffer_load_dwordx4 v[32:35], v2, s[12:15], s44 offen offset:0 sc1
buffer_load_dwordx4 v[36:39], v2, s[12:15], s44 offen offset:256 sc1
buffer_load_dwordx4 v[40:43], v2, s[12:15], s44 offen offset:512 sc1
buffer_load_dwordx4 v[44:47], v2, s[12:15], s44 offen offset:768 sc1
s_waitcnt vmcnt(0)
v_max3_u32 v19, v32, v33, v34
v_max3_u32 v19, v19, v35, v36
v_max3_u32 v19, v19, v37, v38
v_max3_u32 v19, v19, v39, v40
v_max3_u32 v19, v19, v41, v42
v_max3_u32 v19, v19, v43, v44
v_max3_u32 v19, v19, v45, v46
v_max_u32 v19, v19, v47
v_cmp_eq_u32 vcc, -1, v19
s_sub_u32 s45, s45, 1
s_cmp_eq_u32 s45, 0
s_cbranch_scc1 Lok_55
s_nop 2
s_cbranch_vccnz Lre_56
Lok_55:
s_waitcnt lgkmcnt(0)
v_mfma_f32_16x16x32_bf16 v[128:131], v[48:51], v[32:35], v[128:131]
ds_read_b128 v[80:83], v2 offset:8192
v_mfma_f32_16x16x32_bf16 v[132:135], v[48:51], v[36:39], v[132:135]
ds_read_b64_tr_b16 v[96:97], v5 offset:24576
v_mfma_f32_16x16x32_bf16 v[136:139], v[48:51], v[40:43], v[136:139]
ds_read_b64_tr_b16 v[98:99], v5 offset:28672
v_mfma_f32_16x16x32_bf16 v[140:143], v[48:51], v[44:47], v[140:143]
ds_read_b128 v[84:87], v2 offset:8448
v_mfma_f32_16x16x32_bf16 v[204:207], v[64:67], v[44:47], v[204:207]
ds_read_b128 v[88:91], v2 offset:8704
v_mfma_f32_16x16x32_bf16 v[200:203], v[64:67], v[40:43], v[200:203]
ds_read_b128 v[92:95], v2 offset:8960
v_mfma_f32_16x16x32_bf16 v[196:199], v[64:67], v[36:39], v[196:199]
ds_read_b64_tr_b16 v[112:113], v5 offset:40960
v_mfma_f32_16x16x32_bf16 v[192:195], v[64:67], v[32:35], v[192:195]
ds_read_b64_tr_b16 v[114:115], v5 offset:45056
v_mfma_f32_16x16x32_bf16 v[144:147], v[52:55], v[32:35], v[144:147]
ds_read_b64_tr_b16 v[100:101], v6 offset:24576
v_mfma_f32_16x16x32_bf16 v[148:151], v[52:55], v[36:39], v[148:151]
ds_read_b64_tr_b16 v[102:103], v6 offset:28672
v_mfma_f32_16x16x32_bf16 v[152:155], v[52:55], v[40:43], v[152:155]
ds_read_b64_tr_b16 v[116:117], v6 offset:40960
v_mfma_f32_16x16x32_bf16 v[156:159], v[52:55], v[44:47], v[156:159]
ds_read_b64_tr_b16 v[118:119], v6 offset:45056
v_mfma_f32_16x16x32_bf16 v[220:223], v[68:71], v[44:47], v[220:223]
ds_read_b64_tr_b16 v[104:105], v7 offset:24576
v_mfma_f32_16x16x32_bf16 v[216:219], v[68:71], v[40:43], v[216:219]
ds_read_b64_tr_b16 v[106:107], v7 offset:28672
v_mfma_f32_16x16x32_bf16 v[212:215], v[68:71], v[36:39], v[212:215]
ds_read_b64_tr_b16 v[120:121], v7 offset:40960
v_mfma_f32_16x16x32_bf16 v[208:211], v[68:71], v[32:35], v[208:211]
ds_read_b64_tr_b16 v[122:123], v7 offset:45056
v_mfma_f32_16x16x32_bf16 v[160:163], v[56:59], v[32:35], v[160:163]
ds_read_b64_tr_b16 v[108:109], v8 offset:24576
v_mfma_f32_16x16x32_bf16 v[164:167], v[56:59], v[36:39], v[164:167]
ds_read_b64_tr_b16 v[110:111], v8 offset:28672
v_mfma_f32_16x16x32_bf16 v[168:171], v[56:59], v[40:43], v[168:171]
ds_read_b64_tr_b16 v[124:125], v8 offset:40960
v_mfma_f32_16x16x32_bf16 v[172:175], v[56:59], v[44:47], v[172:175]
ds_read_b64_tr_b16 v[126:127], v8 offset:45056
s_waitcnt lgkmcnt(14)
v_mfma_f32_16x16x32_bf16 v[236:239], v[72:75], v[44:47], v[236:239]
v_max3_u32 v19, v80, v81, v82
v_mfma_f32_16x16x32_bf16 v[232:235], v[72:75], v[40:43], v[232:235]
v_max3_u32 v19, v19, v83, v84
v_mfma_f32_16x16x32_bf16 v[228:231], v[72:75], v[36:39], v[228:231]
v_max3_u32 v19, v19, v85, v86
v_mfma_f32_16x16x32_bf16 v[224:227], v[72:75], v[32:35], v[224:227]
v_max3_u32 v19, v19, v87, v88
v_mfma_f32_16x16x32_bf16 v[176:179], v[60:63], v[32:35], v[176:179]
v_max3_u32 v19, v19, v89, v90
v_mfma_f32_16x16x32_bf16 v[180:183], v[60:63], v[36:39], v[180:183]
v_max3_u32 v19, v19, v91, v92
v_mfma_f32_16x16x32_bf16 v[184:187], v[60:63], v[40:43], v[184:187]
v_max3_u32 v19, v19, v93, v94
v_mfma_f32_16x16x32_bf16 v[188:191], v[60:63], v[44:47], v[188:191]
v_max_u32 v19, v19, v95
v_mfma_f32_16x16x32_bf16 v[252:255], v[76:79], v[44:47], v[252:255]
v_cmp_eq_u32 vcc, -1, v19
v_mfma_f32_16x16x32_bf16 v[248:251], v[76:79], v[40:43], v[248:251]
v_mfma_f32_16x16x32_bf16 v[244:247], v[76:79], v[36:39], v[244:247]
v_mfma_f32_16x16x32_bf16 v[240:243], v[76:79], v[32:35], v[240:243]
s_nop 1
s_cbranch_vccz Lok_57
s_add_u32 s44, s35, 4
s_and_b32 s44, s44, 15
s_lshl_b32 s44, s44, 14
s_add_u32 s44, s44, 8192
s_mov_b32 s45, 0x20000
Lre_58:
buffer_load_dwordx4 v[80:83], v2, s[12:15], s44 offen offset:0 sc1
buffer_load_dwordx4 v[84:87], v2, s[12:15], s44 offen offset:256 sc1
buffer_load_dwordx4 v[88:91], v2, s[12:15], s44 offen offset:512 sc1
buffer_load_dwordx4 v[92:95], v2, s[12:15], s44 offen offset:768 sc1
s_waitcnt vmcnt(0)
v_max3_u32 v19, v80, v81, v82
v_max3_u32 v19, v19, v83, v84
v_max3_u32 v19, v19, v85, v86
v_max3_u32 v19, v19, v87, v88
v_max3_u32 v19, v19, v89, v90
v_max3_u32 v19, v19, v91, v92
v_max3_u32 v19, v19, v93, v94
v_max_u32 v19, v19, v95
v_cmp_eq_u32 vcc, -1, v19
s_sub_u32 s45, s45, 1
s_cmp_eq_u32 s45, 0
s_cbranch_scc1 Lok_57
s_nop 2
s_cbranch_vccnz Lre_58
Lok_57:
s_waitcnt lgkmcnt(0)
s_barrier
v_mfma_f32_16x16x32_bf16 v[128:131], v[96:99], v[80:83], v[128:131]
ds_read_b128 v[32:35], v3 offset:0
v_mfma_f32_16x16x32_bf16 v[132:135], v[96:99], v[84:87], v[132:135]
ds_read_b64_tr_b16 v[48:49], v9 offset:16384
v_mfma_f32_16x16x32_bf16 v[136:139], v[96:99], v[88:91], v[136:139]
ds_read_b64_tr_b16 v[50:51], v9 offset:20480
v_mfma_f32_16x16x32_bf16 v[140:143], v[96:99], v[92:95], v[140:143]
ds_read_b128 v[36:39], v3 offset:256
v_mfma_f32_16x16x32_bf16 v[204:207], v[112:115], v[92:95], v[204:207]
ds_read_b128 v[40:43], v3 offset:512
v_mfma_f32_16x16x32_bf16 v[200:203], v[112:115], v[88:91], v[200:203]
ds_read_b128 v[44:47], v3 offset:768
v_mfma_f32_16x16x32_bf16 v[196:199], v[112:115], v[84:87], v[196:199]
ds_read_b64_tr_b16 v[64:65], v9 offset:32768
v_mfma_f32_16x16x32_bf16 v[192:195], v[112:115], v[80:83], v[192:195]
ds_read_b64_tr_b16 v[66:67], v9 offset:36864
v_mfma_f32_16x16x32_bf16 v[144:147], v[100:103], v[80:83], v[144:147]
ds_read_b64_tr_b16 v[52:53], v10 offset:16384
v_mfma_f32_16x16x32_bf16 v[148:151], v[100:103], v[84:87], v[148:151]
ds_read_b64_tr_b16 v[54:55], v10 offset:20480
v_mfma_f32_16x16x32_bf16 v[152:155], v[100:103], v[88:91], v[152:155]
ds_read_b64_tr_b16 v[68:69], v10 offset:32768
v_mfma_f32_16x16x32_bf16 v[156:159], v[100:103], v[92:95], v[156:159]
ds_read_b64_tr_b16 v[70:71], v10 offset:36864
v_mfma_f32_16x16x32_bf16 v[220:223], v[116:119], v[92:95], v[220:223]
ds_read_b64_tr_b16 v[56:57], v11 offset:16384
v_mfma_f32_16x16x32_bf16 v[216:219], v[116:119], v[88:91], v[216:219]
ds_read_b64_tr_b16 v[58:59], v11 offset:20480
v_mfma_f32_16x16x32_bf16 v[212:215], v[116:119], v[84:87], v[212:215]
ds_read_b64_tr_b16 v[72:73], v11 offset:32768
v_mfma_f32_16x16x32_bf16 v[208:211], v[116:119], v[80:83], v[208:211]
ds_read_b64_tr_b16 v[74:75], v11 offset:36864
v_mfma_f32_16x16x32_bf16 v[160:163], v[104:107], v[80:83], v[160:163]
ds_read_b64_tr_b16 v[60:61], v12 offset:16384
v_mfma_f32_16x16x32_bf16 v[164:167], v[104:107], v[84:87], v[164:167]
ds_read_b64_tr_b16 v[62:63], v12 offset:20480
v_mfma_f32_16x16x32_bf16 v[168:171], v[104:107], v[88:91], v[168:171]
ds_read_b64_tr_b16 v[76:77], v12 offset:32768
v_mfma_f32_16x16x32_bf16 v[172:175], v[104:107], v[92:95], v[172:175]
ds_read_b64_tr_b16 v[78:79], v12 offset:36864
s_waitcnt lgkmcnt(14)
v_mfma_f32_16x16x32_bf16 v[236:239], v[120:123], v[92:95], v[236:239]
v_max3_u32 v19, v32, v33, v34
v_mfma_f32_16x16x32_bf16 v[232:235], v[120:123], v[88:91], v[232:235]
v_max3_u32 v19, v19, v35, v36
v_mfma_f32_16x16x32_bf16 v[228:231], v[120:123], v[84:87], v[228:231]
v_max3_u32 v19, v19, v37, v38
v_mfma_f32_16x16x32_bf16 v[224:227], v[120:123], v[80:83], v[224:227]
v_max3_u32 v19, v19, v39, v40
v_mfma_f32_16x16x32_bf16 v[176:179], v[108:111], v[80:83], v[176:179]
v_max3_u32 v19, v19, v41, v42
v_mfma_f32_16x16x32_bf16 v[180:183], v[108:111], v[84:87], v[180:183]
v_max3_u32 v19, v19, v43, v44
v_mfma_f32_16x16x32_bf16 v[184:187], v[108:111], v[88:91], v[184:187]
v_max3_u32 v19, v19, v45, v46
v_mfma_f32_16x16x32_bf16 v[188:191], v[108:111], v[92:95], v[188:191]
v_max_u32 v19, v19, v47
v_mfma_f32_16x16x32_bf16 v[252:255], v[124:127], v[92:95], v[252:255]
v_cmp_eq_u32 vcc, -1, v19
v_mfma_f32_16x16x32_bf16 v[248:251], v[124:127], v[88:91], v[248:251]
v_mfma_f32_16x16x32_bf16 v[244:247], v[124:127], v[84:87], v[244:247]
v_mfma_f32_16x16x32_bf16 v[240:243], v[124:127], v[80:83], v[240:243]
s_nop 1
s_cbranch_vccz Lok_59
s_add_u32 s44, s35, 5
s_and_b32 s44, s44, 15
s_lshl_b32 s44, s44, 14
s_add_u32 s44, s44, 0
s_mov_b32 s45, 0x20000
Lre_60:
buffer_load_dwordx4 v[32:35], v2, s[12:15], s44 offen offset:0 sc1
buffer_load_dwordx4 v[36:39], v2, s[12:15], s44 offen offset:256 sc1
buffer_load_dwordx4 v[40:43], v2, s[12:15], s44 offen offset:512 sc1
buffer_load_dwordx4 v[44:47], v2, s[12:15], s44 offen offset:768 sc1
s_waitcnt vmcnt(0)
v_max3_u32 v19, v32, v33, v34
v_max3_u32 v19, v19, v35, v36
v_max3_u32 v19, v19, v37, v38
v_max3_u32 v19, v19, v39, v40
v_max3_u32 v19, v19, v41, v42
v_max3_u32 v19, v19, v43, v44
v_max3_u32 v19, v19, v45, v46
v_max_u32 v19, v19, v47
v_cmp_eq_u32 vcc, -1, v19
s_sub_u32 s45, s45, 1
s_cmp_eq_u32 s45, 0
s_cbranch_scc1 Lok_59
s_nop 2
s_cbranch_vccnz Lre_60
Lok_59:
s_waitcnt lgkmcnt(0)
v_mfma_f32_16x16x32_bf16 v[128:131], v[48:51], v[32:35], v[128:131]
ds_read_b128 v[80:83], v3 offset:8192
v_mfma_f32_16x16x32_bf16 v[132:135], v[48:51], v[36:39], v[132:135]
ds_read_b64_tr_b16 v[96:97], v9 offset:24576
v_mfma_f32_16x16x32_bf16 v[136:139], v[48:51], v[40:43], v[136:139]
ds_read_b64_tr_b16 v[98:99], v9 offset:28672
v_mfma_f32_16x16x32_bf16 v[140:143], v[48:51], v[44:47], v[140:143]
ds_read_b128 v[84:87], v3 offset:8448
v_mfma_f32_16x16x32_bf16 v[204:207], v[64:67], v[44:47], v[204:207]
ds_read_b128 v[88:91], v3 offset:8704
v_mfma_f32_16x16x32_bf16 v[200:203], v[64:67], v[40:43], v[200:203]
ds_read_b128 v[92:95], v3 offset:8960
v_mfma_f32_16x16x32_bf16 v[196:199], v[64:67], v[36:39], v[196:199]
ds_read_b64_tr_b16 v[112:113], v9 offset:40960
v_mfma_f32_16x16x32_bf16 v[192:195], v[64:67], v[32:35], v[192:195]
ds_read_b64_tr_b16 v[114:115], v9 offset:45056
v_mfma_f32_16x16x32_bf16 v[144:147], v[52:55], v[32:35], v[144:147]
ds_read_b64_tr_b16 v[100:101], v10 offset:24576
v_mfma_f32_16x16x32_bf16 v[148:151], v[52:55], v[36:39], v[148:151]
ds_read_b64_tr_b16 v[102:103], v10 offset:28672
v_mfma_f32_16x16x32_bf16 v[152:155], v[52:55], v[40:43], v[152:155]
ds_read_b64_tr_b16 v[116:117], v10 offset:40960
v_mfma_f32_16x16x32_bf16 v[156:159], v[52:55], v[44:47], v[156:159]
ds_read_b64_tr_b16 v[118:119], v10 offset:45056
v_mfma_f32_16x16x32_bf16 v[220:223], v[68:71], v[44:47], v[220:223]
ds_read_b64_tr_b16 v[104:105], v11 offset:24576
v_mfma_f32_16x16x32_bf16 v[216:219], v[68:71], v[40:43], v[216:219]
ds_read_b64_tr_b16 v[106:107], v11 offset:28672
v_mfma_f32_16x16x32_bf16 v[212:215], v[68:71], v[36:39], v[212:215]
ds_read_b64_tr_b16 v[120:121], v11 offset:40960
v_mfma_f32_16x16x32_bf16 v[208:211], v[68:71], v[32:35], v[208:211]
ds_read_b64_tr_b16 v[122:123], v11 offset:45056
v_mfma_f32_16x16x32_bf16 v[160:163], v[56:59], v[32:35], v[160:163]
ds_read_b64_tr_b16 v[108:109], v12 offset:24576
v_mfma_f32_16x16x32_bf16 v[164:167], v[56:59], v[36:39], v[164:167]
ds_read_b64_tr_b16 v[110:111], v12 offset:28672
v_mfma_f32_16x16x32_bf16 v[168:171], v[56:59], v[40:43], v[168:171]
ds_read_b64_tr_b16 v[124:125], v12 offset:40960
v_mfma_f32_16x16x32_bf16 v[172:175], v[56:59], v[44:47], v[172:175]
ds_read_b64_tr_b16 v[126:127], v12 offset:45056
s_waitcnt lgkmcnt(14)
v_mfma_f32_16x16x32_bf16 v[236:239], v[72:75], v[44:47], v[236:239]
v_max3_u32 v19, v80, v81, v82
v_mfma_f32_16x16x32_bf16 v[232:235], v[72:75], v[40:43], v[232:235]
v_max3_u32 v19, v19, v83, v84
v_mfma_f32_16x16x32_bf16 v[228:231], v[72:75], v[36:39], v[228:231]
v_max3_u32 v19, v19, v85, v86
v_mfma_f32_16x16x32_bf16 v[224:227], v[72:75], v[32:35], v[224:227]
v_max3_u32 v19, v19, v87, v88
v_mfma_f32_16x16x32_bf16 v[176:179], v[60:63], v[32:35], v[176:179]
v_max3_u32 v19, v19, v89, v90
v_mfma_f32_16x16x32_bf16 v[180:183], v[60:63], v[36:39], v[180:183]
v_max3_u32 v19, v19, v91, v92
v_mfma_f32_16x16x32_bf16 v[184:187], v[60:63], v[40:43], v[184:187]
v_max3_u32 v19, v19, v93, v94
v_mfma_f32_16x16x32_bf16 v[188:191], v[60:63], v[44:47], v[188:191]
v_max_u32 v19, v19, v95
v_mfma_f32_16x16x32_bf16 v[252:255], v[76:79], v[44:47], v[252:255]
v_cmp_eq_u32 vcc, -1, v19
v_mfma_f32_16x16x32_bf16 v[248:251], v[76:79], v[40:43], v[248:251]
v_mfma_f32_16x16x32_bf16 v[244:247], v[76:79], v[36:39], v[244:247]
v_mfma_f32_16x16x32_bf16 v[240:243], v[76:79], v[32:35], v[240:243]
s_nop 1
s_cbranch_vccz Lok_61
s_add_u32 s44, s35, 5
s_and_b32 s44, s44, 15
s_lshl_b32 s44, s44, 14
s_add_u32 s44, s44, 8192
s_mov_b32 s45, 0x20000
Lre_62:
buffer_load_dwordx4 v[80:83], v2, s[12:15], s44 offen offset:0 sc1
buffer_load_dwordx4 v[84:87], v2, s[12:15], s44 offen offset:256 sc1
buffer_load_dwordx4 v[88:91], v2, s[12:15], s44 offen offset:512 sc1
buffer_load_dwordx4 v[92:95], v2, s[12:15], s44 offen offset:768 sc1
s_waitcnt vmcnt(0)
v_max3_u32 v19, v80, v81, v82
v_max3_u32 v19, v19, v83, v84
v_max3_u32 v19, v19, v85, v86
v_max3_u32 v19, v19, v87, v88
v_max3_u32 v19, v19, v89, v90
v_max3_u32 v19, v19, v91, v92
v_max3_u32 v19, v19, v93, v94
v_max_u32 v19, v19, v95
v_cmp_eq_u32 vcc, -1, v19
s_sub_u32 s45, s45, 1
s_cmp_eq_u32 s45, 0
s_cbranch_scc1 Lok_61
s_nop 2
s_cbranch_vccnz Lre_62
Lok_61:
s_waitcnt lgkmcnt(0)
s_barrier
v_mfma_f32_16x16x32_bf16 v[128:131], v[96:99], v[80:83], v[128:131]
ds_read_b128 v[32:35], v4 offset:0
v_mfma_f32_16x16x32_bf16 v[132:135], v[96:99], v[84:87], v[132:135]
ds_read_b64_tr_b16 v[48:49], v13 offset:16384
v_mfma_f32_16x16x32_bf16 v[136:139], v[96:99], v[88:91], v[136:139]
ds_read_b64_tr_b16 v[50:51], v13 offset:20480
v_mfma_f32_16x16x32_bf16 v[140:143], v[96:99], v[92:95], v[140:143]
ds_read_b128 v[36:39], v4 offset:256
v_mfma_f32_16x16x32_bf16 v[204:207], v[112:115], v[92:95], v[204:207]
ds_read_b128 v[40:43], v4 offset:512
v_mfma_f32_16x16x32_bf16 v[200:203], v[112:115], v[88:91], v[200:203]
ds_read_b128 v[44:47], v4 offset:768
v_mfma_f32_16x16x32_bf16 v[196:199], v[112:115], v[84:87], v[196:199]
ds_read_b64_tr_b16 v[64:65], v13 offset:32768
v_mfma_f32_16x16x32_bf16 v[192:195], v[112:115], v[80:83], v[192:195]
ds_read_b64_tr_b16 v[66:67], v13 offset:36864
v_mfma_f32_16x16x32_bf16 v[144:147], v[100:103], v[80:83], v[144:147]
ds_read_b64_tr_b16 v[52:53], v14 offset:16384
v_mfma_f32_16x16x32_bf16 v[148:151], v[100:103], v[84:87], v[148:151]
ds_read_b64_tr_b16 v[54:55], v14 offset:20480
v_mfma_f32_16x16x32_bf16 v[152:155], v[100:103], v[88:91], v[152:155]
ds_read_b64_tr_b16 v[68:69], v14 offset:32768
v_mfma_f32_16x16x32_bf16 v[156:159], v[100:103], v[92:95], v[156:159]
ds_read_b64_tr_b16 v[70:71], v14 offset:36864
v_mfma_f32_16x16x32_bf16 v[220:223], v[116:119], v[92:95], v[220:223]
ds_read_b64_tr_b16 v[56:57], v15 offset:16384
v_mfma_f32_16x16x32_bf16 v[216:219], v[116:119], v[88:91], v[216:219]
ds_read_b64_tr_b16 v[58:59], v15 offset:20480
v_mfma_f32_16x16x32_bf16 v[212:215], v[116:119], v[84:87], v[212:215]
ds_read_b64_tr_b16 v[72:73], v15 offset:32768
v_mfma_f32_16x16x32_bf16 v[208:211], v[116:119], v[80:83], v[208:211]
ds_read_b64_tr_b16 v[74:75], v15 offset:36864
v_mfma_f32_16x16x32_bf16 v[160:163], v[104:107], v[80:83], v[160:163]
ds_read_b64_tr_b16 v[60:61], v16 offset:16384
v_mfma_f32_16x16x32_bf16 v[164:167], v[104:107], v[84:87], v[164:167]
ds_read_b64_tr_b16 v[62:63], v16 offset:20480
v_mfma_f32_16x16x32_bf16 v[168:171], v[104:107], v[88:91], v[168:171]
ds_read_b64_tr_b16 v[76:77], v16 offset:32768
v_mfma_f32_16x16x32_bf16 v[172:175], v[104:107], v[92:95], v[172:175]
ds_read_b64_tr_b16 v[78:79], v16 offset:36864
s_waitcnt lgkmcnt(14)
v_mfma_f32_16x16x32_bf16 v[236:239], v[120:123], v[92:95], v[236:239]
v_max3_u32 v19, v32, v33, v34
v_mfma_f32_16x16x32_bf16 v[232:235], v[120:123], v[88:91], v[232:235]
v_max3_u32 v19, v19, v35, v36
v_mfma_f32_16x16x32_bf16 v[228:231], v[120:123], v[84:87], v[228:231]
v_max3_u32 v19, v19, v37, v38
v_mfma_f32_16x16x32_bf16 v[224:227], v[120:123], v[80:83], v[224:227]
v_max3_u32 v19, v19, v39, v40
v_mfma_f32_16x16x32_bf16 v[176:179], v[108:111], v[80:83], v[176:179]
v_max3_u32 v19, v19, v41, v42
v_mfma_f32_16x16x32_bf16 v[180:183], v[108:111], v[84:87], v[180:183]
v_max3_u32 v19, v19, v43, v44
v_mfma_f32_16x16x32_bf16 v[184:187], v[108:111], v[88:91], v[184:187]
v_max3_u32 v19, v19, v45, v46
v_mfma_f32_16x16x32_bf16 v[188:191], v[108:111], v[92:95], v[188:191]
v_max_u32 v19, v19, v47
v_mfma_f32_16x16x32_bf16 v[252:255], v[124:127], v[92:95], v[252:255]
v_cmp_eq_u32 vcc, -1, v19
v_mfma_f32_16x16x32_bf16 v[248:251], v[124:127], v[88:91], v[248:251]
v_mfma_f32_16x16x32_bf16 v[244:247], v[124:127], v[84:87], v[244:247]
v_mfma_f32_16x16x32_bf16 v[240:243], v[124:127], v[80:83], v[240:243]
s_nop 1
s_cbranch_vccz Lok_63
s_add_u32 s44, s35, 6
s_and_b32 s44, s44, 15
s_lshl_b32 s44, s44, 14
s_add_u32 s44, s44, 0
s_mov_b32 s45, 0x20000
Lre_64:
buffer_load_dwordx4 v[32:35], v2, s[12:15], s44 offen offset:0 sc1
buffer_load_dwordx4 v[36:39], v2, s[12:15], s44 offen offset:256 sc1
buffer_load_dwordx4 v[40:43], v2, s[12:15], s44 offen offset:512 sc1
buffer_load_dwordx4 v[44:47], v2, s[12:15], s44 offen offset:768 sc1
s_waitcnt vmcnt(0)
v_max3_u32 v19, v32, v33, v34
v_max3_u32 v19, v19, v35, v36
v_max3_u32 v19, v19, v37, v38
v_max3_u32 v19, v19, v39, v40
v_max3_u32 v19, v19, v41, v42
v_max3_u32 v19, v19, v43, v44
v_max3_u32 v19, v19, v45, v46
v_max_u32 v19, v19, v47
v_cmp_eq_u32 vcc, -1, v19
s_sub_u32 s45, s45, 1
s_cmp_eq_u32 s45, 0
s_cbranch_scc1 Lok_63
s_nop 2
s_cbranch_vccnz Lre_64
Lok_63:
s_waitcnt lgkmcnt(0)
v_mfma_f32_16x16x32_bf16 v[128:131], v[48:51], v[32:35], v[128:131]
ds_read_b128 v[80:83], v4 offset:8192
v_mfma_f32_16x16x32_bf16 v[132:135], v[48:51], v[36:39], v[132:135]
ds_read_b64_tr_b16 v[96:97], v13 offset:24576
v_mfma_f32_16x16x32_bf16 v[136:139], v[48:51], v[40:43], v[136:139]
ds_read_b64_tr_b16 v[98:99], v13 offset:28672
v_mfma_f32_16x16x32_bf16 v[140:143], v[48:51], v[44:47], v[140:143]
ds_read_b128 v[84:87], v4 offset:8448
v_mfma_f32_16x16x32_bf16 v[204:207], v[64:67], v[44:47], v[204:207]
ds_read_b128 v[88:91], v4 offset:8704
v_mfma_f32_16x16x32_bf16 v[200:203], v[64:67], v[40:43], v[200:203]
ds_read_b128 v[92:95], v4 offset:8960
v_mfma_f32_16x16x32_bf16 v[196:199], v[64:67], v[36:39], v[196:199]
ds_read_b64_tr_b16 v[112:113], v13 offset:40960
v_mfma_f32_16x16x32_bf16 v[192:195], v[64:67], v[32:35], v[192:195]
ds_read_b64_tr_b16 v[114:115], v13 offset:45056
v_mfma_f32_16x16x32_bf16 v[144:147], v[52:55], v[32:35], v[144:147]
ds_read_b64_tr_b16 v[100:101], v14 offset:24576
v_mfma_f32_16x16x32_bf16 v[148:151], v[52:55], v[36:39], v[148:151]
ds_read_b64_tr_b16 v[102:103], v14 offset:28672
v_mfma_f32_16x16x32_bf16 v[152:155], v[52:55], v[40:43], v[152:155]
ds_read_b64_tr_b16 v[116:117], v14 offset:40960
v_mfma_f32_16x16x32_bf16 v[156:159], v[52:55], v[44:47], v[156:159]
ds_read_b64_tr_b16 v[118:119], v14 offset:45056
v_mfma_f32_16x16x32_bf16 v[220:223], v[68:71], v[44:47], v[220:223]
ds_read_b64_tr_b16 v[104:105], v15 offset:24576
v_mfma_f32_16x16x32_bf16 v[216:219], v[68:71], v[40:43], v[216:219]
ds_read_b64_tr_b16 v[106:107], v15 offset:28672
v_mfma_f32_16x16x32_bf16 v[212:215], v[68:71], v[36:39], v[212:215]
ds_read_b64_tr_b16 v[120:121], v15 offset:40960
v_mfma_f32_16x16x32_bf16 v[208:211], v[68:71], v[32:35], v[208:211]
ds_read_b64_tr_b16 v[122:123], v15 offset:45056
v_mfma_f32_16x16x32_bf16 v[160:163], v[56:59], v[32:35], v[160:163]
ds_read_b64_tr_b16 v[108:109], v16 offset:24576
v_mfma_f32_16x16x32_bf16 v[164:167], v[56:59], v[36:39], v[164:167]
ds_read_b64_tr_b16 v[110:111], v16 offset:28672
v_mfma_f32_16x16x32_bf16 v[168:171], v[56:59], v[40:43], v[168:171]
ds_read_b64_tr_b16 v[124:125], v16 offset:40960
v_mfma_f32_16x16x32_bf16 v[172:175], v[56:59], v[44:47], v[172:175]
ds_read_b64_tr_b16 v[126:127], v16 offset:45056
s_waitcnt lgkmcnt(14)
v_mfma_f32_16x16x32_bf16 v[236:239], v[72:75], v[44:47], v[236:239]
v_max3_u32 v19, v80, v81, v82
v_mfma_f32_16x16x32_bf16 v[232:235], v[72:75], v[40:43], v[232:235]
v_max3_u32 v19, v19, v83, v84
v_mfma_f32_16x16x32_bf16 v[228:231], v[72:75], v[36:39], v[228:231]
v_max3_u32 v19, v19, v85, v86
v_mfma_f32_16x16x32_bf16 v[224:227], v[72:75], v[32:35], v[224:227]
v_max3_u32 v19, v19, v87, v88
v_mfma_f32_16x16x32_bf16 v[176:179], v[60:63], v[32:35], v[176:179]
v_max3_u32 v19, v19, v89, v90
v_mfma_f32_16x16x32_bf16 v[180:183], v[60:63], v[36:39], v[180:183]
v_max3_u32 v19, v19, v91, v92
v_mfma_f32_16x16x32_bf16 v[184:187], v[60:63], v[40:43], v[184:187]
v_max3_u32 v19, v19, v93, v94
v_mfma_f32_16x16x32_bf16 v[188:191], v[60:63], v[44:47], v[188:191]
v_max_u32 v19, v19, v95
v_mfma_f32_16x16x32_bf16 v[252:255], v[76:79], v[44:47], v[252:255]
v_cmp_eq_u32 vcc, -1, v19
v_mfma_f32_16x16x32_bf16 v[248:251], v[76:79], v[40:43], v[248:251]
v_mfma_f32_16x16x32_bf16 v[244:247], v[76:79], v[36:39], v[244:247]
v_mfma_f32_16x16x32_bf16 v[240:243], v[76:79], v[32:35], v[240:243]
s_nop 1
s_cbranch_vccz Lok_65
s_add_u32 s44, s35, 6
s_and_b32 s44, s44, 15
s_lshl_b32 s44, s44, 14
s_add_u32 s44, s44, 8192
s_mov_b32 s45, 0x20000
Lre_66:
buffer_load_dwordx4 v[80:83], v2, s[12:15], s44 offen offset:0 sc1
buffer_load_dwordx4 v[84:87], v2, s[12:15], s44 offen offset:256 sc1
buffer_load_dwordx4 v[88:91], v2, s[12:15], s44 offen offset:512 sc1
buffer_load_dwordx4 v[92:95], v2, s[12:15], s44 offen offset:768 sc1
s_waitcnt vmcnt(0)
v_max3_u32 v19, v80, v81, v82
v_max3_u32 v19, v19, v83, v84
v_max3_u32 v19, v19, v85, v86
v_max3_u32 v19, v19, v87, v88
v_max3_u32 v19, v19, v89, v90
v_max3_u32 v19, v19, v91, v92
v_max3_u32 v19, v19, v93, v94
v_max_u32 v19, v19, v95
v_cmp_eq_u32 vcc, -1, v19
s_sub_u32 s45, s45, 1
s_cmp_eq_u32 s45, 0
s_cbranch_scc1 Lok_65
s_nop 2
s_cbranch_vccnz Lre_66
Lok_65:
s_waitcnt lgkmcnt(0)
s_barrier
v_mfma_f32_16x16x32_bf16 v[128:131], v[96:99], v[80:83], v[128:131]
ds_read_b128 v[32:35], v2 offset:0
v_mfma_f32_16x16x32_bf16 v[132:135], v[96:99], v[84:87], v[132:135]
ds_read_b64_tr_b16 v[48:49], v5 offset:16384
v_mfma_f32_16x16x32_bf16 v[136:139], v[96:99], v[88:91], v[136:139]
ds_read_b64_tr_b16 v[50:51], v5 offset:20480
v_mfma_f32_16x16x32_bf16 v[140:143], v[96:99], v[92:95], v[140:143]
ds_read_b128 v[36:39], v2 offset:256
v_mfma_f32_16x16x32_bf16 v[204:207], v[112:115], v[92:95], v[204:207]
ds_read_b128 v[40:43], v2 offset:512
v_mfma_f32_16x16x32_bf16 v[200:203], v[112:115], v[88:91], v[200:203]
ds_read_b128 v[44:47], v2 offset:768
v_mfma_f32_16x16x32_bf16 v[196:199], v[112:115], v[84:87], v[196:199]
ds_read_b64_tr_b16 v[64:65], v5 offset:32768
v_mfma_f32_16x16x32_bf16 v[192:195], v[112:115], v[80:83], v[192:195]
ds_read_b64_tr_b16 v[66:67], v5 offset:36864
v_mfma_f32_16x16x32_bf16 v[144:147], v[100:103], v[80:83], v[144:147]
ds_read_b64_tr_b16 v[52:53], v6 offset:16384
v_mfma_f32_16x16x32_bf16 v[148:151], v[100:103], v[84:87], v[148:151]
ds_read_b64_tr_b16 v[54:55], v6 offset:20480
v_mfma_f32_16x16x32_bf16 v[152:155], v[100:103], v[88:91], v[152:155]
ds_read_b64_tr_b16 v[68:69], v6 offset:32768
v_mfma_f32_16x16x32_bf16 v[156:159], v[100:103], v[92:95], v[156:159]
ds_read_b64_tr_b16 v[70:71], v6 offset:36864
v_mfma_f32_16x16x32_bf16 v[220:223], v[116:119], v[92:95], v[220:223]
ds_read_b64_tr_b16 v[56:57], v7 offset:16384
v_mfma_f32_16x16x32_bf16 v[216:219], v[116:119], v[88:91], v[216:219]
ds_read_b64_tr_b16 v[58:59], v7 offset:20480
v_mfma_f32_16x16x32_bf16 v[212:215], v[116:119], v[84:87], v[212:215]
ds_read_b64_tr_b16 v[72:73], v7 offset:32768
v_mfma_f32_16x16x32_bf16 v[208:211], v[116:119], v[80:83], v[208:211]
ds_read_b64_tr_b16 v[74:75], v7 offset:36864
v_mfma_f32_16x16x32_bf16 v[160:163], v[104:107], v[80:83], v[160:163]
ds_read_b64_tr_b16 v[60:61], v8 offset:16384
v_mfma_f32_16x16x32_bf16 v[164:167], v[104:107], v[84:87], v[164:167]
ds_read_b64_tr_b16 v[62:63], v8 offset:20480
v_mfma_f32_16x16x32_bf16 v[168:171], v[104:107], v[88:91], v[168:171]
ds_read_b64_tr_b16 v[76:77], v8 offset:32768
v_mfma_f32_16x16x32_bf16 v[172:175], v[104:107], v[92:95], v[172:175]
ds_read_b64_tr_b16 v[78:79], v8 offset:36864
s_waitcnt lgkmcnt(14)
v_mfma_f32_16x16x32_bf16 v[236:239], v[120:123], v[92:95], v[236:239]
v_max3_u32 v19, v32, v33, v34
v_mfma_f32_16x16x32_bf16 v[232:235], v[120:123], v[88:91], v[232:235]
v_max3_u32 v19, v19, v35, v36
v_mfma_f32_16x16x32_bf16 v[228:231], v[120:123], v[84:87], v[228:231]
v_max3_u32 v19, v19, v37, v38
v_mfma_f32_16x16x32_bf16 v[224:227], v[120:123], v[80:83], v[224:227]
v_max3_u32 v19, v19, v39, v40
v_mfma_f32_16x16x32_bf16 v[176:179], v[108:111], v[80:83], v[176:179]
v_max3_u32 v19, v19, v41, v42
v_mfma_f32_16x16x32_bf16 v[180:183], v[108:111], v[84:87], v[180:183]
v_max3_u32 v19, v19, v43, v44
v_mfma_f32_16x16x32_bf16 v[184:187], v[108:111], v[88:91], v[184:187]
v_max3_u32 v19, v19, v45, v46
v_mfma_f32_16x16x32_bf16 v[188:191], v[108:111], v[92:95], v[188:191]
v_max_u32 v19, v19, v47
v_mfma_f32_16x16x32_bf16 v[252:255], v[124:127], v[92:95], v[252:255]
v_cmp_eq_u32 vcc, -1, v19
v_mfma_f32_16x16x32_bf16 v[248:251], v[124:127], v[88:91], v[248:251]
v_mfma_f32_16x16x32_bf16 v[244:247], v[124:127], v[84:87], v[244:247]
v_mfma_f32_16x16x32_bf16 v[240:243], v[124:127], v[80:83], v[240:243]
s_nop 1
s_cbranch_vccz Lok_67
s_add_u32 s44, s35, 7
s_and_b32 s44, s44, 15
s_lshl_b32 s44, s44, 14
s_add_u32 s44, s44, 0
s_mov_b32 s45, 0x20000
Lre_68:
buffer_load_dwordx4 v[32:35], v2, s[12:15], s44 offen offset:0 sc1
buffer_load_dwordx4 v[36:39], v2, s[12:15], s44 offen offset:256 sc1
buffer_load_dwordx4 v[40:43], v2, s[12:15], s44 offen offset:512 sc1
buffer_load_dwordx4 v[44:47], v2, s[12:15], s44 offen offset:768 sc1
s_waitcnt vmcnt(0)
v_max3_u32 v19, v32, v33, v34
v_max3_u32 v19, v19, v35, v36
v_max3_u32 v19, v19, v37, v38
v_max3_u32 v19, v19, v39, v40
v_max3_u32 v19, v19, v41, v42
v_max3_u32 v19, v19, v43, v44
v_max3_u32 v19, v19, v45, v46
v_max_u32 v19, v19, v47
v_cmp_eq_u32 vcc, -1, v19
s_sub_u32 s45, s45, 1
s_cmp_eq_u32 s45, 0
s_cbranch_scc1 Lok_67
s_nop 2
s_cbranch_vccnz Lre_68
Lok_67:
s_waitcnt lgkmcnt(0)
v_mfma_f32_16x16x32_bf16 v[128:131], v[48:51], v[32:35], v[128:131]
ds_read_b128 v[80:83], v2 offset:8192
v_mfma_f32_16x16x32_bf16 v[132:135], v[48:51], v[36:39], v[132:135]
ds_read_b64_tr_b16 v[96:97], v5 offset:24576
v_mfma_f32_16x16x32_bf16 v[136:139], v[48:51], v[40:43], v[136:139]
ds_read_b64_tr_b16 v[98:99], v5 offset:28672
v_mfma_f32_16x16x32_bf16 v[140:143], v[48:51], v[44:47], v[140:143]
ds_read_b128 v[84:87], v2 offset:8448
v_mfma_f32_16x16x32_bf16 v[204:207], v[64:67], v[44:47], v[204:207]
ds_read_b128 v[88:91], v2 offset:8704
v_mfma_f32_16x16x32_bf16 v[200:203], v[64:67], v[40:43], v[200:203]
ds_read_b128 v[92:95], v2 offset:8960
v_mfma_f32_16x16x32_bf16 v[196:199], v[64:67], v[36:39], v[196:199]
ds_read_b64_tr_b16 v[112:113], v5 offset:40960
v_mfma_f32_16x16x32_bf16 v[192:195], v[64:67], v[32:35], v[192:195]
ds_read_b64_tr_b16 v[114:115], v5 offset:45056
v_mfma_f32_16x16x32_bf16 v[144:147], v[52:55], v[32:35], v[144:147]
ds_read_b64_tr_b16 v[100:101], v6 offset:24576
v_mfma_f32_16x16x32_bf16 v[148:151], v[52:55], v[36:39], v[148:151]
ds_read_b64_tr_b16 v[102:103], v6 offset:28672
v_mfma_f32_16x16x32_bf16 v[152:155], v[52:55], v[40:43], v[152:155]
ds_read_b64_tr_b16 v[116:117], v6 offset:40960
v_mfma_f32_16x16x32_bf16 v[156:159], v[52:55], v[44:47], v[156:159]
ds_read_b64_tr_b16 v[118:119], v6 offset:45056
v_mfma_f32_16x16x32_bf16 v[220:223], v[68:71], v[44:47], v[220:223]
ds_read_b64_tr_b16 v[104:105], v7 offset:24576
v_mfma_f32_16x16x32_bf16 v[216:219], v[68:71], v[40:43], v[216:219]
ds_read_b64_tr_b16 v[106:107], v7 offset:28672
v_mfma_f32_16x16x32_bf16 v[212:215], v[68:71], v[36:39], v[212:215]
ds_read_b64_tr_b16 v[120:121], v7 offset:40960
v_mfma_f32_16x16x32_bf16 v[208:211], v[68:71], v[32:35], v[208:211]
ds_read_b64_tr_b16 v[122:123], v7 offset:45056
v_mfma_f32_16x16x32_bf16 v[160:163], v[56:59], v[32:35], v[160:163]
ds_read_b64_tr_b16 v[108:109], v8 offset:24576
v_mfma_f32_16x16x32_bf16 v[164:167], v[56:59], v[36:39], v[164:167]
ds_read_b64_tr_b16 v[110:111], v8 offset:28672
v_mfma_f32_16x16x32_bf16 v[168:171], v[56:59], v[40:43], v[168:171]
ds_read_b64_tr_b16 v[124:125], v8 offset:40960
v_mfma_f32_16x16x32_bf16 v[172:175], v[56:59], v[44:47], v[172:175]
ds_read_b64_tr_b16 v[126:127], v8 offset:45056
s_waitcnt lgkmcnt(14)
v_mfma_f32_16x16x32_bf16 v[236:239], v[72:75], v[44:47], v[236:239]
v_max3_u32 v19, v80, v81, v82
v_mfma_f32_16x16x32_bf16 v[232:235], v[72:75], v[40:43], v[232:235]
v_max3_u32 v19, v19, v83, v84
v_mfma_f32_16x16x32_bf16 v[228:231], v[72:75], v[36:39], v[228:231]
v_max3_u32 v19, v19, v85, v86
v_mfma_f32_16x16x32_bf16 v[224:227], v[72:75], v[32:35], v[224:227]
v_max3_u32 v19, v19, v87, v88
v_mfma_f32_16x16x32_bf16 v[176:179], v[60:63], v[32:35], v[176:179]
v_max3_u32 v19, v19, v89, v90
v_mfma_f32_16x16x32_bf16 v[180:183], v[60:63], v[36:39], v[180:183]
v_max3_u32 v19, v19, v91, v92
v_mfma_f32_16x16x32_bf16 v[184:187], v[60:63], v[40:43], v[184:187]
v_max3_u32 v19, v19, v93, v94
v_mfma_f32_16x16x32_bf16 v[188:191], v[60:63], v[44:47], v[188:191]
v_max_u32 v19, v19, v95
v_mfma_f32_16x16x32_bf16 v[252:255], v[76:79], v[44:47], v[252:255]
v_cmp_eq_u32 vcc, -1, v19
v_mfma_f32_16x16x32_bf16 v[248:251], v[76:79], v[40:43], v[248:251]
v_mfma_f32_16x16x32_bf16 v[244:247], v[76:79], v[36:39], v[244:247]
v_mfma_f32_16x16x32_bf16 v[240:243], v[76:79], v[32:35], v[240:243]
s_nop 1
s_cbranch_vccz Lok_69
s_add_u32 s44, s35, 7
s_and_b32 s44, s44, 15
s_lshl_b32 s44, s44, 14
s_add_u32 s44, s44, 8192
s_mov_b32 s45, 0x20000
Lre_70:
buffer_load_dwordx4 v[80:83], v2, s[12:15], s44 offen offset:0 sc1
buffer_load_dwordx4 v[84:87], v2, s[12:15], s44 offen offset:256 sc1
buffer_load_dwordx4 v[88:91], v2, s[12:15], s44 offen offset:512 sc1
buffer_load_dwordx4 v[92:95], v2, s[12:15], s44 offen offset:768 sc1
s_waitcnt vmcnt(0)
v_max3_u32 v19, v80, v81, v82
v_max3_u32 v19, v19, v83, v84
v_max3_u32 v19, v19, v85, v86
v_max3_u32 v19, v19, v87, v88
v_max3_u32 v19, v19, v89, v90
v_max3_u32 v19, v19, v91, v92
v_max3_u32 v19, v19, v93, v94
v_max_u32 v19, v19, v95
v_cmp_eq_u32 vcc, -1, v19
s_sub_u32 s45, s45, 1
s_cmp_eq_u32 s45, 0
s_cbranch_scc1 Lok_69
s_nop 2
s_cbranch_vccnz Lre_70
Lok_69:
s_waitcnt lgkmcnt(0)
s_barrier
v_mfma_f32_16x16x32_bf16 v[128:131], v[96:99], v[80:83], v[128:131]
ds_read_b128 v[32:35], v3 offset:0
v_mfma_f32_16x16x32_bf16 v[132:135], v[96:99], v[84:87], v[132:135]
ds_read_b64_tr_b16 v[48:49], v9 offset:16384
v_mfma_f32_16x16x32_bf16 v[136:139], v[96:99], v[88:91], v[136:139]
ds_read_b64_tr_b16 v[50:51], v9 offset:20480
v_mfma_f32_16x16x32_bf16 v[140:143], v[96:99], v[92:95], v[140:143]
ds_read_b128 v[36:39], v3 offset:256
v_mfma_f32_16x16x32_bf16 v[204:207], v[112:115], v[92:95], v[204:207]
ds_read_b128 v[40:43], v3 offset:512
v_mfma_f32_16x16x32_bf16 v[200:203], v[112:115], v[88:91], v[200:203]
ds_read_b128 v[44:47], v3 offset:768
v_mfma_f32_16x16x32_bf16 v[196:199], v[112:115], v[84:87], v[196:199]
ds_read_b64_tr_b16 v[64:65], v9 offset:32768
v_mfma_f32_16x16x32_bf16 v[192:195], v[112:115], v[80:83], v[192:195]
ds_read_b64_tr_b16 v[66:67], v9 offset:36864
v_mfma_f32_16x16x32_bf16 v[144:147], v[100:103], v[80:83], v[144:147]
ds_read_b64_tr_b16 v[52:53], v10 offset:16384
v_mfma_f32_16x16x32_bf16 v[148:151], v[100:103], v[84:87], v[148:151]
ds_read_b64_tr_b16 v[54:55], v10 offset:20480
v_mfma_f32_16x16x32_bf16 v[152:155], v[100:103], v[88:91], v[152:155]
ds_read_b64_tr_b16 v[68:69], v10 offset:32768
v_mfma_f32_16x16x32_bf16 v[156:159], v[100:103], v[92:95], v[156:159]
ds_read_b64_tr_b16 v[70:71], v10 offset:36864
v_mfma_f32_16x16x32_bf16 v[220:223], v[116:119], v[92:95], v[220:223]
ds_read_b64_tr_b16 v[56:57], v11 offset:16384
v_mfma_f32_16x16x32_bf16 v[216:219], v[116:119], v[88:91], v[216:219]
ds_read_b64_tr_b16 v[58:59], v11 offset:20480
v_mfma_f32_16x16x32_bf16 v[212:215], v[116:119], v[84:87], v[212:215]
ds_read_b64_tr_b16 v[72:73], v11 offset:32768
v_mfma_f32_16x16x32_bf16 v[208:211], v[116:119], v[80:83], v[208:211]
ds_read_b64_tr_b16 v[74:75], v11 offset:36864
v_mfma_f32_16x16x32_bf16 v[160:163], v[104:107], v[80:83], v[160:163]
ds_read_b64_tr_b16 v[60:61], v12 offset:16384
v_mfma_f32_16x16x32_bf16 v[164:167], v[104:107], v[84:87], v[164:167]
ds_read_b64_tr_b16 v[62:63], v12 offset:20480
v_mfma_f32_16x16x32_bf16 v[168:171], v[104:107], v[88:91], v[168:171]
ds_read_b64_tr_b16 v[76:77], v12 offset:32768
v_mfma_f32_16x16x32_bf16 v[172:175], v[104:107], v[92:95], v[172:175]
ds_read_b64_tr_b16 v[78:79], v12 offset:36864
v_mfma_f32_16x16x32_bf16 v[236:239], v[120:123], v[92:95], v[236:239]
v_mfma_f32_16x16x32_bf16 v[232:235], v[120:123], v[88:91], v[232:235]
v_mfma_f32_16x16x32_bf16 v[228:231], v[120:123], v[84:87], v[228:231]
v_mfma_f32_16x16x32_bf16 v[224:227], v[120:123], v[80:83], v[224:227]
v_mfma_f32_16x16x32_bf16 v[176:179], v[108:111], v[80:83], v[176:179]
v_mfma_f32_16x16x32_bf16 v[180:183], v[108:111], v[84:87], v[180:183]
v_mfma_f32_16x16x32_bf16 v[184:187], v[108:111], v[88:91], v[184:187]
v_mfma_f32_16x16x32_bf16 v[188:191], v[108:111], v[92:95], v[188:191]
v_mfma_f32_16x16x32_bf16 v[252:255], v[124:127], v[92:95], v[252:255]
v_mfma_f32_16x16x32_bf16 v[248:251], v[124:127], v[88:91], v[248:251]
v_mfma_f32_16x16x32_bf16 v[244:247], v[124:127], v[84:87], v[244:247]
v_mfma_f32_16x16x32_bf16 v[240:243], v[124:127], v[80:83], v[240:243]
s_mov_b32 s41, 2
.p2align 3
Lk3_71:
s_waitcnt lgkmcnt(0)
v_mfma_f32_16x16x32_bf16 v[128:131], v[48:51], v[32:35], v[128:131]
ds_read_b128 v[80:83], v3 offset:8192
v_mfma_f32_16x16x32_bf16 v[132:135], v[48:51], v[36:39], v[132:135]
ds_read_b64_tr_b16 v[96:97], v9 offset:24576
v_mfma_f32_16x16x32_bf16 v[136:139], v[48:51], v[40:43], v[136:139]
ds_read_b64_tr_b16 v[98:99], v9 offset:28672
v_mfma_f32_16x16x32_bf16 v[140:143], v[48:51], v[44:47], v[140:143]
ds_read_b128 v[84:87], v3 offset:8448
v_mfma_f32_16x16x32_bf16 v[204:207], v[64:67], v[44:47], v[204:207]
ds_read_b128 v[88:91], v3 offset:8704
v_mfma_f32_16x16x32_bf16 v[200:203], v[64:67], v[40:43], v[200:203]
ds_read_b128 v[92:95], v3 offset:8960
v_mfma_f32_16x16x32_bf16 v[196:199], v[64:67], v[36:39], v[196:199]
ds_read_b64_tr_b16 v[112:113], v9 offset:40960
v_mfma_f32_16x16x32_bf16 v[192:195], v[64:67], v[32:35], v[192:195]
ds_read_b64_tr_b16 v[114:115], v9 offset:45056
v_mfma_f32_16x16x32_bf16 v[144:147], v[52:55], v[32:35], v[144:147]
ds_read_b64_tr_b16 v[100:101], v10 offset:24576
v_mfma_f32_16x16x32_bf16 v[148:151], v[52:55], v[36:39], v[148:151]
ds_read_b64_tr_b16 v[102:103], v10 offset:28672
v_mfma_f32_16x16x32_bf16 v[152:155], v[52:55], v[40:43], v[152:155]
ds_read_b64_tr_b16 v[116:117], v10 offset:40960
v_mfma_f32_16x16x32_bf16 v[156:159], v[52:55], v[44:47], v[156:159]
ds_read_b64_tr_b16 v[118:119], v10 offset:45056
v_mfma_f32_16x16x32_bf16 v[220:223], v[68:71], v[44:47], v[220:223]
ds_read_b64_tr_b16 v[104:105], v11 offset:24576
v_mfma_f32_16x16x32_bf16 v[216:219], v[68:71], v[40:43], v[216:219]
ds_read_b64_tr_b16 v[106:107], v11 offset:28672
v_mfma_f32_16x16x32_bf16 v[212:215], v[68:71], v[36:39], v[212:215]
ds_read_b64_tr_b16 v[120:121], v11 offset:40960
v_mfma_f32_16x16x32_bf16 v[208:211], v[68:71], v[32:35], v[208:211]
ds_read_b64_tr_b16 v[122:123], v11 offset:45056
v_mfma_f32_16x16x32_bf16 v[160:163], v[56:59], v[32:35], v[160:163]
ds_read_b64_tr_b16 v[108:109], v12 offset:24576
v_mfma_f32_16x16x32_bf16 v[164:167], v[56:59], v[36:39], v[164:167]
ds_read_b64_tr_b16 v[110:111], v12 offset:28672
v_mfma_f32_16x16x32_bf16 v[168:171], v[56:59], v[40:43], v[168:171]
ds_read_b64_tr_b16 v[124:125], v12 offset:40960
v_mfma_f32_16x16x32_bf16 v[172:175], v[56:59], v[44:47], v[172:175]
ds_read_b64_tr_b16 v[126:127], v12 offset:45056
v_mfma_f32_16x16x32_bf16 v[236:239], v[72:75], v[44:47], v[236:239]
v_mfma_f32_16x16x32_bf16 v[232:235], v[72:75], v[40:43], v[232:235]
v_mfma_f32_16x16x32_bf16 v[228:231], v[72:75], v[36:39], v[228:231]
v_mfma_f32_16x16x32_bf16 v[224:227], v[72:75], v[32:35], v[224:227]
v_mfma_f32_16x16x32_bf16 v[176:179], v[60:63], v[32:35], v[176:179]
v_mfma_f32_16x16x32_bf16 v[180:183], v[60:63], v[36:39], v[180:183]
v_mfma_f32_16x16x32_bf16 v[184:187], v[60:63], v[40:43], v[184:187]
v_mfma_f32_16x16x32_bf16 v[188:191], v[60:63], v[44:47], v[188:191]
v_mfma_f32_16x16x32_bf16 v[252:255], v[76:79], v[44:47], v[252:255]
v_mfma_f32_16x16x32_bf16 v[248:251], v[76:79], v[40:43], v[248:251]
v_mfma_f32_16x16x32_bf16 v[244:247], v[76:79], v[36:39], v[244:247]
v_mfma_f32_16x16x32_bf16 v[240:243], v[76:79], v[32:35], v[240:243]
s_waitcnt lgkmcnt(0)
s_barrier
v_mfma_f32_16x16x32_bf16 v[128:131], v[96:99], v[80:83], v[128:131]
ds_read_b128 v[32:35], v4 offset:0
v_mfma_f32_16x16x32_bf16 v[132:135], v[96:99], v[84:87], v[132:135]
ds_read_b64_tr_b16 v[48:49], v13 offset:16384
v_mfma_f32_16x16x32_bf16 v[136:139], v[96:99], v[88:91], v[136:139]
ds_read_b64_tr_b16 v[50:51], v13 offset:20480
v_mfma_f32_16x16x32_bf16 v[140:143], v[96:99], v[92:95], v[140:143]
ds_read_b128 v[36:39], v4 offset:256
v_mfma_f32_16x16x32_bf16 v[204:207], v[112:115], v[92:95], v[204:207]
ds_read_b128 v[40:43], v4 offset:512
v_mfma_f32_16x16x32_bf16 v[200:203], v[112:115], v[88:91], v[200:203]
ds_read_b128 v[44:47], v4 offset:768
v_mfma_f32_16x16x32_bf16 v[196:199], v[112:115], v[84:87], v[196:199]
ds_read_b64_tr_b16 v[64:65], v13 offset:32768
v_mfma_f32_16x16x32_bf16 v[192:195], v[112:115], v[80:83], v[192:195]
ds_read_b64_tr_b16 v[66:67], v13 offset:36864
v_mfma_f32_16x16x32_bf16 v[144:147], v[100:103], v[80:83], v[144:147]
ds_read_b64_tr_b16 v[52:53], v14 offset:16384
v_mfma_f32_16x16x32_bf16 v[148:151], v[100:103], v[84:87], v[148:151]
ds_read_b64_tr_b16 v[54:55], v14 offset:20480
v_mfma_f32_16x16x32_bf16 v[152:155], v[100:103], v[88:91], v[152:155]
ds_read_b64_tr_b16 v[68:69], v14 offset:32768
v_mfma_f32_16x16x32_bf16 v[156:159], v[100:103], v[92:95], v[156:159]
ds_read_b64_tr_b16 v[70:71], v14 offset:36864
v_mfma_f32_16x16x32_bf16 v[220:223], v[116:119], v[92:95], v[220:223]
ds_read_b64_tr_b16 v[56:57], v15 offset:16384
v_mfma_f32_16x16x32_bf16 v[216:219], v[116:119], v[88:91], v[216:219]
ds_read_b64_tr_b16 v[58:59], v15 offset:20480
v_mfma_f32_16x16x32_bf16 v[212:215], v[116:119], v[84:87], v[212:215]
ds_read_b64_tr_b16 v[72:73], v15 offset:32768
v_mfma_f32_16x16x32_bf16 v[208:211], v[116:119], v[80:83], v[208:211]
ds_read_b64_tr_b16 v[74:75], v15 offset:36864
v_mfma_f32_16x16x32_bf16 v[160:163], v[104:107], v[80:83], v[160:163]
ds_read_b64_tr_b16 v[60:61], v16 offset:16384
v_mfma_f32_16x16x32_bf16 v[164:167], v[104:107], v[84:87], v[164:167]
ds_read_b64_tr_b16 v[62:63], v16 offset:20480
v_mfma_f32_16x16x32_bf16 v[168:171], v[104:107], v[88:91], v[168:171]
ds_read_b64_tr_b16 v[76:77], v16 offset:32768
v_mfma_f32_16x16x32_bf16 v[172:175], v[104:107], v[92:95], v[172:175]
ds_read_b64_tr_b16 v[78:79], v16 offset:36864
v_mfma_f32_16x16x32_bf16 v[236:239], v[120:123], v[92:95], v[236:239]
v_mfma_f32_16x16x32_bf16 v[232:235], v[120:123], v[88:91], v[232:235]
v_mfma_f32_16x16x32_bf16 v[228:231], v[120:123], v[84:87], v[228:231]
v_mfma_f32_16x16x32_bf16 v[224:227], v[120:123], v[80:83], v[224:227]
v_mfma_f32_16x16x32_bf16 v[176:179], v[108:111], v[80:83], v[176:179]
v_mfma_f32_16x16x32_bf16 v[180:183], v[108:111], v[84:87], v[180:183]
v_mfma_f32_16x16x32_bf16 v[184:187], v[108:111], v[88:91], v[184:187]
v_mfma_f32_16x16x32_bf16 v[188:191], v[108:111], v[92:95], v[188:191]
v_mfma_f32_16x16x32_bf16 v[252:255], v[124:127], v[92:95], v[252:255]
v_mfma_f32_16x16x32_bf16 v[248:251], v[124:127], v[88:91], v[248:251]
v_mfma_f32_16x16x32_bf16 v[244:247], v[124:127], v[84:87], v[244:247]
v_mfma_f32_16x16x32_bf16 v[240:243], v[124:127], v[80:83], v[240:243]
s_waitcnt lgkmcnt(0)
v_mfma_f32_16x16x32_bf16 v[128:131], v[48:51], v[32:35], v[128:131]
ds_read_b128 v[80:83], v4 offset:8192
v_mfma_f32_16x16x32_bf16 v[132:135], v[48:51], v[36:39], v[132:135]
ds_read_b64_tr_b16 v[96:97], v13 offset:24576
v_mfma_f32_16x16x32_bf16 v[136:139], v[48:51], v[40:43], v[136:139]
ds_read_b64_tr_b16 v[98:99], v13 offset:28672
v_mfma_f32_16x16x32_bf16 v[140:143], v[48:51], v[44:47], v[140:143]
ds_read_b128 v[84:87], v4 offset:8448
v_mfma_f32_16x16x32_bf16 v[204:207], v[64:67], v[44:47], v[204:207]
ds_read_b128 v[88:91], v4 offset:8704
v_mfma_f32_16x16x32_bf16 v[200:203], v[64:67], v[40:43], v[200:203]
ds_read_b128 v[92:95], v4 offset:8960
v_mfma_f32_16x16x32_bf16 v[196:199], v[64:67], v[36:39], v[196:199]
ds_read_b64_tr_b16 v[112:113], v13 offset:40960
v_mfma_f32_16x16x32_bf16 v[192:195], v[64:67], v[32:35], v[192:195]
ds_read_b64_tr_b16 v[114:115], v13 offset:45056
v_mfma_f32_16x16x32_bf16 v[144:147], v[52:55], v[32:35], v[144:147]
ds_read_b64_tr_b16 v[100:101], v14 offset:24576
v_mfma_f32_16x16x32_bf16 v[148:151], v[52:55], v[36:39], v[148:151]
ds_read_b64_tr_b16 v[102:103], v14 offset:28672
v_mfma_f32_16x16x32_bf16 v[152:155], v[52:55], v[40:43], v[152:155]
ds_read_b64_tr_b16 v[116:117], v14 offset:40960
v_mfma_f32_16x16x32_bf16 v[156:159], v[52:55], v[44:47], v[156:159]
ds_read_b64_tr_b16 v[118:119], v14 offset:45056
v_mfma_f32_16x16x32_bf16 v[220:223], v[68:71], v[44:47], v[220:223]
ds_read_b64_tr_b16 v[104:105], v15 offset:24576
v_mfma_f32_16x16x32_bf16 v[216:219], v[68:71], v[40:43], v[216:219]
ds_read_b64_tr_b16 v[106:107], v15 offset:28672
v_mfma_f32_16x16x32_bf16 v[212:215], v[68:71], v[36:39], v[212:215]
ds_read_b64_tr_b16 v[120:121], v15 offset:40960
v_mfma_f32_16x16x32_bf16 v[208:211], v[68:71], v[32:35], v[208:211]
ds_read_b64_tr_b16 v[122:123], v15 offset:45056
v_mfma_f32_16x16x32_bf16 v[160:163], v[56:59], v[32:35], v[160:163]
ds_read_b64_tr_b16 v[108:109], v16 offset:24576
v_mfma_f32_16x16x32_bf16 v[164:167], v[56:59], v[36:39], v[164:167]
ds_read_b64_tr_b16 v[110:111], v16 offset:28672
v_mfma_f32_16x16x32_bf16 v[168:171], v[56:59], v[40:43], v[168:171]
ds_read_b64_tr_b16 v[124:125], v16 offset:40960
v_mfma_f32_16x16x32_bf16 v[172:175], v[56:59], v[44:47], v[172:175]
ds_read_b64_tr_b16 v[126:127], v16 offset:45056
v_mfma_f32_16x16x32_bf16 v[236:239], v[72:75], v[44:47], v[236:239]
v_mfma_f32_16x16x32_bf16 v[232:235], v[72:75], v[40:43], v[232:235]
v_mfma_f32_16x16x32_bf16 v[228:231], v[72:75], v[36:39], v[228:231]
v_mfma_f32_16x16x32_bf16 v[224:227], v[72:75], v[32:35], v[224:227]
v_mfma_f32_16x16x32_bf16 v[176:179], v[60:63], v[32:35], v[176:179]
v_mfma_f32_16x16x32_bf16 v[180:183], v[60:63], v[36:39], v[180:183]
v_mfma_f32_16x16x32_bf16 v[184:187], v[60:63], v[40:43], v[184:187]
v_mfma_f32_16x16x32_bf16 v[188:191], v[60:63], v[44:47], v[188:191]
v_mfma_f32_16x16x32_bf16 v[252:255], v[76:79], v[44:47], v[252:255]
v_mfma_f32_16x16x32_bf16 v[248:251], v[76:79], v[40:43], v[248:251]
v_mfma_f32_16x16x32_bf16 v[244:247], v[76:79], v[36:39], v[244:247]
v_mfma_f32_16x16x32_bf16 v[240:243], v[76:79], v[32:35], v[240:243]
s_waitcnt lgkmcnt(0)
s_barrier
v_mfma_f32_16x16x32_bf16 v[128:131], v[96:99], v[80:83], v[128:131]
ds_read_b128 v[32:35], v2 offset:0
v_mfma_f32_16x16x32_bf16 v[132:135], v[96:99], v[84:87], v[132:135]
ds_read_b64_tr_b16 v[48:49], v5 offset:16384
v_mfma_f32_16x16x32_bf16 v[136:139], v[96:99], v[88:91], v[136:139]
ds_read_b64_tr_b16 v[50:51], v5 offset:20480
v_mfma_f32_16x16x32_bf16 v[140:143], v[96:99], v[92:95], v[140:143]
ds_read_b128 v[36:39], v2 offset:256
v_mfma_f32_16x16x32_bf16 v[204:207], v[112:115], v[92:95], v[204:207]
ds_read_b128 v[40:43], v2 offset:512
v_mfma_f32_16x16x32_bf16 v[200:203], v[112:115], v[88:91], v[200:203]
ds_read_b128 v[44:47], v2 offset:768
v_mfma_f32_16x16x32_bf16 v[196:199], v[112:115], v[84:87], v[196:199]
ds_read_b64_tr_b16 v[64:65], v5 offset:32768
v_mfma_f32_16x16x32_bf16 v[192:195], v[112:115], v[80:83], v[192:195]
ds_read_b64_tr_b16 v[66:67], v5 offset:36864
v_mfma_f32_16x16x32_bf16 v[144:147], v[100:103], v[80:83], v[144:147]
ds_read_b64_tr_b16 v[52:53], v6 offset:16384
v_mfma_f32_16x16x32_bf16 v[148:151], v[100:103], v[84:87], v[148:151]
ds_read_b64_tr_b16 v[54:55], v6 offset:20480
v_mfma_f32_16x16x32_bf16 v[152:155], v[100:103], v[88:91], v[152:155]
ds_read_b64_tr_b16 v[68:69], v6 offset:32768
v_mfma_f32_16x16x32_bf16 v[156:159], v[100:103], v[92:95], v[156:159]
ds_read_b64_tr_b16 v[70:71], v6 offset:36864
v_mfma_f32_16x16x32_bf16 v[220:223], v[116:119], v[92:95], v[220:223]
ds_read_b64_tr_b16 v[56:57], v7 offset:16384
v_mfma_f32_16x16x32_bf16 v[216:219], v[116:119], v[88:91], v[216:219]
ds_read_b64_tr_b16 v[58:59], v7 offset:20480
v_mfma_f32_16x16x32_bf16 v[212:215], v[116:119], v[84:87], v[212:215]
ds_read_b64_tr_b16 v[72:73], v7 offset:32768
v_mfma_f32_16x16x32_bf16 v[208:211], v[116:119], v[80:83], v[208:211]
ds_read_b64_tr_b16 v[74:75], v7 offset:36864
v_mfma_f32_16x16x32_bf16 v[160:163], v[104:107], v[80:83], v[160:163]
ds_read_b64_tr_b16 v[60:61], v8 offset:16384
v_mfma_f32_16x16x32_bf16 v[164:167], v[104:107], v[84:87], v[164:167]
ds_read_b64_tr_b16 v[62:63], v8 offset:20480
v_mfma_f32_16x16x32_bf16 v[168:171], v[104:107], v[88:91], v[168:171]
ds_read_b64_tr_b16 v[76:77], v8 offset:32768
v_mfma_f32_16x16x32_bf16 v[172:175], v[104:107], v[92:95], v[172:175]
ds_read_b64_tr_b16 v[78:79], v8 offset:36864
v_mfma_f32_16x16x32_bf16 v[236:239], v[120:123], v[92:95], v[236:239]
v_mfma_f32_16x16x32_bf16 v[232:235], v[120:123], v[88:91], v[232:235]
v_mfma_f32_16x16x32_bf16 v[228:231], v[120:123], v[84:87], v[228:231]
v_mfma_f32_16x16x32_bf16 v[224:227], v[120:123], v[80:83], v[224:227]
v_mfma_f32_16x16x32_bf16 v[176:179], v[108:111], v[80:83], v[176:179]
v_mfma_f32_16x16x32_bf16 v[180:183], v[108:111], v[84:87], v[180:183]
v_mfma_f32_16x16x32_bf16 v[184:187], v[108:111], v[88:91], v[184:187]
v_mfma_f32_16x16x32_bf16 v[188:191], v[108:111], v[92:95], v[188:191]
v_mfma_f32_16x16x32_bf16 v[252:255], v[124:127], v[92:95], v[252:255]
v_mfma_f32_16x16x32_bf16 v[248:251], v[124:127], v[88:91], v[248:251]
v_mfma_f32_16x16x32_bf16 v[244:247], v[124:127], v[84:87], v[244:247]
v_mfma_f32_16x16x32_bf16 v[240:243], v[124:127], v[80:83], v[240:243]
s_waitcnt lgkmcnt(0)
v_mfma_f32_16x16x32_bf16 v[128:131], v[48:51], v[32:35], v[128:131]
ds_read_b128 v[80:83], v2 offset:8192
v_mfma_f32_16x16x32_bf16 v[132:135], v[48:51], v[36:39], v[132:135]
ds_read_b64_tr_b16 v[96:97], v5 offset:24576
v_mfma_f32_16x16x32_bf16 v[136:139], v[48:51], v[40:43], v[136:139]
ds_read_b64_tr_b16 v[98:99], v5 offset:28672
v_mfma_f32_16x16x32_bf16 v[140:143], v[48:51], v[44:47], v[140:143]
ds_read_b128 v[84:87], v2 offset:8448
v_mfma_f32_16x16x32_bf16 v[204:207], v[64:67], v[44:47], v[204:207]
ds_read_b128 v[88:91], v2 offset:8704
v_mfma_f32_16x16x32_bf16 v[200:203], v[64:67], v[40:43], v[200:203]
ds_read_b128 v[92:95], v2 offset:8960
v_mfma_f32_16x16x32_bf16 v[196:199], v[64:67], v[36:39], v[196:199]
ds_read_b64_tr_b16 v[112:113], v5 offset:40960
v_mfma_f32_16x16x32_bf16 v[192:195], v[64:67], v[32:35], v[192:195]
ds_read_b64_tr_b16 v[114:115], v5 offset:45056
v_mfma_f32_16x16x32_bf16 v[144:147], v[52:55], v[32:35], v[144:147]
ds_read_b64_tr_b16 v[100:101], v6 offset:24576
v_mfma_f32_16x16x32_bf16 v[148:151], v[52:55], v[36:39], v[148:151]
ds_read_b64_tr_b16 v[102:103], v6 offset:28672
v_mfma_f32_16x16x32_bf16 v[152:155], v[52:55], v[40:43], v[152:155]
ds_read_b64_tr_b16 v[116:117], v6 offset:40960
v_mfma_f32_16x16x32_bf16 v[156:159], v[52:55], v[44:47], v[156:159]
ds_read_b64_tr_b16 v[118:119], v6 offset:45056
v_mfma_f32_16x16x32_bf16 v[220:223], v[68:71], v[44:47], v[220:223]
ds_read_b64_tr_b16 v[104:105], v7 offset:24576
v_mfma_f32_16x16x32_bf16 v[216:219], v[68:71], v[40:43], v[216:219]
ds_read_b64_tr_b16 v[106:107], v7 offset:28672
v_mfma_f32_16x16x32_bf16 v[212:215], v[68:71], v[36:39], v[212:215]
ds_read_b64_tr_b16 v[120:121], v7 offset:40960
v_mfma_f32_16x16x32_bf16 v[208:211], v[68:71], v[32:35], v[208:211]
ds_read_b64_tr_b16 v[122:123], v7 offset:45056
v_mfma_f32_16x16x32_bf16 v[160:163], v[56:59], v[32:35], v[160:163]
ds_read_b64_tr_b16 v[108:109], v8 offset:24576
v_mfma_f32_16x16x32_bf16 v[164:167], v[56:59], v[36:39], v[164:167]
ds_read_b64_tr_b16 v[110:111], v8 offset:28672
v_mfma_f32_16x16x32_bf16 v[168:171], v[56:59], v[40:43], v[168:171]
ds_read_b64_tr_b16 v[124:125], v8 offset:40960
v_mfma_f32_16x16x32_bf16 v[172:175], v[56:59], v[44:47], v[172:175]
ds_read_b64_tr_b16 v[126:127], v8 offset:45056
v_mfma_f32_16x16x32_bf16 v[236:239], v[72:75], v[44:47], v[236:239]
v_mfma_f32_16x16x32_bf16 v[232:235], v[72:75], v[40:43], v[232:235]
v_mfma_f32_16x16x32_bf16 v[228:231], v[72:75], v[36:39], v[228:231]
v_mfma_f32_16x16x32_bf16 v[224:227], v[72:75], v[32:35], v[224:227]
v_mfma_f32_16x16x32_bf16 v[176:179], v[60:63], v[32:35], v[176:179]
v_mfma_f32_16x16x32_bf16 v[180:183], v[60:63], v[36:39], v[180:183]
v_mfma_f32_16x16x32_bf16 v[184:187], v[60:63], v[40:43], v[184:187]
v_mfma_f32_16x16x32_bf16 v[188:191], v[60:63], v[44:47], v[188:191]
v_mfma_f32_16x16x32_bf16 v[252:255], v[76:79], v[44:47], v[252:255]
v_mfma_f32_16x16x32_bf16 v[248:251], v[76:79], v[40:43], v[248:251]
v_mfma_f32_16x16x32_bf16 v[244:247], v[76:79], v[36:39], v[244:247]
v_mfma_f32_16x16x32_bf16 v[240:243], v[76:79], v[32:35], v[240:243]
s_waitcnt lgkmcnt(0)
s_barrier
v_mfma_f32_16x16x32_bf16 v[128:131], v[96:99], v[80:83], v[128:131]
ds_read_b128 v[32:35], v3 offset:0
v_mfma_f32_16x16x32_bf16 v[132:135], v[96:99], v[84:87], v[132:135]
ds_read_b64_tr_b16 v[48:49], v9 offset:16384
v_mfma_f32_16x16x32_bf16 v[136:139], v[96:99], v[88:91], v[136:139]
ds_read_b64_tr_b16 v[50:51], v9 offset:20480
v_mfma_f32_16x16x32_bf16 v[140:143], v[96:99], v[92:95], v[140:143]
ds_read_b128 v[36:39], v3 offset:256
v_mfma_f32_16x16x32_bf16 v[204:207], v[112:115], v[92:95], v[204:207]
ds_read_b128 v[40:43], v3 offset:512
v_mfma_f32_16x16x32_bf16 v[200:203], v[112:115], v[88:91], v[200:203]
ds_read_b128 v[44:47], v3 offset:768
v_mfma_f32_16x16x32_bf16 v[196:199], v[112:115], v[84:87], v[196:199]
ds_read_b64_tr_b16 v[64:65], v9 offset:32768
v_mfma_f32_16x16x32_bf16 v[192:195], v[112:115], v[80:83], v[192:195]
ds_read_b64_tr_b16 v[66:67], v9 offset:36864
v_mfma_f32_16x16x32_bf16 v[144:147], v[100:103], v[80:83], v[144:147]
ds_read_b64_tr_b16 v[52:53], v10 offset:16384
v_mfma_f32_16x16x32_bf16 v[148:151], v[100:103], v[84:87], v[148:151]
ds_read_b64_tr_b16 v[54:55], v10 offset:20480
v_mfma_f32_16x16x32_bf16 v[152:155], v[100:103], v[88:91], v[152:155]
ds_read_b64_tr_b16 v[68:69], v10 offset:32768
v_mfma_f32_16x16x32_bf16 v[156:159], v[100:103], v[92:95], v[156:159]
ds_read_b64_tr_b16 v[70:71], v10 offset:36864
v_mfma_f32_16x16x32_bf16 v[220:223], v[116:119], v[92:95], v[220:223]
ds_read_b64_tr_b16 v[56:57], v11 offset:16384
v_mfma_f32_16x16x32_bf16 v[216:219], v[116:119], v[88:91], v[216:219]
ds_read_b64_tr_b16 v[58:59], v11 offset:20480
v_mfma_f32_16x16x32_bf16 v[212:215], v[116:119], v[84:87], v[212:215]
ds_read_b64_tr_b16 v[72:73], v11 offset:32768
v_mfma_f32_16x16x32_bf16 v[208:211], v[116:119], v[80:83], v[208:211]
ds_read_b64_tr_b16 v[74:75], v11 offset:36864
v_mfma_f32_16x16x32_bf16 v[160:163], v[104:107], v[80:83], v[160:163]
ds_read_b64_tr_b16 v[60:61], v12 offset:16384
v_mfma_f32_16x16x32_bf16 v[164:167], v[104:107], v[84:87], v[164:167]
ds_read_b64_tr_b16 v[62:63], v12 offset:20480
v_mfma_f32_16x16x32_bf16 v[168:171], v[104:107], v[88:91], v[168:171]
ds_read_b64_tr_b16 v[76:77], v12 offset:32768
v_mfma_f32_16x16x32_bf16 v[172:175], v[104:107], v[92:95], v[172:175]
ds_read_b64_tr_b16 v[78:79], v12 offset:36864
v_mfma_f32_16x16x32_bf16 v[236:239], v[120:123], v[92:95], v[236:239]
v_mfma_f32_16x16x32_bf16 v[232:235], v[120:123], v[88:91], v[232:235]
v_mfma_f32_16x16x32_bf16 v[228:231], v[120:123], v[84:87], v[228:231]
v_mfma_f32_16x16x32_bf16 v[224:227], v[120:123], v[80:83], v[224:227]
v_mfma_f32_16x16x32_bf16 v[176:179], v[108:111], v[80:83], v[176:179]
v_mfma_f32_16x16x32_bf16 v[180:183], v[108:111], v[84:87], v[180:183]
v_mfma_f32_16x16x32_bf16 v[184:187], v[108:111], v[88:91], v[184:187]
v_mfma_f32_16x16x32_bf16 v[188:191], v[108:111], v[92:95], v[188:191]
v_mfma_f32_16x16x32_bf16 v[252:255], v[124:127], v[92:95], v[252:255]
v_mfma_f32_16x16x32_bf16 v[248:251], v[124:127], v[88:91], v[248:251]
v_mfma_f32_16x16x32_bf16 v[244:247], v[124:127], v[84:87], v[244:247]
v_mfma_f32_16x16x32_bf16 v[240:243], v[124:127], v[80:83], v[240:243]
s_sub_u32 s41, s41, 1
s_cmp_lg_u32 s41, 0
s_cbranch_scc1 Lk3_71
s_waitcnt lgkmcnt(0)
v_mfma_f32_16x16x32_bf16 v[128:131], v[48:51], v[32:35], v[128:131]
ds_read_b128 v[80:83], v3 offset:8192
v_mfma_f32_16x16x32_bf16 v[132:135], v[48:51], v[36:39], v[132:135]
ds_read_b64_tr_b16 v[96:97], v9 offset:24576
v_mfma_f32_16x16x32_bf16 v[136:139], v[48:51], v[40:43], v[136:139]
ds_read_b64_tr_b16 v[98:99], v9 offset:28672
v_mfma_f32_16x16x32_bf16 v[140:143], v[48:51], v[44:47], v[140:143]
ds_read_b128 v[84:87], v3 offset:8448
v_mfma_f32_16x16x32_bf16 v[204:207], v[64:67], v[44:47], v[204:207]
ds_read_b128 v[88:91], v3 offset:8704
v_mfma_f32_16x16x32_bf16 v[200:203], v[64:67], v[40:43], v[200:203]
ds_read_b128 v[92:95], v3 offset:8960
v_mfma_f32_16x16x32_bf16 v[196:199], v[64:67], v[36:39], v[196:199]
ds_read_b64_tr_b16 v[112:113], v9 offset:40960
v_mfma_f32_16x16x32_bf16 v[192:195], v[64:67], v[32:35], v[192:195]
ds_read_b64_tr_b16 v[114:115], v9 offset:45056
v_mfma_f32_16x16x32_bf16 v[144:147], v[52:55], v[32:35], v[144:147]
ds_read_b64_tr_b16 v[100:101], v10 offset:24576
v_mfma_f32_16x16x32_bf16 v[148:151], v[52:55], v[36:39], v[148:151]
ds_read_b64_tr_b16 v[102:103], v10 offset:28672
v_mfma_f32_16x16x32_bf16 v[152:155], v[52:55], v[40:43], v[152:155]
ds_read_b64_tr_b16 v[116:117], v10 offset:40960
v_mfma_f32_16x16x32_bf16 v[156:159], v[52:55], v[44:47], v[156:159]
ds_read_b64_tr_b16 v[118:119], v10 offset:45056
v_mfma_f32_16x16x32_bf16 v[220:223], v[68:71], v[44:47], v[220:223]
ds_read_b64_tr_b16 v[104:105], v11 offset:24576
v_mfma_f32_16x16x32_bf16 v[216:219], v[68:71], v[40:43], v[216:219]
ds_read_b64_tr_b16 v[106:107], v11 offset:28672
v_mfma_f32_16x16x32_bf16 v[212:215], v[68:71], v[36:39], v[212:215]
ds_read_b64_tr_b16 v[120:121], v11 offset:40960
v_mfma_f32_16x16x32_bf16 v[208:211], v[68:71], v[32:35], v[208:211]
ds_read_b64_tr_b16 v[122:123], v11 offset:45056
v_mfma_f32_16x16x32_bf16 v[160:163], v[56:59], v[32:35], v[160:163]
ds_read_b64_tr_b16 v[108:109], v12 offset:24576
v_mfma_f32_16x16x32_bf16 v[164:167], v[56:59], v[36:39], v[164:167]
ds_read_b64_tr_b16 v[110:111], v12 offset:28672
v_mfma_f32_16x16x32_bf16 v[168:171], v[56:59], v[40:43], v[168:171]
ds_read_b64_tr_b16 v[124:125], v12 offset:40960
v_mfma_f32_16x16x32_bf16 v[172:175], v[56:59], v[44:47], v[172:175]
ds_read_b64_tr_b16 v[126:127], v12 offset:45056
v_mfma_f32_16x16x32_bf16 v[236:239], v[72:75], v[44:47], v[236:239]
v_mfma_f32_16x16x32_bf16 v[232:235], v[72:75], v[40:43], v[232:235]
v_mfma_f32_16x16x32_bf16 v[228:231], v[72:75], v[36:39], v[228:231]
v_mfma_f32_16x16x32_bf16 v[224:227], v[72:75], v[32:35], v[224:227]
v_mfma_f32_16x16x32_bf16 v[176:179], v[60:63], v[32:35], v[176:179]
v_mfma_f32_16x16x32_bf16 v[180:183], v[60:63], v[36:39], v[180:183]
v_mfma_f32_16x16x32_bf16 v[184:187], v[60:63], v[40:43], v[184:187]
v_mfma_f32_16x16x32_bf16 v[188:191], v[60:63], v[44:47], v[188:191]
v_mfma_f32_16x16x32_bf16 v[252:255], v[76:79], v[44:47], v[252:255]
v_mfma_f32_16x16x32_bf16 v[248:251], v[76:79], v[40:43], v[248:251]
v_mfma_f32_16x16x32_bf16 v[244:247], v[76:79], v[36:39], v[244:247]
v_mfma_f32_16x16x32_bf16 v[240:243], v[76:79], v[32:35], v[240:243]
s_waitcnt lgkmcnt(0)
s_barrier
v_mfma_f32_16x16x32_bf16 v[128:131], v[96:99], v[80:83], v[128:131]
ds_read_b128 v[32:35], v4 offset:0
v_mfma_f32_16x16x32_bf16 v[132:135], v[96:99], v[84:87], v[132:135]
ds_read_b64_tr_b16 v[48:49], v13 offset:16384
v_mfma_f32_16x16x32_bf16 v[136:139], v[96:99], v[88:91], v[136:139]
ds_read_b64_tr_b16 v[50:51], v13 offset:20480
v_mfma_f32_16x16x32_bf16 v[140:143], v[96:99], v[92:95], v[140:143]
ds_read_b128 v[36:39], v4 offset:256
v_mfma_f32_16x16x32_bf16 v[204:207], v[112:115], v[92:95], v[204:207]
ds_read_b128 v[40:43], v4 offset:512
v_mfma_f32_16x16x32_bf16 v[200:203], v[112:115], v[88:91], v[200:203]
ds_read_b128 v[44:47], v4 offset:768
v_mfma_f32_16x16x32_bf16 v[196:199], v[112:115], v[84:87], v[196:199]
ds_read_b64_tr_b16 v[64:65], v13 offset:32768
v_mfma_f32_16x16x32_bf16 v[192:195], v[112:115], v[80:83], v[192:195]
ds_read_b64_tr_b16 v[66:67], v13 offset:36864
v_mfma_f32_16x16x32_bf16 v[144:147], v[100:103], v[80:83], v[144:147]
ds_read_b64_tr_b16 v[52:53], v14 offset:16384
v_mfma_f32_16x16x32_bf16 v[148:151], v[100:103], v[84:87], v[148:151]
ds_read_b64_tr_b16 v[54:55], v14 offset:20480
v_mfma_f32_16x16x32_bf16 v[152:155], v[100:103], v[88:91], v[152:155]
ds_read_b64_tr_b16 v[68:69], v14 offset:32768
v_mfma_f32_16x16x32_bf16 v[156:159], v[100:103], v[92:95], v[156:159]
ds_read_b64_tr_b16 v[70:71], v14 offset:36864
v_mfma_f32_16x16x32_bf16 v[220:223], v[116:119], v[92:95], v[220:223]
ds_read_b64_tr_b16 v[56:57], v15 offset:16384
v_mfma_f32_16x16x32_bf16 v[216:219], v[116:119], v[88:91], v[216:219]
ds_read_b64_tr_b16 v[58:59], v15 offset:20480
v_mfma_f32_16x16x32_bf16 v[212:215], v[116:119], v[84:87], v[212:215]
ds_read_b64_tr_b16 v[72:73], v15 offset:32768
v_mfma_f32_16x16x32_bf16 v[208:211], v[116:119], v[80:83], v[208:211]
ds_read_b64_tr_b16 v[74:75], v15 offset:36864
v_mfma_f32_16x16x32_bf16 v[160:163], v[104:107], v[80:83], v[160:163]
ds_read_b64_tr_b16 v[60:61], v16 offset:16384
v_mfma_f32_16x16x32_bf16 v[164:167], v[104:107], v[84:87], v[164:167]
ds_read_b64_tr_b16 v[62:63], v16 offset:20480
v_mfma_f32_16x16x32_bf16 v[168:171], v[104:107], v[88:91], v[168:171]
ds_read_b64_tr_b16 v[76:77], v16 offset:32768
v_mfma_f32_16x16x32_bf16 v[172:175], v[104:107], v[92:95], v[172:175]
ds_read_b64_tr_b16 v[78:79], v16 offset:36864
v_mfma_f32_16x16x32_bf16 v[236:239], v[120:123], v[92:95], v[236:239]
v_mfma_f32_16x16x32_bf16 v[232:235], v[120:123], v[88:91], v[232:235]
v_mfma_f32_16x16x32_bf16 v[228:231], v[120:123], v[84:87], v[228:231]
v_mfma_f32_16x16x32_bf16 v[224:227], v[120:123], v[80:83], v[224:227]
v_mfma_f32_16x16x32_bf16 v[176:179], v[108:111], v[80:83], v[176:179]
v_mfma_f32_16x16x32_bf16 v[180:183], v[108:111], v[84:87], v[180:183]
v_mfma_f32_16x16x32_bf16 v[184:187], v[108:111], v[88:91], v[184:187]
v_mfma_f32_16x16x32_bf16 v[188:191], v[108:111], v[92:95], v[188:191]
v_mfma_f32_16x16x32_bf16 v[252:255], v[124:127], v[92:95], v[252:255]
v_mfma_f32_16x16x32_bf16 v[248:251], v[124:127], v[88:91], v[248:251]
v_mfma_f32_16x16x32_bf16 v[244:247], v[124:127], v[84:87], v[244:247]
v_mfma_f32_16x16x32_bf16 v[240:243], v[124:127], v[80:83], v[240:243]
s_waitcnt lgkmcnt(0)
v_mfma_f32_16x16x32_bf16 v[128:131], v[48:51], v[32:35], v[128:131]
ds_read_b128 v[80:83], v4 offset:8192
v_mfma_f32_16x16x32_bf16 v[132:135], v[48:51], v[36:39], v[132:135]
ds_read_b64_tr_b16 v[96:97], v13 offset:24576
v_mfma_f32_16x16x32_bf16 v[136:139], v[48:51], v[40:43], v[136:139]
ds_read_b64_tr_b16 v[98:99], v13 offset:28672
v_mfma_f32_16x16x32_bf16 v[140:143], v[48:51], v[44:47], v[140:143]
ds_read_b128 v[84:87], v4 offset:8448
v_mfma_f32_16x16x32_bf16 v[204:207], v[64:67], v[44:47], v[204:207]
ds_read_b128 v[88:91], v4 offset:8704
v_mfma_f32_16x16x32_bf16 v[200:203], v[64:67], v[40:43], v[200:203]
ds_read_b128 v[92:95], v4 offset:8960
v_mfma_f32_16x16x32_bf16 v[196:199], v[64:67], v[36:39], v[196:199]
ds_read_b64_tr_b16 v[112:113], v13 offset:40960
v_mfma_f32_16x16x32_bf16 v[192:195], v[64:67], v[32:35], v[192:195]
ds_read_b64_tr_b16 v[114:115], v13 offset:45056
v_mfma_f32_16x16x32_bf16 v[144:147], v[52:55], v[32:35], v[144:147]
ds_read_b64_tr_b16 v[100:101], v14 offset:24576
v_mfma_f32_16x16x32_bf16 v[148:151], v[52:55], v[36:39], v[148:151]
ds_read_b64_tr_b16 v[102:103], v14 offset:28672
v_mfma_f32_16x16x32_bf16 v[152:155], v[52:55], v[40:43], v[152:155]
ds_read_b64_tr_b16 v[116:117], v14 offset:40960
v_mfma_f32_16x16x32_bf16 v[156:159], v[52:55], v[44:47], v[156:159]
ds_read_b64_tr_b16 v[118:119], v14 offset:45056
v_mfma_f32_16x16x32_bf16 v[220:223], v[68:71], v[44:47], v[220:223]
ds_read_b64_tr_b16 v[104:105], v15 offset:24576
v_mfma_f32_16x16x32_bf16 v[216:219], v[68:71], v[40:43], v[216:219]
ds_read_b64_tr_b16 v[106:107], v15 offset:28672
v_mfma_f32_16x16x32_bf16 v[212:215], v[68:71], v[36:39], v[212:215]
ds_read_b64_tr_b16 v[120:121], v15 offset:40960
v_mfma_f32_16x16x32_bf16 v[208:211], v[68:71], v[32:35], v[208:211]
ds_read_b64_tr_b16 v[122:123], v15 offset:45056
v_mfma_f32_16x16x32_bf16 v[160:163], v[56:59], v[32:35], v[160:163]
ds_read_b64_tr_b16 v[108:109], v16 offset:24576
v_mfma_f32_16x16x32_bf16 v[164:167], v[56:59], v[36:39], v[164:167]
ds_read_b64_tr_b16 v[110:111], v16 offset:28672
v_mfma_f32_16x16x32_bf16 v[168:171], v[56:59], v[40:43], v[168:171]
ds_read_b64_tr_b16 v[124:125], v16 offset:40960
v_mfma_f32_16x16x32_bf16 v[172:175], v[56:59], v[44:47], v[172:175]
ds_read_b64_tr_b16 v[126:127], v16 offset:45056
v_mfma_f32_16x16x32_bf16 v[236:239], v[72:75], v[44:47], v[236:239]
v_mfma_f32_16x16x32_bf16 v[232:235], v[72:75], v[40:43], v[232:235]
v_mfma_f32_16x16x32_bf16 v[228:231], v[72:75], v[36:39], v[228:231]
v_mfma_f32_16x16x32_bf16 v[224:227], v[72:75], v[32:35], v[224:227]
v_mfma_f32_16x16x32_bf16 v[176:179], v[60:63], v[32:35], v[176:179]
v_mfma_f32_16x16x32_bf16 v[180:183], v[60:63], v[36:39], v[180:183]
v_mfma_f32_16x16x32_bf16 v[184:187], v[60:63], v[40:43], v[184:187]
v_mfma_f32_16x16x32_bf16 v[188:191], v[60:63], v[44:47], v[188:191]
v_mfma_f32_16x16x32_bf16 v[252:255], v[76:79], v[44:47], v[252:255]
v_mfma_f32_16x16x32_bf16 v[248:251], v[76:79], v[40:43], v[248:251]
v_mfma_f32_16x16x32_bf16 v[244:247], v[76:79], v[36:39], v[244:247]
v_mfma_f32_16x16x32_bf16 v[240:243], v[76:79], v[32:35], v[240:243]
s_waitcnt lgkmcnt(0)
s_barrier
s_cmp_eq_u32 s36, 3
s_cbranch_scc1 L3h_72
s_add_u32 s42, s42, 1
s_and_b32 s42, s42, 15
s_add_u32 m0, s39, 98304
s_mul_i32 s37, s42, s40
buffer_load_dwordx4 v22, s[8:11], s37 offen sc1 lds
v_mfma_f32_16x16x32_bf16 v[128:131], v[96:99], v[80:83], v[128:131]
s_lshl_b32 s43, s46, 9
v_mfma_f32_16x16x32_bf16 v[132:135], v[96:99], v[84:87], v[132:135]
s_add_u32 s43, s43, 147456
s_add_u32 m0, s39, 99328
s_add_u32 s37, s37, s38
buffer_load_dwordx4 v23, s[8:11], s37 offen sc1 lds
v_mfma_f32_16x16x32_bf16 v[136:139], v[96:99], v[88:91], v[136:139]
v_lshl_add_u32 v19, v17, 3, s43
v_mfma_f32_16x16x32_bf16 v[140:143], v[96:99], v[92:95], v[140:143]
s_add_u32 m0, s39, 100352
s_add_u32 s37, s37, s38
buffer_load_dwordx4 v22, s[8:11], s37 offen sc1 lds
ds_read_b64 v[2:3], v19 offset:0
v_mfma_f32_16x16x32_bf16 v[204:207], v[112:115], v[92:95], v[204:207]
ds_read_b64 v[4:5], v19 offset:128
s_add_u32 m0, s39, 101376
s_add_u32 s37, s37, s38
buffer_load_dwordx4 v23, s[8:11], s37 offen sc1 lds
v_mfma_f32_16x16x32_bf16 v[200:203], v[112:115], v[88:91], v[200:203]
ds_read_b64 v[6:7], v19 offset:256
v_mfma_f32_16x16x32_bf16 v[196:199], v[112:115], v[84:87], v[196:199]
s_add_u32 m0, s39, 102400
s_add_u32 s37, s37, s38
buffer_load_dwordx4 v22, s[8:11], s37 offen sc1 lds
ds_read_b64 v[8:9], v19 offset:384
v_mfma_f32_16x16x32_bf16 v[192:195], v[112:115], v[80:83], v[192:195]
s_mul_i32 s43, s47, 256
s_add_u32 m0, s39, 103424
s_add_u32 s37, s37, s38
buffer_load_dwordx4 v23, s[8:11], s37 offen sc1 lds
v_mfma_f32_16x16x32_bf16 v[144:147], v[100:103], v[80:83], v[144:147]
s_add_u32 s43, s43, 148480
v_mfma_f32_16x16x32_bf16 v[148:151], v[100:103], v[84:87], v[148:151]
s_add_u32 m0, s39, 104448
s_add_u32 s37, s37, s38
buffer_load_dwordx4 v22, s[8:11], s37 offen sc1 lds
v_lshl_add_u32 v19, v18, 4, s43
v_mfma_f32_16x16x32_bf16 v[152:155], v[100:103], v[88:91], v[152:155]
ds_read_b128 v[48:51], v19 offset:0
s_add_u32 m0, s39, 105472
s_add_u32 s37, s37, s38
buffer_load_dwordx4 v23, s[8:11], s37 offen sc1 lds
v_mfma_f32_16x16x32_bf16 v[156:159], v[100:103], v[92:95], v[156:159]
ds_read_b128 v[52:55], v19 offset:64
v_mfma_f32_16x16x32_bf16 v[220:223], v[116:119], v[92:95], v[220:223]
s_add_u32 m0, s39, 106496
s_add_u32 s37, s37, s38
buffer_load_dwordx4 v22, s[8:11], s37 offen sc1 lds
ds_read_b128 v[56:59], v19 offset:128
v_mfma_f32_16x16x32_bf16 v[216:219], v[116:119], v[88:91], v[216:219]
ds_read_b128 v[60:63], v19 offset:192
v_mfma_f32_16x16x32_bf16 v[212:215], v[116:119], v[84:87], v[212:215]
s_add_u32 m0, s39, 107520
s_add_u32 s37, s37, s38
buffer_load_dwordx4 v23, s[8:11], s37 offen sc1 lds
ds_read_b128 v[64:67], v19 offset:896
v_mfma_f32_16x16x32_bf16 v[208:211], v[116:119], v[80:83], v[208:211]
ds_read_b128 v[68:71], v19 offset:960
s_add_u32 m0, s39, 108544
s_add_u32 s37, s37, s38
buffer_load_dwordx4 v22, s[8:11], s37 offen sc1 lds
v_mfma_f32_16x16x32_bf16 v[160:163], v[104:107], v[80:83], v[160:163]
ds_read_b128 v[72:75], v19 offset:1024
v_mfma_f32_16x16x32_bf16 v[164:167], v[104:107], v[84:87], v[164:167]
s_add_u32 m0, s39, 109568
s_add_u32 s37, s37, s38
buffer_load_dwordx4 v23, s[8:11], s37 offen sc1 lds
ds_read_b128 v[76:79], v19 offset:1088
v_mfma_f32_16x16x32_bf16 v[168:171], v[104:107], v[88:91], v[168:171]
v_mfma_f32_16x16x32_bf16 v[172:175], v[104:107], v[92:95], v[172:175]
s_add_u32 m0, s39, 110592
s_add_u32 s37, s37, s38
buffer_load_dwordx4 v22, s[8:11], s37 offen sc1 lds
v_mfma_f32_16x16x32_bf16 v[236:239], v[120:123], v[92:95], v[236:239]
v_mfma_f32_16x16x32_bf16 v[232:235], v[120:123], v[88:91], v[232:235]
v_mfma_f32_16x16x32_bf16 v[228:231], v[120:123], v[84:87], v[228:231]
s_add_u32 m0, s39, 111616
s_add_u32 s37, s37, s38
buffer_load_dwordx4 v23, s[8:11], s37 offen sc1 lds
v_mfma_f32_16x16x32_bf16 v[224:227], v[120:123], v[80:83], v[224:227]
v_mfma_f32_16x16x32_bf16 v[176:179], v[108:111], v[80:83], v[176:179]
v_mfma_f32_16x16x32_bf16 v[180:183], v[108:111], v[84:87], v[180:183]
s_add_u32 m0, s39, 112640
s_add_u32 s37, s37, s38
buffer_load_dwordx4 v22, s[8:11], s37 offen sc1 lds
v_mfma_f32_16x16x32_bf16 v[184:187], v[108:111], v[88:91], v[184:187]
v_mfma_f32_16x16x32_bf16 v[188:191], v[108:111], v[92:95], v[188:191]
v_mfma_f32_16x16x32_bf16 v[252:255], v[124:127], v[92:95], v[252:255]
s_add_u32 m0, s39, 113664
s_add_u32 s37, s37, s38
buffer_load_dwordx4 v23, s[8:11], s37 offen sc1 lds
v_mfma_f32_16x16x32_bf16 v[248:251], v[124:127], v[88:91], v[248:251]
v_mfma_f32_16x16x32_bf16 v[244:247], v[124:127], v[84:87], v[244:247]
v_mfma_f32_16x16x32_bf16 v[240:243], v[124:127], v[80:83], v[240:243]
s_setprio 0
s_waitcnt lgkmcnt(0)
v_mov_b32 v32, v2
v_mul_f32 v88, v3, v3
v_mul_f32 v36, 0xc0135761, v3
v_mul_f32 v89, 0xbdd2d3e8, v3
v_rcp_f32 v44, v88
v_mul_f32 v40, v89, v88
v_mov_b32 v33, v4
v_mul_f32 v88, v5, v5
v_mul_f32 v37, 0xc0135761, v5
v_mul_f32 v89, 0xbdd2d3e8, v5
v_rcp_f32 v45, v88
v_mul_f32 v41, v89, v88
v_mov_b32 v34, v6
v_mul_f32 v88, v7, v7
v_mul_f32 v38, 0xc0135761, v7
v_mul_f32 v89, 0xbdd2d3e8, v7
v_rcp_f32 v46, v88
v_mul_f32 v42, v89, v88
v_mov_b32 v35, v8
v_mul_f32 v88, v9, v9
v_mul_f32 v39, 0xc0135761, v9
v_mul_f32 v89, 0xbdd2d3e8, v9
v_rcp_f32 v47, v88
v_mul_f32 v43, v89, v88
s_barrier
s_add_u32 s42, s42, 1
s_and_b32 s42, s42, 15
s_add_u32 m0, s39, 0
s_mul_i32 s37, s42, s40
buffer_load_dwordx4 v22, s[8:11], s37 offen sc1 lds
v_fma_f32 v128, -v32, v48, v128
v_fma_f32 v129, -v32, v49, v129
v_fma_f32 v130, -v32, v50, v130
v_fma_f32 v131, -v32, v51, v131
s_add_u32 m0, s39, 1024
s_add_u32 s37, s37, s38
buffer_load_dwordx4 v23, s[8:11], s37 offen sc1 lds
v_fma_f32 v192, -v32, v64, v192
v_fma_f32 v193, -v32, v65, v193
v_fma_f32 v194, -v32, v66, v194
s_add_u32 m0, s39, 2048
s_add_u32 s37, s37, s38
buffer_load_dwordx4 v22, s[8:11], s37 offen sc1 lds
v_fma_f32 v195, -v32, v67, v195
v_mul_f32 v80, v128, v128
v_mul_f32 v81, v129, v129
s_add_u32 m0, s39, 3072
s_add_u32 s37, s37, s38
buffer_load_dwordx4 v23, s[8:11], s37 offen sc1 lds
v_mul_f32 v82, v130, v130
v_mul_f32 v83, v131, v131
v_fma_f32 v80, v80, v40, v36
s_add_u32 m0, s39, 4096
s_add_u32 s37, s37, s38
buffer_load_dwordx4 v22, s[8:11], s37 offen sc1 lds
v_fma_f32 v81, v81, v40, v36
v_fma_f32 v82, v82, v40, v36
v_fma_f32 v83, v83, v40, v36
v_mul_f32 v80, v80, v128
s_add_u32 m0, s39, 5120
s_add_u32 s37, s37, s38
buffer_load_dwordx4 v23, s[8:11], s37 offen sc1 lds
v_mul_f32 v81, v81, v129
v_mul_f32 v82, v82, v130
v_mul_f32 v83, v83, v131
s_add_u32 m0, s39, 6144
s_add_u32 s37, s37, s38
buffer_load_dwordx4 v22, s[8:11], s37 offen sc1 lds
v_exp_f32 v80, v80
v_exp_f32 v81, v81
v_exp_f32 v82, v82
s_add_u32 m0, s39, 7168
s_add_u32 s37, s37, s38
buffer_load_dwordx4 v23, s[8:11], s37 offen sc1 lds
v_exp_f32 v83, v83
v_mul_f32 v192, v128, v192
v_mul_f32 v193, v129, v193
s_add_u32 m0, s39, 8192
s_add_u32 s37, s37, s38
buffer_load_dwordx4 v22, s[8:11], s37 offen sc1 lds
v_mul_f32 v194, v130, v194
v_mul_f32 v195, v131, v195
v_fma_f32 v80, v80, v44, v44
v_fma_f32 v81, v81, v44, v44
s_add_u32 m0, s39, 9216
s_add_u32 s37, s37, s38
buffer_load_dwordx4 v23, s[8:11], s37 offen sc1 lds
v_fma_f32 v82, v82, v44, v44
v_fma_f32 v83, v83, v44, v44
v_rcp_f32 v80, v80
s_add_u32 m0, s39, 10240
s_add_u32 s37, s37, s38
buffer_load_dwordx4 v22, s[8:11], s37 offen sc1 lds
v_rcp_f32 v81, v81
v_rcp_f32 v82, v82
v_rcp_f32 v83, v83
s_add_u32 m0, s39, 11264
s_add_u32 s37, s37, s38
buffer_load_dwordx4 v23, s[8:11], s37 offen sc1 lds
v_mul_f32 v192, v192, v80
v_mul_f32 v193, v193, v81
v_mul_f32 v194, v194, v82
s_add_u32 m0, s39, 12288
s_add_u32 s37, s37, s38
buffer_load_dwordx4 v22, s[8:11], s37 offen sc1 lds
v_mul_f32 v195, v195, v83
v_cvt_pk_bf16_f32 v96, v192, v193
v_cvt_pk_bf16_f32 v97, v194, v195
v_fma_f32 v144, -v32, v52, v144
s_add_u32 m0, s39, 13312
s_add_u32 s37, s37, s38
buffer_load_dwordx4 v23, s[8:11], s37 offen sc1 lds
v_fma_f32 v145, -v32, v53, v145
v_fma_f32 v146, -v32, v54, v146
v_fma_f32 v147, -v32, v55, v147
s_add_u32 m0, s39, 14336
s_add_u32 s37, s37, s38
buffer_load_dwordx4 v22, s[8:11], s37 offen sc1 lds
v_fma_f32 v208, -v32, v68, v208
v_fma_f32 v209, -v32, v69, v209
v_fma_f32 v210, -v32, v70, v210
s_add_u32 m0, s39, 15360
s_add_u32 s37, s37, s38
buffer_load_dwordx4 v23, s[8:11], s37 offen sc1 lds
v_fma_f32 v211, -v32, v71, v211
v_mul_f32 v84, v144, v144
v_mul_f32 v85, v145, v145
s_waitcnt vmcnt(16)
s_barrier
s_add_u32 s42, s42, 1
s_and_b32 s42, s42, 15
s_add_u32 m0, s39, 49152
s_mul_i32 s37, s42, s40
buffer_load_dwordx4 v22, s[8:11], s37 offen sc1 lds
v_mul_f32 v86, v146, v146
v_mul_f32 v87, v147, v147
v_fma_f32 v84, v84, v40, v36
v_fma_f32 v85, v85, v40, v36
v_fma_f32 v86, v86, v40, v36
s_add_u32 m0, s39, 50176
s_add_u32 s37, s37, s38
buffer_load_dwordx4 v23, s[8:11], s37 offen sc1 lds
v_fma_f32 v87, v87, v40, v36
v_mul_f32 v84, v84, v144
v_mul_f32 v85, v85, v145
v_mul_f32 v86, v86, v146
v_mul_f32 v87, v87, v147
s_add_u32 m0, s39, 51200
s_add_u32 s37, s37, s38
buffer_load_dwordx4 v22, s[8:11], s37 offen sc1 lds
v_exp_f32 v84, v84
v_exp_f32 v85, v85
v_exp_f32 v86, v86
v_exp_f32 v87, v87
s_add_u32 m0, s39, 52224
s_add_u32 s37, s37, s38
buffer_load_dwordx4 v23, s[8:11], s37 offen sc1 lds
v_mul_f32 v208, v144, v208
v_mul_f32 v209, v145, v209
v_mul_f32 v210, v146, v210
v_mul_f32 v211, v147, v211
v_fma_f32 v84, v84, v44, v44
s_add_u32 m0, s39, 53248
s_add_u32 s37, s37, s38
buffer_load_dwordx4 v22, s[8:11], s37 offen sc1 lds
v_fma_f32 v85, v85, v44, v44
v_fma_f32 v86, v86, v44, v44
v_fma_f32 v87, v87, v44, v44
v_rcp_f32 v84, v84
v_rcp_f32 v85, v85
s_add_u32 m0, s39, 54272
s_add_u32 s37, s37, s38
buffer_load_dwordx4 v23, s[8:11], s37 offen sc1 lds
v_rcp_f32 v86, v86
v_rcp_f32 v87, v87
v_mul_f32 v208, v208, v84
v_mul_f32 v209, v209, v85
s_add_u32 m0, s39, 55296
s_add_u32 s37, s37, s38
buffer_load_dwordx4 v22, s[8:11], s37 offen sc1 lds
v_mul_f32 v210, v210, v86
v_mul_f32 v211, v211, v87
v_cvt_pk_bf16_f32 v98, v208, v209
v_cvt_pk_bf16_f32 v99, v210, v211
s_add_u32 m0, s39, 56320
s_add_u32 s37, s37, s38
buffer_load_dwordx4 v23, s[8:11], s37 offen sc1 lds
v_fma_f32 v132, -v33, v48, v132
v_fma_f32 v133, -v33, v49, v133
v_fma_f32 v134, -v33, v50, v134
v_fma_f32 v135, -v33, v51, v135
s_add_u32 m0, s39, 57344
s_add_u32 s37, s37, s38
buffer_load_dwordx4 v22, s[8:11], s37 offen sc1 lds
v_fma_f32 v196, -v33, v64, v196
v_fma_f32 v197, -v33, v65, v197
v_fma_f32 v198, -v33, v66, v198
v_fma_f32 v199, -v33, v67, v199
v_mul_f32 v80, v132, v132
s_add_u32 m0, s39, 58368
s_add_u32 s37, s37, s38
buffer_load_dwordx4 v23, s[8:11], s37 offen sc1 lds
v_mul_f32 v81, v133, v133
v_mul_f32 v82, v134, v134
v_mul_f32 v83, v135, v135
v_fma_f32 v80, v80, v41, v37
v_fma_f32 v81, v81, v41, v37
s_add_u32 m0, s39, 59392
s_add_u32 s37, s37, s38
buffer_load_dwordx4 v22, s[8:11], s37 offen sc1 lds
v_fma_f32 v82, v82, v41, v37
v_fma_f32 v83, v83, v41, v37
v_mul_f32 v80, v80, v132
v_mul_f32 v81, v81, v133
s_add_u32 m0, s39, 60416
s_add_u32 s37, s37, s38
buffer_load_dwordx4 v23, s[8:11], s37 offen sc1 lds
v_mul_f32 v82, v82, v134
v_lshlrev_b32 v19, 11, v18
v_lshl_add_u32 v19, v17, 4, v19
s_lshl_b32 s43, s46, 10
v_add_u32 v2, s43, v19
s_add_u32 m0, s39, 61440
s_add_u32 s37, s37, s38
buffer_load_dwordx4 v22, s[8:11], s37 offen sc1 lds
v_add_u32 v3, 0x10000, v2
v_lshrrev_b32 v19, 2, v17
v_lshl_add_u32 v20, v18, 2, v19
v_bfe_u32 v21, v20, 1, 2
s_lshl_b32 s43, s47, 1
s_add_u32 m0, s39, 62464
s_add_u32 s37, s37, s38
buffer_load_dwordx4 v23, s[8:11], s37 offen sc1 lds
v_xor_b32 v21, s43, v21
v_lshlrev_b32 v20, 7, v20
v_lshl_add_u32 v20, v21, 5, v20
v_and_b32 v19, 3, v1
s_add_u32 m0, s39, 63488
s_add_u32 s37, s37, s38
buffer_load_dwordx4 v22, s[8:11], s37 offen sc1 lds
v_lshl_add_u32 v20, v19, 3, v20
v_add_u32 v5, 16384, v20
v_xor_b32 v6, 32, v5
v_add_u32 v7, 0x10000, v5
v_add_u32 v8, 0x10000, v6
s_add_u32 m0, s39, 64512
s_add_u32 s37, s37, s38
buffer_load_dwordx4 v23, s[8:11], s37 offen sc1 lds
s_lshl_b32 s43, s36, 12
v_lshl_add_u32 v9, v1, 4, s43
s_mov_b32 s54, 0x10000
s_movk_i32 s52, 0x1000
buffer_store_dwordx4 v[96:99], v27, s[24:27], 0 offen offset:0 sc1
s_waitcnt vmcnt(17)
s_barrier
s_add_u32 s42, s42, 1
s_and_b32 s42, s42, 15
s_add_u32 m0, s39, 98304
s_mul_i32 s37, s42, s40
buffer_load_dwordx4 v22, s[8:11], s37 offen sc1 lds
v_mul_f32 v83, v83, v135
v_exp_f32 v80, v80
v_exp_f32 v81, v81
v_exp_f32 v82, v82
s_add_u32 m0, s39, 99328
s_add_u32 s37, s37, s38
buffer_load_dwordx4 v23, s[8:11], s37 offen sc1 lds
v_exp_f32 v83, v83
v_mul_f32 v196, v132, v196
v_mul_f32 v197, v133, v197
s_add_u32 m0, s39, 100352
s_add_u32 s37, s37, s38
buffer_load_dwordx4 v22, s[8:11], s37 offen sc1 lds
v_mul_f32 v198, v134, v198
v_mul_f32 v199, v135, v199
v_fma_f32 v80, v80, v45, v45
s_add_u32 m0, s39, 101376
s_add_u32 s37, s37, s38
buffer_load_dwordx4 v23, s[8:11], s37 offen sc1 lds
v_fma_f32 v81, v81, v45, v45
v_fma_f32 v82, v82, v45, v45
v_fma_f32 v83, v83, v45, v45
s_add_u32 m0, s39, 102400
s_add_u32 s37, s37, s38
buffer_load_dwordx4 v22, s[8:11], s37 offen sc1 lds
v_rcp_f32 v80, v80
v_rcp_f32 v81, v81
v_rcp_f32 v82, v82
v_rcp_f32 v83, v83
s_add_u32 m0, s39, 103424
s_add_u32 s37, s37, s38
buffer_load_dwordx4 v23, s[8:11], s37 offen sc1 lds
v_mul_f32 v196, v196, v80
v_mul_f32 v197, v197, v81
v_mul_f32 v198, v198, v82
s_add_u32 m0, s39, 104448
s_add_u32 s37, s37, s38
buffer_load_dwordx4 v22, s[8:11], s37 offen sc1 lds
v_mul_f32 v199, v199, v83
v_cvt_pk_bf16_f32 v100, v196, v197
v_cvt_pk_bf16_f32 v101, v198, v199
s_add_u32 m0, s39, 105472
s_add_u32 s37, s37, s38
buffer_load_dwordx4 v23, s[8:11], s37 offen sc1 lds
v_fma_f32 v148, -v33, v52, v148
v_fma_f32 v149, -v33, v53, v149
v_fma_f32 v150, -v33, v54, v150
s_add_u32 m0, s39, 106496
s_add_u32 s37, s37, s38
buffer_load_dwordx4 v22, s[8:11], s37 offen sc1 lds
v_fma_f32 v151, -v33, v55, v151
v_fma_f32 v212, -v33, v68, v212
v_fma_f32 v213, -v33, v69, v213
v_fma_f32 v214, -v33, v70, v214
s_add_u32 m0, s39, 107520
s_add_u32 s37, s37, s38
buffer_load_dwordx4 v23, s[8:11], s37 offen sc1 lds
v_fma_f32 v215, -v33, v71, v215
v_mul_f32 v84, v148, v148
v_mul_f32 v85, v149, v149
s_add_u32 m0, s39, 108544
s_add_u32 s37, s37, s38
buffer_load_dwordx4 v22, s[8:11], s37 offen sc1 lds
v_mul_f32 v86, v150, v150
v_mul_f32 v87, v151, v151
v_fma_f32 v84, v84, v41, v37
s_add_u32 m0, s39, 109568
s_add_u32 s37, s37, s38
buffer_load_dwordx4 v23, s[8:11], s37 offen sc1 lds
v_fma_f32 v85, v85, v41, v37
v_fma_f32 v86, v86, v41, v37
v_fma_f32 v87, v87, v41, v37
s_add_u32 m0, s39, 110592
s_add_u32 s37, s37, s38
buffer_load_dwordx4 v22, s[8:11], s37 offen sc1 lds
v_mul_f32 v84, v84, v148
v_mul_f32 v85, v85, v149
v_mul_f32 v86, v86, v150
v_mul_f32 v87, v87, v151
s_add_u32 m0, s39, 111616
s_add_u32 s37, s37, s38
buffer_load_dwordx4 v23, s[8:11], s37 offen sc1 lds
v_exp_f32 v84, v84
v_exp_f32 v85, v85
v_exp_f32 v86, v86
s_add_u32 m0, s39, 112640
s_add_u32 s37, s37, s38
buffer_load_dwordx4 v22, s[8:11], s37 offen sc1 lds
v_exp_f32 v87, v87
v_mul_f32 v212, v148, v212
v_mul_f32 v213, v149, v213
s_add_u32 m0, s39, 113664
s_add_u32 s37, s37, s38
buffer_load_dwordx4 v23, s[8:11], s37 offen sc1 lds
v_mul_f32 v214, v150, v214
v_mul_f32 v215, v151, v215
v_fma_f32 v84, v84, v45, v45
s_waitcnt vmcnt(17)
s_barrier
s_add_u32 s42, s42, 1
s_and_b32 s42, s42, 15
s_add_u32 m0, s39, 0
s_mul_i32 s37, s42, s40
buffer_load_dwordx4 v22, s[8:11], s37 offen sc1 lds
v_fma_f32 v85, v85, v45, v45
v_fma_f32 v86, v86, v45, v45
v_fma_f32 v87, v87, v45, v45
v_rcp_f32 v84, v84
s_add_u32 m0, s39, 1024
s_add_u32 s37, s37, s38
buffer_load_dwordx4 v23, s[8:11], s37 offen sc1 lds
v_rcp_f32 v85, v85
v_rcp_f32 v86, v86
v_rcp_f32 v87, v87
s_add_u32 m0, s39, 2048
s_add_u32 s37, s37, s38
buffer_load_dwordx4 v22, s[8:11], s37 offen sc1 lds
v_mul_f32 v212, v212, v84
v_mul_f32 v213, v213, v85
v_mul_f32 v214, v214, v86
s_add_u32 m0, s39, 3072
s_add_u32 s37, s37, s38
buffer_load_dwordx4 v23, s[8:11], s37 offen sc1 lds
v_mul_f32 v215, v215, v87
v_cvt_pk_bf16_f32 v102, v212, v213
v_cvt_pk_bf16_f32 v103, v214, v215
s_add_u32 m0, s39, 4096
s_add_u32 s37, s37, s38
buffer_load_dwordx4 v22, s[8:11], s37 offen sc1 lds
v_fma_f32 v136, -v34, v48, v136
v_fma_f32 v137, -v34, v49, v137
v_fma_f32 v138, -v34, v50, v138
s_add_u32 m0, s39, 5120
s_add_u32 s37, s37, s38
buffer_load_dwordx4 v23, s[8:11], s37 offen sc1 lds
v_fma_f32 v139, -v34, v51, v139
v_fma_f32 v200, -v34, v64, v200
v_fma_f32 v201, -v34, v65, v201
s_add_u32 m0, s39, 6144
s_add_u32 s37, s37, s38
buffer_load_dwordx4 v22, s[8:11], s37 offen sc1 lds
v_fma_f32 v202, -v34, v66, v202
v_fma_f32 v203, -v34, v67, v203
v_mul_f32 v80, v136, v136
v_mul_f32 v81, v137, v137
s_add_u32 m0, s39, 7168
s_add_u32 s37, s37, s38
buffer_load_dwordx4 v23, s[8:11], s37 offen sc1 lds
v_mul_f32 v82, v138, v138
v_mul_f32 v83, v139, v139
v_fma_f32 v80, v80, v42, v38
s_add_u32 m0, s39, 8192
s_add_u32 s37, s37, s38
buffer_load_dwordx4 v22, s[8:11], s37 offen sc1 lds
v_fma_f32 v81, v81, v42, v38
v_fma_f32 v82, v82, v42, v38
v_fma_f32 v83, v83, v42, v38
s_add_u32 m0, s39, 9216
s_add_u32 s37, s37, s38
buffer_load_dwordx4 v23, s[8:11], s37 offen sc1 lds
v_mul_f32 v80, v80, v136
v_mul_f32 v81, v81, v137
v_mul_f32 v82, v82, v138
v_mul_f32 v83, v83, v139
s_add_u32 m0, s39, 10240
s_add_u32 s37, s37, s38
buffer_load_dwordx4 v22, s[8:11], s37 offen sc1 lds
v_exp_f32 v80, v80
v_exp_f32 v81, v81
v_exp_f32 v82, v82
s_add_u32 m0, s39, 11264
s_add_u32 s37, s37, s38
buffer_load_dwordx4 v23, s[8:11], s37 offen sc1 lds
v_exp_f32 v83, v83
v_mul_f32 v200, v136, v200
v_mul_f32 v201, v137, v201
s_add_u32 m0, s39, 12288
s_add_u32 s37, s37, s38
buffer_load_dwordx4 v22, s[8:11], s37 offen sc1 lds
v_mul_f32 v202, v138, v202
v_mul_f32 v203, v139, v203
v_fma_f32 v80, v80, v46, v46
v_fma_f32 v81, v81, v46, v46
s_add_u32 m0, s39, 13312
s_add_u32 s37, s37, s38
buffer_load_dwordx4 v23, s[8:11], s37 offen sc1 lds
v_fma_f32 v82, v82, v46, v46
v_fma_f32 v83, v83, v46, v46
v_rcp_f32 v80, v80
s_add_u32 m0, s39, 14336
s_add_u32 s37, s37, s38
buffer_load_dwordx4 v22, s[8:11], s37 offen sc1 lds
v_rcp_f32 v81, v81
v_rcp_f32 v82, v82
v_rcp_f32 v83, v83
s_add_u32 m0, s39, 15360
s_add_u32 s37, s37, s38
buffer_load_dwordx4 v23, s[8:11], s37 offen sc1 lds
v_mul_f32 v200, v200, v80
v_mul_f32 v201, v201, v81
v_mul_f32 v202, v202, v82
buffer_store_dwordx4 v[100:103], v27, s[24:27], 0 offen offset:256 sc1
s_waitcnt vmcnt(17)
s_barrier
s_add_u32 s42, s42, 1
s_and_b32 s42, s42, 15
s_add_u32 m0, s39, 49152
s_mul_i32 s37, s42, s40
buffer_load_dwordx4 v22, s[8:11], s37 offen sc1 lds
v_mul_f32 v203, v203, v83
v_cvt_pk_bf16_f32 v104, v200, v201
v_cvt_pk_bf16_f32 v105, v202, v203
v_fma_f32 v152, -v34, v52, v152
s_add_u32 m0, s39, 50176
s_add_u32 s37, s37, s38
buffer_load_dwordx4 v23, s[8:11], s37 offen sc1 lds
v_fma_f32 v153, -v34, v53, v153
v_fma_f32 v154, -v34, v54, v154
v_fma_f32 v155, -v34, v55, v155
s_add_u32 m0, s39, 51200
s_add_u32 s37, s37, s38
buffer_load_dwordx4 v22, s[8:11], s37 offen sc1 lds
v_fma_f32 v216, -v34, v68, v216
v_fma_f32 v217, -v34, v69, v217
v_fma_f32 v218, -v34, v70, v218
s_add_u32 m0, s39, 52224
s_add_u32 s37, s37, s38
buffer_load_dwordx4 v23, s[8:11], s37 offen sc1 lds
v_fma_f32 v219, -v34, v71, v219
v_mul_f32 v84, v152, v152
v_mul_f32 v85, v153, v153
s_add_u32 m0, s39, 53248
s_add_u32 s37, s37, s38
buffer_load_dwordx4 v22, s[8:11], s37 offen sc1 lds
v_mul_f32 v86, v154, v154
v_mul_f32 v87, v155, v155
v_fma_f32 v84, v84, v42, v38
v_fma_f32 v85, v85, v42, v38
s_add_u32 m0, s39, 54272
s_add_u32 s37, s37, s38
buffer_load_dwordx4 v23, s[8:11], s37 offen sc1 lds
v_fma_f32 v86, v86, v42, v38
v_fma_f32 v87, v87, v42, v38
v_mul_f32 v84, v84, v152
s_add_u32 m0, s39, 55296
s_add_u32 s37, s37, s38
buffer_load_dwordx4 v22, s[8:11], s37 offen sc1 lds
v_mul_f32 v85, v85, v153
v_mul_f32 v86, v86, v154
v_mul_f32 v87, v87, v155
s_add_u32 m0, s39, 56320
s_add_u32 s37, s37, s38
buffer_load_dwordx4 v23, s[8:11], s37 offen sc1 lds
v_exp_f32 v84, v84
v_exp_f32 v85, v85
v_exp_f32 v86, v86
s_add_u32 m0, s39, 57344
s_add_u32 s37, s37, s38
buffer_load_dwordx4 v22, s[8:11], s37 offen sc1 lds
v_exp_f32 v87, v87
v_mul_f32 v216, v152, v216
v_mul_f32 v217, v153, v217
v_mul_f32 v218, v154, v218
s_add_u32 m0, s39, 58368
s_add_u32 s37, s37, s38
buffer_load_dwordx4 v23, s[8:11], s37 offen sc1 lds
v_mul_f32 v219, v155, v219
v_fma_f32 v84, v84, v46, v46
v_fma_f32 v85, v85, v46, v46
s_add_u32 m0, s39, 59392
s_add_u32 s37, s37, s38
buffer_load_dwordx4 v22, s[8:11], s37 offen sc1 lds
v_fma_f32 v86, v86, v46, v46
v_fma_f32 v87, v87, v46, v46
v_rcp_f32 v84, v84
s_add_u32 m0, s39, 60416
s_add_u32 s37, s37, s38
buffer_load_dwordx4 v23, s[8:11], s37 offen sc1 lds
v_rcp_f32 v85, v85
v_rcp_f32 v86, v86
v_rcp_f32 v87, v87
s_add_u32 m0, s39, 61440
s_add_u32 s37, s37, s38
buffer_load_dwordx4 v22, s[8:11], s37 offen sc1 lds
v_mul_f32 v216, v216, v84
v_mul_f32 v217, v217, v85
v_mul_f32 v218, v218, v86
v_mul_f32 v219, v219, v87
s_add_u32 m0, s39, 62464
s_add_u32 s37, s37, s38
buffer_load_dwordx4 v23, s[8:11], s37 offen sc1 lds
v_cvt_pk_bf16_f32 v106, v216, v217
v_cvt_pk_bf16_f32 v107, v218, v219
s_add_u32 m0, s39, 63488
s_add_u32 s37, s37, s38
buffer_load_dwordx4 v22, s[8:11], s37 offen sc1 lds
v_fma_f32 v140, -v35, v48, v140
v_fma_f32 v141, -v35, v49, v141
v_fma_f32 v142, -v35, v50, v142
s_add_u32 m0, s39, 64512
s_add_u32 s37, s37, s38
buffer_load_dwordx4 v23, s[8:11], s37 offen sc1 lds
v_fma_f32 v143, -v35, v51, v143
v_fma_f32 v204, -v35, v64, v204
v_fma_f32 v205, -v35, v65, v205
buffer_store_dwordx4 v[104:107], v27, s[24:27], 0 offen offset:512 sc1
s_waitcnt vmcnt(18)
s_barrier
s_add_u32 s42, s42, 1
s_and_b32 s42, s42, 15
s_add_u32 m0, s39, 98304
s_mul_i32 s37, s42, s40
buffer_load_dwordx4 v22, s[8:11], s37 offen sc1 lds
v_fma_f32 v206, -v35, v66, v206
v_fma_f32 v207, -v35, v67, v207
v_mul_f32 v80, v140, v140
v_mul_f32 v81, v141, v141
s_add_u32 m0, s39, 99328
s_add_u32 s37, s37, s38
buffer_load_dwordx4 v23, s[8:11], s37 offen sc1 lds
v_mul_f32 v82, v142, v142
v_mul_f32 v83, v143, v143
v_fma_f32 v80, v80, v43, v39
s_add_u32 m0, s39, 100352
s_add_u32 s37, s37, s38
buffer_load_dwordx4 v22, s[8:11], s37 offen sc1 lds
v_fma_f32 v81, v81, v43, v39
v_fma_f32 v82, v82, v43, v39
v_fma_f32 v83, v83, v43, v39
s_add_u32 m0, s39, 101376
s_add_u32 s37, s37, s38
buffer_load_dwordx4 v23, s[8:11], s37 offen sc1 lds
v_mul_f32 v80, v80, v140
v_mul_f32 v81, v81, v141
v_mul_f32 v82, v82, v142
s_add_u32 m0, s39, 102400
s_add_u32 s37, s37, s38
buffer_load_dwordx4 v22, s[8:11], s37 offen sc1 lds
v_mul_f32 v83, v83, v143
v_exp_f32 v80, v80
v_exp_f32 v81, v81
v_exp_f32 v82, v82
s_add_u32 m0, s39, 103424
s_add_u32 s37, s37, s38
buffer_load_dwordx4 v23, s[8:11], s37 offen sc1 lds
v_exp_f32 v83, v83
v_mul_f32 v204, v140, v204
v_mul_f32 v205, v141, v205
s_add_u32 m0, s39, 104448
s_add_u32 s37, s37, s38
buffer_load_dwordx4 v22, s[8:11], s37 offen sc1 lds
v_mul_f32 v206, v142, v206
v_mul_f32 v207, v143, v207
v_fma_f32 v80, v80, v47, v47
s_add_u32 m0, s39, 105472
s_add_u32 s37, s37, s38
buffer_load_dwordx4 v23, s[8:11], s37 offen sc1 lds
v_fma_f32 v81, v81, v47, v47
v_fma_f32 v82, v82, v47, v47
v_fma_f32 v83, v83, v47, v47
s_add_u32 m0, s39, 106496
s_add_u32 s37, s37, s38
buffer_load_dwordx4 v22, s[8:11], s37 offen sc1 lds
v_rcp_f32 v80, v80
v_rcp_f32 v81, v81
v_rcp_f32 v82, v82
v_rcp_f32 v83, v83
s_add_u32 m0, s39, 107520
s_add_u32 s37, s37, s38
buffer_load_dwordx4 v23, s[8:11], s37 offen sc1 lds
v_mul_f32 v204, v204, v80
v_mul_f32 v205, v205, v81
v_mul_f32 v206, v206, v82
s_add_u32 m0, s39, 108544
s_add_u32 s37, s37, s38
buffer_load_dwordx4 v22, s[8:11], s37 offen sc1 lds
v_mul_f32 v207, v207, v83
v_cvt_pk_bf16_f32 v108, v204, v205
v_cvt_pk_bf16_f32 v109, v206, v207
s_add_u32 m0, s39, 109568
s_add_u32 s37, s37, s38
buffer_load_dwordx4 v23, s[8:11], s37 offen sc1 lds
v_fma_f32 v156, -v35, v52, v156
v_fma_f32 v157, -v35, v53, v157
v_fma_f32 v158, -v35, v54, v158
s_add_u32 m0, s39, 110592
s_add_u32 s37, s37, s38
buffer_load_dwordx4 v22, s[8:11], s37 offen sc1 lds
v_fma_f32 v159, -v35, v55, v159
v_fma_f32 v220, -v35, v68, v220
v_fma_f32 v221, -v35, v69, v221
v_fma_f32 v222, -v35, v70, v222
s_add_u32 m0, s39, 111616
s_add_u32 s37, s37, s38
buffer_load_dwordx4 v23, s[8:11], s37 offen sc1 lds
v_fma_f32 v223, -v35, v71, v223
v_mul_f32 v84, v156, v156
v_mul_f32 v85, v157, v157
s_add_u32 m0, s39, 112640
s_add_u32 s37, s37, s38
buffer_load_dwordx4 v22, s[8:11], s37 offen sc1 lds
v_mul_f32 v86, v158, v158
v_mul_f32 v87, v159, v159
v_fma_f32 v84, v84, v43, v39
s_add_u32 m0, s39, 113664
s_add_u32 s37, s37, s38
buffer_load_dwordx4 v23, s[8:11], s37 offen sc1 lds
v_fma_f32 v85, v85, v43, v39
v_fma_f32 v86, v86, v43, v39
v_fma_f32 v87, v87, v43, v39
s_waitcnt vmcnt(17)
s_barrier
s_add_u32 s42, s42, 1
s_and_b32 s42, s42, 15
s_add_u32 m0, s39, 0
s_mul_i32 s37, s42, s40
buffer_load_dwordx4 v22, s[8:11], s37 offen sc1 lds
v_mul_f32 v84, v84, v156
v_mul_f32 v85, v85, v157
v_mul_f32 v86, v86, v158
v_mul_f32 v87, v87, v159
s_add_u32 m0, s39, 1024
s_add_u32 s37, s37, s38
buffer_load_dwordx4 v23, s[8:11], s37 offen sc1 lds
v_exp_f32 v84, v84
v_exp_f32 v85, v85
v_exp_f32 v86, v86
s_add_u32 m0, s39, 2048
s_add_u32 s37, s37, s38
buffer_load_dwordx4 v22, s[8:11], s37 offen sc1 lds
v_exp_f32 v87, v87
v_mul_f32 v220, v156, v220
v_mul_f32 v221, v157, v221
s_add_u32 m0, s39, 3072
s_add_u32 s37, s37, s38
buffer_load_dwordx4 v23, s[8:11], s37 offen sc1 lds
v_mul_f32 v222, v158, v222
v_mul_f32 v223, v159, v223
v_fma_f32 v84, v84, v47, v47
v_fma_f32 v85, v85, v47, v47
s_add_u32 m0, s39, 4096
s_add_u32 s37, s37, s38
buffer_load_dwordx4 v22, s[8:11], s37 offen sc1 lds
v_fma_f32 v86, v86, v47, v47
v_fma_f32 v87, v87, v47, v47
v_rcp_f32 v84, v84
s_add_u32 m0, s39, 5120
s_add_u32 s37, s37, s38
buffer_load_dwordx4 v23, s[8:11], s37 offen sc1 lds
v_rcp_f32 v85, v85
v_rcp_f32 v86, v86
v_rcp_f32 v87, v87
s_add_u32 m0, s39, 6144
s_add_u32 s37, s37, s38
buffer_load_dwordx4 v22, s[8:11], s37 offen sc1 lds
v_mul_f32 v220, v220, v84
v_mul_f32 v221, v221, v85
v_mul_f32 v222, v222, v86
v_mul_f32 v223, v223, v87
s_add_u32 m0, s39, 7168
s_add_u32 s37, s37, s38
buffer_load_dwordx4 v23, s[8:11], s37 offen sc1 lds
v_cvt_pk_bf16_f32 v110, v220, v221
v_cvt_pk_bf16_f32 v111, v222, v223
s_add_u32 m0, s39, 8192
s_add_u32 s37, s37, s38
buffer_load_dwordx4 v22, s[8:11], s37 offen sc1 lds
v_fma_f32 v160, -v32, v56, v160
v_fma_f32 v161, -v32, v57, v161
v_fma_f32 v162, -v32, v58, v162
s_add_u32 m0, s39, 9216
s_add_u32 s37, s37, s38
buffer_load_dwordx4 v23, s[8:11], s37 offen sc1 lds
v_fma_f32 v163, -v32, v59, v163
v_fma_f32 v224, -v32, v72, v224
v_fma_f32 v225, -v32, v73, v225
v_fma_f32 v226, -v32, v74, v226
s_add_u32 m0, s39, 10240
s_add_u32 s37, s37, s38
buffer_load_dwordx4 v22, s[8:11], s37 offen sc1 lds
v_fma_f32 v227, -v32, v75, v227
v_mul_f32 v80, v160, v160
v_mul_f32 v81, v161, v161
s_add_u32 m0, s39, 11264
s_add_u32 s37, s37, s38
buffer_load_dwordx4 v23, s[8:11], s37 offen sc1 lds
v_mul_f32 v82, v162, v162
v_mul_f32 v83, v163, v163
v_fma_f32 v80, v80, v40, v36
s_add_u32 m0, s39, 12288
s_add_u32 s37, s37, s38
buffer_load_dwordx4 v22, s[8:11], s37 offen sc1 lds
v_fma_f32 v81, v81, v40, v36
v_fma_f32 v82, v82, v40, v36
v_fma_f32 v83, v83, v40, v36
v_mul_f32 v80, v80, v160
s_add_u32 m0, s39, 13312
s_add_u32 s37, s37, s38
buffer_load_dwordx4 v23, s[8:11], s37 offen sc1 lds
v_mul_f32 v81, v81, v161
v_mul_f32 v82, v82, v162
v_mul_f32 v83, v83, v163
s_add_u32 m0, s39, 14336
s_add_u32 s37, s37, s38
buffer_load_dwordx4 v22, s[8:11], s37 offen sc1 lds
v_exp_f32 v80, v80
v_exp_f32 v81, v81
v_exp_f32 v82, v82
s_add_u32 m0, s39, 15360
s_add_u32 s37, s37, s38
buffer_load_dwordx4 v23, s[8:11], s37 offen sc1 lds
v_exp_f32 v83, v83
v_mul_f32 v224, v160, v224
v_mul_f32 v225, v161, v225
buffer_store_dwordx4 v[108:111], v27, s[24:27], 0 offen offset:768 sc1
s_waitcnt vmcnt(17)
s_barrier
s_add_u32 s42, s42, 1
s_and_b32 s42, s42, 15
s_add_u32 m0, s39, 49152
s_mul_i32 s37, s42, s40
buffer_load_dwordx4 v22, s[8:11], s37 offen sc1 lds
v_mul_f32 v226, v162, v226
v_mul_f32 v227, v163, v227
v_fma_f32 v80, v80, v44, v44
v_fma_f32 v81, v81, v44, v44
s_add_u32 m0, s39, 50176
s_add_u32 s37, s37, s38
buffer_load_dwordx4 v23, s[8:11], s37 offen sc1 lds
v_fma_f32 v82, v82, v44, v44
v_fma_f32 v83, v83, v44, v44
v_rcp_f32 v80, v80
v_rcp_f32 v81, v81
s_add_u32 m0, s39, 51200
s_add_u32 s37, s37, s38
buffer_load_dwordx4 v22, s[8:11], s37 offen sc1 lds
v_rcp_f32 v82, v82
v_rcp_f32 v83, v83
v_mul_f32 v224, v224, v80
v_mul_f32 v225, v225, v81
s_add_u32 m0, s39, 52224
s_add_u32 s37, s37, s38
buffer_load_dwordx4 v23, s[8:11], s37 offen sc1 lds
v_mul_f32 v226, v226, v82
v_mul_f32 v227, v227, v83
v_cvt_pk_bf16_f32 v96, v224, v225
v_cvt_pk_bf16_f32 v97, v226, v227
s_add_u32 m0, s39, 53248
s_add_u32 s37, s37, s38
buffer_load_dwordx4 v22, s[8:11], s37 offen sc1 lds
v_fma_f32 v176, -v32, v60, v176
v_fma_f32 v177, -v32, v61, v177
v_fma_f32 v178, -v32, v62, v178
v_fma_f32 v179, -v32, v63, v179
s_add_u32 m0, s39, 54272
s_add_u32 s37, s37, s38
buffer_load_dwordx4 v23, s[8:11], s37 offen sc1 lds
v_fma_f32 v240, -v32, v76, v240
v_fma_f32 v241, -v32, v77, v241
v_fma_f32 v242, -v32, v78, v242
v_fma_f32 v243, -v32, v79, v243
s_add_u32 m0, s39, 55296
s_add_u32 s37, s37, s38
buffer_load_dwordx4 v22, s[8:11], s37 offen sc1 lds
v_mul_f32 v84, v176, v176
v_mul_f32 v85, v177, v177
v_mul_f32 v86, v178, v178
v_mul_f32 v87, v179, v179
s_add_u32 m0, s39, 56320
s_add_u32 s37, s37, s38
buffer_load_dwordx4 v23, s[8:11], s37 offen sc1 lds
v_fma_f32 v84, v84, v40, v36
v_fma_f32 v85, v85, v40, v36
v_fma_f32 v86, v86, v40, v36
s_add_u32 m0, s39, 57344
s_add_u32 s37, s37, s38
buffer_load_dwordx4 v22, s[8:11], s37 offen sc1 lds
v_fma_f32 v87, v87, v40, v36
v_mul_f32 v84, v84, v176
v_mul_f32 v85, v85, v177
v_mul_f32 v86, v86, v178
s_add_u32 m0, s39, 58368
s_add_u32 s37, s37, s38
buffer_load_dwordx4 v23, s[8:11], s37 offen sc1 lds
v_mul_f32 v87, v87, v179
v_exp_f32 v84, v84
v_exp_f32 v85, v85
v_exp_f32 v86, v86
s_add_u32 m0, s39, 59392
s_add_u32 s37, s37, s38
buffer_load_dwordx4 v22, s[8:11], s37 offen sc1 lds
v_exp_f32 v87, v87
v_mul_f32 v240, v176, v240
v_mul_f32 v241, v177, v241
v_mul_f32 v242, v178, v242
s_add_u32 m0, s39, 60416
s_add_u32 s37, s37, s38
buffer_load_dwordx4 v23, s[8:11], s37 offen sc1 lds
v_mul_f32 v243, v179, v243
v_fma_f32 v84, v84, v44, v44
v_fma_f32 v85, v85, v44, v44
v_fma_f32 v86, v86, v44, v44
s_add_u32 m0, s39, 61440
s_add_u32 s37, s37, s38
buffer_load_dwordx4 v22, s[8:11], s37 offen sc1 lds
v_fma_f32 v87, v87, v44, v44
v_rcp_f32 v84, v84
v_rcp_f32 v85, v85
v_rcp_f32 v86, v86
s_add_u32 m0, s39, 62464
s_add_u32 s37, s37, s38
buffer_load_dwordx4 v23, s[8:11], s37 offen sc1 lds
v_rcp_f32 v87, v87
v_lshlrev_b32 v19, 11, v18
v_lshl_add_u32 v19, v17, 4, v19
s_lshl_b32 s43, s46, 10
s_add_u32 m0, s39, 63488
s_add_u32 s37, s37, s38
buffer_load_dwordx4 v22, s[8:11], s37 offen sc1 lds
s_lshl_b32 s44, s47, 13
v_add3_u32 v208, v19, s43, 0
v_add_u32 v208, s44, v208
buffer_load_dwordx4 v[192:195], v208, s[20:23], 0 offen offset:0 sc1
s_add_u32 m0, s39, 64512
s_add_u32 s37, s37, s38
buffer_load_dwordx4 v23, s[8:11], s37 offen sc1 lds
buffer_load_dwordx4 v[196:199], v208, s[20:23], 0 offen offset:256 sc1
buffer_load_dwordx4 v[200:203], v208, s[20:23], 0 offen offset:512 sc1
buffer_load_dwordx4 v[204:207], v208, s[20:23], 0 offen offset:768 sc1
s_waitcnt vmcnt(20)
s_barrier
s_add_u32 s42, s42, 1
s_and_b32 s42, s42, 15
s_add_u32 m0, s39, 98304
s_mul_i32 s37, s42, s40
buffer_load_dwordx4 v22, s[8:11], s37 offen sc1 lds
v_mul_f32 v240, v240, v84
v_mul_f32 v241, v241, v85
v_mul_f32 v242, v242, v86
v_mul_f32 v243, v243, v87
s_add_u32 m0, s39, 99328
s_add_u32 s37, s37, s38
buffer_load_dwordx4 v23, s[8:11], s37 offen sc1 lds
v_cvt_pk_bf16_f32 v98, v240, v241
v_cvt_pk_bf16_f32 v99, v242, v243
s_add_u32 m0, s39, 100352
s_add_u32 s37, s37, s38
buffer_load_dwordx4 v22, s[8:11], s37 offen sc1 lds
v_fma_f32 v164, -v33, v56, v164
v_fma_f32 v165, -v33, v57, v165
v_fma_f32 v166, -v33, v58, v166
s_add_u32 m0, s39, 101376
s_add_u32 s37, s37, s38
buffer_load_dwordx4 v23, s[8:11], s37 offen sc1 lds
v_fma_f32 v167, -v33, v59, v167
v_fma_f32 v228, -v33, v72, v228
v_fma_f32 v229, -v33, v73, v229
s_add_u32 m0, s39, 102400
s_add_u32 s37, s37, s38
buffer_load_dwordx4 v22, s[8:11], s37 offen sc1 lds
v_fma_f32 v230, -v33, v74, v230
v_fma_f32 v231, -v33, v75, v231
v_mul_f32 v80, v164, v164
v_mul_f32 v81, v165, v165
s_add_u32 m0, s39, 103424
s_add_u32 s37, s37, s38
buffer_load_dwordx4 v23, s[8:11], s37 offen sc1 lds
v_mul_f32 v82, v166, v166
v_mul_f32 v83, v167, v167
v_fma_f32 v80, v80, v41, v37
s_add_u32 m0, s39, 104448
s_add_u32 s37, s37, s38
buffer_load_dwordx4 v22, s[8:11], s37 offen sc1 lds
v_fma_f32 v81, v81, v41, v37
v_fma_f32 v82, v82, v41, v37
v_fma_f32 v83, v83, v41, v37
s_add_u32 m0, s39, 105472
s_add_u32 s37, s37, s38
buffer_load_dwordx4 v23, s[8:11], s37 offen sc1 lds
v_mul_f32 v80, v80, v164
v_mul_f32 v81, v81, v165
v_mul_f32 v82, v82, v166
s_add_u32 m0, s39, 106496
s_add_u32 s37, s37, s38
buffer_load_dwordx4 v22, s[8:11], s37 offen sc1 lds
v_mul_f32 v83, v83, v167
v_exp_f32 v80, v80
v_exp_f32 v81, v81
v_exp_f32 v82, v82
s_add_u32 m0, s39, 107520
s_add_u32 s37, s37, s38
buffer_load_dwordx4 v23, s[8:11], s37 offen sc1 lds
v_exp_f32 v83, v83
v_mul_f32 v228, v164, v228
v_mul_f32 v229, v165, v229
s_add_u32 m0, s39, 108544
s_add_u32 s37, s37, s38
buffer_load_dwordx4 v22, s[8:11], s37 offen sc1 lds
v_mul_f32 v230, v166, v230
v_mul_f32 v231, v167, v231
v_fma_f32 v80, v80, v45, v45
s_add_u32 m0, s39, 109568
s_add_u32 s37, s37, s38
buffer_load_dwordx4 v23, s[8:11], s37 offen sc1 lds
v_fma_f32 v81, v81, v45, v45
v_fma_f32 v82, v82, v45, v45
v_fma_f32 v83, v83, v45, v45
s_add_u32 m0, s39, 110592
s_add_u32 s37, s37, s38
buffer_load_dwordx4 v22, s[8:11], s37 offen sc1 lds
v_rcp_f32 v80, v80
v_rcp_f32 v81, v81
v_rcp_f32 v82, v82
v_rcp_f32 v83, v83
s_add_u32 m0, s39, 111616
s_add_u32 s37, s37, s38
buffer_load_dwordx4 v23, s[8:11], s37 offen sc1 lds
v_mul_f32 v228, v228, v80
v_mul_f32 v229, v229, v81
v_mul_f32 v230, v230, v82
s_add_u32 m0, s39, 112640
s_add_u32 s37, s37, s38
buffer_load_dwordx4 v22, s[8:11], s37 offen sc1 lds
v_mul_f32 v231, v231, v83
v_cvt_pk_bf16_f32 v100, v228, v229
v_cvt_pk_bf16_f32 v101, v230, v231
s_add_u32 m0, s39, 113664
s_add_u32 s37, s37, s38
buffer_load_dwordx4 v23, s[8:11], s37 offen sc1 lds
v_fma_f32 v180, -v33, v60, v180
v_fma_f32 v181, -v33, v61, v181
v_fma_f32 v182, -v33, v62, v182
buffer_store_dwordx4 v[96:99], v27, s[24:27], s53 offen offset:0 sc1
s_waitcnt vmcnt(20)
s_barrier
s_add_u32 s42, s42, 1
s_and_b32 s42, s42, 15
s_add_u32 m0, s39, 0
s_mul_i32 s37, s42, s40
buffer_load_dwordx4 v22, s[8:11], s37 offen sc1 lds
v_fma_f32 v183, -v33, v63, v183
v_fma_f32 v244, -v33, v76, v244
v_fma_f32 v245, -v33, v77, v245
v_fma_f32 v246, -v33, v78, v246
s_add_u32 m0, s39, 1024
s_add_u32 s37, s37, s38
buffer_load_dwordx4 v23, s[8:11], s37 offen sc1 lds
v_fma_f32 v247, -v33, v79, v247
v_mul_f32 v84, v180, v180
v_mul_f32 v85, v181, v181
s_add_u32 m0, s39, 2048
s_add_u32 s37, s37, s38
buffer_load_dwordx4 v22, s[8:11], s37 offen sc1 lds
v_mul_f32 v86, v182, v182
v_mul_f32 v87, v183, v183
v_fma_f32 v84, v84, v41, v37
s_add_u32 m0, s39, 3072
s_add_u32 s37, s37, s38
buffer_load_dwordx4 v23, s[8:11], s37 offen sc1 lds
v_fma_f32 v85, v85, v41, v37
v_fma_f32 v86, v86, v41, v37
v_fma_f32 v87, v87, v41, v37
v_mul_f32 v84, v84, v180
s_add_u32 m0, s39, 4096
s_add_u32 s37, s37, s38
buffer_load_dwordx4 v22, s[8:11], s37 offen sc1 lds
v_mul_f32 v85, v85, v181
v_mul_f32 v86, v86, v182
v_mul_f32 v87, v87, v183
s_add_u32 m0, s39, 5120
s_add_u32 s37, s37, s38
buffer_load_dwordx4 v23, s[8:11], s37 offen sc1 lds
v_exp_f32 v84, v84
v_exp_f32 v85, v85
v_exp_f32 v86, v86
s_add_u32 m0, s39, 6144
s_add_u32 s37, s37, s38
buffer_load_dwordx4 v22, s[8:11], s37 offen sc1 lds
v_exp_f32 v87, v87
v_mul_f32 v244, v180, v244
v_mul_f32 v245, v181, v245
v_mul_f32 v246, v182, v246
s_add_u32 m0, s39, 7168
s_add_u32 s37, s37, s38
buffer_load_dwordx4 v23, s[8:11], s37 offen sc1 lds
v_mul_f32 v247, v183, v247
v_fma_f32 v84, v84, v45, v45
v_fma_f32 v85, v85, v45, v45
s_add_u32 m0, s39, 8192
s_add_u32 s37, s37, s38
buffer_load_dwordx4 v22, s[8:11], s37 offen sc1 lds
v_fma_f32 v86, v86, v45, v45
v_fma_f32 v87, v87, v45, v45
v_rcp_f32 v84, v84
s_add_u32 m0, s39, 9216
s_add_u32 s37, s37, s38
buffer_load_dwordx4 v23, s[8:11], s37 offen sc1 lds
v_rcp_f32 v85, v85
v_rcp_f32 v86, v86
v_rcp_f32 v87, v87
v_mul_f32 v244, v244, v84
s_add_u32 m0, s39, 10240
s_add_u32 s37, s37, s38
buffer_load_dwordx4 v22, s[8:11], s37 offen sc1 lds
v_mul_f32 v245, v245, v85
v_mul_f32 v246, v246, v86
v_mul_f32 v247, v247, v87
s_add_u32 m0, s39, 11264
s_add_u32 s37, s37, s38
buffer_load_dwordx4 v23, s[8:11], s37 offen sc1 lds
v_cvt_pk_bf16_f32 v102, v244, v245
v_cvt_pk_bf16_f32 v103, v246, v247
s_add_u32 m0, s39, 12288
s_add_u32 s37, s37, s38
buffer_load_dwordx4 v22, s[8:11], s37 offen sc1 lds
v_fma_f32 v168, -v34, v56, v168
v_fma_f32 v169, -v34, v57, v169
v_fma_f32 v170, -v34, v58, v170
v_fma_f32 v171, -v34, v59, v171
s_add_u32 m0, s39, 13312
s_add_u32 s37, s37, s38
buffer_load_dwordx4 v23, s[8:11], s37 offen sc1 lds
v_fma_f32 v232, -v34, v72, v232
v_fma_f32 v233, -v34, v73, v233
v_fma_f32 v234, -v34, v74, v234
s_add_u32 m0, s39, 14336
s_add_u32 s37, s37, s38
buffer_load_dwordx4 v22, s[8:11], s37 offen sc1 lds
v_fma_f32 v235, -v34, v75, v235
v_mul_f32 v80, v168, v168
v_mul_f32 v81, v169, v169
s_add_u32 m0, s39, 15360
s_add_u32 s37, s37, s38
buffer_load_dwordx4 v23, s[8:11], s37 offen sc1 lds
v_mul_f32 v82, v170, v170
v_mul_f32 v83, v171, v171
v_fma_f32 v80, v80, v42, v38
buffer_store_dwordx4 v[100:103], v27, s[24:27], s53 offen offset:256 sc1
s_waitcnt vmcnt(18)
s_barrier
s_add_u32 s42, s42, 1
s_and_b32 s42, s42, 15
s_add_u32 m0, s39, 49152
s_mul_i32 s37, s42, s40
buffer_load_dwordx4 v22, s[8:11], s37 offen sc1 lds
v_fma_f32 v81, v81, v42, v38
v_fma_f32 v82, v82, v42, v38
v_fma_f32 v83, v83, v42, v38
v_mul_f32 v80, v80, v168
s_add_u32 m0, s39, 50176
s_add_u32 s37, s37, s38
buffer_load_dwordx4 v23, s[8:11], s37 offen sc1 lds
v_mul_f32 v81, v81, v169
v_mul_f32 v82, v82, v170
v_mul_f32 v83, v83, v171
s_add_u32 m0, s39, 51200
s_add_u32 s37, s37, s38
buffer_load_dwordx4 v22, s[8:11], s37 offen sc1 lds
v_exp_f32 v80, v80
v_exp_f32 v81, v81
v_exp_f32 v82, v82
s_add_u32 m0, s39, 52224
s_add_u32 s37, s37, s38
buffer_load_dwordx4 v23, s[8:11], s37 offen sc1 lds
v_exp_f32 v83, v83
v_mul_f32 v232, v168, v232
v_mul_f32 v233, v169, v233
s_add_u32 m0, s39, 53248
s_add_u32 s37, s37, s38
buffer_load_dwordx4 v22, s[8:11], s37 offen sc1 lds
v_mul_f32 v234, v170, v234
v_mul_f32 v235, v171, v235
v_fma_f32 v80, v80, v46, v46
v_fma_f32 v81, v81, v46, v46
s_add_u32 m0, s39, 54272
s_add_u32 s37, s37, s38
buffer_load_dwordx4 v23, s[8:11], s37 offen sc1 lds
v_fma_f32 v82, v82, v46, v46
v_fma_f32 v83, v83, v46, v46
v_rcp_f32 v80, v80
s_add_u32 m0, s39, 55296
s_add_u32 s37, s37, s38
buffer_load_dwordx4 v22, s[8:11], s37 offen sc1 lds
v_rcp_f32 v81, v81
v_rcp_f32 v82, v82
v_rcp_f32 v83, v83
s_add_u32 m0, s39, 56320
s_add_u32 s37, s37, s38
buffer_load_dwordx4 v23, s[8:11], s37 offen sc1 lds
v_mul_f32 v232, v232, v80
v_mul_f32 v233, v233, v81
v_mul_f32 v234, v234, v82
s_add_u32 m0, s39, 57344
s_add_u32 s37, s37, s38
buffer_load_dwordx4 v22, s[8:11], s37 offen sc1 lds
v_mul_f32 v235, v235, v83
v_cvt_pk_bf16_f32 v104, v232, v233
v_cvt_pk_bf16_f32 v105, v234, v235
v_fma_f32 v184, -v34, v60, v184
s_add_u32 m0, s39, 58368
s_add_u32 s37, s37, s38
buffer_load_dwordx4 v23, s[8:11], s37 offen sc1 lds
v_fma_f32 v185, -v34, v61, v185
v_fma_f32 v186, -v34, v62, v186
v_fma_f32 v187, -v34, v63, v187
s_add_u32 m0, s39, 59392
s_add_u32 s37, s37, s38
buffer_load_dwordx4 v22, s[8:11], s37 offen sc1 lds
v_fma_f32 v248, -v34, v76, v248
v_fma_f32 v249, -v34, v77, v249
v_fma_f32 v250, -v34, v78, v250
s_add_u32 m0, s39, 60416
s_add_u32 s37, s37, s38
buffer_load_dwordx4 v23, s[8:11], s37 offen sc1 lds
v_fma_f32 v251, -v34, v79, v251
v_mul_f32 v84, v184, v184
v_mul_f32 v85, v185, v185
s_add_u32 m0, s39, 61440
s_add_u32 s37, s37, s38
buffer_load_dwordx4 v22, s[8:11], s37 offen sc1 lds
v_mul_f32 v86, v186, v186
v_mul_f32 v87, v187, v187
v_fma_f32 v84, v84, v42, v38
v_fma_f32 v85, v85, v42, v38
s_add_u32 m0, s39, 62464
s_add_u32 s37, s37, s38
buffer_load_dwordx4 v23, s[8:11], s37 offen sc1 lds
v_fma_f32 v86, v86, v42, v38
v_fma_f32 v87, v87, v42, v38
v_mul_f32 v84, v84, v184
s_add_u32 m0, s39, 63488
s_add_u32 s37, s37, s38
buffer_load_dwordx4 v22, s[8:11], s37 offen sc1 lds
v_mul_f32 v85, v85, v185
v_mul_f32 v86, v86, v186
v_mul_f32 v87, v87, v187
s_add_u32 m0, s39, 64512
s_add_u32 s37, s37, s38
buffer_load_dwordx4 v23, s[8:11], s37 offen sc1 lds
v_exp_f32 v84, v84
v_exp_f32 v85, v85
v_exp_f32 v86, v86
s_waitcnt vmcnt(17)
s_barrier
s_add_u32 s42, s42, 1
s_and_b32 s42, s42, 15
s_add_u32 m0, s39, 98304
s_mul_i32 s37, s42, s40
buffer_load_dwordx4 v22, s[8:11], s37 offen sc1 lds
v_exp_f32 v87, v87
v_mul_f32 v248, v184, v248
v_mul_f32 v249, v185, v249
v_mul_f32 v250, v186, v250
s_add_u32 m0, s39, 99328
s_add_u32 s37, s37, s38
buffer_load_dwordx4 v23, s[8:11], s37 offen sc1 lds
v_mul_f32 v251, v187, v251
v_fma_f32 v84, v84, v46, v46
v_fma_f32 v85, v85, v46, v46
s_add_u32 m0, s39, 100352
s_add_u32 s37, s37, s38
buffer_load_dwordx4 v22, s[8:11], s37 offen sc1 lds
v_fma_f32 v86, v86, v46, v46
v_fma_f32 v87, v87, v46, v46
v_rcp_f32 v84, v84
s_add_u32 m0, s39, 101376
s_add_u32 s37, s37, s38
buffer_load_dwordx4 v23, s[8:11], s37 offen sc1 lds
v_rcp_f32 v85, v85
v_rcp_f32 v86, v86
v_rcp_f32 v87, v87
s_add_u32 m0, s39, 102400
s_add_u32 s37, s37, s38
buffer_load_dwordx4 v22, s[8:11], s37 offen sc1 lds
v_mul_f32 v248, v248, v84
v_mul_f32 v249, v249, v85
v_mul_f32 v250, v250, v86
v_mul_f32 v251, v251, v87
s_add_u32 m0, s39, 103424
s_add_u32 s37, s37, s38
buffer_load_dwordx4 v23, s[8:11], s37 offen sc1 lds
v_cvt_pk_bf16_f32 v106, v248, v249
v_cvt_pk_bf16_f32 v107, v250, v251
s_add_u32 m0, s39, 104448
s_add_u32 s37, s37, s38
buffer_load_dwordx4 v22, s[8:11], s37 offen sc1 lds
v_fma_f32 v172, -v35, v56, v172
v_fma_f32 v173, -v35, v57, v173
v_fma_f32 v174, -v35, v58, v174
s_add_u32 m0, s39, 105472
s_add_u32 s37, s37, s38
buffer_load_dwordx4 v23, s[8:11], s37 offen sc1 lds
v_fma_f32 v175, -v35, v59, v175
v_fma_f32 v236, -v35, v72, v236
v_fma_f32 v237, -v35, v73, v237
s_add_u32 m0, s39, 106496
s_add_u32 s37, s37, s38
buffer_load_dwordx4 v22, s[8:11], s37 offen sc1 lds
v_fma_f32 v238, -v35, v74, v238
v_fma_f32 v239, -v35, v75, v239
v_mul_f32 v80, v172, v172
v_mul_f32 v81, v173, v173
s_add_u32 m0, s39, 107520
s_add_u32 s37, s37, s38
buffer_load_dwordx4 v23, s[8:11], s37 offen sc1 lds
v_mul_f32 v82, v174, v174
v_mul_f32 v83, v175, v175
v_fma_f32 v80, v80, v43, v39
s_add_u32 m0, s39, 108544
s_add_u32 s37, s37, s38
buffer_load_dwordx4 v22, s[8:11], s37 offen sc1 lds
v_fma_f32 v81, v81, v43, v39
v_fma_f32 v82, v82, v43, v39
v_fma_f32 v83, v83, v43, v39
s_add_u32 m0, s39, 109568
s_add_u32 s37, s37, s38
buffer_load_dwordx4 v23, s[8:11], s37 offen sc1 lds
v_mul_f32 v80, v80, v172
v_mul_f32 v81, v81, v173
v_mul_f32 v82, v82, v174
s_add_u32 m0, s39, 110592
s_add_u32 s37, s37, s38
buffer_load_dwordx4 v22, s[8:11], s37 offen sc1 lds
v_mul_f32 v83, v83, v175
v_exp_f32 v80, v80
v_exp_f32 v81, v81
v_exp_f32 v82, v82
s_add_u32 m0, s39, 111616
s_add_u32 s37, s37, s38
buffer_load_dwordx4 v23, s[8:11], s37 offen sc1 lds
v_exp_f32 v83, v83
v_mul_f32 v236, v172, v236
v_mul_f32 v237, v173, v237
s_add_u32 m0, s39, 112640
s_add_u32 s37, s37, s38
buffer_load_dwordx4 v22, s[8:11], s37 offen sc1 lds
v_mul_f32 v238, v174, v238
v_mul_f32 v239, v175, v239
v_fma_f32 v80, v80, v47, v47
s_add_u32 m0, s39, 113664
s_add_u32 s37, s37, s38
buffer_load_dwordx4 v23, s[8:11], s37 offen sc1 lds
v_fma_f32 v81, v81, v47, v47
v_fma_f32 v82, v82, v47, v47
v_fma_f32 v83, v83, v47, v47
buffer_store_dwordx4 v[104:107], v27, s[24:27], s53 offen offset:512 sc1
s_waitcnt vmcnt(17)
s_barrier
s_add_u32 s42, s42, 1
s_and_b32 s42, s42, 15
s_add_u32 m0, s39, 0
s_mul_i32 s37, s42, s40
buffer_load_dwordx4 v22, s[8:11], s37 offen sc1 lds
v_rcp_f32 v80, v80
v_rcp_f32 v81, v81
v_rcp_f32 v82, v82
v_rcp_f32 v83, v83
s_add_u32 m0, s39, 1024
s_add_u32 s37, s37, s38
buffer_load_dwordx4 v23, s[8:11], s37 offen sc1 lds
v_mul_f32 v236, v236, v80
v_mul_f32 v237, v237, v81
v_mul_f32 v238, v238, v82
s_add_u32 m0, s39, 2048
s_add_u32 s37, s37, s38
buffer_load_dwordx4 v22, s[8:11], s37 offen sc1 lds
v_mul_f32 v239, v239, v83
v_cvt_pk_bf16_f32 v108, v236, v237
v_cvt_pk_bf16_f32 v109, v238, v239
s_add_u32 m0, s39, 3072
s_add_u32 s37, s37, s38
buffer_load_dwordx4 v23, s[8:11], s37 offen sc1 lds
v_fma_f32 v188, -v35, v60, v188
v_fma_f32 v189, -v35, v61, v189
v_fma_f32 v190, -v35, v62, v190
v_fma_f32 v191, -v35, v63, v191
s_add_u32 m0, s39, 4096
s_add_u32 s37, s37, s38
buffer_load_dwordx4 v22, s[8:11], s37 offen sc1 lds
v_fma_f32 v252, -v35, v76, v252
v_fma_f32 v253, -v35, v77, v253
v_fma_f32 v254, -v35, v78, v254
s_add_u32 m0, s39, 5120
s_add_u32 s37, s37, s38
buffer_load_dwordx4 v23, s[8:11], s37 offen sc1 lds
v_fma_f32 v255, -v35, v79, v255
v_mul_f32 v84, v188, v188
v_mul_f32 v85, v189, v189
s_add_u32 m0, s39, 6144
s_add_u32 s37, s37, s38
buffer_load_dwordx4 v22, s[8:11], s37 offen sc1 lds
v_mul_f32 v86, v190, v190
v_mul_f32 v87, v191, v191
v_fma_f32 v84, v84, v43, v39
v_fma_f32 v85, v85, v43, v39
s_add_u32 m0, s39, 7168
s_add_u32 s37, s37, s38
buffer_load_dwordx4 v23, s[8:11], s37 offen sc1 lds
v_fma_f32 v86, v86, v43, v39
v_fma_f32 v87, v87, v43, v39
v_mul_f32 v84, v84, v188
s_add_u32 m0, s39, 8192
s_add_u32 s37, s37, s38
buffer_load_dwordx4 v22, s[8:11], s37 offen sc1 lds
v_mul_f32 v85, v85, v189
v_mul_f32 v86, v86, v190
v_mul_f32 v87, v87, v191
s_add_u32 m0, s39, 9216
s_add_u32 s37, s37, s38
buffer_load_dwordx4 v23, s[8:11], s37 offen sc1 lds
v_exp_f32 v84, v84
v_exp_f32 v85, v85
v_exp_f32 v86, v86
v_exp_f32 v87, v87
s_add_u32 m0, s39, 10240
s_add_u32 s37, s37, s38
buffer_load_dwordx4 v22, s[8:11], s37 offen sc1 lds
v_mul_f32 v252, v188, v252
v_mul_f32 v253, v189, v253
v_mul_f32 v254, v190, v254
s_add_u32 m0, s39, 11264
s_add_u32 s37, s37, s38
buffer_load_dwordx4 v23, s[8:11], s37 offen sc1 lds
v_mul_f32 v255, v191, v255
v_fma_f32 v84, v84, v47, v47
v_fma_f32 v85, v85, v47, v47
s_add_u32 m0, s39, 12288
s_add_u32 s37, s37, s38
buffer_load_dwordx4 v22, s[8:11], s37 offen sc1 lds
v_fma_f32 v86, v86, v47, v47
v_fma_f32 v87, v87, v47, v47
v_rcp_f32 v84, v84
v_rcp_f32 v85, v85
s_add_u32 m0, s39, 13312
s_add_u32 s37, s37, s38
buffer_load_dwordx4 v23, s[8:11], s37 offen sc1 lds
v_rcp_f32 v86, v86
v_rcp_f32 v87, v87
v_mul_f32 v252, v252, v84
s_add_u32 m0, s39, 14336
s_add_u32 s37, s37, s38
buffer_load_dwordx4 v22, s[8:11], s37 offen sc1 lds
v_mul_f32 v253, v253, v85
v_mul_f32 v254, v254, v86
v_mul_f32 v255, v255, v87
s_add_u32 m0, s39, 15360
s_add_u32 s37, s37, s38
buffer_load_dwordx4 v23, s[8:11], s37 offen sc1 lds
v_cvt_pk_bf16_f32 v110, v252, v253
v_cvt_pk_bf16_f32 v111, v254, v255
buffer_store_dwordx4 v[108:111], v27, s[24:27], s53 offen offset:768 sc1
s_waitcnt vmcnt(18)
s_barrier
s_mul_i32 s44, s34, 917504
s_lshl_b32 s39, s51, 13
s_add_u32 s44, s44, s39
s_add_u32 s44, s44, 8388608
s_and_b32 s43, s51, 1
s_xor_b32 s43, s43, s35
s_lshl_b32 s43, s43, 7
s_mov_b32 s10, 909312
s_movk_i32 s38, 1024
s_movk_i32 s40, 9216
s_movk_i32 s37, 0x4000
s_cmp_ge_u32 s51, 2
s_cselect_b32 s8, s60, s32
s_cselect_b32 s9, s61, s33
s_cselect_b32 s10, 7338112, s10
s_cselect_b32 s43, s43, s44
s_cselect_b32 s38, 16384, s38
s_cselect_b32 s40, 81920, s40
s_cselect_b32 s55, 81920, s38
s_cselect_b32 s37, 262144, s37
s_cselect_b32 s45, -1, 0
s_add_u32 s8, s8, s43
s_addc_u32 s9, s9, 0
s_mov_b32 s11, 0x20000
s_and_b32 s53, s35, 1
s_mul_i32 s54, s53, 6
s_mul_i32 s54, s54, s37
s_mul_i32 s29, s53, 2
s_add_u32 s29, s29, 6
s_mul_i32 s29, s29, s37
s_and_b32 s43, s45, 4290838528
s_add_u32 s29, s29, s43
s_mul_i32 s37, s37, 0
s_sub_u32 s37, s37, s40
v_lshrrev_b32 v19, 3, v1
v_mul_u32_u24 v19, 1920, v19
v_lshrrev_b32 v20, 4, v1
v_lshlrev_b32 v20, 5, v20
v_and_b32 v19, s45, v19
v_and_b32 v20, s45, v20
v_lshlrev_b32 v21, 4, v1
v_xor_b32 v21, v21, v20
v_add_u32 v21, v21, v19
s_mov_b64 s[72:73], -1
s_add_u32 m0, s39, 65536
s_add_u32 s37, s37, s40
buffer_load_dwordx4 v21, s[8:11], s37 offen sc1 lds
v_lshlrev_b32 v128, 16, v192
v_and_b32 v129, 0xffff0000, v192
v_lshlrev_b32 v130, 16, v193
v_and_b32 v131, 0xffff0000, v193
s_add_u32 m0, s39, 66560
s_add_u32 s37, s37, s38
buffer_load_dwordx4 v21, s[8:11], s37 offen sc1 lds
v_lshlrev_b32 v132, 16, v194
v_and_b32 v133, 0xffff0000, v194
v_lshlrev_b32 v134, 16, v195
v_and_b32 v135, 0xffff0000, v195
s_add_u32 m0, s39, 67584
s_add_u32 s37, s37, s38
buffer_load_dwordx4 v21, s[8:11], s37 offen sc1 lds
v_lshlrev_b32 v136, 16, v196
v_and_b32 v137, 0xffff0000, v196
v_lshlrev_b32 v138, 16, v197
v_and_b32 v139, 0xffff0000, v197
s_add_u32 m0, s39, 68608
s_add_u32 s37, s37, s38
buffer_load_dwordx4 v21, s[8:11], s37 offen sc1 lds
v_lshlrev_b32 v140, 16, v198
v_and_b32 v141, 0xffff0000, v198
v_lshlrev_b32 v142, 16, v199
v_and_b32 v143, 0xffff0000, v199
s_add_u32 m0, s39, 69632
s_add_u32 s37, s37, s55
buffer_load_dwordx4 v21, s[8:11], s37 offen sc1 lds
v_lshlrev_b32 v144, 16, v200
v_and_b32 v145, 0xffff0000, v200
v_lshlrev_b32 v146, 16, v201
v_and_b32 v147, 0xffff0000, v201
s_add_u32 m0, s39, 70656
s_add_u32 s37, s37, s38
buffer_load_dwordx4 v21, s[8:11], s37 offen sc1 lds
v_lshlrev_b32 v148, 16, v202
v_and_b32 v149, 0xffff0000, v202
v_lshlrev_b32 v150, 16, v203
v_and_b32 v151, 0xffff0000, v203
s_add_u32 m0, s39, 71680
s_add_u32 s37, s37, s38
buffer_load_dwordx4 v21, s[8:11], s37 offen sc1 lds
v_lshlrev_b32 v152, 16, v204
v_and_b32 v153, 0xffff0000, v204
v_lshlrev_b32 v154, 16, v205
v_and_b32 v155, 0xffff0000, v205
s_add_u32 m0, s39, 72704
s_add_u32 s37, s37, s38
buffer_load_dwordx4 v21, s[8:11], s37 offen sc1 lds
v_lshlrev_b32 v156, 16, v206
v_and_b32 v157, 0xffff0000, v206
v_lshlrev_b32 v158, 16, v207
v_and_b32 v159, 0xffff0000, v207
s_waitcnt vmcnt(8)
s_barrier
s_add_u32 m0, s39, 98304
s_add_u32 s37, s37, s40
buffer_load_dwordx4 v21, s[8:11], s37 offen sc1 lds
v_mov_b32 v192, 0
v_mov_b32 v193, 0
v_mov_b32 v194, 0
v_mov_b32 v195, 0
s_add_u32 m0, s39, 99328
s_add_u32 s37, s37, s38
buffer_load_dwordx4 v21, s[8:11], s37 offen sc1 lds
v_mov_b32 v196, 0
v_mov_b32 v197, 0
v_mov_b32 v198, 0
v_mov_b32 v199, 0
s_add_u32 m0, s39, 100352
s_add_u32 s37, s37, s38
buffer_load_dwordx4 v21, s[8:11], s37 offen sc1 lds
v_mov_b32 v200, 0
v_mov_b32 v201, 0
v_mov_b32 v202, 0
v_mov_b32 v203, 0
s_add_u32 m0, s39, 101376
s_add_u32 s37, s37, s38
buffer_load_dwordx4 v21, s[8:11], s37 offen sc1 lds
v_mov_b32 v204, 0
v_mov_b32 v205, 0
v_mov_b32 v206, 0
v_mov_b32 v207, 0
s_add_u32 m0, s39, 102400
s_add_u32 s37, s37, s55
buffer_load_dwordx4 v21, s[8:11], s37 offen sc1 lds
v_mov_b32 v208, 0
v_mov_b32 v209, 0
v_mov_b32 v210, 0
v_mov_b32 v211, 0
s_add_u32 m0, s39, 103424
s_add_u32 s37, s37, s38
buffer_load_dwordx4 v21, s[8:11], s37 offen sc1 lds
v_mov_b32 v212, 0
v_mov_b32 v213, 0
v_mov_b32 v214, 0
v_mov_b32 v215, 0
s_add_u32 m0, s39, 104448
s_add_u32 s37, s37, s38
buffer_load_dwordx4 v21, s[8:11], s37 offen sc1 lds
v_mov_b32 v216, 0
v_mov_b32 v217, 0
v_mov_b32 v218, 0
v_mov_b32 v219, 0
s_add_u32 m0, s39, 105472
s_add_u32 s37, s37, s38
buffer_load_dwordx4 v21, s[8:11], s37 offen sc1 lds
v_mov_b32 v220, 0
v_mov_b32 v221, 0
v_mov_b32 v222, 0
v_mov_b32 v223, 0
s_waitcnt vmcnt(8)
s_barrier
s_branch LK4_73
.p2align 6
Lw_100:
s_branch Lr_101
s_nop 0
.p2align 3
L3h_72:
v_mfma_f32_16x16x32_bf16 v[128:131], v[96:99], v[80:83], v[128:131]
s_lshl_b32 s43, s46, 9
v_mfma_f32_16x16x32_bf16 v[132:135], v[96:99], v[84:87], v[132:135]
s_add_u32 s43, s43, 147456
v_mfma_f32_16x16x32_bf16 v[136:139], v[96:99], v[88:91], v[136:139]
v_lshl_add_u32 v19, v17, 3, s43
v_mfma_f32_16x16x32_bf16 v[140:143], v[96:99], v[92:95], v[140:143]
ds_read_b64 v[2:3], v19 offset:0
v_mfma_f32_16x16x32_bf16 v[204:207], v[112:115], v[92:95], v[204:207]
ds_read_b64 v[4:5], v19 offset:128
v_mfma_f32_16x16x32_bf16 v[200:203], v[112:115], v[88:91], v[200:203]
ds_read_b64 v[6:7], v19 offset:256
v_mfma_f32_16x16x32_bf16 v[196:199], v[112:115], v[84:87], v[196:199]
ds_read_b64 v[8:9], v19 offset:384
v_mfma_f32_16x16x32_bf16 v[192:195], v[112:115], v[80:83], v[192:195]
s_mul_i32 s43, s47, 256
v_mfma_f32_16x16x32_bf16 v[144:147], v[100:103], v[80:83], v[144:147]
s_add_u32 s43, s43, 148480
v_mfma_f32_16x16x32_bf16 v[148:151], v[100:103], v[84:87], v[148:151]
v_lshl_add_u32 v19, v18, 4, s43
v_mfma_f32_16x16x32_bf16 v[152:155], v[100:103], v[88:91], v[152:155]
ds_read_b128 v[48:51], v19 offset:0
v_mfma_f32_16x16x32_bf16 v[156:159], v[100:103], v[92:95], v[156:159]
ds_read_b128 v[52:55], v19 offset:64
v_mfma_f32_16x16x32_bf16 v[220:223], v[116:119], v[92:95], v[220:223]
ds_read_b128 v[56:59], v19 offset:128
v_mfma_f32_16x16x32_bf16 v[216:219], v[116:119], v[88:91], v[216:219]
ds_read_b128 v[60:63], v19 offset:192
v_mfma_f32_16x16x32_bf16 v[212:215], v[116:119], v[84:87], v[212:215]
ds_read_b128 v[64:67], v19 offset:896
v_mfma_f32_16x16x32_bf16 v[208:211], v[116:119], v[80:83], v[208:211]
ds_read_b128 v[68:71], v19 offset:960
v_mfma_f32_16x16x32_bf16 v[160:163], v[104:107], v[80:83], v[160:163]
ds_read_b128 v[72:75], v19 offset:1024
v_mfma_f32_16x16x32_bf16 v[164:167], v[104:107], v[84:87], v[164:167]
ds_read_b128 v[76:79], v19 offset:1088
v_mfma_f32_16x16x32_bf16 v[168:171], v[104:107], v[88:91], v[168:171]
v_mfma_f32_16x16x32_bf16 v[172:175], v[104:107], v[92:95], v[172:175]
v_mfma_f32_16x16x32_bf16 v[236:239], v[120:123], v[92:95], v[236:239]
v_mfma_f32_16x16x32_bf16 v[232:235], v[120:123], v[88:91], v[232:235]
v_mfma_f32_16x16x32_bf16 v[228:231], v[120:123], v[84:87], v[228:231]
v_mfma_f32_16x16x32_bf16 v[224:227], v[120:123], v[80:83], v[224:227]
v_mfma_f32_16x16x32_bf16 v[176:179], v[108:111], v[80:83], v[176:179]
v_mfma_f32_16x16x32_bf16 v[180:183], v[108:111], v[84:87], v[180:183]
v_mfma_f32_16x16x32_bf16 v[184:187], v[108:111], v[88:91], v[184:187]
v_mfma_f32_16x16x32_bf16 v[188:191], v[108:111], v[92:95], v[188:191]
v_mfma_f32_16x16x32_bf16 v[252:255], v[124:127], v[92:95], v[252:255]
v_mfma_f32_16x16x32_bf16 v[248:251], v[124:127], v[88:91], v[248:251]
v_mfma_f32_16x16x32_bf16 v[244:247], v[124:127], v[84:87], v[244:247]
v_mfma_f32_16x16x32_bf16 v[240:243], v[124:127], v[80:83], v[240:243]
s_setprio 0
s_waitcnt lgkmcnt(0)
v_mov_b32 v32, v2
v_mul_f32 v88, v3, v3
v_mul_f32 v36, 0xc0135761, v3
v_mul_f32 v89, 0xbdd2d3e8, v3
v_rcp_f32 v44, v88
v_mul_f32 v40, v89, v88
v_mov_b32 v33, v4
v_mul_f32 v88, v5, v5
v_mul_f32 v37, 0xc0135761, v5
v_mul_f32 v89, 0xbdd2d3e8, v5
v_rcp_f32 v45, v88
v_mul_f32 v41, v89, v88
v_mov_b32 v34, v6
v_mul_f32 v88, v7, v7
v_mul_f32 v38, 0xc0135761, v7
v_mul_f32 v89, 0xbdd2d3e8, v7
v_rcp_f32 v46, v88
v_mul_f32 v42, v89, v88
v_mov_b32 v35, v8
v_mul_f32 v88, v9, v9
v_mul_f32 v39, 0xc0135761, v9
v_mul_f32 v89, 0xbdd2d3e8, v9
v_rcp_f32 v47, v88
v_mul_f32 v43, v89, v88
s_barrier
v_fma_f32 v128, -v32, v48, v128
v_fma_f32 v129, -v32, v49, v129
v_fma_f32 v130, -v32, v50, v130
v_fma_f32 v131, -v32, v51, v131
v_fma_f32 v192, -v32, v64, v192
v_fma_f32 v193, -v32, v65, v193
v_fma_f32 v194, -v32, v66, v194
v_fma_f32 v195, -v32, v67, v195
v_mul_f32 v80, v128, v128
v_mul_f32 v81, v129, v129
v_mul_f32 v82, v130, v130
v_mul_f32 v83, v131, v131
v_fma_f32 v80, v80, v40, v36
v_fma_f32 v81, v81, v40, v36
v_fma_f32 v82, v82, v40, v36
v_fma_f32 v83, v83, v40, v36
v_mul_f32 v80, v80, v128
v_mul_f32 v81, v81, v129
v_mul_f32 v82, v82, v130
v_mul_f32 v83, v83, v131
v_exp_f32 v80, v80
v_exp_f32 v81, v81
v_exp_f32 v82, v82
v_exp_f32 v83, v83
v_mul_f32 v192, v128, v192
v_mul_f32 v193, v129, v193
v_mul_f32 v194, v130, v194
v_mul_f32 v195, v131, v195
v_fma_f32 v80, v80, v44, v44
v_fma_f32 v81, v81, v44, v44
v_fma_f32 v82, v82, v44, v44
v_fma_f32 v83, v83, v44, v44
v_rcp_f32 v80, v80
v_rcp_f32 v81, v81
v_rcp_f32 v82, v82
v_rcp_f32 v83, v83
v_mul_f32 v192, v192, v80
v_mul_f32 v193, v193, v81
v_mul_f32 v194, v194, v82
v_mul_f32 v195, v195, v83
v_cvt_pk_bf16_f32 v96, v192, v193
v_cvt_pk_bf16_f32 v97, v194, v195
v_fma_f32 v144, -v32, v52, v144
v_fma_f32 v145, -v32, v53, v145
v_fma_f32 v146, -v32, v54, v146
v_fma_f32 v147, -v32, v55, v147
v_fma_f32 v208, -v32, v68, v208
v_fma_f32 v209, -v32, v69, v209
v_fma_f32 v210, -v32, v70, v210
v_fma_f32 v211, -v32, v71, v211
v_mul_f32 v84, v144, v144
v_mul_f32 v85, v145, v145
s_barrier
v_mul_f32 v86, v146, v146
v_mul_f32 v87, v147, v147
v_fma_f32 v84, v84, v40, v36
v_fma_f32 v85, v85, v40, v36
v_fma_f32 v86, v86, v40, v36
v_fma_f32 v87, v87, v40, v36
v_mul_f32 v84, v84, v144
v_mul_f32 v85, v85, v145
v_mul_f32 v86, v86, v146
v_mul_f32 v87, v87, v147
v_exp_f32 v84, v84
v_exp_f32 v85, v85
v_exp_f32 v86, v86
v_exp_f32 v87, v87
v_mul_f32 v208, v144, v208
v_mul_f32 v209, v145, v209
v_mul_f32 v210, v146, v210
v_mul_f32 v211, v147, v211
v_fma_f32 v84, v84, v44, v44
v_fma_f32 v85, v85, v44, v44
v_fma_f32 v86, v86, v44, v44
v_fma_f32 v87, v87, v44, v44
v_rcp_f32 v84, v84
v_rcp_f32 v85, v85
v_rcp_f32 v86, v86
v_rcp_f32 v87, v87
v_mul_f32 v208, v208, v84
v_mul_f32 v209, v209, v85
v_mul_f32 v210, v210, v86
v_mul_f32 v211, v211, v87
v_cvt_pk_bf16_f32 v98, v208, v209
v_cvt_pk_bf16_f32 v99, v210, v211
buffer_store_dwordx4 v[96:99], v27, s[24:27], 0 offen offset:0 sc1
v_fma_f32 v132, -v33, v48, v132
v_fma_f32 v133, -v33, v49, v133
v_fma_f32 v134, -v33, v50, v134
v_fma_f32 v135, -v33, v51, v135
v_fma_f32 v196, -v33, v64, v196
v_fma_f32 v197, -v33, v65, v197
v_fma_f32 v198, -v33, v66, v198
v_fma_f32 v199, -v33, v67, v199
v_mul_f32 v80, v132, v132
v_mul_f32 v81, v133, v133
v_mul_f32 v82, v134, v134
v_mul_f32 v83, v135, v135
v_fma_f32 v80, v80, v41, v37
v_fma_f32 v81, v81, v41, v37
v_fma_f32 v82, v82, v41, v37
v_fma_f32 v83, v83, v41, v37
v_mul_f32 v80, v80, v132
v_mul_f32 v81, v81, v133
v_mul_f32 v82, v82, v134
v_lshlrev_b32 v19, 11, v18
v_lshl_add_u32 v19, v17, 4, v19
s_lshl_b32 s43, s46, 10
v_add_u32 v2, s43, v19
v_add_u32 v3, 0x10000, v2
v_lshrrev_b32 v19, 2, v17
v_lshl_add_u32 v20, v18, 2, v19
v_bfe_u32 v21, v20, 1, 2
s_lshl_b32 s43, s47, 1
v_xor_b32 v21, s43, v21
v_lshlrev_b32 v20, 7, v20
v_lshl_add_u32 v20, v21, 5, v20
v_and_b32 v19, 3, v1
v_lshl_add_u32 v20, v19, 3, v20
v_add_u32 v5, 16384, v20
v_xor_b32 v6, 32, v5
v_add_u32 v7, 0x10000, v5
v_add_u32 v8, 0x10000, v6
s_lshl_b32 s43, s36, 12
v_lshl_add_u32 v9, v1, 4, s43
s_mov_b32 s54, 0x10000
s_movk_i32 s52, 0x1000
s_barrier
s_mov_b32 s88, s4
s_mov_b32 s89, s5
s_mov_b32 s90, 7340032
s_mov_b32 s91, 0x20000
s_mov_b32 s92, s6
s_mov_b32 s93, s7
s_mov_b32 s94, 7340032
s_mov_b32 s95, 0x20000
s_lshr_b32 s43, s35, 3
v_and_b32 v19, 1, v1
v_bfe_u32 v23, v1, 2, 2
s_lshl_b32 s44, s43, 1
s_add_u32 s44, s44, 6
v_add_u32 v23, s44, v23
s_mul_i32 s44, s43, 6
s_add_u32 s44, s44, 1
v_mad_u32_u24 v23, v19, s44, v23
s_lshl_b32 s44, s43, 10
s_lshl_b32 s43, s43, 11
s_sub_u32 s43, 6528, s43
s_lshr_b32 s45, s2, 3
s_mul_i32 s45, s45, 14336
s_add_u32 s43, s43, s45
v_mul_lo_u32 v31, v19, s44
v_bfe_u32 v19, v1, 1, 1
v_mul_u32_u24 v19, 7168, v19
v_add3_u32 v31, v31, v19, s43
v_add_u32 v19, 8, v23
v_and_b32 v19, 15, v19
v_mul_u32_u24 v19, 458752, v19
v_add_u32 v19, v19, v31
buffer_load_dword v30, v19, s[88:91], 0 offen
buffer_load_dword v30, v19, s[92:95], 0 offen
v_mul_f32 v83, v83, v135
v_exp_f32 v80, v80
v_exp_f32 v81, v81
v_exp_f32 v82, v82
v_exp_f32 v83, v83
v_mul_f32 v196, v132, v196
v_mul_f32 v197, v133, v197
v_mul_f32 v198, v134, v198
v_mul_f32 v199, v135, v199
v_fma_f32 v80, v80, v45, v45
v_fma_f32 v81, v81, v45, v45
v_fma_f32 v82, v82, v45, v45
v_fma_f32 v83, v83, v45, v45
v_rcp_f32 v80, v80
v_rcp_f32 v81, v81
v_rcp_f32 v82, v82
v_rcp_f32 v83, v83
v_mul_f32 v196, v196, v80
v_mul_f32 v197, v197, v81
v_mul_f32 v198, v198, v82
v_mul_f32 v199, v199, v83
v_cvt_pk_bf16_f32 v100, v196, v197
v_cvt_pk_bf16_f32 v101, v198, v199
v_fma_f32 v148, -v33, v52, v148
v_fma_f32 v149, -v33, v53, v149
v_fma_f32 v150, -v33, v54, v150
v_fma_f32 v151, -v33, v55, v151
v_fma_f32 v212, -v33, v68, v212
v_fma_f32 v213, -v33, v69, v213
v_fma_f32 v214, -v33, v70, v214
v_fma_f32 v215, -v33, v71, v215
v_mul_f32 v84, v148, v148
v_mul_f32 v85, v149, v149
v_mul_f32 v86, v150, v150
v_mul_f32 v87, v151, v151
v_fma_f32 v84, v84, v41, v37
v_fma_f32 v85, v85, v41, v37
v_fma_f32 v86, v86, v41, v37
v_fma_f32 v87, v87, v41, v37
v_mul_f32 v84, v84, v148
v_mul_f32 v85, v85, v149
v_mul_f32 v86, v86, v150
v_mul_f32 v87, v87, v151
v_exp_f32 v84, v84
v_exp_f32 v85, v85
v_exp_f32 v86, v86
v_exp_f32 v87, v87
v_mul_f32 v212, v148, v212
v_mul_f32 v213, v149, v213
v_mul_f32 v214, v150, v214
v_mul_f32 v215, v151, v215
v_fma_f32 v84, v84, v45, v45
s_barrier
v_fma_f32 v85, v85, v45, v45
v_fma_f32 v86, v86, v45, v45
v_fma_f32 v87, v87, v45, v45
v_rcp_f32 v84, v84
v_rcp_f32 v85, v85
v_rcp_f32 v86, v86
v_rcp_f32 v87, v87
v_mul_f32 v212, v212, v84
v_mul_f32 v213, v213, v85
v_mul_f32 v214, v214, v86
v_mul_f32 v215, v215, v87
v_cvt_pk_bf16_f32 v102, v212, v213
v_cvt_pk_bf16_f32 v103, v214, v215
buffer_store_dwordx4 v[100:103], v27, s[24:27], 0 offen offset:256 sc1
v_fma_f32 v136, -v34, v48, v136
v_fma_f32 v137, -v34, v49, v137
v_fma_f32 v138, -v34, v50, v138
v_fma_f32 v139, -v34, v51, v139
v_fma_f32 v200, -v34, v64, v200
v_fma_f32 v201, -v34, v65, v201
v_fma_f32 v202, -v34, v66, v202
v_fma_f32 v203, -v34, v67, v203
v_mul_f32 v80, v136, v136
v_mul_f32 v81, v137, v137
v_mul_f32 v82, v138, v138
v_mul_f32 v83, v139, v139
v_fma_f32 v80, v80, v42, v38
v_fma_f32 v81, v81, v42, v38
v_fma_f32 v82, v82, v42, v38
v_fma_f32 v83, v83, v42, v38
v_mul_f32 v80, v80, v136
v_mul_f32 v81, v81, v137
v_mul_f32 v82, v82, v138
v_mul_f32 v83, v83, v139
v_exp_f32 v80, v80
v_exp_f32 v81, v81
v_exp_f32 v82, v82
v_exp_f32 v83, v83
v_mul_f32 v200, v136, v200
v_mul_f32 v201, v137, v201
v_mul_f32 v202, v138, v202
v_mul_f32 v203, v139, v203
v_fma_f32 v80, v80, v46, v46
v_fma_f32 v81, v81, v46, v46
v_fma_f32 v82, v82, v46, v46
v_fma_f32 v83, v83, v46, v46
v_rcp_f32 v80, v80
v_rcp_f32 v81, v81
v_rcp_f32 v82, v82
v_rcp_f32 v83, v83
v_mul_f32 v200, v200, v80
v_mul_f32 v201, v201, v81
v_mul_f32 v202, v202, v82
s_barrier
v_mul_f32 v203, v203, v83
v_cvt_pk_bf16_f32 v104, v200, v201
v_cvt_pk_bf16_f32 v105, v202, v203
v_fma_f32 v152, -v34, v52, v152
v_fma_f32 v153, -v34, v53, v153
v_fma_f32 v154, -v34, v54, v154
v_fma_f32 v155, -v34, v55, v155
v_fma_f32 v216, -v34, v68, v216
v_fma_f32 v217, -v34, v69, v217
v_fma_f32 v218, -v34, v70, v218
v_fma_f32 v219, -v34, v71, v219
v_mul_f32 v84, v152, v152
v_mul_f32 v85, v153, v153
v_mul_f32 v86, v154, v154
v_mul_f32 v87, v155, v155
v_fma_f32 v84, v84, v42, v38
v_fma_f32 v85, v85, v42, v38
v_fma_f32 v86, v86, v42, v38
v_fma_f32 v87, v87, v42, v38
v_mul_f32 v84, v84, v152
v_mul_f32 v85, v85, v153
v_mul_f32 v86, v86, v154
v_mul_f32 v87, v87, v155
v_exp_f32 v84, v84
v_exp_f32 v85, v85
v_exp_f32 v86, v86
v_exp_f32 v87, v87
v_mul_f32 v216, v152, v216
v_mul_f32 v217, v153, v217
v_mul_f32 v218, v154, v218
v_mul_f32 v219, v155, v219
v_fma_f32 v84, v84, v46, v46
v_fma_f32 v85, v85, v46, v46
v_fma_f32 v86, v86, v46, v46
v_fma_f32 v87, v87, v46, v46
v_rcp_f32 v84, v84
v_rcp_f32 v85, v85
v_rcp_f32 v86, v86
v_rcp_f32 v87, v87
v_mul_f32 v216, v216, v84
v_mul_f32 v217, v217, v85
v_mul_f32 v218, v218, v86
v_mul_f32 v219, v219, v87
v_cvt_pk_bf16_f32 v106, v216, v217
v_cvt_pk_bf16_f32 v107, v218, v219
buffer_store_dwordx4 v[104:107], v27, s[24:27], 0 offen offset:512 sc1
v_fma_f32 v140, -v35, v48, v140
v_fma_f32 v141, -v35, v49, v141
v_fma_f32 v142, -v35, v50, v142
v_fma_f32 v143, -v35, v51, v143
v_fma_f32 v204, -v35, v64, v204
v_fma_f32 v205, -v35, v65, v205
s_barrier
v_fma_f32 v206, -v35, v66, v206
v_fma_f32 v207, -v35, v67, v207
v_mul_f32 v80, v140, v140
v_mul_f32 v81, v141, v141
v_mul_f32 v82, v142, v142
v_mul_f32 v83, v143, v143
v_fma_f32 v80, v80, v43, v39
v_fma_f32 v81, v81, v43, v39
v_fma_f32 v82, v82, v43, v39
v_fma_f32 v83, v83, v43, v39
v_mul_f32 v80, v80, v140
v_mul_f32 v81, v81, v141
v_mul_f32 v82, v82, v142
v_mul_f32 v83, v83, v143
v_exp_f32 v80, v80
v_exp_f32 v81, v81
v_exp_f32 v82, v82
v_exp_f32 v83, v83
v_mul_f32 v204, v140, v204
v_mul_f32 v205, v141, v205
v_mul_f32 v206, v142, v206
v_mul_f32 v207, v143, v207
v_fma_f32 v80, v80, v47, v47
v_fma_f32 v81, v81, v47, v47
v_fma_f32 v82, v82, v47, v47
v_fma_f32 v83, v83, v47, v47
v_rcp_f32 v80, v80
v_rcp_f32 v81, v81
v_rcp_f32 v82, v82
v_rcp_f32 v83, v83
v_mul_f32 v204, v204, v80
v_mul_f32 v205, v205, v81
v_mul_f32 v206, v206, v82
v_mul_f32 v207, v207, v83
v_cvt_pk_bf16_f32 v108, v204, v205
v_cvt_pk_bf16_f32 v109, v206, v207
v_fma_f32 v156, -v35, v52, v156
v_fma_f32 v157, -v35, v53, v157
v_fma_f32 v158, -v35, v54, v158
v_fma_f32 v159, -v35, v55, v159
v_fma_f32 v220, -v35, v68, v220
v_fma_f32 v221, -v35, v69, v221
v_fma_f32 v222, -v35, v70, v222
v_fma_f32 v223, -v35, v71, v223
v_mul_f32 v84, v156, v156
v_mul_f32 v85, v157, v157
v_mul_f32 v86, v158, v158
v_mul_f32 v87, v159, v159
v_fma_f32 v84, v84, v43, v39
v_fma_f32 v85, v85, v43, v39
v_fma_f32 v86, v86, v43, v39
v_fma_f32 v87, v87, v43, v39
s_barrier
s_getpc_b64 s[78:79]
Lpc_74:
s_sub_u32 s78, s78, Lpc_74-sequential_preLN__sliding_local_dilated__glu_gated_geglu__prompt_kernel
s_subb_u32 s79, s79, 0
s_lshr_b32 s43, s2, 3
s_mul_i32 s43, s43, 3840
v_min_u32 v19, 29, v1
v_lshl_add_u32 v19, v19, 7, s43
v_min_u32 v19, Ldone_1-sequential_preLN__sliding_local_dilated__glu_gated_geglu__prompt_kernel, v19
global_load_dword v30, v19, s[78:79]
s_mov_b32 s88, s4
s_mov_b32 s89, s5
s_mov_b32 s90, 7340032
s_mov_b32 s91, 0x20000
s_mov_b32 s92, s6
s_mov_b32 s93, s7
s_mov_b32 s94, 7340032
s_mov_b32 s95, 0x20000
s_lshr_b32 s43, s35, 3
v_and_b32 v19, 1, v1
v_bfe_u32 v23, v1, 2, 2
s_lshl_b32 s44, s43, 1
s_add_u32 s44, s44, 6
v_add_u32 v23, s44, v23
s_mul_i32 s44, s43, 6
s_add_u32 s44, s44, 1
v_mad_u32_u24 v23, v19, s44, v23
s_lshl_b32 s44, s43, 10
s_lshl_b32 s43, s43, 11
s_sub_u32 s43, 6528, s43
s_lshr_b32 s45, s2, 3
s_mul_i32 s45, s45, 14336
s_add_u32 s43, s43, s45
v_mul_lo_u32 v31, v19, s44
v_bfe_u32 v19, v1, 1, 1
v_mul_u32_u24 v19, 7168, v19
v_add3_u32 v31, v31, v19, s43
v_add_u32 v19, 12, v23
v_and_b32 v19, 15, v19
v_mul_u32_u24 v19, 458752, v19
v_add_u32 v19, v19, v31
buffer_load_dword v30, v19, s[88:91], 0 offen
buffer_load_dword v30, v19, s[92:95], 0 offen
v_mul_f32 v84, v84, v156
v_mul_f32 v85, v85, v157
v_mul_f32 v86, v86, v158
v_mul_f32 v87, v87, v159
v_exp_f32 v84, v84
v_exp_f32 v85, v85
v_exp_f32 v86, v86
v_exp_f32 v87, v87
v_mul_f32 v220, v156, v220
v_mul_f32 v221, v157, v221
v_mul_f32 v222, v158, v222
v_mul_f32 v223, v159, v223
v_fma_f32 v84, v84, v47, v47
v_fma_f32 v85, v85, v47, v47
v_fma_f32 v86, v86, v47, v47
v_fma_f32 v87, v87, v47, v47
v_rcp_f32 v84, v84
v_rcp_f32 v85, v85
v_rcp_f32 v86, v86
v_rcp_f32 v87, v87
v_mul_f32 v220, v220, v84
v_mul_f32 v221, v221, v85
v_mul_f32 v222, v222, v86
v_mul_f32 v223, v223, v87
v_cvt_pk_bf16_f32 v110, v220, v221
v_cvt_pk_bf16_f32 v111, v222, v223
buffer_store_dwordx4 v[108:111], v27, s[24:27], 0 offen offset:768 sc1
v_fma_f32 v160, -v32, v56, v160
v_fma_f32 v161, -v32, v57, v161
v_fma_f32 v162, -v32, v58, v162
v_fma_f32 v163, -v32, v59, v163
v_fma_f32 v224, -v32, v72, v224
v_fma_f32 v225, -v32, v73, v225
v_fma_f32 v226, -v32, v74, v226
v_fma_f32 v227, -v32, v75, v227
v_mul_f32 v80, v160, v160
v_mul_f32 v81, v161, v161
v_mul_f32 v82, v162, v162
v_mul_f32 v83, v163, v163
v_fma_f32 v80, v80, v40, v36
v_fma_f32 v81, v81, v40, v36
v_fma_f32 v82, v82, v40, v36
v_fma_f32 v83, v83, v40, v36
v_mul_f32 v80, v80, v160
v_mul_f32 v81, v81, v161
v_mul_f32 v82, v82, v162
v_mul_f32 v83, v83, v163
v_exp_f32 v80, v80
v_exp_f32 v81, v81
v_exp_f32 v82, v82
v_exp_f32 v83, v83
v_mul_f32 v224, v160, v224
v_mul_f32 v225, v161, v225
s_barrier
v_mul_f32 v226, v162, v226
v_mul_f32 v227, v163, v227
v_fma_f32 v80, v80, v44, v44
v_fma_f32 v81, v81, v44, v44
v_fma_f32 v82, v82, v44, v44
v_fma_f32 v83, v83, v44, v44
v_rcp_f32 v80, v80
v_rcp_f32 v81, v81
v_rcp_f32 v82, v82
v_rcp_f32 v83, v83
v_mul_f32 v224, v224, v80
v_mul_f32 v225, v225, v81
v_mul_f32 v226, v226, v82
v_mul_f32 v227, v227, v83
v_cvt_pk_bf16_f32 v96, v224, v225
v_cvt_pk_bf16_f32 v97, v226, v227
v_fma_f32 v176, -v32, v60, v176
v_fma_f32 v177, -v32, v61, v177
v_fma_f32 v178, -v32, v62, v178
v_fma_f32 v179, -v32, v63, v179
v_fma_f32 v240, -v32, v76, v240
v_fma_f32 v241, -v32, v77, v241
v_fma_f32 v242, -v32, v78, v242
v_fma_f32 v243, -v32, v79, v243
v_mul_f32 v84, v176, v176
v_mul_f32 v85, v177, v177
v_mul_f32 v86, v178, v178
v_mul_f32 v87, v179, v179
v_fma_f32 v84, v84, v40, v36
v_fma_f32 v85, v85, v40, v36
v_fma_f32 v86, v86, v40, v36
v_fma_f32 v87, v87, v40, v36
v_mul_f32 v84, v84, v176
v_mul_f32 v85, v85, v177
v_mul_f32 v86, v86, v178
v_mul_f32 v87, v87, v179
v_exp_f32 v84, v84
v_exp_f32 v85, v85
v_exp_f32 v86, v86
v_exp_f32 v87, v87
v_mul_f32 v240, v176, v240
v_mul_f32 v241, v177, v241
v_mul_f32 v242, v178, v242
v_mul_f32 v243, v179, v243
v_fma_f32 v84, v84, v44, v44
v_fma_f32 v85, v85, v44, v44
v_fma_f32 v86, v86, v44, v44
v_fma_f32 v87, v87, v44, v44
v_rcp_f32 v84, v84
v_rcp_f32 v85, v85
v_rcp_f32 v86, v86
v_rcp_f32 v87, v87
v_lshlrev_b32 v19, 11, v18
v_lshl_add_u32 v19, v17, 4, v19
s_lshl_b32 s43, s46, 10
s_lshl_b32 s44, s47, 13
v_add3_u32 v208, v19, s43, 0
v_add_u32 v208, s44, v208
buffer_load_dwordx4 v[192:195], v208, s[20:23], 0 offen offset:0 sc1
buffer_load_dwordx4 v[196:199], v208, s[20:23], 0 offen offset:256 sc1
buffer_load_dwordx4 v[200:203], v208, s[20:23], 0 offen offset:512 sc1
buffer_load_dwordx4 v[204:207], v208, s[20:23], 0 offen offset:768 sc1
s_waitcnt vmcnt(4)
s_barrier
s_add_u32 s43, s34, 32
s_lshl_b32 s43, s43, 7
v_mov_b32 v21, s43
v_mov_b32 v22, 1
s_mov_b64 exec, 1
buffer_atomic_add v22, v21, s[56:59], 0 offen sc1
s_mov_b64 exec, -1
v_mul_f32 v240, v240, v84
v_mul_f32 v241, v241, v85
v_mul_f32 v242, v242, v86
v_mul_f32 v243, v243, v87
v_cvt_pk_bf16_f32 v98, v240, v241
v_cvt_pk_bf16_f32 v99, v242, v243
buffer_store_dwordx4 v[96:99], v27, s[24:27], s53 offen offset:0 sc1
v_fma_f32 v164, -v33, v56, v164
v_fma_f32 v165, -v33, v57, v165
v_fma_f32 v166, -v33, v58, v166
v_fma_f32 v167, -v33, v59, v167
v_fma_f32 v228, -v33, v72, v228
v_fma_f32 v229, -v33, v73, v229
v_fma_f32 v230, -v33, v74, v230
v_fma_f32 v231, -v33, v75, v231
v_mul_f32 v80, v164, v164
v_mul_f32 v81, v165, v165
v_mul_f32 v82, v166, v166
v_mul_f32 v83, v167, v167
v_fma_f32 v80, v80, v41, v37
v_fma_f32 v81, v81, v41, v37
v_fma_f32 v82, v82, v41, v37
v_fma_f32 v83, v83, v41, v37
v_mul_f32 v80, v80, v164
v_mul_f32 v81, v81, v165
v_mul_f32 v82, v82, v166
v_mul_f32 v83, v83, v167
v_exp_f32 v80, v80
v_exp_f32 v81, v81
v_exp_f32 v82, v82
v_exp_f32 v83, v83
v_mul_f32 v228, v164, v228
v_mul_f32 v229, v165, v229
v_mul_f32 v230, v166, v230
v_mul_f32 v231, v167, v231
v_fma_f32 v80, v80, v45, v45
v_fma_f32 v81, v81, v45, v45
v_fma_f32 v82, v82, v45, v45
v_fma_f32 v83, v83, v45, v45
v_rcp_f32 v80, v80
v_rcp_f32 v81, v81
v_rcp_f32 v82, v82
v_rcp_f32 v83, v83
v_mul_f32 v228, v228, v80
v_mul_f32 v229, v229, v81
v_mul_f32 v230, v230, v82
v_mul_f32 v231, v231, v83
v_cvt_pk_bf16_f32 v100, v228, v229
v_cvt_pk_bf16_f32 v101, v230, v231
v_fma_f32 v180, -v33, v60, v180
v_fma_f32 v181, -v33, v61, v181
v_fma_f32 v182, -v33, v62, v182
s_barrier
s_mov_b32 s80, s60
s_mov_b32 s81, s61
s_mov_b32 s82, 7340032
s_mov_b32 s83, 0x20000
v_and_b32 v29, 31, v1
v_lshlrev_b32 v29, 11, v29
s_and_b32 s43, s35, 8
s_or_b32 s43, s43, 3
s_lshl_b32 s43, s43, 7
v_add_u32 v29, s43, v29
s_lshr_b32 s44, s2, 3
s_lshl_b32 s44, s44, 17
s_add_u32 s43, s44, 0
buffer_load_dword v30, v29, s[80:83], s43 offen
v_fma_f32 v183, -v33, v63, v183
v_fma_f32 v244, -v33, v76, v244
v_fma_f32 v245, -v33, v77, v245
v_fma_f32 v246, -v33, v78, v246
v_fma_f32 v247, -v33, v79, v247
v_mul_f32 v84, v180, v180
v_mul_f32 v85, v181, v181
v_mul_f32 v86, v182, v182
v_mul_f32 v87, v183, v183
v_fma_f32 v84, v84, v41, v37
v_fma_f32 v85, v85, v41, v37
v_fma_f32 v86, v86, v41, v37
v_fma_f32 v87, v87, v41, v37
v_mul_f32 v84, v84, v180
v_mul_f32 v85, v85, v181
v_mul_f32 v86, v86, v182
v_mul_f32 v87, v87, v183
v_exp_f32 v84, v84
v_exp_f32 v85, v85
v_exp_f32 v86, v86
v_exp_f32 v87, v87
v_mul_f32 v244, v180, v244
v_mul_f32 v245, v181, v245
v_mul_f32 v246, v182, v246
v_mul_f32 v247, v183, v247
v_fma_f32 v84, v84, v45, v45
v_fma_f32 v85, v85, v45, v45
v_fma_f32 v86, v86, v45, v45
v_fma_f32 v87, v87, v45, v45
v_rcp_f32 v84, v84
v_rcp_f32 v85, v85
v_rcp_f32 v86, v86
v_rcp_f32 v87, v87
v_mul_f32 v244, v244, v84
v_mul_f32 v245, v245, v85
v_mul_f32 v246, v246, v86
v_mul_f32 v247, v247, v87
v_cvt_pk_bf16_f32 v102, v244, v245
v_cvt_pk_bf16_f32 v103, v246, v247
buffer_store_dwordx4 v[100:103], v27, s[24:27], s53 offen offset:256 sc1
v_fma_f32 v168, -v34, v56, v168
v_fma_f32 v169, -v34, v57, v169
v_fma_f32 v170, -v34, v58, v170
v_fma_f32 v171, -v34, v59, v171
v_fma_f32 v232, -v34, v72, v232
v_fma_f32 v233, -v34, v73, v233
v_fma_f32 v234, -v34, v74, v234
v_fma_f32 v235, -v34, v75, v235
v_mul_f32 v80, v168, v168
v_mul_f32 v81, v169, v169
v_mul_f32 v82, v170, v170
v_mul_f32 v83, v171, v171
v_fma_f32 v80, v80, v42, v38
s_waitcnt vmcnt(2)
s_barrier
v_fma_f32 v81, v81, v42, v38
v_fma_f32 v82, v82, v42, v38
v_fma_f32 v83, v83, v42, v38
v_mul_f32 v80, v80, v168
v_mul_f32 v81, v81, v169
v_mul_f32 v82, v82, v170
v_mul_f32 v83, v83, v171
v_exp_f32 v80, v80
v_exp_f32 v81, v81
v_exp_f32 v82, v82
v_exp_f32 v83, v83
v_mul_f32 v232, v168, v232
v_mul_f32 v233, v169, v233
v_mul_f32 v234, v170, v234
v_mul_f32 v235, v171, v235
v_fma_f32 v80, v80, v46, v46
v_fma_f32 v81, v81, v46, v46
v_fma_f32 v82, v82, v46, v46
v_fma_f32 v83, v83, v46, v46
v_rcp_f32 v80, v80
v_rcp_f32 v81, v81
v_rcp_f32 v82, v82
v_rcp_f32 v83, v83
v_mul_f32 v232, v232, v80
v_mul_f32 v233, v233, v81
v_mul_f32 v234, v234, v82
v_mul_f32 v235, v235, v83
v_cvt_pk_bf16_f32 v104, v232, v233
v_cvt_pk_bf16_f32 v105, v234, v235
v_fma_f32 v184, -v34, v60, v184
v_fma_f32 v185, -v34, v61, v185
v_fma_f32 v186, -v34, v62, v186
v_fma_f32 v187, -v34, v63, v187
v_fma_f32 v248, -v34, v76, v248
v_fma_f32 v249, -v34, v77, v249
v_fma_f32 v250, -v34, v78, v250
v_fma_f32 v251, -v34, v79, v251
v_mul_f32 v84, v184, v184
v_mul_f32 v85, v185, v185
v_mul_f32 v86, v186, v186
v_mul_f32 v87, v187, v187
v_fma_f32 v84, v84, v42, v38
v_fma_f32 v85, v85, v42, v38
v_fma_f32 v86, v86, v42, v38
v_fma_f32 v87, v87, v42, v38
v_mul_f32 v84, v84, v184
v_mul_f32 v85, v85, v185
v_mul_f32 v86, v86, v186
v_mul_f32 v87, v87, v187
v_exp_f32 v84, v84
v_exp_f32 v85, v85
v_exp_f32 v86, v86
s_barrier
s_add_u32 s43, s34, 32
s_lshl_b32 s43, s43, 7
v_mov_b32 v21, s43
v_mov_b32 v23, 16
buffer_load_dword v22, v21, s[56:59], 0 offen sc1
v_exp_f32 v87, v87
v_mul_f32 v248, v184, v248
v_mul_f32 v249, v185, v249
v_mul_f32 v250, v186, v250
v_mul_f32 v251, v187, v251
v_fma_f32 v84, v84, v46, v46
v_fma_f32 v85, v85, v46, v46
v_fma_f32 v86, v86, v46, v46
v_fma_f32 v87, v87, v46, v46
v_rcp_f32 v84, v84
v_rcp_f32 v85, v85
v_rcp_f32 v86, v86
v_rcp_f32 v87, v87
v_mul_f32 v248, v248, v84
v_mul_f32 v249, v249, v85
v_mul_f32 v250, v250, v86
v_mul_f32 v251, v251, v87
v_cvt_pk_bf16_f32 v106, v248, v249
v_cvt_pk_bf16_f32 v107, v250, v251
buffer_store_dwordx4 v[104:107], v27, s[24:27], s53 offen offset:512 sc1
v_fma_f32 v172, -v35, v56, v172
v_fma_f32 v173, -v35, v57, v173
v_fma_f32 v174, -v35, v58, v174
v_fma_f32 v175, -v35, v59, v175
v_fma_f32 v236, -v35, v72, v236
v_fma_f32 v237, -v35, v73, v237
v_fma_f32 v238, -v35, v74, v238
v_fma_f32 v239, -v35, v75, v239
v_mul_f32 v80, v172, v172
v_mul_f32 v81, v173, v173
v_mul_f32 v82, v174, v174
v_mul_f32 v83, v175, v175
v_fma_f32 v80, v80, v43, v39
v_fma_f32 v81, v81, v43, v39
v_fma_f32 v82, v82, v43, v39
v_fma_f32 v83, v83, v43, v39
v_mul_f32 v80, v80, v172
v_mul_f32 v81, v81, v173
v_mul_f32 v82, v82, v174
v_mul_f32 v83, v83, v175
v_exp_f32 v80, v80
v_exp_f32 v81, v81
v_exp_f32 v82, v82
v_exp_f32 v83, v83
v_mul_f32 v236, v172, v236
v_mul_f32 v237, v173, v237
v_mul_f32 v238, v174, v238
v_mul_f32 v239, v175, v239
v_fma_f32 v80, v80, v47, v47
v_fma_f32 v81, v81, v47, v47
v_fma_f32 v82, v82, v47, v47
v_fma_f32 v83, v83, v47, v47
s_barrier
v_rcp_f32 v80, v80
v_rcp_f32 v81, v81
v_rcp_f32 v82, v82
v_rcp_f32 v83, v83
v_mul_f32 v236, v236, v80
v_mul_f32 v237, v237, v81
v_mul_f32 v238, v238, v82
v_mul_f32 v239, v239, v83
v_cvt_pk_bf16_f32 v108, v236, v237
v_cvt_pk_bf16_f32 v109, v238, v239
v_fma_f32 v188, -v35, v60, v188
v_fma_f32 v189, -v35, v61, v189
v_fma_f32 v190, -v35, v62, v190
v_fma_f32 v191, -v35, v63, v191
v_fma_f32 v252, -v35, v76, v252
v_fma_f32 v253, -v35, v77, v253
v_fma_f32 v254, -v35, v78, v254
v_fma_f32 v255, -v35, v79, v255
v_mul_f32 v84, v188, v188
v_mul_f32 v85, v189, v189
v_mul_f32 v86, v190, v190
v_mul_f32 v87, v191, v191
v_fma_f32 v84, v84, v43, v39
v_fma_f32 v85, v85, v43, v39
v_fma_f32 v86, v86, v43, v39
v_fma_f32 v87, v87, v43, v39
v_mul_f32 v84, v84, v188
v_mul_f32 v85, v85, v189
v_mul_f32 v86, v86, v190
v_mul_f32 v87, v87, v191
v_exp_f32 v84, v84
v_exp_f32 v85, v85
v_exp_f32 v86, v86
v_exp_f32 v87, v87
v_mul_f32 v252, v188, v252
v_mul_f32 v253, v189, v253
v_mul_f32 v254, v190, v254
v_mul_f32 v255, v191, v255
v_fma_f32 v84, v84, v47, v47
v_fma_f32 v85, v85, v47, v47
v_fma_f32 v86, v86, v47, v47
v_fma_f32 v87, v87, v47, v47
v_rcp_f32 v84, v84
v_rcp_f32 v85, v85
v_rcp_f32 v86, v86
v_rcp_f32 v87, v87
v_mul_f32 v252, v252, v84
v_mul_f32 v253, v253, v85
v_mul_f32 v254, v254, v86
v_mul_f32 v255, v255, v87
v_cvt_pk_bf16_f32 v110, v252, v253
v_cvt_pk_bf16_f32 v111, v254, v255
buffer_store_dwordx4 v[108:111], v27, s[24:27], s53 offen offset:768 sc1
s_mov_b32 s41, 0x10000
s_waitcnt vmcnt(2)
s_branch Lpf_77
Lpoll_75:
s_waitcnt vmcnt(0)
Lpf_77:
v_cmp_ne_u32 vcc, v23, v22
s_nop 4
s_cbranch_vccz Lpok_76
buffer_load_dword v22, v21, s[56:59], 0 offen sc1
s_sub_u32 s41, s41, 1
s_cmp_lg_u32 s41, 0
s_cbranch_scc1 Lpoll_75
s_waitcnt vmcnt(0)
Lpok_76:
s_barrier
v_lshlrev_b32 v128, 16, v192
v_and_b32 v129, 0xffff0000, v192
v_lshlrev_b32 v130, 16, v193
v_and_b32 v131, 0xffff0000, v193
v_lshlrev_b32 v132, 16, v194
v_and_b32 v133, 0xffff0000, v194
v_lshlrev_b32 v134, 16, v195
v_and_b32 v135, 0xffff0000, v195
v_lshlrev_b32 v136, 16, v196
v_and_b32 v137, 0xffff0000, v196
v_lshlrev_b32 v138, 16, v197
v_and_b32 v139, 0xffff0000, v197
v_lshlrev_b32 v140, 16, v198
v_and_b32 v141, 0xffff0000, v198
v_lshlrev_b32 v142, 16, v199
v_and_b32 v143, 0xffff0000, v199
v_lshlrev_b32 v144, 16, v200
v_and_b32 v145, 0xffff0000, v200
v_lshlrev_b32 v146, 16, v201
v_and_b32 v147, 0xffff0000, v201
v_lshlrev_b32 v148, 16, v202
v_and_b32 v149, 0xffff0000, v202
v_lshlrev_b32 v150, 16, v203
v_and_b32 v151, 0xffff0000, v203
v_lshlrev_b32 v152, 16, v204
v_and_b32 v153, 0xffff0000, v204
v_lshlrev_b32 v154, 16, v205
v_and_b32 v155, 0xffff0000, v205
v_lshlrev_b32 v156, 16, v206
v_and_b32 v157, 0xffff0000, v206
v_lshlrev_b32 v158, 16, v207
v_and_b32 v159, 0xffff0000, v207
s_waitcnt vmcnt(0)
s_barrier
s_add_u32 s43, s34, 48
s_lshl_b32 s43, s43, 7
v_mov_b32 v22, s43
v_mov_b32 v23, 1
s_mov_b64 exec, 1
buffer_atomic_add v23, v22, s[56:59], 0 offen sc1
s_mov_b64 exec, -1
s_branch Lw_78
Lr_79:
v_mov_b32 v192, 0
v_mov_b32 v193, 0
v_mov_b32 v194, 0
v_mov_b32 v195, 0
v_mov_b32 v196, 0
v_mov_b32 v197, 0
v_mov_b32 v198, 0
v_mov_b32 v199, 0
v_mov_b32 v200, 0
v_mov_b32 v201, 0
v_mov_b32 v202, 0
v_mov_b32 v203, 0
v_mov_b32 v204, 0
v_mov_b32 v205, 0
v_mov_b32 v206, 0
v_mov_b32 v207, 0
v_mov_b32 v208, 0
v_mov_b32 v209, 0
v_mov_b32 v210, 0
v_mov_b32 v211, 0
v_mov_b32 v212, 0
v_mov_b32 v213, 0
v_mov_b32 v214, 0
v_mov_b32 v215, 0
v_mov_b32 v216, 0
v_mov_b32 v217, 0
v_mov_b32 v218, 0
v_mov_b32 v219, 0
v_mov_b32 v220, 0
v_mov_b32 v221, 0
v_mov_b32 v222, 0
v_mov_b32 v223, 0
s_barrier
.p2align 3
LK4_73:
s_setprio 1
ds_read_b64_tr_b16 v[64:65], v7 offset:0
ds_read_b128 v[32:35], v3 offset:0
ds_read_b64_tr_b16 v[66:67], v7 offset:2048
ds_read_b128 v[36:39], v3 offset:256
ds_read_b64_tr_b16 v[68:69], v8 offset:0
ds_read_b128 v[40:43], v3 offset:512
ds_read_b64_tr_b16 v[70:71], v8 offset:2048
ds_read_b128 v[44:47], v3 offset:768
ds_read_b64_tr_b16 v[72:73], v7 offset:4096
ds_read_b128 v[48:51], v3 offset:8192
ds_read_b64_tr_b16 v[74:75], v7 offset:6144
ds_read_b128 v[52:55], v3 offset:8448
ds_read_b64_tr_b16 v[76:77], v8 offset:4096
ds_read_b128 v[56:59], v3 offset:8704
ds_read_b64_tr_b16 v[78:79], v8 offset:6144
ds_read_b128 v[60:63], v3 offset:8960
s_waitcnt vmcnt(0) lgkmcnt(0)
s_barrier
v_mfma_f32_16x16x32_bf16 v[128:131], v[64:67], v[32:35], v[128:131]
ds_read_b64_tr_b16 v[160:161], v7 offset:32768
v_mfma_f32_16x16x32_bf16 v[132:135], v[68:71], v[32:35], v[132:135]
ds_read_b128 v[96:99], v3 offset:32768
v_mfma_f32_16x16x32_bf16 v[136:139], v[64:67], v[36:39], v[136:139]
ds_read_b64_tr_b16 v[162:163], v7 offset:34816
v_mfma_f32_16x16x32_bf16 v[140:143], v[68:71], v[36:39], v[140:143]
ds_read_b128 v[100:103], v3 offset:33024
v_mfma_f32_16x16x32_bf16 v[144:147], v[64:67], v[40:43], v[144:147]
ds_read_b64_tr_b16 v[164:165], v8 offset:32768
v_mfma_f32_16x16x32_bf16 v[148:151], v[68:71], v[40:43], v[148:151]
ds_read_b128 v[104:107], v3 offset:33280
v_mfma_f32_16x16x32_bf16 v[152:155], v[64:67], v[44:47], v[152:155]
ds_read_b64_tr_b16 v[166:167], v8 offset:34816
v_mfma_f32_16x16x32_bf16 v[156:159], v[68:71], v[44:47], v[156:159]
ds_read_b128 v[108:111], v3 offset:33536
v_mfma_f32_16x16x32_bf16 v[128:131], v[72:75], v[48:51], v[128:131]
ds_read_b64_tr_b16 v[168:169], v7 offset:36864
v_mfma_f32_16x16x32_bf16 v[132:135], v[76:79], v[48:51], v[132:135]
ds_read_b128 v[112:115], v3 offset:40960
v_mfma_f32_16x16x32_bf16 v[136:139], v[72:75], v[52:55], v[136:139]
ds_read_b64_tr_b16 v[170:171], v7 offset:38912
v_mfma_f32_16x16x32_bf16 v[140:143], v[76:79], v[52:55], v[140:143]
ds_read_b128 v[116:119], v3 offset:41216
v_mfma_f32_16x16x32_bf16 v[144:147], v[72:75], v[56:59], v[144:147]
ds_read_b64_tr_b16 v[172:173], v8 offset:36864
v_mfma_f32_16x16x32_bf16 v[148:151], v[76:79], v[56:59], v[148:151]
ds_read_b128 v[120:123], v3 offset:41472
v_mfma_f32_16x16x32_bf16 v[152:155], v[72:75], v[60:63], v[152:155]
ds_read_b64_tr_b16 v[174:175], v8 offset:38912
v_mfma_f32_16x16x32_bf16 v[156:159], v[76:79], v[60:63], v[156:159]
ds_read_b128 v[124:127], v3 offset:41728
s_waitcnt lgkmcnt(0)
s_barrier
v_mfma_f32_16x16x32_bf16 v[128:131], v[160:163], v[96:99], v[128:131]
ds_read_b64_tr_b16 v[64:65], v5 offset:0
v_mfma_f32_16x16x32_bf16 v[132:135], v[164:167], v[96:99], v[132:135]
ds_read_b128 v[32:35], v2 offset:0
v_mfma_f32_16x16x32_bf16 v[136:139], v[160:163], v[100:103], v[136:139]
ds_read_b64_tr_b16 v[66:67], v5 offset:2048
v_mfma_f32_16x16x32_bf16 v[140:143], v[164:167], v[100:103], v[140:143]
ds_read_b128 v[36:39], v2 offset:256
v_mfma_f32_16x16x32_bf16 v[144:147], v[160:163], v[104:107], v[144:147]
ds_read_b64_tr_b16 v[68:69], v6 offset:0
v_mfma_f32_16x16x32_bf16 v[148:151], v[164:167], v[104:107], v[148:151]
ds_read_b128 v[40:43], v2 offset:512
v_mfma_f32_16x16x32_bf16 v[152:155], v[160:163], v[108:111], v[152:155]
ds_read_b64_tr_b16 v[70:71], v6 offset:2048
v_mfma_f32_16x16x32_bf16 v[156:159], v[164:167], v[108:111], v[156:159]
ds_read_b128 v[44:47], v2 offset:768
v_mfma_f32_16x16x32_bf16 v[128:131], v[168:171], v[112:115], v[128:131]
ds_read_b64_tr_b16 v[72:73], v5 offset:4096
v_mfma_f32_16x16x32_bf16 v[132:135], v[172:175], v[112:115], v[132:135]
ds_read_b128 v[48:51], v2 offset:8192
v_mfma_f32_16x16x32_bf16 v[136:139], v[168:171], v[116:119], v[136:139]
ds_read_b64_tr_b16 v[74:75], v5 offset:6144
v_mfma_f32_16x16x32_bf16 v[140:143], v[172:175], v[116:119], v[140:143]
ds_read_b128 v[52:55], v2 offset:8448
v_mfma_f32_16x16x32_bf16 v[144:147], v[168:171], v[120:123], v[144:147]
ds_read_b64_tr_b16 v[76:77], v6 offset:4096
v_mfma_f32_16x16x32_bf16 v[148:151], v[172:175], v[120:123], v[148:151]
ds_read_b128 v[56:59], v2 offset:8704
v_mfma_f32_16x16x32_bf16 v[152:155], v[168:171], v[124:127], v[152:155]
ds_read_b64_tr_b16 v[78:79], v6 offset:6144
v_mfma_f32_16x16x32_bf16 v[156:159], v[172:175], v[124:127], v[156:159]
ds_read_b128 v[60:63], v2 offset:8960
s_waitcnt lgkmcnt(0)
s_barrier
v_mfma_f32_16x16x32_bf16 v[128:131], v[64:67], v[32:35], v[128:131]
ds_read_b64_tr_b16 v[160:161], v5 offset:32768
v_mfma_f32_16x16x32_bf16 v[132:135], v[68:71], v[32:35], v[132:135]
ds_read_b128 v[96:99], v2 offset:32768
v_mfma_f32_16x16x32_bf16 v[136:139], v[64:67], v[36:39], v[136:139]
ds_read_b64_tr_b16 v[162:163], v5 offset:34816
v_mfma_f32_16x16x32_bf16 v[140:143], v[68:71], v[36:39], v[140:143]
ds_read_b128 v[100:103], v2 offset:33024
v_mfma_f32_16x16x32_bf16 v[144:147], v[64:67], v[40:43], v[144:147]
ds_read_b64_tr_b16 v[164:165], v6 offset:32768
v_mfma_f32_16x16x32_bf16 v[148:151], v[68:71], v[40:43], v[148:151]
ds_read_b128 v[104:107], v2 offset:33280
v_mfma_f32_16x16x32_bf16 v[152:155], v[64:67], v[44:47], v[152:155]
ds_read_b64_tr_b16 v[166:167], v6 offset:34816
v_mfma_f32_16x16x32_bf16 v[156:159], v[68:71], v[44:47], v[156:159]
ds_read_b128 v[108:111], v2 offset:33536
v_mfma_f32_16x16x32_bf16 v[128:131], v[72:75], v[48:51], v[128:131]
ds_read_b64_tr_b16 v[168:169], v5 offset:36864
v_mfma_f32_16x16x32_bf16 v[132:135], v[76:79], v[48:51], v[132:135]
ds_read_b128 v[112:115], v2 offset:40960
v_mfma_f32_16x16x32_bf16 v[136:139], v[72:75], v[52:55], v[136:139]
ds_read_b64_tr_b16 v[170:171], v5 offset:38912
v_mfma_f32_16x16x32_bf16 v[140:143], v[76:79], v[52:55], v[140:143]
ds_read_b128 v[116:119], v2 offset:41216
v_mfma_f32_16x16x32_bf16 v[144:147], v[72:75], v[56:59], v[144:147]
ds_read_b64_tr_b16 v[172:173], v6 offset:36864
v_mfma_f32_16x16x32_bf16 v[148:151], v[76:79], v[56:59], v[148:151]
ds_read_b128 v[120:123], v2 offset:41472
v_mfma_f32_16x16x32_bf16 v[152:155], v[72:75], v[60:63], v[152:155]
ds_read_b64_tr_b16 v[174:175], v6 offset:38912
v_mfma_f32_16x16x32_bf16 v[156:159], v[76:79], v[60:63], v[156:159]
ds_read_b128 v[124:127], v2 offset:41728
s_waitcnt lgkmcnt(0)
s_barrier
v_mfma_f32_16x16x32_bf16 v[128:131], v[160:163], v[96:99], v[128:131]
ds_read_b64_tr_b16 v[64:65], v7 offset:0
v_mfma_f32_16x16x32_bf16 v[132:135], v[164:167], v[96:99], v[132:135]
ds_read_b128 v[32:35], v3 offset:0
v_mfma_f32_16x16x32_bf16 v[136:139], v[160:163], v[100:103], v[136:139]
ds_read_b64_tr_b16 v[66:67], v7 offset:2048
v_mfma_f32_16x16x32_bf16 v[140:143], v[164:167], v[100:103], v[140:143]
ds_read_b128 v[36:39], v3 offset:256
v_mfma_f32_16x16x32_bf16 v[144:147], v[160:163], v[104:107], v[144:147]
ds_read_b64_tr_b16 v[68:69], v8 offset:0
v_mfma_f32_16x16x32_bf16 v[148:151], v[164:167], v[104:107], v[148:151]
ds_read_b128 v[40:43], v3 offset:512
v_mfma_f32_16x16x32_bf16 v[152:155], v[160:163], v[108:111], v[152:155]
ds_read_b64_tr_b16 v[70:71], v8 offset:2048
v_mfma_f32_16x16x32_bf16 v[156:159], v[164:167], v[108:111], v[156:159]
ds_read_b128 v[44:47], v3 offset:768
v_mfma_f32_16x16x32_bf16 v[128:131], v[168:171], v[112:115], v[128:131]
ds_read_b64_tr_b16 v[80:81], v7 offset:8192
v_mfma_f32_16x16x32_bf16 v[132:135], v[172:175], v[112:115], v[132:135]
ds_read_b64_tr_b16 v[82:83], v7 offset:10240
v_mfma_f32_16x16x32_bf16 v[136:139], v[168:171], v[116:119], v[136:139]
ds_read_b64_tr_b16 v[84:85], v8 offset:8192
v_mfma_f32_16x16x32_bf16 v[140:143], v[172:175], v[116:119], v[140:143]
ds_read_b64_tr_b16 v[86:87], v8 offset:10240
v_mfma_f32_16x16x32_bf16 v[144:147], v[168:171], v[120:123], v[144:147]
ds_read_b64_tr_b16 v[72:73], v7 offset:4096
v_mfma_f32_16x16x32_bf16 v[148:151], v[172:175], v[120:123], v[148:151]
ds_read_b128 v[48:51], v3 offset:8192
v_mfma_f32_16x16x32_bf16 v[152:155], v[168:171], v[124:127], v[152:155]
ds_read_b64_tr_b16 v[74:75], v7 offset:6144
v_mfma_f32_16x16x32_bf16 v[156:159], v[172:175], v[124:127], v[156:159]
ds_read_b128 v[52:55], v3 offset:8448
ds_read_b64_tr_b16 v[76:77], v8 offset:4096
ds_read_b128 v[56:59], v3 offset:8704
ds_read_b64_tr_b16 v[78:79], v8 offset:6144
ds_read_b128 v[60:63], v3 offset:8960
ds_read_b64_tr_b16 v[88:89], v7 offset:12288
ds_read_b64_tr_b16 v[90:91], v7 offset:14336
ds_read_b64_tr_b16 v[92:93], v8 offset:12288
ds_read_b64_tr_b16 v[94:95], v8 offset:14336
s_mov_b32 s41, 4
.p2align 3
Lk4_80:
s_waitcnt lgkmcnt(0)
s_barrier
v_mfma_f32_16x16x32_bf16 v[128:131], v[64:67], v[32:35], v[128:131]
ds_read_b64_tr_b16 v[160:161], v7 offset:32768
v_mfma_f32_16x16x32_bf16 v[132:135], v[68:71], v[32:35], v[132:135]
ds_read_b128 v[96:99], v3 offset:32768
v_mfma_f32_16x16x32_bf16 v[192:195], v[80:83], v[32:35], v[192:195]
ds_read_b64_tr_b16 v[162:163], v7 offset:34816
v_mfma_f32_16x16x32_bf16 v[196:199], v[84:87], v[32:35], v[196:199]
ds_read_b128 v[100:103], v3 offset:33024
v_mfma_f32_16x16x32_bf16 v[136:139], v[64:67], v[36:39], v[136:139]
ds_read_b64_tr_b16 v[164:165], v8 offset:32768
v_mfma_f32_16x16x32_bf16 v[140:143], v[68:71], v[36:39], v[140:143]
ds_read_b128 v[104:107], v3 offset:33280
v_mfma_f32_16x16x32_bf16 v[200:203], v[80:83], v[36:39], v[200:203]
ds_read_b64_tr_b16 v[166:167], v8 offset:34816
v_mfma_f32_16x16x32_bf16 v[204:207], v[84:87], v[36:39], v[204:207]
ds_read_b128 v[108:111], v3 offset:33536
v_mfma_f32_16x16x32_bf16 v[144:147], v[64:67], v[40:43], v[144:147]
ds_read_b64_tr_b16 v[176:177], v7 offset:40960
v_mfma_f32_16x16x32_bf16 v[148:151], v[68:71], v[40:43], v[148:151]
ds_read_b64_tr_b16 v[178:179], v7 offset:43008
v_mfma_f32_16x16x32_bf16 v[208:211], v[80:83], v[40:43], v[208:211]
ds_read_b64_tr_b16 v[180:181], v8 offset:40960
v_mfma_f32_16x16x32_bf16 v[212:215], v[84:87], v[40:43], v[212:215]
ds_read_b64_tr_b16 v[182:183], v8 offset:43008
v_mfma_f32_16x16x32_bf16 v[152:155], v[64:67], v[44:47], v[152:155]
ds_read_b64_tr_b16 v[168:169], v7 offset:36864
v_mfma_f32_16x16x32_bf16 v[156:159], v[68:71], v[44:47], v[156:159]
ds_read_b128 v[112:115], v3 offset:40960
v_mfma_f32_16x16x32_bf16 v[216:219], v[80:83], v[44:47], v[216:219]
ds_read_b64_tr_b16 v[170:171], v7 offset:38912
v_mfma_f32_16x16x32_bf16 v[220:223], v[84:87], v[44:47], v[220:223]
ds_read_b128 v[116:119], v3 offset:41216
v_mfma_f32_16x16x32_bf16 v[128:131], v[72:75], v[48:51], v[128:131]
ds_read_b64_tr_b16 v[172:173], v8 offset:36864
v_mfma_f32_16x16x32_bf16 v[132:135], v[76:79], v[48:51], v[132:135]
ds_read_b128 v[120:123], v3 offset:41472
v_mfma_f32_16x16x32_bf16 v[192:195], v[88:91], v[48:51], v[192:195]
ds_read_b64_tr_b16 v[174:175], v8 offset:38912
v_mfma_f32_16x16x32_bf16 v[196:199], v[92:95], v[48:51], v[196:199]
ds_read_b128 v[124:127], v3 offset:41728
v_mfma_f32_16x16x32_bf16 v[136:139], v[72:75], v[52:55], v[136:139]
ds_read_b64_tr_b16 v[184:185], v7 offset:45056
v_mfma_f32_16x16x32_bf16 v[140:143], v[76:79], v[52:55], v[140:143]
ds_read_b64_tr_b16 v[186:187], v7 offset:47104
v_mfma_f32_16x16x32_bf16 v[200:203], v[88:91], v[52:55], v[200:203]
ds_read_b64_tr_b16 v[188:189], v8 offset:45056
v_mfma_f32_16x16x32_bf16 v[204:207], v[92:95], v[52:55], v[204:207]
ds_read_b64_tr_b16 v[190:191], v8 offset:47104
v_mfma_f32_16x16x32_bf16 v[144:147], v[72:75], v[56:59], v[144:147]
v_mfma_f32_16x16x32_bf16 v[148:151], v[76:79], v[56:59], v[148:151]
v_mfma_f32_16x16x32_bf16 v[208:211], v[88:91], v[56:59], v[208:211]
v_mfma_f32_16x16x32_bf16 v[212:215], v[92:95], v[56:59], v[212:215]
v_mfma_f32_16x16x32_bf16 v[152:155], v[72:75], v[60:63], v[152:155]
v_mfma_f32_16x16x32_bf16 v[156:159], v[76:79], v[60:63], v[156:159]
v_mfma_f32_16x16x32_bf16 v[216:219], v[88:91], v[60:63], v[216:219]
v_mfma_f32_16x16x32_bf16 v[220:223], v[92:95], v[60:63], v[220:223]
s_waitcnt lgkmcnt(0)
s_barrier
v_mfma_f32_16x16x32_bf16 v[128:131], v[160:163], v[96:99], v[128:131]
ds_read_b64_tr_b16 v[64:65], v5 offset:0
v_mfma_f32_16x16x32_bf16 v[132:135], v[164:167], v[96:99], v[132:135]
ds_read_b128 v[32:35], v2 offset:0
v_mfma_f32_16x16x32_bf16 v[192:195], v[176:179], v[96:99], v[192:195]
ds_read_b64_tr_b16 v[66:67], v5 offset:2048
v_mfma_f32_16x16x32_bf16 v[196:199], v[180:183], v[96:99], v[196:199]
ds_read_b128 v[36:39], v2 offset:256
v_mfma_f32_16x16x32_bf16 v[136:139], v[160:163], v[100:103], v[136:139]
ds_read_b64_tr_b16 v[68:69], v6 offset:0
v_mfma_f32_16x16x32_bf16 v[140:143], v[164:167], v[100:103], v[140:143]
ds_read_b128 v[40:43], v2 offset:512
v_mfma_f32_16x16x32_bf16 v[200:203], v[176:179], v[100:103], v[200:203]
ds_read_b64_tr_b16 v[70:71], v6 offset:2048
v_mfma_f32_16x16x32_bf16 v[204:207], v[180:183], v[100:103], v[204:207]
ds_read_b128 v[44:47], v2 offset:768
v_mfma_f32_16x16x32_bf16 v[144:147], v[160:163], v[104:107], v[144:147]
ds_read_b64_tr_b16 v[80:81], v5 offset:8192
v_mfma_f32_16x16x32_bf16 v[148:151], v[164:167], v[104:107], v[148:151]
ds_read_b64_tr_b16 v[82:83], v5 offset:10240
v_mfma_f32_16x16x32_bf16 v[208:211], v[176:179], v[104:107], v[208:211]
ds_read_b64_tr_b16 v[84:85], v6 offset:8192
v_mfma_f32_16x16x32_bf16 v[212:215], v[180:183], v[104:107], v[212:215]
ds_read_b64_tr_b16 v[86:87], v6 offset:10240
v_mfma_f32_16x16x32_bf16 v[152:155], v[160:163], v[108:111], v[152:155]
ds_read_b64_tr_b16 v[72:73], v5 offset:4096
v_mfma_f32_16x16x32_bf16 v[156:159], v[164:167], v[108:111], v[156:159]
ds_read_b128 v[48:51], v2 offset:8192
v_mfma_f32_16x16x32_bf16 v[216:219], v[176:179], v[108:111], v[216:219]
ds_read_b64_tr_b16 v[74:75], v5 offset:6144
v_mfma_f32_16x16x32_bf16 v[220:223], v[180:183], v[108:111], v[220:223]
ds_read_b128 v[52:55], v2 offset:8448
v_mfma_f32_16x16x32_bf16 v[128:131], v[168:171], v[112:115], v[128:131]
ds_read_b64_tr_b16 v[76:77], v6 offset:4096
v_mfma_f32_16x16x32_bf16 v[132:135], v[172:175], v[112:115], v[132:135]
ds_read_b128 v[56:59], v2 offset:8704
v_mfma_f32_16x16x32_bf16 v[192:195], v[184:187], v[112:115], v[192:195]
ds_read_b64_tr_b16 v[78:79], v6 offset:6144
v_mfma_f32_16x16x32_bf16 v[196:199], v[188:191], v[112:115], v[196:199]
ds_read_b128 v[60:63], v2 offset:8960
v_mfma_f32_16x16x32_bf16 v[136:139], v[168:171], v[116:119], v[136:139]
ds_read_b64_tr_b16 v[88:89], v5 offset:12288
v_mfma_f32_16x16x32_bf16 v[140:143], v[172:175], v[116:119], v[140:143]
ds_read_b64_tr_b16 v[90:91], v5 offset:14336
v_mfma_f32_16x16x32_bf16 v[200:203], v[184:187], v[116:119], v[200:203]
ds_read_b64_tr_b16 v[92:93], v6 offset:12288
v_mfma_f32_16x16x32_bf16 v[204:207], v[188:191], v[116:119], v[204:207]
ds_read_b64_tr_b16 v[94:95], v6 offset:14336
v_mfma_f32_16x16x32_bf16 v[144:147], v[168:171], v[120:123], v[144:147]
v_mfma_f32_16x16x32_bf16 v[148:151], v[172:175], v[120:123], v[148:151]
v_mfma_f32_16x16x32_bf16 v[208:211], v[184:187], v[120:123], v[208:211]
v_mfma_f32_16x16x32_bf16 v[212:215], v[188:191], v[120:123], v[212:215]
v_mfma_f32_16x16x32_bf16 v[152:155], v[168:171], v[124:127], v[152:155]
v_mfma_f32_16x16x32_bf16 v[156:159], v[172:175], v[124:127], v[156:159]
v_mfma_f32_16x16x32_bf16 v[216:219], v[184:187], v[124:127], v[216:219]
v_mfma_f32_16x16x32_bf16 v[220:223], v[188:191], v[124:127], v[220:223]
s_waitcnt lgkmcnt(0)
s_barrier
v_mfma_f32_16x16x32_bf16 v[128:131], v[64:67], v[32:35], v[128:131]
ds_read_b64_tr_b16 v[160:161], v5 offset:32768
v_mfma_f32_16x16x32_bf16 v[132:135], v[68:71], v[32:35], v[132:135]
ds_read_b128 v[96:99], v2 offset:32768
v_mfma_f32_16x16x32_bf16 v[192:195], v[80:83], v[32:35], v[192:195]
ds_read_b64_tr_b16 v[162:163], v5 offset:34816
v_mfma_f32_16x16x32_bf16 v[196:199], v[84:87], v[32:35], v[196:199]
ds_read_b128 v[100:103], v2 offset:33024
v_mfma_f32_16x16x32_bf16 v[136:139], v[64:67], v[36:39], v[136:139]
ds_read_b64_tr_b16 v[164:165], v6 offset:32768
v_mfma_f32_16x16x32_bf16 v[140:143], v[68:71], v[36:39], v[140:143]
ds_read_b128 v[104:107], v2 offset:33280
v_mfma_f32_16x16x32_bf16 v[200:203], v[80:83], v[36:39], v[200:203]
ds_read_b64_tr_b16 v[166:167], v6 offset:34816
v_mfma_f32_16x16x32_bf16 v[204:207], v[84:87], v[36:39], v[204:207]
ds_read_b128 v[108:111], v2 offset:33536
v_mfma_f32_16x16x32_bf16 v[144:147], v[64:67], v[40:43], v[144:147]
ds_read_b64_tr_b16 v[176:177], v5 offset:40960
v_mfma_f32_16x16x32_bf16 v[148:151], v[68:71], v[40:43], v[148:151]
ds_read_b64_tr_b16 v[178:179], v5 offset:43008
v_mfma_f32_16x16x32_bf16 v[208:211], v[80:83], v[40:43], v[208:211]
ds_read_b64_tr_b16 v[180:181], v6 offset:40960
v_mfma_f32_16x16x32_bf16 v[212:215], v[84:87], v[40:43], v[212:215]
ds_read_b64_tr_b16 v[182:183], v6 offset:43008
v_mfma_f32_16x16x32_bf16 v[152:155], v[64:67], v[44:47], v[152:155]
ds_read_b64_tr_b16 v[168:169], v5 offset:36864
v_mfma_f32_16x16x32_bf16 v[156:159], v[68:71], v[44:47], v[156:159]
ds_read_b128 v[112:115], v2 offset:40960
v_mfma_f32_16x16x32_bf16 v[216:219], v[80:83], v[44:47], v[216:219]
ds_read_b64_tr_b16 v[170:171], v5 offset:38912
v_mfma_f32_16x16x32_bf16 v[220:223], v[84:87], v[44:47], v[220:223]
ds_read_b128 v[116:119], v2 offset:41216
v_mfma_f32_16x16x32_bf16 v[128:131], v[72:75], v[48:51], v[128:131]
ds_read_b64_tr_b16 v[172:173], v6 offset:36864
v_mfma_f32_16x16x32_bf16 v[132:135], v[76:79], v[48:51], v[132:135]
ds_read_b128 v[120:123], v2 offset:41472
v_mfma_f32_16x16x32_bf16 v[192:195], v[88:91], v[48:51], v[192:195]
ds_read_b64_tr_b16 v[174:175], v6 offset:38912
v_mfma_f32_16x16x32_bf16 v[196:199], v[92:95], v[48:51], v[196:199]
ds_read_b128 v[124:127], v2 offset:41728
v_mfma_f32_16x16x32_bf16 v[136:139], v[72:75], v[52:55], v[136:139]
ds_read_b64_tr_b16 v[184:185], v5 offset:45056
v_mfma_f32_16x16x32_bf16 v[140:143], v[76:79], v[52:55], v[140:143]
ds_read_b64_tr_b16 v[186:187], v5 offset:47104
v_mfma_f32_16x16x32_bf16 v[200:203], v[88:91], v[52:55], v[200:203]
ds_read_b64_tr_b16 v[188:189], v6 offset:45056
v_mfma_f32_16x16x32_bf16 v[204:207], v[92:95], v[52:55], v[204:207]
ds_read_b64_tr_b16 v[190:191], v6 offset:47104
v_mfma_f32_16x16x32_bf16 v[144:147], v[72:75], v[56:59], v[144:147]
v_mfma_f32_16x16x32_bf16 v[148:151], v[76:79], v[56:59], v[148:151]
v_mfma_f32_16x16x32_bf16 v[208:211], v[88:91], v[56:59], v[208:211]
v_mfma_f32_16x16x32_bf16 v[212:215], v[92:95], v[56:59], v[212:215]
v_mfma_f32_16x16x32_bf16 v[152:155], v[72:75], v[60:63], v[152:155]
v_mfma_f32_16x16x32_bf16 v[156:159], v[76:79], v[60:63], v[156:159]
v_mfma_f32_16x16x32_bf16 v[216:219], v[88:91], v[60:63], v[216:219]
v_mfma_f32_16x16x32_bf16 v[220:223], v[92:95], v[60:63], v[220:223]
s_waitcnt lgkmcnt(0)
s_barrier
v_mfma_f32_16x16x32_bf16 v[128:131], v[160:163], v[96:99], v[128:131]
ds_read_b64_tr_b16 v[64:65], v7 offset:0
v_mfma_f32_16x16x32_bf16 v[132:135], v[164:167], v[96:99], v[132:135]
ds_read_b128 v[32:35], v3 offset:0
v_mfma_f32_16x16x32_bf16 v[192:195], v[176:179], v[96:99], v[192:195]
ds_read_b64_tr_b16 v[66:67], v7 offset:2048
v_mfma_f32_16x16x32_bf16 v[196:199], v[180:183], v[96:99], v[196:199]
ds_read_b128 v[36:39], v3 offset:256
v_mfma_f32_16x16x32_bf16 v[136:139], v[160:163], v[100:103], v[136:139]
ds_read_b64_tr_b16 v[68:69], v8 offset:0
v_mfma_f32_16x16x32_bf16 v[140:143], v[164:167], v[100:103], v[140:143]
ds_read_b128 v[40:43], v3 offset:512
v_mfma_f32_16x16x32_bf16 v[200:203], v[176:179], v[100:103], v[200:203]
ds_read_b64_tr_b16 v[70:71], v8 offset:2048
v_mfma_f32_16x16x32_bf16 v[204:207], v[180:183], v[100:103], v[204:207]
ds_read_b128 v[44:47], v3 offset:768
v_mfma_f32_16x16x32_bf16 v[144:147], v[160:163], v[104:107], v[144:147]
ds_read_b64_tr_b16 v[80:81], v7 offset:8192
v_mfma_f32_16x16x32_bf16 v[148:151], v[164:167], v[104:107], v[148:151]
ds_read_b64_tr_b16 v[82:83], v7 offset:10240
v_mfma_f32_16x16x32_bf16 v[208:211], v[176:179], v[104:107], v[208:211]
ds_read_b64_tr_b16 v[84:85], v8 offset:8192
v_mfma_f32_16x16x32_bf16 v[212:215], v[180:183], v[104:107], v[212:215]
ds_read_b64_tr_b16 v[86:87], v8 offset:10240
v_mfma_f32_16x16x32_bf16 v[152:155], v[160:163], v[108:111], v[152:155]
ds_read_b64_tr_b16 v[72:73], v7 offset:4096
v_mfma_f32_16x16x32_bf16 v[156:159], v[164:167], v[108:111], v[156:159]
ds_read_b128 v[48:51], v3 offset:8192
v_mfma_f32_16x16x32_bf16 v[216:219], v[176:179], v[108:111], v[216:219]
ds_read_b64_tr_b16 v[74:75], v7 offset:6144
v_mfma_f32_16x16x32_bf16 v[220:223], v[180:183], v[108:111], v[220:223]
ds_read_b128 v[52:55], v3 offset:8448
v_mfma_f32_16x16x32_bf16 v[128:131], v[168:171], v[112:115], v[128:131]
ds_read_b64_tr_b16 v[76:77], v8 offset:4096
v_mfma_f32_16x16x32_bf16 v[132:135], v[172:175], v[112:115], v[132:135]
ds_read_b128 v[56:59], v3 offset:8704
v_mfma_f32_16x16x32_bf16 v[192:195], v[184:187], v[112:115], v[192:195]
ds_read_b64_tr_b16 v[78:79], v8 offset:6144
v_mfma_f32_16x16x32_bf16 v[196:199], v[188:191], v[112:115], v[196:199]
ds_read_b128 v[60:63], v3 offset:8960
v_mfma_f32_16x16x32_bf16 v[136:139], v[168:171], v[116:119], v[136:139]
ds_read_b64_tr_b16 v[88:89], v7 offset:12288
v_mfma_f32_16x16x32_bf16 v[140:143], v[172:175], v[116:119], v[140:143]
ds_read_b64_tr_b16 v[90:91], v7 offset:14336
v_mfma_f32_16x16x32_bf16 v[200:203], v[184:187], v[116:119], v[200:203]
ds_read_b64_tr_b16 v[92:93], v8 offset:12288
v_mfma_f32_16x16x32_bf16 v[204:207], v[188:191], v[116:119], v[204:207]
ds_read_b64_tr_b16 v[94:95], v8 offset:14336
v_mfma_f32_16x16x32_bf16 v[144:147], v[168:171], v[120:123], v[144:147]
v_mfma_f32_16x16x32_bf16 v[148:151], v[172:175], v[120:123], v[148:151]
v_mfma_f32_16x16x32_bf16 v[208:211], v[184:187], v[120:123], v[208:211]
v_mfma_f32_16x16x32_bf16 v[212:215], v[188:191], v[120:123], v[212:215]
v_mfma_f32_16x16x32_bf16 v[152:155], v[168:171], v[124:127], v[152:155]
v_mfma_f32_16x16x32_bf16 v[156:159], v[172:175], v[124:127], v[156:159]
v_mfma_f32_16x16x32_bf16 v[216:219], v[184:187], v[124:127], v[216:219]
v_mfma_f32_16x16x32_bf16 v[220:223], v[188:191], v[124:127], v[220:223]
s_sub_u32 s41, s41, 1
s_cmp_lg_u32 s41, 0
s_cbranch_scc1 Lk4_80
s_waitcnt lgkmcnt(0)
s_barrier
v_mfma_f32_16x16x32_bf16 v[128:131], v[64:67], v[32:35], v[128:131]
ds_read_b64_tr_b16 v[160:161], v7 offset:32768
v_mfma_f32_16x16x32_bf16 v[132:135], v[68:71], v[32:35], v[132:135]
ds_read_b128 v[96:99], v3 offset:32768
v_mfma_f32_16x16x32_bf16 v[192:195], v[80:83], v[32:35], v[192:195]
ds_read_b64_tr_b16 v[162:163], v7 offset:34816
v_mfma_f32_16x16x32_bf16 v[196:199], v[84:87], v[32:35], v[196:199]
ds_read_b128 v[100:103], v3 offset:33024
v_mfma_f32_16x16x32_bf16 v[136:139], v[64:67], v[36:39], v[136:139]
ds_read_b64_tr_b16 v[164:165], v8 offset:32768
v_mfma_f32_16x16x32_bf16 v[140:143], v[68:71], v[36:39], v[140:143]
ds_read_b128 v[104:107], v3 offset:33280
v_mfma_f32_16x16x32_bf16 v[200:203], v[80:83], v[36:39], v[200:203]
ds_read_b64_tr_b16 v[166:167], v8 offset:34816
v_mfma_f32_16x16x32_bf16 v[204:207], v[84:87], v[36:39], v[204:207]
ds_read_b128 v[108:111], v3 offset:33536
v_mfma_f32_16x16x32_bf16 v[144:147], v[64:67], v[40:43], v[144:147]
ds_read_b64_tr_b16 v[176:177], v7 offset:40960
v_mfma_f32_16x16x32_bf16 v[148:151], v[68:71], v[40:43], v[148:151]
ds_read_b64_tr_b16 v[178:179], v7 offset:43008
v_mfma_f32_16x16x32_bf16 v[208:211], v[80:83], v[40:43], v[208:211]
ds_read_b64_tr_b16 v[180:181], v8 offset:40960
v_mfma_f32_16x16x32_bf16 v[212:215], v[84:87], v[40:43], v[212:215]
ds_read_b64_tr_b16 v[182:183], v8 offset:43008
v_mfma_f32_16x16x32_bf16 v[152:155], v[64:67], v[44:47], v[152:155]
ds_read_b64_tr_b16 v[168:169], v7 offset:36864
v_mfma_f32_16x16x32_bf16 v[156:159], v[68:71], v[44:47], v[156:159]
ds_read_b128 v[112:115], v3 offset:40960
v_mfma_f32_16x16x32_bf16 v[216:219], v[80:83], v[44:47], v[216:219]
ds_read_b64_tr_b16 v[170:171], v7 offset:38912
v_mfma_f32_16x16x32_bf16 v[220:223], v[84:87], v[44:47], v[220:223]
ds_read_b128 v[116:119], v3 offset:41216
v_mfma_f32_16x16x32_bf16 v[128:131], v[72:75], v[48:51], v[128:131]
ds_read_b64_tr_b16 v[172:173], v8 offset:36864
v_mfma_f32_16x16x32_bf16 v[132:135], v[76:79], v[48:51], v[132:135]
ds_read_b128 v[120:123], v3 offset:41472
v_mfma_f32_16x16x32_bf16 v[192:195], v[88:91], v[48:51], v[192:195]
ds_read_b64_tr_b16 v[174:175], v8 offset:38912
v_mfma_f32_16x16x32_bf16 v[196:199], v[92:95], v[48:51], v[196:199]
ds_read_b128 v[124:127], v3 offset:41728
v_mfma_f32_16x16x32_bf16 v[136:139], v[72:75], v[52:55], v[136:139]
ds_read_b64_tr_b16 v[184:185], v7 offset:45056
v_mfma_f32_16x16x32_bf16 v[140:143], v[76:79], v[52:55], v[140:143]
ds_read_b64_tr_b16 v[186:187], v7 offset:47104
v_mfma_f32_16x16x32_bf16 v[200:203], v[88:91], v[52:55], v[200:203]
ds_read_b64_tr_b16 v[188:189], v8 offset:45056
v_mfma_f32_16x16x32_bf16 v[204:207], v[92:95], v[52:55], v[204:207]
ds_read_b64_tr_b16 v[190:191], v8 offset:47104
v_mfma_f32_16x16x32_bf16 v[144:147], v[72:75], v[56:59], v[144:147]
v_mfma_f32_16x16x32_bf16 v[148:151], v[76:79], v[56:59], v[148:151]
v_mfma_f32_16x16x32_bf16 v[208:211], v[88:91], v[56:59], v[208:211]
v_mfma_f32_16x16x32_bf16 v[212:215], v[92:95], v[56:59], v[212:215]
v_mfma_f32_16x16x32_bf16 v[152:155], v[72:75], v[60:63], v[152:155]
v_mfma_f32_16x16x32_bf16 v[156:159], v[76:79], v[60:63], v[156:159]
v_mfma_f32_16x16x32_bf16 v[216:219], v[88:91], v[60:63], v[216:219]
v_mfma_f32_16x16x32_bf16 v[220:223], v[92:95], v[60:63], v[220:223]
s_waitcnt lgkmcnt(0)
s_barrier
v_mfma_f32_16x16x32_bf16 v[128:131], v[160:163], v[96:99], v[128:131]
ds_read_b64_tr_b16 v[64:65], v5 offset:0
v_mfma_f32_16x16x32_bf16 v[132:135], v[164:167], v[96:99], v[132:135]
ds_read_b128 v[32:35], v2 offset:0
v_mfma_f32_16x16x32_bf16 v[192:195], v[176:179], v[96:99], v[192:195]
ds_read_b64_tr_b16 v[66:67], v5 offset:2048
v_mfma_f32_16x16x32_bf16 v[196:199], v[180:183], v[96:99], v[196:199]
ds_read_b128 v[36:39], v2 offset:256
v_mfma_f32_16x16x32_bf16 v[136:139], v[160:163], v[100:103], v[136:139]
ds_read_b64_tr_b16 v[68:69], v6 offset:0
v_mfma_f32_16x16x32_bf16 v[140:143], v[164:167], v[100:103], v[140:143]
ds_read_b128 v[40:43], v2 offset:512
v_mfma_f32_16x16x32_bf16 v[200:203], v[176:179], v[100:103], v[200:203]
ds_read_b64_tr_b16 v[70:71], v6 offset:2048
v_mfma_f32_16x16x32_bf16 v[204:207], v[180:183], v[100:103], v[204:207]
ds_read_b128 v[44:47], v2 offset:768
v_mfma_f32_16x16x32_bf16 v[144:147], v[160:163], v[104:107], v[144:147]
ds_read_b64_tr_b16 v[80:81], v5 offset:8192
v_mfma_f32_16x16x32_bf16 v[148:151], v[164:167], v[104:107], v[148:151]
ds_read_b64_tr_b16 v[82:83], v5 offset:10240
v_mfma_f32_16x16x32_bf16 v[208:211], v[176:179], v[104:107], v[208:211]
ds_read_b64_tr_b16 v[84:85], v6 offset:8192
v_mfma_f32_16x16x32_bf16 v[212:215], v[180:183], v[104:107], v[212:215]
ds_read_b64_tr_b16 v[86:87], v6 offset:10240
v_mfma_f32_16x16x32_bf16 v[152:155], v[160:163], v[108:111], v[152:155]
ds_read_b64_tr_b16 v[72:73], v5 offset:4096
v_mfma_f32_16x16x32_bf16 v[156:159], v[164:167], v[108:111], v[156:159]
ds_read_b128 v[48:51], v2 offset:8192
v_mfma_f32_16x16x32_bf16 v[216:219], v[176:179], v[108:111], v[216:219]
ds_read_b64_tr_b16 v[74:75], v5 offset:6144
v_mfma_f32_16x16x32_bf16 v[220:223], v[180:183], v[108:111], v[220:223]
ds_read_b128 v[52:55], v2 offset:8448
v_mfma_f32_16x16x32_bf16 v[128:131], v[168:171], v[112:115], v[128:131]
ds_read_b64_tr_b16 v[76:77], v6 offset:4096
v_mfma_f32_16x16x32_bf16 v[132:135], v[172:175], v[112:115], v[132:135]
ds_read_b128 v[56:59], v2 offset:8704
v_mfma_f32_16x16x32_bf16 v[192:195], v[184:187], v[112:115], v[192:195]
ds_read_b64_tr_b16 v[78:79], v6 offset:6144
v_mfma_f32_16x16x32_bf16 v[196:199], v[188:191], v[112:115], v[196:199]
ds_read_b128 v[60:63], v2 offset:8960
v_mfma_f32_16x16x32_bf16 v[136:139], v[168:171], v[116:119], v[136:139]
ds_read_b64_tr_b16 v[88:89], v5 offset:12288
v_mfma_f32_16x16x32_bf16 v[140:143], v[172:175], v[116:119], v[140:143]
ds_read_b64_tr_b16 v[90:91], v5 offset:14336
v_mfma_f32_16x16x32_bf16 v[200:203], v[184:187], v[116:119], v[200:203]
ds_read_b64_tr_b16 v[92:93], v6 offset:12288
v_mfma_f32_16x16x32_bf16 v[204:207], v[188:191], v[116:119], v[204:207]
ds_read_b64_tr_b16 v[94:95], v6 offset:14336
v_mfma_f32_16x16x32_bf16 v[144:147], v[168:171], v[120:123], v[144:147]
v_mfma_f32_16x16x32_bf16 v[148:151], v[172:175], v[120:123], v[148:151]
v_mfma_f32_16x16x32_bf16 v[208:211], v[184:187], v[120:123], v[208:211]
v_mfma_f32_16x16x32_bf16 v[212:215], v[188:191], v[120:123], v[212:215]
v_mfma_f32_16x16x32_bf16 v[152:155], v[168:171], v[124:127], v[152:155]
v_mfma_f32_16x16x32_bf16 v[156:159], v[172:175], v[124:127], v[156:159]
v_mfma_f32_16x16x32_bf16 v[216:219], v[184:187], v[124:127], v[216:219]
v_mfma_f32_16x16x32_bf16 v[220:223], v[188:191], v[124:127], v[220:223]
s_waitcnt lgkmcnt(0)
s_barrier
v_mfma_f32_16x16x32_bf16 v[128:131], v[64:67], v[32:35], v[128:131]
ds_read_b64_tr_b16 v[160:161], v5 offset:32768
v_mfma_f32_16x16x32_bf16 v[132:135], v[68:71], v[32:35], v[132:135]
ds_read_b128 v[96:99], v2 offset:32768
v_mfma_f32_16x16x32_bf16 v[192:195], v[80:83], v[32:35], v[192:195]
ds_read_b64_tr_b16 v[162:163], v5 offset:34816
v_mfma_f32_16x16x32_bf16 v[196:199], v[84:87], v[32:35], v[196:199]
ds_read_b128 v[100:103], v2 offset:33024
v_mfma_f32_16x16x32_bf16 v[136:139], v[64:67], v[36:39], v[136:139]
ds_read_b64_tr_b16 v[164:165], v6 offset:32768
v_mfma_f32_16x16x32_bf16 v[140:143], v[68:71], v[36:39], v[140:143]
ds_read_b128 v[104:107], v2 offset:33280
v_mfma_f32_16x16x32_bf16 v[200:203], v[80:83], v[36:39], v[200:203]
ds_read_b64_tr_b16 v[166:167], v6 offset:34816
v_mfma_f32_16x16x32_bf16 v[204:207], v[84:87], v[36:39], v[204:207]
ds_read_b128 v[108:111], v2 offset:33536
v_mfma_f32_16x16x32_bf16 v[144:147], v[64:67], v[40:43], v[144:147]
ds_read_b64_tr_b16 v[176:177], v5 offset:40960
v_mfma_f32_16x16x32_bf16 v[148:151], v[68:71], v[40:43], v[148:151]
ds_read_b64_tr_b16 v[178:179], v5 offset:43008
v_mfma_f32_16x16x32_bf16 v[208:211], v[80:83], v[40:43], v[208:211]
ds_read_b64_tr_b16 v[180:181], v6 offset:40960
v_mfma_f32_16x16x32_bf16 v[212:215], v[84:87], v[40:43], v[212:215]
ds_read_b64_tr_b16 v[182:183], v6 offset:43008
v_mfma_f32_16x16x32_bf16 v[152:155], v[64:67], v[44:47], v[152:155]
ds_read_b64_tr_b16 v[168:169], v5 offset:36864
v_mfma_f32_16x16x32_bf16 v[156:159], v[68:71], v[44:47], v[156:159]
ds_read_b128 v[112:115], v2 offset:40960
v_mfma_f32_16x16x32_bf16 v[216:219], v[80:83], v[44:47], v[216:219]
ds_read_b64_tr_b16 v[170:171], v5 offset:38912
v_mfma_f32_16x16x32_bf16 v[220:223], v[84:87], v[44:47], v[220:223]
ds_read_b128 v[116:119], v2 offset:41216
v_mfma_f32_16x16x32_bf16 v[128:131], v[72:75], v[48:51], v[128:131]
ds_read_b64_tr_b16 v[172:173], v6 offset:36864
v_mfma_f32_16x16x32_bf16 v[132:135], v[76:79], v[48:51], v[132:135]
ds_read_b128 v[120:123], v2 offset:41472
v_mfma_f32_16x16x32_bf16 v[192:195], v[88:91], v[48:51], v[192:195]
ds_read_b64_tr_b16 v[174:175], v6 offset:38912
v_mfma_f32_16x16x32_bf16 v[196:199], v[92:95], v[48:51], v[196:199]
ds_read_b128 v[124:127], v2 offset:41728
v_mfma_f32_16x16x32_bf16 v[136:139], v[72:75], v[52:55], v[136:139]
ds_read_b64_tr_b16 v[184:185], v5 offset:45056
v_mfma_f32_16x16x32_bf16 v[140:143], v[76:79], v[52:55], v[140:143]
ds_read_b64_tr_b16 v[186:187], v5 offset:47104
v_mfma_f32_16x16x32_bf16 v[200:203], v[88:91], v[52:55], v[200:203]
ds_read_b64_tr_b16 v[188:189], v6 offset:45056
v_mfma_f32_16x16x32_bf16 v[204:207], v[92:95], v[52:55], v[204:207]
ds_read_b64_tr_b16 v[190:191], v6 offset:47104
v_mfma_f32_16x16x32_bf16 v[144:147], v[72:75], v[56:59], v[144:147]
v_mfma_f32_16x16x32_bf16 v[148:151], v[76:79], v[56:59], v[148:151]
v_mfma_f32_16x16x32_bf16 v[208:211], v[88:91], v[56:59], v[208:211]
v_mfma_f32_16x16x32_bf16 v[212:215], v[92:95], v[56:59], v[212:215]
v_mfma_f32_16x16x32_bf16 v[152:155], v[72:75], v[60:63], v[152:155]
v_mfma_f32_16x16x32_bf16 v[156:159], v[76:79], v[60:63], v[156:159]
v_mfma_f32_16x16x32_bf16 v[216:219], v[88:91], v[60:63], v[216:219]
v_mfma_f32_16x16x32_bf16 v[220:223], v[92:95], v[60:63], v[220:223]
s_waitcnt lgkmcnt(0)
s_barrier
v_mfma_f32_16x16x32_bf16 v[128:131], v[160:163], v[96:99], v[128:131]
ds_read_b64_tr_b16 v[64:65], v7 offset:0
v_mfma_f32_16x16x32_bf16 v[132:135], v[164:167], v[96:99], v[132:135]
ds_read_b128 v[32:35], v3 offset:0
v_mfma_f32_16x16x32_bf16 v[192:195], v[176:179], v[96:99], v[192:195]
ds_read_b64_tr_b16 v[66:67], v7 offset:2048
v_mfma_f32_16x16x32_bf16 v[196:199], v[180:183], v[96:99], v[196:199]
ds_read_b128 v[36:39], v3 offset:256
v_mfma_f32_16x16x32_bf16 v[136:139], v[160:163], v[100:103], v[136:139]
ds_read_b64_tr_b16 v[68:69], v8 offset:0
v_mfma_f32_16x16x32_bf16 v[140:143], v[164:167], v[100:103], v[140:143]
ds_read_b128 v[40:43], v3 offset:512
v_mfma_f32_16x16x32_bf16 v[200:203], v[176:179], v[100:103], v[200:203]
ds_read_b64_tr_b16 v[70:71], v8 offset:2048
v_mfma_f32_16x16x32_bf16 v[204:207], v[180:183], v[100:103], v[204:207]
ds_read_b128 v[44:47], v3 offset:768
v_mfma_f32_16x16x32_bf16 v[144:147], v[160:163], v[104:107], v[144:147]
ds_read_b64_tr_b16 v[72:73], v7 offset:4096
v_mfma_f32_16x16x32_bf16 v[148:151], v[164:167], v[104:107], v[148:151]
ds_read_b128 v[48:51], v3 offset:8192
v_mfma_f32_16x16x32_bf16 v[208:211], v[176:179], v[104:107], v[208:211]
ds_read_b64_tr_b16 v[74:75], v7 offset:6144
v_mfma_f32_16x16x32_bf16 v[212:215], v[180:183], v[104:107], v[212:215]
ds_read_b128 v[52:55], v3 offset:8448
v_mfma_f32_16x16x32_bf16 v[152:155], v[160:163], v[108:111], v[152:155]
ds_read_b64_tr_b16 v[76:77], v8 offset:4096
v_mfma_f32_16x16x32_bf16 v[156:159], v[164:167], v[108:111], v[156:159]
ds_read_b128 v[56:59], v3 offset:8704
v_mfma_f32_16x16x32_bf16 v[216:219], v[176:179], v[108:111], v[216:219]
ds_read_b64_tr_b16 v[78:79], v8 offset:6144
v_mfma_f32_16x16x32_bf16 v[220:223], v[180:183], v[108:111], v[220:223]
ds_read_b128 v[60:63], v3 offset:8960
v_mfma_f32_16x16x32_bf16 v[128:131], v[168:171], v[112:115], v[128:131]
v_mfma_f32_16x16x32_bf16 v[132:135], v[172:175], v[112:115], v[132:135]
v_mfma_f32_16x16x32_bf16 v[192:195], v[184:187], v[112:115], v[192:195]
v_mfma_f32_16x16x32_bf16 v[196:199], v[188:191], v[112:115], v[196:199]
v_mfma_f32_16x16x32_bf16 v[136:139], v[168:171], v[116:119], v[136:139]
v_mfma_f32_16x16x32_bf16 v[140:143], v[172:175], v[116:119], v[140:143]
v_mfma_f32_16x16x32_bf16 v[200:203], v[184:187], v[116:119], v[200:203]
v_mfma_f32_16x16x32_bf16 v[204:207], v[188:191], v[116:119], v[204:207]
v_mfma_f32_16x16x32_bf16 v[144:147], v[168:171], v[120:123], v[144:147]
v_mfma_f32_16x16x32_bf16 v[148:151], v[172:175], v[120:123], v[148:151]
v_mfma_f32_16x16x32_bf16 v[208:211], v[184:187], v[120:123], v[208:211]
v_mfma_f32_16x16x32_bf16 v[212:215], v[188:191], v[120:123], v[212:215]
v_mfma_f32_16x16x32_bf16 v[152:155], v[168:171], v[124:127], v[152:155]
v_mfma_f32_16x16x32_bf16 v[156:159], v[172:175], v[124:127], v[156:159]
v_mfma_f32_16x16x32_bf16 v[216:219], v[184:187], v[124:127], v[216:219]
v_mfma_f32_16x16x32_bf16 v[220:223], v[188:191], v[124:127], v[220:223]
s_mov_b32 s54, 0x10000
s_waitcnt lgkmcnt(0)
s_barrier
v_mfma_f32_16x16x32_bf16 v[128:131], v[64:67], v[32:35], v[128:131]
ds_read_b64_tr_b16 v[160:161], v7 offset:32768
v_mfma_f32_16x16x32_bf16 v[132:135], v[68:71], v[32:35], v[132:135]
ds_read_b128 v[96:99], v3 offset:32768
v_mfma_f32_16x16x32_bf16 v[136:139], v[64:67], v[36:39], v[136:139]
ds_read_b64_tr_b16 v[162:163], v7 offset:34816
v_mfma_f32_16x16x32_bf16 v[140:143], v[68:71], v[36:39], v[140:143]
ds_read_b128 v[100:103], v3 offset:33024
v_cvt_pk_bf16_f32 v224, v192, v193
v_mfma_f32_16x16x32_bf16 v[144:147], v[64:67], v[40:43], v[144:147]
ds_read_b64_tr_b16 v[164:165], v8 offset:32768
v_cvt_pk_bf16_f32 v225, v194, v195
v_mfma_f32_16x16x32_bf16 v[148:151], v[68:71], v[40:43], v[148:151]
v_cvt_pk_bf16_f32 v226, v196, v197
ds_read_b128 v[104:107], v3 offset:33280
v_cvt_pk_bf16_f32 v227, v198, v199
v_mfma_f32_16x16x32_bf16 v[152:155], v[64:67], v[44:47], v[152:155]
buffer_store_dwordx4 v[224:227], v9, s[64:67], 0 offen offset:0 sc1
ds_read_b64_tr_b16 v[166:167], v8 offset:34816
v_cvt_pk_bf16_f32 v228, v200, v201
v_mfma_f32_16x16x32_bf16 v[156:159], v[68:71], v[44:47], v[156:159]
ds_read_b128 v[108:111], v3 offset:33536
v_cvt_pk_bf16_f32 v229, v202, v203
v_mfma_f32_16x16x32_bf16 v[128:131], v[72:75], v[48:51], v[128:131]
v_cvt_pk_bf16_f32 v230, v204, v205
ds_read_b64_tr_b16 v[168:169], v7 offset:36864
v_cvt_pk_bf16_f32 v231, v206, v207
v_mfma_f32_16x16x32_bf16 v[132:135], v[76:79], v[48:51], v[132:135]
buffer_store_dwordx4 v[228:231], v9, s[64:67], 0 offen offset:1024 sc1
ds_read_b128 v[112:115], v3 offset:40960
v_cvt_pk_bf16_f32 v232, v208, v209
v_mfma_f32_16x16x32_bf16 v[136:139], v[72:75], v[52:55], v[136:139]
ds_read_b64_tr_b16 v[170:171], v7 offset:38912
v_cvt_pk_bf16_f32 v233, v210, v211
v_mfma_f32_16x16x32_bf16 v[140:143], v[76:79], v[52:55], v[140:143]
v_cvt_pk_bf16_f32 v234, v212, v213
ds_read_b128 v[116:119], v3 offset:41216
v_cvt_pk_bf16_f32 v235, v214, v215
v_mfma_f32_16x16x32_bf16 v[144:147], v[72:75], v[56:59], v[144:147]
buffer_store_dwordx4 v[232:235], v9, s[64:67], 0 offen offset:2048 sc1
ds_read_b64_tr_b16 v[172:173], v8 offset:36864
v_cvt_pk_bf16_f32 v236, v216, v217
v_mfma_f32_16x16x32_bf16 v[148:151], v[76:79], v[56:59], v[148:151]
ds_read_b128 v[120:123], v3 offset:41472
v_cvt_pk_bf16_f32 v237, v218, v219
v_mfma_f32_16x16x32_bf16 v[152:155], v[72:75], v[60:63], v[152:155]
v_cvt_pk_bf16_f32 v238, v220, v221
ds_read_b64_tr_b16 v[174:175], v8 offset:38912
v_cvt_pk_bf16_f32 v239, v222, v223
v_mfma_f32_16x16x32_bf16 v[156:159], v[76:79], v[60:63], v[156:159]
buffer_store_dwordx4 v[236:239], v9, s[64:67], 0 offen offset:3072 sc1
ds_read_b128 v[124:127], v3 offset:41728
s_waitcnt lgkmcnt(0)
s_barrier
v_mfma_f32_16x16x32_bf16 v[128:131], v[160:163], v[96:99], v[128:131]
ds_read_b64_tr_b16 v[64:65], v5 offset:0
v_mfma_f32_16x16x32_bf16 v[132:135], v[164:167], v[96:99], v[132:135]
ds_read_b128 v[32:35], v2 offset:0
v_mfma_f32_16x16x32_bf16 v[136:139], v[160:163], v[100:103], v[136:139]
ds_read_b64_tr_b16 v[66:67], v5 offset:2048
v_mfma_f32_16x16x32_bf16 v[140:143], v[164:167], v[100:103], v[140:143]
ds_read_b128 v[36:39], v2 offset:256
v_mfma_f32_16x16x32_bf16 v[144:147], v[160:163], v[104:107], v[144:147]
ds_read_b64_tr_b16 v[68:69], v6 offset:0
v_mfma_f32_16x16x32_bf16 v[148:151], v[164:167], v[104:107], v[148:151]
ds_read_b128 v[40:43], v2 offset:512
v_mfma_f32_16x16x32_bf16 v[152:155], v[160:163], v[108:111], v[152:155]
ds_read_b64_tr_b16 v[70:71], v6 offset:2048
v_mfma_f32_16x16x32_bf16 v[156:159], v[164:167], v[108:111], v[156:159]
ds_read_b128 v[44:47], v2 offset:768
v_mfma_f32_16x16x32_bf16 v[128:131], v[168:171], v[112:115], v[128:131]
ds_read_b64_tr_b16 v[72:73], v5 offset:4096
v_mfma_f32_16x16x32_bf16 v[132:135], v[172:175], v[112:115], v[132:135]
ds_read_b128 v[48:51], v2 offset:8192
v_mfma_f32_16x16x32_bf16 v[136:139], v[168:171], v[116:119], v[136:139]
ds_read_b64_tr_b16 v[74:75], v5 offset:6144
v_mfma_f32_16x16x32_bf16 v[140:143], v[172:175], v[116:119], v[140:143]
ds_read_b128 v[52:55], v2 offset:8448
v_mfma_f32_16x16x32_bf16 v[144:147], v[168:171], v[120:123], v[144:147]
ds_read_b64_tr_b16 v[76:77], v6 offset:4096
v_mfma_f32_16x16x32_bf16 v[148:151], v[172:175], v[120:123], v[148:151]
ds_read_b128 v[56:59], v2 offset:8704
v_mfma_f32_16x16x32_bf16 v[152:155], v[168:171], v[124:127], v[152:155]
ds_read_b64_tr_b16 v[78:79], v6 offset:6144
v_mfma_f32_16x16x32_bf16 v[156:159], v[172:175], v[124:127], v[156:159]
ds_read_b128 v[60:63], v2 offset:8960
s_waitcnt lgkmcnt(0)
s_barrier
v_mfma_f32_16x16x32_bf16 v[128:131], v[64:67], v[32:35], v[128:131]
ds_read_b64_tr_b16 v[160:161], v5 offset:32768
v_mfma_f32_16x16x32_bf16 v[132:135], v[68:71], v[32:35], v[132:135]
ds_read_b128 v[96:99], v2 offset:32768
v_mfma_f32_16x16x32_bf16 v[136:139], v[64:67], v[36:39], v[136:139]
ds_read_b64_tr_b16 v[162:163], v5 offset:34816
v_mfma_f32_16x16x32_bf16 v[140:143], v[68:71], v[36:39], v[140:143]
ds_read_b128 v[100:103], v2 offset:33024
v_mfma_f32_16x16x32_bf16 v[144:147], v[64:67], v[40:43], v[144:147]
ds_read_b64_tr_b16 v[164:165], v6 offset:32768
v_mfma_f32_16x16x32_bf16 v[148:151], v[68:71], v[40:43], v[148:151]
ds_read_b128 v[104:107], v2 offset:33280
v_mfma_f32_16x16x32_bf16 v[152:155], v[64:67], v[44:47], v[152:155]
ds_read_b64_tr_b16 v[166:167], v6 offset:34816
v_mfma_f32_16x16x32_bf16 v[156:159], v[68:71], v[44:47], v[156:159]
ds_read_b128 v[108:111], v2 offset:33536
v_mfma_f32_16x16x32_bf16 v[128:131], v[72:75], v[48:51], v[128:131]
ds_read_b64_tr_b16 v[168:169], v5 offset:36864
v_mfma_f32_16x16x32_bf16 v[132:135], v[76:79], v[48:51], v[132:135]
ds_read_b128 v[112:115], v2 offset:40960
v_mfma_f32_16x16x32_bf16 v[136:139], v[72:75], v[52:55], v[136:139]
ds_read_b64_tr_b16 v[170:171], v5 offset:38912
v_mfma_f32_16x16x32_bf16 v[140:143], v[76:79], v[52:55], v[140:143]
ds_read_b128 v[116:119], v2 offset:41216
v_mfma_f32_16x16x32_bf16 v[144:147], v[72:75], v[56:59], v[144:147]
ds_read_b64_tr_b16 v[172:173], v6 offset:36864
v_mfma_f32_16x16x32_bf16 v[148:151], v[76:79], v[56:59], v[148:151]
ds_read_b128 v[120:123], v2 offset:41472
v_mfma_f32_16x16x32_bf16 v[152:155], v[72:75], v[60:63], v[152:155]
ds_read_b64_tr_b16 v[174:175], v6 offset:38912
v_mfma_f32_16x16x32_bf16 v[156:159], v[76:79], v[60:63], v[156:159]
ds_read_b128 v[124:127], v2 offset:41728
s_waitcnt vmcnt(0) lgkmcnt(0)
s_barrier
v_mfma_f32_16x16x32_bf16 v[128:131], v[160:163], v[96:99], v[128:131]
ds_read_b64_tr_b16 v[64:65], v7 offset:0
v_mfma_f32_16x16x32_bf16 v[132:135], v[164:167], v[96:99], v[132:135]
ds_read_b128 v[32:35], v3 offset:0
v_mfma_f32_16x16x32_bf16 v[136:139], v[160:163], v[100:103], v[136:139]
ds_read_b64_tr_b16 v[66:67], v7 offset:2048
v_mfma_f32_16x16x32_bf16 v[140:143], v[164:167], v[100:103], v[140:143]
ds_read_b128 v[36:39], v3 offset:256
v_mfma_f32_16x16x32_bf16 v[144:147], v[160:163], v[104:107], v[144:147]
ds_read_b64_tr_b16 v[68:69], v8 offset:0
v_mfma_f32_16x16x32_bf16 v[148:151], v[164:167], v[104:107], v[148:151]
ds_read_b128 v[40:43], v3 offset:512
v_mfma_f32_16x16x32_bf16 v[152:155], v[160:163], v[108:111], v[152:155]
ds_read_b64_tr_b16 v[70:71], v8 offset:2048
v_mfma_f32_16x16x32_bf16 v[156:159], v[164:167], v[108:111], v[156:159]
ds_read_b128 v[44:47], v3 offset:768
v_mfma_f32_16x16x32_bf16 v[128:131], v[168:171], v[112:115], v[128:131]
ds_read_b64_tr_b16 v[72:73], v7 offset:4096
v_mfma_f32_16x16x32_bf16 v[132:135], v[172:175], v[112:115], v[132:135]
ds_read_b128 v[48:51], v3 offset:8192
v_mfma_f32_16x16x32_bf16 v[136:139], v[168:171], v[116:119], v[136:139]
ds_read_b64_tr_b16 v[74:75], v7 offset:6144
v_mfma_f32_16x16x32_bf16 v[140:143], v[172:175], v[116:119], v[140:143]
ds_read_b128 v[52:55], v3 offset:8448
v_mfma_f32_16x16x32_bf16 v[144:147], v[168:171], v[120:123], v[144:147]
ds_read_b64_tr_b16 v[76:77], v8 offset:4096
v_mfma_f32_16x16x32_bf16 v[148:151], v[172:175], v[120:123], v[148:151]
ds_read_b128 v[56:59], v3 offset:8704
v_mfma_f32_16x16x32_bf16 v[152:155], v[168:171], v[124:127], v[152:155]
ds_read_b64_tr_b16 v[78:79], v8 offset:6144
v_mfma_f32_16x16x32_bf16 v[156:159], v[172:175], v[124:127], v[156:159]
ds_read_b128 v[60:63], v3 offset:8960
s_waitcnt lgkmcnt(0)
s_barrier
v_mfma_f32_16x16x32_bf16 v[128:131], v[64:67], v[32:35], v[128:131]
ds_read_b64_tr_b16 v[160:161], v7 offset:32768
v_mfma_f32_16x16x32_bf16 v[132:135], v[68:71], v[32:35], v[132:135]
ds_read_b128 v[96:99], v3 offset:32768
v_mfma_f32_16x16x32_bf16 v[136:139], v[64:67], v[36:39], v[136:139]
ds_read_b64_tr_b16 v[162:163], v7 offset:34816
v_mfma_f32_16x16x32_bf16 v[140:143], v[68:71], v[36:39], v[140:143]
ds_read_b128 v[100:103], v3 offset:33024
v_mfma_f32_16x16x32_bf16 v[144:147], v[64:67], v[40:43], v[144:147]
ds_read_b64_tr_b16 v[164:165], v8 offset:32768
v_mfma_f32_16x16x32_bf16 v[148:151], v[68:71], v[40:43], v[148:151]
ds_read_b128 v[104:107], v3 offset:33280
v_mfma_f32_16x16x32_bf16 v[152:155], v[64:67], v[44:47], v[152:155]
ds_read_b64_tr_b16 v[166:167], v8 offset:34816
v_mfma_f32_16x16x32_bf16 v[156:159], v[68:71], v[44:47], v[156:159]
ds_read_b128 v[108:111], v3 offset:33536
v_mfma_f32_16x16x32_bf16 v[128:131], v[72:75], v[48:51], v[128:131]
ds_read_b64_tr_b16 v[168:169], v7 offset:36864
v_mfma_f32_16x16x32_bf16 v[132:135], v[76:79], v[48:51], v[132:135]
ds_read_b128 v[112:115], v3 offset:40960
v_mfma_f32_16x16x32_bf16 v[136:139], v[72:75], v[52:55], v[136:139]
ds_read_b64_tr_b16 v[170:171], v7 offset:38912
v_mfma_f32_16x16x32_bf16 v[140:143], v[76:79], v[52:55], v[140:143]
ds_read_b128 v[116:119], v3 offset:41216
v_mfma_f32_16x16x32_bf16 v[144:147], v[72:75], v[56:59], v[144:147]
ds_read_b64_tr_b16 v[172:173], v8 offset:36864
v_mfma_f32_16x16x32_bf16 v[148:151], v[76:79], v[56:59], v[148:151]
ds_read_b128 v[120:123], v3 offset:41472
v_mfma_f32_16x16x32_bf16 v[152:155], v[72:75], v[60:63], v[152:155]
ds_read_b64_tr_b16 v[174:175], v8 offset:38912
v_mfma_f32_16x16x32_bf16 v[156:159], v[76:79], v[60:63], v[156:159]
ds_read_b128 v[124:127], v3 offset:41728
s_waitcnt lgkmcnt(0)
s_barrier
v_mfma_f32_16x16x32_bf16 v[128:131], v[160:163], v[96:99], v[128:131]
ds_read_b64_tr_b16 v[64:65], v5 offset:0
v_mfma_f32_16x16x32_bf16 v[132:135], v[164:167], v[96:99], v[132:135]
ds_read_b128 v[32:35], v2 offset:0
v_mfma_f32_16x16x32_bf16 v[136:139], v[160:163], v[100:103], v[136:139]
ds_read_b64_tr_b16 v[66:67], v5 offset:2048
v_mfma_f32_16x16x32_bf16 v[140:143], v[164:167], v[100:103], v[140:143]
ds_read_b128 v[36:39], v2 offset:256
v_mfma_f32_16x16x32_bf16 v[144:147], v[160:163], v[104:107], v[144:147]
ds_read_b64_tr_b16 v[68:69], v6 offset:0
v_mfma_f32_16x16x32_bf16 v[148:151], v[164:167], v[104:107], v[148:151]
ds_read_b128 v[40:43], v2 offset:512
v_mfma_f32_16x16x32_bf16 v[152:155], v[160:163], v[108:111], v[152:155]
ds_read_b64_tr_b16 v[70:71], v6 offset:2048
v_mfma_f32_16x16x32_bf16 v[156:159], v[164:167], v[108:111], v[156:159]
ds_read_b128 v[44:47], v2 offset:768
v_mfma_f32_16x16x32_bf16 v[128:131], v[168:171], v[112:115], v[128:131]
ds_read_b64_tr_b16 v[72:73], v5 offset:4096
v_mfma_f32_16x16x32_bf16 v[132:135], v[172:175], v[112:115], v[132:135]
ds_read_b128 v[48:51], v2 offset:8192
v_mfma_f32_16x16x32_bf16 v[136:139], v[168:171], v[116:119], v[136:139]
ds_read_b64_tr_b16 v[74:75], v5 offset:6144
v_mfma_f32_16x16x32_bf16 v[140:143], v[172:175], v[116:119], v[140:143]
ds_read_b128 v[52:55], v2 offset:8448
v_mfma_f32_16x16x32_bf16 v[144:147], v[168:171], v[120:123], v[144:147]
ds_read_b64_tr_b16 v[76:77], v6 offset:4096
v_mfma_f32_16x16x32_bf16 v[148:151], v[172:175], v[120:123], v[148:151]
ds_read_b128 v[56:59], v2 offset:8704
v_mfma_f32_16x16x32_bf16 v[152:155], v[168:171], v[124:127], v[152:155]
ds_read_b64_tr_b16 v[78:79], v6 offset:6144
v_mfma_f32_16x16x32_bf16 v[156:159], v[172:175], v[124:127], v[156:159]
ds_read_b128 v[60:63], v2 offset:8960
s_waitcnt lgkmcnt(0)
s_barrier
v_mfma_f32_16x16x32_bf16 v[128:131], v[64:67], v[32:35], v[128:131]
ds_read_b64_tr_b16 v[160:161], v5 offset:32768
v_mfma_f32_16x16x32_bf16 v[132:135], v[68:71], v[32:35], v[132:135]
ds_read_b128 v[96:99], v2 offset:32768
v_mfma_f32_16x16x32_bf16 v[136:139], v[64:67], v[36:39], v[136:139]
ds_read_b64_tr_b16 v[162:163], v5 offset:34816
v_mfma_f32_16x16x32_bf16 v[140:143], v[68:71], v[36:39], v[140:143]
ds_read_b128 v[100:103], v2 offset:33024
v_mfma_f32_16x16x32_bf16 v[144:147], v[64:67], v[40:43], v[144:147]
ds_read_b64_tr_b16 v[164:165], v6 offset:32768
v_mfma_f32_16x16x32_bf16 v[148:151], v[68:71], v[40:43], v[148:151]
ds_read_b128 v[104:107], v2 offset:33280
v_mfma_f32_16x16x32_bf16 v[152:155], v[64:67], v[44:47], v[152:155]
ds_read_b64_tr_b16 v[166:167], v6 offset:34816
v_mfma_f32_16x16x32_bf16 v[156:159], v[68:71], v[44:47], v[156:159]
ds_read_b128 v[108:111], v2 offset:33536
v_mfma_f32_16x16x32_bf16 v[128:131], v[72:75], v[48:51], v[128:131]
ds_read_b64_tr_b16 v[168:169], v5 offset:36864
v_mfma_f32_16x16x32_bf16 v[132:135], v[76:79], v[48:51], v[132:135]
ds_read_b128 v[112:115], v2 offset:40960
v_mfma_f32_16x16x32_bf16 v[136:139], v[72:75], v[52:55], v[136:139]
ds_read_b64_tr_b16 v[170:171], v5 offset:38912
v_mfma_f32_16x16x32_bf16 v[140:143], v[76:79], v[52:55], v[140:143]
ds_read_b128 v[116:119], v2 offset:41216
v_mfma_f32_16x16x32_bf16 v[144:147], v[72:75], v[56:59], v[144:147]
ds_read_b64_tr_b16 v[172:173], v6 offset:36864
v_mfma_f32_16x16x32_bf16 v[148:151], v[76:79], v[56:59], v[148:151]
ds_read_b128 v[120:123], v2 offset:41472
v_mfma_f32_16x16x32_bf16 v[152:155], v[72:75], v[60:63], v[152:155]
ds_read_b64_tr_b16 v[174:175], v6 offset:38912
v_mfma_f32_16x16x32_bf16 v[156:159], v[76:79], v[60:63], v[156:159]
ds_read_b128 v[124:127], v2 offset:41728
s_waitcnt lgkmcnt(0)
s_barrier
v_mfma_f32_16x16x32_bf16 v[128:131], v[160:163], v[96:99], v[128:131]
ds_read_b64_tr_b16 v[64:65], v7 offset:0
v_mfma_f32_16x16x32_bf16 v[132:135], v[164:167], v[96:99], v[132:135]
ds_read_b128 v[32:35], v3 offset:0
v_mfma_f32_16x16x32_bf16 v[136:139], v[160:163], v[100:103], v[136:139]
ds_read_b64_tr_b16 v[66:67], v7 offset:2048
v_mfma_f32_16x16x32_bf16 v[140:143], v[164:167], v[100:103], v[140:143]
ds_read_b128 v[36:39], v3 offset:256
v_mfma_f32_16x16x32_bf16 v[144:147], v[160:163], v[104:107], v[144:147]
ds_read_b64_tr_b16 v[68:69], v8 offset:0
v_mfma_f32_16x16x32_bf16 v[148:151], v[164:167], v[104:107], v[148:151]
ds_read_b128 v[40:43], v3 offset:512
v_mfma_f32_16x16x32_bf16 v[152:155], v[160:163], v[108:111], v[152:155]
ds_read_b64_tr_b16 v[70:71], v8 offset:2048
v_mfma_f32_16x16x32_bf16 v[156:159], v[164:167], v[108:111], v[156:159]
ds_read_b128 v[44:47], v3 offset:768
v_mfma_f32_16x16x32_bf16 v[128:131], v[168:171], v[112:115], v[128:131]
ds_read_b64_tr_b16 v[72:73], v7 offset:4096
v_mfma_f32_16x16x32_bf16 v[132:135], v[172:175], v[112:115], v[132:135]
ds_read_b128 v[48:51], v3 offset:8192
v_mfma_f32_16x16x32_bf16 v[136:139], v[168:171], v[116:119], v[136:139]
ds_read_b64_tr_b16 v[74:75], v7 offset:6144
v_mfma_f32_16x16x32_bf16 v[140:143], v[172:175], v[116:119], v[140:143]
ds_read_b128 v[52:55], v3 offset:8448
v_mfma_f32_16x16x32_bf16 v[144:147], v[168:171], v[120:123], v[144:147]
ds_read_b64_tr_b16 v[76:77], v8 offset:4096
v_mfma_f32_16x16x32_bf16 v[148:151], v[172:175], v[120:123], v[148:151]
ds_read_b128 v[56:59], v3 offset:8704
v_mfma_f32_16x16x32_bf16 v[152:155], v[168:171], v[124:127], v[152:155]
ds_read_b64_tr_b16 v[78:79], v8 offset:6144
v_mfma_f32_16x16x32_bf16 v[156:159], v[172:175], v[124:127], v[156:159]
ds_read_b128 v[60:63], v3 offset:8960
s_waitcnt lgkmcnt(0)
s_barrier
v_mfma_f32_16x16x32_bf16 v[128:131], v[64:67], v[32:35], v[128:131]
ds_read_b64_tr_b16 v[160:161], v7 offset:32768
v_mfma_f32_16x16x32_bf16 v[132:135], v[68:71], v[32:35], v[132:135]
ds_read_b128 v[96:99], v3 offset:32768
v_mfma_f32_16x16x32_bf16 v[136:139], v[64:67], v[36:39], v[136:139]
ds_read_b64_tr_b16 v[162:163], v7 offset:34816
v_mfma_f32_16x16x32_bf16 v[140:143], v[68:71], v[36:39], v[140:143]
ds_read_b128 v[100:103], v3 offset:33024
v_mfma_f32_16x16x32_bf16 v[144:147], v[64:67], v[40:43], v[144:147]
ds_read_b64_tr_b16 v[164:165], v8 offset:32768
v_mfma_f32_16x16x32_bf16 v[148:151], v[68:71], v[40:43], v[148:151]
ds_read_b128 v[104:107], v3 offset:33280
v_mfma_f32_16x16x32_bf16 v[152:155], v[64:67], v[44:47], v[152:155]
ds_read_b64_tr_b16 v[166:167], v8 offset:34816
v_mfma_f32_16x16x32_bf16 v[156:159], v[68:71], v[44:47], v[156:159]
ds_read_b128 v[108:111], v3 offset:33536
v_mfma_f32_16x16x32_bf16 v[128:131], v[72:75], v[48:51], v[128:131]
ds_read_b64_tr_b16 v[168:169], v7 offset:36864
v_mfma_f32_16x16x32_bf16 v[132:135], v[76:79], v[48:51], v[132:135]
ds_read_b128 v[112:115], v3 offset:40960
v_mfma_f32_16x16x32_bf16 v[136:139], v[72:75], v[52:55], v[136:139]
ds_read_b64_tr_b16 v[170:171], v7 offset:38912
v_mfma_f32_16x16x32_bf16 v[140:143], v[76:79], v[52:55], v[140:143]
ds_read_b128 v[116:119], v3 offset:41216
v_mfma_f32_16x16x32_bf16 v[144:147], v[72:75], v[56:59], v[144:147]
ds_read_b64_tr_b16 v[172:173], v8 offset:36864
v_mfma_f32_16x16x32_bf16 v[148:151], v[76:79], v[56:59], v[148:151]
ds_read_b128 v[120:123], v3 offset:41472
v_mfma_f32_16x16x32_bf16 v[152:155], v[72:75], v[60:63], v[152:155]
ds_read_b64_tr_b16 v[174:175], v8 offset:38912
v_mfma_f32_16x16x32_bf16 v[156:159], v[76:79], v[60:63], v[156:159]
ds_read_b128 v[124:127], v3 offset:41728
s_waitcnt lgkmcnt(0)
s_barrier
v_mfma_f32_16x16x32_bf16 v[128:131], v[160:163], v[96:99], v[128:131]
ds_read_b64_tr_b16 v[64:65], v5 offset:0
v_mfma_f32_16x16x32_bf16 v[132:135], v[164:167], v[96:99], v[132:135]
ds_read_b128 v[32:35], v2 offset:0
v_mfma_f32_16x16x32_bf16 v[136:139], v[160:163], v[100:103], v[136:139]
ds_read_b64_tr_b16 v[66:67], v5 offset:2048
v_mfma_f32_16x16x32_bf16 v[140:143], v[164:167], v[100:103], v[140:143]
ds_read_b128 v[36:39], v2 offset:256
buffer_load_dwordx4 v[192:195], v9, s[68:71], 0 offen offset:0 sc1
v_mfma_f32_16x16x32_bf16 v[144:147], v[160:163], v[104:107], v[144:147]
ds_read_b64_tr_b16 v[68:69], v6 offset:0
v_mfma_f32_16x16x32_bf16 v[148:151], v[164:167], v[104:107], v[148:151]
ds_read_b128 v[40:43], v2 offset:512
v_mfma_f32_16x16x32_bf16 v[152:155], v[160:163], v[108:111], v[152:155]
ds_read_b64_tr_b16 v[70:71], v6 offset:2048
buffer_load_dwordx4 v[196:199], v9, s[68:71], 0 offen offset:1024 sc1
v_mfma_f32_16x16x32_bf16 v[156:159], v[164:167], v[108:111], v[156:159]
ds_read_b128 v[44:47], v2 offset:768
v_mfma_f32_16x16x32_bf16 v[128:131], v[168:171], v[112:115], v[128:131]
ds_read_b64_tr_b16 v[72:73], v5 offset:4096
v_mfma_f32_16x16x32_bf16 v[132:135], v[172:175], v[112:115], v[132:135]
ds_read_b128 v[48:51], v2 offset:8192
buffer_load_dwordx4 v[200:203], v9, s[68:71], 0 offen offset:2048 sc1
v_mfma_f32_16x16x32_bf16 v[136:139], v[168:171], v[116:119], v[136:139]
ds_read_b64_tr_b16 v[74:75], v5 offset:6144
v_mfma_f32_16x16x32_bf16 v[140:143], v[172:175], v[116:119], v[140:143]
ds_read_b128 v[52:55], v2 offset:8448
v_mfma_f32_16x16x32_bf16 v[144:147], v[168:171], v[120:123], v[144:147]
ds_read_b64_tr_b16 v[76:77], v6 offset:4096
buffer_load_dwordx4 v[204:207], v9, s[68:71], 0 offen offset:3072 sc1
v_mfma_f32_16x16x32_bf16 v[148:151], v[172:175], v[120:123], v[148:151]
ds_read_b128 v[56:59], v2 offset:8704
v_mfma_f32_16x16x32_bf16 v[152:155], v[168:171], v[124:127], v[152:155]
ds_read_b64_tr_b16 v[78:79], v6 offset:6144
v_mfma_f32_16x16x32_bf16 v[156:159], v[172:175], v[124:127], v[156:159]
ds_read_b128 v[60:63], v2 offset:8960
s_waitcnt lgkmcnt(0)
s_barrier
v_mfma_f32_16x16x32_bf16 v[128:131], v[64:67], v[32:35], v[128:131]
ds_read_b64_tr_b16 v[160:161], v5 offset:32768
v_mfma_f32_16x16x32_bf16 v[132:135], v[68:71], v[32:35], v[132:135]
ds_read_b128 v[96:99], v2 offset:32768
v_mfma_f32_16x16x32_bf16 v[136:139], v[64:67], v[36:39], v[136:139]
ds_read_b64_tr_b16 v[162:163], v5 offset:34816
v_mfma_f32_16x16x32_bf16 v[140:143], v[68:71], v[36:39], v[140:143]
ds_read_b128 v[100:103], v2 offset:33024
v_mfma_f32_16x16x32_bf16 v[144:147], v[64:67], v[40:43], v[144:147]
ds_read_b64_tr_b16 v[164:165], v6 offset:32768
v_mfma_f32_16x16x32_bf16 v[148:151], v[68:71], v[40:43], v[148:151]
ds_read_b128 v[104:107], v2 offset:33280
v_mfma_f32_16x16x32_bf16 v[152:155], v[64:67], v[44:47], v[152:155]
ds_read_b64_tr_b16 v[166:167], v6 offset:34816
v_mfma_f32_16x16x32_bf16 v[156:159], v[68:71], v[44:47], v[156:159]
ds_read_b128 v[108:111], v2 offset:33536
v_mfma_f32_16x16x32_bf16 v[128:131], v[72:75], v[48:51], v[128:131]
ds_read_b64_tr_b16 v[168:169], v5 offset:36864
v_mfma_f32_16x16x32_bf16 v[132:135], v[76:79], v[48:51], v[132:135]
ds_read_b128 v[112:115], v2 offset:40960
v_mfma_f32_16x16x32_bf16 v[136:139], v[72:75], v[52:55], v[136:139]
ds_read_b64_tr_b16 v[170:171], v5 offset:38912
v_mfma_f32_16x16x32_bf16 v[140:143], v[76:79], v[52:55], v[140:143]
ds_read_b128 v[116:119], v2 offset:41216
v_mfma_f32_16x16x32_bf16 v[144:147], v[72:75], v[56:59], v[144:147]
ds_read_b64_tr_b16 v[172:173], v6 offset:36864
v_mfma_f32_16x16x32_bf16 v[148:151], v[76:79], v[56:59], v[148:151]
ds_read_b128 v[120:123], v2 offset:41472
v_mfma_f32_16x16x32_bf16 v[152:155], v[72:75], v[60:63], v[152:155]
ds_read_b64_tr_b16 v[174:175], v6 offset:38912
v_mfma_f32_16x16x32_bf16 v[156:159], v[76:79], v[60:63], v[156:159]
ds_read_b128 v[124:127], v2 offset:41728
s_waitcnt lgkmcnt(0)
s_barrier
v_mfma_f32_16x16x32_bf16 v[128:131], v[160:163], v[96:99], v[128:131]
v_mfma_f32_16x16x32_bf16 v[132:135], v[164:167], v[96:99], v[132:135]
v_mfma_f32_16x16x32_bf16 v[136:139], v[160:163], v[100:103], v[136:139]
v_mfma_f32_16x16x32_bf16 v[140:143], v[164:167], v[100:103], v[140:143]
v_mfma_f32_16x16x32_bf16 v[144:147], v[160:163], v[104:107], v[144:147]
v_mfma_f32_16x16x32_bf16 v[148:151], v[164:167], v[104:107], v[148:151]
v_mfma_f32_16x16x32_bf16 v[152:155], v[160:163], v[108:111], v[152:155]
v_mfma_f32_16x16x32_bf16 v[156:159], v[164:167], v[108:111], v[156:159]
s_waitcnt vmcnt(0)
v_mfma_f32_16x16x32_bf16 v[128:131], v[168:171], v[112:115], v[128:131]
v_lshlrev_b32 v224, 16, v192
v_and_b32 v225, 0xffff0000, v192
v_lshlrev_b32 v226, 16, v193
v_and_b32 v227, 0xffff0000, v193
v_mfma_f32_16x16x32_bf16 v[132:135], v[172:175], v[112:115], v[132:135]
v_lshlrev_b32 v228, 16, v194
v_and_b32 v229, 0xffff0000, v194
v_lshlrev_b32 v230, 16, v195
v_and_b32 v231, 0xffff0000, v195
v_mfma_f32_16x16x32_bf16 v[136:139], v[168:171], v[116:119], v[136:139]
v_lshlrev_b32 v232, 16, v196
v_and_b32 v233, 0xffff0000, v196
v_lshlrev_b32 v234, 16, v197
v_and_b32 v235, 0xffff0000, v197
v_mfma_f32_16x16x32_bf16 v[140:143], v[172:175], v[116:119], v[140:143]
v_lshlrev_b32 v236, 16, v198
v_and_b32 v237, 0xffff0000, v198
v_lshlrev_b32 v238, 16, v199
v_and_b32 v239, 0xffff0000, v199
v_mfma_f32_16x16x32_bf16 v[144:147], v[168:171], v[120:123], v[144:147]
v_lshlrev_b32 v240, 16, v200
v_and_b32 v241, 0xffff0000, v200
v_lshlrev_b32 v242, 16, v201
v_and_b32 v243, 0xffff0000, v201
v_mfma_f32_16x16x32_bf16 v[148:151], v[172:175], v[120:123], v[148:151]
v_lshlrev_b32 v244, 16, v202
v_and_b32 v245, 0xffff0000, v202
v_lshlrev_b32 v246, 16, v203
v_and_b32 v247, 0xffff0000, v203
v_mfma_f32_16x16x32_bf16 v[152:155], v[168:171], v[124:127], v[152:155]
v_lshlrev_b32 v248, 16, v204
v_and_b32 v249, 0xffff0000, v204
v_lshlrev_b32 v250, 16, v205
v_and_b32 v251, 0xffff0000, v205
v_mfma_f32_16x16x32_bf16 v[156:159], v[172:175], v[124:127], v[156:159]
v_lshlrev_b32 v252, 16, v206
v_and_b32 v253, 0xffff0000, v206
v_lshlrev_b32 v254, 16, v207
v_and_b32 v255, 0xffff0000, v207
s_waitcnt vmcnt(0)
s_nop 4
v_pk_add_f32 v[128:129], v[128:129], v[224:225]
v_pk_add_f32 v[130:131], v[130:131], v[226:227]
v_pk_add_f32 v[132:133], v[132:133], v[228:229]
v_pk_add_f32 v[134:135], v[134:135], v[230:231]
v_cvt_pk_bf16_f32 v32, v128, v129
v_cvt_pk_bf16_f32 v33, v130, v131
v_cvt_pk_bf16_f32 v34, v132, v133
v_cvt_pk_bf16_f32 v35, v134, v135
v_pk_add_f32 v[136:137], v[136:137], v[232:233]
v_pk_add_f32 v[138:139], v[138:139], v[234:235]
v_pk_add_f32 v[140:141], v[140:141], v[236:237]
v_pk_add_f32 v[142:143], v[142:143], v[238:239]
v_cvt_pk_bf16_f32 v36, v136, v137
v_cvt_pk_bf16_f32 v37, v138, v139
v_cvt_pk_bf16_f32 v38, v140, v141
v_cvt_pk_bf16_f32 v39, v142, v143
v_pk_add_f32 v[144:145], v[144:145], v[240:241]
v_pk_add_f32 v[146:147], v[146:147], v[242:243]
v_pk_add_f32 v[148:149], v[148:149], v[244:245]
v_pk_add_f32 v[150:151], v[150:151], v[246:247]
v_cvt_pk_bf16_f32 v40, v144, v145
v_cvt_pk_bf16_f32 v41, v146, v147
v_cvt_pk_bf16_f32 v42, v148, v149
v_cvt_pk_bf16_f32 v43, v150, v151
v_pk_add_f32 v[152:153], v[152:153], v[248:249]
v_pk_add_f32 v[154:155], v[154:155], v[250:251]
v_pk_add_f32 v[156:157], v[156:157], v[252:253]
v_pk_add_f32 v[158:159], v[158:159], v[254:255]
v_cvt_pk_bf16_f32 v44, v152, v153
v_cvt_pk_bf16_f32 v45, v154, v155
v_cvt_pk_bf16_f32 v46, v156, v157
v_cvt_pk_bf16_f32 v47, v158, v159
v_permlane16_swap_b32 v32, v34
v_permlane16_swap_b32 v33, v35
buffer_store_dwordx4 v[32:35], v28, s[16:19], 0 offen offset:0
v_permlane16_swap_b32 v36, v38
v_permlane16_swap_b32 v37, v39
buffer_store_dwordx4 v[36:39], v28, s[16:19], 0 offen offset:2048
v_permlane16_swap_b32 v40, v42
v_permlane16_swap_b32 v41, v43
buffer_store_dwordx4 v[40:43], v28, s[16:19], s54 offen offset:0
v_permlane16_swap_b32 v44, v46
v_permlane16_swap_b32 v45, v47
buffer_store_dwordx4 v[44:47], v28, s[16:19], s54 offen offset:2048
s_branch Ldone_1
.p2align 6
Lw_19:
s_branch Lr_20
s_nop 0
.p2align 3
LG1_42:
s_cmp_eq_u32 s36, 7
s_cbranch_scc1 L7_81
s_mul_i32 s44, s34, 262144
s_lshl_b32 s39, s51, 13
s_add_u32 s44, s44, s39
s_add_u32 s44, s44, 0
s_lshl_b32 s43, s35, 7
s_mov_b32 s10, 253952
s_movk_i32 s38, 1024
s_movk_i32 s40, 9216
s_cmp_eq_u32 s51, 2
s_cselect_b32 s8, s28, s32
s_cselect_b32 s9, s29, s33
s_cselect_b32 s10, 2095232, s10
s_cselect_b32 s43, s43, s44
s_cselect_b32 s38, 16384, s38
s_cselect_b32 s40, 16384, s40
s_cselect_b32 s55, 16384, s38
s_cselect_b32 s45, -1, 0
s_add_u32 s8, s8, s43
s_addc_u32 s9, s9, 0
s_mov_b32 s11, 0x20000
s_sub_u32 s37, 0, s40
v_lshrrev_b32 v19, 3, v1
v_mul_u32_u24 v19, 1920, v19
v_lshrrev_b32 v20, 4, v1
v_lshlrev_b32 v20, 5, v20
v_and_b32 v19, s45, v19
v_and_b32 v20, s45, v20
v_lshlrev_b32 v23, 4, v1
v_xor_b32 v23, v23, v20
v_add_u32 v23, v23, v19
s_lshl_b32 s43, s34, 18
s_add_u32 s12, s32, s43
s_addc_u32 s13, s33, 0
s_mov_b32 s14, 262144
s_mov_b32 s15, 0x20000
v_lshlrev_b32 v21, 4, v1
s_lshl_b32 s54, s36, 11
s_add_u32 s43, s35, 1
s_and_b32 s43, s43, 15
s_lshl_b32 s43, s43, 14
s_add_u32 s30, s43, s54
s_add_u32 s43, s35, 2
s_and_b32 s43, s43, 15
s_lshl_b32 s43, s43, 14
s_add_u32 s31, s43, s54
s_cmp_eq_u32 s51, 1
s_cbranch_scc1 Lp_85
s_cmp_eq_u32 s51, 2
s_cbranch_scc1 Lp_86
.p2align 3
Lp_84:
s_add_u32 s42, s35, 2
s_waitcnt vmcnt(0)
s_barrier
ds_write_b128 v27, v[68:71] offset:0
ds_write_b128 v27, v[116:119] offset:512
s_add_u32 s43, s34, 0
s_lshl_b32 s43, s43, 7
v_mov_b32 v8, s43
v_mov_b32 v10, 16
buffer_load_dword v9, v8, s[56:59], 0 offen sc1
s_mov_b32 s41, 0x10000
Lpoll_87:
s_waitcnt vmcnt(0)
Lpf_89:
v_cmp_ne_u32 vcc, v10, v9
s_nop 4
s_cbranch_vccz Lpok_88
buffer_load_dword v9, v8, s[56:59], 0 offen sc1
s_sub_u32 s41, s41, 1
s_cmp_lg_u32 s41, 0
s_cbranch_scc1 Lpoll_87
s_waitcnt vmcnt(0)
Lpok_88:
s_waitcnt lgkmcnt(0)
s_barrier
s_add_u32 m0, s54, 16384
s_add_u32 s43, s30, 0
buffer_load_dwordx4 v21, s[12:15], s43 offen sc1 lds
s_add_u32 m0, s54, 17408
s_add_u32 s43, s30, 1024
buffer_load_dwordx4 v21, s[12:15], s43 offen sc1 lds
s_add_u32 m0, s54, 32768
s_add_u32 s43, s31, 0
buffer_load_dwordx4 v21, s[12:15], s43 offen sc1 lds
s_add_u32 m0, s54, 33792
s_add_u32 s43, s31, 1024
buffer_load_dwordx4 v21, s[12:15], s43 offen sc1 lds
s_add_u32 s42, s42, 1
s_and_b32 s42, s42, 15
s_add_u32 m0, s39, 49152
s_lshl_b32 s37, s42, 14
buffer_load_dwordx4 v23, s[8:11], s37 offen sc1 lds
s_add_u32 m0, s39, 50176
s_add_u32 s37, s37, s38
buffer_load_dwordx4 v23, s[8:11], s37 offen sc1 lds
s_add_u32 m0, s39, 51200
s_add_u32 s37, s37, s38
buffer_load_dwordx4 v23, s[8:11], s37 offen sc1 lds
s_add_u32 m0, s39, 52224
s_add_u32 s37, s37, s38
buffer_load_dwordx4 v23, s[8:11], s37 offen sc1 lds
s_add_u32 m0, s39, 53248
s_add_u32 s37, s37, s38
buffer_load_dwordx4 v23, s[8:11], s37 offen sc1 lds
s_add_u32 m0, s39, 54272
s_add_u32 s37, s37, s38
buffer_load_dwordx4 v23, s[8:11], s37 offen sc1 lds
s_add_u32 m0, s39, 55296
s_add_u32 s37, s37, s38
buffer_load_dwordx4 v23, s[8:11], s37 offen sc1 lds
s_add_u32 m0, s39, 56320
s_add_u32 s37, s37, s38
buffer_load_dwordx4 v23, s[8:11], s37 offen sc1 lds
s_waitcnt vmcnt(10)
s_barrier
s_add_u32 s42, s42, 1
s_and_b32 s42, s42, 15
s_add_u32 m0, s39, 0
s_lshl_b32 s37, s42, 14
buffer_load_dwordx4 v23, s[8:11], s37 offen sc1 lds
s_add_u32 m0, s39, 1024
s_add_u32 s37, s37, s38
buffer_load_dwordx4 v23, s[8:11], s37 offen sc1 lds
s_add_u32 m0, s39, 2048
s_add_u32 s37, s37, s38
buffer_load_dwordx4 v23, s[8:11], s37 offen sc1 lds
s_add_u32 m0, s39, 3072
s_add_u32 s37, s37, s38
buffer_load_dwordx4 v23, s[8:11], s37 offen sc1 lds
s_add_u32 m0, s39, 4096
s_add_u32 s37, s37, s38
buffer_load_dwordx4 v23, s[8:11], s37 offen sc1 lds
s_add_u32 m0, s39, 5120
s_add_u32 s37, s37, s38
buffer_load_dwordx4 v23, s[8:11], s37 offen sc1 lds
s_add_u32 m0, s39, 6144
s_add_u32 s37, s37, s38
buffer_load_dwordx4 v23, s[8:11], s37 offen sc1 lds
s_add_u32 m0, s39, 7168
s_add_u32 s37, s37, s38
buffer_load_dwordx4 v23, s[8:11], s37 offen sc1 lds
s_waitcnt vmcnt(16)
s_barrier
s_add_u32 s42, s42, 1
s_and_b32 s42, s42, 15
s_add_u32 m0, s39, 16384
s_lshl_b32 s37, s42, 14
buffer_load_dwordx4 v23, s[8:11], s37 offen sc1 lds
s_add_u32 m0, s39, 17408
s_add_u32 s37, s37, s38
buffer_load_dwordx4 v23, s[8:11], s37 offen sc1 lds
s_add_u32 m0, s39, 18432
s_add_u32 s37, s37, s38
buffer_load_dwordx4 v23, s[8:11], s37 offen sc1 lds
s_add_u32 m0, s39, 19456
s_add_u32 s37, s37, s38
buffer_load_dwordx4 v23, s[8:11], s37 offen sc1 lds
s_add_u32 m0, s39, 20480
s_add_u32 s37, s37, s38
buffer_load_dwordx4 v23, s[8:11], s37 offen sc1 lds
s_add_u32 m0, s39, 21504
s_add_u32 s37, s37, s38
buffer_load_dwordx4 v23, s[8:11], s37 offen sc1 lds
s_add_u32 m0, s39, 22528
s_add_u32 s37, s37, s38
buffer_load_dwordx4 v23, s[8:11], s37 offen sc1 lds
s_add_u32 m0, s39, 23552
s_add_u32 s37, s37, s38
buffer_load_dwordx4 v23, s[8:11], s37 offen sc1 lds
s_waitcnt vmcnt(16)
s_barrier
s_add_u32 s42, s42, 1
s_and_b32 s42, s42, 15
s_add_u32 m0, s39, 32768
s_lshl_b32 s37, s42, 14
buffer_load_dwordx4 v23, s[8:11], s37 offen sc1 lds
s_add_u32 m0, s39, 33792
s_add_u32 s37, s37, s38
buffer_load_dwordx4 v23, s[8:11], s37 offen sc1 lds
s_add_u32 m0, s39, 34816
s_add_u32 s37, s37, s38
buffer_load_dwordx4 v23, s[8:11], s37 offen sc1 lds
s_add_u32 m0, s39, 35840
s_add_u32 s37, s37, s38
buffer_load_dwordx4 v23, s[8:11], s37 offen sc1 lds
s_add_u32 m0, s39, 36864
s_add_u32 s37, s37, s38
buffer_load_dwordx4 v23, s[8:11], s37 offen sc1 lds
s_add_u32 m0, s39, 37888
s_add_u32 s37, s37, s38
buffer_load_dwordx4 v23, s[8:11], s37 offen sc1 lds
s_add_u32 m0, s39, 38912
s_add_u32 s37, s37, s38
buffer_load_dwordx4 v23, s[8:11], s37 offen sc1 lds
s_add_u32 m0, s39, 39936
s_add_u32 s37, s37, s38
buffer_load_dwordx4 v23, s[8:11], s37 offen sc1 lds
s_waitcnt vmcnt(16)
s_barrier
s_add_u32 s42, s42, 1
s_and_b32 s42, s42, 15
s_add_u32 m0, s39, 49152
s_lshl_b32 s37, s42, 14
buffer_load_dwordx4 v23, s[8:11], s37 offen sc1 lds
s_add_u32 m0, s39, 50176
s_add_u32 s37, s37, s38
buffer_load_dwordx4 v23, s[8:11], s37 offen sc1 lds
s_add_u32 m0, s39, 51200
s_add_u32 s37, s37, s38
buffer_load_dwordx4 v23, s[8:11], s37 offen sc1 lds
s_add_u32 m0, s39, 52224
s_add_u32 s37, s37, s38
buffer_load_dwordx4 v23, s[8:11], s37 offen sc1 lds
s_add_u32 m0, s39, 53248
s_add_u32 s37, s37, s38
buffer_load_dwordx4 v23, s[8:11], s37 offen sc1 lds
s_add_u32 m0, s39, 54272
s_add_u32 s37, s37, s38
buffer_load_dwordx4 v23, s[8:11], s37 offen sc1 lds
s_add_u32 m0, s39, 55296
s_add_u32 s37, s37, s38
buffer_load_dwordx4 v23, s[8:11], s37 offen sc1 lds
s_add_u32 m0, s39, 56320
s_add_u32 s37, s37, s38
buffer_load_dwordx4 v23, s[8:11], s37 offen sc1 lds
s_waitcnt vmcnt(16)
s_barrier
s_add_u32 s42, s42, 1
s_and_b32 s42, s42, 15
s_add_u32 m0, s39, 0
s_lshl_b32 s37, s42, 14
buffer_load_dwordx4 v23, s[8:11], s37 offen sc1 lds
s_add_u32 m0, s39, 1024
s_add_u32 s37, s37, s38
buffer_load_dwordx4 v23, s[8:11], s37 offen sc1 lds
s_add_u32 m0, s39, 2048
s_add_u32 s37, s37, s38
buffer_load_dwordx4 v23, s[8:11], s37 offen sc1 lds
s_add_u32 m0, s39, 3072
s_add_u32 s37, s37, s38
buffer_load_dwordx4 v23, s[8:11], s37 offen sc1 lds
s_add_u32 m0, s39, 4096
s_add_u32 s37, s37, s38
buffer_load_dwordx4 v23, s[8:11], s37 offen sc1 lds
s_add_u32 m0, s39, 5120
s_add_u32 s37, s37, s38
buffer_load_dwordx4 v23, s[8:11], s37 offen sc1 lds
s_add_u32 m0, s39, 6144
s_add_u32 s37, s37, s38
buffer_load_dwordx4 v23, s[8:11], s37 offen sc1 lds
s_add_u32 m0, s39, 7168
s_add_u32 s37, s37, s38
buffer_load_dwordx4 v23, s[8:11], s37 offen sc1 lds
s_waitcnt vmcnt(16)
s_barrier
s_add_u32 s42, s42, 1
s_and_b32 s42, s42, 15
s_add_u32 m0, s39, 16384
s_lshl_b32 s37, s42, 14
buffer_load_dwordx4 v23, s[8:11], s37 offen sc1 lds
s_add_u32 m0, s39, 17408
s_add_u32 s37, s37, s38
buffer_load_dwordx4 v23, s[8:11], s37 offen sc1 lds
s_add_u32 m0, s39, 18432
s_add_u32 s37, s37, s38
buffer_load_dwordx4 v23, s[8:11], s37 offen sc1 lds
s_add_u32 m0, s39, 19456
s_add_u32 s37, s37, s38
buffer_load_dwordx4 v23, s[8:11], s37 offen sc1 lds
s_add_u32 m0, s39, 20480
s_add_u32 s37, s37, s38
buffer_load_dwordx4 v23, s[8:11], s37 offen sc1 lds
s_add_u32 m0, s39, 21504
s_add_u32 s37, s37, s38
buffer_load_dwordx4 v23, s[8:11], s37 offen sc1 lds
s_add_u32 m0, s39, 22528
s_add_u32 s37, s37, s38
buffer_load_dwordx4 v23, s[8:11], s37 offen sc1 lds
s_add_u32 m0, s39, 23552
s_add_u32 s37, s37, s38
buffer_load_dwordx4 v23, s[8:11], s37 offen sc1 lds
s_waitcnt vmcnt(16)
s_barrier
s_add_u32 s42, s42, 1
s_and_b32 s42, s42, 15
s_add_u32 m0, s39, 32768
s_lshl_b32 s37, s42, 14
buffer_load_dwordx4 v23, s[8:11], s37 offen sc1 lds
s_add_u32 m0, s39, 33792
s_add_u32 s37, s37, s38
buffer_load_dwordx4 v23, s[8:11], s37 offen sc1 lds
s_add_u32 m0, s39, 34816
s_add_u32 s37, s37, s38
buffer_load_dwordx4 v23, s[8:11], s37 offen sc1 lds
s_add_u32 m0, s39, 35840
s_add_u32 s37, s37, s38
buffer_load_dwordx4 v23, s[8:11], s37 offen sc1 lds
s_add_u32 m0, s39, 36864
s_add_u32 s37, s37, s38
buffer_load_dwordx4 v23, s[8:11], s37 offen sc1 lds
s_add_u32 m0, s39, 37888
s_add_u32 s37, s37, s38
buffer_load_dwordx4 v23, s[8:11], s37 offen sc1 lds
s_add_u32 m0, s39, 38912
s_add_u32 s37, s37, s38
buffer_load_dwordx4 v23, s[8:11], s37 offen sc1 lds
s_add_u32 m0, s39, 39936
s_add_u32 s37, s37, s38
buffer_load_dwordx4 v23, s[8:11], s37 offen sc1 lds
s_waitcnt vmcnt(16)
s_barrier
s_add_u32 s42, s42, 1
s_and_b32 s42, s42, 15
s_add_u32 m0, s39, 49152
s_lshl_b32 s37, s42, 14
buffer_load_dwordx4 v23, s[8:11], s37 offen sc1 lds
s_add_u32 m0, s39, 50176
s_add_u32 s37, s37, s38
buffer_load_dwordx4 v23, s[8:11], s37 offen sc1 lds
s_add_u32 m0, s39, 51200
s_add_u32 s37, s37, s38
buffer_load_dwordx4 v23, s[8:11], s37 offen sc1 lds
s_add_u32 m0, s39, 52224
s_add_u32 s37, s37, s38
buffer_load_dwordx4 v23, s[8:11], s37 offen sc1 lds
s_add_u32 m0, s39, 53248
s_add_u32 s37, s37, s38
buffer_load_dwordx4 v23, s[8:11], s37 offen sc1 lds
s_add_u32 m0, s39, 54272
s_add_u32 s37, s37, s38
buffer_load_dwordx4 v23, s[8:11], s37 offen sc1 lds
s_add_u32 m0, s39, 55296
s_add_u32 s37, s37, s38
buffer_load_dwordx4 v23, s[8:11], s37 offen sc1 lds
s_add_u32 m0, s39, 56320
s_add_u32 s37, s37, s38
buffer_load_dwordx4 v23, s[8:11], s37 offen sc1 lds
s_waitcnt vmcnt(16)
s_barrier
s_add_u32 s42, s42, 1
s_and_b32 s42, s42, 15
s_add_u32 m0, s39, 0
s_lshl_b32 s37, s42, 14
buffer_load_dwordx4 v23, s[8:11], s37 offen sc1 lds
s_add_u32 m0, s39, 1024
s_add_u32 s37, s37, s38
buffer_load_dwordx4 v23, s[8:11], s37 offen sc1 lds
s_add_u32 m0, s39, 2048
s_add_u32 s37, s37, s38
buffer_load_dwordx4 v23, s[8:11], s37 offen sc1 lds
s_add_u32 m0, s39, 3072
s_add_u32 s37, s37, s38
buffer_load_dwordx4 v23, s[8:11], s37 offen sc1 lds
s_add_u32 m0, s39, 4096
s_add_u32 s37, s37, s38
buffer_load_dwordx4 v23, s[8:11], s37 offen sc1 lds
s_add_u32 m0, s39, 5120
s_add_u32 s37, s37, s38
buffer_load_dwordx4 v23, s[8:11], s37 offen sc1 lds
s_add_u32 m0, s39, 6144
s_add_u32 s37, s37, s38
buffer_load_dwordx4 v23, s[8:11], s37 offen sc1 lds
s_add_u32 m0, s39, 7168
s_add_u32 s37, s37, s38
buffer_load_dwordx4 v23, s[8:11], s37 offen sc1 lds
s_waitcnt vmcnt(16)
s_barrier
s_add_u32 s42, s42, 1
s_and_b32 s42, s42, 15
s_add_u32 m0, s39, 16384
s_lshl_b32 s37, s42, 14
buffer_load_dwordx4 v23, s[8:11], s37 offen sc1 lds
s_add_u32 m0, s39, 17408
s_add_u32 s37, s37, s38
buffer_load_dwordx4 v23, s[8:11], s37 offen sc1 lds
s_add_u32 m0, s39, 18432
s_add_u32 s37, s37, s38
buffer_load_dwordx4 v23, s[8:11], s37 offen sc1 lds
s_add_u32 m0, s39, 19456
s_add_u32 s37, s37, s38
buffer_load_dwordx4 v23, s[8:11], s37 offen sc1 lds
s_add_u32 m0, s39, 20480
s_add_u32 s37, s37, s38
buffer_load_dwordx4 v23, s[8:11], s37 offen sc1 lds
s_add_u32 m0, s39, 21504
s_add_u32 s37, s37, s38
buffer_load_dwordx4 v23, s[8:11], s37 offen sc1 lds
s_add_u32 m0, s39, 22528
s_add_u32 s37, s37, s38
buffer_load_dwordx4 v23, s[8:11], s37 offen sc1 lds
s_add_u32 m0, s39, 23552
s_add_u32 s37, s37, s38
buffer_load_dwordx4 v23, s[8:11], s37 offen sc1 lds
s_waitcnt vmcnt(16)
s_barrier
s_add_u32 s42, s42, 1
s_and_b32 s42, s42, 15
s_add_u32 m0, s39, 32768
s_lshl_b32 s37, s42, 14
buffer_load_dwordx4 v23, s[8:11], s37 offen sc1 lds
s_add_u32 m0, s39, 33792
s_add_u32 s37, s37, s38
buffer_load_dwordx4 v23, s[8:11], s37 offen sc1 lds
s_add_u32 m0, s39, 34816
s_add_u32 s37, s37, s38
buffer_load_dwordx4 v23, s[8:11], s37 offen sc1 lds
s_add_u32 m0, s39, 35840
s_add_u32 s37, s37, s38
buffer_load_dwordx4 v23, s[8:11], s37 offen sc1 lds
s_add_u32 m0, s39, 36864
s_add_u32 s37, s37, s38
buffer_load_dwordx4 v23, s[8:11], s37 offen sc1 lds
s_add_u32 m0, s39, 37888
s_add_u32 s37, s37, s38
buffer_load_dwordx4 v23, s[8:11], s37 offen sc1 lds
s_add_u32 m0, s39, 38912
s_add_u32 s37, s37, s38
buffer_load_dwordx4 v23, s[8:11], s37 offen sc1 lds
s_add_u32 m0, s39, 39936
s_add_u32 s37, s37, s38
buffer_load_dwordx4 v23, s[8:11], s37 offen sc1 lds
s_waitcnt vmcnt(16)
s_barrier
s_add_u32 s42, s42, 1
s_and_b32 s42, s42, 15
s_add_u32 m0, s39, 49152
s_lshl_b32 s37, s42, 14
buffer_load_dwordx4 v23, s[8:11], s37 offen sc1 lds
s_add_u32 m0, s39, 50176
s_add_u32 s37, s37, s38
buffer_load_dwordx4 v23, s[8:11], s37 offen sc1 lds
s_add_u32 m0, s39, 51200
s_add_u32 s37, s37, s38
buffer_load_dwordx4 v23, s[8:11], s37 offen sc1 lds
s_add_u32 m0, s39, 52224
s_add_u32 s37, s37, s38
buffer_load_dwordx4 v23, s[8:11], s37 offen sc1 lds
s_add_u32 m0, s39, 53248
s_add_u32 s37, s37, s38
buffer_load_dwordx4 v23, s[8:11], s37 offen sc1 lds
s_add_u32 m0, s39, 54272
s_add_u32 s37, s37, s38
buffer_load_dwordx4 v23, s[8:11], s37 offen sc1 lds
s_add_u32 m0, s39, 55296
s_add_u32 s37, s37, s38
buffer_load_dwordx4 v23, s[8:11], s37 offen sc1 lds
s_add_u32 m0, s39, 56320
s_add_u32 s37, s37, s38
buffer_load_dwordx4 v23, s[8:11], s37 offen sc1 lds
s_lshl_b32 s43, s35, 8
s_cmp_eq_u32 s51, 1
s_cselect_b32 s8, s4, s6
s_cselect_b32 s9, s5, s7
s_sub_u32 s10, 7340032, s43
s_lshl_b32 s44, s34, 18
s_add_u32 s44, s44, 4194304
s_movk_i32 s38, 28672
s_cmp_eq_u32 s51, 0
s_cselect_b32 s8, s32, s8
s_cselect_b32 s9, s33, s9
s_cselect_b32 s10, 262144, s10
s_cselect_b32 s43, s44, s43
s_cselect_b32 s38, 1024, s38
s_cselect_b32 s45, 0, -1
s_add_u32 s8, s8, s43
s_addc_u32 s9, s9, 0
s_mov_b32 s11, 0x20000
s_lshl_b32 s40, s38, 4
s_add_u32 s42, s35, 15
s_lshl_b32 s39, s51, 14
v_lshrrev_b32 v19, 4, v1
v_lshlrev_b32 v20, 5, v19
v_mul_u32_u24 v19, 6912, v19
v_and_b32 v19, s45, v19
v_and_b32 v20, s45, v20
v_lshlrev_b32 v21, 4, v1
v_xor_b32 v21, v21, v20
v_add_u32 v22, v21, v19
s_and_b32 s45, s45, 128
v_xor_b32 v23, s45, v22
s_waitcnt vmcnt(16)
s_barrier
s_waitcnt vmcnt(8)
s_barrier
s_waitcnt vmcnt(0)
s_barrier
s_barrier
s_barrier
s_add_u32 s43, s34, 16
s_lshl_b32 s43, s43, 7
v_mov_b32 v8, s43
v_mov_b32 v10, 16
buffer_load_dword v9, v8, s[56:59], 0 offen sc1
s_waitcnt vmcnt(0)
s_add_u32 s43, s34, 16
s_lshl_b32 s43, s43, 7
v_mov_b32 v8, s43
v_mov_b32 v10, 16
buffer_load_dword v9, v8, s[56:59], 0 offen sc1
s_waitcnt vmcnt(0)
s_add_u32 s42, s42, 1
s_add_u32 s42, s42, 1
s_and_b32 s42, s42, 15
s_add_u32 m0, s39, 0
s_mul_i32 s37, s42, s40
buffer_load_dwordx4 v22, s[8:11], s37 offen sc1 lds
s_add_u32 m0, s39, 1024
s_add_u32 s37, s37, s38
buffer_load_dwordx4 v23, s[8:11], s37 offen sc1 lds
s_add_u32 m0, s39, 2048
s_add_u32 s37, s37, s38
buffer_load_dwordx4 v22, s[8:11], s37 offen sc1 lds
s_add_u32 m0, s39, 3072
s_add_u32 s37, s37, s38
buffer_load_dwordx4 v23, s[8:11], s37 offen sc1 lds
s_add_u32 m0, s39, 4096
s_add_u32 s37, s37, s38
buffer_load_dwordx4 v22, s[8:11], s37 offen sc1 lds
s_add_u32 m0, s39, 5120
s_add_u32 s37, s37, s38
buffer_load_dwordx4 v23, s[8:11], s37 offen sc1 lds
s_add_u32 m0, s39, 6144
s_add_u32 s37, s37, s38
buffer_load_dwordx4 v22, s[8:11], s37 offen sc1 lds
s_add_u32 m0, s39, 7168
s_add_u32 s37, s37, s38
buffer_load_dwordx4 v23, s[8:11], s37 offen sc1 lds
s_add_u32 m0, s39, 8192
s_add_u32 s37, s37, s38
buffer_load_dwordx4 v22, s[8:11], s37 offen sc1 lds
s_add_u32 m0, s39, 9216
s_add_u32 s37, s37, s38
buffer_load_dwordx4 v23, s[8:11], s37 offen sc1 lds
s_add_u32 m0, s39, 10240
s_add_u32 s37, s37, s38
buffer_load_dwordx4 v22, s[8:11], s37 offen sc1 lds
s_add_u32 m0, s39, 11264
s_add_u32 s37, s37, s38
buffer_load_dwordx4 v23, s[8:11], s37 offen sc1 lds
s_add_u32 m0, s39, 12288
s_add_u32 s37, s37, s38
buffer_load_dwordx4 v22, s[8:11], s37 offen sc1 lds
s_add_u32 m0, s39, 13312
s_add_u32 s37, s37, s38
buffer_load_dwordx4 v23, s[8:11], s37 offen sc1 lds
s_add_u32 m0, s39, 14336
s_add_u32 s37, s37, s38
buffer_load_dwordx4 v22, s[8:11], s37 offen sc1 lds
s_add_u32 m0, s39, 15360
s_add_u32 s37, s37, s38
buffer_load_dwordx4 v23, s[8:11], s37 offen sc1 lds
s_add_u32 s42, s42, 1
s_and_b32 s42, s42, 15
s_add_u32 m0, s39, 49152
s_mul_i32 s37, s42, s40
buffer_load_dwordx4 v22, s[8:11], s37 offen sc1 lds
s_add_u32 m0, s39, 50176
s_add_u32 s37, s37, s38
buffer_load_dwordx4 v23, s[8:11], s37 offen sc1 lds
s_add_u32 m0, s39, 51200
s_add_u32 s37, s37, s38
buffer_load_dwordx4 v22, s[8:11], s37 offen sc1 lds
s_add_u32 m0, s39, 52224
s_add_u32 s37, s37, s38
buffer_load_dwordx4 v23, s[8:11], s37 offen sc1 lds
s_add_u32 m0, s39, 53248
s_add_u32 s37, s37, s38
buffer_load_dwordx4 v22, s[8:11], s37 offen sc1 lds
s_add_u32 m0, s39, 54272
s_add_u32 s37, s37, s38
buffer_load_dwordx4 v23, s[8:11], s37 offen sc1 lds
s_add_u32 m0, s39, 55296
s_add_u32 s37, s37, s38
buffer_load_dwordx4 v22, s[8:11], s37 offen sc1 lds
s_add_u32 m0, s39, 56320
s_add_u32 s37, s37, s38
buffer_load_dwordx4 v23, s[8:11], s37 offen sc1 lds
s_add_u32 m0, s39, 57344
s_add_u32 s37, s37, s38
buffer_load_dwordx4 v22, s[8:11], s37 offen sc1 lds
s_add_u32 m0, s39, 58368
s_add_u32 s37, s37, s38
buffer_load_dwordx4 v23, s[8:11], s37 offen sc1 lds
s_add_u32 m0, s39, 59392
s_add_u32 s37, s37, s38
buffer_load_dwordx4 v22, s[8:11], s37 offen sc1 lds
s_add_u32 m0, s39, 60416
s_add_u32 s37, s37, s38
buffer_load_dwordx4 v23, s[8:11], s37 offen sc1 lds
s_add_u32 m0, s39, 61440
s_add_u32 s37, s37, s38
buffer_load_dwordx4 v22, s[8:11], s37 offen sc1 lds
s_add_u32 m0, s39, 62464
s_add_u32 s37, s37, s38
buffer_load_dwordx4 v23, s[8:11], s37 offen sc1 lds
s_add_u32 m0, s39, 63488
s_add_u32 s37, s37, s38
buffer_load_dwordx4 v22, s[8:11], s37 offen sc1 lds
s_add_u32 m0, s39, 64512
s_add_u32 s37, s37, s38
buffer_load_dwordx4 v23, s[8:11], s37 offen sc1 lds
s_branch LP3_83
.p2align 6
Lw_17:
s_branch Lr_18
s_nop 0
.p2align 3
Lp_85:
s_add_u32 s42, s35, 2
s_waitcnt vmcnt(0)
s_barrier
s_add_u32 s43, s34, 0
s_lshl_b32 s43, s43, 7
v_mov_b32 v13, s43
v_mov_b32 v14, 1
s_mov_b64 exec, 1
buffer_atomic_add v14, v13, s[56:59], 0 offen sc1
s_mov_b64 exec, -1
ds_write_b128 v27, v[68:71] offset:0
ds_write_b128 v27, v[116:119] offset:512
s_waitcnt lgkmcnt(0)
s_barrier
s_add_u32 m0, s54, 16384
s_add_u32 s43, s30, 0
buffer_load_dwordx4 v21, s[12:15], s43 offen sc1 lds
s_add_u32 m0, s54, 17408
s_add_u32 s43, s30, 1024
buffer_load_dwordx4 v21, s[12:15], s43 offen sc1 lds
s_add_u32 m0, s54, 32768
s_add_u32 s43, s31, 0
buffer_load_dwordx4 v21, s[12:15], s43 offen sc1 lds
s_add_u32 m0, s54, 33792
s_add_u32 s43, s31, 1024
buffer_load_dwordx4 v21, s[12:15], s43 offen sc1 lds
s_add_u32 s42, s42, 1
s_and_b32 s42, s42, 15
s_add_u32 m0, s39, 49152
s_lshl_b32 s37, s42, 14
buffer_load_dwordx4 v23, s[8:11], s37 offen sc1 lds
s_add_u32 m0, s39, 50176
s_add_u32 s37, s37, s38
buffer_load_dwordx4 v23, s[8:11], s37 offen sc1 lds
s_add_u32 m0, s39, 51200
s_add_u32 s37, s37, s38
buffer_load_dwordx4 v23, s[8:11], s37 offen sc1 lds
s_add_u32 m0, s39, 52224
s_add_u32 s37, s37, s38
buffer_load_dwordx4 v23, s[8:11], s37 offen sc1 lds
s_add_u32 m0, s39, 53248
s_add_u32 s37, s37, s38
buffer_load_dwordx4 v23, s[8:11], s37 offen sc1 lds
s_add_u32 m0, s39, 54272
s_add_u32 s37, s37, s38
buffer_load_dwordx4 v23, s[8:11], s37 offen sc1 lds
s_add_u32 m0, s39, 55296
s_add_u32 s37, s37, s38
buffer_load_dwordx4 v23, s[8:11], s37 offen sc1 lds
s_add_u32 m0, s39, 56320
s_add_u32 s37, s37, s38
buffer_load_dwordx4 v23, s[8:11], s37 offen sc1 lds
s_waitcnt vmcnt(10)
s_barrier
s_add_u32 s42, s42, 1
s_and_b32 s42, s42, 15
s_add_u32 m0, s39, 0
s_lshl_b32 s37, s42, 14
buffer_load_dwordx4 v23, s[8:11], s37 offen sc1 lds
s_add_u32 m0, s39, 1024
s_add_u32 s37, s37, s38
buffer_load_dwordx4 v23, s[8:11], s37 offen sc1 lds
s_add_u32 m0, s39, 2048
s_add_u32 s37, s37, s38
buffer_load_dwordx4 v23, s[8:11], s37 offen sc1 lds
s_add_u32 m0, s39, 3072
s_add_u32 s37, s37, s38
buffer_load_dwordx4 v23, s[8:11], s37 offen sc1 lds
s_add_u32 m0, s39, 4096
s_add_u32 s37, s37, s38
buffer_load_dwordx4 v23, s[8:11], s37 offen sc1 lds
s_add_u32 m0, s39, 5120
s_add_u32 s37, s37, s38
buffer_load_dwordx4 v23, s[8:11], s37 offen sc1 lds
s_add_u32 m0, s39, 6144
s_add_u32 s37, s37, s38
buffer_load_dwordx4 v23, s[8:11], s37 offen sc1 lds
s_add_u32 m0, s39, 7168
s_add_u32 s37, s37, s38
buffer_load_dwordx4 v23, s[8:11], s37 offen sc1 lds
s_waitcnt vmcnt(16)
s_barrier
s_add_u32 s42, s42, 1
s_and_b32 s42, s42, 15
s_add_u32 m0, s39, 16384
s_lshl_b32 s37, s42, 14
buffer_load_dwordx4 v23, s[8:11], s37 offen sc1 lds
s_add_u32 m0, s39, 17408
s_add_u32 s37, s37, s38
buffer_load_dwordx4 v23, s[8:11], s37 offen sc1 lds
s_add_u32 m0, s39, 18432
s_add_u32 s37, s37, s38
buffer_load_dwordx4 v23, s[8:11], s37 offen sc1 lds
s_add_u32 m0, s39, 19456
s_add_u32 s37, s37, s38
buffer_load_dwordx4 v23, s[8:11], s37 offen sc1 lds
s_add_u32 m0, s39, 20480
s_add_u32 s37, s37, s38
buffer_load_dwordx4 v23, s[8:11], s37 offen sc1 lds
s_add_u32 m0, s39, 21504
s_add_u32 s37, s37, s38
buffer_load_dwordx4 v23, s[8:11], s37 offen sc1 lds
s_add_u32 m0, s39, 22528
s_add_u32 s37, s37, s38
buffer_load_dwordx4 v23, s[8:11], s37 offen sc1 lds
s_add_u32 m0, s39, 23552
s_add_u32 s37, s37, s38
buffer_load_dwordx4 v23, s[8:11], s37 offen sc1 lds
s_waitcnt vmcnt(16)
s_barrier
s_add_u32 s42, s42, 1
s_and_b32 s42, s42, 15
s_add_u32 m0, s39, 32768
s_lshl_b32 s37, s42, 14
buffer_load_dwordx4 v23, s[8:11], s37 offen sc1 lds
s_add_u32 m0, s39, 33792
s_add_u32 s37, s37, s38
buffer_load_dwordx4 v23, s[8:11], s37 offen sc1 lds
s_add_u32 m0, s39, 34816
s_add_u32 s37, s37, s38
buffer_load_dwordx4 v23, s[8:11], s37 offen sc1 lds
s_add_u32 m0, s39, 35840
s_add_u32 s37, s37, s38
buffer_load_dwordx4 v23, s[8:11], s37 offen sc1 lds
s_add_u32 m0, s39, 36864
s_add_u32 s37, s37, s38
buffer_load_dwordx4 v23, s[8:11], s37 offen sc1 lds
s_add_u32 m0, s39, 37888
s_add_u32 s37, s37, s38
buffer_load_dwordx4 v23, s[8:11], s37 offen sc1 lds
s_add_u32 m0, s39, 38912
s_add_u32 s37, s37, s38
buffer_load_dwordx4 v23, s[8:11], s37 offen sc1 lds
s_add_u32 m0, s39, 39936
s_add_u32 s37, s37, s38
buffer_load_dwordx4 v23, s[8:11], s37 offen sc1 lds
s_waitcnt vmcnt(16)
s_barrier
s_add_u32 s42, s42, 1
s_and_b32 s42, s42, 15
s_add_u32 m0, s39, 49152
s_lshl_b32 s37, s42, 14
buffer_load_dwordx4 v23, s[8:11], s37 offen sc1 lds
s_add_u32 m0, s39, 50176
s_add_u32 s37, s37, s38
buffer_load_dwordx4 v23, s[8:11], s37 offen sc1 lds
s_add_u32 m0, s39, 51200
s_add_u32 s37, s37, s38
buffer_load_dwordx4 v23, s[8:11], s37 offen sc1 lds
s_add_u32 m0, s39, 52224
s_add_u32 s37, s37, s38
buffer_load_dwordx4 v23, s[8:11], s37 offen sc1 lds
s_add_u32 m0, s39, 53248
s_add_u32 s37, s37, s38
buffer_load_dwordx4 v23, s[8:11], s37 offen sc1 lds
s_add_u32 m0, s39, 54272
s_add_u32 s37, s37, s38
buffer_load_dwordx4 v23, s[8:11], s37 offen sc1 lds
s_add_u32 m0, s39, 55296
s_add_u32 s37, s37, s38
buffer_load_dwordx4 v23, s[8:11], s37 offen sc1 lds
s_add_u32 m0, s39, 56320
s_add_u32 s37, s37, s38
buffer_load_dwordx4 v23, s[8:11], s37 offen sc1 lds
s_waitcnt vmcnt(16)
s_barrier
s_add_u32 s42, s42, 1
s_and_b32 s42, s42, 15
s_add_u32 m0, s39, 0
s_lshl_b32 s37, s42, 14
buffer_load_dwordx4 v23, s[8:11], s37 offen sc1 lds
s_add_u32 m0, s39, 1024
s_add_u32 s37, s37, s38
buffer_load_dwordx4 v23, s[8:11], s37 offen sc1 lds
s_add_u32 m0, s39, 2048
s_add_u32 s37, s37, s38
buffer_load_dwordx4 v23, s[8:11], s37 offen sc1 lds
s_add_u32 m0, s39, 3072
s_add_u32 s37, s37, s38
buffer_load_dwordx4 v23, s[8:11], s37 offen sc1 lds
s_add_u32 m0, s39, 4096
s_add_u32 s37, s37, s38
buffer_load_dwordx4 v23, s[8:11], s37 offen sc1 lds
s_add_u32 m0, s39, 5120
s_add_u32 s37, s37, s38
buffer_load_dwordx4 v23, s[8:11], s37 offen sc1 lds
s_add_u32 m0, s39, 6144
s_add_u32 s37, s37, s38
buffer_load_dwordx4 v23, s[8:11], s37 offen sc1 lds
s_add_u32 m0, s39, 7168
s_add_u32 s37, s37, s38
buffer_load_dwordx4 v23, s[8:11], s37 offen sc1 lds
s_waitcnt vmcnt(16)
s_barrier
s_add_u32 s42, s42, 1
s_and_b32 s42, s42, 15
s_add_u32 m0, s39, 16384
s_lshl_b32 s37, s42, 14
buffer_load_dwordx4 v23, s[8:11], s37 offen sc1 lds
s_add_u32 m0, s39, 17408
s_add_u32 s37, s37, s38
buffer_load_dwordx4 v23, s[8:11], s37 offen sc1 lds
s_add_u32 m0, s39, 18432
s_add_u32 s37, s37, s38
buffer_load_dwordx4 v23, s[8:11], s37 offen sc1 lds
s_add_u32 m0, s39, 19456
s_add_u32 s37, s37, s38
buffer_load_dwordx4 v23, s[8:11], s37 offen sc1 lds
s_add_u32 m0, s39, 20480
s_add_u32 s37, s37, s38
buffer_load_dwordx4 v23, s[8:11], s37 offen sc1 lds
s_add_u32 m0, s39, 21504
s_add_u32 s37, s37, s38
buffer_load_dwordx4 v23, s[8:11], s37 offen sc1 lds
s_add_u32 m0, s39, 22528
s_add_u32 s37, s37, s38
buffer_load_dwordx4 v23, s[8:11], s37 offen sc1 lds
s_add_u32 m0, s39, 23552
s_add_u32 s37, s37, s38
buffer_load_dwordx4 v23, s[8:11], s37 offen sc1 lds
s_waitcnt vmcnt(16)
s_barrier
s_add_u32 s42, s42, 1
s_and_b32 s42, s42, 15
s_add_u32 m0, s39, 32768
s_lshl_b32 s37, s42, 14
buffer_load_dwordx4 v23, s[8:11], s37 offen sc1 lds
s_add_u32 m0, s39, 33792
s_add_u32 s37, s37, s38
buffer_load_dwordx4 v23, s[8:11], s37 offen sc1 lds
s_add_u32 m0, s39, 34816
s_add_u32 s37, s37, s38
buffer_load_dwordx4 v23, s[8:11], s37 offen sc1 lds
s_add_u32 m0, s39, 35840
s_add_u32 s37, s37, s38
buffer_load_dwordx4 v23, s[8:11], s37 offen sc1 lds
s_add_u32 m0, s39, 36864
s_add_u32 s37, s37, s38
buffer_load_dwordx4 v23, s[8:11], s37 offen sc1 lds
s_add_u32 m0, s39, 37888
s_add_u32 s37, s37, s38
buffer_load_dwordx4 v23, s[8:11], s37 offen sc1 lds
s_add_u32 m0, s39, 38912
s_add_u32 s37, s37, s38
buffer_load_dwordx4 v23, s[8:11], s37 offen sc1 lds
s_add_u32 m0, s39, 39936
s_add_u32 s37, s37, s38
buffer_load_dwordx4 v23, s[8:11], s37 offen sc1 lds
s_waitcnt vmcnt(16)
s_barrier
s_add_u32 s42, s42, 1
s_and_b32 s42, s42, 15
s_add_u32 m0, s39, 49152
s_lshl_b32 s37, s42, 14
buffer_load_dwordx4 v23, s[8:11], s37 offen sc1 lds
s_add_u32 m0, s39, 50176
s_add_u32 s37, s37, s38
buffer_load_dwordx4 v23, s[8:11], s37 offen sc1 lds
s_add_u32 m0, s39, 51200
s_add_u32 s37, s37, s38
buffer_load_dwordx4 v23, s[8:11], s37 offen sc1 lds
s_add_u32 m0, s39, 52224
s_add_u32 s37, s37, s38
buffer_load_dwordx4 v23, s[8:11], s37 offen sc1 lds
s_add_u32 m0, s39, 53248
s_add_u32 s37, s37, s38
buffer_load_dwordx4 v23, s[8:11], s37 offen sc1 lds
s_add_u32 m0, s39, 54272
s_add_u32 s37, s37, s38
buffer_load_dwordx4 v23, s[8:11], s37 offen sc1 lds
s_add_u32 m0, s39, 55296
s_add_u32 s37, s37, s38
buffer_load_dwordx4 v23, s[8:11], s37 offen sc1 lds
s_add_u32 m0, s39, 56320
s_add_u32 s37, s37, s38
buffer_load_dwordx4 v23, s[8:11], s37 offen sc1 lds
s_waitcnt vmcnt(16)
s_barrier
s_add_u32 s42, s42, 1
s_and_b32 s42, s42, 15
s_add_u32 m0, s39, 0
s_lshl_b32 s37, s42, 14
buffer_load_dwordx4 v23, s[8:11], s37 offen sc1 lds
s_add_u32 m0, s39, 1024
s_add_u32 s37, s37, s38
buffer_load_dwordx4 v23, s[8:11], s37 offen sc1 lds
s_add_u32 m0, s39, 2048
s_add_u32 s37, s37, s38
buffer_load_dwordx4 v23, s[8:11], s37 offen sc1 lds
s_add_u32 m0, s39, 3072
s_add_u32 s37, s37, s38
buffer_load_dwordx4 v23, s[8:11], s37 offen sc1 lds
s_add_u32 m0, s39, 4096
s_add_u32 s37, s37, s38
buffer_load_dwordx4 v23, s[8:11], s37 offen sc1 lds
s_add_u32 m0, s39, 5120
s_add_u32 s37, s37, s38
buffer_load_dwordx4 v23, s[8:11], s37 offen sc1 lds
s_add_u32 m0, s39, 6144
s_add_u32 s37, s37, s38
buffer_load_dwordx4 v23, s[8:11], s37 offen sc1 lds
s_add_u32 m0, s39, 7168
s_add_u32 s37, s37, s38
buffer_load_dwordx4 v23, s[8:11], s37 offen sc1 lds
s_waitcnt vmcnt(16)
s_barrier
s_add_u32 s42, s42, 1
s_and_b32 s42, s42, 15
s_add_u32 m0, s39, 16384
s_lshl_b32 s37, s42, 14
buffer_load_dwordx4 v23, s[8:11], s37 offen sc1 lds
s_add_u32 m0, s39, 17408
s_add_u32 s37, s37, s38
buffer_load_dwordx4 v23, s[8:11], s37 offen sc1 lds
s_add_u32 m0, s39, 18432
s_add_u32 s37, s37, s38
buffer_load_dwordx4 v23, s[8:11], s37 offen sc1 lds
s_add_u32 m0, s39, 19456
s_add_u32 s37, s37, s38
buffer_load_dwordx4 v23, s[8:11], s37 offen sc1 lds
s_add_u32 m0, s39, 20480
s_add_u32 s37, s37, s38
buffer_load_dwordx4 v23, s[8:11], s37 offen sc1 lds
s_add_u32 m0, s39, 21504
s_add_u32 s37, s37, s38
buffer_load_dwordx4 v23, s[8:11], s37 offen sc1 lds
s_add_u32 m0, s39, 22528
s_add_u32 s37, s37, s38
buffer_load_dwordx4 v23, s[8:11], s37 offen sc1 lds
s_add_u32 m0, s39, 23552
s_add_u32 s37, s37, s38
buffer_load_dwordx4 v23, s[8:11], s37 offen sc1 lds
s_waitcnt vmcnt(16)
s_barrier
s_add_u32 s42, s42, 1
s_and_b32 s42, s42, 15
s_add_u32 m0, s39, 32768
s_lshl_b32 s37, s42, 14
buffer_load_dwordx4 v23, s[8:11], s37 offen sc1 lds
s_add_u32 m0, s39, 33792
s_add_u32 s37, s37, s38
buffer_load_dwordx4 v23, s[8:11], s37 offen sc1 lds
s_add_u32 m0, s39, 34816
s_add_u32 s37, s37, s38
buffer_load_dwordx4 v23, s[8:11], s37 offen sc1 lds
s_add_u32 m0, s39, 35840
s_add_u32 s37, s37, s38
buffer_load_dwordx4 v23, s[8:11], s37 offen sc1 lds
s_add_u32 m0, s39, 36864
s_add_u32 s37, s37, s38
buffer_load_dwordx4 v23, s[8:11], s37 offen sc1 lds
s_add_u32 m0, s39, 37888
s_add_u32 s37, s37, s38
buffer_load_dwordx4 v23, s[8:11], s37 offen sc1 lds
s_add_u32 m0, s39, 38912
s_add_u32 s37, s37, s38
buffer_load_dwordx4 v23, s[8:11], s37 offen sc1 lds
s_add_u32 m0, s39, 39936
s_add_u32 s37, s37, s38
buffer_load_dwordx4 v23, s[8:11], s37 offen sc1 lds
s_waitcnt vmcnt(16)
s_barrier
s_add_u32 s42, s42, 1
s_and_b32 s42, s42, 15
s_add_u32 m0, s39, 49152
s_lshl_b32 s37, s42, 14
buffer_load_dwordx4 v23, s[8:11], s37 offen sc1 lds
s_add_u32 m0, s39, 50176
s_add_u32 s37, s37, s38
buffer_load_dwordx4 v23, s[8:11], s37 offen sc1 lds
s_add_u32 m0, s39, 51200
s_add_u32 s37, s37, s38
buffer_load_dwordx4 v23, s[8:11], s37 offen sc1 lds
s_add_u32 m0, s39, 52224
s_add_u32 s37, s37, s38
buffer_load_dwordx4 v23, s[8:11], s37 offen sc1 lds
s_add_u32 m0, s39, 53248
s_add_u32 s37, s37, s38
buffer_load_dwordx4 v23, s[8:11], s37 offen sc1 lds
s_add_u32 m0, s39, 54272
s_add_u32 s37, s37, s38
buffer_load_dwordx4 v23, s[8:11], s37 offen sc1 lds
s_add_u32 m0, s39, 55296
s_add_u32 s37, s37, s38
buffer_load_dwordx4 v23, s[8:11], s37 offen sc1 lds
s_add_u32 m0, s39, 56320
s_add_u32 s37, s37, s38
buffer_load_dwordx4 v23, s[8:11], s37 offen sc1 lds
s_lshl_b32 s43, s35, 8
s_cmp_eq_u32 s51, 1
s_cselect_b32 s8, s4, s6
s_cselect_b32 s9, s5, s7
s_sub_u32 s10, 7340032, s43
s_lshl_b32 s44, s34, 18
s_add_u32 s44, s44, 4194304
s_movk_i32 s38, 28672
s_cmp_eq_u32 s51, 0
s_cselect_b32 s8, s32, s8
s_cselect_b32 s9, s33, s9
s_cselect_b32 s10, 262144, s10
s_cselect_b32 s43, s44, s43
s_cselect_b32 s38, 1024, s38
s_cselect_b32 s45, 0, -1
s_add_u32 s8, s8, s43
s_addc_u32 s9, s9, 0
s_mov_b32 s11, 0x20000
s_lshl_b32 s40, s38, 4
s_add_u32 s42, s35, 15
s_lshl_b32 s39, s51, 14
v_lshrrev_b32 v19, 4, v1
v_lshlrev_b32 v20, 5, v19
v_mul_u32_u24 v19, 6912, v19
v_and_b32 v19, s45, v19
v_and_b32 v20, s45, v20
v_lshlrev_b32 v21, 4, v1
v_xor_b32 v21, v21, v20
v_add_u32 v22, v21, v19
s_and_b32 s45, s45, 128
v_xor_b32 v23, s45, v22
s_waitcnt vmcnt(16)
s_barrier
s_add_u32 s42, s42, 1
s_and_b32 s42, s42, 15
s_add_u32 m0, s39, 98304
s_mul_i32 s37, s42, s40
buffer_load_dwordx4 v22, s[8:11], s37 offen sc1 lds
s_add_u32 m0, s39, 99328
s_add_u32 s37, s37, s38
buffer_load_dwordx4 v23, s[8:11], s37 offen sc1 lds
s_add_u32 m0, s39, 100352
s_add_u32 s37, s37, s38
buffer_load_dwordx4 v22, s[8:11], s37 offen sc1 lds
s_add_u32 m0, s39, 101376
s_add_u32 s37, s37, s38
buffer_load_dwordx4 v23, s[8:11], s37 offen sc1 lds
s_add_u32 m0, s39, 102400
s_add_u32 s37, s37, s38
buffer_load_dwordx4 v22, s[8:11], s37 offen sc1 lds
s_add_u32 m0, s39, 103424
s_add_u32 s37, s37, s38
buffer_load_dwordx4 v23, s[8:11], s37 offen sc1 lds
s_add_u32 m0, s39, 104448
s_add_u32 s37, s37, s38
buffer_load_dwordx4 v22, s[8:11], s37 offen sc1 lds
s_add_u32 m0, s39, 105472
s_add_u32 s37, s37, s38
buffer_load_dwordx4 v23, s[8:11], s37 offen sc1 lds
s_add_u32 m0, s39, 106496
s_add_u32 s37, s37, s38
buffer_load_dwordx4 v22, s[8:11], s37 offen sc1 lds
s_add_u32 m0, s39, 107520
s_add_u32 s37, s37, s38
buffer_load_dwordx4 v23, s[8:11], s37 offen sc1 lds
s_add_u32 m0, s39, 108544
s_add_u32 s37, s37, s38
buffer_load_dwordx4 v22, s[8:11], s37 offen sc1 lds
s_add_u32 m0, s39, 109568
s_add_u32 s37, s37, s38
buffer_load_dwordx4 v23, s[8:11], s37 offen sc1 lds
s_add_u32 m0, s39, 110592
s_add_u32 s37, s37, s38
buffer_load_dwordx4 v22, s[8:11], s37 offen sc1 lds
s_add_u32 m0, s39, 111616
s_add_u32 s37, s37, s38
buffer_load_dwordx4 v23, s[8:11], s37 offen sc1 lds
s_add_u32 m0, s39, 112640
s_add_u32 s37, s37, s38
buffer_load_dwordx4 v22, s[8:11], s37 offen sc1 lds
s_add_u32 m0, s39, 113664
s_add_u32 s37, s37, s38
buffer_load_dwordx4 v23, s[8:11], s37 offen sc1 lds
s_waitcnt vmcnt(24)
s_barrier
s_waitcnt vmcnt(16)
s_barrier
s_add_u32 s42, s42, 1
s_and_b32 s42, s42, 15
s_add_u32 m0, s39, 0
s_mul_i32 s37, s42, s40
buffer_load_dwordx4 v22, s[8:11], s37 offen sc1 lds
s_add_u32 m0, s39, 1024
s_add_u32 s37, s37, s38
buffer_load_dwordx4 v23, s[8:11], s37 offen sc1 lds
s_add_u32 m0, s39, 2048
s_add_u32 s37, s37, s38
buffer_load_dwordx4 v22, s[8:11], s37 offen sc1 lds
s_add_u32 m0, s39, 3072
s_add_u32 s37, s37, s38
buffer_load_dwordx4 v23, s[8:11], s37 offen sc1 lds
s_add_u32 m0, s39, 4096
s_add_u32 s37, s37, s38
buffer_load_dwordx4 v22, s[8:11], s37 offen sc1 lds
s_add_u32 m0, s39, 5120
s_add_u32 s37, s37, s38
buffer_load_dwordx4 v23, s[8:11], s37 offen sc1 lds
s_add_u32 m0, s39, 6144
s_add_u32 s37, s37, s38
buffer_load_dwordx4 v22, s[8:11], s37 offen sc1 lds
s_add_u32 m0, s39, 7168
s_add_u32 s37, s37, s38
buffer_load_dwordx4 v23, s[8:11], s37 offen sc1 lds
s_add_u32 m0, s39, 8192
s_add_u32 s37, s37, s38
buffer_load_dwordx4 v22, s[8:11], s37 offen sc1 lds
s_add_u32 m0, s39, 9216
s_add_u32 s37, s37, s38
buffer_load_dwordx4 v23, s[8:11], s37 offen sc1 lds
s_add_u32 m0, s39, 10240
s_add_u32 s37, s37, s38
buffer_load_dwordx4 v22, s[8:11], s37 offen sc1 lds
s_add_u32 m0, s39, 11264
s_add_u32 s37, s37, s38
buffer_load_dwordx4 v23, s[8:11], s37 offen sc1 lds
s_add_u32 m0, s39, 12288
s_add_u32 s37, s37, s38
buffer_load_dwordx4 v22, s[8:11], s37 offen sc1 lds
s_add_u32 m0, s39, 13312
s_add_u32 s37, s37, s38
buffer_load_dwordx4 v23, s[8:11], s37 offen sc1 lds
s_add_u32 m0, s39, 14336
s_add_u32 s37, s37, s38
buffer_load_dwordx4 v22, s[8:11], s37 offen sc1 lds
s_add_u32 m0, s39, 15360
s_add_u32 s37, s37, s38
buffer_load_dwordx4 v23, s[8:11], s37 offen sc1 lds
s_barrier
s_waitcnt vmcnt(16)
s_barrier
s_add_u32 s42, s42, 1
s_and_b32 s42, s42, 15
s_add_u32 m0, s39, 49152
s_mul_i32 s37, s42, s40
buffer_load_dwordx4 v22, s[8:11], s37 offen sc1 lds
s_add_u32 m0, s39, 50176
s_add_u32 s37, s37, s38
buffer_load_dwordx4 v23, s[8:11], s37 offen sc1 lds
s_add_u32 m0, s39, 51200
s_add_u32 s37, s37, s38
buffer_load_dwordx4 v22, s[8:11], s37 offen sc1 lds
s_add_u32 m0, s39, 52224
s_add_u32 s37, s37, s38
buffer_load_dwordx4 v23, s[8:11], s37 offen sc1 lds
s_add_u32 m0, s39, 53248
s_add_u32 s37, s37, s38
buffer_load_dwordx4 v22, s[8:11], s37 offen sc1 lds
s_add_u32 m0, s39, 54272
s_add_u32 s37, s37, s38
buffer_load_dwordx4 v23, s[8:11], s37 offen sc1 lds
s_add_u32 m0, s39, 55296
s_add_u32 s37, s37, s38
buffer_load_dwordx4 v22, s[8:11], s37 offen sc1 lds
s_add_u32 m0, s39, 56320
s_add_u32 s37, s37, s38
buffer_load_dwordx4 v23, s[8:11], s37 offen sc1 lds
s_add_u32 m0, s39, 57344
s_add_u32 s37, s37, s38
buffer_load_dwordx4 v22, s[8:11], s37 offen sc1 lds
s_add_u32 m0, s39, 58368
s_add_u32 s37, s37, s38
buffer_load_dwordx4 v23, s[8:11], s37 offen sc1 lds
s_add_u32 m0, s39, 59392
s_add_u32 s37, s37, s38
buffer_load_dwordx4 v22, s[8:11], s37 offen sc1 lds
s_add_u32 m0, s39, 60416
s_add_u32 s37, s37, s38
buffer_load_dwordx4 v23, s[8:11], s37 offen sc1 lds
s_add_u32 m0, s39, 61440
s_add_u32 s37, s37, s38
buffer_load_dwordx4 v22, s[8:11], s37 offen sc1 lds
s_add_u32 m0, s39, 62464
s_add_u32 s37, s37, s38
buffer_load_dwordx4 v23, s[8:11], s37 offen sc1 lds
s_add_u32 m0, s39, 63488
s_add_u32 s37, s37, s38
buffer_load_dwordx4 v22, s[8:11], s37 offen sc1 lds
s_add_u32 m0, s39, 64512
s_add_u32 s37, s37, s38
buffer_load_dwordx4 v23, s[8:11], s37 offen sc1 lds
s_branch LP3_83
.p2align 6
Lw_15:
s_branch Lr_16
s_nop 0
.p2align 3
Lp_86:
s_add_u32 s42, s35, 15
s_waitcnt vmcnt(0)
s_barrier
ds_write_b128 v27, v[68:71] offset:0
ds_write_b128 v27, v[116:119] offset:512
s_add_u32 s42, s42, 1
s_and_b32 s42, s42, 15
s_add_u32 m0, s39, 49152
s_lshl_b32 s37, s42, 17
buffer_load_dwordx4 v23, s[8:11], s37 offen sc1 lds
s_add_u32 m0, s39, 50176
s_add_u32 s37, s37, s38
buffer_load_dwordx4 v23, s[8:11], s37 offen sc1 lds
s_add_u32 m0, s39, 51200
s_add_u32 s37, s37, s38
buffer_load_dwordx4 v23, s[8:11], s37 offen sc1 lds
s_add_u32 m0, s39, 52224
s_add_u32 s37, s37, s38
buffer_load_dwordx4 v23, s[8:11], s37 offen sc1 lds
s_add_u32 m0, s39, 53248
s_add_u32 s37, s37, s38
buffer_load_dwordx4 v23, s[8:11], s37 offen sc1 lds
s_add_u32 m0, s39, 54272
s_add_u32 s37, s37, s38
buffer_load_dwordx4 v23, s[8:11], s37 offen sc1 lds
s_add_u32 m0, s39, 55296
s_add_u32 s37, s37, s38
buffer_load_dwordx4 v23, s[8:11], s37 offen sc1 lds
s_add_u32 m0, s39, 56320
s_add_u32 s37, s37, s38
buffer_load_dwordx4 v23, s[8:11], s37 offen sc1 lds
s_add_u32 s42, s42, 1
s_and_b32 s42, s42, 15
s_add_u32 m0, s39, 57344
s_lshl_b32 s37, s42, 17
buffer_load_dwordx4 v23, s[8:11], s37 offen sc1 lds
s_add_u32 m0, s39, 58368
s_add_u32 s37, s37, s38
buffer_load_dwordx4 v23, s[8:11], s37 offen sc1 lds
s_add_u32 m0, s39, 59392
s_add_u32 s37, s37, s38
buffer_load_dwordx4 v23, s[8:11], s37 offen sc1 lds
s_add_u32 m0, s39, 60416
s_add_u32 s37, s37, s38
buffer_load_dwordx4 v23, s[8:11], s37 offen sc1 lds
s_add_u32 m0, s39, 61440
s_add_u32 s37, s37, s38
buffer_load_dwordx4 v23, s[8:11], s37 offen sc1 lds
s_add_u32 m0, s39, 62464
s_add_u32 s37, s37, s38
buffer_load_dwordx4 v23, s[8:11], s37 offen sc1 lds
s_add_u32 m0, s39, 63488
s_add_u32 s37, s37, s38
buffer_load_dwordx4 v23, s[8:11], s37 offen sc1 lds
s_add_u32 m0, s39, 64512
s_add_u32 s37, s37, s38
buffer_load_dwordx4 v23, s[8:11], s37 offen sc1 lds
s_add_u32 s42, s42, 1
s_and_b32 s42, s42, 15
s_add_u32 m0, s39, 65536
s_lshl_b32 s37, s42, 17
buffer_load_dwordx4 v23, s[8:11], s37 offen sc1 lds
s_add_u32 m0, s39, 66560
s_add_u32 s37, s37, s38
buffer_load_dwordx4 v23, s[8:11], s37 offen sc1 lds
s_add_u32 m0, s39, 67584
s_add_u32 s37, s37, s38
buffer_load_dwordx4 v23, s[8:11], s37 offen sc1 lds
s_add_u32 m0, s39, 68608
s_add_u32 s37, s37, s38
buffer_load_dwordx4 v23, s[8:11], s37 offen sc1 lds
s_add_u32 m0, s39, 69632
s_add_u32 s37, s37, s38
buffer_load_dwordx4 v23, s[8:11], s37 offen sc1 lds
s_add_u32 m0, s39, 70656
s_add_u32 s37, s37, s38
buffer_load_dwordx4 v23, s[8:11], s37 offen sc1 lds
s_add_u32 m0, s39, 71680
s_add_u32 s37, s37, s38
buffer_load_dwordx4 v23, s[8:11], s37 offen sc1 lds
s_add_u32 m0, s39, 72704
s_add_u32 s37, s37, s38
buffer_load_dwordx4 v23, s[8:11], s37 offen sc1 lds
s_add_u32 s42, s42, 1
s_and_b32 s42, s42, 15
s_add_u32 m0, s39, 73728
s_lshl_b32 s37, s42, 17
buffer_load_dwordx4 v23, s[8:11], s37 offen sc1 lds
s_add_u32 m0, s39, 74752
s_add_u32 s37, s37, s38
buffer_load_dwordx4 v23, s[8:11], s37 offen sc1 lds
s_add_u32 m0, s39, 75776
s_add_u32 s37, s37, s38
buffer_load_dwordx4 v23, s[8:11], s37 offen sc1 lds
s_add_u32 m0, s39, 76800
s_add_u32 s37, s37, s38
buffer_load_dwordx4 v23, s[8:11], s37 offen sc1 lds
s_add_u32 m0, s39, 77824
s_add_u32 s37, s37, s38
buffer_load_dwordx4 v23, s[8:11], s37 offen sc1 lds
s_add_u32 m0, s39, 78848
s_add_u32 s37, s37, s38
buffer_load_dwordx4 v23, s[8:11], s37 offen sc1 lds
s_add_u32 m0, s39, 79872
s_add_u32 s37, s37, s38
buffer_load_dwordx4 v23, s[8:11], s37 offen sc1 lds
s_add_u32 m0, s39, 80896
s_add_u32 s37, s37, s38
buffer_load_dwordx4 v23, s[8:11], s37 offen sc1 lds
s_waitcnt vmcnt(24)
s_waitcnt lgkmcnt(0)
s_barrier
s_add_u32 m0, s54, 16384
s_add_u32 s43, s30, 0
buffer_load_dwordx4 v21, s[12:15], s43 offen sc1 lds
s_add_u32 m0, s54, 17408
s_add_u32 s43, s30, 1024
buffer_load_dwordx4 v21, s[12:15], s43 offen sc1 lds
s_add_u32 m0, s54, 32768
s_add_u32 s43, s31, 0
buffer_load_dwordx4 v21, s[12:15], s43 offen sc1 lds
s_add_u32 m0, s54, 33792
s_add_u32 s43, s31, 1024
buffer_load_dwordx4 v21, s[12:15], s43 offen sc1 lds
s_add_u32 s42, s42, 1
s_and_b32 s42, s42, 15
s_add_u32 m0, s39, 81920
s_lshl_b32 s37, s42, 17
buffer_load_dwordx4 v23, s[8:11], s37 offen sc1 lds
s_add_u32 m0, s39, 82944
s_add_u32 s37, s37, s38
buffer_load_dwordx4 v23, s[8:11], s37 offen sc1 lds
s_add_u32 m0, s39, 83968
s_add_u32 s37, s37, s38
buffer_load_dwordx4 v23, s[8:11], s37 offen sc1 lds
s_add_u32 m0, s39, 84992
s_add_u32 s37, s37, s38
buffer_load_dwordx4 v23, s[8:11], s37 offen sc1 lds
s_add_u32 m0, s39, 86016
s_add_u32 s37, s37, s38
buffer_load_dwordx4 v23, s[8:11], s37 offen sc1 lds
s_add_u32 m0, s39, 87040
s_add_u32 s37, s37, s38
buffer_load_dwordx4 v23, s[8:11], s37 offen sc1 lds
s_add_u32 m0, s39, 88064
s_add_u32 s37, s37, s38
buffer_load_dwordx4 v23, s[8:11], s37 offen sc1 lds
s_add_u32 m0, s39, 89088
s_add_u32 s37, s37, s38
buffer_load_dwordx4 v23, s[8:11], s37 offen sc1 lds
s_waitcnt vmcnt(10)
s_barrier
s_add_u32 s42, s42, 1
s_and_b32 s42, s42, 15
s_add_u32 m0, s39, 90112
s_lshl_b32 s37, s42, 17
buffer_load_dwordx4 v23, s[8:11], s37 offen sc1 lds
s_add_u32 m0, s39, 91136
s_add_u32 s37, s37, s38
buffer_load_dwordx4 v23, s[8:11], s37 offen sc1 lds
s_add_u32 m0, s39, 92160
s_add_u32 s37, s37, s38
buffer_load_dwordx4 v23, s[8:11], s37 offen sc1 lds
s_add_u32 m0, s39, 93184
s_add_u32 s37, s37, s38
buffer_load_dwordx4 v23, s[8:11], s37 offen sc1 lds
s_add_u32 m0, s39, 94208
s_add_u32 s37, s37, s38
buffer_load_dwordx4 v23, s[8:11], s37 offen sc1 lds
s_add_u32 m0, s39, 95232
s_add_u32 s37, s37, s38
buffer_load_dwordx4 v23, s[8:11], s37 offen sc1 lds
s_add_u32 m0, s39, 96256
s_add_u32 s37, s37, s38
buffer_load_dwordx4 v23, s[8:11], s37 offen sc1 lds
s_add_u32 m0, s39, 97280
s_add_u32 s37, s37, s38
buffer_load_dwordx4 v23, s[8:11], s37 offen sc1 lds
s_waitcnt vmcnt(16)
s_barrier
s_add_u32 s42, s42, 1
s_and_b32 s42, s42, 15
s_add_u32 m0, s39, 98304
s_lshl_b32 s37, s42, 17
buffer_load_dwordx4 v23, s[8:11], s37 offen sc1 lds
s_add_u32 m0, s39, 99328
s_add_u32 s37, s37, s38
buffer_load_dwordx4 v23, s[8:11], s37 offen sc1 lds
s_add_u32 m0, s39, 100352
s_add_u32 s37, s37, s38
buffer_load_dwordx4 v23, s[8:11], s37 offen sc1 lds
s_add_u32 m0, s39, 101376
s_add_u32 s37, s37, s38
buffer_load_dwordx4 v23, s[8:11], s37 offen sc1 lds
s_add_u32 m0, s39, 102400
s_add_u32 s37, s37, s38
buffer_load_dwordx4 v23, s[8:11], s37 offen sc1 lds
s_add_u32 m0, s39, 103424
s_add_u32 s37, s37, s38
buffer_load_dwordx4 v23, s[8:11], s37 offen sc1 lds
s_add_u32 m0, s39, 104448
s_add_u32 s37, s37, s38
buffer_load_dwordx4 v23, s[8:11], s37 offen sc1 lds
s_add_u32 m0, s39, 105472
s_add_u32 s37, s37, s38
buffer_load_dwordx4 v23, s[8:11], s37 offen sc1 lds
s_waitcnt vmcnt(28)
s_barrier
s_add_u32 s42, s42, 1
s_and_b32 s42, s42, 15
s_add_u32 m0, s39, 106496
s_lshl_b32 s37, s42, 17
buffer_load_dwordx4 v23, s[8:11], s37 offen sc1 lds
s_add_u32 m0, s39, 107520
s_add_u32 s37, s37, s38
buffer_load_dwordx4 v23, s[8:11], s37 offen sc1 lds
s_add_u32 m0, s39, 108544
s_add_u32 s37, s37, s38
buffer_load_dwordx4 v23, s[8:11], s37 offen sc1 lds
s_add_u32 m0, s39, 109568
s_add_u32 s37, s37, s38
buffer_load_dwordx4 v23, s[8:11], s37 offen sc1 lds
s_add_u32 m0, s39, 110592
s_add_u32 s37, s37, s38
buffer_load_dwordx4 v23, s[8:11], s37 offen sc1 lds
s_add_u32 m0, s39, 111616
s_add_u32 s37, s37, s38
buffer_load_dwordx4 v23, s[8:11], s37 offen sc1 lds
s_add_u32 m0, s39, 112640
s_add_u32 s37, s37, s38
buffer_load_dwordx4 v23, s[8:11], s37 offen sc1 lds
s_add_u32 m0, s39, 113664
s_add_u32 s37, s37, s38
buffer_load_dwordx4 v23, s[8:11], s37 offen sc1 lds
s_waitcnt vmcnt(24)
s_barrier
s_add_u32 s42, s42, 1
s_and_b32 s42, s42, 15
s_add_u32 m0, s39, 114688
s_lshl_b32 s37, s42, 17
buffer_load_dwordx4 v23, s[8:11], s37 offen sc1 lds
s_add_u32 m0, s39, 115712
s_add_u32 s37, s37, s38
buffer_load_dwordx4 v23, s[8:11], s37 offen sc1 lds
s_add_u32 m0, s39, 116736
s_add_u32 s37, s37, s38
buffer_load_dwordx4 v23, s[8:11], s37 offen sc1 lds
s_add_u32 m0, s39, 117760
s_add_u32 s37, s37, s38
buffer_load_dwordx4 v23, s[8:11], s37 offen sc1 lds
s_add_u32 m0, s39, 118784
s_add_u32 s37, s37, s38
buffer_load_dwordx4 v23, s[8:11], s37 offen sc1 lds
s_add_u32 m0, s39, 119808
s_add_u32 s37, s37, s38
buffer_load_dwordx4 v23, s[8:11], s37 offen sc1 lds
s_add_u32 m0, s39, 120832
s_add_u32 s37, s37, s38
buffer_load_dwordx4 v23, s[8:11], s37 offen sc1 lds
s_add_u32 m0, s39, 121856
s_add_u32 s37, s37, s38
buffer_load_dwordx4 v23, s[8:11], s37 offen sc1 lds
s_waitcnt vmcnt(24)
s_barrier
s_add_u32 s42, s42, 1
s_and_b32 s42, s42, 15
s_add_u32 m0, s39, 122880
s_lshl_b32 s37, s42, 17
buffer_load_dwordx4 v23, s[8:11], s37 offen sc1 lds
s_add_u32 m0, s39, 123904
s_add_u32 s37, s37, s38
buffer_load_dwordx4 v23, s[8:11], s37 offen sc1 lds
s_add_u32 m0, s39, 124928
s_add_u32 s37, s37, s38
buffer_load_dwordx4 v23, s[8:11], s37 offen sc1 lds
s_add_u32 m0, s39, 125952
s_add_u32 s37, s37, s38
buffer_load_dwordx4 v23, s[8:11], s37 offen sc1 lds
s_add_u32 m0, s39, 126976
s_add_u32 s37, s37, s38
buffer_load_dwordx4 v23, s[8:11], s37 offen sc1 lds
s_add_u32 m0, s39, 128000
s_add_u32 s37, s37, s38
buffer_load_dwordx4 v23, s[8:11], s37 offen sc1 lds
s_add_u32 m0, s39, 129024
s_add_u32 s37, s37, s38
buffer_load_dwordx4 v23, s[8:11], s37 offen sc1 lds
s_add_u32 m0, s39, 130048
s_add_u32 s37, s37, s38
buffer_load_dwordx4 v23, s[8:11], s37 offen sc1 lds
s_waitcnt vmcnt(24)
s_barrier
s_add_u32 s42, s42, 1
s_and_b32 s42, s42, 15
s_add_u32 m0, s39, 49152
s_lshl_b32 s37, s42, 17
buffer_load_dwordx4 v23, s[8:11], s37 offen sc1 lds
s_add_u32 m0, s39, 50176
s_add_u32 s37, s37, s38
buffer_load_dwordx4 v23, s[8:11], s37 offen sc1 lds
s_add_u32 m0, s39, 51200
s_add_u32 s37, s37, s38
buffer_load_dwordx4 v23, s[8:11], s37 offen sc1 lds
s_add_u32 m0, s39, 52224
s_add_u32 s37, s37, s38
buffer_load_dwordx4 v23, s[8:11], s37 offen sc1 lds
s_add_u32 m0, s39, 53248
s_add_u32 s37, s37, s38
buffer_load_dwordx4 v23, s[8:11], s37 offen sc1 lds
s_add_u32 m0, s39, 54272
s_add_u32 s37, s37, s38
buffer_load_dwordx4 v23, s[8:11], s37 offen sc1 lds
s_add_u32 m0, s39, 55296
s_add_u32 s37, s37, s38
buffer_load_dwordx4 v23, s[8:11], s37 offen sc1 lds
s_add_u32 m0, s39, 56320
s_add_u32 s37, s37, s38
buffer_load_dwordx4 v23, s[8:11], s37 offen sc1 lds
s_waitcnt vmcnt(24)
s_barrier
s_add_u32 s42, s42, 1
s_and_b32 s42, s42, 15
s_add_u32 m0, s39, 57344
s_lshl_b32 s37, s42, 17
buffer_load_dwordx4 v23, s[8:11], s37 offen sc1 lds
s_add_u32 m0, s39, 58368
s_add_u32 s37, s37, s38
buffer_load_dwordx4 v23, s[8:11], s37 offen sc1 lds
s_add_u32 m0, s39, 59392
s_add_u32 s37, s37, s38
buffer_load_dwordx4 v23, s[8:11], s37 offen sc1 lds
s_add_u32 m0, s39, 60416
s_add_u32 s37, s37, s38
buffer_load_dwordx4 v23, s[8:11], s37 offen sc1 lds
s_add_u32 m0, s39, 61440
s_add_u32 s37, s37, s38
buffer_load_dwordx4 v23, s[8:11], s37 offen sc1 lds
s_add_u32 m0, s39, 62464
s_add_u32 s37, s37, s38
buffer_load_dwordx4 v23, s[8:11], s37 offen sc1 lds
s_add_u32 m0, s39, 63488
s_add_u32 s37, s37, s38
buffer_load_dwordx4 v23, s[8:11], s37 offen sc1 lds
s_add_u32 m0, s39, 64512
s_add_u32 s37, s37, s38
buffer_load_dwordx4 v23, s[8:11], s37 offen sc1 lds
s_waitcnt vmcnt(24)
s_barrier
s_add_u32 s42, s42, 1
s_and_b32 s42, s42, 15
s_add_u32 m0, s39, 65536
s_lshl_b32 s37, s42, 17
buffer_load_dwordx4 v23, s[8:11], s37 offen sc1 lds
s_add_u32 m0, s39, 66560
s_add_u32 s37, s37, s38
buffer_load_dwordx4 v23, s[8:11], s37 offen sc1 lds
s_add_u32 m0, s39, 67584
s_add_u32 s37, s37, s38
buffer_load_dwordx4 v23, s[8:11], s37 offen sc1 lds
s_add_u32 m0, s39, 68608
s_add_u32 s37, s37, s38
buffer_load_dwordx4 v23, s[8:11], s37 offen sc1 lds
s_add_u32 m0, s39, 69632
s_add_u32 s37, s37, s38
buffer_load_dwordx4 v23, s[8:11], s37 offen sc1 lds
s_add_u32 m0, s39, 70656
s_add_u32 s37, s37, s38
buffer_load_dwordx4 v23, s[8:11], s37 offen sc1 lds
s_add_u32 m0, s39, 71680
s_add_u32 s37, s37, s38
buffer_load_dwordx4 v23, s[8:11], s37 offen sc1 lds
s_add_u32 m0, s39, 72704
s_add_u32 s37, s37, s38
buffer_load_dwordx4 v23, s[8:11], s37 offen sc1 lds
s_waitcnt vmcnt(24)
s_barrier
s_add_u32 s42, s42, 1
s_and_b32 s42, s42, 15
s_add_u32 m0, s39, 73728
s_lshl_b32 s37, s42, 17
buffer_load_dwordx4 v23, s[8:11], s37 offen sc1 lds
s_add_u32 m0, s39, 74752
s_add_u32 s37, s37, s38
buffer_load_dwordx4 v23, s[8:11], s37 offen sc1 lds
s_add_u32 m0, s39, 75776
s_add_u32 s37, s37, s38
buffer_load_dwordx4 v23, s[8:11], s37 offen sc1 lds
s_add_u32 m0, s39, 76800
s_add_u32 s37, s37, s38
buffer_load_dwordx4 v23, s[8:11], s37 offen sc1 lds
s_add_u32 m0, s39, 77824
s_add_u32 s37, s37, s38
buffer_load_dwordx4 v23, s[8:11], s37 offen sc1 lds
s_add_u32 m0, s39, 78848
s_add_u32 s37, s37, s38
buffer_load_dwordx4 v23, s[8:11], s37 offen sc1 lds
s_add_u32 m0, s39, 79872
s_add_u32 s37, s37, s38
buffer_load_dwordx4 v23, s[8:11], s37 offen sc1 lds
s_add_u32 m0, s39, 80896
s_add_u32 s37, s37, s38
buffer_load_dwordx4 v23, s[8:11], s37 offen sc1 lds
s_waitcnt vmcnt(24)
s_barrier
s_add_u32 s42, s42, 1
s_and_b32 s42, s42, 15
s_add_u32 m0, s39, 81920
s_lshl_b32 s37, s42, 17
buffer_load_dwordx4 v23, s[8:11], s37 offen sc1 lds
s_add_u32 m0, s39, 82944
s_add_u32 s37, s37, s38
buffer_load_dwordx4 v23, s[8:11], s37 offen sc1 lds
s_add_u32 m0, s39, 83968
s_add_u32 s37, s37, s38
buffer_load_dwordx4 v23, s[8:11], s37 offen sc1 lds
s_add_u32 m0, s39, 84992
s_add_u32 s37, s37, s38
buffer_load_dwordx4 v23, s[8:11], s37 offen sc1 lds
s_add_u32 m0, s39, 86016
s_add_u32 s37, s37, s38
buffer_load_dwordx4 v23, s[8:11], s37 offen sc1 lds
s_add_u32 m0, s39, 87040
s_add_u32 s37, s37, s38
buffer_load_dwordx4 v23, s[8:11], s37 offen sc1 lds
s_add_u32 m0, s39, 88064
s_add_u32 s37, s37, s38
buffer_load_dwordx4 v23, s[8:11], s37 offen sc1 lds
s_add_u32 m0, s39, 89088
s_add_u32 s37, s37, s38
buffer_load_dwordx4 v23, s[8:11], s37 offen sc1 lds
s_waitcnt vmcnt(24)
s_barrier
s_add_u32 s42, s42, 1
s_and_b32 s42, s42, 15
s_add_u32 m0, s39, 90112
s_lshl_b32 s37, s42, 17
buffer_load_dwordx4 v23, s[8:11], s37 offen sc1 lds
s_add_u32 m0, s39, 91136
s_add_u32 s37, s37, s38
buffer_load_dwordx4 v23, s[8:11], s37 offen sc1 lds
s_add_u32 m0, s39, 92160
s_add_u32 s37, s37, s38
buffer_load_dwordx4 v23, s[8:11], s37 offen sc1 lds
s_add_u32 m0, s39, 93184
s_add_u32 s37, s37, s38
buffer_load_dwordx4 v23, s[8:11], s37 offen sc1 lds
s_add_u32 m0, s39, 94208
s_add_u32 s37, s37, s38
buffer_load_dwordx4 v23, s[8:11], s37 offen sc1 lds
s_add_u32 m0, s39, 95232
s_add_u32 s37, s37, s38
buffer_load_dwordx4 v23, s[8:11], s37 offen sc1 lds
s_add_u32 m0, s39, 96256
s_add_u32 s37, s37, s38
buffer_load_dwordx4 v23, s[8:11], s37 offen sc1 lds
s_add_u32 m0, s39, 97280
s_add_u32 s37, s37, s38
buffer_load_dwordx4 v23, s[8:11], s37 offen sc1 lds
s_waitcnt vmcnt(24)
s_barrier
s_lshl_b32 s43, s35, 8
s_cmp_eq_u32 s51, 1
s_cselect_b32 s8, s4, s6
s_cselect_b32 s9, s5, s7
s_sub_u32 s10, 7340032, s43
s_lshl_b32 s44, s34, 18
s_add_u32 s44, s44, 4194304
s_movk_i32 s38, 28672
s_cmp_eq_u32 s51, 0
s_cselect_b32 s8, s32, s8
s_cselect_b32 s9, s33, s9
s_cselect_b32 s10, 262144, s10
s_cselect_b32 s43, s44, s43
s_cselect_b32 s38, 1024, s38
s_cselect_b32 s45, 0, -1
s_add_u32 s8, s8, s43
s_addc_u32 s9, s9, 0
s_mov_b32 s11, 0x20000
s_lshl_b32 s40, s38, 4
s_add_u32 s42, s35, 15
s_lshl_b32 s39, s51, 14
v_lshrrev_b32 v19, 4, v1
v_lshlrev_b32 v20, 5, v19
v_mul_u32_u24 v19, 6912, v19
v_and_b32 v19, s45, v19
v_and_b32 v20, s45, v20
v_lshlrev_b32 v21, 4, v1
v_xor_b32 v21, v21, v20
v_add_u32 v22, v21, v19
s_and_b32 s45, s45, 128
v_xor_b32 v23, s45, v22
s_waitcnt vmcnt(16)
s_barrier
s_add_u32 s42, s42, 1
s_and_b32 s42, s42, 15
s_add_u32 m0, s39, 98304
s_mul_i32 s37, s42, s40
buffer_load_dwordx4 v22, s[8:11], s37 offen sc1 lds
s_add_u32 m0, s39, 99328
s_add_u32 s37, s37, s38
buffer_load_dwordx4 v23, s[8:11], s37 offen sc1 lds
s_add_u32 m0, s39, 100352
s_add_u32 s37, s37, s38
buffer_load_dwordx4 v22, s[8:11], s37 offen sc1 lds
s_add_u32 m0, s39, 101376
s_add_u32 s37, s37, s38
buffer_load_dwordx4 v23, s[8:11], s37 offen sc1 lds
s_add_u32 m0, s39, 102400
s_add_u32 s37, s37, s38
buffer_load_dwordx4 v22, s[8:11], s37 offen sc1 lds
s_add_u32 m0, s39, 103424
s_add_u32 s37, s37, s38
buffer_load_dwordx4 v23, s[8:11], s37 offen sc1 lds
s_add_u32 m0, s39, 104448
s_add_u32 s37, s37, s38
buffer_load_dwordx4 v22, s[8:11], s37 offen sc1 lds
s_add_u32 m0, s39, 105472
s_add_u32 s37, s37, s38
buffer_load_dwordx4 v23, s[8:11], s37 offen sc1 lds
s_add_u32 m0, s39, 106496
s_add_u32 s37, s37, s38
buffer_load_dwordx4 v22, s[8:11], s37 offen sc1 lds
s_add_u32 m0, s39, 107520
s_add_u32 s37, s37, s38
buffer_load_dwordx4 v23, s[8:11], s37 offen sc1 lds
s_add_u32 m0, s39, 108544
s_add_u32 s37, s37, s38
buffer_load_dwordx4 v22, s[8:11], s37 offen sc1 lds
s_add_u32 m0, s39, 109568
s_add_u32 s37, s37, s38
buffer_load_dwordx4 v23, s[8:11], s37 offen sc1 lds
s_add_u32 m0, s39, 110592
s_add_u32 s37, s37, s38
buffer_load_dwordx4 v22, s[8:11], s37 offen sc1 lds
s_add_u32 m0, s39, 111616
s_add_u32 s37, s37, s38
buffer_load_dwordx4 v23, s[8:11], s37 offen sc1 lds
s_add_u32 m0, s39, 112640
s_add_u32 s37, s37, s38
buffer_load_dwordx4 v22, s[8:11], s37 offen sc1 lds
s_add_u32 m0, s39, 113664
s_add_u32 s37, s37, s38
buffer_load_dwordx4 v23, s[8:11], s37 offen sc1 lds
s_waitcnt vmcnt(24)
s_barrier
s_waitcnt vmcnt(16)
s_barrier
s_add_u32 s42, s42, 1
s_and_b32 s42, s42, 15
s_add_u32 m0, s39, 0
s_mul_i32 s37, s42, s40
buffer_load_dwordx4 v22, s[8:11], s37 offen sc1 lds
s_add_u32 m0, s39, 1024
s_add_u32 s37, s37, s38
buffer_load_dwordx4 v23, s[8:11], s37 offen sc1 lds
s_add_u32 m0, s39, 2048
s_add_u32 s37, s37, s38
buffer_load_dwordx4 v22, s[8:11], s37 offen sc1 lds
s_add_u32 m0, s39, 3072
s_add_u32 s37, s37, s38
buffer_load_dwordx4 v23, s[8:11], s37 offen sc1 lds
s_add_u32 m0, s39, 4096
s_add_u32 s37, s37, s38
buffer_load_dwordx4 v22, s[8:11], s37 offen sc1 lds
s_add_u32 m0, s39, 5120
s_add_u32 s37, s37, s38
buffer_load_dwordx4 v23, s[8:11], s37 offen sc1 lds
s_add_u32 m0, s39, 6144
s_add_u32 s37, s37, s38
buffer_load_dwordx4 v22, s[8:11], s37 offen sc1 lds
s_add_u32 m0, s39, 7168
s_add_u32 s37, s37, s38
buffer_load_dwordx4 v23, s[8:11], s37 offen sc1 lds
s_add_u32 m0, s39, 8192
s_add_u32 s37, s37, s38
buffer_load_dwordx4 v22, s[8:11], s37 offen sc1 lds
s_add_u32 m0, s39, 9216
s_add_u32 s37, s37, s38
buffer_load_dwordx4 v23, s[8:11], s37 offen sc1 lds
s_add_u32 m0, s39, 10240
s_add_u32 s37, s37, s38
buffer_load_dwordx4 v22, s[8:11], s37 offen sc1 lds
s_add_u32 m0, s39, 11264
s_add_u32 s37, s37, s38
buffer_load_dwordx4 v23, s[8:11], s37 offen sc1 lds
s_add_u32 m0, s39, 12288
s_add_u32 s37, s37, s38
buffer_load_dwordx4 v22, s[8:11], s37 offen sc1 lds
s_add_u32 m0, s39, 13312
s_add_u32 s37, s37, s38
buffer_load_dwordx4 v23, s[8:11], s37 offen sc1 lds
s_add_u32 m0, s39, 14336
s_add_u32 s37, s37, s38
buffer_load_dwordx4 v22, s[8:11], s37 offen sc1 lds
s_add_u32 m0, s39, 15360
s_add_u32 s37, s37, s38
buffer_load_dwordx4 v23, s[8:11], s37 offen sc1 lds
s_barrier
s_waitcnt vmcnt(16)
s_barrier
s_add_u32 s42, s42, 1
s_and_b32 s42, s42, 15
s_add_u32 m0, s39, 49152
s_mul_i32 s37, s42, s40
buffer_load_dwordx4 v22, s[8:11], s37 offen sc1 lds
s_add_u32 m0, s39, 50176
s_add_u32 s37, s37, s38
buffer_load_dwordx4 v23, s[8:11], s37 offen sc1 lds
s_add_u32 m0, s39, 51200
s_add_u32 s37, s37, s38
buffer_load_dwordx4 v22, s[8:11], s37 offen sc1 lds
s_add_u32 m0, s39, 52224
s_add_u32 s37, s37, s38
buffer_load_dwordx4 v23, s[8:11], s37 offen sc1 lds
s_add_u32 m0, s39, 53248
s_add_u32 s37, s37, s38
buffer_load_dwordx4 v22, s[8:11], s37 offen sc1 lds
s_add_u32 m0, s39, 54272
s_add_u32 s37, s37, s38
buffer_load_dwordx4 v23, s[8:11], s37 offen sc1 lds
s_add_u32 m0, s39, 55296
s_add_u32 s37, s37, s38
buffer_load_dwordx4 v22, s[8:11], s37 offen sc1 lds
s_add_u32 m0, s39, 56320
s_add_u32 s37, s37, s38
buffer_load_dwordx4 v23, s[8:11], s37 offen sc1 lds
s_add_u32 m0, s39, 57344
s_add_u32 s37, s37, s38
buffer_load_dwordx4 v22, s[8:11], s37 offen sc1 lds
s_add_u32 m0, s39, 58368
s_add_u32 s37, s37, s38
buffer_load_dwordx4 v23, s[8:11], s37 offen sc1 lds
s_add_u32 m0, s39, 59392
s_add_u32 s37, s37, s38
buffer_load_dwordx4 v22, s[8:11], s37 offen sc1 lds
s_add_u32 m0, s39, 60416
s_add_u32 s37, s37, s38
buffer_load_dwordx4 v23, s[8:11], s37 offen sc1 lds
s_add_u32 m0, s39, 61440
s_add_u32 s37, s37, s38
buffer_load_dwordx4 v22, s[8:11], s37 offen sc1 lds
s_add_u32 m0, s39, 62464
s_add_u32 s37, s37, s38
buffer_load_dwordx4 v23, s[8:11], s37 offen sc1 lds
s_add_u32 m0, s39, 63488
s_add_u32 s37, s37, s38
buffer_load_dwordx4 v22, s[8:11], s37 offen sc1 lds
s_add_u32 m0, s39, 64512
s_add_u32 s37, s37, s38
buffer_load_dwordx4 v23, s[8:11], s37 offen sc1 lds
.p2align 3
LP3_83:
s_mul_i32 s43, s2, 28672
s_mul_i32 s44, s51, 7168
s_add_u32 s43, s43, s44
s_add_u32 s80, s60, s43
s_addc_u32 s81, s61, 0
s_waitcnt vmcnt(16)
s_barrier
s_add_u32 s42, s42, 1
s_and_b32 s42, s42, 15
s_add_u32 m0, s39, 98304
s_mul_i32 s37, s42, s40
buffer_load_dwordx4 v22, s[8:11], s37 offen sc1 lds
s_add_u32 m0, s39, 99328
s_add_u32 s37, s37, s38
buffer_load_dwordx4 v23, s[8:11], s37 offen sc1 lds
s_add_u32 m0, s39, 100352
s_add_u32 s37, s37, s38
buffer_load_dwordx4 v22, s[8:11], s37 offen sc1 lds
s_add_u32 m0, s39, 101376
s_add_u32 s37, s37, s38
buffer_load_dwordx4 v23, s[8:11], s37 offen sc1 lds
s_add_u32 m0, s39, 102400
s_add_u32 s37, s37, s38
buffer_load_dwordx4 v22, s[8:11], s37 offen sc1 lds
s_add_u32 m0, s39, 103424
s_add_u32 s37, s37, s38
buffer_load_dwordx4 v23, s[8:11], s37 offen sc1 lds
s_add_u32 m0, s39, 104448
s_add_u32 s37, s37, s38
buffer_load_dwordx4 v22, s[8:11], s37 offen sc1 lds
s_add_u32 m0, s39, 105472
s_add_u32 s37, s37, s38
buffer_load_dwordx4 v23, s[8:11], s37 offen sc1 lds
s_add_u32 m0, s39, 106496
s_add_u32 s37, s37, s38
buffer_load_dwordx4 v22, s[8:11], s37 offen sc1 lds
s_add_u32 m0, s39, 107520
s_add_u32 s37, s37, s38
buffer_load_dwordx4 v23, s[8:11], s37 offen sc1 lds
s_add_u32 m0, s39, 108544
s_add_u32 s37, s37, s38
buffer_load_dwordx4 v22, s[8:11], s37 offen sc1 lds
s_add_u32 m0, s39, 109568
s_add_u32 s37, s37, s38
buffer_load_dwordx4 v23, s[8:11], s37 offen sc1 lds
s_add_u32 m0, s39, 110592
s_add_u32 s37, s37, s38
buffer_load_dwordx4 v22, s[8:11], s37 offen sc1 lds
s_add_u32 m0, s39, 111616
s_add_u32 s37, s37, s38
buffer_load_dwordx4 v23, s[8:11], s37 offen sc1 lds
s_add_u32 m0, s39, 112640
s_add_u32 s37, s37, s38
buffer_load_dwordx4 v22, s[8:11], s37 offen sc1 lds
s_add_u32 m0, s39, 113664
s_add_u32 s37, s37, s38
buffer_load_dwordx4 v23, s[8:11], s37 offen sc1 lds
s_load_dword s64, s[80:81], 0
s_load_dword s65, s[80:81], 64
s_load_dword s66, s[80:81], 128
s_load_dword s67, s[80:81], 192
s_load_dword s68, s[80:81], 256
s_load_dword s69, s[80:81], 320
s_load_dword s70, s[80:81], 384
s_load_dword s71, s[80:81], 448
s_load_dword s72, s[80:81], 512
s_add_u32 s80, s80, 576
s_addc_u32 s81, s81, 0
s_waitcnt vmcnt(16)
s_barrier
s_mov_b32 s41, 2
.p2align 3
Lp3_90:
s_add_u32 s42, s42, 1
s_and_b32 s42, s42, 15
s_add_u32 m0, s39, 0
s_mul_i32 s37, s42, s40
buffer_load_dwordx4 v22, s[8:11], s37 offen sc1 lds
s_add_u32 m0, s39, 1024
s_add_u32 s37, s37, s38
buffer_load_dwordx4 v23, s[8:11], s37 offen sc1 lds
s_add_u32 m0, s39, 2048
s_add_u32 s37, s37, s38
buffer_load_dwordx4 v22, s[8:11], s37 offen sc1 lds
s_add_u32 m0, s39, 3072
s_add_u32 s37, s37, s38
buffer_load_dwordx4 v23, s[8:11], s37 offen sc1 lds
s_add_u32 m0, s39, 4096
s_add_u32 s37, s37, s38
buffer_load_dwordx4 v22, s[8:11], s37 offen sc1 lds
s_add_u32 m0, s39, 5120
s_add_u32 s37, s37, s38
buffer_load_dwordx4 v23, s[8:11], s37 offen sc1 lds
s_add_u32 m0, s39, 6144
s_add_u32 s37, s37, s38
buffer_load_dwordx4 v22, s[8:11], s37 offen sc1 lds
s_add_u32 m0, s39, 7168
s_add_u32 s37, s37, s38
buffer_load_dwordx4 v23, s[8:11], s37 offen sc1 lds
s_add_u32 m0, s39, 8192
s_add_u32 s37, s37, s38
buffer_load_dwordx4 v22, s[8:11], s37 offen sc1 lds
s_add_u32 m0, s39, 9216
s_add_u32 s37, s37, s38
buffer_load_dwordx4 v23, s[8:11], s37 offen sc1 lds
s_add_u32 m0, s39, 10240
s_add_u32 s37, s37, s38
buffer_load_dwordx4 v22, s[8:11], s37 offen sc1 lds
s_add_u32 m0, s39, 11264
s_add_u32 s37, s37, s38
buffer_load_dwordx4 v23, s[8:11], s37 offen sc1 lds
s_add_u32 m0, s39, 12288
s_add_u32 s37, s37, s38
buffer_load_dwordx4 v22, s[8:11], s37 offen sc1 lds
s_add_u32 m0, s39, 13312
s_add_u32 s37, s37, s38
buffer_load_dwordx4 v23, s[8:11], s37 offen sc1 lds
s_add_u32 m0, s39, 14336
s_add_u32 s37, s37, s38
buffer_load_dwordx4 v22, s[8:11], s37 offen sc1 lds
s_add_u32 m0, s39, 15360
s_add_u32 s37, s37, s38
buffer_load_dwordx4 v23, s[8:11], s37 offen sc1 lds
s_load_dword s64, s[80:81], 0
s_load_dword s65, s[80:81], 64
s_load_dword s66, s[80:81], 128
s_load_dword s67, s[80:81], 192
s_load_dword s68, s[80:81], 256
s_load_dword s69, s[80:81], 320
s_load_dword s70, s[80:81], 384
s_load_dword s71, s[80:81], 448
s_load_dword s72, s[80:81], 512
s_add_u32 s80, s80, 576
s_addc_u32 s81, s81, 0
s_waitcnt vmcnt(16)
s_barrier
s_add_u32 s42, s42, 1
s_and_b32 s42, s42, 15
s_add_u32 m0, s39, 49152
s_mul_i32 s37, s42, s40
buffer_load_dwordx4 v22, s[8:11], s37 offen sc1 lds
s_add_u32 m0, s39, 50176
s_add_u32 s37, s37, s38
buffer_load_dwordx4 v23, s[8:11], s37 offen sc1 lds
s_add_u32 m0, s39, 51200
s_add_u32 s37, s37, s38
buffer_load_dwordx4 v22, s[8:11], s37 offen sc1 lds
s_add_u32 m0, s39, 52224
s_add_u32 s37, s37, s38
buffer_load_dwordx4 v23, s[8:11], s37 offen sc1 lds
s_add_u32 m0, s39, 53248
s_add_u32 s37, s37, s38
buffer_load_dwordx4 v22, s[8:11], s37 offen sc1 lds
s_add_u32 m0, s39, 54272
s_add_u32 s37, s37, s38
buffer_load_dwordx4 v23, s[8:11], s37 offen sc1 lds
s_add_u32 m0, s39, 55296
s_add_u32 s37, s37, s38
buffer_load_dwordx4 v22, s[8:11], s37 offen sc1 lds
s_add_u32 m0, s39, 56320
s_add_u32 s37, s37, s38
buffer_load_dwordx4 v23, s[8:11], s37 offen sc1 lds
s_add_u32 m0, s39, 57344
s_add_u32 s37, s37, s38
buffer_load_dwordx4 v22, s[8:11], s37 offen sc1 lds
s_add_u32 m0, s39, 58368
s_add_u32 s37, s37, s38
buffer_load_dwordx4 v23, s[8:11], s37 offen sc1 lds
s_add_u32 m0, s39, 59392
s_add_u32 s37, s37, s38
buffer_load_dwordx4 v22, s[8:11], s37 offen sc1 lds
s_add_u32 m0, s39, 60416
s_add_u32 s37, s37, s38
buffer_load_dwordx4 v23, s[8:11], s37 offen sc1 lds
s_add_u32 m0, s39, 61440
s_add_u32 s37, s37, s38
buffer_load_dwordx4 v22, s[8:11], s37 offen sc1 lds
s_add_u32 m0, s39, 62464
s_add_u32 s37, s37, s38
buffer_load_dwordx4 v23, s[8:11], s37 offen sc1 lds
s_add_u32 m0, s39, 63488
s_add_u32 s37, s37, s38
buffer_load_dwordx4 v22, s[8:11], s37 offen sc1 lds
s_add_u32 m0, s39, 64512
s_add_u32 s37, s37, s38
buffer_load_dwordx4 v23, s[8:11], s37 offen sc1 lds
s_load_dword s64, s[80:81], 0
s_load_dword s65, s[80:81], 64
s_load_dword s66, s[80:81], 128
s_load_dword s67, s[80:81], 192
s_load_dword s68, s[80:81], 256
s_load_dword s69, s[80:81], 320
s_load_dword s70, s[80:81], 384
s_load_dword s71, s[80:81], 448
s_load_dword s72, s[80:81], 512
s_add_u32 s80, s80, 576
s_addc_u32 s81, s81, 0
s_waitcnt vmcnt(16)
s_barrier
s_add_u32 s42, s42, 1
s_and_b32 s42, s42, 15
s_add_u32 m0, s39, 98304
s_mul_i32 s37, s42, s40
buffer_load_dwordx4 v22, s[8:11], s37 offen sc1 lds
s_add_u32 m0, s39, 99328
s_add_u32 s37, s37, s38
buffer_load_dwordx4 v23, s[8:11], s37 offen sc1 lds
s_add_u32 m0, s39, 100352
s_add_u32 s37, s37, s38
buffer_load_dwordx4 v22, s[8:11], s37 offen sc1 lds
s_add_u32 m0, s39, 101376
s_add_u32 s37, s37, s38
buffer_load_dwordx4 v23, s[8:11], s37 offen sc1 lds
s_add_u32 m0, s39, 102400
s_add_u32 s37, s37, s38
buffer_load_dwordx4 v22, s[8:11], s37 offen sc1 lds
s_add_u32 m0, s39, 103424
s_add_u32 s37, s37, s38
buffer_load_dwordx4 v23, s[8:11], s37 offen sc1 lds
s_add_u32 m0, s39, 104448
s_add_u32 s37, s37, s38
buffer_load_dwordx4 v22, s[8:11], s37 offen sc1 lds
s_add_u32 m0, s39, 105472
s_add_u32 s37, s37, s38
buffer_load_dwordx4 v23, s[8:11], s37 offen sc1 lds
s_add_u32 m0, s39, 106496
s_add_u32 s37, s37, s38
buffer_load_dwordx4 v22, s[8:11], s37 offen sc1 lds
s_add_u32 m0, s39, 107520
s_add_u32 s37, s37, s38
buffer_load_dwordx4 v23, s[8:11], s37 offen sc1 lds
s_add_u32 m0, s39, 108544
s_add_u32 s37, s37, s38
buffer_load_dwordx4 v22, s[8:11], s37 offen sc1 lds
s_add_u32 m0, s39, 109568
s_add_u32 s37, s37, s38
buffer_load_dwordx4 v23, s[8:11], s37 offen sc1 lds
s_add_u32 m0, s39, 110592
s_add_u32 s37, s37, s38
buffer_load_dwordx4 v22, s[8:11], s37 offen sc1 lds
s_add_u32 m0, s39, 111616
s_add_u32 s37, s37, s38
buffer_load_dwordx4 v23, s[8:11], s37 offen sc1 lds
s_add_u32 m0, s39, 112640
s_add_u32 s37, s37, s38
buffer_load_dwordx4 v22, s[8:11], s37 offen sc1 lds
s_add_u32 m0, s39, 113664
s_add_u32 s37, s37, s38
buffer_load_dwordx4 v23, s[8:11], s37 offen sc1 lds
s_load_dword s64, s[80:81], 0
s_load_dword s65, s[80:81], 64
s_load_dword s66, s[80:81], 128
s_load_dword s67, s[80:81], 192
s_load_dword s68, s[80:81], 256
s_load_dword s69, s[80:81], 320
s_load_dword s70, s[80:81], 384
s_load_dword s71, s[80:81], 448
s_load_dword s72, s[80:81], 512
s_add_u32 s80, s80, 576
s_addc_u32 s81, s81, 0
s_waitcnt vmcnt(16)
s_barrier
s_sub_u32 s41, s41, 1
s_cmp_lg_u32 s41, 0
s_cbranch_scc1 Lp3_90
s_add_u32 s42, s42, 1
s_and_b32 s42, s42, 15
s_add_u32 m0, s39, 0
s_mul_i32 s37, s42, s40
buffer_load_dwordx4 v22, s[8:11], s37 offen sc1 lds
s_add_u32 m0, s39, 1024
s_add_u32 s37, s37, s38
buffer_load_dwordx4 v23, s[8:11], s37 offen sc1 lds
s_add_u32 m0, s39, 2048
s_add_u32 s37, s37, s38
buffer_load_dwordx4 v22, s[8:11], s37 offen sc1 lds
s_add_u32 m0, s39, 3072
s_add_u32 s37, s37, s38
buffer_load_dwordx4 v23, s[8:11], s37 offen sc1 lds
s_add_u32 m0, s39, 4096
s_add_u32 s37, s37, s38
buffer_load_dwordx4 v22, s[8:11], s37 offen sc1 lds
s_add_u32 m0, s39, 5120
s_add_u32 s37, s37, s38
buffer_load_dwordx4 v23, s[8:11], s37 offen sc1 lds
s_add_u32 m0, s39, 6144
s_add_u32 s37, s37, s38
buffer_load_dwordx4 v22, s[8:11], s37 offen sc1 lds
s_add_u32 m0, s39, 7168
s_add_u32 s37, s37, s38
buffer_load_dwordx4 v23, s[8:11], s37 offen sc1 lds
s_add_u32 m0, s39, 8192
s_add_u32 s37, s37, s38
buffer_load_dwordx4 v22, s[8:11], s37 offen sc1 lds
s_add_u32 m0, s39, 9216
s_add_u32 s37, s37, s38
buffer_load_dwordx4 v23, s[8:11], s37 offen sc1 lds
s_add_u32 m0, s39, 10240
s_add_u32 s37, s37, s38
buffer_load_dwordx4 v22, s[8:11], s37 offen sc1 lds
s_add_u32 m0, s39, 11264
s_add_u32 s37, s37, s38
buffer_load_dwordx4 v23, s[8:11], s37 offen sc1 lds
s_add_u32 m0, s39, 12288
s_add_u32 s37, s37, s38
buffer_load_dwordx4 v22, s[8:11], s37 offen sc1 lds
s_add_u32 m0, s39, 13312
s_add_u32 s37, s37, s38
buffer_load_dwordx4 v23, s[8:11], s37 offen sc1 lds
s_add_u32 m0, s39, 14336
s_add_u32 s37, s37, s38
buffer_load_dwordx4 v22, s[8:11], s37 offen sc1 lds
s_add_u32 m0, s39, 15360
s_add_u32 s37, s37, s38
buffer_load_dwordx4 v23, s[8:11], s37 offen sc1 lds
s_load_dword s64, s[80:81], 0
s_load_dword s65, s[80:81], 64
s_load_dword s66, s[80:81], 128
s_load_dword s67, s[80:81], 192
s_load_dword s68, s[80:81], 256
s_load_dword s69, s[80:81], 320
s_load_dword s70, s[80:81], 384
s_load_dword s71, s[80:81], 448
s_load_dword s72, s[80:81], 512
s_add_u32 s80, s80, 576
s_addc_u32 s81, s81, 0
s_waitcnt vmcnt(16)
s_barrier
s_add_u32 s42, s42, 1
s_and_b32 s42, s42, 15
s_add_u32 m0, s39, 49152
s_mul_i32 s37, s42, s40
buffer_load_dwordx4 v22, s[8:11], s37 offen sc1 lds
s_add_u32 m0, s39, 50176
s_add_u32 s37, s37, s38
buffer_load_dwordx4 v23, s[8:11], s37 offen sc1 lds
s_add_u32 m0, s39, 51200
s_add_u32 s37, s37, s38
buffer_load_dwordx4 v22, s[8:11], s37 offen sc1 lds
s_add_u32 m0, s39, 52224
s_add_u32 s37, s37, s38
buffer_load_dwordx4 v23, s[8:11], s37 offen sc1 lds
s_add_u32 m0, s39, 53248
s_add_u32 s37, s37, s38
buffer_load_dwordx4 v22, s[8:11], s37 offen sc1 lds
s_add_u32 m0, s39, 54272
s_add_u32 s37, s37, s38
buffer_load_dwordx4 v23, s[8:11], s37 offen sc1 lds
s_add_u32 m0, s39, 55296
s_add_u32 s37, s37, s38
buffer_load_dwordx4 v22, s[8:11], s37 offen sc1 lds
s_add_u32 m0, s39, 56320
s_add_u32 s37, s37, s38
buffer_load_dwordx4 v23, s[8:11], s37 offen sc1 lds
s_add_u32 m0, s39, 57344
s_add_u32 s37, s37, s38
buffer_load_dwordx4 v22, s[8:11], s37 offen sc1 lds
s_add_u32 m0, s39, 58368
s_add_u32 s37, s37, s38
buffer_load_dwordx4 v23, s[8:11], s37 offen sc1 lds
s_add_u32 m0, s39, 59392
s_add_u32 s37, s37, s38
buffer_load_dwordx4 v22, s[8:11], s37 offen sc1 lds
s_add_u32 m0, s39, 60416
s_add_u32 s37, s37, s38
buffer_load_dwordx4 v23, s[8:11], s37 offen sc1 lds
s_add_u32 m0, s39, 61440
s_add_u32 s37, s37, s38
buffer_load_dwordx4 v22, s[8:11], s37 offen sc1 lds
s_add_u32 m0, s39, 62464
s_add_u32 s37, s37, s38
buffer_load_dwordx4 v23, s[8:11], s37 offen sc1 lds
s_add_u32 m0, s39, 63488
s_add_u32 s37, s37, s38
buffer_load_dwordx4 v22, s[8:11], s37 offen sc1 lds
s_add_u32 m0, s39, 64512
s_add_u32 s37, s37, s38
buffer_load_dwordx4 v23, s[8:11], s37 offen sc1 lds
s_load_dword s64, s[80:81], 0
s_load_dword s65, s[80:81], 64
s_load_dword s66, s[80:81], 128
s_load_dword s67, s[80:81], 192
s_load_dword s68, s[80:81], 256
s_load_dword s69, s[80:81], 320
s_load_dword s70, s[80:81], 384
s_load_dword s71, s[80:81], 448
s_load_dword s72, s[80:81], 512
s_add_u32 s80, s80, 576
s_addc_u32 s81, s81, 0
s_waitcnt vmcnt(16)
s_barrier
s_add_u32 s42, s42, 1
s_and_b32 s42, s42, 15
s_add_u32 m0, s39, 98304
s_mul_i32 s37, s42, s40
buffer_load_dwordx4 v22, s[8:11], s37 offen sc1 lds
s_and_b32 s53, s35, 1
s_lshl_b32 s53, s53, 1
s_mul_i32 s43, s47, 3
s_add_u32 m0, s39, 99328
s_add_u32 s37, s37, s38
buffer_load_dwordx4 v23, s[8:11], s37 offen sc1 lds
s_add_u32 s53, s53, s43
v_lshlrev_b32 v19, 11, v18
v_lshl_add_u32 v19, v17, 4, v19
s_add_u32 m0, s39, 100352
s_add_u32 s37, s37, s38
buffer_load_dwordx4 v22, s[8:11], s37 offen sc1 lds
s_lshl_b32 s43, s46, 10
v_add_u32 v2, s43, v19
v_add_u32 v3, 49152, v2
s_add_u32 m0, s39, 101376
s_add_u32 s37, s37, s38
buffer_load_dwordx4 v23, s[8:11], s37 offen sc1 lds
v_add_u32 v4, 98304, v2
v_lshrrev_b32 v19, 2, v17
v_lshl_add_u32 v20, v18, 2, v19
s_add_u32 m0, s39, 102400
s_add_u32 s37, s37, s38
buffer_load_dwordx4 v22, s[8:11], s37 offen sc1 lds
v_and_b32 v21, 7, v20
v_lshlrev_b32 v20, 8, v20
v_and_b32 v19, 3, v1
s_add_u32 m0, s39, 103424
s_add_u32 s37, s37, s38
buffer_load_dwordx4 v23, s[8:11], s37 offen sc1 lds
v_lshl_add_u32 v20, v19, 3, v20
s_add_u32 s43, s53, 0
v_xor_b32 v19, s43, v21
s_add_u32 m0, s39, 104448
s_add_u32 s37, s37, s38
buffer_load_dwordx4 v22, s[8:11], s37 offen sc1 lds
v_lshl_add_u32 v5, v19, 5, v20
s_add_u32 s43, s53, 1
v_xor_b32 v19, s43, v21
s_add_u32 m0, s39, 105472
s_add_u32 s37, s37, s38
buffer_load_dwordx4 v23, s[8:11], s37 offen sc1 lds
v_lshl_add_u32 v6, v19, 5, v20
s_add_u32 s43, s53, 2
v_xor_b32 v19, s43, v21
s_add_u32 m0, s39, 106496
s_add_u32 s37, s37, s38
buffer_load_dwordx4 v22, s[8:11], s37 offen sc1 lds
v_lshl_add_u32 v7, v19, 5, v20
v_add_u32 v9, 49152, v5
v_add_u32 v10, 49152, v6
s_add_u32 m0, s39, 107520
s_add_u32 s37, s37, s38
buffer_load_dwordx4 v23, s[8:11], s37 offen sc1 lds
v_add_u32 v11, 49152, v7
v_add_u32 v13, 98304, v5
v_add_u32 v14, 98304, v6
s_add_u32 m0, s39, 108544
s_add_u32 s37, s37, s38
buffer_load_dwordx4 v22, s[8:11], s37 offen sc1 lds
v_add_u32 v15, 98304, v7
s_lshl_b32 s43, s46, 9
s_add_u32 s43, s43, 147456
s_add_u32 m0, s39, 109568
s_add_u32 s37, s37, s38
buffer_load_dwordx4 v23, s[8:11], s37 offen sc1 lds
v_lshl_add_u32 v19, v17, 3, s43
ds_read_b64 v[80:81], v19 offset:0
ds_read_b64 v[82:83], v19 offset:128
s_add_u32 m0, s39, 110592
s_add_u32 s37, s37, s38
buffer_load_dwordx4 v22, s[8:11], s37 offen sc1 lds
ds_read_b64 v[84:85], v19 offset:256
ds_read_b64 v[86:87], v19 offset:384
s_mul_i32 s43, s47, 192
s_add_u32 m0, s39, 111616
s_add_u32 s37, s37, s38
buffer_load_dwordx4 v23, s[8:11], s37 offen sc1 lds
s_add_u32 s43, s43, 148992
v_lshl_add_u32 v19, v18, 4, s43
ds_read_b128 v[48:51], v19 offset:0
s_add_u32 m0, s39, 112640
s_add_u32 s37, s37, s38
buffer_load_dwordx4 v22, s[8:11], s37 offen sc1 lds
ds_read_b128 v[52:55], v19 offset:64
ds_read_b128 v[56:59], v19 offset:128
ds_read_b128 v[60:63], v19 offset:896
s_add_u32 m0, s39, 113664
s_add_u32 s37, s37, s38
buffer_load_dwordx4 v23, s[8:11], s37 offen sc1 lds
ds_read_b128 v[64:67], v19 offset:960
ds_read_b128 v[68:71], v19 offset:1024
s_waitcnt vmcnt(16)
s_barrier
s_add_u32 s42, s42, 1
s_and_b32 s42, s42, 15
s_add_u32 m0, s39, 0
s_mul_i32 s37, s42, s40
buffer_load_dwordx4 v22, s[8:11], s37 offen sc1 lds
s_waitcnt lgkmcnt(0)
v_mul_f32 v88, v81, v81
s_add_u32 m0, s39, 1024
s_add_u32 s37, s37, s38
buffer_load_dwordx4 v23, s[8:11], s37 offen sc1 lds
v_mul_f32 v228, 0xc0135761, v81
s_add_u32 m0, s39, 2048
s_add_u32 s37, s37, s38
buffer_load_dwordx4 v22, s[8:11], s37 offen sc1 lds
v_mul_f32 v89, 0xbdd2d3e8, v81
s_add_u32 m0, s39, 3072
s_add_u32 s37, s37, s38
buffer_load_dwordx4 v23, s[8:11], s37 offen sc1 lds
v_rcp_f32 v236, v88
v_mul_f32 v232, v89, v88
s_add_u32 m0, s39, 4096
s_add_u32 s37, s37, s38
buffer_load_dwordx4 v22, s[8:11], s37 offen sc1 lds
v_mul_f32 v88, v83, v83
s_add_u32 m0, s39, 5120
s_add_u32 s37, s37, s38
buffer_load_dwordx4 v23, s[8:11], s37 offen sc1 lds
v_mul_f32 v229, 0xc0135761, v83
s_add_u32 m0, s39, 6144
s_add_u32 s37, s37, s38
buffer_load_dwordx4 v22, s[8:11], s37 offen sc1 lds
v_mul_f32 v89, 0xbdd2d3e8, v83
v_rcp_f32 v237, v88
s_add_u32 m0, s39, 7168
s_add_u32 s37, s37, s38
buffer_load_dwordx4 v23, s[8:11], s37 offen sc1 lds
v_mul_f32 v233, v89, v88
s_add_u32 m0, s39, 8192
s_add_u32 s37, s37, s38
buffer_load_dwordx4 v22, s[8:11], s37 offen sc1 lds
v_mul_f32 v88, v85, v85
s_add_u32 m0, s39, 9216
s_add_u32 s37, s37, s38
buffer_load_dwordx4 v23, s[8:11], s37 offen sc1 lds
v_mul_f32 v230, 0xc0135761, v85
v_mul_f32 v89, 0xbdd2d3e8, v85
s_add_u32 m0, s39, 10240
s_add_u32 s37, s37, s38
buffer_load_dwordx4 v22, s[8:11], s37 offen sc1 lds
v_rcp_f32 v238, v88
s_add_u32 m0, s39, 11264
s_add_u32 s37, s37, s38
buffer_load_dwordx4 v23, s[8:11], s37 offen sc1 lds
v_mul_f32 v234, v89, v88
s_add_u32 m0, s39, 12288
s_add_u32 s37, s37, s38
buffer_load_dwordx4 v22, s[8:11], s37 offen sc1 lds
v_mul_f32 v88, v87, v87
v_mul_f32 v231, 0xc0135761, v87
s_add_u32 m0, s39, 13312
s_add_u32 s37, s37, s38
buffer_load_dwordx4 v23, s[8:11], s37 offen sc1 lds
v_mul_f32 v89, 0xbdd2d3e8, v87
s_add_u32 m0, s39, 14336
s_add_u32 s37, s37, s38
buffer_load_dwordx4 v22, s[8:11], s37 offen sc1 lds
v_rcp_f32 v239, v88
s_add_u32 m0, s39, 15360
s_add_u32 s37, s37, s38
buffer_load_dwordx4 v23, s[8:11], s37 offen sc1 lds
v_mul_f32 v235, v89, v88
s_mul_i32 s43, s34, 917504
s_mul_i32 s44, s49, 24576
s_add_u32 s43, s43, s44
s_add_u32 s43, s43, 8912896
s_add_u32 s24, s32, s43
s_addc_u32 s25, s33, 0
s_mov_b32 s26, 24576
s_mov_b32 s27, 0x20000
s_mov_b32 s53, 262144
s_lshl_b32 s43, s47, 13
s_lshl_b32 s44, s46, 10
s_add_u32 s43, s43, s44
v_lshlrev_b32 v19, 11, v18
v_lshl_add_u32 v19, v17, 4, v19
v_add_u32 v27, s43, v19
s_lshl_b32 s43, s47, 12
s_add_u32 s43, s43, s44
s_add_u32 s43, s43, 16384
v_and_b32 v19, 1, v18
v_lshlrev_b32 v19, 11, v19
v_lshrrev_b32 v20, 1, v18
v_lshl_add_u32 v19, v20, 8, v19
v_lshl_add_u32 v19, v17, 4, v19
v_add_u32 v28, s43, v19
s_load_dword s64, s[80:81], 0
s_load_dword s65, s[80:81], 64
s_load_dword s66, s[80:81], 128
s_load_dword s67, s[80:81], 192
s_load_dword s68, s[80:81], 256
s_load_dword s69, s[80:81], 320
s_load_dword s70, s[80:81], 384
s_load_dword s71, s[80:81], 448
s_add_u32 s80, s80, 512
s_addc_u32 s81, s81, 0
s_waitcnt vmcnt(16)
s_barrier
s_add_u32 s42, s42, 1
s_and_b32 s42, s42, 15
s_add_u32 m0, s39, 49152
s_mul_i32 s37, s42, s40
buffer_load_dwordx4 v22, s[8:11], s37 offen sc1 lds
v_mul_f32 v128, -v80, v48
v_mul_f32 v129, -v80, v49
s_add_u32 m0, s39, 50176
s_add_u32 s37, s37, s38
buffer_load_dwordx4 v23, s[8:11], s37 offen sc1 lds
v_mul_f32 v130, -v80, v50
v_mul_f32 v131, -v80, v51
s_add_u32 m0, s39, 51200
s_add_u32 s37, s37, s38
buffer_load_dwordx4 v22, s[8:11], s37 offen sc1 lds
v_mul_f32 v132, -v82, v48
v_mul_f32 v133, -v82, v49
s_add_u32 m0, s39, 52224
s_add_u32 s37, s37, s38
buffer_load_dwordx4 v23, s[8:11], s37 offen sc1 lds
v_mul_f32 v134, -v82, v50
v_mul_f32 v135, -v82, v51
s_add_u32 m0, s39, 53248
s_add_u32 s37, s37, s38
buffer_load_dwordx4 v22, s[8:11], s37 offen sc1 lds
v_mul_f32 v136, -v84, v48
v_mul_f32 v137, -v84, v49
s_add_u32 m0, s39, 54272
s_add_u32 s37, s37, s38
buffer_load_dwordx4 v23, s[8:11], s37 offen sc1 lds
v_mul_f32 v138, -v84, v50
v_mul_f32 v139, -v84, v51
s_add_u32 m0, s39, 55296
s_add_u32 s37, s37, s38
buffer_load_dwordx4 v22, s[8:11], s37 offen sc1 lds
v_mul_f32 v140, -v86, v48
v_mul_f32 v141, -v86, v49
s_add_u32 m0, s39, 56320
s_add_u32 s37, s37, s38
buffer_load_dwordx4 v23, s[8:11], s37 offen sc1 lds
v_mul_f32 v142, -v86, v50
v_mul_f32 v143, -v86, v51
s_add_u32 m0, s39, 57344
s_add_u32 s37, s37, s38
buffer_load_dwordx4 v22, s[8:11], s37 offen sc1 lds
v_mul_f32 v144, -v80, v52
v_mul_f32 v145, -v80, v53
s_add_u32 m0, s39, 58368
s_add_u32 s37, s37, s38
buffer_load_dwordx4 v23, s[8:11], s37 offen sc1 lds
v_mul_f32 v146, -v80, v54
v_mul_f32 v147, -v80, v55
s_add_u32 m0, s39, 59392
s_add_u32 s37, s37, s38
buffer_load_dwordx4 v22, s[8:11], s37 offen sc1 lds
v_mul_f32 v148, -v82, v52
v_mul_f32 v149, -v82, v53
s_add_u32 m0, s39, 60416
s_add_u32 s37, s37, s38
buffer_load_dwordx4 v23, s[8:11], s37 offen sc1 lds
v_mul_f32 v150, -v82, v54
v_mul_f32 v151, -v82, v55
s_add_u32 m0, s39, 61440
s_add_u32 s37, s37, s38
buffer_load_dwordx4 v22, s[8:11], s37 offen sc1 lds
v_mul_f32 v152, -v84, v52
v_mul_f32 v153, -v84, v53
s_add_u32 m0, s39, 62464
s_add_u32 s37, s37, s38
buffer_load_dwordx4 v23, s[8:11], s37 offen sc1 lds
v_mul_f32 v154, -v84, v54
v_mul_f32 v155, -v84, v55
s_add_u32 m0, s39, 63488
s_add_u32 s37, s37, s38
buffer_load_dwordx4 v22, s[8:11], s37 offen sc1 lds
v_mul_f32 v156, -v86, v52
v_mul_f32 v157, -v86, v53
s_add_u32 m0, s39, 64512
s_add_u32 s37, s37, s38
buffer_load_dwordx4 v23, s[8:11], s37 offen sc1 lds
v_mul_f32 v158, -v86, v54
v_mul_f32 v159, -v86, v55
s_load_dword s64, s[80:81], 0
s_load_dword s65, s[80:81], 64
s_load_dword s66, s[80:81], 128
s_load_dword s67, s[80:81], 192
s_load_dword s68, s[80:81], 256
s_load_dword s69, s[80:81], 320
s_load_dword s70, s[80:81], 384
s_load_dword s71, s[80:81], 448
s_add_u32 s80, s80, 512
s_addc_u32 s81, s81, 0
s_waitcnt vmcnt(16)
s_barrier
s_add_u32 s42, s42, 1
s_and_b32 s42, s42, 15
s_add_u32 m0, s39, 98304
s_mul_i32 s37, s42, s40
buffer_load_dwordx4 v22, s[8:11], s37 offen sc1 lds
v_mul_f32 v160, -v80, v56
v_mul_f32 v161, -v80, v57
s_add_u32 m0, s39, 99328
s_add_u32 s37, s37, s38
buffer_load_dwordx4 v23, s[8:11], s37 offen sc1 lds
v_mul_f32 v162, -v80, v58
v_mul_f32 v163, -v80, v59
s_add_u32 m0, s39, 100352
s_add_u32 s37, s37, s38
buffer_load_dwordx4 v22, s[8:11], s37 offen sc1 lds
v_mul_f32 v164, -v82, v56
v_mul_f32 v165, -v82, v57
s_add_u32 m0, s39, 101376
s_add_u32 s37, s37, s38
buffer_load_dwordx4 v23, s[8:11], s37 offen sc1 lds
v_mul_f32 v166, -v82, v58
v_mul_f32 v167, -v82, v59
s_add_u32 m0, s39, 102400
s_add_u32 s37, s37, s38
buffer_load_dwordx4 v22, s[8:11], s37 offen sc1 lds
v_mul_f32 v168, -v84, v56
v_mul_f32 v169, -v84, v57
s_add_u32 m0, s39, 103424
s_add_u32 s37, s37, s38
buffer_load_dwordx4 v23, s[8:11], s37 offen sc1 lds
v_mul_f32 v170, -v84, v58
v_mul_f32 v171, -v84, v59
s_add_u32 m0, s39, 104448
s_add_u32 s37, s37, s38
buffer_load_dwordx4 v22, s[8:11], s37 offen sc1 lds
v_mul_f32 v172, -v86, v56
v_mul_f32 v173, -v86, v57
s_add_u32 m0, s39, 105472
s_add_u32 s37, s37, s38
buffer_load_dwordx4 v23, s[8:11], s37 offen sc1 lds
v_mul_f32 v174, -v86, v58
v_mul_f32 v175, -v86, v59
s_add_u32 m0, s39, 106496
s_add_u32 s37, s37, s38
buffer_load_dwordx4 v22, s[8:11], s37 offen sc1 lds
v_mul_f32 v176, -v80, v60
v_mul_f32 v177, -v80, v61
s_add_u32 m0, s39, 107520
s_add_u32 s37, s37, s38
buffer_load_dwordx4 v23, s[8:11], s37 offen sc1 lds
v_mul_f32 v178, -v80, v62
v_mul_f32 v179, -v80, v63
s_add_u32 m0, s39, 108544
s_add_u32 s37, s37, s38
buffer_load_dwordx4 v22, s[8:11], s37 offen sc1 lds
v_mul_f32 v180, -v82, v60
v_mul_f32 v181, -v82, v61
s_add_u32 m0, s39, 109568
s_add_u32 s37, s37, s38
buffer_load_dwordx4 v23, s[8:11], s37 offen sc1 lds
v_mul_f32 v182, -v82, v62
v_mul_f32 v183, -v82, v63
s_add_u32 m0, s39, 110592
s_add_u32 s37, s37, s38
buffer_load_dwordx4 v22, s[8:11], s37 offen sc1 lds
v_mul_f32 v184, -v84, v60
v_mul_f32 v185, -v84, v61
s_add_u32 m0, s39, 111616
s_add_u32 s37, s37, s38
buffer_load_dwordx4 v23, s[8:11], s37 offen sc1 lds
v_mul_f32 v186, -v84, v62
v_mul_f32 v187, -v84, v63
s_add_u32 m0, s39, 112640
s_add_u32 s37, s37, s38
buffer_load_dwordx4 v22, s[8:11], s37 offen sc1 lds
v_mul_f32 v188, -v86, v60
v_mul_f32 v189, -v86, v61
s_add_u32 m0, s39, 113664
s_add_u32 s37, s37, s38
buffer_load_dwordx4 v23, s[8:11], s37 offen sc1 lds
v_mul_f32 v190, -v86, v62
v_mul_f32 v191, -v86, v63
s_load_dword s64, s[80:81], 0
s_load_dword s65, s[80:81], 64
s_load_dword s66, s[80:81], 128
s_load_dword s67, s[80:81], 192
s_load_dword s68, s[80:81], 256
s_load_dword s69, s[80:81], 320
s_load_dword s70, s[80:81], 384
s_load_dword s71, s[80:81], 448
s_add_u32 s80, s80, 512
s_addc_u32 s81, s81, 0
s_waitcnt vmcnt(16)
s_barrier
s_mul_i32 s43, s49, 192
s_and_b32 s43, s43, 0xffffff80
s_add_u32 s43, s43, 4096
s_cmp_eq_u32 s51, 1
s_cselect_b32 s8, s4, s6
s_cselect_b32 s9, s5, s7
s_sub_u32 s10, 7340032, s43
s_lshl_b32 s44, s34, 18
s_add_u32 s44, s44, 4194304
s_movk_i32 s38, 28672
s_cmp_eq_u32 s51, 0
s_cselect_b32 s8, s32, s8
s_cselect_b32 s9, s33, s9
s_cselect_b32 s10, 262144, s10
s_cselect_b32 s43, s44, s43
s_cselect_b32 s38, 1024, s38
s_cselect_b32 s45, 0, -1
s_add_u32 s8, s8, s43
s_addc_u32 s9, s9, 0
s_mov_b32 s11, 0x20000
s_lshl_b32 s40, s38, 4
s_add_u32 s42, s35, 15
s_lshl_b32 s39, s51, 14
v_lshrrev_b32 v19, 4, v1
v_lshlrev_b32 v20, 5, v19
v_mul_u32_u24 v19, 6912, v19
v_and_b32 v19, s45, v19
v_and_b32 v20, s45, v20
v_lshlrev_b32 v21, 4, v1
v_xor_b32 v21, v21, v20
v_add_u32 v22, v21, v19
s_and_b32 s45, s45, 128
v_xor_b32 v23, s45, v22
s_add_u32 s42, s42, 1
s_and_b32 s42, s42, 15
s_add_u32 m0, s39, 0
s_mul_i32 s37, s42, s40
buffer_load_dwordx4 v22, s[8:11], s37 offen sc1 lds
v_mul_f32 v192, -v80, v64
v_mul_f32 v193, -v80, v65
s_add_u32 m0, s39, 1024
s_add_u32 s37, s37, s38
buffer_load_dwordx4 v23, s[8:11], s37 offen sc1 lds
v_mul_f32 v194, -v80, v66
v_mul_f32 v195, -v80, v67
s_add_u32 m0, s39, 2048
s_add_u32 s37, s37, s38
buffer_load_dwordx4 v22, s[8:11], s37 offen sc1 lds
v_mul_f32 v196, -v82, v64
v_mul_f32 v197, -v82, v65
s_add_u32 m0, s39, 3072
s_add_u32 s37, s37, s38
buffer_load_dwordx4 v23, s[8:11], s37 offen sc1 lds
v_mul_f32 v198, -v82, v66
v_mul_f32 v199, -v82, v67
s_add_u32 m0, s39, 4096
s_add_u32 s37, s37, s38
buffer_load_dwordx4 v22, s[8:11], s37 offen sc1 lds
v_mul_f32 v200, -v84, v64
v_mul_f32 v201, -v84, v65
s_add_u32 m0, s39, 5120
s_add_u32 s37, s37, s38
buffer_load_dwordx4 v23, s[8:11], s37 offen sc1 lds
v_mul_f32 v202, -v84, v66
v_mul_f32 v203, -v84, v67
s_add_u32 m0, s39, 6144
s_add_u32 s37, s37, s38
buffer_load_dwordx4 v22, s[8:11], s37 offen sc1 lds
v_mul_f32 v204, -v86, v64
v_mul_f32 v205, -v86, v65
s_add_u32 m0, s39, 7168
s_add_u32 s37, s37, s38
buffer_load_dwordx4 v23, s[8:11], s37 offen sc1 lds
v_mul_f32 v206, -v86, v66
v_mul_f32 v207, -v86, v67
s_add_u32 m0, s39, 8192
s_add_u32 s37, s37, s38
buffer_load_dwordx4 v22, s[8:11], s37 offen sc1 lds
v_mul_f32 v208, -v80, v68
v_mul_f32 v209, -v80, v69
s_add_u32 m0, s39, 9216
s_add_u32 s37, s37, s38
buffer_load_dwordx4 v23, s[8:11], s37 offen sc1 lds
v_mul_f32 v210, -v80, v70
v_mul_f32 v211, -v80, v71
s_add_u32 m0, s39, 10240
s_add_u32 s37, s37, s38
buffer_load_dwordx4 v22, s[8:11], s37 offen sc1 lds
v_mul_f32 v212, -v82, v68
v_mul_f32 v213, -v82, v69
s_add_u32 m0, s39, 11264
s_add_u32 s37, s37, s38
buffer_load_dwordx4 v23, s[8:11], s37 offen sc1 lds
v_mul_f32 v214, -v82, v70
v_mul_f32 v215, -v82, v71
s_add_u32 m0, s39, 12288
s_add_u32 s37, s37, s38
buffer_load_dwordx4 v22, s[8:11], s37 offen sc1 lds
v_mul_f32 v216, -v84, v68
v_mul_f32 v217, -v84, v69
s_add_u32 m0, s39, 13312
s_add_u32 s37, s37, s38
buffer_load_dwordx4 v23, s[8:11], s37 offen sc1 lds
v_mul_f32 v218, -v84, v70
v_mul_f32 v219, -v84, v71
s_add_u32 m0, s39, 14336
s_add_u32 s37, s37, s38
buffer_load_dwordx4 v22, s[8:11], s37 offen sc1 lds
v_mul_f32 v220, -v86, v68
v_mul_f32 v221, -v86, v69
s_add_u32 m0, s39, 15360
s_add_u32 s37, s37, s38
buffer_load_dwordx4 v23, s[8:11], s37 offen sc1 lds
v_mul_f32 v222, -v86, v70
v_mul_f32 v223, -v86, v71
s_load_dword s64, s[80:81], 0
s_load_dword s65, s[80:81], 64
s_load_dword s66, s[80:81], 128
s_load_dword s67, s[80:81], 192
s_load_dword s68, s[80:81], 256
s_load_dword s69, s[80:81], 320
s_load_dword s70, s[80:81], 384
s_add_u32 s80, s80, 448
s_addc_u32 s81, s81, 0
s_waitcnt vmcnt(16)
s_barrier
s_add_u32 s42, s42, 1
s_and_b32 s42, s42, 15
s_add_u32 m0, s39, 49152
s_mul_i32 s37, s42, s40
buffer_load_dwordx4 v22, s[8:11], s37 offen sc1 lds
s_add_u32 m0, s39, 50176
s_add_u32 s37, s37, s38
buffer_load_dwordx4 v23, s[8:11], s37 offen sc1 lds
s_add_u32 m0, s39, 51200
s_add_u32 s37, s37, s38
buffer_load_dwordx4 v22, s[8:11], s37 offen sc1 lds
s_add_u32 m0, s39, 52224
s_add_u32 s37, s37, s38
buffer_load_dwordx4 v23, s[8:11], s37 offen sc1 lds
s_add_u32 m0, s39, 53248
s_add_u32 s37, s37, s38
buffer_load_dwordx4 v22, s[8:11], s37 offen sc1 lds
s_add_u32 m0, s39, 54272
s_add_u32 s37, s37, s38
buffer_load_dwordx4 v23, s[8:11], s37 offen sc1 lds
s_add_u32 m0, s39, 55296
s_add_u32 s37, s37, s38
buffer_load_dwordx4 v22, s[8:11], s37 offen sc1 lds
s_add_u32 m0, s39, 56320
s_add_u32 s37, s37, s38
buffer_load_dwordx4 v23, s[8:11], s37 offen sc1 lds
s_add_u32 m0, s39, 57344
s_add_u32 s37, s37, s38
buffer_load_dwordx4 v22, s[8:11], s37 offen sc1 lds
s_add_u32 m0, s39, 58368
s_add_u32 s37, s37, s38
buffer_load_dwordx4 v23, s[8:11], s37 offen sc1 lds
s_add_u32 m0, s39, 59392
s_add_u32 s37, s37, s38
buffer_load_dwordx4 v22, s[8:11], s37 offen sc1 lds
s_add_u32 m0, s39, 60416
s_add_u32 s37, s37, s38
buffer_load_dwordx4 v23, s[8:11], s37 offen sc1 lds
s_add_u32 m0, s39, 61440
s_add_u32 s37, s37, s38
buffer_load_dwordx4 v22, s[8:11], s37 offen sc1 lds
s_add_u32 m0, s39, 62464
s_add_u32 s37, s37, s38
buffer_load_dwordx4 v23, s[8:11], s37 offen sc1 lds
s_add_u32 m0, s39, 63488
s_add_u32 s37, s37, s38
buffer_load_dwordx4 v22, s[8:11], s37 offen sc1 lds
s_add_u32 m0, s39, 64512
s_add_u32 s37, s37, s38
buffer_load_dwordx4 v23, s[8:11], s37 offen sc1 lds
s_mul_i32 s44, s34, 917504
s_lshl_b32 s39, s51, 13
s_add_u32 s44, s44, s39
s_add_u32 s44, s44, 8388608
s_and_b32 s43, s51, 1
s_xor_b32 s43, s43, s35
s_lshl_b32 s43, s43, 7
s_mov_b32 s10, 909312
s_movk_i32 s38, 1024
s_movk_i32 s40, 9216
s_movk_i32 s37, 0x4000
s_cmp_ge_u32 s51, 2
s_cselect_b32 s8, s60, s32
s_cselect_b32 s9, s61, s33
s_cselect_b32 s10, 7338112, s10
s_cselect_b32 s43, s43, s44
s_cselect_b32 s38, 16384, s38
s_cselect_b32 s40, 81920, s40
s_cselect_b32 s55, 81920, s38
s_cselect_b32 s37, 262144, s37
s_cselect_b32 s45, -1, 0
s_add_u32 s8, s8, s43
s_addc_u32 s9, s9, 0
s_mov_b32 s11, 0x20000
s_and_b32 s53, s35, 1
s_mul_i32 s54, s53, 6
s_mul_i32 s54, s54, s37
s_mul_i32 s29, s53, 2
s_add_u32 s29, s29, 6
s_mul_i32 s29, s29, s37
s_and_b32 s43, s45, 4290838528
s_add_u32 s29, s29, s43
s_mul_i32 s37, s37, 2
s_sub_u32 s37, s37, s40
v_lshrrev_b32 v19, 3, v1
v_mul_u32_u24 v19, 1920, v19
v_lshrrev_b32 v20, 4, v1
v_lshlrev_b32 v20, 5, v20
v_and_b32 v19, s45, v19
v_and_b32 v20, s45, v20
v_lshlrev_b32 v21, 4, v1
v_xor_b32 v21, v21, v20
v_add_u32 v21, v21, v19
s_waitcnt vmcnt(16)
s_barrier
s_branch LK3b_82
.p2align 6
Lw_38:
s_branch Lr_39
s_nop 0
.p2align 3
L7_81:
s_lshr_b32 s43, s2, 5
s_cmp_eq_u32 s43, 3
s_cbranch_scc1 Lnojob_91
s_cmp_gt_u32 s43, 3
s_cselect_b32 s43, 32, 0
s_sub_u32 s43, s2, s43
s_lshr_b32 s43, s43, 1
s_and_b32 s44, s2, 1
s_cmp_eq_u32 s44, 0
s_cselect_b32 s68, s4, s6
s_cselect_b32 s69, s5, s7
s_mul_i32 s45, s43, 2341
s_lshr_b32 s45, s45, 16
s_mul_i32 s46, s45, 28
s_sub_u32 s46, s43, s46
v_lshrrev_b32 v4, 4, v1
s_lshl_b32 s43, s45, 8
v_add_u32 v4, s43, v4
v_mul_u32_u24 v4, 7168, v4
v_and_b32 v5, 15, v1
v_lshl_add_u32 v4, v5, 4, v4
s_lshl_b32 s43, s46, 8
v_add_u32 v4, s43, v4
s_mov_b32 s64, s68
s_mov_b32 s65, s69
s_mov_b32 s66, 7340032
s_mov_b32 s67, 0x20000
s_lshl_b32 s55, s45, 1
s_add_u32 s55, s55, s44
s_mul_i32 s55, s55, 14336
s_lshl_b32 s45, s46, 9
s_mov_b32 s50, s46
s_add_u32 s55, s55, s45
v_lshl_add_u32 v5, v5, 5, s55
s_add_u32 s72, s32, 27262976
s_addc_u32 s73, s33, 0
s_mov_b32 s74, 114688
s_mov_b32 s75, 0x20000
v_mov_b32 v32, 0
v_mov_b32 v33, 0
v_mov_b32 v34, 0
v_mov_b32 v35, 0
v_mov_b32 v36, 0
v_mov_b32 v37, 0
v_mov_b32 v38, 0
v_mov_b32 v39, 0
s_lshl_b32 s43, s34, 18
s_add_u32 s12, s32, s43
s_addc_u32 s13, s33, 0
s_mov_b32 s14, 262144
s_mov_b32 s15, 0x20000
v_lshlrev_b32 v21, 4, v1
s_lshl_b32 s54, s36, 11
s_add_u32 s43, s35, 1
s_and_b32 s43, s43, 15
s_lshl_b32 s43, s43, 14
s_add_u32 s30, s43, s54
s_add_u32 s43, s35, 2
s_and_b32 s43, s43, 15
s_lshl_b32 s43, s43, 14
s_add_u32 s31, s43, s54
s_waitcnt vmcnt(0)
s_barrier
ds_write_b128 v27, v[68:71] offset:0
ds_write_b128 v27, v[116:119] offset:512
s_mov_b32 s43, 917504
buffer_load_dwordx4 v[56:59], v4, s[64:67], s43 offen
s_mov_b32 s43, 946176
buffer_load_dwordx4 v[60:63], v4, s[64:67], s43 offen
s_mov_b32 s43, 974848
buffer_load_dwordx4 v[64:67], v4, s[64:67], s43 offen
s_mov_b32 s43, 1003520
buffer_load_dwordx4 v[72:75], v4, s[64:67], s43 offen
s_mov_b32 s43, 1032192
buffer_load_dwordx4 v[76:79], v4, s[64:67], s43 offen
s_mov_b32 s43, 1060864
buffer_load_dwordx4 v[80:83], v4, s[64:67], s43 offen
s_mov_b32 s43, 1089536
buffer_load_dwordx4 v[84:87], v4, s[64:67], s43 offen
s_mov_b32 s43, 1118208
buffer_load_dwordx4 v[88:91], v4, s[64:67], s43 offen
s_mov_b32 s43, 1146880
buffer_load_dwordx4 v[92:95], v4, s[64:67], s43 offen
s_mov_b32 s43, 1175552
buffer_load_dwordx4 v[96:99], v4, s[64:67], s43 offen
s_mov_b32 s43, 1204224
buffer_load_dwordx4 v[100:103], v4, s[64:67], s43 offen
s_mov_b32 s43, 1232896
buffer_load_dwordx4 v[104:107], v4, s[64:67], s43 offen
s_mov_b32 s43, 1261568
buffer_load_dwordx4 v[108:111], v4, s[64:67], s43 offen
s_mov_b32 s43, 1290240
buffer_load_dwordx4 v[112:115], v4, s[64:67], s43 offen
s_mov_b32 s43, 1318912
buffer_load_dwordx4 v[120:123], v4, s[64:67], s43 offen
s_mov_b32 s43, 1347584
buffer_load_dwordx4 v[124:127], v4, s[64:67], s43 offen
v_lshlrev_b32 v40, 16, v128
v_and_b32 v41, 0xffff0000, v128
v_lshlrev_b32 v42, 16, v129
v_and_b32 v43, 0xffff0000, v129
v_lshlrev_b32 v44, 16, v130
v_and_b32 v45, 0xffff0000, v130
v_lshlrev_b32 v46, 16, v131
v_and_b32 v47, 0xffff0000, v131
v_pk_add_f32 v[32:33], v[32:33], v[40:41]
v_pk_add_f32 v[34:35], v[34:35], v[42:43]
v_pk_add_f32 v[36:37], v[36:37], v[44:45]
v_pk_add_f32 v[38:39], v[38:39], v[46:47]
v_lshlrev_b32 v48, 16, v132
v_and_b32 v49, 0xffff0000, v132
v_lshlrev_b32 v50, 16, v133
v_and_b32 v51, 0xffff0000, v133
v_lshlrev_b32 v52, 16, v134
v_and_b32 v53, 0xffff0000, v134
v_lshlrev_b32 v54, 16, v135
v_and_b32 v55, 0xffff0000, v135
v_pk_add_f32 v[32:33], v[32:33], v[48:49]
v_pk_add_f32 v[34:35], v[34:35], v[50:51]
v_pk_add_f32 v[36:37], v[36:37], v[52:53]
v_pk_add_f32 v[38:39], v[38:39], v[54:55]
v_lshlrev_b32 v40, 16, v136
v_and_b32 v41, 0xffff0000, v136
v_lshlrev_b32 v42, 16, v137
v_and_b32 v43, 0xffff0000, v137
v_lshlrev_b32 v44, 16, v138
v_and_b32 v45, 0xffff0000, v138
v_lshlrev_b32 v46, 16, v139
v_and_b32 v47, 0xffff0000, v139
v_pk_add_f32 v[32:33], v[32:33], v[40:41]
v_pk_add_f32 v[34:35], v[34:35], v[42:43]
v_pk_add_f32 v[36:37], v[36:37], v[44:45]
v_pk_add_f32 v[38:39], v[38:39], v[46:47]
v_lshlrev_b32 v48, 16, v140
v_and_b32 v49, 0xffff0000, v140
v_lshlrev_b32 v50, 16, v141
v_and_b32 v51, 0xffff0000, v141
v_lshlrev_b32 v52, 16, v142
v_and_b32 v53, 0xffff0000, v142
v_lshlrev_b32 v54, 16, v143
v_and_b32 v55, 0xffff0000, v143
v_pk_add_f32 v[32:33], v[32:33], v[48:49]
v_pk_add_f32 v[34:35], v[34:35], v[50:51]
v_pk_add_f32 v[36:37], v[36:37], v[52:53]
v_pk_add_f32 v[38:39], v[38:39], v[54:55]
v_lshlrev_b32 v40, 16, v144
v_and_b32 v41, 0xffff0000, v144
v_lshlrev_b32 v42, 16, v145
v_and_b32 v43, 0xffff0000, v145
v_lshlrev_b32 v44, 16, v146
v_and_b32 v45, 0xffff0000, v146
v_lshlrev_b32 v46, 16, v147
v_and_b32 v47, 0xffff0000, v147
v_pk_add_f32 v[32:33], v[32:33], v[40:41]
v_pk_add_f32 v[34:35], v[34:35], v[42:43]
v_pk_add_f32 v[36:37], v[36:37], v[44:45]
v_pk_add_f32 v[38:39], v[38:39], v[46:47]
v_lshlrev_b32 v48, 16, v148
v_and_b32 v49, 0xffff0000, v148
v_lshlrev_b32 v50, 16, v149
v_and_b32 v51, 0xffff0000, v149
v_lshlrev_b32 v52, 16, v150
v_and_b32 v53, 0xffff0000, v150
v_lshlrev_b32 v54, 16, v151
v_and_b32 v55, 0xffff0000, v151
v_pk_add_f32 v[32:33], v[32:33], v[48:49]
v_pk_add_f32 v[34:35], v[34:35], v[50:51]
v_pk_add_f32 v[36:37], v[36:37], v[52:53]
v_pk_add_f32 v[38:39], v[38:39], v[54:55]
v_lshlrev_b32 v40, 16, v152
v_and_b32 v41, 0xffff0000, v152
v_lshlrev_b32 v42, 16, v153
v_and_b32 v43, 0xffff0000, v153
v_lshlrev_b32 v44, 16, v154
v_and_b32 v45, 0xffff0000, v154
v_lshlrev_b32 v46, 16, v155
v_and_b32 v47, 0xffff0000, v155
v_pk_add_f32 v[32:33], v[32:33], v[40:41]
v_pk_add_f32 v[34:35], v[34:35], v[42:43]
v_pk_add_f32 v[36:37], v[36:37], v[44:45]
v_pk_add_f32 v[38:39], v[38:39], v[46:47]
v_lshlrev_b32 v48, 16, v156
v_and_b32 v49, 0xffff0000, v156
v_lshlrev_b32 v50, 16, v157
v_and_b32 v51, 0xffff0000, v157
v_lshlrev_b32 v52, 16, v158
v_and_b32 v53, 0xffff0000, v158
v_lshlrev_b32 v54, 16, v159
v_and_b32 v55, 0xffff0000, v159
v_pk_add_f32 v[32:33], v[32:33], v[48:49]
v_pk_add_f32 v[34:35], v[34:35], v[50:51]
v_pk_add_f32 v[36:37], v[36:37], v[52:53]
v_pk_add_f32 v[38:39], v[38:39], v[54:55]
s_waitcnt lgkmcnt(0)
s_barrier
s_add_u32 m0, s54, 16384
s_add_u32 s43, s30, 0
buffer_load_dwordx4 v21, s[12:15], s43 offen sc1 lds
s_add_u32 m0, s54, 17408
s_add_u32 s43, s30, 1024
buffer_load_dwordx4 v21, s[12:15], s43 offen sc1 lds
s_add_u32 m0, s54, 32768
s_add_u32 s43, s31, 0
buffer_load_dwordx4 v21, s[12:15], s43 offen sc1 lds
s_add_u32 m0, s54, 33792
s_add_u32 s43, s31, 1024
buffer_load_dwordx4 v21, s[12:15], s43 offen sc1 lds
s_waitcnt vmcnt(2)
s_barrier
s_waitcnt vmcnt(0)
s_barrier
v_lshlrev_b32 v40, 16, v160
v_and_b32 v41, 0xffff0000, v160
v_lshlrev_b32 v42, 16, v161
v_and_b32 v43, 0xffff0000, v161
v_lshlrev_b32 v44, 16, v162
v_and_b32 v45, 0xffff0000, v162
v_lshlrev_b32 v46, 16, v163
v_and_b32 v47, 0xffff0000, v163
v_pk_add_f32 v[32:33], v[32:33], v[40:41]
v_pk_add_f32 v[34:35], v[34:35], v[42:43]
v_pk_add_f32 v[36:37], v[36:37], v[44:45]
v_pk_add_f32 v[38:39], v[38:39], v[46:47]
v_lshlrev_b32 v48, 16, v164
v_and_b32 v49, 0xffff0000, v164
v_lshlrev_b32 v50, 16, v165
v_and_b32 v51, 0xffff0000, v165
v_lshlrev_b32 v52, 16, v166
v_and_b32 v53, 0xffff0000, v166
v_lshlrev_b32 v54, 16, v167
v_and_b32 v55, 0xffff0000, v167
v_pk_add_f32 v[32:33], v[32:33], v[48:49]
v_pk_add_f32 v[34:35], v[34:35], v[50:51]
v_pk_add_f32 v[36:37], v[36:37], v[52:53]
v_pk_add_f32 v[38:39], v[38:39], v[54:55]
v_lshlrev_b32 v40, 16, v168
v_and_b32 v41, 0xffff0000, v168
v_lshlrev_b32 v42, 16, v169
v_and_b32 v43, 0xffff0000, v169
v_lshlrev_b32 v44, 16, v170
v_and_b32 v45, 0xffff0000, v170
v_lshlrev_b32 v46, 16, v171
v_and_b32 v47, 0xffff0000, v171
v_pk_add_f32 v[32:33], v[32:33], v[40:41]
v_pk_add_f32 v[34:35], v[34:35], v[42:43]
v_pk_add_f32 v[36:37], v[36:37], v[44:45]
v_pk_add_f32 v[38:39], v[38:39], v[46:47]
v_lshlrev_b32 v48, 16, v172
v_and_b32 v49, 0xffff0000, v172
v_lshlrev_b32 v50, 16, v173
v_and_b32 v51, 0xffff0000, v173
v_lshlrev_b32 v52, 16, v174
v_and_b32 v53, 0xffff0000, v174
v_lshlrev_b32 v54, 16, v175
v_and_b32 v55, 0xffff0000, v175
v_pk_add_f32 v[32:33], v[32:33], v[48:49]
v_pk_add_f32 v[34:35], v[34:35], v[50:51]
v_pk_add_f32 v[36:37], v[36:37], v[52:53]
v_pk_add_f32 v[38:39], v[38:39], v[54:55]
s_barrier
v_lshlrev_b32 v40, 16, v176
v_and_b32 v41, 0xffff0000, v176
v_lshlrev_b32 v42, 16, v177
v_and_b32 v43, 0xffff0000, v177
v_lshlrev_b32 v44, 16, v178
v_and_b32 v45, 0xffff0000, v178
v_lshlrev_b32 v46, 16, v179
v_and_b32 v47, 0xffff0000, v179
v_pk_add_f32 v[32:33], v[32:33], v[40:41]
v_pk_add_f32 v[34:35], v[34:35], v[42:43]
v_pk_add_f32 v[36:37], v[36:37], v[44:45]
v_pk_add_f32 v[38:39], v[38:39], v[46:47]
v_lshlrev_b32 v48, 16, v180
v_and_b32 v49, 0xffff0000, v180
v_lshlrev_b32 v50, 16, v181
v_and_b32 v51, 0xffff0000, v181
v_lshlrev_b32 v52, 16, v182
v_and_b32 v53, 0xffff0000, v182
v_lshlrev_b32 v54, 16, v183
v_and_b32 v55, 0xffff0000, v183
v_pk_add_f32 v[32:33], v[32:33], v[48:49]
v_pk_add_f32 v[34:35], v[34:35], v[50:51]
v_pk_add_f32 v[36:37], v[36:37], v[52:53]
v_pk_add_f32 v[38:39], v[38:39], v[54:55]
v_lshlrev_b32 v40, 16, v184
v_and_b32 v41, 0xffff0000, v184
v_lshlrev_b32 v42, 16, v185
v_and_b32 v43, 0xffff0000, v185
v_lshlrev_b32 v44, 16, v186
v_and_b32 v45, 0xffff0000, v186
v_lshlrev_b32 v46, 16, v187
v_and_b32 v47, 0xffff0000, v187
v_pk_add_f32 v[32:33], v[32:33], v[40:41]
v_pk_add_f32 v[34:35], v[34:35], v[42:43]
v_pk_add_f32 v[36:37], v[36:37], v[44:45]
v_pk_add_f32 v[38:39], v[38:39], v[46:47]
v_lshlrev_b32 v48, 16, v188
v_and_b32 v49, 0xffff0000, v188
v_lshlrev_b32 v50, 16, v189
v_and_b32 v51, 0xffff0000, v189
v_lshlrev_b32 v52, 16, v190
v_and_b32 v53, 0xffff0000, v190
v_lshlrev_b32 v54, 16, v191
v_and_b32 v55, 0xffff0000, v191
v_pk_add_f32 v[32:33], v[32:33], v[48:49]
v_pk_add_f32 v[34:35], v[34:35], v[50:51]
v_pk_add_f32 v[36:37], v[36:37], v[52:53]
v_pk_add_f32 v[38:39], v[38:39], v[54:55]
s_barrier
v_lshlrev_b32 v40, 16, v192
v_and_b32 v41, 0xffff0000, v192
v_lshlrev_b32 v42, 16, v193
v_and_b32 v43, 0xffff0000, v193
v_lshlrev_b32 v44, 16, v194
v_and_b32 v45, 0xffff0000, v194
v_lshlrev_b32 v46, 16, v195
v_and_b32 v47, 0xffff0000, v195
v_pk_add_f32 v[32:33], v[32:33], v[40:41]
v_pk_add_f32 v[34:35], v[34:35], v[42:43]
v_pk_add_f32 v[36:37], v[36:37], v[44:45]
v_pk_add_f32 v[38:39], v[38:39], v[46:47]
v_lshlrev_b32 v48, 16, v196
v_and_b32 v49, 0xffff0000, v196
v_lshlrev_b32 v50, 16, v197
v_and_b32 v51, 0xffff0000, v197
v_lshlrev_b32 v52, 16, v198
v_and_b32 v53, 0xffff0000, v198
v_lshlrev_b32 v54, 16, v199
v_and_b32 v55, 0xffff0000, v199
v_pk_add_f32 v[32:33], v[32:33], v[48:49]
v_pk_add_f32 v[34:35], v[34:35], v[50:51]
v_pk_add_f32 v[36:37], v[36:37], v[52:53]
v_pk_add_f32 v[38:39], v[38:39], v[54:55]
v_lshlrev_b32 v40, 16, v200
v_and_b32 v41, 0xffff0000, v200
v_lshlrev_b32 v42, 16, v201
v_and_b32 v43, 0xffff0000, v201
v_lshlrev_b32 v44, 16, v202
v_and_b32 v45, 0xffff0000, v202
v_lshlrev_b32 v46, 16, v203
v_and_b32 v47, 0xffff0000, v203
v_pk_add_f32 v[32:33], v[32:33], v[40:41]
v_pk_add_f32 v[34:35], v[34:35], v[42:43]
v_pk_add_f32 v[36:37], v[36:37], v[44:45]
v_pk_add_f32 v[38:39], v[38:39], v[46:47]
v_lshlrev_b32 v48, 16, v204
v_and_b32 v49, 0xffff0000, v204
v_lshlrev_b32 v50, 16, v205
v_and_b32 v51, 0xffff0000, v205
v_lshlrev_b32 v52, 16, v206
v_and_b32 v53, 0xffff0000, v206
v_lshlrev_b32 v54, 16, v207
v_and_b32 v55, 0xffff0000, v207
v_pk_add_f32 v[32:33], v[32:33], v[48:49]
v_pk_add_f32 v[34:35], v[34:35], v[50:51]
v_pk_add_f32 v[36:37], v[36:37], v[52:53]
v_pk_add_f32 v[38:39], v[38:39], v[54:55]
s_barrier
v_lshlrev_b32 v40, 16, v208
v_and_b32 v41, 0xffff0000, v208
v_lshlrev_b32 v42, 16, v209
v_and_b32 v43, 0xffff0000, v209
v_lshlrev_b32 v44, 16, v210
v_and_b32 v45, 0xffff0000, v210
v_lshlrev_b32 v46, 16, v211
v_and_b32 v47, 0xffff0000, v211
v_pk_add_f32 v[32:33], v[32:33], v[40:41]
v_pk_add_f32 v[34:35], v[34:35], v[42:43]
v_pk_add_f32 v[36:37], v[36:37], v[44:45]
v_pk_add_f32 v[38:39], v[38:39], v[46:47]
v_lshlrev_b32 v48, 16, v212
v_and_b32 v49, 0xffff0000, v212
v_lshlrev_b32 v50, 16, v213
v_and_b32 v51, 0xffff0000, v213
v_lshlrev_b32 v52, 16, v214
v_and_b32 v53, 0xffff0000, v214
v_lshlrev_b32 v54, 16, v215
v_and_b32 v55, 0xffff0000, v215
v_pk_add_f32 v[32:33], v[32:33], v[48:49]
v_pk_add_f32 v[34:35], v[34:35], v[50:51]
v_pk_add_f32 v[36:37], v[36:37], v[52:53]
v_pk_add_f32 v[38:39], v[38:39], v[54:55]
v_lshlrev_b32 v40, 16, v216
v_and_b32 v41, 0xffff0000, v216
v_lshlrev_b32 v42, 16, v217
v_and_b32 v43, 0xffff0000, v217
v_lshlrev_b32 v44, 16, v218
v_and_b32 v45, 0xffff0000, v218
v_lshlrev_b32 v46, 16, v219
v_and_b32 v47, 0xffff0000, v219
v_pk_add_f32 v[32:33], v[32:33], v[40:41]
v_pk_add_f32 v[34:35], v[34:35], v[42:43]
v_pk_add_f32 v[36:37], v[36:37], v[44:45]
v_pk_add_f32 v[38:39], v[38:39], v[46:47]
v_lshlrev_b32 v48, 16, v220
v_and_b32 v49, 0xffff0000, v220
v_lshlrev_b32 v50, 16, v221
v_and_b32 v51, 0xffff0000, v221
v_lshlrev_b32 v52, 16, v222
v_and_b32 v53, 0xffff0000, v222
v_lshlrev_b32 v54, 16, v223
v_and_b32 v55, 0xffff0000, v223
v_pk_add_f32 v[32:33], v[32:33], v[48:49]
v_pk_add_f32 v[34:35], v[34:35], v[50:51]
v_pk_add_f32 v[36:37], v[36:37], v[52:53]
v_pk_add_f32 v[38:39], v[38:39], v[54:55]
s_barrier
v_lshlrev_b32 v40, 16, v224
v_and_b32 v41, 0xffff0000, v224
v_lshlrev_b32 v42, 16, v225
v_and_b32 v43, 0xffff0000, v225
v_lshlrev_b32 v44, 16, v226
v_and_b32 v45, 0xffff0000, v226
v_lshlrev_b32 v46, 16, v227
v_and_b32 v47, 0xffff0000, v227
v_pk_add_f32 v[32:33], v[32:33], v[40:41]
v_pk_add_f32 v[34:35], v[34:35], v[42:43]
v_pk_add_f32 v[36:37], v[36:37], v[44:45]
v_pk_add_f32 v[38:39], v[38:39], v[46:47]
v_lshlrev_b32 v48, 16, v228
v_and_b32 v49, 0xffff0000, v228
v_lshlrev_b32 v50, 16, v229
v_and_b32 v51, 0xffff0000, v229
v_lshlrev_b32 v52, 16, v230
v_and_b32 v53, 0xffff0000, v230
v_lshlrev_b32 v54, 16, v231
v_and_b32 v55, 0xffff0000, v231
v_pk_add_f32 v[32:33], v[32:33], v[48:49]
v_pk_add_f32 v[34:35], v[34:35], v[50:51]
v_pk_add_f32 v[36:37], v[36:37], v[52:53]
v_pk_add_f32 v[38:39], v[38:39], v[54:55]
v_lshlrev_b32 v40, 16, v232
v_and_b32 v41, 0xffff0000, v232
v_lshlrev_b32 v42, 16, v233
v_and_b32 v43, 0xffff0000, v233
v_lshlrev_b32 v44, 16, v234
v_and_b32 v45, 0xffff0000, v234
v_lshlrev_b32 v46, 16, v235
v_and_b32 v47, 0xffff0000, v235
v_pk_add_f32 v[32:33], v[32:33], v[40:41]
v_pk_add_f32 v[34:35], v[34:35], v[42:43]
v_pk_add_f32 v[36:37], v[36:37], v[44:45]
v_pk_add_f32 v[38:39], v[38:39], v[46:47]
v_lshlrev_b32 v48, 16, v236
v_and_b32 v49, 0xffff0000, v236
v_lshlrev_b32 v50, 16, v237
v_and_b32 v51, 0xffff0000, v237
v_lshlrev_b32 v52, 16, v238
v_and_b32 v53, 0xffff0000, v238
v_lshlrev_b32 v54, 16, v239
v_and_b32 v55, 0xffff0000, v239
v_pk_add_f32 v[32:33], v[32:33], v[48:49]
v_pk_add_f32 v[34:35], v[34:35], v[50:51]
v_pk_add_f32 v[36:37], v[36:37], v[52:53]
v_pk_add_f32 v[38:39], v[38:39], v[54:55]
s_barrier
v_lshlrev_b32 v40, 16, v240
v_and_b32 v41, 0xffff0000, v240
v_lshlrev_b32 v42, 16, v241
v_and_b32 v43, 0xffff0000, v241
v_lshlrev_b32 v44, 16, v242
v_and_b32 v45, 0xffff0000, v242
v_lshlrev_b32 v46, 16, v243
v_and_b32 v47, 0xffff0000, v243
v_pk_add_f32 v[32:33], v[32:33], v[40:41]
v_pk_add_f32 v[34:35], v[34:35], v[42:43]
v_pk_add_f32 v[36:37], v[36:37], v[44:45]
v_pk_add_f32 v[38:39], v[38:39], v[46:47]
v_lshlrev_b32 v48, 16, v244
v_and_b32 v49, 0xffff0000, v244
v_lshlrev_b32 v50, 16, v245
v_and_b32 v51, 0xffff0000, v245
v_lshlrev_b32 v52, 16, v246
v_and_b32 v53, 0xffff0000, v246
v_lshlrev_b32 v54, 16, v247
v_and_b32 v55, 0xffff0000, v247
v_pk_add_f32 v[32:33], v[32:33], v[48:49]
v_pk_add_f32 v[34:35], v[34:35], v[50:51]
v_pk_add_f32 v[36:37], v[36:37], v[52:53]
v_pk_add_f32 v[38:39], v[38:39], v[54:55]
v_lshlrev_b32 v40, 16, v248
v_and_b32 v41, 0xffff0000, v248
v_lshlrev_b32 v42, 16, v249
v_and_b32 v43, 0xffff0000, v249
v_lshlrev_b32 v44, 16, v250
v_and_b32 v45, 0xffff0000, v250
v_lshlrev_b32 v46, 16, v251
v_and_b32 v47, 0xffff0000, v251
v_pk_add_f32 v[32:33], v[32:33], v[40:41]
v_pk_add_f32 v[34:35], v[34:35], v[42:43]
v_pk_add_f32 v[36:37], v[36:37], v[44:45]
v_pk_add_f32 v[38:39], v[38:39], v[46:47]
v_lshlrev_b32 v48, 16, v252
v_and_b32 v49, 0xffff0000, v252
v_lshlrev_b32 v50, 16, v253
v_and_b32 v51, 0xffff0000, v253
v_lshlrev_b32 v52, 16, v254
v_and_b32 v53, 0xffff0000, v254
v_lshlrev_b32 v54, 16, v255
v_and_b32 v55, 0xffff0000, v255
v_pk_add_f32 v[32:33], v[32:33], v[48:49]
v_pk_add_f32 v[34:35], v[34:35], v[50:51]
v_pk_add_f32 v[36:37], v[36:37], v[52:53]
v_pk_add_f32 v[38:39], v[38:39], v[54:55]
s_barrier
s_mov_b32 s43, 1376256
buffer_load_dwordx4 v[128:131], v4, s[64:67], s43 offen
s_mov_b32 s43, 1404928
buffer_load_dwordx4 v[132:135], v4, s[64:67], s43 offen
s_mov_b32 s43, 1433600
buffer_load_dwordx4 v[136:139], v4, s[64:67], s43 offen
s_mov_b32 s43, 1462272
buffer_load_dwordx4 v[140:143], v4, s[64:67], s43 offen
s_mov_b32 s43, 1490944
buffer_load_dwordx4 v[144:147], v4, s[64:67], s43 offen
s_mov_b32 s43, 1519616
buffer_load_dwordx4 v[148:151], v4, s[64:67], s43 offen
s_mov_b32 s43, 1548288
buffer_load_dwordx4 v[152:155], v4, s[64:67], s43 offen
s_mov_b32 s43, 1576960
buffer_load_dwordx4 v[156:159], v4, s[64:67], s43 offen
s_mov_b32 s43, 1605632
buffer_load_dwordx4 v[160:163], v4, s[64:67], s43 offen
s_mov_b32 s43, 1634304
buffer_load_dwordx4 v[164:167], v4, s[64:67], s43 offen
s_mov_b32 s43, 1662976
buffer_load_dwordx4 v[168:171], v4, s[64:67], s43 offen
s_mov_b32 s43, 1691648
buffer_load_dwordx4 v[172:175], v4, s[64:67], s43 offen
s_mov_b32 s43, 1720320
buffer_load_dwordx4 v[176:179], v4, s[64:67], s43 offen
s_mov_b32 s43, 1748992
buffer_load_dwordx4 v[180:183], v4, s[64:67], s43 offen
s_mov_b32 s43, 1777664
buffer_load_dwordx4 v[184:187], v4, s[64:67], s43 offen
s_mov_b32 s43, 1806336
buffer_load_dwordx4 v[188:191], v4, s[64:67], s43 offen
s_barrier
v_lshlrev_b32 v40, 16, v56
v_and_b32 v41, 0xffff0000, v56
v_lshlrev_b32 v42, 16, v57
v_and_b32 v43, 0xffff0000, v57
v_lshlrev_b32 v44, 16, v58
v_and_b32 v45, 0xffff0000, v58
v_lshlrev_b32 v46, 16, v59
v_and_b32 v47, 0xffff0000, v59
v_pk_add_f32 v[32:33], v[32:33], v[40:41]
v_pk_add_f32 v[34:35], v[34:35], v[42:43]
v_pk_add_f32 v[36:37], v[36:37], v[44:45]
v_pk_add_f32 v[38:39], v[38:39], v[46:47]
v_lshlrev_b32 v48, 16, v60
v_and_b32 v49, 0xffff0000, v60
v_lshlrev_b32 v50, 16, v61
v_and_b32 v51, 0xffff0000, v61
v_lshlrev_b32 v52, 16, v62
v_and_b32 v53, 0xffff0000, v62
v_lshlrev_b32 v54, 16, v63
v_and_b32 v55, 0xffff0000, v63
v_pk_add_f32 v[32:33], v[32:33], v[48:49]
v_pk_add_f32 v[34:35], v[34:35], v[50:51]
v_pk_add_f32 v[36:37], v[36:37], v[52:53]
v_pk_add_f32 v[38:39], v[38:39], v[54:55]
v_lshlrev_b32 v40, 16, v64
v_and_b32 v41, 0xffff0000, v64
v_lshlrev_b32 v42, 16, v65
v_and_b32 v43, 0xffff0000, v65
v_lshlrev_b32 v44, 16, v66
v_and_b32 v45, 0xffff0000, v66
v_lshlrev_b32 v46, 16, v67
v_and_b32 v47, 0xffff0000, v67
v_pk_add_f32 v[32:33], v[32:33], v[40:41]
v_pk_add_f32 v[34:35], v[34:35], v[42:43]
v_pk_add_f32 v[36:37], v[36:37], v[44:45]
v_pk_add_f32 v[38:39], v[38:39], v[46:47]
v_lshlrev_b32 v48, 16, v72
v_and_b32 v49, 0xffff0000, v72
v_lshlrev_b32 v50, 16, v73
v_and_b32 v51, 0xffff0000, v73
v_lshlrev_b32 v52, 16, v74
v_and_b32 v53, 0xffff0000, v74
v_lshlrev_b32 v54, 16, v75
v_and_b32 v55, 0xffff0000, v75
v_pk_add_f32 v[32:33], v[32:33], v[48:49]
v_pk_add_f32 v[34:35], v[34:35], v[50:51]
v_pk_add_f32 v[36:37], v[36:37], v[52:53]
v_pk_add_f32 v[38:39], v[38:39], v[54:55]
s_barrier
v_lshlrev_b32 v40, 16, v76
v_and_b32 v41, 0xffff0000, v76
v_lshlrev_b32 v42, 16, v77
v_and_b32 v43, 0xffff0000, v77
v_lshlrev_b32 v44, 16, v78
v_and_b32 v45, 0xffff0000, v78
v_lshlrev_b32 v46, 16, v79
v_and_b32 v47, 0xffff0000, v79
v_pk_add_f32 v[32:33], v[32:33], v[40:41]
v_pk_add_f32 v[34:35], v[34:35], v[42:43]
v_pk_add_f32 v[36:37], v[36:37], v[44:45]
v_pk_add_f32 v[38:39], v[38:39], v[46:47]
v_lshlrev_b32 v48, 16, v80
v_and_b32 v49, 0xffff0000, v80
v_lshlrev_b32 v50, 16, v81
v_and_b32 v51, 0xffff0000, v81
v_lshlrev_b32 v52, 16, v82
v_and_b32 v53, 0xffff0000, v82
v_lshlrev_b32 v54, 16, v83
v_and_b32 v55, 0xffff0000, v83
v_pk_add_f32 v[32:33], v[32:33], v[48:49]
v_pk_add_f32 v[34:35], v[34:35], v[50:51]
v_pk_add_f32 v[36:37], v[36:37], v[52:53]
v_pk_add_f32 v[38:39], v[38:39], v[54:55]
v_lshlrev_b32 v40, 16, v84
v_and_b32 v41, 0xffff0000, v84
v_lshlrev_b32 v42, 16, v85
v_and_b32 v43, 0xffff0000, v85
v_lshlrev_b32 v44, 16, v86
v_and_b32 v45, 0xffff0000, v86
v_lshlrev_b32 v46, 16, v87
v_and_b32 v47, 0xffff0000, v87
v_pk_add_f32 v[32:33], v[32:33], v[40:41]
v_pk_add_f32 v[34:35], v[34:35], v[42:43]
v_pk_add_f32 v[36:37], v[36:37], v[44:45]
v_pk_add_f32 v[38:39], v[38:39], v[46:47]
v_lshlrev_b32 v48, 16, v88
v_and_b32 v49, 0xffff0000, v88
v_lshlrev_b32 v50, 16, v89
v_and_b32 v51, 0xffff0000, v89
v_lshlrev_b32 v52, 16, v90
v_and_b32 v53, 0xffff0000, v90
v_lshlrev_b32 v54, 16, v91
v_and_b32 v55, 0xffff0000, v91
v_pk_add_f32 v[32:33], v[32:33], v[48:49]
v_pk_add_f32 v[34:35], v[34:35], v[50:51]
v_pk_add_f32 v[36:37], v[36:37], v[52:53]
v_pk_add_f32 v[38:39], v[38:39], v[54:55]
s_barrier
v_lshlrev_b32 v40, 16, v92
v_and_b32 v41, 0xffff0000, v92
v_lshlrev_b32 v42, 16, v93
v_and_b32 v43, 0xffff0000, v93
v_lshlrev_b32 v44, 16, v94
v_and_b32 v45, 0xffff0000, v94
v_lshlrev_b32 v46, 16, v95
v_and_b32 v47, 0xffff0000, v95
v_pk_add_f32 v[32:33], v[32:33], v[40:41]
v_pk_add_f32 v[34:35], v[34:35], v[42:43]
v_pk_add_f32 v[36:37], v[36:37], v[44:45]
v_pk_add_f32 v[38:39], v[38:39], v[46:47]
v_lshlrev_b32 v48, 16, v96
v_and_b32 v49, 0xffff0000, v96
v_lshlrev_b32 v50, 16, v97
v_and_b32 v51, 0xffff0000, v97
v_lshlrev_b32 v52, 16, v98
v_and_b32 v53, 0xffff0000, v98
v_lshlrev_b32 v54, 16, v99
v_and_b32 v55, 0xffff0000, v99
v_pk_add_f32 v[32:33], v[32:33], v[48:49]
v_pk_add_f32 v[34:35], v[34:35], v[50:51]
v_pk_add_f32 v[36:37], v[36:37], v[52:53]
v_pk_add_f32 v[38:39], v[38:39], v[54:55]
v_lshlrev_b32 v40, 16, v100
v_and_b32 v41, 0xffff0000, v100
v_lshlrev_b32 v42, 16, v101
v_and_b32 v43, 0xffff0000, v101
v_lshlrev_b32 v44, 16, v102
v_and_b32 v45, 0xffff0000, v102
v_lshlrev_b32 v46, 16, v103
v_and_b32 v47, 0xffff0000, v103
v_pk_add_f32 v[32:33], v[32:33], v[40:41]
v_pk_add_f32 v[34:35], v[34:35], v[42:43]
v_pk_add_f32 v[36:37], v[36:37], v[44:45]
v_pk_add_f32 v[38:39], v[38:39], v[46:47]
v_lshlrev_b32 v48, 16, v104
v_and_b32 v49, 0xffff0000, v104
v_lshlrev_b32 v50, 16, v105
v_and_b32 v51, 0xffff0000, v105
v_lshlrev_b32 v52, 16, v106
v_and_b32 v53, 0xffff0000, v106
v_lshlrev_b32 v54, 16, v107
v_and_b32 v55, 0xffff0000, v107
v_pk_add_f32 v[32:33], v[32:33], v[48:49]
v_pk_add_f32 v[34:35], v[34:35], v[50:51]
v_pk_add_f32 v[36:37], v[36:37], v[52:53]
v_pk_add_f32 v[38:39], v[38:39], v[54:55]
s_barrier
v_lshlrev_b32 v40, 16, v108
v_and_b32 v41, 0xffff0000, v108
v_lshlrev_b32 v42, 16, v109
v_and_b32 v43, 0xffff0000, v109
v_lshlrev_b32 v44, 16, v110
v_and_b32 v45, 0xffff0000, v110
v_lshlrev_b32 v46, 16, v111
v_and_b32 v47, 0xffff0000, v111
v_pk_add_f32 v[32:33], v[32:33], v[40:41]
v_pk_add_f32 v[34:35], v[34:35], v[42:43]
v_pk_add_f32 v[36:37], v[36:37], v[44:45]
v_pk_add_f32 v[38:39], v[38:39], v[46:47]
v_lshlrev_b32 v48, 16, v112
v_and_b32 v49, 0xffff0000, v112
v_lshlrev_b32 v50, 16, v113
v_and_b32 v51, 0xffff0000, v113
v_lshlrev_b32 v52, 16, v114
v_and_b32 v53, 0xffff0000, v114
v_lshlrev_b32 v54, 16, v115
v_and_b32 v55, 0xffff0000, v115
v_pk_add_f32 v[32:33], v[32:33], v[48:49]
v_pk_add_f32 v[34:35], v[34:35], v[50:51]
v_pk_add_f32 v[36:37], v[36:37], v[52:53]
v_pk_add_f32 v[38:39], v[38:39], v[54:55]
v_lshlrev_b32 v40, 16, v120
v_and_b32 v41, 0xffff0000, v120
v_lshlrev_b32 v42, 16, v121
v_and_b32 v43, 0xffff0000, v121
v_lshlrev_b32 v44, 16, v122
v_and_b32 v45, 0xffff0000, v122
v_lshlrev_b32 v46, 16, v123
v_and_b32 v47, 0xffff0000, v123
v_pk_add_f32 v[32:33], v[32:33], v[40:41]
v_pk_add_f32 v[34:35], v[34:35], v[42:43]
v_pk_add_f32 v[36:37], v[36:37], v[44:45]
v_pk_add_f32 v[38:39], v[38:39], v[46:47]
v_lshlrev_b32 v48, 16, v124
v_and_b32 v49, 0xffff0000, v124
v_lshlrev_b32 v50, 16, v125
v_and_b32 v51, 0xffff0000, v125
v_lshlrev_b32 v52, 16, v126
v_and_b32 v53, 0xffff0000, v126
v_lshlrev_b32 v54, 16, v127
v_and_b32 v55, 0xffff0000, v127
v_pk_add_f32 v[32:33], v[32:33], v[48:49]
v_pk_add_f32 v[34:35], v[34:35], v[50:51]
v_pk_add_f32 v[36:37], v[36:37], v[52:53]
v_pk_add_f32 v[38:39], v[38:39], v[54:55]
s_barrier
s_waitcnt vmcnt(0)
v_lshlrev_b32 v40, 16, v128
v_and_b32 v41, 0xffff0000, v128
v_lshlrev_b32 v42, 16, v129
v_and_b32 v43, 0xffff0000, v129
v_lshlrev_b32 v44, 16, v130
v_and_b32 v45, 0xffff0000, v130
v_lshlrev_b32 v46, 16, v131
v_and_b32 v47, 0xffff0000, v131
v_pk_add_f32 v[32:33], v[32:33], v[40:41]
v_pk_add_f32 v[34:35], v[34:35], v[42:43]
v_pk_add_f32 v[36:37], v[36:37], v[44:45]
v_pk_add_f32 v[38:39], v[38:39], v[46:47]
v_lshlrev_b32 v48, 16, v132
v_and_b32 v49, 0xffff0000, v132
v_lshlrev_b32 v50, 16, v133
v_and_b32 v51, 0xffff0000, v133
v_lshlrev_b32 v52, 16, v134
v_and_b32 v53, 0xffff0000, v134
v_lshlrev_b32 v54, 16, v135
v_and_b32 v55, 0xffff0000, v135
v_pk_add_f32 v[32:33], v[32:33], v[48:49]
v_pk_add_f32 v[34:35], v[34:35], v[50:51]
v_pk_add_f32 v[36:37], v[36:37], v[52:53]
v_pk_add_f32 v[38:39], v[38:39], v[54:55]
v_lshlrev_b32 v40, 16, v136
v_and_b32 v41, 0xffff0000, v136
v_lshlrev_b32 v42, 16, v137
v_and_b32 v43, 0xffff0000, v137
v_lshlrev_b32 v44, 16, v138
v_and_b32 v45, 0xffff0000, v138
v_lshlrev_b32 v46, 16, v139
v_and_b32 v47, 0xffff0000, v139
v_pk_add_f32 v[32:33], v[32:33], v[40:41]
v_pk_add_f32 v[34:35], v[34:35], v[42:43]
v_pk_add_f32 v[36:37], v[36:37], v[44:45]
v_pk_add_f32 v[38:39], v[38:39], v[46:47]
v_lshlrev_b32 v48, 16, v140
v_and_b32 v49, 0xffff0000, v140
v_lshlrev_b32 v50, 16, v141
v_and_b32 v51, 0xffff0000, v141
v_lshlrev_b32 v52, 16, v142
v_and_b32 v53, 0xffff0000, v142
v_lshlrev_b32 v54, 16, v143
v_and_b32 v55, 0xffff0000, v143
v_pk_add_f32 v[32:33], v[32:33], v[48:49]
v_pk_add_f32 v[34:35], v[34:35], v[50:51]
v_pk_add_f32 v[36:37], v[36:37], v[52:53]
v_pk_add_f32 v[38:39], v[38:39], v[54:55]
s_barrier
v_lshlrev_b32 v40, 16, v144
v_and_b32 v41, 0xffff0000, v144
v_lshlrev_b32 v42, 16, v145
v_and_b32 v43, 0xffff0000, v145
v_lshlrev_b32 v44, 16, v146
v_and_b32 v45, 0xffff0000, v146
v_lshlrev_b32 v46, 16, v147
v_and_b32 v47, 0xffff0000, v147
v_pk_add_f32 v[32:33], v[32:33], v[40:41]
v_pk_add_f32 v[34:35], v[34:35], v[42:43]
v_pk_add_f32 v[36:37], v[36:37], v[44:45]
v_pk_add_f32 v[38:39], v[38:39], v[46:47]
v_lshlrev_b32 v48, 16, v148
v_and_b32 v49, 0xffff0000, v148
v_lshlrev_b32 v50, 16, v149
v_and_b32 v51, 0xffff0000, v149
v_lshlrev_b32 v52, 16, v150
v_and_b32 v53, 0xffff0000, v150
v_lshlrev_b32 v54, 16, v151
v_and_b32 v55, 0xffff0000, v151
v_pk_add_f32 v[32:33], v[32:33], v[48:49]
v_pk_add_f32 v[34:35], v[34:35], v[50:51]
v_pk_add_f32 v[36:37], v[36:37], v[52:53]
v_pk_add_f32 v[38:39], v[38:39], v[54:55]
v_lshlrev_b32 v40, 16, v152
v_and_b32 v41, 0xffff0000, v152
v_lshlrev_b32 v42, 16, v153
v_and_b32 v43, 0xffff0000, v153
v_lshlrev_b32 v44, 16, v154
v_and_b32 v45, 0xffff0000, v154
v_lshlrev_b32 v46, 16, v155
v_and_b32 v47, 0xffff0000, v155
v_pk_add_f32 v[32:33], v[32:33], v[40:41]
v_pk_add_f32 v[34:35], v[34:35], v[42:43]
v_pk_add_f32 v[36:37], v[36:37], v[44:45]
v_pk_add_f32 v[38:39], v[38:39], v[46:47]
v_lshlrev_b32 v48, 16, v156
v_and_b32 v49, 0xffff0000, v156
v_lshlrev_b32 v50, 16, v157
v_and_b32 v51, 0xffff0000, v157
v_lshlrev_b32 v52, 16, v158
v_and_b32 v53, 0xffff0000, v158
v_lshlrev_b32 v54, 16, v159
v_and_b32 v55, 0xffff0000, v159
v_pk_add_f32 v[32:33], v[32:33], v[48:49]
v_pk_add_f32 v[34:35], v[34:35], v[50:51]
v_pk_add_f32 v[36:37], v[36:37], v[52:53]
v_pk_add_f32 v[38:39], v[38:39], v[54:55]
s_barrier
v_lshlrev_b32 v40, 16, v160
v_and_b32 v41, 0xffff0000, v160
v_lshlrev_b32 v42, 16, v161
v_and_b32 v43, 0xffff0000, v161
v_lshlrev_b32 v44, 16, v162
v_and_b32 v45, 0xffff0000, v162
v_lshlrev_b32 v46, 16, v163
v_and_b32 v47, 0xffff0000, v163
v_pk_add_f32 v[32:33], v[32:33], v[40:41]
v_pk_add_f32 v[34:35], v[34:35], v[42:43]
v_pk_add_f32 v[36:37], v[36:37], v[44:45]
v_pk_add_f32 v[38:39], v[38:39], v[46:47]
v_lshlrev_b32 v48, 16, v164
v_and_b32 v49, 0xffff0000, v164
v_lshlrev_b32 v50, 16, v165
v_and_b32 v51, 0xffff0000, v165
v_lshlrev_b32 v52, 16, v166
v_and_b32 v53, 0xffff0000, v166
v_lshlrev_b32 v54, 16, v167
v_and_b32 v55, 0xffff0000, v167
v_pk_add_f32 v[32:33], v[32:33], v[48:49]
v_pk_add_f32 v[34:35], v[34:35], v[50:51]
v_pk_add_f32 v[36:37], v[36:37], v[52:53]
v_pk_add_f32 v[38:39], v[38:39], v[54:55]
v_lshlrev_b32 v40, 16, v168
v_and_b32 v41, 0xffff0000, v168
v_lshlrev_b32 v42, 16, v169
v_and_b32 v43, 0xffff0000, v169
v_lshlrev_b32 v44, 16, v170
v_and_b32 v45, 0xffff0000, v170
v_lshlrev_b32 v46, 16, v171
v_and_b32 v47, 0xffff0000, v171
v_pk_add_f32 v[32:33], v[32:33], v[40:41]
v_pk_add_f32 v[34:35], v[34:35], v[42:43]
v_pk_add_f32 v[36:37], v[36:37], v[44:45]
v_pk_add_f32 v[38:39], v[38:39], v[46:47]
v_lshlrev_b32 v48, 16, v172
v_and_b32 v49, 0xffff0000, v172
v_lshlrev_b32 v50, 16, v173
v_and_b32 v51, 0xffff0000, v173
v_lshlrev_b32 v52, 16, v174
v_and_b32 v53, 0xffff0000, v174
v_lshlrev_b32 v54, 16, v175
v_and_b32 v55, 0xffff0000, v175
v_pk_add_f32 v[32:33], v[32:33], v[48:49]
v_pk_add_f32 v[34:35], v[34:35], v[50:51]
v_pk_add_f32 v[36:37], v[36:37], v[52:53]
v_pk_add_f32 v[38:39], v[38:39], v[54:55]
s_barrier
v_lshlrev_b32 v40, 16, v176
v_and_b32 v41, 0xffff0000, v176
v_lshlrev_b32 v42, 16, v177
v_and_b32 v43, 0xffff0000, v177
v_lshlrev_b32 v44, 16, v178
v_and_b32 v45, 0xffff0000, v178
v_lshlrev_b32 v46, 16, v179
v_and_b32 v47, 0xffff0000, v179
v_pk_add_f32 v[32:33], v[32:33], v[40:41]
v_pk_add_f32 v[34:35], v[34:35], v[42:43]
v_pk_add_f32 v[36:37], v[36:37], v[44:45]
v_pk_add_f32 v[38:39], v[38:39], v[46:47]
v_lshlrev_b32 v48, 16, v180
v_and_b32 v49, 0xffff0000, v180
v_lshlrev_b32 v50, 16, v181
v_and_b32 v51, 0xffff0000, v181
v_lshlrev_b32 v52, 16, v182
v_and_b32 v53, 0xffff0000, v182
v_lshlrev_b32 v54, 16, v183
v_and_b32 v55, 0xffff0000, v183
v_pk_add_f32 v[32:33], v[32:33], v[48:49]
v_pk_add_f32 v[34:35], v[34:35], v[50:51]
v_pk_add_f32 v[36:37], v[36:37], v[52:53]
v_pk_add_f32 v[38:39], v[38:39], v[54:55]
v_lshlrev_b32 v40, 16, v184
v_and_b32 v41, 0xffff0000, v184
v_lshlrev_b32 v42, 16, v185
v_and_b32 v43, 0xffff0000, v185
v_lshlrev_b32 v44, 16, v186
v_and_b32 v45, 0xffff0000, v186
v_lshlrev_b32 v46, 16, v187
v_and_b32 v47, 0xffff0000, v187
v_pk_add_f32 v[32:33], v[32:33], v[40:41]
v_pk_add_f32 v[34:35], v[34:35], v[42:43]
v_pk_add_f32 v[36:37], v[36:37], v[44:45]
v_pk_add_f32 v[38:39], v[38:39], v[46:47]
v_lshlrev_b32 v48, 16, v188
v_and_b32 v49, 0xffff0000, v188
v_lshlrev_b32 v50, 16, v189
v_and_b32 v51, 0xffff0000, v189
v_lshlrev_b32 v52, 16, v190
v_and_b32 v53, 0xffff0000, v190
v_lshlrev_b32 v54, 16, v191
v_and_b32 v55, 0xffff0000, v191
v_pk_add_f32 v[32:33], v[32:33], v[48:49]
v_pk_add_f32 v[34:35], v[34:35], v[50:51]
v_pk_add_f32 v[36:37], v[36:37], v[52:53]
v_pk_add_f32 v[38:39], v[38:39], v[54:55]
s_barrier
s_nop 2
v_mov_b32 v40, v32
v_mov_b32 v41, v33
v_mov_b32 v42, v34
v_mov_b32 v43, v35
v_mov_b32 v44, v36
v_mov_b32 v45, v37
v_mov_b32 v46, v38
v_mov_b32 v47, v39
s_nop 0
v_permlane16_swap_b32 v32, v40
v_permlane16_swap_b32 v33, v41
v_permlane16_swap_b32 v34, v42
v_permlane16_swap_b32 v35, v43
v_permlane16_swap_b32 v36, v44
v_permlane16_swap_b32 v37, v45
v_permlane16_swap_b32 v38, v46
v_permlane16_swap_b32 v39, v47
v_add_f32 v32, v32, v40
v_add_f32 v33, v33, v41
v_add_f32 v34, v34, v42
v_add_f32 v35, v35, v43
v_add_f32 v36, v36, v44
v_add_f32 v37, v37, v45
v_add_f32 v38, v38, v46
v_add_f32 v39, v39, v47
v_mov_b32 v40, v32
v_mov_b32 v41, v33
v_mov_b32 v42, v34
v_mov_b32 v43, v35
v_mov_b32 v44, v36
v_mov_b32 v45, v37
v_mov_b32 v46, v38
v_mov_b32 v47, v39
s_nop 0
v_permlane32_swap_b32 v32, v40
v_permlane32_swap_b32 v33, v41
v_permlane32_swap_b32 v34, v42
v_permlane32_swap_b32 v35, v43
v_permlane32_swap_b32 v36, v44
v_permlane32_swap_b32 v37, v45
v_permlane32_swap_b32 v38, v46
v_permlane32_swap_b32 v39, v47
v_add_f32 v32, v32, v40
v_add_f32 v33, v33, v41
v_add_f32 v34, v34, v42
v_add_f32 v35, v35, v43
v_add_f32 v36, v36, v44
v_add_f32 v37, v37, v45
v_add_f32 v38, v38, v46
v_add_f32 v39, v39, v47
s_mov_b64 exec, 0xffff
buffer_store_dwordx4 v[32:35], v5, s[72:75], 0 offen sc1
buffer_store_dwordx4 v[36:39], v5, s[72:75], 0 offen offset:16 sc1
s_mov_b64 exec, -1
s_waitcnt vmcnt(0)
s_add_u32 s43, s50, 96
s_lshl_b32 s43, s43, 7
v_mov_b32 v12, s43
v_mov_b32 v13, 1
s_mov_b64 exec, 1
buffer_atomic_add v13, v12, s[56:59], 0 offen sc1
s_mov_b64 exec, -1
s_branch Lcsd_92
.p2align 6
Lw_40:
s_branch Lr_41
s_nop 0
Lnojob_91:
s_lshl_b32 s43, s34, 18
s_add_u32 s12, s32, s43
s_addc_u32 s13, s33, 0
s_mov_b32 s14, 262144
s_mov_b32 s15, 0x20000
v_lshlrev_b32 v21, 4, v1
s_lshl_b32 s54, s36, 11
s_add_u32 s43, s35, 1
s_and_b32 s43, s43, 15
s_lshl_b32 s43, s43, 14
s_add_u32 s30, s43, s54
s_add_u32 s43, s35, 2
s_and_b32 s43, s43, 15
s_lshl_b32 s43, s43, 14
s_add_u32 s31, s43, s54
s_waitcnt vmcnt(0)
s_barrier
ds_write_b128 v27, v[68:71] offset:0
ds_write_b128 v27, v[116:119] offset:512
s_waitcnt lgkmcnt(0)
s_barrier
s_add_u32 m0, s54, 16384
s_add_u32 s43, s30, 0
buffer_load_dwordx4 v21, s[12:15], s43 offen sc1 lds
s_add_u32 m0, s54, 17408
s_add_u32 s43, s30, 1024
buffer_load_dwordx4 v21, s[12:15], s43 offen sc1 lds
s_add_u32 m0, s54, 32768
s_add_u32 s43, s31, 0
buffer_load_dwordx4 v21, s[12:15], s43 offen sc1 lds
s_add_u32 m0, s54, 33792
s_add_u32 s43, s31, 1024
buffer_load_dwordx4 v21, s[12:15], s43 offen sc1 lds
s_waitcnt vmcnt(2)
s_barrier
s_waitcnt vmcnt(0)
s_barrier
s_barrier
s_barrier
s_barrier
s_barrier
s_barrier
s_barrier
s_barrier
s_barrier
s_barrier
s_barrier
s_barrier
s_barrier
s_barrier
s_barrier
s_barrier
.p2align 3
Lcsd_92:
s_mov_b32 s46, 1
s_lshl_b32 s43, s34, 18
s_add_u32 s12, s32, s43
s_addc_u32 s13, s33, 0
s_add_u32 s12, s12, 4194304
s_addc_u32 s13, s13, 0
s_mov_b32 s14, 262144
s_mov_b32 s15, 0x20000
v_lshlrev_b32 v21, 4, v1
s_lshl_b32 s54, s36, 11
s_add_u32 s43, s35, 1
s_and_b32 s43, s43, 15
s_lshl_b32 s43, s43, 14
s_add_u32 s30, s43, s54
s_add_u32 s43, s35, 2
s_and_b32 s43, s43, 15
s_lshl_b32 s43, s43, 14
s_add_u32 s31, s43, s54
s_mov_b32 s88, s4
s_mov_b32 s89, s5
s_mov_b32 s90, 7340032
s_mov_b32 s91, 0x20000
s_mov_b32 s92, s6
s_mov_b32 s93, s7
s_mov_b32 s94, 7340032
s_mov_b32 s95, 0x20000
s_lshr_b32 s43, s35, 3
v_and_b32 v19, 1, v1
v_bfe_u32 v23, v1, 2, 2
s_lshl_b32 s44, s43, 3
s_add_u32 s44, s44, 1
v_lshl_add_u32 v23, v19, 2, v23
v_add_u32 v23, s44, v23
s_lshl_b32 s43, s43, 11
s_add_u32 s43, s43, 384
s_movk_i32 s44, 1024
s_lshr_b32 s45, s2, 3
s_mul_i32 s45, s45, 14336
s_add_u32 s43, s43, s45
v_mul_lo_u32 v31, v19, s44
v_bfe_u32 v19, v1, 1, 1
v_mul_u32_u24 v19, 7168, v19
v_add3_u32 v31, v31, v19, s43
v_add_u32 v19, 3, v23
v_and_b32 v19, 15, v19
v_mul_u32_u24 v19, 458752, v19
v_add_u32 v19, v19, v31
buffer_load_dword v30, v19, s[88:91], 0 offen
buffer_load_dword v30, v19, s[92:95], 0 offen
s_lshl_b32 s43, s34, 14
s_add_u32 s64, s32, s43
s_addc_u32 s65, s33, 0
s_add_u32 s64, s64, 25165824
s_addc_u32 s65, s65, 0
s_mov_b32 s66, 16384
s_mov_b32 s67, 0x20000
s_add_u32 s72, s32, 27262976
s_addc_u32 s73, s33, 0
s_mov_b32 s74, 114688
s_mov_b32 s75, 0x20000
s_barrier
s_add_u32 s43, s34, 16
s_lshl_b32 s43, s43, 7
v_mov_b32 v8, s43
v_mov_b32 v9, 1
s_mov_b64 exec, 1
buffer_atomic_add v9, v8, s[56:59], 0 offen sc1
s_mov_b64 exec, -1
s_mul_i32 s43, s2, 28672
s_mul_i32 s44, s51, 7168
s_add_u32 s43, s43, s44
s_add_u32 s80, s60, s43
s_addc_u32 s81, s61, 0
s_load_dword s82, s[80:81], 0
s_load_dword s83, s[80:81], 64
s_load_dword s84, s[80:81], 128
s_load_dword s85, s[80:81], 192
s_load_dword s86, s[80:81], 256
s_load_dword s87, s[80:81], 320
s_load_dword s82, s[80:81], 384
s_load_dword s83, s[80:81], 448
s_load_dword s84, s[80:81], 512
s_load_dword s85, s[80:81], 576
s_load_dword s86, s[80:81], 640
s_add_u32 s80, s80, 704
s_addc_u32 s81, s81, 0
s_barrier
s_load_dword s82, s[80:81], 0
s_load_dword s83, s[80:81], 64
s_load_dword s84, s[80:81], 128
s_load_dword s85, s[80:81], 192
s_load_dword s86, s[80:81], 256
s_load_dword s87, s[80:81], 320
s_load_dword s82, s[80:81], 384
s_load_dword s83, s[80:81], 448
s_load_dword s84, s[80:81], 512
s_load_dword s85, s[80:81], 576
s_load_dword s86, s[80:81], 640
s_add_u32 s80, s80, 704
s_addc_u32 s81, s81, 0
s_barrier
v_add_u32 v19, 7, v23
v_and_b32 v19, 15, v19
v_mul_u32_u24 v19, 458752, v19
v_add_u32 v19, v19, v31
buffer_load_dword v30, v19, s[88:91], 0 offen
buffer_load_dword v30, v19, s[92:95], 0 offen
s_mul_i32 s43, s49, 96
s_add_u32 s44, s43, 95
s_lshr_b32 s43, s43, 7
s_lshr_b32 s44, s44, 7
s_add_u32 s43, s43, 16
s_add_u32 s44, s44, 16
v_mov_b32 v12, s44
v_writelane_b32 v12, s35, 0
v_writelane_b32 v12, s43, 1
v_add_u32 v12, 96, v12
v_lshlrev_b32 v12, 7, v12
v_mov_b32 v14, 8
buffer_load_dword v13, v12, s[56:59], 0 offen sc1
s_load_dword s82, s[80:81], 0
s_load_dword s83, s[80:81], 64
s_load_dword s84, s[80:81], 128
s_load_dword s85, s[80:81], 192
s_load_dword s86, s[80:81], 256
s_load_dword s87, s[80:81], 320
s_load_dword s82, s[80:81], 384
s_load_dword s83, s[80:81], 448
s_load_dword s84, s[80:81], 512
s_load_dword s85, s[80:81], 576
s_load_dword s86, s[80:81], 640
s_add_u32 s80, s80, 704
s_addc_u32 s81, s81, 0
s_barrier
s_add_u32 s43, s34, 16
s_lshl_b32 s43, s43, 7
v_mov_b32 v8, s43
v_mov_b32 v10, 16
buffer_load_dword v9, v8, s[56:59], 0 offen sc1
s_load_dword s82, s[80:81], 0
s_load_dword s83, s[80:81], 64
s_load_dword s84, s[80:81], 128
s_load_dword s85, s[80:81], 192
s_load_dword s86, s[80:81], 256
s_load_dword s87, s[80:81], 320
s_load_dword s82, s[80:81], 384
s_load_dword s83, s[80:81], 448
s_load_dword s84, s[80:81], 512
s_load_dword s85, s[80:81], 576
s_load_dword s86, s[80:81], 640
s_add_u32 s80, s80, 704
s_addc_u32 s81, s81, 0
s_barrier
s_mov_b32 s41, 0x10000
Lpoll_93:
s_waitcnt vmcnt(0)
Lpf_95:
v_cmp_ne_u32 vcc, v10, v9
s_nop 4
s_cbranch_vccz Lpok_94
buffer_load_dword v9, v8, s[56:59], 0 offen sc1
s_sub_u32 s41, s41, 1
s_cmp_lg_u32 s41, 0
s_cbranch_scc1 Lpoll_93
s_waitcnt vmcnt(0)
Lpok_94:
s_mov_b32 s41, 0x10000
Lpoll_96:
s_waitcnt vmcnt(0)
Lpf_98:
v_cmp_ne_u32 vcc, v14, v13
s_nop 4
s_cbranch_vccz Lpok_97
buffer_load_dword v13, v12, s[56:59], 0 offen sc1
s_sub_u32 s41, s41, 1
s_cmp_lg_u32 s41, 0
s_cbranch_scc1 Lpoll_96
s_waitcnt vmcnt(0)
Lpok_97:
v_min_u32 v12, 55, v1
v_lshlrev_b32 v13, 4, v12
s_lshl_b32 s43, s35, 9
s_mul_i32 s44, s49, 384
s_add_u32 s44, s44, 7680
v_mov_b32 v14, s44
v_mov_b32 v15, s43
v_cmp_gt_u32 vcc, 32, v12
s_nop 1
v_cndmask_b32 v14, v14, v15, vcc
v_add_u32 v14, v14, v13
v_add_u32 v13, 148480, v13
s_mov_b32 s43, 0
buffer_load_dwordx4 v[192:195], v14, s[72:75], s43 offen sc1
s_mov_b32 s43, 28672
buffer_load_dwordx4 v[196:199], v14, s[72:75], s43 offen sc1
s_mov_b32 s43, 57344
buffer_load_dwordx4 v[200:203], v14, s[72:75], s43 offen sc1
s_mov_b32 s43, 86016
buffer_load_dwordx4 v[204:207], v14, s[72:75], s43 offen sc1
s_mov_b32 s43, 14336
buffer_load_dwordx4 v[208:211], v14, s[72:75], s43 offen sc1
s_mov_b32 s43, 43008
buffer_load_dwordx4 v[212:215], v14, s[72:75], s43 offen sc1
s_mov_b32 s43, 71680
buffer_load_dwordx4 v[216:219], v14, s[72:75], s43 offen sc1
s_mov_b32 s43, 100352
buffer_load_dwordx4 v[220:223], v14, s[72:75], s43 offen sc1
s_load_dword s82, s[80:81], 0
s_load_dword s83, s[80:81], 64
s_load_dword s84, s[80:81], 128
s_load_dword s85, s[80:81], 192
s_load_dword s86, s[80:81], 256
s_load_dword s87, s[80:81], 320
s_load_dword s82, s[80:81], 384
s_load_dword s83, s[80:81], 448
s_load_dword s84, s[80:81], 512
s_load_dword s85, s[80:81], 576
s_load_dword s86, s[80:81], 640
s_add_u32 s80, s80, 704
s_addc_u32 s81, s81, 0
s_barrier
s_getpc_b64 s[78:79]
Lpc_99:
s_sub_u32 s78, s78, Lpc_99-sequential_preLN__sliding_local_dilated__glu_gated_geglu__prompt_kernel
s_subb_u32 s79, s79, 0
s_lshr_b32 s43, s2, 3
s_mul_i32 s43, s43, 3840
v_min_u32 v19, 29, v1
v_lshl_add_u32 v19, v19, 7, s43
v_min_u32 v19, Ldone_1-sequential_preLN__sliding_local_dilated__glu_gated_geglu__prompt_kernel, v19
global_load_dword v30, v19, s[78:79]
s_mov_b32 s43, 0
buffer_load_dwordx4 v[128:131], v21, s[64:67], s43 offen sc1
s_mov_b32 s43, 1024
buffer_load_dwordx4 v[132:135], v21, s[64:67], s43 offen sc1
s_mov_b32 s43, 2048
buffer_load_dwordx4 v[136:139], v21, s[64:67], s43 offen sc1
s_mov_b32 s43, 3072
buffer_load_dwordx4 v[140:143], v21, s[64:67], s43 offen sc1
s_mov_b32 s43, 4096
buffer_load_dwordx4 v[144:147], v21, s[64:67], s43 offen sc1
s_mov_b32 s43, 5120
buffer_load_dwordx4 v[148:151], v21, s[64:67], s43 offen sc1
s_mov_b32 s43, 6144
buffer_load_dwordx4 v[152:155], v21, s[64:67], s43 offen sc1
s_mov_b32 s43, 7168
buffer_load_dwordx4 v[156:159], v21, s[64:67], s43 offen sc1
s_mov_b32 s43, 8192
buffer_load_dwordx4 v[160:163], v21, s[64:67], s43 offen sc1
s_mov_b32 s43, 9216
buffer_load_dwordx4 v[164:167], v21, s[64:67], s43 offen sc1
s_mov_b32 s43, 10240
buffer_load_dwordx4 v[168:171], v21, s[64:67], s43 offen sc1
s_mov_b32 s43, 11264
buffer_load_dwordx4 v[172:175], v21, s[64:67], s43 offen sc1
s_mov_b32 s43, 12288
buffer_load_dwordx4 v[176:179], v21, s[64:67], s43 offen sc1
s_mov_b32 s43, 13312
buffer_load_dwordx4 v[180:183], v21, s[64:67], s43 offen sc1
s_mov_b32 s43, 14336
buffer_load_dwordx4 v[184:187], v21, s[64:67], s43 offen sc1
s_mov_b32 s43, 15360
buffer_load_dwordx4 v[188:191], v21, s[64:67], s43 offen sc1
s_load_dword s82, s[80:81], 0
s_load_dword s83, s[80:81], 64
s_load_dword s84, s[80:81], 128
s_load_dword s85, s[80:81], 192
s_load_dword s86, s[80:81], 256
s_load_dword s87, s[80:81], 320
s_load_dword s82, s[80:81], 384
s_load_dword s83, s[80:81], 448
s_load_dword s84, s[80:81], 512
s_load_dword s85, s[80:81], 576
s_load_dword s86, s[80:81], 640
s_add_u32 s80, s80, 704
s_addc_u32 s81, s81, 0
s_barrier
v_add_u32 v19, 11, v23
v_and_b32 v19, 15, v19
v_mul_u32_u24 v19, 458752, v19
v_add_u32 v19, v19, v31
buffer_load_dword v30, v19, s[88:91], 0 offen
buffer_load_dword v30, v19, s[92:95], 0 offen
s_waitcnt vmcnt(16)
v_add_f32 v192, v192, v196
v_add_f32 v200, v200, v204
v_add_f32 v193, v193, v197
v_add_f32 v201, v201, v205
v_add_f32 v194, v194, v198
v_add_f32 v202, v202, v206
v_add_f32 v195, v195, v199
v_add_f32 v203, v203, v207
v_add_f32 v192, v192, v200
v_add_f32 v193, v193, v201
v_add_f32 v194, v194, v202
v_add_f32 v195, v195, v203
ds_write_b128 v13, v[192:195] offset:0
v_add_f32 v208, v208, v212
v_add_f32 v216, v216, v220
v_add_f32 v209, v209, v213
v_add_f32 v217, v217, v221
v_add_f32 v210, v210, v214
v_add_f32 v218, v218, v222
v_add_f32 v211, v211, v215
v_add_f32 v219, v219, v223
v_add_f32 v208, v208, v216
v_add_f32 v209, v209, v217
v_add_f32 v210, v210, v218
v_add_f32 v211, v211, v219
ds_write_b128 v13, v[208:211] offset:896
s_barrier
s_waitcnt vmcnt(0)
v_add_f32 v128, v128, v132
v_add_f32 v129, v129, v133
v_add_f32 v130, v130, v134
v_add_f32 v131, v131, v135
v_add_f32 v128, v128, v136
v_add_f32 v129, v129, v137
v_add_f32 v130, v130, v138
v_add_f32 v131, v131, v139
v_add_f32 v128, v128, v140
v_add_f32 v129, v129, v141
v_add_f32 v130, v130, v142
v_add_f32 v131, v131, v143
v_add_f32 v128, v128, v144
v_add_f32 v129, v129, v145
v_add_f32 v130, v130, v146
v_add_f32 v131, v131, v147
v_add_f32 v128, v128, v148
v_add_f32 v129, v129, v149
v_add_f32 v130, v130, v150
v_add_f32 v131, v131, v151
v_add_f32 v128, v128, v152
v_add_f32 v129, v129, v153
v_add_f32 v130, v130, v154
v_add_f32 v131, v131, v155
v_add_f32 v128, v128, v156
v_add_f32 v129, v129, v157
v_add_f32 v130, v130, v158
v_add_f32 v131, v131, v159
v_add_f32 v128, v128, v160
v_add_f32 v129, v129, v161
v_add_f32 v130, v130, v162
v_add_f32 v131, v131, v163
v_add_f32 v128, v128, v164
v_add_f32 v129, v129, v165
v_add_f32 v130, v130, v166
v_add_f32 v131, v131, v167
v_add_f32 v128, v128, v168
v_add_f32 v129, v129, v169
v_add_f32 v130, v130, v170
v_add_f32 v131, v131, v171
v_add_f32 v128, v128, v172
v_add_f32 v129, v129, v173
v_add_f32 v130, v130, v174
v_add_f32 v131, v131, v175
v_add_f32 v128, v128, v176
v_add_f32 v129, v129, v177
v_add_f32 v130, v130, v178
v_add_f32 v131, v131, v179
v_add_f32 v128, v128, v180
v_add_f32 v129, v129, v181
v_add_f32 v130, v130, v182
v_add_f32 v131, v131, v183
v_add_f32 v128, v128, v184
v_add_f32 v129, v129, v185
v_add_f32 v130, v130, v186
v_add_f32 v131, v131, v187
v_add_f32 v128, v128, v188
v_add_f32 v129, v129, v189
v_add_f32 v130, v130, v190
v_add_f32 v131, v131, v191
v_mul_f32 v128, 0x3a800000, v128
v_mul_f32 v129, 0x3a800000, v129
v_fma_f32 v129, -v128, v128, v129
v_max_f32 v129, 0, v129
v_add_f32 v129, 0x3727c5ac, v129
v_rsq_f32 v129, v129
v_mul_f32 v130, 0x3a800000, v130
v_mul_f32 v131, 0x3a800000, v131
v_fma_f32 v131, -v130, v130, v131
v_max_f32 v131, 0, v131
v_add_f32 v131, 0x3727c5ac, v131
v_rsq_f32 v131, v131
v_add_u32 v19, 147456, v21
ds_write_b128 v19, v[128:131]
s_waitcnt lgkmcnt(0)
s_load_dword s82, s[80:81], 0
s_load_dword s83, s[80:81], 64
s_load_dword s84, s[80:81], 128
s_load_dword s85, s[80:81], 192
s_load_dword s86, s[80:81], 256
s_load_dword s87, s[80:81], 320
s_load_dword s82, s[80:81], 384
s_load_dword s83, s[80:81], 448
s_load_dword s84, s[80:81], 512
s_load_dword s85, s[80:81], 576
s_load_dword s86, s[80:81], 640
s_add_u32 s80, s80, 704
s_addc_u32 s81, s81, 0
s_barrier
s_load_dword s82, s[80:81], 0
s_load_dword s83, s[80:81], 64
s_load_dword s84, s[80:81], 128
s_load_dword s85, s[80:81], 192
s_load_dword s86, s[80:81], 256
s_load_dword s87, s[80:81], 320
s_load_dword s82, s[80:81], 384
s_load_dword s83, s[80:81], 448
s_load_dword s84, s[80:81], 512
s_load_dword s85, s[80:81], 576
s_load_dword s86, s[80:81], 640
s_add_u32 s80, s80, 704
s_addc_u32 s81, s81, 0
s_barrier
v_add_u32 v19, 15, v23
v_and_b32 v19, 15, v19
v_mul_u32_u24 v19, 458752, v19
v_add_u32 v19, v19, v31
buffer_load_dword v30, v19, s[88:91], 0 offen
buffer_load_dword v30, v19, s[92:95], 0 offen
s_and_b32 s53, s35, 1
s_lshl_b32 s53, s53, 1
s_mul_i32 s43, s47, 3
s_add_u32 s53, s53, s43
v_lshlrev_b32 v19, 11, v18
v_lshl_add_u32 v19, v17, 4, v19
s_lshl_b32 s43, s46, 10
v_add_u32 v2, s43, v19
v_add_u32 v3, 49152, v2
v_add_u32 v4, 98304, v2
v_lshrrev_b32 v19, 2, v17
v_lshl_add_u32 v20, v18, 2, v19
v_and_b32 v21, 7, v20
v_lshlrev_b32 v20, 8, v20
v_and_b32 v19, 3, v1
v_lshl_add_u32 v20, v19, 3, v20
s_add_u32 s43, s53, 0
v_xor_b32 v19, s43, v21
v_lshl_add_u32 v5, v19, 5, v20
s_add_u32 s43, s53, 1
v_xor_b32 v19, s43, v21
v_lshl_add_u32 v6, v19, 5, v20
s_add_u32 s43, s53, 2
v_xor_b32 v19, s43, v21
v_lshl_add_u32 v7, v19, 5, v20
v_add_u32 v9, 49152, v5
v_add_u32 v10, 49152, v6
v_add_u32 v11, 49152, v7
v_add_u32 v13, 98304, v5
v_add_u32 v14, 98304, v6
v_add_u32 v15, 98304, v7
s_lshl_b32 s43, s46, 9
s_add_u32 s43, s43, 147456
v_lshl_add_u32 v19, v17, 3, s43
ds_read_b64 v[80:81], v19 offset:0
ds_read_b64 v[82:83], v19 offset:128
ds_read_b64 v[84:85], v19 offset:256
ds_read_b64 v[86:87], v19 offset:384
s_mul_i32 s43, s47, 192
s_add_u32 s43, s43, 148992
v_lshl_add_u32 v19, v18, 4, s43
ds_read_b128 v[48:51], v19 offset:0
ds_read_b128 v[52:55], v19 offset:64
ds_read_b128 v[56:59], v19 offset:128
ds_read_b128 v[60:63], v19 offset:896
ds_read_b128 v[64:67], v19 offset:960
ds_read_b128 v[68:71], v19 offset:1024
s_barrier
s_mov_b32 s88, s4
s_mov_b32 s89, s5
s_mov_b32 s90, 7340032
s_mov_b32 s91, 0x20000
s_mov_b32 s92, s6
s_mov_b32 s93, s7
s_mov_b32 s94, 7340032
s_mov_b32 s95, 0x20000
s_lshr_b32 s43, s35, 3
v_and_b32 v19, 1, v1
v_bfe_u32 v23, v1, 2, 2
s_lshl_b32 s44, s43, 1
s_add_u32 s44, s44, 6
v_add_u32 v23, s44, v23
s_mul_i32 s44, s43, 6
s_add_u32 s44, s44, 1
v_mad_u32_u24 v23, v19, s44, v23
s_lshl_b32 s44, s43, 10
s_lshl_b32 s43, s43, 11
s_sub_u32 s43, 6528, s43
s_lshr_b32 s45, s2, 3
s_mul_i32 s45, s45, 14336
s_add_u32 s43, s43, s45
v_mul_lo_u32 v31, v19, s44
v_bfe_u32 v19, v1, 1, 1
v_mul_u32_u24 v19, 7168, v19
v_add3_u32 v31, v31, v19, s43
v_add_u32 v19, 0, v23
v_and_b32 v19, 15, v19
v_mul_u32_u24 v19, 458752, v19
v_add_u32 v19, v19, v31
buffer_load_dword v30, v19, s[88:91], 0 offen
buffer_load_dword v30, v19, s[92:95], 0 offen
s_waitcnt lgkmcnt(0)
v_mul_f32 v88, v81, v81
v_mul_f32 v228, 0xc0135761, v81
v_mul_f32 v89, 0xbdd2d3e8, v81
v_rcp_f32 v236, v88
v_mul_f32 v232, v89, v88
v_mul_f32 v88, v83, v83
v_mul_f32 v229, 0xc0135761, v83
v_mul_f32 v89, 0xbdd2d3e8, v83
v_rcp_f32 v237, v88
v_mul_f32 v233, v89, v88
v_mul_f32 v88, v85, v85
v_mul_f32 v230, 0xc0135761, v85
v_mul_f32 v89, 0xbdd2d3e8, v85
v_rcp_f32 v238, v88
v_mul_f32 v234, v89, v88
v_mul_f32 v88, v87, v87
v_mul_f32 v231, 0xc0135761, v87
v_mul_f32 v89, 0xbdd2d3e8, v87
v_rcp_f32 v239, v88
v_mul_f32 v235, v89, v88
s_mul_i32 s43, s34, 917504
s_mul_i32 s44, s49, 24576
s_add_u32 s43, s43, s44
s_add_u32 s43, s43, 8912896
s_add_u32 s24, s32, s43
s_addc_u32 s25, s33, 0
s_mov_b32 s26, 24576
s_mov_b32 s27, 0x20000
s_mov_b32 s53, 262144
s_lshl_b32 s43, s47, 13
s_lshl_b32 s44, s46, 10
s_add_u32 s43, s43, s44
v_lshlrev_b32 v19, 11, v18
v_lshl_add_u32 v19, v17, 4, v19
v_add_u32 v27, s43, v19
s_lshl_b32 s43, s47, 12
s_add_u32 s43, s43, s44
s_add_u32 s43, s43, 16384
v_and_b32 v19, 1, v18
v_lshlrev_b32 v19, 11, v19
v_lshrrev_b32 v20, 1, v18
v_lshl_add_u32 v19, v20, 8, v19
v_lshl_add_u32 v19, v17, 4, v19
v_add_u32 v28, s43, v19
s_load_dword s82, s[80:81], 0
s_load_dword s83, s[80:81], 64
s_load_dword s84, s[80:81], 128
s_load_dword s85, s[80:81], 192
s_load_dword s86, s[80:81], 256
s_load_dword s87, s[80:81], 320
s_load_dword s82, s[80:81], 384
s_load_dword s83, s[80:81], 448
s_add_u32 s80, s80, 512
s_addc_u32 s81, s81, 0
s_barrier
v_mul_f32 v128, -v80, v48
v_mul_f32 v129, -v80, v49
v_mul_f32 v130, -v80, v50
v_mul_f32 v131, -v80, v51
v_mul_f32 v132, -v82, v48
v_mul_f32 v133, -v82, v49
v_mul_f32 v134, -v82, v50
v_mul_f32 v135, -v82, v51
v_mul_f32 v136, -v84, v48
v_mul_f32 v137, -v84, v49
v_mul_f32 v138, -v84, v50
v_mul_f32 v139, -v84, v51
v_mul_f32 v140, -v86, v48
v_mul_f32 v141, -v86, v49
v_mul_f32 v142, -v86, v50
v_mul_f32 v143, -v86, v51
v_mul_f32 v144, -v80, v52
v_mul_f32 v145, -v80, v53
v_mul_f32 v146, -v80, v54
v_mul_f32 v147, -v80, v55
v_mul_f32 v148, -v82, v52
v_mul_f32 v149, -v82, v53
v_mul_f32 v150, -v82, v54
v_mul_f32 v151, -v82, v55
v_mul_f32 v152, -v84, v52
v_mul_f32 v153, -v84, v53
v_mul_f32 v154, -v84, v54
v_mul_f32 v155, -v84, v55
v_mul_f32 v156, -v86, v52
v_mul_f32 v157, -v86, v53
v_mul_f32 v158, -v86, v54
v_mul_f32 v159, -v86, v55
s_load_dword s82, s[80:81], 0
s_load_dword s83, s[80:81], 64
s_load_dword s84, s[80:81], 128
s_load_dword s85, s[80:81], 192
s_load_dword s86, s[80:81], 256
s_load_dword s87, s[80:81], 320
s_load_dword s82, s[80:81], 384
s_load_dword s83, s[80:81], 448
s_add_u32 s80, s80, 512
s_addc_u32 s81, s81, 0
s_barrier
v_mul_f32 v160, -v80, v56
v_mul_f32 v161, -v80, v57
v_mul_f32 v162, -v80, v58
v_mul_f32 v163, -v80, v59
v_mul_f32 v164, -v82, v56
v_mul_f32 v165, -v82, v57
v_mul_f32 v166, -v82, v58
v_mul_f32 v167, -v82, v59
v_mul_f32 v168, -v84, v56
v_mul_f32 v169, -v84, v57
v_mul_f32 v170, -v84, v58
v_mul_f32 v171, -v84, v59
v_mul_f32 v172, -v86, v56
v_mul_f32 v173, -v86, v57
v_mul_f32 v174, -v86, v58
v_mul_f32 v175, -v86, v59
v_mul_f32 v176, -v80, v60
v_mul_f32 v177, -v80, v61
v_mul_f32 v178, -v80, v62
v_mul_f32 v179, -v80, v63
v_mul_f32 v180, -v82, v60
v_mul_f32 v181, -v82, v61
v_mul_f32 v182, -v82, v62
v_mul_f32 v183, -v82, v63
v_mul_f32 v184, -v84, v60
v_mul_f32 v185, -v84, v61
v_mul_f32 v186, -v84, v62
v_mul_f32 v187, -v84, v63
v_mul_f32 v188, -v86, v60
v_mul_f32 v189, -v86, v61
v_mul_f32 v190, -v86, v62
v_mul_f32 v191, -v86, v63
s_load_dword s82, s[80:81], 0
s_load_dword s83, s[80:81], 64
s_load_dword s84, s[80:81], 128
s_load_dword s85, s[80:81], 192
s_load_dword s86, s[80:81], 256
s_load_dword s87, s[80:81], 320
s_load_dword s82, s[80:81], 384
s_load_dword s83, s[80:81], 448
s_add_u32 s80, s80, 512
s_addc_u32 s81, s81, 0
s_barrier
v_mul_f32 v192, -v80, v64
v_mul_f32 v193, -v80, v65
v_mul_f32 v194, -v80, v66
v_mul_f32 v195, -v80, v67
v_mul_f32 v196, -v82, v64
v_mul_f32 v197, -v82, v65
v_mul_f32 v198, -v82, v66
v_mul_f32 v199, -v82, v67
v_mul_f32 v200, -v84, v64
v_mul_f32 v201, -v84, v65
v_mul_f32 v202, -v84, v66
v_mul_f32 v203, -v84, v67
v_mul_f32 v204, -v86, v64
v_mul_f32 v205, -v86, v65
v_mul_f32 v206, -v86, v66
v_mul_f32 v207, -v86, v67
v_mul_f32 v208, -v80, v68
v_mul_f32 v209, -v80, v69
v_mul_f32 v210, -v80, v70
v_mul_f32 v211, -v80, v71
v_mul_f32 v212, -v82, v68
v_mul_f32 v213, -v82, v69
v_mul_f32 v214, -v82, v70
v_mul_f32 v215, -v82, v71
v_mul_f32 v216, -v84, v68
v_mul_f32 v217, -v84, v69
v_mul_f32 v218, -v84, v70
v_mul_f32 v219, -v84, v71
v_mul_f32 v220, -v86, v68
v_mul_f32 v221, -v86, v69
v_mul_f32 v222, -v86, v70
v_mul_f32 v223, -v86, v71
s_barrier
s_branch Lw_100
Lr_101:
v_add_u32 v19, 4, v23
v_and_b32 v19, 15, v19
v_mul_u32_u24 v19, 458752, v19
v_add_u32 v19, v19, v31
buffer_load_dword v30, v19, s[88:91], 0 offen
buffer_load_dword v30, v19, s[92:95], 0 offen
s_mul_i32 s44, s34, 917504
s_lshl_b32 s39, s51, 13
s_add_u32 s44, s44, s39
s_add_u32 s44, s44, 8388608
s_and_b32 s43, s51, 1
s_xor_b32 s43, s43, s35
s_lshl_b32 s43, s43, 7
s_mov_b32 s10, 909312
s_movk_i32 s38, 1024
s_movk_i32 s40, 9216
s_movk_i32 s37, 0x4000
s_cmp_ge_u32 s51, 2
s_cselect_b32 s8, s60, s32
s_cselect_b32 s9, s61, s33
s_cselect_b32 s10, 7338112, s10
s_cselect_b32 s43, s43, s44
s_cselect_b32 s38, 16384, s38
s_cselect_b32 s40, 81920, s40
s_cselect_b32 s55, 81920, s38
s_cselect_b32 s37, 262144, s37
s_cselect_b32 s45, -1, 0
s_add_u32 s8, s8, s43
s_addc_u32 s9, s9, 0
s_mov_b32 s11, 0x20000
s_and_b32 s53, s35, 1
s_mul_i32 s54, s53, 6
s_mul_i32 s54, s54, s37
s_mul_i32 s29, s53, 2
s_add_u32 s29, s29, 6
s_mul_i32 s29, s29, s37
s_and_b32 s43, s45, 4290838528
s_add_u32 s29, s29, s43
s_mul_i32 s37, s37, 2
s_sub_u32 s37, s37, s40
v_lshrrev_b32 v19, 3, v1
v_mul_u32_u24 v19, 1920, v19
v_lshrrev_b32 v20, 4, v1
v_lshlrev_b32 v20, 5, v20
v_and_b32 v19, s45, v19
v_and_b32 v20, s45, v20
v_lshlrev_b32 v21, 4, v1
v_xor_b32 v21, v21, v20
v_add_u32 v21, v21, v19
s_barrier
.p2align 3
LK3b_82:
s_setprio 1
ds_read_b128 v[32:35], v2 offset:0
ds_read_b64_tr_b16 v[48:49], v5 offset:16384
ds_read_b64_tr_b16 v[50:51], v5 offset:20480
ds_read_b128 v[36:39], v2 offset:256
ds_read_b128 v[40:43], v2 offset:512
ds_read_b128 v[44:47], v2 offset:768
ds_read_b64_tr_b16 v[60:61], v5 offset:32768
ds_read_b64_tr_b16 v[62:63], v5 offset:36864
ds_read_b64_tr_b16 v[52:53], v6 offset:16384
ds_read_b64_tr_b16 v[54:55], v6 offset:20480
ds_read_b64_tr_b16 v[64:65], v6 offset:32768
ds_read_b64_tr_b16 v[66:67], v6 offset:36864
ds_read_b64_tr_b16 v[56:57], v7 offset:16384
ds_read_b64_tr_b16 v[58:59], v7 offset:20480
ds_read_b64_tr_b16 v[68:69], v7 offset:32768
ds_read_b64_tr_b16 v[70:71], v7 offset:36864
s_mov_b32 s41, 5
.p2align 3
Lk3_102:
s_waitcnt lgkmcnt(0)
v_mfma_f32_16x16x32_bf16 v[128:131], v[48:51], v[32:35], v[128:131]
ds_read_b128 v[80:83], v2 offset:8192
v_mfma_f32_16x16x32_bf16 v[132:135], v[48:51], v[36:39], v[132:135]
ds_read_b64_tr_b16 v[96:97], v5 offset:24576
v_mfma_f32_16x16x32_bf16 v[136:139], v[48:51], v[40:43], v[136:139]
ds_read_b64_tr_b16 v[98:99], v5 offset:28672
v_mfma_f32_16x16x32_bf16 v[140:143], v[48:51], v[44:47], v[140:143]
ds_read_b128 v[84:87], v2 offset:8448
v_mfma_f32_16x16x32_bf16 v[188:191], v[60:63], v[44:47], v[188:191]
ds_read_b128 v[88:91], v2 offset:8704
v_mfma_f32_16x16x32_bf16 v[184:187], v[60:63], v[40:43], v[184:187]
ds_read_b128 v[92:95], v2 offset:8960
v_mfma_f32_16x16x32_bf16 v[180:183], v[60:63], v[36:39], v[180:183]
ds_read_b64_tr_b16 v[108:109], v5 offset:40960
v_mfma_f32_16x16x32_bf16 v[176:179], v[60:63], v[32:35], v[176:179]
ds_read_b64_tr_b16 v[110:111], v5 offset:45056
v_mfma_f32_16x16x32_bf16 v[144:147], v[52:55], v[32:35], v[144:147]
ds_read_b64_tr_b16 v[100:101], v6 offset:24576
v_mfma_f32_16x16x32_bf16 v[148:151], v[52:55], v[36:39], v[148:151]
ds_read_b64_tr_b16 v[102:103], v6 offset:28672
v_mfma_f32_16x16x32_bf16 v[152:155], v[52:55], v[40:43], v[152:155]
ds_read_b64_tr_b16 v[112:113], v6 offset:40960
v_mfma_f32_16x16x32_bf16 v[156:159], v[52:55], v[44:47], v[156:159]
ds_read_b64_tr_b16 v[114:115], v6 offset:45056
v_mfma_f32_16x16x32_bf16 v[204:207], v[64:67], v[44:47], v[204:207]
ds_read_b64_tr_b16 v[104:105], v7 offset:24576
v_mfma_f32_16x16x32_bf16 v[200:203], v[64:67], v[40:43], v[200:203]
ds_read_b64_tr_b16 v[106:107], v7 offset:28672
v_mfma_f32_16x16x32_bf16 v[196:199], v[64:67], v[36:39], v[196:199]
ds_read_b64_tr_b16 v[116:117], v7 offset:40960
v_mfma_f32_16x16x32_bf16 v[192:195], v[64:67], v[32:35], v[192:195]
ds_read_b64_tr_b16 v[118:119], v7 offset:45056
v_mfma_f32_16x16x32_bf16 v[160:163], v[56:59], v[32:35], v[160:163]
v_mfma_f32_16x16x32_bf16 v[164:167], v[56:59], v[36:39], v[164:167]
v_mfma_f32_16x16x32_bf16 v[168:171], v[56:59], v[40:43], v[168:171]
v_mfma_f32_16x16x32_bf16 v[172:175], v[56:59], v[44:47], v[172:175]
v_mfma_f32_16x16x32_bf16 v[220:223], v[68:71], v[44:47], v[220:223]
v_mfma_f32_16x16x32_bf16 v[216:219], v[68:71], v[40:43], v[216:219]
v_mfma_f32_16x16x32_bf16 v[212:215], v[68:71], v[36:39], v[212:215]
v_mfma_f32_16x16x32_bf16 v[208:211], v[68:71], v[32:35], v[208:211]
s_waitcnt vmcnt(0) lgkmcnt(0)
s_barrier
v_mfma_f32_16x16x32_bf16 v[128:131], v[96:99], v[80:83], v[128:131]
ds_read_b128 v[32:35], v3 offset:0
v_mfma_f32_16x16x32_bf16 v[132:135], v[96:99], v[84:87], v[132:135]
ds_read_b64_tr_b16 v[48:49], v9 offset:16384
v_mfma_f32_16x16x32_bf16 v[136:139], v[96:99], v[88:91], v[136:139]
ds_read_b64_tr_b16 v[50:51], v9 offset:20480
v_mfma_f32_16x16x32_bf16 v[140:143], v[96:99], v[92:95], v[140:143]
ds_read_b128 v[36:39], v3 offset:256
v_mfma_f32_16x16x32_bf16 v[188:191], v[108:111], v[92:95], v[188:191]
ds_read_b128 v[40:43], v3 offset:512
v_mfma_f32_16x16x32_bf16 v[184:187], v[108:111], v[88:91], v[184:187]
ds_read_b128 v[44:47], v3 offset:768
v_mfma_f32_16x16x32_bf16 v[180:183], v[108:111], v[84:87], v[180:183]
ds_read_b64_tr_b16 v[60:61], v9 offset:32768
v_mfma_f32_16x16x32_bf16 v[176:179], v[108:111], v[80:83], v[176:179]
ds_read_b64_tr_b16 v[62:63], v9 offset:36864
v_mfma_f32_16x16x32_bf16 v[144:147], v[100:103], v[80:83], v[144:147]
ds_read_b64_tr_b16 v[52:53], v10 offset:16384
v_mfma_f32_16x16x32_bf16 v[148:151], v[100:103], v[84:87], v[148:151]
ds_read_b64_tr_b16 v[54:55], v10 offset:20480
v_mfma_f32_16x16x32_bf16 v[152:155], v[100:103], v[88:91], v[152:155]
ds_read_b64_tr_b16 v[64:65], v10 offset:32768
v_mfma_f32_16x16x32_bf16 v[156:159], v[100:103], v[92:95], v[156:159]
ds_read_b64_tr_b16 v[66:67], v10 offset:36864
v_mfma_f32_16x16x32_bf16 v[204:207], v[112:115], v[92:95], v[204:207]
ds_read_b64_tr_b16 v[56:57], v11 offset:16384
v_mfma_f32_16x16x32_bf16 v[200:203], v[112:115], v[88:91], v[200:203]
ds_read_b64_tr_b16 v[58:59], v11 offset:20480
v_mfma_f32_16x16x32_bf16 v[196:199], v[112:115], v[84:87], v[196:199]
ds_read_b64_tr_b16 v[68:69], v11 offset:32768
v_mfma_f32_16x16x32_bf16 v[192:195], v[112:115], v[80:83], v[192:195]
ds_read_b64_tr_b16 v[70:71], v11 offset:36864
v_mfma_f32_16x16x32_bf16 v[160:163], v[104:107], v[80:83], v[160:163]
v_mfma_f32_16x16x32_bf16 v[164:167], v[104:107], v[84:87], v[164:167]
v_mfma_f32_16x16x32_bf16 v[168:171], v[104:107], v[88:91], v[168:171]
v_mfma_f32_16x16x32_bf16 v[172:175], v[104:107], v[92:95], v[172:175]
v_mfma_f32_16x16x32_bf16 v[220:223], v[116:119], v[92:95], v[220:223]
v_mfma_f32_16x16x32_bf16 v[216:219], v[116:119], v[88:91], v[216:219]
v_mfma_f32_16x16x32_bf16 v[212:215], v[116:119], v[84:87], v[212:215]
v_mfma_f32_16x16x32_bf16 v[208:211], v[116:119], v[80:83], v[208:211]
s_waitcnt lgkmcnt(0)
v_mfma_f32_16x16x32_bf16 v[128:131], v[48:51], v[32:35], v[128:131]
ds_read_b128 v[80:83], v3 offset:8192
v_mfma_f32_16x16x32_bf16 v[132:135], v[48:51], v[36:39], v[132:135]
ds_read_b64_tr_b16 v[96:97], v9 offset:24576
v_mfma_f32_16x16x32_bf16 v[136:139], v[48:51], v[40:43], v[136:139]
ds_read_b64_tr_b16 v[98:99], v9 offset:28672
v_mfma_f32_16x16x32_bf16 v[140:143], v[48:51], v[44:47], v[140:143]
ds_read_b128 v[84:87], v3 offset:8448
v_mfma_f32_16x16x32_bf16 v[188:191], v[60:63], v[44:47], v[188:191]
ds_read_b128 v[88:91], v3 offset:8704
v_mfma_f32_16x16x32_bf16 v[184:187], v[60:63], v[40:43], v[184:187]
ds_read_b128 v[92:95], v3 offset:8960
v_mfma_f32_16x16x32_bf16 v[180:183], v[60:63], v[36:39], v[180:183]
ds_read_b64_tr_b16 v[108:109], v9 offset:40960
v_mfma_f32_16x16x32_bf16 v[176:179], v[60:63], v[32:35], v[176:179]
ds_read_b64_tr_b16 v[110:111], v9 offset:45056
v_mfma_f32_16x16x32_bf16 v[144:147], v[52:55], v[32:35], v[144:147]
ds_read_b64_tr_b16 v[100:101], v10 offset:24576
v_mfma_f32_16x16x32_bf16 v[148:151], v[52:55], v[36:39], v[148:151]
ds_read_b64_tr_b16 v[102:103], v10 offset:28672
v_mfma_f32_16x16x32_bf16 v[152:155], v[52:55], v[40:43], v[152:155]
ds_read_b64_tr_b16 v[112:113], v10 offset:40960
v_mfma_f32_16x16x32_bf16 v[156:159], v[52:55], v[44:47], v[156:159]
ds_read_b64_tr_b16 v[114:115], v10 offset:45056
v_mfma_f32_16x16x32_bf16 v[204:207], v[64:67], v[44:47], v[204:207]
ds_read_b64_tr_b16 v[104:105], v11 offset:24576
v_mfma_f32_16x16x32_bf16 v[200:203], v[64:67], v[40:43], v[200:203]
ds_read_b64_tr_b16 v[106:107], v11 offset:28672
v_mfma_f32_16x16x32_bf16 v[196:199], v[64:67], v[36:39], v[196:199]
ds_read_b64_tr_b16 v[116:117], v11 offset:40960
v_mfma_f32_16x16x32_bf16 v[192:195], v[64:67], v[32:35], v[192:195]
ds_read_b64_tr_b16 v[118:119], v11 offset:45056
v_mfma_f32_16x16x32_bf16 v[160:163], v[56:59], v[32:35], v[160:163]
v_mfma_f32_16x16x32_bf16 v[164:167], v[56:59], v[36:39], v[164:167]
v_mfma_f32_16x16x32_bf16 v[168:171], v[56:59], v[40:43], v[168:171]
v_mfma_f32_16x16x32_bf16 v[172:175], v[56:59], v[44:47], v[172:175]
v_mfma_f32_16x16x32_bf16 v[220:223], v[68:71], v[44:47], v[220:223]
v_mfma_f32_16x16x32_bf16 v[216:219], v[68:71], v[40:43], v[216:219]
v_mfma_f32_16x16x32_bf16 v[212:215], v[68:71], v[36:39], v[212:215]
v_mfma_f32_16x16x32_bf16 v[208:211], v[68:71], v[32:35], v[208:211]
s_waitcnt lgkmcnt(0)
s_barrier
v_mfma_f32_16x16x32_bf16 v[128:131], v[96:99], v[80:83], v[128:131]
ds_read_b128 v[32:35], v4 offset:0
v_mfma_f32_16x16x32_bf16 v[132:135], v[96:99], v[84:87], v[132:135]
ds_read_b64_tr_b16 v[48:49], v13 offset:16384
v_mfma_f32_16x16x32_bf16 v[136:139], v[96:99], v[88:91], v[136:139]
ds_read_b64_tr_b16 v[50:51], v13 offset:20480
v_mfma_f32_16x16x32_bf16 v[140:143], v[96:99], v[92:95], v[140:143]
ds_read_b128 v[36:39], v4 offset:256
v_mfma_f32_16x16x32_bf16 v[188:191], v[108:111], v[92:95], v[188:191]
ds_read_b128 v[40:43], v4 offset:512
v_mfma_f32_16x16x32_bf16 v[184:187], v[108:111], v[88:91], v[184:187]
ds_read_b128 v[44:47], v4 offset:768
v_mfma_f32_16x16x32_bf16 v[180:183], v[108:111], v[84:87], v[180:183]
ds_read_b64_tr_b16 v[60:61], v13 offset:32768
v_mfma_f32_16x16x32_bf16 v[176:179], v[108:111], v[80:83], v[176:179]
ds_read_b64_tr_b16 v[62:63], v13 offset:36864
v_mfma_f32_16x16x32_bf16 v[144:147], v[100:103], v[80:83], v[144:147]
ds_read_b64_tr_b16 v[52:53], v14 offset:16384
v_mfma_f32_16x16x32_bf16 v[148:151], v[100:103], v[84:87], v[148:151]
ds_read_b64_tr_b16 v[54:55], v14 offset:20480
v_mfma_f32_16x16x32_bf16 v[152:155], v[100:103], v[88:91], v[152:155]
ds_read_b64_tr_b16 v[64:65], v14 offset:32768
v_mfma_f32_16x16x32_bf16 v[156:159], v[100:103], v[92:95], v[156:159]
ds_read_b64_tr_b16 v[66:67], v14 offset:36864
v_mfma_f32_16x16x32_bf16 v[204:207], v[112:115], v[92:95], v[204:207]
ds_read_b64_tr_b16 v[56:57], v15 offset:16384
v_mfma_f32_16x16x32_bf16 v[200:203], v[112:115], v[88:91], v[200:203]
ds_read_b64_tr_b16 v[58:59], v15 offset:20480
v_mfma_f32_16x16x32_bf16 v[196:199], v[112:115], v[84:87], v[196:199]
ds_read_b64_tr_b16 v[68:69], v15 offset:32768
v_mfma_f32_16x16x32_bf16 v[192:195], v[112:115], v[80:83], v[192:195]
ds_read_b64_tr_b16 v[70:71], v15 offset:36864
v_mfma_f32_16x16x32_bf16 v[160:163], v[104:107], v[80:83], v[160:163]
v_mfma_f32_16x16x32_bf16 v[164:167], v[104:107], v[84:87], v[164:167]
v_mfma_f32_16x16x32_bf16 v[168:171], v[104:107], v[88:91], v[168:171]
v_mfma_f32_16x16x32_bf16 v[172:175], v[104:107], v[92:95], v[172:175]
v_mfma_f32_16x16x32_bf16 v[220:223], v[116:119], v[92:95], v[220:223]
v_mfma_f32_16x16x32_bf16 v[216:219], v[116:119], v[88:91], v[216:219]
v_mfma_f32_16x16x32_bf16 v[212:215], v[116:119], v[84:87], v[212:215]
v_mfma_f32_16x16x32_bf16 v[208:211], v[116:119], v[80:83], v[208:211]
s_waitcnt lgkmcnt(0)
v_mfma_f32_16x16x32_bf16 v[128:131], v[48:51], v[32:35], v[128:131]
ds_read_b128 v[80:83], v4 offset:8192
v_mfma_f32_16x16x32_bf16 v[132:135], v[48:51], v[36:39], v[132:135]
ds_read_b64_tr_b16 v[96:97], v13 offset:24576
v_mfma_f32_16x16x32_bf16 v[136:139], v[48:51], v[40:43], v[136:139]
ds_read_b64_tr_b16 v[98:99], v13 offset:28672
v_mfma_f32_16x16x32_bf16 v[140:143], v[48:51], v[44:47], v[140:143]
ds_read_b128 v[84:87], v4 offset:8448
v_mfma_f32_16x16x32_bf16 v[188:191], v[60:63], v[44:47], v[188:191]
ds_read_b128 v[88:91], v4 offset:8704
v_mfma_f32_16x16x32_bf16 v[184:187], v[60:63], v[40:43], v[184:187]
ds_read_b128 v[92:95], v4 offset:8960
v_mfma_f32_16x16x32_bf16 v[180:183], v[60:63], v[36:39], v[180:183]
ds_read_b64_tr_b16 v[108:109], v13 offset:40960
v_mfma_f32_16x16x32_bf16 v[176:179], v[60:63], v[32:35], v[176:179]
ds_read_b64_tr_b16 v[110:111], v13 offset:45056
v_mfma_f32_16x16x32_bf16 v[144:147], v[52:55], v[32:35], v[144:147]
ds_read_b64_tr_b16 v[100:101], v14 offset:24576
v_mfma_f32_16x16x32_bf16 v[148:151], v[52:55], v[36:39], v[148:151]
ds_read_b64_tr_b16 v[102:103], v14 offset:28672
v_mfma_f32_16x16x32_bf16 v[152:155], v[52:55], v[40:43], v[152:155]
ds_read_b64_tr_b16 v[112:113], v14 offset:40960
v_mfma_f32_16x16x32_bf16 v[156:159], v[52:55], v[44:47], v[156:159]
ds_read_b64_tr_b16 v[114:115], v14 offset:45056
v_mfma_f32_16x16x32_bf16 v[204:207], v[64:67], v[44:47], v[204:207]
ds_read_b64_tr_b16 v[104:105], v15 offset:24576
v_mfma_f32_16x16x32_bf16 v[200:203], v[64:67], v[40:43], v[200:203]
ds_read_b64_tr_b16 v[106:107], v15 offset:28672
v_mfma_f32_16x16x32_bf16 v[196:199], v[64:67], v[36:39], v[196:199]
ds_read_b64_tr_b16 v[116:117], v15 offset:40960
v_mfma_f32_16x16x32_bf16 v[192:195], v[64:67], v[32:35], v[192:195]
ds_read_b64_tr_b16 v[118:119], v15 offset:45056
v_mfma_f32_16x16x32_bf16 v[160:163], v[56:59], v[32:35], v[160:163]
v_mfma_f32_16x16x32_bf16 v[164:167], v[56:59], v[36:39], v[164:167]
v_mfma_f32_16x16x32_bf16 v[168:171], v[56:59], v[40:43], v[168:171]
v_mfma_f32_16x16x32_bf16 v[172:175], v[56:59], v[44:47], v[172:175]
v_mfma_f32_16x16x32_bf16 v[220:223], v[68:71], v[44:47], v[220:223]
v_mfma_f32_16x16x32_bf16 v[216:219], v[68:71], v[40:43], v[216:219]
v_mfma_f32_16x16x32_bf16 v[212:215], v[68:71], v[36:39], v[212:215]
v_mfma_f32_16x16x32_bf16 v[208:211], v[68:71], v[32:35], v[208:211]
s_waitcnt lgkmcnt(0)
s_barrier
v_mfma_f32_16x16x32_bf16 v[128:131], v[96:99], v[80:83], v[128:131]
ds_read_b128 v[32:35], v2 offset:0
v_mfma_f32_16x16x32_bf16 v[132:135], v[96:99], v[84:87], v[132:135]
ds_read_b64_tr_b16 v[48:49], v5 offset:16384
v_mfma_f32_16x16x32_bf16 v[136:139], v[96:99], v[88:91], v[136:139]
ds_read_b64_tr_b16 v[50:51], v5 offset:20480
v_mfma_f32_16x16x32_bf16 v[140:143], v[96:99], v[92:95], v[140:143]
ds_read_b128 v[36:39], v2 offset:256
v_mfma_f32_16x16x32_bf16 v[188:191], v[108:111], v[92:95], v[188:191]
ds_read_b128 v[40:43], v2 offset:512
v_mfma_f32_16x16x32_bf16 v[184:187], v[108:111], v[88:91], v[184:187]
ds_read_b128 v[44:47], v2 offset:768
v_mfma_f32_16x16x32_bf16 v[180:183], v[108:111], v[84:87], v[180:183]
ds_read_b64_tr_b16 v[60:61], v5 offset:32768
v_mfma_f32_16x16x32_bf16 v[176:179], v[108:111], v[80:83], v[176:179]
ds_read_b64_tr_b16 v[62:63], v5 offset:36864
v_mfma_f32_16x16x32_bf16 v[144:147], v[100:103], v[80:83], v[144:147]
ds_read_b64_tr_b16 v[52:53], v6 offset:16384
v_mfma_f32_16x16x32_bf16 v[148:151], v[100:103], v[84:87], v[148:151]
ds_read_b64_tr_b16 v[54:55], v6 offset:20480
v_mfma_f32_16x16x32_bf16 v[152:155], v[100:103], v[88:91], v[152:155]
ds_read_b64_tr_b16 v[64:65], v6 offset:32768
v_mfma_f32_16x16x32_bf16 v[156:159], v[100:103], v[92:95], v[156:159]
ds_read_b64_tr_b16 v[66:67], v6 offset:36864
v_mfma_f32_16x16x32_bf16 v[204:207], v[112:115], v[92:95], v[204:207]
ds_read_b64_tr_b16 v[56:57], v7 offset:16384
v_mfma_f32_16x16x32_bf16 v[200:203], v[112:115], v[88:91], v[200:203]
ds_read_b64_tr_b16 v[58:59], v7 offset:20480
v_mfma_f32_16x16x32_bf16 v[196:199], v[112:115], v[84:87], v[196:199]
ds_read_b64_tr_b16 v[68:69], v7 offset:32768
v_mfma_f32_16x16x32_bf16 v[192:195], v[112:115], v[80:83], v[192:195]
ds_read_b64_tr_b16 v[70:71], v7 offset:36864
v_mfma_f32_16x16x32_bf16 v[160:163], v[104:107], v[80:83], v[160:163]
v_mfma_f32_16x16x32_bf16 v[164:167], v[104:107], v[84:87], v[164:167]
v_mfma_f32_16x16x32_bf16 v[168:171], v[104:107], v[88:91], v[168:171]
v_mfma_f32_16x16x32_bf16 v[172:175], v[104:107], v[92:95], v[172:175]
v_mfma_f32_16x16x32_bf16 v[220:223], v[116:119], v[92:95], v[220:223]
v_mfma_f32_16x16x32_bf16 v[216:219], v[116:119], v[88:91], v[216:219]
v_mfma_f32_16x16x32_bf16 v[212:215], v[116:119], v[84:87], v[212:215]
v_mfma_f32_16x16x32_bf16 v[208:211], v[116:119], v[80:83], v[208:211]
s_sub_u32 s41, s41, 1
s_cmp_lg_u32 s41, 0
s_cbranch_scc1 Lk3_102
s_waitcnt lgkmcnt(0)
v_mfma_f32_16x16x32_bf16 v[128:131], v[48:51], v[32:35], v[128:131]
ds_read_b128 v[80:83], v2 offset:8192
v_mfma_f32_16x16x32_bf16 v[132:135], v[48:51], v[36:39], v[132:135]
ds_read_b64_tr_b16 v[96:97], v5 offset:24576
v_mfma_f32_16x16x32_bf16 v[136:139], v[48:51], v[40:43], v[136:139]
ds_read_b64_tr_b16 v[98:99], v5 offset:28672
v_mfma_f32_16x16x32_bf16 v[140:143], v[48:51], v[44:47], v[140:143]
ds_read_b128 v[84:87], v2 offset:8448
v_mfma_f32_16x16x32_bf16 v[188:191], v[60:63], v[44:47], v[188:191]
ds_read_b128 v[88:91], v2 offset:8704
v_mfma_f32_16x16x32_bf16 v[184:187], v[60:63], v[40:43], v[184:187]
ds_read_b128 v[92:95], v2 offset:8960
v_mfma_f32_16x16x32_bf16 v[180:183], v[60:63], v[36:39], v[180:183]
ds_read_b64_tr_b16 v[108:109], v5 offset:40960
v_mfma_f32_16x16x32_bf16 v[176:179], v[60:63], v[32:35], v[176:179]
ds_read_b64_tr_b16 v[110:111], v5 offset:45056
v_mfma_f32_16x16x32_bf16 v[144:147], v[52:55], v[32:35], v[144:147]
ds_read_b64_tr_b16 v[100:101], v6 offset:24576
v_mfma_f32_16x16x32_bf16 v[148:151], v[52:55], v[36:39], v[148:151]
ds_read_b64_tr_b16 v[102:103], v6 offset:28672
v_mfma_f32_16x16x32_bf16 v[152:155], v[52:55], v[40:43], v[152:155]
ds_read_b64_tr_b16 v[112:113], v6 offset:40960
v_mfma_f32_16x16x32_bf16 v[156:159], v[52:55], v[44:47], v[156:159]
ds_read_b64_tr_b16 v[114:115], v6 offset:45056
v_mfma_f32_16x16x32_bf16 v[204:207], v[64:67], v[44:47], v[204:207]
ds_read_b64_tr_b16 v[104:105], v7 offset:24576
v_mfma_f32_16x16x32_bf16 v[200:203], v[64:67], v[40:43], v[200:203]
ds_read_b64_tr_b16 v[106:107], v7 offset:28672
v_mfma_f32_16x16x32_bf16 v[196:199], v[64:67], v[36:39], v[196:199]
ds_read_b64_tr_b16 v[116:117], v7 offset:40960
v_mfma_f32_16x16x32_bf16 v[192:195], v[64:67], v[32:35], v[192:195]
ds_read_b64_tr_b16 v[118:119], v7 offset:45056
v_mfma_f32_16x16x32_bf16 v[160:163], v[56:59], v[32:35], v[160:163]
v_mfma_f32_16x16x32_bf16 v[164:167], v[56:59], v[36:39], v[164:167]
v_mfma_f32_16x16x32_bf16 v[168:171], v[56:59], v[40:43], v[168:171]
v_mfma_f32_16x16x32_bf16 v[172:175], v[56:59], v[44:47], v[172:175]
v_mfma_f32_16x16x32_bf16 v[220:223], v[68:71], v[44:47], v[220:223]
v_mfma_f32_16x16x32_bf16 v[216:219], v[68:71], v[40:43], v[216:219]
v_mfma_f32_16x16x32_bf16 v[212:215], v[68:71], v[36:39], v[212:215]
v_mfma_f32_16x16x32_bf16 v[208:211], v[68:71], v[32:35], v[208:211]
s_waitcnt lgkmcnt(0)
s_barrier
s_cmp_eq_u32 s36, 7
s_cbranch_scc1 L7b_103
s_add_u32 m0, s39, 0
s_add_u32 s37, s37, s40
buffer_load_dwordx4 v21, s[8:11], s37 offen sc1 lds
v_mfma_f32_16x16x32_bf16 v[128:131], v[96:99], v[80:83], v[128:131]
v_mfma_f32_16x16x32_bf16 v[132:135], v[96:99], v[84:87], v[132:135]
s_add_u32 m0, s39, 1024
s_add_u32 s37, s37, s38
buffer_load_dwordx4 v21, s[8:11], s37 offen sc1 lds
v_mfma_f32_16x16x32_bf16 v[136:139], v[96:99], v[88:91], v[136:139]
s_add_u32 m0, s39, 2048
s_add_u32 s37, s37, s38
buffer_load_dwordx4 v21, s[8:11], s37 offen sc1 lds
v_mfma_f32_16x16x32_bf16 v[140:143], v[96:99], v[92:95], v[140:143]
v_mfma_f32_16x16x32_bf16 v[188:191], v[108:111], v[92:95], v[188:191]
s_add_u32 m0, s39, 3072
s_add_u32 s37, s37, s38
buffer_load_dwordx4 v21, s[8:11], s37 offen sc1 lds
v_mfma_f32_16x16x32_bf16 v[184:187], v[108:111], v[88:91], v[184:187]
s_add_u32 m0, s39, 4096
s_add_u32 s37, s37, s55
buffer_load_dwordx4 v21, s[8:11], s37 offen sc1 lds
v_mfma_f32_16x16x32_bf16 v[180:183], v[108:111], v[84:87], v[180:183]
v_mfma_f32_16x16x32_bf16 v[176:179], v[108:111], v[80:83], v[176:179]
s_add_u32 m0, s39, 5120
s_add_u32 s37, s37, s38
buffer_load_dwordx4 v21, s[8:11], s37 offen sc1 lds
v_mfma_f32_16x16x32_bf16 v[144:147], v[100:103], v[80:83], v[144:147]
s_add_u32 m0, s39, 6144
s_add_u32 s37, s37, s38
buffer_load_dwordx4 v21, s[8:11], s37 offen sc1 lds
v_mfma_f32_16x16x32_bf16 v[148:151], v[100:103], v[84:87], v[148:151]
v_mfma_f32_16x16x32_bf16 v[152:155], v[100:103], v[88:91], v[152:155]
s_add_u32 m0, s39, 7168
s_add_u32 s37, s37, s38
buffer_load_dwordx4 v21, s[8:11], s37 offen sc1 lds
v_mfma_f32_16x16x32_bf16 v[156:159], v[100:103], v[92:95], v[156:159]
s_add_u32 m0, s39, 32768
s_add_u32 s37, s37, s40
buffer_load_dwordx4 v21, s[8:11], s37 offen sc1 lds
v_mfma_f32_16x16x32_bf16 v[204:207], v[112:115], v[92:95], v[204:207]
v_mfma_f32_16x16x32_bf16 v[200:203], v[112:115], v[88:91], v[200:203]
s_add_u32 m0, s39, 33792
s_add_u32 s37, s37, s38
buffer_load_dwordx4 v21, s[8:11], s37 offen sc1 lds
v_mfma_f32_16x16x32_bf16 v[196:199], v[112:115], v[84:87], v[196:199]
s_add_u32 m0, s39, 34816
s_add_u32 s37, s37, s38
buffer_load_dwordx4 v21, s[8:11], s37 offen sc1 lds
v_mfma_f32_16x16x32_bf16 v[192:195], v[112:115], v[80:83], v[192:195]
v_mfma_f32_16x16x32_bf16 v[160:163], v[104:107], v[80:83], v[160:163]
s_add_u32 m0, s39, 35840
s_add_u32 s37, s37, s38
buffer_load_dwordx4 v21, s[8:11], s37 offen sc1 lds
v_mfma_f32_16x16x32_bf16 v[164:167], v[104:107], v[84:87], v[164:167]
s_add_u32 m0, s39, 36864
s_add_u32 s37, s37, s55
buffer_load_dwordx4 v21, s[8:11], s37 offen sc1 lds
v_mfma_f32_16x16x32_bf16 v[168:171], v[104:107], v[88:91], v[168:171]
v_mfma_f32_16x16x32_bf16 v[172:175], v[104:107], v[92:95], v[172:175]
s_add_u32 m0, s39, 37888
s_add_u32 s37, s37, s38
buffer_load_dwordx4 v21, s[8:11], s37 offen sc1 lds
v_mfma_f32_16x16x32_bf16 v[220:223], v[116:119], v[92:95], v[220:223]
s_add_u32 m0, s39, 38912
s_add_u32 s37, s37, s38
buffer_load_dwordx4 v21, s[8:11], s37 offen sc1 lds
v_mfma_f32_16x16x32_bf16 v[216:219], v[116:119], v[88:91], v[216:219]
v_mfma_f32_16x16x32_bf16 v[212:215], v[116:119], v[84:87], v[212:215]
s_add_u32 m0, s39, 39936
s_add_u32 s37, s37, s38
buffer_load_dwordx4 v21, s[8:11], s37 offen sc1 lds
v_mfma_f32_16x16x32_bf16 v[208:211], v[116:119], v[80:83], v[208:211]
s_setprio 0
s_barrier
s_add_u32 s37, s37, s54
s_add_u32 m0, s39, 65536
s_add_u32 s37, s37, s40
buffer_load_dwordx4 v21, s[8:11], s37 offen sc1 lds
v_mul_f32 v80, v128, v128
v_mul_f32 v81, v129, v129
v_mul_f32 v82, v130, v130
v_mul_f32 v83, v131, v131
v_fma_f32 v80, v80, v232, v228
v_fma_f32 v81, v81, v232, v228
v_fma_f32 v82, v82, v232, v228
s_add_u32 m0, s39, 66560
s_add_u32 s37, s37, s38
buffer_load_dwordx4 v21, s[8:11], s37 offen sc1 lds
v_fma_f32 v83, v83, v232, v228
v_mul_f32 v80, v80, v128
v_mul_f32 v81, v81, v129
v_mul_f32 v82, v82, v130
v_mul_f32 v83, v83, v131
v_exp_f32 v80, v80
s_add_u32 m0, s39, 67584
s_add_u32 s37, s37, s38
buffer_load_dwordx4 v21, s[8:11], s37 offen sc1 lds
v_exp_f32 v81, v81
v_exp_f32 v82, v82
v_exp_f32 v83, v83
v_mul_f32 v176, v128, v176
v_mul_f32 v177, v129, v177
v_mul_f32 v178, v130, v178
v_mul_f32 v179, v131, v179
s_add_u32 m0, s39, 68608
s_add_u32 s37, s37, s38
buffer_load_dwordx4 v21, s[8:11], s37 offen sc1 lds
v_fma_f32 v80, v80, v236, v236
v_fma_f32 v81, v81, v236, v236
v_fma_f32 v82, v82, v236, v236
v_fma_f32 v83, v83, v236, v236
v_rcp_f32 v80, v80
v_rcp_f32 v81, v81
s_add_u32 m0, s39, 69632
s_add_u32 s37, s37, s55
buffer_load_dwordx4 v21, s[8:11], s37 offen sc1 lds
v_rcp_f32 v82, v82
v_rcp_f32 v83, v83
v_mul_f32 v176, v176, v80
v_mul_f32 v177, v177, v81
v_mul_f32 v178, v178, v82
v_mul_f32 v179, v179, v83
v_cvt_pk_bf16_f32 v96, v176, v177
s_add_u32 m0, s39, 70656
s_add_u32 s37, s37, s38
buffer_load_dwordx4 v21, s[8:11], s37 offen sc1 lds
v_cvt_pk_bf16_f32 v97, v178, v179
v_mul_f32 v84, v144, v144
v_mul_f32 v85, v145, v145
v_mul_f32 v86, v146, v146
v_mul_f32 v87, v147, v147
v_fma_f32 v84, v84, v232, v228
s_add_u32 m0, s39, 71680
s_add_u32 s37, s37, s38
buffer_load_dwordx4 v21, s[8:11], s37 offen sc1 lds
v_fma_f32 v85, v85, v232, v228
v_fma_f32 v86, v86, v232, v228
v_fma_f32 v87, v87, v232, v228
v_mul_f32 v84, v84, v144
v_mul_f32 v85, v85, v145
v_mul_f32 v86, v86, v146
v_mul_f32 v87, v87, v147
s_add_u32 m0, s39, 72704
s_add_u32 s37, s37, s38
buffer_load_dwordx4 v21, s[8:11], s37 offen sc1 lds
v_exp_f32 v84, v84
v_exp_f32 v85, v85
v_exp_f32 v86, v86
v_exp_f32 v87, v87
v_mul_f32 v192, v144, v192
v_mul_f32 v193, v145, v193
s_waitcnt vmcnt(16)
s_barrier
s_add_u32 m0, s39, 98304
s_add_u32 s37, s37, s40
buffer_load_dwordx4 v21, s[8:11], s37 offen sc1 lds
v_mul_f32 v194, v146, v194
v_mul_f32 v195, v147, v195
v_fma_f32 v84, v84, v236, v236
v_fma_f32 v85, v85, v236, v236
v_fma_f32 v86, v86, v236, v236
v_fma_f32 v87, v87, v236, v236
v_rcp_f32 v84, v84
s_add_u32 m0, s39, 99328
s_add_u32 s37, s37, s38
buffer_load_dwordx4 v21, s[8:11], s37 offen sc1 lds
v_rcp_f32 v85, v85
v_rcp_f32 v86, v86
v_rcp_f32 v87, v87
v_mul_f32 v192, v192, v84
v_mul_f32 v193, v193, v85
v_mul_f32 v194, v194, v86
v_mul_f32 v195, v195, v87
s_add_u32 m0, s39, 100352
s_add_u32 s37, s37, s38
buffer_load_dwordx4 v21, s[8:11], s37 offen sc1 lds
v_cvt_pk_bf16_f32 v98, v192, v193
v_cvt_pk_bf16_f32 v99, v194, v195
v_mul_f32 v80, v160, v160
v_mul_f32 v81, v161, v161
v_mul_f32 v82, v162, v162
s_add_u32 m0, s39, 101376
s_add_u32 s37, s37, s38
buffer_load_dwordx4 v21, s[8:11], s37 offen sc1 lds
v_mul_f32 v83, v163, v163
v_fma_f32 v80, v80, v232, v228
v_fma_f32 v81, v81, v232, v228
v_fma_f32 v82, v82, v232, v228
v_fma_f32 v83, v83, v232, v228
v_mul_f32 v80, v80, v160
v_mul_f32 v81, v81, v161
s_add_u32 m0, s39, 102400
s_add_u32 s37, s37, s55
buffer_load_dwordx4 v21, s[8:11], s37 offen sc1 lds
v_mul_f32 v82, v82, v162
v_mul_f32 v83, v83, v163
v_exp_f32 v80, v80
v_exp_f32 v81, v81
v_exp_f32 v82, v82
v_exp_f32 v83, v83
v_mul_f32 v208, v160, v208
s_add_u32 m0, s39, 103424
s_add_u32 s37, s37, s38
buffer_load_dwordx4 v21, s[8:11], s37 offen sc1 lds
v_mul_f32 v209, v161, v209
v_mul_f32 v210, v162, v210
v_mul_f32 v211, v163, v211
v_fma_f32 v80, v80, v236, v236
v_fma_f32 v81, v81, v236, v236
v_fma_f32 v82, v82, v236, v236
s_add_u32 m0, s39, 104448
s_add_u32 s37, s37, s38
buffer_load_dwordx4 v21, s[8:11], s37 offen sc1 lds
v_fma_f32 v83, v83, v236, v236
v_rcp_f32 v80, v80
v_rcp_f32 v81, v81
v_rcp_f32 v82, v82
v_rcp_f32 v83, v83
v_mul_f32 v208, v208, v80
v_mul_f32 v209, v209, v81
s_add_u32 m0, s39, 105472
s_add_u32 s37, s37, s38
buffer_load_dwordx4 v21, s[8:11], s37 offen sc1 lds
v_mul_f32 v210, v210, v82
v_mul_f32 v211, v211, v83
v_cvt_pk_bf16_f32 v112, v208, v209
v_cvt_pk_bf16_f32 v113, v210, v211
v_mul_f32 v80, v132, v132
v_mul_f32 v81, v133, v133
buffer_store_dwordx4 v[96:99], v27, s[24:27], 0 offen offset:0 sc1
s_waitcnt vmcnt(17)
s_barrier
s_add_u32 m0, s39, 0
s_add_u32 s37, s37, s40
buffer_load_dwordx4 v21, s[8:11], s37 offen sc1 lds
v_mul_f32 v82, v134, v134
v_mul_f32 v83, v135, v135
v_fma_f32 v80, v80, v233, v229
v_fma_f32 v81, v81, v233, v229
v_fma_f32 v82, v82, v233, v229
v_fma_f32 v83, v83, v233, v229
v_mul_f32 v80, v80, v132
s_add_u32 m0, s39, 1024
s_add_u32 s37, s37, s38
buffer_load_dwordx4 v21, s[8:11], s37 offen sc1 lds
v_mul_f32 v81, v81, v133
v_mul_f32 v82, v82, v134
v_mul_f32 v83, v83, v135
v_exp_f32 v80, v80
v_exp_f32 v81, v81
v_exp_f32 v82, v82
s_add_u32 m0, s39, 2048
s_add_u32 s37, s37, s38
buffer_load_dwordx4 v21, s[8:11], s37 offen sc1 lds
v_exp_f32 v83, v83
v_mul_f32 v180, v132, v180
v_mul_f32 v181, v133, v181
v_mul_f32 v182, v134, v182
v_mul_f32 v183, v135, v183
v_fma_f32 v80, v80, v237, v237
v_fma_f32 v81, v81, v237, v237
s_add_u32 m0, s39, 3072
s_add_u32 s37, s37, s38
buffer_load_dwordx4 v21, s[8:11], s37 offen sc1 lds
v_fma_f32 v82, v82, v237, v237
v_fma_f32 v83, v83, v237, v237
v_rcp_f32 v80, v80
v_rcp_f32 v81, v81
v_rcp_f32 v82, v82
v_rcp_f32 v83, v83
s_add_u32 m0, s39, 4096
s_add_u32 s37, s37, s55
buffer_load_dwordx4 v21, s[8:11], s37 offen sc1 lds
v_mul_f32 v180, v180, v80
v_mul_f32 v181, v181, v81
v_mul_f32 v182, v182, v82
v_mul_f32 v183, v183, v83
v_cvt_pk_bf16_f32 v100, v180, v181
v_cvt_pk_bf16_f32 v101, v182, v183
v_mul_f32 v84, v148, v148
s_add_u32 m0, s39, 5120
s_add_u32 s37, s37, s38
buffer_load_dwordx4 v21, s[8:11], s37 offen sc1 lds
v_mul_f32 v85, v149, v149
v_mul_f32 v86, v150, v150
v_mul_f32 v87, v151, v151
v_fma_f32 v84, v84, v233, v229
v_fma_f32 v85, v85, v233, v229
v_fma_f32 v86, v86, v233, v229
s_add_u32 m0, s39, 6144
s_add_u32 s37, s37, s38
buffer_load_dwordx4 v21, s[8:11], s37 offen sc1 lds
v_fma_f32 v87, v87, v233, v229
v_mul_f32 v84, v84, v148
v_mul_f32 v85, v85, v149
v_mul_f32 v86, v86, v150
v_mul_f32 v87, v87, v151
v_exp_f32 v84, v84
v_exp_f32 v85, v85
s_add_u32 m0, s39, 7168
s_add_u32 s37, s37, s38
buffer_load_dwordx4 v21, s[8:11], s37 offen sc1 lds
v_exp_f32 v86, v86
v_exp_f32 v87, v87
v_mul_f32 v196, v148, v196
v_mul_f32 v197, v149, v197
v_mul_f32 v198, v150, v198
v_mul_f32 v199, v151, v199
s_waitcnt vmcnt(17)
s_barrier
s_add_u32 m0, s39, 32768
s_add_u32 s37, s37, s40
buffer_load_dwordx4 v21, s[8:11], s37 offen sc1 lds
v_fma_f32 v84, v84, v237, v237
v_fma_f32 v85, v85, v237, v237
v_fma_f32 v86, v86, v237, v237
v_fma_f32 v87, v87, v237, v237
v_rcp_f32 v84, v84
v_rcp_f32 v85, v85
v_rcp_f32 v86, v86
s_add_u32 m0, s39, 33792
s_add_u32 s37, s37, s38
buffer_load_dwordx4 v21, s[8:11], s37 offen sc1 lds
v_rcp_f32 v87, v87
v_mul_f32 v196, v196, v84
v_mul_f32 v197, v197, v85
v_mul_f32 v198, v198, v86
v_mul_f32 v199, v199, v87
v_cvt_pk_bf16_f32 v102, v196, v197
v_cvt_pk_bf16_f32 v103, v198, v199
s_add_u32 m0, s39, 34816
s_add_u32 s37, s37, s38
buffer_load_dwordx4 v21, s[8:11], s37 offen sc1 lds
v_mul_f32 v80, v164, v164
v_mul_f32 v81, v165, v165
v_mul_f32 v82, v166, v166
v_mul_f32 v83, v167, v167
v_fma_f32 v80, v80, v233, v229
s_add_u32 m0, s39, 35840
s_add_u32 s37, s37, s38
buffer_load_dwordx4 v21, s[8:11], s37 offen sc1 lds
v_fma_f32 v81, v81, v233, v229
v_fma_f32 v82, v82, v233, v229
v_fma_f32 v83, v83, v233, v229
v_mul_f32 v80, v80, v164
v_mul_f32 v81, v81, v165
v_mul_f32 v82, v82, v166
v_mul_f32 v83, v83, v167
s_add_u32 m0, s39, 36864
s_add_u32 s37, s37, s55
buffer_load_dwordx4 v21, s[8:11], s37 offen sc1 lds
v_exp_f32 v80, v80
v_exp_f32 v81, v81
v_exp_f32 v82, v82
v_exp_f32 v83, v83
v_mul_f32 v212, v164, v212
v_mul_f32 v213, v165, v213
v_mul_f32 v214, v166, v214
s_add_u32 m0, s39, 37888
s_add_u32 s37, s37, s38
buffer_load_dwordx4 v21, s[8:11], s37 offen sc1 lds
v_mul_f32 v215, v167, v215
v_fma_f32 v80, v80, v237, v237
v_fma_f32 v81, v81, v237, v237
v_fma_f32 v82, v82, v237, v237
v_fma_f32 v83, v83, v237, v237
v_rcp_f32 v80, v80
s_add_u32 m0, s39, 38912
s_add_u32 s37, s37, s38
buffer_load_dwordx4 v21, s[8:11], s37 offen sc1 lds
v_rcp_f32 v81, v81
v_rcp_f32 v82, v82
v_rcp_f32 v83, v83
v_mul_f32 v212, v212, v80
v_mul_f32 v213, v213, v81
v_mul_f32 v214, v214, v82
v_mul_f32 v215, v215, v83
s_add_u32 m0, s39, 39936
s_add_u32 s37, s37, s38
buffer_load_dwordx4 v21, s[8:11], s37 offen sc1 lds
v_cvt_pk_bf16_f32 v114, v212, v213
v_cvt_pk_bf16_f32 v115, v214, v215
s_nop 1
v_permlane32_swap_b32 v112, v114
v_permlane32_swap_b32 v113, v115
buffer_store_dwordx4 v[100:103], v27, s[24:27], 0 offen offset:256 sc1
buffer_store_dwordx4 v[112:115], v28, s[24:27], 0 offen offset:0 sc1
s_waitcnt vmcnt(19)
s_barrier
s_add_u32 m0, s39, 65536
s_add_u32 s37, s37, s40
buffer_load_dwordx4 v21, s[8:11], s37 offen sc1 lds
v_mul_f32 v80, v136, v136
v_mul_f32 v81, v137, v137
v_mul_f32 v82, v138, v138
v_mul_f32 v83, v139, v139
v_fma_f32 v80, v80, v234, v230
v_fma_f32 v81, v81, v234, v230
v_fma_f32 v82, v82, v234, v230
s_add_u32 m0, s39, 66560
s_add_u32 s37, s37, s38
buffer_load_dwordx4 v21, s[8:11], s37 offen sc1 lds
v_fma_f32 v83, v83, v234, v230
v_mul_f32 v80, v80, v136
v_mul_f32 v81, v81, v137
v_mul_f32 v82, v82, v138
v_mul_f32 v83, v83, v139
v_exp_f32 v80, v80
s_add_u32 m0, s39, 67584
s_add_u32 s37, s37, s38
buffer_load_dwordx4 v21, s[8:11], s37 offen sc1 lds
v_exp_f32 v81, v81
v_exp_f32 v82, v82
v_exp_f32 v83, v83
v_mul_f32 v184, v136, v184
v_mul_f32 v185, v137, v185
v_mul_f32 v186, v138, v186
v_mul_f32 v187, v139, v187
s_add_u32 m0, s39, 68608
s_add_u32 s37, s37, s38
buffer_load_dwordx4 v21, s[8:11], s37 offen sc1 lds
v_fma_f32 v80, v80, v238, v238
v_fma_f32 v81, v81, v238, v238
v_fma_f32 v82, v82, v238, v238
v_fma_f32 v83, v83, v238, v238
v_rcp_f32 v80, v80
v_rcp_f32 v81, v81
s_add_u32 m0, s39, 69632
s_add_u32 s37, s37, s55
buffer_load_dwordx4 v21, s[8:11], s37 offen sc1 lds
v_rcp_f32 v82, v82
v_rcp_f32 v83, v83
v_mul_f32 v184, v184, v80
v_mul_f32 v185, v185, v81
v_mul_f32 v186, v186, v82
v_mul_f32 v187, v187, v83
v_cvt_pk_bf16_f32 v104, v184, v185
s_add_u32 m0, s39, 70656
s_add_u32 s37, s37, s38
buffer_load_dwordx4 v21, s[8:11], s37 offen sc1 lds
v_cvt_pk_bf16_f32 v105, v186, v187
v_mul_f32 v84, v152, v152
v_mul_f32 v85, v153, v153
v_mul_f32 v86, v154, v154
v_mul_f32 v87, v155, v155
v_fma_f32 v84, v84, v234, v230
s_add_u32 m0, s39, 71680
s_add_u32 s37, s37, s38
buffer_load_dwordx4 v21, s[8:11], s37 offen sc1 lds
v_fma_f32 v85, v85, v234, v230
v_fma_f32 v86, v86, v234, v230
v_fma_f32 v87, v87, v234, v230
v_mul_f32 v84, v84, v152
v_mul_f32 v85, v85, v153
v_mul_f32 v86, v86, v154
v_mul_f32 v87, v87, v155
s_add_u32 m0, s39, 72704
s_add_u32 s37, s37, s38
buffer_load_dwordx4 v21, s[8:11], s37 offen sc1 lds
v_exp_f32 v84, v84
v_exp_f32 v85, v85
v_exp_f32 v86, v86
v_exp_f32 v87, v87
v_mul_f32 v200, v152, v200
v_mul_f32 v201, v153, v201
s_waitcnt vmcnt(18)
s_barrier
s_add_u32 m0, s39, 98304
s_add_u32 s37, s37, s40
buffer_load_dwordx4 v21, s[8:11], s37 offen sc1 lds
v_mul_f32 v202, v154, v202
v_mul_f32 v203, v155, v203
v_fma_f32 v84, v84, v238, v238
v_fma_f32 v85, v85, v238, v238
v_fma_f32 v86, v86, v238, v238
v_fma_f32 v87, v87, v238, v238
v_rcp_f32 v84, v84
s_add_u32 m0, s39, 99328
s_add_u32 s37, s37, s38
buffer_load_dwordx4 v21, s[8:11], s37 offen sc1 lds
v_rcp_f32 v85, v85
v_rcp_f32 v86, v86
v_rcp_f32 v87, v87
v_mul_f32 v200, v200, v84
v_mul_f32 v201, v201, v85
v_mul_f32 v202, v202, v86
v_mul_f32 v203, v203, v87
s_add_u32 m0, s39, 100352
s_add_u32 s37, s37, s38
buffer_load_dwordx4 v21, s[8:11], s37 offen sc1 lds
v_cvt_pk_bf16_f32 v106, v200, v201
v_cvt_pk_bf16_f32 v107, v202, v203
v_mul_f32 v80, v168, v168
v_mul_f32 v81, v169, v169
v_mul_f32 v82, v170, v170
s_add_u32 m0, s39, 101376
s_add_u32 s37, s37, s38
buffer_load_dwordx4 v21, s[8:11], s37 offen sc1 lds
v_mul_f32 v83, v171, v171
v_fma_f32 v80, v80, v234, v230
v_fma_f32 v81, v81, v234, v230
v_fma_f32 v82, v82, v234, v230
v_fma_f32 v83, v83, v234, v230
v_mul_f32 v80, v80, v168
v_mul_f32 v81, v81, v169
s_add_u32 m0, s39, 102400
s_add_u32 s37, s37, s55
buffer_load_dwordx4 v21, s[8:11], s37 offen sc1 lds
v_mul_f32 v82, v82, v170
v_mul_f32 v83, v83, v171
v_exp_f32 v80, v80
v_exp_f32 v81, v81
v_exp_f32 v82, v82
v_exp_f32 v83, v83
v_mul_f32 v216, v168, v216
s_add_u32 m0, s39, 103424
s_add_u32 s37, s37, s38
buffer_load_dwordx4 v21, s[8:11], s37 offen sc1 lds
v_mul_f32 v217, v169, v217
v_mul_f32 v218, v170, v218
v_mul_f32 v219, v171, v219
v_fma_f32 v80, v80, v238, v238
v_fma_f32 v81, v81, v238, v238
v_fma_f32 v82, v82, v238, v238
s_add_u32 m0, s39, 104448
s_add_u32 s37, s37, s38
buffer_load_dwordx4 v21, s[8:11], s37 offen sc1 lds
v_fma_f32 v83, v83, v238, v238
v_rcp_f32 v80, v80
v_rcp_f32 v81, v81
v_rcp_f32 v82, v82
v_rcp_f32 v83, v83
v_mul_f32 v216, v216, v80
v_mul_f32 v217, v217, v81
s_add_u32 m0, s39, 105472
s_add_u32 s37, s37, s38
buffer_load_dwordx4 v21, s[8:11], s37 offen sc1 lds
v_mul_f32 v218, v218, v82
v_mul_f32 v219, v219, v83
v_cvt_pk_bf16_f32 v116, v216, v217
v_cvt_pk_bf16_f32 v117, v218, v219
v_mul_f32 v80, v140, v140
v_mul_f32 v81, v141, v141
buffer_store_dwordx4 v[104:107], v27, s[24:27], 0 offen offset:512 sc1
s_waitcnt vmcnt(19)
s_barrier
s_add_u32 s37, s37, s29
s_add_u32 m0, s39, 0
s_add_u32 s37, s37, s40
buffer_load_dwordx4 v21, s[8:11], s37 offen sc1 lds
v_mul_f32 v82, v142, v142
v_mul_f32 v83, v143, v143
v_fma_f32 v80, v80, v235, v231
v_fma_f32 v81, v81, v235, v231
v_fma_f32 v82, v82, v235, v231
v_fma_f32 v83, v83, v235, v231
v_mul_f32 v80, v80, v140
s_add_u32 m0, s39, 1024
s_add_u32 s37, s37, s38
buffer_load_dwordx4 v21, s[8:11], s37 offen sc1 lds
v_mul_f32 v81, v81, v141
v_mul_f32 v82, v82, v142
v_mul_f32 v83, v83, v143
v_exp_f32 v80, v80
v_exp_f32 v81, v81
v_exp_f32 v82, v82
s_add_u32 m0, s39, 2048
s_add_u32 s37, s37, s38
buffer_load_dwordx4 v21, s[8:11], s37 offen sc1 lds
v_exp_f32 v83, v83
v_mul_f32 v188, v140, v188
v_mul_f32 v189, v141, v189
v_mul_f32 v190, v142, v190
v_mul_f32 v191, v143, v191
v_fma_f32 v80, v80, v239, v239
v_fma_f32 v81, v81, v239, v239
s_add_u32 m0, s39, 3072
s_add_u32 s37, s37, s38
buffer_load_dwordx4 v21, s[8:11], s37 offen sc1 lds
v_fma_f32 v82, v82, v239, v239
v_fma_f32 v83, v83, v239, v239
v_rcp_f32 v80, v80
v_rcp_f32 v81, v81
v_rcp_f32 v82, v82
v_rcp_f32 v83, v83
s_add_u32 m0, s39, 4096
s_add_u32 s37, s37, s55
buffer_load_dwordx4 v21, s[8:11], s37 offen sc1 lds
v_mul_f32 v188, v188, v80
v_mul_f32 v189, v189, v81
v_mul_f32 v190, v190, v82
v_mul_f32 v191, v191, v83
v_cvt_pk_bf16_f32 v108, v188, v189
v_cvt_pk_bf16_f32 v109, v190, v191
v_mul_f32 v84, v156, v156
s_add_u32 m0, s39, 5120
s_add_u32 s37, s37, s38
buffer_load_dwordx4 v21, s[8:11], s37 offen sc1 lds
v_mul_f32 v85, v157, v157
v_mul_f32 v86, v158, v158
v_mul_f32 v87, v159, v159
v_fma_f32 v84, v84, v235, v231
v_fma_f32 v85, v85, v235, v231
v_fma_f32 v86, v86, v235, v231
s_add_u32 m0, s39, 6144
s_add_u32 s37, s37, s38
buffer_load_dwordx4 v21, s[8:11], s37 offen sc1 lds
v_fma_f32 v87, v87, v235, v231
v_mul_f32 v84, v84, v156
v_mul_f32 v85, v85, v157
v_mul_f32 v86, v86, v158
v_mul_f32 v87, v87, v159
v_exp_f32 v84, v84
v_exp_f32 v85, v85
s_add_u32 m0, s39, 7168
s_add_u32 s37, s37, s38
buffer_load_dwordx4 v21, s[8:11], s37 offen sc1 lds
v_exp_f32 v86, v86
v_exp_f32 v87, v87
v_mul_f32 v204, v156, v204
v_mul_f32 v205, v157, v205
v_mul_f32 v206, v158, v206
v_mul_f32 v207, v159, v207
s_waitcnt vmcnt(17)
s_barrier
s_add_u32 m0, s39, 32768
s_add_u32 s37, s37, s40
buffer_load_dwordx4 v21, s[8:11], s37 offen sc1 lds
v_fma_f32 v84, v84, v239, v239
v_fma_f32 v85, v85, v239, v239
v_fma_f32 v86, v86, v239, v239
v_fma_f32 v87, v87, v239, v239
v_rcp_f32 v84, v84
v_rcp_f32 v85, v85
v_rcp_f32 v86, v86
s_add_u32 m0, s39, 33792
s_add_u32 s37, s37, s38
buffer_load_dwordx4 v21, s[8:11], s37 offen sc1 lds
v_rcp_f32 v87, v87
v_mul_f32 v204, v204, v84
v_mul_f32 v205, v205, v85
v_mul_f32 v206, v206, v86
v_mul_f32 v207, v207, v87
v_cvt_pk_bf16_f32 v110, v204, v205
v_cvt_pk_bf16_f32 v111, v206, v207
s_add_u32 m0, s39, 34816
s_add_u32 s37, s37, s38
buffer_load_dwordx4 v21, s[8:11], s37 offen sc1 lds
v_mul_f32 v80, v172, v172
v_mul_f32 v81, v173, v173
v_mul_f32 v82, v174, v174
v_mul_f32 v83, v175, v175
v_fma_f32 v80, v80, v235, v231
s_add_u32 m0, s39, 35840
s_add_u32 s37, s37, s38
buffer_load_dwordx4 v21, s[8:11], s37 offen sc1 lds
v_fma_f32 v81, v81, v235, v231
v_fma_f32 v82, v82, v235, v231
v_fma_f32 v83, v83, v235, v231
v_mul_f32 v80, v80, v172
v_mul_f32 v81, v81, v173
v_mul_f32 v82, v82, v174
v_mul_f32 v83, v83, v175
s_add_u32 m0, s39, 36864
s_add_u32 s37, s37, s55
buffer_load_dwordx4 v21, s[8:11], s37 offen sc1 lds
v_exp_f32 v80, v80
v_exp_f32 v81, v81
v_exp_f32 v82, v82
v_exp_f32 v83, v83
v_mul_f32 v220, v172, v220
v_mul_f32 v221, v173, v221
v_mul_f32 v222, v174, v222
s_add_u32 m0, s39, 37888
s_add_u32 s37, s37, s38
buffer_load_dwordx4 v21, s[8:11], s37 offen sc1 lds
v_mul_f32 v223, v175, v223
v_fma_f32 v80, v80, v239, v239
v_fma_f32 v81, v81, v239, v239
v_fma_f32 v82, v82, v239, v239
v_fma_f32 v83, v83, v239, v239
v_rcp_f32 v80, v80
s_add_u32 m0, s39, 38912
s_add_u32 s37, s37, s38
buffer_load_dwordx4 v21, s[8:11], s37 offen sc1 lds
v_rcp_f32 v81, v81
v_rcp_f32 v82, v82
v_rcp_f32 v83, v83
v_mul_f32 v220, v220, v80
v_mul_f32 v221, v221, v81
v_mul_f32 v222, v222, v82
v_mul_f32 v223, v223, v83
s_add_u32 m0, s39, 39936
s_add_u32 s37, s37, s38
buffer_load_dwordx4 v21, s[8:11], s37 offen sc1 lds
v_cvt_pk_bf16_f32 v118, v220, v221
v_cvt_pk_bf16_f32 v119, v222, v223
s_nop 1
v_permlane32_swap_b32 v116, v118
v_permlane32_swap_b32 v117, v119
buffer_store_dwordx4 v[108:111], v27, s[24:27], 0 offen offset:768 sc1
buffer_store_dwordx4 v[116:119], v28, s[24:27], 0 offen offset:512 sc1
s_waitcnt vmcnt(19)
s_barrier
s_add_u32 m0, s39, 65536
s_add_u32 s37, s37, s40
buffer_load_dwordx4 v21, s[8:11], s37 offen sc1 lds
s_add_u32 m0, s39, 66560
s_add_u32 s37, s37, s38
buffer_load_dwordx4 v21, s[8:11], s37 offen sc1 lds
s_add_u32 m0, s39, 67584
s_add_u32 s37, s37, s38
buffer_load_dwordx4 v21, s[8:11], s37 offen sc1 lds
s_add_u32 m0, s39, 68608
s_add_u32 s37, s37, s38
buffer_load_dwordx4 v21, s[8:11], s37 offen sc1 lds
s_add_u32 m0, s39, 69632
s_add_u32 s37, s37, s55
buffer_load_dwordx4 v21, s[8:11], s37 offen sc1 lds
s_add_u32 m0, s39, 70656
s_add_u32 s37, s37, s38
buffer_load_dwordx4 v21, s[8:11], s37 offen sc1 lds
s_add_u32 m0, s39, 71680
s_add_u32 s37, s37, s38
buffer_load_dwordx4 v21, s[8:11], s37 offen sc1 lds
s_add_u32 m0, s39, 72704
s_add_u32 s37, s37, s38
buffer_load_dwordx4 v21, s[8:11], s37 offen sc1 lds
s_waitcnt vmcnt(8)
s_barrier
s_add_u32 m0, s39, 98304
s_add_u32 s37, s37, s40
buffer_load_dwordx4 v21, s[8:11], s37 offen sc1 lds
s_add_u32 m0, s39, 99328
s_add_u32 s37, s37, s38
buffer_load_dwordx4 v21, s[8:11], s37 offen sc1 lds
s_add_u32 m0, s39, 100352
s_add_u32 s37, s37, s38
buffer_load_dwordx4 v21, s[8:11], s37 offen sc1 lds
s_add_u32 m0, s39, 101376
s_add_u32 s37, s37, s38
buffer_load_dwordx4 v21, s[8:11], s37 offen sc1 lds
s_add_u32 m0, s39, 102400
s_add_u32 s37, s37, s55
buffer_load_dwordx4 v21, s[8:11], s37 offen sc1 lds
s_add_u32 m0, s39, 103424
s_add_u32 s37, s37, s38
buffer_load_dwordx4 v21, s[8:11], s37 offen sc1 lds
s_add_u32 m0, s39, 104448
s_add_u32 s37, s37, s38
buffer_load_dwordx4 v21, s[8:11], s37 offen sc1 lds
s_add_u32 m0, s39, 105472
s_add_u32 s37, s37, s38
buffer_load_dwordx4 v21, s[8:11], s37 offen sc1 lds
s_waitcnt vmcnt(18)
s_barrier
s_add_u32 m0, s39, 0
s_add_u32 s37, s37, s40
buffer_load_dwordx4 v21, s[8:11], s37 offen sc1 lds
s_add_u32 m0, s39, 1024
s_add_u32 s37, s37, s38
buffer_load_dwordx4 v21, s[8:11], s37 offen sc1 lds
s_add_u32 m0, s39, 2048
s_add_u32 s37, s37, s38
buffer_load_dwordx4 v21, s[8:11], s37 offen sc1 lds
s_add_u32 m0, s39, 3072
s_add_u32 s37, s37, s38
buffer_load_dwordx4 v21, s[8:11], s37 offen sc1 lds
s_add_u32 m0, s39, 4096
s_add_u32 s37, s37, s55
buffer_load_dwordx4 v21, s[8:11], s37 offen sc1 lds
s_add_u32 m0, s39, 5120
s_add_u32 s37, s37, s38
buffer_load_dwordx4 v21, s[8:11], s37 offen sc1 lds
s_add_u32 m0, s39, 6144
s_add_u32 s37, s37, s38
buffer_load_dwordx4 v21, s[8:11], s37 offen sc1 lds
s_add_u32 m0, s39, 7168
s_add_u32 s37, s37, s38
buffer_load_dwordx4 v21, s[8:11], s37 offen sc1 lds
s_waitcnt vmcnt(16)
s_barrier
s_add_u32 m0, s39, 32768
s_add_u32 s37, s37, s40
buffer_load_dwordx4 v21, s[8:11], s37 offen sc1 lds
s_add_u32 m0, s39, 33792
s_add_u32 s37, s37, s38
buffer_load_dwordx4 v21, s[8:11], s37 offen sc1 lds
s_add_u32 m0, s39, 34816
s_add_u32 s37, s37, s38
buffer_load_dwordx4 v21, s[8:11], s37 offen sc1 lds
s_add_u32 m0, s39, 35840
s_add_u32 s37, s37, s38
buffer_load_dwordx4 v21, s[8:11], s37 offen sc1 lds
s_add_u32 m0, s39, 36864
s_add_u32 s37, s37, s55
buffer_load_dwordx4 v21, s[8:11], s37 offen sc1 lds
s_add_u32 m0, s39, 37888
s_add_u32 s37, s37, s38
buffer_load_dwordx4 v21, s[8:11], s37 offen sc1 lds
s_add_u32 m0, s39, 38912
s_add_u32 s37, s37, s38
buffer_load_dwordx4 v21, s[8:11], s37 offen sc1 lds
s_add_u32 m0, s39, 39936
s_add_u32 s37, s37, s38
buffer_load_dwordx4 v21, s[8:11], s37 offen sc1 lds
s_waitcnt vmcnt(16)
s_barrier
s_add_u32 m0, s39, 65536
s_add_u32 s37, s37, s40
buffer_load_dwordx4 v21, s[8:11], s37 offen sc1 lds
s_add_u32 m0, s39, 66560
s_add_u32 s37, s37, s38
buffer_load_dwordx4 v21, s[8:11], s37 offen sc1 lds
s_add_u32 m0, s39, 67584
s_add_u32 s37, s37, s38
buffer_load_dwordx4 v21, s[8:11], s37 offen sc1 lds
s_add_u32 m0, s39, 68608
s_add_u32 s37, s37, s38
buffer_load_dwordx4 v21, s[8:11], s37 offen sc1 lds
s_add_u32 m0, s39, 69632
s_add_u32 s37, s37, s55
buffer_load_dwordx4 v21, s[8:11], s37 offen sc1 lds
s_add_u32 m0, s39, 70656
s_add_u32 s37, s37, s38
buffer_load_dwordx4 v21, s[8:11], s37 offen sc1 lds
s_add_u32 m0, s39, 71680
s_add_u32 s37, s37, s38
buffer_load_dwordx4 v21, s[8:11], s37 offen sc1 lds
s_add_u32 m0, s39, 72704
s_add_u32 s37, s37, s38
buffer_load_dwordx4 v21, s[8:11], s37 offen sc1 lds
s_waitcnt vmcnt(16)
s_barrier
s_add_u32 m0, s39, 98304
s_add_u32 s37, s37, s40
buffer_load_dwordx4 v21, s[8:11], s37 offen sc1 lds
s_add_u32 m0, s39, 99328
s_add_u32 s37, s37, s38
buffer_load_dwordx4 v21, s[8:11], s37 offen sc1 lds
s_add_u32 m0, s39, 100352
s_add_u32 s37, s37, s38
buffer_load_dwordx4 v21, s[8:11], s37 offen sc1 lds
s_add_u32 m0, s39, 101376
s_add_u32 s37, s37, s38
buffer_load_dwordx4 v21, s[8:11], s37 offen sc1 lds
s_add_u32 m0, s39, 102400
s_add_u32 s37, s37, s55
buffer_load_dwordx4 v21, s[8:11], s37 offen sc1 lds
s_add_u32 m0, s39, 103424
s_add_u32 s37, s37, s38
buffer_load_dwordx4 v21, s[8:11], s37 offen sc1 lds
s_add_u32 m0, s39, 104448
s_add_u32 s37, s37, s38
buffer_load_dwordx4 v21, s[8:11], s37 offen sc1 lds
s_add_u32 m0, s39, 105472
s_add_u32 s37, s37, s38
buffer_load_dwordx4 v21, s[8:11], s37 offen sc1 lds
s_waitcnt vmcnt(16)
s_barrier
s_cmp_eq_u32 s51, 2
s_cbranch_scc1 LW4_104
s_mul_i32 s40, s53, 98304
s_add_u32 m0, s39, 0
s_add_u32 s37, s40, 524288
buffer_load_dwordx4 v21, s[8:11], s37 offen sc1 lds
s_add_u32 m0, s39, 1024
s_add_u32 s37, s40, 525312
buffer_load_dwordx4 v21, s[8:11], s37 offen sc1 lds
s_add_u32 m0, s39, 2048
s_add_u32 s37, s40, 526336
buffer_load_dwordx4 v21, s[8:11], s37 offen sc1 lds
s_add_u32 m0, s39, 3072
s_add_u32 s37, s40, 527360
buffer_load_dwordx4 v21, s[8:11], s37 offen sc1 lds
s_add_u32 m0, s39, 4096
s_add_u32 s37, s40, 528384
buffer_load_dwordx4 v21, s[8:11], s37 offen sc1 lds
s_add_u32 m0, s39, 5120
s_add_u32 s37, s40, 529408
buffer_load_dwordx4 v21, s[8:11], s37 offen sc1 lds
s_add_u32 m0, s39, 6144
s_add_u32 s37, s40, 530432
buffer_load_dwordx4 v21, s[8:11], s37 offen sc1 lds
s_add_u32 m0, s39, 7168
s_add_u32 s37, s40, 531456
buffer_load_dwordx4 v21, s[8:11], s37 offen sc1 lds
s_waitcnt vmcnt(16)
s_barrier
s_add_u32 m0, s39, 32768
s_add_u32 s37, s40, 540672
buffer_load_dwordx4 v21, s[8:11], s37 offen sc1 lds
s_add_u32 m0, s39, 33792
s_add_u32 s37, s40, 541696
buffer_load_dwordx4 v21, s[8:11], s37 offen sc1 lds
s_add_u32 m0, s39, 34816
s_add_u32 s37, s40, 542720
buffer_load_dwordx4 v21, s[8:11], s37 offen sc1 lds
s_add_u32 m0, s39, 35840
s_add_u32 s37, s40, 543744
buffer_load_dwordx4 v21, s[8:11], s37 offen sc1 lds
s_add_u32 m0, s39, 36864
s_add_u32 s37, s40, 544768
buffer_load_dwordx4 v21, s[8:11], s37 offen sc1 lds
s_add_u32 m0, s39, 37888
s_add_u32 s37, s40, 545792
buffer_load_dwordx4 v21, s[8:11], s37 offen sc1 lds
s_add_u32 m0, s39, 38912
s_add_u32 s37, s40, 546816
buffer_load_dwordx4 v21, s[8:11], s37 offen sc1 lds
s_add_u32 m0, s39, 39936
s_add_u32 s37, s40, 547840
buffer_load_dwordx4 v21, s[8:11], s37 offen sc1 lds
s_waitcnt vmcnt(16)
s_barrier
s_add_u32 m0, s39, 65536
s_add_u32 s37, s40, 557056
buffer_load_dwordx4 v21, s[8:11], s37 offen sc1 lds
s_add_u32 m0, s39, 66560
s_add_u32 s37, s40, 558080
buffer_load_dwordx4 v21, s[8:11], s37 offen sc1 lds
s_add_u32 m0, s39, 67584
s_add_u32 s37, s40, 559104
buffer_load_dwordx4 v21, s[8:11], s37 offen sc1 lds
s_add_u32 m0, s39, 68608
s_add_u32 s37, s40, 560128
buffer_load_dwordx4 v21, s[8:11], s37 offen sc1 lds
s_add_u32 m0, s39, 69632
s_add_u32 s37, s40, 561152
buffer_load_dwordx4 v21, s[8:11], s37 offen sc1 lds
s_add_u32 m0, s39, 70656
s_add_u32 s37, s40, 562176
buffer_load_dwordx4 v21, s[8:11], s37 offen sc1 lds
s_add_u32 m0, s39, 71680
s_add_u32 s37, s40, 563200
buffer_load_dwordx4 v21, s[8:11], s37 offen sc1 lds
s_add_u32 m0, s39, 72704
s_add_u32 s37, s40, 564224
buffer_load_dwordx4 v21, s[8:11], s37 offen sc1 lds
s_waitcnt vmcnt(16)
s_barrier
s_add_u32 m0, s39, 98304
s_add_u32 s37, s40, 573440
buffer_load_dwordx4 v21, s[8:11], s37 offen sc1 lds
s_add_u32 m0, s39, 99328
s_add_u32 s37, s40, 574464
buffer_load_dwordx4 v21, s[8:11], s37 offen sc1 lds
s_add_u32 m0, s39, 100352
s_add_u32 s37, s40, 575488
buffer_load_dwordx4 v21, s[8:11], s37 offen sc1 lds
s_add_u32 m0, s39, 101376
s_add_u32 s37, s40, 576512
buffer_load_dwordx4 v21, s[8:11], s37 offen sc1 lds
s_add_u32 m0, s39, 102400
s_add_u32 s37, s40, 577536
buffer_load_dwordx4 v21, s[8:11], s37 offen sc1 lds
s_add_u32 m0, s39, 103424
s_add_u32 s37, s40, 578560
buffer_load_dwordx4 v21, s[8:11], s37 offen sc1 lds
s_add_u32 m0, s39, 104448
s_add_u32 s37, s40, 579584
buffer_load_dwordx4 v21, s[8:11], s37 offen sc1 lds
s_add_u32 m0, s39, 105472
s_add_u32 s37, s40, 580608
buffer_load_dwordx4 v21, s[8:11], s37 offen sc1 lds
s_waitcnt vmcnt(16)
s_barrier
s_add_u32 m0, s39, 0
s_add_u32 s37, s40, 589824
buffer_load_dwordx4 v21, s[8:11], s37 offen sc1 lds
s_add_u32 m0, s39, 1024
s_add_u32 s37, s40, 590848
buffer_load_dwordx4 v21, s[8:11], s37 offen sc1 lds
s_add_u32 m0, s39, 2048
s_add_u32 s37, s40, 591872
buffer_load_dwordx4 v21, s[8:11], s37 offen sc1 lds
s_add_u32 m0, s39, 3072
s_add_u32 s37, s40, 592896
buffer_load_dwordx4 v21, s[8:11], s37 offen sc1 lds
s_add_u32 m0, s39, 4096
s_add_u32 s37, s40, 593920
buffer_load_dwordx4 v21, s[8:11], s37 offen sc1 lds
s_add_u32 m0, s39, 5120
s_add_u32 s37, s40, 594944
buffer_load_dwordx4 v21, s[8:11], s37 offen sc1 lds
s_add_u32 m0, s39, 6144
s_add_u32 s37, s40, 595968
buffer_load_dwordx4 v21, s[8:11], s37 offen sc1 lds
s_add_u32 m0, s39, 7168
s_add_u32 s37, s40, 596992
buffer_load_dwordx4 v21, s[8:11], s37 offen sc1 lds
s_waitcnt vmcnt(16)
s_barrier
s_add_u32 m0, s39, 32768
s_add_u32 s37, s40, 606208
buffer_load_dwordx4 v21, s[8:11], s37 offen sc1 lds
s_add_u32 m0, s39, 33792
s_add_u32 s37, s40, 607232
buffer_load_dwordx4 v21, s[8:11], s37 offen sc1 lds
s_add_u32 m0, s39, 34816
s_add_u32 s37, s40, 608256
buffer_load_dwordx4 v21, s[8:11], s37 offen sc1 lds
s_add_u32 m0, s39, 35840
s_add_u32 s37, s40, 609280
buffer_load_dwordx4 v21, s[8:11], s37 offen sc1 lds
s_add_u32 m0, s39, 36864
s_add_u32 s37, s40, 610304
buffer_load_dwordx4 v21, s[8:11], s37 offen sc1 lds
s_add_u32 m0, s39, 37888
s_add_u32 s37, s40, 611328
buffer_load_dwordx4 v21, s[8:11], s37 offen sc1 lds
s_add_u32 m0, s39, 38912
s_add_u32 s37, s40, 612352
buffer_load_dwordx4 v21, s[8:11], s37 offen sc1 lds
s_add_u32 m0, s39, 39936
s_add_u32 s37, s40, 613376
buffer_load_dwordx4 v21, s[8:11], s37 offen sc1 lds
s_waitcnt vmcnt(16)
s_barrier
s_add_u32 m0, s39, 65536
s_mov_b32 s37, 720896
buffer_load_dwordx4 v21, s[8:11], s37 offen sc1 lds
s_add_u32 m0, s39, 66560
s_mov_b32 s37, 721920
buffer_load_dwordx4 v21, s[8:11], s37 offen sc1 lds
s_add_u32 m0, s39, 67584
s_mov_b32 s37, 722944
buffer_load_dwordx4 v21, s[8:11], s37 offen sc1 lds
s_add_u32 m0, s39, 68608
s_mov_b32 s37, 723968
buffer_load_dwordx4 v21, s[8:11], s37 offen sc1 lds
s_add_u32 m0, s39, 69632
s_mov_b32 s37, 724992
buffer_load_dwordx4 v21, s[8:11], s37 offen sc1 lds
s_add_u32 m0, s39, 70656
s_mov_b32 s37, 726016
buffer_load_dwordx4 v21, s[8:11], s37 offen sc1 lds
s_add_u32 m0, s39, 71680
s_mov_b32 s37, 727040
buffer_load_dwordx4 v21, s[8:11], s37 offen sc1 lds
s_add_u32 m0, s39, 72704
s_mov_b32 s37, 728064
buffer_load_dwordx4 v21, s[8:11], s37 offen sc1 lds
s_waitcnt vmcnt(16)
s_barrier
s_add_u32 m0, s39, 98304
s_mov_b32 s37, 737280
buffer_load_dwordx4 v21, s[8:11], s37 offen sc1 lds
s_add_u32 m0, s39, 99328
s_mov_b32 s37, 738304
buffer_load_dwordx4 v21, s[8:11], s37 offen sc1 lds
s_add_u32 m0, s39, 100352
s_mov_b32 s37, 739328
buffer_load_dwordx4 v21, s[8:11], s37 offen sc1 lds
s_add_u32 m0, s39, 101376
s_mov_b32 s37, 740352
buffer_load_dwordx4 v21, s[8:11], s37 offen sc1 lds
s_add_u32 m0, s39, 102400
s_mov_b32 s37, 741376
buffer_load_dwordx4 v21, s[8:11], s37 offen sc1 lds
s_add_u32 m0, s39, 103424
s_mov_b32 s37, 742400
buffer_load_dwordx4 v21, s[8:11], s37 offen sc1 lds
s_add_u32 m0, s39, 104448
s_mov_b32 s37, 743424
buffer_load_dwordx4 v21, s[8:11], s37 offen sc1 lds
s_add_u32 m0, s39, 105472
s_mov_b32 s37, 744448
buffer_load_dwordx4 v21, s[8:11], s37 offen sc1 lds
s_waitcnt vmcnt(16)
s_barrier
s_add_u32 m0, s39, 0
s_mov_b32 s37, 753664
buffer_load_dwordx4 v21, s[8:11], s37 offen sc1 lds
s_add_u32 m0, s39, 1024
s_mov_b32 s37, 754688
buffer_load_dwordx4 v21, s[8:11], s37 offen sc1 lds
s_add_u32 m0, s39, 2048
s_mov_b32 s37, 755712
buffer_load_dwordx4 v21, s[8:11], s37 offen sc1 lds
s_add_u32 m0, s39, 3072
s_mov_b32 s37, 756736
buffer_load_dwordx4 v21, s[8:11], s37 offen sc1 lds
s_add_u32 m0, s39, 4096
s_mov_b32 s37, 757760
buffer_load_dwordx4 v21, s[8:11], s37 offen sc1 lds
s_add_u32 m0, s39, 5120
s_mov_b32 s37, 758784
buffer_load_dwordx4 v21, s[8:11], s37 offen sc1 lds
s_add_u32 m0, s39, 6144
s_mov_b32 s37, 759808
buffer_load_dwordx4 v21, s[8:11], s37 offen sc1 lds
s_add_u32 m0, s39, 7168
s_mov_b32 s37, 760832
buffer_load_dwordx4 v21, s[8:11], s37 offen sc1 lds
s_waitcnt vmcnt(16)
s_barrier
s_add_u32 m0, s39, 32768
s_mov_b32 s37, 770048
buffer_load_dwordx4 v21, s[8:11], s37 offen sc1 lds
s_add_u32 m0, s39, 33792
s_mov_b32 s37, 771072
buffer_load_dwordx4 v21, s[8:11], s37 offen sc1 lds
s_add_u32 m0, s39, 34816
s_mov_b32 s37, 772096
buffer_load_dwordx4 v21, s[8:11], s37 offen sc1 lds
s_add_u32 m0, s39, 35840
s_mov_b32 s37, 773120
buffer_load_dwordx4 v21, s[8:11], s37 offen sc1 lds
s_add_u32 m0, s39, 36864
s_mov_b32 s37, 774144
buffer_load_dwordx4 v21, s[8:11], s37 offen sc1 lds
s_add_u32 m0, s39, 37888
s_mov_b32 s37, 775168
buffer_load_dwordx4 v21, s[8:11], s37 offen sc1 lds
s_add_u32 m0, s39, 38912
s_mov_b32 s37, 776192
buffer_load_dwordx4 v21, s[8:11], s37 offen sc1 lds
s_add_u32 m0, s39, 39936
s_mov_b32 s37, 777216
buffer_load_dwordx4 v21, s[8:11], s37 offen sc1 lds
s_waitcnt vmcnt(16)
s_barrier
s_add_u32 m0, s39, 65536
s_mov_b32 s37, 786432
buffer_load_dwordx4 v21, s[8:11], s37 offen sc1 lds
s_add_u32 m0, s39, 66560
s_mov_b32 s37, 787456
buffer_load_dwordx4 v21, s[8:11], s37 offen sc1 lds
s_add_u32 m0, s39, 67584
s_mov_b32 s37, 788480
buffer_load_dwordx4 v21, s[8:11], s37 offen sc1 lds
s_add_u32 m0, s39, 68608
s_mov_b32 s37, 789504
buffer_load_dwordx4 v21, s[8:11], s37 offen sc1 lds
s_add_u32 m0, s39, 69632
s_mov_b32 s37, 790528
buffer_load_dwordx4 v21, s[8:11], s37 offen sc1 lds
s_add_u32 m0, s39, 70656
s_mov_b32 s37, 791552
buffer_load_dwordx4 v21, s[8:11], s37 offen sc1 lds
s_add_u32 m0, s39, 71680
s_mov_b32 s37, 792576
buffer_load_dwordx4 v21, s[8:11], s37 offen sc1 lds
s_add_u32 m0, s39, 72704
s_mov_b32 s37, 793600
buffer_load_dwordx4 v21, s[8:11], s37 offen sc1 lds
s_waitcnt vmcnt(16)
s_barrier
s_add_u32 m0, s39, 98304
s_mov_b32 s37, 802816
buffer_load_dwordx4 v21, s[8:11], s37 offen sc1 lds
s_add_u32 m0, s39, 99328
s_mov_b32 s37, 803840
buffer_load_dwordx4 v21, s[8:11], s37 offen sc1 lds
s_add_u32 m0, s39, 100352
s_mov_b32 s37, 804864
buffer_load_dwordx4 v21, s[8:11], s37 offen sc1 lds
s_add_u32 m0, s39, 101376
s_mov_b32 s37, 805888
buffer_load_dwordx4 v21, s[8:11], s37 offen sc1 lds
s_add_u32 m0, s39, 102400
s_mov_b32 s37, 806912
buffer_load_dwordx4 v21, s[8:11], s37 offen sc1 lds
s_add_u32 m0, s39, 103424
s_mov_b32 s37, 807936
buffer_load_dwordx4 v21, s[8:11], s37 offen sc1 lds
s_add_u32 m0, s39, 104448
s_mov_b32 s37, 808960
buffer_load_dwordx4 v21, s[8:11], s37 offen sc1 lds
s_add_u32 m0, s39, 105472
s_mov_b32 s37, 809984
buffer_load_dwordx4 v21, s[8:11], s37 offen sc1 lds
s_waitcnt vmcnt(16)
s_barrier
s_add_u32 m0, s39, 0
s_mov_b32 s37, 819200
buffer_load_dwordx4 v21, s[8:11], s37 offen sc1 lds
s_add_u32 m0, s39, 1024
s_mov_b32 s37, 820224
buffer_load_dwordx4 v21, s[8:11], s37 offen sc1 lds
s_add_u32 m0, s39, 2048
s_mov_b32 s37, 821248
buffer_load_dwordx4 v21, s[8:11], s37 offen sc1 lds
s_add_u32 m0, s39, 3072
s_mov_b32 s37, 822272
buffer_load_dwordx4 v21, s[8:11], s37 offen sc1 lds
s_add_u32 m0, s39, 4096
s_mov_b32 s37, 823296
buffer_load_dwordx4 v21, s[8:11], s37 offen sc1 lds
s_add_u32 m0, s39, 5120
s_mov_b32 s37, 824320
buffer_load_dwordx4 v21, s[8:11], s37 offen sc1 lds
s_add_u32 m0, s39, 6144
s_mov_b32 s37, 825344
buffer_load_dwordx4 v21, s[8:11], s37 offen sc1 lds
s_add_u32 m0, s39, 7168
s_mov_b32 s37, 826368
buffer_load_dwordx4 v21, s[8:11], s37 offen sc1 lds
s_waitcnt vmcnt(16)
s_barrier
s_add_u32 m0, s39, 32768
s_mov_b32 s37, 835584
buffer_load_dwordx4 v21, s[8:11], s37 offen sc1 lds
s_add_u32 m0, s39, 33792
s_mov_b32 s37, 836608
buffer_load_dwordx4 v21, s[8:11], s37 offen sc1 lds
s_add_u32 m0, s39, 34816
s_mov_b32 s37, 837632
buffer_load_dwordx4 v21, s[8:11], s37 offen sc1 lds
s_add_u32 m0, s39, 35840
s_mov_b32 s37, 838656
buffer_load_dwordx4 v21, s[8:11], s37 offen sc1 lds
s_add_u32 m0, s39, 36864
s_mov_b32 s37, 839680
buffer_load_dwordx4 v21, s[8:11], s37 offen sc1 lds
s_add_u32 m0, s39, 37888
s_mov_b32 s37, 840704
buffer_load_dwordx4 v21, s[8:11], s37 offen sc1 lds
s_add_u32 m0, s39, 38912
s_mov_b32 s37, 841728
buffer_load_dwordx4 v21, s[8:11], s37 offen sc1 lds
s_add_u32 m0, s39, 39936
s_mov_b32 s37, 842752
buffer_load_dwordx4 v21, s[8:11], s37 offen sc1 lds
s_waitcnt vmcnt(16)
s_barrier
s_add_u32 m0, s39, 65536
s_mov_b32 s37, 851968
buffer_load_dwordx4 v21, s[8:11], s37 offen sc1 lds
s_add_u32 m0, s39, 66560
s_mov_b32 s37, 852992
buffer_load_dwordx4 v21, s[8:11], s37 offen sc1 lds
s_add_u32 m0, s39, 67584
s_mov_b32 s37, 854016
buffer_load_dwordx4 v21, s[8:11], s37 offen sc1 lds
s_add_u32 m0, s39, 68608
s_mov_b32 s37, 855040
buffer_load_dwordx4 v21, s[8:11], s37 offen sc1 lds
s_add_u32 m0, s39, 69632
s_mov_b32 s37, 856064
buffer_load_dwordx4 v21, s[8:11], s37 offen sc1 lds
s_add_u32 m0, s39, 70656
s_mov_b32 s37, 857088
buffer_load_dwordx4 v21, s[8:11], s37 offen sc1 lds
s_add_u32 m0, s39, 71680
s_mov_b32 s37, 858112
buffer_load_dwordx4 v21, s[8:11], s37 offen sc1 lds
s_add_u32 m0, s39, 72704
s_mov_b32 s37, 859136
buffer_load_dwordx4 v21, s[8:11], s37 offen sc1 lds
s_waitcnt vmcnt(16)
s_barrier
s_add_u32 m0, s39, 98304
s_mov_b32 s37, 868352
buffer_load_dwordx4 v21, s[8:11], s37 offen sc1 lds
s_add_u32 m0, s39, 99328
s_mov_b32 s37, 869376
buffer_load_dwordx4 v21, s[8:11], s37 offen sc1 lds
s_add_u32 m0, s39, 100352
s_mov_b32 s37, 870400
buffer_load_dwordx4 v21, s[8:11], s37 offen sc1 lds
s_add_u32 m0, s39, 101376
s_mov_b32 s37, 871424
buffer_load_dwordx4 v21, s[8:11], s37 offen sc1 lds
s_add_u32 m0, s39, 102400
s_mov_b32 s37, 872448
buffer_load_dwordx4 v21, s[8:11], s37 offen sc1 lds
s_add_u32 m0, s39, 103424
s_mov_b32 s37, 873472
buffer_load_dwordx4 v21, s[8:11], s37 offen sc1 lds
s_add_u32 m0, s39, 104448
s_mov_b32 s37, 874496
buffer_load_dwordx4 v21, s[8:11], s37 offen sc1 lds
s_add_u32 m0, s39, 105472
s_mov_b32 s37, 875520
buffer_load_dwordx4 v21, s[8:11], s37 offen sc1 lds
s_waitcnt vmcnt(16)
s_barrier
s_add_u32 m0, s39, 0
s_mov_b32 s37, 884736
buffer_load_dwordx4 v21, s[8:11], s37 offen sc1 lds
s_add_u32 m0, s39, 1024
s_mov_b32 s37, 885760
buffer_load_dwordx4 v21, s[8:11], s37 offen sc1 lds
s_add_u32 m0, s39, 2048
s_mov_b32 s37, 886784
buffer_load_dwordx4 v21, s[8:11], s37 offen sc1 lds
s_add_u32 m0, s39, 3072
s_mov_b32 s37, 887808
buffer_load_dwordx4 v21, s[8:11], s37 offen sc1 lds
s_add_u32 m0, s39, 4096
s_mov_b32 s37, 888832
buffer_load_dwordx4 v21, s[8:11], s37 offen sc1 lds
s_add_u32 m0, s39, 5120
s_mov_b32 s37, 889856
buffer_load_dwordx4 v21, s[8:11], s37 offen sc1 lds
s_add_u32 m0, s39, 6144
s_mov_b32 s37, 890880
buffer_load_dwordx4 v21, s[8:11], s37 offen sc1 lds
s_add_u32 m0, s39, 7168
s_mov_b32 s37, 891904
buffer_load_dwordx4 v21, s[8:11], s37 offen sc1 lds
s_waitcnt vmcnt(16)
s_barrier
s_add_u32 m0, s39, 32768
s_mov_b32 s37, 901120
buffer_load_dwordx4 v21, s[8:11], s37 offen sc1 lds
s_add_u32 m0, s39, 33792
s_mov_b32 s37, 902144
buffer_load_dwordx4 v21, s[8:11], s37 offen sc1 lds
s_add_u32 m0, s39, 34816
s_mov_b32 s37, 903168
buffer_load_dwordx4 v21, s[8:11], s37 offen sc1 lds
s_add_u32 m0, s39, 35840
s_mov_b32 s37, 904192
buffer_load_dwordx4 v21, s[8:11], s37 offen sc1 lds
s_add_u32 m0, s39, 36864
s_mov_b32 s37, 905216
buffer_load_dwordx4 v21, s[8:11], s37 offen sc1 lds
s_add_u32 m0, s39, 37888
s_mov_b32 s37, 906240
buffer_load_dwordx4 v21, s[8:11], s37 offen sc1 lds
s_add_u32 m0, s39, 38912
s_mov_b32 s37, 907264
buffer_load_dwordx4 v21, s[8:11], s37 offen sc1 lds
s_add_u32 m0, s39, 39936
s_mov_b32 s37, 908288
buffer_load_dwordx4 v21, s[8:11], s37 offen sc1 lds
s_waitcnt vmcnt(16)
s_barrier
s_waitcnt vmcnt(8)
s_barrier
s_waitcnt vmcnt(0)
s_barrier
s_branch Ldone_1
.p2align 6
Lw_108:
s_branch Lr_109
s_nop 0
.p2align 3
LW4_104:
s_mul_i32 s40, s53, 786432
s_add_u32 m0, s39, 0
s_add_u32 s37, s40, 4194304
buffer_load_dwordx4 v21, s[8:11], s37 offen sc1 lds
s_add_u32 m0, s39, 1024
s_add_u32 s37, s40, 4210688
buffer_load_dwordx4 v21, s[8:11], s37 offen sc1 lds
s_add_u32 m0, s39, 2048
s_add_u32 s37, s40, 4227072
buffer_load_dwordx4 v21, s[8:11], s37 offen sc1 lds
s_add_u32 m0, s39, 3072
s_add_u32 s37, s40, 4243456
buffer_load_dwordx4 v21, s[8:11], s37 offen sc1 lds
s_add_u32 m0, s39, 4096
s_add_u32 s37, s40, 4292608
buffer_load_dwordx4 v21, s[8:11], s37 offen sc1 lds
s_add_u32 m0, s39, 5120
s_add_u32 s37, s40, 4308992
buffer_load_dwordx4 v21, s[8:11], s37 offen sc1 lds
s_add_u32 m0, s39, 6144
s_add_u32 s37, s40, 4325376
buffer_load_dwordx4 v21, s[8:11], s37 offen sc1 lds
s_add_u32 m0, s39, 7168
s_add_u32 s37, s40, 4341760
buffer_load_dwordx4 v21, s[8:11], s37 offen sc1 lds
s_waitcnt vmcnt(16)
s_barrier
s_add_u32 m0, s39, 32768
s_add_u32 s37, s40, 4259840
buffer_load_dwordx4 v21, s[8:11], s37 offen sc1 lds
s_add_u32 m0, s39, 33792
s_add_u32 s37, s40, 4358144
buffer_load_dwordx4 v21, s[8:11], s37 offen sc1 lds
s_add_u32 m0, s39, 34816
s_add_u32 s37, s40, 4276224
buffer_load_dwordx4 v21, s[8:11], s37 offen sc1 lds
s_add_u32 m0, s39, 35840
s_add_u32 s37, s40, 4374528
buffer_load_dwordx4 v21, s[8:11], s37 offen sc1 lds
s_add_u32 m0, s39, 36864
s_add_u32 s37, s40, 4390912
buffer_load_dwordx4 v21, s[8:11], s37 offen sc1 lds
s_add_u32 m0, s39, 37888
s_add_u32 s37, s40, 4407296
buffer_load_dwordx4 v21, s[8:11], s37 offen sc1 lds
s_add_u32 m0, s39, 38912
s_add_u32 s37, s40, 4423680
buffer_load_dwordx4 v21, s[8:11], s37 offen sc1 lds
s_add_u32 m0, s39, 39936
s_add_u32 s37, s40, 4440064
buffer_load_dwordx4 v21, s[8:11], s37 offen sc1 lds
s_waitcnt vmcnt(16)
s_barrier
s_add_u32 m0, s39, 65536
s_add_u32 s37, s40, 4489216
buffer_load_dwordx4 v21, s[8:11], s37 offen sc1 lds
s_add_u32 m0, s39, 66560
s_add_u32 s37, s40, 4505600
buffer_load_dwordx4 v21, s[8:11], s37 offen sc1 lds
s_add_u32 m0, s39, 67584
s_add_u32 s37, s40, 4521984
buffer_load_dwordx4 v21, s[8:11], s37 offen sc1 lds
s_add_u32 m0, s39, 68608
s_add_u32 s37, s40, 4538368
buffer_load_dwordx4 v21, s[8:11], s37 offen sc1 lds
s_add_u32 m0, s39, 69632
s_add_u32 s37, s40, 4456448
buffer_load_dwordx4 v21, s[8:11], s37 offen sc1 lds
s_add_u32 m0, s39, 70656
s_add_u32 s37, s40, 4554752
buffer_load_dwordx4 v21, s[8:11], s37 offen sc1 lds
s_add_u32 m0, s39, 71680
s_add_u32 s37, s40, 4472832
buffer_load_dwordx4 v21, s[8:11], s37 offen sc1 lds
s_add_u32 m0, s39, 72704
s_add_u32 s37, s40, 4571136
buffer_load_dwordx4 v21, s[8:11], s37 offen sc1 lds
s_waitcnt vmcnt(16)
s_barrier
s_add_u32 m0, s39, 98304
s_add_u32 s37, s40, 4587520
buffer_load_dwordx4 v21, s[8:11], s37 offen sc1 lds
s_add_u32 m0, s39, 99328
s_add_u32 s37, s40, 4603904
buffer_load_dwordx4 v21, s[8:11], s37 offen sc1 lds
s_add_u32 m0, s39, 100352
s_add_u32 s37, s40, 4620288
buffer_load_dwordx4 v21, s[8:11], s37 offen sc1 lds
s_add_u32 m0, s39, 101376
s_add_u32 s37, s40, 4636672
buffer_load_dwordx4 v21, s[8:11], s37 offen sc1 lds
s_add_u32 m0, s39, 102400
s_add_u32 s37, s40, 4685824
buffer_load_dwordx4 v21, s[8:11], s37 offen sc1 lds
s_add_u32 m0, s39, 103424
s_add_u32 s37, s40, 4702208
buffer_load_dwordx4 v21, s[8:11], s37 offen sc1 lds
s_add_u32 m0, s39, 104448
s_add_u32 s37, s40, 4718592
buffer_load_dwordx4 v21, s[8:11], s37 offen sc1 lds
s_add_u32 m0, s39, 105472
s_add_u32 s37, s40, 4734976
buffer_load_dwordx4 v21, s[8:11], s37 offen sc1 lds
s_waitcnt vmcnt(16)
s_barrier
s_add_u32 m0, s39, 0
s_add_u32 s37, s40, 4653056
buffer_load_dwordx4 v21, s[8:11], s37 offen sc1 lds
s_add_u32 m0, s39, 1024
s_add_u32 s37, s40, 4751360
buffer_load_dwordx4 v21, s[8:11], s37 offen sc1 lds
s_add_u32 m0, s39, 2048
s_add_u32 s37, s40, 4669440
buffer_load_dwordx4 v21, s[8:11], s37 offen sc1 lds
s_add_u32 m0, s39, 3072
s_add_u32 s37, s40, 4767744
buffer_load_dwordx4 v21, s[8:11], s37 offen sc1 lds
s_add_u32 m0, s39, 4096
s_add_u32 s37, s40, 4784128
buffer_load_dwordx4 v21, s[8:11], s37 offen sc1 lds
s_add_u32 m0, s39, 5120
s_add_u32 s37, s40, 4800512
buffer_load_dwordx4 v21, s[8:11], s37 offen sc1 lds
s_add_u32 m0, s39, 6144
s_add_u32 s37, s40, 4816896
buffer_load_dwordx4 v21, s[8:11], s37 offen sc1 lds
s_add_u32 m0, s39, 7168
s_add_u32 s37, s40, 4833280
buffer_load_dwordx4 v21, s[8:11], s37 offen sc1 lds
s_waitcnt vmcnt(16)
s_barrier
s_add_u32 m0, s39, 32768
s_add_u32 s37, s40, 4882432
buffer_load_dwordx4 v21, s[8:11], s37 offen sc1 lds
s_add_u32 m0, s39, 33792
s_add_u32 s37, s40, 4898816
buffer_load_dwordx4 v21, s[8:11], s37 offen sc1 lds
s_add_u32 m0, s39, 34816
s_add_u32 s37, s40, 4915200
buffer_load_dwordx4 v21, s[8:11], s37 offen sc1 lds
s_add_u32 m0, s39, 35840
s_add_u32 s37, s40, 4931584
buffer_load_dwordx4 v21, s[8:11], s37 offen sc1 lds
s_add_u32 m0, s39, 36864
s_add_u32 s37, s40, 4849664
buffer_load_dwordx4 v21, s[8:11], s37 offen sc1 lds
s_add_u32 m0, s39, 37888
s_add_u32 s37, s40, 4947968
buffer_load_dwordx4 v21, s[8:11], s37 offen sc1 lds
s_add_u32 m0, s39, 38912
s_add_u32 s37, s40, 4866048
buffer_load_dwordx4 v21, s[8:11], s37 offen sc1 lds
s_add_u32 m0, s39, 39936
s_add_u32 s37, s40, 4964352
buffer_load_dwordx4 v21, s[8:11], s37 offen sc1 lds
s_waitcnt vmcnt(16)
s_barrier
s_add_u32 m0, s39, 65536
s_mov_b32 s37, 5767168
buffer_load_dwordx4 v21, s[8:11], s37 offen sc1 lds
s_add_u32 m0, s39, 66560
s_mov_b32 s37, 5783552
buffer_load_dwordx4 v21, s[8:11], s37 offen sc1 lds
s_add_u32 m0, s39, 67584
s_mov_b32 s37, 5799936
buffer_load_dwordx4 v21, s[8:11], s37 offen sc1 lds
s_add_u32 m0, s39, 68608
s_mov_b32 s37, 5816320
buffer_load_dwordx4 v21, s[8:11], s37 offen sc1 lds
s_add_u32 m0, s39, 69632
s_mov_b32 s37, 5865472
buffer_load_dwordx4 v21, s[8:11], s37 offen sc1 lds
s_add_u32 m0, s39, 70656
s_mov_b32 s37, 5881856
buffer_load_dwordx4 v21, s[8:11], s37 offen sc1 lds
s_add_u32 m0, s39, 71680
s_mov_b32 s37, 5898240
buffer_load_dwordx4 v21, s[8:11], s37 offen sc1 lds
s_add_u32 m0, s39, 72704
s_mov_b32 s37, 5914624
buffer_load_dwordx4 v21, s[8:11], s37 offen sc1 lds
s_waitcnt vmcnt(16)
s_barrier
s_add_u32 m0, s39, 98304
s_mov_b32 s37, 5832704
buffer_load_dwordx4 v21, s[8:11], s37 offen sc1 lds
s_add_u32 m0, s39, 99328
s_mov_b32 s37, 5931008
buffer_load_dwordx4 v21, s[8:11], s37 offen sc1 lds
s_add_u32 m0, s39, 100352
s_mov_b32 s37, 5849088
buffer_load_dwordx4 v21, s[8:11], s37 offen sc1 lds
s_add_u32 m0, s39, 101376
s_mov_b32 s37, 5947392
buffer_load_dwordx4 v21, s[8:11], s37 offen sc1 lds
s_add_u32 m0, s39, 102400
s_mov_b32 s37, 5963776
buffer_load_dwordx4 v21, s[8:11], s37 offen sc1 lds
s_add_u32 m0, s39, 103424
s_mov_b32 s37, 5980160
buffer_load_dwordx4 v21, s[8:11], s37 offen sc1 lds
s_add_u32 m0, s39, 104448
s_mov_b32 s37, 5996544
buffer_load_dwordx4 v21, s[8:11], s37 offen sc1 lds
s_add_u32 m0, s39, 105472
s_mov_b32 s37, 6012928
buffer_load_dwordx4 v21, s[8:11], s37 offen sc1 lds
s_waitcnt vmcnt(16)
s_barrier
s_add_u32 m0, s39, 0
s_mov_b32 s37, 6062080
buffer_load_dwordx4 v21, s[8:11], s37 offen sc1 lds
s_add_u32 m0, s39, 1024
s_mov_b32 s37, 6078464
buffer_load_dwordx4 v21, s[8:11], s37 offen sc1 lds
s_add_u32 m0, s39, 2048
s_mov_b32 s37, 6094848
buffer_load_dwordx4 v21, s[8:11], s37 offen sc1 lds
s_add_u32 m0, s39, 3072
s_mov_b32 s37, 6111232
buffer_load_dwordx4 v21, s[8:11], s37 offen sc1 lds
s_add_u32 m0, s39, 4096
s_mov_b32 s37, 6029312
buffer_load_dwordx4 v21, s[8:11], s37 offen sc1 lds
s_add_u32 m0, s39, 5120
s_mov_b32 s37, 6127616
buffer_load_dwordx4 v21, s[8:11], s37 offen sc1 lds
s_add_u32 m0, s39, 6144
s_mov_b32 s37, 6045696
buffer_load_dwordx4 v21, s[8:11], s37 offen sc1 lds
s_add_u32 m0, s39, 7168
s_mov_b32 s37, 6144000
buffer_load_dwordx4 v21, s[8:11], s37 offen sc1 lds
s_waitcnt vmcnt(16)
s_barrier
s_add_u32 m0, s39, 32768
s_mov_b32 s37, 6160384
buffer_load_dwordx4 v21, s[8:11], s37 offen sc1 lds
s_add_u32 m0, s39, 33792
s_mov_b32 s37, 6176768
buffer_load_dwordx4 v21, s[8:11], s37 offen sc1 lds
s_add_u32 m0, s39, 34816
s_mov_b32 s37, 6193152
buffer_load_dwordx4 v21, s[8:11], s37 offen sc1 lds
s_add_u32 m0, s39, 35840
s_mov_b32 s37, 6209536
buffer_load_dwordx4 v21, s[8:11], s37 offen sc1 lds
s_add_u32 m0, s39, 36864
s_mov_b32 s37, 6258688
buffer_load_dwordx4 v21, s[8:11], s37 offen sc1 lds
s_add_u32 m0, s39, 37888
s_mov_b32 s37, 6275072
buffer_load_dwordx4 v21, s[8:11], s37 offen sc1 lds
s_add_u32 m0, s39, 38912
s_mov_b32 s37, 6291456
buffer_load_dwordx4 v21, s[8:11], s37 offen sc1 lds
s_add_u32 m0, s39, 39936
s_mov_b32 s37, 6307840
buffer_load_dwordx4 v21, s[8:11], s37 offen sc1 lds
s_waitcnt vmcnt(16)
s_barrier
s_add_u32 m0, s39, 65536
s_mov_b32 s37, 6225920
buffer_load_dwordx4 v21, s[8:11], s37 offen sc1 lds
s_add_u32 m0, s39, 66560
s_mov_b32 s37, 6324224
buffer_load_dwordx4 v21, s[8:11], s37 offen sc1 lds
s_add_u32 m0, s39, 67584
s_mov_b32 s37, 6242304
buffer_load_dwordx4 v21, s[8:11], s37 offen sc1 lds
s_add_u32 m0, s39, 68608
s_mov_b32 s37, 6340608
buffer_load_dwordx4 v21, s[8:11], s37 offen sc1 lds
s_add_u32 m0, s39, 69632
s_mov_b32 s37, 6356992
buffer_load_dwordx4 v21, s[8:11], s37 offen sc1 lds
s_add_u32 m0, s39, 70656
s_mov_b32 s37, 6373376
buffer_load_dwordx4 v21, s[8:11], s37 offen sc1 lds
s_add_u32 m0, s39, 71680
s_mov_b32 s37, 6389760
buffer_load_dwordx4 v21, s[8:11], s37 offen sc1 lds
s_add_u32 m0, s39, 72704
s_mov_b32 s37, 6406144
buffer_load_dwordx4 v21, s[8:11], s37 offen sc1 lds
s_waitcnt vmcnt(16)
s_barrier
s_add_u32 m0, s39, 98304
s_mov_b32 s37, 6455296
buffer_load_dwordx4 v21, s[8:11], s37 offen sc1 lds
s_add_u32 m0, s39, 99328
s_mov_b32 s37, 6471680
buffer_load_dwordx4 v21, s[8:11], s37 offen sc1 lds
s_add_u32 m0, s39, 100352
s_mov_b32 s37, 6488064
buffer_load_dwordx4 v21, s[8:11], s37 offen sc1 lds
s_add_u32 m0, s39, 101376
s_mov_b32 s37, 6504448
buffer_load_dwordx4 v21, s[8:11], s37 offen sc1 lds
s_add_u32 m0, s39, 102400
s_mov_b32 s37, 6422528
buffer_load_dwordx4 v21, s[8:11], s37 offen sc1 lds
s_add_u32 m0, s39, 103424
s_mov_b32 s37, 6520832
buffer_load_dwordx4 v21, s[8:11], s37 offen sc1 lds
s_add_u32 m0, s39, 104448
s_mov_b32 s37, 6438912
buffer_load_dwordx4 v21, s[8:11], s37 offen sc1 lds
s_add_u32 m0, s39, 105472
s_mov_b32 s37, 6537216
buffer_load_dwordx4 v21, s[8:11], s37 offen sc1 lds
s_waitcnt vmcnt(16)
s_barrier
s_add_u32 m0, s39, 0
s_mov_b32 s37, 6553600
buffer_load_dwordx4 v21, s[8:11], s37 offen sc1 lds
s_add_u32 m0, s39, 1024
s_mov_b32 s37, 6569984
buffer_load_dwordx4 v21, s[8:11], s37 offen sc1 lds
s_add_u32 m0, s39, 2048
s_mov_b32 s37, 6586368
buffer_load_dwordx4 v21, s[8:11], s37 offen sc1 lds
s_add_u32 m0, s39, 3072
s_mov_b32 s37, 6602752
buffer_load_dwordx4 v21, s[8:11], s37 offen sc1 lds
s_add_u32 m0, s39, 4096
s_mov_b32 s37, 6651904
buffer_load_dwordx4 v21, s[8:11], s37 offen sc1 lds
s_add_u32 m0, s39, 5120
s_mov_b32 s37, 6668288
buffer_load_dwordx4 v21, s[8:11], s37 offen sc1 lds
s_add_u32 m0, s39, 6144
s_mov_b32 s37, 6684672
buffer_load_dwordx4 v21, s[8:11], s37 offen sc1 lds
s_add_u32 m0, s39, 7168
s_mov_b32 s37, 6701056
buffer_load_dwordx4 v21, s[8:11], s37 offen sc1 lds
s_waitcnt vmcnt(16)
s_barrier
s_add_u32 m0, s39, 32768
s_mov_b32 s37, 6619136
buffer_load_dwordx4 v21, s[8:11], s37 offen sc1 lds
s_add_u32 m0, s39, 33792
s_mov_b32 s37, 6717440
buffer_load_dwordx4 v21, s[8:11], s37 offen sc1 lds
s_add_u32 m0, s39, 34816
s_mov_b32 s37, 6635520
buffer_load_dwordx4 v21, s[8:11], s37 offen sc1 lds
s_add_u32 m0, s39, 35840
s_mov_b32 s37, 6733824
buffer_load_dwordx4 v21, s[8:11], s37 offen sc1 lds
s_add_u32 m0, s39, 36864
s_mov_b32 s37, 6750208
buffer_load_dwordx4 v21, s[8:11], s37 offen sc1 lds
s_add_u32 m0, s39, 37888
s_mov_b32 s37, 6766592
buffer_load_dwordx4 v21, s[8:11], s37 offen sc1 lds
s_add_u32 m0, s39, 38912
s_mov_b32 s37, 6782976
buffer_load_dwordx4 v21, s[8:11], s37 offen sc1 lds
s_add_u32 m0, s39, 39936
s_mov_b32 s37, 6799360
buffer_load_dwordx4 v21, s[8:11], s37 offen sc1 lds
s_waitcnt vmcnt(16)
s_barrier
s_add_u32 m0, s39, 65536
s_mov_b32 s37, 6848512
buffer_load_dwordx4 v21, s[8:11], s37 offen sc1 lds
s_add_u32 m0, s39, 66560
s_mov_b32 s37, 6864896
buffer_load_dwordx4 v21, s[8:11], s37 offen sc1 lds
s_add_u32 m0, s39, 67584
s_mov_b32 s37, 6881280
buffer_load_dwordx4 v21, s[8:11], s37 offen sc1 lds
s_add_u32 m0, s39, 68608
s_mov_b32 s37, 6897664
buffer_load_dwordx4 v21, s[8:11], s37 offen sc1 lds
s_add_u32 m0, s39, 69632
s_mov_b32 s37, 6815744
buffer_load_dwordx4 v21, s[8:11], s37 offen sc1 lds
s_add_u32 m0, s39, 70656
s_mov_b32 s37, 6914048
buffer_load_dwordx4 v21, s[8:11], s37 offen sc1 lds
s_add_u32 m0, s39, 71680
s_mov_b32 s37, 6832128
buffer_load_dwordx4 v21, s[8:11], s37 offen sc1 lds
s_add_u32 m0, s39, 72704
s_mov_b32 s37, 6930432
buffer_load_dwordx4 v21, s[8:11], s37 offen sc1 lds
s_waitcnt vmcnt(16)
s_barrier
s_add_u32 m0, s39, 98304
s_mov_b32 s37, 6946816
buffer_load_dwordx4 v21, s[8:11], s37 offen sc1 lds
s_add_u32 m0, s39, 99328
s_mov_b32 s37, 6963200
buffer_load_dwordx4 v21, s[8:11], s37 offen sc1 lds
s_add_u32 m0, s39, 100352
s_mov_b32 s37, 6979584
buffer_load_dwordx4 v21, s[8:11], s37 offen sc1 lds
s_add_u32 m0, s39, 101376
s_mov_b32 s37, 6995968
buffer_load_dwordx4 v21, s[8:11], s37 offen sc1 lds
s_add_u32 m0, s39, 102400
s_mov_b32 s37, 7045120
buffer_load_dwordx4 v21, s[8:11], s37 offen sc1 lds
s_add_u32 m0, s39, 103424
s_mov_b32 s37, 7061504
buffer_load_dwordx4 v21, s[8:11], s37 offen sc1 lds
s_add_u32 m0, s39, 104448
s_mov_b32 s37, 7077888
buffer_load_dwordx4 v21, s[8:11], s37 offen sc1 lds
s_add_u32 m0, s39, 105472
s_mov_b32 s37, 7094272
buffer_load_dwordx4 v21, s[8:11], s37 offen sc1 lds
s_waitcnt vmcnt(16)
s_barrier
s_add_u32 m0, s39, 0
s_mov_b32 s37, 7012352
buffer_load_dwordx4 v21, s[8:11], s37 offen sc1 lds
s_add_u32 m0, s39, 1024
s_mov_b32 s37, 7110656
buffer_load_dwordx4 v21, s[8:11], s37 offen sc1 lds
s_add_u32 m0, s39, 2048
s_mov_b32 s37, 7028736
buffer_load_dwordx4 v21, s[8:11], s37 offen sc1 lds
s_add_u32 m0, s39, 3072
s_mov_b32 s37, 7127040
buffer_load_dwordx4 v21, s[8:11], s37 offen sc1 lds
s_add_u32 m0, s39, 4096
s_mov_b32 s37, 7143424
buffer_load_dwordx4 v21, s[8:11], s37 offen sc1 lds
s_add_u32 m0, s39, 5120
s_mov_b32 s37, 7159808
buffer_load_dwordx4 v21, s[8:11], s37 offen sc1 lds
s_add_u32 m0, s39, 6144
s_mov_b32 s37, 7176192
buffer_load_dwordx4 v21, s[8:11], s37 offen sc1 lds
s_add_u32 m0, s39, 7168
s_mov_b32 s37, 7192576
buffer_load_dwordx4 v21, s[8:11], s37 offen sc1 lds
s_waitcnt vmcnt(16)
s_barrier
s_add_u32 m0, s39, 32768
s_mov_b32 s37, 7241728
buffer_load_dwordx4 v21, s[8:11], s37 offen sc1 lds
s_add_u32 m0, s39, 33792
s_mov_b32 s37, 7258112
buffer_load_dwordx4 v21, s[8:11], s37 offen sc1 lds
s_add_u32 m0, s39, 34816
s_mov_b32 s37, 7274496
buffer_load_dwordx4 v21, s[8:11], s37 offen sc1 lds
s_add_u32 m0, s39, 35840
s_mov_b32 s37, 7290880
buffer_load_dwordx4 v21, s[8:11], s37 offen sc1 lds
s_add_u32 m0, s39, 36864
s_mov_b32 s37, 7208960
buffer_load_dwordx4 v21, s[8:11], s37 offen sc1 lds
s_add_u32 m0, s39, 37888
s_mov_b32 s37, 7307264
buffer_load_dwordx4 v21, s[8:11], s37 offen sc1 lds
s_add_u32 m0, s39, 38912
s_mov_b32 s37, 7225344
buffer_load_dwordx4 v21, s[8:11], s37 offen sc1 lds
s_add_u32 m0, s39, 39936
s_mov_b32 s37, 7323648
buffer_load_dwordx4 v21, s[8:11], s37 offen sc1 lds
s_waitcnt vmcnt(16)
s_barrier
s_waitcnt vmcnt(8)
s_barrier
s_waitcnt vmcnt(0)
s_barrier
s_branch Ldone_1
.p2align 6
Lw_78:
s_branch Lr_79
s_nop 0
.p2align 3
L7b_103:
v_mfma_f32_16x16x32_bf16 v[128:131], v[96:99], v[80:83], v[128:131]
v_mfma_f32_16x16x32_bf16 v[132:135], v[96:99], v[84:87], v[132:135]
v_mfma_f32_16x16x32_bf16 v[136:139], v[96:99], v[88:91], v[136:139]
v_mfma_f32_16x16x32_bf16 v[140:143], v[96:99], v[92:95], v[140:143]
v_mfma_f32_16x16x32_bf16 v[188:191], v[108:111], v[92:95], v[188:191]
v_mfma_f32_16x16x32_bf16 v[184:187], v[108:111], v[88:91], v[184:187]
v_mfma_f32_16x16x32_bf16 v[180:183], v[108:111], v[84:87], v[180:183]
v_mfma_f32_16x16x32_bf16 v[176:179], v[108:111], v[80:83], v[176:179]
v_mfma_f32_16x16x32_bf16 v[144:147], v[100:103], v[80:83], v[144:147]
v_mfma_f32_16x16x32_bf16 v[148:151], v[100:103], v[84:87], v[148:151]
v_mfma_f32_16x16x32_bf16 v[152:155], v[100:103], v[88:91], v[152:155]
v_mfma_f32_16x16x32_bf16 v[156:159], v[100:103], v[92:95], v[156:159]
v_mfma_f32_16x16x32_bf16 v[204:207], v[112:115], v[92:95], v[204:207]
v_mfma_f32_16x16x32_bf16 v[200:203], v[112:115], v[88:91], v[200:203]
v_mfma_f32_16x16x32_bf16 v[196:199], v[112:115], v[84:87], v[196:199]
v_mfma_f32_16x16x32_bf16 v[192:195], v[112:115], v[80:83], v[192:195]
v_mfma_f32_16x16x32_bf16 v[160:163], v[104:107], v[80:83], v[160:163]
v_mfma_f32_16x16x32_bf16 v[164:167], v[104:107], v[84:87], v[164:167]
v_mfma_f32_16x16x32_bf16 v[168:171], v[104:107], v[88:91], v[168:171]
v_mfma_f32_16x16x32_bf16 v[172:175], v[104:107], v[92:95], v[172:175]
v_mfma_f32_16x16x32_bf16 v[220:223], v[116:119], v[92:95], v[220:223]
v_mfma_f32_16x16x32_bf16 v[216:219], v[116:119], v[88:91], v[216:219]
v_mfma_f32_16x16x32_bf16 v[212:215], v[116:119], v[84:87], v[212:215]
v_mfma_f32_16x16x32_bf16 v[208:211], v[116:119], v[80:83], v[208:211]
s_mul_i32 s43, s38, 32
s_add_u32 s37, s37, s43
s_setprio 0
s_barrier
s_mov_b32 s80, s60
s_mov_b32 s81, s61
s_mov_b32 s82, 7340032
s_mov_b32 s83, 0x20000
v_and_b32 v29, 31, v1
v_lshlrev_b32 v29, 11, v29
s_and_b32 s43, s35, 8
s_or_b32 s43, s43, 3
s_lshl_b32 s43, s43, 7
v_add_u32 v29, s43, v29
s_add_u32 s37, s37, s54
s_add_u32 m0, s39, 65536
s_add_u32 s37, s37, s40
buffer_load_dwordx4 v21, s[8:11], s37 offen sc1 lds
v_mul_f32 v80, v128, v128
v_mul_f32 v81, v129, v129
v_mul_f32 v82, v130, v130
v_mul_f32 v83, v131, v131
v_fma_f32 v80, v80, v232, v228
v_fma_f32 v81, v81, v232, v228
v_fma_f32 v82, v82, v232, v228
s_add_u32 m0, s39, 66560
s_add_u32 s37, s37, s38
buffer_load_dwordx4 v21, s[8:11], s37 offen sc1 lds
v_fma_f32 v83, v83, v232, v228
v_mul_f32 v80, v80, v128
v_mul_f32 v81, v81, v129
v_mul_f32 v82, v82, v130
v_mul_f32 v83, v83, v131
v_exp_f32 v80, v80
s_add_u32 m0, s39, 67584
s_add_u32 s37, s37, s38
buffer_load_dwordx4 v21, s[8:11], s37 offen sc1 lds
v_exp_f32 v81, v81
v_exp_f32 v82, v82
v_exp_f32 v83, v83
v_mul_f32 v176, v128, v176
v_mul_f32 v177, v129, v177
v_mul_f32 v178, v130, v178
v_mul_f32 v179, v131, v179
s_add_u32 m0, s39, 68608
s_add_u32 s37, s37, s38
buffer_load_dwordx4 v21, s[8:11], s37 offen sc1 lds
v_fma_f32 v80, v80, v236, v236
v_fma_f32 v81, v81, v236, v236
v_fma_f32 v82, v82, v236, v236
v_fma_f32 v83, v83, v236, v236
v_rcp_f32 v80, v80
v_rcp_f32 v81, v81
s_add_u32 m0, s39, 69632
s_add_u32 s37, s37, s55
buffer_load_dwordx4 v21, s[8:11], s37 offen sc1 lds
v_rcp_f32 v82, v82
v_rcp_f32 v83, v83
v_mul_f32 v176, v176, v80
v_mul_f32 v177, v177, v81
v_mul_f32 v178, v178, v82
v_mul_f32 v179, v179, v83
v_cvt_pk_bf16_f32 v96, v176, v177
s_add_u32 m0, s39, 70656
s_add_u32 s37, s37, s38
buffer_load_dwordx4 v21, s[8:11], s37 offen sc1 lds
v_cvt_pk_bf16_f32 v97, v178, v179
v_mul_f32 v84, v144, v144
v_mul_f32 v85, v145, v145
v_mul_f32 v86, v146, v146
v_mul_f32 v87, v147, v147
v_fma_f32 v84, v84, v232, v228
s_add_u32 m0, s39, 71680
s_add_u32 s37, s37, s38
buffer_load_dwordx4 v21, s[8:11], s37 offen sc1 lds
v_fma_f32 v85, v85, v232, v228
v_fma_f32 v86, v86, v232, v228
v_fma_f32 v87, v87, v232, v228
v_mul_f32 v84, v84, v144
v_mul_f32 v85, v85, v145
v_mul_f32 v86, v86, v146
v_mul_f32 v87, v87, v147
s_add_u32 m0, s39, 72704
s_add_u32 s37, s37, s38
buffer_load_dwordx4 v21, s[8:11], s37 offen sc1 lds
v_exp_f32 v84, v84
v_exp_f32 v85, v85
v_exp_f32 v86, v86
v_exp_f32 v87, v87
v_mul_f32 v192, v144, v192
v_mul_f32 v193, v145, v193
s_barrier
s_lshr_b32 s44, s2, 3
s_lshl_b32 s44, s44, 17
s_add_u32 s43, s44, 65536
buffer_load_dword v30, v29, s[80:83], s43 offen
s_add_u32 m0, s39, 98304
s_add_u32 s37, s37, s40
buffer_load_dwordx4 v21, s[8:11], s37 offen sc1 lds
v_mul_f32 v194, v146, v194
v_mul_f32 v195, v147, v195
v_fma_f32 v84, v84, v236, v236
v_fma_f32 v85, v85, v236, v236
v_fma_f32 v86, v86, v236, v236
v_fma_f32 v87, v87, v236, v236
v_rcp_f32 v84, v84
s_add_u32 m0, s39, 99328
s_add_u32 s37, s37, s38
buffer_load_dwordx4 v21, s[8:11], s37 offen sc1 lds
v_rcp_f32 v85, v85
v_rcp_f32 v86, v86
v_rcp_f32 v87, v87
v_mul_f32 v192, v192, v84
v_mul_f32 v193, v193, v85
v_mul_f32 v194, v194, v86
v_mul_f32 v195, v195, v87
s_add_u32 m0, s39, 100352
s_add_u32 s37, s37, s38
buffer_load_dwordx4 v21, s[8:11], s37 offen sc1 lds
v_cvt_pk_bf16_f32 v98, v192, v193
v_cvt_pk_bf16_f32 v99, v194, v195
v_mul_f32 v80, v160, v160
v_mul_f32 v81, v161, v161
v_mul_f32 v82, v162, v162
s_add_u32 m0, s39, 101376
s_add_u32 s37, s37, s38
buffer_load_dwordx4 v21, s[8:11], s37 offen sc1 lds
v_mul_f32 v83, v163, v163
v_fma_f32 v80, v80, v232, v228
v_fma_f32 v81, v81, v232, v228
v_fma_f32 v82, v82, v232, v228
v_fma_f32 v83, v83, v232, v228
v_mul_f32 v80, v80, v160
v_mul_f32 v81, v81, v161
s_add_u32 m0, s39, 102400
s_add_u32 s37, s37, s55
buffer_load_dwordx4 v21, s[8:11], s37 offen sc1 lds
v_mul_f32 v82, v82, v162
v_mul_f32 v83, v83, v163
v_exp_f32 v80, v80
v_exp_f32 v81, v81
v_exp_f32 v82, v82
v_exp_f32 v83, v83
v_mul_f32 v208, v160, v208
s_add_u32 m0, s39, 103424
s_add_u32 s37, s37, s38
buffer_load_dwordx4 v21, s[8:11], s37 offen sc1 lds
v_mul_f32 v209, v161, v209
v_mul_f32 v210, v162, v210
v_mul_f32 v211, v163, v211
v_fma_f32 v80, v80, v236, v236
v_fma_f32 v81, v81, v236, v236
v_fma_f32 v82, v82, v236, v236
s_add_u32 m0, s39, 104448
s_add_u32 s37, s37, s38
buffer_load_dwordx4 v21, s[8:11], s37 offen sc1 lds
v_fma_f32 v83, v83, v236, v236
v_rcp_f32 v80, v80
v_rcp_f32 v81, v81
v_rcp_f32 v82, v82
v_rcp_f32 v83, v83
v_mul_f32 v208, v208, v80
v_mul_f32 v209, v209, v81
s_add_u32 m0, s39, 105472
s_add_u32 s37, s37, s38
buffer_load_dwordx4 v21, s[8:11], s37 offen sc1 lds
v_mul_f32 v210, v210, v82
v_mul_f32 v211, v211, v83
v_cvt_pk_bf16_f32 v112, v208, v209
v_cvt_pk_bf16_f32 v113, v210, v211
v_mul_f32 v80, v132, v132
v_mul_f32 v81, v133, v133
buffer_store_dwordx4 v[96:99], v27, s[24:27], 0 offen offset:0 sc1
s_barrier
s_add_u32 m0, s39, 0
s_add_u32 s37, s37, s40
buffer_load_dwordx4 v21, s[8:11], s37 offen sc1 lds
v_mul_f32 v82, v134, v134
v_mul_f32 v83, v135, v135
v_fma_f32 v80, v80, v233, v229
v_fma_f32 v81, v81, v233, v229
v_fma_f32 v82, v82, v233, v229
v_fma_f32 v83, v83, v233, v229
v_mul_f32 v80, v80, v132
s_add_u32 m0, s39, 1024
s_add_u32 s37, s37, s38
buffer_load_dwordx4 v21, s[8:11], s37 offen sc1 lds
v_mul_f32 v81, v81, v133
v_mul_f32 v82, v82, v134
v_mul_f32 v83, v83, v135
v_exp_f32 v80, v80
v_exp_f32 v81, v81
v_exp_f32 v82, v82
s_add_u32 m0, s39, 2048
s_add_u32 s37, s37, s38
buffer_load_dwordx4 v21, s[8:11], s37 offen sc1 lds
v_exp_f32 v83, v83
v_mul_f32 v180, v132, v180
v_mul_f32 v181, v133, v181
v_mul_f32 v182, v134, v182
v_mul_f32 v183, v135, v183
v_fma_f32 v80, v80, v237, v237
v_fma_f32 v81, v81, v237, v237
s_add_u32 m0, s39, 3072
s_add_u32 s37, s37, s38
buffer_load_dwordx4 v21, s[8:11], s37 offen sc1 lds
v_fma_f32 v82, v82, v237, v237
v_fma_f32 v83, v83, v237, v237
v_rcp_f32 v80, v80
v_rcp_f32 v81, v81
v_rcp_f32 v82, v82
v_rcp_f32 v83, v83
s_add_u32 m0, s39, 4096
s_add_u32 s37, s37, s55
buffer_load_dwordx4 v21, s[8:11], s37 offen sc1 lds
v_mul_f32 v180, v180, v80
v_mul_f32 v181, v181, v81
v_mul_f32 v182, v182, v82
v_mul_f32 v183, v183, v83
v_cvt_pk_bf16_f32 v100, v180, v181
v_cvt_pk_bf16_f32 v101, v182, v183
v_mul_f32 v84, v148, v148
s_add_u32 m0, s39, 5120
s_add_u32 s37, s37, s38
buffer_load_dwordx4 v21, s[8:11], s37 offen sc1 lds
v_mul_f32 v85, v149, v149
v_mul_f32 v86, v150, v150
v_mul_f32 v87, v151, v151
v_fma_f32 v84, v84, v233, v229
v_fma_f32 v85, v85, v233, v229
v_fma_f32 v86, v86, v233, v229
s_add_u32 m0, s39, 6144
s_add_u32 s37, s37, s38
buffer_load_dwordx4 v21, s[8:11], s37 offen sc1 lds
v_fma_f32 v87, v87, v233, v229
v_mul_f32 v84, v84, v148
v_mul_f32 v85, v85, v149
v_mul_f32 v86, v86, v150
v_mul_f32 v87, v87, v151
v_exp_f32 v84, v84
v_exp_f32 v85, v85
s_add_u32 m0, s39, 7168
s_add_u32 s37, s37, s38
buffer_load_dwordx4 v21, s[8:11], s37 offen sc1 lds
v_exp_f32 v86, v86
v_exp_f32 v87, v87
v_mul_f32 v196, v148, v196
v_mul_f32 v197, v149, v197
v_mul_f32 v198, v150, v198
v_mul_f32 v199, v151, v199
s_waitcnt vmcnt(18)
s_barrier
s_add_u32 s43, s34, 48
s_lshl_b32 s43, s43, 7
v_mov_b32 v10, s43
v_mov_b32 v12, 16
buffer_load_dword v11, v10, s[56:59], 0 offen sc1
s_add_u32 m0, s39, 32768
s_add_u32 s37, s37, s40
buffer_load_dwordx4 v21, s[8:11], s37 offen sc1 lds
v_fma_f32 v84, v84, v237, v237
v_fma_f32 v85, v85, v237, v237
v_fma_f32 v86, v86, v237, v237
v_fma_f32 v87, v87, v237, v237
v_rcp_f32 v84, v84
v_rcp_f32 v85, v85
v_rcp_f32 v86, v86
s_add_u32 m0, s39, 33792
s_add_u32 s37, s37, s38
buffer_load_dwordx4 v21, s[8:11], s37 offen sc1 lds
v_rcp_f32 v87, v87
v_mul_f32 v196, v196, v84
v_mul_f32 v197, v197, v85
v_mul_f32 v198, v198, v86
v_mul_f32 v199, v199, v87
v_cvt_pk_bf16_f32 v102, v196, v197
v_cvt_pk_bf16_f32 v103, v198, v199
s_add_u32 m0, s39, 34816
s_add_u32 s37, s37, s38
buffer_load_dwordx4 v21, s[8:11], s37 offen sc1 lds
v_mul_f32 v80, v164, v164
v_mul_f32 v81, v165, v165
v_mul_f32 v82, v166, v166
v_mul_f32 v83, v167, v167
v_fma_f32 v80, v80, v233, v229
s_add_u32 m0, s39, 35840
s_add_u32 s37, s37, s38
buffer_load_dwordx4 v21, s[8:11], s37 offen sc1 lds
v_fma_f32 v81, v81, v233, v229
v_fma_f32 v82, v82, v233, v229
v_fma_f32 v83, v83, v233, v229
v_mul_f32 v80, v80, v164
v_mul_f32 v81, v81, v165
v_mul_f32 v82, v82, v166
v_mul_f32 v83, v83, v167
s_add_u32 m0, s39, 36864
s_add_u32 s37, s37, s55
buffer_load_dwordx4 v21, s[8:11], s37 offen sc1 lds
v_exp_f32 v80, v80
v_exp_f32 v81, v81
v_exp_f32 v82, v82
v_exp_f32 v83, v83
v_mul_f32 v212, v164, v212
v_mul_f32 v213, v165, v213
v_mul_f32 v214, v166, v214
s_add_u32 m0, s39, 37888
s_add_u32 s37, s37, s38
buffer_load_dwordx4 v21, s[8:11], s37 offen sc1 lds
v_mul_f32 v215, v167, v215
v_fma_f32 v80, v80, v237, v237
v_fma_f32 v81, v81, v237, v237
v_fma_f32 v82, v82, v237, v237
v_fma_f32 v83, v83, v237, v237
v_rcp_f32 v80, v80
s_add_u32 m0, s39, 38912
s_add_u32 s37, s37, s38
buffer_load_dwordx4 v21, s[8:11], s37 offen sc1 lds
v_rcp_f32 v81, v81
v_rcp_f32 v82, v82
v_rcp_f32 v83, v83
v_mul_f32 v212, v212, v80
v_mul_f32 v213, v213, v81
v_mul_f32 v214, v214, v82
v_mul_f32 v215, v215, v83
s_add_u32 m0, s39, 39936
s_add_u32 s37, s37, s38
buffer_load_dwordx4 v21, s[8:11], s37 offen sc1 lds
v_cvt_pk_bf16_f32 v114, v212, v213
v_cvt_pk_bf16_f32 v115, v214, v215
s_nop 1
v_permlane32_swap_b32 v112, v114
v_permlane32_swap_b32 v113, v115
buffer_store_dwordx4 v[100:103], v27, s[24:27], 0 offen offset:256 sc1
buffer_store_dwordx4 v[112:115], v28, s[24:27], 0 offen offset:0 sc1
s_waitcnt vmcnt(20)
s_barrier
s_add_u32 m0, s39, 65536
s_add_u32 s37, s37, s40
buffer_load_dwordx4 v21, s[8:11], s37 offen sc1 lds
v_mul_f32 v80, v136, v136
v_mul_f32 v81, v137, v137
v_mul_f32 v82, v138, v138
v_mul_f32 v83, v139, v139
v_fma_f32 v80, v80, v234, v230
v_fma_f32 v81, v81, v234, v230
v_fma_f32 v82, v82, v234, v230
s_add_u32 m0, s39, 66560
s_add_u32 s37, s37, s38
buffer_load_dwordx4 v21, s[8:11], s37 offen sc1 lds
v_fma_f32 v83, v83, v234, v230
v_mul_f32 v80, v80, v136
v_mul_f32 v81, v81, v137
v_mul_f32 v82, v82, v138
v_mul_f32 v83, v83, v139
v_exp_f32 v80, v80
s_add_u32 m0, s39, 67584
s_add_u32 s37, s37, s38
buffer_load_dwordx4 v21, s[8:11], s37 offen sc1 lds
v_exp_f32 v81, v81
v_exp_f32 v82, v82
v_exp_f32 v83, v83
v_mul_f32 v184, v136, v184
v_mul_f32 v185, v137, v185
v_mul_f32 v186, v138, v186
v_mul_f32 v187, v139, v187
s_add_u32 m0, s39, 68608
s_add_u32 s37, s37, s38
buffer_load_dwordx4 v21, s[8:11], s37 offen sc1 lds
v_fma_f32 v80, v80, v238, v238
v_fma_f32 v81, v81, v238, v238
v_fma_f32 v82, v82, v238, v238
v_fma_f32 v83, v83, v238, v238
v_rcp_f32 v80, v80
v_rcp_f32 v81, v81
s_add_u32 m0, s39, 69632
s_add_u32 s37, s37, s55
buffer_load_dwordx4 v21, s[8:11], s37 offen sc1 lds
v_rcp_f32 v82, v82
v_rcp_f32 v83, v83
v_mul_f32 v184, v184, v80
v_mul_f32 v185, v185, v81
v_mul_f32 v186, v186, v82
v_mul_f32 v187, v187, v83
v_cvt_pk_bf16_f32 v104, v184, v185
s_add_u32 m0, s39, 70656
s_add_u32 s37, s37, s38
buffer_load_dwordx4 v21, s[8:11], s37 offen sc1 lds
v_cvt_pk_bf16_f32 v105, v186, v187
v_mul_f32 v84, v152, v152
v_mul_f32 v85, v153, v153
v_mul_f32 v86, v154, v154
v_mul_f32 v87, v155, v155
v_fma_f32 v84, v84, v234, v230
s_add_u32 m0, s39, 71680
s_add_u32 s37, s37, s38
buffer_load_dwordx4 v21, s[8:11], s37 offen sc1 lds
v_fma_f32 v85, v85, v234, v230
v_fma_f32 v86, v86, v234, v230
v_fma_f32 v87, v87, v234, v230
v_mul_f32 v84, v84, v152
v_mul_f32 v85, v85, v153
v_mul_f32 v86, v86, v154
v_mul_f32 v87, v87, v155
s_add_u32 m0, s39, 72704
s_add_u32 s37, s37, s38
buffer_load_dwordx4 v21, s[8:11], s37 offen sc1 lds
v_exp_f32 v84, v84
v_exp_f32 v85, v85
v_exp_f32 v86, v86
v_exp_f32 v87, v87
v_mul_f32 v200, v152, v200
v_mul_f32 v201, v153, v201
s_waitcnt vmcnt(19)
s_barrier
s_add_u32 m0, s39, 98304
s_add_u32 s37, s37, s40
buffer_load_dwordx4 v21, s[8:11], s37 offen sc1 lds
v_mul_f32 v202, v154, v202
v_mul_f32 v203, v155, v203
v_fma_f32 v84, v84, v238, v238
v_fma_f32 v85, v85, v238, v238
v_fma_f32 v86, v86, v238, v238
v_fma_f32 v87, v87, v238, v238
v_rcp_f32 v84, v84
s_add_u32 m0, s39, 99328
s_add_u32 s37, s37, s38
buffer_load_dwordx4 v21, s[8:11], s37 offen sc1 lds
v_rcp_f32 v85, v85
v_rcp_f32 v86, v86
v_rcp_f32 v87, v87
v_mul_f32 v200, v200, v84
v_mul_f32 v201, v201, v85
v_mul_f32 v202, v202, v86
v_mul_f32 v203, v203, v87
s_add_u32 m0, s39, 100352
s_add_u32 s37, s37, s38
buffer_load_dwordx4 v21, s[8:11], s37 offen sc1 lds
v_cvt_pk_bf16_f32 v106, v200, v201
v_cvt_pk_bf16_f32 v107, v202, v203
v_mul_f32 v80, v168, v168
v_mul_f32 v81, v169, v169
v_mul_f32 v82, v170, v170
s_add_u32 m0, s39, 101376
s_add_u32 s37, s37, s38
buffer_load_dwordx4 v21, s[8:11], s37 offen sc1 lds
v_mul_f32 v83, v171, v171
v_fma_f32 v80, v80, v234, v230
v_fma_f32 v81, v81, v234, v230
v_fma_f32 v82, v82, v234, v230
v_fma_f32 v83, v83, v234, v230
v_mul_f32 v80, v80, v168
v_mul_f32 v81, v81, v169
s_add_u32 m0, s39, 102400
s_add_u32 s37, s37, s55
buffer_load_dwordx4 v21, s[8:11], s37 offen sc1 lds
v_mul_f32 v82, v82, v170
v_mul_f32 v83, v83, v171
v_exp_f32 v80, v80
v_exp_f32 v81, v81
v_exp_f32 v82, v82
v_exp_f32 v83, v83
v_mul_f32 v216, v168, v216
s_add_u32 m0, s39, 103424
s_add_u32 s37, s37, s38
buffer_load_dwordx4 v21, s[8:11], s37 offen sc1 lds
v_mul_f32 v217, v169, v217
v_mul_f32 v218, v170, v218
v_mul_f32 v219, v171, v219
v_fma_f32 v80, v80, v238, v238
v_fma_f32 v81, v81, v238, v238
v_fma_f32 v82, v82, v238, v238
s_add_u32 m0, s39, 104448
s_add_u32 s37, s37, s38
buffer_load_dwordx4 v21, s[8:11], s37 offen sc1 lds
v_fma_f32 v83, v83, v238, v238
v_rcp_f32 v80, v80
v_rcp_f32 v81, v81
v_rcp_f32 v82, v82
v_rcp_f32 v83, v83
v_mul_f32 v216, v216, v80
v_mul_f32 v217, v217, v81
s_add_u32 m0, s39, 105472
s_add_u32 s37, s37, s38
buffer_load_dwordx4 v21, s[8:11], s37 offen sc1 lds
v_mul_f32 v218, v218, v82
v_mul_f32 v219, v219, v83
v_cvt_pk_bf16_f32 v116, v216, v217
v_cvt_pk_bf16_f32 v117, v218, v219
v_mul_f32 v80, v140, v140
v_mul_f32 v81, v141, v141
buffer_store_dwordx4 v[104:107], v27, s[24:27], 0 offen offset:512 sc1
s_waitcnt vmcnt(19)
s_mov_b32 s41, 0x10000
s_waitcnt vmcnt(27)
s_branch Lpf_107
Lpoll_105:
s_waitcnt vmcnt(0)
Lpf_107:
v_cmp_ne_u32 vcc, v12, v11
s_nop 4
s_cbranch_vccz Lpok_106
buffer_load_dword v11, v10, s[56:59], 0 offen sc1
s_sub_u32 s41, s41, 1
s_cmp_lg_u32 s41, 0
s_cbranch_scc1 Lpoll_105
s_waitcnt vmcnt(0)
Lpok_106:
s_barrier
s_add_u32 s37, s37, s29
s_add_u32 m0, s39, 0
s_add_u32 s37, s37, s40
buffer_load_dwordx4 v21, s[8:11], s37 offen sc1 lds
v_mul_f32 v82, v142, v142
v_mul_f32 v83, v143, v143
v_fma_f32 v80, v80, v235, v231
v_fma_f32 v81, v81, v235, v231
v_fma_f32 v82, v82, v235, v231
v_fma_f32 v83, v83, v235, v231
v_mul_f32 v80, v80, v140
s_add_u32 m0, s39, 1024
s_add_u32 s37, s37, s38
buffer_load_dwordx4 v21, s[8:11], s37 offen sc1 lds
v_mul_f32 v81, v81, v141
v_mul_f32 v82, v82, v142
v_mul_f32 v83, v83, v143
v_exp_f32 v80, v80
v_exp_f32 v81, v81
v_exp_f32 v82, v82
s_add_u32 m0, s39, 2048
s_add_u32 s37, s37, s38
buffer_load_dwordx4 v21, s[8:11], s37 offen sc1 lds
v_exp_f32 v83, v83
v_mul_f32 v188, v140, v188
v_mul_f32 v189, v141, v189
v_mul_f32 v190, v142, v190
v_mul_f32 v191, v143, v191
v_fma_f32 v80, v80, v239, v239
v_fma_f32 v81, v81, v239, v239
s_add_u32 m0, s39, 3072
s_add_u32 s37, s37, s38
buffer_load_dwordx4 v21, s[8:11], s37 offen sc1 lds
v_fma_f32 v82, v82, v239, v239
v_fma_f32 v83, v83, v239, v239
v_rcp_f32 v80, v80
v_rcp_f32 v81, v81
v_rcp_f32 v82, v82
v_rcp_f32 v83, v83
s_add_u32 m0, s39, 4096
s_add_u32 s37, s37, s55
buffer_load_dwordx4 v21, s[8:11], s37 offen sc1 lds
v_mul_f32 v188, v188, v80
v_mul_f32 v189, v189, v81
v_mul_f32 v190, v190, v82
v_mul_f32 v191, v191, v83
v_cvt_pk_bf16_f32 v108, v188, v189
v_cvt_pk_bf16_f32 v109, v190, v191
v_mul_f32 v84, v156, v156
s_add_u32 m0, s39, 5120
s_add_u32 s37, s37, s38
buffer_load_dwordx4 v21, s[8:11], s37 offen sc1 lds
v_mul_f32 v85, v157, v157
v_mul_f32 v86, v158, v158
v_mul_f32 v87, v159, v159
v_fma_f32 v84, v84, v235, v231
v_fma_f32 v85, v85, v235, v231
v_fma_f32 v86, v86, v235, v231
s_add_u32 m0, s39, 6144
s_add_u32 s37, s37, s38
buffer_load_dwordx4 v21, s[8:11], s37 offen sc1 lds
v_fma_f32 v87, v87, v235, v231
v_mul_f32 v84, v84, v156
v_mul_f32 v85, v85, v157
v_mul_f32 v86, v86, v158
v_mul_f32 v87, v87, v159
v_exp_f32 v84, v84
v_exp_f32 v85, v85
s_add_u32 m0, s39, 7168
s_add_u32 s37, s37, s38
buffer_load_dwordx4 v21, s[8:11], s37 offen sc1 lds
v_exp_f32 v86, v86
v_exp_f32 v87, v87
v_mul_f32 v204, v156, v204
v_mul_f32 v205, v157, v205
v_mul_f32 v206, v158, v206
v_mul_f32 v207, v159, v207
s_waitcnt vmcnt(17)
s_barrier
s_add_u32 m0, s39, 32768
s_add_u32 s37, s37, s40
buffer_load_dwordx4 v21, s[8:11], s37 offen sc1 lds
v_fma_f32 v84, v84, v239, v239
v_fma_f32 v85, v85, v239, v239
v_fma_f32 v86, v86, v239, v239
v_fma_f32 v87, v87, v239, v239
v_rcp_f32 v84, v84
v_rcp_f32 v85, v85
v_rcp_f32 v86, v86
s_add_u32 m0, s39, 33792
s_add_u32 s37, s37, s38
buffer_load_dwordx4 v21, s[8:11], s37 offen sc1 lds
v_rcp_f32 v87, v87
v_mul_f32 v204, v204, v84
v_mul_f32 v205, v205, v85
v_mul_f32 v206, v206, v86
v_mul_f32 v207, v207, v87
v_cvt_pk_bf16_f32 v110, v204, v205
v_cvt_pk_bf16_f32 v111, v206, v207
s_add_u32 m0, s39, 34816
s_add_u32 s37, s37, s38
buffer_load_dwordx4 v21, s[8:11], s37 offen sc1 lds
v_mul_f32 v80, v172, v172
v_mul_f32 v81, v173, v173
v_mul_f32 v82, v174, v174
v_mul_f32 v83, v175, v175
v_fma_f32 v80, v80, v235, v231
s_add_u32 m0, s39, 35840
s_add_u32 s37, s37, s38
buffer_load_dwordx4 v21, s[8:11], s37 offen sc1 lds
v_fma_f32 v81, v81, v235, v231
v_fma_f32 v82, v82, v235, v231
v_fma_f32 v83, v83, v235, v231
v_mul_f32 v80, v80, v172
v_mul_f32 v81, v81, v173
v_mul_f32 v82, v82, v174
v_mul_f32 v83, v83, v175
s_add_u32 m0, s39, 36864
s_add_u32 s37, s37, s55
buffer_load_dwordx4 v21, s[8:11], s37 offen sc1 lds
v_exp_f32 v80, v80
v_exp_f32 v81, v81
v_exp_f32 v82, v82
v_exp_f32 v83, v83
v_mul_f32 v220, v172, v220
v_mul_f32 v221, v173, v221
v_mul_f32 v222, v174, v222
s_add_u32 m0, s39, 37888
s_add_u32 s37, s37, s38
buffer_load_dwordx4 v21, s[8:11], s37 offen sc1 lds
v_mul_f32 v223, v175, v223
v_fma_f32 v80, v80, v239, v239
v_fma_f32 v81, v81, v239, v239
v_fma_f32 v82, v82, v239, v239
v_fma_f32 v83, v83, v239, v239
v_rcp_f32 v80, v80
s_add_u32 m0, s39, 38912
s_add_u32 s37, s37, s38
buffer_load_dwordx4 v21, s[8:11], s37 offen sc1 lds
v_rcp_f32 v81, v81
v_rcp_f32 v82, v82
v_rcp_f32 v83, v83
v_mul_f32 v220, v220, v80
v_mul_f32 v221, v221, v81
v_mul_f32 v222, v222, v82
v_mul_f32 v223, v223, v83
s_add_u32 m0, s39, 39936
s_add_u32 s37, s37, s38
buffer_load_dwordx4 v21, s[8:11], s37 offen sc1 lds
v_cvt_pk_bf16_f32 v118, v220, v221
v_cvt_pk_bf16_f32 v119, v222, v223
s_nop 1
v_permlane32_swap_b32 v116, v118
v_permlane32_swap_b32 v117, v119
buffer_store_dwordx4 v[108:111], v27, s[24:27], 0 offen offset:768 sc1
buffer_store_dwordx4 v[116:119], v28, s[24:27], 0 offen offset:512 sc1
s_waitcnt vmcnt(19)
s_barrier
s_add_u32 m0, s39, 65536
s_add_u32 s37, s37, s40
buffer_load_dwordx4 v21, s[8:11], s37 offen sc1 lds
s_add_u32 m0, s39, 66560
s_add_u32 s37, s37, s38
buffer_load_dwordx4 v21, s[8:11], s37 offen sc1 lds
s_add_u32 m0, s39, 67584
s_add_u32 s37, s37, s38
buffer_load_dwordx4 v21, s[8:11], s37 offen sc1 lds
s_add_u32 m0, s39, 68608
s_add_u32 s37, s37, s38
buffer_load_dwordx4 v21, s[8:11], s37 offen sc1 lds
s_add_u32 m0, s39, 69632
s_add_u32 s37, s37, s55
buffer_load_dwordx4 v21, s[8:11], s37 offen sc1 lds
s_add_u32 m0, s39, 70656
s_add_u32 s37, s37, s38
buffer_load_dwordx4 v21, s[8:11], s37 offen sc1 lds
s_add_u32 m0, s39, 71680
s_add_u32 s37, s37, s38
buffer_load_dwordx4 v21, s[8:11], s37 offen sc1 lds
s_add_u32 m0, s39, 72704
s_add_u32 s37, s37, s38
buffer_load_dwordx4 v21, s[8:11], s37 offen sc1 lds
s_waitcnt vmcnt(8)
s_barrier
s_add_u32 s43, s34, 64
s_lshl_b32 s43, s43, 7
v_mov_b32 v10, s43
v_mov_b32 v11, 1
s_mov_b64 exec, 1
buffer_atomic_add v11, v10, s[56:59], 0 offen sc1
s_mov_b64 exec, -1
s_add_u32 m0, s39, 98304
s_add_u32 s37, s37, s40
buffer_load_dwordx4 v21, s[8:11], s37 offen sc1 lds
s_add_u32 m0, s39, 99328
s_add_u32 s37, s37, s38
buffer_load_dwordx4 v21, s[8:11], s37 offen sc1 lds
s_add_u32 m0, s39, 100352
s_add_u32 s37, s37, s38
buffer_load_dwordx4 v21, s[8:11], s37 offen sc1 lds
s_add_u32 m0, s39, 101376
s_add_u32 s37, s37, s38
buffer_load_dwordx4 v21, s[8:11], s37 offen sc1 lds
s_add_u32 m0, s39, 102400
s_add_u32 s37, s37, s55
buffer_load_dwordx4 v21, s[8:11], s37 offen sc1 lds
s_add_u32 m0, s39, 103424
s_add_u32 s37, s37, s38
buffer_load_dwordx4 v21, s[8:11], s37 offen sc1 lds
s_add_u32 m0, s39, 104448
s_add_u32 s37, s37, s38
buffer_load_dwordx4 v21, s[8:11], s37 offen sc1 lds
s_add_u32 m0, s39, 105472
s_add_u32 s37, s37, s38
buffer_load_dwordx4 v21, s[8:11], s37 offen sc1 lds
s_waitcnt vmcnt(19)
s_barrier
s_lshr_b32 s44, s2, 3
s_lshl_b32 s44, s44, 16
s_add_u32 s43, s44, 4194304
buffer_load_dword v30, v29, s[80:83], s43 offen
s_add_u32 m0, s39, 0
s_add_u32 s37, s37, s40
buffer_load_dwordx4 v21, s[8:11], s37 offen sc1 lds
s_add_u32 m0, s39, 1024
s_add_u32 s37, s37, s38
buffer_load_dwordx4 v21, s[8:11], s37 offen sc1 lds
s_add_u32 m0, s39, 2048
s_add_u32 s37, s37, s38
buffer_load_dwordx4 v21, s[8:11], s37 offen sc1 lds
s_add_u32 m0, s39, 3072
s_add_u32 s37, s37, s38
buffer_load_dwordx4 v21, s[8:11], s37 offen sc1 lds
s_add_u32 m0, s39, 4096
s_add_u32 s37, s37, s55
buffer_load_dwordx4 v21, s[8:11], s37 offen sc1 lds
s_add_u32 m0, s39, 5120
s_add_u32 s37, s37, s38
buffer_load_dwordx4 v21, s[8:11], s37 offen sc1 lds
s_add_u32 m0, s39, 6144
s_add_u32 s37, s37, s38
buffer_load_dwordx4 v21, s[8:11], s37 offen sc1 lds
s_add_u32 m0, s39, 7168
s_add_u32 s37, s37, s38
buffer_load_dwordx4 v21, s[8:11], s37 offen sc1 lds
s_waitcnt vmcnt(18)
s_barrier
s_add_u32 s43, s34, 64
s_lshl_b32 s43, s43, 7
v_mov_b32 v10, s43
v_mov_b32 v12, 16
buffer_load_dword v11, v10, s[56:59], 0 offen sc1
s_add_u32 m0, s39, 32768
s_add_u32 s37, s37, s40
buffer_load_dwordx4 v21, s[8:11], s37 offen sc1 lds
s_add_u32 m0, s39, 33792
s_add_u32 s37, s37, s38
buffer_load_dwordx4 v21, s[8:11], s37 offen sc1 lds
s_add_u32 m0, s39, 34816
s_add_u32 s37, s37, s38
buffer_load_dwordx4 v21, s[8:11], s37 offen sc1 lds
s_add_u32 m0, s39, 35840
s_add_u32 s37, s37, s38
buffer_load_dwordx4 v21, s[8:11], s37 offen sc1 lds
s_add_u32 m0, s39, 36864
s_add_u32 s37, s37, s55
buffer_load_dwordx4 v21, s[8:11], s37 offen sc1 lds
s_add_u32 m0, s39, 37888
s_add_u32 s37, s37, s38
buffer_load_dwordx4 v21, s[8:11], s37 offen sc1 lds
s_add_u32 m0, s39, 38912
s_add_u32 s37, s37, s38
buffer_load_dwordx4 v21, s[8:11], s37 offen sc1 lds
s_add_u32 m0, s39, 39936
s_add_u32 s37, s37, s38
buffer_load_dwordx4 v21, s[8:11], s37 offen sc1 lds
s_waitcnt vmcnt(18)
s_barrier
s_add_u32 m0, s39, 65536
s_add_u32 s37, s37, s40
buffer_load_dwordx4 v21, s[8:11], s37 offen sc1 lds
s_add_u32 m0, s39, 66560
s_add_u32 s37, s37, s38
buffer_load_dwordx4 v21, s[8:11], s37 offen sc1 lds
s_add_u32 m0, s39, 67584
s_add_u32 s37, s37, s38
buffer_load_dwordx4 v21, s[8:11], s37 offen sc1 lds
s_add_u32 m0, s39, 68608
s_add_u32 s37, s37, s38
buffer_load_dwordx4 v21, s[8:11], s37 offen sc1 lds
s_add_u32 m0, s39, 69632
s_add_u32 s37, s37, s55
buffer_load_dwordx4 v21, s[8:11], s37 offen sc1 lds
s_add_u32 m0, s39, 70656
s_add_u32 s37, s37, s38
buffer_load_dwordx4 v21, s[8:11], s37 offen sc1 lds
s_add_u32 m0, s39, 71680
s_add_u32 s37, s37, s38
buffer_load_dwordx4 v21, s[8:11], s37 offen sc1 lds
s_add_u32 m0, s39, 72704
s_add_u32 s37, s37, s38
buffer_load_dwordx4 v21, s[8:11], s37 offen sc1 lds
s_waitcnt vmcnt(17)
s_barrier
s_branch Lw_108
Lr_109:
s_add_u32 m0, s39, 98304
s_add_u32 s37, s37, s40
buffer_load_dwordx4 v21, s[8:11], s37 offen sc1 lds
s_add_u32 m0, s39, 99328
s_add_u32 s37, s37, s38
buffer_load_dwordx4 v21, s[8:11], s37 offen sc1 lds
s_add_u32 m0, s39, 100352
s_add_u32 s37, s37, s38
buffer_load_dwordx4 v21, s[8:11], s37 offen sc1 lds
s_add_u32 m0, s39, 101376
s_add_u32 s37, s37, s38
buffer_load_dwordx4 v21, s[8:11], s37 offen sc1 lds
s_add_u32 m0, s39, 102400
s_add_u32 s37, s37, s55
buffer_load_dwordx4 v21, s[8:11], s37 offen sc1 lds
s_add_u32 m0, s39, 103424
s_add_u32 s37, s37, s38
buffer_load_dwordx4 v21, s[8:11], s37 offen sc1 lds
s_add_u32 m0, s39, 104448
s_add_u32 s37, s37, s38
buffer_load_dwordx4 v21, s[8:11], s37 offen sc1 lds
s_add_u32 m0, s39, 105472
s_add_u32 s37, s37, s38
buffer_load_dwordx4 v21, s[8:11], s37 offen sc1 lds
s_waitcnt vmcnt(16)
s_mov_b32 s41, 0x10000
s_waitcnt vmcnt(24)
s_branch Lpf_112
Lpoll_110:
s_waitcnt vmcnt(0)
Lpf_112:
v_cmp_ne_u32 vcc, v12, v11
s_nop 4
s_cbranch_vccz Lpok_111
buffer_load_dword v11, v10, s[56:59], 0 offen sc1
s_sub_u32 s41, s41, 1
s_cmp_lg_u32 s41, 0
s_cbranch_scc1 Lpoll_110
s_waitcnt vmcnt(0)
Lpok_111:
s_barrier
s_mul_i32 s40, s53, 786432
s_add_u32 m0, s39, 0
s_add_u32 s37, s40, 4194304
buffer_load_dwordx4 v21, s[8:11], s37 offen sc1 lds
s_add_u32 m0, s39, 1024
s_add_u32 s37, s40, 4210688
buffer_load_dwordx4 v21, s[8:11], s37 offen sc1 lds
s_add_u32 m0, s39, 2048
s_add_u32 s37, s40, 4227072
buffer_load_dwordx4 v21, s[8:11], s37 offen sc1 lds
s_add_u32 m0, s39, 3072
s_add_u32 s37, s40, 4243456
buffer_load_dwordx4 v21, s[8:11], s37 offen sc1 lds
s_add_u32 m0, s39, 4096
s_add_u32 s37, s40, 4292608
buffer_load_dwordx4 v21, s[8:11], s37 offen sc1 lds
s_add_u32 m0, s39, 5120
s_add_u32 s37, s40, 4308992
buffer_load_dwordx4 v21, s[8:11], s37 offen sc1 lds
s_add_u32 m0, s39, 6144
s_add_u32 s37, s40, 4325376
buffer_load_dwordx4 v21, s[8:11], s37 offen sc1 lds
s_add_u32 m0, s39, 7168
s_add_u32 s37, s40, 4341760
buffer_load_dwordx4 v21, s[8:11], s37 offen sc1 lds
s_waitcnt vmcnt(16)
s_barrier
s_add_u32 m0, s39, 32768
s_add_u32 s37, s40, 4259840
buffer_load_dwordx4 v21, s[8:11], s37 offen sc1 lds
s_add_u32 m0, s39, 33792
s_add_u32 s37, s40, 4358144
buffer_load_dwordx4 v21, s[8:11], s37 offen sc1 lds
s_add_u32 m0, s39, 34816
s_add_u32 s37, s40, 4276224
buffer_load_dwordx4 v21, s[8:11], s37 offen sc1 lds
s_add_u32 m0, s39, 35840
s_add_u32 s37, s40, 4374528
buffer_load_dwordx4 v21, s[8:11], s37 offen sc1 lds
s_add_u32 m0, s39, 36864
s_add_u32 s37, s40, 4390912
buffer_load_dwordx4 v21, s[8:11], s37 offen sc1 lds
s_add_u32 m0, s39, 37888
s_add_u32 s37, s40, 4407296
buffer_load_dwordx4 v21, s[8:11], s37 offen sc1 lds
s_add_u32 m0, s39, 38912
s_add_u32 s37, s40, 4423680
buffer_load_dwordx4 v21, s[8:11], s37 offen sc1 lds
s_add_u32 m0, s39, 39936
s_add_u32 s37, s40, 4440064
buffer_load_dwordx4 v21, s[8:11], s37 offen sc1 lds
s_waitcnt vmcnt(16)
s_barrier
s_add_u32 m0, s39, 65536
s_add_u32 s37, s40, 4489216
buffer_load_dwordx4 v21, s[8:11], s37 offen sc1 lds
s_add_u32 m0, s39, 66560
s_add_u32 s37, s40, 4505600
buffer_load_dwordx4 v21, s[8:11], s37 offen sc1 lds
s_add_u32 m0, s39, 67584
s_add_u32 s37, s40, 4521984
buffer_load_dwordx4 v21, s[8:11], s37 offen sc1 lds
s_add_u32 m0, s39, 68608
s_add_u32 s37, s40, 4538368
buffer_load_dwordx4 v21, s[8:11], s37 offen sc1 lds
s_add_u32 m0, s39, 69632
s_add_u32 s37, s40, 4456448
buffer_load_dwordx4 v21, s[8:11], s37 offen sc1 lds
s_add_u32 m0, s39, 70656
s_add_u32 s37, s40, 4554752
buffer_load_dwordx4 v21, s[8:11], s37 offen sc1 lds
s_add_u32 m0, s39, 71680
s_add_u32 s37, s40, 4472832
buffer_load_dwordx4 v21, s[8:11], s37 offen sc1 lds
s_add_u32 m0, s39, 72704
s_add_u32 s37, s40, 4571136
buffer_load_dwordx4 v21, s[8:11], s37 offen sc1 lds
s_waitcnt vmcnt(16)
s_barrier
s_add_u32 m0, s39, 98304
s_add_u32 s37, s40, 4587520
buffer_load_dwordx4 v21, s[8:11], s37 offen sc1 lds
s_add_u32 m0, s39, 99328
s_add_u32 s37, s40, 4603904
buffer_load_dwordx4 v21, s[8:11], s37 offen sc1 lds
s_add_u32 m0, s39, 100352
s_add_u32 s37, s40, 4620288
buffer_load_dwordx4 v21, s[8:11], s37 offen sc1 lds
s_add_u32 m0, s39, 101376
s_add_u32 s37, s40, 4636672
buffer_load_dwordx4 v21, s[8:11], s37 offen sc1 lds
s_add_u32 m0, s39, 102400
s_add_u32 s37, s40, 4685824
buffer_load_dwordx4 v21, s[8:11], s37 offen sc1 lds
s_add_u32 m0, s39, 103424
s_add_u32 s37, s40, 4702208
buffer_load_dwordx4 v21, s[8:11], s37 offen sc1 lds
s_add_u32 m0, s39, 104448
s_add_u32 s37, s40, 4718592
buffer_load_dwordx4 v21, s[8:11], s37 offen sc1 lds
s_add_u32 m0, s39, 105472
s_add_u32 s37, s40, 4734976
buffer_load_dwordx4 v21, s[8:11], s37 offen sc1 lds
s_waitcnt vmcnt(16)
s_barrier
s_lshr_b32 s44, s2, 3
s_and_b32 s44, s44, 15
s_lshl_b32 s44, s44, 16
s_add_u32 s43, s44, 6291456
buffer_load_dword v30, v29, s[80:83], s43 offen
s_add_u32 m0, s39, 0
s_add_u32 s37, s40, 4653056
buffer_load_dwordx4 v21, s[8:11], s37 offen sc1 lds
s_add_u32 m0, s39, 1024
s_add_u32 s37, s40, 4751360
buffer_load_dwordx4 v21, s[8:11], s37 offen sc1 lds
s_add_u32 m0, s39, 2048
s_add_u32 s37, s40, 4669440
buffer_load_dwordx4 v21, s[8:11], s37 offen sc1 lds
s_add_u32 m0, s39, 3072
s_add_u32 s37, s40, 4767744
buffer_load_dwordx4 v21, s[8:11], s37 offen sc1 lds
s_add_u32 m0, s39, 4096
s_add_u32 s37, s40, 4784128
buffer_load_dwordx4 v21, s[8:11], s37 offen sc1 lds
s_add_u32 m0, s39, 5120
s_add_u32 s37, s40, 4800512
buffer_load_dwordx4 v21, s[8:11], s37 offen sc1 lds
s_add_u32 m0, s39, 6144
s_add_u32 s37, s40, 4816896
buffer_load_dwordx4 v21, s[8:11], s37 offen sc1 lds
s_add_u32 m0, s39, 7168
s_add_u32 s37, s40, 4833280
buffer_load_dwordx4 v21, s[8:11], s37 offen sc1 lds
s_waitcnt vmcnt(17)
s_barrier
s_add_u32 m0, s39, 32768
s_add_u32 s37, s40, 4882432
buffer_load_dwordx4 v21, s[8:11], s37 offen sc1 lds
s_add_u32 m0, s39, 33792
s_add_u32 s37, s40, 4898816
buffer_load_dwordx4 v21, s[8:11], s37 offen sc1 lds
s_add_u32 m0, s39, 34816
s_add_u32 s37, s40, 4915200
buffer_load_dwordx4 v21, s[8:11], s37 offen sc1 lds
s_add_u32 m0, s39, 35840
s_add_u32 s37, s40, 4931584
buffer_load_dwordx4 v21, s[8:11], s37 offen sc1 lds
s_add_u32 m0, s39, 36864
s_add_u32 s37, s40, 4849664
buffer_load_dwordx4 v21, s[8:11], s37 offen sc1 lds
s_add_u32 m0, s39, 37888
s_add_u32 s37, s40, 4947968
buffer_load_dwordx4 v21, s[8:11], s37 offen sc1 lds
s_add_u32 m0, s39, 38912
s_add_u32 s37, s40, 4866048
buffer_load_dwordx4 v21, s[8:11], s37 offen sc1 lds
s_add_u32 m0, s39, 39936
s_add_u32 s37, s40, 4964352
buffer_load_dwordx4 v21, s[8:11], s37 offen sc1 lds
s_waitcnt vmcnt(17)
s_barrier
s_waitcnt vmcnt(8)
s_barrier
s_waitcnt vmcnt(0)
s_barrier
s_barrier
s_barrier
s_barrier
s_barrier
s_barrier
s_lshl_b32 s43, s34, 4
s_add_u32 s43, s43, s35
s_and_b32 s44, s43, 1
s_lshl_b32 s44, s44, 2
s_lshr_b32 s43, s43, 1
s_add_u32 s43, s43, 128
s_lshl_b32 s43, s43, 7
s_add_u32 s43, s43, s44
v_mov_b32 v10, s43
v_mov_b32 v11, 1
s_mov_b64 exec, 1
buffer_store_dword v11, v10, s[56:59], 0 offen sc1
s_mov_b64 exec, -1
s_barrier
s_barrier
s_barrier
s_lshl_b32 s43, s34, 4
s_add_u32 s43, s43, s35
s_xor_b32 s43, s43, 1
s_and_b32 s44, s43, 1
s_lshl_b32 s44, s44, 2
s_lshr_b32 s43, s43, 1
s_add_u32 s43, s43, 128
s_lshl_b32 s43, s43, 7
s_add_u32 s43, s43, s44
v_mov_b32 v10, s43
v_mov_b32 v12, 1
buffer_load_dword v11, v10, s[56:59], 0 offen sc1
s_barrier
s_barrier
s_mov_b32 s41, 0x10000
Lpoll_113:
s_waitcnt vmcnt(0)
Lpf_115:
v_cmp_ne_u32 vcc, v12, v11
s_nop 4
s_cbranch_vccz Lpok_114
buffer_load_dword v11, v10, s[56:59], 0 offen sc1
s_sub_u32 s41, s41, 1
s_cmp_lg_u32 s41, 0
s_cbranch_scc1 Lpoll_113
s_waitcnt vmcnt(0)
Lpok_114:
s_barrier
s_branch Ldone_1
Ldone_1:
s_endpgm
.section .rodata,"a"
.p2align 6
.amdhsa_kernel sequential_preLN__sliding_local_dilated__glu_gated_geglu__prompt_kernel
  .amdhsa_next_free_vgpr 256
  .amdhsa_next_free_sgpr 100
  .amdhsa_accum_offset 256
  .amdhsa_group_segment_fixed_size 0
  .amdhsa_kernarg_size 80
  .amdhsa_user_sgpr_count 2
  .amdhsa_user_sgpr_kernarg_segment_ptr 1
  .amdhsa_system_sgpr_workgroup_id_x 1
  .amdhsa_float_denorm_mode_32 3
  .amdhsa_float_denorm_mode_16_64 3
.end_amdhsa_kernel
```

```asm
; @launch grid=(256,1,1) block=(512,1,1) lds=151552
.amdgcn_target "amdgcn-amd-amdhsa--gfx950"
.text
.globl sequential_preLN__sliding_local_dilated__glu_gated_geglu__prompt_kernel
.p2align 8
.type sequential_preLN__sliding_local_dilated__glu_gated_geglu__prompt_kernel,@function
sequential_preLN__sliding_local_dilated__glu_gated_geglu__prompt_kernel:
s_cmp_ge_u32 s2, 256
s_cbranch_scc1 Ldone_1
s_load_dwordx4 s[4:7], s[0:1], 0
s_load_dwordx2 s[32:33], s[0:1], 72
s_load_dwordx2 s[80:81], s[0:1], 32
s_and_b32 s3, s2, 7
s_lshr_b32 s42, s2, 3
s_and_b32 s48, s42, 3
s_lshr_b32 s49, s42, 2
s_and_b32 s34, s3, 3
s_lshl_b32 s34, s34, 2
s_add_u32 s34, s34, s48
s_lshr_b32 s35, s3, 2
s_lshl_b32 s35, s35, 3
s_add_u32 s35, s35, s49
v_lshrrev_b32 v12, 6, v0
v_and_b32 v1, 63, v0
v_readfirstlane_b32 s36, v12
s_nop 3
s_lshl_b32 s44, s34, 18
s_lshl_b32 s45, s35, 14
s_add_u32 s45, s45, s44
s_lshl_b32 s50, s34, 7
s_sub_u32 s50, s50, 16
s_and_b32 s47, s36, 3
s_lshl_b32 s43, s34, 7
s_lshl_b32 s44, s35, 3
s_add_u32 s43, s43, s44
s_mov_b32 s63, s43
s_lshl_b32 s44, s47, 1
s_add_u32 s51, s43, s44
v_lshlrev_b32 v10, 4, v1
v_lshrrev_b32 v14, 3, v1
v_and_b32 v15, 7, v1
v_and_b32 v16, 2, v14
v_xor_b32 v16, v15, v16
v_lshlrev_b32 v16, 4, v16
v_mul_u32_u24 v17, 6144, v14
s_lshl_b32 s43, s47, 11
v_add3_u32 v2, v17, v16, s43
v_xor_b32 v3, 64, v2
v_lshrrev_b32 v16, 1, v14
v_xor_b32 v16, v15, v16
v_lshlrev_b32 v16, 4, v16
s_lshl_b32 s43, s47, 3
s_add_u32 s43, s43, s50
v_add_u32 v17, s43, v14
s_and_b32 s44, s47, 1
s_lshl_b32 s44, s44, 6
v_add_u32 v18, 0, v17
v_max_i32 v18, 0, v18
v_lshl_add_u32 v18, v18, 11, v16
v_xor_b32 v18, s44, v18
v_mov_b32 v4, v18
v_add_u32 v18, 24, v17
v_max_i32 v18, 0, v18
v_lshl_add_u32 v18, v18, 11, v16
v_xor_b32 v18, s44, v18
v_xor_b32 v5, 64, v18
v_add_u32 v18, 48, v17
v_max_i32 v18, 0, v18
v_lshl_add_u32 v18, v18, 11, v16
v_xor_b32 v18, s44, v18
v_mov_b32 v6, v18
v_add_u32 v18, 72, v17
v_max_i32 v18, 0, v18
v_lshl_add_u32 v18, v18, 11, v16
v_xor_b32 v18, s44, v18
v_xor_b32 v7, 64, v18
v_add_u32 v18, 96, v17
v_max_i32 v18, 0, v18
v_lshl_add_u32 v18, v18, 11, v16
v_xor_b32 v18, s44, v18
v_mov_b32 v8, v18
v_add_u32 v18, 120, v17
v_max_i32 v18, 0, v18
v_lshl_add_u32 v18, v18, 11, v16
v_xor_b32 v18, s44, v18
v_xor_b32 v9, 64, v18
s_lshl_b32 s39, s47, 10
s_lshl_b32 s40, s47, 13
s_add_u32 s40, s40, 18432
s_mov_b32 s37, 0
s_mov_b32 s38, 0
s_bfm_b64 s[60:61], 56, 8
s_cmp_eq_u32 s47, 0
s_cselect_b64 s[60:61], s[60:61], -1
s_mov_b32 s53, 0x3f803f80
v_and_b32 v12, 15, v1
v_lshrrev_b32 v13, 4, v1
s_lshl_b32 s43, s35, 7
s_waitcnt lgkmcnt(0)
s_mov_b32 s8, s4
s_mov_b32 s9, s5
s_mov_b32 s10, 4194304
s_mov_b32 s11, 0x20000
s_add_u32 s12, s6, s43
s_addc_u32 s13, s7, 0
s_mov_b32 s14, 6289536
s_mov_b32 s15, 0x20000
s_add_u32 s16, s32, s45
s_addc_u32 s17, s33, 0
s_mov_b32 s18, 16384
s_mov_b32 s19, 0x20000
s_add_u32 s20, s32, 26214400
s_addc_u32 s21, s33, 0
s_mov_b32 s22, 16384
s_mov_b32 s23, 0x20000
s_cmp_lt_u32 s36, 4
s_cbranch_scc1 Lcons_2
s_cmp_eq_u32 s36, 7
s_cbranch_scc1 Lpf_3
s_add_u32 m0, s39, 0
s_mov_b64 exec, s[60:61]
buffer_load_dwordx4 v4, s[8:11], s37 offen lds
s_mov_b64 exec, -1
s_add_u32 m0, s39, 3072
s_nop 0
buffer_load_dwordx4 v5, s[8:11], s37 offen lds
s_add_u32 m0, s39, 6144
s_nop 0
buffer_load_dwordx4 v6, s[8:11], s37 offen lds
s_add_u32 m0, s39, 9216
s_nop 0
buffer_load_dwordx4 v7, s[8:11], s37 offen lds
s_add_u32 m0, s39, 12288
s_nop 0
buffer_load_dwordx4 v8, s[8:11], s37 offen lds
s_add_u32 m0, s39, 15360
s_nop 0
buffer_load_dwordx4 v9, s[8:11], s37 offen lds
s_add_u32 m0, s40, 0
s_add_u32 s43, s38, 0
buffer_load_dwordx4 v2, s[12:15], s43 offen lds
s_add_u32 m0, s40, 1024
s_add_u32 s43, s38, 49152
buffer_load_dwordx4 v3, s[12:15], s43 offen lds
s_add_u32 m0, s40, 2048
s_add_u32 s43, s38, 98304
buffer_load_dwordx4 v2, s[12:15], s43 offen lds
s_add_u32 m0, s40, 3072
s_add_u32 s43, s38, 147456
buffer_load_dwordx4 v3, s[12:15], s43 offen lds
s_add_u32 m0, s40, 4096
s_add_u32 s43, s38, 196608
buffer_load_dwordx4 v2, s[12:15], s43 offen lds
s_add_u32 m0, s40, 5120
s_add_u32 s43, s38, 245760
buffer_load_dwordx4 v3, s[12:15], s43 offen lds
s_add_u32 m0, s40, 6144
s_add_u32 s43, s38, 294912
buffer_load_dwordx4 v2, s[12:15], s43 offen lds
s_add_u32 m0, s40, 7168
s_add_u32 s43, s38, 344064
buffer_load_dwordx4 v3, s[12:15], s43 offen lds
s_add_u32 s37, s37, 128
s_add_u32 s38, s38, 393216
s_add_u32 m0, s39, 43008
s_mov_b64 exec, s[60:61]
buffer_load_dwordx4 v4, s[8:11], s37 offen lds
s_mov_b64 exec, -1
s_add_u32 m0, s39, 46080
s_nop 0
buffer_load_dwordx4 v5, s[8:11], s37 offen lds
s_add_u32 m0, s39, 49152
s_nop 0
buffer_load_dwordx4 v6, s[8:11], s37 offen lds
s_add_u32 m0, s39, 52224
s_nop 0
buffer_load_dwordx4 v7, s[8:11], s37 offen lds
s_add_u32 m0, s39, 55296
s_nop 0
buffer_load_dwordx4 v8, s[8:11], s37 offen lds
s_add_u32 m0, s39, 58368
s_nop 0
buffer_load_dwordx4 v9, s[8:11], s37 offen lds
s_add_u32 m0, s40, 43008
s_add_u32 s43, s38, 0
buffer_load_dwordx4 v2, s[12:15], s43 offen lds
s_add_u32 m0, s40, 44032
s_add_u32 s43, s38, 49152
buffer_load_dwordx4 v3, s[12:15], s43 offen lds
s_add_u32 m0, s40, 45056
s_add_u32 s43, s38, 98304
buffer_load_dwordx4 v2, s[12:15], s43 offen lds
s_add_u32 m0, s40, 46080
s_add_u32 s43, s38, 147456
buffer_load_dwordx4 v3, s[12:15], s43 offen lds
s_add_u32 m0, s40, 47104
s_add_u32 s43, s38, 196608
buffer_load_dwordx4 v2, s[12:15], s43 offen lds
s_add_u32 m0, s40, 48128
s_add_u32 s43, s38, 245760
buffer_load_dwordx4 v3, s[12:15], s43 offen lds
s_add_u32 m0, s40, 49152
s_add_u32 s43, s38, 294912
buffer_load_dwordx4 v2, s[12:15], s43 offen lds
s_add_u32 m0, s40, 50176
s_add_u32 s43, s38, 344064
buffer_load_dwordx4 v3, s[12:15], s43 offen lds
s_add_u32 s37, s37, 128
s_add_u32 s38, s38, 393216
s_waitcnt vmcnt(14)
s_barrier
s_add_u32 m0, s39, 86016
s_mov_b64 exec, s[60:61]
buffer_load_dwordx4 v4, s[8:11], s37 offen lds
s_mov_b64 exec, -1
s_add_u32 m0, s39, 89088
s_nop 0
buffer_load_dwordx4 v5, s[8:11], s37 offen lds
s_add_u32 m0, s39, 92160
s_nop 0
buffer_load_dwordx4 v6, s[8:11], s37 offen lds
s_add_u32 m0, s39, 95232
s_nop 0
buffer_load_dwordx4 v7, s[8:11], s37 offen lds
s_add_u32 m0, s39, 98304
s_nop 0
buffer_load_dwordx4 v8, s[8:11], s37 offen lds
s_add_u32 m0, s39, 101376
s_nop 0
buffer_load_dwordx4 v9, s[8:11], s37 offen lds
s_add_u32 m0, s40, 86016
s_add_u32 s43, s38, 0
buffer_load_dwordx4 v2, s[12:15], s43 offen lds
s_add_u32 m0, s40, 87040
s_add_u32 s43, s38, 49152
buffer_load_dwordx4 v3, s[12:15], s43 offen lds
s_add_u32 m0, s40, 88064
s_add_u32 s43, s38, 98304
buffer_load_dwordx4 v2, s[12:15], s43 offen lds
s_add_u32 m0, s40, 89088
s_add_u32 s43, s38, 147456
buffer_load_dwordx4 v3, s[12:15], s43 offen lds
s_add_u32 m0, s40, 90112
s_add_u32 s43, s38, 196608
buffer_load_dwordx4 v2, s[12:15], s43 offen lds
s_add_u32 m0, s40, 91136
s_add_u32 s43, s38, 245760
buffer_load_dwordx4 v3, s[12:15], s43 offen lds
s_add_u32 m0, s40, 92160
s_add_u32 s43, s38, 294912
buffer_load_dwordx4 v2, s[12:15], s43 offen lds
s_add_u32 m0, s40, 93184
s_add_u32 s43, s38, 344064
buffer_load_dwordx4 v3, s[12:15], s43 offen lds
s_add_u32 s37, s37, 128
s_add_u32 s38, s38, 393216
s_lshl_b32 s43, s51, 11
buffer_load_dwordx4 v[96:99], v10, s[8:11], s43 offen offset:0
buffer_load_dwordx4 v[100:103], v10, s[8:11], s43 offen offset:1024
buffer_load_dwordx4 v[104:107], v10, s[8:11], s43 offen offset:2048
buffer_load_dwordx4 v[108:111], v10, s[8:11], s43 offen offset:3072
s_lshr_b32 s43, s2, 5
s_cmp_eq_u32 s43, 3
s_cbranch_scc1 Lsj_11
s_cmp_gt_u32 s43, 3
s_cselect_b32 s43, 32, 0
s_sub_u32 s43, s2, s43
s_lshr_b32 s43, s43, 1
s_and_b32 s44, s2, 1
s_lshl_b32 s44, s44, 3
s_add_u32 s44, s44, 32
s_load_dwordx2 s[80:81], s[0:1], s44
s_mul_i32 s45, s43, 2341
s_lshr_b32 s45, s45, 16
s_mul_i32 s46, s45, 28
s_sub_u32 s46, s43, s46
s_lshl_b32 s45, s45, 8
s_mul_i32 s44, s47, 18
s_add_u32 s45, s45, s44
s_add_u32 s45, s45, 184
s_mul_i32 s45, s45, 7168
s_lshl_b32 s46, s46, 8
s_add_u32 s45, s45, s46
s_waitcnt lgkmcnt(0)
s_add_u32 s80, s80, s45
s_addc_u32 s81, s81, 0
Lsj_11:
s_waitcnt vmcnt(18)
s_barrier
s_add_u32 m0, s39, 0
s_mov_b64 exec, s[60:61]
buffer_load_dwordx4 v4, s[8:11], s37 offen lds
s_mov_b64 exec, -1
s_add_u32 m0, s39, 3072
s_nop 0
buffer_load_dwordx4 v5, s[8:11], s37 offen lds
s_add_u32 m0, s39, 6144
s_nop 0
buffer_load_dwordx4 v6, s[8:11], s37 offen lds
s_add_u32 m0, s39, 9216
s_nop 0
buffer_load_dwordx4 v7, s[8:11], s37 offen lds
s_add_u32 m0, s39, 12288
s_nop 0
buffer_load_dwordx4 v8, s[8:11], s37 offen lds
s_add_u32 m0, s39, 15360
s_nop 0
buffer_load_dwordx4 v9, s[8:11], s37 offen lds
s_add_u32 m0, s40, 0
s_add_u32 s43, s38, 0
buffer_load_dwordx4 v2, s[12:15], s43 offen lds
s_add_u32 m0, s40, 1024
s_add_u32 s43, s38, 49152
buffer_load_dwordx4 v3, s[12:15], s43 offen lds
s_add_u32 m0, s40, 2048
s_add_u32 s43, s38, 98304
buffer_load_dwordx4 v2, s[12:15], s43 offen lds
s_add_u32 m0, s40, 3072
s_add_u32 s43, s38, 147456
buffer_load_dwordx4 v3, s[12:15], s43 offen lds
s_add_u32 m0, s40, 4096
s_add_u32 s43, s38, 196608
buffer_load_dwordx4 v2, s[12:15], s43 offen lds
s_add_u32 m0, s40, 5120
s_add_u32 s43, s38, 245760
buffer_load_dwordx4 v3, s[12:15], s43 offen lds
s_add_u32 m0, s40, 6144
s_add_u32 s43, s38, 294912
buffer_load_dwordx4 v2, s[12:15], s43 offen lds
s_add_u32 m0, s40, 7168
s_add_u32 s43, s38, 344064
buffer_load_dwordx4 v3, s[12:15], s43 offen lds
s_add_u32 s37, s37, 128
s_add_u32 s38, s38, 393216
s_waitcnt vmcnt(14)
s_barrier
s_add_u32 m0, s39, 43008
s_mov_b64 exec, s[60:61]
buffer_load_dwordx4 v4, s[8:11], s37 offen lds
s_mov_b64 exec, -1
s_add_u32 m0, s39, 46080
s_nop 0
buffer_load_dwordx4 v5, s[8:11], s37 offen lds
s_add_u32 m0, s39, 49152
s_nop 0
buffer_load_dwordx4 v6, s[8:11], s37 offen lds
s_add_u32 m0, s39, 52224
s_nop 0
buffer_load_dwordx4 v7, s[8:11], s37 offen lds
s_add_u32 m0, s39, 55296
s_nop 0
buffer_load_dwordx4 v8, s[8:11], s37 offen lds
s_add_u32 m0, s39, 58368
s_nop 0
buffer_load_dwordx4 v9, s[8:11], s37 offen lds
s_add_u32 m0, s40, 43008
s_add_u32 s43, s38, 0
buffer_load_dwordx4 v2, s[12:15], s43 offen lds
s_add_u32 m0, s40, 44032
s_add_u32 s43, s38, 49152
buffer_load_dwordx4 v3, s[12:15], s43 offen lds
s_add_u32 m0, s40, 45056
s_add_u32 s43, s38, 98304
buffer_load_dwordx4 v2, s[12:15], s43 offen lds
s_add_u32 m0, s40, 46080
s_add_u32 s43, s38, 147456
buffer_load_dwordx4 v3, s[12:15], s43 offen lds
s_add_u32 m0, s40, 47104
s_add_u32 s43, s38, 196608
buffer_load_dwordx4 v2, s[12:15], s43 offen lds
s_add_u32 m0, s40, 48128
s_add_u32 s43, s38, 245760
buffer_load_dwordx4 v3, s[12:15], s43 offen lds
s_add_u32 m0, s40, 49152
s_add_u32 s43, s38, 294912
buffer_load_dwordx4 v2, s[12:15], s43 offen lds
s_add_u32 m0, s40, 50176
s_add_u32 s43, s38, 344064
buffer_load_dwordx4 v3, s[12:15], s43 offen lds
s_add_u32 s37, s37, 128
s_add_u32 s38, s38, 393216
v_lshlrev_b32 v116, 16, v96
v_and_b32 v117, 0xffff0000, v96
v_mul_f32 v118, v116, v116
v_mul_f32 v119, v117, v117
v_lshlrev_b32 v126, 16, v97
v_and_b32 v127, 0xffff0000, v97
v_add_f32 v116, v116, v126
v_add_f32 v117, v117, v127
v_fmac_f32 v118, v126, v126
v_fmac_f32 v119, v127, v127
v_lshlrev_b32 v124, 16, v98
v_and_b32 v125, 0xffff0000, v98
v_add_f32 v116, v116, v124
v_add_f32 v117, v117, v125
v_fmac_f32 v118, v124, v124
v_fmac_f32 v119, v125, v125
v_lshlrev_b32 v126, 16, v99
v_and_b32 v127, 0xffff0000, v99
v_add_f32 v116, v116, v126
v_add_f32 v117, v117, v127
v_fmac_f32 v118, v126, v126
v_fmac_f32 v119, v127, v127
v_lshlrev_b32 v124, 16, v100
v_and_b32 v125, 0xffff0000, v100
v_add_f32 v116, v116, v124
v_add_f32 v117, v117, v125
v_fmac_f32 v118, v124, v124
v_fmac_f32 v119, v125, v125
v_lshlrev_b32 v126, 16, v101
v_and_b32 v127, 0xffff0000, v101
v_add_f32 v116, v116, v126
v_add_f32 v117, v117, v127
v_fmac_f32 v118, v126, v126
v_fmac_f32 v119, v127, v127
v_lshlrev_b32 v124, 16, v102
v_and_b32 v125, 0xffff0000, v102
v_add_f32 v116, v116, v124
v_add_f32 v117, v117, v125
v_fmac_f32 v118, v124, v124
v_fmac_f32 v119, v125, v125
v_lshlrev_b32 v126, 16, v103
v_and_b32 v127, 0xffff0000, v103
v_add_f32 v116, v116, v126
v_add_f32 v117, v117, v127
v_fmac_f32 v118, v126, v126
v_fmac_f32 v119, v127, v127
v_lshlrev_b32 v120, 16, v104
v_and_b32 v121, 0xffff0000, v104
v_mul_f32 v122, v120, v120
v_mul_f32 v123, v121, v121
s_waitcnt vmcnt(14)
s_barrier
s_add_u32 m0, s39, 86016
s_mov_b64 exec, s[60:61]
buffer_load_dwordx4 v4, s[8:11], s37 offen lds
s_mov_b64 exec, -1
s_add_u32 m0, s39, 89088
s_nop 0
buffer_load_dwordx4 v5, s[8:11], s37 offen lds
s_add_u32 m0, s39, 92160
s_nop 0
buffer_load_dwordx4 v6, s[8:11], s37 offen lds
s_add_u32 m0, s39, 95232
s_nop 0
buffer_load_dwordx4 v7, s[8:11], s37 offen lds
s_add_u32 m0, s39, 98304
s_nop 0
buffer_load_dwordx4 v8, s[8:11], s37 offen lds
s_add_u32 m0, s39, 101376
s_nop 0
buffer_load_dwordx4 v9, s[8:11], s37 offen lds
s_add_u32 m0, s40, 86016
s_add_u32 s43, s38, 0
buffer_load_dwordx4 v2, s[12:15], s43 offen lds
s_add_u32 m0, s40, 87040
s_add_u32 s43, s38, 49152
buffer_load_dwordx4 v3, s[12:15], s43 offen lds
s_add_u32 m0, s40, 88064
s_add_u32 s43, s38, 98304
buffer_load_dwordx4 v2, s[12:15], s43 offen lds
s_add_u32 m0, s40, 89088
s_add_u32 s43, s38, 147456
buffer_load_dwordx4 v3, s[12:15], s43 offen lds
s_add_u32 m0, s40, 90112
s_add_u32 s43, s38, 196608
buffer_load_dwordx4 v2, s[12:15], s43 offen lds
s_add_u32 m0, s40, 91136
s_add_u32 s43, s38, 245760
buffer_load_dwordx4 v3, s[12:15], s43 offen lds
s_add_u32 m0, s40, 92160
s_add_u32 s43, s38, 294912
buffer_load_dwordx4 v2, s[12:15], s43 offen lds
s_add_u32 m0, s40, 93184
s_add_u32 s43, s38, 344064
buffer_load_dwordx4 v3, s[12:15], s43 offen lds
s_add_u32 s37, s37, 128
s_add_u32 s38, s38, 393216
v_lshlrev_b32 v126, 16, v105
v_and_b32 v127, 0xffff0000, v105
v_add_f32 v120, v120, v126
v_add_f32 v121, v121, v127
v_fmac_f32 v122, v126, v126
v_fmac_f32 v123, v127, v127
v_lshlrev_b32 v124, 16, v106
v_and_b32 v125, 0xffff0000, v106
v_add_f32 v120, v120, v124
v_add_f32 v121, v121, v125
v_fmac_f32 v122, v124, v124
v_fmac_f32 v123, v125, v125
v_lshlrev_b32 v126, 16, v107
v_and_b32 v127, 0xffff0000, v107
v_add_f32 v120, v120, v126
v_add_f32 v121, v121, v127
v_fmac_f32 v122, v126, v126
v_fmac_f32 v123, v127, v127
v_lshlrev_b32 v124, 16, v108
v_and_b32 v125, 0xffff0000, v108
v_add_f32 v120, v120, v124
v_add_f32 v121, v121, v125
v_fmac_f32 v122, v124, v124
v_fmac_f32 v123, v125, v125
v_lshlrev_b32 v126, 16, v109
v_and_b32 v127, 0xffff0000, v109
v_add_f32 v120, v120, v126
v_add_f32 v121, v121, v127
v_fmac_f32 v122, v126, v126
v_fmac_f32 v123, v127, v127
v_lshlrev_b32 v124, 16, v110
v_and_b32 v125, 0xffff0000, v110
v_add_f32 v120, v120, v124
v_add_f32 v121, v121, v125
v_fmac_f32 v122, v124, v124
v_fmac_f32 v123, v125, v125
v_lshlrev_b32 v126, 16, v111
v_and_b32 v127, 0xffff0000, v111
v_add_f32 v120, v120, v126
v_add_f32 v121, v121, v127
v_fmac_f32 v122, v126, v126
v_fmac_f32 v123, v127, v127
v_add_f32 v116, v116, v117
v_add_f32 v118, v118, v119
v_add_f32 v120, v120, v121
v_add_f32 v122, v122, v123
v_add_f32_dpp v116, v116, v116 row_ror:8 row_mask:0xf bank_mask:0xf
v_add_f32_dpp v118, v118, v118 row_ror:8 row_mask:0xf bank_mask:0xf
v_add_f32_dpp v120, v120, v120 row_ror:8 row_mask:0xf bank_mask:0xf
v_add_f32_dpp v122, v122, v122 row_ror:8 row_mask:0xf bank_mask:0xf
v_mov_b32 v128, -1
v_mov_b32 v129, -1
v_mov_b32 v130, -1
v_mov_b32 v131, -1
s_mul_i32 s28, s47, 5120
buffer_store_dwordx4 v[128:131], v10, s[16:19], s28 offen sc1
s_add_u32 s28, s28, 1024
buffer_store_dwordx4 v[128:131], v10, s[16:19], s28 offen sc1
s_add_u32 s28, s28, 1024
s_waitcnt vmcnt(16)
s_barrier
s_add_u32 m0, s39, 0
s_mov_b64 exec, s[60:61]
buffer_load_dwordx4 v4, s[8:11], s37 offen lds
s_mov_b64 exec, -1
s_add_u32 m0, s39, 3072
s_nop 0
buffer_load_dwordx4 v5, s[8:11], s37 offen lds
s_add_u32 m0, s39, 6144
s_nop 0
buffer_load_dwordx4 v6, s[8:11], s37 offen lds
s_add_u32 m0, s39, 9216
s_nop 0
buffer_load_dwordx4 v7, s[8:11], s37 offen lds
s_add_u32 m0, s39, 12288
s_nop 0
buffer_load_dwordx4 v8, s[8:11], s37 offen lds
s_add_u32 m0, s39, 15360
s_nop 0
buffer_load_dwordx4 v9, s[8:11], s37 offen lds
s_add_u32 m0, s40, 0
s_add_u32 s43, s38, 0
buffer_load_dwordx4 v2, s[12:15], s43 offen lds
s_add_u32 m0, s40, 1024
s_add_u32 s43, s38, 49152
buffer_load_dwordx4 v3, s[12:15], s43 offen lds
s_add_u32 m0, s40, 2048
s_add_u32 s43, s38, 98304
buffer_load_dwordx4 v2, s[12:15], s43 offen lds
s_add_u32 m0, s40, 3072
s_add_u32 s43, s38, 147456
buffer_load_dwordx4 v3, s[12:15], s43 offen lds
s_add_u32 m0, s40, 4096
s_add_u32 s43, s38, 196608
buffer_load_dwordx4 v2, s[12:15], s43 offen lds
s_add_u32 m0, s40, 5120
s_add_u32 s43, s38, 245760
buffer_load_dwordx4 v3, s[12:15], s43 offen lds
s_add_u32 m0, s40, 6144
s_add_u32 s43, s38, 294912
buffer_load_dwordx4 v2, s[12:15], s43 offen lds
s_add_u32 m0, s40, 7168
s_add_u32 s43, s38, 344064
buffer_load_dwordx4 v3, s[12:15], s43 offen lds
s_add_u32 s37, s37, 128
s_add_u32 s38, s38, 393216
v_add_f32_dpp v116, v116, v116 row_ror:4 row_mask:0xf bank_mask:0xf
v_add_f32_dpp v118, v118, v118 row_ror:4 row_mask:0xf bank_mask:0xf
v_add_f32_dpp v120, v120, v120 row_ror:4 row_mask:0xf bank_mask:0xf
v_add_f32_dpp v122, v122, v122 row_ror:4 row_mask:0xf bank_mask:0xf
v_add_f32_dpp v116, v116, v116 row_ror:2 row_mask:0xf bank_mask:0xf
v_add_f32_dpp v118, v118, v118 row_ror:2 row_mask:0xf bank_mask:0xf
v_add_f32_dpp v120, v120, v120 row_ror:2 row_mask:0xf bank_mask:0xf
v_add_f32_dpp v122, v122, v122 row_ror:2 row_mask:0xf bank_mask:0xf
v_add_f32_dpp v116, v116, v116 row_ror:1 row_mask:0xf bank_mask:0xf
v_add_f32_dpp v118, v118, v118 row_ror:1 row_mask:0xf bank_mask:0xf
v_add_f32_dpp v120, v120, v120 row_ror:1 row_mask:0xf bank_mask:0xf
v_add_f32_dpp v122, v122, v122 row_ror:1 row_mask:0xf bank_mask:0xf
v_mov_b32 v117, v116
v_mov_b32 v119, v118
v_mov_b32 v121, v120
v_mov_b32 v123, v122
s_nop 0
v_permlane16_swap_b32 v116, v117
v_permlane16_swap_b32 v118, v119
v_permlane16_swap_b32 v120, v121
v_permlane16_swap_b32 v122, v123
v_add_f32 v116, v116, v117
v_add_f32 v118, v118, v119
v_add_f32 v120, v120, v121
v_add_f32 v122, v122, v123
v_mov_b32 v117, v116
v_mov_b32 v119, v118
v_mov_b32 v121, v120
v_mov_b32 v123, v122
s_nop 0
v_permlane32_swap_b32 v116, v117
v_permlane32_swap_b32 v118, v119
v_permlane32_swap_b32 v120, v121
v_permlane32_swap_b32 v122, v123
v_add_f32 v116, v116, v117
v_add_f32 v118, v118, v119
v_add_f32 v120, v120, v121
v_add_f32 v122, v122, v123
v_mul_f32 v112, 0x3a800000, v116
v_mul_f32 v113, 0x3a800000, v118
v_fma_f32 v113, -v112, v112, v113
v_max_f32 v113, 0, v113
v_add_f32 v113, 0x3727c5ac, v113
v_rsq_f32 v113, v113
v_mul_f32 v114, 0x3a800000, v120
v_mul_f32 v115, 0x3a800000, v122
v_fma_f32 v115, -v114, v114, v115
v_max_f32 v115, 0, v115
v_add_f32 v115, 0x3727c5ac, v115
v_rsq_f32 v115, v115
s_nop 0
s_lshl_b32 s43, s47, 4
s_add_u32 s43, s43, 130176
v_mov_b32 v11, s43
ds_write_b128 v11, v[112:115]
s_waitcnt lgkmcnt(0)
buffer_store_dwordx4 v[128:131], v10, s[16:19], s28 offen sc1
s_add_u32 s28, s28, 1024
buffer_store_dwordx4 v[128:131], v10, s[16:19], s28 offen sc1
s_add_u32 s28, s28, 1024
s_load_dword s64, s[80:81], 0
s_load_dword s65, s[80:81], 64
s_load_dword s66, s[80:81], 128
s_load_dword s67, s[80:81], 192
s_load_dword s68, s[80:81], 7168
s_load_dword s69, s[80:81], 7232
s_load_dword s70, s[80:81], 7296
s_load_dword s71, s[80:81], 7360
s_add_u32 s80, s80, 14336
s_addc_u32 s81, s81, 0
s_waitcnt vmcnt(18)
s_barrier
s_add_u32 m0, s39, 43008
s_mov_b64 exec, s[60:61]
buffer_load_dwordx4 v4, s[8:11], s37 offen lds
s_mov_b64 exec, -1
s_add_u32 m0, s39, 46080
s_nop 0
buffer_load_dwordx4 v5, s[8:11], s37 offen lds
s_add_u32 m0, s39, 49152
s_nop 0
buffer_load_dwordx4 v6, s[8:11], s37 offen lds
s_add_u32 m0, s39, 52224
s_nop 0
buffer_load_dwordx4 v7, s[8:11], s37 offen lds
s_add_u32 m0, s39, 55296
s_nop 0
buffer_load_dwordx4 v8, s[8:11], s37 offen lds
s_add_u32 m0, s39, 58368
s_nop 0
buffer_load_dwordx4 v9, s[8:11], s37 offen lds
s_add_u32 m0, s40, 43008
s_add_u32 s43, s38, 0
buffer_load_dwordx4 v2, s[12:15], s43 offen lds
s_add_u32 m0, s40, 44032
s_add_u32 s43, s38, 49152
buffer_load_dwordx4 v3, s[12:15], s43 offen lds
s_add_u32 m0, s40, 45056
s_add_u32 s43, s38, 98304
buffer_load_dwordx4 v2, s[12:15], s43 offen lds
s_add_u32 m0, s40, 46080
s_add_u32 s43, s38, 147456
buffer_load_dwordx4 v3, s[12:15], s43 offen lds
s_add_u32 m0, s40, 47104
s_add_u32 s43, s38, 196608
buffer_load_dwordx4 v2, s[12:15], s43 offen lds
s_add_u32 m0, s40, 48128
s_add_u32 s43, s38, 245760
buffer_load_dwordx4 v3, s[12:15], s43 offen lds
s_add_u32 m0, s40, 49152
s_add_u32 s43, s38, 294912
buffer_load_dwordx4 v2, s[12:15], s43 offen lds
s_add_u32 m0, s40, 50176
s_add_u32 s43, s38, 344064
buffer_load_dwordx4 v3, s[12:15], s43 offen lds
s_add_u32 s37, s37, 128
s_add_u32 s38, s38, 393216
buffer_store_dwordx4 v[128:131], v10, s[16:19], s28 offen sc1
s_add_u32 s28, s28, 1024
buffer_store_dwordx4 v[128:131], v10, s[16:19], s28 offen sc1
s_add_u32 s28, s28, 1024
s_load_dword s64, s[80:81], 0
s_load_dword s65, s[80:81], 64
s_load_dword s66, s[80:81], 128
s_load_dword s67, s[80:81], 192
s_load_dword s68, s[80:81], 7168
s_load_dword s69, s[80:81], 7232
s_load_dword s70, s[80:81], 7296
s_load_dword s71, s[80:81], 7360
s_add_u32 s80, s80, 14336
s_addc_u32 s81, s81, 0
s_waitcnt vmcnt(18)
s_barrier
s_add_u32 m0, s39, 86016
s_mov_b64 exec, s[60:61]
buffer_load_dwordx4 v4, s[8:11], s37 offen lds
s_mov_b64 exec, -1
s_add_u32 m0, s39, 89088
s_nop 0
buffer_load_dwordx4 v5, s[8:11], s37 offen lds
s_add_u32 m0, s39, 92160
s_nop 0
buffer_load_dwordx4 v6, s[8:11], s37 offen lds
s_add_u32 m0, s39, 95232
s_nop 0
buffer_load_dwordx4 v7, s[8:11], s37 offen lds
s_add_u32 m0, s39, 98304
s_nop 0
buffer_load_dwordx4 v8, s[8:11], s37 offen lds
s_add_u32 m0, s39, 101376
s_nop 0
buffer_load_dwordx4 v9, s[8:11], s37 offen lds
s_add_u32 m0, s40, 86016
s_add_u32 s43, s38, 0
buffer_load_dwordx4 v2, s[12:15], s43 offen lds
s_add_u32 m0, s40, 87040
s_add_u32 s43, s38, 49152
buffer_load_dwordx4 v3, s[12:15], s43 offen lds
s_add_u32 m0, s40, 88064
s_add_u32 s43, s38, 98304
buffer_load_dwordx4 v2, s[12:15], s43 offen lds
s_add_u32 m0, s40, 89088
s_add_u32 s43, s38, 147456
buffer_load_dwordx4 v3, s[12:15], s43 offen lds
s_add_u32 m0, s40, 90112
s_add_u32 s43, s38, 196608
buffer_load_dwordx4 v2, s[12:15], s43 offen lds
s_add_u32 m0, s40, 91136
s_add_u32 s43, s38, 245760
buffer_load_dwordx4 v3, s[12:15], s43 offen lds
s_add_u32 m0, s40, 92160
s_add_u32 s43, s38, 294912
buffer_load_dwordx4 v2, s[12:15], s43 offen lds
s_add_u32 m0, s40, 93184
s_add_u32 s43, s38, 344064
buffer_load_dwordx4 v3, s[12:15], s43 offen lds
s_add_u32 s37, s37, 128
s_add_u32 s38, s38, 393216
s_add_u32 s24, s16, 4194304
s_addc_u32 s25, s17, 0
s_mov_b32 s26, 16384
s_mov_b32 s27, 0x20000
s_mul_i32 s28, s47, 5120
buffer_store_dwordx4 v[128:131], v10, s[24:27], s28 offen sc1
s_add_u32 s28, s28, 1024
s_load_dword s64, s[80:81], 0
s_load_dword s65, s[80:81], 64
s_load_dword s66, s[80:81], 128
s_load_dword s67, s[80:81], 192
s_load_dword s68, s[80:81], 7168
s_load_dword s69, s[80:81], 7232
s_load_dword s70, s[80:81], 7296
s_load_dword s71, s[80:81], 7360
s_add_u32 s80, s80, 14336
s_addc_u32 s81, s81, 0
s_waitcnt vmcnt(17)
s_barrier
s_add_u32 m0, s39, 0
s_mov_b64 exec, s[60:61]
buffer_load_dwordx4 v4, s[8:11], s37 offen lds
s_mov_b64 exec, -1
s_add_u32 m0, s39, 3072
s_nop 0
buffer_load_dwordx4 v5, s[8:11], s37 offen lds
s_add_u32 m0, s39, 6144
s_nop 0
buffer_load_dwordx4 v6, s[8:11], s37 offen lds
s_add_u32 m0, s39, 9216
s_nop 0
buffer_load_dwordx4 v7, s[8:11], s37 offen lds
s_add_u32 m0, s39, 12288
s_nop 0
buffer_load_dwordx4 v8, s[8:11], s37 offen lds
s_add_u32 m0, s39, 15360
s_nop 0
buffer_load_dwordx4 v9, s[8:11], s37 offen lds
s_add_u32 m0, s40, 0
s_add_u32 s43, s38, 0
buffer_load_dwordx4 v2, s[12:15], s43 offen lds
s_add_u32 m0, s40, 1024
s_add_u32 s43, s38, 49152
buffer_load_dwordx4 v3, s[12:15], s43 offen lds
s_add_u32 m0, s40, 2048
s_add_u32 s43, s38, 98304
buffer_load_dwordx4 v2, s[12:15], s43 offen lds
s_add_u32 m0, s40, 3072
s_add_u32 s43, s38, 147456
buffer_load_dwordx4 v3, s[12:15], s43 offen lds
s_add_u32 m0, s40, 4096
s_add_u32 s43, s38, 196608
buffer_load_dwordx4 v2, s[12:15], s43 offen lds
s_add_u32 m0, s40, 5120
s_add_u32 s43, s38, 245760
buffer_load_dwordx4 v3, s[12:15], s43 offen lds
s_add_u32 m0, s40, 6144
s_add_u32 s43, s38, 294912
buffer_load_dwordx4 v2, s[12:15], s43 offen lds
s_add_u32 m0, s40, 7168
s_add_u32 s43, s38, 344064
buffer_load_dwordx4 v3, s[12:15], s43 offen lds
s_add_u32 s37, s37, 128
s_add_u32 s38, s38, 393216
buffer_store_dwordx4 v[128:131], v10, s[24:27], s28 offen sc1
s_add_u32 s28, s28, 1024
s_load_dword s64, s[80:81], 0
s_load_dword s65, s[80:81], 64
s_load_dword s66, s[80:81], 128
s_load_dword s67, s[80:81], 192
s_load_dword s68, s[80:81], 7168
s_load_dword s69, s[80:81], 7232
s_load_dword s70, s[80:81], 7296
s_load_dword s71, s[80:81], 7360
s_add_u32 s80, s80, 14336
s_addc_u32 s81, s81, 0
s_waitcnt vmcnt(16)
s_barrier
s_add_u32 m0, s39, 43008
s_mov_b64 exec, s[60:61]
buffer_load_dwordx4 v4, s[8:11], s37 offen lds
s_mov_b64 exec, -1
s_add_u32 m0, s39, 46080
s_nop 0
buffer_load_dwordx4 v5, s[8:11], s37 offen lds
s_add_u32 m0, s39, 49152
s_nop 0
buffer_load_dwordx4 v6, s[8:11], s37 offen lds
s_add_u32 m0, s39, 52224
s_nop 0
buffer_load_dwordx4 v7, s[8:11], s37 offen lds
s_add_u32 m0, s39, 55296
s_nop 0
buffer_load_dwordx4 v8, s[8:11], s37 offen lds
s_add_u32 m0, s39, 58368
s_nop 0
buffer_load_dwordx4 v9, s[8:11], s37 offen lds
s_add_u32 m0, s40, 43008
s_add_u32 s43, s38, 0
buffer_load_dwordx4 v2, s[12:15], s43 offen lds
s_add_u32 m0, s40, 44032
s_add_u32 s43, s38, 49152
buffer_load_dwordx4 v3, s[12:15], s43 offen lds
s_add_u32 m0, s40, 45056
s_add_u32 s43, s38, 98304
buffer_load_dwordx4 v2, s[12:15], s43 offen lds
s_add_u32 m0, s40, 46080
s_add_u32 s43, s38, 147456
buffer_load_dwordx4 v3, s[12:15], s43 offen lds
s_add_u32 m0, s40, 47104
s_add_u32 s43, s38, 196608
buffer_load_dwordx4 v2, s[12:15], s43 offen lds
s_add_u32 m0, s40, 48128
s_add_u32 s43, s38, 245760
buffer_load_dwordx4 v3, s[12:15], s43 offen lds
s_add_u32 m0, s40, 49152
s_add_u32 s43, s38, 294912
buffer_load_dwordx4 v2, s[12:15], s43 offen lds
s_add_u32 m0, s40, 50176
s_add_u32 s43, s38, 344064
buffer_load_dwordx4 v3, s[12:15], s43 offen lds
s_add_u32 s37, s37, 128
s_add_u32 s38, s38, 393216
buffer_store_dwordx4 v[128:131], v10, s[24:27], s28 offen sc1
s_add_u32 s28, s28, 1024
s_load_dword s64, s[80:81], 0
s_load_dword s65, s[80:81], 64
s_load_dword s66, s[80:81], 128
s_load_dword s67, s[80:81], 192
s_load_dword s68, s[80:81], 7168
s_load_dword s69, s[80:81], 7232
s_load_dword s70, s[80:81], 7296
s_load_dword s71, s[80:81], 7360
s_add_u32 s80, s80, 14336
s_addc_u32 s81, s81, 0
s_waitcnt vmcnt(16)
s_barrier
s_add_u32 m0, s39, 86016
s_mov_b64 exec, s[60:61]
buffer_load_dwordx4 v4, s[8:11], s37 offen lds
s_mov_b64 exec, -1
s_add_u32 m0, s39, 89088
s_nop 0
buffer_load_dwordx4 v5, s[8:11], s37 offen lds
s_add_u32 m0, s39, 92160
s_nop 0
buffer_load_dwordx4 v6, s[8:11], s37 offen lds
s_add_u32 m0, s39, 95232
s_nop 0
buffer_load_dwordx4 v7, s[8:11], s37 offen lds
s_add_u32 m0, s39, 98304
s_nop 0
buffer_load_dwordx4 v8, s[8:11], s37 offen lds
s_add_u32 m0, s39, 101376
s_nop 0
buffer_load_dwordx4 v9, s[8:11], s37 offen lds
s_add_u32 m0, s40, 86016
s_add_u32 s43, s38, 0
buffer_load_dwordx4 v2, s[12:15], s43 offen lds
s_add_u32 m0, s40, 87040
s_add_u32 s43, s38, 49152
buffer_load_dwordx4 v3, s[12:15], s43 offen lds
s_add_u32 m0, s40, 88064
s_add_u32 s43, s38, 98304
buffer_load_dwordx4 v2, s[12:15], s43 offen lds
s_add_u32 m0, s40, 89088
s_add_u32 s43, s38, 147456
buffer_load_dwordx4 v3, s[12:15], s43 offen lds
s_add_u32 m0, s40, 90112
s_add_u32 s43, s38, 196608
buffer_load_dwordx4 v2, s[12:15], s43 offen lds
s_add_u32 m0, s40, 91136
s_add_u32 s43, s38, 245760
buffer_load_dwordx4 v3, s[12:15], s43 offen lds
s_add_u32 m0, s40, 92160
s_add_u32 s43, s38, 294912
buffer_load_dwordx4 v2, s[12:15], s43 offen lds
s_add_u32 m0, s40, 93184
s_add_u32 s43, s38, 344064
buffer_load_dwordx4 v3, s[12:15], s43 offen lds
s_add_u32 s37, s37, 128
s_add_u32 s38, s38, 393216
buffer_store_dwordx4 v[128:131], v10, s[24:27], s28 offen sc1
s_add_u32 s28, s28, 1024
s_load_dword s64, s[80:81], 0
s_load_dword s65, s[80:81], 64
s_load_dword s66, s[80:81], 128
s_load_dword s67, s[80:81], 192
s_load_dword s68, s[80:81], 7168
s_load_dword s69, s[80:81], 7232
s_load_dword s70, s[80:81], 7296
s_load_dword s71, s[80:81], 7360
s_add_u32 s80, s80, 14336
s_addc_u32 s81, s81, 0
s_waitcnt vmcnt(16)
s_barrier
s_add_u32 m0, s39, 0
s_mov_b64 exec, s[60:61]
buffer_load_dwordx4 v4, s[8:11], s37 offen lds
s_mov_b64 exec, -1
s_add_u32 m0, s39, 3072
s_nop 0
buffer_load_dwordx4 v5, s[8:11], s37 offen lds
s_add_u32 m0, s39, 6144
s_nop 0
buffer_load_dwordx4 v6, s[8:11], s37 offen lds
s_add_u32 m0, s39, 9216
s_nop 0
buffer_load_dwordx4 v7, s[8:11], s37 offen lds
s_add_u32 m0, s39, 12288
s_nop 0
buffer_load_dwordx4 v8, s[8:11], s37 offen lds
s_add_u32 m0, s39, 15360
s_nop 0
buffer_load_dwordx4 v9, s[8:11], s37 offen lds
s_add_u32 m0, s40, 0
s_add_u32 s43, s38, 0
buffer_load_dwordx4 v2, s[12:15], s43 offen lds
s_add_u32 m0, s40, 1024
s_add_u32 s43, s38, 49152
buffer_load_dwordx4 v3, s[12:15], s43 offen lds
s_add_u32 m0, s40, 2048
s_add_u32 s43, s38, 98304
buffer_load_dwordx4 v2, s[12:15], s43 offen lds
s_add_u32 m0, s40, 3072
s_add_u32 s43, s38, 147456
buffer_load_dwordx4 v3, s[12:15], s43 offen lds
s_add_u32 m0, s40, 4096
s_add_u32 s43, s38, 196608
buffer_load_dwordx4 v2, s[12:15], s43 offen lds
s_add_u32 m0, s40, 5120
s_add_u32 s43, s38, 245760
buffer_load_dwordx4 v3, s[12:15], s43 offen lds
s_add_u32 m0, s40, 6144
s_add_u32 s43, s38, 294912
buffer_load_dwordx4 v2, s[12:15], s43 offen lds
s_add_u32 m0, s40, 7168
s_add_u32 s43, s38, 344064
buffer_load_dwordx4 v3, s[12:15], s43 offen lds
s_add_u32 s37, s37, 128
s_add_u32 s38, s38, 393216
buffer_store_dwordx4 v[128:131], v10, s[24:27], s28 offen sc1
s_add_u32 s28, s28, 1024
s_load_dword s64, s[80:81], 0
s_load_dword s65, s[80:81], 64
s_load_dword s66, s[80:81], 128
s_load_dword s67, s[80:81], 192
s_load_dword s68, s[80:81], 7168
s_load_dword s69, s[80:81], 7232
s_load_dword s70, s[80:81], 7296
s_load_dword s71, s[80:81], 7360
s_add_u32 s80, s80, 14336
s_addc_u32 s81, s81, 0
s_waitcnt vmcnt(16)
s_barrier
s_add_u32 m0, s39, 43008
s_mov_b64 exec, s[60:61]
buffer_load_dwordx4 v4, s[8:11], s37 offen lds
s_mov_b64 exec, -1
s_add_u32 m0, s39, 46080
s_nop 0
buffer_load_dwordx4 v5, s[8:11], s37 offen lds
s_add_u32 m0, s39, 49152
s_nop 0
buffer_load_dwordx4 v6, s[8:11], s37 offen lds
s_add_u32 m0, s39, 52224
s_nop 0
buffer_load_dwordx4 v7, s[8:11], s37 offen lds
s_add_u32 m0, s39, 55296
s_nop 0
buffer_load_dwordx4 v8, s[8:11], s37 offen lds
s_add_u32 m0, s39, 58368
s_nop 0
buffer_load_dwordx4 v9, s[8:11], s37 offen lds
s_add_u32 m0, s40, 43008
s_add_u32 s43, s38, 0
buffer_load_dwordx4 v2, s[12:15], s43 offen lds
s_add_u32 m0, s40, 44032
s_add_u32 s43, s38, 49152
buffer_load_dwordx4 v3, s[12:15], s43 offen lds
s_add_u32 m0, s40, 45056
s_add_u32 s43, s38, 98304
buffer_load_dwordx4 v2, s[12:15], s43 offen lds
s_add_u32 m0, s40, 46080
s_add_u32 s43, s38, 147456
buffer_load_dwordx4 v3, s[12:15], s43 offen lds
s_add_u32 m0, s40, 47104
s_add_u32 s43, s38, 196608
buffer_load_dwordx4 v2, s[12:15], s43 offen lds
s_add_u32 m0, s40, 48128
s_add_u32 s43, s38, 245760
buffer_load_dwordx4 v3, s[12:15], s43 offen lds
s_add_u32 m0, s40, 49152
s_add_u32 s43, s38, 294912
buffer_load_dwordx4 v2, s[12:15], s43 offen lds
s_add_u32 m0, s40, 50176
s_add_u32 s43, s38, 344064
buffer_load_dwordx4 v3, s[12:15], s43 offen lds
s_add_u32 s37, s37, 128
s_add_u32 s38, s38, 393216
buffer_store_dwordx4 v[128:131], v10, s[24:27], s28 offen sc1
s_add_u32 s28, s28, 1024
s_load_dword s64, s[80:81], 0
s_load_dword s65, s[80:81], 64
s_load_dword s66, s[80:81], 128
s_load_dword s67, s[80:81], 192
s_load_dword s68, s[80:81], 7168
s_load_dword s69, s[80:81], 7232
s_load_dword s70, s[80:81], 7296
s_load_dword s71, s[80:81], 7360
s_add_u32 s80, s80, 14336
s_addc_u32 s81, s81, 0
s_waitcnt vmcnt(16)
s_barrier
s_add_u32 m0, s39, 86016
s_mov_b64 exec, s[60:61]
buffer_load_dwordx4 v4, s[8:11], s37 offen lds
s_mov_b64 exec, -1
s_add_u32 m0, s39, 89088
s_nop 0
buffer_load_dwordx4 v5, s[8:11], s37 offen lds
s_add_u32 m0, s39, 92160
s_nop 0
buffer_load_dwordx4 v6, s[8:11], s37 offen lds
s_add_u32 m0, s39, 95232
s_nop 0
buffer_load_dwordx4 v7, s[8:11], s37 offen lds
s_add_u32 m0, s39, 98304
s_nop 0
buffer_load_dwordx4 v8, s[8:11], s37 offen lds
s_add_u32 m0, s39, 101376
s_nop 0
buffer_load_dwordx4 v9, s[8:11], s37 offen lds
s_add_u32 m0, s40, 86016
s_add_u32 s43, s38, 0
buffer_load_dwordx4 v2, s[12:15], s43 offen lds
s_add_u32 m0, s40, 87040
s_add_u32 s43, s38, 49152
buffer_load_dwordx4 v3, s[12:15], s43 offen lds
s_add_u32 m0, s40, 88064
s_add_u32 s43, s38, 98304
buffer_load_dwordx4 v2, s[12:15], s43 offen lds
s_add_u32 m0, s40, 89088
s_add_u32 s43, s38, 147456
buffer_load_dwordx4 v3, s[12:15], s43 offen lds
s_add_u32 m0, s40, 90112
s_add_u32 s43, s38, 196608
buffer_load_dwordx4 v2, s[12:15], s43 offen lds
s_add_u32 m0, s40, 91136
s_add_u32 s43, s38, 245760
buffer_load_dwordx4 v3, s[12:15], s43 offen lds
s_add_u32 m0, s40, 92160
s_add_u32 s43, s38, 294912
buffer_load_dwordx4 v2, s[12:15], s43 offen lds
s_add_u32 m0, s40, 93184
s_add_u32 s43, s38, 344064
buffer_load_dwordx4 v3, s[12:15], s43 offen lds
s_add_u32 s37, s37, 128
s_add_u32 s38, s38, 393216
s_load_dword s64, s[80:81], 0
s_load_dword s65, s[80:81], 64
s_load_dword s66, s[80:81], 128
s_load_dword s67, s[80:81], 192
s_load_dword s68, s[80:81], 7168
s_load_dword s69, s[80:81], 7232
s_load_dword s70, s[80:81], 7296
s_load_dword s71, s[80:81], 7360
s_add_u32 s80, s80, 14336
s_addc_u32 s81, s81, 0
s_waitcnt vmcnt(15)
s_barrier
s_add_u32 m0, s39, 0
s_mov_b64 exec, s[60:61]
buffer_load_dwordx4 v4, s[8:11], s37 offen lds
s_mov_b64 exec, -1
s_add_u32 m0, s39, 3072
s_nop 0
buffer_load_dwordx4 v5, s[8:11], s37 offen lds
s_add_u32 m0, s39, 6144
s_nop 0
buffer_load_dwordx4 v6, s[8:11], s37 offen lds
s_add_u32 m0, s39, 9216
s_nop 0
buffer_load_dwordx4 v7, s[8:11], s37 offen lds
s_add_u32 m0, s39, 12288
s_nop 0
buffer_load_dwordx4 v8, s[8:11], s37 offen lds
s_add_u32 m0, s39, 15360
s_nop 0
buffer_load_dwordx4 v9, s[8:11], s37 offen lds
s_add_u32 m0, s40, 0
s_add_u32 s43, s38, 0
buffer_load_dwordx4 v2, s[12:15], s43 offen lds
s_add_u32 m0, s40, 1024
s_add_u32 s43, s38, 49152
buffer_load_dwordx4 v3, s[12:15], s43 offen lds
s_add_u32 m0, s40, 2048
s_add_u32 s43, s38, 98304
buffer_load_dwordx4 v2, s[12:15], s43 offen lds
s_add_u32 m0, s40, 3072
s_add_u32 s43, s38, 147456
buffer_load_dwordx4 v3, s[12:15], s43 offen lds
s_add_u32 m0, s40, 4096
s_add_u32 s43, s38, 196608
buffer_load_dwordx4 v2, s[12:15], s43 offen lds
s_add_u32 m0, s40, 5120
s_add_u32 s43, s38, 245760
buffer_load_dwordx4 v3, s[12:15], s43 offen lds
s_add_u32 m0, s40, 6144
s_add_u32 s43, s38, 294912
buffer_load_dwordx4 v2, s[12:15], s43 offen lds
s_add_u32 m0, s40, 7168
s_add_u32 s43, s38, 344064
buffer_load_dwordx4 v3, s[12:15], s43 offen lds
s_add_u32 s37, s37, 128
s_add_u32 s38, s38, 393216
s_waitcnt vmcnt(14)
s_barrier
s_waitcnt vmcnt(0)
s_barrier
s_barrier
s_cmp_eq_u32 s47, 0
s_cbranch_scc1 Lx_12
s_cmp_eq_u32 s47, 1
s_cbranch_scc1 Lx_13
s_branch Lw_15
Lr_16:
s_branch Lx_14
Lx_13:
s_branch Lw_17
Lr_18:
s_branch Lx_14
Lx_12:
s_branch Lw_19
Lr_20:
Lx_14:
s_waitcnt lgkmcnt(0)
s_and_b32 s43, s36, 1
s_lshr_b32 s44, s36, 1
s_and_b32 s44, s44, 1
s_lshr_b32 s45, s36, 2
v_lshlrev_b32 v14, 2, v13
v_sub_u32 v14, v12, v14
v_subrev_u32 v15, 0, v14
v_cmp_ge_u32 s[52:53], 7, v15
v_add_u32 v15, 16, v15
v_cmp_ge_u32 s[84:85], 7, v15
v_subrev_u32 v15, 1, v14
v_cmp_ge_u32 s[54:55], 7, v15
v_add_u32 v15, 16, v15
v_cmp_ge_u32 s[86:87], 7, v15
v_subrev_u32 v15, 2, v14
v_cmp_ge_u32 s[56:57], 7, v15
v_add_u32 v15, 16, v15
v_cmp_ge_u32 s[88:89], 7, v15
v_subrev_u32 v15, 3, v14
v_cmp_ge_u32 s[58:59], 7, v15
v_add_u32 v15, 16, v15
v_cmp_ge_u32 s[90:91], 7, v15
s_lshl_b32 s46, s45, 6
s_add_u32 s46, s46, s44
s_add_u32 s46, s46, 16
v_lshl_add_u32 v14, v12, 1, s46
s_lshl_b32 s47, s43, 6
v_lshl_add_u32 v15, v13, 4, s47
v_mul_u32_u24 v20, 400, v14
v_add_u32 v20, v20, v15
v_subrev_u32 v16, 32, v14
v_max_i32 v16, 0, v16
v_mul_u32_u24 v21, 400, v16
v_add_u32 v21, v21, v15
v_lshrrev_b32 v16, 2, v12
v_lshl_add_u32 v16, v13, 2, v16
v_lshl_add_u32 v16, v16, 1, s46
v_and_b32 v17, 3, v1
v_lshl_add_u32 v17, v17, 3, s47
v_mul_u32_u24 v22, 400, v16
v_add_u32 v22, v22, v17
v_subrev_u32 v16, 32, v16
v_max_i32 v16, 0, v16
v_mul_u32_u24 v23, 400, v16
v_add_u32 v23, v23, v17
s_lshl_b32 s60, s43, 13
s_lshl_b32 s61, s45, 10
s_add_u32 s60, s60, s61
s_lshl_b32 s61, s44, 8
s_add_u32 s60, s60, s61
v_lshlrev_b32 v27, 11, v13
v_lshl_add_u32 v27, v12, 4, v27
v_add_u32 v27, s60, v27
v_mov_b32 v28, 0xff800000
s_mov_b32 s61, 0x3e8293ee
s_nop 2
s_or_b32 s62, s34, s45
s_cmp_lg_u32 s62, 0
s_cselect_b64 s[64:65], s[84:85], 0
s_cselect_b64 s[66:67], s[86:87], 0
s_cselect_b64 s[68:69], s[88:89], 0
s_cselect_b64 s[70:71], s[90:91], 0
s_branch Latt_4
.p2align 3
Lcons_2:
s_cmp_ge_u32 s36, 2
s_cbranch_scc1 Lsp_5
s_cmp_ge_u32 s2, 128
s_cbranch_scc1 Lsp_5
s_mov_b32 s84, s6
s_mov_b32 s85, s7
s_mov_b32 s86, 6291456
s_mov_b32 s87, 0x20000
s_and_b32 s43, s35, 8
s_or_b32 s43, s43, 3
s_lshl_b32 s43, s43, 7
s_lshr_b32 s44, s2, 3
s_mul_i32 s44, s44, 196608
s_add_u32 s43, s43, s44
s_lshl_b32 s44, s36, 6
v_add_u32 v15, s44, v1
v_min_u32 v15, 95, v15
v_mul_u32_u24 v16, 21846, v15
v_lshrrev_b32 v16, 16, v16
v_mul_u32_u24 v17, 3, v16
v_sub_u32 v15, v15, v17
v_mul_u32_u24 v16, 6144, v16
v_lshl_add_u32 v15, v15, 11, v16
buffer_load_dword v31, v15, s[84:87], s43 offen
Lsp_5:
v_lshrrev_b32 v16, 1, v12
v_xor_b32 v15, v13, v16
v_lshlrev_b32 v15, 4, v15
v_lshl_add_u32 v2, v12, 7, v15
v_xor_b32 v3, 64, v2
v_add_u32 v4, 86016, v2
v_add_u32 v5, 86016, v3
v_lshrrev_b32 v15, 2, v12
v_and_b32 v16, 3, v1
v_lshl_add_u32 v19, v13, 3, v15
v_lshlrev_b32 v19, 7, v19
v_and_b32 v15, 2, v15
v_and_b32 v17, 1, v13
v_lshl_add_u32 v15, v17, 2, v15
v_lshrrev_b32 v17, 1, v16
s_lshl_b32 s43, s36, 1
v_add_u32 v17, s43, v17
v_xor_b32 v15, v15, v17
v_lshl_add_u32 v19, v15, 4, v19
v_and_b32 v16, 1, v16
v_lshl_add_u32 v19, v16, 3, v19
v_add_u32 v6, 18432, v19
v_add_u32 v7, 61440, v19
v_add_u32 v8, 104448, v19
v_mov_b32 v128, 0
v_mov_b32 v129, 0
v_mov_b32 v130, 0
v_mov_b32 v131, 0
v_mov_b32 v132, 0
v_mov_b32 v133, 0
v_mov_b32 v134, 0
v_mov_b32 v135, 0
v_mov_b32 v136, 0
v_mov_b32 v137, 0
v_mov_b32 v138, 0
v_mov_b32 v139, 0
v_mov_b32 v140, 0
v_mov_b32 v141, 0
v_mov_b32 v142, 0
v_mov_b32 v143, 0
v_mov_b32 v144, 0
v_mov_b32 v145, 0
v_mov_b32 v146, 0
v_mov_b32 v147, 0
v_mov_b32 v148, 0
v_mov_b32 v149, 0
v_mov_b32 v150, 0
v_mov_b32 v151, 0
v_mov_b32 v152, 0
v_mov_b32 v153, 0
v_mov_b32 v154, 0
v_mov_b32 v155, 0
v_mov_b32 v156, 0
v_mov_b32 v157, 0
v_mov_b32 v158, 0
v_mov_b32 v159, 0
v_mov_b32 v160, 0
v_mov_b32 v161, 0
v_mov_b32 v162, 0
v_mov_b32 v163, 0
v_mov_b32 v164, 0
v_mov_b32 v165, 0
v_mov_b32 v166, 0
v_mov_b32 v167, 0
v_mov_b32 v168, 0
v_mov_b32 v169, 0
v_mov_b32 v170, 0
v_mov_b32 v171, 0
v_mov_b32 v172, 0
v_mov_b32 v173, 0
v_mov_b32 v174, 0
v_mov_b32 v175, 0
v_mov_b32 v176, 0
v_mov_b32 v177, 0
v_mov_b32 v178, 0
v_mov_b32 v179, 0
v_mov_b32 v180, 0
v_mov_b32 v181, 0
v_mov_b32 v182, 0
v_mov_b32 v183, 0
v_mov_b32 v184, 0
v_mov_b32 v185, 0
v_mov_b32 v186, 0
v_mov_b32 v187, 0
v_mov_b32 v188, 0
v_mov_b32 v189, 0
v_mov_b32 v190, 0
v_mov_b32 v191, 0
v_mov_b32 v192, 0
v_mov_b32 v193, 0
v_mov_b32 v194, 0
v_mov_b32 v195, 0
v_mov_b32 v196, 0
v_mov_b32 v197, 0
v_mov_b32 v198, 0
v_mov_b32 v199, 0
v_mov_b32 v200, 0
v_mov_b32 v201, 0
v_mov_b32 v202, 0
v_mov_b32 v203, 0
v_mov_b32 v204, 0
v_mov_b32 v205, 0
v_mov_b32 v206, 0
v_mov_b32 v207, 0
v_mov_b32 v208, 0
v_mov_b32 v209, 0
v_mov_b32 v210, 0
v_mov_b32 v211, 0
v_mov_b32 v212, 0
v_mov_b32 v213, 0
v_mov_b32 v214, 0
v_mov_b32 v215, 0
v_mov_b32 v216, 0
v_mov_b32 v217, 0
v_mov_b32 v218, 0
v_mov_b32 v219, 0
v_mov_b32 v220, 0
v_mov_b32 v221, 0
v_mov_b32 v222, 0
v_mov_b32 v223, 0
v_mov_b32 v224, 0
v_mov_b32 v225, 0
v_mov_b32 v226, 0
v_mov_b32 v227, 0
v_mov_b32 v228, 0
v_mov_b32 v229, 0
v_mov_b32 v230, 0
v_mov_b32 v231, 0
v_mov_b32 v232, 0
v_mov_b32 v233, 0
v_mov_b32 v234, 0
v_mov_b32 v235, 0
s_and_b32 s43, s36, 1
s_lshr_b32 s44, s36, 1
s_and_b32 s44, s44, 1
s_lshr_b32 s45, s36, 2
v_lshlrev_b32 v14, 2, v13
v_sub_u32 v14, v12, v14
v_subrev_u32 v15, 0, v14
v_cmp_ge_u32 s[52:53], 7, v15
v_add_u32 v15, 16, v15
v_cmp_ge_u32 s[84:85], 7, v15
v_subrev_u32 v15, 1, v14
v_cmp_ge_u32 s[54:55], 7, v15
v_add_u32 v15, 16, v15
v_cmp_ge_u32 s[86:87], 7, v15
v_subrev_u32 v15, 2, v14
v_cmp_ge_u32 s[56:57], 7, v15
v_add_u32 v15, 16, v15
v_cmp_ge_u32 s[88:89], 7, v15
v_subrev_u32 v15, 3, v14
v_cmp_ge_u32 s[58:59], 7, v15
v_add_u32 v15, 16, v15
v_cmp_ge_u32 s[90:91], 7, v15
s_lshl_b32 s46, s45, 6
s_add_u32 s46, s46, s44
s_add_u32 s46, s46, 16
v_lshl_add_u32 v14, v12, 1, s46
s_lshl_b32 s47, s43, 6
v_lshl_add_u32 v15, v13, 4, s47
v_mul_u32_u24 v20, 400, v14
v_add_u32 v20, v20, v15
v_subrev_u32 v16, 32, v14
v_max_i32 v16, 0, v16
v_mul_u32_u24 v21, 400, v16
v_add_u32 v21, v21, v15
v_lshrrev_b32 v16, 2, v12
v_lshl_add_u32 v16, v13, 2, v16
v_lshl_add_u32 v16, v16, 1, s46
v_and_b32 v17, 3, v1
v_lshl_add_u32 v17, v17, 3, s47
v_mul_u32_u24 v22, 400, v16
v_add_u32 v22, v22, v17
v_subrev_u32 v16, 32, v16
v_max_i32 v16, 0, v16
v_mul_u32_u24 v23, 400, v16
v_add_u32 v23, v23, v17
s_lshl_b32 s60, s43, 13
s_lshl_b32 s61, s45, 10
s_add_u32 s60, s60, s61
s_lshl_b32 s61, s44, 8
s_add_u32 s60, s60, s61
v_lshlrev_b32 v27, 11, v13
v_lshl_add_u32 v27, v12, 4, v27
v_add_u32 v27, s60, v27
v_mov_b32 v28, 0xff800000
s_mov_b32 s61, 0x3e8293ee
s_nop 2
s_or_b32 s62, s34, s45
s_cmp_lg_u32 s62, 0
s_cselect_b64 s[64:65], s[84:85], 0
s_cselect_b64 s[66:67], s[86:87], 0
s_cselect_b64 s[68:69], s[88:89], 0
s_cselect_b64 s[70:71], s[90:91], 0
s_lshl_b32 s43, s36, 5
s_add_u32 s43, s43, 16
v_lshl_add_u32 v10, v12, 1, s43
v_lshlrev_b32 v10, 7, v10
v_and_b32 v16, 1, v13
v_lshlrev_b32 v16, 1, v16
v_lshrrev_b32 v17, 1, v13
v_add_u32 v16, v16, v17
v_and_b32 v17, 7, v12
v_xor_b32 v16, v16, v17
v_lshl_add_u32 v10, v16, 4, v10
s_mov_b32 s42, s35
v_lshlrev_b32 v9, 3, v12
v_add_u32 v9, 129024, v9
v_mul_u32_u24 v14, 400, v12
v_lshl_add_u32 v14, v13, 3, v14
s_lshl_b32 s43, s36, 5
v_add_u32 v14, s43, v14
s_barrier
ds_read_b128 v[32:35], v2 offset:0
ds_read_b64_tr_b16 v[72:73], v6 offset:8192
ds_read_b64_tr_b16 v[74:75], v6 offset:8704
ds_read_b64_tr_b16 v[76:77], v6 offset:16384
ds_read_b64_tr_b16 v[78:79], v6 offset:16896
ds_read_b64_tr_b16 v[68:69], v6 offset:0
ds_read_b64_tr_b16 v[70:71], v6 offset:512
ds_read_b128 v[36:39], v2 offset:2048
ds_read_b128 v[40:43], v2 offset:4096
ds_read_b128 v[44:47], v2 offset:6144
ds_read_b128 v[48:51], v2 offset:8192
ds_read_b128 v[52:55], v2 offset:10240
ds_read_b128 v[56:59], v2 offset:12288
ds_read_b128 v[60:63], v2 offset:14336
ds_read_b128 v[64:67], v2 offset:16384
s_mov_b32 s41, 5
.p2align 3
Lcl_6:
s_sub_u32 s42, s42, 1
s_cbranch_scc0 Lxr_7
v_add_u32 v15, 0, v10
v_xor_b32 v16, 64, v15
ds_read_b128 v[240:243], v15 offset:0
ds_read_b128 v[244:247], v16 offset:0
ds_read_b128 v[248:251], v15 offset:128
ds_read_b128 v[252:255], v16 offset:128
Lxr_7:
s_waitcnt lgkmcnt(0)
v_mfma_f32_16x16x32_bf16 v[164:167], v[72:75], v[32:35], v[164:167]
ds_read_b128 v[80:83], v3 offset:0
v_mfma_f32_16x16x32_bf16 v[200:203], v[76:79], v[32:35], v[200:203]
ds_read_b64_tr_b16 v[120:121], v6 offset:12288
v_mfma_f32_16x16x32_bf16 v[128:131], v[68:71], v[32:35], v[128:131]
ds_read_b64_tr_b16 v[122:123], v6 offset:12800
v_mfma_f32_16x16x32_bf16 v[168:171], v[72:75], v[36:39], v[168:171]
ds_read_b64_tr_b16 v[124:125], v6 offset:20480
v_mfma_f32_16x16x32_bf16 v[204:207], v[76:79], v[36:39], v[204:207]
ds_read_b64_tr_b16 v[126:127], v6 offset:20992
v_mfma_f32_16x16x32_bf16 v[132:135], v[68:71], v[36:39], v[132:135]
ds_read_b64_tr_b16 v[116:117], v6 offset:4096
v_mfma_f32_16x16x32_bf16 v[172:175], v[72:75], v[40:43], v[172:175]
ds_read_b64_tr_b16 v[118:119], v6 offset:4608
v_mfma_f32_16x16x32_bf16 v[208:211], v[76:79], v[40:43], v[208:211]
ds_read_b128 v[84:87], v3 offset:2048
v_mfma_f32_16x16x32_bf16 v[136:139], v[68:71], v[40:43], v[136:139]
ds_read_b128 v[88:91], v3 offset:4096
v_mfma_f32_16x16x32_bf16 v[176:179], v[72:75], v[44:47], v[176:179]
ds_read_b128 v[92:95], v3 offset:6144
v_mfma_f32_16x16x32_bf16 v[212:215], v[76:79], v[44:47], v[212:215]
ds_read_b128 v[96:99], v3 offset:8192
v_mfma_f32_16x16x32_bf16 v[140:143], v[68:71], v[44:47], v[140:143]
ds_read_b128 v[100:103], v3 offset:10240
v_mfma_f32_16x16x32_bf16 v[180:183], v[72:75], v[48:51], v[180:183]
ds_read_b128 v[104:107], v3 offset:12288
v_mfma_f32_16x16x32_bf16 v[216:219], v[76:79], v[48:51], v[216:219]
ds_read_b128 v[108:111], v3 offset:14336
v_mfma_f32_16x16x32_bf16 v[144:147], v[68:71], v[48:51], v[144:147]
ds_read_b128 v[112:115], v3 offset:16384
v_mfma_f32_16x16x32_bf16 v[184:187], v[72:75], v[52:55], v[184:187]
v_mfma_f32_16x16x32_bf16 v[220:223], v[76:79], v[52:55], v[220:223]
v_mfma_f32_16x16x32_bf16 v[148:151], v[68:71], v[52:55], v[148:151]
v_mfma_f32_16x16x32_bf16 v[188:191], v[72:75], v[56:59], v[188:191]
v_mfma_f32_16x16x32_bf16 v[224:227], v[76:79], v[56:59], v[224:227]
v_mfma_f32_16x16x32_bf16 v[152:155], v[68:71], v[56:59], v[152:155]
v_mfma_f32_16x16x32_bf16 v[192:195], v[72:75], v[60:63], v[192:195]
v_mfma_f32_16x16x32_bf16 v[228:231], v[76:79], v[60:63], v[228:231]
v_mfma_f32_16x16x32_bf16 v[156:159], v[68:71], v[60:63], v[156:159]
v_mfma_f32_16x16x32_bf16 v[196:199], v[72:75], v[64:67], v[196:199]
v_mfma_f32_16x16x32_bf16 v[232:235], v[76:79], v[64:67], v[232:235]
v_mfma_f32_16x16x32_bf16 v[160:163], v[68:71], v[64:67], v[160:163]
s_waitcnt lgkmcnt(0)
s_barrier
v_mfma_f32_16x16x32_bf16 v[164:167], v[120:123], v[80:83], v[164:167]
ds_read_b128 v[32:35], v2 offset:43008
v_mfma_f32_16x16x32_bf16 v[200:203], v[124:127], v[80:83], v[200:203]
ds_read_b64_tr_b16 v[72:73], v7 offset:8192
v_mfma_f32_16x16x32_bf16 v[128:131], v[116:119], v[80:83], v[128:131]
ds_read_b64_tr_b16 v[74:75], v7 offset:8704
v_mfma_f32_16x16x32_bf16 v[168:171], v[120:123], v[84:87], v[168:171]
ds_read_b64_tr_b16 v[76:77], v7 offset:16384
v_mfma_f32_16x16x32_bf16 v[204:207], v[124:127], v[84:87], v[204:207]
ds_read_b64_tr_b16 v[78:79], v7 offset:16896
v_mfma_f32_16x16x32_bf16 v[132:135], v[116:119], v[84:87], v[132:135]
ds_read_b64_tr_b16 v[68:69], v7 offset:0
v_mfma_f32_16x16x32_bf16 v[172:175], v[120:123], v[88:91], v[172:175]
ds_read_b64_tr_b16 v[70:71], v7 offset:512
v_mfma_f32_16x16x32_bf16 v[208:211], v[124:127], v[88:91], v[208:211]
ds_read_b128 v[36:39], v2 offset:45056
v_mfma_f32_16x16x32_bf16 v[136:139], v[116:119], v[88:91], v[136:139]
ds_read_b128 v[40:43], v2 offset:47104
v_mfma_f32_16x16x32_bf16 v[176:179], v[120:123], v[92:95], v[176:179]
ds_read_b128 v[44:47], v2 offset:49152
v_mfma_f32_16x16x32_bf16 v[212:215], v[124:127], v[92:95], v[212:215]
ds_read_b128 v[48:51], v2 offset:51200
v_mfma_f32_16x16x32_bf16 v[140:143], v[116:119], v[92:95], v[140:143]
ds_read_b128 v[52:55], v2 offset:53248
v_mfma_f32_16x16x32_bf16 v[180:183], v[120:123], v[96:99], v[180:183]
ds_read_b128 v[56:59], v2 offset:55296
v_mfma_f32_16x16x32_bf16 v[216:219], v[124:127], v[96:99], v[216:219]
ds_read_b128 v[60:63], v2 offset:57344
v_mfma_f32_16x16x32_bf16 v[144:147], v[116:119], v[96:99], v[144:147]
ds_read_b128 v[64:67], v2 offset:59392
v_mfma_f32_16x16x32_bf16 v[184:187], v[120:123], v[100:103], v[184:187]
v_mfma_f32_16x16x32_bf16 v[220:223], v[124:127], v[100:103], v[220:223]
v_mfma_f32_16x16x32_bf16 v[148:151], v[116:119], v[100:103], v[148:151]
v_mfma_f32_16x16x32_bf16 v[188:191], v[120:123], v[104:107], v[188:191]
v_mfma_f32_16x16x32_bf16 v[224:227], v[124:127], v[104:107], v[224:227]
v_mfma_f32_16x16x32_bf16 v[152:155], v[116:119], v[104:107], v[152:155]
v_mfma_f32_16x16x32_bf16 v[192:195], v[120:123], v[108:111], v[192:195]
v_mfma_f32_16x16x32_bf16 v[228:231], v[124:127], v[108:111], v[228:231]
v_mfma_f32_16x16x32_bf16 v[156:159], v[116:119], v[108:111], v[156:159]
v_mfma_f32_16x16x32_bf16 v[196:199], v[120:123], v[112:115], v[196:199]
v_mfma_f32_16x16x32_bf16 v[232:235], v[124:127], v[112:115], v[232:235]
v_mfma_f32_16x16x32_bf16 v[160:163], v[116:119], v[112:115], v[160:163]
s_sub_u32 s42, s42, 1
s_cbranch_scc0 Lxr_8
v_add_u32 v15, 43008, v10
v_xor_b32 v16, 64, v15
ds_read_b128 v[240:243], v15 offset:0
ds_read_b128 v[244:247], v16 offset:0
ds_read_b128 v[248:251], v15 offset:128
ds_read_b128 v[252:255], v16 offset:128
Lxr_8:
s_waitcnt lgkmcnt(0)
v_mfma_f32_16x16x32_bf16 v[164:167], v[72:75], v[32:35], v[164:167]
ds_read_b128 v[80:83], v3 offset:43008
v_mfma_f32_16x16x32_bf16 v[200:203], v[76:79], v[32:35], v[200:203]
ds_read_b64_tr_b16 v[120:121], v7 offset:12288
v_mfma_f32_16x16x32_bf16 v[128:131], v[68:71], v[32:35], v[128:131]
ds_read_b64_tr_b16 v[122:123], v7 offset:12800
v_mfma_f32_16x16x32_bf16 v[168:171], v[72:75], v[36:39], v[168:171]
ds_read_b64_tr_b16 v[124:125], v7 offset:20480
v_mfma_f32_16x16x32_bf16 v[204:207], v[76:79], v[36:39], v[204:207]
ds_read_b64_tr_b16 v[126:127], v7 offset:20992
v_mfma_f32_16x16x32_bf16 v[132:135], v[68:71], v[36:39], v[132:135]
ds_read_b64_tr_b16 v[116:117], v7 offset:4096
v_mfma_f32_16x16x32_bf16 v[172:175], v[72:75], v[40:43], v[172:175]
ds_read_b64_tr_b16 v[118:119], v7 offset:4608
v_mfma_f32_16x16x32_bf16 v[208:211], v[76:79], v[40:43], v[208:211]
ds_read_b128 v[84:87], v3 offset:45056
v_mfma_f32_16x16x32_bf16 v[136:139], v[68:71], v[40:43], v[136:139]
ds_read_b128 v[88:91], v3 offset:47104
v_mfma_f32_16x16x32_bf16 v[176:179], v[72:75], v[44:47], v[176:179]
ds_read_b128 v[92:95], v3 offset:49152
v_mfma_f32_16x16x32_bf16 v[212:215], v[76:79], v[44:47], v[212:215]
ds_read_b128 v[96:99], v3 offset:51200
v_mfma_f32_16x16x32_bf16 v[140:143], v[68:71], v[44:47], v[140:143]
ds_read_b128 v[100:103], v3 offset:53248
v_mfma_f32_16x16x32_bf16 v[180:183], v[72:75], v[48:51], v[180:183]
ds_read_b128 v[104:107], v3 offset:55296
v_mfma_f32_16x16x32_bf16 v[216:219], v[76:79], v[48:51], v[216:219]
ds_read_b128 v[108:111], v3 offset:57344
v_mfma_f32_16x16x32_bf16 v[144:147], v[68:71], v[48:51], v[144:147]
ds_read_b128 v[112:115], v3 offset:59392
v_mfma_f32_16x16x32_bf16 v[184:187], v[72:75], v[52:55], v[184:187]
v_mfma_f32_16x16x32_bf16 v[220:223], v[76:79], v[52:55], v[220:223]
v_mfma_f32_16x16x32_bf16 v[148:151], v[68:71], v[52:55], v[148:151]
v_mfma_f32_16x16x32_bf16 v[188:191], v[72:75], v[56:59], v[188:191]
v_mfma_f32_16x16x32_bf16 v[224:227], v[76:79], v[56:59], v[224:227]
v_mfma_f32_16x16x32_bf16 v[152:155], v[68:71], v[56:59], v[152:155]
v_mfma_f32_16x16x32_bf16 v[192:195], v[72:75], v[60:63], v[192:195]
v_mfma_f32_16x16x32_bf16 v[228:231], v[76:79], v[60:63], v[228:231]
v_mfma_f32_16x16x32_bf16 v[156:159], v[68:71], v[60:63], v[156:159]
v_mfma_f32_16x16x32_bf16 v[196:199], v[72:75], v[64:67], v[196:199]
v_mfma_f32_16x16x32_bf16 v[232:235], v[76:79], v[64:67], v[232:235]
v_mfma_f32_16x16x32_bf16 v[160:163], v[68:71], v[64:67], v[160:163]
s_waitcnt lgkmcnt(0)
s_barrier
v_mfma_f32_16x16x32_bf16 v[164:167], v[120:123], v[80:83], v[164:167]
ds_read_b128 v[32:35], v4 offset:0
v_mfma_f32_16x16x32_bf16 v[200:203], v[124:127], v[80:83], v[200:203]
ds_read_b64_tr_b16 v[72:73], v8 offset:8192
v_mfma_f32_16x16x32_bf16 v[128:131], v[116:119], v[80:83], v[128:131]
ds_read_b64_tr_b16 v[74:75], v8 offset:8704
v_mfma_f32_16x16x32_bf16 v[168:171], v[120:123], v[84:87], v[168:171]
ds_read_b64_tr_b16 v[76:77], v8 offset:16384
v_mfma_f32_16x16x32_bf16 v[204:207], v[124:127], v[84:87], v[204:207]
ds_read_b64_tr_b16 v[78:79], v8 offset:16896
v_mfma_f32_16x16x32_bf16 v[132:135], v[116:119], v[84:87], v[132:135]
ds_read_b64_tr_b16 v[68:69], v8 offset:0
v_mfma_f32_16x16x32_bf16 v[172:175], v[120:123], v[88:91], v[172:175]
ds_read_b64_tr_b16 v[70:71], v8 offset:512
v_mfma_f32_16x16x32_bf16 v[208:211], v[124:127], v[88:91], v[208:211]
ds_read_b128 v[36:39], v4 offset:2048
v_mfma_f32_16x16x32_bf16 v[136:139], v[116:119], v[88:91], v[136:139]
ds_read_b128 v[40:43], v4 offset:4096
v_mfma_f32_16x16x32_bf16 v[176:179], v[120:123], v[92:95], v[176:179]
ds_read_b128 v[44:47], v4 offset:6144
v_mfma_f32_16x16x32_bf16 v[212:215], v[124:127], v[92:95], v[212:215]
ds_read_b128 v[48:51], v4 offset:8192
v_mfma_f32_16x16x32_bf16 v[140:143], v[116:119], v[92:95], v[140:143]
ds_read_b128 v[52:55], v4 offset:10240
v_mfma_f32_16x16x32_bf16 v[180:183], v[120:123], v[96:99], v[180:183]
ds_read_b128 v[56:59], v4 offset:12288
v_mfma_f32_16x16x32_bf16 v[216:219], v[124:127], v[96:99], v[216:219]
ds_read_b128 v[60:63], v4 offset:14336
v_mfma_f32_16x16x32_bf16 v[144:147], v[116:119], v[96:99], v[144:147]
ds_read_b128 v[64:67], v4 offset:16384
v_mfma_f32_16x16x32_bf16 v[184:187], v[120:123], v[100:103], v[184:187]
v_mfma_f32_16x16x32_bf16 v[220:223], v[124:127], v[100:103], v[220:223]
v_mfma_f32_16x16x32_bf16 v[148:151], v[116:119], v[100:103], v[148:151]
v_mfma_f32_16x16x32_bf16 v[188:191], v[120:123], v[104:107], v[188:191]
v_mfma_f32_16x16x32_bf16 v[224:227], v[124:127], v[104:107], v[224:227]
v_mfma_f32_16x16x32_bf16 v[152:155], v[116:119], v[104:107], v[152:155]
v_mfma_f32_16x16x32_bf16 v[192:195], v[120:123], v[108:111], v[192:195]
v_mfma_f32_16x16x32_bf16 v[228:231], v[124:127], v[108:111], v[228:231]
v_mfma_f32_16x16x32_bf16 v[156:159], v[116:119], v[108:111], v[156:159]
v_mfma_f32_16x16x32_bf16 v[196:199], v[120:123], v[112:115], v[196:199]
v_mfma_f32_16x16x32_bf16 v[232:235], v[124:127], v[112:115], v[232:235]
v_mfma_f32_16x16x32_bf16 v[160:163], v[116:119], v[112:115], v[160:163]
s_sub_u32 s42, s42, 1
s_cbranch_scc0 Lxr_9
v_add_u32 v15, 86016, v10
v_xor_b32 v16, 64, v15
ds_read_b128 v[240:243], v15 offset:0
ds_read_b128 v[244:247], v16 offset:0
ds_read_b128 v[248:251], v15 offset:128
ds_read_b128 v[252:255], v16 offset:128
Lxr_9:
s_waitcnt lgkmcnt(0)
v_mfma_f32_16x16x32_bf16 v[164:167], v[72:75], v[32:35], v[164:167]
ds_read_b128 v[80:83], v5 offset:0
v_mfma_f32_16x16x32_bf16 v[200:203], v[76:79], v[32:35], v[200:203]
ds_read_b64_tr_b16 v[120:121], v8 offset:12288
v_mfma_f32_16x16x32_bf16 v[128:131], v[68:71], v[32:35], v[128:131]
ds_read_b64_tr_b16 v[122:123], v8 offset:12800
v_mfma_f32_16x16x32_bf16 v[168:171], v[72:75], v[36:39], v[168:171]
ds_read_b64_tr_b16 v[124:125], v8 offset:20480
v_mfma_f32_16x16x32_bf16 v[204:207], v[76:79], v[36:39], v[204:207]
ds_read_b64_tr_b16 v[126:127], v8 offset:20992
v_mfma_f32_16x16x32_bf16 v[132:135], v[68:71], v[36:39], v[132:135]
ds_read_b64_tr_b16 v[116:117], v8 offset:4096
v_mfma_f32_16x16x32_bf16 v[172:175], v[72:75], v[40:43], v[172:175]
ds_read_b64_tr_b16 v[118:119], v8 offset:4608
v_mfma_f32_16x16x32_bf16 v[208:211], v[76:79], v[40:43], v[208:211]
ds_read_b128 v[84:87], v5 offset:2048
v_mfma_f32_16x16x32_bf16 v[136:139], v[68:71], v[40:43], v[136:139]
ds_read_b128 v[88:91], v5 offset:4096
v_mfma_f32_16x16x32_bf16 v[176:179], v[72:75], v[44:47], v[176:179]
ds_read_b128 v[92:95], v5 offset:6144
v_mfma_f32_16x16x32_bf16 v[212:215], v[76:79], v[44:47], v[212:215]
ds_read_b128 v[96:99], v5 offset:8192
v_mfma_f32_16x16x32_bf16 v[140:143], v[68:71], v[44:47], v[140:143]
ds_read_b128 v[100:103], v5 offset:10240
v_mfma_f32_16x16x32_bf16 v[180:183], v[72:75], v[48:51], v[180:183]
ds_read_b128 v[104:107], v5 offset:12288
v_mfma_f32_16x16x32_bf16 v[216:219], v[76:79], v[48:51], v[216:219]
ds_read_b128 v[108:111], v5 offset:14336
v_mfma_f32_16x16x32_bf16 v[144:147], v[68:71], v[48:51], v[144:147]
ds_read_b128 v[112:115], v5 offset:16384
v_mfma_f32_16x16x32_bf16 v[184:187], v[72:75], v[52:55], v[184:187]
v_mfma_f32_16x16x32_bf16 v[220:223], v[76:79], v[52:55], v[220:223]
v_mfma_f32_16x16x32_bf16 v[148:151], v[68:71], v[52:55], v[148:151]
v_mfma_f32_16x16x32_bf16 v[188:191], v[72:75], v[56:59], v[188:191]
v_mfma_f32_16x16x32_bf16 v[224:227], v[76:79], v[56:59], v[224:227]
v_mfma_f32_16x16x32_bf16 v[152:155], v[68:71], v[56:59], v[152:155]
v_mfma_f32_16x16x32_bf16 v[192:195], v[72:75], v[60:63], v[192:195]
v_mfma_f32_16x16x32_bf16 v[228:231], v[76:79], v[60:63], v[228:231]
v_mfma_f32_16x16x32_bf16 v[156:159], v[68:71], v[60:63], v[156:159]
v_mfma_f32_16x16x32_bf16 v[196:199], v[72:75], v[64:67], v[196:199]
v_mfma_f32_16x16x32_bf16 v[232:235], v[76:79], v[64:67], v[232:235]
v_mfma_f32_16x16x32_bf16 v[160:163], v[68:71], v[64:67], v[160:163]
s_waitcnt lgkmcnt(0)
s_barrier
v_mfma_f32_16x16x32_bf16 v[164:167], v[120:123], v[80:83], v[164:167]
ds_read_b128 v[32:35], v2 offset:0
v_mfma_f32_16x16x32_bf16 v[200:203], v[124:127], v[80:83], v[200:203]
ds_read_b64_tr_b16 v[72:73], v6 offset:8192
v_mfma_f32_16x16x32_bf16 v[128:131], v[116:119], v[80:83], v[128:131]
ds_read_b64_tr_b16 v[74:75], v6 offset:8704
v_mfma_f32_16x16x32_bf16 v[168:171], v[120:123], v[84:87], v[168:171]
ds_read_b64_tr_b16 v[76:77], v6 offset:16384
v_mfma_f32_16x16x32_bf16 v[204:207], v[124:127], v[84:87], v[204:207]
ds_read_b64_tr_b16 v[78:79], v6 offset:16896
v_mfma_f32_16x16x32_bf16 v[132:135], v[116:119], v[84:87], v[132:135]
ds_read_b64_tr_b16 v[68:69], v6 offset:0
v_mfma_f32_16x16x32_bf16 v[172:175], v[120:123], v[88:91], v[172:175]
ds_read_b64_tr_b16 v[70:71], v6 offset:512
v_mfma_f32_16x16x32_bf16 v[208:211], v[124:127], v[88:91], v[208:211]
ds_read_b128 v[36:39], v2 offset:2048
v_mfma_f32_16x16x32_bf16 v[136:139], v[116:119], v[88:91], v[136:139]
ds_read_b128 v[40:43], v2 offset:4096
v_mfma_f32_16x16x32_bf16 v[176:179], v[120:123], v[92:95], v[176:179]
ds_read_b128 v[44:47], v2 offset:6144
v_mfma_f32_16x16x32_bf16 v[212:215], v[124:127], v[92:95], v[212:215]
ds_read_b128 v[48:51], v2 offset:8192
v_mfma_f32_16x16x32_bf16 v[140:143], v[116:119], v[92:95], v[140:143]
ds_read_b128 v[52:55], v2 offset:10240
v_mfma_f32_16x16x32_bf16 v[180:183], v[120:123], v[96:99], v[180:183]
ds_read_b128 v[56:59], v2 offset:12288
v_mfma_f32_16x16x32_bf16 v[216:219], v[124:127], v[96:99], v[216:219]
ds_read_b128 v[60:63], v2 offset:14336
v_mfma_f32_16x16x32_bf16 v[144:147], v[116:119], v[96:99], v[144:147]
ds_read_b128 v[64:67], v2 offset:16384
v_mfma_f32_16x16x32_bf16 v[184:187], v[120:123], v[100:103], v[184:187]
v_mfma_f32_16x16x32_bf16 v[220:223], v[124:127], v[100:103], v[220:223]
v_mfma_f32_16x16x32_bf16 v[148:151], v[116:119], v[100:103], v[148:151]
v_mfma_f32_16x16x32_bf16 v[188:191], v[120:123], v[104:107], v[188:191]
v_mfma_f32_16x16x32_bf16 v[224:227], v[124:127], v[104:107], v[224:227]
v_mfma_f32_16x16x32_bf16 v[152:155], v[116:119], v[104:107], v[152:155]
v_mfma_f32_16x16x32_bf16 v[192:195], v[120:123], v[108:111], v[192:195]
v_mfma_f32_16x16x32_bf16 v[228:231], v[124:127], v[108:111], v[228:231]
v_mfma_f32_16x16x32_bf16 v[156:159], v[116:119], v[108:111], v[156:159]
v_mfma_f32_16x16x32_bf16 v[196:199], v[120:123], v[112:115], v[196:199]
v_mfma_f32_16x16x32_bf16 v[232:235], v[124:127], v[112:115], v[232:235]
v_mfma_f32_16x16x32_bf16 v[160:163], v[116:119], v[112:115], v[160:163]
s_sub_u32 s41, s41, 1
s_cmp_lg_u32 s41, 0
s_cbranch_scc1 Lcl_6
s_sub_u32 s42, s42, 1
s_cbranch_scc0 Lxr_10
v_add_u32 v15, 0, v10
v_xor_b32 v16, 64, v15
ds_read_b128 v[240:243], v15 offset:0
ds_read_b128 v[244:247], v16 offset:0
ds_read_b128 v[248:251], v15 offset:128
ds_read_b128 v[252:255], v16 offset:128
Lxr_10:
s_waitcnt lgkmcnt(0)
v_mfma_f32_16x16x32_bf16 v[164:167], v[72:75], v[32:35], v[164:167]
ds_read_b128 v[80:83], v3 offset:0
v_mfma_f32_16x16x32_bf16 v[200:203], v[76:79], v[32:35], v[200:203]
ds_read_b64_tr_b16 v[120:121], v6 offset:12288
v_mfma_f32_16x16x32_bf16 v[128:131], v[68:71], v[32:35], v[128:131]
ds_read_b64_tr_b16 v[122:123], v6 offset:12800
v_mfma_f32_16x16x32_bf16 v[168:171], v[72:75], v[36:39], v[168:171]
ds_read_b64_tr_b16 v[124:125], v6 offset:20480
v_mfma_f32_16x16x32_bf16 v[204:207], v[76:79], v[36:39], v[204:207]
ds_read_b64_tr_b16 v[126:127], v6 offset:20992
v_mfma_f32_16x16x32_bf16 v[132:135], v[68:71], v[36:39], v[132:135]
ds_read_b64_tr_b16 v[116:117], v6 offset:4096
v_mfma_f32_16x16x32_bf16 v[172:175], v[72:75], v[40:43], v[172:175]
ds_read_b64_tr_b16 v[118:119], v6 offset:4608
v_mfma_f32_16x16x32_bf16 v[208:211], v[76:79], v[40:43], v[208:211]
ds_read_b128 v[84:87], v3 offset:2048
v_mfma_f32_16x16x32_bf16 v[136:139], v[68:71], v[40:43], v[136:139]
ds_read_b128 v[88:91], v3 offset:4096
v_mfma_f32_16x16x32_bf16 v[176:179], v[72:75], v[44:47], v[176:179]
ds_read_b128 v[92:95], v3 offset:6144
v_mfma_f32_16x16x32_bf16 v[212:215], v[76:79], v[44:47], v[212:215]
ds_read_b128 v[96:99], v3 offset:8192
v_mfma_f32_16x16x32_bf16 v[140:143], v[68:71], v[44:47], v[140:143]
ds_read_b128 v[100:103], v3 offset:10240
v_mfma_f32_16x16x32_bf16 v[180:183], v[72:75], v[48:51], v[180:183]
ds_read_b128 v[104:107], v3 offset:12288
v_mfma_f32_16x16x32_bf16 v[216:219], v[76:79], v[48:51], v[216:219]
ds_read_b128 v[108:111], v3 offset:14336
v_mfma_f32_16x16x32_bf16 v[144:147], v[68:71], v[48:51], v[144:147]
ds_read_b128 v[112:115], v3 offset:16384
v_mfma_f32_16x16x32_bf16 v[184:187], v[72:75], v[52:55], v[184:187]
v_mfma_f32_16x16x32_bf16 v[220:223], v[76:79], v[52:55], v[220:223]
v_mfma_f32_16x16x32_bf16 v[148:151], v[68:71], v[52:55], v[148:151]
v_mfma_f32_16x16x32_bf16 v[188:191], v[72:75], v[56:59], v[188:191]
v_mfma_f32_16x16x32_bf16 v[224:227], v[76:79], v[56:59], v[224:227]
v_mfma_f32_16x16x32_bf16 v[152:155], v[68:71], v[56:59], v[152:155]
v_mfma_f32_16x16x32_bf16 v[192:195], v[72:75], v[60:63], v[192:195]
v_mfma_f32_16x16x32_bf16 v[228:231], v[76:79], v[60:63], v[228:231]
v_mfma_f32_16x16x32_bf16 v[156:159], v[68:71], v[60:63], v[156:159]
v_mfma_f32_16x16x32_bf16 v[196:199], v[72:75], v[64:67], v[196:199]
v_mfma_f32_16x16x32_bf16 v[232:235], v[76:79], v[64:67], v[232:235]
v_mfma_f32_16x16x32_bf16 v[160:163], v[68:71], v[64:67], v[160:163]
s_waitcnt lgkmcnt(0)
s_barrier
v_mfma_f32_16x16x32_bf16 v[164:167], v[120:123], v[80:83], v[164:167]
ds_read_b64 v[32:33], v9 offset:0
v_mfma_f32_16x16x32_bf16 v[200:203], v[124:127], v[80:83], v[200:203]
ds_read_b64 v[34:35], v9 offset:128
v_mfma_f32_16x16x32_bf16 v[128:131], v[116:119], v[80:83], v[128:131]
ds_read_b64 v[36:37], v9 offset:256
v_mfma_f32_16x16x32_bf16 v[168:171], v[120:123], v[84:87], v[168:171]
ds_read_b64 v[38:39], v9 offset:384
v_mfma_f32_16x16x32_bf16 v[204:207], v[124:127], v[84:87], v[204:207]
ds_read_b64 v[40:41], v9 offset:512
v_mfma_f32_16x16x32_bf16 v[132:135], v[116:119], v[84:87], v[132:135]
ds_read_b64 v[42:43], v9 offset:640
v_mfma_f32_16x16x32_bf16 v[172:175], v[120:123], v[88:91], v[172:175]
ds_read_b64 v[44:45], v9 offset:768
v_mfma_f32_16x16x32_bf16 v[208:211], v[124:127], v[88:91], v[208:211]
ds_read_b64 v[46:47], v9 offset:896
v_mfma_f32_16x16x32_bf16 v[136:139], v[116:119], v[88:91], v[136:139]
ds_read_b64 v[48:49], v9 offset:1024
v_mfma_f32_16x16x32_bf16 v[176:179], v[120:123], v[92:95], v[176:179]
v_mov_b32_dpp v52, v128 row_newbcast:0 row_mask:0xf bank_mask:0xf
v_mov_b32_dpp v53, v129 row_newbcast:0 row_mask:0xf bank_mask:0xf
v_mfma_f32_16x16x32_bf16 v[212:215], v[124:127], v[92:95], v[212:215]
v_mov_b32_dpp v54, v130 row_newbcast:0 row_mask:0xf bank_mask:0xf
v_mov_b32_dpp v55, v131 row_newbcast:0 row_mask:0xf bank_mask:0xf
v_mfma_f32_16x16x32_bf16 v[140:143], v[116:119], v[92:95], v[140:143]
v_mov_b32_dpp v56, v164 row_newbcast:0 row_mask:0xf bank_mask:0xf
v_mov_b32_dpp v57, v165 row_newbcast:0 row_mask:0xf bank_mask:0xf
v_mfma_f32_16x16x32_bf16 v[180:183], v[120:123], v[96:99], v[180:183]
v_mov_b32_dpp v58, v166 row_newbcast:0 row_mask:0xf bank_mask:0xf
v_mov_b32_dpp v59, v167 row_newbcast:0 row_mask:0xf bank_mask:0xf
v_mfma_f32_16x16x32_bf16 v[216:219], v[124:127], v[96:99], v[216:219]
v_mov_b32_dpp v60, v200 row_newbcast:0 row_mask:0xf bank_mask:0xf
v_mov_b32_dpp v61, v201 row_newbcast:0 row_mask:0xf bank_mask:0xf
v_mfma_f32_16x16x32_bf16 v[144:147], v[116:119], v[96:99], v[144:147]
v_mov_b32_dpp v62, v202 row_newbcast:0 row_mask:0xf bank_mask:0xf
v_mov_b32_dpp v63, v203 row_newbcast:0 row_mask:0xf bank_mask:0xf
v_mfma_f32_16x16x32_bf16 v[184:187], v[120:123], v[100:103], v[184:187]
s_waitcnt lgkmcnt(0)
v_fma_f32 v164, -v32, v56, v164
v_mfma_f32_16x16x32_bf16 v[220:223], v[124:127], v[100:103], v[220:223]
v_fma_f32 v165, -v32, v57, v165
v_fma_f32 v166, -v32, v58, v166
v_mfma_f32_16x16x32_bf16 v[148:151], v[116:119], v[100:103], v[148:151]
v_fma_f32 v167, -v32, v59, v167
v_mul_f32 v164, v33, v164
v_mfma_f32_16x16x32_bf16 v[188:191], v[120:123], v[104:107], v[188:191]
v_mul_f32 v165, v33, v165
v_mul_f32 v166, v33, v166
v_mfma_f32_16x16x32_bf16 v[224:227], v[124:127], v[104:107], v[224:227]
v_mul_f32 v167, v33, v167
v_cvt_pk_bf16_f32 v164, v164, v165
v_mfma_f32_16x16x32_bf16 v[152:155], v[116:119], v[104:107], v[152:155]
v_cvt_pk_bf16_f32 v165, v166, v167
ds_write_b64 v14, v[164:165] offset:128
v_mfma_f32_16x16x32_bf16 v[192:195], v[120:123], v[108:111], v[192:195]
v_fma_f32 v200, -v32, v60, v200
v_fma_f32 v201, -v32, v61, v201
v_mfma_f32_16x16x32_bf16 v[228:231], v[124:127], v[108:111], v[228:231]
v_fma_f32 v202, -v32, v62, v202
v_fma_f32 v203, -v32, v63, v203
v_mfma_f32_16x16x32_bf16 v[156:159], v[116:119], v[108:111], v[156:159]
v_mul_f32 v200, v33, v200
v_mul_f32 v201, v33, v201
v_mfma_f32_16x16x32_bf16 v[196:199], v[120:123], v[112:115], v[196:199]
v_mul_f32 v202, v33, v202
v_mul_f32 v203, v33, v203
v_mfma_f32_16x16x32_bf16 v[232:235], v[124:127], v[112:115], v[232:235]
v_cvt_pk_bf16_f32 v200, v200, v201
v_cvt_pk_bf16_f32 v201, v202, v203
v_mfma_f32_16x16x32_bf16 v[160:163], v[116:119], v[112:115], v[160:163]
ds_write_b64 v14, v[200:201] offset:256
v_fma_f32 v132, -v34, v52, v132
v_fma_f32 v133, -v34, v53, v133
v_fma_f32 v134, -v34, v54, v134
v_fma_f32 v135, -v34, v55, v135
v_mul_f32 v132, v35, v132
v_mul_f32 v133, v35, v133
v_mul_f32 v134, v35, v134
v_mul_f32 v135, v35, v135
v_cvt_pk_bf16_f32 v132, v132, v133
v_cvt_pk_bf16_f32 v133, v134, v135
ds_write_b64 v14, v[132:133] offset:6400
v_pk_fma_f32 v[168:169], v[34:35], v[56:57], v[168:169] op_sel_hi:[0,1,1] neg_lo:[1,0,0] neg_hi:[1,0,0]
v_pk_fma_f32 v[170:171], v[34:35], v[58:59], v[170:171] op_sel_hi:[0,1,1] neg_lo:[1,0,0] neg_hi:[1,0,0]
v_pk_mul_f32 v[168:169], v[34:35], v[168:169] op_sel:[1,0] op_sel_hi:[1,1]
v_pk_mul_f32 v[170:171], v[34:35], v[170:171] op_sel:[1,0] op_sel_hi:[1,1]
v_cvt_pk_bf16_f32 v168, v168, v169
v_cvt_pk_bf16_f32 v169, v170, v171
ds_write_b64 v14, v[168:169] offset:6528
v_pk_fma_f32 v[204:205], v[34:35], v[60:61], v[204:205] op_sel_hi:[0,1,1] neg_lo:[1,0,0] neg_hi:[1,0,0]
v_pk_fma_f32 v[206:207], v[34:35], v[62:63], v[206:207] op_sel_hi:[0,1,1] neg_lo:[1,0,0] neg_hi:[1,0,0]
v_pk_mul_f32 v[204:205], v[34:35], v[204:205] op_sel:[1,0] op_sel_hi:[1,1]
v_pk_mul_f32 v[206:207], v[34:35], v[206:207] op_sel:[1,0] op_sel_hi:[1,1]
v_cvt_pk_bf16_f32 v204, v204, v205
v_cvt_pk_bf16_f32 v205, v206, v207
ds_write_b64 v14, v[204:205] offset:6656
v_pk_fma_f32 v[136:137], v[36:37], v[52:53], v[136:137] op_sel_hi:[0,1,1] neg_lo:[1,0,0] neg_hi:[1,0,0]
v_pk_fma_f32 v[138:139], v[36:37], v[54:55], v[138:139] op_sel_hi:[0,1,1] neg_lo:[1,0,0] neg_hi:[1,0,0]
v_pk_mul_f32 v[136:137], v[36:37], v[136:137] op_sel:[1,0] op_sel_hi:[1,1]
v_pk_mul_f32 v[138:139], v[36:37], v[138:139] op_sel:[1,0] op_sel_hi:[1,1]
v_cvt_pk_bf16_f32 v136, v136, v137
v_cvt_pk_bf16_f32 v137, v138, v139
ds_write_b64 v14, v[136:137] offset:12800
v_pk_fma_f32 v[172:173], v[36:37], v[56:57], v[172:173] op_sel_hi:[0,1,1] neg_lo:[1,0,0] neg_hi:[1,0,0]
v_pk_fma_f32 v[174:175], v[36:37], v[58:59], v[174:175] op_sel_hi:[0,1,1] neg_lo:[1,0,0] neg_hi:[1,0,0]
v_pk_mul_f32 v[172:173], v[36:37], v[172:173] op_sel:[1,0] op_sel_hi:[1,1]
v_pk_mul_f32 v[174:175], v[36:37], v[174:175] op_sel:[1,0] op_sel_hi:[1,1]
v_cvt_pk_bf16_f32 v172, v172, v173
v_cvt_pk_bf16_f32 v173, v174, v175
ds_write_b64 v14, v[172:173] offset:12928
v_pk_fma_f32 v[208:209], v[36:37], v[60:61], v[208:209] op_sel_hi:[0,1,1] neg_lo:[1,0,0] neg_hi:[1,0,0]
v_pk_fma_f32 v[210:211], v[36:37], v[62:63], v[210:211] op_sel_hi:[0,1,1] neg_lo:[1,0,0] neg_hi:[1,0,0]
v_pk_mul_f32 v[208:209], v[36:37], v[208:209] op_sel:[1,0] op_sel_hi:[1,1]
v_pk_mul_f32 v[210:211], v[36:37], v[210:211] op_sel:[1,0] op_sel_hi:[1,1]
v_cvt_pk_bf16_f32 v208, v208, v209
v_cvt_pk_bf16_f32 v209, v210, v211
ds_write_b64 v14, v[208:209] offset:13056
v_pk_fma_f32 v[140:141], v[38:39], v[52:53], v[140:141] op_sel_hi:[0,1,1] neg_lo:[1,0,0] neg_hi:[1,0,0]
v_pk_fma_f32 v[142:143], v[38:39], v[54:55], v[142:143] op_sel_hi:[0,1,1] neg_lo:[1,0,0] neg_hi:[1,0,0]
v_pk_mul_f32 v[140:141], v[38:39], v[140:141] op_sel:[1,0] op_sel_hi:[1,1]
v_pk_mul_f32 v[142:143], v[38:39], v[142:143] op_sel:[1,0] op_sel_hi:[1,1]
v_cvt_pk_bf16_f32 v140, v140, v141
v_cvt_pk_bf16_f32 v141, v142, v143
ds_write_b64 v14, v[140:141] offset:19200
v_pk_fma_f32 v[176:177], v[38:39], v[56:57], v[176:177] op_sel_hi:[0,1,1] neg_lo:[1,0,0] neg_hi:[1,0,0]
v_pk_fma_f32 v[178:179], v[38:39], v[58:59], v[178:179] op_sel_hi:[0,1,1] neg_lo:[1,0,0] neg_hi:[1,0,0]
v_pk_mul_f32 v[176:177], v[38:39], v[176:177] op_sel:[1,0] op_sel_hi:[1,1]
v_pk_mul_f32 v[178:179], v[38:39], v[178:179] op_sel:[1,0] op_sel_hi:[1,1]
v_cvt_pk_bf16_f32 v176, v176, v177
v_cvt_pk_bf16_f32 v177, v178, v179
ds_write_b64 v14, v[176:177] offset:19328
v_pk_fma_f32 v[212:213], v[38:39], v[60:61], v[212:213] op_sel_hi:[0,1,1] neg_lo:[1,0,0] neg_hi:[1,0,0]
v_pk_fma_f32 v[214:215], v[38:39], v[62:63], v[214:215] op_sel_hi:[0,1,1] neg_lo:[1,0,0] neg_hi:[1,0,0]
v_pk_mul_f32 v[212:213], v[38:39], v[212:213] op_sel:[1,0] op_sel_hi:[1,1]
v_pk_mul_f32 v[214:215], v[38:39], v[214:215] op_sel:[1,0] op_sel_hi:[1,1]
v_cvt_pk_bf16_f32 v212, v212, v213
v_cvt_pk_bf16_f32 v213, v214, v215
ds_write_b64 v14, v[212:213] offset:19456
v_pk_fma_f32 v[144:145], v[40:41], v[52:53], v[144:145] op_sel_hi:[0,1,1] neg_lo:[1,0,0] neg_hi:[1,0,0]
v_pk_fma_f32 v[146:147], v[40:41], v[54:55], v[146:147] op_sel_hi:[0,1,1] neg_lo:[1,0,0] neg_hi:[1,0,0]
v_pk_mul_f32 v[144:145], v[40:41], v[144:145] op_sel:[1,0] op_sel_hi:[1,1]
v_pk_mul_f32 v[146:147], v[40:41], v[146:147] op_sel:[1,0] op_sel_hi:[1,1]
v_cvt_pk_bf16_f32 v144, v144, v145
v_cvt_pk_bf16_f32 v145, v146, v147
ds_write_b64 v14, v[144:145] offset:25600
v_pk_fma_f32 v[180:181], v[40:41], v[56:57], v[180:181] op_sel_hi:[0,1,1] neg_lo:[1,0,0] neg_hi:[1,0,0]
v_pk_fma_f32 v[182:183], v[40:41], v[58:59], v[182:183] op_sel_hi:[0,1,1] neg_lo:[1,0,0] neg_hi:[1,0,0]
v_pk_mul_f32 v[180:181], v[40:41], v[180:181] op_sel:[1,0] op_sel_hi:[1,1]
v_pk_mul_f32 v[182:183], v[40:41], v[182:183] op_sel:[1,0] op_sel_hi:[1,1]
v_cvt_pk_bf16_f32 v180, v180, v181
v_cvt_pk_bf16_f32 v181, v182, v183
ds_write_b64 v14, v[180:181] offset:25728
v_pk_fma_f32 v[216:217], v[40:41], v[60:61], v[216:217] op_sel_hi:[0,1,1] neg_lo:[1,0,0] neg_hi:[1,0,0]
v_pk_fma_f32 v[218:219], v[40:41], v[62:63], v[218:219] op_sel_hi:[0,1,1] neg_lo:[1,0,0] neg_hi:[1,0,0]
v_pk_mul_f32 v[216:217], v[40:41], v[216:217] op_sel:[1,0] op_sel_hi:[1,1]
v_pk_mul_f32 v[218:219], v[40:41], v[218:219] op_sel:[1,0] op_sel_hi:[1,1]
v_cvt_pk_bf16_f32 v216, v216, v217
v_cvt_pk_bf16_f32 v217, v218, v219
ds_write_b64 v14, v[216:217] offset:25856
v_pk_fma_f32 v[148:149], v[42:43], v[52:53], v[148:149] op_sel_hi:[0,1,1] neg_lo:[1,0,0] neg_hi:[1,0,0]
v_pk_fma_f32 v[150:151], v[42:43], v[54:55], v[150:151] op_sel_hi:[0,1,1] neg_lo:[1,0,0] neg_hi:[1,0,0]
v_pk_mul_f32 v[148:149], v[42:43], v[148:149] op_sel:[1,0] op_sel_hi:[1,1]
v_pk_mul_f32 v[150:151], v[42:43], v[150:151] op_sel:[1,0] op_sel_hi:[1,1]
v_cvt_pk_bf16_f32 v148, v148, v149
v_cvt_pk_bf16_f32 v149, v150, v151
ds_write_b64 v14, v[148:149] offset:32000
v_pk_fma_f32 v[184:185], v[42:43], v[56:57], v[184:185] op_sel_hi:[0,1,1] neg_lo:[1,0,0] neg_hi:[1,0,0]
v_pk_fma_f32 v[186:187], v[42:43], v[58:59], v[186:187] op_sel_hi:[0,1,1] neg_lo:[1,0,0] neg_hi:[1,0,0]
v_pk_mul_f32 v[184:185], v[42:43], v[184:185] op_sel:[1,0] op_sel_hi:[1,1]
v_pk_mul_f32 v[186:187], v[42:43], v[186:187] op_sel:[1,0] op_sel_hi:[1,1]
v_cvt_pk_bf16_f32 v184, v184, v185
v_cvt_pk_bf16_f32 v185, v186, v187
ds_write_b64 v14, v[184:185] offset:32128
v_pk_fma_f32 v[220:221], v[42:43], v[60:61], v[220:221] op_sel_hi:[0,1,1] neg_lo:[1,0,0] neg_hi:[1,0,0]
v_pk_fma_f32 v[222:223], v[42:43], v[62:63], v[222:223] op_sel_hi:[0,1,1] neg_lo:[1,0,0] neg_hi:[1,0,0]
v_pk_mul_f32 v[220:221], v[42:43], v[220:221] op_sel:[1,0] op_sel_hi:[1,1]
v_pk_mul_f32 v[222:223], v[42:43], v[222:223] op_sel:[1,0] op_sel_hi:[1,1]
v_cvt_pk_bf16_f32 v220, v220, v221
v_cvt_pk_bf16_f32 v221, v222, v223
ds_write_b64 v14, v[220:221] offset:32256
v_pk_fma_f32 v[152:153], v[44:45], v[52:53], v[152:153] op_sel_hi:[0,1,1] neg_lo:[1,0,0] neg_hi:[1,0,0]
v_pk_fma_f32 v[154:155], v[44:45], v[54:55], v[154:155] op_sel_hi:[0,1,1] neg_lo:[1,0,0] neg_hi:[1,0,0]
v_pk_mul_f32 v[152:153], v[44:45], v[152:153] op_sel:[1,0] op_sel_hi:[1,1]
v_pk_mul_f32 v[154:155], v[44:45], v[154:155] op_sel:[1,0] op_sel_hi:[1,1]
v_cvt_pk_bf16_f32 v152, v152, v153
v_cvt_pk_bf16_f32 v153, v154, v155
ds_write_b64 v14, v[152:153] offset:38400
v_pk_fma_f32 v[188:189], v[44:45], v[56:57], v[188:189] op_sel_hi:[0,1,1] neg_lo:[1,0,0] neg_hi:[1,0,0]
v_pk_fma_f32 v[190:191], v[44:45], v[58:59], v[190:191] op_sel_hi:[0,1,1] neg_lo:[1,0,0] neg_hi:[1,0,0]
v_pk_mul_f32 v[188:189], v[44:45], v[188:189] op_sel:[1,0] op_sel_hi:[1,1]
v_pk_mul_f32 v[190:191], v[44:45], v[190:191] op_sel:[1,0] op_sel_hi:[1,1]
v_cvt_pk_bf16_f32 v188, v188, v189
v_cvt_pk_bf16_f32 v189, v190, v191
ds_write_b64 v14, v[188:189] offset:38528
v_pk_fma_f32 v[224:225], v[44:45], v[60:61], v[224:225] op_sel_hi:[0,1,1] neg_lo:[1,0,0] neg_hi:[1,0,0]
v_pk_fma_f32 v[226:227], v[44:45], v[62:63], v[226:227] op_sel_hi:[0,1,1] neg_lo:[1,0,0] neg_hi:[1,0,0]
v_pk_mul_f32 v[224:225], v[44:45], v[224:225] op_sel:[1,0] op_sel_hi:[1,1]
v_pk_mul_f32 v[226:227], v[44:45], v[226:227] op_sel:[1,0] op_sel_hi:[1,1]
v_cvt_pk_bf16_f32 v224, v224, v225
v_cvt_pk_bf16_f32 v225, v226, v227
ds_write_b64 v14, v[224:225] offset:38656
v_pk_fma_f32 v[156:157], v[46:47], v[52:53], v[156:157] op_sel_hi:[0,1,1] neg_lo:[1,0,0] neg_hi:[1,0,0]
v_pk_fma_f32 v[158:159], v[46:47], v[54:55], v[158:159] op_sel_hi:[0,1,1] neg_lo:[1,0,0] neg_hi:[1,0,0]
v_pk_mul_f32 v[156:157], v[46:47], v[156:157] op_sel:[1,0] op_sel_hi:[1,1]
v_pk_mul_f32 v[158:159], v[46:47], v[158:159] op_sel:[1,0] op_sel_hi:[1,1]
v_cvt_pk_bf16_f32 v156, v156, v157
v_cvt_pk_bf16_f32 v157, v158, v159
ds_write_b64 v14, v[156:157] offset:44800
v_pk_fma_f32 v[192:193], v[46:47], v[56:57], v[192:193] op_sel_hi:[0,1,1] neg_lo:[1,0,0] neg_hi:[1,0,0]
v_pk_fma_f32 v[194:195], v[46:47], v[58:59], v[194:195] op_sel_hi:[0,1,1] neg_lo:[1,0,0] neg_hi:[1,0,0]
v_pk_mul_f32 v[192:193], v[46:47], v[192:193] op_sel:[1,0] op_sel_hi:[1,1]
v_pk_mul_f32 v[194:195], v[46:47], v[194:195] op_sel:[1,0] op_sel_hi:[1,1]
v_cvt_pk_bf16_f32 v192, v192, v193
v_cvt_pk_bf16_f32 v193, v194, v195
ds_write_b64 v14, v[192:193] offset:44928
v_pk_fma_f32 v[228:229], v[46:47], v[60:61], v[228:229] op_sel_hi:[0,1,1] neg_lo:[1,0,0] neg_hi:[1,0,0]
v_pk_fma_f32 v[230:231], v[46:47], v[62:63], v[230:231] op_sel_hi:[0,1,1] neg_lo:[1,0,0] neg_hi:[1,0,0]
v_pk_mul_f32 v[228:229], v[46:47], v[228:229] op_sel:[1,0] op_sel_hi:[1,1]
v_pk_mul_f32 v[230:231], v[46:47], v[230:231] op_sel:[1,0] op_sel_hi:[1,1]
v_cvt_pk_bf16_f32 v228, v228, v229
v_cvt_pk_bf16_f32 v229, v230, v231
ds_write_b64 v14, v[228:229] offset:45056
v_pk_fma_f32 v[160:161], v[48:49], v[52:53], v[160:161] op_sel_hi:[0,1,1] neg_lo:[1,0,0] neg_hi:[1,0,0]
v_pk_fma_f32 v[162:163], v[48:49], v[54:55], v[162:163] op_sel_hi:[0,1,1] neg_lo:[1,0,0] neg_hi:[1,0,0]
v_pk_mul_f32 v[160:161], v[48:49], v[160:161] op_sel:[1,0] op_sel_hi:[1,1]
v_pk_mul_f32 v[162:163], v[48:49], v[162:163] op_sel:[1,0] op_sel_hi:[1,1]
v_cvt_pk_bf16_f32 v160, v160, v161
v_cvt_pk_bf16_f32 v161, v162, v163
ds_write_b64 v14, v[160:161] offset:51200
v_pk_fma_f32 v[196:197], v[48:49], v[56:57], v[196:197] op_sel_hi:[0,1,1] neg_lo:[1,0,0] neg_hi:[1,0,0]
v_pk_fma_f32 v[198:199], v[48:49], v[58:59], v[198:199] op_sel_hi:[0,1,1] neg_lo:[1,0,0] neg_hi:[1,0,0]
v_pk_mul_f32 v[196:197], v[48:49], v[196:197] op_sel:[1,0] op_sel_hi:[1,1]
v_pk_mul_f32 v[198:199], v[48:49], v[198:199] op_sel:[1,0] op_sel_hi:[1,1]
v_cvt_pk_bf16_f32 v196, v196, v197
v_cvt_pk_bf16_f32 v197, v198, v199
ds_write_b64 v14, v[196:197] offset:51328
v_pk_fma_f32 v[232:233], v[48:49], v[60:61], v[232:233] op_sel_hi:[0,1,1] neg_lo:[1,0,0] neg_hi:[1,0,0]
v_pk_fma_f32 v[234:235], v[48:49], v[62:63], v[234:235] op_sel_hi:[0,1,1] neg_lo:[1,0,0] neg_hi:[1,0,0]
v_pk_mul_f32 v[232:233], v[48:49], v[232:233] op_sel:[1,0] op_sel_hi:[1,1]
v_pk_mul_f32 v[234:235], v[48:49], v[234:235] op_sel:[1,0] op_sel_hi:[1,1]
v_cvt_pk_bf16_f32 v232, v232, v233
v_cvt_pk_bf16_f32 v233, v234, v235
ds_write_b64 v14, v[232:233] offset:51456
s_waitcnt lgkmcnt(0)
s_branch Latt_4
Lpf_3:
s_load_dwordx2 s[26:27], s[0:1], 64
s_or_b32 s43, s34, s35
s_cmp_lg_u32 s43, 0
s_cbranch_scc1 Lz_21
s_add_u32 s84, s32, 28311552
s_addc_u32 s85, s33, 0
s_mov_b32 s86, 32768
s_mov_b32 s87, 0x20000
v_lshlrev_b32 v14, 7, v1
v_mov_b32 v36, 0
v_mov_b32 v37, 0
s_mov_b32 s43, 0
buffer_store_dwordx2 v[36:37], v14, s[84:87], s43 offen sc1
s_mov_b32 s43, 8192
buffer_store_dwordx2 v[36:37], v14, s[84:87], s43 offen sc1
s_mov_b32 s43, 16384
buffer_store_dwordx2 v[36:37], v14, s[84:87], s43 offen sc1
s_mov_b32 s43, 24576
buffer_store_dwordx2 v[36:37], v14, s[84:87], s43 offen sc1
Lz_21:
s_lshl_b32 s43, s51, 11
buffer_load_dwordx4 v[96:99], v10, s[8:11], s43 offen offset:0
buffer_load_dwordx4 v[100:103], v10, s[8:11], s43 offen offset:1024
buffer_load_dwordx4 v[104:107], v10, s[8:11], s43 offen offset:2048
buffer_load_dwordx4 v[108:111], v10, s[8:11], s43 offen offset:3072
v_min_u32 v14, 23, v1
v_lshrrev_b32 v15, 3, v14
v_mul_u32_u24 v15, 43008, v15
v_and_b32 v14, 7, v14
v_lshl_add_u32 v15, v14, 4, v15
v_mov_b32 v32, 0x3f803f80
v_mov_b32 v33, 0x3f803f80
v_mov_b32 v34, 0x3f803f80
v_mov_b32 v35, 0x3f803f80
ds_write_b128 v15, v[32:35]
v_add_u32 v14, 0, v1
v_min_u32 v14, 47, v14
v_mul_u32_u24 v15, 21846, v14
v_lshrrev_b32 v15, 16, v15
v_mul_u32_u24 v16, 3, v15
v_sub_u32 v16, v14, v16
s_mul_i32 s43, s48, 16
v_add_u32 v15, s43, v15
v_mul_u32_u24 v15, 6144, v15
v_lshl_add_u32 v2, v16, 11, v15
s_waitcnt lgkmcnt(0)
s_mov_b32 s56, s26
s_mov_b32 s57, s27
s_mov_b32 s58, 256
s_mov_b32 s59, 0x20000
v_lshlrev_b32 v14, 7, v1
s_barrier
s_cmp_ge_u32 s2, 128
s_cbranch_scc1 Lm_23
s_mov_b32 s84, s6
s_mov_b32 s85, s7
s_mov_b32 s86, 6291456
s_mov_b32 s87, 0x20000
s_mul_i32 s43, s2, 24576
buffer_load_dword v31, v14, s[84:87], s43 offen
s_add_u32 s43, s43, 8192
buffer_load_dword v31, v14, s[84:87], s43 offen
s_add_u32 s43, s43, 8192
buffer_load_dword v31, v14, s[84:87], s43 offen
Lm_23:
s_mov_b32 s84, s6
s_mov_b32 s85, s7
s_mov_b32 s86, 6291456
s_mov_b32 s87, 0x20000
s_lshr_b32 s44, s2, 3
s_lshr_b32 s43, s2, 5
s_cmp_eq_u32 s43, 3
s_cbranch_scc1 Lsj_24
s_cmp_gt_u32 s43, 3
s_cselect_b32 s43, 32, 0
s_sub_u32 s43, s2, s43
s_lshr_b32 s43, s43, 1
s_and_b32 s44, s2, 1
s_lshl_b32 s44, s44, 3
s_add_u32 s44, s44, 32
s_load_dwordx2 s[80:81], s[0:1], s44
s_mul_i32 s45, s43, 2341
s_lshr_b32 s45, s45, 16
s_mul_i32 s46, s45, 28
s_sub_u32 s46, s43, s46
s_lshl_b32 s45, s45, 8
s_mul_i32 s44, s47, 18
s_add_u32 s45, s45, s44
s_add_u32 s45, s45, 184
s_mul_i32 s45, s45, 7168
s_lshl_b32 s46, s46, 8
s_add_u32 s45, s45, s46
s_waitcnt lgkmcnt(0)
s_add_u32 s80, s80, s45
s_addc_u32 s81, s81, 0
Lsj_24:
s_barrier
s_cmp_ge_u32 s2, 128
s_cbranch_scc0 Lm_25
s_mov_b32 s84, s6
s_mov_b32 s85, s7
s_mov_b32 s86, 6291456
s_mov_b32 s87, 0x20000
s_mul_i32 s43, s2, 24576
buffer_load_dword v31, v14, s[84:87], s43 offen
s_add_u32 s43, s43, 8192
buffer_load_dword v31, v14, s[84:87], s43 offen
s_add_u32 s43, s43, 8192
buffer_load_dword v31, v14, s[84:87], s43 offen
Lm_25:
s_barrier
s_getpc_b64 s[88:89]
Lpc_26:
s_sub_u32 s88, s88, Lpc_26-sequential_preLN__sliding_local_dilated__glu_gated_geglu__prompt_kernel
s_subb_u32 s89, s89, 0
s_lshr_b32 s43, s2, 3
s_mul_i32 s43, s43, 3840
v_min_u32 v15, 29, v1
v_lshl_add_u32 v15, v15, 7, s43
v_min_u32 v15, Ldone_1-sequential_preLN__sliding_local_dilated__glu_gated_geglu__prompt_kernel, v15
global_load_dword v31, v15, s[88:89]
s_or_b32 s43, s34, s35
s_cmp_lg_u32 s43, 0
s_cbranch_scc1 Lz_27
s_waitcnt vmcnt(0)
v_mov_b32 v5, 1
v_mov_b32 v6, 0
s_mov_b64 exec, 1
buffer_store_dword v5, v6, s[56:59], 0 offen sc1
s_mov_b64 exec, -1
Lz_27:
s_waitcnt vmcnt(1)
v_lshlrev_b32 v116, 16, v96
v_and_b32 v117, 0xffff0000, v96
v_mul_f32 v118, v116, v116
v_mul_f32 v119, v117, v117
v_lshlrev_b32 v126, 16, v97
v_and_b32 v127, 0xffff0000, v97
v_add_f32 v116, v116, v126
v_add_f32 v117, v117, v127
v_fmac_f32 v118, v126, v126
v_fmac_f32 v119, v127, v127
v_lshlrev_b32 v124, 16, v98
v_and_b32 v125, 0xffff0000, v98
v_add_f32 v116, v116, v124
v_add_f32 v117, v117, v125
v_fmac_f32 v118, v124, v124
v_fmac_f32 v119, v125, v125
v_lshlrev_b32 v126, 16, v99
v_and_b32 v127, 0xffff0000, v99
v_add_f32 v116, v116, v126
v_add_f32 v117, v117, v127
v_fmac_f32 v118, v126, v126
v_fmac_f32 v119, v127, v127
v_lshlrev_b32 v124, 16, v100
v_and_b32 v125, 0xffff0000, v100
v_add_f32 v116, v116, v124
v_add_f32 v117, v117, v125
v_fmac_f32 v118, v124, v124
v_fmac_f32 v119, v125, v125
v_lshlrev_b32 v126, 16, v101
v_and_b32 v127, 0xffff0000, v101
v_add_f32 v116, v116, v126
v_add_f32 v117, v117, v127
v_fmac_f32 v118, v126, v126
v_fmac_f32 v119, v127, v127
v_lshlrev_b32 v124, 16, v102
v_and_b32 v125, 0xffff0000, v102
v_add_f32 v116, v116, v124
v_add_f32 v117, v117, v125
v_fmac_f32 v118, v124, v124
v_fmac_f32 v119, v125, v125
v_lshlrev_b32 v126, 16, v103
v_and_b32 v127, 0xffff0000, v103
v_add_f32 v116, v116, v126
v_add_f32 v117, v117, v127
v_fmac_f32 v118, v126, v126
v_fmac_f32 v119, v127, v127
v_lshlrev_b32 v120, 16, v104
v_and_b32 v121, 0xffff0000, v104
v_mul_f32 v122, v120, v120
v_mul_f32 v123, v121, v121
s_barrier
s_cmp_lt_u32 s2, 128
s_cbranch_scc1 Lm_28
s_mov_b32 s84, s6
s_mov_b32 s85, s7
s_mov_b32 s86, 6291456
s_mov_b32 s87, 0x20000
s_lshr_b32 s44, s2, 3
s_and_b32 s43, s35, 8
s_or_b32 s43, s43, 3
s_lshl_b32 s43, s43, 7
s_mul_i32 s45, s44, 196608
s_add_u32 s43, s43, s45
v_add_u32 v15, 0, v1
v_min_u32 v15, 95, v15
v_mul_u32_u24 v16, 21846, v15
v_lshrrev_b32 v16, 16, v16
v_mul_u32_u24 v17, 3, v16
v_sub_u32 v15, v15, v17
v_mul_u32_u24 v16, 6144, v16
v_lshl_add_u32 v15, v15, 11, v16
buffer_load_dword v31, v15, s[84:87], s43 offen
v_add_u32 v15, 64, v1
v_min_u32 v15, 95, v15
v_mul_u32_u24 v16, 21846, v15
v_lshrrev_b32 v16, 16, v16
v_mul_u32_u24 v17, 3, v16
v_sub_u32 v15, v15, v17
v_mul_u32_u24 v16, 6144, v16
v_lshl_add_u32 v15, v15, 11, v16
buffer_load_dword v31, v15, s[84:87], s43 offen
Lm_28:
v_lshlrev_b32 v126, 16, v105
v_and_b32 v127, 0xffff0000, v105
v_add_f32 v120, v120, v126
v_add_f32 v121, v121, v127
v_fmac_f32 v122, v126, v126
v_fmac_f32 v123, v127, v127
v_lshlrev_b32 v124, 16, v106
v_and_b32 v125, 0xffff0000, v106
v_add_f32 v120, v120, v124
v_add_f32 v121, v121, v125
v_fmac_f32 v122, v124, v124
v_fmac_f32 v123, v125, v125
v_lshlrev_b32 v126, 16, v107
v_and_b32 v127, 0xffff0000, v107
v_add_f32 v120, v120, v126
v_add_f32 v121, v121, v127
v_fmac_f32 v122, v126, v126
v_fmac_f32 v123, v127, v127
v_lshlrev_b32 v124, 16, v108
v_and_b32 v125, 0xffff0000, v108
v_add_f32 v120, v120, v124
v_add_f32 v121, v121, v125
v_fmac_f32 v122, v124, v124
v_fmac_f32 v123, v125, v125
v_lshlrev_b32 v126, 16, v109
v_and_b32 v127, 0xffff0000, v109
v_add_f32 v120, v120, v126
v_add_f32 v121, v121, v127
v_fmac_f32 v122, v126, v126
v_fmac_f32 v123, v127, v127
v_lshlrev_b32 v124, 16, v110
v_and_b32 v125, 0xffff0000, v110
v_add_f32 v120, v120, v124
v_add_f32 v121, v121, v125
v_fmac_f32 v122, v124, v124
v_fmac_f32 v123, v125, v125
v_lshlrev_b32 v126, 16, v111
v_and_b32 v127, 0xffff0000, v111
v_add_f32 v120, v120, v126
v_add_f32 v121, v121, v127
v_fmac_f32 v122, v126, v126
v_fmac_f32 v123, v127, v127
v_add_f32 v116, v116, v117
v_add_f32 v118, v118, v119
v_add_f32 v120, v120, v121
v_add_f32 v122, v122, v123
v_add_f32_dpp v116, v116, v116 row_ror:8 row_mask:0xf bank_mask:0xf
v_add_f32_dpp v118, v118, v118 row_ror:8 row_mask:0xf bank_mask:0xf
v_add_f32_dpp v120, v120, v120 row_ror:8 row_mask:0xf bank_mask:0xf
v_add_f32_dpp v122, v122, v122 row_ror:8 row_mask:0xf bank_mask:0xf
s_barrier
v_add_f32_dpp v116, v116, v116 row_ror:4 row_mask:0xf bank_mask:0xf
v_add_f32_dpp v118, v118, v118 row_ror:4 row_mask:0xf bank_mask:0xf
v_add_f32_dpp v120, v120, v120 row_ror:4 row_mask:0xf bank_mask:0xf
v_add_f32_dpp v122, v122, v122 row_ror:4 row_mask:0xf bank_mask:0xf
v_add_f32_dpp v116, v116, v116 row_ror:2 row_mask:0xf bank_mask:0xf
v_add_f32_dpp v118, v118, v118 row_ror:2 row_mask:0xf bank_mask:0xf
v_add_f32_dpp v120, v120, v120 row_ror:2 row_mask:0xf bank_mask:0xf
v_add_f32_dpp v122, v122, v122 row_ror:2 row_mask:0xf bank_mask:0xf
v_add_f32_dpp v116, v116, v116 row_ror:1 row_mask:0xf bank_mask:0xf
v_add_f32_dpp v118, v118, v118 row_ror:1 row_mask:0xf bank_mask:0xf
v_add_f32_dpp v120, v120, v120 row_ror:1 row_mask:0xf bank_mask:0xf
v_add_f32_dpp v122, v122, v122 row_ror:1 row_mask:0xf bank_mask:0xf
v_mov_b32 v117, v116
v_mov_b32 v119, v118
v_mov_b32 v121, v120
v_mov_b32 v123, v122
s_nop 0
v_permlane16_swap_b32 v116, v117
v_permlane16_swap_b32 v118, v119
v_permlane16_swap_b32 v120, v121
v_permlane16_swap_b32 v122, v123
v_add_f32 v116, v116, v117
v_add_f32 v118, v118, v119
v_add_f32 v120, v120, v121
v_add_f32 v122, v122, v123
v_mov_b32 v117, v116
v_mov_b32 v119, v118
v_mov_b32 v121, v120
v_mov_b32 v123, v122
s_nop 0
v_permlane32_swap_b32 v116, v117
v_permlane32_swap_b32 v118, v119
v_permlane32_swap_b32 v120, v121
v_permlane32_swap_b32 v122, v123
v_add_f32 v116, v116, v117
v_add_f32 v118, v118, v119
v_add_f32 v120, v120, v121
v_add_f32 v122, v122, v123
v_mul_f32 v112, 0x3a800000, v116
v_mul_f32 v113, 0x3a800000, v118
v_fma_f32 v113, -v112, v112, v113
v_max_f32 v113, 0, v113
v_add_f32 v113, 0x3727c5ac, v113
v_rsq_f32 v113, v113
v_mul_f32 v114, 0x3a800000, v120
v_mul_f32 v115, 0x3a800000, v122
v_fma_f32 v115, -v114, v114, v115
v_max_f32 v115, 0, v115
v_add_f32 v115, 0x3727c5ac, v115
v_rsq_f32 v115, v115
s_nop 0
s_lshl_b32 s43, s47, 4
s_add_u32 s43, s43, 130176
v_mov_b32 v11, s43
ds_write_b128 v11, v[112:115]
s_waitcnt lgkmcnt(0)
s_barrier
v_lshlrev_b32 v5, 4, v1
v_and_b32 v5, 63, v5
v_add_u32 v6, 130176, v5
ds_read_b128 v[112:115], v6
s_lshl_b32 s43, s63, 3
v_add_u32 v5, s43, v5
s_waitcnt lgkmcnt(0)
s_mov_b64 exec, 15
buffer_store_dwordx4 v[112:115], v5, s[20:23], 0 offen sc1
s_mov_b64 exec, -1
s_load_dword s64, s[80:81], 0
s_load_dword s65, s[80:81], 64
s_load_dword s66, s[80:81], 128
s_load_dword s67, s[80:81], 192
s_load_dword s68, s[80:81], 7168
s_load_dword s69, s[80:81], 7232
s_load_dword s70, s[80:81], 7296
s_load_dword s71, s[80:81], 7360
s_add_u32 s80, s80, 14336
s_addc_u32 s81, s81, 0
s_barrier
v_mov_b32 v7, 0
v_mov_b32 v9, 1
buffer_load_dword v8, v7, s[56:59], 0 offen sc1
s_load_dword s64, s[80:81], 0
s_load_dword s65, s[80:81], 64
s_load_dword s66, s[80:81], 128
s_load_dword s67, s[80:81], 192
s_load_dword s68, s[80:81], 7168
s_load_dword s69, s[80:81], 7232
s_load_dword s70, s[80:81], 7296
s_load_dword s71, s[80:81], 7360
s_add_u32 s80, s80, 14336
s_addc_u32 s81, s81, 0
s_barrier
s_load_dword s64, s[80:81], 0
s_load_dword s65, s[80:81], 64
s_load_dword s66, s[80:81], 128
s_load_dword s67, s[80:81], 192
s_load_dword s68, s[80:81], 7168
s_load_dword s69, s[80:81], 7232
s_load_dword s70, s[80:81], 7296
s_load_dword s71, s[80:81], 7360
s_add_u32 s80, s80, 14336
s_addc_u32 s81, s81, 0
s_barrier
s_mov_b32 s41, 0x10000
Lpoll_29:
s_waitcnt vmcnt(0)
Lpf_31:
v_cmp_ne_u32 vcc, v9, v8
s_nop 4
s_cbranch_vccz Lpok_30
buffer_load_dword v8, v7, s[56:59], 0 offen sc1
s_sub_u32 s41, s41, 1
s_cmp_lg_u32 s41, 0
s_cbranch_scc1 Lpoll_29
s_waitcnt vmcnt(0)
Lpok_30:
s_add_u32 s56, s32, 28311552
s_addc_u32 s57, s33, 0
s_mov_b32 s58, 32768
s_mov_b32 s59, 0x20000
s_add_u32 s43, s34, 80
s_lshl_b32 s43, s43, 7
v_mov_b32 v5, s43
v_mov_b32 v6, 1
s_mov_b64 exec, 1
buffer_atomic_add v6, v5, s[56:59], 0 offen sc1
s_mov_b64 exec, -1
s_load_dword s64, s[80:81], 0
s_load_dword s65, s[80:81], 64
s_load_dword s66, s[80:81], 128
s_load_dword s67, s[80:81], 192
s_load_dword s68, s[80:81], 7168
s_load_dword s69, s[80:81], 7232
s_load_dword s70, s[80:81], 7296
s_load_dword s71, s[80:81], 7360
s_add_u32 s80, s80, 14336
s_addc_u32 s81, s81, 0
s_barrier
s_load_dword s64, s[80:81], 0
s_load_dword s65, s[80:81], 64
s_load_dword s66, s[80:81], 128
s_load_dword s67, s[80:81], 192
s_load_dword s68, s[80:81], 7168
s_load_dword s69, s[80:81], 7232
s_load_dword s70, s[80:81], 7296
s_load_dword s71, s[80:81], 7360
s_add_u32 s80, s80, 14336
s_addc_u32 s81, s81, 0
s_barrier
s_getpc_b64 s[88:89]
Lpc_32:
s_sub_u32 s88, s88, Lpc_32-sequential_preLN__sliding_local_dilated__glu_gated_geglu__prompt_kernel
s_subb_u32 s89, s89, 0
s_lshr_b32 s43, s2, 3
s_mul_i32 s43, s43, 3840
v_min_u32 v15, 29, v1
v_lshl_add_u32 v15, v15, 7, s43
v_min_u32 v15, Ldone_1-sequential_preLN__sliding_local_dilated__glu_gated_geglu__prompt_kernel, v15
global_load_dword v31, v15, s[88:89]
s_sub_u32 s44, s34, 1
s_max_i32 s44, s44, 0
v_mov_b32 v5, s44
v_mov_b32 v6, s34
v_cmp_eq_u32 vcc, 0, v1
s_nop 1
v_cndmask_b32 v5, v5, v6, vcc
v_add_u32 v5, 80, v5
v_lshlrev_b32 v5, 7, v5
buffer_load_dword v6, v5, s[56:59], 0 offen sc1
s_load_dword s64, s[80:81], 0
s_load_dword s65, s[80:81], 64
s_load_dword s66, s[80:81], 128
s_load_dword s67, s[80:81], 192
s_load_dword s68, s[80:81], 7168
s_load_dword s69, s[80:81], 7232
s_load_dword s70, s[80:81], 7296
s_load_dword s71, s[80:81], 7360
s_add_u32 s80, s80, 14336
s_addc_u32 s81, s81, 0
s_barrier
s_load_dword s64, s[80:81], 0
s_load_dword s65, s[80:81], 64
s_load_dword s66, s[80:81], 128
s_load_dword s67, s[80:81], 192
s_load_dword s68, s[80:81], 7168
s_load_dword s69, s[80:81], 7232
s_load_dword s70, s[80:81], 7296
s_load_dword s71, s[80:81], 7360
s_add_u32 s80, s80, 14336
s_addc_u32 s81, s81, 0
s_barrier
v_mov_b32 v7, 16
s_mov_b32 s41, 0x10000
Lpoll_33:
s_waitcnt vmcnt(0)
Lpf_35:
v_cmp_ne_u32 vcc, v7, v6
s_nop 4
s_cbranch_vccz Lpok_34
buffer_load_dword v6, v5, s[56:59], 0 offen sc1
s_sub_u32 s41, s41, 1
s_cmp_lg_u32 s41, 0
s_cbranch_scc1 Lpoll_33
s_waitcnt vmcnt(0)
Lpok_34:
v_add_u32 v5, 0, v1
v_min_u32 v5, 143, v5
v_lshlrev_b32 v20, 3, v5
v_add_u32 v5, s50, v5
v_max_i32 v5, 0, v5
v_lshlrev_b32 v5, 3, v5
buffer_load_dwordx2 v[32:33], v5, s[20:23], 0 offen sc1
v_add_u32 v5, 64, v1
v_min_u32 v5, 143, v5
v_lshlrev_b32 v21, 3, v5
v_add_u32 v5, s50, v5
v_max_i32 v5, 0, v5
v_lshlrev_b32 v5, 3, v5
buffer_load_dwordx2 v[34:35], v5, s[20:23], 0 offen sc1
v_add_u32 v5, 128, v1
v_min_u32 v5, 143, v5
v_lshlrev_b32 v22, 3, v5
v_add_u32 v5, s50, v5
v_max_i32 v5, 0, v5
v_lshlrev_b32 v5, 3, v5
buffer_load_dwordx2 v[36:37], v5, s[20:23], 0 offen sc1
s_load_dword s64, s[80:81], 0
s_load_dword s65, s[80:81], 64
s_load_dword s66, s[80:81], 128
s_load_dword s67, s[80:81], 192
s_load_dword s68, s[80:81], 7168
s_load_dword s69, s[80:81], 7232
s_load_dword s70, s[80:81], 7296
s_load_dword s71, s[80:81], 7360
s_add_u32 s80, s80, 14336
s_addc_u32 s81, s81, 0
s_barrier
s_load_dwordx2 s[88:89], s[0:1], 16
v_lshlrev_b32 v29, 7, v1
s_lshl_b32 s43, s2, 13
s_waitcnt lgkmcnt(0)
s_mov_b32 s84, s88
s_mov_b32 s85, s89
s_mov_b32 s86, 2097152
s_mov_b32 s87, 0x20000
buffer_load_dword v30, v29, s[84:87], s43 offen
v_and_b32 v29, 31, v1
v_lshlrev_b32 v29, 11, v29
s_and_b32 s43, s35, 8
s_or_b32 s43, s43, 3
s_lshl_b32 s43, s43, 7
s_lshr_b32 s44, s2, 3
s_lshl_b32 s44, s44, 16
s_add_u32 s43, s43, s44
buffer_load_dword v30, v29, s[84:87], s43 offen
s_barrier
s_waitcnt vmcnt(2)
v_add_u32 v20, 129024, v20
ds_write_b64 v20, v[32:33]
v_add_u32 v21, 129024, v21
ds_write_b64 v21, v[34:35]
v_add_u32 v22, 129024, v22
ds_write_b64 v22, v[36:37]
s_waitcnt lgkmcnt(0)
s_lshr_b32 s43, s2, 5
s_cmp_eq_u32 s43, 3
s_cbranch_scc1 Lnj_36
s_cmp_gt_u32 s43, 3
s_cselect_b32 s43, 32, 0
s_sub_u32 s43, s2, s43
s_lshr_b32 s43, s43, 1
s_and_b32 s44, s2, 1
s_lshl_b32 s45, s44, 3
s_add_u32 s45, s45, 32
s_load_dwordx2 s[88:89], s[0:1], s45
s_mul_i32 s45, s43, 2341
s_lshr_b32 s45, s45, 16
s_mul_i32 s46, s45, 28
s_sub_u32 s46, s43, s46
v_lshrrev_b32 v28, 4, v1
s_lshl_b32 s43, s45, 8
v_add_u32 v28, s43, v28
v_mul_u32_u24 v28, 7168, v28
v_and_b32 v29, 15, v1
v_lshl_add_u32 v28, v29, 4, v28
s_lshl_b32 s43, s46, 8
v_add_u32 v28, s43, v28
s_waitcnt lgkmcnt(0)
s_mov_b32 s84, s88
s_mov_b32 s85, s89
s_mov_b32 s86, 7340032
s_mov_b32 s87, 0x20000
s_mov_b32 s43, 0
buffer_load_dwordx4 v[128:131], v28, s[84:87], s43 offen
s_mov_b32 s43, 28672
buffer_load_dwordx4 v[132:135], v28, s[84:87], s43 offen
s_mov_b32 s43, 57344
buffer_load_dwordx4 v[136:139], v28, s[84:87], s43 offen
s_mov_b32 s43, 86016
buffer_load_dwordx4 v[140:143], v28, s[84:87], s43 offen
s_mov_b32 s43, 114688
buffer_load_dwordx4 v[144:147], v28, s[84:87], s43 offen
s_mov_b32 s43, 143360
buffer_load_dwordx4 v[148:151], v28, s[84:87], s43 offen
s_mov_b32 s43, 172032
buffer_load_dwordx4 v[152:155], v28, s[84:87], s43 offen
s_mov_b32 s43, 200704
buffer_load_dwordx4 v[156:159], v28, s[84:87], s43 offen
s_mov_b32 s43, 229376
buffer_load_dwordx4 v[160:163], v28, s[84:87], s43 offen
s_mov_b32 s43, 258048
buffer_load_dwordx4 v[164:167], v28, s[84:87], s43 offen
s_mov_b32 s43, 286720
buffer_load_dwordx4 v[168:171], v28, s[84:87], s43 offen
s_mov_b32 s43, 315392
buffer_load_dwordx4 v[172:175], v28, s[84:87], s43 offen
s_mov_b32 s43, 344064
buffer_load_dwordx4 v[176:179], v28, s[84:87], s43 offen
s_mov_b32 s43, 372736
buffer_load_dwordx4 v[180:183], v28, s[84:87], s43 offen
s_mov_b32 s43, 401408
buffer_load_dwordx4 v[184:187], v28, s[84:87], s43 offen
s_mov_b32 s43, 430080
buffer_load_dwordx4 v[188:191], v28, s[84:87], s43 offen
Lnj_36:
s_barrier
s_lshr_b32 s43, s2, 5
s_cmp_eq_u32 s43, 3
s_cbranch_scc1 Lnj_37
s_cmp_gt_u32 s43, 3
s_cselect_b32 s43, 32, 0
s_sub_u32 s43, s2, s43
s_lshr_b32 s43, s43, 1
s_and_b32 s44, s2, 1
s_lshl_b32 s45, s44, 3
s_add_u32 s45, s45, 32
s_load_dwordx2 s[88:89], s[0:1], s45
s_mul_i32 s45, s43, 2341
s_lshr_b32 s45, s45, 16
s_mul_i32 s46, s45, 28
s_sub_u32 s46, s43, s46
v_lshrrev_b32 v28, 4, v1
s_lshl_b32 s43, s45, 8
v_add_u32 v28, s43, v28
v_mul_u32_u24 v28, 7168, v28
v_and_b32 v29, 15, v1
v_lshl_add_u32 v28, v29, 4, v28
s_lshl_b32 s43, s46, 8
v_add_u32 v28, s43, v28
s_waitcnt lgkmcnt(0)
s_mov_b32 s84, s88
s_mov_b32 s85, s89
s_mov_b32 s86, 7340032
s_mov_b32 s87, 0x20000
s_mov_b32 s43, 458752
buffer_load_dwordx4 v[192:195], v28, s[84:87], s43 offen
s_mov_b32 s43, 487424
buffer_load_dwordx4 v[196:199], v28, s[84:87], s43 offen
s_mov_b32 s43, 516096
buffer_load_dwordx4 v[200:203], v28, s[84:87], s43 offen
s_mov_b32 s43, 544768
buffer_load_dwordx4 v[204:207], v28, s[84:87], s43 offen
s_mov_b32 s43, 573440
buffer_load_dwordx4 v[208:211], v28, s[84:87], s43 offen
s_mov_b32 s43, 602112
buffer_load_dwordx4 v[212:215], v28, s[84:87], s43 offen
s_mov_b32 s43, 630784
buffer_load_dwordx4 v[216:219], v28, s[84:87], s43 offen
s_mov_b32 s43, 659456
buffer_load_dwordx4 v[220:223], v28, s[84:87], s43 offen
s_mov_b32 s43, 688128
buffer_load_dwordx4 v[224:227], v28, s[84:87], s43 offen
s_mov_b32 s43, 716800
buffer_load_dwordx4 v[228:231], v28, s[84:87], s43 offen
s_mov_b32 s43, 745472
buffer_load_dwordx4 v[232:235], v28, s[84:87], s43 offen
s_mov_b32 s43, 774144
buffer_load_dwordx4 v[236:239], v28, s[84:87], s43 offen
s_mov_b32 s43, 802816
buffer_load_dwordx4 v[240:243], v28, s[84:87], s43 offen
s_mov_b32 s43, 831488
buffer_load_dwordx4 v[244:247], v28, s[84:87], s43 offen
s_mov_b32 s43, 860160
buffer_load_dwordx4 v[248:251], v28, s[84:87], s43 offen
s_mov_b32 s43, 888832
buffer_load_dwordx4 v[252:255], v28, s[84:87], s43 offen
Lnj_37:
s_barrier
s_branch Lw_38
Lr_39:
s_branch Lw_40
Lr_41:
s_waitcnt lgkmcnt(0)
s_and_b32 s43, s36, 1
s_lshr_b32 s44, s36, 1
s_and_b32 s44, s44, 1
s_lshr_b32 s45, s36, 2
v_lshlrev_b32 v14, 2, v13
v_sub_u32 v14, v12, v14
v_subrev_u32 v15, 0, v14
v_cmp_ge_u32 s[52:53], 7, v15
v_add_u32 v15, 16, v15
v_cmp_ge_u32 s[84:85], 7, v15
v_subrev_u32 v15, 1, v14
v_cmp_ge_u32 s[54:55], 7, v15
v_add_u32 v15, 16, v15
v_cmp_ge_u32 s[86:87], 7, v15
v_subrev_u32 v15, 2, v14
v_cmp_ge_u32 s[56:57], 7, v15
v_add_u32 v15, 16, v15
v_cmp_ge_u32 s[88:89], 7, v15
v_subrev_u32 v15, 3, v14
v_cmp_ge_u32 s[58:59], 7, v15
v_add_u32 v15, 16, v15
v_cmp_ge_u32 s[90:91], 7, v15
s_lshl_b32 s46, s45, 6
s_add_u32 s46, s46, s44
s_add_u32 s46, s46, 16
v_lshl_add_u32 v14, v12, 1, s46
s_lshl_b32 s47, s43, 6
v_lshl_add_u32 v15, v13, 4, s47
v_mul_u32_u24 v20, 400, v14
v_add_u32 v20, v20, v15
v_subrev_u32 v16, 32, v14
v_max_i32 v16, 0, v16
v_mul_u32_u24 v21, 400, v16
v_add_u32 v21, v21, v15
v_lshrrev_b32 v16, 2, v12
v_lshl_add_u32 v16, v13, 2, v16
v_lshl_add_u32 v16, v16, 1, s46
v_and_b32 v17, 3, v1
v_lshl_add_u32 v17, v17, 3, s47
v_mul_u32_u24 v22, 400, v16
v_add_u32 v22, v22, v17
v_subrev_u32 v16, 32, v16
v_max_i32 v16, 0, v16
v_mul_u32_u24 v23, 400, v16
v_add_u32 v23, v23, v17
s_lshl_b32 s60, s43, 13
s_lshl_b32 s61, s45, 10
s_add_u32 s60, s60, s61
s_lshl_b32 s61, s44, 8
s_add_u32 s60, s60, s61
v_lshlrev_b32 v27, 11, v13
v_lshl_add_u32 v27, v12, 4, v27
v_add_u32 v27, s60, v27
v_mov_b32 v28, 0xff800000
s_mov_b32 s61, 0x3e8293ee
s_nop 2
s_or_b32 s62, s34, s45
s_cmp_lg_u32 s62, 0
s_cselect_b64 s[64:65], s[84:85], 0
s_cselect_b64 s[66:67], s[86:87], 0
s_cselect_b64 s[68:69], s[88:89], 0
s_cselect_b64 s[70:71], s[90:91], 0
.p2align 3
Latt_4:
s_barrier
ds_read_b128 v[32:35], v20 offset:0
ds_read_b128 v[36:39], v20 offset:128
ds_read_b128 v[40:43], v21 offset:128
ds_read_b128 v[80:83], v20 offset:12800
ds_read_b128 v[84:87], v20 offset:12928
ds_read_b128 v[88:91], v20 offset:128
ds_read_b64_tr_b16 v[44:45], v23 offset:256
ds_read_b64_tr_b16 v[46:47], v22 offset:256
ds_read_b64_tr_b16 v[48:49], v23 offset:288
ds_read_b64_tr_b16 v[50:51], v22 offset:288
ds_read_b64_tr_b16 v[92:93], v22 offset:256
ds_read_b64_tr_b16 v[94:95], v22 offset:13056
ds_read_b64_tr_b16 v[96:97], v22 offset:288
ds_read_b64_tr_b16 v[98:99], v22 offset:13088
s_waitcnt lgkmcnt(11)
v_mfma_f32_16x16x32_bf16 v[52:55], v[40:43], v[32:35], 0
v_mfma_f32_16x16x32_bf16 v[56:59], v[36:39], v[32:35], 0
s_waitcnt lgkmcnt(8)
v_mfma_f32_16x16x32_bf16 v[100:103], v[88:91], v[80:83], 0
v_mfma_f32_16x16x32_bf16 v[104:107], v[84:87], v[80:83], 0
s_nop 7
v_cndmask_b32 v52, v28, v52, s[64:65]
v_cndmask_b32 v100, v28, v100, s[84:85]
v_cndmask_b32 v53, v28, v53, s[66:67]
v_cndmask_b32 v101, v28, v101, s[86:87]
v_cndmask_b32 v54, v28, v54, s[68:69]
v_cndmask_b32 v102, v28, v102, s[88:89]
v_cndmask_b32 v55, v28, v55, s[70:71]
v_cndmask_b32 v103, v28, v103, s[90:91]
v_cndmask_b32 v56, v28, v56, s[52:53]
v_cndmask_b32 v104, v28, v104, s[52:53]
v_cndmask_b32 v57, v28, v57, s[54:55]
v_cndmask_b32 v105, v28, v105, s[54:55]
v_cndmask_b32 v58, v28, v58, s[56:57]
v_cndmask_b32 v106, v28, v106, s[56:57]
v_cndmask_b32 v59, v28, v59, s[58:59]
v_cndmask_b32 v107, v28, v107, s[58:59]
v_max3_f32 v60, v52, v53, v54
v_max3_f32 v108, v100, v101, v102
v_max3_f32 v61, v55, v56, v57
v_max3_f32 v109, v103, v104, v105
v_max3_f32 v60, v60, v58, v59
v_max3_f32 v108, v108, v106, v107
v_max_f32 v60, v60, v61
v_max_f32 v108, v108, v109
v_mov_b32 v61, v60
v_mov_b32 v109, v108
s_nop 0
v_permlane32_swap_b32 v60, v61
v_permlane32_swap_b32 v108, v109
v_max_f32 v60, v60, v61
v_max_f32 v108, v108, v109
v_mov_b32 v61, v60
v_mov_b32 v109, v108
s_nop 0
v_permlane16_swap_b32 v60, v61
v_permlane16_swap_b32 v108, v109
v_max_f32 v60, v60, v61
v_max_f32 v108, v108, v109
v_mul_f32 v60, s61, v60
v_mul_f32 v108, s61, v108
v_fma_f32 v52, v52, s61, -v60
v_fma_f32 v100, v100, s61, -v108
v_fma_f32 v53, v53, s61, -v60
v_fma_f32 v101, v101, s61, -v108
v_fma_f32 v54, v54, s61, -v60
v_fma_f32 v102, v102, s61, -v108
v_fma_f32 v55, v55, s61, -v60
v_fma_f32 v103, v103, s61, -v108
v_fma_f32 v56, v56, s61, -v60
v_fma_f32 v104, v104, s61, -v108
v_fma_f32 v57, v57, s61, -v60
v_fma_f32 v105, v105, s61, -v108
v_fma_f32 v58, v58, s61, -v60
v_fma_f32 v106, v106, s61, -v108
v_fma_f32 v59, v59, s61, -v60
v_fma_f32 v107, v107, s61, -v108
v_exp_f32 v52, v52
v_exp_f32 v100, v100
v_exp_f32 v53, v53
v_exp_f32 v101, v101
v_exp_f32 v54, v54
v_exp_f32 v102, v102
v_exp_f32 v55, v55
v_exp_f32 v103, v103
v_exp_f32 v56, v56
v_exp_f32 v104, v104
v_exp_f32 v57, v57
v_exp_f32 v105, v105
v_exp_f32 v58, v58
v_exp_f32 v106, v106
v_exp_f32 v59, v59
v_exp_f32 v107, v107
v_cvt_pk_bf16_f32 v64, v52, v53
v_cvt_pk_bf16_f32 v112, v100, v101
v_cvt_pk_bf16_f32 v65, v54, v55
v_cvt_pk_bf16_f32 v113, v102, v103
v_cvt_pk_bf16_f32 v66, v56, v57
v_cvt_pk_bf16_f32 v114, v104, v105
v_cvt_pk_bf16_f32 v67, v58, v59
v_cvt_pk_bf16_f32 v115, v106, v107
s_waitcnt lgkmcnt(0)
v_mfma_f32_16x16x32_bf16 v[68:71], v[44:47], v[64:67], 0
v_mfma_f32_16x16x32_bf16 v[72:75], v[48:51], v[64:67], 0
v_mfma_f32_16x16x32_bf16 v[116:119], v[92:95], v[112:115], 0
v_mfma_f32_16x16x32_bf16 v[120:123], v[96:99], v[112:115], 0
s_load_dwordx4 s[4:7], s[0:1], 32
s_load_dwordx2 s[28:29], s[0:1], 16
s_load_dwordx4 s[60:63], s[0:1], 48
v_add_f32 v60, v52, v53
v_add_f32 v108, v100, v101
v_add_f32 v61, v54, v55
v_add_f32 v109, v102, v103
v_add_f32 v56, v56, v57
v_add_f32 v104, v104, v105
v_add_f32 v58, v58, v59
v_add_f32 v106, v106, v107
v_add_f32 v60, v60, v61
v_add_f32 v108, v108, v109
v_add_f32 v56, v56, v58
v_add_f32 v104, v104, v106
v_add_f32 v60, v60, v56
v_add_f32 v108, v108, v104
v_mov_b32 v61, v60
v_mov_b32 v109, v108
s_nop 0
v_permlane32_swap_b32 v60, v61
v_permlane32_swap_b32 v108, v109
v_add_f32 v60, v60, v61
v_add_f32 v108, v108, v109
v_mov_b32 v61, v60
v_mov_b32 v109, v108
s_nop 0
v_permlane16_swap_b32 v60, v61
v_permlane16_swap_b32 v108, v109
v_add_f32 v60, v60, v61
v_add_f32 v108, v108, v109
v_rcp_f32 v60, v60
v_rcp_f32 v108, v108
s_nop 0
v_pk_mul_f32 v[68:69], v[60:61], v[68:69] op_sel_hi:[0,1]
v_pk_mul_f32 v[70:71], v[60:61], v[70:71] op_sel_hi:[0,1]
v_pk_mul_f32 v[72:73], v[60:61], v[72:73] op_sel_hi:[0,1]
v_pk_mul_f32 v[74:75], v[60:61], v[74:75] op_sel_hi:[0,1]
v_cvt_pk_bf16_f32 v68, v68, v69
v_cvt_pk_bf16_f32 v69, v70, v71
v_cvt_pk_bf16_f32 v70, v72, v73
v_cvt_pk_bf16_f32 v71, v74, v75
buffer_store_dwordx4 v[68:71], v27, s[16:19], 0 offen offset:0 sc1
v_pk_mul_f32 v[116:117], v[108:109], v[116:117] op_sel_hi:[0,1]
v_pk_mul_f32 v[118:119], v[108:109], v[118:119] op_sel_hi:[0,1]
v_pk_mul_f32 v[120:121], v[108:109], v[120:121] op_sel_hi:[0,1]
v_pk_mul_f32 v[122:123], v[108:109], v[122:123] op_sel_hi:[0,1]
v_cvt_pk_bf16_f32 v116, v116, v117
v_cvt_pk_bf16_f32 v117, v118, v119
v_cvt_pk_bf16_f32 v118, v120, v121
v_cvt_pk_bf16_f32 v119, v122, v123
buffer_store_dwordx4 v[116:119], v27, s[16:19], 0 offen offset:512 sc1
s_add_u32 s56, s32, 28311552
s_addc_u32 s57, s33, 0
s_mov_b32 s58, 32768
s_mov_b32 s59, 0x20000
v_and_b32 v17, 15, v1
v_lshrrev_b32 v18, 4, v1
s_lshr_b32 s46, s36, 1
s_and_b32 s46, s46, 1
s_and_b32 s47, s36, 1
s_and_b32 s51, s36, 3
s_bfe_u32 s49, s35, 0x20001
s_sub_u32 s43, 0, s49
s_and_b32 s43, s43, 3
s_cmp_ge_u32 s35, 8
s_cselect_b32 s49, s43, s49
s_lshl_b32 s49, s49, 2
s_lshr_b32 s43, s35, 3
s_lshl_b32 s43, s43, 1
s_add_u32 s49, s49, s43
s_and_b32 s43, s35, 1
s_add_u32 s49, s49, s43
s_waitcnt lgkmcnt(0)
s_cmp_ge_u32 s36, 4
s_cbranch_scc1 LG1_42
v_lshlrev_b32 v19, 11, v18
v_lshl_add_u32 v19, v17, 4, v19
s_lshl_b32 s43, s36, 9
v_add_u32 v2, s43, v19
v_add_u32 v4, 98304, v2
v_lshrrev_b32 v19, 2, v17
v_lshl_add_u32 v20, v18, 2, v19
v_bfe_u32 v21, v20, 1, 2
v_lshlrev_b32 v20, 7, v20
v_lshl_add_u32 v20, v21, 5, v20
v_and_b32 v19, 3, v1
v_lshl_add_u32 v20, v19, 3, v20
v_add_u32 v5, 0x10000, v20
v_xor_b32 v6, 32, v5
v_xor_b32 v7, 64, v5
v_xor_b32 v8, 96, v5
v_add_u32 v9, 0x10000, v5
v_add_u32 v10, 0x10000, v6
v_add_u32 v11, 0x10000, v7
v_add_u32 v12, 0x10000, v8
s_lshl_b32 s43, s34, 18
s_lshl_b32 s44, s35, 14
s_add_u32 s43, s43, s44
s_add_u32 s20, s32, s43
s_addc_u32 s21, s33, 0
s_add_u32 s20, s20, 4194304
s_addc_u32 s21, s21, 0
s_mov_b32 s22, 16384
s_mov_b32 s23, 0x20000
s_lshl_b32 s43, s34, 14
s_lshl_b32 s44, s35, 10
s_add_u32 s43, s43, s44
s_add_u32 s24, s32, s43
s_addc_u32 s25, s33, 0
s_add_u32 s24, s24, 25165824
s_addc_u32 s25, s25, 0
s_mov_b32 s26, 1024
s_mov_b32 s27, 0x20000
s_movk_i32 s50, 0x2000
v_lshrrev_b32 v19, 1, v18
v_lshl_add_u32 v19, v19, 4, v17
s_lshl_b32 s43, s36, 5
v_add_u32 v19, s43, v19
v_and_b32 v20, 1, v18
v_lshlrev_b32 v20, 2, v20
v_lshl_add_u32 v22, v19, 3, v20
s_lshl_b32 s43, s34, 18
s_add_u32 s12, s32, s43
s_addc_u32 s13, s33, 0
s_mov_b32 s14, 262144
s_mov_b32 s15, 0x20000
v_lshlrev_b32 v21, 4, v1
s_lshl_b32 s54, s36, 11
s_add_u32 s43, s35, 1
s_and_b32 s43, s43, 15
s_lshl_b32 s43, s43, 14
s_add_u32 s30, s43, s54
s_add_u32 s43, s35, 2
s_and_b32 s43, s43, 15
s_lshl_b32 s43, s43, 14
s_add_u32 s31, s43, s54
s_waitcnt vmcnt(0)
s_barrier
ds_write_b128 v27, v[68:71] offset:0
ds_write_b128 v27, v[116:119] offset:512
v_permlane16_swap_b32 v240, v242
v_permlane16_swap_b32 v241, v243
v_permlane16_swap_b32 v244, v246
v_permlane16_swap_b32 v245, v247
v_permlane16_swap_b32 v248, v250
v_permlane16_swap_b32 v249, v251
v_permlane16_swap_b32 v252, v254
v_permlane16_swap_b32 v253, v255
v_lshlrev_b32 v128, 16, v240
v_and_b32 v129, 0xffff0000, v240
v_lshlrev_b32 v130, 16, v241
v_and_b32 v131, 0xffff0000, v241
v_lshlrev_b32 v132, 16, v242
v_and_b32 v133, 0xffff0000, v242
v_lshlrev_b32 v134, 16, v243
v_and_b32 v135, 0xffff0000, v243
v_lshlrev_b32 v136, 16, v244
v_and_b32 v137, 0xffff0000, v244
v_lshlrev_b32 v138, 16, v245
v_and_b32 v139, 0xffff0000, v245
v_lshlrev_b32 v140, 16, v246
v_and_b32 v141, 0xffff0000, v246
v_lshlrev_b32 v142, 16, v247
v_and_b32 v143, 0xffff0000, v247
v_lshlrev_b32 v144, 16, v248
v_and_b32 v145, 0xffff0000, v248
v_lshlrev_b32 v146, 16, v249
v_and_b32 v147, 0xffff0000, v249
v_lshlrev_b32 v148, 16, v250
v_and_b32 v149, 0xffff0000, v250
v_lshlrev_b32 v150, 16, v251
v_and_b32 v151, 0xffff0000, v251
v_lshlrev_b32 v152, 16, v252
v_and_b32 v153, 0xffff0000, v252
v_lshlrev_b32 v154, 16, v253
v_and_b32 v155, 0xffff0000, v253
v_lshlrev_b32 v156, 16, v254
v_and_b32 v157, 0xffff0000, v254
v_lshlrev_b32 v158, 16, v255
v_and_b32 v159, 0xffff0000, v255
s_waitcnt lgkmcnt(0)
s_barrier
s_add_u32 m0, s54, 16384
s_add_u32 s43, s30, 0
buffer_load_dwordx4 v21, s[12:15], s43 offen sc1 lds
s_add_u32 m0, s54, 17408
s_add_u32 s43, s30, 1024
buffer_load_dwordx4 v21, s[12:15], s43 offen sc1 lds
s_add_u32 m0, s54, 32768
s_add_u32 s43, s31, 0
buffer_load_dwordx4 v21, s[12:15], s43 offen sc1 lds
s_add_u32 m0, s54, 33792
s_add_u32 s43, s31, 1024
buffer_load_dwordx4 v21, s[12:15], s43 offen sc1 lds
ds_read_b128 v[32:35], v2 offset:0
ds_read_b64_tr_b16 v[48:49], v5 offset:0
ds_read_b64_tr_b16 v[50:51], v5 offset:2048
ds_read_b64_tr_b16 v[52:53], v6 offset:0
ds_read_b64_tr_b16 v[54:55], v6 offset:2048
ds_read_b128 v[36:39], v2 offset:256
ds_read_b64_tr_b16 v[56:57], v7 offset:0
ds_read_b64_tr_b16 v[58:59], v7 offset:2048
ds_read_b64_tr_b16 v[60:61], v8 offset:0
ds_read_b64_tr_b16 v[62:63], v8 offset:2048
ds_read_b128 v[40:43], v2 offset:8192
ds_read_b64_tr_b16 v[64:65], v5 offset:4096
ds_read_b64_tr_b16 v[66:67], v5 offset:6144
ds_read_b64_tr_b16 v[68:69], v6 offset:4096
ds_read_b64_tr_b16 v[70:71], v6 offset:6144
ds_read_b128 v[44:47], v2 offset:8448
ds_read_b64_tr_b16 v[72:73], v7 offset:4096
ds_read_b64_tr_b16 v[74:75], v7 offset:6144
ds_read_b64_tr_b16 v[76:77], v8 offset:4096
ds_read_b64_tr_b16 v[78:79], v8 offset:6144
s_waitcnt lgkmcnt(0)
v_mfma_f32_16x16x32_bf16 v[128:131], v[48:51], v[32:35], v[128:131]
v_mfma_f32_16x16x32_bf16 v[132:135], v[52:55], v[32:35], v[132:135]
v_mfma_f32_16x16x32_bf16 v[136:139], v[56:59], v[32:35], v[136:139]
v_mfma_f32_16x16x32_bf16 v[140:143], v[60:63], v[32:35], v[140:143]
v_mfma_f32_16x16x32_bf16 v[144:147], v[48:51], v[36:39], v[144:147]
v_mfma_f32_16x16x32_bf16 v[148:151], v[52:55], v[36:39], v[148:151]
v_mfma_f32_16x16x32_bf16 v[152:155], v[56:59], v[36:39], v[152:155]
v_mfma_f32_16x16x32_bf16 v[156:159], v[60:63], v[36:39], v[156:159]
v_mfma_f32_16x16x32_bf16 v[128:131], v[64:67], v[40:43], v[128:131]
v_mfma_f32_16x16x32_bf16 v[132:135], v[68:71], v[40:43], v[132:135]
v_mfma_f32_16x16x32_bf16 v[136:139], v[72:75], v[40:43], v[136:139]
v_mfma_f32_16x16x32_bf16 v[140:143], v[76:79], v[40:43], v[140:143]
v_mfma_f32_16x16x32_bf16 v[144:147], v[64:67], v[44:47], v[144:147]
v_mfma_f32_16x16x32_bf16 v[148:151], v[68:71], v[44:47], v[148:151]
v_mfma_f32_16x16x32_bf16 v[152:155], v[72:75], v[44:47], v[152:155]
v_mfma_f32_16x16x32_bf16 v[156:159], v[76:79], v[44:47], v[156:159]
s_waitcnt vmcnt(2)
s_barrier
ds_read_b128 v[80:83], v2 offset:16384
ds_read_b64_tr_b16 v[96:97], v5 offset:8192
ds_read_b64_tr_b16 v[98:99], v5 offset:10240
ds_read_b64_tr_b16 v[100:101], v6 offset:8192
ds_read_b64_tr_b16 v[102:103], v6 offset:10240
ds_read_b128 v[84:87], v2 offset:16640
ds_read_b64_tr_b16 v[104:105], v7 offset:8192
ds_read_b64_tr_b16 v[106:107], v7 offset:10240
ds_read_b64_tr_b16 v[108:109], v8 offset:8192
ds_read_b64_tr_b16 v[110:111], v8 offset:10240
ds_read_b128 v[88:91], v2 offset:24576
ds_read_b64_tr_b16 v[112:113], v5 offset:12288
ds_read_b64_tr_b16 v[114:115], v5 offset:14336
ds_read_b64_tr_b16 v[116:117], v6 offset:12288
ds_read_b64_tr_b16 v[118:119], v6 offset:14336
ds_read_b128 v[92:95], v2 offset:24832
ds_read_b64_tr_b16 v[120:121], v7 offset:12288
ds_read_b64_tr_b16 v[122:123], v7 offset:14336
ds_read_b64_tr_b16 v[124:125], v8 offset:12288
ds_read_b64_tr_b16 v[126:127], v8 offset:14336
s_waitcnt vmcnt(0) lgkmcnt(0)
v_max3_u32 v19, v80, v81, v82
v_max3_u32 v19, v19, v83, v84
v_max3_u32 v19, v19, v85, v86
v_max3_u32 v19, v19, v87, v88
v_max3_u32 v19, v19, v89, v90
v_max3_u32 v19, v19, v91, v92
v_max3_u32 v19, v19, v93, v94
v_max_u32 v19, v19, v95
v_cmp_eq_u32 vcc, -1, v19
s_nop 4
s_cbranch_vccz Lok_43
s_add_u32 s44, s35, 1
s_and_b32 s44, s44, 15
s_lshl_b32 s44, s44, 14
s_add_u32 s43, s44, 0x2000
s_mov_b32 s45, 0x20000
Lre_44:
buffer_load_dwordx4 v[80:83], v2, s[12:15], s44 offen offset:0 sc1
buffer_load_dwordx4 v[84:87], v2, s[12:15], s44 offen offset:256 sc1
buffer_load_dwordx4 v[88:91], v2, s[12:15], s43 offen offset:0 sc1
buffer_load_dwordx4 v[92:95], v2, s[12:15], s43 offen offset:256 sc1
s_waitcnt vmcnt(0)
v_max3_u32 v19, v80, v81, v82
v_max3_u32 v19, v19, v83, v84
v_max3_u32 v19, v19, v85, v86
v_max3_u32 v19, v19, v87, v88
v_max3_u32 v19, v19, v89, v90
v_max3_u32 v19, v19, v91, v92
v_max3_u32 v19, v19, v93, v94
v_max_u32 v19, v19, v95
v_cmp_eq_u32 vcc, -1, v19
s_sub_u32 s45, s45, 1
s_cmp_eq_u32 s45, 0
s_cbranch_scc1 Lok_43
s_nop 2
s_cbranch_vccnz Lre_44
Lok_43:
s_barrier
v_mfma_f32_16x16x32_bf16 v[128:131], v[96:99], v[80:83], v[128:131]
ds_read_b128 v[32:35], v2 offset:32768
ds_read_b64_tr_b16 v[48:49], v5 offset:16384
v_mfma_f32_16x16x32_bf16 v[132:135], v[100:103], v[80:83], v[132:135]
ds_read_b64_tr_b16 v[50:51], v5 offset:18432
v_mfma_f32_16x16x32_bf16 v[136:139], v[104:107], v[80:83], v[136:139]
ds_read_b64_tr_b16 v[52:53], v6 offset:16384
v_mfma_f32_16x16x32_bf16 v[140:143], v[108:111], v[80:83], v[140:143]
ds_read_b64_tr_b16 v[54:55], v6 offset:18432
v_mfma_f32_16x16x32_bf16 v[144:147], v[96:99], v[84:87], v[144:147]
ds_read_b128 v[36:39], v2 offset:33024
ds_read_b64_tr_b16 v[56:57], v7 offset:16384
v_mfma_f32_16x16x32_bf16 v[148:151], v[100:103], v[84:87], v[148:151]
ds_read_b64_tr_b16 v[58:59], v7 offset:18432
v_mfma_f32_16x16x32_bf16 v[152:155], v[104:107], v[84:87], v[152:155]
ds_read_b64_tr_b16 v[60:61], v8 offset:16384
v_mfma_f32_16x16x32_bf16 v[156:159], v[108:111], v[84:87], v[156:159]
ds_read_b64_tr_b16 v[62:63], v8 offset:18432
v_mfma_f32_16x16x32_bf16 v[128:131], v[112:115], v[88:91], v[128:131]
ds_read_b128 v[40:43], v2 offset:40960
ds_read_b64_tr_b16 v[64:65], v5 offset:20480
v_mfma_f32_16x16x32_bf16 v[132:135], v[116:119], v[88:91], v[132:135]
ds_read_b64_tr_b16 v[66:67], v5 offset:22528
v_mfma_f32_16x16x32_bf16 v[136:139], v[120:123], v[88:91], v[136:139]
ds_read_b64_tr_b16 v[68:69], v6 offset:20480
v_mfma_f32_16x16x32_bf16 v[140:143], v[124:127], v[88:91], v[140:143]
ds_read_b64_tr_b16 v[70:71], v6 offset:22528
v_mfma_f32_16x16x32_bf16 v[144:147], v[112:115], v[92:95], v[144:147]
ds_read_b128 v[44:47], v2 offset:41216
ds_read_b64_tr_b16 v[72:73], v7 offset:20480
v_mfma_f32_16x16x32_bf16 v[148:151], v[116:119], v[92:95], v[148:151]
ds_read_b64_tr_b16 v[74:75], v7 offset:22528
v_mfma_f32_16x16x32_bf16 v[152:155], v[120:123], v[92:95], v[152:155]
ds_read_b64_tr_b16 v[76:77], v8 offset:20480
v_mfma_f32_16x16x32_bf16 v[156:159], v[124:127], v[92:95], v[156:159]
ds_read_b64_tr_b16 v[78:79], v8 offset:22528
s_waitcnt lgkmcnt(0)
v_max3_u32 v19, v32, v33, v34
v_max3_u32 v19, v19, v35, v36
v_max3_u32 v19, v19, v37, v38
v_max3_u32 v19, v19, v39, v40
v_max3_u32 v19, v19, v41, v42
v_max3_u32 v19, v19, v43, v44
v_max3_u32 v19, v19, v45, v46
v_max_u32 v19, v19, v47
v_cmp_eq_u32 vcc, -1, v19
s_nop 4
s_cbranch_vccz Lok_45
s_add_u32 s44, s35, 2
s_and_b32 s44, s44, 15
s_lshl_b32 s44, s44, 14
s_add_u32 s43, s44, 0x2000
s_mov_b32 s45, 0x20000
Lre_46:
buffer_load_dwordx4 v[32:35], v2, s[12:15], s44 offen offset:0 sc1
buffer_load_dwordx4 v[36:39], v2, s[12:15], s44 offen offset:256 sc1
buffer_load_dwordx4 v[40:43], v2, s[12:15], s43 offen offset:0 sc1
buffer_load_dwordx4 v[44:47], v2, s[12:15], s43 offen offset:256 sc1
s_waitcnt vmcnt(0)
v_max3_u32 v19, v32, v33, v34
v_max3_u32 v19, v19, v35, v36
v_max3_u32 v19, v19, v37, v38
v_max3_u32 v19, v19, v39, v40
v_max3_u32 v19, v19, v41, v42
v_max3_u32 v19, v19, v43, v44
v_max3_u32 v19, v19, v45, v46
v_max_u32 v19, v19, v47
v_cmp_eq_u32 vcc, -1, v19
s_sub_u32 s45, s45, 1
s_cmp_eq_u32 s45, 0
s_cbranch_scc1 Lok_45
s_nop 2
s_cbranch_vccnz Lre_46
Lok_45:
s_barrier
v_mfma_f32_16x16x32_bf16 v[128:131], v[48:51], v[32:35], v[128:131]
ds_read_b128 v[80:83], v2 offset:49152
ds_read_b64_tr_b16 v[96:97], v5 offset:24576
v_mfma_f32_16x16x32_bf16 v[132:135], v[52:55], v[32:35], v[132:135]
ds_read_b64_tr_b16 v[98:99], v5 offset:26624
v_mfma_f32_16x16x32_bf16 v[136:139], v[56:59], v[32:35], v[136:139]
ds_read_b64_tr_b16 v[100:101], v6 offset:24576
v_mfma_f32_16x16x32_bf16 v[140:143], v[60:63], v[32:35], v[140:143]
ds_read_b64_tr_b16 v[102:103], v6 offset:26624
v_mfma_f32_16x16x32_bf16 v[144:147], v[48:51], v[36:39], v[144:147]
ds_read_b128 v[84:87], v2 offset:49408
ds_read_b64_tr_b16 v[104:105], v7 offset:24576
v_mfma_f32_16x16x32_bf16 v[148:151], v[52:55], v[36:39], v[148:151]
ds_read_b64_tr_b16 v[106:107], v7 offset:26624
v_mfma_f32_16x16x32_bf16 v[152:155], v[56:59], v[36:39], v[152:155]
ds_read_b64_tr_b16 v[108:109], v8 offset:24576
v_mfma_f32_16x16x32_bf16 v[156:159], v[60:63], v[36:39], v[156:159]
ds_read_b64_tr_b16 v[110:111], v8 offset:26624
v_mfma_f32_16x16x32_bf16 v[128:131], v[64:67], v[40:43], v[128:131]
ds_read_b128 v[88:91], v2 offset:57344
ds_read_b64_tr_b16 v[112:113], v5 offset:28672
v_mfma_f32_16x16x32_bf16 v[132:135], v[68:71], v[40:43], v[132:135]
ds_read_b64_tr_b16 v[114:115], v5 offset:30720
v_mfma_f32_16x16x32_bf16 v[136:139], v[72:75], v[40:43], v[136:139]
ds_read_b64_tr_b16 v[116:117], v6 offset:28672
v_mfma_f32_16x16x32_bf16 v[140:143], v[76:79], v[40:43], v[140:143]
ds_read_b64_tr_b16 v[118:119], v6 offset:30720
v_mfma_f32_16x16x32_bf16 v[144:147], v[64:67], v[44:47], v[144:147]
ds_read_b128 v[92:95], v2 offset:57600
ds_read_b64_tr_b16 v[120:121], v7 offset:28672
v_mfma_f32_16x16x32_bf16 v[148:151], v[68:71], v[44:47], v[148:151]
ds_read_b64_tr_b16 v[122:123], v7 offset:30720
v_mfma_f32_16x16x32_bf16 v[152:155], v[72:75], v[44:47], v[152:155]
ds_read_b64_tr_b16 v[124:125], v8 offset:28672
v_mfma_f32_16x16x32_bf16 v[156:159], v[76:79], v[44:47], v[156:159]
ds_read_b64_tr_b16 v[126:127], v8 offset:30720
s_waitcnt lgkmcnt(0)
v_max3_u32 v19, v80, v81, v82
v_max3_u32 v19, v19, v83, v84
v_max3_u32 v19, v19, v85, v86
v_max3_u32 v19, v19, v87, v88
v_max3_u32 v19, v19, v89, v90
v_max3_u32 v19, v19, v91, v92
v_max3_u32 v19, v19, v93, v94
v_max_u32 v19, v19, v95
v_cmp_eq_u32 vcc, -1, v19
s_nop 4
s_cbranch_vccz Lok_47
s_add_u32 s44, s35, 3
s_and_b32 s44, s44, 15
s_lshl_b32 s44, s44, 14
s_add_u32 s43, s44, 0x2000
s_mov_b32 s45, 0x20000
Lre_48:
buffer_load_dwordx4 v[80:83], v2, s[12:15], s44 offen offset:0 sc1
buffer_load_dwordx4 v[84:87], v2, s[12:15], s44 offen offset:256 sc1
buffer_load_dwordx4 v[88:91], v2, s[12:15], s43 offen offset:0 sc1
buffer_load_dwordx4 v[92:95], v2, s[12:15], s43 offen offset:256 sc1
s_waitcnt vmcnt(0)
v_max3_u32 v19, v80, v81, v82
v_max3_u32 v19, v19, v83, v84
v_max3_u32 v19, v19, v85, v86
v_max3_u32 v19, v19, v87, v88
v_max3_u32 v19, v19, v89, v90
v_max3_u32 v19, v19, v91, v92
v_max3_u32 v19, v19, v93, v94
v_max_u32 v19, v19, v95
v_cmp_eq_u32 vcc, -1, v19
s_sub_u32 s45, s45, 1
s_cmp_eq_u32 s45, 0
s_cbranch_scc1 Lok_47
s_nop 2
s_cbranch_vccnz Lre_48
Lok_47:
s_barrier
v_mfma_f32_16x16x32_bf16 v[128:131], v[96:99], v[80:83], v[128:131]
ds_read_b128 v[32:35], v2 offset:0
ds_read_b64_tr_b16 v[48:49], v5 offset:32768
v_mfma_f32_16x16x32_bf16 v[132:135], v[100:103], v[80:83], v[132:135]
ds_read_b64_tr_b16 v[50:51], v5 offset:34816
v_mfma_f32_16x16x32_bf16 v[136:139], v[104:107], v[80:83], v[136:139]
ds_read_b64_tr_b16 v[52:53], v6 offset:32768
v_mfma_f32_16x16x32_bf16 v[140:143], v[108:111], v[80:83], v[140:143]
ds_read_b64_tr_b16 v[54:55], v6 offset:34816
v_mfma_f32_16x16x32_bf16 v[144:147], v[96:99], v[84:87], v[144:147]
ds_read_b128 v[36:39], v2 offset:256
ds_read_b64_tr_b16 v[56:57], v7 offset:32768
v_mfma_f32_16x16x32_bf16 v[148:151], v[100:103], v[84:87], v[148:151]
ds_read_b64_tr_b16 v[58:59], v7 offset:34816
v_mfma_f32_16x16x32_bf16 v[152:155], v[104:107], v[84:87], v[152:155]
ds_read_b64_tr_b16 v[60:61], v8 offset:32768
v_mfma_f32_16x16x32_bf16 v[156:159], v[108:111], v[84:87], v[156:159]
ds_read_b64_tr_b16 v[62:63], v8 offset:34816
v_mfma_f32_16x16x32_bf16 v[128:131], v[112:115], v[88:91], v[128:131]
ds_read_b128 v[40:43], v2 offset:8192
ds_read_b64_tr_b16 v[64:65], v5 offset:36864
v_mfma_f32_16x16x32_bf16 v[132:135], v[116:119], v[88:91], v[132:135]
ds_read_b64_tr_b16 v[66:67], v5 offset:38912
v_mfma_f32_16x16x32_bf16 v[136:139], v[120:123], v[88:91], v[136:139]
ds_read_b64_tr_b16 v[68:69], v6 offset:36864
v_mfma_f32_16x16x32_bf16 v[140:143], v[124:127], v[88:91], v[140:143]
ds_read_b64_tr_b16 v[70:71], v6 offset:38912
v_mfma_f32_16x16x32_bf16 v[144:147], v[112:115], v[92:95], v[144:147]
ds_read_b128 v[44:47], v2 offset:8448
ds_read_b64_tr_b16 v[72:73], v7 offset:36864
v_mfma_f32_16x16x32_bf16 v[148:151], v[116:119], v[92:95], v[148:151]
ds_read_b64_tr_b16 v[74:75], v7 offset:38912
v_mfma_f32_16x16x32_bf16 v[152:155], v[120:123], v[92:95], v[152:155]
ds_read_b64_tr_b16 v[76:77], v8 offset:36864
v_mfma_f32_16x16x32_bf16 v[156:159], v[124:127], v[92:95], v[156:159]
ds_read_b64_tr_b16 v[78:79], v8 offset:38912
s_waitcnt lgkmcnt(0)
v_max3_u32 v19, v32, v33, v34
v_max3_u32 v19, v19, v35, v36
v_max3_u32 v19, v19, v37, v38
v_max3_u32 v19, v19, v39, v40
v_max3_u32 v19, v19, v41, v42
v_max3_u32 v19, v19, v43, v44
v_max3_u32 v19, v19, v45, v46
v_max_u32 v19, v19, v47
v_cmp_eq_u32 vcc, -1, v19
s_nop 4
s_cbranch_vccz Lok_49
s_add_u32 s44, s35, 4
s_and_b32 s44, s44, 15
s_lshl_b32 s44, s44, 14
s_add_u32 s43, s44, 0x2000
s_mov_b32 s45, 0x20000
Lre_50:
buffer_load_dwordx4 v[32:35], v2, s[12:15], s44 offen offset:0 sc1
buffer_load_dwordx4 v[36:39], v2, s[12:15], s44 offen offset:256 sc1
buffer_load_dwordx4 v[40:43], v2, s[12:15], s43 offen offset:0 sc1
buffer_load_dwordx4 v[44:47], v2, s[12:15], s43 offen offset:256 sc1
s_waitcnt vmcnt(0)
v_max3_u32 v19, v32, v33, v34
v_max3_u32 v19, v19, v35, v36
v_max3_u32 v19, v19, v37, v38
v_max3_u32 v19, v19, v39, v40
v_max3_u32 v19, v19, v41, v42
v_max3_u32 v19, v19, v43, v44
v_max3_u32 v19, v19, v45, v46
v_max_u32 v19, v19, v47
v_cmp_eq_u32 vcc, -1, v19
s_sub_u32 s45, s45, 1
s_cmp_eq_u32 s45, 0
s_cbranch_scc1 Lok_49
s_nop 2
s_cbranch_vccnz Lre_50
Lok_49:
s_barrier
v_mfma_f32_16x16x32_bf16 v[128:131], v[48:51], v[32:35], v[128:131]
ds_read_b128 v[80:83], v2 offset:16384
ds_read_b64_tr_b16 v[96:97], v5 offset:40960
v_mfma_f32_16x16x32_bf16 v[132:135], v[52:55], v[32:35], v[132:135]
ds_read_b64_tr_b16 v[98:99], v5 offset:43008
v_mfma_f32_16x16x32_bf16 v[136:139], v[56:59], v[32:35], v[136:139]
ds_read_b64_tr_b16 v[100:101], v6 offset:40960
v_mfma_f32_16x16x32_bf16 v[140:143], v[60:63], v[32:35], v[140:143]
ds_read_b64_tr_b16 v[102:103], v6 offset:43008
v_mfma_f32_16x16x32_bf16 v[144:147], v[48:51], v[36:39], v[144:147]
ds_read_b128 v[84:87], v2 offset:16640
ds_read_b64_tr_b16 v[104:105], v7 offset:40960
v_mfma_f32_16x16x32_bf16 v[148:151], v[52:55], v[36:39], v[148:151]
ds_read_b64_tr_b16 v[106:107], v7 offset:43008
v_mfma_f32_16x16x32_bf16 v[152:155], v[56:59], v[36:39], v[152:155]
ds_read_b64_tr_b16 v[108:109], v8 offset:40960
v_mfma_f32_16x16x32_bf16 v[156:159], v[60:63], v[36:39], v[156:159]
ds_read_b64_tr_b16 v[110:111], v8 offset:43008
v_mfma_f32_16x16x32_bf16 v[128:131], v[64:67], v[40:43], v[128:131]
ds_read_b128 v[88:91], v2 offset:24576
ds_read_b64_tr_b16 v[112:113], v5 offset:45056
v_mfma_f32_16x16x32_bf16 v[132:135], v[68:71], v[40:43], v[132:135]
ds_read_b64_tr_b16 v[114:115], v5 offset:47104
v_mfma_f32_16x16x32_bf16 v[136:139], v[72:75], v[40:43], v[136:139]
ds_read_b64_tr_b16 v[116:117], v6 offset:45056
v_mfma_f32_16x16x32_bf16 v[140:143], v[76:79], v[40:43], v[140:143]
ds_read_b64_tr_b16 v[118:119], v6 offset:47104
v_mfma_f32_16x16x32_bf16 v[144:147], v[64:67], v[44:47], v[144:147]
ds_read_b128 v[92:95], v2 offset:24832
ds_read_b64_tr_b16 v[120:121], v7 offset:45056
v_mfma_f32_16x16x32_bf16 v[148:151], v[68:71], v[44:47], v[148:151]
ds_read_b64_tr_b16 v[122:123], v7 offset:47104
v_mfma_f32_16x16x32_bf16 v[152:155], v[72:75], v[44:47], v[152:155]
ds_read_b64_tr_b16 v[124:125], v8 offset:45056
v_mfma_f32_16x16x32_bf16 v[156:159], v[76:79], v[44:47], v[156:159]
ds_read_b64_tr_b16 v[126:127], v8 offset:47104
s_waitcnt lgkmcnt(0)
v_max3_u32 v19, v80, v81, v82
v_max3_u32 v19, v19, v83, v84
v_max3_u32 v19, v19, v85, v86
v_max3_u32 v19, v19, v87, v88
v_max3_u32 v19, v19, v89, v90
v_max3_u32 v19, v19, v91, v92
v_max3_u32 v19, v19, v93, v94
v_max_u32 v19, v19, v95
v_cmp_eq_u32 vcc, -1, v19
s_nop 4
s_cbranch_vccz Lok_51
s_add_u32 s44, s35, 5
s_and_b32 s44, s44, 15
s_lshl_b32 s44, s44, 14
s_add_u32 s43, s44, 0x2000
s_mov_b32 s45, 0x20000
Lre_52:
buffer_load_dwordx4 v[80:83], v2, s[12:15], s44 offen offset:0 sc1
buffer_load_dwordx4 v[84:87], v2, s[12:15], s44 offen offset:256 sc1
buffer_load_dwordx4 v[88:91], v2, s[12:15], s43 offen offset:0 sc1
buffer_load_dwordx4 v[92:95], v2, s[12:15], s43 offen offset:256 sc1
s_waitcnt vmcnt(0)
v_max3_u32 v19, v80, v81, v82
v_max3_u32 v19, v19, v83, v84
v_max3_u32 v19, v19, v85, v86
v_max3_u32 v19, v19, v87, v88
v_max3_u32 v19, v19, v89, v90
v_max3_u32 v19, v19, v91, v92
v_max3_u32 v19, v19, v93, v94
v_max_u32 v19, v19, v95
v_cmp_eq_u32 vcc, -1, v19
s_sub_u32 s45, s45, 1
s_cmp_eq_u32 s45, 0
s_cbranch_scc1 Lok_51
s_nop 2
s_cbranch_vccnz Lre_52
Lok_51:
s_barrier
v_mfma_f32_16x16x32_bf16 v[128:131], v[96:99], v[80:83], v[128:131]
ds_read_b128 v[32:35], v2 offset:32768
ds_read_b64_tr_b16 v[48:49], v5 offset:49152
v_mfma_f32_16x16x32_bf16 v[132:135], v[100:103], v[80:83], v[132:135]
ds_read_b64_tr_b16 v[50:51], v5 offset:51200
v_mfma_f32_16x16x32_bf16 v[136:139], v[104:107], v[80:83], v[136:139]
ds_read_b64_tr_b16 v[52:53], v6 offset:49152
v_mfma_f32_16x16x32_bf16 v[140:143], v[108:111], v[80:83], v[140:143]
ds_read_b64_tr_b16 v[54:55], v6 offset:51200
v_mfma_f32_16x16x32_bf16 v[144:147], v[96:99], v[84:87], v[144:147]
ds_read_b128 v[36:39], v2 offset:33024
ds_read_b64_tr_b16 v[56:57], v7 offset:49152
v_mfma_f32_16x16x32_bf16 v[148:151], v[100:103], v[84:87], v[148:151]
ds_read_b64_tr_b16 v[58:59], v7 offset:51200
v_mfma_f32_16x16x32_bf16 v[152:155], v[104:107], v[84:87], v[152:155]
ds_read_b64_tr_b16 v[60:61], v8 offset:49152
v_mfma_f32_16x16x32_bf16 v[156:159], v[108:111], v[84:87], v[156:159]
ds_read_b64_tr_b16 v[62:63], v8 offset:51200
v_mfma_f32_16x16x32_bf16 v[128:131], v[112:115], v[88:91], v[128:131]
ds_read_b128 v[40:43], v2 offset:40960
ds_read_b64_tr_b16 v[64:65], v5 offset:53248
v_mfma_f32_16x16x32_bf16 v[132:135], v[116:119], v[88:91], v[132:135]
ds_read_b64_tr_b16 v[66:67], v5 offset:55296
v_mfma_f32_16x16x32_bf16 v[136:139], v[120:123], v[88:91], v[136:139]
ds_read_b64_tr_b16 v[68:69], v6 offset:53248
v_mfma_f32_16x16x32_bf16 v[140:143], v[124:127], v[88:91], v[140:143]
ds_read_b64_tr_b16 v[70:71], v6 offset:55296
v_mfma_f32_16x16x32_bf16 v[144:147], v[112:115], v[92:95], v[144:147]
ds_read_b128 v[44:47], v2 offset:41216
ds_read_b64_tr_b16 v[72:73], v7 offset:53248
v_mfma_f32_16x16x32_bf16 v[148:151], v[116:119], v[92:95], v[148:151]
ds_read_b64_tr_b16 v[74:75], v7 offset:55296
v_mfma_f32_16x16x32_bf16 v[152:155], v[120:123], v[92:95], v[152:155]
ds_read_b64_tr_b16 v[76:77], v8 offset:53248
v_mfma_f32_16x16x32_bf16 v[156:159], v[124:127], v[92:95], v[156:159]
ds_read_b64_tr_b16 v[78:79], v8 offset:55296
s_waitcnt lgkmcnt(0)
v_max3_u32 v19, v32, v33, v34
v_max3_u32 v19, v19, v35, v36
v_max3_u32 v19, v19, v37, v38
v_max3_u32 v19, v19, v39, v40
v_max3_u32 v19, v19, v41, v42
v_max3_u32 v19, v19, v43, v44
v_max3_u32 v19, v19, v45, v46
v_max_u32 v19, v19, v47
v_cmp_eq_u32 vcc, -1, v19
s_nop 4
s_cbranch_vccz Lok_53
s_add_u32 s44, s35, 6
s_and_b32 s44, s44, 15
s_lshl_b32 s44, s44, 14
s_add_u32 s43, s44, 0x2000
s_mov_b32 s45, 0x20000
Lre_54:
buffer_load_dwordx4 v[32:35], v2, s[12:15], s44 offen offset:0 sc1
buffer_load_dwordx4 v[36:39], v2, s[12:15], s44 offen offset:256 sc1
buffer_load_dwordx4 v[40:43], v2, s[12:15], s43 offen offset:0 sc1
buffer_load_dwordx4 v[44:47], v2, s[12:15], s43 offen offset:256 sc1
s_waitcnt vmcnt(0)
v_max3_u32 v19, v32, v33, v34
v_max3_u32 v19, v19, v35, v36
v_max3_u32 v19, v19, v37, v38
v_max3_u32 v19, v19, v39, v40
v_max3_u32 v19, v19, v41, v42
v_max3_u32 v19, v19, v43, v44
v_max3_u32 v19, v19, v45, v46
v_max_u32 v19, v19, v47
v_cmp_eq_u32 vcc, -1, v19
s_sub_u32 s45, s45, 1
s_cmp_eq_u32 s45, 0
s_cbranch_scc1 Lok_53
s_nop 2
s_cbranch_vccnz Lre_54
Lok_53:
s_barrier
v_mfma_f32_16x16x32_bf16 v[128:131], v[48:51], v[32:35], v[128:131]
ds_read_b128 v[80:83], v2 offset:49152
ds_read_b64_tr_b16 v[96:97], v5 offset:57344
v_mfma_f32_16x16x32_bf16 v[132:135], v[52:55], v[32:35], v[132:135]
ds_read_b64_tr_b16 v[98:99], v5 offset:59392
v_mfma_f32_16x16x32_bf16 v[136:139], v[56:59], v[32:35], v[136:139]
ds_read_b64_tr_b16 v[100:101], v6 offset:57344
v_mfma_f32_16x16x32_bf16 v[140:143], v[60:63], v[32:35], v[140:143]
ds_read_b64_tr_b16 v[102:103], v6 offset:59392
v_mfma_f32_16x16x32_bf16 v[144:147], v[48:51], v[36:39], v[144:147]
ds_read_b128 v[84:87], v2 offset:49408
ds_read_b64_tr_b16 v[104:105], v7 offset:57344
v_mfma_f32_16x16x32_bf16 v[148:151], v[52:55], v[36:39], v[148:151]
ds_read_b64_tr_b16 v[106:107], v7 offset:59392
v_mfma_f32_16x16x32_bf16 v[152:155], v[56:59], v[36:39], v[152:155]
ds_read_b64_tr_b16 v[108:109], v8 offset:57344
v_mfma_f32_16x16x32_bf16 v[156:159], v[60:63], v[36:39], v[156:159]
ds_read_b64_tr_b16 v[110:111], v8 offset:59392
v_mfma_f32_16x16x32_bf16 v[128:131], v[64:67], v[40:43], v[128:131]
ds_read_b128 v[88:91], v2 offset:57344
ds_read_b64_tr_b16 v[112:113], v5 offset:61440
v_mfma_f32_16x16x32_bf16 v[132:135], v[68:71], v[40:43], v[132:135]
ds_read_b64_tr_b16 v[114:115], v5 offset:63488
v_mfma_f32_16x16x32_bf16 v[136:139], v[72:75], v[40:43], v[136:139]
ds_read_b64_tr_b16 v[116:117], v6 offset:61440
v_mfma_f32_16x16x32_bf16 v[140:143], v[76:79], v[40:43], v[140:143]
ds_read_b64_tr_b16 v[118:119], v6 offset:63488
v_mfma_f32_16x16x32_bf16 v[144:147], v[64:67], v[44:47], v[144:147]
ds_read_b128 v[92:95], v2 offset:57600
ds_read_b64_tr_b16 v[120:121], v7 offset:61440
v_mfma_f32_16x16x32_bf16 v[148:151], v[68:71], v[44:47], v[148:151]
ds_read_b64_tr_b16 v[122:123], v7 offset:63488
v_mfma_f32_16x16x32_bf16 v[152:155], v[72:75], v[44:47], v[152:155]
ds_read_b64_tr_b16 v[124:125], v8 offset:61440
v_mfma_f32_16x16x32_bf16 v[156:159], v[76:79], v[44:47], v[156:159]
ds_read_b64_tr_b16 v[126:127], v8 offset:63488
s_waitcnt lgkmcnt(0)
v_max3_u32 v19, v80, v81, v82
v_max3_u32 v19, v19, v83, v84
v_max3_u32 v19, v19, v85, v86
v_max3_u32 v19, v19, v87, v88
v_max3_u32 v19, v19, v89, v90
v_max3_u32 v19, v19, v91, v92
v_max3_u32 v19, v19, v93, v94
v_max_u32 v19, v19, v95
v_cmp_eq_u32 vcc, -1, v19
s_nop 4
s_cbranch_vccz Lok_55
s_add_u32 s44, s35, 7
s_and_b32 s44, s44, 15
s_lshl_b32 s44, s44, 14
s_add_u32 s43, s44, 0x2000
s_mov_b32 s45, 0x20000
Lre_56:
buffer_load_dwordx4 v[80:83], v2, s[12:15], s44 offen offset:0 sc1
buffer_load_dwordx4 v[84:87], v2, s[12:15], s44 offen offset:256 sc1
buffer_load_dwordx4 v[88:91], v2, s[12:15], s43 offen offset:0 sc1
buffer_load_dwordx4 v[92:95], v2, s[12:15], s43 offen offset:256 sc1
s_waitcnt vmcnt(0)
v_max3_u32 v19, v80, v81, v82
v_max3_u32 v19, v19, v83, v84
v_max3_u32 v19, v19, v85, v86
v_max3_u32 v19, v19, v87, v88
v_max3_u32 v19, v19, v89, v90
v_max3_u32 v19, v19, v91, v92
v_max3_u32 v19, v19, v93, v94
v_max_u32 v19, v19, v95
v_cmp_eq_u32 vcc, -1, v19
s_sub_u32 s45, s45, 1
s_cmp_eq_u32 s45, 0
s_cbranch_scc1 Lok_55
s_nop 2
s_cbranch_vccnz Lre_56
Lok_55:
s_barrier
v_mfma_f32_16x16x32_bf16 v[128:131], v[96:99], v[80:83], v[128:131]
ds_read_b128 v[32:35], v2 offset:0
ds_read_b64_tr_b16 v[48:49], v9 offset:0
v_mfma_f32_16x16x32_bf16 v[132:135], v[100:103], v[80:83], v[132:135]
ds_read_b64_tr_b16 v[50:51], v9 offset:2048
v_mfma_f32_16x16x32_bf16 v[136:139], v[104:107], v[80:83], v[136:139]
ds_read_b64_tr_b16 v[52:53], v10 offset:0
v_mfma_f32_16x16x32_bf16 v[140:143], v[108:111], v[80:83], v[140:143]
ds_read_b64_tr_b16 v[54:55], v10 offset:2048
v_mfma_f32_16x16x32_bf16 v[144:147], v[96:99], v[84:87], v[144:147]
ds_read_b128 v[36:39], v2 offset:256
ds_read_b64_tr_b16 v[56:57], v11 offset:0
v_mfma_f32_16x16x32_bf16 v[148:151], v[100:103], v[84:87], v[148:151]
ds_read_b64_tr_b16 v[58:59], v11 offset:2048
v_mfma_f32_16x16x32_bf16 v[152:155], v[104:107], v[84:87], v[152:155]
ds_read_b64_tr_b16 v[60:61], v12 offset:0
v_mfma_f32_16x16x32_bf16 v[156:159], v[108:111], v[84:87], v[156:159]
ds_read_b64_tr_b16 v[62:63], v12 offset:2048
v_mfma_f32_16x16x32_bf16 v[128:131], v[112:115], v[88:91], v[128:131]
ds_read_b128 v[40:43], v2 offset:8192
ds_read_b64_tr_b16 v[64:65], v9 offset:4096
v_mfma_f32_16x16x32_bf16 v[132:135], v[116:119], v[88:91], v[132:135]
ds_read_b64_tr_b16 v[66:67], v9 offset:6144
v_mfma_f32_16x16x32_bf16 v[136:139], v[120:123], v[88:91], v[136:139]
ds_read_b64_tr_b16 v[68:69], v10 offset:4096
v_mfma_f32_16x16x32_bf16 v[140:143], v[124:127], v[88:91], v[140:143]
ds_read_b64_tr_b16 v[70:71], v10 offset:6144
v_mfma_f32_16x16x32_bf16 v[144:147], v[112:115], v[92:95], v[144:147]
ds_read_b128 v[44:47], v2 offset:8448
ds_read_b64_tr_b16 v[72:73], v11 offset:4096
v_mfma_f32_16x16x32_bf16 v[148:151], v[116:119], v[92:95], v[148:151]
ds_read_b64_tr_b16 v[74:75], v11 offset:6144
v_mfma_f32_16x16x32_bf16 v[152:155], v[120:123], v[92:95], v[152:155]
ds_read_b64_tr_b16 v[76:77], v12 offset:4096
v_mfma_f32_16x16x32_bf16 v[156:159], v[124:127], v[92:95], v[156:159]
ds_read_b64_tr_b16 v[78:79], v12 offset:6144
s_waitcnt lgkmcnt(0)
v_max3_u32 v19, v32, v33, v34
v_max3_u32 v19, v19, v35, v36
v_max3_u32 v19, v19, v37, v38
v_max3_u32 v19, v19, v39, v40
v_max3_u32 v19, v19, v41, v42
v_max3_u32 v19, v19, v43, v44
v_max3_u32 v19, v19, v45, v46
v_max_u32 v19, v19, v47
v_cmp_eq_u32 vcc, -1, v19
s_nop 4
s_cbranch_vccz Lok_57
s_add_u32 s44, s35, 8
s_and_b32 s44, s44, 15
s_lshl_b32 s44, s44, 14
s_add_u32 s43, s44, 0x2000
s_mov_b32 s45, 0x20000
Lre_58:
buffer_load_dwordx4 v[32:35], v2, s[12:15], s44 offen offset:0 sc1
buffer_load_dwordx4 v[36:39], v2, s[12:15], s44 offen offset:256 sc1
buffer_load_dwordx4 v[40:43], v2, s[12:15], s43 offen offset:0 sc1
buffer_load_dwordx4 v[44:47], v2, s[12:15], s43 offen offset:256 sc1
s_waitcnt vmcnt(0)
v_max3_u32 v19, v32, v33, v34
v_max3_u32 v19, v19, v35, v36
v_max3_u32 v19, v19, v37, v38
v_max3_u32 v19, v19, v39, v40
v_max3_u32 v19, v19, v41, v42
v_max3_u32 v19, v19, v43, v44
v_max3_u32 v19, v19, v45, v46
v_max_u32 v19, v19, v47
v_cmp_eq_u32 vcc, -1, v19
s_sub_u32 s45, s45, 1
s_cmp_eq_u32 s45, 0
s_cbranch_scc1 Lok_57
s_nop 2
s_cbranch_vccnz Lre_58
Lok_57:
s_barrier
v_mfma_f32_16x16x32_bf16 v[128:131], v[48:51], v[32:35], v[128:131]
ds_read_b128 v[80:83], v2 offset:16384
ds_read_b64_tr_b16 v[96:97], v9 offset:8192
v_mfma_f32_16x16x32_bf16 v[132:135], v[52:55], v[32:35], v[132:135]
ds_read_b64_tr_b16 v[98:99], v9 offset:10240
v_mfma_f32_16x16x32_bf16 v[136:139], v[56:59], v[32:35], v[136:139]
ds_read_b64_tr_b16 v[100:101], v10 offset:8192
v_mfma_f32_16x16x32_bf16 v[140:143], v[60:63], v[32:35], v[140:143]
ds_read_b64_tr_b16 v[102:103], v10 offset:10240
v_mfma_f32_16x16x32_bf16 v[144:147], v[48:51], v[36:39], v[144:147]
ds_read_b128 v[84:87], v2 offset:16640
ds_read_b64_tr_b16 v[104:105], v11 offset:8192
v_mfma_f32_16x16x32_bf16 v[148:151], v[52:55], v[36:39], v[148:151]
ds_read_b64_tr_b16 v[106:107], v11 offset:10240
v_mfma_f32_16x16x32_bf16 v[152:155], v[56:59], v[36:39], v[152:155]
ds_read_b64_tr_b16 v[108:109], v12 offset:8192
v_mfma_f32_16x16x32_bf16 v[156:159], v[60:63], v[36:39], v[156:159]
ds_read_b64_tr_b16 v[110:111], v12 offset:10240
v_mfma_f32_16x16x32_bf16 v[128:131], v[64:67], v[40:43], v[128:131]
ds_read_b128 v[88:91], v2 offset:24576
ds_read_b64_tr_b16 v[112:113], v9 offset:12288
v_mfma_f32_16x16x32_bf16 v[132:135], v[68:71], v[40:43], v[132:135]
ds_read_b64_tr_b16 v[114:115], v9 offset:14336
v_mfma_f32_16x16x32_bf16 v[136:139], v[72:75], v[40:43], v[136:139]
ds_read_b64_tr_b16 v[116:117], v10 offset:12288
v_mfma_f32_16x16x32_bf16 v[140:143], v[76:79], v[40:43], v[140:143]
ds_read_b64_tr_b16 v[118:119], v10 offset:14336
v_mfma_f32_16x16x32_bf16 v[144:147], v[64:67], v[44:47], v[144:147]
ds_read_b128 v[92:95], v2 offset:24832
ds_read_b64_tr_b16 v[120:121], v11 offset:12288
v_mfma_f32_16x16x32_bf16 v[148:151], v[68:71], v[44:47], v[148:151]
ds_read_b64_tr_b16 v[122:123], v11 offset:14336
v_mfma_f32_16x16x32_bf16 v[152:155], v[72:75], v[44:47], v[152:155]
ds_read_b64_tr_b16 v[124:125], v12 offset:12288
v_mfma_f32_16x16x32_bf16 v[156:159], v[76:79], v[44:47], v[156:159]
ds_read_b64_tr_b16 v[126:127], v12 offset:14336
s_waitcnt lgkmcnt(0)
v_max3_u32 v19, v80, v81, v82
v_max3_u32 v19, v19, v83, v84
v_max3_u32 v19, v19, v85, v86
v_max3_u32 v19, v19, v87, v88
v_max3_u32 v19, v19, v89, v90
v_max3_u32 v19, v19, v91, v92
v_max3_u32 v19, v19, v93, v94
v_max_u32 v19, v19, v95
v_cmp_eq_u32 vcc, -1, v19
s_nop 4
s_cbranch_vccz Lok_59
s_add_u32 s44, s35, 9
s_and_b32 s44, s44, 15
s_lshl_b32 s44, s44, 14
s_add_u32 s43, s44, 0x2000
s_mov_b32 s45, 0x20000
Lre_60:
buffer_load_dwordx4 v[80:83], v2, s[12:15], s44 offen offset:0 sc1
buffer_load_dwordx4 v[84:87], v2, s[12:15], s44 offen offset:256 sc1
buffer_load_dwordx4 v[88:91], v2, s[12:15], s43 offen offset:0 sc1
buffer_load_dwordx4 v[92:95], v2, s[12:15], s43 offen offset:256 sc1
s_waitcnt vmcnt(0)
v_max3_u32 v19, v80, v81, v82
v_max3_u32 v19, v19, v83, v84
v_max3_u32 v19, v19, v85, v86
v_max3_u32 v19, v19, v87, v88
v_max3_u32 v19, v19, v89, v90
v_max3_u32 v19, v19, v91, v92
v_max3_u32 v19, v19, v93, v94
v_max_u32 v19, v19, v95
v_cmp_eq_u32 vcc, -1, v19
s_sub_u32 s45, s45, 1
s_cmp_eq_u32 s45, 0
s_cbranch_scc1 Lok_59
s_nop 2
s_cbranch_vccnz Lre_60
Lok_59:
s_barrier
v_mfma_f32_16x16x32_bf16 v[128:131], v[96:99], v[80:83], v[128:131]
ds_read_b128 v[32:35], v2 offset:32768
ds_read_b64_tr_b16 v[48:49], v5 offset:0
v_mfma_f32_16x16x32_bf16 v[132:135], v[100:103], v[80:83], v[132:135]
ds_read_b64_tr_b16 v[50:51], v5 offset:2048
v_mfma_f32_16x16x32_bf16 v[136:139], v[104:107], v[80:83], v[136:139]
ds_read_b64_tr_b16 v[52:53], v6 offset:0
v_mfma_f32_16x16x32_bf16 v[140:143], v[108:111], v[80:83], v[140:143]
ds_read_b64_tr_b16 v[54:55], v6 offset:2048
v_mfma_f32_16x16x32_bf16 v[144:147], v[96:99], v[84:87], v[144:147]
ds_read_b128 v[36:39], v2 offset:33024
ds_read_b64_tr_b16 v[56:57], v7 offset:0
v_mfma_f32_16x16x32_bf16 v[148:151], v[100:103], v[84:87], v[148:151]
ds_read_b64_tr_b16 v[58:59], v7 offset:2048
v_mfma_f32_16x16x32_bf16 v[152:155], v[104:107], v[84:87], v[152:155]
ds_read_b64_tr_b16 v[60:61], v8 offset:0
v_mfma_f32_16x16x32_bf16 v[156:159], v[108:111], v[84:87], v[156:159]
ds_read_b64_tr_b16 v[62:63], v8 offset:2048
v_mfma_f32_16x16x32_bf16 v[128:131], v[112:115], v[88:91], v[128:131]
ds_read_b128 v[40:43], v2 offset:40960
ds_read_b64_tr_b16 v[64:65], v5 offset:4096
v_mfma_f32_16x16x32_bf16 v[132:135], v[116:119], v[88:91], v[132:135]
ds_read_b64_tr_b16 v[66:67], v5 offset:6144
v_mfma_f32_16x16x32_bf16 v[136:139], v[120:123], v[88:91], v[136:139]
ds_read_b64_tr_b16 v[68:69], v6 offset:4096
v_mfma_f32_16x16x32_bf16 v[140:143], v[124:127], v[88:91], v[140:143]
ds_read_b64_tr_b16 v[70:71], v6 offset:6144
v_mfma_f32_16x16x32_bf16 v[144:147], v[112:115], v[92:95], v[144:147]
ds_read_b128 v[44:47], v2 offset:41216
ds_read_b64_tr_b16 v[72:73], v7 offset:4096
v_mfma_f32_16x16x32_bf16 v[148:151], v[116:119], v[92:95], v[148:151]
ds_read_b64_tr_b16 v[74:75], v7 offset:6144
v_mfma_f32_16x16x32_bf16 v[152:155], v[120:123], v[92:95], v[152:155]
ds_read_b64_tr_b16 v[76:77], v8 offset:4096
v_mfma_f32_16x16x32_bf16 v[156:159], v[124:127], v[92:95], v[156:159]
ds_read_b64_tr_b16 v[78:79], v8 offset:6144
s_waitcnt lgkmcnt(0)
v_max3_u32 v19, v32, v33, v34
v_max3_u32 v19, v19, v35, v36
v_max3_u32 v19, v19, v37, v38
v_max3_u32 v19, v19, v39, v40
v_max3_u32 v19, v19, v41, v42
v_max3_u32 v19, v19, v43, v44
v_max3_u32 v19, v19, v45, v46
v_max_u32 v19, v19, v47
v_cmp_eq_u32 vcc, -1, v19
s_nop 4
s_cbranch_vccz Lok_61
s_add_u32 s44, s35, 10
s_and_b32 s44, s44, 15
s_lshl_b32 s44, s44, 14
s_add_u32 s43, s44, 0x2000
s_mov_b32 s45, 0x20000
Lre_62:
buffer_load_dwordx4 v[32:35], v2, s[12:15], s44 offen offset:0 sc1
buffer_load_dwordx4 v[36:39], v2, s[12:15], s44 offen offset:256 sc1
buffer_load_dwordx4 v[40:43], v2, s[12:15], s43 offen offset:0 sc1
buffer_load_dwordx4 v[44:47], v2, s[12:15], s43 offen offset:256 sc1
s_waitcnt vmcnt(0)
v_max3_u32 v19, v32, v33, v34
v_max3_u32 v19, v19, v35, v36
v_max3_u32 v19, v19, v37, v38
v_max3_u32 v19, v19, v39, v40
v_max3_u32 v19, v19, v41, v42
v_max3_u32 v19, v19, v43, v44
v_max3_u32 v19, v19, v45, v46
v_max_u32 v19, v19, v47
v_cmp_eq_u32 vcc, -1, v19
s_sub_u32 s45, s45, 1
s_cmp_eq_u32 s45, 0
s_cbranch_scc1 Lok_61
s_nop 2
s_cbranch_vccnz Lre_62
Lok_61:
s_barrier
v_mfma_f32_16x16x32_bf16 v[128:131], v[48:51], v[32:35], v[128:131]
ds_read_b128 v[80:83], v2 offset:49152
ds_read_b64_tr_b16 v[96:97], v5 offset:8192
v_mfma_f32_16x16x32_bf16 v[132:135], v[52:55], v[32:35], v[132:135]
ds_read_b64_tr_b16 v[98:99], v5 offset:10240
v_mfma_f32_16x16x32_bf16 v[136:139], v[56:59], v[32:35], v[136:139]
ds_read_b64_tr_b16 v[100:101], v6 offset:8192
v_mfma_f32_16x16x32_bf16 v[140:143], v[60:63], v[32:35], v[140:143]
ds_read_b64_tr_b16 v[102:103], v6 offset:10240
v_mfma_f32_16x16x32_bf16 v[144:147], v[48:51], v[36:39], v[144:147]
ds_read_b128 v[84:87], v2 offset:49408
ds_read_b64_tr_b16 v[104:105], v7 offset:8192
v_mfma_f32_16x16x32_bf16 v[148:151], v[52:55], v[36:39], v[148:151]
ds_read_b64_tr_b16 v[106:107], v7 offset:10240
v_mfma_f32_16x16x32_bf16 v[152:155], v[56:59], v[36:39], v[152:155]
ds_read_b64_tr_b16 v[108:109], v8 offset:8192
v_mfma_f32_16x16x32_bf16 v[156:159], v[60:63], v[36:39], v[156:159]
ds_read_b64_tr_b16 v[110:111], v8 offset:10240
v_mfma_f32_16x16x32_bf16 v[128:131], v[64:67], v[40:43], v[128:131]
ds_read_b128 v[88:91], v2 offset:57344
ds_read_b64_tr_b16 v[112:113], v5 offset:12288
v_mfma_f32_16x16x32_bf16 v[132:135], v[68:71], v[40:43], v[132:135]
ds_read_b64_tr_b16 v[114:115], v5 offset:14336
v_mfma_f32_16x16x32_bf16 v[136:139], v[72:75], v[40:43], v[136:139]
ds_read_b64_tr_b16 v[116:117], v6 offset:12288
v_mfma_f32_16x16x32_bf16 v[140:143], v[76:79], v[40:43], v[140:143]
ds_read_b64_tr_b16 v[118:119], v6 offset:14336
v_mfma_f32_16x16x32_bf16 v[144:147], v[64:67], v[44:47], v[144:147]
ds_read_b128 v[92:95], v2 offset:57600
ds_read_b64_tr_b16 v[120:121], v7 offset:12288
v_mfma_f32_16x16x32_bf16 v[148:151], v[68:71], v[44:47], v[148:151]
ds_read_b64_tr_b16 v[122:123], v7 offset:14336
v_mfma_f32_16x16x32_bf16 v[152:155], v[72:75], v[44:47], v[152:155]
ds_read_b64_tr_b16 v[124:125], v8 offset:12288
v_mfma_f32_16x16x32_bf16 v[156:159], v[76:79], v[44:47], v[156:159]
ds_read_b64_tr_b16 v[126:127], v8 offset:14336
s_waitcnt lgkmcnt(0)
s_barrier
v_mfma_f32_16x16x32_bf16 v[128:131], v[96:99], v[80:83], v[128:131]
ds_read_b128 v[32:35], v2 offset:0
ds_read_b64_tr_b16 v[48:49], v5 offset:16384
v_mfma_f32_16x16x32_bf16 v[132:135], v[100:103], v[80:83], v[132:135]
ds_read_b64_tr_b16 v[50:51], v5 offset:18432
v_mfma_f32_16x16x32_bf16 v[136:139], v[104:107], v[80:83], v[136:139]
ds_read_b64_tr_b16 v[52:53], v6 offset:16384
v_mfma_f32_16x16x32_bf16 v[140:143], v[108:111], v[80:83], v[140:143]
ds_read_b64_tr_b16 v[54:55], v6 offset:18432
v_mfma_f32_16x16x32_bf16 v[144:147], v[96:99], v[84:87], v[144:147]
ds_read_b128 v[36:39], v2 offset:256
ds_read_b64_tr_b16 v[56:57], v7 offset:16384
v_mfma_f32_16x16x32_bf16 v[148:151], v[100:103], v[84:87], v[148:151]
ds_read_b64_tr_b16 v[58:59], v7 offset:18432
v_mfma_f32_16x16x32_bf16 v[152:155], v[104:107], v[84:87], v[152:155]
ds_read_b64_tr_b16 v[60:61], v8 offset:16384
v_mfma_f32_16x16x32_bf16 v[156:159], v[108:111], v[84:87], v[156:159]
ds_read_b64_tr_b16 v[62:63], v8 offset:18432
v_mfma_f32_16x16x32_bf16 v[128:131], v[112:115], v[88:91], v[128:131]
ds_read_b128 v[40:43], v2 offset:8192
ds_read_b64_tr_b16 v[64:65], v5 offset:20480
v_mfma_f32_16x16x32_bf16 v[132:135], v[116:119], v[88:91], v[132:135]
ds_read_b64_tr_b16 v[66:67], v5 offset:22528
v_mfma_f32_16x16x32_bf16 v[136:139], v[120:123], v[88:91], v[136:139]
ds_read_b64_tr_b16 v[68:69], v6 offset:20480
v_mfma_f32_16x16x32_bf16 v[140:143], v[124:127], v[88:91], v[140:143]
ds_read_b64_tr_b16 v[70:71], v6 offset:22528
v_mfma_f32_16x16x32_bf16 v[144:147], v[112:115], v[92:95], v[144:147]
ds_read_b128 v[44:47], v2 offset:8448
ds_read_b64_tr_b16 v[72:73], v7 offset:20480
v_mfma_f32_16x16x32_bf16 v[148:151], v[116:119], v[92:95], v[148:151]
ds_read_b64_tr_b16 v[74:75], v7 offset:22528
v_mfma_f32_16x16x32_bf16 v[152:155], v[120:123], v[92:95], v[152:155]
ds_read_b64_tr_b16 v[76:77], v8 offset:20480
v_mfma_f32_16x16x32_bf16 v[156:159], v[124:127], v[92:95], v[156:159]
ds_read_b64_tr_b16 v[78:79], v8 offset:22528
s_waitcnt lgkmcnt(0)
s_barrier
v_mfma_f32_16x16x32_bf16 v[128:131], v[48:51], v[32:35], v[128:131]
ds_read_b128 v[80:83], v2 offset:16384
ds_read_b64_tr_b16 v[96:97], v5 offset:24576
v_mfma_f32_16x16x32_bf16 v[132:135], v[52:55], v[32:35], v[132:135]
ds_read_b64_tr_b16 v[98:99], v5 offset:26624
v_mfma_f32_16x16x32_bf16 v[136:139], v[56:59], v[32:35], v[136:139]
ds_read_b64_tr_b16 v[100:101], v6 offset:24576
v_mfma_f32_16x16x32_bf16 v[140:143], v[60:63], v[32:35], v[140:143]
ds_read_b64_tr_b16 v[102:103], v6 offset:26624
v_mfma_f32_16x16x32_bf16 v[144:147], v[48:51], v[36:39], v[144:147]
ds_read_b128 v[84:87], v2 offset:16640
ds_read_b64_tr_b16 v[104:105], v7 offset:24576
v_mfma_f32_16x16x32_bf16 v[148:151], v[52:55], v[36:39], v[148:151]
ds_read_b64_tr_b16 v[106:107], v7 offset:26624
v_mfma_f32_16x16x32_bf16 v[152:155], v[56:59], v[36:39], v[152:155]
ds_read_b64_tr_b16 v[108:109], v8 offset:24576
v_mfma_f32_16x16x32_bf16 v[156:159], v[60:63], v[36:39], v[156:159]
ds_read_b64_tr_b16 v[110:111], v8 offset:26624
v_mfma_f32_16x16x32_bf16 v[128:131], v[64:67], v[40:43], v[128:131]
ds_read_b128 v[88:91], v2 offset:24576
ds_read_b64_tr_b16 v[112:113], v5 offset:28672
v_mfma_f32_16x16x32_bf16 v[132:135], v[68:71], v[40:43], v[132:135]
ds_read_b64_tr_b16 v[114:115], v5 offset:30720
v_mfma_f32_16x16x32_bf16 v[136:139], v[72:75], v[40:43], v[136:139]
ds_read_b64_tr_b16 v[116:117], v6 offset:28672
v_mfma_f32_16x16x32_bf16 v[140:143], v[76:79], v[40:43], v[140:143]
ds_read_b64_tr_b16 v[118:119], v6 offset:30720
v_mfma_f32_16x16x32_bf16 v[144:147], v[64:67], v[44:47], v[144:147]
ds_read_b128 v[92:95], v2 offset:24832
ds_read_b64_tr_b16 v[120:121], v7 offset:28672
v_mfma_f32_16x16x32_bf16 v[148:151], v[68:71], v[44:47], v[148:151]
ds_read_b64_tr_b16 v[122:123], v7 offset:30720
v_mfma_f32_16x16x32_bf16 v[152:155], v[72:75], v[44:47], v[152:155]
ds_read_b64_tr_b16 v[124:125], v8 offset:28672
v_mfma_f32_16x16x32_bf16 v[156:159], v[76:79], v[44:47], v[156:159]
ds_read_b64_tr_b16 v[126:127], v8 offset:30720
s_waitcnt lgkmcnt(0)
s_barrier
v_mfma_f32_16x16x32_bf16 v[128:131], v[96:99], v[80:83], v[128:131]
ds_read_b128 v[32:35], v2 offset:32768
ds_read_b64_tr_b16 v[48:49], v5 offset:32768
v_mfma_f32_16x16x32_bf16 v[132:135], v[100:103], v[80:83], v[132:135]
ds_read_b64_tr_b16 v[50:51], v5 offset:34816
v_mfma_f32_16x16x32_bf16 v[136:139], v[104:107], v[80:83], v[136:139]
ds_read_b64_tr_b16 v[52:53], v6 offset:32768
v_mfma_f32_16x16x32_bf16 v[140:143], v[108:111], v[80:83], v[140:143]
ds_read_b64_tr_b16 v[54:55], v6 offset:34816
v_mfma_f32_16x16x32_bf16 v[144:147], v[96:99], v[84:87], v[144:147]
ds_read_b128 v[36:39], v2 offset:33024
ds_read_b64_tr_b16 v[56:57], v7 offset:32768
v_mfma_f32_16x16x32_bf16 v[148:151], v[100:103], v[84:87], v[148:151]
ds_read_b64_tr_b16 v[58:59], v7 offset:34816
v_mfma_f32_16x16x32_bf16 v[152:155], v[104:107], v[84:87], v[152:155]
ds_read_b64_tr_b16 v[60:61], v8 offset:32768
v_mfma_f32_16x16x32_bf16 v[156:159], v[108:111], v[84:87], v[156:159]
ds_read_b64_tr_b16 v[62:63], v8 offset:34816
v_mfma_f32_16x16x32_bf16 v[128:131], v[112:115], v[88:91], v[128:131]
ds_read_b128 v[40:43], v2 offset:40960
ds_read_b64_tr_b16 v[64:65], v5 offset:36864
v_mfma_f32_16x16x32_bf16 v[132:135], v[116:119], v[88:91], v[132:135]
ds_read_b64_tr_b16 v[66:67], v5 offset:38912
v_mfma_f32_16x16x32_bf16 v[136:139], v[120:123], v[88:91], v[136:139]
ds_read_b64_tr_b16 v[68:69], v6 offset:36864
v_mfma_f32_16x16x32_bf16 v[140:143], v[124:127], v[88:91], v[140:143]
ds_read_b64_tr_b16 v[70:71], v6 offset:38912
v_mfma_f32_16x16x32_bf16 v[144:147], v[112:115], v[92:95], v[144:147]
ds_read_b128 v[44:47], v2 offset:41216
ds_read_b64_tr_b16 v[72:73], v7 offset:36864
v_mfma_f32_16x16x32_bf16 v[148:151], v[116:119], v[92:95], v[148:151]
ds_read_b64_tr_b16 v[74:75], v7 offset:38912
v_mfma_f32_16x16x32_bf16 v[152:155], v[120:123], v[92:95], v[152:155]
ds_read_b64_tr_b16 v[76:77], v8 offset:36864
v_mfma_f32_16x16x32_bf16 v[156:159], v[124:127], v[92:95], v[156:159]
ds_read_b64_tr_b16 v[78:79], v8 offset:38912
s_waitcnt lgkmcnt(0)
s_barrier
v_mfma_f32_16x16x32_bf16 v[128:131], v[48:51], v[32:35], v[128:131]
ds_read_b128 v[80:83], v2 offset:49152
ds_read_b64_tr_b16 v[96:97], v5 offset:40960
v_mfma_f32_16x16x32_bf16 v[132:135], v[52:55], v[32:35], v[132:135]
ds_read_b64_tr_b16 v[98:99], v5 offset:43008
v_mfma_f32_16x16x32_bf16 v[136:139], v[56:59], v[32:35], v[136:139]
ds_read_b64_tr_b16 v[100:101], v6 offset:40960
v_mfma_f32_16x16x32_bf16 v[140:143], v[60:63], v[32:35], v[140:143]
ds_read_b64_tr_b16 v[102:103], v6 offset:43008
v_mfma_f32_16x16x32_bf16 v[144:147], v[48:51], v[36:39], v[144:147]
ds_read_b128 v[84:87], v2 offset:49408
ds_read_b64_tr_b16 v[104:105], v7 offset:40960
v_mfma_f32_16x16x32_bf16 v[148:151], v[52:55], v[36:39], v[148:151]
ds_read_b64_tr_b16 v[106:107], v7 offset:43008
v_mfma_f32_16x16x32_bf16 v[152:155], v[56:59], v[36:39], v[152:155]
ds_read_b64_tr_b16 v[108:109], v8 offset:40960
v_mfma_f32_16x16x32_bf16 v[156:159], v[60:63], v[36:39], v[156:159]
ds_read_b64_tr_b16 v[110:111], v8 offset:43008
v_mfma_f32_16x16x32_bf16 v[128:131], v[64:67], v[40:43], v[128:131]
ds_read_b128 v[88:91], v2 offset:57344
ds_read_b64_tr_b16 v[112:113], v5 offset:45056
v_mfma_f32_16x16x32_bf16 v[132:135], v[68:71], v[40:43], v[132:135]
ds_read_b64_tr_b16 v[114:115], v5 offset:47104
v_mfma_f32_16x16x32_bf16 v[136:139], v[72:75], v[40:43], v[136:139]
ds_read_b64_tr_b16 v[116:117], v6 offset:45056
v_mfma_f32_16x16x32_bf16 v[140:143], v[76:79], v[40:43], v[140:143]
ds_read_b64_tr_b16 v[118:119], v6 offset:47104
v_mfma_f32_16x16x32_bf16 v[144:147], v[64:67], v[44:47], v[144:147]
ds_read_b128 v[92:95], v2 offset:57600
ds_read_b64_tr_b16 v[120:121], v7 offset:45056
v_mfma_f32_16x16x32_bf16 v[148:151], v[68:71], v[44:47], v[148:151]
ds_read_b64_tr_b16 v[122:123], v7 offset:47104
v_mfma_f32_16x16x32_bf16 v[152:155], v[72:75], v[44:47], v[152:155]
ds_read_b64_tr_b16 v[124:125], v8 offset:45056
v_mfma_f32_16x16x32_bf16 v[156:159], v[76:79], v[44:47], v[156:159]
ds_read_b64_tr_b16 v[126:127], v8 offset:47104
s_waitcnt lgkmcnt(0)
s_barrier
v_mfma_f32_16x16x32_bf16 v[128:131], v[96:99], v[80:83], v[128:131]
v_mfma_f32_16x16x32_bf16 v[132:135], v[100:103], v[80:83], v[132:135]
v_mfma_f32_16x16x32_bf16 v[136:139], v[104:107], v[80:83], v[136:139]
v_mfma_f32_16x16x32_bf16 v[140:143], v[108:111], v[80:83], v[140:143]
v_mfma_f32_16x16x32_bf16 v[144:147], v[96:99], v[84:87], v[144:147]
v_mfma_f32_16x16x32_bf16 v[148:151], v[100:103], v[84:87], v[148:151]
v_mfma_f32_16x16x32_bf16 v[152:155], v[104:107], v[84:87], v[152:155]
v_mfma_f32_16x16x32_bf16 v[156:159], v[108:111], v[84:87], v[156:159]
v_mfma_f32_16x16x32_bf16 v[128:131], v[112:115], v[88:91], v[128:131]
v_mfma_f32_16x16x32_bf16 v[132:135], v[116:119], v[88:91], v[132:135]
v_mfma_f32_16x16x32_bf16 v[136:139], v[120:123], v[88:91], v[136:139]
v_mfma_f32_16x16x32_bf16 v[140:143], v[124:127], v[88:91], v[140:143]
v_mfma_f32_16x16x32_bf16 v[144:147], v[112:115], v[92:95], v[144:147]
v_mfma_f32_16x16x32_bf16 v[148:151], v[116:119], v[92:95], v[148:151]
v_mfma_f32_16x16x32_bf16 v[152:155], v[120:123], v[92:95], v[152:155]
v_mfma_f32_16x16x32_bf16 v[156:159], v[124:127], v[92:95], v[156:159]
s_nop 4
v_cvt_pk_bf16_f32 v96, v128, v129
v_cvt_pk_bf16_f32 v97, v130, v131
v_cvt_pk_bf16_f32 v98, v132, v133
v_cvt_pk_bf16_f32 v99, v134, v135
buffer_store_dwordx4 v[96:99], v2, s[20:23], 0 offen offset:0 sc1
ds_write_b128 v4, v[96:99] offset:0
v_cvt_pk_bf16_f32 v100, v136, v137
v_cvt_pk_bf16_f32 v101, v138, v139
v_cvt_pk_bf16_f32 v102, v140, v141
v_cvt_pk_bf16_f32 v103, v142, v143
buffer_store_dwordx4 v[100:103], v2, s[20:23], s50 offen offset:0 sc1
ds_write_b128 v4, v[100:103] offset:8192
v_cvt_pk_bf16_f32 v104, v144, v145
v_cvt_pk_bf16_f32 v105, v146, v147
v_cvt_pk_bf16_f32 v106, v148, v149
v_cvt_pk_bf16_f32 v107, v150, v151
buffer_store_dwordx4 v[104:107], v2, s[20:23], 0 offen offset:256 sc1
ds_write_b128 v4, v[104:107] offset:256
v_cvt_pk_bf16_f32 v108, v152, v153
v_cvt_pk_bf16_f32 v109, v154, v155
v_cvt_pk_bf16_f32 v110, v156, v157
v_cvt_pk_bf16_f32 v111, v158, v159
buffer_store_dwordx4 v[108:111], v2, s[20:23], s50 offen offset:256 sc1
ds_write_b128 v4, v[108:111] offset:8448
v_pk_mul_f32 v[118:119], v[128:129], v[128:129]
v_pk_mul_f32 v[122:123], v[144:145], v[144:145]
v_pk_fma_f32 v[118:119], v[130:131], v[130:131], v[118:119]
v_pk_add_f32 v[116:117], v[130:131], v[128:129]
v_pk_fma_f32 v[122:123], v[146:147], v[146:147], v[122:123]
v_pk_add_f32 v[120:121], v[146:147], v[144:145]
v_pk_fma_f32 v[118:119], v[132:133], v[132:133], v[118:119]
v_pk_add_f32 v[116:117], v[132:133], v[116:117]
v_pk_fma_f32 v[122:123], v[148:149], v[148:149], v[122:123]
v_pk_add_f32 v[120:121], v[148:149], v[120:121]
v_pk_fma_f32 v[118:119], v[134:135], v[134:135], v[118:119]
v_pk_add_f32 v[116:117], v[134:135], v[116:117]
v_pk_fma_f32 v[122:123], v[150:151], v[150:151], v[122:123]
v_pk_add_f32 v[120:121], v[150:151], v[120:121]
v_pk_fma_f32 v[118:119], v[136:137], v[136:137], v[118:119]
v_pk_add_f32 v[116:117], v[136:137], v[116:117]
v_pk_fma_f32 v[122:123], v[152:153], v[152:153], v[122:123]
v_pk_add_f32 v[120:121], v[152:153], v[120:121]
v_pk_fma_f32 v[118:119], v[138:139], v[138:139], v[118:119]
v_pk_add_f32 v[116:117], v[138:139], v[116:117]
v_pk_fma_f32 v[122:123], v[154:155], v[154:155], v[122:123]
v_pk_add_f32 v[120:121], v[154:155], v[120:121]
v_pk_fma_f32 v[118:119], v[140:141], v[140:141], v[118:119]
v_pk_add_f32 v[116:117], v[140:141], v[116:117]
v_pk_fma_f32 v[122:123], v[156:157], v[156:157], v[122:123]
v_pk_add_f32 v[120:121], v[156:157], v[120:121]
v_pk_fma_f32 v[118:119], v[142:143], v[142:143], v[118:119]
v_pk_add_f32 v[116:117], v[142:143], v[116:117]
v_pk_fma_f32 v[122:123], v[158:159], v[158:159], v[122:123]
v_pk_add_f32 v[120:121], v[158:159], v[120:121]
v_add_f32 v112, v116, v117
v_add_f32 v113, v118, v119
v_add_f32 v114, v120, v121
v_add_f32 v115, v122, v123
s_nop 1
v_permlane32_swap_b32 v112, v114
v_permlane32_swap_b32 v113, v115
v_add_f32 v112, v112, v114
v_add_f32 v113, v113, v115
s_nop 1
v_permlane16_swap_b32 v112, v113
v_add_f32 v112, v112, v113
buffer_store_dword v112, v22, s[24:27], 0 offen sc1
s_waitcnt lgkmcnt(0)
s_barrier
s_lshl_b32 s53, s47, 2
v_lshlrev_b32 v19, 11, v18
v_lshl_add_u32 v19, v17, 4, v19
s_lshl_b32 s43, s46, 10
v_add_u32 v2, s43, v19
v_add_u32 v3, 49152, v2
v_add_u32 v4, 98304, v2
v_lshrrev_b32 v19, 2, v17
v_lshl_add_u32 v20, v18, 2, v19
v_and_b32 v21, 7, v20
v_lshlrev_b32 v20, 8, v20
v_and_b32 v19, 3, v1
v_lshl_add_u32 v20, v19, 3, v20
s_add_u32 s43, s53, 0
v_xor_b32 v19, s43, v21
v_lshl_add_u32 v5, v19, 5, v20
s_add_u32 s43, s53, 1
v_xor_b32 v19, s43, v21
v_lshl_add_u32 v6, v19, 5, v20
s_add_u32 s43, s53, 2
v_xor_b32 v19, s43, v21
v_lshl_add_u32 v7, v19, 5, v20
s_add_u32 s43, s53, 3
v_xor_b32 v19, s43, v21
v_lshl_add_u32 v8, v19, 5, v20
v_add_u32 v9, 49152, v5
v_add_u32 v10, 49152, v6
v_add_u32 v11, 49152, v7
v_add_u32 v12, 49152, v8
v_add_u32 v13, 98304, v5
v_add_u32 v14, 98304, v6
v_add_u32 v15, 98304, v7
v_add_u32 v16, 98304, v8
ds_read_b128 v[32:35], v4 offset:0
ds_read_b64_tr_b16 v[48:49], v13 offset:16384
ds_read_b64_tr_b16 v[50:51], v13 offset:20480
ds_read_b128 v[36:39], v4 offset:256
ds_read_b128 v[40:43], v4 offset:512
ds_read_b128 v[44:47], v4 offset:768
ds_read_b64_tr_b16 v[64:65], v13 offset:32768
ds_read_b64_tr_b16 v[66:67], v13 offset:36864
ds_read_b64_tr_b16 v[52:53], v14 offset:16384
ds_read_b64_tr_b16 v[54:55], v14 offset:20480
ds_read_b64_tr_b16 v[68:69], v14 offset:32768
ds_read_b64_tr_b16 v[70:71], v14 offset:36864
ds_read_b64_tr_b16 v[56:57], v15 offset:16384
ds_read_b64_tr_b16 v[58:59], v15 offset:20480
ds_read_b64_tr_b16 v[72:73], v15 offset:32768
ds_read_b64_tr_b16 v[74:75], v15 offset:36864
ds_read_b64_tr_b16 v[60:61], v16 offset:16384
ds_read_b64_tr_b16 v[62:63], v16 offset:20480
ds_read_b64_tr_b16 v[76:77], v16 offset:32768
ds_read_b64_tr_b16 v[78:79], v16 offset:36864
s_waitcnt lgkmcnt(0)
v_mfma_f32_16x16x32_bf16 v[128:131], v[48:51], v[32:35], 0
ds_read_b128 v[80:83], v4 offset:8192
v_mfma_f32_16x16x32_bf16 v[132:135], v[48:51], v[36:39], 0
ds_read_b64_tr_b16 v[96:97], v13 offset:24576
v_mfma_f32_16x16x32_bf16 v[136:139], v[48:51], v[40:43], 0
ds_read_b64_tr_b16 v[98:99], v13 offset:28672
v_mfma_f32_16x16x32_bf16 v[140:143], v[48:51], v[44:47], 0
ds_read_b128 v[84:87], v4 offset:8448
v_mfma_f32_16x16x32_bf16 v[204:207], v[64:67], v[44:47], 0
ds_read_b128 v[88:91], v4 offset:8704
v_mfma_f32_16x16x32_bf16 v[200:203], v[64:67], v[40:43], 0
ds_read_b128 v[92:95], v4 offset:8960
v_mfma_f32_16x16x32_bf16 v[196:199], v[64:67], v[36:39], 0
ds_read_b64_tr_b16 v[112:113], v13 offset:40960
v_mfma_f32_16x16x32_bf16 v[192:195], v[64:67], v[32:35], 0
ds_read_b64_tr_b16 v[114:115], v13 offset:45056
v_mfma_f32_16x16x32_bf16 v[144:147], v[52:55], v[32:35], 0
ds_read_b64_tr_b16 v[100:101], v14 offset:24576
v_mfma_f32_16x16x32_bf16 v[148:151], v[52:55], v[36:39], 0
ds_read_b64_tr_b16 v[102:103], v14 offset:28672
v_mfma_f32_16x16x32_bf16 v[152:155], v[52:55], v[40:43], 0
ds_read_b64_tr_b16 v[116:117], v14 offset:40960
v_mfma_f32_16x16x32_bf16 v[156:159], v[52:55], v[44:47], 0
ds_read_b64_tr_b16 v[118:119], v14 offset:45056
v_mfma_f32_16x16x32_bf16 v[220:223], v[68:71], v[44:47], 0
ds_read_b64_tr_b16 v[104:105], v15 offset:24576
v_mfma_f32_16x16x32_bf16 v[216:219], v[68:71], v[40:43], 0
ds_read_b64_tr_b16 v[106:107], v15 offset:28672
v_mfma_f32_16x16x32_bf16 v[212:215], v[68:71], v[36:39], 0
ds_read_b64_tr_b16 v[120:121], v15 offset:40960
v_mfma_f32_16x16x32_bf16 v[208:211], v[68:71], v[32:35], 0
ds_read_b64_tr_b16 v[122:123], v15 offset:45056
v_mfma_f32_16x16x32_bf16 v[160:163], v[56:59], v[32:35], 0
ds_read_b64_tr_b16 v[108:109], v16 offset:24576
v_mfma_f32_16x16x32_bf16 v[164:167], v[56:59], v[36:39], 0
ds_read_b64_tr_b16 v[110:111], v16 offset:28672
v_mfma_f32_16x16x32_bf16 v[168:171], v[56:59], v[40:43], 0
ds_read_b64_tr_b16 v[124:125], v16 offset:40960
v_mfma_f32_16x16x32_bf16 v[172:175], v[56:59], v[44:47], 0
ds_read_b64_tr_b16 v[126:127], v16 offset:45056
v_mfma_f32_16x16x32_bf16 v[236:239], v[72:75], v[44:47], 0
v_mfma_f32_16x16x32_bf16 v[232:235], v[72:75], v[40:43], 0
v_mfma_f32_16x16x32_bf16 v[228:231], v[72:75], v[36:39], 0
v_mfma_f32_16x16x32_bf16 v[224:227], v[72:75], v[32:35], 0
v_mfma_f32_16x16x32_bf16 v[176:179], v[60:63], v[32:35], 0
v_mfma_f32_16x16x32_bf16 v[180:183], v[60:63], v[36:39], 0
v_mfma_f32_16x16x32_bf16 v[184:187], v[60:63], v[40:43], 0
v_mfma_f32_16x16x32_bf16 v[188:191], v[60:63], v[44:47], 0
v_mfma_f32_16x16x32_bf16 v[252:255], v[76:79], v[44:47], 0
v_mfma_f32_16x16x32_bf16 v[248:251], v[76:79], v[40:43], 0
v_mfma_f32_16x16x32_bf16 v[244:247], v[76:79], v[36:39], 0
v_mfma_f32_16x16x32_bf16 v[240:243], v[76:79], v[32:35], 0
s_waitcnt lgkmcnt(0)
v_mfma_f32_16x16x32_bf16 v[128:131], v[96:99], v[80:83], v[128:131]
v_mfma_f32_16x16x32_bf16 v[132:135], v[96:99], v[84:87], v[132:135]
v_mfma_f32_16x16x32_bf16 v[136:139], v[96:99], v[88:91], v[136:139]
v_mfma_f32_16x16x32_bf16 v[140:143], v[96:99], v[92:95], v[140:143]
v_mfma_f32_16x16x32_bf16 v[204:207], v[112:115], v[92:95], v[204:207]
v_mfma_f32_16x16x32_bf16 v[200:203], v[112:115], v[88:91], v[200:203]
v_mfma_f32_16x16x32_bf16 v[196:199], v[112:115], v[84:87], v[196:199]
v_mfma_f32_16x16x32_bf16 v[192:195], v[112:115], v[80:83], v[192:195]
v_mfma_f32_16x16x32_bf16 v[144:147], v[100:103], v[80:83], v[144:147]
v_mfma_f32_16x16x32_bf16 v[148:151], v[100:103], v[84:87], v[148:151]
v_mfma_f32_16x16x32_bf16 v[152:155], v[100:103], v[88:91], v[152:155]
v_mfma_f32_16x16x32_bf16 v[156:159], v[100:103], v[92:95], v[156:159]
v_mfma_f32_16x16x32_bf16 v[220:223], v[116:119], v[92:95], v[220:223]
v_mfma_f32_16x16x32_bf16 v[216:219], v[116:119], v[88:91], v[216:219]
v_mfma_f32_16x16x32_bf16 v[212:215], v[116:119], v[84:87], v[212:215]
v_mfma_f32_16x16x32_bf16 v[208:211], v[116:119], v[80:83], v[208:211]
v_mfma_f32_16x16x32_bf16 v[160:163], v[104:107], v[80:83], v[160:163]
v_mfma_f32_16x16x32_bf16 v[164:167], v[104:107], v[84:87], v[164:167]
v_mfma_f32_16x16x32_bf16 v[168:171], v[104:107], v[88:91], v[168:171]
v_mfma_f32_16x16x32_bf16 v[172:175], v[104:107], v[92:95], v[172:175]
v_mfma_f32_16x16x32_bf16 v[236:239], v[120:123], v[92:95], v[236:239]
v_mfma_f32_16x16x32_bf16 v[232:235], v[120:123], v[88:91], v[232:235]
v_mfma_f32_16x16x32_bf16 v[228:231], v[120:123], v[84:87], v[228:231]
v_mfma_f32_16x16x32_bf16 v[224:227], v[120:123], v[80:83], v[224:227]
v_mfma_f32_16x16x32_bf16 v[176:179], v[108:111], v[80:83], v[176:179]
v_mfma_f32_16x16x32_bf16 v[180:183], v[108:111], v[84:87], v[180:183]
v_mfma_f32_16x16x32_bf16 v[184:187], v[108:111], v[88:91], v[184:187]
v_mfma_f32_16x16x32_bf16 v[188:191], v[108:111], v[92:95], v[188:191]
v_mfma_f32_16x16x32_bf16 v[252:255], v[124:127], v[92:95], v[252:255]
v_mfma_f32_16x16x32_bf16 v[248:251], v[124:127], v[88:91], v[248:251]
v_mfma_f32_16x16x32_bf16 v[244:247], v[124:127], v[84:87], v[244:247]
v_mfma_f32_16x16x32_bf16 v[240:243], v[124:127], v[80:83], v[240:243]
s_mul_i32 s43, s49, 192
s_and_b32 s43, s43, 0xffffff80
s_add_u32 s43, s43, 4096
s_cmp_eq_u32 s51, 1
s_cselect_b32 s8, s4, s6
s_cselect_b32 s9, s5, s7
s_sub_u32 s10, 7340032, s43
s_lshl_b32 s44, s34, 18
s_add_u32 s44, s44, 4194304
s_movk_i32 s38, 28672
s_cmp_eq_u32 s51, 0
s_cselect_b32 s8, s32, s8
s_cselect_b32 s9, s33, s9
s_cselect_b32 s10, 262144, s10
s_cselect_b32 s43, s44, s43
s_cselect_b32 s38, 1024, s38
s_cselect_b32 s45, 0, -1
s_add_u32 s8, s8, s43
s_addc_u32 s9, s9, 0
s_mov_b32 s11, 0x20000
s_lshl_b32 s40, s38, 4
s_add_u32 s42, s35, 17
s_lshl_b32 s39, s51, 14
v_lshrrev_b32 v19, 4, v1
v_lshlrev_b32 v20, 5, v19
v_mul_u32_u24 v19, 6912, v19
v_and_b32 v19, s45, v19
v_and_b32 v20, s45, v20
v_lshlrev_b32 v21, 4, v1
v_xor_b32 v21, v21, v20
v_add_u32 v22, v21, v19
s_and_b32 s45, s45, 128
v_xor_b32 v23, s45, v22
s_mul_i32 s43, s34, 917504
s_mul_i32 s44, s35, 16384
s_add_u32 s43, s43, s44
s_add_u32 s43, s43, 8388608
s_add_u32 s24, s32, s43
s_addc_u32 s25, s33, 0
s_mov_b32 s26, 278528
s_mov_b32 s27, 0x20000
s_mov_b32 s53, 262144
s_lshl_b32 s43, s47, 13
s_lshl_b32 s44, s46, 10
s_add_u32 s43, s43, s44
v_lshlrev_b32 v19, 11, v18
v_lshl_add_u32 v19, v17, 4, v19
v_add_u32 v27, s43, v19
s_lshl_b32 s43, s34, 18
s_lshl_b32 s44, s35, 7
s_add_u32 s43, s43, s44
s_add_u32 s16, s62, s43
s_addc_u32 s17, s63, 0
s_mov_b32 s18, 260224
s_mov_b32 s19, 0x20000
s_lshl_b32 s43, s46, 6
v_lshl_add_u32 v19, v17, 1, s43
v_lshlrev_b32 v19, 11, v19
v_and_b32 v20, 1, v18
v_lshl_add_u32 v19, v20, 5, v19
v_lshrrev_b32 v20, 1, v18
v_lshl_add_u32 v19, v20, 4, v19
s_lshl_b32 s43, s47, 6
v_add_u32 v28, s43, v19
s_lshl_b32 s43, s34, 4
s_add_u32 s43, s43, s35
s_xor_b32 s43, s43, 0
s_lshl_b32 s43, s43, 15
s_add_u32 s43, s43, 33554432
s_add_u32 s64, s32, s43
s_addc_u32 s65, s33, 0
s_mov_b32 s66, 32768
s_mov_b32 s67, 0x20000
s_lshl_b32 s43, s34, 4
s_add_u32 s43, s43, s35
s_xor_b32 s43, s43, 1
s_lshl_b32 s43, s43, 15
s_add_u32 s43, s43, 33554432
s_add_u32 s68, s32, s43
s_addc_u32 s69, s33, 0
s_mov_b32 s70, 32768
s_mov_b32 s71, 0x20000
s_lshl_b32 s43, s34, 18
s_add_u32 s12, s32, s43
s_addc_u32 s13, s33, 0
s_add_u32 s12, s12, 4194304
s_addc_u32 s13, s13, 0
s_mov_b32 s14, 262144
s_mov_b32 s15, 0x20000
v_lshlrev_b32 v21, 4, v1
s_lshl_b32 s54, s36, 11
s_add_u32 s43, s35, 1
s_and_b32 s43, s43, 15
s_lshl_b32 s43, s43, 14
s_add_u32 s30, s43, s54
s_add_u32 s43, s35, 2
s_and_b32 s43, s43, 15
s_lshl_b32 s43, s43, 14
s_add_u32 s31, s43, s54
s_waitcnt vmcnt(0)
s_barrier
s_setprio 1
ds_read_b128 v[32:35], v2 offset:0
ds_read_b64_tr_b16 v[48:49], v5 offset:16384
ds_read_b64_tr_b16 v[50:51], v5 offset:20480
ds_read_b128 v[36:39], v2 offset:256
ds_read_b128 v[40:43], v2 offset:512
ds_read_b128 v[44:47], v2 offset:768
ds_read_b64_tr_b16 v[64:65], v5 offset:32768
ds_read_b64_tr_b16 v[66:67], v5 offset:36864
ds_read_b64_tr_b16 v[52:53], v6 offset:16384
ds_read_b64_tr_b16 v[54:55], v6 offset:20480
ds_read_b64_tr_b16 v[68:69], v6 offset:32768
ds_read_b64_tr_b16 v[70:71], v6 offset:36864
ds_read_b64_tr_b16 v[56:57], v7 offset:16384
ds_read_b64_tr_b16 v[58:59], v7 offset:20480
ds_read_b64_tr_b16 v[72:73], v7 offset:32768
ds_read_b64_tr_b16 v[74:75], v7 offset:36864
ds_read_b64_tr_b16 v[60:61], v8 offset:16384
ds_read_b64_tr_b16 v[62:63], v8 offset:20480
ds_read_b64_tr_b16 v[76:77], v8 offset:32768
ds_read_b64_tr_b16 v[78:79], v8 offset:36864
s_waitcnt lgkmcnt(14)
v_max3_u32 v19, v32, v33, v34
v_max3_u32 v19, v19, v35, v36
v_max3_u32 v19, v19, v37, v38
v_max3_u32 v19, v19, v39, v40
v_max3_u32 v19, v19, v41, v42
v_max3_u32 v19, v19, v43, v44
v_max3_u32 v19, v19, v45, v46
v_max_u32 v19, v19, v47
v_cmp_eq_u32 vcc, -1, v19
s_nop 4
s_cbranch_vccz Lok_63
s_add_u32 s44, s35, 1
s_and_b32 s44, s44, 15
s_lshl_b32 s44, s44, 14
s_add_u32 s44, s44, 0
s_mov_b32 s45, 0x20000
Lre_64:
buffer_load_dwordx4 v[32:35], v2, s[12:15], s44 offen offset:0 sc1
buffer_load_dwordx4 v[36:39], v2, s[12:15], s44 offen offset:256 sc1
buffer_load_dwordx4 v[40:43], v2, s[12:15], s44 offen offset:512 sc1
buffer_load_dwordx4 v[44:47], v2, s[12:15], s44 offen offset:768 sc1
s_waitcnt vmcnt(0)
v_max3_u32 v19, v32, v33, v34
v_max3_u32 v19, v19, v35, v36
v_max3_u32 v19, v19, v37, v38
v_max3_u32 v19, v19, v39, v40
v_max3_u32 v19, v19, v41, v42
v_max3_u32 v19, v19, v43, v44
v_max3_u32 v19, v19, v45, v46
v_max_u32 v19, v19, v47
v_cmp_eq_u32 vcc, -1, v19
s_sub_u32 s45, s45, 1
s_cmp_eq_u32 s45, 0
s_cbranch_scc1 Lok_63
s_nop 2
s_cbranch_vccnz Lre_64
Lok_63:
s_waitcnt lgkmcnt(0)
v_mfma_f32_16x16x32_bf16 v[128:131], v[48:51], v[32:35], v[128:131]
ds_read_b128 v[80:83], v2 offset:8192
v_mfma_f32_16x16x32_bf16 v[132:135], v[48:51], v[36:39], v[132:135]
ds_read_b64_tr_b16 v[96:97], v5 offset:24576
v_mfma_f32_16x16x32_bf16 v[136:139], v[48:51], v[40:43], v[136:139]
ds_read_b64_tr_b16 v[98:99], v5 offset:28672
v_mfma_f32_16x16x32_bf16 v[140:143], v[48:51], v[44:47], v[140:143]
ds_read_b128 v[84:87], v2 offset:8448
v_mfma_f32_16x16x32_bf16 v[204:207], v[64:67], v[44:47], v[204:207]
ds_read_b128 v[88:91], v2 offset:8704
v_mfma_f32_16x16x32_bf16 v[200:203], v[64:67], v[40:43], v[200:203]
ds_read_b128 v[92:95], v2 offset:8960
v_mfma_f32_16x16x32_bf16 v[196:199], v[64:67], v[36:39], v[196:199]
ds_read_b64_tr_b16 v[112:113], v5 offset:40960
v_mfma_f32_16x16x32_bf16 v[192:195], v[64:67], v[32:35], v[192:195]
ds_read_b64_tr_b16 v[114:115], v5 offset:45056
v_mfma_f32_16x16x32_bf16 v[144:147], v[52:55], v[32:35], v[144:147]
ds_read_b64_tr_b16 v[100:101], v6 offset:24576
v_mfma_f32_16x16x32_bf16 v[148:151], v[52:55], v[36:39], v[148:151]
ds_read_b64_tr_b16 v[102:103], v6 offset:28672
v_mfma_f32_16x16x32_bf16 v[152:155], v[52:55], v[40:43], v[152:155]
ds_read_b64_tr_b16 v[116:117], v6 offset:40960
v_mfma_f32_16x16x32_bf16 v[156:159], v[52:55], v[44:47], v[156:159]
ds_read_b64_tr_b16 v[118:119], v6 offset:45056
v_mfma_f32_16x16x32_bf16 v[220:223], v[68:71], v[44:47], v[220:223]
ds_read_b64_tr_b16 v[104:105], v7 offset:24576
v_mfma_f32_16x16x32_bf16 v[216:219], v[68:71], v[40:43], v[216:219]
ds_read_b64_tr_b16 v[106:107], v7 offset:28672
v_mfma_f32_16x16x32_bf16 v[212:215], v[68:71], v[36:39], v[212:215]
ds_read_b64_tr_b16 v[120:121], v7 offset:40960
v_mfma_f32_16x16x32_bf16 v[208:211], v[68:71], v[32:35], v[208:211]
ds_read_b64_tr_b16 v[122:123], v7 offset:45056
v_mfma_f32_16x16x32_bf16 v[160:163], v[56:59], v[32:35], v[160:163]
ds_read_b64_tr_b16 v[108:109], v8 offset:24576
v_mfma_f32_16x16x32_bf16 v[164:167], v[56:59], v[36:39], v[164:167]
ds_read_b64_tr_b16 v[110:111], v8 offset:28672
v_mfma_f32_16x16x32_bf16 v[168:171], v[56:59], v[40:43], v[168:171]
ds_read_b64_tr_b16 v[124:125], v8 offset:40960
v_mfma_f32_16x16x32_bf16 v[172:175], v[56:59], v[44:47], v[172:175]
ds_read_b64_tr_b16 v[126:127], v8 offset:45056
s_waitcnt lgkmcnt(14)
v_mfma_f32_16x16x32_bf16 v[236:239], v[72:75], v[44:47], v[236:239]
v_max3_u32 v19, v80, v81, v82
v_mfma_f32_16x16x32_bf16 v[232:235], v[72:75], v[40:43], v[232:235]
v_max3_u32 v19, v19, v83, v84
v_mfma_f32_16x16x32_bf16 v[228:231], v[72:75], v[36:39], v[228:231]
v_max3_u32 v19, v19, v85, v86
v_mfma_f32_16x16x32_bf16 v[224:227], v[72:75], v[32:35], v[224:227]
v_max3_u32 v19, v19, v87, v88
v_mfma_f32_16x16x32_bf16 v[176:179], v[60:63], v[32:35], v[176:179]
v_max3_u32 v19, v19, v89, v90
v_mfma_f32_16x16x32_bf16 v[180:183], v[60:63], v[36:39], v[180:183]
v_max3_u32 v19, v19, v91, v92
v_mfma_f32_16x16x32_bf16 v[184:187], v[60:63], v[40:43], v[184:187]
v_max3_u32 v19, v19, v93, v94
v_mfma_f32_16x16x32_bf16 v[188:191], v[60:63], v[44:47], v[188:191]
v_max_u32 v19, v19, v95
v_mfma_f32_16x16x32_bf16 v[252:255], v[76:79], v[44:47], v[252:255]
v_cmp_eq_u32 vcc, -1, v19
v_mfma_f32_16x16x32_bf16 v[248:251], v[76:79], v[40:43], v[248:251]
v_mfma_f32_16x16x32_bf16 v[244:247], v[76:79], v[36:39], v[244:247]
v_mfma_f32_16x16x32_bf16 v[240:243], v[76:79], v[32:35], v[240:243]
s_nop 1
s_cbranch_vccz Lok_65
s_add_u32 s44, s35, 1
s_and_b32 s44, s44, 15
s_lshl_b32 s44, s44, 14
s_add_u32 s44, s44, 8192
s_mov_b32 s45, 0x20000
Lre_66:
buffer_load_dwordx4 v[80:83], v2, s[12:15], s44 offen offset:0 sc1
buffer_load_dwordx4 v[84:87], v2, s[12:15], s44 offen offset:256 sc1
buffer_load_dwordx4 v[88:91], v2, s[12:15], s44 offen offset:512 sc1
buffer_load_dwordx4 v[92:95], v2, s[12:15], s44 offen offset:768 sc1
s_waitcnt vmcnt(0)
v_max3_u32 v19, v80, v81, v82
v_max3_u32 v19, v19, v83, v84
v_max3_u32 v19, v19, v85, v86
v_max3_u32 v19, v19, v87, v88
v_max3_u32 v19, v19, v89, v90
v_max3_u32 v19, v19, v91, v92
v_max3_u32 v19, v19, v93, v94
v_max_u32 v19, v19, v95
v_cmp_eq_u32 vcc, -1, v19
s_sub_u32 s45, s45, 1
s_cmp_eq_u32 s45, 0
s_cbranch_scc1 Lok_65
s_nop 2
s_cbranch_vccnz Lre_66
Lok_65:
s_waitcnt lgkmcnt(0)
s_barrier
v_mfma_f32_16x16x32_bf16 v[128:131], v[96:99], v[80:83], v[128:131]
ds_read_b128 v[32:35], v3 offset:0
v_mfma_f32_16x16x32_bf16 v[132:135], v[96:99], v[84:87], v[132:135]
ds_read_b64_tr_b16 v[48:49], v9 offset:16384
v_mfma_f32_16x16x32_bf16 v[136:139], v[96:99], v[88:91], v[136:139]
ds_read_b64_tr_b16 v[50:51], v9 offset:20480
v_mfma_f32_16x16x32_bf16 v[140:143], v[96:99], v[92:95], v[140:143]
ds_read_b128 v[36:39], v3 offset:256
v_mfma_f32_16x16x32_bf16 v[204:207], v[112:115], v[92:95], v[204:207]
ds_read_b128 v[40:43], v3 offset:512
v_mfma_f32_16x16x32_bf16 v[200:203], v[112:115], v[88:91], v[200:203]
ds_read_b128 v[44:47], v3 offset:768
v_mfma_f32_16x16x32_bf16 v[196:199], v[112:115], v[84:87], v[196:199]
ds_read_b64_tr_b16 v[64:65], v9 offset:32768
v_mfma_f32_16x16x32_bf16 v[192:195], v[112:115], v[80:83], v[192:195]
ds_read_b64_tr_b16 v[66:67], v9 offset:36864
v_mfma_f32_16x16x32_bf16 v[144:147], v[100:103], v[80:83], v[144:147]
ds_read_b64_tr_b16 v[52:53], v10 offset:16384
v_mfma_f32_16x16x32_bf16 v[148:151], v[100:103], v[84:87], v[148:151]
ds_read_b64_tr_b16 v[54:55], v10 offset:20480
v_mfma_f32_16x16x32_bf16 v[152:155], v[100:103], v[88:91], v[152:155]
ds_read_b64_tr_b16 v[68:69], v10 offset:32768
v_mfma_f32_16x16x32_bf16 v[156:159], v[100:103], v[92:95], v[156:159]
ds_read_b64_tr_b16 v[70:71], v10 offset:36864
v_mfma_f32_16x16x32_bf16 v[220:223], v[116:119], v[92:95], v[220:223]
ds_read_b64_tr_b16 v[56:57], v11 offset:16384
v_mfma_f32_16x16x32_bf16 v[216:219], v[116:119], v[88:91], v[216:219]
ds_read_b64_tr_b16 v[58:59], v11 offset:20480
v_mfma_f32_16x16x32_bf16 v[212:215], v[116:119], v[84:87], v[212:215]
ds_read_b64_tr_b16 v[72:73], v11 offset:32768
v_mfma_f32_16x16x32_bf16 v[208:211], v[116:119], v[80:83], v[208:211]
ds_read_b64_tr_b16 v[74:75], v11 offset:36864
v_mfma_f32_16x16x32_bf16 v[160:163], v[104:107], v[80:83], v[160:163]
ds_read_b64_tr_b16 v[60:61], v12 offset:16384
v_mfma_f32_16x16x32_bf16 v[164:167], v[104:107], v[84:87], v[164:167]
ds_read_b64_tr_b16 v[62:63], v12 offset:20480
v_mfma_f32_16x16x32_bf16 v[168:171], v[104:107], v[88:91], v[168:171]
ds_read_b64_tr_b16 v[76:77], v12 offset:32768
v_mfma_f32_16x16x32_bf16 v[172:175], v[104:107], v[92:95], v[172:175]
ds_read_b64_tr_b16 v[78:79], v12 offset:36864
s_waitcnt lgkmcnt(14)
v_mfma_f32_16x16x32_bf16 v[236:239], v[120:123], v[92:95], v[236:239]
v_max3_u32 v19, v32, v33, v34
v_mfma_f32_16x16x32_bf16 v[232:235], v[120:123], v[88:91], v[232:235]
v_max3_u32 v19, v19, v35, v36
v_mfma_f32_16x16x32_bf16 v[228:231], v[120:123], v[84:87], v[228:231]
v_max3_u32 v19, v19, v37, v38
v_mfma_f32_16x16x32_bf16 v[224:227], v[120:123], v[80:83], v[224:227]
v_max3_u32 v19, v19, v39, v40
v_mfma_f32_16x16x32_bf16 v[176:179], v[108:111], v[80:83], v[176:179]
v_max3_u32 v19, v19, v41, v42
v_mfma_f32_16x16x32_bf16 v[180:183], v[108:111], v[84:87], v[180:183]
v_max3_u32 v19, v19, v43, v44
v_mfma_f32_16x16x32_bf16 v[184:187], v[108:111], v[88:91], v[184:187]
v_max3_u32 v19, v19, v45, v46
v_mfma_f32_16x16x32_bf16 v[188:191], v[108:111], v[92:95], v[188:191]
v_max_u32 v19, v19, v47
v_mfma_f32_16x16x32_bf16 v[252:255], v[124:127], v[92:95], v[252:255]
v_cmp_eq_u32 vcc, -1, v19
v_mfma_f32_16x16x32_bf16 v[248:251], v[124:127], v[88:91], v[248:251]
v_mfma_f32_16x16x32_bf16 v[244:247], v[124:127], v[84:87], v[244:247]
v_mfma_f32_16x16x32_bf16 v[240:243], v[124:127], v[80:83], v[240:243]
s_nop 1
s_cbranch_vccz Lok_67
s_add_u32 s44, s35, 2
s_and_b32 s44, s44, 15
s_lshl_b32 s44, s44, 14
s_add_u32 s44, s44, 0
s_mov_b32 s45, 0x20000
Lre_68:
buffer_load_dwordx4 v[32:35], v2, s[12:15], s44 offen offset:0 sc1
buffer_load_dwordx4 v[36:39], v2, s[12:15], s44 offen offset:256 sc1
buffer_load_dwordx4 v[40:43], v2, s[12:15], s44 offen offset:512 sc1
buffer_load_dwordx4 v[44:47], v2, s[12:15], s44 offen offset:768 sc1
s_waitcnt vmcnt(0)
v_max3_u32 v19, v32, v33, v34
v_max3_u32 v19, v19, v35, v36
v_max3_u32 v19, v19, v37, v38
v_max3_u32 v19, v19, v39, v40
v_max3_u32 v19, v19, v41, v42
v_max3_u32 v19, v19, v43, v44
v_max3_u32 v19, v19, v45, v46
v_max_u32 v19, v19, v47
v_cmp_eq_u32 vcc, -1, v19
s_sub_u32 s45, s45, 1
s_cmp_eq_u32 s45, 0
s_cbranch_scc1 Lok_67
s_nop 2
s_cbranch_vccnz Lre_68
Lok_67:
s_waitcnt lgkmcnt(0)
v_mfma_f32_16x16x32_bf16 v[128:131], v[48:51], v[32:35], v[128:131]
ds_read_b128 v[80:83], v3 offset:8192
v_mfma_f32_16x16x32_bf16 v[132:135], v[48:51], v[36:39], v[132:135]
ds_read_b64_tr_b16 v[96:97], v9 offset:24576
v_mfma_f32_16x16x32_bf16 v[136:139], v[48:51], v[40:43], v[136:139]
ds_read_b64_tr_b16 v[98:99], v9 offset:28672
v_mfma_f32_16x16x32_bf16 v[140:143], v[48:51], v[44:47], v[140:143]
ds_read_b128 v[84:87], v3 offset:8448
v_mfma_f32_16x16x32_bf16 v[204:207], v[64:67], v[44:47], v[204:207]
ds_read_b128 v[88:91], v3 offset:8704
v_mfma_f32_16x16x32_bf16 v[200:203], v[64:67], v[40:43], v[200:203]
ds_read_b128 v[92:95], v3 offset:8960
v_mfma_f32_16x16x32_bf16 v[196:199], v[64:67], v[36:39], v[196:199]
ds_read_b64_tr_b16 v[112:113], v9 offset:40960
v_mfma_f32_16x16x32_bf16 v[192:195], v[64:67], v[32:35], v[192:195]
ds_read_b64_tr_b16 v[114:115], v9 offset:45056
v_mfma_f32_16x16x32_bf16 v[144:147], v[52:55], v[32:35], v[144:147]
ds_read_b64_tr_b16 v[100:101], v10 offset:24576
v_mfma_f32_16x16x32_bf16 v[148:151], v[52:55], v[36:39], v[148:151]
ds_read_b64_tr_b16 v[102:103], v10 offset:28672
v_mfma_f32_16x16x32_bf16 v[152:155], v[52:55], v[40:43], v[152:155]
ds_read_b64_tr_b16 v[116:117], v10 offset:40960
v_mfma_f32_16x16x32_bf16 v[156:159], v[52:55], v[44:47], v[156:159]
ds_read_b64_tr_b16 v[118:119], v10 offset:45056
v_mfma_f32_16x16x32_bf16 v[220:223], v[68:71], v[44:47], v[220:223]
ds_read_b64_tr_b16 v[104:105], v11 offset:24576
v_mfma_f32_16x16x32_bf16 v[216:219], v[68:71], v[40:43], v[216:219]
ds_read_b64_tr_b16 v[106:107], v11 offset:28672
v_mfma_f32_16x16x32_bf16 v[212:215], v[68:71], v[36:39], v[212:215]
ds_read_b64_tr_b16 v[120:121], v11 offset:40960
v_mfma_f32_16x16x32_bf16 v[208:211], v[68:71], v[32:35], v[208:211]
ds_read_b64_tr_b16 v[122:123], v11 offset:45056
v_mfma_f32_16x16x32_bf16 v[160:163], v[56:59], v[32:35], v[160:163]
ds_read_b64_tr_b16 v[108:109], v12 offset:24576
v_mfma_f32_16x16x32_bf16 v[164:167], v[56:59], v[36:39], v[164:167]
ds_read_b64_tr_b16 v[110:111], v12 offset:28672
v_mfma_f32_16x16x32_bf16 v[168:171], v[56:59], v[40:43], v[168:171]
ds_read_b64_tr_b16 v[124:125], v12 offset:40960
v_mfma_f32_16x16x32_bf16 v[172:175], v[56:59], v[44:47], v[172:175]
ds_read_b64_tr_b16 v[126:127], v12 offset:45056
s_waitcnt lgkmcnt(14)
v_mfma_f32_16x16x32_bf16 v[236:239], v[72:75], v[44:47], v[236:239]
v_max3_u32 v19, v80, v81, v82
v_mfma_f32_16x16x32_bf16 v[232:235], v[72:75], v[40:43], v[232:235]
v_max3_u32 v19, v19, v83, v84
v_mfma_f32_16x16x32_bf16 v[228:231], v[72:75], v[36:39], v[228:231]
v_max3_u32 v19, v19, v85, v86
v_mfma_f32_16x16x32_bf16 v[224:227], v[72:75], v[32:35], v[224:227]
v_max3_u32 v19, v19, v87, v88
v_mfma_f32_16x16x32_bf16 v[176:179], v[60:63], v[32:35], v[176:179]
v_max3_u32 v19, v19, v89, v90
v_mfma_f32_16x16x32_bf16 v[180:183], v[60:63], v[36:39], v[180:183]
v_max3_u32 v19, v19, v91, v92
v_mfma_f32_16x16x32_bf16 v[184:187], v[60:63], v[40:43], v[184:187]
v_max3_u32 v19, v19, v93, v94
v_mfma_f32_16x16x32_bf16 v[188:191], v[60:63], v[44:47], v[188:191]
v_max_u32 v19, v19, v95
v_mfma_f32_16x16x32_bf16 v[252:255], v[76:79], v[44:47], v[252:255]
v_cmp_eq_u32 vcc, -1, v19
v_mfma_f32_16x16x32_bf16 v[248:251], v[76:79], v[40:43], v[248:251]
v_mfma_f32_16x16x32_bf16 v[244:247], v[76:79], v[36:39], v[244:247]
v_mfma_f32_16x16x32_bf16 v[240:243], v[76:79], v[32:35], v[240:243]
s_nop 1
s_cbranch_vccz Lok_69
s_add_u32 s44, s35, 2
s_and_b32 s44, s44, 15
s_lshl_b32 s44, s44, 14
s_add_u32 s44, s44, 8192
s_mov_b32 s45, 0x20000
Lre_70:
buffer_load_dwordx4 v[80:83], v2, s[12:15], s44 offen offset:0 sc1
buffer_load_dwordx4 v[84:87], v2, s[12:15], s44 offen offset:256 sc1
buffer_load_dwordx4 v[88:91], v2, s[12:15], s44 offen offset:512 sc1
buffer_load_dwordx4 v[92:95], v2, s[12:15], s44 offen offset:768 sc1
s_waitcnt vmcnt(0)
v_max3_u32 v19, v80, v81, v82
v_max3_u32 v19, v19, v83, v84
v_max3_u32 v19, v19, v85, v86
v_max3_u32 v19, v19, v87, v88
v_max3_u32 v19, v19, v89, v90
v_max3_u32 v19, v19, v91, v92
v_max3_u32 v19, v19, v93, v94
v_max_u32 v19, v19, v95
v_cmp_eq_u32 vcc, -1, v19
s_sub_u32 s45, s45, 1
s_cmp_eq_u32 s45, 0
s_cbranch_scc1 Lok_69
s_nop 2
s_cbranch_vccnz Lre_70
Lok_69:
s_waitcnt lgkmcnt(0)
s_barrier
v_mfma_f32_16x16x32_bf16 v[128:131], v[96:99], v[80:83], v[128:131]
ds_read_b128 v[32:35], v4 offset:0
v_mfma_f32_16x16x32_bf16 v[132:135], v[96:99], v[84:87], v[132:135]
ds_read_b64_tr_b16 v[48:49], v13 offset:16384
v_mfma_f32_16x16x32_bf16 v[136:139], v[96:99], v[88:91], v[136:139]
ds_read_b64_tr_b16 v[50:51], v13 offset:20480
v_mfma_f32_16x16x32_bf16 v[140:143], v[96:99], v[92:95], v[140:143]
ds_read_b128 v[36:39], v4 offset:256
v_mfma_f32_16x16x32_bf16 v[204:207], v[112:115], v[92:95], v[204:207]
ds_read_b128 v[40:43], v4 offset:512
v_mfma_f32_16x16x32_bf16 v[200:203], v[112:115], v[88:91], v[200:203]
ds_read_b128 v[44:47], v4 offset:768
v_mfma_f32_16x16x32_bf16 v[196:199], v[112:115], v[84:87], v[196:199]
ds_read_b64_tr_b16 v[64:65], v13 offset:32768
v_mfma_f32_16x16x32_bf16 v[192:195], v[112:115], v[80:83], v[192:195]
ds_read_b64_tr_b16 v[66:67], v13 offset:36864
v_mfma_f32_16x16x32_bf16 v[144:147], v[100:103], v[80:83], v[144:147]
ds_read_b64_tr_b16 v[52:53], v14 offset:16384
v_mfma_f32_16x16x32_bf16 v[148:151], v[100:103], v[84:87], v[148:151]
ds_read_b64_tr_b16 v[54:55], v14 offset:20480
v_mfma_f32_16x16x32_bf16 v[152:155], v[100:103], v[88:91], v[152:155]
ds_read_b64_tr_b16 v[68:69], v14 offset:32768
v_mfma_f32_16x16x32_bf16 v[156:159], v[100:103], v[92:95], v[156:159]
ds_read_b64_tr_b16 v[70:71], v14 offset:36864
v_mfma_f32_16x16x32_bf16 v[220:223], v[116:119], v[92:95], v[220:223]
ds_read_b64_tr_b16 v[56:57], v15 offset:16384
v_mfma_f32_16x16x32_bf16 v[216:219], v[116:119], v[88:91], v[216:219]
ds_read_b64_tr_b16 v[58:59], v15 offset:20480
v_mfma_f32_16x16x32_bf16 v[212:215], v[116:119], v[84:87], v[212:215]
ds_read_b64_tr_b16 v[72:73], v15 offset:32768
v_mfma_f32_16x16x32_bf16 v[208:211], v[116:119], v[80:83], v[208:211]
ds_read_b64_tr_b16 v[74:75], v15 offset:36864
v_mfma_f32_16x16x32_bf16 v[160:163], v[104:107], v[80:83], v[160:163]
ds_read_b64_tr_b16 v[60:61], v16 offset:16384
v_mfma_f32_16x16x32_bf16 v[164:167], v[104:107], v[84:87], v[164:167]
ds_read_b64_tr_b16 v[62:63], v16 offset:20480
v_mfma_f32_16x16x32_bf16 v[168:171], v[104:107], v[88:91], v[168:171]
ds_read_b64_tr_b16 v[76:77], v16 offset:32768
v_mfma_f32_16x16x32_bf16 v[172:175], v[104:107], v[92:95], v[172:175]
ds_read_b64_tr_b16 v[78:79], v16 offset:36864
s_waitcnt lgkmcnt(14)
v_mfma_f32_16x16x32_bf16 v[236:239], v[120:123], v[92:95], v[236:239]
v_max3_u32 v19, v32, v33, v34
v_mfma_f32_16x16x32_bf16 v[232:235], v[120:123], v[88:91], v[232:235]
v_max3_u32 v19, v19, v35, v36
v_mfma_f32_16x16x32_bf16 v[228:231], v[120:123], v[84:87], v[228:231]
v_max3_u32 v19, v19, v37, v38
v_mfma_f32_16x16x32_bf16 v[224:227], v[120:123], v[80:83], v[224:227]
v_max3_u32 v19, v19, v39, v40
v_mfma_f32_16x16x32_bf16 v[176:179], v[108:111], v[80:83], v[176:179]
v_max3_u32 v19, v19, v41, v42
v_mfma_f32_16x16x32_bf16 v[180:183], v[108:111], v[84:87], v[180:183]
v_max3_u32 v19, v19, v43, v44
v_mfma_f32_16x16x32_bf16 v[184:187], v[108:111], v[88:91], v[184:187]
v_max3_u32 v19, v19, v45, v46
v_mfma_f32_16x16x32_bf16 v[188:191], v[108:111], v[92:95], v[188:191]
v_max_u32 v19, v19, v47
v_mfma_f32_16x16x32_bf16 v[252:255], v[124:127], v[92:95], v[252:255]
v_cmp_eq_u32 vcc, -1, v19
v_mfma_f32_16x16x32_bf16 v[248:251], v[124:127], v[88:91], v[248:251]
v_mfma_f32_16x16x32_bf16 v[244:247], v[124:127], v[84:87], v[244:247]
v_mfma_f32_16x16x32_bf16 v[240:243], v[124:127], v[80:83], v[240:243]
s_nop 1
s_cbranch_vccz Lok_71
s_add_u32 s44, s35, 3
s_and_b32 s44, s44, 15
s_lshl_b32 s44, s44, 14
s_add_u32 s44, s44, 0
s_mov_b32 s45, 0x20000
Lre_72:
buffer_load_dwordx4 v[32:35], v2, s[12:15], s44 offen offset:0 sc1
buffer_load_dwordx4 v[36:39], v2, s[12:15], s44 offen offset:256 sc1
buffer_load_dwordx4 v[40:43], v2, s[12:15], s44 offen offset:512 sc1
buffer_load_dwordx4 v[44:47], v2, s[12:15], s44 offen offset:768 sc1
s_waitcnt vmcnt(0)
v_max3_u32 v19, v32, v33, v34
v_max3_u32 v19, v19, v35, v36
v_max3_u32 v19, v19, v37, v38
v_max3_u32 v19, v19, v39, v40
v_max3_u32 v19, v19, v41, v42
v_max3_u32 v19, v19, v43, v44
v_max3_u32 v19, v19, v45, v46
v_max_u32 v19, v19, v47
v_cmp_eq_u32 vcc, -1, v19
s_sub_u32 s45, s45, 1
s_cmp_eq_u32 s45, 0
s_cbranch_scc1 Lok_71
s_nop 2
s_cbranch_vccnz Lre_72
Lok_71:
s_waitcnt lgkmcnt(0)
v_mfma_f32_16x16x32_bf16 v[128:131], v[48:51], v[32:35], v[128:131]
ds_read_b128 v[80:83], v4 offset:8192
v_mfma_f32_16x16x32_bf16 v[132:135], v[48:51], v[36:39], v[132:135]
ds_read_b64_tr_b16 v[96:97], v13 offset:24576
v_mfma_f32_16x16x32_bf16 v[136:139], v[48:51], v[40:43], v[136:139]
ds_read_b64_tr_b16 v[98:99], v13 offset:28672
v_mfma_f32_16x16x32_bf16 v[140:143], v[48:51], v[44:47], v[140:143]
ds_read_b128 v[84:87], v4 offset:8448
v_mfma_f32_16x16x32_bf16 v[204:207], v[64:67], v[44:47], v[204:207]
ds_read_b128 v[88:91], v4 offset:8704
v_mfma_f32_16x16x32_bf16 v[200:203], v[64:67], v[40:43], v[200:203]
ds_read_b128 v[92:95], v4 offset:8960
v_mfma_f32_16x16x32_bf16 v[196:199], v[64:67], v[36:39], v[196:199]
ds_read_b64_tr_b16 v[112:113], v13 offset:40960
v_mfma_f32_16x16x32_bf16 v[192:195], v[64:67], v[32:35], v[192:195]
ds_read_b64_tr_b16 v[114:115], v13 offset:45056
v_mfma_f32_16x16x32_bf16 v[144:147], v[52:55], v[32:35], v[144:147]
ds_read_b64_tr_b16 v[100:101], v14 offset:24576
v_mfma_f32_16x16x32_bf16 v[148:151], v[52:55], v[36:39], v[148:151]
ds_read_b64_tr_b16 v[102:103], v14 offset:28672
v_mfma_f32_16x16x32_bf16 v[152:155], v[52:55], v[40:43], v[152:155]
ds_read_b64_tr_b16 v[116:117], v14 offset:40960
v_mfma_f32_16x16x32_bf16 v[156:159], v[52:55], v[44:47], v[156:159]
ds_read_b64_tr_b16 v[118:119], v14 offset:45056
v_mfma_f32_16x16x32_bf16 v[220:223], v[68:71], v[44:47], v[220:223]
ds_read_b64_tr_b16 v[104:105], v15 offset:24576
v_mfma_f32_16x16x32_bf16 v[216:219], v[68:71], v[40:43], v[216:219]
ds_read_b64_tr_b16 v[106:107], v15 offset:28672
v_mfma_f32_16x16x32_bf16 v[212:215], v[68:71], v[36:39], v[212:215]
ds_read_b64_tr_b16 v[120:121], v15 offset:40960
v_mfma_f32_16x16x32_bf16 v[208:211], v[68:71], v[32:35], v[208:211]
ds_read_b64_tr_b16 v[122:123], v15 offset:45056
v_mfma_f32_16x16x32_bf16 v[160:163], v[56:59], v[32:35], v[160:163]
ds_read_b64_tr_b16 v[108:109], v16 offset:24576
v_mfma_f32_16x16x32_bf16 v[164:167], v[56:59], v[36:39], v[164:167]
ds_read_b64_tr_b16 v[110:111], v16 offset:28672
v_mfma_f32_16x16x32_bf16 v[168:171], v[56:59], v[40:43], v[168:171]
ds_read_b64_tr_b16 v[124:125], v16 offset:40960
v_mfma_f32_16x16x32_bf16 v[172:175], v[56:59], v[44:47], v[172:175]
ds_read_b64_tr_b16 v[126:127], v16 offset:45056
s_waitcnt lgkmcnt(14)
v_mfma_f32_16x16x32_bf16 v[236:239], v[72:75], v[44:47], v[236:239]
v_max3_u32 v19, v80, v81, v82
v_mfma_f32_16x16x32_bf16 v[232:235], v[72:75], v[40:43], v[232:235]
v_max3_u32 v19, v19, v83, v84
v_mfma_f32_16x16x32_bf16 v[228:231], v[72:75], v[36:39], v[228:231]
v_max3_u32 v19, v19, v85, v86
v_mfma_f32_16x16x32_bf16 v[224:227], v[72:75], v[32:35], v[224:227]
v_max3_u32 v19, v19, v87, v88
v_mfma_f32_16x16x32_bf16 v[176:179], v[60:63], v[32:35], v[176:179]
v_max3_u32 v19, v19, v89, v90
v_mfma_f32_16x16x32_bf16 v[180:183], v[60:63], v[36:39], v[180:183]
v_max3_u32 v19, v19, v91, v92
v_mfma_f32_16x16x32_bf16 v[184:187], v[60:63], v[40:43], v[184:187]
v_max3_u32 v19, v19, v93, v94
v_mfma_f32_16x16x32_bf16 v[188:191], v[60:63], v[44:47], v[188:191]
v_max_u32 v19, v19, v95
v_mfma_f32_16x16x32_bf16 v[252:255], v[76:79], v[44:47], v[252:255]
v_cmp_eq_u32 vcc, -1, v19
v_mfma_f32_16x16x32_bf16 v[248:251], v[76:79], v[40:43], v[248:251]
v_mfma_f32_16x16x32_bf16 v[244:247], v[76:79], v[36:39], v[244:247]
v_mfma_f32_16x16x32_bf16 v[240:243], v[76:79], v[32:35], v[240:243]
s_nop 1
s_cbranch_vccz Lok_73
s_add_u32 s44, s35, 3
s_and_b32 s44, s44, 15
s_lshl_b32 s44, s44, 14
s_add_u32 s44, s44, 8192
s_mov_b32 s45, 0x20000
Lre_74:
buffer_load_dwordx4 v[80:83], v2, s[12:15], s44 offen offset:0 sc1
buffer_load_dwordx4 v[84:87], v2, s[12:15], s44 offen offset:256 sc1
buffer_load_dwordx4 v[88:91], v2, s[12:15], s44 offen offset:512 sc1
buffer_load_dwordx4 v[92:95], v2, s[12:15], s44 offen offset:768 sc1
s_waitcnt vmcnt(0)
v_max3_u32 v19, v80, v81, v82
v_max3_u32 v19, v19, v83, v84
v_max3_u32 v19, v19, v85, v86
v_max3_u32 v19, v19, v87, v88
v_max3_u32 v19, v19, v89, v90
v_max3_u32 v19, v19, v91, v92
v_max3_u32 v19, v19, v93, v94
v_max_u32 v19, v19, v95
v_cmp_eq_u32 vcc, -1, v19
s_sub_u32 s45, s45, 1
s_cmp_eq_u32 s45, 0
s_cbranch_scc1 Lok_73
s_nop 2
s_cbranch_vccnz Lre_74
Lok_73:
s_waitcnt lgkmcnt(0)
s_barrier
v_mfma_f32_16x16x32_bf16 v[128:131], v[96:99], v[80:83], v[128:131]
ds_read_b128 v[32:35], v2 offset:0
v_mfma_f32_16x16x32_bf16 v[132:135], v[96:99], v[84:87], v[132:135]
ds_read_b64_tr_b16 v[48:49], v5 offset:16384
v_mfma_f32_16x16x32_bf16 v[136:139], v[96:99], v[88:91], v[136:139]
ds_read_b64_tr_b16 v[50:51], v5 offset:20480
v_mfma_f32_16x16x32_bf16 v[140:143], v[96:99], v[92:95], v[140:143]
ds_read_b128 v[36:39], v2 offset:256
v_mfma_f32_16x16x32_bf16 v[204:207], v[112:115], v[92:95], v[204:207]
ds_read_b128 v[40:43], v2 offset:512
v_mfma_f32_16x16x32_bf16 v[200:203], v[112:115], v[88:91], v[200:203]
ds_read_b128 v[44:47], v2 offset:768
v_mfma_f32_16x16x32_bf16 v[196:199], v[112:115], v[84:87], v[196:199]
ds_read_b64_tr_b16 v[64:65], v5 offset:32768
v_mfma_f32_16x16x32_bf16 v[192:195], v[112:115], v[80:83], v[192:195]
ds_read_b64_tr_b16 v[66:67], v5 offset:36864
v_mfma_f32_16x16x32_bf16 v[144:147], v[100:103], v[80:83], v[144:147]
ds_read_b64_tr_b16 v[52:53], v6 offset:16384
v_mfma_f32_16x16x32_bf16 v[148:151], v[100:103], v[84:87], v[148:151]
ds_read_b64_tr_b16 v[54:55], v6 offset:20480
v_mfma_f32_16x16x32_bf16 v[152:155], v[100:103], v[88:91], v[152:155]
ds_read_b64_tr_b16 v[68:69], v6 offset:32768
v_mfma_f32_16x16x32_bf16 v[156:159], v[100:103], v[92:95], v[156:159]
ds_read_b64_tr_b16 v[70:71], v6 offset:36864
v_mfma_f32_16x16x32_bf16 v[220:223], v[116:119], v[92:95], v[220:223]
ds_read_b64_tr_b16 v[56:57], v7 offset:16384
v_mfma_f32_16x16x32_bf16 v[216:219], v[116:119], v[88:91], v[216:219]
ds_read_b64_tr_b16 v[58:59], v7 offset:20480
v_mfma_f32_16x16x32_bf16 v[212:215], v[116:119], v[84:87], v[212:215]
ds_read_b64_tr_b16 v[72:73], v7 offset:32768
v_mfma_f32_16x16x32_bf16 v[208:211], v[116:119], v[80:83], v[208:211]
ds_read_b64_tr_b16 v[74:75], v7 offset:36864
v_mfma_f32_16x16x32_bf16 v[160:163], v[104:107], v[80:83], v[160:163]
ds_read_b64_tr_b16 v[60:61], v8 offset:16384
v_mfma_f32_16x16x32_bf16 v[164:167], v[104:107], v[84:87], v[164:167]
ds_read_b64_tr_b16 v[62:63], v8 offset:20480
v_mfma_f32_16x16x32_bf16 v[168:171], v[104:107], v[88:91], v[168:171]
ds_read_b64_tr_b16 v[76:77], v8 offset:32768
v_mfma_f32_16x16x32_bf16 v[172:175], v[104:107], v[92:95], v[172:175]
ds_read_b64_tr_b16 v[78:79], v8 offset:36864
s_waitcnt lgkmcnt(14)
v_mfma_f32_16x16x32_bf16 v[236:239], v[120:123], v[92:95], v[236:239]
v_max3_u32 v19, v32, v33, v34
v_mfma_f32_16x16x32_bf16 v[232:235], v[120:123], v[88:91], v[232:235]
v_max3_u32 v19, v19, v35, v36
v_mfma_f32_16x16x32_bf16 v[228:231], v[120:123], v[84:87], v[228:231]
v_max3_u32 v19, v19, v37, v38
v_mfma_f32_16x16x32_bf16 v[224:227], v[120:123], v[80:83], v[224:227]
v_max3_u32 v19, v19, v39, v40
v_mfma_f32_16x16x32_bf16 v[176:179], v[108:111], v[80:83], v[176:179]
v_max3_u32 v19, v19, v41, v42
v_mfma_f32_16x16x32_bf16 v[180:183], v[108:111], v[84:87], v[180:183]
v_max3_u32 v19, v19, v43, v44
v_mfma_f32_16x16x32_bf16 v[184:187], v[108:111], v[88:91], v[184:187]
v_max3_u32 v19, v19, v45, v46
v_mfma_f32_16x16x32_bf16 v[188:191], v[108:111], v[92:95], v[188:191]
v_max_u32 v19, v19, v47
v_mfma_f32_16x16x32_bf16 v[252:255], v[124:127], v[92:95], v[252:255]
v_cmp_eq_u32 vcc, -1, v19
v_mfma_f32_16x16x32_bf16 v[248:251], v[124:127], v[88:91], v[248:251]
v_mfma_f32_16x16x32_bf16 v[244:247], v[124:127], v[84:87], v[244:247]
v_mfma_f32_16x16x32_bf16 v[240:243], v[124:127], v[80:83], v[240:243]
s_nop 1
s_cbranch_vccz Lok_75
s_add_u32 s44, s35, 4
s_and_b32 s44, s44, 15
s_lshl_b32 s44, s44, 14
s_add_u32 s44, s44, 0
s_mov_b32 s45, 0x20000
Lre_76:
buffer_load_dwordx4 v[32:35], v2, s[12:15], s44 offen offset:0 sc1
buffer_load_dwordx4 v[36:39], v2, s[12:15], s44 offen offset:256 sc1
buffer_load_dwordx4 v[40:43], v2, s[12:15], s44 offen offset:512 sc1
buffer_load_dwordx4 v[44:47], v2, s[12:15], s44 offen offset:768 sc1
s_waitcnt vmcnt(0)
v_max3_u32 v19, v32, v33, v34
v_max3_u32 v19, v19, v35, v36
v_max3_u32 v19, v19, v37, v38
v_max3_u32 v19, v19, v39, v40
v_max3_u32 v19, v19, v41, v42
v_max3_u32 v19, v19, v43, v44
v_max3_u32 v19, v19, v45, v46
v_max_u32 v19, v19, v47
v_cmp_eq_u32 vcc, -1, v19
s_sub_u32 s45, s45, 1
s_cmp_eq_u32 s45, 0
s_cbranch_scc1 Lok_75
s_nop 2
s_cbranch_vccnz Lre_76
Lok_75:
s_waitcnt lgkmcnt(0)
v_mfma_f32_16x16x32_bf16 v[128:131], v[48:51], v[32:35], v[128:131]
ds_read_b128 v[80:83], v2 offset:8192
v_mfma_f32_16x16x32_bf16 v[132:135], v[48:51], v[36:39], v[132:135]
ds_read_b64_tr_b16 v[96:97], v5 offset:24576
v_mfma_f32_16x16x32_bf16 v[136:139], v[48:51], v[40:43], v[136:139]
ds_read_b64_tr_b16 v[98:99], v5 offset:28672
v_mfma_f32_16x16x32_bf16 v[140:143], v[48:51], v[44:47], v[140:143]
ds_read_b128 v[84:87], v2 offset:8448
v_mfma_f32_16x16x32_bf16 v[204:207], v[64:67], v[44:47], v[204:207]
ds_read_b128 v[88:91], v2 offset:8704
v_mfma_f32_16x16x32_bf16 v[200:203], v[64:67], v[40:43], v[200:203]
ds_read_b128 v[92:95], v2 offset:8960
v_mfma_f32_16x16x32_bf16 v[196:199], v[64:67], v[36:39], v[196:199]
ds_read_b64_tr_b16 v[112:113], v5 offset:40960
v_mfma_f32_16x16x32_bf16 v[192:195], v[64:67], v[32:35], v[192:195]
ds_read_b64_tr_b16 v[114:115], v5 offset:45056
v_mfma_f32_16x16x32_bf16 v[144:147], v[52:55], v[32:35], v[144:147]
ds_read_b64_tr_b16 v[100:101], v6 offset:24576
v_mfma_f32_16x16x32_bf16 v[148:151], v[52:55], v[36:39], v[148:151]
ds_read_b64_tr_b16 v[102:103], v6 offset:28672
v_mfma_f32_16x16x32_bf16 v[152:155], v[52:55], v[40:43], v[152:155]
ds_read_b64_tr_b16 v[116:117], v6 offset:40960
v_mfma_f32_16x16x32_bf16 v[156:159], v[52:55], v[44:47], v[156:159]
ds_read_b64_tr_b16 v[118:119], v6 offset:45056
v_mfma_f32_16x16x32_bf16 v[220:223], v[68:71], v[44:47], v[220:223]
ds_read_b64_tr_b16 v[104:105], v7 offset:24576
v_mfma_f32_16x16x32_bf16 v[216:219], v[68:71], v[40:43], v[216:219]
ds_read_b64_tr_b16 v[106:107], v7 offset:28672
v_mfma_f32_16x16x32_bf16 v[212:215], v[68:71], v[36:39], v[212:215]
ds_read_b64_tr_b16 v[120:121], v7 offset:40960
v_mfma_f32_16x16x32_bf16 v[208:211], v[68:71], v[32:35], v[208:211]
ds_read_b64_tr_b16 v[122:123], v7 offset:45056
v_mfma_f32_16x16x32_bf16 v[160:163], v[56:59], v[32:35], v[160:163]
ds_read_b64_tr_b16 v[108:109], v8 offset:24576
v_mfma_f32_16x16x32_bf16 v[164:167], v[56:59], v[36:39], v[164:167]
ds_read_b64_tr_b16 v[110:111], v8 offset:28672
v_mfma_f32_16x16x32_bf16 v[168:171], v[56:59], v[40:43], v[168:171]
ds_read_b64_tr_b16 v[124:125], v8 offset:40960
v_mfma_f32_16x16x32_bf16 v[172:175], v[56:59], v[44:47], v[172:175]
ds_read_b64_tr_b16 v[126:127], v8 offset:45056
s_waitcnt lgkmcnt(14)
v_mfma_f32_16x16x32_bf16 v[236:239], v[72:75], v[44:47], v[236:239]
v_max3_u32 v19, v80, v81, v82
v_mfma_f32_16x16x32_bf16 v[232:235], v[72:75], v[40:43], v[232:235]
v_max3_u32 v19, v19, v83, v84
v_mfma_f32_16x16x32_bf16 v[228:231], v[72:75], v[36:39], v[228:231]
v_max3_u32 v19, v19, v85, v86
v_mfma_f32_16x16x32_bf16 v[224:227], v[72:75], v[32:35], v[224:227]
v_max3_u32 v19, v19, v87, v88
v_mfma_f32_16x16x32_bf16 v[176:179], v[60:63], v[32:35], v[176:179]
v_max3_u32 v19, v19, v89, v90
v_mfma_f32_16x16x32_bf16 v[180:183], v[60:63], v[36:39], v[180:183]
v_max3_u32 v19, v19, v91, v92
v_mfma_f32_16x16x32_bf16 v[184:187], v[60:63], v[40:43], v[184:187]
v_max3_u32 v19, v19, v93, v94
v_mfma_f32_16x16x32_bf16 v[188:191], v[60:63], v[44:47], v[188:191]
v_max_u32 v19, v19, v95
v_mfma_f32_16x16x32_bf16 v[252:255], v[76:79], v[44:47], v[252:255]
v_cmp_eq_u32 vcc, -1, v19
v_mfma_f32_16x16x32_bf16 v[248:251], v[76:79], v[40:43], v[248:251]
v_mfma_f32_16x16x32_bf16 v[244:247], v[76:79], v[36:39], v[244:247]
v_mfma_f32_16x16x32_bf16 v[240:243], v[76:79], v[32:35], v[240:243]
s_nop 1
s_cbranch_vccz Lok_77
s_add_u32 s44, s35, 4
s_and_b32 s44, s44, 15
s_lshl_b32 s44, s44, 14
s_add_u32 s44, s44, 8192
s_mov_b32 s45, 0x20000
Lre_78:
buffer_load_dwordx4 v[80:83], v2, s[12:15], s44 offen offset:0 sc1
buffer_load_dwordx4 v[84:87], v2, s[12:15], s44 offen offset:256 sc1
buffer_load_dwordx4 v[88:91], v2, s[12:15], s44 offen offset:512 sc1
buffer_load_dwordx4 v[92:95], v2, s[12:15], s44 offen offset:768 sc1
s_waitcnt vmcnt(0)
v_max3_u32 v19, v80, v81, v82
v_max3_u32 v19, v19, v83, v84
v_max3_u32 v19, v19, v85, v86
v_max3_u32 v19, v19, v87, v88
v_max3_u32 v19, v19, v89, v90
v_max3_u32 v19, v19, v91, v92
v_max3_u32 v19, v19, v93, v94
v_max_u32 v19, v19, v95
v_cmp_eq_u32 vcc, -1, v19
s_sub_u32 s45, s45, 1
s_cmp_eq_u32 s45, 0
s_cbranch_scc1 Lok_77
s_nop 2
s_cbranch_vccnz Lre_78
Lok_77:
s_waitcnt lgkmcnt(0)
s_barrier
v_mfma_f32_16x16x32_bf16 v[128:131], v[96:99], v[80:83], v[128:131]
ds_read_b128 v[32:35], v3 offset:0
v_mfma_f32_16x16x32_bf16 v[132:135], v[96:99], v[84:87], v[132:135]
ds_read_b64_tr_b16 v[48:49], v9 offset:16384
v_mfma_f32_16x16x32_bf16 v[136:139], v[96:99], v[88:91], v[136:139]
ds_read_b64_tr_b16 v[50:51], v9 offset:20480
v_mfma_f32_16x16x32_bf16 v[140:143], v[96:99], v[92:95], v[140:143]
ds_read_b128 v[36:39], v3 offset:256
v_mfma_f32_16x16x32_bf16 v[204:207], v[112:115], v[92:95], v[204:207]
ds_read_b128 v[40:43], v3 offset:512
v_mfma_f32_16x16x32_bf16 v[200:203], v[112:115], v[88:91], v[200:203]
ds_read_b128 v[44:47], v3 offset:768
v_mfma_f32_16x16x32_bf16 v[196:199], v[112:115], v[84:87], v[196:199]
ds_read_b64_tr_b16 v[64:65], v9 offset:32768
v_mfma_f32_16x16x32_bf16 v[192:195], v[112:115], v[80:83], v[192:195]
ds_read_b64_tr_b16 v[66:67], v9 offset:36864
v_mfma_f32_16x16x32_bf16 v[144:147], v[100:103], v[80:83], v[144:147]
ds_read_b64_tr_b16 v[52:53], v10 offset:16384
v_mfma_f32_16x16x32_bf16 v[148:151], v[100:103], v[84:87], v[148:151]
ds_read_b64_tr_b16 v[54:55], v10 offset:20480
v_mfma_f32_16x16x32_bf16 v[152:155], v[100:103], v[88:91], v[152:155]
ds_read_b64_tr_b16 v[68:69], v10 offset:32768
v_mfma_f32_16x16x32_bf16 v[156:159], v[100:103], v[92:95], v[156:159]
ds_read_b64_tr_b16 v[70:71], v10 offset:36864
v_mfma_f32_16x16x32_bf16 v[220:223], v[116:119], v[92:95], v[220:223]
ds_read_b64_tr_b16 v[56:57], v11 offset:16384
v_mfma_f32_16x16x32_bf16 v[216:219], v[116:119], v[88:91], v[216:219]
ds_read_b64_tr_b16 v[58:59], v11 offset:20480
v_mfma_f32_16x16x32_bf16 v[212:215], v[116:119], v[84:87], v[212:215]
ds_read_b64_tr_b16 v[72:73], v11 offset:32768
v_mfma_f32_16x16x32_bf16 v[208:211], v[116:119], v[80:83], v[208:211]
ds_read_b64_tr_b16 v[74:75], v11 offset:36864
v_mfma_f32_16x16x32_bf16 v[160:163], v[104:107], v[80:83], v[160:163]
ds_read_b64_tr_b16 v[60:61], v12 offset:16384
v_mfma_f32_16x16x32_bf16 v[164:167], v[104:107], v[84:87], v[164:167]
ds_read_b64_tr_b16 v[62:63], v12 offset:20480
v_mfma_f32_16x16x32_bf16 v[168:171], v[104:107], v[88:91], v[168:171]
ds_read_b64_tr_b16 v[76:77], v12 offset:32768
v_mfma_f32_16x16x32_bf16 v[172:175], v[104:107], v[92:95], v[172:175]
ds_read_b64_tr_b16 v[78:79], v12 offset:36864
s_waitcnt lgkmcnt(14)
v_mfma_f32_16x16x32_bf16 v[236:239], v[120:123], v[92:95], v[236:239]
v_max3_u32 v19, v32, v33, v34
v_mfma_f32_16x16x32_bf16 v[232:235], v[120:123], v[88:91], v[232:235]
v_max3_u32 v19, v19, v35, v36
v_mfma_f32_16x16x32_bf16 v[228:231], v[120:123], v[84:87], v[228:231]
v_max3_u32 v19, v19, v37, v38
v_mfma_f32_16x16x32_bf16 v[224:227], v[120:123], v[80:83], v[224:227]
v_max3_u32 v19, v19, v39, v40
v_mfma_f32_16x16x32_bf16 v[176:179], v[108:111], v[80:83], v[176:179]
v_max3_u32 v19, v19, v41, v42
v_mfma_f32_16x16x32_bf16 v[180:183], v[108:111], v[84:87], v[180:183]
v_max3_u32 v19, v19, v43, v44
v_mfma_f32_16x16x32_bf16 v[184:187], v[108:111], v[88:91], v[184:187]
v_max3_u32 v19, v19, v45, v46
v_mfma_f32_16x16x32_bf16 v[188:191], v[108:111], v[92:95], v[188:191]
v_max_u32 v19, v19, v47
v_mfma_f32_16x16x32_bf16 v[252:255], v[124:127], v[92:95], v[252:255]
v_cmp_eq_u32 vcc, -1, v19
v_mfma_f32_16x16x32_bf16 v[248:251], v[124:127], v[88:91], v[248:251]
v_mfma_f32_16x16x32_bf16 v[244:247], v[124:127], v[84:87], v[244:247]
v_mfma_f32_16x16x32_bf16 v[240:243], v[124:127], v[80:83], v[240:243]
s_nop 1
s_cbranch_vccz Lok_79
s_add_u32 s44, s35, 5
s_and_b32 s44, s44, 15
s_lshl_b32 s44, s44, 14
s_add_u32 s44, s44, 0
s_mov_b32 s45, 0x20000
Lre_80:
buffer_load_dwordx4 v[32:35], v2, s[12:15], s44 offen offset:0 sc1
buffer_load_dwordx4 v[36:39], v2, s[12:15], s44 offen offset:256 sc1
buffer_load_dwordx4 v[40:43], v2, s[12:15], s44 offen offset:512 sc1
buffer_load_dwordx4 v[44:47], v2, s[12:15], s44 offen offset:768 sc1
s_waitcnt vmcnt(0)
v_max3_u32 v19, v32, v33, v34
v_max3_u32 v19, v19, v35, v36
v_max3_u32 v19, v19, v37, v38
v_max3_u32 v19, v19, v39, v40
v_max3_u32 v19, v19, v41, v42
v_max3_u32 v19, v19, v43, v44
v_max3_u32 v19, v19, v45, v46
v_max_u32 v19, v19, v47
v_cmp_eq_u32 vcc, -1, v19
s_sub_u32 s45, s45, 1
s_cmp_eq_u32 s45, 0
s_cbranch_scc1 Lok_79
s_nop 2
s_cbranch_vccnz Lre_80
Lok_79:
s_waitcnt lgkmcnt(0)
v_mfma_f32_16x16x32_bf16 v[128:131], v[48:51], v[32:35], v[128:131]
ds_read_b128 v[80:83], v3 offset:8192
v_mfma_f32_16x16x32_bf16 v[132:135], v[48:51], v[36:39], v[132:135]
ds_read_b64_tr_b16 v[96:97], v9 offset:24576
v_mfma_f32_16x16x32_bf16 v[136:139], v[48:51], v[40:43], v[136:139]
ds_read_b64_tr_b16 v[98:99], v9 offset:28672
v_mfma_f32_16x16x32_bf16 v[140:143], v[48:51], v[44:47], v[140:143]
ds_read_b128 v[84:87], v3 offset:8448
v_mfma_f32_16x16x32_bf16 v[204:207], v[64:67], v[44:47], v[204:207]
ds_read_b128 v[88:91], v3 offset:8704
v_mfma_f32_16x16x32_bf16 v[200:203], v[64:67], v[40:43], v[200:203]
ds_read_b128 v[92:95], v3 offset:8960
v_mfma_f32_16x16x32_bf16 v[196:199], v[64:67], v[36:39], v[196:199]
ds_read_b64_tr_b16 v[112:113], v9 offset:40960
v_mfma_f32_16x16x32_bf16 v[192:195], v[64:67], v[32:35], v[192:195]
ds_read_b64_tr_b16 v[114:115], v9 offset:45056
v_mfma_f32_16x16x32_bf16 v[144:147], v[52:55], v[32:35], v[144:147]
ds_read_b64_tr_b16 v[100:101], v10 offset:24576
v_mfma_f32_16x16x32_bf16 v[148:151], v[52:55], v[36:39], v[148:151]
ds_read_b64_tr_b16 v[102:103], v10 offset:28672
v_mfma_f32_16x16x32_bf16 v[152:155], v[52:55], v[40:43], v[152:155]
ds_read_b64_tr_b16 v[116:117], v10 offset:40960
v_mfma_f32_16x16x32_bf16 v[156:159], v[52:55], v[44:47], v[156:159]
ds_read_b64_tr_b16 v[118:119], v10 offset:45056
v_mfma_f32_16x16x32_bf16 v[220:223], v[68:71], v[44:47], v[220:223]
ds_read_b64_tr_b16 v[104:105], v11 offset:24576
v_mfma_f32_16x16x32_bf16 v[216:219], v[68:71], v[40:43], v[216:219]
ds_read_b64_tr_b16 v[106:107], v11 offset:28672
v_mfma_f32_16x16x32_bf16 v[212:215], v[68:71], v[36:39], v[212:215]
ds_read_b64_tr_b16 v[120:121], v11 offset:40960
v_mfma_f32_16x16x32_bf16 v[208:211], v[68:71], v[32:35], v[208:211]
ds_read_b64_tr_b16 v[122:123], v11 offset:45056
v_mfma_f32_16x16x32_bf16 v[160:163], v[56:59], v[32:35], v[160:163]
ds_read_b64_tr_b16 v[108:109], v12 offset:24576
v_mfma_f32_16x16x32_bf16 v[164:167], v[56:59], v[36:39], v[164:167]
ds_read_b64_tr_b16 v[110:111], v12 offset:28672
v_mfma_f32_16x16x32_bf16 v[168:171], v[56:59], v[40:43], v[168:171]
ds_read_b64_tr_b16 v[124:125], v12 offset:40960
v_mfma_f32_16x16x32_bf16 v[172:175], v[56:59], v[44:47], v[172:175]
ds_read_b64_tr_b16 v[126:127], v12 offset:45056
s_waitcnt lgkmcnt(14)
v_mfma_f32_16x16x32_bf16 v[236:239], v[72:75], v[44:47], v[236:239]
v_max3_u32 v19, v80, v81, v82
v_mfma_f32_16x16x32_bf16 v[232:235], v[72:75], v[40:43], v[232:235]
v_max3_u32 v19, v19, v83, v84
v_mfma_f32_16x16x32_bf16 v[228:231], v[72:75], v[36:39], v[228:231]
v_max3_u32 v19, v19, v85, v86
v_mfma_f32_16x16x32_bf16 v[224:227], v[72:75], v[32:35], v[224:227]
v_max3_u32 v19, v19, v87, v88
v_mfma_f32_16x16x32_bf16 v[176:179], v[60:63], v[32:35], v[176:179]
v_max3_u32 v19, v19, v89, v90
v_mfma_f32_16x16x32_bf16 v[180:183], v[60:63], v[36:39], v[180:183]
v_max3_u32 v19, v19, v91, v92
v_mfma_f32_16x16x32_bf16 v[184:187], v[60:63], v[40:43], v[184:187]
v_max3_u32 v19, v19, v93, v94
v_mfma_f32_16x16x32_bf16 v[188:191], v[60:63], v[44:47], v[188:191]
v_max_u32 v19, v19, v95
v_mfma_f32_16x16x32_bf16 v[252:255], v[76:79], v[44:47], v[252:255]
v_cmp_eq_u32 vcc, -1, v19
v_mfma_f32_16x16x32_bf16 v[248:251], v[76:79], v[40:43], v[248:251]
v_mfma_f32_16x16x32_bf16 v[244:247], v[76:79], v[36:39], v[244:247]
v_mfma_f32_16x16x32_bf16 v[240:243], v[76:79], v[32:35], v[240:243]
s_nop 1
s_cbranch_vccz Lok_81
s_add_u32 s44, s35, 5
s_and_b32 s44, s44, 15
s_lshl_b32 s44, s44, 14
s_add_u32 s44, s44, 8192
s_mov_b32 s45, 0x20000
Lre_82:
buffer_load_dwordx4 v[80:83], v2, s[12:15], s44 offen offset:0 sc1
buffer_load_dwordx4 v[84:87], v2, s[12:15], s44 offen offset:256 sc1
buffer_load_dwordx4 v[88:91], v2, s[12:15], s44 offen offset:512 sc1
buffer_load_dwordx4 v[92:95], v2, s[12:15], s44 offen offset:768 sc1
s_waitcnt vmcnt(0)
v_max3_u32 v19, v80, v81, v82
v_max3_u32 v19, v19, v83, v84
v_max3_u32 v19, v19, v85, v86
v_max3_u32 v19, v19, v87, v88
v_max3_u32 v19, v19, v89, v90
v_max3_u32 v19, v19, v91, v92
v_max3_u32 v19, v19, v93, v94
v_max_u32 v19, v19, v95
v_cmp_eq_u32 vcc, -1, v19
s_sub_u32 s45, s45, 1
s_cmp_eq_u32 s45, 0
s_cbranch_scc1 Lok_81
s_nop 2
s_cbranch_vccnz Lre_82
Lok_81:
s_waitcnt lgkmcnt(0)
s_barrier
v_mfma_f32_16x16x32_bf16 v[128:131], v[96:99], v[80:83], v[128:131]
ds_read_b128 v[32:35], v4 offset:0
v_mfma_f32_16x16x32_bf16 v[132:135], v[96:99], v[84:87], v[132:135]
ds_read_b64_tr_b16 v[48:49], v13 offset:16384
v_mfma_f32_16x16x32_bf16 v[136:139], v[96:99], v[88:91], v[136:139]
ds_read_b64_tr_b16 v[50:51], v13 offset:20480
v_mfma_f32_16x16x32_bf16 v[140:143], v[96:99], v[92:95], v[140:143]
ds_read_b128 v[36:39], v4 offset:256
v_mfma_f32_16x16x32_bf16 v[204:207], v[112:115], v[92:95], v[204:207]
ds_read_b128 v[40:43], v4 offset:512
v_mfma_f32_16x16x32_bf16 v[200:203], v[112:115], v[88:91], v[200:203]
ds_read_b128 v[44:47], v4 offset:768
v_mfma_f32_16x16x32_bf16 v[196:199], v[112:115], v[84:87], v[196:199]
ds_read_b64_tr_b16 v[64:65], v13 offset:32768
v_mfma_f32_16x16x32_bf16 v[192:195], v[112:115], v[80:83], v[192:195]
ds_read_b64_tr_b16 v[66:67], v13 offset:36864
v_mfma_f32_16x16x32_bf16 v[144:147], v[100:103], v[80:83], v[144:147]
ds_read_b64_tr_b16 v[52:53], v14 offset:16384
v_mfma_f32_16x16x32_bf16 v[148:151], v[100:103], v[84:87], v[148:151]
ds_read_b64_tr_b16 v[54:55], v14 offset:20480
v_mfma_f32_16x16x32_bf16 v[152:155], v[100:103], v[88:91], v[152:155]
ds_read_b64_tr_b16 v[68:69], v14 offset:32768
v_mfma_f32_16x16x32_bf16 v[156:159], v[100:103], v[92:95], v[156:159]
ds_read_b64_tr_b16 v[70:71], v14 offset:36864
v_mfma_f32_16x16x32_bf16 v[220:223], v[116:119], v[92:95], v[220:223]
ds_read_b64_tr_b16 v[56:57], v15 offset:16384
v_mfma_f32_16x16x32_bf16 v[216:219], v[116:119], v[88:91], v[216:219]
ds_read_b64_tr_b16 v[58:59], v15 offset:20480
v_mfma_f32_16x16x32_bf16 v[212:215], v[116:119], v[84:87], v[212:215]
ds_read_b64_tr_b16 v[72:73], v15 offset:32768
v_mfma_f32_16x16x32_bf16 v[208:211], v[116:119], v[80:83], v[208:211]
ds_read_b64_tr_b16 v[74:75], v15 offset:36864
v_mfma_f32_16x16x32_bf16 v[160:163], v[104:107], v[80:83], v[160:163]
ds_read_b64_tr_b16 v[60:61], v16 offset:16384
v_mfma_f32_16x16x32_bf16 v[164:167], v[104:107], v[84:87], v[164:167]
ds_read_b64_tr_b16 v[62:63], v16 offset:20480
v_mfma_f32_16x16x32_bf16 v[168:171], v[104:107], v[88:91], v[168:171]
ds_read_b64_tr_b16 v[76:77], v16 offset:32768
v_mfma_f32_16x16x32_bf16 v[172:175], v[104:107], v[92:95], v[172:175]
ds_read_b64_tr_b16 v[78:79], v16 offset:36864
s_waitcnt lgkmcnt(14)
v_mfma_f32_16x16x32_bf16 v[236:239], v[120:123], v[92:95], v[236:239]
v_max3_u32 v19, v32, v33, v34
v_mfma_f32_16x16x32_bf16 v[232:235], v[120:123], v[88:91], v[232:235]
v_max3_u32 v19, v19, v35, v36
v_mfma_f32_16x16x32_bf16 v[228:231], v[120:123], v[84:87], v[228:231]
v_max3_u32 v19, v19, v37, v38
v_mfma_f32_16x16x32_bf16 v[224:227], v[120:123], v[80:83], v[224:227]
v_max3_u32 v19, v19, v39, v40
v_mfma_f32_16x16x32_bf16 v[176:179], v[108:111], v[80:83], v[176:179]
v_max3_u32 v19, v19, v41, v42
v_mfma_f32_16x16x32_bf16 v[180:183], v[108:111], v[84:87], v[180:183]
v_max3_u32 v19, v19, v43, v44
v_mfma_f32_16x16x32_bf16 v[184:187], v[108:111], v[88:91], v[184:187]
v_max3_u32 v19, v19, v45, v46
v_mfma_f32_16x16x32_bf16 v[188:191], v[108:111], v[92:95], v[188:191]
v_max_u32 v19, v19, v47
v_mfma_f32_16x16x32_bf16 v[252:255], v[124:127], v[92:95], v[252:255]
v_cmp_eq_u32 vcc, -1, v19
v_mfma_f32_16x16x32_bf16 v[248:251], v[124:127], v[88:91], v[248:251]
v_mfma_f32_16x16x32_bf16 v[244:247], v[124:127], v[84:87], v[244:247]
v_mfma_f32_16x16x32_bf16 v[240:243], v[124:127], v[80:83], v[240:243]
s_nop 1
s_cbranch_vccz Lok_83
s_add_u32 s44, s35, 6
s_and_b32 s44, s44, 15
s_lshl_b32 s44, s44, 14
s_add_u32 s44, s44, 0
s_mov_b32 s45, 0x20000
Lre_84:
buffer_load_dwordx4 v[32:35], v2, s[12:15], s44 offen offset:0 sc1
buffer_load_dwordx4 v[36:39], v2, s[12:15], s44 offen offset:256 sc1
buffer_load_dwordx4 v[40:43], v2, s[12:15], s44 offen offset:512 sc1
buffer_load_dwordx4 v[44:47], v2, s[12:15], s44 offen offset:768 sc1
s_waitcnt vmcnt(0)
v_max3_u32 v19, v32, v33, v34
v_max3_u32 v19, v19, v35, v36
v_max3_u32 v19, v19, v37, v38
v_max3_u32 v19, v19, v39, v40
v_max3_u32 v19, v19, v41, v42
v_max3_u32 v19, v19, v43, v44
v_max3_u32 v19, v19, v45, v46
v_max_u32 v19, v19, v47
v_cmp_eq_u32 vcc, -1, v19
s_sub_u32 s45, s45, 1
s_cmp_eq_u32 s45, 0
s_cbranch_scc1 Lok_83
s_nop 2
s_cbranch_vccnz Lre_84
Lok_83:
s_waitcnt lgkmcnt(0)
v_mfma_f32_16x16x32_bf16 v[128:131], v[48:51], v[32:35], v[128:131]
ds_read_b128 v[80:83], v4 offset:8192
v_mfma_f32_16x16x32_bf16 v[132:135], v[48:51], v[36:39], v[132:135]
ds_read_b64_tr_b16 v[96:97], v13 offset:24576
v_mfma_f32_16x16x32_bf16 v[136:139], v[48:51], v[40:43], v[136:139]
ds_read_b64_tr_b16 v[98:99], v13 offset:28672
v_mfma_f32_16x16x32_bf16 v[140:143], v[48:51], v[44:47], v[140:143]
ds_read_b128 v[84:87], v4 offset:8448
v_mfma_f32_16x16x32_bf16 v[204:207], v[64:67], v[44:47], v[204:207]
ds_read_b128 v[88:91], v4 offset:8704
v_mfma_f32_16x16x32_bf16 v[200:203], v[64:67], v[40:43], v[200:203]
ds_read_b128 v[92:95], v4 offset:8960
v_mfma_f32_16x16x32_bf16 v[196:199], v[64:67], v[36:39], v[196:199]
ds_read_b64_tr_b16 v[112:113], v13 offset:40960
v_mfma_f32_16x16x32_bf16 v[192:195], v[64:67], v[32:35], v[192:195]
ds_read_b64_tr_b16 v[114:115], v13 offset:45056
v_mfma_f32_16x16x32_bf16 v[144:147], v[52:55], v[32:35], v[144:147]
ds_read_b64_tr_b16 v[100:101], v14 offset:24576
v_mfma_f32_16x16x32_bf16 v[148:151], v[52:55], v[36:39], v[148:151]
ds_read_b64_tr_b16 v[102:103], v14 offset:28672
v_mfma_f32_16x16x32_bf16 v[152:155], v[52:55], v[40:43], v[152:155]
ds_read_b64_tr_b16 v[116:117], v14 offset:40960
v_mfma_f32_16x16x32_bf16 v[156:159], v[52:55], v[44:47], v[156:159]
ds_read_b64_tr_b16 v[118:119], v14 offset:45056
v_mfma_f32_16x16x32_bf16 v[220:223], v[68:71], v[44:47], v[220:223]
ds_read_b64_tr_b16 v[104:105], v15 offset:24576
v_mfma_f32_16x16x32_bf16 v[216:219], v[68:71], v[40:43], v[216:219]
ds_read_b64_tr_b16 v[106:107], v15 offset:28672
v_mfma_f32_16x16x32_bf16 v[212:215], v[68:71], v[36:39], v[212:215]
ds_read_b64_tr_b16 v[120:121], v15 offset:40960
v_mfma_f32_16x16x32_bf16 v[208:211], v[68:71], v[32:35], v[208:211]
ds_read_b64_tr_b16 v[122:123], v15 offset:45056
v_mfma_f32_16x16x32_bf16 v[160:163], v[56:59], v[32:35], v[160:163]
ds_read_b64_tr_b16 v[108:109], v16 offset:24576
v_mfma_f32_16x16x32_bf16 v[164:167], v[56:59], v[36:39], v[164:167]
ds_read_b64_tr_b16 v[110:111], v16 offset:28672
v_mfma_f32_16x16x32_bf16 v[168:171], v[56:59], v[40:43], v[168:171]
ds_read_b64_tr_b16 v[124:125], v16 offset:40960
v_mfma_f32_16x16x32_bf16 v[172:175], v[56:59], v[44:47], v[172:175]
ds_read_b64_tr_b16 v[126:127], v16 offset:45056
s_waitcnt lgkmcnt(14)
v_mfma_f32_16x16x32_bf16 v[236:239], v[72:75], v[44:47], v[236:239]
v_max3_u32 v19, v80, v81, v82
v_mfma_f32_16x16x32_bf16 v[232:235], v[72:75], v[40:43], v[232:235]
v_max3_u32 v19, v19, v83, v84
v_mfma_f32_16x16x32_bf16 v[228:231], v[72:75], v[36:39], v[228:231]
v_max3_u32 v19, v19, v85, v86
v_mfma_f32_16x16x32_bf16 v[224:227], v[72:75], v[32:35], v[224:227]
v_max3_u32 v19, v19, v87, v88
v_mfma_f32_16x16x32_bf16 v[176:179], v[60:63], v[32:35], v[176:179]
v_max3_u32 v19, v19, v89, v90
v_mfma_f32_16x16x32_bf16 v[180:183], v[60:63], v[36:39], v[180:183]
v_max3_u32 v19, v19, v91, v92
v_mfma_f32_16x16x32_bf16 v[184:187], v[60:63], v[40:43], v[184:187]
v_max3_u32 v19, v19, v93, v94
v_mfma_f32_16x16x32_bf16 v[188:191], v[60:63], v[44:47], v[188:191]
v_max_u32 v19, v19, v95
v_mfma_f32_16x16x32_bf16 v[252:255], v[76:79], v[44:47], v[252:255]
v_cmp_eq_u32 vcc, -1, v19
v_mfma_f32_16x16x32_bf16 v[248:251], v[76:79], v[40:43], v[248:251]
v_mfma_f32_16x16x32_bf16 v[244:247], v[76:79], v[36:39], v[244:247]
v_mfma_f32_16x16x32_bf16 v[240:243], v[76:79], v[32:35], v[240:243]
s_nop 1
s_cbranch_vccz Lok_85
s_add_u32 s44, s35, 6
s_and_b32 s44, s44, 15
s_lshl_b32 s44, s44, 14
s_add_u32 s44, s44, 8192
s_mov_b32 s45, 0x20000
Lre_86:
buffer_load_dwordx4 v[80:83], v2, s[12:15], s44 offen offset:0 sc1
buffer_load_dwordx4 v[84:87], v2, s[12:15], s44 offen offset:256 sc1
buffer_load_dwordx4 v[88:91], v2, s[12:15], s44 offen offset:512 sc1
buffer_load_dwordx4 v[92:95], v2, s[12:15], s44 offen offset:768 sc1
s_waitcnt vmcnt(0)
v_max3_u32 v19, v80, v81, v82
v_max3_u32 v19, v19, v83, v84
v_max3_u32 v19, v19, v85, v86
v_max3_u32 v19, v19, v87, v88
v_max3_u32 v19, v19, v89, v90
v_max3_u32 v19, v19, v91, v92
v_max3_u32 v19, v19, v93, v94
v_max_u32 v19, v19, v95
v_cmp_eq_u32 vcc, -1, v19
s_sub_u32 s45, s45, 1
s_cmp_eq_u32 s45, 0
s_cbranch_scc1 Lok_85
s_nop 2
s_cbranch_vccnz Lre_86
Lok_85:
s_waitcnt lgkmcnt(0)
s_barrier
v_mfma_f32_16x16x32_bf16 v[128:131], v[96:99], v[80:83], v[128:131]
ds_read_b128 v[32:35], v2 offset:0
v_mfma_f32_16x16x32_bf16 v[132:135], v[96:99], v[84:87], v[132:135]
ds_read_b64_tr_b16 v[48:49], v5 offset:16384
v_mfma_f32_16x16x32_bf16 v[136:139], v[96:99], v[88:91], v[136:139]
ds_read_b64_tr_b16 v[50:51], v5 offset:20480
v_mfma_f32_16x16x32_bf16 v[140:143], v[96:99], v[92:95], v[140:143]
ds_read_b128 v[36:39], v2 offset:256
v_mfma_f32_16x16x32_bf16 v[204:207], v[112:115], v[92:95], v[204:207]
ds_read_b128 v[40:43], v2 offset:512
v_mfma_f32_16x16x32_bf16 v[200:203], v[112:115], v[88:91], v[200:203]
ds_read_b128 v[44:47], v2 offset:768
v_mfma_f32_16x16x32_bf16 v[196:199], v[112:115], v[84:87], v[196:199]
ds_read_b64_tr_b16 v[64:65], v5 offset:32768
v_mfma_f32_16x16x32_bf16 v[192:195], v[112:115], v[80:83], v[192:195]
ds_read_b64_tr_b16 v[66:67], v5 offset:36864
v_mfma_f32_16x16x32_bf16 v[144:147], v[100:103], v[80:83], v[144:147]
ds_read_b64_tr_b16 v[52:53], v6 offset:16384
v_mfma_f32_16x16x32_bf16 v[148:151], v[100:103], v[84:87], v[148:151]
ds_read_b64_tr_b16 v[54:55], v6 offset:20480
v_mfma_f32_16x16x32_bf16 v[152:155], v[100:103], v[88:91], v[152:155]
ds_read_b64_tr_b16 v[68:69], v6 offset:32768
v_mfma_f32_16x16x32_bf16 v[156:159], v[100:103], v[92:95], v[156:159]
ds_read_b64_tr_b16 v[70:71], v6 offset:36864
v_mfma_f32_16x16x32_bf16 v[220:223], v[116:119], v[92:95], v[220:223]
ds_read_b64_tr_b16 v[56:57], v7 offset:16384
v_mfma_f32_16x16x32_bf16 v[216:219], v[116:119], v[88:91], v[216:219]
ds_read_b64_tr_b16 v[58:59], v7 offset:20480
v_mfma_f32_16x16x32_bf16 v[212:215], v[116:119], v[84:87], v[212:215]
ds_read_b64_tr_b16 v[72:73], v7 offset:32768
v_mfma_f32_16x16x32_bf16 v[208:211], v[116:119], v[80:83], v[208:211]
ds_read_b64_tr_b16 v[74:75], v7 offset:36864
v_mfma_f32_16x16x32_bf16 v[160:163], v[104:107], v[80:83], v[160:163]
ds_read_b64_tr_b16 v[60:61], v8 offset:16384
v_mfma_f32_16x16x32_bf16 v[164:167], v[104:107], v[84:87], v[164:167]
ds_read_b64_tr_b16 v[62:63], v8 offset:20480
v_mfma_f32_16x16x32_bf16 v[168:171], v[104:107], v[88:91], v[168:171]
ds_read_b64_tr_b16 v[76:77], v8 offset:32768
v_mfma_f32_16x16x32_bf16 v[172:175], v[104:107], v[92:95], v[172:175]
ds_read_b64_tr_b16 v[78:79], v8 offset:36864
s_waitcnt lgkmcnt(14)
v_mfma_f32_16x16x32_bf16 v[236:239], v[120:123], v[92:95], v[236:239]
v_max3_u32 v19, v32, v33, v34
v_mfma_f32_16x16x32_bf16 v[232:235], v[120:123], v[88:91], v[232:235]
v_max3_u32 v19, v19, v35, v36
v_mfma_f32_16x16x32_bf16 v[228:231], v[120:123], v[84:87], v[228:231]
v_max3_u32 v19, v19, v37, v38
v_mfma_f32_16x16x32_bf16 v[224:227], v[120:123], v[80:83], v[224:227]
v_max3_u32 v19, v19, v39, v40
v_mfma_f32_16x16x32_bf16 v[176:179], v[108:111], v[80:83], v[176:179]
v_max3_u32 v19, v19, v41, v42
v_mfma_f32_16x16x32_bf16 v[180:183], v[108:111], v[84:87], v[180:183]
v_max3_u32 v19, v19, v43, v44
v_mfma_f32_16x16x32_bf16 v[184:187], v[108:111], v[88:91], v[184:187]
v_max3_u32 v19, v19, v45, v46
v_mfma_f32_16x16x32_bf16 v[188:191], v[108:111], v[92:95], v[188:191]
v_max_u32 v19, v19, v47
v_mfma_f32_16x16x32_bf16 v[252:255], v[124:127], v[92:95], v[252:255]
v_cmp_eq_u32 vcc, -1, v19
v_mfma_f32_16x16x32_bf16 v[248:251], v[124:127], v[88:91], v[248:251]
v_mfma_f32_16x16x32_bf16 v[244:247], v[124:127], v[84:87], v[244:247]
v_mfma_f32_16x16x32_bf16 v[240:243], v[124:127], v[80:83], v[240:243]
s_nop 1
s_cbranch_vccz Lok_87
s_add_u32 s44, s35, 7
s_and_b32 s44, s44, 15
s_lshl_b32 s44, s44, 14
s_add_u32 s44, s44, 0
s_mov_b32 s45, 0x20000
Lre_88:
buffer_load_dwordx4 v[32:35], v2, s[12:15], s44 offen offset:0 sc1
buffer_load_dwordx4 v[36:39], v2, s[12:15], s44 offen offset:256 sc1
buffer_load_dwordx4 v[40:43], v2, s[12:15], s44 offen offset:512 sc1
buffer_load_dwordx4 v[44:47], v2, s[12:15], s44 offen offset:768 sc1
s_waitcnt vmcnt(0)
v_max3_u32 v19, v32, v33, v34
v_max3_u32 v19, v19, v35, v36
v_max3_u32 v19, v19, v37, v38
v_max3_u32 v19, v19, v39, v40
v_max3_u32 v19, v19, v41, v42
v_max3_u32 v19, v19, v43, v44
v_max3_u32 v19, v19, v45, v46
v_max_u32 v19, v19, v47
v_cmp_eq_u32 vcc, -1, v19
s_sub_u32 s45, s45, 1
s_cmp_eq_u32 s45, 0
s_cbranch_scc1 Lok_87
s_nop 2
s_cbranch_vccnz Lre_88
Lok_87:
s_waitcnt lgkmcnt(0)
v_mfma_f32_16x16x32_bf16 v[128:131], v[48:51], v[32:35], v[128:131]
ds_read_b128 v[80:83], v2 offset:8192
v_mfma_f32_16x16x32_bf16 v[132:135], v[48:51], v[36:39], v[132:135]
ds_read_b64_tr_b16 v[96:97], v5 offset:24576
v_mfma_f32_16x16x32_bf16 v[136:139], v[48:51], v[40:43], v[136:139]
ds_read_b64_tr_b16 v[98:99], v5 offset:28672
v_mfma_f32_16x16x32_bf16 v[140:143], v[48:51], v[44:47], v[140:143]
ds_read_b128 v[84:87], v2 offset:8448
v_mfma_f32_16x16x32_bf16 v[204:207], v[64:67], v[44:47], v[204:207]
ds_read_b128 v[88:91], v2 offset:8704
v_mfma_f32_16x16x32_bf16 v[200:203], v[64:67], v[40:43], v[200:203]
ds_read_b128 v[92:95], v2 offset:8960
v_mfma_f32_16x16x32_bf16 v[196:199], v[64:67], v[36:39], v[196:199]
ds_read_b64_tr_b16 v[112:113], v5 offset:40960
v_mfma_f32_16x16x32_bf16 v[192:195], v[64:67], v[32:35], v[192:195]
ds_read_b64_tr_b16 v[114:115], v5 offset:45056
v_mfma_f32_16x16x32_bf16 v[144:147], v[52:55], v[32:35], v[144:147]
ds_read_b64_tr_b16 v[100:101], v6 offset:24576
v_mfma_f32_16x16x32_bf16 v[148:151], v[52:55], v[36:39], v[148:151]
ds_read_b64_tr_b16 v[102:103], v6 offset:28672
v_mfma_f32_16x16x32_bf16 v[152:155], v[52:55], v[40:43], v[152:155]
ds_read_b64_tr_b16 v[116:117], v6 offset:40960
v_mfma_f32_16x16x32_bf16 v[156:159], v[52:55], v[44:47], v[156:159]
ds_read_b64_tr_b16 v[118:119], v6 offset:45056
v_mfma_f32_16x16x32_bf16 v[220:223], v[68:71], v[44:47], v[220:223]
ds_read_b64_tr_b16 v[104:105], v7 offset:24576
v_mfma_f32_16x16x32_bf16 v[216:219], v[68:71], v[40:43], v[216:219]
ds_read_b64_tr_b16 v[106:107], v7 offset:28672
v_mfma_f32_16x16x32_bf16 v[212:215], v[68:71], v[36:39], v[212:215]
ds_read_b64_tr_b16 v[120:121], v7 offset:40960
v_mfma_f32_16x16x32_bf16 v[208:211], v[68:71], v[32:35], v[208:211]
ds_read_b64_tr_b16 v[122:123], v7 offset:45056
v_mfma_f32_16x16x32_bf16 v[160:163], v[56:59], v[32:35], v[160:163]
ds_read_b64_tr_b16 v[108:109], v8 offset:24576
v_mfma_f32_16x16x32_bf16 v[164:167], v[56:59], v[36:39], v[164:167]
ds_read_b64_tr_b16 v[110:111], v8 offset:28672
v_mfma_f32_16x16x32_bf16 v[168:171], v[56:59], v[40:43], v[168:171]
ds_read_b64_tr_b16 v[124:125], v8 offset:40960
v_mfma_f32_16x16x32_bf16 v[172:175], v[56:59], v[44:47], v[172:175]
ds_read_b64_tr_b16 v[126:127], v8 offset:45056
s_waitcnt lgkmcnt(14)
v_mfma_f32_16x16x32_bf16 v[236:239], v[72:75], v[44:47], v[236:239]
v_max3_u32 v19, v80, v81, v82
v_mfma_f32_16x16x32_bf16 v[232:235], v[72:75], v[40:43], v[232:235]
v_max3_u32 v19, v19, v83, v84
v_mfma_f32_16x16x32_bf16 v[228:231], v[72:75], v[36:39], v[228:231]
v_max3_u32 v19, v19, v85, v86
v_mfma_f32_16x16x32_bf16 v[224:227], v[72:75], v[32:35], v[224:227]
v_max3_u32 v19, v19, v87, v88
v_mfma_f32_16x16x32_bf16 v[176:179], v[60:63], v[32:35], v[176:179]
v_max3_u32 v19, v19, v89, v90
v_mfma_f32_16x16x32_bf16 v[180:183], v[60:63], v[36:39], v[180:183]
v_max3_u32 v19, v19, v91, v92
v_mfma_f32_16x16x32_bf16 v[184:187], v[60:63], v[40:43], v[184:187]
v_max3_u32 v19, v19, v93, v94
v_mfma_f32_16x16x32_bf16 v[188:191], v[60:63], v[44:47], v[188:191]
v_max_u32 v19, v19, v95
v_mfma_f32_16x16x32_bf16 v[252:255], v[76:79], v[44:47], v[252:255]
v_cmp_eq_u32 vcc, -1, v19
v_mfma_f32_16x16x32_bf16 v[248:251], v[76:79], v[40:43], v[248:251]
v_mfma_f32_16x16x32_bf16 v[244:247], v[76:79], v[36:39], v[244:247]
v_mfma_f32_16x16x32_bf16 v[240:243], v[76:79], v[32:35], v[240:243]
s_nop 1
s_cbranch_vccz Lok_89
s_add_u32 s44, s35, 7
s_and_b32 s44, s44, 15
s_lshl_b32 s44, s44, 14
s_add_u32 s44, s44, 8192
s_mov_b32 s45, 0x20000
Lre_90:
buffer_load_dwordx4 v[80:83], v2, s[12:15], s44 offen offset:0 sc1
buffer_load_dwordx4 v[84:87], v2, s[12:15], s44 offen offset:256 sc1
buffer_load_dwordx4 v[88:91], v2, s[12:15], s44 offen offset:512 sc1
buffer_load_dwordx4 v[92:95], v2, s[12:15], s44 offen offset:768 sc1
s_waitcnt vmcnt(0)
v_max3_u32 v19, v80, v81, v82
v_max3_u32 v19, v19, v83, v84
v_max3_u32 v19, v19, v85, v86
v_max3_u32 v19, v19, v87, v88
v_max3_u32 v19, v19, v89, v90
v_max3_u32 v19, v19, v91, v92
v_max3_u32 v19, v19, v93, v94
v_max_u32 v19, v19, v95
v_cmp_eq_u32 vcc, -1, v19
s_sub_u32 s45, s45, 1
s_cmp_eq_u32 s45, 0
s_cbranch_scc1 Lok_89
s_nop 2
s_cbranch_vccnz Lre_90
Lok_89:
s_waitcnt lgkmcnt(0)
s_barrier
v_mfma_f32_16x16x32_bf16 v[128:131], v[96:99], v[80:83], v[128:131]
ds_read_b128 v[32:35], v3 offset:0
v_mfma_f32_16x16x32_bf16 v[132:135], v[96:99], v[84:87], v[132:135]
ds_read_b64_tr_b16 v[48:49], v9 offset:16384
v_mfma_f32_16x16x32_bf16 v[136:139], v[96:99], v[88:91], v[136:139]
ds_read_b64_tr_b16 v[50:51], v9 offset:20480
v_mfma_f32_16x16x32_bf16 v[140:143], v[96:99], v[92:95], v[140:143]
ds_read_b128 v[36:39], v3 offset:256
v_mfma_f32_16x16x32_bf16 v[204:207], v[112:115], v[92:95], v[204:207]
ds_read_b128 v[40:43], v3 offset:512
v_mfma_f32_16x16x32_bf16 v[200:203], v[112:115], v[88:91], v[200:203]
ds_read_b128 v[44:47], v3 offset:768
v_mfma_f32_16x16x32_bf16 v[196:199], v[112:115], v[84:87], v[196:199]
ds_read_b64_tr_b16 v[64:65], v9 offset:32768
v_mfma_f32_16x16x32_bf16 v[192:195], v[112:115], v[80:83], v[192:195]
ds_read_b64_tr_b16 v[66:67], v9 offset:36864
v_mfma_f32_16x16x32_bf16 v[144:147], v[100:103], v[80:83], v[144:147]
ds_read_b64_tr_b16 v[52:53], v10 offset:16384
v_mfma_f32_16x16x32_bf16 v[148:151], v[100:103], v[84:87], v[148:151]
ds_read_b64_tr_b16 v[54:55], v10 offset:20480
v_mfma_f32_16x16x32_bf16 v[152:155], v[100:103], v[88:91], v[152:155]
ds_read_b64_tr_b16 v[68:69], v10 offset:32768
v_mfma_f32_16x16x32_bf16 v[156:159], v[100:103], v[92:95], v[156:159]
ds_read_b64_tr_b16 v[70:71], v10 offset:36864
v_mfma_f32_16x16x32_bf16 v[220:223], v[116:119], v[92:95], v[220:223]
ds_read_b64_tr_b16 v[56:57], v11 offset:16384
v_mfma_f32_16x16x32_bf16 v[216:219], v[116:119], v[88:91], v[216:219]
ds_read_b64_tr_b16 v[58:59], v11 offset:20480
v_mfma_f32_16x16x32_bf16 v[212:215], v[116:119], v[84:87], v[212:215]
ds_read_b64_tr_b16 v[72:73], v11 offset:32768
v_mfma_f32_16x16x32_bf16 v[208:211], v[116:119], v[80:83], v[208:211]
ds_read_b64_tr_b16 v[74:75], v11 offset:36864
v_mfma_f32_16x16x32_bf16 v[160:163], v[104:107], v[80:83], v[160:163]
ds_read_b64_tr_b16 v[60:61], v12 offset:16384
v_mfma_f32_16x16x32_bf16 v[164:167], v[104:107], v[84:87], v[164:167]
ds_read_b64_tr_b16 v[62:63], v12 offset:20480
v_mfma_f32_16x16x32_bf16 v[168:171], v[104:107], v[88:91], v[168:171]
ds_read_b64_tr_b16 v[76:77], v12 offset:32768
v_mfma_f32_16x16x32_bf16 v[172:175], v[104:107], v[92:95], v[172:175]
ds_read_b64_tr_b16 v[78:79], v12 offset:36864
v_mfma_f32_16x16x32_bf16 v[236:239], v[120:123], v[92:95], v[236:239]
v_mfma_f32_16x16x32_bf16 v[232:235], v[120:123], v[88:91], v[232:235]
v_mfma_f32_16x16x32_bf16 v[228:231], v[120:123], v[84:87], v[228:231]
v_mfma_f32_16x16x32_bf16 v[224:227], v[120:123], v[80:83], v[224:227]
v_mfma_f32_16x16x32_bf16 v[176:179], v[108:111], v[80:83], v[176:179]
v_mfma_f32_16x16x32_bf16 v[180:183], v[108:111], v[84:87], v[180:183]
v_mfma_f32_16x16x32_bf16 v[184:187], v[108:111], v[88:91], v[184:187]
v_mfma_f32_16x16x32_bf16 v[188:191], v[108:111], v[92:95], v[188:191]
v_mfma_f32_16x16x32_bf16 v[252:255], v[124:127], v[92:95], v[252:255]
v_mfma_f32_16x16x32_bf16 v[248:251], v[124:127], v[88:91], v[248:251]
v_mfma_f32_16x16x32_bf16 v[244:247], v[124:127], v[84:87], v[244:247]
v_mfma_f32_16x16x32_bf16 v[240:243], v[124:127], v[80:83], v[240:243]
s_mov_b32 s41, 2
.p2align 3
Lk3_91:
s_waitcnt lgkmcnt(0)
v_mfma_f32_16x16x32_bf16 v[128:131], v[48:51], v[32:35], v[128:131]
ds_read_b128 v[80:83], v3 offset:8192
v_mfma_f32_16x16x32_bf16 v[132:135], v[48:51], v[36:39], v[132:135]
ds_read_b64_tr_b16 v[96:97], v9 offset:24576
v_mfma_f32_16x16x32_bf16 v[136:139], v[48:51], v[40:43], v[136:139]
ds_read_b64_tr_b16 v[98:99], v9 offset:28672
v_mfma_f32_16x16x32_bf16 v[140:143], v[48:51], v[44:47], v[140:143]
ds_read_b128 v[84:87], v3 offset:8448
v_mfma_f32_16x16x32_bf16 v[204:207], v[64:67], v[44:47], v[204:207]
ds_read_b128 v[88:91], v3 offset:8704
v_mfma_f32_16x16x32_bf16 v[200:203], v[64:67], v[40:43], v[200:203]
ds_read_b128 v[92:95], v3 offset:8960
v_mfma_f32_16x16x32_bf16 v[196:199], v[64:67], v[36:39], v[196:199]
ds_read_b64_tr_b16 v[112:113], v9 offset:40960
v_mfma_f32_16x16x32_bf16 v[192:195], v[64:67], v[32:35], v[192:195]
ds_read_b64_tr_b16 v[114:115], v9 offset:45056
v_mfma_f32_16x16x32_bf16 v[144:147], v[52:55], v[32:35], v[144:147]
ds_read_b64_tr_b16 v[100:101], v10 offset:24576
v_mfma_f32_16x16x32_bf16 v[148:151], v[52:55], v[36:39], v[148:151]
ds_read_b64_tr_b16 v[102:103], v10 offset:28672
v_mfma_f32_16x16x32_bf16 v[152:155], v[52:55], v[40:43], v[152:155]
ds_read_b64_tr_b16 v[116:117], v10 offset:40960
v_mfma_f32_16x16x32_bf16 v[156:159], v[52:55], v[44:47], v[156:159]
ds_read_b64_tr_b16 v[118:119], v10 offset:45056
v_mfma_f32_16x16x32_bf16 v[220:223], v[68:71], v[44:47], v[220:223]
ds_read_b64_tr_b16 v[104:105], v11 offset:24576
v_mfma_f32_16x16x32_bf16 v[216:219], v[68:71], v[40:43], v[216:219]
ds_read_b64_tr_b16 v[106:107], v11 offset:28672
v_mfma_f32_16x16x32_bf16 v[212:215], v[68:71], v[36:39], v[212:215]
ds_read_b64_tr_b16 v[120:121], v11 offset:40960
v_mfma_f32_16x16x32_bf16 v[208:211], v[68:71], v[32:35], v[208:211]
ds_read_b64_tr_b16 v[122:123], v11 offset:45056
v_mfma_f32_16x16x32_bf16 v[160:163], v[56:59], v[32:35], v[160:163]
ds_read_b64_tr_b16 v[108:109], v12 offset:24576
v_mfma_f32_16x16x32_bf16 v[164:167], v[56:59], v[36:39], v[164:167]
ds_read_b64_tr_b16 v[110:111], v12 offset:28672
v_mfma_f32_16x16x32_bf16 v[168:171], v[56:59], v[40:43], v[168:171]
ds_read_b64_tr_b16 v[124:125], v12 offset:40960
v_mfma_f32_16x16x32_bf16 v[172:175], v[56:59], v[44:47], v[172:175]
ds_read_b64_tr_b16 v[126:127], v12 offset:45056
v_mfma_f32_16x16x32_bf16 v[236:239], v[72:75], v[44:47], v[236:239]
v_mfma_f32_16x16x32_bf16 v[232:235], v[72:75], v[40:43], v[232:235]
v_mfma_f32_16x16x32_bf16 v[228:231], v[72:75], v[36:39], v[228:231]
v_mfma_f32_16x16x32_bf16 v[224:227], v[72:75], v[32:35], v[224:227]
v_mfma_f32_16x16x32_bf16 v[176:179], v[60:63], v[32:35], v[176:179]
v_mfma_f32_16x16x32_bf16 v[180:183], v[60:63], v[36:39], v[180:183]
v_mfma_f32_16x16x32_bf16 v[184:187], v[60:63], v[40:43], v[184:187]
v_mfma_f32_16x16x32_bf16 v[188:191], v[60:63], v[44:47], v[188:191]
v_mfma_f32_16x16x32_bf16 v[252:255], v[76:79], v[44:47], v[252:255]
v_mfma_f32_16x16x32_bf16 v[248:251], v[76:79], v[40:43], v[248:251]
v_mfma_f32_16x16x32_bf16 v[244:247], v[76:79], v[36:39], v[244:247]
v_mfma_f32_16x16x32_bf16 v[240:243], v[76:79], v[32:35], v[240:243]
s_waitcnt lgkmcnt(0)
s_barrier
v_mfma_f32_16x16x32_bf16 v[128:131], v[96:99], v[80:83], v[128:131]
ds_read_b128 v[32:35], v4 offset:0
v_mfma_f32_16x16x32_bf16 v[132:135], v[96:99], v[84:87], v[132:135]
ds_read_b64_tr_b16 v[48:49], v13 offset:16384
v_mfma_f32_16x16x32_bf16 v[136:139], v[96:99], v[88:91], v[136:139]
ds_read_b64_tr_b16 v[50:51], v13 offset:20480
v_mfma_f32_16x16x32_bf16 v[140:143], v[96:99], v[92:95], v[140:143]
ds_read_b128 v[36:39], v4 offset:256
v_mfma_f32_16x16x32_bf16 v[204:207], v[112:115], v[92:95], v[204:207]
ds_read_b128 v[40:43], v4 offset:512
v_mfma_f32_16x16x32_bf16 v[200:203], v[112:115], v[88:91], v[200:203]
ds_read_b128 v[44:47], v4 offset:768
v_mfma_f32_16x16x32_bf16 v[196:199], v[112:115], v[84:87], v[196:199]
ds_read_b64_tr_b16 v[64:65], v13 offset:32768
v_mfma_f32_16x16x32_bf16 v[192:195], v[112:115], v[80:83], v[192:195]
ds_read_b64_tr_b16 v[66:67], v13 offset:36864
v_mfma_f32_16x16x32_bf16 v[144:147], v[100:103], v[80:83], v[144:147]
ds_read_b64_tr_b16 v[52:53], v14 offset:16384
v_mfma_f32_16x16x32_bf16 v[148:151], v[100:103], v[84:87], v[148:151]
ds_read_b64_tr_b16 v[54:55], v14 offset:20480
v_mfma_f32_16x16x32_bf16 v[152:155], v[100:103], v[88:91], v[152:155]
ds_read_b64_tr_b16 v[68:69], v14 offset:32768
v_mfma_f32_16x16x32_bf16 v[156:159], v[100:103], v[92:95], v[156:159]
ds_read_b64_tr_b16 v[70:71], v14 offset:36864
v_mfma_f32_16x16x32_bf16 v[220:223], v[116:119], v[92:95], v[220:223]
ds_read_b64_tr_b16 v[56:57], v15 offset:16384
v_mfma_f32_16x16x32_bf16 v[216:219], v[116:119], v[88:91], v[216:219]
ds_read_b64_tr_b16 v[58:59], v15 offset:20480
v_mfma_f32_16x16x32_bf16 v[212:215], v[116:119], v[84:87], v[212:215]
ds_read_b64_tr_b16 v[72:73], v15 offset:32768
v_mfma_f32_16x16x32_bf16 v[208:211], v[116:119], v[80:83], v[208:211]
ds_read_b64_tr_b16 v[74:75], v15 offset:36864
v_mfma_f32_16x16x32_bf16 v[160:163], v[104:107], v[80:83], v[160:163]
ds_read_b64_tr_b16 v[60:61], v16 offset:16384
v_mfma_f32_16x16x32_bf16 v[164:167], v[104:107], v[84:87], v[164:167]
ds_read_b64_tr_b16 v[62:63], v16 offset:20480
v_mfma_f32_16x16x32_bf16 v[168:171], v[104:107], v[88:91], v[168:171]
ds_read_b64_tr_b16 v[76:77], v16 offset:32768
v_mfma_f32_16x16x32_bf16 v[172:175], v[104:107], v[92:95], v[172:175]
ds_read_b64_tr_b16 v[78:79], v16 offset:36864
v_mfma_f32_16x16x32_bf16 v[236:239], v[120:123], v[92:95], v[236:239]
v_mfma_f32_16x16x32_bf16 v[232:235], v[120:123], v[88:91], v[232:235]
v_mfma_f32_16x16x32_bf16 v[228:231], v[120:123], v[84:87], v[228:231]
v_mfma_f32_16x16x32_bf16 v[224:227], v[120:123], v[80:83], v[224:227]
v_mfma_f32_16x16x32_bf16 v[176:179], v[108:111], v[80:83], v[176:179]
v_mfma_f32_16x16x32_bf16 v[180:183], v[108:111], v[84:87], v[180:183]
v_mfma_f32_16x16x32_bf16 v[184:187], v[108:111], v[88:91], v[184:187]
v_mfma_f32_16x16x32_bf16 v[188:191], v[108:111], v[92:95], v[188:191]
v_mfma_f32_16x16x32_bf16 v[252:255], v[124:127], v[92:95], v[252:255]
v_mfma_f32_16x16x32_bf16 v[248:251], v[124:127], v[88:91], v[248:251]
v_mfma_f32_16x16x32_bf16 v[244:247], v[124:127], v[84:87], v[244:247]
v_mfma_f32_16x16x32_bf16 v[240:243], v[124:127], v[80:83], v[240:243]
s_waitcnt lgkmcnt(0)
v_mfma_f32_16x16x32_bf16 v[128:131], v[48:51], v[32:35], v[128:131]
ds_read_b128 v[80:83], v4 offset:8192
v_mfma_f32_16x16x32_bf16 v[132:135], v[48:51], v[36:39], v[132:135]
ds_read_b64_tr_b16 v[96:97], v13 offset:24576
v_mfma_f32_16x16x32_bf16 v[136:139], v[48:51], v[40:43], v[136:139]
ds_read_b64_tr_b16 v[98:99], v13 offset:28672
v_mfma_f32_16x16x32_bf16 v[140:143], v[48:51], v[44:47], v[140:143]
ds_read_b128 v[84:87], v4 offset:8448
v_mfma_f32_16x16x32_bf16 v[204:207], v[64:67], v[44:47], v[204:207]
ds_read_b128 v[88:91], v4 offset:8704
v_mfma_f32_16x16x32_bf16 v[200:203], v[64:67], v[40:43], v[200:203]
ds_read_b128 v[92:95], v4 offset:8960
v_mfma_f32_16x16x32_bf16 v[196:199], v[64:67], v[36:39], v[196:199]
ds_read_b64_tr_b16 v[112:113], v13 offset:40960
v_mfma_f32_16x16x32_bf16 v[192:195], v[64:67], v[32:35], v[192:195]
ds_read_b64_tr_b16 v[114:115], v13 offset:45056
v_mfma_f32_16x16x32_bf16 v[144:147], v[52:55], v[32:35], v[144:147]
ds_read_b64_tr_b16 v[100:101], v14 offset:24576
v_mfma_f32_16x16x32_bf16 v[148:151], v[52:55], v[36:39], v[148:151]
ds_read_b64_tr_b16 v[102:103], v14 offset:28672
v_mfma_f32_16x16x32_bf16 v[152:155], v[52:55], v[40:43], v[152:155]
ds_read_b64_tr_b16 v[116:117], v14 offset:40960
v_mfma_f32_16x16x32_bf16 v[156:159], v[52:55], v[44:47], v[156:159]
ds_read_b64_tr_b16 v[118:119], v14 offset:45056
v_mfma_f32_16x16x32_bf16 v[220:223], v[68:71], v[44:47], v[220:223]
ds_read_b64_tr_b16 v[104:105], v15 offset:24576
v_mfma_f32_16x16x32_bf16 v[216:219], v[68:71], v[40:43], v[216:219]
ds_read_b64_tr_b16 v[106:107], v15 offset:28672
v_mfma_f32_16x16x32_bf16 v[212:215], v[68:71], v[36:39], v[212:215]
ds_read_b64_tr_b16 v[120:121], v15 offset:40960
v_mfma_f32_16x16x32_bf16 v[208:211], v[68:71], v[32:35], v[208:211]
ds_read_b64_tr_b16 v[122:123], v15 offset:45056
v_mfma_f32_16x16x32_bf16 v[160:163], v[56:59], v[32:35], v[160:163]
ds_read_b64_tr_b16 v[108:109], v16 offset:24576
v_mfma_f32_16x16x32_bf16 v[164:167], v[56:59], v[36:39], v[164:167]
ds_read_b64_tr_b16 v[110:111], v16 offset:28672
v_mfma_f32_16x16x32_bf16 v[168:171], v[56:59], v[40:43], v[168:171]
ds_read_b64_tr_b16 v[124:125], v16 offset:40960
v_mfma_f32_16x16x32_bf16 v[172:175], v[56:59], v[44:47], v[172:175]
ds_read_b64_tr_b16 v[126:127], v16 offset:45056
v_mfma_f32_16x16x32_bf16 v[236:239], v[72:75], v[44:47], v[236:239]
v_mfma_f32_16x16x32_bf16 v[232:235], v[72:75], v[40:43], v[232:235]
v_mfma_f32_16x16x32_bf16 v[228:231], v[72:75], v[36:39], v[228:231]
v_mfma_f32_16x16x32_bf16 v[224:227], v[72:75], v[32:35], v[224:227]
v_mfma_f32_16x16x32_bf16 v[176:179], v[60:63], v[32:35], v[176:179]
v_mfma_f32_16x16x32_bf16 v[180:183], v[60:63], v[36:39], v[180:183]
v_mfma_f32_16x16x32_bf16 v[184:187], v[60:63], v[40:43], v[184:187]
v_mfma_f32_16x16x32_bf16 v[188:191], v[60:63], v[44:47], v[188:191]
v_mfma_f32_16x16x32_bf16 v[252:255], v[76:79], v[44:47], v[252:255]
v_mfma_f32_16x16x32_bf16 v[248:251], v[76:79], v[40:43], v[248:251]
v_mfma_f32_16x16x32_bf16 v[244:247], v[76:79], v[36:39], v[244:247]
v_mfma_f32_16x16x32_bf16 v[240:243], v[76:79], v[32:35], v[240:243]
s_waitcnt lgkmcnt(0)
s_barrier
v_mfma_f32_16x16x32_bf16 v[128:131], v[96:99], v[80:83], v[128:131]
ds_read_b128 v[32:35], v2 offset:0
v_mfma_f32_16x16x32_bf16 v[132:135], v[96:99], v[84:87], v[132:135]
ds_read_b64_tr_b16 v[48:49], v5 offset:16384
v_mfma_f32_16x16x32_bf16 v[136:139], v[96:99], v[88:91], v[136:139]
ds_read_b64_tr_b16 v[50:51], v5 offset:20480
v_mfma_f32_16x16x32_bf16 v[140:143], v[96:99], v[92:95], v[140:143]
ds_read_b128 v[36:39], v2 offset:256
v_mfma_f32_16x16x32_bf16 v[204:207], v[112:115], v[92:95], v[204:207]
ds_read_b128 v[40:43], v2 offset:512
v_mfma_f32_16x16x32_bf16 v[200:203], v[112:115], v[88:91], v[200:203]
ds_read_b128 v[44:47], v2 offset:768
v_mfma_f32_16x16x32_bf16 v[196:199], v[112:115], v[84:87], v[196:199]
ds_read_b64_tr_b16 v[64:65], v5 offset:32768
v_mfma_f32_16x16x32_bf16 v[192:195], v[112:115], v[80:83], v[192:195]
ds_read_b64_tr_b16 v[66:67], v5 offset:36864
v_mfma_f32_16x16x32_bf16 v[144:147], v[100:103], v[80:83], v[144:147]
ds_read_b64_tr_b16 v[52:53], v6 offset:16384
v_mfma_f32_16x16x32_bf16 v[148:151], v[100:103], v[84:87], v[148:151]
ds_read_b64_tr_b16 v[54:55], v6 offset:20480
v_mfma_f32_16x16x32_bf16 v[152:155], v[100:103], v[88:91], v[152:155]
ds_read_b64_tr_b16 v[68:69], v6 offset:32768
v_mfma_f32_16x16x32_bf16 v[156:159], v[100:103], v[92:95], v[156:159]
ds_read_b64_tr_b16 v[70:71], v6 offset:36864
v_mfma_f32_16x16x32_bf16 v[220:223], v[116:119], v[92:95], v[220:223]
ds_read_b64_tr_b16 v[56:57], v7 offset:16384
v_mfma_f32_16x16x32_bf16 v[216:219], v[116:119], v[88:91], v[216:219]
ds_read_b64_tr_b16 v[58:59], v7 offset:20480
v_mfma_f32_16x16x32_bf16 v[212:215], v[116:119], v[84:87], v[212:215]
ds_read_b64_tr_b16 v[72:73], v7 offset:32768
v_mfma_f32_16x16x32_bf16 v[208:211], v[116:119], v[80:83], v[208:211]
ds_read_b64_tr_b16 v[74:75], v7 offset:36864
v_mfma_f32_16x16x32_bf16 v[160:163], v[104:107], v[80:83], v[160:163]
ds_read_b64_tr_b16 v[60:61], v8 offset:16384
v_mfma_f32_16x16x32_bf16 v[164:167], v[104:107], v[84:87], v[164:167]
ds_read_b64_tr_b16 v[62:63], v8 offset:20480
v_mfma_f32_16x16x32_bf16 v[168:171], v[104:107], v[88:91], v[168:171]
ds_read_b64_tr_b16 v[76:77], v8 offset:32768
v_mfma_f32_16x16x32_bf16 v[172:175], v[104:107], v[92:95], v[172:175]
ds_read_b64_tr_b16 v[78:79], v8 offset:36864
v_mfma_f32_16x16x32_bf16 v[236:239], v[120:123], v[92:95], v[236:239]
v_mfma_f32_16x16x32_bf16 v[232:235], v[120:123], v[88:91], v[232:235]
v_mfma_f32_16x16x32_bf16 v[228:231], v[120:123], v[84:87], v[228:231]
v_mfma_f32_16x16x32_bf16 v[224:227], v[120:123], v[80:83], v[224:227]
v_mfma_f32_16x16x32_bf16 v[176:179], v[108:111], v[80:83], v[176:179]
v_mfma_f32_16x16x32_bf16 v[180:183], v[108:111], v[84:87], v[180:183]
v_mfma_f32_16x16x32_bf16 v[184:187], v[108:111], v[88:91], v[184:187]
v_mfma_f32_16x16x32_bf16 v[188:191], v[108:111], v[92:95], v[188:191]
v_mfma_f32_16x16x32_bf16 v[252:255], v[124:127], v[92:95], v[252:255]
v_mfma_f32_16x16x32_bf16 v[248:251], v[124:127], v[88:91], v[248:251]
v_mfma_f32_16x16x32_bf16 v[244:247], v[124:127], v[84:87], v[244:247]
v_mfma_f32_16x16x32_bf16 v[240:243], v[124:127], v[80:83], v[240:243]
s_waitcnt lgkmcnt(0)
v_mfma_f32_16x16x32_bf16 v[128:131], v[48:51], v[32:35], v[128:131]
ds_read_b128 v[80:83], v2 offset:8192
v_mfma_f32_16x16x32_bf16 v[132:135], v[48:51], v[36:39], v[132:135]
ds_read_b64_tr_b16 v[96:97], v5 offset:24576
v_mfma_f32_16x16x32_bf16 v[136:139], v[48:51], v[40:43], v[136:139]
ds_read_b64_tr_b16 v[98:99], v5 offset:28672
v_mfma_f32_16x16x32_bf16 v[140:143], v[48:51], v[44:47], v[140:143]
ds_read_b128 v[84:87], v2 offset:8448
v_mfma_f32_16x16x32_bf16 v[204:207], v[64:67], v[44:47], v[204:207]
ds_read_b128 v[88:91], v2 offset:8704
v_mfma_f32_16x16x32_bf16 v[200:203], v[64:67], v[40:43], v[200:203]
ds_read_b128 v[92:95], v2 offset:8960
v_mfma_f32_16x16x32_bf16 v[196:199], v[64:67], v[36:39], v[196:199]
ds_read_b64_tr_b16 v[112:113], v5 offset:40960
v_mfma_f32_16x16x32_bf16 v[192:195], v[64:67], v[32:35], v[192:195]
ds_read_b64_tr_b16 v[114:115], v5 offset:45056
v_mfma_f32_16x16x32_bf16 v[144:147], v[52:55], v[32:35], v[144:147]
ds_read_b64_tr_b16 v[100:101], v6 offset:24576
v_mfma_f32_16x16x32_bf16 v[148:151], v[52:55], v[36:39], v[148:151]
ds_read_b64_tr_b16 v[102:103], v6 offset:28672
v_mfma_f32_16x16x32_bf16 v[152:155], v[52:55], v[40:43], v[152:155]
ds_read_b64_tr_b16 v[116:117], v6 offset:40960
v_mfma_f32_16x16x32_bf16 v[156:159], v[52:55], v[44:47], v[156:159]
ds_read_b64_tr_b16 v[118:119], v6 offset:45056
v_mfma_f32_16x16x32_bf16 v[220:223], v[68:71], v[44:47], v[220:223]
ds_read_b64_tr_b16 v[104:105], v7 offset:24576
v_mfma_f32_16x16x32_bf16 v[216:219], v[68:71], v[40:43], v[216:219]
ds_read_b64_tr_b16 v[106:107], v7 offset:28672
v_mfma_f32_16x16x32_bf16 v[212:215], v[68:71], v[36:39], v[212:215]
ds_read_b64_tr_b16 v[120:121], v7 offset:40960
v_mfma_f32_16x16x32_bf16 v[208:211], v[68:71], v[32:35], v[208:211]
ds_read_b64_tr_b16 v[122:123], v7 offset:45056
v_mfma_f32_16x16x32_bf16 v[160:163], v[56:59], v[32:35], v[160:163]
ds_read_b64_tr_b16 v[108:109], v8 offset:24576
v_mfma_f32_16x16x32_bf16 v[164:167], v[56:59], v[36:39], v[164:167]
ds_read_b64_tr_b16 v[110:111], v8 offset:28672
v_mfma_f32_16x16x32_bf16 v[168:171], v[56:59], v[40:43], v[168:171]
ds_read_b64_tr_b16 v[124:125], v8 offset:40960
v_mfma_f32_16x16x32_bf16 v[172:175], v[56:59], v[44:47], v[172:175]
ds_read_b64_tr_b16 v[126:127], v8 offset:45056
v_mfma_f32_16x16x32_bf16 v[236:239], v[72:75], v[44:47], v[236:239]
v_mfma_f32_16x16x32_bf16 v[232:235], v[72:75], v[40:43], v[232:235]
v_mfma_f32_16x16x32_bf16 v[228:231], v[72:75], v[36:39], v[228:231]
v_mfma_f32_16x16x32_bf16 v[224:227], v[72:75], v[32:35], v[224:227]
v_mfma_f32_16x16x32_bf16 v[176:179], v[60:63], v[32:35], v[176:179]
v_mfma_f32_16x16x32_bf16 v[180:183], v[60:63], v[36:39], v[180:183]
v_mfma_f32_16x16x32_bf16 v[184:187], v[60:63], v[40:43], v[184:187]
v_mfma_f32_16x16x32_bf16 v[188:191], v[60:63], v[44:47], v[188:191]
v_mfma_f32_16x16x32_bf16 v[252:255], v[76:79], v[44:47], v[252:255]
v_mfma_f32_16x16x32_bf16 v[248:251], v[76:79], v[40:43], v[248:251]
v_mfma_f32_16x16x32_bf16 v[244:247], v[76:79], v[36:39], v[244:247]
v_mfma_f32_16x16x32_bf16 v[240:243], v[76:79], v[32:35], v[240:243]
s_waitcnt lgkmcnt(0)
s_barrier
v_mfma_f32_16x16x32_bf16 v[128:131], v[96:99], v[80:83], v[128:131]
ds_read_b128 v[32:35], v3 offset:0
v_mfma_f32_16x16x32_bf16 v[132:135], v[96:99], v[84:87], v[132:135]
ds_read_b64_tr_b16 v[48:49], v9 offset:16384
v_mfma_f32_16x16x32_bf16 v[136:139], v[96:99], v[88:91], v[136:139]
ds_read_b64_tr_b16 v[50:51], v9 offset:20480
v_mfma_f32_16x16x32_bf16 v[140:143], v[96:99], v[92:95], v[140:143]
ds_read_b128 v[36:39], v3 offset:256
v_mfma_f32_16x16x32_bf16 v[204:207], v[112:115], v[92:95], v[204:207]
ds_read_b128 v[40:43], v3 offset:512
v_mfma_f32_16x16x32_bf16 v[200:203], v[112:115], v[88:91], v[200:203]
ds_read_b128 v[44:47], v3 offset:768
v_mfma_f32_16x16x32_bf16 v[196:199], v[112:115], v[84:87], v[196:199]
ds_read_b64_tr_b16 v[64:65], v9 offset:32768
v_mfma_f32_16x16x32_bf16 v[192:195], v[112:115], v[80:83], v[192:195]
ds_read_b64_tr_b16 v[66:67], v9 offset:36864
v_mfma_f32_16x16x32_bf16 v[144:147], v[100:103], v[80:83], v[144:147]
ds_read_b64_tr_b16 v[52:53], v10 offset:16384
v_mfma_f32_16x16x32_bf16 v[148:151], v[100:103], v[84:87], v[148:151]
ds_read_b64_tr_b16 v[54:55], v10 offset:20480
v_mfma_f32_16x16x32_bf16 v[152:155], v[100:103], v[88:91], v[152:155]
ds_read_b64_tr_b16 v[68:69], v10 offset:32768
v_mfma_f32_16x16x32_bf16 v[156:159], v[100:103], v[92:95], v[156:159]
ds_read_b64_tr_b16 v[70:71], v10 offset:36864
v_mfma_f32_16x16x32_bf16 v[220:223], v[116:119], v[92:95], v[220:223]
ds_read_b64_tr_b16 v[56:57], v11 offset:16384
v_mfma_f32_16x16x32_bf16 v[216:219], v[116:119], v[88:91], v[216:219]
ds_read_b64_tr_b16 v[58:59], v11 offset:20480
v_mfma_f32_16x16x32_bf16 v[212:215], v[116:119], v[84:87], v[212:215]
ds_read_b64_tr_b16 v[72:73], v11 offset:32768
v_mfma_f32_16x16x32_bf16 v[208:211], v[116:119], v[80:83], v[208:211]
ds_read_b64_tr_b16 v[74:75], v11 offset:36864
v_mfma_f32_16x16x32_bf16 v[160:163], v[104:107], v[80:83], v[160:163]
ds_read_b64_tr_b16 v[60:61], v12 offset:16384
v_mfma_f32_16x16x32_bf16 v[164:167], v[104:107], v[84:87], v[164:167]
ds_read_b64_tr_b16 v[62:63], v12 offset:20480
v_mfma_f32_16x16x32_bf16 v[168:171], v[104:107], v[88:91], v[168:171]
ds_read_b64_tr_b16 v[76:77], v12 offset:32768
v_mfma_f32_16x16x32_bf16 v[172:175], v[104:107], v[92:95], v[172:175]
ds_read_b64_tr_b16 v[78:79], v12 offset:36864
v_mfma_f32_16x16x32_bf16 v[236:239], v[120:123], v[92:95], v[236:239]
v_mfma_f32_16x16x32_bf16 v[232:235], v[120:123], v[88:91], v[232:235]
v_mfma_f32_16x16x32_bf16 v[228:231], v[120:123], v[84:87], v[228:231]
v_mfma_f32_16x16x32_bf16 v[224:227], v[120:123], v[80:83], v[224:227]
v_mfma_f32_16x16x32_bf16 v[176:179], v[108:111], v[80:83], v[176:179]
v_mfma_f32_16x16x32_bf16 v[180:183], v[108:111], v[84:87], v[180:183]
v_mfma_f32_16x16x32_bf16 v[184:187], v[108:111], v[88:91], v[184:187]
v_mfma_f32_16x16x32_bf16 v[188:191], v[108:111], v[92:95], v[188:191]
v_mfma_f32_16x16x32_bf16 v[252:255], v[124:127], v[92:95], v[252:255]
v_mfma_f32_16x16x32_bf16 v[248:251], v[124:127], v[88:91], v[248:251]
v_mfma_f32_16x16x32_bf16 v[244:247], v[124:127], v[84:87], v[244:247]
v_mfma_f32_16x16x32_bf16 v[240:243], v[124:127], v[80:83], v[240:243]
s_sub_u32 s41, s41, 1
s_cmp_lg_u32 s41, 0
s_cbranch_scc1 Lk3_91
s_waitcnt lgkmcnt(0)
v_mfma_f32_16x16x32_bf16 v[128:131], v[48:51], v[32:35], v[128:131]
ds_read_b128 v[80:83], v3 offset:8192
v_mfma_f32_16x16x32_bf16 v[132:135], v[48:51], v[36:39], v[132:135]
ds_read_b64_tr_b16 v[96:97], v9 offset:24576
v_mfma_f32_16x16x32_bf16 v[136:139], v[48:51], v[40:43], v[136:139]
ds_read_b64_tr_b16 v[98:99], v9 offset:28672
v_mfma_f32_16x16x32_bf16 v[140:143], v[48:51], v[44:47], v[140:143]
ds_read_b128 v[84:87], v3 offset:8448
v_mfma_f32_16x16x32_bf16 v[204:207], v[64:67], v[44:47], v[204:207]
ds_read_b128 v[88:91], v3 offset:8704
v_mfma_f32_16x16x32_bf16 v[200:203], v[64:67], v[40:43], v[200:203]
ds_read_b128 v[92:95], v3 offset:8960
v_mfma_f32_16x16x32_bf16 v[196:199], v[64:67], v[36:39], v[196:199]
ds_read_b64_tr_b16 v[112:113], v9 offset:40960
v_mfma_f32_16x16x32_bf16 v[192:195], v[64:67], v[32:35], v[192:195]
ds_read_b64_tr_b16 v[114:115], v9 offset:45056
v_mfma_f32_16x16x32_bf16 v[144:147], v[52:55], v[32:35], v[144:147]
ds_read_b64_tr_b16 v[100:101], v10 offset:24576
v_mfma_f32_16x16x32_bf16 v[148:151], v[52:55], v[36:39], v[148:151]
ds_read_b64_tr_b16 v[102:103], v10 offset:28672
v_mfma_f32_16x16x32_bf16 v[152:155], v[52:55], v[40:43], v[152:155]
ds_read_b64_tr_b16 v[116:117], v10 offset:40960
v_mfma_f32_16x16x32_bf16 v[156:159], v[52:55], v[44:47], v[156:159]
ds_read_b64_tr_b16 v[118:119], v10 offset:45056
v_mfma_f32_16x16x32_bf16 v[220:223], v[68:71], v[44:47], v[220:223]
ds_read_b64_tr_b16 v[104:105], v11 offset:24576
v_mfma_f32_16x16x32_bf16 v[216:219], v[68:71], v[40:43], v[216:219]
ds_read_b64_tr_b16 v[106:107], v11 offset:28672
v_mfma_f32_16x16x32_bf16 v[212:215], v[68:71], v[36:39], v[212:215]
ds_read_b64_tr_b16 v[120:121], v11 offset:40960
v_mfma_f32_16x16x32_bf16 v[208:211], v[68:71], v[32:35], v[208:211]
ds_read_b64_tr_b16 v[122:123], v11 offset:45056
v_mfma_f32_16x16x32_bf16 v[160:163], v[56:59], v[32:35], v[160:163]
ds_read_b64_tr_b16 v[108:109], v12 offset:24576
v_mfma_f32_16x16x32_bf16 v[164:167], v[56:59], v[36:39], v[164:167]
ds_read_b64_tr_b16 v[110:111], v12 offset:28672
v_mfma_f32_16x16x32_bf16 v[168:171], v[56:59], v[40:43], v[168:171]
ds_read_b64_tr_b16 v[124:125], v12 offset:40960
v_mfma_f32_16x16x32_bf16 v[172:175], v[56:59], v[44:47], v[172:175]
ds_read_b64_tr_b16 v[126:127], v12 offset:45056
v_mfma_f32_16x16x32_bf16 v[236:239], v[72:75], v[44:47], v[236:239]
v_mfma_f32_16x16x32_bf16 v[232:235], v[72:75], v[40:43], v[232:235]
v_mfma_f32_16x16x32_bf16 v[228:231], v[72:75], v[36:39], v[228:231]
v_mfma_f32_16x16x32_bf16 v[224:227], v[72:75], v[32:35], v[224:227]
v_mfma_f32_16x16x32_bf16 v[176:179], v[60:63], v[32:35], v[176:179]
v_mfma_f32_16x16x32_bf16 v[180:183], v[60:63], v[36:39], v[180:183]
v_mfma_f32_16x16x32_bf16 v[184:187], v[60:63], v[40:43], v[184:187]
v_mfma_f32_16x16x32_bf16 v[188:191], v[60:63], v[44:47], v[188:191]
v_mfma_f32_16x16x32_bf16 v[252:255], v[76:79], v[44:47], v[252:255]
v_mfma_f32_16x16x32_bf16 v[248:251], v[76:79], v[40:43], v[248:251]
v_mfma_f32_16x16x32_bf16 v[244:247], v[76:79], v[36:39], v[244:247]
v_mfma_f32_16x16x32_bf16 v[240:243], v[76:79], v[32:35], v[240:243]
s_waitcnt lgkmcnt(0)
s_barrier
v_mfma_f32_16x16x32_bf16 v[128:131], v[96:99], v[80:83], v[128:131]
ds_read_b128 v[32:35], v4 offset:0
v_mfma_f32_16x16x32_bf16 v[132:135], v[96:99], v[84:87], v[132:135]
ds_read_b64_tr_b16 v[48:49], v13 offset:16384
v_mfma_f32_16x16x32_bf16 v[136:139], v[96:99], v[88:91], v[136:139]
ds_read_b64_tr_b16 v[50:51], v13 offset:20480
v_mfma_f32_16x16x32_bf16 v[140:143], v[96:99], v[92:95], v[140:143]
ds_read_b128 v[36:39], v4 offset:256
v_mfma_f32_16x16x32_bf16 v[204:207], v[112:115], v[92:95], v[204:207]
ds_read_b128 v[40:43], v4 offset:512
v_mfma_f32_16x16x32_bf16 v[200:203], v[112:115], v[88:91], v[200:203]
ds_read_b128 v[44:47], v4 offset:768
v_mfma_f32_16x16x32_bf16 v[196:199], v[112:115], v[84:87], v[196:199]
ds_read_b64_tr_b16 v[64:65], v13 offset:32768
v_mfma_f32_16x16x32_bf16 v[192:195], v[112:115], v[80:83], v[192:195]
ds_read_b64_tr_b16 v[66:67], v13 offset:36864
v_mfma_f32_16x16x32_bf16 v[144:147], v[100:103], v[80:83], v[144:147]
ds_read_b64_tr_b16 v[52:53], v14 offset:16384
v_mfma_f32_16x16x32_bf16 v[148:151], v[100:103], v[84:87], v[148:151]
ds_read_b64_tr_b16 v[54:55], v14 offset:20480
v_mfma_f32_16x16x32_bf16 v[152:155], v[100:103], v[88:91], v[152:155]
ds_read_b64_tr_b16 v[68:69], v14 offset:32768
v_mfma_f32_16x16x32_bf16 v[156:159], v[100:103], v[92:95], v[156:159]
ds_read_b64_tr_b16 v[70:71], v14 offset:36864
v_mfma_f32_16x16x32_bf16 v[220:223], v[116:119], v[92:95], v[220:223]
ds_read_b64_tr_b16 v[56:57], v15 offset:16384
v_mfma_f32_16x16x32_bf16 v[216:219], v[116:119], v[88:91], v[216:219]
ds_read_b64_tr_b16 v[58:59], v15 offset:20480
v_mfma_f32_16x16x32_bf16 v[212:215], v[116:119], v[84:87], v[212:215]
ds_read_b64_tr_b16 v[72:73], v15 offset:32768
v_mfma_f32_16x16x32_bf16 v[208:211], v[116:119], v[80:83], v[208:211]
ds_read_b64_tr_b16 v[74:75], v15 offset:36864
v_mfma_f32_16x16x32_bf16 v[160:163], v[104:107], v[80:83], v[160:163]
ds_read_b64_tr_b16 v[60:61], v16 offset:16384
v_mfma_f32_16x16x32_bf16 v[164:167], v[104:107], v[84:87], v[164:167]
ds_read_b64_tr_b16 v[62:63], v16 offset:20480
v_mfma_f32_16x16x32_bf16 v[168:171], v[104:107], v[88:91], v[168:171]
ds_read_b64_tr_b16 v[76:77], v16 offset:32768
v_mfma_f32_16x16x32_bf16 v[172:175], v[104:107], v[92:95], v[172:175]
ds_read_b64_tr_b16 v[78:79], v16 offset:36864
v_mfma_f32_16x16x32_bf16 v[236:239], v[120:123], v[92:95], v[236:239]
v_mfma_f32_16x16x32_bf16 v[232:235], v[120:123], v[88:91], v[232:235]
v_mfma_f32_16x16x32_bf16 v[228:231], v[120:123], v[84:87], v[228:231]
v_mfma_f32_16x16x32_bf16 v[224:227], v[120:123], v[80:83], v[224:227]
v_mfma_f32_16x16x32_bf16 v[176:179], v[108:111], v[80:83], v[176:179]
v_mfma_f32_16x16x32_bf16 v[180:183], v[108:111], v[84:87], v[180:183]
v_mfma_f32_16x16x32_bf16 v[184:187], v[108:111], v[88:91], v[184:187]
v_mfma_f32_16x16x32_bf16 v[188:191], v[108:111], v[92:95], v[188:191]
v_mfma_f32_16x16x32_bf16 v[252:255], v[124:127], v[92:95], v[252:255]
v_mfma_f32_16x16x32_bf16 v[248:251], v[124:127], v[88:91], v[248:251]
v_mfma_f32_16x16x32_bf16 v[244:247], v[124:127], v[84:87], v[244:247]
v_mfma_f32_16x16x32_bf16 v[240:243], v[124:127], v[80:83], v[240:243]
s_waitcnt lgkmcnt(0)
v_mfma_f32_16x16x32_bf16 v[128:131], v[48:51], v[32:35], v[128:131]
ds_read_b128 v[80:83], v4 offset:8192
v_mfma_f32_16x16x32_bf16 v[132:135], v[48:51], v[36:39], v[132:135]
ds_read_b64_tr_b16 v[96:97], v13 offset:24576
v_mfma_f32_16x16x32_bf16 v[136:139], v[48:51], v[40:43], v[136:139]
ds_read_b64_tr_b16 v[98:99], v13 offset:28672
v_mfma_f32_16x16x32_bf16 v[140:143], v[48:51], v[44:47], v[140:143]
ds_read_b128 v[84:87], v4 offset:8448
v_mfma_f32_16x16x32_bf16 v[204:207], v[64:67], v[44:47], v[204:207]
ds_read_b128 v[88:91], v4 offset:8704
v_mfma_f32_16x16x32_bf16 v[200:203], v[64:67], v[40:43], v[200:203]
ds_read_b128 v[92:95], v4 offset:8960
v_mfma_f32_16x16x32_bf16 v[196:199], v[64:67], v[36:39], v[196:199]
ds_read_b64_tr_b16 v[112:113], v13 offset:40960
v_mfma_f32_16x16x32_bf16 v[192:195], v[64:67], v[32:35], v[192:195]
ds_read_b64_tr_b16 v[114:115], v13 offset:45056
v_mfma_f32_16x16x32_bf16 v[144:147], v[52:55], v[32:35], v[144:147]
ds_read_b64_tr_b16 v[100:101], v14 offset:24576
v_mfma_f32_16x16x32_bf16 v[148:151], v[52:55], v[36:39], v[148:151]
ds_read_b64_tr_b16 v[102:103], v14 offset:28672
v_mfma_f32_16x16x32_bf16 v[152:155], v[52:55], v[40:43], v[152:155]
ds_read_b64_tr_b16 v[116:117], v14 offset:40960
v_mfma_f32_16x16x32_bf16 v[156:159], v[52:55], v[44:47], v[156:159]
ds_read_b64_tr_b16 v[118:119], v14 offset:45056
v_mfma_f32_16x16x32_bf16 v[220:223], v[68:71], v[44:47], v[220:223]
ds_read_b64_tr_b16 v[104:105], v15 offset:24576
v_mfma_f32_16x16x32_bf16 v[216:219], v[68:71], v[40:43], v[216:219]
ds_read_b64_tr_b16 v[106:107], v15 offset:28672
v_mfma_f32_16x16x32_bf16 v[212:215], v[68:71], v[36:39], v[212:215]
ds_read_b64_tr_b16 v[120:121], v15 offset:40960
v_mfma_f32_16x16x32_bf16 v[208:211], v[68:71], v[32:35], v[208:211]
ds_read_b64_tr_b16 v[122:123], v15 offset:45056
v_mfma_f32_16x16x32_bf16 v[160:163], v[56:59], v[32:35], v[160:163]
ds_read_b64_tr_b16 v[108:109], v16 offset:24576
v_mfma_f32_16x16x32_bf16 v[164:167], v[56:59], v[36:39], v[164:167]
ds_read_b64_tr_b16 v[110:111], v16 offset:28672
v_mfma_f32_16x16x32_bf16 v[168:171], v[56:59], v[40:43], v[168:171]
ds_read_b64_tr_b16 v[124:125], v16 offset:40960
v_mfma_f32_16x16x32_bf16 v[172:175], v[56:59], v[44:47], v[172:175]
ds_read_b64_tr_b16 v[126:127], v16 offset:45056
v_mfma_f32_16x16x32_bf16 v[236:239], v[72:75], v[44:47], v[236:239]
v_mfma_f32_16x16x32_bf16 v[232:235], v[72:75], v[40:43], v[232:235]
v_mfma_f32_16x16x32_bf16 v[228:231], v[72:75], v[36:39], v[228:231]
v_mfma_f32_16x16x32_bf16 v[224:227], v[72:75], v[32:35], v[224:227]
v_mfma_f32_16x16x32_bf16 v[176:179], v[60:63], v[32:35], v[176:179]
v_mfma_f32_16x16x32_bf16 v[180:183], v[60:63], v[36:39], v[180:183]
v_mfma_f32_16x16x32_bf16 v[184:187], v[60:63], v[40:43], v[184:187]
v_mfma_f32_16x16x32_bf16 v[188:191], v[60:63], v[44:47], v[188:191]
v_mfma_f32_16x16x32_bf16 v[252:255], v[76:79], v[44:47], v[252:255]
v_mfma_f32_16x16x32_bf16 v[248:251], v[76:79], v[40:43], v[248:251]
v_mfma_f32_16x16x32_bf16 v[244:247], v[76:79], v[36:39], v[244:247]
v_mfma_f32_16x16x32_bf16 v[240:243], v[76:79], v[32:35], v[240:243]
s_waitcnt lgkmcnt(0)
s_barrier
s_cmp_eq_u32 s36, 3
s_cbranch_scc1 L3h_92
s_add_u32 s42, s42, 1
s_and_b32 s42, s42, 15
s_add_u32 m0, s39, 98304
s_mul_i32 s37, s42, s40
buffer_load_dwordx4 v22, s[8:11], s37 offen sc1 lds
v_mfma_f32_16x16x32_bf16 v[128:131], v[96:99], v[80:83], v[128:131]
s_lshl_b32 s43, s46, 9
v_mfma_f32_16x16x32_bf16 v[132:135], v[96:99], v[84:87], v[132:135]
s_add_u32 s43, s43, 147456
s_add_u32 m0, s39, 99328
s_add_u32 s37, s37, s38
buffer_load_dwordx4 v23, s[8:11], s37 offen sc1 lds
v_mfma_f32_16x16x32_bf16 v[136:139], v[96:99], v[88:91], v[136:139]
v_lshl_add_u32 v19, v17, 3, s43
v_mfma_f32_16x16x32_bf16 v[140:143], v[96:99], v[92:95], v[140:143]
s_add_u32 m0, s39, 100352
s_add_u32 s37, s37, s38
buffer_load_dwordx4 v22, s[8:11], s37 offen sc1 lds
ds_read_b64 v[2:3], v19 offset:0
v_mfma_f32_16x16x32_bf16 v[204:207], v[112:115], v[92:95], v[204:207]
ds_read_b64 v[4:5], v19 offset:128
s_add_u32 m0, s39, 101376
s_add_u32 s37, s37, s38
buffer_load_dwordx4 v23, s[8:11], s37 offen sc1 lds
v_mfma_f32_16x16x32_bf16 v[200:203], v[112:115], v[88:91], v[200:203]
ds_read_b64 v[6:7], v19 offset:256
v_mfma_f32_16x16x32_bf16 v[196:199], v[112:115], v[84:87], v[196:199]
s_add_u32 m0, s39, 102400
s_add_u32 s37, s37, s38
buffer_load_dwordx4 v22, s[8:11], s37 offen sc1 lds
ds_read_b64 v[8:9], v19 offset:384
v_mfma_f32_16x16x32_bf16 v[192:195], v[112:115], v[80:83], v[192:195]
s_mul_i32 s43, s47, 256
s_add_u32 m0, s39, 103424
s_add_u32 s37, s37, s38
buffer_load_dwordx4 v23, s[8:11], s37 offen sc1 lds
v_mfma_f32_16x16x32_bf16 v[144:147], v[100:103], v[80:83], v[144:147]
s_add_u32 s43, s43, 148480
v_mfma_f32_16x16x32_bf16 v[148:151], v[100:103], v[84:87], v[148:151]
s_add_u32 m0, s39, 104448
s_add_u32 s37, s37, s38
buffer_load_dwordx4 v22, s[8:11], s37 offen sc1 lds
v_lshl_add_u32 v19, v18, 4, s43
v_mfma_f32_16x16x32_bf16 v[152:155], v[100:103], v[88:91], v[152:155]
ds_read_b128 v[48:51], v19 offset:0
s_add_u32 m0, s39, 105472
s_add_u32 s37, s37, s38
buffer_load_dwordx4 v23, s[8:11], s37 offen sc1 lds
v_mfma_f32_16x16x32_bf16 v[156:159], v[100:103], v[92:95], v[156:159]
ds_read_b128 v[52:55], v19 offset:64
v_mfma_f32_16x16x32_bf16 v[220:223], v[116:119], v[92:95], v[220:223]
s_add_u32 m0, s39, 106496
s_add_u32 s37, s37, s38
buffer_load_dwordx4 v22, s[8:11], s37 offen sc1 lds
ds_read_b128 v[56:59], v19 offset:128
v_mfma_f32_16x16x32_bf16 v[216:219], v[116:119], v[88:91], v[216:219]
ds_read_b128 v[60:63], v19 offset:192
v_mfma_f32_16x16x32_bf16 v[212:215], v[116:119], v[84:87], v[212:215]
s_add_u32 m0, s39, 107520
s_add_u32 s37, s37, s38
buffer_load_dwordx4 v23, s[8:11], s37 offen sc1 lds
ds_read_b128 v[64:67], v19 offset:896
v_mfma_f32_16x16x32_bf16 v[208:211], v[116:119], v[80:83], v[208:211]
ds_read_b128 v[68:71], v19 offset:960
s_add_u32 m0, s39, 108544
s_add_u32 s37, s37, s38
buffer_load_dwordx4 v22, s[8:11], s37 offen sc1 lds
v_mfma_f32_16x16x32_bf16 v[160:163], v[104:107], v[80:83], v[160:163]
ds_read_b128 v[72:75], v19 offset:1024
v_mfma_f32_16x16x32_bf16 v[164:167], v[104:107], v[84:87], v[164:167]
s_add_u32 m0, s39, 109568
s_add_u32 s37, s37, s38
buffer_load_dwordx4 v23, s[8:11], s37 offen sc1 lds
ds_read_b128 v[76:79], v19 offset:1088
v_mfma_f32_16x16x32_bf16 v[168:171], v[104:107], v[88:91], v[168:171]
v_mfma_f32_16x16x32_bf16 v[172:175], v[104:107], v[92:95], v[172:175]
s_add_u32 m0, s39, 110592
s_add_u32 s37, s37, s38
buffer_load_dwordx4 v22, s[8:11], s37 offen sc1 lds
v_mfma_f32_16x16x32_bf16 v[236:239], v[120:123], v[92:95], v[236:239]
v_mfma_f32_16x16x32_bf16 v[232:235], v[120:123], v[88:91], v[232:235]
v_mfma_f32_16x16x32_bf16 v[228:231], v[120:123], v[84:87], v[228:231]
s_add_u32 m0, s39, 111616
s_add_u32 s37, s37, s38
buffer_load_dwordx4 v23, s[8:11], s37 offen sc1 lds
v_mfma_f32_16x16x32_bf16 v[224:227], v[120:123], v[80:83], v[224:227]
v_mfma_f32_16x16x32_bf16 v[176:179], v[108:111], v[80:83], v[176:179]
v_mfma_f32_16x16x32_bf16 v[180:183], v[108:111], v[84:87], v[180:183]
s_add_u32 m0, s39, 112640
s_add_u32 s37, s37, s38
buffer_load_dwordx4 v22, s[8:11], s37 offen sc1 lds
v_mfma_f32_16x16x32_bf16 v[184:187], v[108:111], v[88:91], v[184:187]
v_mfma_f32_16x16x32_bf16 v[188:191], v[108:111], v[92:95], v[188:191]
v_mfma_f32_16x16x32_bf16 v[252:255], v[124:127], v[92:95], v[252:255]
s_add_u32 m0, s39, 113664
s_add_u32 s37, s37, s38
buffer_load_dwordx4 v23, s[8:11], s37 offen sc1 lds
v_mfma_f32_16x16x32_bf16 v[248:251], v[124:127], v[88:91], v[248:251]
v_mfma_f32_16x16x32_bf16 v[244:247], v[124:127], v[84:87], v[244:247]
v_mfma_f32_16x16x32_bf16 v[240:243], v[124:127], v[80:83], v[240:243]
s_setprio 0
s_waitcnt lgkmcnt(0)
v_mov_b32 v32, v2
v_mul_f32 v88, v3, v3
v_mul_f32 v36, 0xc0135761, v3
v_mul_f32 v89, 0xbdd2d3e8, v3
v_rcp_f32 v44, v88
v_mul_f32 v40, v89, v88
v_mov_b32 v33, v4
v_mul_f32 v88, v5, v5
v_mul_f32 v37, 0xc0135761, v5
v_mul_f32 v89, 0xbdd2d3e8, v5
v_rcp_f32 v45, v88
v_mul_f32 v41, v89, v88
v_mov_b32 v34, v6
v_mul_f32 v88, v7, v7
v_mul_f32 v38, 0xc0135761, v7
v_mul_f32 v89, 0xbdd2d3e8, v7
v_rcp_f32 v46, v88
v_mul_f32 v42, v89, v88
v_mov_b32 v35, v8
v_mul_f32 v88, v9, v9
v_mul_f32 v39, 0xc0135761, v9
v_mul_f32 v89, 0xbdd2d3e8, v9
v_rcp_f32 v47, v88
v_mul_f32 v43, v89, v88
s_barrier
s_add_u32 s42, s42, 1
s_and_b32 s42, s42, 15
s_add_u32 m0, s39, 0
s_mul_i32 s37, s42, s40
buffer_load_dwordx4 v22, s[8:11], s37 offen sc1 lds
v_fma_f32 v128, -v32, v48, v128
v_fma_f32 v129, -v32, v49, v129
v_fma_f32 v130, -v32, v50, v130
v_fma_f32 v131, -v32, v51, v131
s_add_u32 m0, s39, 1024
s_add_u32 s37, s37, s38
buffer_load_dwordx4 v23, s[8:11], s37 offen sc1 lds
v_fma_f32 v192, -v32, v64, v192
v_fma_f32 v193, -v32, v65, v193
v_fma_f32 v194, -v32, v66, v194
s_add_u32 m0, s39, 2048
s_add_u32 s37, s37, s38
buffer_load_dwordx4 v22, s[8:11], s37 offen sc1 lds
v_fma_f32 v195, -v32, v67, v195
v_mul_f32 v80, v128, v128
v_mul_f32 v81, v129, v129
s_add_u32 m0, s39, 3072
s_add_u32 s37, s37, s38
buffer_load_dwordx4 v23, s[8:11], s37 offen sc1 lds
v_mul_f32 v82, v130, v130
v_mul_f32 v83, v131, v131
v_fma_f32 v80, v80, v40, v36
s_add_u32 m0, s39, 4096
s_add_u32 s37, s37, s38
buffer_load_dwordx4 v22, s[8:11], s37 offen sc1 lds
v_fma_f32 v81, v81, v40, v36
v_fma_f32 v82, v82, v40, v36
v_fma_f32 v83, v83, v40, v36
v_mul_f32 v80, v80, v128
s_add_u32 m0, s39, 5120
s_add_u32 s37, s37, s38
buffer_load_dwordx4 v23, s[8:11], s37 offen sc1 lds
v_mul_f32 v81, v81, v129
v_mul_f32 v82, v82, v130
v_mul_f32 v83, v83, v131
s_add_u32 m0, s39, 6144
s_add_u32 s37, s37, s38
buffer_load_dwordx4 v22, s[8:11], s37 offen sc1 lds
v_exp_f32 v80, v80
v_exp_f32 v81, v81
v_exp_f32 v82, v82
s_add_u32 m0, s39, 7168
s_add_u32 s37, s37, s38
buffer_load_dwordx4 v23, s[8:11], s37 offen sc1 lds
v_exp_f32 v83, v83
v_mul_f32 v192, v128, v192
v_mul_f32 v193, v129, v193
s_add_u32 m0, s39, 8192
s_add_u32 s37, s37, s38
buffer_load_dwordx4 v22, s[8:11], s37 offen sc1 lds
v_mul_f32 v194, v130, v194
v_mul_f32 v195, v131, v195
v_fma_f32 v80, v80, v44, v44
v_fma_f32 v81, v81, v44, v44
s_add_u32 m0, s39, 9216
s_add_u32 s37, s37, s38
buffer_load_dwordx4 v23, s[8:11], s37 offen sc1 lds
v_fma_f32 v82, v82, v44, v44
v_fma_f32 v83, v83, v44, v44
v_rcp_f32 v80, v80
s_add_u32 m0, s39, 10240
s_add_u32 s37, s37, s38
buffer_load_dwordx4 v22, s[8:11], s37 offen sc1 lds
v_rcp_f32 v81, v81
v_rcp_f32 v82, v82
v_rcp_f32 v83, v83
s_add_u32 m0, s39, 11264
s_add_u32 s37, s37, s38
buffer_load_dwordx4 v23, s[8:11], s37 offen sc1 lds
v_mul_f32 v192, v192, v80
v_mul_f32 v193, v193, v81
v_mul_f32 v194, v194, v82
s_add_u32 m0, s39, 12288
s_add_u32 s37, s37, s38
buffer_load_dwordx4 v22, s[8:11], s37 offen sc1 lds
v_mul_f32 v195, v195, v83
v_cvt_pk_bf16_f32 v96, v192, v193
v_cvt_pk_bf16_f32 v97, v194, v195
v_fma_f32 v144, -v32, v52, v144
s_add_u32 m0, s39, 13312
s_add_u32 s37, s37, s38
buffer_load_dwordx4 v23, s[8:11], s37 offen sc1 lds
v_fma_f32 v145, -v32, v53, v145
v_fma_f32 v146, -v32, v54, v146
v_fma_f32 v147, -v32, v55, v147
s_add_u32 m0, s39, 14336
s_add_u32 s37, s37, s38
buffer_load_dwordx4 v22, s[8:11], s37 offen sc1 lds
v_fma_f32 v208, -v32, v68, v208
v_fma_f32 v209, -v32, v69, v209
v_fma_f32 v210, -v32, v70, v210
s_add_u32 m0, s39, 15360
s_add_u32 s37, s37, s38
buffer_load_dwordx4 v23, s[8:11], s37 offen sc1 lds
v_fma_f32 v211, -v32, v71, v211
v_mul_f32 v84, v144, v144
v_mul_f32 v85, v145, v145
s_waitcnt vmcnt(16)
s_barrier
s_add_u32 s42, s42, 1
s_and_b32 s42, s42, 15
s_add_u32 m0, s39, 49152
s_mul_i32 s37, s42, s40
buffer_load_dwordx4 v22, s[8:11], s37 offen sc1 lds
v_mul_f32 v86, v146, v146
v_mul_f32 v87, v147, v147
v_fma_f32 v84, v84, v40, v36
v_fma_f32 v85, v85, v40, v36
v_fma_f32 v86, v86, v40, v36
s_add_u32 m0, s39, 50176
s_add_u32 s37, s37, s38
buffer_load_dwordx4 v23, s[8:11], s37 offen sc1 lds
v_fma_f32 v87, v87, v40, v36
v_mul_f32 v84, v84, v144
v_mul_f32 v85, v85, v145
v_mul_f32 v86, v86, v146
v_mul_f32 v87, v87, v147
s_add_u32 m0, s39, 51200
s_add_u32 s37, s37, s38
buffer_load_dwordx4 v22, s[8:11], s37 offen sc1 lds
v_exp_f32 v84, v84
v_exp_f32 v85, v85
v_exp_f32 v86, v86
v_exp_f32 v87, v87
s_add_u32 m0, s39, 52224
s_add_u32 s37, s37, s38
buffer_load_dwordx4 v23, s[8:11], s37 offen sc1 lds
v_mul_f32 v208, v144, v208
v_mul_f32 v209, v145, v209
v_mul_f32 v210, v146, v210
v_mul_f32 v211, v147, v211
v_fma_f32 v84, v84, v44, v44
s_add_u32 m0, s39, 53248
s_add_u32 s37, s37, s38
buffer_load_dwordx4 v22, s[8:11], s37 offen sc1 lds
v_fma_f32 v85, v85, v44, v44
v_fma_f32 v86, v86, v44, v44
v_fma_f32 v87, v87, v44, v44
v_rcp_f32 v84, v84
v_rcp_f32 v85, v85
s_add_u32 m0, s39, 54272
s_add_u32 s37, s37, s38
buffer_load_dwordx4 v23, s[8:11], s37 offen sc1 lds
v_rcp_f32 v86, v86
v_rcp_f32 v87, v87
v_mul_f32 v208, v208, v84
v_mul_f32 v209, v209, v85
s_add_u32 m0, s39, 55296
s_add_u32 s37, s37, s38
buffer_load_dwordx4 v22, s[8:11], s37 offen sc1 lds
v_mul_f32 v210, v210, v86
v_mul_f32 v211, v211, v87
v_cvt_pk_bf16_f32 v98, v208, v209
v_cvt_pk_bf16_f32 v99, v210, v211
s_add_u32 m0, s39, 56320
s_add_u32 s37, s37, s38
buffer_load_dwordx4 v23, s[8:11], s37 offen sc1 lds
v_fma_f32 v132, -v33, v48, v132
v_fma_f32 v133, -v33, v49, v133
v_fma_f32 v134, -v33, v50, v134
v_fma_f32 v135, -v33, v51, v135
s_add_u32 m0, s39, 57344
s_add_u32 s37, s37, s38
buffer_load_dwordx4 v22, s[8:11], s37 offen sc1 lds
v_fma_f32 v196, -v33, v64, v196
v_fma_f32 v197, -v33, v65, v197
v_fma_f32 v198, -v33, v66, v198
v_fma_f32 v199, -v33, v67, v199
v_mul_f32 v80, v132, v132
s_add_u32 m0, s39, 58368
s_add_u32 s37, s37, s38
buffer_load_dwordx4 v23, s[8:11], s37 offen sc1 lds
v_mul_f32 v81, v133, v133
v_mul_f32 v82, v134, v134
v_mul_f32 v83, v135, v135
v_fma_f32 v80, v80, v41, v37
v_fma_f32 v81, v81, v41, v37
s_add_u32 m0, s39, 59392
s_add_u32 s37, s37, s38
buffer_load_dwordx4 v22, s[8:11], s37 offen sc1 lds
v_fma_f32 v82, v82, v41, v37
v_fma_f32 v83, v83, v41, v37
v_mul_f32 v80, v80, v132
v_mul_f32 v81, v81, v133
s_add_u32 m0, s39, 60416
s_add_u32 s37, s37, s38
buffer_load_dwordx4 v23, s[8:11], s37 offen sc1 lds
v_mul_f32 v82, v82, v134
v_lshlrev_b32 v19, 11, v18
v_lshl_add_u32 v19, v17, 4, v19
s_lshl_b32 s43, s46, 10
v_add_u32 v2, s43, v19
s_add_u32 m0, s39, 61440
s_add_u32 s37, s37, s38
buffer_load_dwordx4 v22, s[8:11], s37 offen sc1 lds
v_add_u32 v3, 0x10000, v2
v_lshrrev_b32 v19, 2, v17
v_lshl_add_u32 v20, v18, 2, v19
v_bfe_u32 v21, v20, 1, 2
s_lshl_b32 s43, s47, 1
s_add_u32 m0, s39, 62464
s_add_u32 s37, s37, s38
buffer_load_dwordx4 v23, s[8:11], s37 offen sc1 lds
v_xor_b32 v21, s43, v21
v_lshlrev_b32 v20, 7, v20
v_lshl_add_u32 v20, v21, 5, v20
v_and_b32 v19, 3, v1
s_add_u32 m0, s39, 63488
s_add_u32 s37, s37, s38
buffer_load_dwordx4 v22, s[8:11], s37 offen sc1 lds
v_lshl_add_u32 v20, v19, 3, v20
v_add_u32 v5, 16384, v20
v_xor_b32 v6, 32, v5
v_add_u32 v7, 0x10000, v5
v_add_u32 v8, 0x10000, v6
s_add_u32 m0, s39, 64512
s_add_u32 s37, s37, s38
buffer_load_dwordx4 v23, s[8:11], s37 offen sc1 lds
s_lshl_b32 s43, s36, 12
v_lshl_add_u32 v9, v1, 4, s43
s_mov_b32 s54, 0x10000
s_movk_i32 s52, 0x1000
buffer_store_dwordx4 v[96:99], v27, s[24:27], 0 offen offset:0 sc1
s_waitcnt vmcnt(17)
s_barrier
s_add_u32 s42, s42, 1
s_and_b32 s42, s42, 15
s_add_u32 m0, s39, 98304
s_mul_i32 s37, s42, s40
buffer_load_dwordx4 v22, s[8:11], s37 offen sc1 lds
v_mul_f32 v83, v83, v135
v_exp_f32 v80, v80
v_exp_f32 v81, v81
v_exp_f32 v82, v82
s_add_u32 m0, s39, 99328
s_add_u32 s37, s37, s38
buffer_load_dwordx4 v23, s[8:11], s37 offen sc1 lds
v_exp_f32 v83, v83
v_mul_f32 v196, v132, v196
v_mul_f32 v197, v133, v197
s_add_u32 m0, s39, 100352
s_add_u32 s37, s37, s38
buffer_load_dwordx4 v22, s[8:11], s37 offen sc1 lds
v_mul_f32 v198, v134, v198
v_mul_f32 v199, v135, v199
v_fma_f32 v80, v80, v45, v45
s_add_u32 m0, s39, 101376
s_add_u32 s37, s37, s38
buffer_load_dwordx4 v23, s[8:11], s37 offen sc1 lds
v_fma_f32 v81, v81, v45, v45
v_fma_f32 v82, v82, v45, v45
v_fma_f32 v83, v83, v45, v45
s_add_u32 m0, s39, 102400
s_add_u32 s37, s37, s38
buffer_load_dwordx4 v22, s[8:11], s37 offen sc1 lds
v_rcp_f32 v80, v80
v_rcp_f32 v81, v81
v_rcp_f32 v82, v82
v_rcp_f32 v83, v83
s_add_u32 m0, s39, 103424
s_add_u32 s37, s37, s38
buffer_load_dwordx4 v23, s[8:11], s37 offen sc1 lds
v_mul_f32 v196, v196, v80
v_mul_f32 v197, v197, v81
v_mul_f32 v198, v198, v82
s_add_u32 m0, s39, 104448
s_add_u32 s37, s37, s38
buffer_load_dwordx4 v22, s[8:11], s37 offen sc1 lds
v_mul_f32 v199, v199, v83
v_cvt_pk_bf16_f32 v100, v196, v197
v_cvt_pk_bf16_f32 v101, v198, v199
s_add_u32 m0, s39, 105472
s_add_u32 s37, s37, s38
buffer_load_dwordx4 v23, s[8:11], s37 offen sc1 lds
v_fma_f32 v148, -v33, v52, v148
v_fma_f32 v149, -v33, v53, v149
v_fma_f32 v150, -v33, v54, v150
s_add_u32 m0, s39, 106496
s_add_u32 s37, s37, s38
buffer_load_dwordx4 v22, s[8:11], s37 offen sc1 lds
v_fma_f32 v151, -v33, v55, v151
v_fma_f32 v212, -v33, v68, v212
v_fma_f32 v213, -v33, v69, v213
v_fma_f32 v214, -v33, v70, v214
s_add_u32 m0, s39, 107520
s_add_u32 s37, s37, s38
buffer_load_dwordx4 v23, s[8:11], s37 offen sc1 lds
v_fma_f32 v215, -v33, v71, v215
v_mul_f32 v84, v148, v148
v_mul_f32 v85, v149, v149
s_add_u32 m0, s39, 108544
s_add_u32 s37, s37, s38
buffer_load_dwordx4 v22, s[8:11], s37 offen sc1 lds
v_mul_f32 v86, v150, v150
v_mul_f32 v87, v151, v151
v_fma_f32 v84, v84, v41, v37
s_add_u32 m0, s39, 109568
s_add_u32 s37, s37, s38
buffer_load_dwordx4 v23, s[8:11], s37 offen sc1 lds
v_fma_f32 v85, v85, v41, v37
v_fma_f32 v86, v86, v41, v37
v_fma_f32 v87, v87, v41, v37
s_add_u32 m0, s39, 110592
s_add_u32 s37, s37, s38
buffer_load_dwordx4 v22, s[8:11], s37 offen sc1 lds
v_mul_f32 v84, v84, v148
v_mul_f32 v85, v85, v149
v_mul_f32 v86, v86, v150
v_mul_f32 v87, v87, v151
s_add_u32 m0, s39, 111616
s_add_u32 s37, s37, s38
buffer_load_dwordx4 v23, s[8:11], s37 offen sc1 lds
v_exp_f32 v84, v84
v_exp_f32 v85, v85
v_exp_f32 v86, v86
s_add_u32 m0, s39, 112640
s_add_u32 s37, s37, s38
buffer_load_dwordx4 v22, s[8:11], s37 offen sc1 lds
v_exp_f32 v87, v87
v_mul_f32 v212, v148, v212
v_mul_f32 v213, v149, v213
s_add_u32 m0, s39, 113664
s_add_u32 s37, s37, s38
buffer_load_dwordx4 v23, s[8:11], s37 offen sc1 lds
v_mul_f32 v214, v150, v214
v_mul_f32 v215, v151, v215
v_fma_f32 v84, v84, v45, v45
s_waitcnt vmcnt(17)
s_barrier
s_add_u32 s42, s42, 1
s_and_b32 s42, s42, 15
s_add_u32 m0, s39, 0
s_mul_i32 s37, s42, s40
buffer_load_dwordx4 v22, s[8:11], s37 offen sc1 lds
v_fma_f32 v85, v85, v45, v45
v_fma_f32 v86, v86, v45, v45
v_fma_f32 v87, v87, v45, v45
v_rcp_f32 v84, v84
s_add_u32 m0, s39, 1024
s_add_u32 s37, s37, s38
buffer_load_dwordx4 v23, s[8:11], s37 offen sc1 lds
v_rcp_f32 v85, v85
v_rcp_f32 v86, v86
v_rcp_f32 v87, v87
s_add_u32 m0, s39, 2048
s_add_u32 s37, s37, s38
buffer_load_dwordx4 v22, s[8:11], s37 offen sc1 lds
v_mul_f32 v212, v212, v84
v_mul_f32 v213, v213, v85
v_mul_f32 v214, v214, v86
s_add_u32 m0, s39, 3072
s_add_u32 s37, s37, s38
buffer_load_dwordx4 v23, s[8:11], s37 offen sc1 lds
v_mul_f32 v215, v215, v87
v_cvt_pk_bf16_f32 v102, v212, v213
v_cvt_pk_bf16_f32 v103, v214, v215
s_add_u32 m0, s39, 4096
s_add_u32 s37, s37, s38
buffer_load_dwordx4 v22, s[8:11], s37 offen sc1 lds
v_fma_f32 v136, -v34, v48, v136
v_fma_f32 v137, -v34, v49, v137
v_fma_f32 v138, -v34, v50, v138
s_add_u32 m0, s39, 5120
s_add_u32 s37, s37, s38
buffer_load_dwordx4 v23, s[8:11], s37 offen sc1 lds
v_fma_f32 v139, -v34, v51, v139
v_fma_f32 v200, -v34, v64, v200
v_fma_f32 v201, -v34, v65, v201
s_add_u32 m0, s39, 6144
s_add_u32 s37, s37, s38
buffer_load_dwordx4 v22, s[8:11], s37 offen sc1 lds
v_fma_f32 v202, -v34, v66, v202
v_fma_f32 v203, -v34, v67, v203
v_mul_f32 v80, v136, v136
v_mul_f32 v81, v137, v137
s_add_u32 m0, s39, 7168
s_add_u32 s37, s37, s38
buffer_load_dwordx4 v23, s[8:11], s37 offen sc1 lds
v_mul_f32 v82, v138, v138
v_mul_f32 v83, v139, v139
v_fma_f32 v80, v80, v42, v38
s_add_u32 m0, s39, 8192
s_add_u32 s37, s37, s38
buffer_load_dwordx4 v22, s[8:11], s37 offen sc1 lds
v_fma_f32 v81, v81, v42, v38
v_fma_f32 v82, v82, v42, v38
v_fma_f32 v83, v83, v42, v38
s_add_u32 m0, s39, 9216
s_add_u32 s37, s37, s38
buffer_load_dwordx4 v23, s[8:11], s37 offen sc1 lds
v_mul_f32 v80, v80, v136
v_mul_f32 v81, v81, v137
v_mul_f32 v82, v82, v138
v_mul_f32 v83, v83, v139
s_add_u32 m0, s39, 10240
s_add_u32 s37, s37, s38
buffer_load_dwordx4 v22, s[8:11], s37 offen sc1 lds
v_exp_f32 v80, v80
v_exp_f32 v81, v81
v_exp_f32 v82, v82
s_add_u32 m0, s39, 11264
s_add_u32 s37, s37, s38
buffer_load_dwordx4 v23, s[8:11], s37 offen sc1 lds
v_exp_f32 v83, v83
v_mul_f32 v200, v136, v200
v_mul_f32 v201, v137, v201
s_add_u32 m0, s39, 12288
s_add_u32 s37, s37, s38
buffer_load_dwordx4 v22, s[8:11], s37 offen sc1 lds
v_mul_f32 v202, v138, v202
v_mul_f32 v203, v139, v203
v_fma_f32 v80, v80, v46, v46
v_fma_f32 v81, v81, v46, v46
s_add_u32 m0, s39, 13312
s_add_u32 s37, s37, s38
buffer_load_dwordx4 v23, s[8:11], s37 offen sc1 lds
v_fma_f32 v82, v82, v46, v46
v_fma_f32 v83, v83, v46, v46
v_rcp_f32 v80, v80
s_add_u32 m0, s39, 14336
s_add_u32 s37, s37, s38
buffer_load_dwordx4 v22, s[8:11], s37 offen sc1 lds
v_rcp_f32 v81, v81
v_rcp_f32 v82, v82
v_rcp_f32 v83, v83
s_add_u32 m0, s39, 15360
s_add_u32 s37, s37, s38
buffer_load_dwordx4 v23, s[8:11], s37 offen sc1 lds
v_mul_f32 v200, v200, v80
v_mul_f32 v201, v201, v81
v_mul_f32 v202, v202, v82
buffer_store_dwordx4 v[100:103], v27, s[24:27], 0 offen offset:256 sc1
s_waitcnt vmcnt(17)
s_barrier
s_add_u32 s42, s42, 1
s_and_b32 s42, s42, 15
s_add_u32 m0, s39, 49152
s_mul_i32 s37, s42, s40
buffer_load_dwordx4 v22, s[8:11], s37 offen sc1 lds
v_mul_f32 v203, v203, v83
v_cvt_pk_bf16_f32 v104, v200, v201
v_cvt_pk_bf16_f32 v105, v202, v203
v_fma_f32 v152, -v34, v52, v152
s_add_u32 m0, s39, 50176
s_add_u32 s37, s37, s38
buffer_load_dwordx4 v23, s[8:11], s37 offen sc1 lds
v_fma_f32 v153, -v34, v53, v153
v_fma_f32 v154, -v34, v54, v154
v_fma_f32 v155, -v34, v55, v155
s_add_u32 m0, s39, 51200
s_add_u32 s37, s37, s38
buffer_load_dwordx4 v22, s[8:11], s37 offen sc1 lds
v_fma_f32 v216, -v34, v68, v216
v_fma_f32 v217, -v34, v69, v217
v_fma_f32 v218, -v34, v70, v218
s_add_u32 m0, s39, 52224
s_add_u32 s37, s37, s38
buffer_load_dwordx4 v23, s[8:11], s37 offen sc1 lds
v_fma_f32 v219, -v34, v71, v219
v_mul_f32 v84, v152, v152
v_mul_f32 v85, v153, v153
s_add_u32 m0, s39, 53248
s_add_u32 s37, s37, s38
buffer_load_dwordx4 v22, s[8:11], s37 offen sc1 lds
v_mul_f32 v86, v154, v154
v_mul_f32 v87, v155, v155
v_fma_f32 v84, v84, v42, v38
v_fma_f32 v85, v85, v42, v38
s_add_u32 m0, s39, 54272
s_add_u32 s37, s37, s38
buffer_load_dwordx4 v23, s[8:11], s37 offen sc1 lds
v_fma_f32 v86, v86, v42, v38
v_fma_f32 v87, v87, v42, v38
v_mul_f32 v84, v84, v152
s_add_u32 m0, s39, 55296
s_add_u32 s37, s37, s38
buffer_load_dwordx4 v22, s[8:11], s37 offen sc1 lds
v_mul_f32 v85, v85, v153
v_mul_f32 v86, v86, v154
v_mul_f32 v87, v87, v155
s_add_u32 m0, s39, 56320
s_add_u32 s37, s37, s38
buffer_load_dwordx4 v23, s[8:11], s37 offen sc1 lds
v_exp_f32 v84, v84
v_exp_f32 v85, v85
v_exp_f32 v86, v86
s_add_u32 m0, s39, 57344
s_add_u32 s37, s37, s38
buffer_load_dwordx4 v22, s[8:11], s37 offen sc1 lds
v_exp_f32 v87, v87
v_mul_f32 v216, v152, v216
v_mul_f32 v217, v153, v217
v_mul_f32 v218, v154, v218
s_add_u32 m0, s39, 58368
s_add_u32 s37, s37, s38
buffer_load_dwordx4 v23, s[8:11], s37 offen sc1 lds
v_mul_f32 v219, v155, v219
v_fma_f32 v84, v84, v46, v46
v_fma_f32 v85, v85, v46, v46
s_add_u32 m0, s39, 59392
s_add_u32 s37, s37, s38
buffer_load_dwordx4 v22, s[8:11], s37 offen sc1 lds
v_fma_f32 v86, v86, v46, v46
v_fma_f32 v87, v87, v46, v46
v_rcp_f32 v84, v84
s_add_u32 m0, s39, 60416
s_add_u32 s37, s37, s38
buffer_load_dwordx4 v23, s[8:11], s37 offen sc1 lds
v_rcp_f32 v85, v85
v_rcp_f32 v86, v86
v_rcp_f32 v87, v87
s_add_u32 m0, s39, 61440
s_add_u32 s37, s37, s38
buffer_load_dwordx4 v22, s[8:11], s37 offen sc1 lds
v_mul_f32 v216, v216, v84
v_mul_f32 v217, v217, v85
v_mul_f32 v218, v218, v86
v_mul_f32 v219, v219, v87
s_add_u32 m0, s39, 62464
s_add_u32 s37, s37, s38
buffer_load_dwordx4 v23, s[8:11], s37 offen sc1 lds
v_cvt_pk_bf16_f32 v106, v216, v217
v_cvt_pk_bf16_f32 v107, v218, v219
s_add_u32 m0, s39, 63488
s_add_u32 s37, s37, s38
buffer_load_dwordx4 v22, s[8:11], s37 offen sc1 lds
v_fma_f32 v140, -v35, v48, v140
v_fma_f32 v141, -v35, v49, v141
v_fma_f32 v142, -v35, v50, v142
s_add_u32 m0, s39, 64512
s_add_u32 s37, s37, s38
buffer_load_dwordx4 v23, s[8:11], s37 offen sc1 lds
v_fma_f32 v143, -v35, v51, v143
v_fma_f32 v204, -v35, v64, v204
v_fma_f32 v205, -v35, v65, v205
buffer_store_dwordx4 v[104:107], v27, s[24:27], 0 offen offset:512 sc1
s_waitcnt vmcnt(18)
s_barrier
s_add_u32 s42, s42, 1
s_and_b32 s42, s42, 15
s_add_u32 m0, s39, 98304
s_mul_i32 s37, s42, s40
buffer_load_dwordx4 v22, s[8:11], s37 offen sc1 lds
v_fma_f32 v206, -v35, v66, v206
v_fma_f32 v207, -v35, v67, v207
v_mul_f32 v80, v140, v140
v_mul_f32 v81, v141, v141
s_add_u32 m0, s39, 99328
s_add_u32 s37, s37, s38
buffer_load_dwordx4 v23, s[8:11], s37 offen sc1 lds
v_mul_f32 v82, v142, v142
v_mul_f32 v83, v143, v143
v_fma_f32 v80, v80, v43, v39
s_add_u32 m0, s39, 100352
s_add_u32 s37, s37, s38
buffer_load_dwordx4 v22, s[8:11], s37 offen sc1 lds
v_fma_f32 v81, v81, v43, v39
v_fma_f32 v82, v82, v43, v39
v_fma_f32 v83, v83, v43, v39
s_add_u32 m0, s39, 101376
s_add_u32 s37, s37, s38
buffer_load_dwordx4 v23, s[8:11], s37 offen sc1 lds
v_mul_f32 v80, v80, v140
v_mul_f32 v81, v81, v141
v_mul_f32 v82, v82, v142
s_add_u32 m0, s39, 102400
s_add_u32 s37, s37, s38
buffer_load_dwordx4 v22, s[8:11], s37 offen sc1 lds
v_mul_f32 v83, v83, v143
v_exp_f32 v80, v80
v_exp_f32 v81, v81
v_exp_f32 v82, v82
s_add_u32 m0, s39, 103424
s_add_u32 s37, s37, s38
buffer_load_dwordx4 v23, s[8:11], s37 offen sc1 lds
v_exp_f32 v83, v83
v_mul_f32 v204, v140, v204
v_mul_f32 v205, v141, v205
s_add_u32 m0, s39, 104448
s_add_u32 s37, s37, s38
buffer_load_dwordx4 v22, s[8:11], s37 offen sc1 lds
v_mul_f32 v206, v142, v206
v_mul_f32 v207, v143, v207
v_fma_f32 v80, v80, v47, v47
s_add_u32 m0, s39, 105472
s_add_u32 s37, s37, s38
buffer_load_dwordx4 v23, s[8:11], s37 offen sc1 lds
v_fma_f32 v81, v81, v47, v47
v_fma_f32 v82, v82, v47, v47
v_fma_f32 v83, v83, v47, v47
s_add_u32 m0, s39, 106496
s_add_u32 s37, s37, s38
buffer_load_dwordx4 v22, s[8:11], s37 offen sc1 lds
v_rcp_f32 v80, v80
v_rcp_f32 v81, v81
v_rcp_f32 v82, v82
v_rcp_f32 v83, v83
s_add_u32 m0, s39, 107520
s_add_u32 s37, s37, s38
buffer_load_dwordx4 v23, s[8:11], s37 offen sc1 lds
v_mul_f32 v204, v204, v80
v_mul_f32 v205, v205, v81
v_mul_f32 v206, v206, v82
s_add_u32 m0, s39, 108544
s_add_u32 s37, s37, s38
buffer_load_dwordx4 v22, s[8:11], s37 offen sc1 lds
v_mul_f32 v207, v207, v83
v_cvt_pk_bf16_f32 v108, v204, v205
v_cvt_pk_bf16_f32 v109, v206, v207
s_add_u32 m0, s39, 109568
s_add_u32 s37, s37, s38
buffer_load_dwordx4 v23, s[8:11], s37 offen sc1 lds
v_fma_f32 v156, -v35, v52, v156
v_fma_f32 v157, -v35, v53, v157
v_fma_f32 v158, -v35, v54, v158
s_add_u32 m0, s39, 110592
s_add_u32 s37, s37, s38
buffer_load_dwordx4 v22, s[8:11], s37 offen sc1 lds
v_fma_f32 v159, -v35, v55, v159
v_fma_f32 v220, -v35, v68, v220
v_fma_f32 v221, -v35, v69, v221
v_fma_f32 v222, -v35, v70, v222
s_add_u32 m0, s39, 111616
s_add_u32 s37, s37, s38
buffer_load_dwordx4 v23, s[8:11], s37 offen sc1 lds
v_fma_f32 v223, -v35, v71, v223
v_mul_f32 v84, v156, v156
v_mul_f32 v85, v157, v157
s_add_u32 m0, s39, 112640
s_add_u32 s37, s37, s38
buffer_load_dwordx4 v22, s[8:11], s37 offen sc1 lds
v_mul_f32 v86, v158, v158
v_mul_f32 v87, v159, v159
v_fma_f32 v84, v84, v43, v39
s_add_u32 m0, s39, 113664
s_add_u32 s37, s37, s38
buffer_load_dwordx4 v23, s[8:11], s37 offen sc1 lds
v_fma_f32 v85, v85, v43, v39
v_fma_f32 v86, v86, v43, v39
v_fma_f32 v87, v87, v43, v39
s_waitcnt vmcnt(17)
s_barrier
s_add_u32 s42, s42, 1
s_and_b32 s42, s42, 15
s_add_u32 m0, s39, 0
s_mul_i32 s37, s42, s40
buffer_load_dwordx4 v22, s[8:11], s37 offen sc1 lds
v_mul_f32 v84, v84, v156
v_mul_f32 v85, v85, v157
v_mul_f32 v86, v86, v158
v_mul_f32 v87, v87, v159
s_add_u32 m0, s39, 1024
s_add_u32 s37, s37, s38
buffer_load_dwordx4 v23, s[8:11], s37 offen sc1 lds
v_exp_f32 v84, v84
v_exp_f32 v85, v85
v_exp_f32 v86, v86
s_add_u32 m0, s39, 2048
s_add_u32 s37, s37, s38
buffer_load_dwordx4 v22, s[8:11], s37 offen sc1 lds
v_exp_f32 v87, v87
v_mul_f32 v220, v156, v220
v_mul_f32 v221, v157, v221
s_add_u32 m0, s39, 3072
s_add_u32 s37, s37, s38
buffer_load_dwordx4 v23, s[8:11], s37 offen sc1 lds
v_mul_f32 v222, v158, v222
v_mul_f32 v223, v159, v223
v_fma_f32 v84, v84, v47, v47
v_fma_f32 v85, v85, v47, v47
s_add_u32 m0, s39, 4096
s_add_u32 s37, s37, s38
buffer_load_dwordx4 v22, s[8:11], s37 offen sc1 lds
v_fma_f32 v86, v86, v47, v47
v_fma_f32 v87, v87, v47, v47
v_rcp_f32 v84, v84
s_add_u32 m0, s39, 5120
s_add_u32 s37, s37, s38
buffer_load_dwordx4 v23, s[8:11], s37 offen sc1 lds
v_rcp_f32 v85, v85
v_rcp_f32 v86, v86
v_rcp_f32 v87, v87
s_add_u32 m0, s39, 6144
s_add_u32 s37, s37, s38
buffer_load_dwordx4 v22, s[8:11], s37 offen sc1 lds
v_mul_f32 v220, v220, v84
v_mul_f32 v221, v221, v85
v_mul_f32 v222, v222, v86
v_mul_f32 v223, v223, v87
s_add_u32 m0, s39, 7168
s_add_u32 s37, s37, s38
buffer_load_dwordx4 v23, s[8:11], s37 offen sc1 lds
v_cvt_pk_bf16_f32 v110, v220, v221
v_cvt_pk_bf16_f32 v111, v222, v223
s_add_u32 m0, s39, 8192
s_add_u32 s37, s37, s38
buffer_load_dwordx4 v22, s[8:11], s37 offen sc1 lds
v_fma_f32 v160, -v32, v56, v160
v_fma_f32 v161, -v32, v57, v161
v_fma_f32 v162, -v32, v58, v162
s_add_u32 m0, s39, 9216
s_add_u32 s37, s37, s38
buffer_load_dwordx4 v23, s[8:11], s37 offen sc1 lds
v_fma_f32 v163, -v32, v59, v163
v_fma_f32 v224, -v32, v72, v224
v_fma_f32 v225, -v32, v73, v225
v_fma_f32 v226, -v32, v74, v226
s_add_u32 m0, s39, 10240
s_add_u32 s37, s37, s38
buffer_load_dwordx4 v22, s[8:11], s37 offen sc1 lds
v_fma_f32 v227, -v32, v75, v227
v_mul_f32 v80, v160, v160
v_mul_f32 v81, v161, v161
s_add_u32 m0, s39, 11264
s_add_u32 s37, s37, s38
buffer_load_dwordx4 v23, s[8:11], s37 offen sc1 lds
v_mul_f32 v82, v162, v162
v_mul_f32 v83, v163, v163
v_fma_f32 v80, v80, v40, v36
s_add_u32 m0, s39, 12288
s_add_u32 s37, s37, s38
buffer_load_dwordx4 v22, s[8:11], s37 offen sc1 lds
v_fma_f32 v81, v81, v40, v36
v_fma_f32 v82, v82, v40, v36
v_fma_f32 v83, v83, v40, v36
v_mul_f32 v80, v80, v160
s_add_u32 m0, s39, 13312
s_add_u32 s37, s37, s38
buffer_load_dwordx4 v23, s[8:11], s37 offen sc1 lds
v_mul_f32 v81, v81, v161
v_mul_f32 v82, v82, v162
v_mul_f32 v83, v83, v163
s_add_u32 m0, s39, 14336
s_add_u32 s37, s37, s38
buffer_load_dwordx4 v22, s[8:11], s37 offen sc1 lds
v_exp_f32 v80, v80
v_exp_f32 v81, v81
v_exp_f32 v82, v82
s_add_u32 m0, s39, 15360
s_add_u32 s37, s37, s38
buffer_load_dwordx4 v23, s[8:11], s37 offen sc1 lds
v_exp_f32 v83, v83
v_mul_f32 v224, v160, v224
v_mul_f32 v225, v161, v225
buffer_store_dwordx4 v[108:111], v27, s[24:27], 0 offen offset:768 sc1
s_waitcnt vmcnt(17)
s_barrier
s_add_u32 s42, s42, 1
s_and_b32 s42, s42, 15
s_add_u32 m0, s39, 49152
s_mul_i32 s37, s42, s40
buffer_load_dwordx4 v22, s[8:11], s37 offen sc1 lds
v_mul_f32 v226, v162, v226
v_mul_f32 v227, v163, v227
v_fma_f32 v80, v80, v44, v44
v_fma_f32 v81, v81, v44, v44
s_add_u32 m0, s39, 50176
s_add_u32 s37, s37, s38
buffer_load_dwordx4 v23, s[8:11], s37 offen sc1 lds
v_fma_f32 v82, v82, v44, v44
v_fma_f32 v83, v83, v44, v44
v_rcp_f32 v80, v80
v_rcp_f32 v81, v81
s_add_u32 m0, s39, 51200
s_add_u32 s37, s37, s38
buffer_load_dwordx4 v22, s[8:11], s37 offen sc1 lds
v_rcp_f32 v82, v82
v_rcp_f32 v83, v83
v_mul_f32 v224, v224, v80
v_mul_f32 v225, v225, v81
s_add_u32 m0, s39, 52224
s_add_u32 s37, s37, s38
buffer_load_dwordx4 v23, s[8:11], s37 offen sc1 lds
v_mul_f32 v226, v226, v82
v_mul_f32 v227, v227, v83
v_cvt_pk_bf16_f32 v96, v224, v225
v_cvt_pk_bf16_f32 v97, v226, v227
s_add_u32 m0, s39, 53248
s_add_u32 s37, s37, s38
buffer_load_dwordx4 v22, s[8:11], s37 offen sc1 lds
v_fma_f32 v176, -v32, v60, v176
v_fma_f32 v177, -v32, v61, v177
v_fma_f32 v178, -v32, v62, v178
v_fma_f32 v179, -v32, v63, v179
s_add_u32 m0, s39, 54272
s_add_u32 s37, s37, s38
buffer_load_dwordx4 v23, s[8:11], s37 offen sc1 lds
v_fma_f32 v240, -v32, v76, v240
v_fma_f32 v241, -v32, v77, v241
v_fma_f32 v242, -v32, v78, v242
v_fma_f32 v243, -v32, v79, v243
s_add_u32 m0, s39, 55296
s_add_u32 s37, s37, s38
buffer_load_dwordx4 v22, s[8:11], s37 offen sc1 lds
v_mul_f32 v84, v176, v176
v_mul_f32 v85, v177, v177
v_mul_f32 v86, v178, v178
v_mul_f32 v87, v179, v179
s_add_u32 m0, s39, 56320
s_add_u32 s37, s37, s38
buffer_load_dwordx4 v23, s[8:11], s37 offen sc1 lds
v_fma_f32 v84, v84, v40, v36
v_fma_f32 v85, v85, v40, v36
v_fma_f32 v86, v86, v40, v36
s_add_u32 m0, s39, 57344
s_add_u32 s37, s37, s38
buffer_load_dwordx4 v22, s[8:11], s37 offen sc1 lds
v_fma_f32 v87, v87, v40, v36
v_mul_f32 v84, v84, v176
v_mul_f32 v85, v85, v177
v_mul_f32 v86, v86, v178
s_add_u32 m0, s39, 58368
s_add_u32 s37, s37, s38
buffer_load_dwordx4 v23, s[8:11], s37 offen sc1 lds
v_mul_f32 v87, v87, v179
v_exp_f32 v84, v84
v_exp_f32 v85, v85
v_exp_f32 v86, v86
s_add_u32 m0, s39, 59392
s_add_u32 s37, s37, s38
buffer_load_dwordx4 v22, s[8:11], s37 offen sc1 lds
v_exp_f32 v87, v87
v_mul_f32 v240, v176, v240
v_mul_f32 v241, v177, v241
v_mul_f32 v242, v178, v242
s_add_u32 m0, s39, 60416
s_add_u32 s37, s37, s38
buffer_load_dwordx4 v23, s[8:11], s37 offen sc1 lds
v_mul_f32 v243, v179, v243
v_fma_f32 v84, v84, v44, v44
v_fma_f32 v85, v85, v44, v44
v_fma_f32 v86, v86, v44, v44
s_add_u32 m0, s39, 61440
s_add_u32 s37, s37, s38
buffer_load_dwordx4 v22, s[8:11], s37 offen sc1 lds
v_fma_f32 v87, v87, v44, v44
v_rcp_f32 v84, v84
v_rcp_f32 v85, v85
v_rcp_f32 v86, v86
s_add_u32 m0, s39, 62464
s_add_u32 s37, s37, s38
buffer_load_dwordx4 v23, s[8:11], s37 offen sc1 lds
v_rcp_f32 v87, v87
v_lshlrev_b32 v19, 11, v18
v_lshl_add_u32 v19, v17, 4, v19
s_lshl_b32 s43, s46, 10
s_add_u32 m0, s39, 63488
s_add_u32 s37, s37, s38
buffer_load_dwordx4 v22, s[8:11], s37 offen sc1 lds
s_lshl_b32 s44, s47, 13
v_add3_u32 v208, v19, s43, 0
v_add_u32 v208, s44, v208
buffer_load_dwordx4 v[192:195], v208, s[20:23], 0 offen offset:0 sc1
s_add_u32 m0, s39, 64512
s_add_u32 s37, s37, s38
buffer_load_dwordx4 v23, s[8:11], s37 offen sc1 lds
buffer_load_dwordx4 v[196:199], v208, s[20:23], 0 offen offset:256 sc1
buffer_load_dwordx4 v[200:203], v208, s[20:23], 0 offen offset:512 sc1
buffer_load_dwordx4 v[204:207], v208, s[20:23], 0 offen offset:768 sc1
s_waitcnt vmcnt(20)
s_barrier
s_add_u32 s42, s42, 1
s_and_b32 s42, s42, 15
s_add_u32 m0, s39, 98304
s_mul_i32 s37, s42, s40
buffer_load_dwordx4 v22, s[8:11], s37 offen sc1 lds
v_mul_f32 v240, v240, v84
v_mul_f32 v241, v241, v85
v_mul_f32 v242, v242, v86
v_mul_f32 v243, v243, v87
s_add_u32 m0, s39, 99328
s_add_u32 s37, s37, s38
buffer_load_dwordx4 v23, s[8:11], s37 offen sc1 lds
v_cvt_pk_bf16_f32 v98, v240, v241
v_cvt_pk_bf16_f32 v99, v242, v243
s_add_u32 m0, s39, 100352
s_add_u32 s37, s37, s38
buffer_load_dwordx4 v22, s[8:11], s37 offen sc1 lds
v_fma_f32 v164, -v33, v56, v164
v_fma_f32 v165, -v33, v57, v165
v_fma_f32 v166, -v33, v58, v166
s_add_u32 m0, s39, 101376
s_add_u32 s37, s37, s38
buffer_load_dwordx4 v23, s[8:11], s37 offen sc1 lds
v_fma_f32 v167, -v33, v59, v167
v_fma_f32 v228, -v33, v72, v228
v_fma_f32 v229, -v33, v73, v229
s_add_u32 m0, s39, 102400
s_add_u32 s37, s37, s38
buffer_load_dwordx4 v22, s[8:11], s37 offen sc1 lds
v_fma_f32 v230, -v33, v74, v230
v_fma_f32 v231, -v33, v75, v231
v_mul_f32 v80, v164, v164
v_mul_f32 v81, v165, v165
s_add_u32 m0, s39, 103424
s_add_u32 s37, s37, s38
buffer_load_dwordx4 v23, s[8:11], s37 offen sc1 lds
v_mul_f32 v82, v166, v166
v_mul_f32 v83, v167, v167
v_fma_f32 v80, v80, v41, v37
s_add_u32 m0, s39, 104448
s_add_u32 s37, s37, s38
buffer_load_dwordx4 v22, s[8:11], s37 offen sc1 lds
v_fma_f32 v81, v81, v41, v37
v_fma_f32 v82, v82, v41, v37
v_fma_f32 v83, v83, v41, v37
s_add_u32 m0, s39, 105472
s_add_u32 s37, s37, s38
buffer_load_dwordx4 v23, s[8:11], s37 offen sc1 lds
v_mul_f32 v80, v80, v164
v_mul_f32 v81, v81, v165
v_mul_f32 v82, v82, v166
s_add_u32 m0, s39, 106496
s_add_u32 s37, s37, s38
buffer_load_dwordx4 v22, s[8:11], s37 offen sc1 lds
v_mul_f32 v83, v83, v167
v_exp_f32 v80, v80
v_exp_f32 v81, v81
v_exp_f32 v82, v82
s_add_u32 m0, s39, 107520
s_add_u32 s37, s37, s38
buffer_load_dwordx4 v23, s[8:11], s37 offen sc1 lds
v_exp_f32 v83, v83
v_mul_f32 v228, v164, v228
v_mul_f32 v229, v165, v229
s_add_u32 m0, s39, 108544
s_add_u32 s37, s37, s38
buffer_load_dwordx4 v22, s[8:11], s37 offen sc1 lds
v_mul_f32 v230, v166, v230
v_mul_f32 v231, v167, v231
v_fma_f32 v80, v80, v45, v45
s_add_u32 m0, s39, 109568
s_add_u32 s37, s37, s38
buffer_load_dwordx4 v23, s[8:11], s37 offen sc1 lds
v_fma_f32 v81, v81, v45, v45
v_fma_f32 v82, v82, v45, v45
v_fma_f32 v83, v83, v45, v45
s_add_u32 m0, s39, 110592
s_add_u32 s37, s37, s38
buffer_load_dwordx4 v22, s[8:11], s37 offen sc1 lds
v_rcp_f32 v80, v80
v_rcp_f32 v81, v81
v_rcp_f32 v82, v82
v_rcp_f32 v83, v83
s_add_u32 m0, s39, 111616
s_add_u32 s37, s37, s38
buffer_load_dwordx4 v23, s[8:11], s37 offen sc1 lds
v_mul_f32 v228, v228, v80
v_mul_f32 v229, v229, v81
v_mul_f32 v230, v230, v82
s_add_u32 m0, s39, 112640
s_add_u32 s37, s37, s38
buffer_load_dwordx4 v22, s[8:11], s37 offen sc1 lds
v_mul_f32 v231, v231, v83
v_cvt_pk_bf16_f32 v100, v228, v229
v_cvt_pk_bf16_f32 v101, v230, v231
s_add_u32 m0, s39, 113664
s_add_u32 s37, s37, s38
buffer_load_dwordx4 v23, s[8:11], s37 offen sc1 lds
v_fma_f32 v180, -v33, v60, v180
v_fma_f32 v181, -v33, v61, v181
v_fma_f32 v182, -v33, v62, v182
buffer_store_dwordx4 v[96:99], v27, s[24:27], s53 offen offset:0 sc1
s_waitcnt vmcnt(20)
s_barrier
s_add_u32 s42, s42, 1
s_and_b32 s42, s42, 15
s_add_u32 m0, s39, 0
s_mul_i32 s37, s42, s40
buffer_load_dwordx4 v22, s[8:11], s37 offen sc1 lds
v_fma_f32 v183, -v33, v63, v183
v_fma_f32 v244, -v33, v76, v244
v_fma_f32 v245, -v33, v77, v245
v_fma_f32 v246, -v33, v78, v246
s_add_u32 m0, s39, 1024
s_add_u32 s37, s37, s38
buffer_load_dwordx4 v23, s[8:11], s37 offen sc1 lds
v_fma_f32 v247, -v33, v79, v247
v_mul_f32 v84, v180, v180
v_mul_f32 v85, v181, v181
s_add_u32 m0, s39, 2048
s_add_u32 s37, s37, s38
buffer_load_dwordx4 v22, s[8:11], s37 offen sc1 lds
v_mul_f32 v86, v182, v182
v_mul_f32 v87, v183, v183
v_fma_f32 v84, v84, v41, v37
s_add_u32 m0, s39, 3072
s_add_u32 s37, s37, s38
buffer_load_dwordx4 v23, s[8:11], s37 offen sc1 lds
v_fma_f32 v85, v85, v41, v37
v_fma_f32 v86, v86, v41, v37
v_fma_f32 v87, v87, v41, v37
v_mul_f32 v84, v84, v180
s_add_u32 m0, s39, 4096
s_add_u32 s37, s37, s38
buffer_load_dwordx4 v22, s[8:11], s37 offen sc1 lds
v_mul_f32 v85, v85, v181
v_mul_f32 v86, v86, v182
v_mul_f32 v87, v87, v183
s_add_u32 m0, s39, 5120
s_add_u32 s37, s37, s38
buffer_load_dwordx4 v23, s[8:11], s37 offen sc1 lds
v_exp_f32 v84, v84
v_exp_f32 v85, v85
v_exp_f32 v86, v86
s_add_u32 m0, s39, 6144
s_add_u32 s37, s37, s38
buffer_load_dwordx4 v22, s[8:11], s37 offen sc1 lds
v_exp_f32 v87, v87
v_mul_f32 v244, v180, v244
v_mul_f32 v245, v181, v245
v_mul_f32 v246, v182, v246
s_add_u32 m0, s39, 7168
s_add_u32 s37, s37, s38
buffer_load_dwordx4 v23, s[8:11], s37 offen sc1 lds
v_mul_f32 v247, v183, v247
v_fma_f32 v84, v84, v45, v45
v_fma_f32 v85, v85, v45, v45
s_add_u32 m0, s39, 8192
s_add_u32 s37, s37, s38
buffer_load_dwordx4 v22, s[8:11], s37 offen sc1 lds
v_fma_f32 v86, v86, v45, v45
v_fma_f32 v87, v87, v45, v45
v_rcp_f32 v84, v84
s_add_u32 m0, s39, 9216
s_add_u32 s37, s37, s38
buffer_load_dwordx4 v23, s[8:11], s37 offen sc1 lds
v_rcp_f32 v85, v85
v_rcp_f32 v86, v86
v_rcp_f32 v87, v87
v_mul_f32 v244, v244, v84
s_add_u32 m0, s39, 10240
s_add_u32 s37, s37, s38
buffer_load_dwordx4 v22, s[8:11], s37 offen sc1 lds
v_mul_f32 v245, v245, v85
v_mul_f32 v246, v246, v86
v_mul_f32 v247, v247, v87
s_add_u32 m0, s39, 11264
s_add_u32 s37, s37, s38
buffer_load_dwordx4 v23, s[8:11], s37 offen sc1 lds
v_cvt_pk_bf16_f32 v102, v244, v245
v_cvt_pk_bf16_f32 v103, v246, v247
s_add_u32 m0, s39, 12288
s_add_u32 s37, s37, s38
buffer_load_dwordx4 v22, s[8:11], s37 offen sc1 lds
v_fma_f32 v168, -v34, v56, v168
v_fma_f32 v169, -v34, v57, v169
v_fma_f32 v170, -v34, v58, v170
v_fma_f32 v171, -v34, v59, v171
s_add_u32 m0, s39, 13312
s_add_u32 s37, s37, s38
buffer_load_dwordx4 v23, s[8:11], s37 offen sc1 lds
v_fma_f32 v232, -v34, v72, v232
v_fma_f32 v233, -v34, v73, v233
v_fma_f32 v234, -v34, v74, v234
s_add_u32 m0, s39, 14336
s_add_u32 s37, s37, s38
buffer_load_dwordx4 v22, s[8:11], s37 offen sc1 lds
v_fma_f32 v235, -v34, v75, v235
v_mul_f32 v80, v168, v168
v_mul_f32 v81, v169, v169
s_add_u32 m0, s39, 15360
s_add_u32 s37, s37, s38
buffer_load_dwordx4 v23, s[8:11], s37 offen sc1 lds
v_mul_f32 v82, v170, v170
v_mul_f32 v83, v171, v171
v_fma_f32 v80, v80, v42, v38
buffer_store_dwordx4 v[100:103], v27, s[24:27], s53 offen offset:256 sc1
s_waitcnt vmcnt(18)
s_barrier
s_add_u32 s42, s42, 1
s_and_b32 s42, s42, 15
s_add_u32 m0, s39, 49152
s_mul_i32 s37, s42, s40
buffer_load_dwordx4 v22, s[8:11], s37 offen sc1 lds
v_fma_f32 v81, v81, v42, v38
v_fma_f32 v82, v82, v42, v38
v_fma_f32 v83, v83, v42, v38
v_mul_f32 v80, v80, v168
s_add_u32 m0, s39, 50176
s_add_u32 s37, s37, s38
buffer_load_dwordx4 v23, s[8:11], s37 offen sc1 lds
v_mul_f32 v81, v81, v169
v_mul_f32 v82, v82, v170
v_mul_f32 v83, v83, v171
s_add_u32 m0, s39, 51200
s_add_u32 s37, s37, s38
buffer_load_dwordx4 v22, s[8:11], s37 offen sc1 lds
v_exp_f32 v80, v80
v_exp_f32 v81, v81
v_exp_f32 v82, v82
s_add_u32 m0, s39, 52224
s_add_u32 s37, s37, s38
buffer_load_dwordx4 v23, s[8:11], s37 offen sc1 lds
v_exp_f32 v83, v83
v_mul_f32 v232, v168, v232
v_mul_f32 v233, v169, v233
s_add_u32 m0, s39, 53248
s_add_u32 s37, s37, s38
buffer_load_dwordx4 v22, s[8:11], s37 offen sc1 lds
v_mul_f32 v234, v170, v234
v_mul_f32 v235, v171, v235
v_fma_f32 v80, v80, v46, v46
v_fma_f32 v81, v81, v46, v46
s_add_u32 m0, s39, 54272
s_add_u32 s37, s37, s38
buffer_load_dwordx4 v23, s[8:11], s37 offen sc1 lds
v_fma_f32 v82, v82, v46, v46
v_fma_f32 v83, v83, v46, v46
v_rcp_f32 v80, v80
s_add_u32 m0, s39, 55296
s_add_u32 s37, s37, s38
buffer_load_dwordx4 v22, s[8:11], s37 offen sc1 lds
v_rcp_f32 v81, v81
v_rcp_f32 v82, v82
v_rcp_f32 v83, v83
s_add_u32 m0, s39, 56320
s_add_u32 s37, s37, s38
buffer_load_dwordx4 v23, s[8:11], s37 offen sc1 lds
v_mul_f32 v232, v232, v80
v_mul_f32 v233, v233, v81
v_mul_f32 v234, v234, v82
s_add_u32 m0, s39, 57344
s_add_u32 s37, s37, s38
buffer_load_dwordx4 v22, s[8:11], s37 offen sc1 lds
v_mul_f32 v235, v235, v83
v_cvt_pk_bf16_f32 v104, v232, v233
v_cvt_pk_bf16_f32 v105, v234, v235
v_fma_f32 v184, -v34, v60, v184
s_add_u32 m0, s39, 58368
s_add_u32 s37, s37, s38
buffer_load_dwordx4 v23, s[8:11], s37 offen sc1 lds
v_fma_f32 v185, -v34, v61, v185
v_fma_f32 v186, -v34, v62, v186
v_fma_f32 v187, -v34, v63, v187
s_add_u32 m0, s39, 59392
s_add_u32 s37, s37, s38
buffer_load_dwordx4 v22, s[8:11], s37 offen sc1 lds
v_fma_f32 v248, -v34, v76, v248
v_fma_f32 v249, -v34, v77, v249
v_fma_f32 v250, -v34, v78, v250
s_add_u32 m0, s39, 60416
s_add_u32 s37, s37, s38
buffer_load_dwordx4 v23, s[8:11], s37 offen sc1 lds
v_fma_f32 v251, -v34, v79, v251
v_mul_f32 v84, v184, v184
v_mul_f32 v85, v185, v185
s_add_u32 m0, s39, 61440
s_add_u32 s37, s37, s38
buffer_load_dwordx4 v22, s[8:11], s37 offen sc1 lds
v_mul_f32 v86, v186, v186
v_mul_f32 v87, v187, v187
v_fma_f32 v84, v84, v42, v38
v_fma_f32 v85, v85, v42, v38
s_add_u32 m0, s39, 62464
s_add_u32 s37, s37, s38
buffer_load_dwordx4 v23, s[8:11], s37 offen sc1 lds
v_fma_f32 v86, v86, v42, v38
v_fma_f32 v87, v87, v42, v38
v_mul_f32 v84, v84, v184
s_add_u32 m0, s39, 63488
s_add_u32 s37, s37, s38
buffer_load_dwordx4 v22, s[8:11], s37 offen sc1 lds
v_mul_f32 v85, v85, v185
v_mul_f32 v86, v86, v186
v_mul_f32 v87, v87, v187
s_add_u32 m0, s39, 64512
s_add_u32 s37, s37, s38
buffer_load_dwordx4 v23, s[8:11], s37 offen sc1 lds
v_exp_f32 v84, v84
v_exp_f32 v85, v85
v_exp_f32 v86, v86
s_waitcnt vmcnt(17)
s_barrier
s_add_u32 s42, s42, 1
s_and_b32 s42, s42, 15
s_add_u32 m0, s39, 98304
s_mul_i32 s37, s42, s40
buffer_load_dwordx4 v22, s[8:11], s37 offen sc1 lds
v_exp_f32 v87, v87
v_mul_f32 v248, v184, v248
v_mul_f32 v249, v185, v249
v_mul_f32 v250, v186, v250
s_add_u32 m0, s39, 99328
s_add_u32 s37, s37, s38
buffer_load_dwordx4 v23, s[8:11], s37 offen sc1 lds
v_mul_f32 v251, v187, v251
v_fma_f32 v84, v84, v46, v46
v_fma_f32 v85, v85, v46, v46
s_add_u32 m0, s39, 100352
s_add_u32 s37, s37, s38
buffer_load_dwordx4 v22, s[8:11], s37 offen sc1 lds
v_fma_f32 v86, v86, v46, v46
v_fma_f32 v87, v87, v46, v46
v_rcp_f32 v84, v84
s_add_u32 m0, s39, 101376
s_add_u32 s37, s37, s38
buffer_load_dwordx4 v23, s[8:11], s37 offen sc1 lds
v_rcp_f32 v85, v85
v_rcp_f32 v86, v86
v_rcp_f32 v87, v87
s_add_u32 m0, s39, 102400
s_add_u32 s37, s37, s38
buffer_load_dwordx4 v22, s[8:11], s37 offen sc1 lds
v_mul_f32 v248, v248, v84
v_mul_f32 v249, v249, v85
v_mul_f32 v250, v250, v86
v_mul_f32 v251, v251, v87
s_add_u32 m0, s39, 103424
s_add_u32 s37, s37, s38
buffer_load_dwordx4 v23, s[8:11], s37 offen sc1 lds
v_cvt_pk_bf16_f32 v106, v248, v249
v_cvt_pk_bf16_f32 v107, v250, v251
s_add_u32 m0, s39, 104448
s_add_u32 s37, s37, s38
buffer_load_dwordx4 v22, s[8:11], s37 offen sc1 lds
v_fma_f32 v172, -v35, v56, v172
v_fma_f32 v173, -v35, v57, v173
v_fma_f32 v174, -v35, v58, v174
s_add_u32 m0, s39, 105472
s_add_u32 s37, s37, s38
buffer_load_dwordx4 v23, s[8:11], s37 offen sc1 lds
v_fma_f32 v175, -v35, v59, v175
v_fma_f32 v236, -v35, v72, v236
v_fma_f32 v237, -v35, v73, v237
s_add_u32 m0, s39, 106496
s_add_u32 s37, s37, s38
buffer_load_dwordx4 v22, s[8:11], s37 offen sc1 lds
v_fma_f32 v238, -v35, v74, v238
v_fma_f32 v239, -v35, v75, v239
v_mul_f32 v80, v172, v172
v_mul_f32 v81, v173, v173
s_add_u32 m0, s39, 107520
s_add_u32 s37, s37, s38
buffer_load_dwordx4 v23, s[8:11], s37 offen sc1 lds
v_mul_f32 v82, v174, v174
v_mul_f32 v83, v175, v175
v_fma_f32 v80, v80, v43, v39
s_add_u32 m0, s39, 108544
s_add_u32 s37, s37, s38
buffer_load_dwordx4 v22, s[8:11], s37 offen sc1 lds
v_fma_f32 v81, v81, v43, v39
v_fma_f32 v82, v82, v43, v39
v_fma_f32 v83, v83, v43, v39
s_add_u32 m0, s39, 109568
s_add_u32 s37, s37, s38
buffer_load_dwordx4 v23, s[8:11], s37 offen sc1 lds
v_mul_f32 v80, v80, v172
v_mul_f32 v81, v81, v173
v_mul_f32 v82, v82, v174
s_add_u32 m0, s39, 110592
s_add_u32 s37, s37, s38
buffer_load_dwordx4 v22, s[8:11], s37 offen sc1 lds
v_mul_f32 v83, v83, v175
v_exp_f32 v80, v80
v_exp_f32 v81, v81
v_exp_f32 v82, v82
s_add_u32 m0, s39, 111616
s_add_u32 s37, s37, s38
buffer_load_dwordx4 v23, s[8:11], s37 offen sc1 lds
v_exp_f32 v83, v83
v_mul_f32 v236, v172, v236
v_mul_f32 v237, v173, v237
s_add_u32 m0, s39, 112640
s_add_u32 s37, s37, s38
buffer_load_dwordx4 v22, s[8:11], s37 offen sc1 lds
v_mul_f32 v238, v174, v238
v_mul_f32 v239, v175, v239
v_fma_f32 v80, v80, v47, v47
s_add_u32 m0, s39, 113664
s_add_u32 s37, s37, s38
buffer_load_dwordx4 v23, s[8:11], s37 offen sc1 lds
v_fma_f32 v81, v81, v47, v47
v_fma_f32 v82, v82, v47, v47
v_fma_f32 v83, v83, v47, v47
buffer_store_dwordx4 v[104:107], v27, s[24:27], s53 offen offset:512 sc1
s_waitcnt vmcnt(17)
s_barrier
s_add_u32 s42, s42, 1
s_and_b32 s42, s42, 15
s_add_u32 m0, s39, 0
s_mul_i32 s37, s42, s40
buffer_load_dwordx4 v22, s[8:11], s37 offen sc1 lds
v_rcp_f32 v80, v80
v_rcp_f32 v81, v81
v_rcp_f32 v82, v82
v_rcp_f32 v83, v83
s_add_u32 m0, s39, 1024
s_add_u32 s37, s37, s38
buffer_load_dwordx4 v23, s[8:11], s37 offen sc1 lds
v_mul_f32 v236, v236, v80
v_mul_f32 v237, v237, v81
v_mul_f32 v238, v238, v82
s_add_u32 m0, s39, 2048
s_add_u32 s37, s37, s38
buffer_load_dwordx4 v22, s[8:11], s37 offen sc1 lds
v_mul_f32 v239, v239, v83
v_cvt_pk_bf16_f32 v108, v236, v237
v_cvt_pk_bf16_f32 v109, v238, v239
s_add_u32 m0, s39, 3072
s_add_u32 s37, s37, s38
buffer_load_dwordx4 v23, s[8:11], s37 offen sc1 lds
v_fma_f32 v188, -v35, v60, v188
v_fma_f32 v189, -v35, v61, v189
v_fma_f32 v190, -v35, v62, v190
v_fma_f32 v191, -v35, v63, v191
s_add_u32 m0, s39, 4096
s_add_u32 s37, s37, s38
buffer_load_dwordx4 v22, s[8:11], s37 offen sc1 lds
v_fma_f32 v252, -v35, v76, v252
v_fma_f32 v253, -v35, v77, v253
v_fma_f32 v254, -v35, v78, v254
s_add_u32 m0, s39, 5120
s_add_u32 s37, s37, s38
buffer_load_dwordx4 v23, s[8:11], s37 offen sc1 lds
v_fma_f32 v255, -v35, v79, v255
v_mul_f32 v84, v188, v188
v_mul_f32 v85, v189, v189
s_add_u32 m0, s39, 6144
s_add_u32 s37, s37, s38
buffer_load_dwordx4 v22, s[8:11], s37 offen sc1 lds
v_mul_f32 v86, v190, v190
v_mul_f32 v87, v191, v191
v_fma_f32 v84, v84, v43, v39
v_fma_f32 v85, v85, v43, v39
s_add_u32 m0, s39, 7168
s_add_u32 s37, s37, s38
buffer_load_dwordx4 v23, s[8:11], s37 offen sc1 lds
v_fma_f32 v86, v86, v43, v39
v_fma_f32 v87, v87, v43, v39
v_mul_f32 v84, v84, v188
s_add_u32 m0, s39, 8192
s_add_u32 s37, s37, s38
buffer_load_dwordx4 v22, s[8:11], s37 offen sc1 lds
v_mul_f32 v85, v85, v189
v_mul_f32 v86, v86, v190
v_mul_f32 v87, v87, v191
s_add_u32 m0, s39, 9216
s_add_u32 s37, s37, s38
buffer_load_dwordx4 v23, s[8:11], s37 offen sc1 lds
v_exp_f32 v84, v84
v_exp_f32 v85, v85
v_exp_f32 v86, v86
v_exp_f32 v87, v87
s_add_u32 m0, s39, 10240
s_add_u32 s37, s37, s38
buffer_load_dwordx4 v22, s[8:11], s37 offen sc1 lds
v_mul_f32 v252, v188, v252
v_mul_f32 v253, v189, v253
v_mul_f32 v254, v190, v254
s_add_u32 m0, s39, 11264
s_add_u32 s37, s37, s38
buffer_load_dwordx4 v23, s[8:11], s37 offen sc1 lds
v_mul_f32 v255, v191, v255
v_fma_f32 v84, v84, v47, v47
v_fma_f32 v85, v85, v47, v47
s_add_u32 m0, s39, 12288
s_add_u32 s37, s37, s38
buffer_load_dwordx4 v22, s[8:11], s37 offen sc1 lds
v_fma_f32 v86, v86, v47, v47
v_fma_f32 v87, v87, v47, v47
v_rcp_f32 v84, v84
v_rcp_f32 v85, v85
s_add_u32 m0, s39, 13312
s_add_u32 s37, s37, s38
buffer_load_dwordx4 v23, s[8:11], s37 offen sc1 lds
v_rcp_f32 v86, v86
v_rcp_f32 v87, v87
v_mul_f32 v252, v252, v84
s_add_u32 m0, s39, 14336
s_add_u32 s37, s37, s38
buffer_load_dwordx4 v22, s[8:11], s37 offen sc1 lds
v_mul_f32 v253, v253, v85
v_mul_f32 v254, v254, v86
v_mul_f32 v255, v255, v87
s_add_u32 m0, s39, 15360
s_add_u32 s37, s37, s38
buffer_load_dwordx4 v23, s[8:11], s37 offen sc1 lds
v_cvt_pk_bf16_f32 v110, v252, v253
v_cvt_pk_bf16_f32 v111, v254, v255
buffer_store_dwordx4 v[108:111], v27, s[24:27], s53 offen offset:768 sc1
s_waitcnt vmcnt(18)
s_barrier
s_mul_i32 s44, s34, 917504
s_lshl_b32 s39, s51, 13
s_add_u32 s44, s44, s39
s_add_u32 s44, s44, 8388608
s_and_b32 s43, s51, 1
s_xor_b32 s43, s43, s35
s_lshl_b32 s43, s43, 7
s_mov_b32 s10, 909312
s_movk_i32 s38, 1024
s_movk_i32 s40, 9216
s_movk_i32 s37, 0x4000
s_cmp_ge_u32 s51, 2
s_cselect_b32 s8, s60, s32
s_cselect_b32 s9, s61, s33
s_cselect_b32 s10, 7338112, s10
s_cselect_b32 s43, s43, s44
s_cselect_b32 s38, 16384, s38
s_cselect_b32 s40, 81920, s40
s_cselect_b32 s55, 81920, s38
s_cselect_b32 s37, 262144, s37
s_cselect_b32 s45, -1, 0
s_add_u32 s8, s8, s43
s_addc_u32 s9, s9, 0
s_mov_b32 s11, 0x20000
s_and_b32 s53, s35, 1
s_mul_i32 s54, s53, 6
s_mul_i32 s54, s54, s37
s_mul_i32 s29, s53, 2
s_add_u32 s29, s29, 6
s_mul_i32 s29, s29, s37
s_and_b32 s43, s45, 4290838528
s_add_u32 s29, s29, s43
s_mul_i32 s37, s37, 0
s_sub_u32 s37, s37, s40
v_lshrrev_b32 v19, 3, v1
v_mul_u32_u24 v19, 1920, v19
v_lshrrev_b32 v20, 4, v1
v_lshlrev_b32 v20, 5, v20
v_and_b32 v19, s45, v19
v_and_b32 v20, s45, v20
v_lshlrev_b32 v21, 4, v1
v_xor_b32 v21, v21, v20
v_add_u32 v21, v21, v19
s_mov_b64 s[72:73], -1
s_add_u32 m0, s39, 65536
s_add_u32 s37, s37, s40
buffer_load_dwordx4 v21, s[8:11], s37 offen sc1 lds
v_lshlrev_b32 v128, 16, v192
v_and_b32 v129, 0xffff0000, v192
v_lshlrev_b32 v130, 16, v193
v_and_b32 v131, 0xffff0000, v193
s_add_u32 m0, s39, 66560
s_add_u32 s37, s37, s38
buffer_load_dwordx4 v21, s[8:11], s37 offen sc1 lds
v_lshlrev_b32 v132, 16, v194
v_and_b32 v133, 0xffff0000, v194
v_lshlrev_b32 v134, 16, v195
v_and_b32 v135, 0xffff0000, v195
s_add_u32 m0, s39, 67584
s_add_u32 s37, s37, s38
buffer_load_dwordx4 v21, s[8:11], s37 offen sc1 lds
v_lshlrev_b32 v136, 16, v196
v_and_b32 v137, 0xffff0000, v196
v_lshlrev_b32 v138, 16, v197
v_and_b32 v139, 0xffff0000, v197
s_add_u32 m0, s39, 68608
s_add_u32 s37, s37, s38
buffer_load_dwordx4 v21, s[8:11], s37 offen sc1 lds
v_lshlrev_b32 v140, 16, v198
v_and_b32 v141, 0xffff0000, v198
v_lshlrev_b32 v142, 16, v199
v_and_b32 v143, 0xffff0000, v199
s_add_u32 m0, s39, 69632
s_add_u32 s37, s37, s55
buffer_load_dwordx4 v21, s[8:11], s37 offen sc1 lds
v_lshlrev_b32 v144, 16, v200
v_and_b32 v145, 0xffff0000, v200
v_lshlrev_b32 v146, 16, v201
v_and_b32 v147, 0xffff0000, v201
s_add_u32 m0, s39, 70656
s_add_u32 s37, s37, s38
buffer_load_dwordx4 v21, s[8:11], s37 offen sc1 lds
v_lshlrev_b32 v148, 16, v202
v_and_b32 v149, 0xffff0000, v202
v_lshlrev_b32 v150, 16, v203
v_and_b32 v151, 0xffff0000, v203
s_add_u32 m0, s39, 71680
s_add_u32 s37, s37, s38
buffer_load_dwordx4 v21, s[8:11], s37 offen sc1 lds
v_lshlrev_b32 v152, 16, v204
v_and_b32 v153, 0xffff0000, v204
v_lshlrev_b32 v154, 16, v205
v_and_b32 v155, 0xffff0000, v205
s_add_u32 m0, s39, 72704
s_add_u32 s37, s37, s38
buffer_load_dwordx4 v21, s[8:11], s37 offen sc1 lds
v_lshlrev_b32 v156, 16, v206
v_and_b32 v157, 0xffff0000, v206
v_lshlrev_b32 v158, 16, v207
v_and_b32 v159, 0xffff0000, v207
s_waitcnt vmcnt(8)
s_barrier
s_add_u32 m0, s39, 98304
s_add_u32 s37, s37, s40
buffer_load_dwordx4 v21, s[8:11], s37 offen sc1 lds
v_mov_b32 v192, 0
v_mov_b32 v193, 0
v_mov_b32 v194, 0
v_mov_b32 v195, 0
s_add_u32 m0, s39, 99328
s_add_u32 s37, s37, s38
buffer_load_dwordx4 v21, s[8:11], s37 offen sc1 lds
v_mov_b32 v196, 0
v_mov_b32 v197, 0
v_mov_b32 v198, 0
v_mov_b32 v199, 0
s_add_u32 m0, s39, 100352
s_add_u32 s37, s37, s38
buffer_load_dwordx4 v21, s[8:11], s37 offen sc1 lds
v_mov_b32 v200, 0
v_mov_b32 v201, 0
v_mov_b32 v202, 0
v_mov_b32 v203, 0
s_add_u32 m0, s39, 101376
s_add_u32 s37, s37, s38
buffer_load_dwordx4 v21, s[8:11], s37 offen sc1 lds
v_mov_b32 v204, 0
v_mov_b32 v205, 0
v_mov_b32 v206, 0
v_mov_b32 v207, 0
s_add_u32 m0, s39, 102400
s_add_u32 s37, s37, s55
buffer_load_dwordx4 v21, s[8:11], s37 offen sc1 lds
v_mov_b32 v208, 0
v_mov_b32 v209, 0
v_mov_b32 v210, 0
v_mov_b32 v211, 0
s_add_u32 m0, s39, 103424
s_add_u32 s37, s37, s38
buffer_load_dwordx4 v21, s[8:11], s37 offen sc1 lds
v_mov_b32 v212, 0
v_mov_b32 v213, 0
v_mov_b32 v214, 0
v_mov_b32 v215, 0
s_add_u32 m0, s39, 104448
s_add_u32 s37, s37, s38
buffer_load_dwordx4 v21, s[8:11], s37 offen sc1 lds
v_mov_b32 v216, 0
v_mov_b32 v217, 0
v_mov_b32 v218, 0
v_mov_b32 v219, 0
s_add_u32 m0, s39, 105472
s_add_u32 s37, s37, s38
buffer_load_dwordx4 v21, s[8:11], s37 offen sc1 lds
v_mov_b32 v220, 0
v_mov_b32 v221, 0
v_mov_b32 v222, 0
v_mov_b32 v223, 0
s_waitcnt vmcnt(8)
s_barrier
s_branch LK4_93
.p2align 6
Lw_123:
s_branch Lr_124
s_nop 0
.p2align 3
L3h_92:
v_mfma_f32_16x16x32_bf16 v[128:131], v[96:99], v[80:83], v[128:131]
s_lshl_b32 s43, s46, 9
v_mfma_f32_16x16x32_bf16 v[132:135], v[96:99], v[84:87], v[132:135]
s_add_u32 s43, s43, 147456
v_mfma_f32_16x16x32_bf16 v[136:139], v[96:99], v[88:91], v[136:139]
v_lshl_add_u32 v19, v17, 3, s43
v_mfma_f32_16x16x32_bf16 v[140:143], v[96:99], v[92:95], v[140:143]
ds_read_b64 v[2:3], v19 offset:0
v_mfma_f32_16x16x32_bf16 v[204:207], v[112:115], v[92:95], v[204:207]
ds_read_b64 v[4:5], v19 offset:128
v_mfma_f32_16x16x32_bf16 v[200:203], v[112:115], v[88:91], v[200:203]
ds_read_b64 v[6:7], v19 offset:256
v_mfma_f32_16x16x32_bf16 v[196:199], v[112:115], v[84:87], v[196:199]
ds_read_b64 v[8:9], v19 offset:384
v_mfma_f32_16x16x32_bf16 v[192:195], v[112:115], v[80:83], v[192:195]
s_mul_i32 s43, s47, 256
v_mfma_f32_16x16x32_bf16 v[144:147], v[100:103], v[80:83], v[144:147]
s_add_u32 s43, s43, 148480
v_mfma_f32_16x16x32_bf16 v[148:151], v[100:103], v[84:87], v[148:151]
v_lshl_add_u32 v19, v18, 4, s43
v_mfma_f32_16x16x32_bf16 v[152:155], v[100:103], v[88:91], v[152:155]
ds_read_b128 v[48:51], v19 offset:0
v_mfma_f32_16x16x32_bf16 v[156:159], v[100:103], v[92:95], v[156:159]
ds_read_b128 v[52:55], v19 offset:64
v_mfma_f32_16x16x32_bf16 v[220:223], v[116:119], v[92:95], v[220:223]
ds_read_b128 v[56:59], v19 offset:128
v_mfma_f32_16x16x32_bf16 v[216:219], v[116:119], v[88:91], v[216:219]
ds_read_b128 v[60:63], v19 offset:192
v_mfma_f32_16x16x32_bf16 v[212:215], v[116:119], v[84:87], v[212:215]
ds_read_b128 v[64:67], v19 offset:896
v_mfma_f32_16x16x32_bf16 v[208:211], v[116:119], v[80:83], v[208:211]
ds_read_b128 v[68:71], v19 offset:960
v_mfma_f32_16x16x32_bf16 v[160:163], v[104:107], v[80:83], v[160:163]
ds_read_b128 v[72:75], v19 offset:1024
v_mfma_f32_16x16x32_bf16 v[164:167], v[104:107], v[84:87], v[164:167]
ds_read_b128 v[76:79], v19 offset:1088
v_mfma_f32_16x16x32_bf16 v[168:171], v[104:107], v[88:91], v[168:171]
v_mfma_f32_16x16x32_bf16 v[172:175], v[104:107], v[92:95], v[172:175]
v_mfma_f32_16x16x32_bf16 v[236:239], v[120:123], v[92:95], v[236:239]
v_mfma_f32_16x16x32_bf16 v[232:235], v[120:123], v[88:91], v[232:235]
v_mfma_f32_16x16x32_bf16 v[228:231], v[120:123], v[84:87], v[228:231]
v_mfma_f32_16x16x32_bf16 v[224:227], v[120:123], v[80:83], v[224:227]
v_mfma_f32_16x16x32_bf16 v[176:179], v[108:111], v[80:83], v[176:179]
v_mfma_f32_16x16x32_bf16 v[180:183], v[108:111], v[84:87], v[180:183]
v_mfma_f32_16x16x32_bf16 v[184:187], v[108:111], v[88:91], v[184:187]
v_mfma_f32_16x16x32_bf16 v[188:191], v[108:111], v[92:95], v[188:191]
v_mfma_f32_16x16x32_bf16 v[252:255], v[124:127], v[92:95], v[252:255]
v_mfma_f32_16x16x32_bf16 v[248:251], v[124:127], v[88:91], v[248:251]
v_mfma_f32_16x16x32_bf16 v[244:247], v[124:127], v[84:87], v[244:247]
v_mfma_f32_16x16x32_bf16 v[240:243], v[124:127], v[80:83], v[240:243]
s_setprio 0
s_waitcnt lgkmcnt(0)
v_mov_b32 v32, v2
v_mul_f32 v88, v3, v3
v_mul_f32 v36, 0xc0135761, v3
v_mul_f32 v89, 0xbdd2d3e8, v3
v_rcp_f32 v44, v88
v_mul_f32 v40, v89, v88
v_mov_b32 v33, v4
v_mul_f32 v88, v5, v5
v_mul_f32 v37, 0xc0135761, v5
v_mul_f32 v89, 0xbdd2d3e8, v5
v_rcp_f32 v45, v88
v_mul_f32 v41, v89, v88
v_mov_b32 v34, v6
v_mul_f32 v88, v7, v7
v_mul_f32 v38, 0xc0135761, v7
v_mul_f32 v89, 0xbdd2d3e8, v7
v_rcp_f32 v46, v88
v_mul_f32 v42, v89, v88
v_mov_b32 v35, v8
v_mul_f32 v88, v9, v9
v_mul_f32 v39, 0xc0135761, v9
v_mul_f32 v89, 0xbdd2d3e8, v9
v_rcp_f32 v47, v88
v_mul_f32 v43, v89, v88
s_barrier
v_fma_f32 v128, -v32, v48, v128
v_fma_f32 v129, -v32, v49, v129
v_fma_f32 v130, -v32, v50, v130
v_fma_f32 v131, -v32, v51, v131
v_fma_f32 v192, -v32, v64, v192
v_fma_f32 v193, -v32, v65, v193
v_fma_f32 v194, -v32, v66, v194
v_fma_f32 v195, -v32, v67, v195
v_mul_f32 v80, v128, v128
v_mul_f32 v81, v129, v129
v_mul_f32 v82, v130, v130
v_mul_f32 v83, v131, v131
v_fma_f32 v80, v80, v40, v36
v_fma_f32 v81, v81, v40, v36
v_fma_f32 v82, v82, v40, v36
v_fma_f32 v83, v83, v40, v36
v_mul_f32 v80, v80, v128
v_mul_f32 v81, v81, v129
v_mul_f32 v82, v82, v130
v_mul_f32 v83, v83, v131
v_exp_f32 v80, v80
v_exp_f32 v81, v81
v_exp_f32 v82, v82
v_exp_f32 v83, v83
v_mul_f32 v192, v128, v192
v_mul_f32 v193, v129, v193
v_mul_f32 v194, v130, v194
v_mul_f32 v195, v131, v195
v_fma_f32 v80, v80, v44, v44
v_fma_f32 v81, v81, v44, v44
v_fma_f32 v82, v82, v44, v44
v_fma_f32 v83, v83, v44, v44
v_rcp_f32 v80, v80
v_rcp_f32 v81, v81
v_rcp_f32 v82, v82
v_rcp_f32 v83, v83
v_mul_f32 v192, v192, v80
v_mul_f32 v193, v193, v81
v_mul_f32 v194, v194, v82
v_mul_f32 v195, v195, v83
v_cvt_pk_bf16_f32 v96, v192, v193
v_cvt_pk_bf16_f32 v97, v194, v195
v_fma_f32 v144, -v32, v52, v144
v_fma_f32 v145, -v32, v53, v145
v_fma_f32 v146, -v32, v54, v146
v_fma_f32 v147, -v32, v55, v147
v_fma_f32 v208, -v32, v68, v208
v_fma_f32 v209, -v32, v69, v209
v_fma_f32 v210, -v32, v70, v210
v_fma_f32 v211, -v32, v71, v211
v_mul_f32 v84, v144, v144
v_mul_f32 v85, v145, v145
s_barrier
v_mul_f32 v86, v146, v146
v_mul_f32 v87, v147, v147
v_fma_f32 v84, v84, v40, v36
v_fma_f32 v85, v85, v40, v36
v_fma_f32 v86, v86, v40, v36
v_fma_f32 v87, v87, v40, v36
v_mul_f32 v84, v84, v144
v_mul_f32 v85, v85, v145
v_mul_f32 v86, v86, v146
v_mul_f32 v87, v87, v147
v_exp_f32 v84, v84
v_exp_f32 v85, v85
v_exp_f32 v86, v86
v_exp_f32 v87, v87
v_mul_f32 v208, v144, v208
v_mul_f32 v209, v145, v209
v_mul_f32 v210, v146, v210
v_mul_f32 v211, v147, v211
v_fma_f32 v84, v84, v44, v44
v_fma_f32 v85, v85, v44, v44
v_fma_f32 v86, v86, v44, v44
v_fma_f32 v87, v87, v44, v44
v_rcp_f32 v84, v84
v_rcp_f32 v85, v85
v_rcp_f32 v86, v86
v_rcp_f32 v87, v87
v_mul_f32 v208, v208, v84
v_mul_f32 v209, v209, v85
v_mul_f32 v210, v210, v86
v_mul_f32 v211, v211, v87
v_cvt_pk_bf16_f32 v98, v208, v209
v_cvt_pk_bf16_f32 v99, v210, v211
buffer_store_dwordx4 v[96:99], v27, s[24:27], 0 offen offset:0 sc1
v_fma_f32 v132, -v33, v48, v132
v_fma_f32 v133, -v33, v49, v133
v_fma_f32 v134, -v33, v50, v134
v_fma_f32 v135, -v33, v51, v135
v_fma_f32 v196, -v33, v64, v196
v_fma_f32 v197, -v33, v65, v197
v_fma_f32 v198, -v33, v66, v198
v_fma_f32 v199, -v33, v67, v199
v_mul_f32 v80, v132, v132
v_mul_f32 v81, v133, v133
v_mul_f32 v82, v134, v134
v_mul_f32 v83, v135, v135
v_fma_f32 v80, v80, v41, v37
v_fma_f32 v81, v81, v41, v37
v_fma_f32 v82, v82, v41, v37
v_fma_f32 v83, v83, v41, v37
v_mul_f32 v80, v80, v132
v_mul_f32 v81, v81, v133
v_mul_f32 v82, v82, v134
v_lshlrev_b32 v19, 11, v18
v_lshl_add_u32 v19, v17, 4, v19
s_lshl_b32 s43, s46, 10
v_add_u32 v2, s43, v19
v_add_u32 v3, 0x10000, v2
v_lshrrev_b32 v19, 2, v17
v_lshl_add_u32 v20, v18, 2, v19
v_bfe_u32 v21, v20, 1, 2
s_lshl_b32 s43, s47, 1
v_xor_b32 v21, s43, v21
v_lshlrev_b32 v20, 7, v20
v_lshl_add_u32 v20, v21, 5, v20
v_and_b32 v19, 3, v1
v_lshl_add_u32 v20, v19, 3, v20
v_add_u32 v5, 16384, v20
v_xor_b32 v6, 32, v5
v_add_u32 v7, 0x10000, v5
v_add_u32 v8, 0x10000, v6
s_lshl_b32 s43, s36, 12
v_lshl_add_u32 v9, v1, 4, s43
s_mov_b32 s54, 0x10000
s_movk_i32 s52, 0x1000
s_barrier
s_mov_b32 s88, s4
s_mov_b32 s89, s5
s_mov_b32 s90, 7340032
s_mov_b32 s91, 0x20000
s_mov_b32 s92, s6
s_mov_b32 s93, s7
s_mov_b32 s94, 7340032
s_mov_b32 s95, 0x20000
s_lshr_b32 s43, s35, 3
v_and_b32 v19, 1, v1
v_bfe_u32 v23, v1, 2, 2
s_lshl_b32 s44, s43, 1
s_add_u32 s44, s44, 6
v_add_u32 v23, s44, v23
s_mul_i32 s44, s43, 6
s_add_u32 s44, s44, 1
v_mad_u32_u24 v23, v19, s44, v23
s_lshl_b32 s44, s43, 10
s_lshl_b32 s43, s43, 11
s_sub_u32 s43, 6528, s43
s_lshr_b32 s45, s2, 3
s_mul_i32 s45, s45, 14336
s_add_u32 s43, s43, s45
v_mul_lo_u32 v31, v19, s44
v_bfe_u32 v19, v1, 1, 1
v_mul_u32_u24 v19, 7168, v19
v_add3_u32 v31, v31, v19, s43
v_add_u32 v19, 8, v23
v_and_b32 v19, 15, v19
v_mul_u32_u24 v19, 458752, v19
v_add_u32 v19, v19, v31
buffer_load_dword v30, v19, s[88:91], 0 offen
buffer_load_dword v30, v19, s[92:95], 0 offen
v_mul_f32 v83, v83, v135
v_exp_f32 v80, v80
v_exp_f32 v81, v81
v_exp_f32 v82, v82
v_exp_f32 v83, v83
v_mul_f32 v196, v132, v196
v_mul_f32 v197, v133, v197
v_mul_f32 v198, v134, v198
v_mul_f32 v199, v135, v199
v_fma_f32 v80, v80, v45, v45
v_fma_f32 v81, v81, v45, v45
v_fma_f32 v82, v82, v45, v45
v_fma_f32 v83, v83, v45, v45
v_rcp_f32 v80, v80
v_rcp_f32 v81, v81
v_rcp_f32 v82, v82
v_rcp_f32 v83, v83
v_mul_f32 v196, v196, v80
v_mul_f32 v197, v197, v81
v_mul_f32 v198, v198, v82
v_mul_f32 v199, v199, v83
v_cvt_pk_bf16_f32 v100, v196, v197
v_cvt_pk_bf16_f32 v101, v198, v199
v_fma_f32 v148, -v33, v52, v148
v_fma_f32 v149, -v33, v53, v149
v_fma_f32 v150, -v33, v54, v150
v_fma_f32 v151, -v33, v55, v151
v_fma_f32 v212, -v33, v68, v212
v_fma_f32 v213, -v33, v69, v213
v_fma_f32 v214, -v33, v70, v214
v_fma_f32 v215, -v33, v71, v215
v_mul_f32 v84, v148, v148
v_mul_f32 v85, v149, v149
v_mul_f32 v86, v150, v150
v_mul_f32 v87, v151, v151
v_fma_f32 v84, v84, v41, v37
v_fma_f32 v85, v85, v41, v37
v_fma_f32 v86, v86, v41, v37
v_fma_f32 v87, v87, v41, v37
v_mul_f32 v84, v84, v148
v_mul_f32 v85, v85, v149
v_mul_f32 v86, v86, v150
v_mul_f32 v87, v87, v151
v_exp_f32 v84, v84
v_exp_f32 v85, v85
v_exp_f32 v86, v86
v_exp_f32 v87, v87
v_mul_f32 v212, v148, v212
v_mul_f32 v213, v149, v213
v_mul_f32 v214, v150, v214
v_mul_f32 v215, v151, v215
v_fma_f32 v84, v84, v45, v45
s_barrier
v_fma_f32 v85, v85, v45, v45
v_fma_f32 v86, v86, v45, v45
v_fma_f32 v87, v87, v45, v45
v_rcp_f32 v84, v84
v_rcp_f32 v85, v85
v_rcp_f32 v86, v86
v_rcp_f32 v87, v87
v_mul_f32 v212, v212, v84
v_mul_f32 v213, v213, v85
v_mul_f32 v214, v214, v86
v_mul_f32 v215, v215, v87
v_cvt_pk_bf16_f32 v102, v212, v213
v_cvt_pk_bf16_f32 v103, v214, v215
buffer_store_dwordx4 v[100:103], v27, s[24:27], 0 offen offset:256 sc1
v_fma_f32 v136, -v34, v48, v136
v_fma_f32 v137, -v34, v49, v137
v_fma_f32 v138, -v34, v50, v138
v_fma_f32 v139, -v34, v51, v139
v_fma_f32 v200, -v34, v64, v200
v_fma_f32 v201, -v34, v65, v201
v_fma_f32 v202, -v34, v66, v202
v_fma_f32 v203, -v34, v67, v203
v_mul_f32 v80, v136, v136
v_mul_f32 v81, v137, v137
v_mul_f32 v82, v138, v138
v_mul_f32 v83, v139, v139
v_fma_f32 v80, v80, v42, v38
v_fma_f32 v81, v81, v42, v38
v_fma_f32 v82, v82, v42, v38
v_fma_f32 v83, v83, v42, v38
v_mul_f32 v80, v80, v136
v_mul_f32 v81, v81, v137
v_mul_f32 v82, v82, v138
v_mul_f32 v83, v83, v139
v_exp_f32 v80, v80
v_exp_f32 v81, v81
v_exp_f32 v82, v82
v_exp_f32 v83, v83
v_mul_f32 v200, v136, v200
v_mul_f32 v201, v137, v201
v_mul_f32 v202, v138, v202
v_mul_f32 v203, v139, v203
v_fma_f32 v80, v80, v46, v46
v_fma_f32 v81, v81, v46, v46
v_fma_f32 v82, v82, v46, v46
v_fma_f32 v83, v83, v46, v46
v_rcp_f32 v80, v80
v_rcp_f32 v81, v81
v_rcp_f32 v82, v82
v_rcp_f32 v83, v83
v_mul_f32 v200, v200, v80
v_mul_f32 v201, v201, v81
v_mul_f32 v202, v202, v82
s_barrier
v_mul_f32 v203, v203, v83
v_cvt_pk_bf16_f32 v104, v200, v201
v_cvt_pk_bf16_f32 v105, v202, v203
v_fma_f32 v152, -v34, v52, v152
v_fma_f32 v153, -v34, v53, v153
v_fma_f32 v154, -v34, v54, v154
v_fma_f32 v155, -v34, v55, v155
v_fma_f32 v216, -v34, v68, v216
v_fma_f32 v217, -v34, v69, v217
v_fma_f32 v218, -v34, v70, v218
v_fma_f32 v219, -v34, v71, v219
v_mul_f32 v84, v152, v152
v_mul_f32 v85, v153, v153
v_mul_f32 v86, v154, v154
v_mul_f32 v87, v155, v155
v_fma_f32 v84, v84, v42, v38
v_fma_f32 v85, v85, v42, v38
v_fma_f32 v86, v86, v42, v38
v_fma_f32 v87, v87, v42, v38
v_mul_f32 v84, v84, v152
v_mul_f32 v85, v85, v153
v_mul_f32 v86, v86, v154
v_mul_f32 v87, v87, v155
v_exp_f32 v84, v84
v_exp_f32 v85, v85
v_exp_f32 v86, v86
v_exp_f32 v87, v87
v_mul_f32 v216, v152, v216
v_mul_f32 v217, v153, v217
v_mul_f32 v218, v154, v218
v_mul_f32 v219, v155, v219
v_fma_f32 v84, v84, v46, v46
v_fma_f32 v85, v85, v46, v46
v_fma_f32 v86, v86, v46, v46
v_fma_f32 v87, v87, v46, v46
v_rcp_f32 v84, v84
v_rcp_f32 v85, v85
v_rcp_f32 v86, v86
v_rcp_f32 v87, v87
v_mul_f32 v216, v216, v84
v_mul_f32 v217, v217, v85
v_mul_f32 v218, v218, v86
v_mul_f32 v219, v219, v87
v_cvt_pk_bf16_f32 v106, v216, v217
v_cvt_pk_bf16_f32 v107, v218, v219
buffer_store_dwordx4 v[104:107], v27, s[24:27], 0 offen offset:512 sc1
v_fma_f32 v140, -v35, v48, v140
v_fma_f32 v141, -v35, v49, v141
v_fma_f32 v142, -v35, v50, v142
v_fma_f32 v143, -v35, v51, v143
v_fma_f32 v204, -v35, v64, v204
v_fma_f32 v205, -v35, v65, v205
s_barrier
v_fma_f32 v206, -v35, v66, v206
v_fma_f32 v207, -v35, v67, v207
v_mul_f32 v80, v140, v140
v_mul_f32 v81, v141, v141
v_mul_f32 v82, v142, v142
v_mul_f32 v83, v143, v143
v_fma_f32 v80, v80, v43, v39
v_fma_f32 v81, v81, v43, v39
v_fma_f32 v82, v82, v43, v39
v_fma_f32 v83, v83, v43, v39
v_mul_f32 v80, v80, v140
v_mul_f32 v81, v81, v141
v_mul_f32 v82, v82, v142
v_mul_f32 v83, v83, v143
v_exp_f32 v80, v80
v_exp_f32 v81, v81
v_exp_f32 v82, v82
v_exp_f32 v83, v83
v_mul_f32 v204, v140, v204
v_mul_f32 v205, v141, v205
v_mul_f32 v206, v142, v206
v_mul_f32 v207, v143, v207
v_fma_f32 v80, v80, v47, v47
v_fma_f32 v81, v81, v47, v47
v_fma_f32 v82, v82, v47, v47
v_fma_f32 v83, v83, v47, v47
v_rcp_f32 v80, v80
v_rcp_f32 v81, v81
v_rcp_f32 v82, v82
v_rcp_f32 v83, v83
v_mul_f32 v204, v204, v80
v_mul_f32 v205, v205, v81
v_mul_f32 v206, v206, v82
v_mul_f32 v207, v207, v83
v_cvt_pk_bf16_f32 v108, v204, v205
v_cvt_pk_bf16_f32 v109, v206, v207
v_fma_f32 v156, -v35, v52, v156
v_fma_f32 v157, -v35, v53, v157
v_fma_f32 v158, -v35, v54, v158
v_fma_f32 v159, -v35, v55, v159
v_fma_f32 v220, -v35, v68, v220
v_fma_f32 v221, -v35, v69, v221
v_fma_f32 v222, -v35, v70, v222
v_fma_f32 v223, -v35, v71, v223
v_mul_f32 v84, v156, v156
v_mul_f32 v85, v157, v157
v_mul_f32 v86, v158, v158
v_mul_f32 v87, v159, v159
v_fma_f32 v84, v84, v43, v39
v_fma_f32 v85, v85, v43, v39
v_fma_f32 v86, v86, v43, v39
v_fma_f32 v87, v87, v43, v39
s_barrier
s_getpc_b64 s[78:79]
Lpc_94:
s_sub_u32 s78, s78, Lpc_94-sequential_preLN__sliding_local_dilated__glu_gated_geglu__prompt_kernel
s_subb_u32 s79, s79, 0
s_lshr_b32 s43, s2, 3
s_mul_i32 s43, s43, 3840
v_min_u32 v19, 29, v1
v_lshl_add_u32 v19, v19, 7, s43
v_min_u32 v19, Ldone_1-sequential_preLN__sliding_local_dilated__glu_gated_geglu__prompt_kernel, v19
global_load_dword v30, v19, s[78:79]
s_mov_b32 s88, s4
s_mov_b32 s89, s5
s_mov_b32 s90, 7340032
s_mov_b32 s91, 0x20000
s_mov_b32 s92, s6
s_mov_b32 s93, s7
s_mov_b32 s94, 7340032
s_mov_b32 s95, 0x20000
s_lshr_b32 s43, s35, 3
v_and_b32 v19, 1, v1
v_bfe_u32 v23, v1, 2, 2
s_lshl_b32 s44, s43, 1
s_add_u32 s44, s44, 6
v_add_u32 v23, s44, v23
s_mul_i32 s44, s43, 6
s_add_u32 s44, s44, 1
v_mad_u32_u24 v23, v19, s44, v23
s_lshl_b32 s44, s43, 10
s_lshl_b32 s43, s43, 11
s_sub_u32 s43, 6528, s43
s_lshr_b32 s45, s2, 3
s_mul_i32 s45, s45, 14336
s_add_u32 s43, s43, s45
v_mul_lo_u32 v31, v19, s44
v_bfe_u32 v19, v1, 1, 1
v_mul_u32_u24 v19, 7168, v19
v_add3_u32 v31, v31, v19, s43
v_add_u32 v19, 12, v23
v_and_b32 v19, 15, v19
v_mul_u32_u24 v19, 458752, v19
v_add_u32 v19, v19, v31
buffer_load_dword v30, v19, s[88:91], 0 offen
buffer_load_dword v30, v19, s[92:95], 0 offen
v_mul_f32 v84, v84, v156
v_mul_f32 v85, v85, v157
v_mul_f32 v86, v86, v158
v_mul_f32 v87, v87, v159
v_exp_f32 v84, v84
v_exp_f32 v85, v85
v_exp_f32 v86, v86
v_exp_f32 v87, v87
v_mul_f32 v220, v156, v220
v_mul_f32 v221, v157, v221
v_mul_f32 v222, v158, v222
v_mul_f32 v223, v159, v223
v_fma_f32 v84, v84, v47, v47
v_fma_f32 v85, v85, v47, v47
v_fma_f32 v86, v86, v47, v47
v_fma_f32 v87, v87, v47, v47
v_rcp_f32 v84, v84
v_rcp_f32 v85, v85
v_rcp_f32 v86, v86
v_rcp_f32 v87, v87
v_mul_f32 v220, v220, v84
v_mul_f32 v221, v221, v85
v_mul_f32 v222, v222, v86
v_mul_f32 v223, v223, v87
v_cvt_pk_bf16_f32 v110, v220, v221
v_cvt_pk_bf16_f32 v111, v222, v223
buffer_store_dwordx4 v[108:111], v27, s[24:27], 0 offen offset:768 sc1
v_fma_f32 v160, -v32, v56, v160
v_fma_f32 v161, -v32, v57, v161
v_fma_f32 v162, -v32, v58, v162
v_fma_f32 v163, -v32, v59, v163
v_fma_f32 v224, -v32, v72, v224
v_fma_f32 v225, -v32, v73, v225
v_fma_f32 v226, -v32, v74, v226
v_fma_f32 v227, -v32, v75, v227
v_mul_f32 v80, v160, v160
v_mul_f32 v81, v161, v161
v_mul_f32 v82, v162, v162
v_mul_f32 v83, v163, v163
v_fma_f32 v80, v80, v40, v36
v_fma_f32 v81, v81, v40, v36
v_fma_f32 v82, v82, v40, v36
v_fma_f32 v83, v83, v40, v36
v_mul_f32 v80, v80, v160
v_mul_f32 v81, v81, v161
v_mul_f32 v82, v82, v162
v_mul_f32 v83, v83, v163
v_exp_f32 v80, v80
v_exp_f32 v81, v81
v_exp_f32 v82, v82
v_exp_f32 v83, v83
v_mul_f32 v224, v160, v224
v_mul_f32 v225, v161, v225
s_barrier
v_mul_f32 v226, v162, v226
v_mul_f32 v227, v163, v227
v_fma_f32 v80, v80, v44, v44
v_fma_f32 v81, v81, v44, v44
v_fma_f32 v82, v82, v44, v44
v_fma_f32 v83, v83, v44, v44
v_rcp_f32 v80, v80
v_rcp_f32 v81, v81
v_rcp_f32 v82, v82
v_rcp_f32 v83, v83
v_mul_f32 v224, v224, v80
v_mul_f32 v225, v225, v81
v_mul_f32 v226, v226, v82
v_mul_f32 v227, v227, v83
v_cvt_pk_bf16_f32 v96, v224, v225
v_cvt_pk_bf16_f32 v97, v226, v227
v_fma_f32 v176, -v32, v60, v176
v_fma_f32 v177, -v32, v61, v177
v_fma_f32 v178, -v32, v62, v178
v_fma_f32 v179, -v32, v63, v179
v_fma_f32 v240, -v32, v76, v240
v_fma_f32 v241, -v32, v77, v241
v_fma_f32 v242, -v32, v78, v242
v_fma_f32 v243, -v32, v79, v243
v_mul_f32 v84, v176, v176
v_mul_f32 v85, v177, v177
v_mul_f32 v86, v178, v178
v_mul_f32 v87, v179, v179
v_fma_f32 v84, v84, v40, v36
v_fma_f32 v85, v85, v40, v36
v_fma_f32 v86, v86, v40, v36
v_fma_f32 v87, v87, v40, v36
v_mul_f32 v84, v84, v176
v_mul_f32 v85, v85, v177
v_mul_f32 v86, v86, v178
v_mul_f32 v87, v87, v179
v_exp_f32 v84, v84
v_exp_f32 v85, v85
v_exp_f32 v86, v86
v_exp_f32 v87, v87
v_mul_f32 v240, v176, v240
v_mul_f32 v241, v177, v241
v_mul_f32 v242, v178, v242
v_mul_f32 v243, v179, v243
v_fma_f32 v84, v84, v44, v44
v_fma_f32 v85, v85, v44, v44
v_fma_f32 v86, v86, v44, v44
v_fma_f32 v87, v87, v44, v44
v_rcp_f32 v84, v84
v_rcp_f32 v85, v85
v_rcp_f32 v86, v86
v_rcp_f32 v87, v87
v_lshlrev_b32 v19, 11, v18
v_lshl_add_u32 v19, v17, 4, v19
s_lshl_b32 s43, s46, 10
s_lshl_b32 s44, s47, 13
v_add3_u32 v208, v19, s43, 0
v_add_u32 v208, s44, v208
buffer_load_dwordx4 v[192:195], v208, s[20:23], 0 offen offset:0 sc1
buffer_load_dwordx4 v[196:199], v208, s[20:23], 0 offen offset:256 sc1
buffer_load_dwordx4 v[200:203], v208, s[20:23], 0 offen offset:512 sc1
buffer_load_dwordx4 v[204:207], v208, s[20:23], 0 offen offset:768 sc1
s_waitcnt vmcnt(4)
s_barrier
s_add_u32 s43, s34, 32
s_lshl_b32 s43, s43, 7
v_mov_b32 v21, s43
v_mov_b32 v22, 1
s_mov_b64 exec, 1
buffer_atomic_add v22, v21, s[56:59], 0 offen sc1
s_mov_b64 exec, -1
v_mul_f32 v240, v240, v84
v_mul_f32 v241, v241, v85
v_mul_f32 v242, v242, v86
v_mul_f32 v243, v243, v87
v_cvt_pk_bf16_f32 v98, v240, v241
v_cvt_pk_bf16_f32 v99, v242, v243
buffer_store_dwordx4 v[96:99], v27, s[24:27], s53 offen offset:0 sc1
v_fma_f32 v164, -v33, v56, v164
v_fma_f32 v165, -v33, v57, v165
v_fma_f32 v166, -v33, v58, v166
v_fma_f32 v167, -v33, v59, v167
v_fma_f32 v228, -v33, v72, v228
v_fma_f32 v229, -v33, v73, v229
v_fma_f32 v230, -v33, v74, v230
v_fma_f32 v231, -v33, v75, v231
v_mul_f32 v80, v164, v164
v_mul_f32 v81, v165, v165
v_mul_f32 v82, v166, v166
v_mul_f32 v83, v167, v167
v_fma_f32 v80, v80, v41, v37
v_fma_f32 v81, v81, v41, v37
v_fma_f32 v82, v82, v41, v37
v_fma_f32 v83, v83, v41, v37
v_mul_f32 v80, v80, v164
v_mul_f32 v81, v81, v165
v_mul_f32 v82, v82, v166
v_mul_f32 v83, v83, v167
v_exp_f32 v80, v80
v_exp_f32 v81, v81
v_exp_f32 v82, v82
v_exp_f32 v83, v83
v_mul_f32 v228, v164, v228
v_mul_f32 v229, v165, v229
v_mul_f32 v230, v166, v230
v_mul_f32 v231, v167, v231
v_fma_f32 v80, v80, v45, v45
v_fma_f32 v81, v81, v45, v45
v_fma_f32 v82, v82, v45, v45
v_fma_f32 v83, v83, v45, v45
v_rcp_f32 v80, v80
v_rcp_f32 v81, v81
v_rcp_f32 v82, v82
v_rcp_f32 v83, v83
v_mul_f32 v228, v228, v80
v_mul_f32 v229, v229, v81
v_mul_f32 v230, v230, v82
v_mul_f32 v231, v231, v83
v_cvt_pk_bf16_f32 v100, v228, v229
v_cvt_pk_bf16_f32 v101, v230, v231
v_fma_f32 v180, -v33, v60, v180
v_fma_f32 v181, -v33, v61, v181
v_fma_f32 v182, -v33, v62, v182
s_barrier
s_mov_b32 s80, s60
s_mov_b32 s81, s61
s_mov_b32 s82, 7340032
s_mov_b32 s83, 0x20000
v_and_b32 v29, 31, v1
v_lshlrev_b32 v29, 11, v29
s_and_b32 s43, s35, 8
s_or_b32 s43, s43, 3
s_lshl_b32 s43, s43, 7
v_add_u32 v29, s43, v29
s_lshr_b32 s44, s2, 3
s_lshl_b32 s44, s44, 17
s_add_u32 s43, s44, 0
buffer_load_dword v30, v29, s[80:83], s43 offen
v_fma_f32 v183, -v33, v63, v183
v_fma_f32 v244, -v33, v76, v244
v_fma_f32 v245, -v33, v77, v245
v_fma_f32 v246, -v33, v78, v246
v_fma_f32 v247, -v33, v79, v247
v_mul_f32 v84, v180, v180
v_mul_f32 v85, v181, v181
v_mul_f32 v86, v182, v182
v_mul_f32 v87, v183, v183
v_fma_f32 v84, v84, v41, v37
v_fma_f32 v85, v85, v41, v37
v_fma_f32 v86, v86, v41, v37
v_fma_f32 v87, v87, v41, v37
v_mul_f32 v84, v84, v180
v_mul_f32 v85, v85, v181
v_mul_f32 v86, v86, v182
v_mul_f32 v87, v87, v183
v_exp_f32 v84, v84
v_exp_f32 v85, v85
v_exp_f32 v86, v86
v_exp_f32 v87, v87
v_mul_f32 v244, v180, v244
v_mul_f32 v245, v181, v245
v_mul_f32 v246, v182, v246
v_mul_f32 v247, v183, v247
v_fma_f32 v84, v84, v45, v45
v_fma_f32 v85, v85, v45, v45
v_fma_f32 v86, v86, v45, v45
v_fma_f32 v87, v87, v45, v45
v_rcp_f32 v84, v84
v_rcp_f32 v85, v85
v_rcp_f32 v86, v86
v_rcp_f32 v87, v87
v_mul_f32 v244, v244, v84
v_mul_f32 v245, v245, v85
v_mul_f32 v246, v246, v86
v_mul_f32 v247, v247, v87
v_cvt_pk_bf16_f32 v102, v244, v245
v_cvt_pk_bf16_f32 v103, v246, v247
buffer_store_dwordx4 v[100:103], v27, s[24:27], s53 offen offset:256 sc1
v_fma_f32 v168, -v34, v56, v168
v_fma_f32 v169, -v34, v57, v169
v_fma_f32 v170, -v34, v58, v170
v_fma_f32 v171, -v34, v59, v171
v_fma_f32 v232, -v34, v72, v232
v_fma_f32 v233, -v34, v73, v233
v_fma_f32 v234, -v34, v74, v234
v_fma_f32 v235, -v34, v75, v235
v_mul_f32 v80, v168, v168
v_mul_f32 v81, v169, v169
v_mul_f32 v82, v170, v170
v_mul_f32 v83, v171, v171
v_fma_f32 v80, v80, v42, v38
s_waitcnt vmcnt(2)
s_barrier
v_fma_f32 v81, v81, v42, v38
v_fma_f32 v82, v82, v42, v38
v_fma_f32 v83, v83, v42, v38
v_mul_f32 v80, v80, v168
v_mul_f32 v81, v81, v169
v_mul_f32 v82, v82, v170
v_mul_f32 v83, v83, v171
v_exp_f32 v80, v80
v_exp_f32 v81, v81
v_exp_f32 v82, v82
v_exp_f32 v83, v83
v_mul_f32 v232, v168, v232
v_mul_f32 v233, v169, v233
v_mul_f32 v234, v170, v234
v_mul_f32 v235, v171, v235
v_fma_f32 v80, v80, v46, v46
v_fma_f32 v81, v81, v46, v46
v_fma_f32 v82, v82, v46, v46
v_fma_f32 v83, v83, v46, v46
v_rcp_f32 v80, v80
v_rcp_f32 v81, v81
v_rcp_f32 v82, v82
v_rcp_f32 v83, v83
v_mul_f32 v232, v232, v80
v_mul_f32 v233, v233, v81
v_mul_f32 v234, v234, v82
v_mul_f32 v235, v235, v83
v_cvt_pk_bf16_f32 v104, v232, v233
v_cvt_pk_bf16_f32 v105, v234, v235
v_fma_f32 v184, -v34, v60, v184
v_fma_f32 v185, -v34, v61, v185
v_fma_f32 v186, -v34, v62, v186
v_fma_f32 v187, -v34, v63, v187
v_fma_f32 v248, -v34, v76, v248
v_fma_f32 v249, -v34, v77, v249
v_fma_f32 v250, -v34, v78, v250
v_fma_f32 v251, -v34, v79, v251
v_mul_f32 v84, v184, v184
v_mul_f32 v85, v185, v185
v_mul_f32 v86, v186, v186
v_mul_f32 v87, v187, v187
v_fma_f32 v84, v84, v42, v38
v_fma_f32 v85, v85, v42, v38
v_fma_f32 v86, v86, v42, v38
v_fma_f32 v87, v87, v42, v38
v_mul_f32 v84, v84, v184
v_mul_f32 v85, v85, v185
v_mul_f32 v86, v86, v186
v_mul_f32 v87, v87, v187
v_exp_f32 v84, v84
v_exp_f32 v85, v85
v_exp_f32 v86, v86
s_barrier
s_add_u32 s43, s34, 32
s_lshl_b32 s43, s43, 7
v_mov_b32 v21, s43
v_mov_b32 v23, 16
buffer_load_dword v22, v21, s[56:59], 0 offen sc1
v_exp_f32 v87, v87
v_mul_f32 v248, v184, v248
v_mul_f32 v249, v185, v249
v_mul_f32 v250, v186, v250
v_mul_f32 v251, v187, v251
v_fma_f32 v84, v84, v46, v46
v_fma_f32 v85, v85, v46, v46
v_fma_f32 v86, v86, v46, v46
v_fma_f32 v87, v87, v46, v46
v_rcp_f32 v84, v84
v_rcp_f32 v85, v85
v_rcp_f32 v86, v86
v_rcp_f32 v87, v87
v_mul_f32 v248, v248, v84
v_mul_f32 v249, v249, v85
v_mul_f32 v250, v250, v86
v_mul_f32 v251, v251, v87
v_cvt_pk_bf16_f32 v106, v248, v249
v_cvt_pk_bf16_f32 v107, v250, v251
buffer_store_dwordx4 v[104:107], v27, s[24:27], s53 offen offset:512 sc1
v_fma_f32 v172, -v35, v56, v172
v_fma_f32 v173, -v35, v57, v173
v_fma_f32 v174, -v35, v58, v174
v_fma_f32 v175, -v35, v59, v175
v_fma_f32 v236, -v35, v72, v236
v_fma_f32 v237, -v35, v73, v237
v_fma_f32 v238, -v35, v74, v238
v_fma_f32 v239, -v35, v75, v239
v_mul_f32 v80, v172, v172
v_mul_f32 v81, v173, v173
v_mul_f32 v82, v174, v174
v_mul_f32 v83, v175, v175
v_fma_f32 v80, v80, v43, v39
v_fma_f32 v81, v81, v43, v39
v_fma_f32 v82, v82, v43, v39
v_fma_f32 v83, v83, v43, v39
v_mul_f32 v80, v80, v172
v_mul_f32 v81, v81, v173
v_mul_f32 v82, v82, v174
v_mul_f32 v83, v83, v175
v_exp_f32 v80, v80
v_exp_f32 v81, v81
v_exp_f32 v82, v82
v_exp_f32 v83, v83
v_mul_f32 v236, v172, v236
v_mul_f32 v237, v173, v237
v_mul_f32 v238, v174, v238
v_mul_f32 v239, v175, v239
v_fma_f32 v80, v80, v47, v47
v_fma_f32 v81, v81, v47, v47
v_fma_f32 v82, v82, v47, v47
v_fma_f32 v83, v83, v47, v47
s_barrier
v_rcp_f32 v80, v80
v_rcp_f32 v81, v81
v_rcp_f32 v82, v82
v_rcp_f32 v83, v83
v_mul_f32 v236, v236, v80
v_mul_f32 v237, v237, v81
v_mul_f32 v238, v238, v82
v_mul_f32 v239, v239, v83
v_cvt_pk_bf16_f32 v108, v236, v237
v_cvt_pk_bf16_f32 v109, v238, v239
v_fma_f32 v188, -v35, v60, v188
v_fma_f32 v189, -v35, v61, v189
v_fma_f32 v190, -v35, v62, v190
v_fma_f32 v191, -v35, v63, v191
v_fma_f32 v252, -v35, v76, v252
v_fma_f32 v253, -v35, v77, v253
v_fma_f32 v254, -v35, v78, v254
v_fma_f32 v255, -v35, v79, v255
v_mul_f32 v84, v188, v188
v_mul_f32 v85, v189, v189
v_mul_f32 v86, v190, v190
v_mul_f32 v87, v191, v191
v_fma_f32 v84, v84, v43, v39
v_fma_f32 v85, v85, v43, v39
v_fma_f32 v86, v86, v43, v39
v_fma_f32 v87, v87, v43, v39
v_mul_f32 v84, v84, v188
v_mul_f32 v85, v85, v189
v_mul_f32 v86, v86, v190
v_mul_f32 v87, v87, v191
v_exp_f32 v84, v84
v_exp_f32 v85, v85
v_exp_f32 v86, v86
v_exp_f32 v87, v87
v_mul_f32 v252, v188, v252
v_mul_f32 v253, v189, v253
v_mul_f32 v254, v190, v254
v_mul_f32 v255, v191, v255
v_fma_f32 v84, v84, v47, v47
v_fma_f32 v85, v85, v47, v47
v_fma_f32 v86, v86, v47, v47
v_fma_f32 v87, v87, v47, v47
v_rcp_f32 v84, v84
v_rcp_f32 v85, v85
v_rcp_f32 v86, v86
v_rcp_f32 v87, v87
v_mul_f32 v252, v252, v84
v_mul_f32 v253, v253, v85
v_mul_f32 v254, v254, v86
v_mul_f32 v255, v255, v87
v_cvt_pk_bf16_f32 v110, v252, v253
v_cvt_pk_bf16_f32 v111, v254, v255
buffer_store_dwordx4 v[108:111], v27, s[24:27], s53 offen offset:768 sc1
s_mov_b32 s41, 0x10000
s_waitcnt vmcnt(2)
s_branch Lpf_97
Lpoll_95:
s_waitcnt vmcnt(0)
Lpf_97:
v_cmp_ne_u32 vcc, v23, v22
s_nop 4
s_cbranch_vccz Lpok_96
buffer_load_dword v22, v21, s[56:59], 0 offen sc1
s_sub_u32 s41, s41, 1
s_cmp_lg_u32 s41, 0
s_cbranch_scc1 Lpoll_95
s_waitcnt vmcnt(0)
Lpok_96:
s_barrier
v_lshlrev_b32 v128, 16, v192
v_and_b32 v129, 0xffff0000, v192
v_lshlrev_b32 v130, 16, v193
v_and_b32 v131, 0xffff0000, v193
v_lshlrev_b32 v132, 16, v194
v_and_b32 v133, 0xffff0000, v194
v_lshlrev_b32 v134, 16, v195
v_and_b32 v135, 0xffff0000, v195
v_lshlrev_b32 v136, 16, v196
v_and_b32 v137, 0xffff0000, v196
v_lshlrev_b32 v138, 16, v197
v_and_b32 v139, 0xffff0000, v197
v_lshlrev_b32 v140, 16, v198
v_and_b32 v141, 0xffff0000, v198
v_lshlrev_b32 v142, 16, v199
v_and_b32 v143, 0xffff0000, v199
v_lshlrev_b32 v144, 16, v200
v_and_b32 v145, 0xffff0000, v200
v_lshlrev_b32 v146, 16, v201
v_and_b32 v147, 0xffff0000, v201
v_lshlrev_b32 v148, 16, v202
v_and_b32 v149, 0xffff0000, v202
v_lshlrev_b32 v150, 16, v203
v_and_b32 v151, 0xffff0000, v203
v_lshlrev_b32 v152, 16, v204
v_and_b32 v153, 0xffff0000, v204
v_lshlrev_b32 v154, 16, v205
v_and_b32 v155, 0xffff0000, v205
v_lshlrev_b32 v156, 16, v206
v_and_b32 v157, 0xffff0000, v206
v_lshlrev_b32 v158, 16, v207
v_and_b32 v159, 0xffff0000, v207
s_waitcnt vmcnt(0)
s_barrier
s_add_u32 s43, s34, 48
s_lshl_b32 s43, s43, 7
v_mov_b32 v22, s43
v_mov_b32 v23, 1
s_mov_b64 exec, 1
buffer_atomic_add v23, v22, s[56:59], 0 offen sc1
s_mov_b64 exec, -1
s_branch Lw_98
Lr_99:
v_mov_b32 v192, 0
v_mov_b32 v193, 0
v_mov_b32 v194, 0
v_mov_b32 v195, 0
v_mov_b32 v196, 0
v_mov_b32 v197, 0
v_mov_b32 v198, 0
v_mov_b32 v199, 0
v_mov_b32 v200, 0
v_mov_b32 v201, 0
v_mov_b32 v202, 0
v_mov_b32 v203, 0
v_mov_b32 v204, 0
v_mov_b32 v205, 0
v_mov_b32 v206, 0
v_mov_b32 v207, 0
v_mov_b32 v208, 0
v_mov_b32 v209, 0
v_mov_b32 v210, 0
v_mov_b32 v211, 0
v_mov_b32 v212, 0
v_mov_b32 v213, 0
v_mov_b32 v214, 0
v_mov_b32 v215, 0
v_mov_b32 v216, 0
v_mov_b32 v217, 0
v_mov_b32 v218, 0
v_mov_b32 v219, 0
v_mov_b32 v220, 0
v_mov_b32 v221, 0
v_mov_b32 v222, 0
v_mov_b32 v223, 0
s_barrier
.p2align 3
LK4_93:
s_setprio 1
ds_read_b64_tr_b16 v[64:65], v7 offset:0
ds_read_b128 v[32:35], v3 offset:0
ds_read_b64_tr_b16 v[66:67], v7 offset:2048
ds_read_b128 v[36:39], v3 offset:256
ds_read_b64_tr_b16 v[68:69], v8 offset:0
ds_read_b128 v[40:43], v3 offset:512
ds_read_b64_tr_b16 v[70:71], v8 offset:2048
ds_read_b128 v[44:47], v3 offset:768
ds_read_b64_tr_b16 v[72:73], v7 offset:4096
ds_read_b128 v[48:51], v3 offset:8192
ds_read_b64_tr_b16 v[74:75], v7 offset:6144
ds_read_b128 v[52:55], v3 offset:8448
ds_read_b64_tr_b16 v[76:77], v8 offset:4096
ds_read_b128 v[56:59], v3 offset:8704
ds_read_b64_tr_b16 v[78:79], v8 offset:6144
ds_read_b128 v[60:63], v3 offset:8960
s_waitcnt vmcnt(0) lgkmcnt(0)
s_barrier
v_mfma_f32_16x16x32_bf16 v[128:131], v[64:67], v[32:35], v[128:131]
ds_read_b64_tr_b16 v[160:161], v7 offset:32768
v_mfma_f32_16x16x32_bf16 v[132:135], v[68:71], v[32:35], v[132:135]
ds_read_b128 v[96:99], v3 offset:32768
v_mfma_f32_16x16x32_bf16 v[136:139], v[64:67], v[36:39], v[136:139]
ds_read_b64_tr_b16 v[162:163], v7 offset:34816
v_mfma_f32_16x16x32_bf16 v[140:143], v[68:71], v[36:39], v[140:143]
ds_read_b128 v[100:103], v3 offset:33024
v_mfma_f32_16x16x32_bf16 v[144:147], v[64:67], v[40:43], v[144:147]
ds_read_b64_tr_b16 v[164:165], v8 offset:32768
v_mfma_f32_16x16x32_bf16 v[148:151], v[68:71], v[40:43], v[148:151]
ds_read_b128 v[104:107], v3 offset:33280
v_mfma_f32_16x16x32_bf16 v[152:155], v[64:67], v[44:47], v[152:155]
ds_read_b64_tr_b16 v[166:167], v8 offset:34816
v_mfma_f32_16x16x32_bf16 v[156:159], v[68:71], v[44:47], v[156:159]
ds_read_b128 v[108:111], v3 offset:33536
v_mfma_f32_16x16x32_bf16 v[128:131], v[72:75], v[48:51], v[128:131]
ds_read_b64_tr_b16 v[168:169], v7 offset:36864
v_mfma_f32_16x16x32_bf16 v[132:135], v[76:79], v[48:51], v[132:135]
ds_read_b128 v[112:115], v3 offset:40960
v_mfma_f32_16x16x32_bf16 v[136:139], v[72:75], v[52:55], v[136:139]
ds_read_b64_tr_b16 v[170:171], v7 offset:38912
v_mfma_f32_16x16x32_bf16 v[140:143], v[76:79], v[52:55], v[140:143]
ds_read_b128 v[116:119], v3 offset:41216
v_mfma_f32_16x16x32_bf16 v[144:147], v[72:75], v[56:59], v[144:147]
ds_read_b64_tr_b16 v[172:173], v8 offset:36864
v_mfma_f32_16x16x32_bf16 v[148:151], v[76:79], v[56:59], v[148:151]
ds_read_b128 v[120:123], v3 offset:41472
v_mfma_f32_16x16x32_bf16 v[152:155], v[72:75], v[60:63], v[152:155]
ds_read_b64_tr_b16 v[174:175], v8 offset:38912
v_mfma_f32_16x16x32_bf16 v[156:159], v[76:79], v[60:63], v[156:159]
ds_read_b128 v[124:127], v3 offset:41728
s_waitcnt lgkmcnt(0)
s_barrier
v_mfma_f32_16x16x32_bf16 v[128:131], v[160:163], v[96:99], v[128:131]
ds_read_b64_tr_b16 v[64:65], v5 offset:0
v_mfma_f32_16x16x32_bf16 v[132:135], v[164:167], v[96:99], v[132:135]
ds_read_b128 v[32:35], v2 offset:0
v_mfma_f32_16x16x32_bf16 v[136:139], v[160:163], v[100:103], v[136:139]
ds_read_b64_tr_b16 v[66:67], v5 offset:2048
v_mfma_f32_16x16x32_bf16 v[140:143], v[164:167], v[100:103], v[140:143]
ds_read_b128 v[36:39], v2 offset:256
v_mfma_f32_16x16x32_bf16 v[144:147], v[160:163], v[104:107], v[144:147]
ds_read_b64_tr_b16 v[68:69], v6 offset:0
v_mfma_f32_16x16x32_bf16 v[148:151], v[164:167], v[104:107], v[148:151]
ds_read_b128 v[40:43], v2 offset:512
v_mfma_f32_16x16x32_bf16 v[152:155], v[160:163], v[108:111], v[152:155]
ds_read_b64_tr_b16 v[70:71], v6 offset:2048
v_mfma_f32_16x16x32_bf16 v[156:159], v[164:167], v[108:111], v[156:159]
ds_read_b128 v[44:47], v2 offset:768
v_mfma_f32_16x16x32_bf16 v[128:131], v[168:171], v[112:115], v[128:131]
ds_read_b64_tr_b16 v[72:73], v5 offset:4096
v_mfma_f32_16x16x32_bf16 v[132:135], v[172:175], v[112:115], v[132:135]
ds_read_b128 v[48:51], v2 offset:8192
v_mfma_f32_16x16x32_bf16 v[136:139], v[168:171], v[116:119], v[136:139]
ds_read_b64_tr_b16 v[74:75], v5 offset:6144
v_mfma_f32_16x16x32_bf16 v[140:143], v[172:175], v[116:119], v[140:143]
ds_read_b128 v[52:55], v2 offset:8448
v_mfma_f32_16x16x32_bf16 v[144:147], v[168:171], v[120:123], v[144:147]
ds_read_b64_tr_b16 v[76:77], v6 offset:4096
v_mfma_f32_16x16x32_bf16 v[148:151], v[172:175], v[120:123], v[148:151]
ds_read_b128 v[56:59], v2 offset:8704
v_mfma_f32_16x16x32_bf16 v[152:155], v[168:171], v[124:127], v[152:155]
ds_read_b64_tr_b16 v[78:79], v6 offset:6144
v_mfma_f32_16x16x32_bf16 v[156:159], v[172:175], v[124:127], v[156:159]
ds_read_b128 v[60:63], v2 offset:8960
s_waitcnt lgkmcnt(0)
s_barrier
v_mfma_f32_16x16x32_bf16 v[128:131], v[64:67], v[32:35], v[128:131]
ds_read_b64_tr_b16 v[160:161], v5 offset:32768
v_mfma_f32_16x16x32_bf16 v[132:135], v[68:71], v[32:35], v[132:135]
ds_read_b128 v[96:99], v2 offset:32768
v_mfma_f32_16x16x32_bf16 v[136:139], v[64:67], v[36:39], v[136:139]
ds_read_b64_tr_b16 v[162:163], v5 offset:34816
v_mfma_f32_16x16x32_bf16 v[140:143], v[68:71], v[36:39], v[140:143]
ds_read_b128 v[100:103], v2 offset:33024
v_mfma_f32_16x16x32_bf16 v[144:147], v[64:67], v[40:43], v[144:147]
ds_read_b64_tr_b16 v[164:165], v6 offset:32768
v_mfma_f32_16x16x32_bf16 v[148:151], v[68:71], v[40:43], v[148:151]
ds_read_b128 v[104:107], v2 offset:33280
v_mfma_f32_16x16x32_bf16 v[152:155], v[64:67], v[44:47], v[152:155]
ds_read_b64_tr_b16 v[166:167], v6 offset:34816
v_mfma_f32_16x16x32_bf16 v[156:159], v[68:71], v[44:47], v[156:159]
ds_read_b128 v[108:111], v2 offset:33536
v_mfma_f32_16x16x32_bf16 v[128:131], v[72:75], v[48:51], v[128:131]
ds_read_b64_tr_b16 v[168:169], v5 offset:36864
v_mfma_f32_16x16x32_bf16 v[132:135], v[76:79], v[48:51], v[132:135]
ds_read_b128 v[112:115], v2 offset:40960
v_mfma_f32_16x16x32_bf16 v[136:139], v[72:75], v[52:55], v[136:139]
ds_read_b64_tr_b16 v[170:171], v5 offset:38912
v_mfma_f32_16x16x32_bf16 v[140:143], v[76:79], v[52:55], v[140:143]
ds_read_b128 v[116:119], v2 offset:41216
v_mfma_f32_16x16x32_bf16 v[144:147], v[72:75], v[56:59], v[144:147]
ds_read_b64_tr_b16 v[172:173], v6 offset:36864
v_mfma_f32_16x16x32_bf16 v[148:151], v[76:79], v[56:59], v[148:151]
ds_read_b128 v[120:123], v2 offset:41472
v_mfma_f32_16x16x32_bf16 v[152:155], v[72:75], v[60:63], v[152:155]
ds_read_b64_tr_b16 v[174:175], v6 offset:38912
v_mfma_f32_16x16x32_bf16 v[156:159], v[76:79], v[60:63], v[156:159]
ds_read_b128 v[124:127], v2 offset:41728
s_waitcnt lgkmcnt(0)
s_barrier
v_mfma_f32_16x16x32_bf16 v[128:131], v[160:163], v[96:99], v[128:131]
ds_read_b64_tr_b16 v[64:65], v7 offset:0
v_mfma_f32_16x16x32_bf16 v[132:135], v[164:167], v[96:99], v[132:135]
ds_read_b128 v[32:35], v3 offset:0
v_mfma_f32_16x16x32_bf16 v[136:139], v[160:163], v[100:103], v[136:139]
ds_read_b64_tr_b16 v[66:67], v7 offset:2048
v_mfma_f32_16x16x32_bf16 v[140:143], v[164:167], v[100:103], v[140:143]
ds_read_b128 v[36:39], v3 offset:256
v_mfma_f32_16x16x32_bf16 v[144:147], v[160:163], v[104:107], v[144:147]
ds_read_b64_tr_b16 v[68:69], v8 offset:0
v_mfma_f32_16x16x32_bf16 v[148:151], v[164:167], v[104:107], v[148:151]
ds_read_b128 v[40:43], v3 offset:512
v_mfma_f32_16x16x32_bf16 v[152:155], v[160:163], v[108:111], v[152:155]
ds_read_b64_tr_b16 v[70:71], v8 offset:2048
v_mfma_f32_16x16x32_bf16 v[156:159], v[164:167], v[108:111], v[156:159]
ds_read_b128 v[44:47], v3 offset:768
v_mfma_f32_16x16x32_bf16 v[128:131], v[168:171], v[112:115], v[128:131]
ds_read_b64_tr_b16 v[80:81], v7 offset:8192
v_mfma_f32_16x16x32_bf16 v[132:135], v[172:175], v[112:115], v[132:135]
ds_read_b64_tr_b16 v[82:83], v7 offset:10240
v_mfma_f32_16x16x32_bf16 v[136:139], v[168:171], v[116:119], v[136:139]
ds_read_b64_tr_b16 v[84:85], v8 offset:8192
v_mfma_f32_16x16x32_bf16 v[140:143], v[172:175], v[116:119], v[140:143]
ds_read_b64_tr_b16 v[86:87], v8 offset:10240
v_mfma_f32_16x16x32_bf16 v[144:147], v[168:171], v[120:123], v[144:147]
ds_read_b64_tr_b16 v[72:73], v7 offset:4096
v_mfma_f32_16x16x32_bf16 v[148:151], v[172:175], v[120:123], v[148:151]
ds_read_b128 v[48:51], v3 offset:8192
v_mfma_f32_16x16x32_bf16 v[152:155], v[168:171], v[124:127], v[152:155]
ds_read_b64_tr_b16 v[74:75], v7 offset:6144
v_mfma_f32_16x16x32_bf16 v[156:159], v[172:175], v[124:127], v[156:159]
ds_read_b128 v[52:55], v3 offset:8448
ds_read_b64_tr_b16 v[76:77], v8 offset:4096
ds_read_b128 v[56:59], v3 offset:8704
ds_read_b64_tr_b16 v[78:79], v8 offset:6144
ds_read_b128 v[60:63], v3 offset:8960
ds_read_b64_tr_b16 v[88:89], v7 offset:12288
ds_read_b64_tr_b16 v[90:91], v7 offset:14336
ds_read_b64_tr_b16 v[92:93], v8 offset:12288
ds_read_b64_tr_b16 v[94:95], v8 offset:14336
s_mov_b32 s41, 4
.p2align 3
Lk4_100:
s_waitcnt lgkmcnt(0)
s_barrier
v_mfma_f32_16x16x32_bf16 v[128:131], v[64:67], v[32:35], v[128:131]
ds_read_b64_tr_b16 v[160:161], v7 offset:32768
v_mfma_f32_16x16x32_bf16 v[132:135], v[68:71], v[32:35], v[132:135]
ds_read_b128 v[96:99], v3 offset:32768
v_mfma_f32_16x16x32_bf16 v[192:195], v[80:83], v[32:35], v[192:195]
ds_read_b64_tr_b16 v[162:163], v7 offset:34816
v_mfma_f32_16x16x32_bf16 v[196:199], v[84:87], v[32:35], v[196:199]
ds_read_b128 v[100:103], v3 offset:33024
v_mfma_f32_16x16x32_bf16 v[136:139], v[64:67], v[36:39], v[136:139]
ds_read_b64_tr_b16 v[164:165], v8 offset:32768
v_mfma_f32_16x16x32_bf16 v[140:143], v[68:71], v[36:39], v[140:143]
ds_read_b128 v[104:107], v3 offset:33280
v_mfma_f32_16x16x32_bf16 v[200:203], v[80:83], v[36:39], v[200:203]
ds_read_b64_tr_b16 v[166:167], v8 offset:34816
v_mfma_f32_16x16x32_bf16 v[204:207], v[84:87], v[36:39], v[204:207]
ds_read_b128 v[108:111], v3 offset:33536
v_mfma_f32_16x16x32_bf16 v[144:147], v[64:67], v[40:43], v[144:147]
ds_read_b64_tr_b16 v[176:177], v7 offset:40960
v_mfma_f32_16x16x32_bf16 v[148:151], v[68:71], v[40:43], v[148:151]
ds_read_b64_tr_b16 v[178:179], v7 offset:43008
v_mfma_f32_16x16x32_bf16 v[208:211], v[80:83], v[40:43], v[208:211]
ds_read_b64_tr_b16 v[180:181], v8 offset:40960
v_mfma_f32_16x16x32_bf16 v[212:215], v[84:87], v[40:43], v[212:215]
ds_read_b64_tr_b16 v[182:183], v8 offset:43008
v_mfma_f32_16x16x32_bf16 v[152:155], v[64:67], v[44:47], v[152:155]
ds_read_b64_tr_b16 v[168:169], v7 offset:36864
v_mfma_f32_16x16x32_bf16 v[156:159], v[68:71], v[44:47], v[156:159]
ds_read_b128 v[112:115], v3 offset:40960
v_mfma_f32_16x16x32_bf16 v[216:219], v[80:83], v[44:47], v[216:219]
ds_read_b64_tr_b16 v[170:171], v7 offset:38912
v_mfma_f32_16x16x32_bf16 v[220:223], v[84:87], v[44:47], v[220:223]
ds_read_b128 v[116:119], v3 offset:41216
v_mfma_f32_16x16x32_bf16 v[128:131], v[72:75], v[48:51], v[128:131]
ds_read_b64_tr_b16 v[172:173], v8 offset:36864
v_mfma_f32_16x16x32_bf16 v[132:135], v[76:79], v[48:51], v[132:135]
ds_read_b128 v[120:123], v3 offset:41472
v_mfma_f32_16x16x32_bf16 v[192:195], v[88:91], v[48:51], v[192:195]
ds_read_b64_tr_b16 v[174:175], v8 offset:38912
v_mfma_f32_16x16x32_bf16 v[196:199], v[92:95], v[48:51], v[196:199]
ds_read_b128 v[124:127], v3 offset:41728
v_mfma_f32_16x16x32_bf16 v[136:139], v[72:75], v[52:55], v[136:139]
ds_read_b64_tr_b16 v[184:185], v7 offset:45056
v_mfma_f32_16x16x32_bf16 v[140:143], v[76:79], v[52:55], v[140:143]
ds_read_b64_tr_b16 v[186:187], v7 offset:47104
v_mfma_f32_16x16x32_bf16 v[200:203], v[88:91], v[52:55], v[200:203]
ds_read_b64_tr_b16 v[188:189], v8 offset:45056
v_mfma_f32_16x16x32_bf16 v[204:207], v[92:95], v[52:55], v[204:207]
ds_read_b64_tr_b16 v[190:191], v8 offset:47104
v_mfma_f32_16x16x32_bf16 v[144:147], v[72:75], v[56:59], v[144:147]
v_mfma_f32_16x16x32_bf16 v[148:151], v[76:79], v[56:59], v[148:151]
v_mfma_f32_16x16x32_bf16 v[208:211], v[88:91], v[56:59], v[208:211]
v_mfma_f32_16x16x32_bf16 v[212:215], v[92:95], v[56:59], v[212:215]
v_mfma_f32_16x16x32_bf16 v[152:155], v[72:75], v[60:63], v[152:155]
v_mfma_f32_16x16x32_bf16 v[156:159], v[76:79], v[60:63], v[156:159]
v_mfma_f32_16x16x32_bf16 v[216:219], v[88:91], v[60:63], v[216:219]
v_mfma_f32_16x16x32_bf16 v[220:223], v[92:95], v[60:63], v[220:223]
s_waitcnt lgkmcnt(0)
s_barrier
v_mfma_f32_16x16x32_bf16 v[128:131], v[160:163], v[96:99], v[128:131]
ds_read_b64_tr_b16 v[64:65], v5 offset:0
v_mfma_f32_16x16x32_bf16 v[132:135], v[164:167], v[96:99], v[132:135]
ds_read_b128 v[32:35], v2 offset:0
v_mfma_f32_16x16x32_bf16 v[192:195], v[176:179], v[96:99], v[192:195]
ds_read_b64_tr_b16 v[66:67], v5 offset:2048
v_mfma_f32_16x16x32_bf16 v[196:199], v[180:183], v[96:99], v[196:199]
ds_read_b128 v[36:39], v2 offset:256
v_mfma_f32_16x16x32_bf16 v[136:139], v[160:163], v[100:103], v[136:139]
ds_read_b64_tr_b16 v[68:69], v6 offset:0
v_mfma_f32_16x16x32_bf16 v[140:143], v[164:167], v[100:103], v[140:143]
ds_read_b128 v[40:43], v2 offset:512
v_mfma_f32_16x16x32_bf16 v[200:203], v[176:179], v[100:103], v[200:203]
ds_read_b64_tr_b16 v[70:71], v6 offset:2048
v_mfma_f32_16x16x32_bf16 v[204:207], v[180:183], v[100:103], v[204:207]
ds_read_b128 v[44:47], v2 offset:768
v_mfma_f32_16x16x32_bf16 v[144:147], v[160:163], v[104:107], v[144:147]
ds_read_b64_tr_b16 v[80:81], v5 offset:8192
v_mfma_f32_16x16x32_bf16 v[148:151], v[164:167], v[104:107], v[148:151]
ds_read_b64_tr_b16 v[82:83], v5 offset:10240
v_mfma_f32_16x16x32_bf16 v[208:211], v[176:179], v[104:107], v[208:211]
ds_read_b64_tr_b16 v[84:85], v6 offset:8192
v_mfma_f32_16x16x32_bf16 v[212:215], v[180:183], v[104:107], v[212:215]
ds_read_b64_tr_b16 v[86:87], v6 offset:10240
v_mfma_f32_16x16x32_bf16 v[152:155], v[160:163], v[108:111], v[152:155]
ds_read_b64_tr_b16 v[72:73], v5 offset:4096
v_mfma_f32_16x16x32_bf16 v[156:159], v[164:167], v[108:111], v[156:159]
ds_read_b128 v[48:51], v2 offset:8192
v_mfma_f32_16x16x32_bf16 v[216:219], v[176:179], v[108:111], v[216:219]
ds_read_b64_tr_b16 v[74:75], v5 offset:6144
v_mfma_f32_16x16x32_bf16 v[220:223], v[180:183], v[108:111], v[220:223]
ds_read_b128 v[52:55], v2 offset:8448
v_mfma_f32_16x16x32_bf16 v[128:131], v[168:171], v[112:115], v[128:131]
ds_read_b64_tr_b16 v[76:77], v6 offset:4096
v_mfma_f32_16x16x32_bf16 v[132:135], v[172:175], v[112:115], v[132:135]
ds_read_b128 v[56:59], v2 offset:8704
v_mfma_f32_16x16x32_bf16 v[192:195], v[184:187], v[112:115], v[192:195]
ds_read_b64_tr_b16 v[78:79], v6 offset:6144
v_mfma_f32_16x16x32_bf16 v[196:199], v[188:191], v[112:115], v[196:199]
ds_read_b128 v[60:63], v2 offset:8960
v_mfma_f32_16x16x32_bf16 v[136:139], v[168:171], v[116:119], v[136:139]
ds_read_b64_tr_b16 v[88:89], v5 offset:12288
v_mfma_f32_16x16x32_bf16 v[140:143], v[172:175], v[116:119], v[140:143]
ds_read_b64_tr_b16 v[90:91], v5 offset:14336
v_mfma_f32_16x16x32_bf16 v[200:203], v[184:187], v[116:119], v[200:203]
ds_read_b64_tr_b16 v[92:93], v6 offset:12288
v_mfma_f32_16x16x32_bf16 v[204:207], v[188:191], v[116:119], v[204:207]
ds_read_b64_tr_b16 v[94:95], v6 offset:14336
v_mfma_f32_16x16x32_bf16 v[144:147], v[168:171], v[120:123], v[144:147]
v_mfma_f32_16x16x32_bf16 v[148:151], v[172:175], v[120:123], v[148:151]
v_mfma_f32_16x16x32_bf16 v[208:211], v[184:187], v[120:123], v[208:211]
v_mfma_f32_16x16x32_bf16 v[212:215], v[188:191], v[120:123], v[212:215]
v_mfma_f32_16x16x32_bf16 v[152:155], v[168:171], v[124:127], v[152:155]
v_mfma_f32_16x16x32_bf16 v[156:159], v[172:175], v[124:127], v[156:159]
v_mfma_f32_16x16x32_bf16 v[216:219], v[184:187], v[124:127], v[216:219]
v_mfma_f32_16x16x32_bf16 v[220:223], v[188:191], v[124:127], v[220:223]
s_waitcnt lgkmcnt(0)
s_barrier
v_mfma_f32_16x16x32_bf16 v[128:131], v[64:67], v[32:35], v[128:131]
ds_read_b64_tr_b16 v[160:161], v5 offset:32768
v_mfma_f32_16x16x32_bf16 v[132:135], v[68:71], v[32:35], v[132:135]
ds_read_b128 v[96:99], v2 offset:32768
v_mfma_f32_16x16x32_bf16 v[192:195], v[80:83], v[32:35], v[192:195]
ds_read_b64_tr_b16 v[162:163], v5 offset:34816
v_mfma_f32_16x16x32_bf16 v[196:199], v[84:87], v[32:35], v[196:199]
ds_read_b128 v[100:103], v2 offset:33024
v_mfma_f32_16x16x32_bf16 v[136:139], v[64:67], v[36:39], v[136:139]
ds_read_b64_tr_b16 v[164:165], v6 offset:32768
v_mfma_f32_16x16x32_bf16 v[140:143], v[68:71], v[36:39], v[140:143]
ds_read_b128 v[104:107], v2 offset:33280
v_mfma_f32_16x16x32_bf16 v[200:203], v[80:83], v[36:39], v[200:203]
ds_read_b64_tr_b16 v[166:167], v6 offset:34816
v_mfma_f32_16x16x32_bf16 v[204:207], v[84:87], v[36:39], v[204:207]
ds_read_b128 v[108:111], v2 offset:33536
v_mfma_f32_16x16x32_bf16 v[144:147], v[64:67], v[40:43], v[144:147]
ds_read_b64_tr_b16 v[176:177], v5 offset:40960
v_mfma_f32_16x16x32_bf16 v[148:151], v[68:71], v[40:43], v[148:151]
ds_read_b64_tr_b16 v[178:179], v5 offset:43008
v_mfma_f32_16x16x32_bf16 v[208:211], v[80:83], v[40:43], v[208:211]
ds_read_b64_tr_b16 v[180:181], v6 offset:40960
v_mfma_f32_16x16x32_bf16 v[212:215], v[84:87], v[40:43], v[212:215]
ds_read_b64_tr_b16 v[182:183], v6 offset:43008
v_mfma_f32_16x16x32_bf16 v[152:155], v[64:67], v[44:47], v[152:155]
ds_read_b64_tr_b16 v[168:169], v5 offset:36864
v_mfma_f32_16x16x32_bf16 v[156:159], v[68:71], v[44:47], v[156:159]
ds_read_b128 v[112:115], v2 offset:40960
v_mfma_f32_16x16x32_bf16 v[216:219], v[80:83], v[44:47], v[216:219]
ds_read_b64_tr_b16 v[170:171], v5 offset:38912
v_mfma_f32_16x16x32_bf16 v[220:223], v[84:87], v[44:47], v[220:223]
ds_read_b128 v[116:119], v2 offset:41216
v_mfma_f32_16x16x32_bf16 v[128:131], v[72:75], v[48:51], v[128:131]
ds_read_b64_tr_b16 v[172:173], v6 offset:36864
v_mfma_f32_16x16x32_bf16 v[132:135], v[76:79], v[48:51], v[132:135]
ds_read_b128 v[120:123], v2 offset:41472
v_mfma_f32_16x16x32_bf16 v[192:195], v[88:91], v[48:51], v[192:195]
ds_read_b64_tr_b16 v[174:175], v6 offset:38912
v_mfma_f32_16x16x32_bf16 v[196:199], v[92:95], v[48:51], v[196:199]
ds_read_b128 v[124:127], v2 offset:41728
v_mfma_f32_16x16x32_bf16 v[136:139], v[72:75], v[52:55], v[136:139]
ds_read_b64_tr_b16 v[184:185], v5 offset:45056
v_mfma_f32_16x16x32_bf16 v[140:143], v[76:79], v[52:55], v[140:143]
ds_read_b64_tr_b16 v[186:187], v5 offset:47104
v_mfma_f32_16x16x32_bf16 v[200:203], v[88:91], v[52:55], v[200:203]
ds_read_b64_tr_b16 v[188:189], v6 offset:45056
v_mfma_f32_16x16x32_bf16 v[204:207], v[92:95], v[52:55], v[204:207]
ds_read_b64_tr_b16 v[190:191], v6 offset:47104
v_mfma_f32_16x16x32_bf16 v[144:147], v[72:75], v[56:59], v[144:147]
v_mfma_f32_16x16x32_bf16 v[148:151], v[76:79], v[56:59], v[148:151]
v_mfma_f32_16x16x32_bf16 v[208:211], v[88:91], v[56:59], v[208:211]
v_mfma_f32_16x16x32_bf16 v[212:215], v[92:95], v[56:59], v[212:215]
v_mfma_f32_16x16x32_bf16 v[152:155], v[72:75], v[60:63], v[152:155]
v_mfma_f32_16x16x32_bf16 v[156:159], v[76:79], v[60:63], v[156:159]
v_mfma_f32_16x16x32_bf16 v[216:219], v[88:91], v[60:63], v[216:219]
v_mfma_f32_16x16x32_bf16 v[220:223], v[92:95], v[60:63], v[220:223]
s_waitcnt lgkmcnt(0)
s_barrier
v_mfma_f32_16x16x32_bf16 v[128:131], v[160:163], v[96:99], v[128:131]
ds_read_b64_tr_b16 v[64:65], v7 offset:0
v_mfma_f32_16x16x32_bf16 v[132:135], v[164:167], v[96:99], v[132:135]
ds_read_b128 v[32:35], v3 offset:0
v_mfma_f32_16x16x32_bf16 v[192:195], v[176:179], v[96:99], v[192:195]
ds_read_b64_tr_b16 v[66:67], v7 offset:2048
v_mfma_f32_16x16x32_bf16 v[196:199], v[180:183], v[96:99], v[196:199]
ds_read_b128 v[36:39], v3 offset:256
v_mfma_f32_16x16x32_bf16 v[136:139], v[160:163], v[100:103], v[136:139]
ds_read_b64_tr_b16 v[68:69], v8 offset:0
v_mfma_f32_16x16x32_bf16 v[140:143], v[164:167], v[100:103], v[140:143]
ds_read_b128 v[40:43], v3 offset:512
v_mfma_f32_16x16x32_bf16 v[200:203], v[176:179], v[100:103], v[200:203]
ds_read_b64_tr_b16 v[70:71], v8 offset:2048
v_mfma_f32_16x16x32_bf16 v[204:207], v[180:183], v[100:103], v[204:207]
ds_read_b128 v[44:47], v3 offset:768
v_mfma_f32_16x16x32_bf16 v[144:147], v[160:163], v[104:107], v[144:147]
ds_read_b64_tr_b16 v[80:81], v7 offset:8192
v_mfma_f32_16x16x32_bf16 v[148:151], v[164:167], v[104:107], v[148:151]
ds_read_b64_tr_b16 v[82:83], v7 offset:10240
v_mfma_f32_16x16x32_bf16 v[208:211], v[176:179], v[104:107], v[208:211]
ds_read_b64_tr_b16 v[84:85], v8 offset:8192
v_mfma_f32_16x16x32_bf16 v[212:215], v[180:183], v[104:107], v[212:215]
ds_read_b64_tr_b16 v[86:87], v8 offset:10240
v_mfma_f32_16x16x32_bf16 v[152:155], v[160:163], v[108:111], v[152:155]
ds_read_b64_tr_b16 v[72:73], v7 offset:4096
v_mfma_f32_16x16x32_bf16 v[156:159], v[164:167], v[108:111], v[156:159]
ds_read_b128 v[48:51], v3 offset:8192
v_mfma_f32_16x16x32_bf16 v[216:219], v[176:179], v[108:111], v[216:219]
ds_read_b64_tr_b16 v[74:75], v7 offset:6144
v_mfma_f32_16x16x32_bf16 v[220:223], v[180:183], v[108:111], v[220:223]
ds_read_b128 v[52:55], v3 offset:8448
v_mfma_f32_16x16x32_bf16 v[128:131], v[168:171], v[112:115], v[128:131]
ds_read_b64_tr_b16 v[76:77], v8 offset:4096
v_mfma_f32_16x16x32_bf16 v[132:135], v[172:175], v[112:115], v[132:135]
ds_read_b128 v[56:59], v3 offset:8704
v_mfma_f32_16x16x32_bf16 v[192:195], v[184:187], v[112:115], v[192:195]
ds_read_b64_tr_b16 v[78:79], v8 offset:6144
v_mfma_f32_16x16x32_bf16 v[196:199], v[188:191], v[112:115], v[196:199]
ds_read_b128 v[60:63], v3 offset:8960
v_mfma_f32_16x16x32_bf16 v[136:139], v[168:171], v[116:119], v[136:139]
ds_read_b64_tr_b16 v[88:89], v7 offset:12288
v_mfma_f32_16x16x32_bf16 v[140:143], v[172:175], v[116:119], v[140:143]
ds_read_b64_tr_b16 v[90:91], v7 offset:14336
v_mfma_f32_16x16x32_bf16 v[200:203], v[184:187], v[116:119], v[200:203]
ds_read_b64_tr_b16 v[92:93], v8 offset:12288
v_mfma_f32_16x16x32_bf16 v[204:207], v[188:191], v[116:119], v[204:207]
ds_read_b64_tr_b16 v[94:95], v8 offset:14336
v_mfma_f32_16x16x32_bf16 v[144:147], v[168:171], v[120:123], v[144:147]
v_mfma_f32_16x16x32_bf16 v[148:151], v[172:175], v[120:123], v[148:151]
v_mfma_f32_16x16x32_bf16 v[208:211], v[184:187], v[120:123], v[208:211]
v_mfma_f32_16x16x32_bf16 v[212:215], v[188:191], v[120:123], v[212:215]
v_mfma_f32_16x16x32_bf16 v[152:155], v[168:171], v[124:127], v[152:155]
v_mfma_f32_16x16x32_bf16 v[156:159], v[172:175], v[124:127], v[156:159]
v_mfma_f32_16x16x32_bf16 v[216:219], v[184:187], v[124:127], v[216:219]
v_mfma_f32_16x16x32_bf16 v[220:223], v[188:191], v[124:127], v[220:223]
s_sub_u32 s41, s41, 1
s_cmp_lg_u32 s41, 0
s_cbranch_scc1 Lk4_100
s_waitcnt lgkmcnt(0)
s_barrier
v_mfma_f32_16x16x32_bf16 v[128:131], v[64:67], v[32:35], v[128:131]
ds_read_b64_tr_b16 v[160:161], v7 offset:32768
v_mfma_f32_16x16x32_bf16 v[132:135], v[68:71], v[32:35], v[132:135]
ds_read_b128 v[96:99], v3 offset:32768
v_mfma_f32_16x16x32_bf16 v[192:195], v[80:83], v[32:35], v[192:195]
ds_read_b64_tr_b16 v[162:163], v7 offset:34816
v_mfma_f32_16x16x32_bf16 v[196:199], v[84:87], v[32:35], v[196:199]
ds_read_b128 v[100:103], v3 offset:33024
v_mfma_f32_16x16x32_bf16 v[136:139], v[64:67], v[36:39], v[136:139]
ds_read_b64_tr_b16 v[164:165], v8 offset:32768
v_mfma_f32_16x16x32_bf16 v[140:143], v[68:71], v[36:39], v[140:143]
ds_read_b128 v[104:107], v3 offset:33280
v_mfma_f32_16x16x32_bf16 v[200:203], v[80:83], v[36:39], v[200:203]
ds_read_b64_tr_b16 v[166:167], v8 offset:34816
v_mfma_f32_16x16x32_bf16 v[204:207], v[84:87], v[36:39], v[204:207]
ds_read_b128 v[108:111], v3 offset:33536
v_mfma_f32_16x16x32_bf16 v[144:147], v[64:67], v[40:43], v[144:147]
ds_read_b64_tr_b16 v[176:177], v7 offset:40960
v_mfma_f32_16x16x32_bf16 v[148:151], v[68:71], v[40:43], v[148:151]
ds_read_b64_tr_b16 v[178:179], v7 offset:43008
v_mfma_f32_16x16x32_bf16 v[208:211], v[80:83], v[40:43], v[208:211]
ds_read_b64_tr_b16 v[180:181], v8 offset:40960
v_mfma_f32_16x16x32_bf16 v[212:215], v[84:87], v[40:43], v[212:215]
ds_read_b64_tr_b16 v[182:183], v8 offset:43008
v_mfma_f32_16x16x32_bf16 v[152:155], v[64:67], v[44:47], v[152:155]
ds_read_b64_tr_b16 v[168:169], v7 offset:36864
v_mfma_f32_16x16x32_bf16 v[156:159], v[68:71], v[44:47], v[156:159]
ds_read_b128 v[112:115], v3 offset:40960
v_mfma_f32_16x16x32_bf16 v[216:219], v[80:83], v[44:47], v[216:219]
ds_read_b64_tr_b16 v[170:171], v7 offset:38912
v_mfma_f32_16x16x32_bf16 v[220:223], v[84:87], v[44:47], v[220:223]
ds_read_b128 v[116:119], v3 offset:41216
v_mfma_f32_16x16x32_bf16 v[128:131], v[72:75], v[48:51], v[128:131]
ds_read_b64_tr_b16 v[172:173], v8 offset:36864
v_mfma_f32_16x16x32_bf16 v[132:135], v[76:79], v[48:51], v[132:135]
ds_read_b128 v[120:123], v3 offset:41472
v_mfma_f32_16x16x32_bf16 v[192:195], v[88:91], v[48:51], v[192:195]
ds_read_b64_tr_b16 v[174:175], v8 offset:38912
v_mfma_f32_16x16x32_bf16 v[196:199], v[92:95], v[48:51], v[196:199]
ds_read_b128 v[124:127], v3 offset:41728
v_mfma_f32_16x16x32_bf16 v[136:139], v[72:75], v[52:55], v[136:139]
ds_read_b64_tr_b16 v[184:185], v7 offset:45056
v_mfma_f32_16x16x32_bf16 v[140:143], v[76:79], v[52:55], v[140:143]
ds_read_b64_tr_b16 v[186:187], v7 offset:47104
v_mfma_f32_16x16x32_bf16 v[200:203], v[88:91], v[52:55], v[200:203]
ds_read_b64_tr_b16 v[188:189], v8 offset:45056
v_mfma_f32_16x16x32_bf16 v[204:207], v[92:95], v[52:55], v[204:207]
ds_read_b64_tr_b16 v[190:191], v8 offset:47104
v_mfma_f32_16x16x32_bf16 v[144:147], v[72:75], v[56:59], v[144:147]
v_mfma_f32_16x16x32_bf16 v[148:151], v[76:79], v[56:59], v[148:151]
v_mfma_f32_16x16x32_bf16 v[208:211], v[88:91], v[56:59], v[208:211]
v_mfma_f32_16x16x32_bf16 v[212:215], v[92:95], v[56:59], v[212:215]
v_mfma_f32_16x16x32_bf16 v[152:155], v[72:75], v[60:63], v[152:155]
v_mfma_f32_16x16x32_bf16 v[156:159], v[76:79], v[60:63], v[156:159]
v_mfma_f32_16x16x32_bf16 v[216:219], v[88:91], v[60:63], v[216:219]
v_mfma_f32_16x16x32_bf16 v[220:223], v[92:95], v[60:63], v[220:223]
s_waitcnt lgkmcnt(0)
s_barrier
v_mfma_f32_16x16x32_bf16 v[128:131], v[160:163], v[96:99], v[128:131]
ds_read_b64_tr_b16 v[64:65], v5 offset:0
v_mfma_f32_16x16x32_bf16 v[132:135], v[164:167], v[96:99], v[132:135]
ds_read_b128 v[32:35], v2 offset:0
v_mfma_f32_16x16x32_bf16 v[192:195], v[176:179], v[96:99], v[192:195]
ds_read_b64_tr_b16 v[66:67], v5 offset:2048
v_mfma_f32_16x16x32_bf16 v[196:199], v[180:183], v[96:99], v[196:199]
ds_read_b128 v[36:39], v2 offset:256
v_mfma_f32_16x16x32_bf16 v[136:139], v[160:163], v[100:103], v[136:139]
ds_read_b64_tr_b16 v[68:69], v6 offset:0
v_mfma_f32_16x16x32_bf16 v[140:143], v[164:167], v[100:103], v[140:143]
ds_read_b128 v[40:43], v2 offset:512
v_mfma_f32_16x16x32_bf16 v[200:203], v[176:179], v[100:103], v[200:203]
ds_read_b64_tr_b16 v[70:71], v6 offset:2048
v_mfma_f32_16x16x32_bf16 v[204:207], v[180:183], v[100:103], v[204:207]
ds_read_b128 v[44:47], v2 offset:768
v_mfma_f32_16x16x32_bf16 v[144:147], v[160:163], v[104:107], v[144:147]
ds_read_b64_tr_b16 v[80:81], v5 offset:8192
v_mfma_f32_16x16x32_bf16 v[148:151], v[164:167], v[104:107], v[148:151]
ds_read_b64_tr_b16 v[82:83], v5 offset:10240
v_mfma_f32_16x16x32_bf16 v[208:211], v[176:179], v[104:107], v[208:211]
ds_read_b64_tr_b16 v[84:85], v6 offset:8192
v_mfma_f32_16x16x32_bf16 v[212:215], v[180:183], v[104:107], v[212:215]
ds_read_b64_tr_b16 v[86:87], v6 offset:10240
v_mfma_f32_16x16x32_bf16 v[152:155], v[160:163], v[108:111], v[152:155]
ds_read_b64_tr_b16 v[72:73], v5 offset:4096
v_mfma_f32_16x16x32_bf16 v[156:159], v[164:167], v[108:111], v[156:159]
ds_read_b128 v[48:51], v2 offset:8192
v_mfma_f32_16x16x32_bf16 v[216:219], v[176:179], v[108:111], v[216:219]
ds_read_b64_tr_b16 v[74:75], v5 offset:6144
v_mfma_f32_16x16x32_bf16 v[220:223], v[180:183], v[108:111], v[220:223]
ds_read_b128 v[52:55], v2 offset:8448
v_mfma_f32_16x16x32_bf16 v[128:131], v[168:171], v[112:115], v[128:131]
ds_read_b64_tr_b16 v[76:77], v6 offset:4096
v_mfma_f32_16x16x32_bf16 v[132:135], v[172:175], v[112:115], v[132:135]
ds_read_b128 v[56:59], v2 offset:8704
v_mfma_f32_16x16x32_bf16 v[192:195], v[184:187], v[112:115], v[192:195]
ds_read_b64_tr_b16 v[78:79], v6 offset:6144
v_mfma_f32_16x16x32_bf16 v[196:199], v[188:191], v[112:115], v[196:199]
ds_read_b128 v[60:63], v2 offset:8960
v_mfma_f32_16x16x32_bf16 v[136:139], v[168:171], v[116:119], v[136:139]
ds_read_b64_tr_b16 v[88:89], v5 offset:12288
v_mfma_f32_16x16x32_bf16 v[140:143], v[172:175], v[116:119], v[140:143]
ds_read_b64_tr_b16 v[90:91], v5 offset:14336
v_mfma_f32_16x16x32_bf16 v[200:203], v[184:187], v[116:119], v[200:203]
ds_read_b64_tr_b16 v[92:93], v6 offset:12288
v_mfma_f32_16x16x32_bf16 v[204:207], v[188:191], v[116:119], v[204:207]
ds_read_b64_tr_b16 v[94:95], v6 offset:14336
v_mfma_f32_16x16x32_bf16 v[144:147], v[168:171], v[120:123], v[144:147]
v_mfma_f32_16x16x32_bf16 v[148:151], v[172:175], v[120:123], v[148:151]
v_mfma_f32_16x16x32_bf16 v[208:211], v[184:187], v[120:123], v[208:211]
v_mfma_f32_16x16x32_bf16 v[212:215], v[188:191], v[120:123], v[212:215]
v_mfma_f32_16x16x32_bf16 v[152:155], v[168:171], v[124:127], v[152:155]
v_mfma_f32_16x16x32_bf16 v[156:159], v[172:175], v[124:127], v[156:159]
v_mfma_f32_16x16x32_bf16 v[216:219], v[184:187], v[124:127], v[216:219]
v_mfma_f32_16x16x32_bf16 v[220:223], v[188:191], v[124:127], v[220:223]
s_waitcnt lgkmcnt(0)
s_barrier
v_mfma_f32_16x16x32_bf16 v[128:131], v[64:67], v[32:35], v[128:131]
ds_read_b64_tr_b16 v[160:161], v5 offset:32768
v_mfma_f32_16x16x32_bf16 v[132:135], v[68:71], v[32:35], v[132:135]
ds_read_b128 v[96:99], v2 offset:32768
v_mfma_f32_16x16x32_bf16 v[192:195], v[80:83], v[32:35], v[192:195]
ds_read_b64_tr_b16 v[162:163], v5 offset:34816
v_mfma_f32_16x16x32_bf16 v[196:199], v[84:87], v[32:35], v[196:199]
ds_read_b128 v[100:103], v2 offset:33024
v_mfma_f32_16x16x32_bf16 v[136:139], v[64:67], v[36:39], v[136:139]
ds_read_b64_tr_b16 v[164:165], v6 offset:32768
v_mfma_f32_16x16x32_bf16 v[140:143], v[68:71], v[36:39], v[140:143]
ds_read_b128 v[104:107], v2 offset:33280
v_mfma_f32_16x16x32_bf16 v[200:203], v[80:83], v[36:39], v[200:203]
ds_read_b64_tr_b16 v[166:167], v6 offset:34816
v_mfma_f32_16x16x32_bf16 v[204:207], v[84:87], v[36:39], v[204:207]
ds_read_b128 v[108:111], v2 offset:33536
v_mfma_f32_16x16x32_bf16 v[144:147], v[64:67], v[40:43], v[144:147]
ds_read_b64_tr_b16 v[176:177], v5 offset:40960
v_mfma_f32_16x16x32_bf16 v[148:151], v[68:71], v[40:43], v[148:151]
ds_read_b64_tr_b16 v[178:179], v5 offset:43008
v_mfma_f32_16x16x32_bf16 v[208:211], v[80:83], v[40:43], v[208:211]
ds_read_b64_tr_b16 v[180:181], v6 offset:40960
v_mfma_f32_16x16x32_bf16 v[212:215], v[84:87], v[40:43], v[212:215]
ds_read_b64_tr_b16 v[182:183], v6 offset:43008
v_mfma_f32_16x16x32_bf16 v[152:155], v[64:67], v[44:47], v[152:155]
ds_read_b64_tr_b16 v[168:169], v5 offset:36864
v_mfma_f32_16x16x32_bf16 v[156:159], v[68:71], v[44:47], v[156:159]
ds_read_b128 v[112:115], v2 offset:40960
v_mfma_f32_16x16x32_bf16 v[216:219], v[80:83], v[44:47], v[216:219]
ds_read_b64_tr_b16 v[170:171], v5 offset:38912
v_mfma_f32_16x16x32_bf16 v[220:223], v[84:87], v[44:47], v[220:223]
ds_read_b128 v[116:119], v2 offset:41216
v_mfma_f32_16x16x32_bf16 v[128:131], v[72:75], v[48:51], v[128:131]
ds_read_b64_tr_b16 v[172:173], v6 offset:36864
v_mfma_f32_16x16x32_bf16 v[132:135], v[76:79], v[48:51], v[132:135]
ds_read_b128 v[120:123], v2 offset:41472
v_mfma_f32_16x16x32_bf16 v[192:195], v[88:91], v[48:51], v[192:195]
ds_read_b64_tr_b16 v[174:175], v6 offset:38912
v_mfma_f32_16x16x32_bf16 v[196:199], v[92:95], v[48:51], v[196:199]
ds_read_b128 v[124:127], v2 offset:41728
v_mfma_f32_16x16x32_bf16 v[136:139], v[72:75], v[52:55], v[136:139]
ds_read_b64_tr_b16 v[184:185], v5 offset:45056
v_mfma_f32_16x16x32_bf16 v[140:143], v[76:79], v[52:55], v[140:143]
ds_read_b64_tr_b16 v[186:187], v5 offset:47104
v_mfma_f32_16x16x32_bf16 v[200:203], v[88:91], v[52:55], v[200:203]
ds_read_b64_tr_b16 v[188:189], v6 offset:45056
v_mfma_f32_16x16x32_bf16 v[204:207], v[92:95], v[52:55], v[204:207]
ds_read_b64_tr_b16 v[190:191], v6 offset:47104
v_mfma_f32_16x16x32_bf16 v[144:147], v[72:75], v[56:59], v[144:147]
v_mfma_f32_16x16x32_bf16 v[148:151], v[76:79], v[56:59], v[148:151]
v_mfma_f32_16x16x32_bf16 v[208:211], v[88:91], v[56:59], v[208:211]
v_mfma_f32_16x16x32_bf16 v[212:215], v[92:95], v[56:59], v[212:215]
v_mfma_f32_16x16x32_bf16 v[152:155], v[72:75], v[60:63], v[152:155]
v_mfma_f32_16x16x32_bf16 v[156:159], v[76:79], v[60:63], v[156:159]
v_mfma_f32_16x16x32_bf16 v[216:219], v[88:91], v[60:63], v[216:219]
v_mfma_f32_16x16x32_bf16 v[220:223], v[92:95], v[60:63], v[220:223]
s_waitcnt lgkmcnt(0)
s_barrier
v_mfma_f32_16x16x32_bf16 v[128:131], v[160:163], v[96:99], v[128:131]
ds_read_b64_tr_b16 v[64:65], v7 offset:0
v_mfma_f32_16x16x32_bf16 v[132:135], v[164:167], v[96:99], v[132:135]
ds_read_b128 v[32:35], v3 offset:0
v_mfma_f32_16x16x32_bf16 v[192:195], v[176:179], v[96:99], v[192:195]
ds_read_b64_tr_b16 v[66:67], v7 offset:2048
v_mfma_f32_16x16x32_bf16 v[196:199], v[180:183], v[96:99], v[196:199]
ds_read_b128 v[36:39], v3 offset:256
v_mfma_f32_16x16x32_bf16 v[136:139], v[160:163], v[100:103], v[136:139]
ds_read_b64_tr_b16 v[68:69], v8 offset:0
v_mfma_f32_16x16x32_bf16 v[140:143], v[164:167], v[100:103], v[140:143]
ds_read_b128 v[40:43], v3 offset:512
v_mfma_f32_16x16x32_bf16 v[200:203], v[176:179], v[100:103], v[200:203]
ds_read_b64_tr_b16 v[70:71], v8 offset:2048
v_mfma_f32_16x16x32_bf16 v[204:207], v[180:183], v[100:103], v[204:207]
ds_read_b128 v[44:47], v3 offset:768
v_mfma_f32_16x16x32_bf16 v[144:147], v[160:163], v[104:107], v[144:147]
ds_read_b64_tr_b16 v[72:73], v7 offset:4096
v_mfma_f32_16x16x32_bf16 v[148:151], v[164:167], v[104:107], v[148:151]
ds_read_b128 v[48:51], v3 offset:8192
v_mfma_f32_16x16x32_bf16 v[208:211], v[176:179], v[104:107], v[208:211]
ds_read_b64_tr_b16 v[74:75], v7 offset:6144
v_mfma_f32_16x16x32_bf16 v[212:215], v[180:183], v[104:107], v[212:215]
ds_read_b128 v[52:55], v3 offset:8448
v_mfma_f32_16x16x32_bf16 v[152:155], v[160:163], v[108:111], v[152:155]
ds_read_b64_tr_b16 v[76:77], v8 offset:4096
v_mfma_f32_16x16x32_bf16 v[156:159], v[164:167], v[108:111], v[156:159]
ds_read_b128 v[56:59], v3 offset:8704
v_mfma_f32_16x16x32_bf16 v[216:219], v[176:179], v[108:111], v[216:219]
ds_read_b64_tr_b16 v[78:79], v8 offset:6144
v_mfma_f32_16x16x32_bf16 v[220:223], v[180:183], v[108:111], v[220:223]
ds_read_b128 v[60:63], v3 offset:8960
v_mfma_f32_16x16x32_bf16 v[128:131], v[168:171], v[112:115], v[128:131]
v_mfma_f32_16x16x32_bf16 v[132:135], v[172:175], v[112:115], v[132:135]
v_mfma_f32_16x16x32_bf16 v[192:195], v[184:187], v[112:115], v[192:195]
v_mfma_f32_16x16x32_bf16 v[196:199], v[188:191], v[112:115], v[196:199]
v_mfma_f32_16x16x32_bf16 v[136:139], v[168:171], v[116:119], v[136:139]
v_mfma_f32_16x16x32_bf16 v[140:143], v[172:175], v[116:119], v[140:143]
v_mfma_f32_16x16x32_bf16 v[200:203], v[184:187], v[116:119], v[200:203]
v_mfma_f32_16x16x32_bf16 v[204:207], v[188:191], v[116:119], v[204:207]
v_mfma_f32_16x16x32_bf16 v[144:147], v[168:171], v[120:123], v[144:147]
v_mfma_f32_16x16x32_bf16 v[148:151], v[172:175], v[120:123], v[148:151]
v_mfma_f32_16x16x32_bf16 v[208:211], v[184:187], v[120:123], v[208:211]
v_mfma_f32_16x16x32_bf16 v[212:215], v[188:191], v[120:123], v[212:215]
v_mfma_f32_16x16x32_bf16 v[152:155], v[168:171], v[124:127], v[152:155]
v_mfma_f32_16x16x32_bf16 v[156:159], v[172:175], v[124:127], v[156:159]
v_mfma_f32_16x16x32_bf16 v[216:219], v[184:187], v[124:127], v[216:219]
v_mfma_f32_16x16x32_bf16 v[220:223], v[188:191], v[124:127], v[220:223]
s_mov_b32 s54, 0x10000
s_waitcnt lgkmcnt(0)
s_barrier
v_mfma_f32_16x16x32_bf16 v[128:131], v[64:67], v[32:35], v[128:131]
ds_read_b64_tr_b16 v[160:161], v7 offset:32768
v_mfma_f32_16x16x32_bf16 v[132:135], v[68:71], v[32:35], v[132:135]
ds_read_b128 v[96:99], v3 offset:32768
v_mfma_f32_16x16x32_bf16 v[136:139], v[64:67], v[36:39], v[136:139]
ds_read_b64_tr_b16 v[162:163], v7 offset:34816
v_mfma_f32_16x16x32_bf16 v[140:143], v[68:71], v[36:39], v[140:143]
ds_read_b128 v[100:103], v3 offset:33024
v_cvt_pk_bf16_f32 v224, v192, v193
v_mfma_f32_16x16x32_bf16 v[144:147], v[64:67], v[40:43], v[144:147]
ds_read_b64_tr_b16 v[164:165], v8 offset:32768
v_cvt_pk_bf16_f32 v225, v194, v195
v_mfma_f32_16x16x32_bf16 v[148:151], v[68:71], v[40:43], v[148:151]
v_cvt_pk_bf16_f32 v226, v196, v197
ds_read_b128 v[104:107], v3 offset:33280
v_cvt_pk_bf16_f32 v227, v198, v199
v_mfma_f32_16x16x32_bf16 v[152:155], v[64:67], v[44:47], v[152:155]
buffer_store_dwordx4 v[224:227], v9, s[64:67], 0 offen offset:0 sc1
ds_read_b64_tr_b16 v[166:167], v8 offset:34816
v_cvt_pk_bf16_f32 v228, v200, v201
v_mfma_f32_16x16x32_bf16 v[156:159], v[68:71], v[44:47], v[156:159]
ds_read_b128 v[108:111], v3 offset:33536
v_cvt_pk_bf16_f32 v229, v202, v203
v_mfma_f32_16x16x32_bf16 v[128:131], v[72:75], v[48:51], v[128:131]
v_cvt_pk_bf16_f32 v230, v204, v205
ds_read_b64_tr_b16 v[168:169], v7 offset:36864
v_cvt_pk_bf16_f32 v231, v206, v207
v_mfma_f32_16x16x32_bf16 v[132:135], v[76:79], v[48:51], v[132:135]
buffer_store_dwordx4 v[228:231], v9, s[64:67], 0 offen offset:1024 sc1
ds_read_b128 v[112:115], v3 offset:40960
v_cvt_pk_bf16_f32 v232, v208, v209
v_mfma_f32_16x16x32_bf16 v[136:139], v[72:75], v[52:55], v[136:139]
ds_read_b64_tr_b16 v[170:171], v7 offset:38912
v_cvt_pk_bf16_f32 v233, v210, v211
v_mfma_f32_16x16x32_bf16 v[140:143], v[76:79], v[52:55], v[140:143]
v_cvt_pk_bf16_f32 v234, v212, v213
ds_read_b128 v[116:119], v3 offset:41216
v_cvt_pk_bf16_f32 v235, v214, v215
v_mfma_f32_16x16x32_bf16 v[144:147], v[72:75], v[56:59], v[144:147]
buffer_store_dwordx4 v[232:235], v9, s[64:67], 0 offen offset:2048 sc1
ds_read_b64_tr_b16 v[172:173], v8 offset:36864
v_cvt_pk_bf16_f32 v236, v216, v217
v_mfma_f32_16x16x32_bf16 v[148:151], v[76:79], v[56:59], v[148:151]
ds_read_b128 v[120:123], v3 offset:41472
v_cvt_pk_bf16_f32 v237, v218, v219
v_mfma_f32_16x16x32_bf16 v[152:155], v[72:75], v[60:63], v[152:155]
v_cvt_pk_bf16_f32 v238, v220, v221
ds_read_b64_tr_b16 v[174:175], v8 offset:38912
v_cvt_pk_bf16_f32 v239, v222, v223
v_mfma_f32_16x16x32_bf16 v[156:159], v[76:79], v[60:63], v[156:159]
buffer_store_dwordx4 v[236:239], v9, s[64:67], 0 offen offset:3072 sc1
ds_read_b128 v[124:127], v3 offset:41728
s_waitcnt lgkmcnt(0)
s_barrier
v_mfma_f32_16x16x32_bf16 v[128:131], v[160:163], v[96:99], v[128:131]
ds_read_b64_tr_b16 v[64:65], v5 offset:0
v_mfma_f32_16x16x32_bf16 v[132:135], v[164:167], v[96:99], v[132:135]
ds_read_b128 v[32:35], v2 offset:0
v_mfma_f32_16x16x32_bf16 v[136:139], v[160:163], v[100:103], v[136:139]
ds_read_b64_tr_b16 v[66:67], v5 offset:2048
v_mfma_f32_16x16x32_bf16 v[140:143], v[164:167], v[100:103], v[140:143]
ds_read_b128 v[36:39], v2 offset:256
v_mfma_f32_16x16x32_bf16 v[144:147], v[160:163], v[104:107], v[144:147]
ds_read_b64_tr_b16 v[68:69], v6 offset:0
v_mfma_f32_16x16x32_bf16 v[148:151], v[164:167], v[104:107], v[148:151]
ds_read_b128 v[40:43], v2 offset:512
v_mfma_f32_16x16x32_bf16 v[152:155], v[160:163], v[108:111], v[152:155]
ds_read_b64_tr_b16 v[70:71], v6 offset:2048
v_mfma_f32_16x16x32_bf16 v[156:159], v[164:167], v[108:111], v[156:159]
ds_read_b128 v[44:47], v2 offset:768
v_mfma_f32_16x16x32_bf16 v[128:131], v[168:171], v[112:115], v[128:131]
ds_read_b64_tr_b16 v[72:73], v5 offset:4096
v_mfma_f32_16x16x32_bf16 v[132:135], v[172:175], v[112:115], v[132:135]
ds_read_b128 v[48:51], v2 offset:8192
v_mfma_f32_16x16x32_bf16 v[136:139], v[168:171], v[116:119], v[136:139]
ds_read_b64_tr_b16 v[74:75], v5 offset:6144
v_mfma_f32_16x16x32_bf16 v[140:143], v[172:175], v[116:119], v[140:143]
ds_read_b128 v[52:55], v2 offset:8448
v_mfma_f32_16x16x32_bf16 v[144:147], v[168:171], v[120:123], v[144:147]
ds_read_b64_tr_b16 v[76:77], v6 offset:4096
v_mfma_f32_16x16x32_bf16 v[148:151], v[172:175], v[120:123], v[148:151]
ds_read_b128 v[56:59], v2 offset:8704
v_mfma_f32_16x16x32_bf16 v[152:155], v[168:171], v[124:127], v[152:155]
ds_read_b64_tr_b16 v[78:79], v6 offset:6144
v_mfma_f32_16x16x32_bf16 v[156:159], v[172:175], v[124:127], v[156:159]
ds_read_b128 v[60:63], v2 offset:8960
s_waitcnt lgkmcnt(0)
s_barrier
v_mfma_f32_16x16x32_bf16 v[128:131], v[64:67], v[32:35], v[128:131]
ds_read_b64_tr_b16 v[160:161], v5 offset:32768
v_mfma_f32_16x16x32_bf16 v[132:135], v[68:71], v[32:35], v[132:135]
ds_read_b128 v[96:99], v2 offset:32768
v_mfma_f32_16x16x32_bf16 v[136:139], v[64:67], v[36:39], v[136:139]
ds_read_b64_tr_b16 v[162:163], v5 offset:34816
v_mfma_f32_16x16x32_bf16 v[140:143], v[68:71], v[36:39], v[140:143]
ds_read_b128 v[100:103], v2 offset:33024
v_mfma_f32_16x16x32_bf16 v[144:147], v[64:67], v[40:43], v[144:147]
ds_read_b64_tr_b16 v[164:165], v6 offset:32768
v_mfma_f32_16x16x32_bf16 v[148:151], v[68:71], v[40:43], v[148:151]
ds_read_b128 v[104:107], v2 offset:33280
v_mfma_f32_16x16x32_bf16 v[152:155], v[64:67], v[44:47], v[152:155]
ds_read_b64_tr_b16 v[166:167], v6 offset:34816
v_mfma_f32_16x16x32_bf16 v[156:159], v[68:71], v[44:47], v[156:159]
ds_read_b128 v[108:111], v2 offset:33536
v_mfma_f32_16x16x32_bf16 v[128:131], v[72:75], v[48:51], v[128:131]
ds_read_b64_tr_b16 v[168:169], v5 offset:36864
v_mfma_f32_16x16x32_bf16 v[132:135], v[76:79], v[48:51], v[132:135]
ds_read_b128 v[112:115], v2 offset:40960
v_mfma_f32_16x16x32_bf16 v[136:139], v[72:75], v[52:55], v[136:139]
ds_read_b64_tr_b16 v[170:171], v5 offset:38912
v_mfma_f32_16x16x32_bf16 v[140:143], v[76:79], v[52:55], v[140:143]
ds_read_b128 v[116:119], v2 offset:41216
v_mfma_f32_16x16x32_bf16 v[144:147], v[72:75], v[56:59], v[144:147]
ds_read_b64_tr_b16 v[172:173], v6 offset:36864
v_mfma_f32_16x16x32_bf16 v[148:151], v[76:79], v[56:59], v[148:151]
ds_read_b128 v[120:123], v2 offset:41472
v_mfma_f32_16x16x32_bf16 v[152:155], v[72:75], v[60:63], v[152:155]
ds_read_b64_tr_b16 v[174:175], v6 offset:38912
v_mfma_f32_16x16x32_bf16 v[156:159], v[76:79], v[60:63], v[156:159]
ds_read_b128 v[124:127], v2 offset:41728
s_waitcnt vmcnt(0) lgkmcnt(0)
s_barrier
v_mfma_f32_16x16x32_bf16 v[128:131], v[160:163], v[96:99], v[128:131]
ds_read_b64_tr_b16 v[64:65], v7 offset:0
v_mfma_f32_16x16x32_bf16 v[132:135], v[164:167], v[96:99], v[132:135]
ds_read_b128 v[32:35], v3 offset:0
v_mfma_f32_16x16x32_bf16 v[136:139], v[160:163], v[100:103], v[136:139]
ds_read_b64_tr_b16 v[66:67], v7 offset:2048
v_mfma_f32_16x16x32_bf16 v[140:143], v[164:167], v[100:103], v[140:143]
ds_read_b128 v[36:39], v3 offset:256
v_mfma_f32_16x16x32_bf16 v[144:147], v[160:163], v[104:107], v[144:147]
ds_read_b64_tr_b16 v[68:69], v8 offset:0
v_mfma_f32_16x16x32_bf16 v[148:151], v[164:167], v[104:107], v[148:151]
ds_read_b128 v[40:43], v3 offset:512
v_mfma_f32_16x16x32_bf16 v[152:155], v[160:163], v[108:111], v[152:155]
ds_read_b64_tr_b16 v[70:71], v8 offset:2048
v_mfma_f32_16x16x32_bf16 v[156:159], v[164:167], v[108:111], v[156:159]
ds_read_b128 v[44:47], v3 offset:768
v_mfma_f32_16x16x32_bf16 v[128:131], v[168:171], v[112:115], v[128:131]
ds_read_b64_tr_b16 v[72:73], v7 offset:4096
v_mfma_f32_16x16x32_bf16 v[132:135], v[172:175], v[112:115], v[132:135]
ds_read_b128 v[48:51], v3 offset:8192
v_mfma_f32_16x16x32_bf16 v[136:139], v[168:171], v[116:119], v[136:139]
ds_read_b64_tr_b16 v[74:75], v7 offset:6144
v_mfma_f32_16x16x32_bf16 v[140:143], v[172:175], v[116:119], v[140:143]
ds_read_b128 v[52:55], v3 offset:8448
v_mfma_f32_16x16x32_bf16 v[144:147], v[168:171], v[120:123], v[144:147]
ds_read_b64_tr_b16 v[76:77], v8 offset:4096
v_mfma_f32_16x16x32_bf16 v[148:151], v[172:175], v[120:123], v[148:151]
ds_read_b128 v[56:59], v3 offset:8704
v_mfma_f32_16x16x32_bf16 v[152:155], v[168:171], v[124:127], v[152:155]
ds_read_b64_tr_b16 v[78:79], v8 offset:6144
v_mfma_f32_16x16x32_bf16 v[156:159], v[172:175], v[124:127], v[156:159]
ds_read_b128 v[60:63], v3 offset:8960
s_waitcnt lgkmcnt(0)
s_barrier
v_mfma_f32_16x16x32_bf16 v[128:131], v[64:67], v[32:35], v[128:131]
ds_read_b64_tr_b16 v[160:161], v7 offset:32768
v_mfma_f32_16x16x32_bf16 v[132:135], v[68:71], v[32:35], v[132:135]
ds_read_b128 v[96:99], v3 offset:32768
v_mfma_f32_16x16x32_bf16 v[136:139], v[64:67], v[36:39], v[136:139]
ds_read_b64_tr_b16 v[162:163], v7 offset:34816
v_mfma_f32_16x16x32_bf16 v[140:143], v[68:71], v[36:39], v[140:143]
ds_read_b128 v[100:103], v3 offset:33024
v_mfma_f32_16x16x32_bf16 v[144:147], v[64:67], v[40:43], v[144:147]
ds_read_b64_tr_b16 v[164:165], v8 offset:32768
v_mfma_f32_16x16x32_bf16 v[148:151], v[68:71], v[40:43], v[148:151]
ds_read_b128 v[104:107], v3 offset:33280
v_mfma_f32_16x16x32_bf16 v[152:155], v[64:67], v[44:47], v[152:155]
ds_read_b64_tr_b16 v[166:167], v8 offset:34816
v_mfma_f32_16x16x32_bf16 v[156:159], v[68:71], v[44:47], v[156:159]
ds_read_b128 v[108:111], v3 offset:33536
v_mfma_f32_16x16x32_bf16 v[128:131], v[72:75], v[48:51], v[128:131]
ds_read_b64_tr_b16 v[168:169], v7 offset:36864
v_mfma_f32_16x16x32_bf16 v[132:135], v[76:79], v[48:51], v[132:135]
ds_read_b128 v[112:115], v3 offset:40960
v_mfma_f32_16x16x32_bf16 v[136:139], v[72:75], v[52:55], v[136:139]
ds_read_b64_tr_b16 v[170:171], v7 offset:38912
v_mfma_f32_16x16x32_bf16 v[140:143], v[76:79], v[52:55], v[140:143]
ds_read_b128 v[116:119], v3 offset:41216
v_mfma_f32_16x16x32_bf16 v[144:147], v[72:75], v[56:59], v[144:147]
ds_read_b64_tr_b16 v[172:173], v8 offset:36864
v_mfma_f32_16x16x32_bf16 v[148:151], v[76:79], v[56:59], v[148:151]
ds_read_b128 v[120:123], v3 offset:41472
v_mfma_f32_16x16x32_bf16 v[152:155], v[72:75], v[60:63], v[152:155]
ds_read_b64_tr_b16 v[174:175], v8 offset:38912
v_mfma_f32_16x16x32_bf16 v[156:159], v[76:79], v[60:63], v[156:159]
ds_read_b128 v[124:127], v3 offset:41728
s_waitcnt lgkmcnt(0)
s_barrier
v_mfma_f32_16x16x32_bf16 v[128:131], v[160:163], v[96:99], v[128:131]
ds_read_b64_tr_b16 v[64:65], v5 offset:0
v_mfma_f32_16x16x32_bf16 v[132:135], v[164:167], v[96:99], v[132:135]
ds_read_b128 v[32:35], v2 offset:0
v_mfma_f32_16x16x32_bf16 v[136:139], v[160:163], v[100:103], v[136:139]
ds_read_b64_tr_b16 v[66:67], v5 offset:2048
v_mfma_f32_16x16x32_bf16 v[140:143], v[164:167], v[100:103], v[140:143]
ds_read_b128 v[36:39], v2 offset:256
v_mfma_f32_16x16x32_bf16 v[144:147], v[160:163], v[104:107], v[144:147]
ds_read_b64_tr_b16 v[68:69], v6 offset:0
v_mfma_f32_16x16x32_bf16 v[148:151], v[164:167], v[104:107], v[148:151]
ds_read_b128 v[40:43], v2 offset:512
v_mfma_f32_16x16x32_bf16 v[152:155], v[160:163], v[108:111], v[152:155]
ds_read_b64_tr_b16 v[70:71], v6 offset:2048
v_mfma_f32_16x16x32_bf16 v[156:159], v[164:167], v[108:111], v[156:159]
ds_read_b128 v[44:47], v2 offset:768
v_mfma_f32_16x16x32_bf16 v[128:131], v[168:171], v[112:115], v[128:131]
ds_read_b64_tr_b16 v[72:73], v5 offset:4096
v_mfma_f32_16x16x32_bf16 v[132:135], v[172:175], v[112:115], v[132:135]
ds_read_b128 v[48:51], v2 offset:8192
v_mfma_f32_16x16x32_bf16 v[136:139], v[168:171], v[116:119], v[136:139]
ds_read_b64_tr_b16 v[74:75], v5 offset:6144
v_mfma_f32_16x16x32_bf16 v[140:143], v[172:175], v[116:119], v[140:143]
ds_read_b128 v[52:55], v2 offset:8448
v_mfma_f32_16x16x32_bf16 v[144:147], v[168:171], v[120:123], v[144:147]
ds_read_b64_tr_b16 v[76:77], v6 offset:4096
v_mfma_f32_16x16x32_bf16 v[148:151], v[172:175], v[120:123], v[148:151]
ds_read_b128 v[56:59], v2 offset:8704
v_mfma_f32_16x16x32_bf16 v[152:155], v[168:171], v[124:127], v[152:155]
ds_read_b64_tr_b16 v[78:79], v6 offset:6144
v_mfma_f32_16x16x32_bf16 v[156:159], v[172:175], v[124:127], v[156:159]
ds_read_b128 v[60:63], v2 offset:8960
s_waitcnt lgkmcnt(0)
s_barrier
v_mfma_f32_16x16x32_bf16 v[128:131], v[64:67], v[32:35], v[128:131]
ds_read_b64_tr_b16 v[160:161], v5 offset:32768
v_mfma_f32_16x16x32_bf16 v[132:135], v[68:71], v[32:35], v[132:135]
ds_read_b128 v[96:99], v2 offset:32768
v_mfma_f32_16x16x32_bf16 v[136:139], v[64:67], v[36:39], v[136:139]
ds_read_b64_tr_b16 v[162:163], v5 offset:34816
v_mfma_f32_16x16x32_bf16 v[140:143], v[68:71], v[36:39], v[140:143]
ds_read_b128 v[100:103], v2 offset:33024
v_mfma_f32_16x16x32_bf16 v[144:147], v[64:67], v[40:43], v[144:147]
ds_read_b64_tr_b16 v[164:165], v6 offset:32768
v_mfma_f32_16x16x32_bf16 v[148:151], v[68:71], v[40:43], v[148:151]
ds_read_b128 v[104:107], v2 offset:33280
v_mfma_f32_16x16x32_bf16 v[152:155], v[64:67], v[44:47], v[152:155]
ds_read_b64_tr_b16 v[166:167], v6 offset:34816
v_mfma_f32_16x16x32_bf16 v[156:159], v[68:71], v[44:47], v[156:159]
ds_read_b128 v[108:111], v2 offset:33536
v_mfma_f32_16x16x32_bf16 v[128:131], v[72:75], v[48:51], v[128:131]
ds_read_b64_tr_b16 v[168:169], v5 offset:36864
v_mfma_f32_16x16x32_bf16 v[132:135], v[76:79], v[48:51], v[132:135]
ds_read_b128 v[112:115], v2 offset:40960
v_mfma_f32_16x16x32_bf16 v[136:139], v[72:75], v[52:55], v[136:139]
ds_read_b64_tr_b16 v[170:171], v5 offset:38912
v_mfma_f32_16x16x32_bf16 v[140:143], v[76:79], v[52:55], v[140:143]
ds_read_b128 v[116:119], v2 offset:41216
v_mfma_f32_16x16x32_bf16 v[144:147], v[72:75], v[56:59], v[144:147]
ds_read_b64_tr_b16 v[172:173], v6 offset:36864
v_mfma_f32_16x16x32_bf16 v[148:151], v[76:79], v[56:59], v[148:151]
ds_read_b128 v[120:123], v2 offset:41472
v_mfma_f32_16x16x32_bf16 v[152:155], v[72:75], v[60:63], v[152:155]
ds_read_b64_tr_b16 v[174:175], v6 offset:38912
v_mfma_f32_16x16x32_bf16 v[156:159], v[76:79], v[60:63], v[156:159]
ds_read_b128 v[124:127], v2 offset:41728
s_waitcnt lgkmcnt(0)
s_barrier
v_mfma_f32_16x16x32_bf16 v[128:131], v[160:163], v[96:99], v[128:131]
ds_read_b64_tr_b16 v[64:65], v7 offset:0
v_mfma_f32_16x16x32_bf16 v[132:135], v[164:167], v[96:99], v[132:135]
ds_read_b128 v[32:35], v3 offset:0
v_mfma_f32_16x16x32_bf16 v[136:139], v[160:163], v[100:103], v[136:139]
ds_read_b64_tr_b16 v[66:67], v7 offset:2048
v_mfma_f32_16x16x32_bf16 v[140:143], v[164:167], v[100:103], v[140:143]
ds_read_b128 v[36:39], v3 offset:256
v_mfma_f32_16x16x32_bf16 v[144:147], v[160:163], v[104:107], v[144:147]
ds_read_b64_tr_b16 v[68:69], v8 offset:0
v_mfma_f32_16x16x32_bf16 v[148:151], v[164:167], v[104:107], v[148:151]
ds_read_b128 v[40:43], v3 offset:512
v_mfma_f32_16x16x32_bf16 v[152:155], v[160:163], v[108:111], v[152:155]
ds_read_b64_tr_b16 v[70:71], v8 offset:2048
v_mfma_f32_16x16x32_bf16 v[156:159], v[164:167], v[108:111], v[156:159]
ds_read_b128 v[44:47], v3 offset:768
v_mfma_f32_16x16x32_bf16 v[128:131], v[168:171], v[112:115], v[128:131]
ds_read_b64_tr_b16 v[72:73], v7 offset:4096
v_mfma_f32_16x16x32_bf16 v[132:135], v[172:175], v[112:115], v[132:135]
ds_read_b128 v[48:51], v3 offset:8192
v_mfma_f32_16x16x32_bf16 v[136:139], v[168:171], v[116:119], v[136:139]
ds_read_b64_tr_b16 v[74:75], v7 offset:6144
v_mfma_f32_16x16x32_bf16 v[140:143], v[172:175], v[116:119], v[140:143]
ds_read_b128 v[52:55], v3 offset:8448
v_mfma_f32_16x16x32_bf16 v[144:147], v[168:171], v[120:123], v[144:147]
ds_read_b64_tr_b16 v[76:77], v8 offset:4096
v_mfma_f32_16x16x32_bf16 v[148:151], v[172:175], v[120:123], v[148:151]
ds_read_b128 v[56:59], v3 offset:8704
v_mfma_f32_16x16x32_bf16 v[152:155], v[168:171], v[124:127], v[152:155]
ds_read_b64_tr_b16 v[78:79], v8 offset:6144
v_mfma_f32_16x16x32_bf16 v[156:159], v[172:175], v[124:127], v[156:159]
ds_read_b128 v[60:63], v3 offset:8960
s_waitcnt lgkmcnt(0)
s_barrier
v_mfma_f32_16x16x32_bf16 v[128:131], v[64:67], v[32:35], v[128:131]
ds_read_b64_tr_b16 v[160:161], v7 offset:32768
v_mfma_f32_16x16x32_bf16 v[132:135], v[68:71], v[32:35], v[132:135]
ds_read_b128 v[96:99], v3 offset:32768
v_mfma_f32_16x16x32_bf16 v[136:139], v[64:67], v[36:39], v[136:139]
ds_read_b64_tr_b16 v[162:163], v7 offset:34816
v_mfma_f32_16x16x32_bf16 v[140:143], v[68:71], v[36:39], v[140:143]
ds_read_b128 v[100:103], v3 offset:33024
v_mfma_f32_16x16x32_bf16 v[144:147], v[64:67], v[40:43], v[144:147]
ds_read_b64_tr_b16 v[164:165], v8 offset:32768
v_mfma_f32_16x16x32_bf16 v[148:151], v[68:71], v[40:43], v[148:151]
ds_read_b128 v[104:107], v3 offset:33280
v_mfma_f32_16x16x32_bf16 v[152:155], v[64:67], v[44:47], v[152:155]
ds_read_b64_tr_b16 v[166:167], v8 offset:34816
v_mfma_f32_16x16x32_bf16 v[156:159], v[68:71], v[44:47], v[156:159]
ds_read_b128 v[108:111], v3 offset:33536
v_mfma_f32_16x16x32_bf16 v[128:131], v[72:75], v[48:51], v[128:131]
ds_read_b64_tr_b16 v[168:169], v7 offset:36864
v_mfma_f32_16x16x32_bf16 v[132:135], v[76:79], v[48:51], v[132:135]
ds_read_b128 v[112:115], v3 offset:40960
v_mfma_f32_16x16x32_bf16 v[136:139], v[72:75], v[52:55], v[136:139]
ds_read_b64_tr_b16 v[170:171], v7 offset:38912
v_mfma_f32_16x16x32_bf16 v[140:143], v[76:79], v[52:55], v[140:143]
ds_read_b128 v[116:119], v3 offset:41216
v_mfma_f32_16x16x32_bf16 v[144:147], v[72:75], v[56:59], v[144:147]
ds_read_b64_tr_b16 v[172:173], v8 offset:36864
v_mfma_f32_16x16x32_bf16 v[148:151], v[76:79], v[56:59], v[148:151]
ds_read_b128 v[120:123], v3 offset:41472
v_mfma_f32_16x16x32_bf16 v[152:155], v[72:75], v[60:63], v[152:155]
ds_read_b64_tr_b16 v[174:175], v8 offset:38912
v_mfma_f32_16x16x32_bf16 v[156:159], v[76:79], v[60:63], v[156:159]
ds_read_b128 v[124:127], v3 offset:41728
s_waitcnt lgkmcnt(0)
s_barrier
v_mfma_f32_16x16x32_bf16 v[128:131], v[160:163], v[96:99], v[128:131]
ds_read_b64_tr_b16 v[64:65], v5 offset:0
v_mfma_f32_16x16x32_bf16 v[132:135], v[164:167], v[96:99], v[132:135]
ds_read_b128 v[32:35], v2 offset:0
v_mfma_f32_16x16x32_bf16 v[136:139], v[160:163], v[100:103], v[136:139]
ds_read_b64_tr_b16 v[66:67], v5 offset:2048
v_mfma_f32_16x16x32_bf16 v[140:143], v[164:167], v[100:103], v[140:143]
ds_read_b128 v[36:39], v2 offset:256
buffer_load_dwordx4 v[192:195], v9, s[68:71], 0 offen offset:0 sc1
v_mfma_f32_16x16x32_bf16 v[144:147], v[160:163], v[104:107], v[144:147]
ds_read_b64_tr_b16 v[68:69], v6 offset:0
v_mfma_f32_16x16x32_bf16 v[148:151], v[164:167], v[104:107], v[148:151]
ds_read_b128 v[40:43], v2 offset:512
v_mfma_f32_16x16x32_bf16 v[152:155], v[160:163], v[108:111], v[152:155]
ds_read_b64_tr_b16 v[70:71], v6 offset:2048
buffer_load_dwordx4 v[196:199], v9, s[68:71], 0 offen offset:1024 sc1
v_mfma_f32_16x16x32_bf16 v[156:159], v[164:167], v[108:111], v[156:159]
ds_read_b128 v[44:47], v2 offset:768
v_mfma_f32_16x16x32_bf16 v[128:131], v[168:171], v[112:115], v[128:131]
ds_read_b64_tr_b16 v[72:73], v5 offset:4096
v_mfma_f32_16x16x32_bf16 v[132:135], v[172:175], v[112:115], v[132:135]
ds_read_b128 v[48:51], v2 offset:8192
buffer_load_dwordx4 v[200:203], v9, s[68:71], 0 offen offset:2048 sc1
v_mfma_f32_16x16x32_bf16 v[136:139], v[168:171], v[116:119], v[136:139]
ds_read_b64_tr_b16 v[74:75], v5 offset:6144
v_mfma_f32_16x16x32_bf16 v[140:143], v[172:175], v[116:119], v[140:143]
ds_read_b128 v[52:55], v2 offset:8448
v_mfma_f32_16x16x32_bf16 v[144:147], v[168:171], v[120:123], v[144:147]
ds_read_b64_tr_b16 v[76:77], v6 offset:4096
buffer_load_dwordx4 v[204:207], v9, s[68:71], 0 offen offset:3072 sc1
v_mfma_f32_16x16x32_bf16 v[148:151], v[172:175], v[120:123], v[148:151]
ds_read_b128 v[56:59], v2 offset:8704
v_mfma_f32_16x16x32_bf16 v[152:155], v[168:171], v[124:127], v[152:155]
ds_read_b64_tr_b16 v[78:79], v6 offset:6144
v_mfma_f32_16x16x32_bf16 v[156:159], v[172:175], v[124:127], v[156:159]
ds_read_b128 v[60:63], v2 offset:8960
s_waitcnt lgkmcnt(0)
s_barrier
v_mfma_f32_16x16x32_bf16 v[128:131], v[64:67], v[32:35], v[128:131]
ds_read_b64_tr_b16 v[160:161], v5 offset:32768
v_mfma_f32_16x16x32_bf16 v[132:135], v[68:71], v[32:35], v[132:135]
ds_read_b128 v[96:99], v2 offset:32768
v_mfma_f32_16x16x32_bf16 v[136:139], v[64:67], v[36:39], v[136:139]
ds_read_b64_tr_b16 v[162:163], v5 offset:34816
v_mfma_f32_16x16x32_bf16 v[140:143], v[68:71], v[36:39], v[140:143]
ds_read_b128 v[100:103], v2 offset:33024
v_mfma_f32_16x16x32_bf16 v[144:147], v[64:67], v[40:43], v[144:147]
ds_read_b64_tr_b16 v[164:165], v6 offset:32768
v_mfma_f32_16x16x32_bf16 v[148:151], v[68:71], v[40:43], v[148:151]
ds_read_b128 v[104:107], v2 offset:33280
v_mfma_f32_16x16x32_bf16 v[152:155], v[64:67], v[44:47], v[152:155]
ds_read_b64_tr_b16 v[166:167], v6 offset:34816
v_mfma_f32_16x16x32_bf16 v[156:159], v[68:71], v[44:47], v[156:159]
ds_read_b128 v[108:111], v2 offset:33536
v_mfma_f32_16x16x32_bf16 v[128:131], v[72:75], v[48:51], v[128:131]
ds_read_b64_tr_b16 v[168:169], v5 offset:36864
v_mfma_f32_16x16x32_bf16 v[132:135], v[76:79], v[48:51], v[132:135]
ds_read_b128 v[112:115], v2 offset:40960
v_mfma_f32_16x16x32_bf16 v[136:139], v[72:75], v[52:55], v[136:139]
ds_read_b64_tr_b16 v[170:171], v5 offset:38912
v_mfma_f32_16x16x32_bf16 v[140:143], v[76:79], v[52:55], v[140:143]
ds_read_b128 v[116:119], v2 offset:41216
v_mfma_f32_16x16x32_bf16 v[144:147], v[72:75], v[56:59], v[144:147]
ds_read_b64_tr_b16 v[172:173], v6 offset:36864
v_mfma_f32_16x16x32_bf16 v[148:151], v[76:79], v[56:59], v[148:151]
ds_read_b128 v[120:123], v2 offset:41472
v_mfma_f32_16x16x32_bf16 v[152:155], v[72:75], v[60:63], v[152:155]
ds_read_b64_tr_b16 v[174:175], v6 offset:38912
v_mfma_f32_16x16x32_bf16 v[156:159], v[76:79], v[60:63], v[156:159]
ds_read_b128 v[124:127], v2 offset:41728
s_waitcnt lgkmcnt(0)
s_barrier
v_mfma_f32_16x16x32_bf16 v[128:131], v[160:163], v[96:99], v[128:131]
v_mfma_f32_16x16x32_bf16 v[132:135], v[164:167], v[96:99], v[132:135]
v_mfma_f32_16x16x32_bf16 v[136:139], v[160:163], v[100:103], v[136:139]
v_mfma_f32_16x16x32_bf16 v[140:143], v[164:167], v[100:103], v[140:143]
v_mfma_f32_16x16x32_bf16 v[144:147], v[160:163], v[104:107], v[144:147]
v_mfma_f32_16x16x32_bf16 v[148:151], v[164:167], v[104:107], v[148:151]
v_mfma_f32_16x16x32_bf16 v[152:155], v[160:163], v[108:111], v[152:155]
v_mfma_f32_16x16x32_bf16 v[156:159], v[164:167], v[108:111], v[156:159]
s_waitcnt vmcnt(0)
v_mfma_f32_16x16x32_bf16 v[128:131], v[168:171], v[112:115], v[128:131]
v_lshlrev_b32 v224, 16, v192
v_and_b32 v225, 0xffff0000, v192
v_lshlrev_b32 v226, 16, v193
v_and_b32 v227, 0xffff0000, v193
v_mfma_f32_16x16x32_bf16 v[132:135], v[172:175], v[112:115], v[132:135]
v_lshlrev_b32 v228, 16, v194
v_and_b32 v229, 0xffff0000, v194
v_lshlrev_b32 v230, 16, v195
v_and_b32 v231, 0xffff0000, v195
v_mfma_f32_16x16x32_bf16 v[136:139], v[168:171], v[116:119], v[136:139]
v_lshlrev_b32 v232, 16, v196
v_and_b32 v233, 0xffff0000, v196
v_lshlrev_b32 v234, 16, v197
v_and_b32 v235, 0xffff0000, v197
v_mfma_f32_16x16x32_bf16 v[140:143], v[172:175], v[116:119], v[140:143]
v_lshlrev_b32 v236, 16, v198
v_and_b32 v237, 0xffff0000, v198
v_lshlrev_b32 v238, 16, v199
v_and_b32 v239, 0xffff0000, v199
v_mfma_f32_16x16x32_bf16 v[144:147], v[168:171], v[120:123], v[144:147]
v_lshlrev_b32 v240, 16, v200
v_and_b32 v241, 0xffff0000, v200
v_lshlrev_b32 v242, 16, v201
v_and_b32 v243, 0xffff0000, v201
v_mfma_f32_16x16x32_bf16 v[148:151], v[172:175], v[120:123], v[148:151]
v_lshlrev_b32 v244, 16, v202
v_and_b32 v245, 0xffff0000, v202
v_lshlrev_b32 v246, 16, v203
v_and_b32 v247, 0xffff0000, v203
v_mfma_f32_16x16x32_bf16 v[152:155], v[168:171], v[124:127], v[152:155]
v_lshlrev_b32 v248, 16, v204
v_and_b32 v249, 0xffff0000, v204
v_lshlrev_b32 v250, 16, v205
v_and_b32 v251, 0xffff0000, v205
v_mfma_f32_16x16x32_bf16 v[156:159], v[172:175], v[124:127], v[156:159]
v_lshlrev_b32 v252, 16, v206
v_and_b32 v253, 0xffff0000, v206
v_lshlrev_b32 v254, 16, v207
v_and_b32 v255, 0xffff0000, v207
s_waitcnt vmcnt(0)
s_nop 4
v_pk_add_f32 v[128:129], v[128:129], v[224:225]
v_pk_add_f32 v[130:131], v[130:131], v[226:227]
v_pk_add_f32 v[132:133], v[132:133], v[228:229]
v_pk_add_f32 v[134:135], v[134:135], v[230:231]
v_cvt_pk_bf16_f32 v32, v128, v129
v_cvt_pk_bf16_f32 v33, v130, v131
v_cvt_pk_bf16_f32 v34, v132, v133
v_cvt_pk_bf16_f32 v35, v134, v135
v_pk_add_f32 v[136:137], v[136:137], v[232:233]
v_pk_add_f32 v[138:139], v[138:139], v[234:235]
v_pk_add_f32 v[140:141], v[140:141], v[236:237]
v_pk_add_f32 v[142:143], v[142:143], v[238:239]
v_cvt_pk_bf16_f32 v36, v136, v137
v_cvt_pk_bf16_f32 v37, v138, v139
v_cvt_pk_bf16_f32 v38, v140, v141
v_cvt_pk_bf16_f32 v39, v142, v143
v_pk_add_f32 v[144:145], v[144:145], v[240:241]
v_pk_add_f32 v[146:147], v[146:147], v[242:243]
v_pk_add_f32 v[148:149], v[148:149], v[244:245]
v_pk_add_f32 v[150:151], v[150:151], v[246:247]
v_cvt_pk_bf16_f32 v40, v144, v145
v_cvt_pk_bf16_f32 v41, v146, v147
v_cvt_pk_bf16_f32 v42, v148, v149
v_cvt_pk_bf16_f32 v43, v150, v151
v_pk_add_f32 v[152:153], v[152:153], v[248:249]
v_pk_add_f32 v[154:155], v[154:155], v[250:251]
v_pk_add_f32 v[156:157], v[156:157], v[252:253]
v_pk_add_f32 v[158:159], v[158:159], v[254:255]
v_cvt_pk_bf16_f32 v44, v152, v153
v_cvt_pk_bf16_f32 v45, v154, v155
v_cvt_pk_bf16_f32 v46, v156, v157
v_cvt_pk_bf16_f32 v47, v158, v159
v_permlane16_swap_b32 v32, v34
v_permlane16_swap_b32 v33, v35
buffer_store_dwordx4 v[32:35], v28, s[16:19], 0 offen offset:0
v_permlane16_swap_b32 v36, v38
v_permlane16_swap_b32 v37, v39
buffer_store_dwordx4 v[36:39], v28, s[16:19], 0 offen offset:2048
v_permlane16_swap_b32 v40, v42
v_permlane16_swap_b32 v41, v43
buffer_store_dwordx4 v[40:43], v28, s[16:19], s54 offen offset:0
v_permlane16_swap_b32 v44, v46
v_permlane16_swap_b32 v45, v47
buffer_store_dwordx4 v[44:47], v28, s[16:19], s54 offen offset:2048
s_branch Ldone_1
.p2align 6
Lw_19:
s_branch Lr_20
s_nop 0
.p2align 3
LG1_42:
s_cmp_eq_u32 s36, 7
s_cbranch_scc1 L7_101
s_mul_i32 s44, s34, 262144
s_lshl_b32 s39, s51, 13
s_add_u32 s44, s44, s39
s_add_u32 s44, s44, 0
s_lshl_b32 s43, s35, 7
s_mov_b32 s10, 253952
s_movk_i32 s38, 1024
s_movk_i32 s40, 9216
s_cmp_eq_u32 s51, 2
s_cselect_b32 s8, s28, s32
s_cselect_b32 s9, s29, s33
s_cselect_b32 s10, 2095232, s10
s_cselect_b32 s43, s43, s44
s_cselect_b32 s38, 16384, s38
s_cselect_b32 s40, 16384, s40
s_cselect_b32 s55, 16384, s38
s_cselect_b32 s45, -1, 0
s_add_u32 s8, s8, s43
s_addc_u32 s9, s9, 0
s_mov_b32 s11, 0x20000
s_sub_u32 s37, 0, s40
v_lshrrev_b32 v19, 3, v1
v_mul_u32_u24 v19, 1920, v19
v_lshrrev_b32 v20, 4, v1
v_lshlrev_b32 v20, 5, v20
v_and_b32 v19, s45, v19
v_and_b32 v20, s45, v20
v_lshlrev_b32 v23, 4, v1
v_xor_b32 v23, v23, v20
v_add_u32 v23, v23, v19
s_lshl_b32 s43, s34, 18
s_add_u32 s12, s32, s43
s_addc_u32 s13, s33, 0
s_mov_b32 s14, 262144
s_mov_b32 s15, 0x20000
v_lshlrev_b32 v21, 4, v1
s_lshl_b32 s54, s36, 11
s_add_u32 s43, s35, 1
s_and_b32 s43, s43, 15
s_lshl_b32 s43, s43, 14
s_add_u32 s30, s43, s54
s_add_u32 s43, s35, 2
s_and_b32 s43, s43, 15
s_lshl_b32 s43, s43, 14
s_add_u32 s31, s43, s54
s_cmp_eq_u32 s51, 1
s_cbranch_scc1 Lp_105
s_cmp_eq_u32 s51, 2
s_cbranch_scc1 Lp_106
.p2align 3
Lp_104:
s_add_u32 s42, s35, 2
s_waitcnt vmcnt(0)
s_barrier
ds_write_b128 v27, v[68:71] offset:0
ds_write_b128 v27, v[116:119] offset:512
s_waitcnt lgkmcnt(0)
s_barrier
s_add_u32 m0, s54, 16384
s_add_u32 s43, s30, 0
buffer_load_dwordx4 v21, s[12:15], s43 offen sc1 lds
s_add_u32 m0, s54, 17408
s_add_u32 s43, s30, 1024
buffer_load_dwordx4 v21, s[12:15], s43 offen sc1 lds
s_add_u32 m0, s54, 32768
s_add_u32 s43, s31, 0
buffer_load_dwordx4 v21, s[12:15], s43 offen sc1 lds
s_add_u32 m0, s54, 33792
s_add_u32 s43, s31, 1024
buffer_load_dwordx4 v21, s[12:15], s43 offen sc1 lds
s_add_u32 s42, s42, 1
s_and_b32 s42, s42, 15
s_add_u32 m0, s39, 49152
s_lshl_b32 s37, s42, 14
buffer_load_dwordx4 v23, s[8:11], s37 offen sc1 lds
s_add_u32 m0, s39, 50176
s_add_u32 s37, s37, s38
buffer_load_dwordx4 v23, s[8:11], s37 offen sc1 lds
s_add_u32 m0, s39, 51200
s_add_u32 s37, s37, s38
buffer_load_dwordx4 v23, s[8:11], s37 offen sc1 lds
s_add_u32 m0, s39, 52224
s_add_u32 s37, s37, s38
buffer_load_dwordx4 v23, s[8:11], s37 offen sc1 lds
s_add_u32 m0, s39, 53248
s_add_u32 s37, s37, s38
buffer_load_dwordx4 v23, s[8:11], s37 offen sc1 lds
s_add_u32 m0, s39, 54272
s_add_u32 s37, s37, s38
buffer_load_dwordx4 v23, s[8:11], s37 offen sc1 lds
s_add_u32 m0, s39, 55296
s_add_u32 s37, s37, s38
buffer_load_dwordx4 v23, s[8:11], s37 offen sc1 lds
s_add_u32 m0, s39, 56320
s_add_u32 s37, s37, s38
buffer_load_dwordx4 v23, s[8:11], s37 offen sc1 lds
s_waitcnt vmcnt(10)
s_barrier
s_add_u32 s42, s42, 1
s_and_b32 s42, s42, 15
s_add_u32 m0, s39, 0
s_lshl_b32 s37, s42, 14
buffer_load_dwordx4 v23, s[8:11], s37 offen sc1 lds
s_add_u32 m0, s39, 1024
s_add_u32 s37, s37, s38
buffer_load_dwordx4 v23, s[8:11], s37 offen sc1 lds
s_add_u32 m0, s39, 2048
s_add_u32 s37, s37, s38
buffer_load_dwordx4 v23, s[8:11], s37 offen sc1 lds
s_add_u32 m0, s39, 3072
s_add_u32 s37, s37, s38
buffer_load_dwordx4 v23, s[8:11], s37 offen sc1 lds
s_add_u32 m0, s39, 4096
s_add_u32 s37, s37, s38
buffer_load_dwordx4 v23, s[8:11], s37 offen sc1 lds
s_add_u32 m0, s39, 5120
s_add_u32 s37, s37, s38
buffer_load_dwordx4 v23, s[8:11], s37 offen sc1 lds
s_add_u32 m0, s39, 6144
s_add_u32 s37, s37, s38
buffer_load_dwordx4 v23, s[8:11], s37 offen sc1 lds
s_add_u32 m0, s39, 7168
s_add_u32 s37, s37, s38
buffer_load_dwordx4 v23, s[8:11], s37 offen sc1 lds
s_waitcnt vmcnt(16)
s_barrier
s_add_u32 s42, s42, 1
s_and_b32 s42, s42, 15
s_add_u32 m0, s39, 16384
s_lshl_b32 s37, s42, 14
buffer_load_dwordx4 v23, s[8:11], s37 offen sc1 lds
s_add_u32 m0, s39, 17408
s_add_u32 s37, s37, s38
buffer_load_dwordx4 v23, s[8:11], s37 offen sc1 lds
s_add_u32 m0, s39, 18432
s_add_u32 s37, s37, s38
buffer_load_dwordx4 v23, s[8:11], s37 offen sc1 lds
s_add_u32 m0, s39, 19456
s_add_u32 s37, s37, s38
buffer_load_dwordx4 v23, s[8:11], s37 offen sc1 lds
s_add_u32 m0, s39, 20480
s_add_u32 s37, s37, s38
buffer_load_dwordx4 v23, s[8:11], s37 offen sc1 lds
s_add_u32 m0, s39, 21504
s_add_u32 s37, s37, s38
buffer_load_dwordx4 v23, s[8:11], s37 offen sc1 lds
s_add_u32 m0, s39, 22528
s_add_u32 s37, s37, s38
buffer_load_dwordx4 v23, s[8:11], s37 offen sc1 lds
s_add_u32 m0, s39, 23552
s_add_u32 s37, s37, s38
buffer_load_dwordx4 v23, s[8:11], s37 offen sc1 lds
s_waitcnt vmcnt(16)
s_barrier
s_add_u32 s42, s42, 1
s_and_b32 s42, s42, 15
s_add_u32 m0, s39, 32768
s_lshl_b32 s37, s42, 14
buffer_load_dwordx4 v23, s[8:11], s37 offen sc1 lds
s_add_u32 m0, s39, 33792
s_add_u32 s37, s37, s38
buffer_load_dwordx4 v23, s[8:11], s37 offen sc1 lds
s_add_u32 m0, s39, 34816
s_add_u32 s37, s37, s38
buffer_load_dwordx4 v23, s[8:11], s37 offen sc1 lds
s_add_u32 m0, s39, 35840
s_add_u32 s37, s37, s38
buffer_load_dwordx4 v23, s[8:11], s37 offen sc1 lds
s_add_u32 m0, s39, 36864
s_add_u32 s37, s37, s38
buffer_load_dwordx4 v23, s[8:11], s37 offen sc1 lds
s_add_u32 m0, s39, 37888
s_add_u32 s37, s37, s38
buffer_load_dwordx4 v23, s[8:11], s37 offen sc1 lds
s_add_u32 m0, s39, 38912
s_add_u32 s37, s37, s38
buffer_load_dwordx4 v23, s[8:11], s37 offen sc1 lds
s_add_u32 m0, s39, 39936
s_add_u32 s37, s37, s38
buffer_load_dwordx4 v23, s[8:11], s37 offen sc1 lds
s_waitcnt vmcnt(16)
s_barrier
s_add_u32 s42, s42, 1
s_and_b32 s42, s42, 15
s_add_u32 m0, s39, 49152
s_lshl_b32 s37, s42, 14
buffer_load_dwordx4 v23, s[8:11], s37 offen sc1 lds
s_add_u32 m0, s39, 50176
s_add_u32 s37, s37, s38
buffer_load_dwordx4 v23, s[8:11], s37 offen sc1 lds
s_add_u32 m0, s39, 51200
s_add_u32 s37, s37, s38
buffer_load_dwordx4 v23, s[8:11], s37 offen sc1 lds
s_add_u32 m0, s39, 52224
s_add_u32 s37, s37, s38
buffer_load_dwordx4 v23, s[8:11], s37 offen sc1 lds
s_add_u32 m0, s39, 53248
s_add_u32 s37, s37, s38
buffer_load_dwordx4 v23, s[8:11], s37 offen sc1 lds
s_add_u32 m0, s39, 54272
s_add_u32 s37, s37, s38
buffer_load_dwordx4 v23, s[8:11], s37 offen sc1 lds
s_add_u32 m0, s39, 55296
s_add_u32 s37, s37, s38
buffer_load_dwordx4 v23, s[8:11], s37 offen sc1 lds
s_add_u32 m0, s39, 56320
s_add_u32 s37, s37, s38
buffer_load_dwordx4 v23, s[8:11], s37 offen sc1 lds
s_waitcnt vmcnt(16)
s_barrier
s_add_u32 s42, s42, 1
s_and_b32 s42, s42, 15
s_add_u32 m0, s39, 0
s_lshl_b32 s37, s42, 14
buffer_load_dwordx4 v23, s[8:11], s37 offen sc1 lds
s_add_u32 m0, s39, 1024
s_add_u32 s37, s37, s38
buffer_load_dwordx4 v23, s[8:11], s37 offen sc1 lds
s_add_u32 m0, s39, 2048
s_add_u32 s37, s37, s38
buffer_load_dwordx4 v23, s[8:11], s37 offen sc1 lds
s_add_u32 m0, s39, 3072
s_add_u32 s37, s37, s38
buffer_load_dwordx4 v23, s[8:11], s37 offen sc1 lds
s_add_u32 m0, s39, 4096
s_add_u32 s37, s37, s38
buffer_load_dwordx4 v23, s[8:11], s37 offen sc1 lds
s_add_u32 m0, s39, 5120
s_add_u32 s37, s37, s38
buffer_load_dwordx4 v23, s[8:11], s37 offen sc1 lds
s_add_u32 m0, s39, 6144
s_add_u32 s37, s37, s38
buffer_load_dwordx4 v23, s[8:11], s37 offen sc1 lds
s_add_u32 m0, s39, 7168
s_add_u32 s37, s37, s38
buffer_load_dwordx4 v23, s[8:11], s37 offen sc1 lds
s_waitcnt vmcnt(16)
s_barrier
s_add_u32 s42, s42, 1
s_and_b32 s42, s42, 15
s_add_u32 m0, s39, 16384
s_lshl_b32 s37, s42, 14
buffer_load_dwordx4 v23, s[8:11], s37 offen sc1 lds
s_add_u32 m0, s39, 17408
s_add_u32 s37, s37, s38
buffer_load_dwordx4 v23, s[8:11], s37 offen sc1 lds
s_add_u32 m0, s39, 18432
s_add_u32 s37, s37, s38
buffer_load_dwordx4 v23, s[8:11], s37 offen sc1 lds
s_add_u32 m0, s39, 19456
s_add_u32 s37, s37, s38
buffer_load_dwordx4 v23, s[8:11], s37 offen sc1 lds
s_add_u32 m0, s39, 20480
s_add_u32 s37, s37, s38
buffer_load_dwordx4 v23, s[8:11], s37 offen sc1 lds
s_add_u32 m0, s39, 21504
s_add_u32 s37, s37, s38
buffer_load_dwordx4 v23, s[8:11], s37 offen sc1 lds
s_add_u32 m0, s39, 22528
s_add_u32 s37, s37, s38
buffer_load_dwordx4 v23, s[8:11], s37 offen sc1 lds
s_add_u32 m0, s39, 23552
s_add_u32 s37, s37, s38
buffer_load_dwordx4 v23, s[8:11], s37 offen sc1 lds
s_waitcnt vmcnt(16)
s_barrier
s_add_u32 s42, s42, 1
s_and_b32 s42, s42, 15
s_add_u32 m0, s39, 32768
s_lshl_b32 s37, s42, 14
buffer_load_dwordx4 v23, s[8:11], s37 offen sc1 lds
s_add_u32 m0, s39, 33792
s_add_u32 s37, s37, s38
buffer_load_dwordx4 v23, s[8:11], s37 offen sc1 lds
s_add_u32 m0, s39, 34816
s_add_u32 s37, s37, s38
buffer_load_dwordx4 v23, s[8:11], s37 offen sc1 lds
s_add_u32 m0, s39, 35840
s_add_u32 s37, s37, s38
buffer_load_dwordx4 v23, s[8:11], s37 offen sc1 lds
s_add_u32 m0, s39, 36864
s_add_u32 s37, s37, s38
buffer_load_dwordx4 v23, s[8:11], s37 offen sc1 lds
s_add_u32 m0, s39, 37888
s_add_u32 s37, s37, s38
buffer_load_dwordx4 v23, s[8:11], s37 offen sc1 lds
s_add_u32 m0, s39, 38912
s_add_u32 s37, s37, s38
buffer_load_dwordx4 v23, s[8:11], s37 offen sc1 lds
s_add_u32 m0, s39, 39936
s_add_u32 s37, s37, s38
buffer_load_dwordx4 v23, s[8:11], s37 offen sc1 lds
s_waitcnt vmcnt(16)
s_barrier
s_add_u32 s42, s42, 1
s_and_b32 s42, s42, 15
s_add_u32 m0, s39, 49152
s_lshl_b32 s37, s42, 14
buffer_load_dwordx4 v23, s[8:11], s37 offen sc1 lds
s_add_u32 m0, s39, 50176
s_add_u32 s37, s37, s38
buffer_load_dwordx4 v23, s[8:11], s37 offen sc1 lds
s_add_u32 m0, s39, 51200
s_add_u32 s37, s37, s38
buffer_load_dwordx4 v23, s[8:11], s37 offen sc1 lds
s_add_u32 m0, s39, 52224
s_add_u32 s37, s37, s38
buffer_load_dwordx4 v23, s[8:11], s37 offen sc1 lds
s_add_u32 m0, s39, 53248
s_add_u32 s37, s37, s38
buffer_load_dwordx4 v23, s[8:11], s37 offen sc1 lds
s_add_u32 m0, s39, 54272
s_add_u32 s37, s37, s38
buffer_load_dwordx4 v23, s[8:11], s37 offen sc1 lds
s_add_u32 m0, s39, 55296
s_add_u32 s37, s37, s38
buffer_load_dwordx4 v23, s[8:11], s37 offen sc1 lds
s_add_u32 m0, s39, 56320
s_add_u32 s37, s37, s38
buffer_load_dwordx4 v23, s[8:11], s37 offen sc1 lds
s_waitcnt vmcnt(16)
s_barrier
s_add_u32 s42, s42, 1
s_and_b32 s42, s42, 15
s_add_u32 m0, s39, 0
s_lshl_b32 s37, s42, 14
buffer_load_dwordx4 v23, s[8:11], s37 offen sc1 lds
s_add_u32 m0, s39, 1024
s_add_u32 s37, s37, s38
buffer_load_dwordx4 v23, s[8:11], s37 offen sc1 lds
s_add_u32 m0, s39, 2048
s_add_u32 s37, s37, s38
buffer_load_dwordx4 v23, s[8:11], s37 offen sc1 lds
s_add_u32 m0, s39, 3072
s_add_u32 s37, s37, s38
buffer_load_dwordx4 v23, s[8:11], s37 offen sc1 lds
s_add_u32 m0, s39, 4096
s_add_u32 s37, s37, s38
buffer_load_dwordx4 v23, s[8:11], s37 offen sc1 lds
s_add_u32 m0, s39, 5120
s_add_u32 s37, s37, s38
buffer_load_dwordx4 v23, s[8:11], s37 offen sc1 lds
s_add_u32 m0, s39, 6144
s_add_u32 s37, s37, s38
buffer_load_dwordx4 v23, s[8:11], s37 offen sc1 lds
s_add_u32 m0, s39, 7168
s_add_u32 s37, s37, s38
buffer_load_dwordx4 v23, s[8:11], s37 offen sc1 lds
s_waitcnt vmcnt(16)
s_barrier
s_add_u32 s42, s42, 1
s_and_b32 s42, s42, 15
s_add_u32 m0, s39, 16384
s_lshl_b32 s37, s42, 14
buffer_load_dwordx4 v23, s[8:11], s37 offen sc1 lds
s_add_u32 m0, s39, 17408
s_add_u32 s37, s37, s38
buffer_load_dwordx4 v23, s[8:11], s37 offen sc1 lds
s_add_u32 m0, s39, 18432
s_add_u32 s37, s37, s38
buffer_load_dwordx4 v23, s[8:11], s37 offen sc1 lds
s_add_u32 m0, s39, 19456
s_add_u32 s37, s37, s38
buffer_load_dwordx4 v23, s[8:11], s37 offen sc1 lds
s_add_u32 m0, s39, 20480
s_add_u32 s37, s37, s38
buffer_load_dwordx4 v23, s[8:11], s37 offen sc1 lds
s_add_u32 m0, s39, 21504
s_add_u32 s37, s37, s38
buffer_load_dwordx4 v23, s[8:11], s37 offen sc1 lds
s_add_u32 m0, s39, 22528
s_add_u32 s37, s37, s38
buffer_load_dwordx4 v23, s[8:11], s37 offen sc1 lds
s_add_u32 m0, s39, 23552
s_add_u32 s37, s37, s38
buffer_load_dwordx4 v23, s[8:11], s37 offen sc1 lds
s_waitcnt vmcnt(16)
s_barrier
s_add_u32 s42, s42, 1
s_and_b32 s42, s42, 15
s_add_u32 m0, s39, 32768
s_lshl_b32 s37, s42, 14
buffer_load_dwordx4 v23, s[8:11], s37 offen sc1 lds
s_add_u32 m0, s39, 33792
s_add_u32 s37, s37, s38
buffer_load_dwordx4 v23, s[8:11], s37 offen sc1 lds
s_add_u32 m0, s39, 34816
s_add_u32 s37, s37, s38
buffer_load_dwordx4 v23, s[8:11], s37 offen sc1 lds
s_add_u32 m0, s39, 35840
s_add_u32 s37, s37, s38
buffer_load_dwordx4 v23, s[8:11], s37 offen sc1 lds
s_add_u32 m0, s39, 36864
s_add_u32 s37, s37, s38
buffer_load_dwordx4 v23, s[8:11], s37 offen sc1 lds
s_add_u32 m0, s39, 37888
s_add_u32 s37, s37, s38
buffer_load_dwordx4 v23, s[8:11], s37 offen sc1 lds
s_add_u32 m0, s39, 38912
s_add_u32 s37, s37, s38
buffer_load_dwordx4 v23, s[8:11], s37 offen sc1 lds
s_add_u32 m0, s39, 39936
s_add_u32 s37, s37, s38
buffer_load_dwordx4 v23, s[8:11], s37 offen sc1 lds
s_waitcnt vmcnt(16)
s_barrier
s_add_u32 s42, s42, 1
s_and_b32 s42, s42, 15
s_add_u32 m0, s39, 49152
s_lshl_b32 s37, s42, 14
buffer_load_dwordx4 v23, s[8:11], s37 offen sc1 lds
s_add_u32 m0, s39, 50176
s_add_u32 s37, s37, s38
buffer_load_dwordx4 v23, s[8:11], s37 offen sc1 lds
s_add_u32 m0, s39, 51200
s_add_u32 s37, s37, s38
buffer_load_dwordx4 v23, s[8:11], s37 offen sc1 lds
s_add_u32 m0, s39, 52224
s_add_u32 s37, s37, s38
buffer_load_dwordx4 v23, s[8:11], s37 offen sc1 lds
s_add_u32 m0, s39, 53248
s_add_u32 s37, s37, s38
buffer_load_dwordx4 v23, s[8:11], s37 offen sc1 lds
s_add_u32 m0, s39, 54272
s_add_u32 s37, s37, s38
buffer_load_dwordx4 v23, s[8:11], s37 offen sc1 lds
s_add_u32 m0, s39, 55296
s_add_u32 s37, s37, s38
buffer_load_dwordx4 v23, s[8:11], s37 offen sc1 lds
s_add_u32 m0, s39, 56320
s_add_u32 s37, s37, s38
buffer_load_dwordx4 v23, s[8:11], s37 offen sc1 lds
s_lshl_b32 s43, s35, 8
s_cmp_eq_u32 s51, 1
s_cselect_b32 s8, s4, s6
s_cselect_b32 s9, s5, s7
s_sub_u32 s10, 7340032, s43
s_lshl_b32 s44, s34, 18
s_add_u32 s44, s44, 4194304
s_movk_i32 s38, 28672
s_cmp_eq_u32 s51, 0
s_cselect_b32 s8, s32, s8
s_cselect_b32 s9, s33, s9
s_cselect_b32 s10, 262144, s10
s_cselect_b32 s43, s44, s43
s_cselect_b32 s38, 1024, s38
s_cselect_b32 s45, 0, -1
s_add_u32 s8, s8, s43
s_addc_u32 s9, s9, 0
s_mov_b32 s11, 0x20000
s_lshl_b32 s40, s38, 4
s_add_u32 s42, s35, 15
s_lshl_b32 s39, s51, 14
v_lshrrev_b32 v19, 4, v1
v_lshlrev_b32 v20, 5, v19
v_mul_u32_u24 v19, 6912, v19
v_and_b32 v19, s45, v19
v_and_b32 v20, s45, v20
v_lshlrev_b32 v21, 4, v1
v_xor_b32 v21, v21, v20
v_add_u32 v22, v21, v19
s_and_b32 s45, s45, 128
v_xor_b32 v23, s45, v22
s_waitcnt vmcnt(16)
s_barrier
s_waitcnt vmcnt(8)
s_barrier
s_waitcnt vmcnt(0)
s_barrier
s_barrier
s_barrier
s_add_u32 s43, s34, 16
s_lshl_b32 s43, s43, 7
v_mov_b32 v8, s43
v_mov_b32 v10, 16
buffer_load_dword v9, v8, s[56:59], 0 offen sc1
s_waitcnt vmcnt(0)
s_add_u32 s43, s34, 16
s_lshl_b32 s43, s43, 7
v_mov_b32 v8, s43
v_mov_b32 v10, 16
buffer_load_dword v9, v8, s[56:59], 0 offen sc1
s_waitcnt vmcnt(0)
s_add_u32 s42, s42, 1
s_add_u32 s42, s42, 1
s_and_b32 s42, s42, 15
s_add_u32 m0, s39, 0
s_mul_i32 s37, s42, s40
buffer_load_dwordx4 v22, s[8:11], s37 offen sc1 lds
s_add_u32 m0, s39, 1024
s_add_u32 s37, s37, s38
buffer_load_dwordx4 v23, s[8:11], s37 offen sc1 lds
s_add_u32 m0, s39, 2048
s_add_u32 s37, s37, s38
buffer_load_dwordx4 v22, s[8:11], s37 offen sc1 lds
s_add_u32 m0, s39, 3072
s_add_u32 s37, s37, s38
buffer_load_dwordx4 v23, s[8:11], s37 offen sc1 lds
s_add_u32 m0, s39, 4096
s_add_u32 s37, s37, s38
buffer_load_dwordx4 v22, s[8:11], s37 offen sc1 lds
s_add_u32 m0, s39, 5120
s_add_u32 s37, s37, s38
buffer_load_dwordx4 v23, s[8:11], s37 offen sc1 lds
s_add_u32 m0, s39, 6144
s_add_u32 s37, s37, s38
buffer_load_dwordx4 v22, s[8:11], s37 offen sc1 lds
s_add_u32 m0, s39, 7168
s_add_u32 s37, s37, s38
buffer_load_dwordx4 v23, s[8:11], s37 offen sc1 lds
s_add_u32 m0, s39, 8192
s_add_u32 s37, s37, s38
buffer_load_dwordx4 v22, s[8:11], s37 offen sc1 lds
s_add_u32 m0, s39, 9216
s_add_u32 s37, s37, s38
buffer_load_dwordx4 v23, s[8:11], s37 offen sc1 lds
s_add_u32 m0, s39, 10240
s_add_u32 s37, s37, s38
buffer_load_dwordx4 v22, s[8:11], s37 offen sc1 lds
s_add_u32 m0, s39, 11264
s_add_u32 s37, s37, s38
buffer_load_dwordx4 v23, s[8:11], s37 offen sc1 lds
s_add_u32 m0, s39, 12288
s_add_u32 s37, s37, s38
buffer_load_dwordx4 v22, s[8:11], s37 offen sc1 lds
s_add_u32 m0, s39, 13312
s_add_u32 s37, s37, s38
buffer_load_dwordx4 v23, s[8:11], s37 offen sc1 lds
s_add_u32 m0, s39, 14336
s_add_u32 s37, s37, s38
buffer_load_dwordx4 v22, s[8:11], s37 offen sc1 lds
s_add_u32 m0, s39, 15360
s_add_u32 s37, s37, s38
buffer_load_dwordx4 v23, s[8:11], s37 offen sc1 lds
s_add_u32 s42, s42, 1
s_and_b32 s42, s42, 15
s_add_u32 m0, s39, 49152
s_mul_i32 s37, s42, s40
buffer_load_dwordx4 v22, s[8:11], s37 offen sc1 lds
s_add_u32 m0, s39, 50176
s_add_u32 s37, s37, s38
buffer_load_dwordx4 v23, s[8:11], s37 offen sc1 lds
s_add_u32 m0, s39, 51200
s_add_u32 s37, s37, s38
buffer_load_dwordx4 v22, s[8:11], s37 offen sc1 lds
s_add_u32 m0, s39, 52224
s_add_u32 s37, s37, s38
buffer_load_dwordx4 v23, s[8:11], s37 offen sc1 lds
s_add_u32 m0, s39, 53248
s_add_u32 s37, s37, s38
buffer_load_dwordx4 v22, s[8:11], s37 offen sc1 lds
s_add_u32 m0, s39, 54272
s_add_u32 s37, s37, s38
buffer_load_dwordx4 v23, s[8:11], s37 offen sc1 lds
s_add_u32 m0, s39, 55296
s_add_u32 s37, s37, s38
buffer_load_dwordx4 v22, s[8:11], s37 offen sc1 lds
s_add_u32 m0, s39, 56320
s_add_u32 s37, s37, s38
buffer_load_dwordx4 v23, s[8:11], s37 offen sc1 lds
s_add_u32 m0, s39, 57344
s_add_u32 s37, s37, s38
buffer_load_dwordx4 v22, s[8:11], s37 offen sc1 lds
s_add_u32 m0, s39, 58368
s_add_u32 s37, s37, s38
buffer_load_dwordx4 v23, s[8:11], s37 offen sc1 lds
s_add_u32 m0, s39, 59392
s_add_u32 s37, s37, s38
buffer_load_dwordx4 v22, s[8:11], s37 offen sc1 lds
s_add_u32 m0, s39, 60416
s_add_u32 s37, s37, s38
buffer_load_dwordx4 v23, s[8:11], s37 offen sc1 lds
s_add_u32 m0, s39, 61440
s_add_u32 s37, s37, s38
buffer_load_dwordx4 v22, s[8:11], s37 offen sc1 lds
s_add_u32 m0, s39, 62464
s_add_u32 s37, s37, s38
buffer_load_dwordx4 v23, s[8:11], s37 offen sc1 lds
s_add_u32 m0, s39, 63488
s_add_u32 s37, s37, s38
buffer_load_dwordx4 v22, s[8:11], s37 offen sc1 lds
s_add_u32 m0, s39, 64512
s_add_u32 s37, s37, s38
buffer_load_dwordx4 v23, s[8:11], s37 offen sc1 lds
s_branch LP3_103
.p2align 6
Lw_17:
s_branch Lr_18
s_nop 0
.p2align 3
Lp_105:
s_add_u32 s42, s35, 2
s_waitcnt vmcnt(0)
s_barrier
s_add_u32 s43, s34, 0
s_lshl_b32 s43, s43, 7
v_mov_b32 v13, s43
v_mov_b32 v14, 1
s_mov_b64 exec, 1
buffer_atomic_add v14, v13, s[56:59], 0 offen sc1
s_mov_b64 exec, -1
ds_write_b128 v27, v[68:71] offset:0
ds_write_b128 v27, v[116:119] offset:512
s_waitcnt lgkmcnt(0)
s_barrier
s_add_u32 m0, s54, 16384
s_add_u32 s43, s30, 0
buffer_load_dwordx4 v21, s[12:15], s43 offen sc1 lds
s_add_u32 m0, s54, 17408
s_add_u32 s43, s30, 1024
buffer_load_dwordx4 v21, s[12:15], s43 offen sc1 lds
s_add_u32 m0, s54, 32768
s_add_u32 s43, s31, 0
buffer_load_dwordx4 v21, s[12:15], s43 offen sc1 lds
s_add_u32 m0, s54, 33792
s_add_u32 s43, s31, 1024
buffer_load_dwordx4 v21, s[12:15], s43 offen sc1 lds
s_add_u32 s42, s42, 1
s_and_b32 s42, s42, 15
s_add_u32 m0, s39, 49152
s_lshl_b32 s37, s42, 14
buffer_load_dwordx4 v23, s[8:11], s37 offen sc1 lds
s_add_u32 m0, s39, 50176
s_add_u32 s37, s37, s38
buffer_load_dwordx4 v23, s[8:11], s37 offen sc1 lds
s_add_u32 m0, s39, 51200
s_add_u32 s37, s37, s38
buffer_load_dwordx4 v23, s[8:11], s37 offen sc1 lds
s_add_u32 m0, s39, 52224
s_add_u32 s37, s37, s38
buffer_load_dwordx4 v23, s[8:11], s37 offen sc1 lds
s_add_u32 m0, s39, 53248
s_add_u32 s37, s37, s38
buffer_load_dwordx4 v23, s[8:11], s37 offen sc1 lds
s_add_u32 m0, s39, 54272
s_add_u32 s37, s37, s38
buffer_load_dwordx4 v23, s[8:11], s37 offen sc1 lds
s_add_u32 m0, s39, 55296
s_add_u32 s37, s37, s38
buffer_load_dwordx4 v23, s[8:11], s37 offen sc1 lds
s_add_u32 m0, s39, 56320
s_add_u32 s37, s37, s38
buffer_load_dwordx4 v23, s[8:11], s37 offen sc1 lds
s_waitcnt vmcnt(10)
s_barrier
s_add_u32 s42, s42, 1
s_and_b32 s42, s42, 15
s_add_u32 m0, s39, 0
s_lshl_b32 s37, s42, 14
buffer_load_dwordx4 v23, s[8:11], s37 offen sc1 lds
s_add_u32 m0, s39, 1024
s_add_u32 s37, s37, s38
buffer_load_dwordx4 v23, s[8:11], s37 offen sc1 lds
s_add_u32 m0, s39, 2048
s_add_u32 s37, s37, s38
buffer_load_dwordx4 v23, s[8:11], s37 offen sc1 lds
s_add_u32 m0, s39, 3072
s_add_u32 s37, s37, s38
buffer_load_dwordx4 v23, s[8:11], s37 offen sc1 lds
s_add_u32 m0, s39, 4096
s_add_u32 s37, s37, s38
buffer_load_dwordx4 v23, s[8:11], s37 offen sc1 lds
s_add_u32 m0, s39, 5120
s_add_u32 s37, s37, s38
buffer_load_dwordx4 v23, s[8:11], s37 offen sc1 lds
s_add_u32 m0, s39, 6144
s_add_u32 s37, s37, s38
buffer_load_dwordx4 v23, s[8:11], s37 offen sc1 lds
s_add_u32 m0, s39, 7168
s_add_u32 s37, s37, s38
buffer_load_dwordx4 v23, s[8:11], s37 offen sc1 lds
s_waitcnt vmcnt(16)
s_barrier
s_add_u32 s42, s42, 1
s_and_b32 s42, s42, 15
s_add_u32 m0, s39, 16384
s_lshl_b32 s37, s42, 14
buffer_load_dwordx4 v23, s[8:11], s37 offen sc1 lds
s_add_u32 m0, s39, 17408
s_add_u32 s37, s37, s38
buffer_load_dwordx4 v23, s[8:11], s37 offen sc1 lds
s_add_u32 m0, s39, 18432
s_add_u32 s37, s37, s38
buffer_load_dwordx4 v23, s[8:11], s37 offen sc1 lds
s_add_u32 m0, s39, 19456
s_add_u32 s37, s37, s38
buffer_load_dwordx4 v23, s[8:11], s37 offen sc1 lds
s_add_u32 m0, s39, 20480
s_add_u32 s37, s37, s38
buffer_load_dwordx4 v23, s[8:11], s37 offen sc1 lds
s_add_u32 m0, s39, 21504
s_add_u32 s37, s37, s38
buffer_load_dwordx4 v23, s[8:11], s37 offen sc1 lds
s_add_u32 m0, s39, 22528
s_add_u32 s37, s37, s38
buffer_load_dwordx4 v23, s[8:11], s37 offen sc1 lds
s_add_u32 m0, s39, 23552
s_add_u32 s37, s37, s38
buffer_load_dwordx4 v23, s[8:11], s37 offen sc1 lds
s_waitcnt vmcnt(16)
s_barrier
s_add_u32 s42, s42, 1
s_and_b32 s42, s42, 15
s_add_u32 m0, s39, 32768
s_lshl_b32 s37, s42, 14
buffer_load_dwordx4 v23, s[8:11], s37 offen sc1 lds
s_add_u32 m0, s39, 33792
s_add_u32 s37, s37, s38
buffer_load_dwordx4 v23, s[8:11], s37 offen sc1 lds
s_add_u32 m0, s39, 34816
s_add_u32 s37, s37, s38
buffer_load_dwordx4 v23, s[8:11], s37 offen sc1 lds
s_add_u32 m0, s39, 35840
s_add_u32 s37, s37, s38
buffer_load_dwordx4 v23, s[8:11], s37 offen sc1 lds
s_add_u32 m0, s39, 36864
s_add_u32 s37, s37, s38
buffer_load_dwordx4 v23, s[8:11], s37 offen sc1 lds
s_add_u32 m0, s39, 37888
s_add_u32 s37, s37, s38
buffer_load_dwordx4 v23, s[8:11], s37 offen sc1 lds
s_add_u32 m0, s39, 38912
s_add_u32 s37, s37, s38
buffer_load_dwordx4 v23, s[8:11], s37 offen sc1 lds
s_add_u32 m0, s39, 39936
s_add_u32 s37, s37, s38
buffer_load_dwordx4 v23, s[8:11], s37 offen sc1 lds
s_waitcnt vmcnt(16)
s_barrier
s_add_u32 s42, s42, 1
s_and_b32 s42, s42, 15
s_add_u32 m0, s39, 49152
s_lshl_b32 s37, s42, 14
buffer_load_dwordx4 v23, s[8:11], s37 offen sc1 lds
s_add_u32 m0, s39, 50176
s_add_u32 s37, s37, s38
buffer_load_dwordx4 v23, s[8:11], s37 offen sc1 lds
s_add_u32 m0, s39, 51200
s_add_u32 s37, s37, s38
buffer_load_dwordx4 v23, s[8:11], s37 offen sc1 lds
s_add_u32 m0, s39, 52224
s_add_u32 s37, s37, s38
buffer_load_dwordx4 v23, s[8:11], s37 offen sc1 lds
s_add_u32 m0, s39, 53248
s_add_u32 s37, s37, s38
buffer_load_dwordx4 v23, s[8:11], s37 offen sc1 lds
s_add_u32 m0, s39, 54272
s_add_u32 s37, s37, s38
buffer_load_dwordx4 v23, s[8:11], s37 offen sc1 lds
s_add_u32 m0, s39, 55296
s_add_u32 s37, s37, s38
buffer_load_dwordx4 v23, s[8:11], s37 offen sc1 lds
s_add_u32 m0, s39, 56320
s_add_u32 s37, s37, s38
buffer_load_dwordx4 v23, s[8:11], s37 offen sc1 lds
s_waitcnt vmcnt(16)
s_barrier
s_add_u32 s42, s42, 1
s_and_b32 s42, s42, 15
s_add_u32 m0, s39, 0
s_lshl_b32 s37, s42, 14
buffer_load_dwordx4 v23, s[8:11], s37 offen sc1 lds
s_add_u32 m0, s39, 1024
s_add_u32 s37, s37, s38
buffer_load_dwordx4 v23, s[8:11], s37 offen sc1 lds
s_add_u32 m0, s39, 2048
s_add_u32 s37, s37, s38
buffer_load_dwordx4 v23, s[8:11], s37 offen sc1 lds
s_add_u32 m0, s39, 3072
s_add_u32 s37, s37, s38
buffer_load_dwordx4 v23, s[8:11], s37 offen sc1 lds
s_add_u32 m0, s39, 4096
s_add_u32 s37, s37, s38
buffer_load_dwordx4 v23, s[8:11], s37 offen sc1 lds
s_add_u32 m0, s39, 5120
s_add_u32 s37, s37, s38
buffer_load_dwordx4 v23, s[8:11], s37 offen sc1 lds
s_add_u32 m0, s39, 6144
s_add_u32 s37, s37, s38
buffer_load_dwordx4 v23, s[8:11], s37 offen sc1 lds
s_add_u32 m0, s39, 7168
s_add_u32 s37, s37, s38
buffer_load_dwordx4 v23, s[8:11], s37 offen sc1 lds
s_waitcnt vmcnt(16)
s_barrier
s_add_u32 s42, s42, 1
s_and_b32 s42, s42, 15
s_add_u32 m0, s39, 16384
s_lshl_b32 s37, s42, 14
buffer_load_dwordx4 v23, s[8:11], s37 offen sc1 lds
s_add_u32 m0, s39, 17408
s_add_u32 s37, s37, s38
buffer_load_dwordx4 v23, s[8:11], s37 offen sc1 lds
s_add_u32 m0, s39, 18432
s_add_u32 s37, s37, s38
buffer_load_dwordx4 v23, s[8:11], s37 offen sc1 lds
s_add_u32 m0, s39, 19456
s_add_u32 s37, s37, s38
buffer_load_dwordx4 v23, s[8:11], s37 offen sc1 lds
s_add_u32 m0, s39, 20480
s_add_u32 s37, s37, s38
buffer_load_dwordx4 v23, s[8:11], s37 offen sc1 lds
s_add_u32 m0, s39, 21504
s_add_u32 s37, s37, s38
buffer_load_dwordx4 v23, s[8:11], s37 offen sc1 lds
s_add_u32 m0, s39, 22528
s_add_u32 s37, s37, s38
buffer_load_dwordx4 v23, s[8:11], s37 offen sc1 lds
s_add_u32 m0, s39, 23552
s_add_u32 s37, s37, s38
buffer_load_dwordx4 v23, s[8:11], s37 offen sc1 lds
s_waitcnt vmcnt(16)
s_barrier
s_add_u32 s42, s42, 1
s_and_b32 s42, s42, 15
s_add_u32 m0, s39, 32768
s_lshl_b32 s37, s42, 14
buffer_load_dwordx4 v23, s[8:11], s37 offen sc1 lds
s_add_u32 m0, s39, 33792
s_add_u32 s37, s37, s38
buffer_load_dwordx4 v23, s[8:11], s37 offen sc1 lds
s_add_u32 m0, s39, 34816
s_add_u32 s37, s37, s38
buffer_load_dwordx4 v23, s[8:11], s37 offen sc1 lds
s_add_u32 m0, s39, 35840
s_add_u32 s37, s37, s38
buffer_load_dwordx4 v23, s[8:11], s37 offen sc1 lds
s_add_u32 m0, s39, 36864
s_add_u32 s37, s37, s38
buffer_load_dwordx4 v23, s[8:11], s37 offen sc1 lds
s_add_u32 m0, s39, 37888
s_add_u32 s37, s37, s38
buffer_load_dwordx4 v23, s[8:11], s37 offen sc1 lds
s_add_u32 m0, s39, 38912
s_add_u32 s37, s37, s38
buffer_load_dwordx4 v23, s[8:11], s37 offen sc1 lds
s_add_u32 m0, s39, 39936
s_add_u32 s37, s37, s38
buffer_load_dwordx4 v23, s[8:11], s37 offen sc1 lds
s_waitcnt vmcnt(16)
s_barrier
s_add_u32 s42, s42, 1
s_and_b32 s42, s42, 15
s_add_u32 m0, s39, 49152
s_lshl_b32 s37, s42, 14
buffer_load_dwordx4 v23, s[8:11], s37 offen sc1 lds
s_add_u32 m0, s39, 50176
s_add_u32 s37, s37, s38
buffer_load_dwordx4 v23, s[8:11], s37 offen sc1 lds
s_add_u32 m0, s39, 51200
s_add_u32 s37, s37, s38
buffer_load_dwordx4 v23, s[8:11], s37 offen sc1 lds
s_add_u32 m0, s39, 52224
s_add_u32 s37, s37, s38
buffer_load_dwordx4 v23, s[8:11], s37 offen sc1 lds
s_add_u32 m0, s39, 53248
s_add_u32 s37, s37, s38
buffer_load_dwordx4 v23, s[8:11], s37 offen sc1 lds
s_add_u32 m0, s39, 54272
s_add_u32 s37, s37, s38
buffer_load_dwordx4 v23, s[8:11], s37 offen sc1 lds
s_add_u32 m0, s39, 55296
s_add_u32 s37, s37, s38
buffer_load_dwordx4 v23, s[8:11], s37 offen sc1 lds
s_add_u32 m0, s39, 56320
s_add_u32 s37, s37, s38
buffer_load_dwordx4 v23, s[8:11], s37 offen sc1 lds
s_waitcnt vmcnt(16)
s_barrier
s_add_u32 s42, s42, 1
s_and_b32 s42, s42, 15
s_add_u32 m0, s39, 0
s_lshl_b32 s37, s42, 14
buffer_load_dwordx4 v23, s[8:11], s37 offen sc1 lds
s_add_u32 m0, s39, 1024
s_add_u32 s37, s37, s38
buffer_load_dwordx4 v23, s[8:11], s37 offen sc1 lds
s_add_u32 m0, s39, 2048
s_add_u32 s37, s37, s38
buffer_load_dwordx4 v23, s[8:11], s37 offen sc1 lds
s_add_u32 m0, s39, 3072
s_add_u32 s37, s37, s38
buffer_load_dwordx4 v23, s[8:11], s37 offen sc1 lds
s_add_u32 m0, s39, 4096
s_add_u32 s37, s37, s38
buffer_load_dwordx4 v23, s[8:11], s37 offen sc1 lds
s_add_u32 m0, s39, 5120
s_add_u32 s37, s37, s38
buffer_load_dwordx4 v23, s[8:11], s37 offen sc1 lds
s_add_u32 m0, s39, 6144
s_add_u32 s37, s37, s38
buffer_load_dwordx4 v23, s[8:11], s37 offen sc1 lds
s_add_u32 m0, s39, 7168
s_add_u32 s37, s37, s38
buffer_load_dwordx4 v23, s[8:11], s37 offen sc1 lds
s_waitcnt vmcnt(16)
s_barrier
s_add_u32 s42, s42, 1
s_and_b32 s42, s42, 15
s_add_u32 m0, s39, 16384
s_lshl_b32 s37, s42, 14
buffer_load_dwordx4 v23, s[8:11], s37 offen sc1 lds
s_add_u32 m0, s39, 17408
s_add_u32 s37, s37, s38
buffer_load_dwordx4 v23, s[8:11], s37 offen sc1 lds
s_add_u32 m0, s39, 18432
s_add_u32 s37, s37, s38
buffer_load_dwordx4 v23, s[8:11], s37 offen sc1 lds
s_add_u32 m0, s39, 19456
s_add_u32 s37, s37, s38
buffer_load_dwordx4 v23, s[8:11], s37 offen sc1 lds
s_add_u32 m0, s39, 20480
s_add_u32 s37, s37, s38
buffer_load_dwordx4 v23, s[8:11], s37 offen sc1 lds
s_add_u32 m0, s39, 21504
s_add_u32 s37, s37, s38
buffer_load_dwordx4 v23, s[8:11], s37 offen sc1 lds
s_add_u32 m0, s39, 22528
s_add_u32 s37, s37, s38
buffer_load_dwordx4 v23, s[8:11], s37 offen sc1 lds
s_add_u32 m0, s39, 23552
s_add_u32 s37, s37, s38
buffer_load_dwordx4 v23, s[8:11], s37 offen sc1 lds
s_waitcnt vmcnt(16)
s_barrier
s_add_u32 s42, s42, 1
s_and_b32 s42, s42, 15
s_add_u32 m0, s39, 32768
s_lshl_b32 s37, s42, 14
buffer_load_dwordx4 v23, s[8:11], s37 offen sc1 lds
s_add_u32 m0, s39, 33792
s_add_u32 s37, s37, s38
buffer_load_dwordx4 v23, s[8:11], s37 offen sc1 lds
s_add_u32 m0, s39, 34816
s_add_u32 s37, s37, s38
buffer_load_dwordx4 v23, s[8:11], s37 offen sc1 lds
s_add_u32 m0, s39, 35840
s_add_u32 s37, s37, s38
buffer_load_dwordx4 v23, s[8:11], s37 offen sc1 lds
s_add_u32 m0, s39, 36864
s_add_u32 s37, s37, s38
buffer_load_dwordx4 v23, s[8:11], s37 offen sc1 lds
s_add_u32 m0, s39, 37888
s_add_u32 s37, s37, s38
buffer_load_dwordx4 v23, s[8:11], s37 offen sc1 lds
s_add_u32 m0, s39, 38912
s_add_u32 s37, s37, s38
buffer_load_dwordx4 v23, s[8:11], s37 offen sc1 lds
s_add_u32 m0, s39, 39936
s_add_u32 s37, s37, s38
buffer_load_dwordx4 v23, s[8:11], s37 offen sc1 lds
s_waitcnt vmcnt(16)
s_barrier
s_add_u32 s42, s42, 1
s_and_b32 s42, s42, 15
s_add_u32 m0, s39, 49152
s_lshl_b32 s37, s42, 14
buffer_load_dwordx4 v23, s[8:11], s37 offen sc1 lds
s_add_u32 m0, s39, 50176
s_add_u32 s37, s37, s38
buffer_load_dwordx4 v23, s[8:11], s37 offen sc1 lds
s_add_u32 m0, s39, 51200
s_add_u32 s37, s37, s38
buffer_load_dwordx4 v23, s[8:11], s37 offen sc1 lds
s_add_u32 m0, s39, 52224
s_add_u32 s37, s37, s38
buffer_load_dwordx4 v23, s[8:11], s37 offen sc1 lds
s_add_u32 m0, s39, 53248
s_add_u32 s37, s37, s38
buffer_load_dwordx4 v23, s[8:11], s37 offen sc1 lds
s_add_u32 m0, s39, 54272
s_add_u32 s37, s37, s38
buffer_load_dwordx4 v23, s[8:11], s37 offen sc1 lds
s_add_u32 m0, s39, 55296
s_add_u32 s37, s37, s38
buffer_load_dwordx4 v23, s[8:11], s37 offen sc1 lds
s_add_u32 m0, s39, 56320
s_add_u32 s37, s37, s38
buffer_load_dwordx4 v23, s[8:11], s37 offen sc1 lds
s_lshl_b32 s43, s35, 8
s_cmp_eq_u32 s51, 1
s_cselect_b32 s8, s4, s6
s_cselect_b32 s9, s5, s7
s_sub_u32 s10, 7340032, s43
s_lshl_b32 s44, s34, 18
s_add_u32 s44, s44, 4194304
s_movk_i32 s38, 28672
s_cmp_eq_u32 s51, 0
s_cselect_b32 s8, s32, s8
s_cselect_b32 s9, s33, s9
s_cselect_b32 s10, 262144, s10
s_cselect_b32 s43, s44, s43
s_cselect_b32 s38, 1024, s38
s_cselect_b32 s45, 0, -1
s_add_u32 s8, s8, s43
s_addc_u32 s9, s9, 0
s_mov_b32 s11, 0x20000
s_lshl_b32 s40, s38, 4
s_add_u32 s42, s35, 15
s_lshl_b32 s39, s51, 14
v_lshrrev_b32 v19, 4, v1
v_lshlrev_b32 v20, 5, v19
v_mul_u32_u24 v19, 6912, v19
v_and_b32 v19, s45, v19
v_and_b32 v20, s45, v20
v_lshlrev_b32 v21, 4, v1
v_xor_b32 v21, v21, v20
v_add_u32 v22, v21, v19
s_and_b32 s45, s45, 128
v_xor_b32 v23, s45, v22
s_waitcnt vmcnt(16)
s_barrier
s_add_u32 s42, s42, 1
s_and_b32 s42, s42, 15
s_add_u32 m0, s39, 98304
s_mul_i32 s37, s42, s40
buffer_load_dwordx4 v22, s[8:11], s37 offen sc1 lds
s_add_u32 m0, s39, 99328
s_add_u32 s37, s37, s38
buffer_load_dwordx4 v23, s[8:11], s37 offen sc1 lds
s_add_u32 m0, s39, 100352
s_add_u32 s37, s37, s38
buffer_load_dwordx4 v22, s[8:11], s37 offen sc1 lds
s_add_u32 m0, s39, 101376
s_add_u32 s37, s37, s38
buffer_load_dwordx4 v23, s[8:11], s37 offen sc1 lds
s_add_u32 m0, s39, 102400
s_add_u32 s37, s37, s38
buffer_load_dwordx4 v22, s[8:11], s37 offen sc1 lds
s_add_u32 m0, s39, 103424
s_add_u32 s37, s37, s38
buffer_load_dwordx4 v23, s[8:11], s37 offen sc1 lds
s_add_u32 m0, s39, 104448
s_add_u32 s37, s37, s38
buffer_load_dwordx4 v22, s[8:11], s37 offen sc1 lds
s_add_u32 m0, s39, 105472
s_add_u32 s37, s37, s38
buffer_load_dwordx4 v23, s[8:11], s37 offen sc1 lds
s_add_u32 m0, s39, 106496
s_add_u32 s37, s37, s38
buffer_load_dwordx4 v22, s[8:11], s37 offen sc1 lds
s_add_u32 m0, s39, 107520
s_add_u32 s37, s37, s38
buffer_load_dwordx4 v23, s[8:11], s37 offen sc1 lds
s_add_u32 m0, s39, 108544
s_add_u32 s37, s37, s38
buffer_load_dwordx4 v22, s[8:11], s37 offen sc1 lds
s_add_u32 m0, s39, 109568
s_add_u32 s37, s37, s38
buffer_load_dwordx4 v23, s[8:11], s37 offen sc1 lds
s_add_u32 m0, s39, 110592
s_add_u32 s37, s37, s38
buffer_load_dwordx4 v22, s[8:11], s37 offen sc1 lds
s_add_u32 m0, s39, 111616
s_add_u32 s37, s37, s38
buffer_load_dwordx4 v23, s[8:11], s37 offen sc1 lds
s_add_u32 m0, s39, 112640
s_add_u32 s37, s37, s38
buffer_load_dwordx4 v22, s[8:11], s37 offen sc1 lds
s_add_u32 m0, s39, 113664
s_add_u32 s37, s37, s38
buffer_load_dwordx4 v23, s[8:11], s37 offen sc1 lds
s_waitcnt vmcnt(24)
s_barrier
s_waitcnt vmcnt(16)
s_barrier
s_add_u32 s42, s42, 1
s_and_b32 s42, s42, 15
s_add_u32 m0, s39, 0
s_mul_i32 s37, s42, s40
buffer_load_dwordx4 v22, s[8:11], s37 offen sc1 lds
s_add_u32 m0, s39, 1024
s_add_u32 s37, s37, s38
buffer_load_dwordx4 v23, s[8:11], s37 offen sc1 lds
s_add_u32 m0, s39, 2048
s_add_u32 s37, s37, s38
buffer_load_dwordx4 v22, s[8:11], s37 offen sc1 lds
s_add_u32 m0, s39, 3072
s_add_u32 s37, s37, s38
buffer_load_dwordx4 v23, s[8:11], s37 offen sc1 lds
s_add_u32 m0, s39, 4096
s_add_u32 s37, s37, s38
buffer_load_dwordx4 v22, s[8:11], s37 offen sc1 lds
s_add_u32 m0, s39, 5120
s_add_u32 s37, s37, s38
buffer_load_dwordx4 v23, s[8:11], s37 offen sc1 lds
s_add_u32 m0, s39, 6144
s_add_u32 s37, s37, s38
buffer_load_dwordx4 v22, s[8:11], s37 offen sc1 lds
s_add_u32 m0, s39, 7168
s_add_u32 s37, s37, s38
buffer_load_dwordx4 v23, s[8:11], s37 offen sc1 lds
s_add_u32 m0, s39, 8192
s_add_u32 s37, s37, s38
buffer_load_dwordx4 v22, s[8:11], s37 offen sc1 lds
s_add_u32 m0, s39, 9216
s_add_u32 s37, s37, s38
buffer_load_dwordx4 v23, s[8:11], s37 offen sc1 lds
s_add_u32 m0, s39, 10240
s_add_u32 s37, s37, s38
buffer_load_dwordx4 v22, s[8:11], s37 offen sc1 lds
s_add_u32 m0, s39, 11264
s_add_u32 s37, s37, s38
buffer_load_dwordx4 v23, s[8:11], s37 offen sc1 lds
s_add_u32 m0, s39, 12288
s_add_u32 s37, s37, s38
buffer_load_dwordx4 v22, s[8:11], s37 offen sc1 lds
s_add_u32 m0, s39, 13312
s_add_u32 s37, s37, s38
buffer_load_dwordx4 v23, s[8:11], s37 offen sc1 lds
s_add_u32 m0, s39, 14336
s_add_u32 s37, s37, s38
buffer_load_dwordx4 v22, s[8:11], s37 offen sc1 lds
s_add_u32 m0, s39, 15360
s_add_u32 s37, s37, s38
buffer_load_dwordx4 v23, s[8:11], s37 offen sc1 lds
s_barrier
s_waitcnt vmcnt(16)
s_barrier
s_add_u32 s42, s42, 1
s_and_b32 s42, s42, 15
s_add_u32 m0, s39, 49152
s_mul_i32 s37, s42, s40
buffer_load_dwordx4 v22, s[8:11], s37 offen sc1 lds
s_add_u32 m0, s39, 50176
s_add_u32 s37, s37, s38
buffer_load_dwordx4 v23, s[8:11], s37 offen sc1 lds
s_add_u32 m0, s39, 51200
s_add_u32 s37, s37, s38
buffer_load_dwordx4 v22, s[8:11], s37 offen sc1 lds
s_add_u32 m0, s39, 52224
s_add_u32 s37, s37, s38
buffer_load_dwordx4 v23, s[8:11], s37 offen sc1 lds
s_add_u32 m0, s39, 53248
s_add_u32 s37, s37, s38
buffer_load_dwordx4 v22, s[8:11], s37 offen sc1 lds
s_add_u32 m0, s39, 54272
s_add_u32 s37, s37, s38
buffer_load_dwordx4 v23, s[8:11], s37 offen sc1 lds
s_add_u32 m0, s39, 55296
s_add_u32 s37, s37, s38
buffer_load_dwordx4 v22, s[8:11], s37 offen sc1 lds
s_add_u32 m0, s39, 56320
s_add_u32 s37, s37, s38
buffer_load_dwordx4 v23, s[8:11], s37 offen sc1 lds
s_add_u32 m0, s39, 57344
s_add_u32 s37, s37, s38
buffer_load_dwordx4 v22, s[8:11], s37 offen sc1 lds
s_add_u32 m0, s39, 58368
s_add_u32 s37, s37, s38
buffer_load_dwordx4 v23, s[8:11], s37 offen sc1 lds
s_add_u32 m0, s39, 59392
s_add_u32 s37, s37, s38
buffer_load_dwordx4 v22, s[8:11], s37 offen sc1 lds
s_add_u32 m0, s39, 60416
s_add_u32 s37, s37, s38
buffer_load_dwordx4 v23, s[8:11], s37 offen sc1 lds
s_add_u32 m0, s39, 61440
s_add_u32 s37, s37, s38
buffer_load_dwordx4 v22, s[8:11], s37 offen sc1 lds
s_add_u32 m0, s39, 62464
s_add_u32 s37, s37, s38
buffer_load_dwordx4 v23, s[8:11], s37 offen sc1 lds
s_add_u32 m0, s39, 63488
s_add_u32 s37, s37, s38
buffer_load_dwordx4 v22, s[8:11], s37 offen sc1 lds
s_add_u32 m0, s39, 64512
s_add_u32 s37, s37, s38
buffer_load_dwordx4 v23, s[8:11], s37 offen sc1 lds
s_branch LP3_103
.p2align 6
Lw_15:
s_branch Lr_16
s_nop 0
.p2align 3
Lp_106:
s_add_u32 s42, s35, 15
s_waitcnt vmcnt(0)
s_barrier
ds_write_b128 v27, v[68:71] offset:0
ds_write_b128 v27, v[116:119] offset:512
s_add_u32 s42, s42, 1
s_and_b32 s42, s42, 15
s_add_u32 m0, s39, 49152
s_lshl_b32 s37, s42, 17
buffer_load_dwordx4 v23, s[8:11], s37 offen sc1 lds
s_add_u32 m0, s39, 50176
s_add_u32 s37, s37, s38
buffer_load_dwordx4 v23, s[8:11], s37 offen sc1 lds
s_add_u32 m0, s39, 51200
s_add_u32 s37, s37, s38
buffer_load_dwordx4 v23, s[8:11], s37 offen sc1 lds
s_add_u32 m0, s39, 52224
s_add_u32 s37, s37, s38
buffer_load_dwordx4 v23, s[8:11], s37 offen sc1 lds
s_add_u32 m0, s39, 53248
s_add_u32 s37, s37, s38
buffer_load_dwordx4 v23, s[8:11], s37 offen sc1 lds
s_add_u32 m0, s39, 54272
s_add_u32 s37, s37, s38
buffer_load_dwordx4 v23, s[8:11], s37 offen sc1 lds
s_add_u32 m0, s39, 55296
s_add_u32 s37, s37, s38
buffer_load_dwordx4 v23, s[8:11], s37 offen sc1 lds
s_add_u32 m0, s39, 56320
s_add_u32 s37, s37, s38
buffer_load_dwordx4 v23, s[8:11], s37 offen sc1 lds
s_add_u32 s42, s42, 1
s_and_b32 s42, s42, 15
s_add_u32 m0, s39, 57344
s_lshl_b32 s37, s42, 17
buffer_load_dwordx4 v23, s[8:11], s37 offen sc1 lds
s_add_u32 m0, s39, 58368
s_add_u32 s37, s37, s38
buffer_load_dwordx4 v23, s[8:11], s37 offen sc1 lds
s_add_u32 m0, s39, 59392
s_add_u32 s37, s37, s38
buffer_load_dwordx4 v23, s[8:11], s37 offen sc1 lds
s_add_u32 m0, s39, 60416
s_add_u32 s37, s37, s38
buffer_load_dwordx4 v23, s[8:11], s37 offen sc1 lds
s_add_u32 m0, s39, 61440
s_add_u32 s37, s37, s38
buffer_load_dwordx4 v23, s[8:11], s37 offen sc1 lds
s_add_u32 m0, s39, 62464
s_add_u32 s37, s37, s38
buffer_load_dwordx4 v23, s[8:11], s37 offen sc1 lds
s_add_u32 m0, s39, 63488
s_add_u32 s37, s37, s38
buffer_load_dwordx4 v23, s[8:11], s37 offen sc1 lds
s_add_u32 m0, s39, 64512
s_add_u32 s37, s37, s38
buffer_load_dwordx4 v23, s[8:11], s37 offen sc1 lds
s_waitcnt vmcnt(8)
s_waitcnt lgkmcnt(0)
s_barrier
s_add_u32 m0, s54, 16384
s_add_u32 s43, s30, 0
buffer_load_dwordx4 v21, s[12:15], s43 offen sc1 lds
s_add_u32 m0, s54, 17408
s_add_u32 s43, s30, 1024
buffer_load_dwordx4 v21, s[12:15], s43 offen sc1 lds
s_add_u32 m0, s54, 32768
s_add_u32 s43, s31, 0
buffer_load_dwordx4 v21, s[12:15], s43 offen sc1 lds
s_add_u32 m0, s54, 33792
s_add_u32 s43, s31, 1024
buffer_load_dwordx4 v21, s[12:15], s43 offen sc1 lds
s_add_u32 s42, s42, 1
s_and_b32 s42, s42, 15
s_add_u32 m0, s39, 65536
s_lshl_b32 s37, s42, 17
buffer_load_dwordx4 v23, s[8:11], s37 offen sc1 lds
s_add_u32 m0, s39, 66560
s_add_u32 s37, s37, s38
buffer_load_dwordx4 v23, s[8:11], s37 offen sc1 lds
s_add_u32 m0, s39, 67584
s_add_u32 s37, s37, s38
buffer_load_dwordx4 v23, s[8:11], s37 offen sc1 lds
s_add_u32 m0, s39, 68608
s_add_u32 s37, s37, s38
buffer_load_dwordx4 v23, s[8:11], s37 offen sc1 lds
s_add_u32 m0, s39, 69632
s_add_u32 s37, s37, s38
buffer_load_dwordx4 v23, s[8:11], s37 offen sc1 lds
s_add_u32 m0, s39, 70656
s_add_u32 s37, s37, s38
buffer_load_dwordx4 v23, s[8:11], s37 offen sc1 lds
s_add_u32 m0, s39, 71680
s_add_u32 s37, s37, s38
buffer_load_dwordx4 v23, s[8:11], s37 offen sc1 lds
s_add_u32 m0, s39, 72704
s_add_u32 s37, s37, s38
buffer_load_dwordx4 v23, s[8:11], s37 offen sc1 lds
s_waitcnt vmcnt(10)
s_barrier
s_add_u32 s42, s42, 1
s_and_b32 s42, s42, 15
s_add_u32 m0, s39, 73728
s_lshl_b32 s37, s42, 17
buffer_load_dwordx4 v23, s[8:11], s37 offen sc1 lds
s_add_u32 m0, s39, 74752
s_add_u32 s37, s37, s38
buffer_load_dwordx4 v23, s[8:11], s37 offen sc1 lds
s_add_u32 m0, s39, 75776
s_add_u32 s37, s37, s38
buffer_load_dwordx4 v23, s[8:11], s37 offen sc1 lds
s_add_u32 m0, s39, 76800
s_add_u32 s37, s37, s38
buffer_load_dwordx4 v23, s[8:11], s37 offen sc1 lds
s_add_u32 m0, s39, 77824
s_add_u32 s37, s37, s38
buffer_load_dwordx4 v23, s[8:11], s37 offen sc1 lds
s_add_u32 m0, s39, 78848
s_add_u32 s37, s37, s38
buffer_load_dwordx4 v23, s[8:11], s37 offen sc1 lds
s_add_u32 m0, s39, 79872
s_add_u32 s37, s37, s38
buffer_load_dwordx4 v23, s[8:11], s37 offen sc1 lds
s_add_u32 m0, s39, 80896
s_add_u32 s37, s37, s38
buffer_load_dwordx4 v23, s[8:11], s37 offen sc1 lds
s_waitcnt vmcnt(8)
s_barrier
s_add_u32 s42, s42, 1
s_and_b32 s42, s42, 15
s_add_u32 m0, s39, 81920
s_lshl_b32 s37, s42, 17
buffer_load_dwordx4 v23, s[8:11], s37 offen sc1 lds
s_add_u32 m0, s39, 82944
s_add_u32 s37, s37, s38
buffer_load_dwordx4 v23, s[8:11], s37 offen sc1 lds
s_add_u32 m0, s39, 83968
s_add_u32 s37, s37, s38
buffer_load_dwordx4 v23, s[8:11], s37 offen sc1 lds
s_add_u32 m0, s39, 84992
s_add_u32 s37, s37, s38
buffer_load_dwordx4 v23, s[8:11], s37 offen sc1 lds
s_add_u32 m0, s39, 86016
s_add_u32 s37, s37, s38
buffer_load_dwordx4 v23, s[8:11], s37 offen sc1 lds
s_add_u32 m0, s39, 87040
s_add_u32 s37, s37, s38
buffer_load_dwordx4 v23, s[8:11], s37 offen sc1 lds
s_add_u32 m0, s39, 88064
s_add_u32 s37, s37, s38
buffer_load_dwordx4 v23, s[8:11], s37 offen sc1 lds
s_add_u32 m0, s39, 89088
s_add_u32 s37, s37, s38
buffer_load_dwordx4 v23, s[8:11], s37 offen sc1 lds
s_add_u32 s42, s42, 1
s_and_b32 s42, s42, 15
s_add_u32 m0, s39, 90112
s_lshl_b32 s37, s42, 17
buffer_load_dwordx4 v23, s[8:11], s37 offen sc1 lds
s_add_u32 m0, s39, 91136
s_add_u32 s37, s37, s38
buffer_load_dwordx4 v23, s[8:11], s37 offen sc1 lds
s_add_u32 m0, s39, 92160
s_add_u32 s37, s37, s38
buffer_load_dwordx4 v23, s[8:11], s37 offen sc1 lds
s_add_u32 m0, s39, 93184
s_add_u32 s37, s37, s38
buffer_load_dwordx4 v23, s[8:11], s37 offen sc1 lds
s_add_u32 m0, s39, 94208
s_add_u32 s37, s37, s38
buffer_load_dwordx4 v23, s[8:11], s37 offen sc1 lds
s_add_u32 m0, s39, 95232
s_add_u32 s37, s37, s38
buffer_load_dwordx4 v23, s[8:11], s37 offen sc1 lds
s_add_u32 m0, s39, 96256
s_add_u32 s37, s37, s38
buffer_load_dwordx4 v23, s[8:11], s37 offen sc1 lds
s_add_u32 m0, s39, 97280
s_add_u32 s37, s37, s38
buffer_load_dwordx4 v23, s[8:11], s37 offen sc1 lds
s_waitcnt vmcnt(16)
s_barrier
s_add_u32 s42, s42, 1
s_and_b32 s42, s42, 15
s_add_u32 m0, s39, 98304
s_lshl_b32 s37, s42, 17
buffer_load_dwordx4 v23, s[8:11], s37 offen sc1 lds
s_add_u32 m0, s39, 99328
s_add_u32 s37, s37, s38
buffer_load_dwordx4 v23, s[8:11], s37 offen sc1 lds
s_add_u32 m0, s39, 100352
s_add_u32 s37, s37, s38
buffer_load_dwordx4 v23, s[8:11], s37 offen sc1 lds
s_add_u32 m0, s39, 101376
s_add_u32 s37, s37, s38
buffer_load_dwordx4 v23, s[8:11], s37 offen sc1 lds
s_add_u32 m0, s39, 102400
s_add_u32 s37, s37, s38
buffer_load_dwordx4 v23, s[8:11], s37 offen sc1 lds
s_add_u32 m0, s39, 103424
s_add_u32 s37, s37, s38
buffer_load_dwordx4 v23, s[8:11], s37 offen sc1 lds
s_add_u32 m0, s39, 104448
s_add_u32 s37, s37, s38
buffer_load_dwordx4 v23, s[8:11], s37 offen sc1 lds
s_add_u32 m0, s39, 105472
s_add_u32 s37, s37, s38
buffer_load_dwordx4 v23, s[8:11], s37 offen sc1 lds
s_add_u32 s42, s42, 1
s_and_b32 s42, s42, 15
s_add_u32 m0, s39, 106496
s_lshl_b32 s37, s42, 17
buffer_load_dwordx4 v23, s[8:11], s37 offen sc1 lds
s_add_u32 m0, s39, 107520
s_add_u32 s37, s37, s38
buffer_load_dwordx4 v23, s[8:11], s37 offen sc1 lds
s_add_u32 m0, s39, 108544
s_add_u32 s37, s37, s38
buffer_load_dwordx4 v23, s[8:11], s37 offen sc1 lds
s_add_u32 m0, s39, 109568
s_add_u32 s37, s37, s38
buffer_load_dwordx4 v23, s[8:11], s37 offen sc1 lds
s_add_u32 m0, s39, 110592
s_add_u32 s37, s37, s38
buffer_load_dwordx4 v23, s[8:11], s37 offen sc1 lds
s_add_u32 m0, s39, 111616
s_add_u32 s37, s37, s38
buffer_load_dwordx4 v23, s[8:11], s37 offen sc1 lds
s_add_u32 m0, s39, 112640
s_add_u32 s37, s37, s38
buffer_load_dwordx4 v23, s[8:11], s37 offen sc1 lds
s_add_u32 m0, s39, 113664
s_add_u32 s37, s37, s38
buffer_load_dwordx4 v23, s[8:11], s37 offen sc1 lds
s_waitcnt vmcnt(24)
s_barrier
s_add_u32 s42, s42, 1
s_and_b32 s42, s42, 15
s_add_u32 m0, s39, 114688
s_lshl_b32 s37, s42, 17
buffer_load_dwordx4 v23, s[8:11], s37 offen sc1 lds
s_add_u32 m0, s39, 115712
s_add_u32 s37, s37, s38
buffer_load_dwordx4 v23, s[8:11], s37 offen sc1 lds
s_add_u32 m0, s39, 116736
s_add_u32 s37, s37, s38
buffer_load_dwordx4 v23, s[8:11], s37 offen sc1 lds
s_add_u32 m0, s39, 117760
s_add_u32 s37, s37, s38
buffer_load_dwordx4 v23, s[8:11], s37 offen sc1 lds
s_add_u32 m0, s39, 118784
s_add_u32 s37, s37, s38
buffer_load_dwordx4 v23, s[8:11], s37 offen sc1 lds
s_add_u32 m0, s39, 119808
s_add_u32 s37, s37, s38
buffer_load_dwordx4 v23, s[8:11], s37 offen sc1 lds
s_add_u32 m0, s39, 120832
s_add_u32 s37, s37, s38
buffer_load_dwordx4 v23, s[8:11], s37 offen sc1 lds
s_add_u32 m0, s39, 121856
s_add_u32 s37, s37, s38
buffer_load_dwordx4 v23, s[8:11], s37 offen sc1 lds
s_add_u32 s42, s42, 1
s_and_b32 s42, s42, 15
s_add_u32 m0, s39, 122880
s_lshl_b32 s37, s42, 17
buffer_load_dwordx4 v23, s[8:11], s37 offen sc1 lds
s_add_u32 m0, s39, 123904
s_add_u32 s37, s37, s38
buffer_load_dwordx4 v23, s[8:11], s37 offen sc1 lds
s_add_u32 m0, s39, 124928
s_add_u32 s37, s37, s38
buffer_load_dwordx4 v23, s[8:11], s37 offen sc1 lds
s_add_u32 m0, s39, 125952
s_add_u32 s37, s37, s38
buffer_load_dwordx4 v23, s[8:11], s37 offen sc1 lds
s_add_u32 m0, s39, 126976
s_add_u32 s37, s37, s38
buffer_load_dwordx4 v23, s[8:11], s37 offen sc1 lds
s_add_u32 m0, s39, 128000
s_add_u32 s37, s37, s38
buffer_load_dwordx4 v23, s[8:11], s37 offen sc1 lds
s_add_u32 m0, s39, 129024
s_add_u32 s37, s37, s38
buffer_load_dwordx4 v23, s[8:11], s37 offen sc1 lds
s_add_u32 m0, s39, 130048
s_add_u32 s37, s37, s38
buffer_load_dwordx4 v23, s[8:11], s37 offen sc1 lds
s_waitcnt vmcnt(32)
s_barrier
s_add_u32 s42, s42, 1
s_and_b32 s42, s42, 15
s_add_u32 m0, s39, 49152
s_lshl_b32 s37, s42, 17
buffer_load_dwordx4 v23, s[8:11], s37 offen sc1 lds
s_add_u32 m0, s39, 50176
s_add_u32 s37, s37, s38
buffer_load_dwordx4 v23, s[8:11], s37 offen sc1 lds
s_add_u32 m0, s39, 51200
s_add_u32 s37, s37, s38
buffer_load_dwordx4 v23, s[8:11], s37 offen sc1 lds
s_add_u32 m0, s39, 52224
s_add_u32 s37, s37, s38
buffer_load_dwordx4 v23, s[8:11], s37 offen sc1 lds
s_add_u32 m0, s39, 53248
s_add_u32 s37, s37, s38
buffer_load_dwordx4 v23, s[8:11], s37 offen sc1 lds
s_add_u32 m0, s39, 54272
s_add_u32 s37, s37, s38
buffer_load_dwordx4 v23, s[8:11], s37 offen sc1 lds
s_add_u32 m0, s39, 55296
s_add_u32 s37, s37, s38
buffer_load_dwordx4 v23, s[8:11], s37 offen sc1 lds
s_add_u32 m0, s39, 56320
s_add_u32 s37, s37, s38
buffer_load_dwordx4 v23, s[8:11], s37 offen sc1 lds
s_add_u32 s42, s42, 1
s_and_b32 s42, s42, 15
s_add_u32 m0, s39, 57344
s_lshl_b32 s37, s42, 17
buffer_load_dwordx4 v23, s[8:11], s37 offen sc1 lds
s_add_u32 m0, s39, 58368
s_add_u32 s37, s37, s38
buffer_load_dwordx4 v23, s[8:11], s37 offen sc1 lds
s_add_u32 m0, s39, 59392
s_add_u32 s37, s37, s38
buffer_load_dwordx4 v23, s[8:11], s37 offen sc1 lds
s_add_u32 m0, s39, 60416
s_add_u32 s37, s37, s38
buffer_load_dwordx4 v23, s[8:11], s37 offen sc1 lds
s_add_u32 m0, s39, 61440
s_add_u32 s37, s37, s38
buffer_load_dwordx4 v23, s[8:11], s37 offen sc1 lds
s_add_u32 m0, s39, 62464
s_add_u32 s37, s37, s38
buffer_load_dwordx4 v23, s[8:11], s37 offen sc1 lds
s_add_u32 m0, s39, 63488
s_add_u32 s37, s37, s38
buffer_load_dwordx4 v23, s[8:11], s37 offen sc1 lds
s_add_u32 m0, s39, 64512
s_add_u32 s37, s37, s38
buffer_load_dwordx4 v23, s[8:11], s37 offen sc1 lds
s_waitcnt vmcnt(40)
s_barrier
s_add_u32 s42, s42, 1
s_and_b32 s42, s42, 15
s_add_u32 m0, s39, 65536
s_lshl_b32 s37, s42, 17
buffer_load_dwordx4 v23, s[8:11], s37 offen sc1 lds
s_add_u32 m0, s39, 66560
s_add_u32 s37, s37, s38
buffer_load_dwordx4 v23, s[8:11], s37 offen sc1 lds
s_add_u32 m0, s39, 67584
s_add_u32 s37, s37, s38
buffer_load_dwordx4 v23, s[8:11], s37 offen sc1 lds
s_add_u32 m0, s39, 68608
s_add_u32 s37, s37, s38
buffer_load_dwordx4 v23, s[8:11], s37 offen sc1 lds
s_add_u32 m0, s39, 69632
s_add_u32 s37, s37, s38
buffer_load_dwordx4 v23, s[8:11], s37 offen sc1 lds
s_add_u32 m0, s39, 70656
s_add_u32 s37, s37, s38
buffer_load_dwordx4 v23, s[8:11], s37 offen sc1 lds
s_add_u32 m0, s39, 71680
s_add_u32 s37, s37, s38
buffer_load_dwordx4 v23, s[8:11], s37 offen sc1 lds
s_add_u32 m0, s39, 72704
s_add_u32 s37, s37, s38
buffer_load_dwordx4 v23, s[8:11], s37 offen sc1 lds
s_add_u32 s42, s42, 1
s_and_b32 s42, s42, 15
s_add_u32 m0, s39, 73728
s_lshl_b32 s37, s42, 17
buffer_load_dwordx4 v23, s[8:11], s37 offen sc1 lds
s_add_u32 m0, s39, 74752
s_add_u32 s37, s37, s38
buffer_load_dwordx4 v23, s[8:11], s37 offen sc1 lds
s_add_u32 m0, s39, 75776
s_add_u32 s37, s37, s38
buffer_load_dwordx4 v23, s[8:11], s37 offen sc1 lds
s_add_u32 m0, s39, 76800
s_add_u32 s37, s37, s38
buffer_load_dwordx4 v23, s[8:11], s37 offen sc1 lds
s_add_u32 m0, s39, 77824
s_add_u32 s37, s37, s38
buffer_load_dwordx4 v23, s[8:11], s37 offen sc1 lds
s_add_u32 m0, s39, 78848
s_add_u32 s37, s37, s38
buffer_load_dwordx4 v23, s[8:11], s37 offen sc1 lds
s_add_u32 m0, s39, 79872
s_add_u32 s37, s37, s38
buffer_load_dwordx4 v23, s[8:11], s37 offen sc1 lds
s_add_u32 m0, s39, 80896
s_add_u32 s37, s37, s38
buffer_load_dwordx4 v23, s[8:11], s37 offen sc1 lds
s_waitcnt vmcnt(48)
s_barrier
s_add_u32 s42, s42, 1
s_and_b32 s42, s42, 15
s_add_u32 m0, s39, 81920
s_lshl_b32 s37, s42, 17
buffer_load_dwordx4 v23, s[8:11], s37 offen sc1 lds
s_add_u32 m0, s39, 82944
s_add_u32 s37, s37, s38
buffer_load_dwordx4 v23, s[8:11], s37 offen sc1 lds
s_add_u32 m0, s39, 83968
s_add_u32 s37, s37, s38
buffer_load_dwordx4 v23, s[8:11], s37 offen sc1 lds
s_add_u32 m0, s39, 84992
s_add_u32 s37, s37, s38
buffer_load_dwordx4 v23, s[8:11], s37 offen sc1 lds
s_add_u32 m0, s39, 86016
s_add_u32 s37, s37, s38
buffer_load_dwordx4 v23, s[8:11], s37 offen sc1 lds
s_add_u32 m0, s39, 87040
s_add_u32 s37, s37, s38
buffer_load_dwordx4 v23, s[8:11], s37 offen sc1 lds
s_add_u32 m0, s39, 88064
s_add_u32 s37, s37, s38
buffer_load_dwordx4 v23, s[8:11], s37 offen sc1 lds
s_add_u32 m0, s39, 89088
s_add_u32 s37, s37, s38
buffer_load_dwordx4 v23, s[8:11], s37 offen sc1 lds
s_add_u32 s42, s42, 1
s_and_b32 s42, s42, 15
s_add_u32 m0, s39, 90112
s_lshl_b32 s37, s42, 17
buffer_load_dwordx4 v23, s[8:11], s37 offen sc1 lds
s_add_u32 m0, s39, 91136
s_add_u32 s37, s37, s38
buffer_load_dwordx4 v23, s[8:11], s37 offen sc1 lds
s_add_u32 m0, s39, 92160
s_add_u32 s37, s37, s38
buffer_load_dwordx4 v23, s[8:11], s37 offen sc1 lds
s_add_u32 m0, s39, 93184
s_add_u32 s37, s37, s38
buffer_load_dwordx4 v23, s[8:11], s37 offen sc1 lds
s_add_u32 m0, s39, 94208
s_add_u32 s37, s37, s38
buffer_load_dwordx4 v23, s[8:11], s37 offen sc1 lds
s_add_u32 m0, s39, 95232
s_add_u32 s37, s37, s38
buffer_load_dwordx4 v23, s[8:11], s37 offen sc1 lds
s_add_u32 m0, s39, 96256
s_add_u32 s37, s37, s38
buffer_load_dwordx4 v23, s[8:11], s37 offen sc1 lds
s_add_u32 m0, s39, 97280
s_add_u32 s37, s37, s38
buffer_load_dwordx4 v23, s[8:11], s37 offen sc1 lds
s_waitcnt vmcnt(56)
s_barrier
s_waitcnt vmcnt(48)
s_barrier
s_waitcnt vmcnt(40)
s_barrier
s_waitcnt vmcnt(32)
s_barrier
s_waitcnt vmcnt(24)
s_barrier
s_lshl_b32 s43, s35, 8
s_cmp_eq_u32 s51, 1
s_cselect_b32 s8, s4, s6
s_cselect_b32 s9, s5, s7
s_sub_u32 s10, 7340032, s43
s_lshl_b32 s44, s34, 18
s_add_u32 s44, s44, 4194304
s_movk_i32 s38, 28672
s_cmp_eq_u32 s51, 0
s_cselect_b32 s8, s32, s8
s_cselect_b32 s9, s33, s9
s_cselect_b32 s10, 262144, s10
s_cselect_b32 s43, s44, s43
s_cselect_b32 s38, 1024, s38
s_cselect_b32 s45, 0, -1
s_add_u32 s8, s8, s43
s_addc_u32 s9, s9, 0
s_mov_b32 s11, 0x20000
s_lshl_b32 s40, s38, 4
s_add_u32 s42, s35, 15
s_lshl_b32 s39, s51, 14
v_lshrrev_b32 v19, 4, v1
v_lshlrev_b32 v20, 5, v19
v_mul_u32_u24 v19, 6912, v19
v_and_b32 v19, s45, v19
v_and_b32 v20, s45, v20
v_lshlrev_b32 v21, 4, v1
v_xor_b32 v21, v21, v20
v_add_u32 v22, v21, v19
s_and_b32 s45, s45, 128
v_xor_b32 v23, s45, v22
s_waitcnt vmcnt(16)
s_barrier
s_add_u32 s42, s42, 1
s_and_b32 s42, s42, 15
s_add_u32 m0, s39, 98304
s_mul_i32 s37, s42, s40
buffer_load_dwordx4 v22, s[8:11], s37 offen sc1 lds
s_add_u32 m0, s39, 99328
s_add_u32 s37, s37, s38
buffer_load_dwordx4 v23, s[8:11], s37 offen sc1 lds
s_add_u32 m0, s39, 100352
s_add_u32 s37, s37, s38
buffer_load_dwordx4 v22, s[8:11], s37 offen sc1 lds
s_add_u32 m0, s39, 101376
s_add_u32 s37, s37, s38
buffer_load_dwordx4 v23, s[8:11], s37 offen sc1 lds
s_add_u32 m0, s39, 102400
s_add_u32 s37, s37, s38
buffer_load_dwordx4 v22, s[8:11], s37 offen sc1 lds
s_add_u32 m0, s39, 103424
s_add_u32 s37, s37, s38
buffer_load_dwordx4 v23, s[8:11], s37 offen sc1 lds
s_add_u32 m0, s39, 104448
s_add_u32 s37, s37, s38
buffer_load_dwordx4 v22, s[8:11], s37 offen sc1 lds
s_add_u32 m0, s39, 105472
s_add_u32 s37, s37, s38
buffer_load_dwordx4 v23, s[8:11], s37 offen sc1 lds
s_add_u32 m0, s39, 106496
s_add_u32 s37, s37, s38
buffer_load_dwordx4 v22, s[8:11], s37 offen sc1 lds
s_add_u32 m0, s39, 107520
s_add_u32 s37, s37, s38
buffer_load_dwordx4 v23, s[8:11], s37 offen sc1 lds
s_add_u32 m0, s39, 108544
s_add_u32 s37, s37, s38
buffer_load_dwordx4 v22, s[8:11], s37 offen sc1 lds
s_add_u32 m0, s39, 109568
s_add_u32 s37, s37, s38
buffer_load_dwordx4 v23, s[8:11], s37 offen sc1 lds
s_add_u32 m0, s39, 110592
s_add_u32 s37, s37, s38
buffer_load_dwordx4 v22, s[8:11], s37 offen sc1 lds
s_add_u32 m0, s39, 111616
s_add_u32 s37, s37, s38
buffer_load_dwordx4 v23, s[8:11], s37 offen sc1 lds
s_add_u32 m0, s39, 112640
s_add_u32 s37, s37, s38
buffer_load_dwordx4 v22, s[8:11], s37 offen sc1 lds
s_add_u32 m0, s39, 113664
s_add_u32 s37, s37, s38
buffer_load_dwordx4 v23, s[8:11], s37 offen sc1 lds
s_waitcnt vmcnt(24)
s_barrier
s_waitcnt vmcnt(16)
s_barrier
s_add_u32 s42, s42, 1
s_and_b32 s42, s42, 15
s_add_u32 m0, s39, 0
s_mul_i32 s37, s42, s40
buffer_load_dwordx4 v22, s[8:11], s37 offen sc1 lds
s_add_u32 m0, s39, 1024
s_add_u32 s37, s37, s38
buffer_load_dwordx4 v23, s[8:11], s37 offen sc1 lds
s_add_u32 m0, s39, 2048
s_add_u32 s37, s37, s38
buffer_load_dwordx4 v22, s[8:11], s37 offen sc1 lds
s_add_u32 m0, s39, 3072
s_add_u32 s37, s37, s38
buffer_load_dwordx4 v23, s[8:11], s37 offen sc1 lds
s_add_u32 m0, s39, 4096
s_add_u32 s37, s37, s38
buffer_load_dwordx4 v22, s[8:11], s37 offen sc1 lds
s_add_u32 m0, s39, 5120
s_add_u32 s37, s37, s38
buffer_load_dwordx4 v23, s[8:11], s37 offen sc1 lds
s_add_u32 m0, s39, 6144
s_add_u32 s37, s37, s38
buffer_load_dwordx4 v22, s[8:11], s37 offen sc1 lds
s_add_u32 m0, s39, 7168
s_add_u32 s37, s37, s38
buffer_load_dwordx4 v23, s[8:11], s37 offen sc1 lds
s_add_u32 m0, s39, 8192
s_add_u32 s37, s37, s38
buffer_load_dwordx4 v22, s[8:11], s37 offen sc1 lds
s_add_u32 m0, s39, 9216
s_add_u32 s37, s37, s38
buffer_load_dwordx4 v23, s[8:11], s37 offen sc1 lds
s_add_u32 m0, s39, 10240
s_add_u32 s37, s37, s38
buffer_load_dwordx4 v22, s[8:11], s37 offen sc1 lds
s_add_u32 m0, s39, 11264
s_add_u32 s37, s37, s38
buffer_load_dwordx4 v23, s[8:11], s37 offen sc1 lds
s_add_u32 m0, s39, 12288
s_add_u32 s37, s37, s38
buffer_load_dwordx4 v22, s[8:11], s37 offen sc1 lds
s_add_u32 m0, s39, 13312
s_add_u32 s37, s37, s38
buffer_load_dwordx4 v23, s[8:11], s37 offen sc1 lds
s_add_u32 m0, s39, 14336
s_add_u32 s37, s37, s38
buffer_load_dwordx4 v22, s[8:11], s37 offen sc1 lds
s_add_u32 m0, s39, 15360
s_add_u32 s37, s37, s38
buffer_load_dwordx4 v23, s[8:11], s37 offen sc1 lds
s_barrier
s_waitcnt vmcnt(16)
s_barrier
s_add_u32 s42, s42, 1
s_and_b32 s42, s42, 15
s_add_u32 m0, s39, 49152
s_mul_i32 s37, s42, s40
buffer_load_dwordx4 v22, s[8:11], s37 offen sc1 lds
s_add_u32 m0, s39, 50176
s_add_u32 s37, s37, s38
buffer_load_dwordx4 v23, s[8:11], s37 offen sc1 lds
s_add_u32 m0, s39, 51200
s_add_u32 s37, s37, s38
buffer_load_dwordx4 v22, s[8:11], s37 offen sc1 lds
s_add_u32 m0, s39, 52224
s_add_u32 s37, s37, s38
buffer_load_dwordx4 v23, s[8:11], s37 offen sc1 lds
s_add_u32 m0, s39, 53248
s_add_u32 s37, s37, s38
buffer_load_dwordx4 v22, s[8:11], s37 offen sc1 lds
s_add_u32 m0, s39, 54272
s_add_u32 s37, s37, s38
buffer_load_dwordx4 v23, s[8:11], s37 offen sc1 lds
s_add_u32 m0, s39, 55296
s_add_u32 s37, s37, s38
buffer_load_dwordx4 v22, s[8:11], s37 offen sc1 lds
s_add_u32 m0, s39, 56320
s_add_u32 s37, s37, s38
buffer_load_dwordx4 v23, s[8:11], s37 offen sc1 lds
s_add_u32 m0, s39, 57344
s_add_u32 s37, s37, s38
buffer_load_dwordx4 v22, s[8:11], s37 offen sc1 lds
s_add_u32 m0, s39, 58368
s_add_u32 s37, s37, s38
buffer_load_dwordx4 v23, s[8:11], s37 offen sc1 lds
s_add_u32 m0, s39, 59392
s_add_u32 s37, s37, s38
buffer_load_dwordx4 v22, s[8:11], s37 offen sc1 lds
s_add_u32 m0, s39, 60416
s_add_u32 s37, s37, s38
buffer_load_dwordx4 v23, s[8:11], s37 offen sc1 lds
s_add_u32 m0, s39, 61440
s_add_u32 s37, s37, s38
buffer_load_dwordx4 v22, s[8:11], s37 offen sc1 lds
s_add_u32 m0, s39, 62464
s_add_u32 s37, s37, s38
buffer_load_dwordx4 v23, s[8:11], s37 offen sc1 lds
s_add_u32 m0, s39, 63488
s_add_u32 s37, s37, s38
buffer_load_dwordx4 v22, s[8:11], s37 offen sc1 lds
s_add_u32 m0, s39, 64512
s_add_u32 s37, s37, s38
buffer_load_dwordx4 v23, s[8:11], s37 offen sc1 lds
.p2align 3
LP3_103:
s_mul_i32 s43, s2, 28672
s_mul_i32 s44, s51, 7168
s_add_u32 s43, s43, s44
s_add_u32 s80, s60, s43
s_addc_u32 s81, s61, 0
s_waitcnt vmcnt(16)
s_barrier
s_add_u32 s42, s42, 1
s_and_b32 s42, s42, 15
s_add_u32 m0, s39, 98304
s_mul_i32 s37, s42, s40
buffer_load_dwordx4 v22, s[8:11], s37 offen sc1 lds
s_add_u32 m0, s39, 99328
s_add_u32 s37, s37, s38
buffer_load_dwordx4 v23, s[8:11], s37 offen sc1 lds
s_add_u32 m0, s39, 100352
s_add_u32 s37, s37, s38
buffer_load_dwordx4 v22, s[8:11], s37 offen sc1 lds
s_add_u32 m0, s39, 101376
s_add_u32 s37, s37, s38
buffer_load_dwordx4 v23, s[8:11], s37 offen sc1 lds
s_add_u32 m0, s39, 102400
s_add_u32 s37, s37, s38
buffer_load_dwordx4 v22, s[8:11], s37 offen sc1 lds
s_add_u32 m0, s39, 103424
s_add_u32 s37, s37, s38
buffer_load_dwordx4 v23, s[8:11], s37 offen sc1 lds
s_add_u32 m0, s39, 104448
s_add_u32 s37, s37, s38
buffer_load_dwordx4 v22, s[8:11], s37 offen sc1 lds
s_add_u32 m0, s39, 105472
s_add_u32 s37, s37, s38
buffer_load_dwordx4 v23, s[8:11], s37 offen sc1 lds
s_add_u32 m0, s39, 106496
s_add_u32 s37, s37, s38
buffer_load_dwordx4 v22, s[8:11], s37 offen sc1 lds
s_add_u32 m0, s39, 107520
s_add_u32 s37, s37, s38
buffer_load_dwordx4 v23, s[8:11], s37 offen sc1 lds
s_add_u32 m0, s39, 108544
s_add_u32 s37, s37, s38
buffer_load_dwordx4 v22, s[8:11], s37 offen sc1 lds
s_add_u32 m0, s39, 109568
s_add_u32 s37, s37, s38
buffer_load_dwordx4 v23, s[8:11], s37 offen sc1 lds
s_add_u32 m0, s39, 110592
s_add_u32 s37, s37, s38
buffer_load_dwordx4 v22, s[8:11], s37 offen sc1 lds
s_add_u32 m0, s39, 111616
s_add_u32 s37, s37, s38
buffer_load_dwordx4 v23, s[8:11], s37 offen sc1 lds
s_add_u32 m0, s39, 112640
s_add_u32 s37, s37, s38
buffer_load_dwordx4 v22, s[8:11], s37 offen sc1 lds
s_add_u32 m0, s39, 113664
s_add_u32 s37, s37, s38
buffer_load_dwordx4 v23, s[8:11], s37 offen sc1 lds
s_load_dword s64, s[80:81], 0
s_load_dword s65, s[80:81], 64
s_load_dword s66, s[80:81], 128
s_load_dword s67, s[80:81], 192
s_load_dword s68, s[80:81], 256
s_load_dword s69, s[80:81], 320
s_load_dword s70, s[80:81], 384
s_load_dword s71, s[80:81], 448
s_load_dword s72, s[80:81], 512
s_add_u32 s80, s80, 576
s_addc_u32 s81, s81, 0
s_waitcnt vmcnt(16)
s_barrier
s_mov_b32 s41, 2
.p2align 3
Lp3_107:
s_add_u32 s42, s42, 1
s_and_b32 s42, s42, 15
s_add_u32 m0, s39, 0
s_mul_i32 s37, s42, s40
buffer_load_dwordx4 v22, s[8:11], s37 offen sc1 lds
s_add_u32 m0, s39, 1024
s_add_u32 s37, s37, s38
buffer_load_dwordx4 v23, s[8:11], s37 offen sc1 lds
s_add_u32 m0, s39, 2048
s_add_u32 s37, s37, s38
buffer_load_dwordx4 v22, s[8:11], s37 offen sc1 lds
s_add_u32 m0, s39, 3072
s_add_u32 s37, s37, s38
buffer_load_dwordx4 v23, s[8:11], s37 offen sc1 lds
s_add_u32 m0, s39, 4096
s_add_u32 s37, s37, s38
buffer_load_dwordx4 v22, s[8:11], s37 offen sc1 lds
s_add_u32 m0, s39, 5120
s_add_u32 s37, s37, s38
buffer_load_dwordx4 v23, s[8:11], s37 offen sc1 lds
s_add_u32 m0, s39, 6144
s_add_u32 s37, s37, s38
buffer_load_dwordx4 v22, s[8:11], s37 offen sc1 lds
s_add_u32 m0, s39, 7168
s_add_u32 s37, s37, s38
buffer_load_dwordx4 v23, s[8:11], s37 offen sc1 lds
s_add_u32 m0, s39, 8192
s_add_u32 s37, s37, s38
buffer_load_dwordx4 v22, s[8:11], s37 offen sc1 lds
s_add_u32 m0, s39, 9216
s_add_u32 s37, s37, s38
buffer_load_dwordx4 v23, s[8:11], s37 offen sc1 lds
s_add_u32 m0, s39, 10240
s_add_u32 s37, s37, s38
buffer_load_dwordx4 v22, s[8:11], s37 offen sc1 lds
s_add_u32 m0, s39, 11264
s_add_u32 s37, s37, s38
buffer_load_dwordx4 v23, s[8:11], s37 offen sc1 lds
s_add_u32 m0, s39, 12288
s_add_u32 s37, s37, s38
buffer_load_dwordx4 v22, s[8:11], s37 offen sc1 lds
s_add_u32 m0, s39, 13312
s_add_u32 s37, s37, s38
buffer_load_dwordx4 v23, s[8:11], s37 offen sc1 lds
s_add_u32 m0, s39, 14336
s_add_u32 s37, s37, s38
buffer_load_dwordx4 v22, s[8:11], s37 offen sc1 lds
s_add_u32 m0, s39, 15360
s_add_u32 s37, s37, s38
buffer_load_dwordx4 v23, s[8:11], s37 offen sc1 lds
s_load_dword s64, s[80:81], 0
s_load_dword s65, s[80:81], 64
s_load_dword s66, s[80:81], 128
s_load_dword s67, s[80:81], 192
s_load_dword s68, s[80:81], 256
s_load_dword s69, s[80:81], 320
s_load_dword s70, s[80:81], 384
s_load_dword s71, s[80:81], 448
s_load_dword s72, s[80:81], 512
s_add_u32 s80, s80, 576
s_addc_u32 s81, s81, 0
s_waitcnt vmcnt(16)
s_barrier
s_add_u32 s42, s42, 1
s_and_b32 s42, s42, 15
s_add_u32 m0, s39, 49152
s_mul_i32 s37, s42, s40
buffer_load_dwordx4 v22, s[8:11], s37 offen sc1 lds
s_add_u32 m0, s39, 50176
s_add_u32 s37, s37, s38
buffer_load_dwordx4 v23, s[8:11], s37 offen sc1 lds
s_add_u32 m0, s39, 51200
s_add_u32 s37, s37, s38
buffer_load_dwordx4 v22, s[8:11], s37 offen sc1 lds
s_add_u32 m0, s39, 52224
s_add_u32 s37, s37, s38
buffer_load_dwordx4 v23, s[8:11], s37 offen sc1 lds
s_add_u32 m0, s39, 53248
s_add_u32 s37, s37, s38
buffer_load_dwordx4 v22, s[8:11], s37 offen sc1 lds
s_add_u32 m0, s39, 54272
s_add_u32 s37, s37, s38
buffer_load_dwordx4 v23, s[8:11], s37 offen sc1 lds
s_add_u32 m0, s39, 55296
s_add_u32 s37, s37, s38
buffer_load_dwordx4 v22, s[8:11], s37 offen sc1 lds
s_add_u32 m0, s39, 56320
s_add_u32 s37, s37, s38
buffer_load_dwordx4 v23, s[8:11], s37 offen sc1 lds
s_add_u32 m0, s39, 57344
s_add_u32 s37, s37, s38
buffer_load_dwordx4 v22, s[8:11], s37 offen sc1 lds
s_add_u32 m0, s39, 58368
s_add_u32 s37, s37, s38
buffer_load_dwordx4 v23, s[8:11], s37 offen sc1 lds
s_add_u32 m0, s39, 59392
s_add_u32 s37, s37, s38
buffer_load_dwordx4 v22, s[8:11], s37 offen sc1 lds
s_add_u32 m0, s39, 60416
s_add_u32 s37, s37, s38
buffer_load_dwordx4 v23, s[8:11], s37 offen sc1 lds
s_add_u32 m0, s39, 61440
s_add_u32 s37, s37, s38
buffer_load_dwordx4 v22, s[8:11], s37 offen sc1 lds
s_add_u32 m0, s39, 62464
s_add_u32 s37, s37, s38
buffer_load_dwordx4 v23, s[8:11], s37 offen sc1 lds
s_add_u32 m0, s39, 63488
s_add_u32 s37, s37, s38
buffer_load_dwordx4 v22, s[8:11], s37 offen sc1 lds
s_add_u32 m0, s39, 64512
s_add_u32 s37, s37, s38
buffer_load_dwordx4 v23, s[8:11], s37 offen sc1 lds
s_load_dword s64, s[80:81], 0
s_load_dword s65, s[80:81], 64
s_load_dword s66, s[80:81], 128
s_load_dword s67, s[80:81], 192
s_load_dword s68, s[80:81], 256
s_load_dword s69, s[80:81], 320
s_load_dword s70, s[80:81], 384
s_load_dword s71, s[80:81], 448
s_load_dword s72, s[80:81], 512
s_add_u32 s80, s80, 576
s_addc_u32 s81, s81, 0
s_waitcnt vmcnt(16)
s_barrier
s_add_u32 s42, s42, 1
s_and_b32 s42, s42, 15
s_add_u32 m0, s39, 98304
s_mul_i32 s37, s42, s40
buffer_load_dwordx4 v22, s[8:11], s37 offen sc1 lds
s_add_u32 m0, s39, 99328
s_add_u32 s37, s37, s38
buffer_load_dwordx4 v23, s[8:11], s37 offen sc1 lds
s_add_u32 m0, s39, 100352
s_add_u32 s37, s37, s38
buffer_load_dwordx4 v22, s[8:11], s37 offen sc1 lds
s_add_u32 m0, s39, 101376
s_add_u32 s37, s37, s38
buffer_load_dwordx4 v23, s[8:11], s37 offen sc1 lds
s_add_u32 m0, s39, 102400
s_add_u32 s37, s37, s38
buffer_load_dwordx4 v22, s[8:11], s37 offen sc1 lds
s_add_u32 m0, s39, 103424
s_add_u32 s37, s37, s38
buffer_load_dwordx4 v23, s[8:11], s37 offen sc1 lds
s_add_u32 m0, s39, 104448
s_add_u32 s37, s37, s38
buffer_load_dwordx4 v22, s[8:11], s37 offen sc1 lds
s_add_u32 m0, s39, 105472
s_add_u32 s37, s37, s38
buffer_load_dwordx4 v23, s[8:11], s37 offen sc1 lds
s_add_u32 m0, s39, 106496
s_add_u32 s37, s37, s38
buffer_load_dwordx4 v22, s[8:11], s37 offen sc1 lds
s_add_u32 m0, s39, 107520
s_add_u32 s37, s37, s38
buffer_load_dwordx4 v23, s[8:11], s37 offen sc1 lds
s_add_u32 m0, s39, 108544
s_add_u32 s37, s37, s38
buffer_load_dwordx4 v22, s[8:11], s37 offen sc1 lds
s_add_u32 m0, s39, 109568
s_add_u32 s37, s37, s38
buffer_load_dwordx4 v23, s[8:11], s37 offen sc1 lds
s_add_u32 m0, s39, 110592
s_add_u32 s37, s37, s38
buffer_load_dwordx4 v22, s[8:11], s37 offen sc1 lds
s_add_u32 m0, s39, 111616
s_add_u32 s37, s37, s38
buffer_load_dwordx4 v23, s[8:11], s37 offen sc1 lds
s_add_u32 m0, s39, 112640
s_add_u32 s37, s37, s38
buffer_load_dwordx4 v22, s[8:11], s37 offen sc1 lds
s_add_u32 m0, s39, 113664
s_add_u32 s37, s37, s38
buffer_load_dwordx4 v23, s[8:11], s37 offen sc1 lds
s_load_dword s64, s[80:81], 0
s_load_dword s65, s[80:81], 64
s_load_dword s66, s[80:81], 128
s_load_dword s67, s[80:81], 192
s_load_dword s68, s[80:81], 256
s_load_dword s69, s[80:81], 320
s_load_dword s70, s[80:81], 384
s_load_dword s71, s[80:81], 448
s_load_dword s72, s[80:81], 512
s_add_u32 s80, s80, 576
s_addc_u32 s81, s81, 0
s_waitcnt vmcnt(16)
s_barrier
s_sub_u32 s41, s41, 1
s_cmp_lg_u32 s41, 0
s_cbranch_scc1 Lp3_107
s_add_u32 s42, s42, 1
s_and_b32 s42, s42, 15
s_add_u32 m0, s39, 0
s_mul_i32 s37, s42, s40
buffer_load_dwordx4 v22, s[8:11], s37 offen sc1 lds
s_add_u32 m0, s39, 1024
s_add_u32 s37, s37, s38
buffer_load_dwordx4 v23, s[8:11], s37 offen sc1 lds
s_add_u32 m0, s39, 2048
s_add_u32 s37, s37, s38
buffer_load_dwordx4 v22, s[8:11], s37 offen sc1 lds
s_add_u32 m0, s39, 3072
s_add_u32 s37, s37, s38
buffer_load_dwordx4 v23, s[8:11], s37 offen sc1 lds
s_add_u32 m0, s39, 4096
s_add_u32 s37, s37, s38
buffer_load_dwordx4 v22, s[8:11], s37 offen sc1 lds
s_add_u32 m0, s39, 5120
s_add_u32 s37, s37, s38
buffer_load_dwordx4 v23, s[8:11], s37 offen sc1 lds
s_add_u32 m0, s39, 6144
s_add_u32 s37, s37, s38
buffer_load_dwordx4 v22, s[8:11], s37 offen sc1 lds
s_add_u32 m0, s39, 7168
s_add_u32 s37, s37, s38
buffer_load_dwordx4 v23, s[8:11], s37 offen sc1 lds
s_add_u32 m0, s39, 8192
s_add_u32 s37, s37, s38
buffer_load_dwordx4 v22, s[8:11], s37 offen sc1 lds
s_add_u32 m0, s39, 9216
s_add_u32 s37, s37, s38
buffer_load_dwordx4 v23, s[8:11], s37 offen sc1 lds
s_add_u32 m0, s39, 10240
s_add_u32 s37, s37, s38
buffer_load_dwordx4 v22, s[8:11], s37 offen sc1 lds
s_add_u32 m0, s39, 11264
s_add_u32 s37, s37, s38
buffer_load_dwordx4 v23, s[8:11], s37 offen sc1 lds
s_add_u32 m0, s39, 12288
s_add_u32 s37, s37, s38
buffer_load_dwordx4 v22, s[8:11], s37 offen sc1 lds
s_add_u32 m0, s39, 13312
s_add_u32 s37, s37, s38
buffer_load_dwordx4 v23, s[8:11], s37 offen sc1 lds
s_add_u32 m0, s39, 14336
s_add_u32 s37, s37, s38
buffer_load_dwordx4 v22, s[8:11], s37 offen sc1 lds
s_add_u32 m0, s39, 15360
s_add_u32 s37, s37, s38
buffer_load_dwordx4 v23, s[8:11], s37 offen sc1 lds
s_load_dword s64, s[80:81], 0
s_load_dword s65, s[80:81], 64
s_load_dword s66, s[80:81], 128
s_load_dword s67, s[80:81], 192
s_load_dword s68, s[80:81], 256
s_load_dword s69, s[80:81], 320
s_load_dword s70, s[80:81], 384
s_load_dword s71, s[80:81], 448
s_load_dword s72, s[80:81], 512
s_add_u32 s80, s80, 576
s_addc_u32 s81, s81, 0
s_waitcnt vmcnt(16)
s_barrier
s_add_u32 s42, s42, 1
s_and_b32 s42, s42, 15
s_add_u32 m0, s39, 49152
s_mul_i32 s37, s42, s40
buffer_load_dwordx4 v22, s[8:11], s37 offen sc1 lds
s_add_u32 m0, s39, 50176
s_add_u32 s37, s37, s38
buffer_load_dwordx4 v23, s[8:11], s37 offen sc1 lds
s_add_u32 m0, s39, 51200
s_add_u32 s37, s37, s38
buffer_load_dwordx4 v22, s[8:11], s37 offen sc1 lds
s_add_u32 m0, s39, 52224
s_add_u32 s37, s37, s38
buffer_load_dwordx4 v23, s[8:11], s37 offen sc1 lds
s_add_u32 m0, s39, 53248
s_add_u32 s37, s37, s38
buffer_load_dwordx4 v22, s[8:11], s37 offen sc1 lds
s_add_u32 m0, s39, 54272
s_add_u32 s37, s37, s38
buffer_load_dwordx4 v23, s[8:11], s37 offen sc1 lds
s_add_u32 m0, s39, 55296
s_add_u32 s37, s37, s38
buffer_load_dwordx4 v22, s[8:11], s37 offen sc1 lds
s_add_u32 m0, s39, 56320
s_add_u32 s37, s37, s38
buffer_load_dwordx4 v23, s[8:11], s37 offen sc1 lds
s_add_u32 m0, s39, 57344
s_add_u32 s37, s37, s38
buffer_load_dwordx4 v22, s[8:11], s37 offen sc1 lds
s_add_u32 m0, s39, 58368
s_add_u32 s37, s37, s38
buffer_load_dwordx4 v23, s[8:11], s37 offen sc1 lds
s_add_u32 m0, s39, 59392
s_add_u32 s37, s37, s38
buffer_load_dwordx4 v22, s[8:11], s37 offen sc1 lds
s_add_u32 m0, s39, 60416
s_add_u32 s37, s37, s38
buffer_load_dwordx4 v23, s[8:11], s37 offen sc1 lds
s_add_u32 m0, s39, 61440
s_add_u32 s37, s37, s38
buffer_load_dwordx4 v22, s[8:11], s37 offen sc1 lds
s_add_u32 m0, s39, 62464
s_add_u32 s37, s37, s38
buffer_load_dwordx4 v23, s[8:11], s37 offen sc1 lds
s_add_u32 m0, s39, 63488
s_add_u32 s37, s37, s38
buffer_load_dwordx4 v22, s[8:11], s37 offen sc1 lds
s_add_u32 m0, s39, 64512
s_add_u32 s37, s37, s38
buffer_load_dwordx4 v23, s[8:11], s37 offen sc1 lds
s_load_dword s64, s[80:81], 0
s_load_dword s65, s[80:81], 64
s_load_dword s66, s[80:81], 128
s_load_dword s67, s[80:81], 192
s_load_dword s68, s[80:81], 256
s_load_dword s69, s[80:81], 320
s_load_dword s70, s[80:81], 384
s_load_dword s71, s[80:81], 448
s_load_dword s72, s[80:81], 512
s_add_u32 s80, s80, 576
s_addc_u32 s81, s81, 0
s_waitcnt vmcnt(16)
s_barrier
s_add_u32 s42, s42, 1
s_and_b32 s42, s42, 15
s_add_u32 m0, s39, 98304
s_mul_i32 s37, s42, s40
buffer_load_dwordx4 v22, s[8:11], s37 offen sc1 lds
s_and_b32 s53, s35, 1
s_lshl_b32 s53, s53, 1
s_mul_i32 s43, s47, 3
s_add_u32 m0, s39, 99328
s_add_u32 s37, s37, s38
buffer_load_dwordx4 v23, s[8:11], s37 offen sc1 lds
s_add_u32 s53, s53, s43
v_lshlrev_b32 v19, 11, v18
v_lshl_add_u32 v19, v17, 4, v19
s_add_u32 m0, s39, 100352
s_add_u32 s37, s37, s38
buffer_load_dwordx4 v22, s[8:11], s37 offen sc1 lds
s_lshl_b32 s43, s46, 10
v_add_u32 v2, s43, v19
v_add_u32 v3, 49152, v2
s_add_u32 m0, s39, 101376
s_add_u32 s37, s37, s38
buffer_load_dwordx4 v23, s[8:11], s37 offen sc1 lds
v_add_u32 v4, 98304, v2
v_lshrrev_b32 v19, 2, v17
v_lshl_add_u32 v20, v18, 2, v19
s_add_u32 m0, s39, 102400
s_add_u32 s37, s37, s38
buffer_load_dwordx4 v22, s[8:11], s37 offen sc1 lds
v_and_b32 v21, 7, v20
v_lshlrev_b32 v20, 8, v20
v_and_b32 v19, 3, v1
s_add_u32 m0, s39, 103424
s_add_u32 s37, s37, s38
buffer_load_dwordx4 v23, s[8:11], s37 offen sc1 lds
v_lshl_add_u32 v20, v19, 3, v20
s_add_u32 s43, s53, 0
v_xor_b32 v19, s43, v21
s_add_u32 m0, s39, 104448
s_add_u32 s37, s37, s38
buffer_load_dwordx4 v22, s[8:11], s37 offen sc1 lds
v_lshl_add_u32 v5, v19, 5, v20
s_add_u32 s43, s53, 1
v_xor_b32 v19, s43, v21
s_add_u32 m0, s39, 105472
s_add_u32 s37, s37, s38
buffer_load_dwordx4 v23, s[8:11], s37 offen sc1 lds
v_lshl_add_u32 v6, v19, 5, v20
s_add_u32 s43, s53, 2
v_xor_b32 v19, s43, v21
s_add_u32 m0, s39, 106496
s_add_u32 s37, s37, s38
buffer_load_dwordx4 v22, s[8:11], s37 offen sc1 lds
v_lshl_add_u32 v7, v19, 5, v20
v_add_u32 v9, 49152, v5
v_add_u32 v10, 49152, v6
s_add_u32 m0, s39, 107520
s_add_u32 s37, s37, s38
buffer_load_dwordx4 v23, s[8:11], s37 offen sc1 lds
v_add_u32 v11, 49152, v7
v_add_u32 v13, 98304, v5
v_add_u32 v14, 98304, v6
s_add_u32 m0, s39, 108544
s_add_u32 s37, s37, s38
buffer_load_dwordx4 v22, s[8:11], s37 offen sc1 lds
v_add_u32 v15, 98304, v7
s_lshl_b32 s43, s46, 9
s_add_u32 s43, s43, 147456
s_add_u32 m0, s39, 109568
s_add_u32 s37, s37, s38
buffer_load_dwordx4 v23, s[8:11], s37 offen sc1 lds
v_lshl_add_u32 v19, v17, 3, s43
ds_read_b64 v[80:81], v19 offset:0
ds_read_b64 v[82:83], v19 offset:128
s_add_u32 m0, s39, 110592
s_add_u32 s37, s37, s38
buffer_load_dwordx4 v22, s[8:11], s37 offen sc1 lds
ds_read_b64 v[84:85], v19 offset:256
ds_read_b64 v[86:87], v19 offset:384
s_mul_i32 s43, s47, 192
s_add_u32 m0, s39, 111616
s_add_u32 s37, s37, s38
buffer_load_dwordx4 v23, s[8:11], s37 offen sc1 lds
s_add_u32 s43, s43, 148992
v_lshl_add_u32 v19, v18, 4, s43
ds_read_b128 v[48:51], v19 offset:0
s_add_u32 m0, s39, 112640
s_add_u32 s37, s37, s38
buffer_load_dwordx4 v22, s[8:11], s37 offen sc1 lds
ds_read_b128 v[52:55], v19 offset:64
ds_read_b128 v[56:59], v19 offset:128
ds_read_b128 v[60:63], v19 offset:896
s_add_u32 m0, s39, 113664
s_add_u32 s37, s37, s38
buffer_load_dwordx4 v23, s[8:11], s37 offen sc1 lds
ds_read_b128 v[64:67], v19 offset:960
ds_read_b128 v[68:71], v19 offset:1024
s_waitcnt vmcnt(16)
s_barrier
s_add_u32 s42, s42, 1
s_and_b32 s42, s42, 15
s_add_u32 m0, s39, 0
s_mul_i32 s37, s42, s40
buffer_load_dwordx4 v22, s[8:11], s37 offen sc1 lds
s_waitcnt lgkmcnt(0)
v_mul_f32 v88, v81, v81
s_add_u32 m0, s39, 1024
s_add_u32 s37, s37, s38
buffer_load_dwordx4 v23, s[8:11], s37 offen sc1 lds
v_mul_f32 v228, 0xc0135761, v81
s_add_u32 m0, s39, 2048
s_add_u32 s37, s37, s38
buffer_load_dwordx4 v22, s[8:11], s37 offen sc1 lds
v_mul_f32 v89, 0xbdd2d3e8, v81
s_add_u32 m0, s39, 3072
s_add_u32 s37, s37, s38
buffer_load_dwordx4 v23, s[8:11], s37 offen sc1 lds
v_rcp_f32 v236, v88
v_mul_f32 v232, v89, v88
s_add_u32 m0, s39, 4096
s_add_u32 s37, s37, s38
buffer_load_dwordx4 v22, s[8:11], s37 offen sc1 lds
v_mul_f32 v88, v83, v83
s_add_u32 m0, s39, 5120
s_add_u32 s37, s37, s38
buffer_load_dwordx4 v23, s[8:11], s37 offen sc1 lds
v_mul_f32 v229, 0xc0135761, v83
s_add_u32 m0, s39, 6144
s_add_u32 s37, s37, s38
buffer_load_dwordx4 v22, s[8:11], s37 offen sc1 lds
v_mul_f32 v89, 0xbdd2d3e8, v83
v_rcp_f32 v237, v88
s_add_u32 m0, s39, 7168
s_add_u32 s37, s37, s38
buffer_load_dwordx4 v23, s[8:11], s37 offen sc1 lds
v_mul_f32 v233, v89, v88
s_add_u32 m0, s39, 8192
s_add_u32 s37, s37, s38
buffer_load_dwordx4 v22, s[8:11], s37 offen sc1 lds
v_mul_f32 v88, v85, v85
s_add_u32 m0, s39, 9216
s_add_u32 s37, s37, s38
buffer_load_dwordx4 v23, s[8:11], s37 offen sc1 lds
v_mul_f32 v230, 0xc0135761, v85
v_mul_f32 v89, 0xbdd2d3e8, v85
s_add_u32 m0, s39, 10240
s_add_u32 s37, s37, s38
buffer_load_dwordx4 v22, s[8:11], s37 offen sc1 lds
v_rcp_f32 v238, v88
s_add_u32 m0, s39, 11264
s_add_u32 s37, s37, s38
buffer_load_dwordx4 v23, s[8:11], s37 offen sc1 lds
v_mul_f32 v234, v89, v88
s_add_u32 m0, s39, 12288
s_add_u32 s37, s37, s38
buffer_load_dwordx4 v22, s[8:11], s37 offen sc1 lds
v_mul_f32 v88, v87, v87
v_mul_f32 v231, 0xc0135761, v87
s_add_u32 m0, s39, 13312
s_add_u32 s37, s37, s38
buffer_load_dwordx4 v23, s[8:11], s37 offen sc1 lds
v_mul_f32 v89, 0xbdd2d3e8, v87
s_add_u32 m0, s39, 14336
s_add_u32 s37, s37, s38
buffer_load_dwordx4 v22, s[8:11], s37 offen sc1 lds
v_rcp_f32 v239, v88
s_add_u32 m0, s39, 15360
s_add_u32 s37, s37, s38
buffer_load_dwordx4 v23, s[8:11], s37 offen sc1 lds
v_mul_f32 v235, v89, v88
s_mul_i32 s43, s34, 917504
s_mul_i32 s44, s49, 24576
s_add_u32 s43, s43, s44
s_add_u32 s43, s43, 8912896
s_add_u32 s24, s32, s43
s_addc_u32 s25, s33, 0
s_mov_b32 s26, 24576
s_mov_b32 s27, 0x20000
s_mov_b32 s53, 262144
s_lshl_b32 s43, s47, 13
s_lshl_b32 s44, s46, 10
s_add_u32 s43, s43, s44
v_lshlrev_b32 v19, 11, v18
v_lshl_add_u32 v19, v17, 4, v19
v_add_u32 v27, s43, v19
s_lshl_b32 s43, s47, 12
s_add_u32 s43, s43, s44
s_add_u32 s43, s43, 16384
v_and_b32 v19, 1, v18
v_lshlrev_b32 v19, 11, v19
v_lshrrev_b32 v20, 1, v18
v_lshl_add_u32 v19, v20, 8, v19
v_lshl_add_u32 v19, v17, 4, v19
v_add_u32 v28, s43, v19
s_load_dword s64, s[80:81], 0
s_load_dword s65, s[80:81], 64
s_load_dword s66, s[80:81], 128
s_load_dword s67, s[80:81], 192
s_load_dword s68, s[80:81], 256
s_load_dword s69, s[80:81], 320
s_load_dword s70, s[80:81], 384
s_load_dword s71, s[80:81], 448
s_add_u32 s80, s80, 512
s_addc_u32 s81, s81, 0
s_waitcnt vmcnt(16)
s_barrier
s_add_u32 s42, s42, 1
s_and_b32 s42, s42, 15
s_add_u32 m0, s39, 49152
s_mul_i32 s37, s42, s40
buffer_load_dwordx4 v22, s[8:11], s37 offen sc1 lds
v_mul_f32 v128, -v80, v48
v_mul_f32 v129, -v80, v49
s_add_u32 m0, s39, 50176
s_add_u32 s37, s37, s38
buffer_load_dwordx4 v23, s[8:11], s37 offen sc1 lds
v_mul_f32 v130, -v80, v50
v_mul_f32 v131, -v80, v51
s_add_u32 m0, s39, 51200
s_add_u32 s37, s37, s38
buffer_load_dwordx4 v22, s[8:11], s37 offen sc1 lds
v_mul_f32 v132, -v82, v48
v_mul_f32 v133, -v82, v49
s_add_u32 m0, s39, 52224
s_add_u32 s37, s37, s38
buffer_load_dwordx4 v23, s[8:11], s37 offen sc1 lds
v_mul_f32 v134, -v82, v50
v_mul_f32 v135, -v82, v51
s_add_u32 m0, s39, 53248
s_add_u32 s37, s37, s38
buffer_load_dwordx4 v22, s[8:11], s37 offen sc1 lds
v_mul_f32 v136, -v84, v48
v_mul_f32 v137, -v84, v49
s_add_u32 m0, s39, 54272
s_add_u32 s37, s37, s38
buffer_load_dwordx4 v23, s[8:11], s37 offen sc1 lds
v_mul_f32 v138, -v84, v50
v_mul_f32 v139, -v84, v51
s_add_u32 m0, s39, 55296
s_add_u32 s37, s37, s38
buffer_load_dwordx4 v22, s[8:11], s37 offen sc1 lds
v_mul_f32 v140, -v86, v48
v_mul_f32 v141, -v86, v49
s_add_u32 m0, s39, 56320
s_add_u32 s37, s37, s38
buffer_load_dwordx4 v23, s[8:11], s37 offen sc1 lds
v_mul_f32 v142, -v86, v50
v_mul_f32 v143, -v86, v51
s_add_u32 m0, s39, 57344
s_add_u32 s37, s37, s38
buffer_load_dwordx4 v22, s[8:11], s37 offen sc1 lds
v_mul_f32 v144, -v80, v52
v_mul_f32 v145, -v80, v53
s_add_u32 m0, s39, 58368
s_add_u32 s37, s37, s38
buffer_load_dwordx4 v23, s[8:11], s37 offen sc1 lds
v_mul_f32 v146, -v80, v54
v_mul_f32 v147, -v80, v55
s_add_u32 m0, s39, 59392
s_add_u32 s37, s37, s38
buffer_load_dwordx4 v22, s[8:11], s37 offen sc1 lds
v_mul_f32 v148, -v82, v52
v_mul_f32 v149, -v82, v53
s_add_u32 m0, s39, 60416
s_add_u32 s37, s37, s38
buffer_load_dwordx4 v23, s[8:11], s37 offen sc1 lds
v_mul_f32 v150, -v82, v54
v_mul_f32 v151, -v82, v55
s_add_u32 m0, s39, 61440
s_add_u32 s37, s37, s38
buffer_load_dwordx4 v22, s[8:11], s37 offen sc1 lds
v_mul_f32 v152, -v84, v52
v_mul_f32 v153, -v84, v53
s_add_u32 m0, s39, 62464
s_add_u32 s37, s37, s38
buffer_load_dwordx4 v23, s[8:11], s37 offen sc1 lds
v_mul_f32 v154, -v84, v54
v_mul_f32 v155, -v84, v55
s_add_u32 m0, s39, 63488
s_add_u32 s37, s37, s38
buffer_load_dwordx4 v22, s[8:11], s37 offen sc1 lds
v_mul_f32 v156, -v86, v52
v_mul_f32 v157, -v86, v53
s_add_u32 m0, s39, 64512
s_add_u32 s37, s37, s38
buffer_load_dwordx4 v23, s[8:11], s37 offen sc1 lds
v_mul_f32 v158, -v86, v54
v_mul_f32 v159, -v86, v55
s_load_dword s64, s[80:81], 0
s_load_dword s65, s[80:81], 64
s_load_dword s66, s[80:81], 128
s_load_dword s67, s[80:81], 192
s_load_dword s68, s[80:81], 256
s_load_dword s69, s[80:81], 320
s_load_dword s70, s[80:81], 384
s_load_dword s71, s[80:81], 448
s_add_u32 s80, s80, 512
s_addc_u32 s81, s81, 0
s_waitcnt vmcnt(16)
s_barrier
s_add_u32 s42, s42, 1
s_and_b32 s42, s42, 15
s_add_u32 m0, s39, 98304
s_mul_i32 s37, s42, s40
buffer_load_dwordx4 v22, s[8:11], s37 offen sc1 lds
v_mul_f32 v160, -v80, v56
v_mul_f32 v161, -v80, v57
s_add_u32 m0, s39, 99328
s_add_u32 s37, s37, s38
buffer_load_dwordx4 v23, s[8:11], s37 offen sc1 lds
v_mul_f32 v162, -v80, v58
v_mul_f32 v163, -v80, v59
s_add_u32 m0, s39, 100352
s_add_u32 s37, s37, s38
buffer_load_dwordx4 v22, s[8:11], s37 offen sc1 lds
v_mul_f32 v164, -v82, v56
v_mul_f32 v165, -v82, v57
s_add_u32 m0, s39, 101376
s_add_u32 s37, s37, s38
buffer_load_dwordx4 v23, s[8:11], s37 offen sc1 lds
v_mul_f32 v166, -v82, v58
v_mul_f32 v167, -v82, v59
s_add_u32 m0, s39, 102400
s_add_u32 s37, s37, s38
buffer_load_dwordx4 v22, s[8:11], s37 offen sc1 lds
v_mul_f32 v168, -v84, v56
v_mul_f32 v169, -v84, v57
s_add_u32 m0, s39, 103424
s_add_u32 s37, s37, s38
buffer_load_dwordx4 v23, s[8:11], s37 offen sc1 lds
v_mul_f32 v170, -v84, v58
v_mul_f32 v171, -v84, v59
s_add_u32 m0, s39, 104448
s_add_u32 s37, s37, s38
buffer_load_dwordx4 v22, s[8:11], s37 offen sc1 lds
v_mul_f32 v172, -v86, v56
v_mul_f32 v173, -v86, v57
s_add_u32 m0, s39, 105472
s_add_u32 s37, s37, s38
buffer_load_dwordx4 v23, s[8:11], s37 offen sc1 lds
v_mul_f32 v174, -v86, v58
v_mul_f32 v175, -v86, v59
s_add_u32 m0, s39, 106496
s_add_u32 s37, s37, s38
buffer_load_dwordx4 v22, s[8:11], s37 offen sc1 lds
v_mul_f32 v176, -v80, v60
v_mul_f32 v177, -v80, v61
s_add_u32 m0, s39, 107520
s_add_u32 s37, s37, s38
buffer_load_dwordx4 v23, s[8:11], s37 offen sc1 lds
v_mul_f32 v178, -v80, v62
v_mul_f32 v179, -v80, v63
s_add_u32 m0, s39, 108544
s_add_u32 s37, s37, s38
buffer_load_dwordx4 v22, s[8:11], s37 offen sc1 lds
v_mul_f32 v180, -v82, v60
v_mul_f32 v181, -v82, v61
s_add_u32 m0, s39, 109568
s_add_u32 s37, s37, s38
buffer_load_dwordx4 v23, s[8:11], s37 offen sc1 lds
v_mul_f32 v182, -v82, v62
v_mul_f32 v183, -v82, v63
s_add_u32 m0, s39, 110592
s_add_u32 s37, s37, s38
buffer_load_dwordx4 v22, s[8:11], s37 offen sc1 lds
v_mul_f32 v184, -v84, v60
v_mul_f32 v185, -v84, v61
s_add_u32 m0, s39, 111616
s_add_u32 s37, s37, s38
buffer_load_dwordx4 v23, s[8:11], s37 offen sc1 lds
v_mul_f32 v186, -v84, v62
v_mul_f32 v187, -v84, v63
s_add_u32 m0, s39, 112640
s_add_u32 s37, s37, s38
buffer_load_dwordx4 v22, s[8:11], s37 offen sc1 lds
v_mul_f32 v188, -v86, v60
v_mul_f32 v189, -v86, v61
s_add_u32 m0, s39, 113664
s_add_u32 s37, s37, s38
buffer_load_dwordx4 v23, s[8:11], s37 offen sc1 lds
v_mul_f32 v190, -v86, v62
v_mul_f32 v191, -v86, v63
s_load_dword s64, s[80:81], 0
s_load_dword s65, s[80:81], 64
s_load_dword s66, s[80:81], 128
s_load_dword s67, s[80:81], 192
s_load_dword s68, s[80:81], 256
s_load_dword s69, s[80:81], 320
s_load_dword s70, s[80:81], 384
s_load_dword s71, s[80:81], 448
s_add_u32 s80, s80, 512
s_addc_u32 s81, s81, 0
s_waitcnt vmcnt(16)
s_barrier
s_mul_i32 s43, s49, 192
s_and_b32 s43, s43, 0xffffff80
s_add_u32 s43, s43, 4096
s_cmp_eq_u32 s51, 1
s_cselect_b32 s8, s4, s6
s_cselect_b32 s9, s5, s7
s_sub_u32 s10, 7340032, s43
s_lshl_b32 s44, s34, 18
s_add_u32 s44, s44, 4194304
s_movk_i32 s38, 28672
s_cmp_eq_u32 s51, 0
s_cselect_b32 s8, s32, s8
s_cselect_b32 s9, s33, s9
s_cselect_b32 s10, 262144, s10
s_cselect_b32 s43, s44, s43
s_cselect_b32 s38, 1024, s38
s_cselect_b32 s45, 0, -1
s_add_u32 s8, s8, s43
s_addc_u32 s9, s9, 0
s_mov_b32 s11, 0x20000
s_lshl_b32 s40, s38, 4
s_add_u32 s42, s35, 15
s_lshl_b32 s39, s51, 14
v_lshrrev_b32 v19, 4, v1
v_lshlrev_b32 v20, 5, v19
v_mul_u32_u24 v19, 6912, v19
v_and_b32 v19, s45, v19
v_and_b32 v20, s45, v20
v_lshlrev_b32 v21, 4, v1
v_xor_b32 v21, v21, v20
v_add_u32 v22, v21, v19
s_and_b32 s45, s45, 128
v_xor_b32 v23, s45, v22
s_add_u32 s42, s42, 1
s_and_b32 s42, s42, 15
s_add_u32 m0, s39, 0
s_mul_i32 s37, s42, s40
buffer_load_dwordx4 v22, s[8:11], s37 offen sc1 lds
v_mul_f32 v192, -v80, v64
v_mul_f32 v193, -v80, v65
s_add_u32 m0, s39, 1024
s_add_u32 s37, s37, s38
buffer_load_dwordx4 v23, s[8:11], s37 offen sc1 lds
v_mul_f32 v194, -v80, v66
v_mul_f32 v195, -v80, v67
s_add_u32 m0, s39, 2048
s_add_u32 s37, s37, s38
buffer_load_dwordx4 v22, s[8:11], s37 offen sc1 lds
v_mul_f32 v196, -v82, v64
v_mul_f32 v197, -v82, v65
s_add_u32 m0, s39, 3072
s_add_u32 s37, s37, s38
buffer_load_dwordx4 v23, s[8:11], s37 offen sc1 lds
v_mul_f32 v198, -v82, v66
v_mul_f32 v199, -v82, v67
s_add_u32 m0, s39, 4096
s_add_u32 s37, s37, s38
buffer_load_dwordx4 v22, s[8:11], s37 offen sc1 lds
v_mul_f32 v200, -v84, v64
v_mul_f32 v201, -v84, v65
s_add_u32 m0, s39, 5120
s_add_u32 s37, s37, s38
buffer_load_dwordx4 v23, s[8:11], s37 offen sc1 lds
v_mul_f32 v202, -v84, v66
v_mul_f32 v203, -v84, v67
s_add_u32 m0, s39, 6144
s_add_u32 s37, s37, s38
buffer_load_dwordx4 v22, s[8:11], s37 offen sc1 lds
v_mul_f32 v204, -v86, v64
v_mul_f32 v205, -v86, v65
s_add_u32 m0, s39, 7168
s_add_u32 s37, s37, s38
buffer_load_dwordx4 v23, s[8:11], s37 offen sc1 lds
v_mul_f32 v206, -v86, v66
v_mul_f32 v207, -v86, v67
s_add_u32 m0, s39, 8192
s_add_u32 s37, s37, s38
buffer_load_dwordx4 v22, s[8:11], s37 offen sc1 lds
v_mul_f32 v208, -v80, v68
v_mul_f32 v209, -v80, v69
s_add_u32 m0, s39, 9216
s_add_u32 s37, s37, s38
buffer_load_dwordx4 v23, s[8:11], s37 offen sc1 lds
v_mul_f32 v210, -v80, v70
v_mul_f32 v211, -v80, v71
s_add_u32 m0, s39, 10240
s_add_u32 s37, s37, s38
buffer_load_dwordx4 v22, s[8:11], s37 offen sc1 lds
v_mul_f32 v212, -v82, v68
v_mul_f32 v213, -v82, v69
s_add_u32 m0, s39, 11264
s_add_u32 s37, s37, s38
buffer_load_dwordx4 v23, s[8:11], s37 offen sc1 lds
v_mul_f32 v214, -v82, v70
v_mul_f32 v215, -v82, v71
s_add_u32 m0, s39, 12288
s_add_u32 s37, s37, s38
buffer_load_dwordx4 v22, s[8:11], s37 offen sc1 lds
v_mul_f32 v216, -v84, v68
v_mul_f32 v217, -v84, v69
s_add_u32 m0, s39, 13312
s_add_u32 s37, s37, s38
buffer_load_dwordx4 v23, s[8:11], s37 offen sc1 lds
v_mul_f32 v218, -v84, v70
v_mul_f32 v219, -v84, v71
s_add_u32 m0, s39, 14336
s_add_u32 s37, s37, s38
buffer_load_dwordx4 v22, s[8:11], s37 offen sc1 lds
v_mul_f32 v220, -v86, v68
v_mul_f32 v221, -v86, v69
s_add_u32 m0, s39, 15360
s_add_u32 s37, s37, s38
buffer_load_dwordx4 v23, s[8:11], s37 offen sc1 lds
v_mul_f32 v222, -v86, v70
v_mul_f32 v223, -v86, v71
s_load_dword s64, s[80:81], 0
s_load_dword s65, s[80:81], 64
s_load_dword s66, s[80:81], 128
s_load_dword s67, s[80:81], 192
s_load_dword s68, s[80:81], 256
s_load_dword s69, s[80:81], 320
s_load_dword s70, s[80:81], 384
s_add_u32 s80, s80, 448
s_addc_u32 s81, s81, 0
s_waitcnt vmcnt(16)
s_barrier
s_add_u32 s42, s42, 1
s_and_b32 s42, s42, 15
s_add_u32 m0, s39, 49152
s_mul_i32 s37, s42, s40
buffer_load_dwordx4 v22, s[8:11], s37 offen sc1 lds
s_add_u32 m0, s39, 50176
s_add_u32 s37, s37, s38
buffer_load_dwordx4 v23, s[8:11], s37 offen sc1 lds
s_add_u32 m0, s39, 51200
s_add_u32 s37, s37, s38
buffer_load_dwordx4 v22, s[8:11], s37 offen sc1 lds
s_add_u32 m0, s39, 52224
s_add_u32 s37, s37, s38
buffer_load_dwordx4 v23, s[8:11], s37 offen sc1 lds
s_add_u32 m0, s39, 53248
s_add_u32 s37, s37, s38
buffer_load_dwordx4 v22, s[8:11], s37 offen sc1 lds
s_add_u32 m0, s39, 54272
s_add_u32 s37, s37, s38
buffer_load_dwordx4 v23, s[8:11], s37 offen sc1 lds
s_add_u32 m0, s39, 55296
s_add_u32 s37, s37, s38
buffer_load_dwordx4 v22, s[8:11], s37 offen sc1 lds
s_add_u32 m0, s39, 56320
s_add_u32 s37, s37, s38
buffer_load_dwordx4 v23, s[8:11], s37 offen sc1 lds
s_add_u32 m0, s39, 57344
s_add_u32 s37, s37, s38
buffer_load_dwordx4 v22, s[8:11], s37 offen sc1 lds
s_add_u32 m0, s39, 58368
s_add_u32 s37, s37, s38
buffer_load_dwordx4 v23, s[8:11], s37 offen sc1 lds
s_add_u32 m0, s39, 59392
s_add_u32 s37, s37, s38
buffer_load_dwordx4 v22, s[8:11], s37 offen sc1 lds
s_add_u32 m0, s39, 60416
s_add_u32 s37, s37, s38
buffer_load_dwordx4 v23, s[8:11], s37 offen sc1 lds
s_add_u32 m0, s39, 61440
s_add_u32 s37, s37, s38
buffer_load_dwordx4 v22, s[8:11], s37 offen sc1 lds
s_add_u32 m0, s39, 62464
s_add_u32 s37, s37, s38
buffer_load_dwordx4 v23, s[8:11], s37 offen sc1 lds
s_add_u32 m0, s39, 63488
s_add_u32 s37, s37, s38
buffer_load_dwordx4 v22, s[8:11], s37 offen sc1 lds
s_add_u32 m0, s39, 64512
s_add_u32 s37, s37, s38
buffer_load_dwordx4 v23, s[8:11], s37 offen sc1 lds
s_mul_i32 s44, s34, 917504
s_lshl_b32 s39, s51, 13
s_add_u32 s44, s44, s39
s_add_u32 s44, s44, 8388608
s_and_b32 s43, s51, 1
s_xor_b32 s43, s43, s35
s_lshl_b32 s43, s43, 7
s_mov_b32 s10, 909312
s_movk_i32 s38, 1024
s_movk_i32 s40, 9216
s_movk_i32 s37, 0x4000
s_cmp_ge_u32 s51, 2
s_cselect_b32 s8, s60, s32
s_cselect_b32 s9, s61, s33
s_cselect_b32 s10, 7338112, s10
s_cselect_b32 s43, s43, s44
s_cselect_b32 s38, 16384, s38
s_cselect_b32 s40, 81920, s40
s_cselect_b32 s55, 81920, s38
s_cselect_b32 s37, 262144, s37
s_cselect_b32 s45, -1, 0
s_add_u32 s8, s8, s43
s_addc_u32 s9, s9, 0
s_mov_b32 s11, 0x20000
s_and_b32 s53, s35, 1
s_mul_i32 s54, s53, 6
s_mul_i32 s54, s54, s37
s_mul_i32 s29, s53, 2
s_add_u32 s29, s29, 6
s_mul_i32 s29, s29, s37
s_and_b32 s43, s45, 4290838528
s_add_u32 s29, s29, s43
s_mul_i32 s37, s37, 2
s_sub_u32 s37, s37, s40
v_lshrrev_b32 v19, 3, v1
v_mul_u32_u24 v19, 1920, v19
v_lshrrev_b32 v20, 4, v1
v_lshlrev_b32 v20, 5, v20
v_and_b32 v19, s45, v19
v_and_b32 v20, s45, v20
v_lshlrev_b32 v21, 4, v1
v_xor_b32 v21, v21, v20
v_add_u32 v21, v21, v19
s_waitcnt vmcnt(16)
s_barrier
s_branch LK3b_102
.p2align 6
Lw_38:
s_branch Lr_39
s_nop 0
.p2align 3
L7_101:
s_lshr_b32 s43, s2, 5
s_cmp_eq_u32 s43, 3
s_cbranch_scc1 Lnojob_108
s_cmp_gt_u32 s43, 3
s_cselect_b32 s43, 32, 0
s_sub_u32 s43, s2, s43
s_lshr_b32 s43, s43, 1
s_and_b32 s44, s2, 1
s_cmp_eq_u32 s44, 0
s_cselect_b32 s68, s4, s6
s_cselect_b32 s69, s5, s7
s_mul_i32 s45, s43, 2341
s_lshr_b32 s45, s45, 16
s_mul_i32 s46, s45, 28
s_sub_u32 s46, s43, s46
v_lshrrev_b32 v4, 4, v1
s_lshl_b32 s43, s45, 8
v_add_u32 v4, s43, v4
v_mul_u32_u24 v4, 7168, v4
v_and_b32 v5, 15, v1
v_lshl_add_u32 v4, v5, 4, v4
s_lshl_b32 s43, s46, 8
v_add_u32 v4, s43, v4
s_mov_b32 s64, s68
s_mov_b32 s65, s69
s_mov_b32 s66, 7340032
s_mov_b32 s67, 0x20000
s_lshl_b32 s55, s45, 1
s_add_u32 s55, s55, s44
s_mul_i32 s55, s55, 14336
s_lshl_b32 s45, s46, 9
s_mov_b32 s50, s46
s_add_u32 s55, s55, s45
v_lshl_add_u32 v5, v5, 5, s55
s_add_u32 s72, s32, 27262976
s_addc_u32 s73, s33, 0
s_mov_b32 s74, 114688
s_mov_b32 s75, 0x20000
v_mov_b32 v32, 0
v_mov_b32 v33, 0
v_mov_b32 v34, 0
v_mov_b32 v35, 0
v_mov_b32 v36, 0
v_mov_b32 v37, 0
v_mov_b32 v38, 0
v_mov_b32 v39, 0
s_lshl_b32 s43, s34, 18
s_add_u32 s12, s32, s43
s_addc_u32 s13, s33, 0
s_mov_b32 s14, 262144
s_mov_b32 s15, 0x20000
v_lshlrev_b32 v21, 4, v1
s_lshl_b32 s54, s36, 11
s_add_u32 s43, s35, 1
s_and_b32 s43, s43, 15
s_lshl_b32 s43, s43, 14
s_add_u32 s30, s43, s54
s_add_u32 s43, s35, 2
s_and_b32 s43, s43, 15
s_lshl_b32 s43, s43, 14
s_add_u32 s31, s43, s54
s_waitcnt vmcnt(0)
s_barrier
ds_write_b128 v27, v[68:71] offset:0
ds_write_b128 v27, v[116:119] offset:512
s_mov_b32 s43, 917504
buffer_load_dwordx4 v[56:59], v4, s[64:67], s43 offen
s_mov_b32 s43, 946176
buffer_load_dwordx4 v[60:63], v4, s[64:67], s43 offen
s_mov_b32 s43, 974848
buffer_load_dwordx4 v[64:67], v4, s[64:67], s43 offen
s_mov_b32 s43, 1003520
buffer_load_dwordx4 v[72:75], v4, s[64:67], s43 offen
s_mov_b32 s43, 1032192
buffer_load_dwordx4 v[76:79], v4, s[64:67], s43 offen
s_mov_b32 s43, 1060864
buffer_load_dwordx4 v[80:83], v4, s[64:67], s43 offen
s_mov_b32 s43, 1089536
buffer_load_dwordx4 v[84:87], v4, s[64:67], s43 offen
s_mov_b32 s43, 1118208
buffer_load_dwordx4 v[88:91], v4, s[64:67], s43 offen
s_mov_b32 s43, 1146880
buffer_load_dwordx4 v[92:95], v4, s[64:67], s43 offen
s_mov_b32 s43, 1175552
buffer_load_dwordx4 v[96:99], v4, s[64:67], s43 offen
s_mov_b32 s43, 1204224
buffer_load_dwordx4 v[100:103], v4, s[64:67], s43 offen
s_mov_b32 s43, 1232896
buffer_load_dwordx4 v[104:107], v4, s[64:67], s43 offen
s_mov_b32 s43, 1261568
buffer_load_dwordx4 v[108:111], v4, s[64:67], s43 offen
s_mov_b32 s43, 1290240
buffer_load_dwordx4 v[112:115], v4, s[64:67], s43 offen
s_mov_b32 s43, 1318912
buffer_load_dwordx4 v[120:123], v4, s[64:67], s43 offen
s_mov_b32 s43, 1347584
buffer_load_dwordx4 v[124:127], v4, s[64:67], s43 offen
v_lshlrev_b32 v40, 16, v128
v_and_b32 v41, 0xffff0000, v128
v_lshlrev_b32 v42, 16, v129
v_and_b32 v43, 0xffff0000, v129
v_lshlrev_b32 v44, 16, v130
v_and_b32 v45, 0xffff0000, v130
v_lshlrev_b32 v46, 16, v131
v_and_b32 v47, 0xffff0000, v131
v_pk_add_f32 v[32:33], v[32:33], v[40:41]
v_pk_add_f32 v[34:35], v[34:35], v[42:43]
v_pk_add_f32 v[36:37], v[36:37], v[44:45]
v_pk_add_f32 v[38:39], v[38:39], v[46:47]
v_lshlrev_b32 v48, 16, v132
v_and_b32 v49, 0xffff0000, v132
v_lshlrev_b32 v50, 16, v133
v_and_b32 v51, 0xffff0000, v133
v_lshlrev_b32 v52, 16, v134
v_and_b32 v53, 0xffff0000, v134
v_lshlrev_b32 v54, 16, v135
v_and_b32 v55, 0xffff0000, v135
v_pk_add_f32 v[32:33], v[32:33], v[48:49]
v_pk_add_f32 v[34:35], v[34:35], v[50:51]
v_pk_add_f32 v[36:37], v[36:37], v[52:53]
v_pk_add_f32 v[38:39], v[38:39], v[54:55]
v_lshlrev_b32 v40, 16, v136
v_and_b32 v41, 0xffff0000, v136
v_lshlrev_b32 v42, 16, v137
v_and_b32 v43, 0xffff0000, v137
v_lshlrev_b32 v44, 16, v138
v_and_b32 v45, 0xffff0000, v138
v_lshlrev_b32 v46, 16, v139
v_and_b32 v47, 0xffff0000, v139
v_pk_add_f32 v[32:33], v[32:33], v[40:41]
v_pk_add_f32 v[34:35], v[34:35], v[42:43]
v_pk_add_f32 v[36:37], v[36:37], v[44:45]
v_pk_add_f32 v[38:39], v[38:39], v[46:47]
v_lshlrev_b32 v48, 16, v140
v_and_b32 v49, 0xffff0000, v140
v_lshlrev_b32 v50, 16, v141
v_and_b32 v51, 0xffff0000, v141
v_lshlrev_b32 v52, 16, v142
v_and_b32 v53, 0xffff0000, v142
v_lshlrev_b32 v54, 16, v143
v_and_b32 v55, 0xffff0000, v143
v_pk_add_f32 v[32:33], v[32:33], v[48:49]
v_pk_add_f32 v[34:35], v[34:35], v[50:51]
v_pk_add_f32 v[36:37], v[36:37], v[52:53]
v_pk_add_f32 v[38:39], v[38:39], v[54:55]
v_lshlrev_b32 v40, 16, v144
v_and_b32 v41, 0xffff0000, v144
v_lshlrev_b32 v42, 16, v145
v_and_b32 v43, 0xffff0000, v145
v_lshlrev_b32 v44, 16, v146
v_and_b32 v45, 0xffff0000, v146
v_lshlrev_b32 v46, 16, v147
v_and_b32 v47, 0xffff0000, v147
v_pk_add_f32 v[32:33], v[32:33], v[40:41]
v_pk_add_f32 v[34:35], v[34:35], v[42:43]
v_pk_add_f32 v[36:37], v[36:37], v[44:45]
v_pk_add_f32 v[38:39], v[38:39], v[46:47]
v_lshlrev_b32 v48, 16, v148
v_and_b32 v49, 0xffff0000, v148
v_lshlrev_b32 v50, 16, v149
v_and_b32 v51, 0xffff0000, v149
v_lshlrev_b32 v52, 16, v150
v_and_b32 v53, 0xffff0000, v150
v_lshlrev_b32 v54, 16, v151
v_and_b32 v55, 0xffff0000, v151
v_pk_add_f32 v[32:33], v[32:33], v[48:49]
v_pk_add_f32 v[34:35], v[34:35], v[50:51]
v_pk_add_f32 v[36:37], v[36:37], v[52:53]
v_pk_add_f32 v[38:39], v[38:39], v[54:55]
v_lshlrev_b32 v40, 16, v152
v_and_b32 v41, 0xffff0000, v152
v_lshlrev_b32 v42, 16, v153
v_and_b32 v43, 0xffff0000, v153
v_lshlrev_b32 v44, 16, v154
v_and_b32 v45, 0xffff0000, v154
v_lshlrev_b32 v46, 16, v155
v_and_b32 v47, 0xffff0000, v155
v_pk_add_f32 v[32:33], v[32:33], v[40:41]
v_pk_add_f32 v[34:35], v[34:35], v[42:43]
v_pk_add_f32 v[36:37], v[36:37], v[44:45]
v_pk_add_f32 v[38:39], v[38:39], v[46:47]
v_lshlrev_b32 v48, 16, v156
v_and_b32 v49, 0xffff0000, v156
v_lshlrev_b32 v50, 16, v157
v_and_b32 v51, 0xffff0000, v157
v_lshlrev_b32 v52, 16, v158
v_and_b32 v53, 0xffff0000, v158
v_lshlrev_b32 v54, 16, v159
v_and_b32 v55, 0xffff0000, v159
v_pk_add_f32 v[32:33], v[32:33], v[48:49]
v_pk_add_f32 v[34:35], v[34:35], v[50:51]
v_pk_add_f32 v[36:37], v[36:37], v[52:53]
v_pk_add_f32 v[38:39], v[38:39], v[54:55]
s_waitcnt lgkmcnt(0)
s_barrier
s_add_u32 m0, s54, 16384
s_add_u32 s43, s30, 0
buffer_load_dwordx4 v21, s[12:15], s43 offen sc1 lds
s_add_u32 m0, s54, 17408
s_add_u32 s43, s30, 1024
buffer_load_dwordx4 v21, s[12:15], s43 offen sc1 lds
s_add_u32 m0, s54, 32768
s_add_u32 s43, s31, 0
buffer_load_dwordx4 v21, s[12:15], s43 offen sc1 lds
s_add_u32 m0, s54, 33792
s_add_u32 s43, s31, 1024
buffer_load_dwordx4 v21, s[12:15], s43 offen sc1 lds
s_waitcnt vmcnt(2)
s_barrier
s_waitcnt vmcnt(0)
s_barrier
v_lshlrev_b32 v40, 16, v160
v_and_b32 v41, 0xffff0000, v160
v_lshlrev_b32 v42, 16, v161
v_and_b32 v43, 0xffff0000, v161
v_lshlrev_b32 v44, 16, v162
v_and_b32 v45, 0xffff0000, v162
v_lshlrev_b32 v46, 16, v163
v_and_b32 v47, 0xffff0000, v163
v_pk_add_f32 v[32:33], v[32:33], v[40:41]
v_pk_add_f32 v[34:35], v[34:35], v[42:43]
v_pk_add_f32 v[36:37], v[36:37], v[44:45]
v_pk_add_f32 v[38:39], v[38:39], v[46:47]
v_lshlrev_b32 v48, 16, v164
v_and_b32 v49, 0xffff0000, v164
v_lshlrev_b32 v50, 16, v165
v_and_b32 v51, 0xffff0000, v165
v_lshlrev_b32 v52, 16, v166
v_and_b32 v53, 0xffff0000, v166
v_lshlrev_b32 v54, 16, v167
v_and_b32 v55, 0xffff0000, v167
v_pk_add_f32 v[32:33], v[32:33], v[48:49]
v_pk_add_f32 v[34:35], v[34:35], v[50:51]
v_pk_add_f32 v[36:37], v[36:37], v[52:53]
v_pk_add_f32 v[38:39], v[38:39], v[54:55]
v_lshlrev_b32 v40, 16, v168
v_and_b32 v41, 0xffff0000, v168
v_lshlrev_b32 v42, 16, v169
v_and_b32 v43, 0xffff0000, v169
v_lshlrev_b32 v44, 16, v170
v_and_b32 v45, 0xffff0000, v170
v_lshlrev_b32 v46, 16, v171
v_and_b32 v47, 0xffff0000, v171
v_pk_add_f32 v[32:33], v[32:33], v[40:41]
v_pk_add_f32 v[34:35], v[34:35], v[42:43]
v_pk_add_f32 v[36:37], v[36:37], v[44:45]
v_pk_add_f32 v[38:39], v[38:39], v[46:47]
v_lshlrev_b32 v48, 16, v172
v_and_b32 v49, 0xffff0000, v172
v_lshlrev_b32 v50, 16, v173
v_and_b32 v51, 0xffff0000, v173
v_lshlrev_b32 v52, 16, v174
v_and_b32 v53, 0xffff0000, v174
v_lshlrev_b32 v54, 16, v175
v_and_b32 v55, 0xffff0000, v175
v_pk_add_f32 v[32:33], v[32:33], v[48:49]
v_pk_add_f32 v[34:35], v[34:35], v[50:51]
v_pk_add_f32 v[36:37], v[36:37], v[52:53]
v_pk_add_f32 v[38:39], v[38:39], v[54:55]
s_barrier
v_lshlrev_b32 v40, 16, v176
v_and_b32 v41, 0xffff0000, v176
v_lshlrev_b32 v42, 16, v177
v_and_b32 v43, 0xffff0000, v177
v_lshlrev_b32 v44, 16, v178
v_and_b32 v45, 0xffff0000, v178
v_lshlrev_b32 v46, 16, v179
v_and_b32 v47, 0xffff0000, v179
v_pk_add_f32 v[32:33], v[32:33], v[40:41]
v_pk_add_f32 v[34:35], v[34:35], v[42:43]
v_pk_add_f32 v[36:37], v[36:37], v[44:45]
v_pk_add_f32 v[38:39], v[38:39], v[46:47]
v_lshlrev_b32 v48, 16, v180
v_and_b32 v49, 0xffff0000, v180
v_lshlrev_b32 v50, 16, v181
v_and_b32 v51, 0xffff0000, v181
v_lshlrev_b32 v52, 16, v182
v_and_b32 v53, 0xffff0000, v182
v_lshlrev_b32 v54, 16, v183
v_and_b32 v55, 0xffff0000, v183
v_pk_add_f32 v[32:33], v[32:33], v[48:49]
v_pk_add_f32 v[34:35], v[34:35], v[50:51]
v_pk_add_f32 v[36:37], v[36:37], v[52:53]
v_pk_add_f32 v[38:39], v[38:39], v[54:55]
v_lshlrev_b32 v40, 16, v184
v_and_b32 v41, 0xffff0000, v184
v_lshlrev_b32 v42, 16, v185
v_and_b32 v43, 0xffff0000, v185
v_lshlrev_b32 v44, 16, v186
v_and_b32 v45, 0xffff0000, v186
v_lshlrev_b32 v46, 16, v187
v_and_b32 v47, 0xffff0000, v187
v_pk_add_f32 v[32:33], v[32:33], v[40:41]
v_pk_add_f32 v[34:35], v[34:35], v[42:43]
v_pk_add_f32 v[36:37], v[36:37], v[44:45]
v_pk_add_f32 v[38:39], v[38:39], v[46:47]
v_lshlrev_b32 v48, 16, v188
v_and_b32 v49, 0xffff0000, v188
v_lshlrev_b32 v50, 16, v189
v_and_b32 v51, 0xffff0000, v189
v_lshlrev_b32 v52, 16, v190
v_and_b32 v53, 0xffff0000, v190
v_lshlrev_b32 v54, 16, v191
v_and_b32 v55, 0xffff0000, v191
v_pk_add_f32 v[32:33], v[32:33], v[48:49]
v_pk_add_f32 v[34:35], v[34:35], v[50:51]
v_pk_add_f32 v[36:37], v[36:37], v[52:53]
v_pk_add_f32 v[38:39], v[38:39], v[54:55]
s_barrier
s_add_u32 s43, s34, 0
s_lshl_b32 s43, s43, 7
v_mov_b32 v8, s43
v_mov_b32 v10, 16
buffer_load_dword v9, v8, s[56:59], 0 offen sc1
v_lshlrev_b32 v40, 16, v192
v_and_b32 v41, 0xffff0000, v192
v_lshlrev_b32 v42, 16, v193
v_and_b32 v43, 0xffff0000, v193
v_lshlrev_b32 v44, 16, v194
v_and_b32 v45, 0xffff0000, v194
v_lshlrev_b32 v46, 16, v195
v_and_b32 v47, 0xffff0000, v195
v_pk_add_f32 v[32:33], v[32:33], v[40:41]
v_pk_add_f32 v[34:35], v[34:35], v[42:43]
v_pk_add_f32 v[36:37], v[36:37], v[44:45]
v_pk_add_f32 v[38:39], v[38:39], v[46:47]
v_lshlrev_b32 v48, 16, v196
v_and_b32 v49, 0xffff0000, v196
v_lshlrev_b32 v50, 16, v197
v_and_b32 v51, 0xffff0000, v197
v_lshlrev_b32 v52, 16, v198
v_and_b32 v53, 0xffff0000, v198
v_lshlrev_b32 v54, 16, v199
v_and_b32 v55, 0xffff0000, v199
v_pk_add_f32 v[32:33], v[32:33], v[48:49]
v_pk_add_f32 v[34:35], v[34:35], v[50:51]
v_pk_add_f32 v[36:37], v[36:37], v[52:53]
v_pk_add_f32 v[38:39], v[38:39], v[54:55]
v_lshlrev_b32 v40, 16, v200
v_and_b32 v41, 0xffff0000, v200
v_lshlrev_b32 v42, 16, v201
v_and_b32 v43, 0xffff0000, v201
v_lshlrev_b32 v44, 16, v202
v_and_b32 v45, 0xffff0000, v202
v_lshlrev_b32 v46, 16, v203
v_and_b32 v47, 0xffff0000, v203
v_pk_add_f32 v[32:33], v[32:33], v[40:41]
v_pk_add_f32 v[34:35], v[34:35], v[42:43]
v_pk_add_f32 v[36:37], v[36:37], v[44:45]
v_pk_add_f32 v[38:39], v[38:39], v[46:47]
v_lshlrev_b32 v48, 16, v204
v_and_b32 v49, 0xffff0000, v204
v_lshlrev_b32 v50, 16, v205
v_and_b32 v51, 0xffff0000, v205
v_lshlrev_b32 v52, 16, v206
v_and_b32 v53, 0xffff0000, v206
v_lshlrev_b32 v54, 16, v207
v_and_b32 v55, 0xffff0000, v207
v_pk_add_f32 v[32:33], v[32:33], v[48:49]
v_pk_add_f32 v[34:35], v[34:35], v[50:51]
v_pk_add_f32 v[36:37], v[36:37], v[52:53]
v_pk_add_f32 v[38:39], v[38:39], v[54:55]
s_barrier
v_lshlrev_b32 v40, 16, v208
v_and_b32 v41, 0xffff0000, v208
v_lshlrev_b32 v42, 16, v209
v_and_b32 v43, 0xffff0000, v209
v_lshlrev_b32 v44, 16, v210
v_and_b32 v45, 0xffff0000, v210
v_lshlrev_b32 v46, 16, v211
v_and_b32 v47, 0xffff0000, v211
v_pk_add_f32 v[32:33], v[32:33], v[40:41]
v_pk_add_f32 v[34:35], v[34:35], v[42:43]
v_pk_add_f32 v[36:37], v[36:37], v[44:45]
v_pk_add_f32 v[38:39], v[38:39], v[46:47]
v_lshlrev_b32 v48, 16, v212
v_and_b32 v49, 0xffff0000, v212
v_lshlrev_b32 v50, 16, v213
v_and_b32 v51, 0xffff0000, v213
v_lshlrev_b32 v52, 16, v214
v_and_b32 v53, 0xffff0000, v214
v_lshlrev_b32 v54, 16, v215
v_and_b32 v55, 0xffff0000, v215
v_pk_add_f32 v[32:33], v[32:33], v[48:49]
v_pk_add_f32 v[34:35], v[34:35], v[50:51]
v_pk_add_f32 v[36:37], v[36:37], v[52:53]
v_pk_add_f32 v[38:39], v[38:39], v[54:55]
v_lshlrev_b32 v40, 16, v216
v_and_b32 v41, 0xffff0000, v216
v_lshlrev_b32 v42, 16, v217
v_and_b32 v43, 0xffff0000, v217
v_lshlrev_b32 v44, 16, v218
v_and_b32 v45, 0xffff0000, v218
v_lshlrev_b32 v46, 16, v219
v_and_b32 v47, 0xffff0000, v219
v_pk_add_f32 v[32:33], v[32:33], v[40:41]
v_pk_add_f32 v[34:35], v[34:35], v[42:43]
v_pk_add_f32 v[36:37], v[36:37], v[44:45]
v_pk_add_f32 v[38:39], v[38:39], v[46:47]
v_lshlrev_b32 v48, 16, v220
v_and_b32 v49, 0xffff0000, v220
v_lshlrev_b32 v50, 16, v221
v_and_b32 v51, 0xffff0000, v221
v_lshlrev_b32 v52, 16, v222
v_and_b32 v53, 0xffff0000, v222
v_lshlrev_b32 v54, 16, v223
v_and_b32 v55, 0xffff0000, v223
v_pk_add_f32 v[32:33], v[32:33], v[48:49]
v_pk_add_f32 v[34:35], v[34:35], v[50:51]
v_pk_add_f32 v[36:37], v[36:37], v[52:53]
v_pk_add_f32 v[38:39], v[38:39], v[54:55]
s_barrier
v_lshlrev_b32 v40, 16, v224
v_and_b32 v41, 0xffff0000, v224
v_lshlrev_b32 v42, 16, v225
v_and_b32 v43, 0xffff0000, v225
v_lshlrev_b32 v44, 16, v226
v_and_b32 v45, 0xffff0000, v226
v_lshlrev_b32 v46, 16, v227
v_and_b32 v47, 0xffff0000, v227
v_pk_add_f32 v[32:33], v[32:33], v[40:41]
v_pk_add_f32 v[34:35], v[34:35], v[42:43]
v_pk_add_f32 v[36:37], v[36:37], v[44:45]
v_pk_add_f32 v[38:39], v[38:39], v[46:47]
v_lshlrev_b32 v48, 16, v228
v_and_b32 v49, 0xffff0000, v228
v_lshlrev_b32 v50, 16, v229
v_and_b32 v51, 0xffff0000, v229
v_lshlrev_b32 v52, 16, v230
v_and_b32 v53, 0xffff0000, v230
v_lshlrev_b32 v54, 16, v231
v_and_b32 v55, 0xffff0000, v231
v_pk_add_f32 v[32:33], v[32:33], v[48:49]
v_pk_add_f32 v[34:35], v[34:35], v[50:51]
v_pk_add_f32 v[36:37], v[36:37], v[52:53]
v_pk_add_f32 v[38:39], v[38:39], v[54:55]
v_lshlrev_b32 v40, 16, v232
v_and_b32 v41, 0xffff0000, v232
v_lshlrev_b32 v42, 16, v233
v_and_b32 v43, 0xffff0000, v233
v_lshlrev_b32 v44, 16, v234
v_and_b32 v45, 0xffff0000, v234
v_lshlrev_b32 v46, 16, v235
v_and_b32 v47, 0xffff0000, v235
v_pk_add_f32 v[32:33], v[32:33], v[40:41]
v_pk_add_f32 v[34:35], v[34:35], v[42:43]
v_pk_add_f32 v[36:37], v[36:37], v[44:45]
v_pk_add_f32 v[38:39], v[38:39], v[46:47]
v_lshlrev_b32 v48, 16, v236
v_and_b32 v49, 0xffff0000, v236
v_lshlrev_b32 v50, 16, v237
v_and_b32 v51, 0xffff0000, v237
v_lshlrev_b32 v52, 16, v238
v_and_b32 v53, 0xffff0000, v238
v_lshlrev_b32 v54, 16, v239
v_and_b32 v55, 0xffff0000, v239
v_pk_add_f32 v[32:33], v[32:33], v[48:49]
v_pk_add_f32 v[34:35], v[34:35], v[50:51]
v_pk_add_f32 v[36:37], v[36:37], v[52:53]
v_pk_add_f32 v[38:39], v[38:39], v[54:55]
s_barrier
s_mov_b32 s41, 0x10000
Lpoll_110:
s_waitcnt vmcnt(0)
Lpf_112:
v_cmp_ne_u32 vcc, v10, v9
s_nop 4
s_cbranch_vccz Lpok_111
buffer_load_dword v9, v8, s[56:59], 0 offen sc1
s_sub_u32 s41, s41, 1
s_cmp_lg_u32 s41, 0
s_cbranch_scc1 Lpoll_110
s_waitcnt vmcnt(0)
Lpok_111:
v_lshlrev_b32 v40, 16, v240
v_and_b32 v41, 0xffff0000, v240
v_lshlrev_b32 v42, 16, v241
v_and_b32 v43, 0xffff0000, v241
v_lshlrev_b32 v44, 16, v242
v_and_b32 v45, 0xffff0000, v242
v_lshlrev_b32 v46, 16, v243
v_and_b32 v47, 0xffff0000, v243
v_pk_add_f32 v[32:33], v[32:33], v[40:41]
v_pk_add_f32 v[34:35], v[34:35], v[42:43]
v_pk_add_f32 v[36:37], v[36:37], v[44:45]
v_pk_add_f32 v[38:39], v[38:39], v[46:47]
v_lshlrev_b32 v48, 16, v244
v_and_b32 v49, 0xffff0000, v244
v_lshlrev_b32 v50, 16, v245
v_and_b32 v51, 0xffff0000, v245
v_lshlrev_b32 v52, 16, v246
v_and_b32 v53, 0xffff0000, v246
v_lshlrev_b32 v54, 16, v247
v_and_b32 v55, 0xffff0000, v247
v_pk_add_f32 v[32:33], v[32:33], v[48:49]
v_pk_add_f32 v[34:35], v[34:35], v[50:51]
v_pk_add_f32 v[36:37], v[36:37], v[52:53]
v_pk_add_f32 v[38:39], v[38:39], v[54:55]
v_lshlrev_b32 v40, 16, v248
v_and_b32 v41, 0xffff0000, v248
v_lshlrev_b32 v42, 16, v249
v_and_b32 v43, 0xffff0000, v249
v_lshlrev_b32 v44, 16, v250
v_and_b32 v45, 0xffff0000, v250
v_lshlrev_b32 v46, 16, v251
v_and_b32 v47, 0xffff0000, v251
v_pk_add_f32 v[32:33], v[32:33], v[40:41]
v_pk_add_f32 v[34:35], v[34:35], v[42:43]
v_pk_add_f32 v[36:37], v[36:37], v[44:45]
v_pk_add_f32 v[38:39], v[38:39], v[46:47]
v_lshlrev_b32 v48, 16, v252
v_and_b32 v49, 0xffff0000, v252
v_lshlrev_b32 v50, 16, v253
v_and_b32 v51, 0xffff0000, v253
v_lshlrev_b32 v52, 16, v254
v_and_b32 v53, 0xffff0000, v254
v_lshlrev_b32 v54, 16, v255
v_and_b32 v55, 0xffff0000, v255
v_pk_add_f32 v[32:33], v[32:33], v[48:49]
v_pk_add_f32 v[34:35], v[34:35], v[50:51]
v_pk_add_f32 v[36:37], v[36:37], v[52:53]
v_pk_add_f32 v[38:39], v[38:39], v[54:55]
s_barrier
s_mov_b32 s43, 1376256
buffer_load_dwordx4 v[128:131], v4, s[64:67], s43 offen
s_mov_b32 s43, 1404928
buffer_load_dwordx4 v[132:135], v4, s[64:67], s43 offen
s_mov_b32 s43, 1433600
buffer_load_dwordx4 v[136:139], v4, s[64:67], s43 offen
s_mov_b32 s43, 1462272
buffer_load_dwordx4 v[140:143], v4, s[64:67], s43 offen
s_mov_b32 s43, 1490944
buffer_load_dwordx4 v[144:147], v4, s[64:67], s43 offen
s_mov_b32 s43, 1519616
buffer_load_dwordx4 v[148:151], v4, s[64:67], s43 offen
s_mov_b32 s43, 1548288
buffer_load_dwordx4 v[152:155], v4, s[64:67], s43 offen
s_mov_b32 s43, 1576960
buffer_load_dwordx4 v[156:159], v4, s[64:67], s43 offen
s_mov_b32 s43, 1605632
buffer_load_dwordx4 v[160:163], v4, s[64:67], s43 offen
s_mov_b32 s43, 1634304
buffer_load_dwordx4 v[164:167], v4, s[64:67], s43 offen
s_mov_b32 s43, 1662976
buffer_load_dwordx4 v[168:171], v4, s[64:67], s43 offen
s_mov_b32 s43, 1691648
buffer_load_dwordx4 v[172:175], v4, s[64:67], s43 offen
s_mov_b32 s43, 1720320
buffer_load_dwordx4 v[176:179], v4, s[64:67], s43 offen
s_mov_b32 s43, 1748992
buffer_load_dwordx4 v[180:183], v4, s[64:67], s43 offen
s_mov_b32 s43, 1777664
buffer_load_dwordx4 v[184:187], v4, s[64:67], s43 offen
s_mov_b32 s43, 1806336
buffer_load_dwordx4 v[188:191], v4, s[64:67], s43 offen
s_barrier
v_lshlrev_b32 v40, 16, v56
v_and_b32 v41, 0xffff0000, v56
v_lshlrev_b32 v42, 16, v57
v_and_b32 v43, 0xffff0000, v57
v_lshlrev_b32 v44, 16, v58
v_and_b32 v45, 0xffff0000, v58
v_lshlrev_b32 v46, 16, v59
v_and_b32 v47, 0xffff0000, v59
v_pk_add_f32 v[32:33], v[32:33], v[40:41]
v_pk_add_f32 v[34:35], v[34:35], v[42:43]
v_pk_add_f32 v[36:37], v[36:37], v[44:45]
v_pk_add_f32 v[38:39], v[38:39], v[46:47]
v_lshlrev_b32 v48, 16, v60
v_and_b32 v49, 0xffff0000, v60
v_lshlrev_b32 v50, 16, v61
v_and_b32 v51, 0xffff0000, v61
v_lshlrev_b32 v52, 16, v62
v_and_b32 v53, 0xffff0000, v62
v_lshlrev_b32 v54, 16, v63
v_and_b32 v55, 0xffff0000, v63
v_pk_add_f32 v[32:33], v[32:33], v[48:49]
v_pk_add_f32 v[34:35], v[34:35], v[50:51]
v_pk_add_f32 v[36:37], v[36:37], v[52:53]
v_pk_add_f32 v[38:39], v[38:39], v[54:55]
v_lshlrev_b32 v40, 16, v64
v_and_b32 v41, 0xffff0000, v64
v_lshlrev_b32 v42, 16, v65
v_and_b32 v43, 0xffff0000, v65
v_lshlrev_b32 v44, 16, v66
v_and_b32 v45, 0xffff0000, v66
v_lshlrev_b32 v46, 16, v67
v_and_b32 v47, 0xffff0000, v67
v_pk_add_f32 v[32:33], v[32:33], v[40:41]
v_pk_add_f32 v[34:35], v[34:35], v[42:43]
v_pk_add_f32 v[36:37], v[36:37], v[44:45]
v_pk_add_f32 v[38:39], v[38:39], v[46:47]
v_lshlrev_b32 v48, 16, v72
v_and_b32 v49, 0xffff0000, v72
v_lshlrev_b32 v50, 16, v73
v_and_b32 v51, 0xffff0000, v73
v_lshlrev_b32 v52, 16, v74
v_and_b32 v53, 0xffff0000, v74
v_lshlrev_b32 v54, 16, v75
v_and_b32 v55, 0xffff0000, v75
v_pk_add_f32 v[32:33], v[32:33], v[48:49]
v_pk_add_f32 v[34:35], v[34:35], v[50:51]
v_pk_add_f32 v[36:37], v[36:37], v[52:53]
v_pk_add_f32 v[38:39], v[38:39], v[54:55]
s_barrier
v_lshlrev_b32 v40, 16, v76
v_and_b32 v41, 0xffff0000, v76
v_lshlrev_b32 v42, 16, v77
v_and_b32 v43, 0xffff0000, v77
v_lshlrev_b32 v44, 16, v78
v_and_b32 v45, 0xffff0000, v78
v_lshlrev_b32 v46, 16, v79
v_and_b32 v47, 0xffff0000, v79
v_pk_add_f32 v[32:33], v[32:33], v[40:41]
v_pk_add_f32 v[34:35], v[34:35], v[42:43]
v_pk_add_f32 v[36:37], v[36:37], v[44:45]
v_pk_add_f32 v[38:39], v[38:39], v[46:47]
v_lshlrev_b32 v48, 16, v80
v_and_b32 v49, 0xffff0000, v80
v_lshlrev_b32 v50, 16, v81
v_and_b32 v51, 0xffff0000, v81
v_lshlrev_b32 v52, 16, v82
v_and_b32 v53, 0xffff0000, v82
v_lshlrev_b32 v54, 16, v83
v_and_b32 v55, 0xffff0000, v83
v_pk_add_f32 v[32:33], v[32:33], v[48:49]
v_pk_add_f32 v[34:35], v[34:35], v[50:51]
v_pk_add_f32 v[36:37], v[36:37], v[52:53]
v_pk_add_f32 v[38:39], v[38:39], v[54:55]
v_lshlrev_b32 v40, 16, v84
v_and_b32 v41, 0xffff0000, v84
v_lshlrev_b32 v42, 16, v85
v_and_b32 v43, 0xffff0000, v85
v_lshlrev_b32 v44, 16, v86
v_and_b32 v45, 0xffff0000, v86
v_lshlrev_b32 v46, 16, v87
v_and_b32 v47, 0xffff0000, v87
v_pk_add_f32 v[32:33], v[32:33], v[40:41]
v_pk_add_f32 v[34:35], v[34:35], v[42:43]
v_pk_add_f32 v[36:37], v[36:37], v[44:45]
v_pk_add_f32 v[38:39], v[38:39], v[46:47]
v_lshlrev_b32 v48, 16, v88
v_and_b32 v49, 0xffff0000, v88
v_lshlrev_b32 v50, 16, v89
v_and_b32 v51, 0xffff0000, v89
v_lshlrev_b32 v52, 16, v90
v_and_b32 v53, 0xffff0000, v90
v_lshlrev_b32 v54, 16, v91
v_and_b32 v55, 0xffff0000, v91
v_pk_add_f32 v[32:33], v[32:33], v[48:49]
v_pk_add_f32 v[34:35], v[34:35], v[50:51]
v_pk_add_f32 v[36:37], v[36:37], v[52:53]
v_pk_add_f32 v[38:39], v[38:39], v[54:55]
s_barrier
v_lshlrev_b32 v40, 16, v92
v_and_b32 v41, 0xffff0000, v92
v_lshlrev_b32 v42, 16, v93
v_and_b32 v43, 0xffff0000, v93
v_lshlrev_b32 v44, 16, v94
v_and_b32 v45, 0xffff0000, v94
v_lshlrev_b32 v46, 16, v95
v_and_b32 v47, 0xffff0000, v95
v_pk_add_f32 v[32:33], v[32:33], v[40:41]
v_pk_add_f32 v[34:35], v[34:35], v[42:43]
v_pk_add_f32 v[36:37], v[36:37], v[44:45]
v_pk_add_f32 v[38:39], v[38:39], v[46:47]
v_lshlrev_b32 v48, 16, v96
v_and_b32 v49, 0xffff0000, v96
v_lshlrev_b32 v50, 16, v97
v_and_b32 v51, 0xffff0000, v97
v_lshlrev_b32 v52, 16, v98
v_and_b32 v53, 0xffff0000, v98
v_lshlrev_b32 v54, 16, v99
v_and_b32 v55, 0xffff0000, v99
v_pk_add_f32 v[32:33], v[32:33], v[48:49]
v_pk_add_f32 v[34:35], v[34:35], v[50:51]
v_pk_add_f32 v[36:37], v[36:37], v[52:53]
v_pk_add_f32 v[38:39], v[38:39], v[54:55]
v_lshlrev_b32 v40, 16, v100
v_and_b32 v41, 0xffff0000, v100
v_lshlrev_b32 v42, 16, v101
v_and_b32 v43, 0xffff0000, v101
v_lshlrev_b32 v44, 16, v102
v_and_b32 v45, 0xffff0000, v102
v_lshlrev_b32 v46, 16, v103
v_and_b32 v47, 0xffff0000, v103
v_pk_add_f32 v[32:33], v[32:33], v[40:41]
v_pk_add_f32 v[34:35], v[34:35], v[42:43]
v_pk_add_f32 v[36:37], v[36:37], v[44:45]
v_pk_add_f32 v[38:39], v[38:39], v[46:47]
v_lshlrev_b32 v48, 16, v104
v_and_b32 v49, 0xffff0000, v104
v_lshlrev_b32 v50, 16, v105
v_and_b32 v51, 0xffff0000, v105
v_lshlrev_b32 v52, 16, v106
v_and_b32 v53, 0xffff0000, v106
v_lshlrev_b32 v54, 16, v107
v_and_b32 v55, 0xffff0000, v107
v_pk_add_f32 v[32:33], v[32:33], v[48:49]
v_pk_add_f32 v[34:35], v[34:35], v[50:51]
v_pk_add_f32 v[36:37], v[36:37], v[52:53]
v_pk_add_f32 v[38:39], v[38:39], v[54:55]
s_barrier
v_lshlrev_b32 v40, 16, v108
v_and_b32 v41, 0xffff0000, v108
v_lshlrev_b32 v42, 16, v109
v_and_b32 v43, 0xffff0000, v109
v_lshlrev_b32 v44, 16, v110
v_and_b32 v45, 0xffff0000, v110
v_lshlrev_b32 v46, 16, v111
v_and_b32 v47, 0xffff0000, v111
v_pk_add_f32 v[32:33], v[32:33], v[40:41]
v_pk_add_f32 v[34:35], v[34:35], v[42:43]
v_pk_add_f32 v[36:37], v[36:37], v[44:45]
v_pk_add_f32 v[38:39], v[38:39], v[46:47]
v_lshlrev_b32 v48, 16, v112
v_and_b32 v49, 0xffff0000, v112
v_lshlrev_b32 v50, 16, v113
v_and_b32 v51, 0xffff0000, v113
v_lshlrev_b32 v52, 16, v114
v_and_b32 v53, 0xffff0000, v114
v_lshlrev_b32 v54, 16, v115
v_and_b32 v55, 0xffff0000, v115
v_pk_add_f32 v[32:33], v[32:33], v[48:49]
v_pk_add_f32 v[34:35], v[34:35], v[50:51]
v_pk_add_f32 v[36:37], v[36:37], v[52:53]
v_pk_add_f32 v[38:39], v[38:39], v[54:55]
v_lshlrev_b32 v40, 16, v120
v_and_b32 v41, 0xffff0000, v120
v_lshlrev_b32 v42, 16, v121
v_and_b32 v43, 0xffff0000, v121
v_lshlrev_b32 v44, 16, v122
v_and_b32 v45, 0xffff0000, v122
v_lshlrev_b32 v46, 16, v123
v_and_b32 v47, 0xffff0000, v123
v_pk_add_f32 v[32:33], v[32:33], v[40:41]
v_pk_add_f32 v[34:35], v[34:35], v[42:43]
v_pk_add_f32 v[36:37], v[36:37], v[44:45]
v_pk_add_f32 v[38:39], v[38:39], v[46:47]
v_lshlrev_b32 v48, 16, v124
v_and_b32 v49, 0xffff0000, v124
v_lshlrev_b32 v50, 16, v125
v_and_b32 v51, 0xffff0000, v125
v_lshlrev_b32 v52, 16, v126
v_and_b32 v53, 0xffff0000, v126
v_lshlrev_b32 v54, 16, v127
v_and_b32 v55, 0xffff0000, v127
v_pk_add_f32 v[32:33], v[32:33], v[48:49]
v_pk_add_f32 v[34:35], v[34:35], v[50:51]
v_pk_add_f32 v[36:37], v[36:37], v[52:53]
v_pk_add_f32 v[38:39], v[38:39], v[54:55]
s_barrier
s_waitcnt vmcnt(0)
v_lshlrev_b32 v40, 16, v128
v_and_b32 v41, 0xffff0000, v128
v_lshlrev_b32 v42, 16, v129
v_and_b32 v43, 0xffff0000, v129
v_lshlrev_b32 v44, 16, v130
v_and_b32 v45, 0xffff0000, v130
v_lshlrev_b32 v46, 16, v131
v_and_b32 v47, 0xffff0000, v131
v_pk_add_f32 v[32:33], v[32:33], v[40:41]
v_pk_add_f32 v[34:35], v[34:35], v[42:43]
v_pk_add_f32 v[36:37], v[36:37], v[44:45]
v_pk_add_f32 v[38:39], v[38:39], v[46:47]
v_lshlrev_b32 v48, 16, v132
v_and_b32 v49, 0xffff0000, v132
v_lshlrev_b32 v50, 16, v133
v_and_b32 v51, 0xffff0000, v133
v_lshlrev_b32 v52, 16, v134
v_and_b32 v53, 0xffff0000, v134
v_lshlrev_b32 v54, 16, v135
v_and_b32 v55, 0xffff0000, v135
v_pk_add_f32 v[32:33], v[32:33], v[48:49]
v_pk_add_f32 v[34:35], v[34:35], v[50:51]
v_pk_add_f32 v[36:37], v[36:37], v[52:53]
v_pk_add_f32 v[38:39], v[38:39], v[54:55]
v_lshlrev_b32 v40, 16, v136
v_and_b32 v41, 0xffff0000, v136
v_lshlrev_b32 v42, 16, v137
v_and_b32 v43, 0xffff0000, v137
v_lshlrev_b32 v44, 16, v138
v_and_b32 v45, 0xffff0000, v138
v_lshlrev_b32 v46, 16, v139
v_and_b32 v47, 0xffff0000, v139
v_pk_add_f32 v[32:33], v[32:33], v[40:41]
v_pk_add_f32 v[34:35], v[34:35], v[42:43]
v_pk_add_f32 v[36:37], v[36:37], v[44:45]
v_pk_add_f32 v[38:39], v[38:39], v[46:47]
v_lshlrev_b32 v48, 16, v140
v_and_b32 v49, 0xffff0000, v140
v_lshlrev_b32 v50, 16, v141
v_and_b32 v51, 0xffff0000, v141
v_lshlrev_b32 v52, 16, v142
v_and_b32 v53, 0xffff0000, v142
v_lshlrev_b32 v54, 16, v143
v_and_b32 v55, 0xffff0000, v143
v_pk_add_f32 v[32:33], v[32:33], v[48:49]
v_pk_add_f32 v[34:35], v[34:35], v[50:51]
v_pk_add_f32 v[36:37], v[36:37], v[52:53]
v_pk_add_f32 v[38:39], v[38:39], v[54:55]
s_barrier
v_lshlrev_b32 v40, 16, v144
v_and_b32 v41, 0xffff0000, v144
v_lshlrev_b32 v42, 16, v145
v_and_b32 v43, 0xffff0000, v145
v_lshlrev_b32 v44, 16, v146
v_and_b32 v45, 0xffff0000, v146
v_lshlrev_b32 v46, 16, v147
v_and_b32 v47, 0xffff0000, v147
v_pk_add_f32 v[32:33], v[32:33], v[40:41]
v_pk_add_f32 v[34:35], v[34:35], v[42:43]
v_pk_add_f32 v[36:37], v[36:37], v[44:45]
v_pk_add_f32 v[38:39], v[38:39], v[46:47]
v_lshlrev_b32 v48, 16, v148
v_and_b32 v49, 0xffff0000, v148
v_lshlrev_b32 v50, 16, v149
v_and_b32 v51, 0xffff0000, v149
v_lshlrev_b32 v52, 16, v150
v_and_b32 v53, 0xffff0000, v150
v_lshlrev_b32 v54, 16, v151
v_and_b32 v55, 0xffff0000, v151
v_pk_add_f32 v[32:33], v[32:33], v[48:49]
v_pk_add_f32 v[34:35], v[34:35], v[50:51]
v_pk_add_f32 v[36:37], v[36:37], v[52:53]
v_pk_add_f32 v[38:39], v[38:39], v[54:55]
v_lshlrev_b32 v40, 16, v152
v_and_b32 v41, 0xffff0000, v152
v_lshlrev_b32 v42, 16, v153
v_and_b32 v43, 0xffff0000, v153
v_lshlrev_b32 v44, 16, v154
v_and_b32 v45, 0xffff0000, v154
v_lshlrev_b32 v46, 16, v155
v_and_b32 v47, 0xffff0000, v155
v_pk_add_f32 v[32:33], v[32:33], v[40:41]
v_pk_add_f32 v[34:35], v[34:35], v[42:43]
v_pk_add_f32 v[36:37], v[36:37], v[44:45]
v_pk_add_f32 v[38:39], v[38:39], v[46:47]
v_lshlrev_b32 v48, 16, v156
v_and_b32 v49, 0xffff0000, v156
v_lshlrev_b32 v50, 16, v157
v_and_b32 v51, 0xffff0000, v157
v_lshlrev_b32 v52, 16, v158
v_and_b32 v53, 0xffff0000, v158
v_lshlrev_b32 v54, 16, v159
v_and_b32 v55, 0xffff0000, v159
v_pk_add_f32 v[32:33], v[32:33], v[48:49]
v_pk_add_f32 v[34:35], v[34:35], v[50:51]
v_pk_add_f32 v[36:37], v[36:37], v[52:53]
v_pk_add_f32 v[38:39], v[38:39], v[54:55]
s_barrier
v_lshlrev_b32 v40, 16, v160
v_and_b32 v41, 0xffff0000, v160
v_lshlrev_b32 v42, 16, v161
v_and_b32 v43, 0xffff0000, v161
v_lshlrev_b32 v44, 16, v162
v_and_b32 v45, 0xffff0000, v162
v_lshlrev_b32 v46, 16, v163
v_and_b32 v47, 0xffff0000, v163
v_pk_add_f32 v[32:33], v[32:33], v[40:41]
v_pk_add_f32 v[34:35], v[34:35], v[42:43]
v_pk_add_f32 v[36:37], v[36:37], v[44:45]
v_pk_add_f32 v[38:39], v[38:39], v[46:47]
v_lshlrev_b32 v48, 16, v164
v_and_b32 v49, 0xffff0000, v164
v_lshlrev_b32 v50, 16, v165
v_and_b32 v51, 0xffff0000, v165
v_lshlrev_b32 v52, 16, v166
v_and_b32 v53, 0xffff0000, v166
v_lshlrev_b32 v54, 16, v167
v_and_b32 v55, 0xffff0000, v167
v_pk_add_f32 v[32:33], v[32:33], v[48:49]
v_pk_add_f32 v[34:35], v[34:35], v[50:51]
v_pk_add_f32 v[36:37], v[36:37], v[52:53]
v_pk_add_f32 v[38:39], v[38:39], v[54:55]
v_lshlrev_b32 v40, 16, v168
v_and_b32 v41, 0xffff0000, v168
v_lshlrev_b32 v42, 16, v169
v_and_b32 v43, 0xffff0000, v169
v_lshlrev_b32 v44, 16, v170
v_and_b32 v45, 0xffff0000, v170
v_lshlrev_b32 v46, 16, v171
v_and_b32 v47, 0xffff0000, v171
v_pk_add_f32 v[32:33], v[32:33], v[40:41]
v_pk_add_f32 v[34:35], v[34:35], v[42:43]
v_pk_add_f32 v[36:37], v[36:37], v[44:45]
v_pk_add_f32 v[38:39], v[38:39], v[46:47]
v_lshlrev_b32 v48, 16, v172
v_and_b32 v49, 0xffff0000, v172
v_lshlrev_b32 v50, 16, v173
v_and_b32 v51, 0xffff0000, v173
v_lshlrev_b32 v52, 16, v174
v_and_b32 v53, 0xffff0000, v174
v_lshlrev_b32 v54, 16, v175
v_and_b32 v55, 0xffff0000, v175
v_pk_add_f32 v[32:33], v[32:33], v[48:49]
v_pk_add_f32 v[34:35], v[34:35], v[50:51]
v_pk_add_f32 v[36:37], v[36:37], v[52:53]
v_pk_add_f32 v[38:39], v[38:39], v[54:55]
s_barrier
v_lshlrev_b32 v40, 16, v176
v_and_b32 v41, 0xffff0000, v176
v_lshlrev_b32 v42, 16, v177
v_and_b32 v43, 0xffff0000, v177
v_lshlrev_b32 v44, 16, v178
v_and_b32 v45, 0xffff0000, v178
v_lshlrev_b32 v46, 16, v179
v_and_b32 v47, 0xffff0000, v179
v_pk_add_f32 v[32:33], v[32:33], v[40:41]
v_pk_add_f32 v[34:35], v[34:35], v[42:43]
v_pk_add_f32 v[36:37], v[36:37], v[44:45]
v_pk_add_f32 v[38:39], v[38:39], v[46:47]
v_lshlrev_b32 v48, 16, v180
v_and_b32 v49, 0xffff0000, v180
v_lshlrev_b32 v50, 16, v181
v_and_b32 v51, 0xffff0000, v181
v_lshlrev_b32 v52, 16, v182
v_and_b32 v53, 0xffff0000, v182
v_lshlrev_b32 v54, 16, v183
v_and_b32 v55, 0xffff0000, v183
v_pk_add_f32 v[32:33], v[32:33], v[48:49]
v_pk_add_f32 v[34:35], v[34:35], v[50:51]
v_pk_add_f32 v[36:37], v[36:37], v[52:53]
v_pk_add_f32 v[38:39], v[38:39], v[54:55]
v_lshlrev_b32 v40, 16, v184
v_and_b32 v41, 0xffff0000, v184
v_lshlrev_b32 v42, 16, v185
v_and_b32 v43, 0xffff0000, v185
v_lshlrev_b32 v44, 16, v186
v_and_b32 v45, 0xffff0000, v186
v_lshlrev_b32 v46, 16, v187
v_and_b32 v47, 0xffff0000, v187
v_pk_add_f32 v[32:33], v[32:33], v[40:41]
v_pk_add_f32 v[34:35], v[34:35], v[42:43]
v_pk_add_f32 v[36:37], v[36:37], v[44:45]
v_pk_add_f32 v[38:39], v[38:39], v[46:47]
v_lshlrev_b32 v48, 16, v188
v_and_b32 v49, 0xffff0000, v188
v_lshlrev_b32 v50, 16, v189
v_and_b32 v51, 0xffff0000, v189
v_lshlrev_b32 v52, 16, v190
v_and_b32 v53, 0xffff0000, v190
v_lshlrev_b32 v54, 16, v191
v_and_b32 v55, 0xffff0000, v191
v_pk_add_f32 v[32:33], v[32:33], v[48:49]
v_pk_add_f32 v[34:35], v[34:35], v[50:51]
v_pk_add_f32 v[36:37], v[36:37], v[52:53]
v_pk_add_f32 v[38:39], v[38:39], v[54:55]
s_barrier
s_nop 2
v_mov_b32 v40, v32
v_mov_b32 v41, v33
v_mov_b32 v42, v34
v_mov_b32 v43, v35
v_mov_b32 v44, v36
v_mov_b32 v45, v37
v_mov_b32 v46, v38
v_mov_b32 v47, v39
s_nop 0
v_permlane16_swap_b32 v32, v40
v_permlane16_swap_b32 v33, v41
v_permlane16_swap_b32 v34, v42
v_permlane16_swap_b32 v35, v43
v_permlane16_swap_b32 v36, v44
v_permlane16_swap_b32 v37, v45
v_permlane16_swap_b32 v38, v46
v_permlane16_swap_b32 v39, v47
v_add_f32 v32, v32, v40
v_add_f32 v33, v33, v41
v_add_f32 v34, v34, v42
v_add_f32 v35, v35, v43
v_add_f32 v36, v36, v44
v_add_f32 v37, v37, v45
v_add_f32 v38, v38, v46
v_add_f32 v39, v39, v47
v_mov_b32 v40, v32
v_mov_b32 v41, v33
v_mov_b32 v42, v34
v_mov_b32 v43, v35
v_mov_b32 v44, v36
v_mov_b32 v45, v37
v_mov_b32 v46, v38
v_mov_b32 v47, v39
s_nop 0
v_permlane32_swap_b32 v32, v40
v_permlane32_swap_b32 v33, v41
v_permlane32_swap_b32 v34, v42
v_permlane32_swap_b32 v35, v43
v_permlane32_swap_b32 v36, v44
v_permlane32_swap_b32 v37, v45
v_permlane32_swap_b32 v38, v46
v_permlane32_swap_b32 v39, v47
v_add_f32 v32, v32, v40
v_add_f32 v33, v33, v41
v_add_f32 v34, v34, v42
v_add_f32 v35, v35, v43
v_add_f32 v36, v36, v44
v_add_f32 v37, v37, v45
v_add_f32 v38, v38, v46
v_add_f32 v39, v39, v47
s_mov_b64 exec, 0xffff
buffer_store_dwordx4 v[32:35], v5, s[72:75], 0 offen sc1
buffer_store_dwordx4 v[36:39], v5, s[72:75], 0 offen offset:16 sc1
s_mov_b64 exec, -1
s_waitcnt vmcnt(0)
s_add_u32 s43, s50, 96
s_lshl_b32 s43, s43, 7
v_mov_b32 v12, s43
v_mov_b32 v13, 1
s_mov_b64 exec, 1
buffer_atomic_add v13, v12, s[56:59], 0 offen sc1
s_mov_b64 exec, -1
s_branch Lcsd_109
.p2align 6
Lw_40:
s_branch Lr_41
s_nop 0
Lnojob_108:
s_lshl_b32 s43, s34, 18
s_add_u32 s12, s32, s43
s_addc_u32 s13, s33, 0
s_mov_b32 s14, 262144
s_mov_b32 s15, 0x20000
v_lshlrev_b32 v21, 4, v1
s_lshl_b32 s54, s36, 11
s_add_u32 s43, s35, 1
s_and_b32 s43, s43, 15
s_lshl_b32 s43, s43, 14
s_add_u32 s30, s43, s54
s_add_u32 s43, s35, 2
s_and_b32 s43, s43, 15
s_lshl_b32 s43, s43, 14
s_add_u32 s31, s43, s54
s_waitcnt vmcnt(0)
s_barrier
ds_write_b128 v27, v[68:71] offset:0
ds_write_b128 v27, v[116:119] offset:512
s_waitcnt lgkmcnt(0)
s_barrier
s_add_u32 m0, s54, 16384
s_add_u32 s43, s30, 0
buffer_load_dwordx4 v21, s[12:15], s43 offen sc1 lds
s_add_u32 m0, s54, 17408
s_add_u32 s43, s30, 1024
buffer_load_dwordx4 v21, s[12:15], s43 offen sc1 lds
s_add_u32 m0, s54, 32768
s_add_u32 s43, s31, 0
buffer_load_dwordx4 v21, s[12:15], s43 offen sc1 lds
s_add_u32 m0, s54, 33792
s_add_u32 s43, s31, 1024
buffer_load_dwordx4 v21, s[12:15], s43 offen sc1 lds
s_waitcnt vmcnt(2)
s_barrier
s_waitcnt vmcnt(0)
s_barrier
s_barrier
s_barrier
s_add_u32 s43, s34, 0
s_lshl_b32 s43, s43, 7
v_mov_b32 v8, s43
v_mov_b32 v10, 16
buffer_load_dword v9, v8, s[56:59], 0 offen sc1
s_barrier
s_barrier
s_barrier
s_mov_b32 s41, 0x10000
Lpoll_113:
s_waitcnt vmcnt(0)
Lpf_115:
v_cmp_ne_u32 vcc, v10, v9
s_nop 4
s_cbranch_vccz Lpok_114
buffer_load_dword v9, v8, s[56:59], 0 offen sc1
s_sub_u32 s41, s41, 1
s_cmp_lg_u32 s41, 0
s_cbranch_scc1 Lpoll_113
s_waitcnt vmcnt(0)
Lpok_114:
s_barrier
s_barrier
s_barrier
s_barrier
s_barrier
s_barrier
s_barrier
s_barrier
s_barrier
s_barrier
.p2align 3
Lcsd_109:
s_mov_b32 s46, 1
s_lshl_b32 s43, s34, 18
s_add_u32 s12, s32, s43
s_addc_u32 s13, s33, 0
s_add_u32 s12, s12, 4194304
s_addc_u32 s13, s13, 0
s_mov_b32 s14, 262144
s_mov_b32 s15, 0x20000
v_lshlrev_b32 v21, 4, v1
s_lshl_b32 s54, s36, 11
s_add_u32 s43, s35, 1
s_and_b32 s43, s43, 15
s_lshl_b32 s43, s43, 14
s_add_u32 s30, s43, s54
s_add_u32 s43, s35, 2
s_and_b32 s43, s43, 15
s_lshl_b32 s43, s43, 14
s_add_u32 s31, s43, s54
s_mov_b32 s88, s4
s_mov_b32 s89, s5
s_mov_b32 s90, 7340032
s_mov_b32 s91, 0x20000
s_mov_b32 s92, s6
s_mov_b32 s93, s7
s_mov_b32 s94, 7340032
s_mov_b32 s95, 0x20000
s_lshr_b32 s43, s35, 3
v_and_b32 v19, 1, v1
v_bfe_u32 v23, v1, 2, 2
s_lshl_b32 s44, s43, 3
s_add_u32 s44, s44, 1
v_lshl_add_u32 v23, v19, 2, v23
v_add_u32 v23, s44, v23
s_lshl_b32 s43, s43, 11
s_add_u32 s43, s43, 384
s_movk_i32 s44, 1024
s_lshr_b32 s45, s2, 3
s_mul_i32 s45, s45, 14336
s_add_u32 s43, s43, s45
v_mul_lo_u32 v31, v19, s44
v_bfe_u32 v19, v1, 1, 1
v_mul_u32_u24 v19, 7168, v19
v_add3_u32 v31, v31, v19, s43
v_add_u32 v19, 3, v23
v_and_b32 v19, 15, v19
v_mul_u32_u24 v19, 458752, v19
v_add_u32 v19, v19, v31
buffer_load_dword v30, v19, s[88:91], 0 offen
buffer_load_dword v30, v19, s[92:95], 0 offen
s_lshl_b32 s43, s34, 14
s_add_u32 s64, s32, s43
s_addc_u32 s65, s33, 0
s_add_u32 s64, s64, 25165824
s_addc_u32 s65, s65, 0
s_mov_b32 s66, 16384
s_mov_b32 s67, 0x20000
s_add_u32 s72, s32, 27262976
s_addc_u32 s73, s33, 0
s_mov_b32 s74, 114688
s_mov_b32 s75, 0x20000
s_barrier
s_add_u32 s43, s34, 16
s_lshl_b32 s43, s43, 7
v_mov_b32 v8, s43
v_mov_b32 v9, 1
s_mov_b64 exec, 1
buffer_atomic_add v9, v8, s[56:59], 0 offen sc1
s_mov_b64 exec, -1
s_mul_i32 s43, s2, 28672
s_mul_i32 s44, s51, 7168
s_add_u32 s43, s43, s44
s_add_u32 s80, s60, s43
s_addc_u32 s81, s61, 0
s_load_dword s82, s[80:81], 0
s_load_dword s83, s[80:81], 64
s_load_dword s84, s[80:81], 128
s_load_dword s85, s[80:81], 192
s_load_dword s86, s[80:81], 256
s_load_dword s87, s[80:81], 320
s_load_dword s82, s[80:81], 384
s_load_dword s83, s[80:81], 448
s_load_dword s84, s[80:81], 512
s_load_dword s85, s[80:81], 576
s_load_dword s86, s[80:81], 640
s_add_u32 s80, s80, 704
s_addc_u32 s81, s81, 0
s_barrier
s_load_dword s82, s[80:81], 0
s_load_dword s83, s[80:81], 64
s_load_dword s84, s[80:81], 128
s_load_dword s85, s[80:81], 192
s_load_dword s86, s[80:81], 256
s_load_dword s87, s[80:81], 320
s_load_dword s82, s[80:81], 384
s_load_dword s83, s[80:81], 448
s_load_dword s84, s[80:81], 512
s_load_dword s85, s[80:81], 576
s_load_dword s86, s[80:81], 640
s_add_u32 s80, s80, 704
s_addc_u32 s81, s81, 0
s_barrier
v_add_u32 v19, 7, v23
v_and_b32 v19, 15, v19
v_mul_u32_u24 v19, 458752, v19
v_add_u32 v19, v19, v31
buffer_load_dword v30, v19, s[88:91], 0 offen
buffer_load_dword v30, v19, s[92:95], 0 offen
s_mul_i32 s43, s49, 96
s_add_u32 s44, s43, 95
s_lshr_b32 s43, s43, 7
s_lshr_b32 s44, s44, 7
s_add_u32 s43, s43, 16
s_add_u32 s44, s44, 16
v_mov_b32 v12, s44
v_writelane_b32 v12, s35, 0
v_writelane_b32 v12, s43, 1
v_add_u32 v12, 96, v12
v_lshlrev_b32 v12, 7, v12
v_mov_b32 v14, 8
buffer_load_dword v13, v12, s[56:59], 0 offen sc1
s_load_dword s82, s[80:81], 0
s_load_dword s83, s[80:81], 64
s_load_dword s84, s[80:81], 128
s_load_dword s85, s[80:81], 192
s_load_dword s86, s[80:81], 256
s_load_dword s87, s[80:81], 320
s_load_dword s82, s[80:81], 384
s_load_dword s83, s[80:81], 448
s_load_dword s84, s[80:81], 512
s_load_dword s85, s[80:81], 576
s_load_dword s86, s[80:81], 640
s_add_u32 s80, s80, 704
s_addc_u32 s81, s81, 0
s_barrier
s_add_u32 s43, s34, 16
s_lshl_b32 s43, s43, 7
v_mov_b32 v8, s43
v_mov_b32 v10, 16
buffer_load_dword v9, v8, s[56:59], 0 offen sc1
s_load_dword s82, s[80:81], 0
s_load_dword s83, s[80:81], 64
s_load_dword s84, s[80:81], 128
s_load_dword s85, s[80:81], 192
s_load_dword s86, s[80:81], 256
s_load_dword s87, s[80:81], 320
s_load_dword s82, s[80:81], 384
s_load_dword s83, s[80:81], 448
s_load_dword s84, s[80:81], 512
s_load_dword s85, s[80:81], 576
s_load_dword s86, s[80:81], 640
s_add_u32 s80, s80, 704
s_addc_u32 s81, s81, 0
s_barrier
s_mov_b32 s41, 0x10000
Lpoll_116:
s_waitcnt vmcnt(0)
Lpf_118:
v_cmp_ne_u32 vcc, v10, v9
s_nop 4
s_cbranch_vccz Lpok_117
buffer_load_dword v9, v8, s[56:59], 0 offen sc1
s_sub_u32 s41, s41, 1
s_cmp_lg_u32 s41, 0
s_cbranch_scc1 Lpoll_116
s_waitcnt vmcnt(0)
Lpok_117:
s_mov_b32 s41, 0x10000
Lpoll_119:
s_waitcnt vmcnt(0)
Lpf_121:
v_cmp_ne_u32 vcc, v14, v13
s_nop 4
s_cbranch_vccz Lpok_120
buffer_load_dword v13, v12, s[56:59], 0 offen sc1
s_sub_u32 s41, s41, 1
s_cmp_lg_u32 s41, 0
s_cbranch_scc1 Lpoll_119
s_waitcnt vmcnt(0)
Lpok_120:
v_min_u32 v12, 55, v1
v_lshlrev_b32 v13, 4, v12
s_lshl_b32 s43, s35, 9
s_mul_i32 s44, s49, 384
s_add_u32 s44, s44, 7680
v_mov_b32 v14, s44
v_mov_b32 v15, s43
v_cmp_gt_u32 vcc, 32, v12
s_nop 1
v_cndmask_b32 v14, v14, v15, vcc
v_add_u32 v14, v14, v13
v_add_u32 v13, 148480, v13
s_mov_b32 s43, 0
buffer_load_dwordx4 v[192:195], v14, s[72:75], s43 offen sc1
s_mov_b32 s43, 28672
buffer_load_dwordx4 v[196:199], v14, s[72:75], s43 offen sc1
s_mov_b32 s43, 57344
buffer_load_dwordx4 v[200:203], v14, s[72:75], s43 offen sc1
s_mov_b32 s43, 86016
buffer_load_dwordx4 v[204:207], v14, s[72:75], s43 offen sc1
s_mov_b32 s43, 14336
buffer_load_dwordx4 v[208:211], v14, s[72:75], s43 offen sc1
s_mov_b32 s43, 43008
buffer_load_dwordx4 v[212:215], v14, s[72:75], s43 offen sc1
s_mov_b32 s43, 71680
buffer_load_dwordx4 v[216:219], v14, s[72:75], s43 offen sc1
s_mov_b32 s43, 100352
buffer_load_dwordx4 v[220:223], v14, s[72:75], s43 offen sc1
s_load_dword s82, s[80:81], 0
s_load_dword s83, s[80:81], 64
s_load_dword s84, s[80:81], 128
s_load_dword s85, s[80:81], 192
s_load_dword s86, s[80:81], 256
s_load_dword s87, s[80:81], 320
s_load_dword s82, s[80:81], 384
s_load_dword s83, s[80:81], 448
s_load_dword s84, s[80:81], 512
s_load_dword s85, s[80:81], 576
s_load_dword s86, s[80:81], 640
s_add_u32 s80, s80, 704
s_addc_u32 s81, s81, 0
s_barrier
s_getpc_b64 s[78:79]
Lpc_122:
s_sub_u32 s78, s78, Lpc_122-sequential_preLN__sliding_local_dilated__glu_gated_geglu__prompt_kernel
s_subb_u32 s79, s79, 0
s_lshr_b32 s43, s2, 3
s_mul_i32 s43, s43, 3840
v_min_u32 v19, 29, v1
v_lshl_add_u32 v19, v19, 7, s43
v_min_u32 v19, Ldone_1-sequential_preLN__sliding_local_dilated__glu_gated_geglu__prompt_kernel, v19
global_load_dword v30, v19, s[78:79]
s_mov_b32 s43, 0
buffer_load_dwordx4 v[128:131], v21, s[64:67], s43 offen sc1
s_mov_b32 s43, 1024
buffer_load_dwordx4 v[132:135], v21, s[64:67], s43 offen sc1
s_mov_b32 s43, 2048
buffer_load_dwordx4 v[136:139], v21, s[64:67], s43 offen sc1
s_mov_b32 s43, 3072
buffer_load_dwordx4 v[140:143], v21, s[64:67], s43 offen sc1
s_mov_b32 s43, 4096
buffer_load_dwordx4 v[144:147], v21, s[64:67], s43 offen sc1
s_mov_b32 s43, 5120
buffer_load_dwordx4 v[148:151], v21, s[64:67], s43 offen sc1
s_mov_b32 s43, 6144
buffer_load_dwordx4 v[152:155], v21, s[64:67], s43 offen sc1
s_mov_b32 s43, 7168
buffer_load_dwordx4 v[156:159], v21, s[64:67], s43 offen sc1
s_mov_b32 s43, 8192
buffer_load_dwordx4 v[160:163], v21, s[64:67], s43 offen sc1
s_mov_b32 s43, 9216
buffer_load_dwordx4 v[164:167], v21, s[64:67], s43 offen sc1
s_mov_b32 s43, 10240
buffer_load_dwordx4 v[168:171], v21, s[64:67], s43 offen sc1
s_mov_b32 s43, 11264
buffer_load_dwordx4 v[172:175], v21, s[64:67], s43 offen sc1
s_mov_b32 s43, 12288
buffer_load_dwordx4 v[176:179], v21, s[64:67], s43 offen sc1
s_mov_b32 s43, 13312
buffer_load_dwordx4 v[180:183], v21, s[64:67], s43 offen sc1
s_mov_b32 s43, 14336
buffer_load_dwordx4 v[184:187], v21, s[64:67], s43 offen sc1
s_mov_b32 s43, 15360
buffer_load_dwordx4 v[188:191], v21, s[64:67], s43 offen sc1
s_load_dword s82, s[80:81], 0
s_load_dword s83, s[80:81], 64
s_load_dword s84, s[80:81], 128
s_load_dword s85, s[80:81], 192
s_load_dword s86, s[80:81], 256
s_load_dword s87, s[80:81], 320
s_load_dword s82, s[80:81], 384
s_load_dword s83, s[80:81], 448
s_load_dword s84, s[80:81], 512
s_load_dword s85, s[80:81], 576
s_load_dword s86, s[80:81], 640
s_add_u32 s80, s80, 704
s_addc_u32 s81, s81, 0
s_barrier
v_add_u32 v19, 11, v23
v_and_b32 v19, 15, v19
v_mul_u32_u24 v19, 458752, v19
v_add_u32 v19, v19, v31
buffer_load_dword v30, v19, s[88:91], 0 offen
buffer_load_dword v30, v19, s[92:95], 0 offen
s_waitcnt vmcnt(16)
v_add_f32 v192, v192, v196
v_add_f32 v200, v200, v204
v_add_f32 v193, v193, v197
v_add_f32 v201, v201, v205
v_add_f32 v194, v194, v198
v_add_f32 v202, v202, v206
v_add_f32 v195, v195, v199
v_add_f32 v203, v203, v207
v_add_f32 v192, v192, v200
v_add_f32 v193, v193, v201
v_add_f32 v194, v194, v202
v_add_f32 v195, v195, v203
ds_write_b128 v13, v[192:195] offset:0
v_add_f32 v208, v208, v212
v_add_f32 v216, v216, v220
v_add_f32 v209, v209, v213
v_add_f32 v217, v217, v221
v_add_f32 v210, v210, v214
v_add_f32 v218, v218, v222
v_add_f32 v211, v211, v215
v_add_f32 v219, v219, v223
v_add_f32 v208, v208, v216
v_add_f32 v209, v209, v217
v_add_f32 v210, v210, v218
v_add_f32 v211, v211, v219
ds_write_b128 v13, v[208:211] offset:896
s_barrier
s_waitcnt vmcnt(0)
v_add_f32 v128, v128, v132
v_add_f32 v129, v129, v133
v_add_f32 v130, v130, v134
v_add_f32 v131, v131, v135
v_add_f32 v128, v128, v136
v_add_f32 v129, v129, v137
v_add_f32 v130, v130, v138
v_add_f32 v131, v131, v139
v_add_f32 v128, v128, v140
v_add_f32 v129, v129, v141
v_add_f32 v130, v130, v142
v_add_f32 v131, v131, v143
v_add_f32 v128, v128, v144
v_add_f32 v129, v129, v145
v_add_f32 v130, v130, v146
v_add_f32 v131, v131, v147
v_add_f32 v128, v128, v148
v_add_f32 v129, v129, v149
v_add_f32 v130, v130, v150
v_add_f32 v131, v131, v151
v_add_f32 v128, v128, v152
v_add_f32 v129, v129, v153
v_add_f32 v130, v130, v154
v_add_f32 v131, v131, v155
v_add_f32 v128, v128, v156
v_add_f32 v129, v129, v157
v_add_f32 v130, v130, v158
v_add_f32 v131, v131, v159
v_add_f32 v128, v128, v160
v_add_f32 v129, v129, v161
v_add_f32 v130, v130, v162
v_add_f32 v131, v131, v163
v_add_f32 v128, v128, v164
v_add_f32 v129, v129, v165
v_add_f32 v130, v130, v166
v_add_f32 v131, v131, v167
v_add_f32 v128, v128, v168
v_add_f32 v129, v129, v169
v_add_f32 v130, v130, v170
v_add_f32 v131, v131, v171
v_add_f32 v128, v128, v172
v_add_f32 v129, v129, v173
v_add_f32 v130, v130, v174
v_add_f32 v131, v131, v175
v_add_f32 v128, v128, v176
v_add_f32 v129, v129, v177
v_add_f32 v130, v130, v178
v_add_f32 v131, v131, v179
v_add_f32 v128, v128, v180
v_add_f32 v129, v129, v181
v_add_f32 v130, v130, v182
v_add_f32 v131, v131, v183
v_add_f32 v128, v128, v184
v_add_f32 v129, v129, v185
v_add_f32 v130, v130, v186
v_add_f32 v131, v131, v187
v_add_f32 v128, v128, v188
v_add_f32 v129, v129, v189
v_add_f32 v130, v130, v190
v_add_f32 v131, v131, v191
v_mul_f32 v128, 0x3a800000, v128
v_mul_f32 v129, 0x3a800000, v129
v_fma_f32 v129, -v128, v128, v129
v_max_f32 v129, 0, v129
v_add_f32 v129, 0x3727c5ac, v129
v_rsq_f32 v129, v129
v_mul_f32 v130, 0x3a800000, v130
v_mul_f32 v131, 0x3a800000, v131
v_fma_f32 v131, -v130, v130, v131
v_max_f32 v131, 0, v131
v_add_f32 v131, 0x3727c5ac, v131
v_rsq_f32 v131, v131
v_add_u32 v19, 147456, v21
ds_write_b128 v19, v[128:131]
s_waitcnt lgkmcnt(0)
s_load_dword s82, s[80:81], 0
s_load_dword s83, s[80:81], 64
s_load_dword s84, s[80:81], 128
s_load_dword s85, s[80:81], 192
s_load_dword s86, s[80:81], 256
s_load_dword s87, s[80:81], 320
s_load_dword s82, s[80:81], 384
s_load_dword s83, s[80:81], 448
s_load_dword s84, s[80:81], 512
s_load_dword s85, s[80:81], 576
s_load_dword s86, s[80:81], 640
s_add_u32 s80, s80, 704
s_addc_u32 s81, s81, 0
s_barrier
s_load_dword s82, s[80:81], 0
s_load_dword s83, s[80:81], 64
s_load_dword s84, s[80:81], 128
s_load_dword s85, s[80:81], 192
s_load_dword s86, s[80:81], 256
s_load_dword s87, s[80:81], 320
s_load_dword s82, s[80:81], 384
s_load_dword s83, s[80:81], 448
s_load_dword s84, s[80:81], 512
s_load_dword s85, s[80:81], 576
s_load_dword s86, s[80:81], 640
s_add_u32 s80, s80, 704
s_addc_u32 s81, s81, 0
s_barrier
v_add_u32 v19, 15, v23
v_and_b32 v19, 15, v19
v_mul_u32_u24 v19, 458752, v19
v_add_u32 v19, v19, v31
buffer_load_dword v30, v19, s[88:91], 0 offen
buffer_load_dword v30, v19, s[92:95], 0 offen
s_and_b32 s53, s35, 1
s_lshl_b32 s53, s53, 1
s_mul_i32 s43, s47, 3
s_add_u32 s53, s53, s43
v_lshlrev_b32 v19, 11, v18
v_lshl_add_u32 v19, v17, 4, v19
s_lshl_b32 s43, s46, 10
v_add_u32 v2, s43, v19
v_add_u32 v3, 49152, v2
v_add_u32 v4, 98304, v2
v_lshrrev_b32 v19, 2, v17
v_lshl_add_u32 v20, v18, 2, v19
v_and_b32 v21, 7, v20
v_lshlrev_b32 v20, 8, v20
v_and_b32 v19, 3, v1
v_lshl_add_u32 v20, v19, 3, v20
s_add_u32 s43, s53, 0
v_xor_b32 v19, s43, v21
v_lshl_add_u32 v5, v19, 5, v20
s_add_u32 s43, s53, 1
v_xor_b32 v19, s43, v21
v_lshl_add_u32 v6, v19, 5, v20
s_add_u32 s43, s53, 2
v_xor_b32 v19, s43, v21
v_lshl_add_u32 v7, v19, 5, v20
v_add_u32 v9, 49152, v5
v_add_u32 v10, 49152, v6
v_add_u32 v11, 49152, v7
v_add_u32 v13, 98304, v5
v_add_u32 v14, 98304, v6
v_add_u32 v15, 98304, v7
s_lshl_b32 s43, s46, 9
s_add_u32 s43, s43, 147456
v_lshl_add_u32 v19, v17, 3, s43
ds_read_b64 v[80:81], v19 offset:0
ds_read_b64 v[82:83], v19 offset:128
ds_read_b64 v[84:85], v19 offset:256
ds_read_b64 v[86:87], v19 offset:384
s_mul_i32 s43, s47, 192
s_add_u32 s43, s43, 148992
v_lshl_add_u32 v19, v18, 4, s43
ds_read_b128 v[48:51], v19 offset:0
ds_read_b128 v[52:55], v19 offset:64
ds_read_b128 v[56:59], v19 offset:128
ds_read_b128 v[60:63], v19 offset:896
ds_read_b128 v[64:67], v19 offset:960
ds_read_b128 v[68:71], v19 offset:1024
s_barrier
s_mov_b32 s88, s4
s_mov_b32 s89, s5
s_mov_b32 s90, 7340032
s_mov_b32 s91, 0x20000
s_mov_b32 s92, s6
s_mov_b32 s93, s7
s_mov_b32 s94, 7340032
s_mov_b32 s95, 0x20000
s_lshr_b32 s43, s35, 3
v_and_b32 v19, 1, v1
v_bfe_u32 v23, v1, 2, 2
s_lshl_b32 s44, s43, 1
s_add_u32 s44, s44, 6
v_add_u32 v23, s44, v23
s_mul_i32 s44, s43, 6
s_add_u32 s44, s44, 1
v_mad_u32_u24 v23, v19, s44, v23
s_lshl_b32 s44, s43, 10
s_lshl_b32 s43, s43, 11
s_sub_u32 s43, 6528, s43
s_lshr_b32 s45, s2, 3
s_mul_i32 s45, s45, 14336
s_add_u32 s43, s43, s45
v_mul_lo_u32 v31, v19, s44
v_bfe_u32 v19, v1, 1, 1
v_mul_u32_u24 v19, 7168, v19
v_add3_u32 v31, v31, v19, s43
v_add_u32 v19, 0, v23
v_and_b32 v19, 15, v19
v_mul_u32_u24 v19, 458752, v19
v_add_u32 v19, v19, v31
buffer_load_dword v30, v19, s[88:91], 0 offen
buffer_load_dword v30, v19, s[92:95], 0 offen
s_waitcnt lgkmcnt(0)
v_mul_f32 v88, v81, v81
v_mul_f32 v228, 0xc0135761, v81
v_mul_f32 v89, 0xbdd2d3e8, v81
v_rcp_f32 v236, v88
v_mul_f32 v232, v89, v88
v_mul_f32 v88, v83, v83
v_mul_f32 v229, 0xc0135761, v83
v_mul_f32 v89, 0xbdd2d3e8, v83
v_rcp_f32 v237, v88
v_mul_f32 v233, v89, v88
v_mul_f32 v88, v85, v85
v_mul_f32 v230, 0xc0135761, v85
v_mul_f32 v89, 0xbdd2d3e8, v85
v_rcp_f32 v238, v88
v_mul_f32 v234, v89, v88
v_mul_f32 v88, v87, v87
v_mul_f32 v231, 0xc0135761, v87
v_mul_f32 v89, 0xbdd2d3e8, v87
v_rcp_f32 v239, v88
v_mul_f32 v235, v89, v88
s_mul_i32 s43, s34, 917504
s_mul_i32 s44, s49, 24576
s_add_u32 s43, s43, s44
s_add_u32 s43, s43, 8912896
s_add_u32 s24, s32, s43
s_addc_u32 s25, s33, 0
s_mov_b32 s26, 24576
s_mov_b32 s27, 0x20000
s_mov_b32 s53, 262144
s_lshl_b32 s43, s47, 13
s_lshl_b32 s44, s46, 10
s_add_u32 s43, s43, s44
v_lshlrev_b32 v19, 11, v18
v_lshl_add_u32 v19, v17, 4, v19
v_add_u32 v27, s43, v19
s_lshl_b32 s43, s47, 12
s_add_u32 s43, s43, s44
s_add_u32 s43, s43, 16384
v_and_b32 v19, 1, v18
v_lshlrev_b32 v19, 11, v19
v_lshrrev_b32 v20, 1, v18
v_lshl_add_u32 v19, v20, 8, v19
v_lshl_add_u32 v19, v17, 4, v19
v_add_u32 v28, s43, v19
s_load_dword s82, s[80:81], 0
s_load_dword s83, s[80:81], 64
s_load_dword s84, s[80:81], 128
s_load_dword s85, s[80:81], 192
s_load_dword s86, s[80:81], 256
s_load_dword s87, s[80:81], 320
s_load_dword s82, s[80:81], 384
s_load_dword s83, s[80:81], 448
s_add_u32 s80, s80, 512
s_addc_u32 s81, s81, 0
s_barrier
v_mul_f32 v128, -v80, v48
v_mul_f32 v129, -v80, v49
v_mul_f32 v130, -v80, v50
v_mul_f32 v131, -v80, v51
v_mul_f32 v132, -v82, v48
v_mul_f32 v133, -v82, v49
v_mul_f32 v134, -v82, v50
v_mul_f32 v135, -v82, v51
v_mul_f32 v136, -v84, v48
v_mul_f32 v137, -v84, v49
v_mul_f32 v138, -v84, v50
v_mul_f32 v139, -v84, v51
v_mul_f32 v140, -v86, v48
v_mul_f32 v141, -v86, v49
v_mul_f32 v142, -v86, v50
v_mul_f32 v143, -v86, v51
v_mul_f32 v144, -v80, v52
v_mul_f32 v145, -v80, v53
v_mul_f32 v146, -v80, v54
v_mul_f32 v147, -v80, v55
v_mul_f32 v148, -v82, v52
v_mul_f32 v149, -v82, v53
v_mul_f32 v150, -v82, v54
v_mul_f32 v151, -v82, v55
v_mul_f32 v152, -v84, v52
v_mul_f32 v153, -v84, v53
v_mul_f32 v154, -v84, v54
v_mul_f32 v155, -v84, v55
v_mul_f32 v156, -v86, v52
v_mul_f32 v157, -v86, v53
v_mul_f32 v158, -v86, v54
v_mul_f32 v159, -v86, v55
s_load_dword s82, s[80:81], 0
s_load_dword s83, s[80:81], 64
s_load_dword s84, s[80:81], 128
s_load_dword s85, s[80:81], 192
s_load_dword s86, s[80:81], 256
s_load_dword s87, s[80:81], 320
s_load_dword s82, s[80:81], 384
s_load_dword s83, s[80:81], 448
s_add_u32 s80, s80, 512
s_addc_u32 s81, s81, 0
s_barrier
v_mul_f32 v160, -v80, v56
v_mul_f32 v161, -v80, v57
v_mul_f32 v162, -v80, v58
v_mul_f32 v163, -v80, v59
v_mul_f32 v164, -v82, v56
v_mul_f32 v165, -v82, v57
v_mul_f32 v166, -v82, v58
v_mul_f32 v167, -v82, v59
v_mul_f32 v168, -v84, v56
v_mul_f32 v169, -v84, v57
v_mul_f32 v170, -v84, v58
v_mul_f32 v171, -v84, v59
v_mul_f32 v172, -v86, v56
v_mul_f32 v173, -v86, v57
v_mul_f32 v174, -v86, v58
v_mul_f32 v175, -v86, v59
v_mul_f32 v176, -v80, v60
v_mul_f32 v177, -v80, v61
v_mul_f32 v178, -v80, v62
v_mul_f32 v179, -v80, v63
v_mul_f32 v180, -v82, v60
v_mul_f32 v181, -v82, v61
v_mul_f32 v182, -v82, v62
v_mul_f32 v183, -v82, v63
v_mul_f32 v184, -v84, v60
v_mul_f32 v185, -v84, v61
v_mul_f32 v186, -v84, v62
v_mul_f32 v187, -v84, v63
v_mul_f32 v188, -v86, v60
v_mul_f32 v189, -v86, v61
v_mul_f32 v190, -v86, v62
v_mul_f32 v191, -v86, v63
s_load_dword s82, s[80:81], 0
s_load_dword s83, s[80:81], 64
s_load_dword s84, s[80:81], 128
s_load_dword s85, s[80:81], 192
s_load_dword s86, s[80:81], 256
s_load_dword s87, s[80:81], 320
s_load_dword s82, s[80:81], 384
s_load_dword s83, s[80:81], 448
s_add_u32 s80, s80, 512
s_addc_u32 s81, s81, 0
s_barrier
v_mul_f32 v192, -v80, v64
v_mul_f32 v193, -v80, v65
v_mul_f32 v194, -v80, v66
v_mul_f32 v195, -v80, v67
v_mul_f32 v196, -v82, v64
v_mul_f32 v197, -v82, v65
v_mul_f32 v198, -v82, v66
v_mul_f32 v199, -v82, v67
v_mul_f32 v200, -v84, v64
v_mul_f32 v201, -v84, v65
v_mul_f32 v202, -v84, v66
v_mul_f32 v203, -v84, v67
v_mul_f32 v204, -v86, v64
v_mul_f32 v205, -v86, v65
v_mul_f32 v206, -v86, v66
v_mul_f32 v207, -v86, v67
v_mul_f32 v208, -v80, v68
v_mul_f32 v209, -v80, v69
v_mul_f32 v210, -v80, v70
v_mul_f32 v211, -v80, v71
v_mul_f32 v212, -v82, v68
v_mul_f32 v213, -v82, v69
v_mul_f32 v214, -v82, v70
v_mul_f32 v215, -v82, v71
v_mul_f32 v216, -v84, v68
v_mul_f32 v217, -v84, v69
v_mul_f32 v218, -v84, v70
v_mul_f32 v219, -v84, v71
v_mul_f32 v220, -v86, v68
v_mul_f32 v221, -v86, v69
v_mul_f32 v222, -v86, v70
v_mul_f32 v223, -v86, v71
s_barrier
s_branch Lw_123
Lr_124:
v_add_u32 v19, 4, v23
v_and_b32 v19, 15, v19
v_mul_u32_u24 v19, 458752, v19
v_add_u32 v19, v19, v31
buffer_load_dword v30, v19, s[88:91], 0 offen
buffer_load_dword v30, v19, s[92:95], 0 offen
s_mul_i32 s44, s34, 917504
s_lshl_b32 s39, s51, 13
s_add_u32 s44, s44, s39
s_add_u32 s44, s44, 8388608
s_and_b32 s43, s51, 1
s_xor_b32 s43, s43, s35
s_lshl_b32 s43, s43, 7
s_mov_b32 s10, 909312
s_movk_i32 s38, 1024
s_movk_i32 s40, 9216
s_movk_i32 s37, 0x4000
s_cmp_ge_u32 s51, 2
s_cselect_b32 s8, s60, s32
s_cselect_b32 s9, s61, s33
s_cselect_b32 s10, 7338112, s10
s_cselect_b32 s43, s43, s44
s_cselect_b32 s38, 16384, s38
s_cselect_b32 s40, 81920, s40
s_cselect_b32 s55, 81920, s38
s_cselect_b32 s37, 262144, s37
s_cselect_b32 s45, -1, 0
s_add_u32 s8, s8, s43
s_addc_u32 s9, s9, 0
s_mov_b32 s11, 0x20000
s_and_b32 s53, s35, 1
s_mul_i32 s54, s53, 6
s_mul_i32 s54, s54, s37
s_mul_i32 s29, s53, 2
s_add_u32 s29, s29, 6
s_mul_i32 s29, s29, s37
s_and_b32 s43, s45, 4290838528
s_add_u32 s29, s29, s43
s_mul_i32 s37, s37, 2
s_sub_u32 s37, s37, s40
v_lshrrev_b32 v19, 3, v1
v_mul_u32_u24 v19, 1920, v19
v_lshrrev_b32 v20, 4, v1
v_lshlrev_b32 v20, 5, v20
v_and_b32 v19, s45, v19
v_and_b32 v20, s45, v20
v_lshlrev_b32 v21, 4, v1
v_xor_b32 v21, v21, v20
v_add_u32 v21, v21, v19
s_barrier
.p2align 3
LK3b_102:
s_setprio 1
ds_read_b128 v[32:35], v2 offset:0
ds_read_b64_tr_b16 v[48:49], v5 offset:16384
ds_read_b64_tr_b16 v[50:51], v5 offset:20480
ds_read_b128 v[36:39], v2 offset:256
ds_read_b128 v[40:43], v2 offset:512
ds_read_b128 v[44:47], v2 offset:768
ds_read_b64_tr_b16 v[60:61], v5 offset:32768
ds_read_b64_tr_b16 v[62:63], v5 offset:36864
ds_read_b64_tr_b16 v[52:53], v6 offset:16384
ds_read_b64_tr_b16 v[54:55], v6 offset:20480
ds_read_b64_tr_b16 v[64:65], v6 offset:32768
ds_read_b64_tr_b16 v[66:67], v6 offset:36864
ds_read_b64_tr_b16 v[56:57], v7 offset:16384
ds_read_b64_tr_b16 v[58:59], v7 offset:20480
ds_read_b64_tr_b16 v[68:69], v7 offset:32768
ds_read_b64_tr_b16 v[70:71], v7 offset:36864
s_mov_b32 s41, 5
.p2align 3
Lk3_125:
s_waitcnt lgkmcnt(0)
v_mfma_f32_16x16x32_bf16 v[128:131], v[48:51], v[32:35], v[128:131]
ds_read_b128 v[80:83], v2 offset:8192
v_mfma_f32_16x16x32_bf16 v[132:135], v[48:51], v[36:39], v[132:135]
ds_read_b64_tr_b16 v[96:97], v5 offset:24576
v_mfma_f32_16x16x32_bf16 v[136:139], v[48:51], v[40:43], v[136:139]
ds_read_b64_tr_b16 v[98:99], v5 offset:28672
v_mfma_f32_16x16x32_bf16 v[140:143], v[48:51], v[44:47], v[140:143]
ds_read_b128 v[84:87], v2 offset:8448
v_mfma_f32_16x16x32_bf16 v[188:191], v[60:63], v[44:47], v[188:191]
ds_read_b128 v[88:91], v2 offset:8704
v_mfma_f32_16x16x32_bf16 v[184:187], v[60:63], v[40:43], v[184:187]
ds_read_b128 v[92:95], v2 offset:8960
v_mfma_f32_16x16x32_bf16 v[180:183], v[60:63], v[36:39], v[180:183]
ds_read_b64_tr_b16 v[108:109], v5 offset:40960
v_mfma_f32_16x16x32_bf16 v[176:179], v[60:63], v[32:35], v[176:179]
ds_read_b64_tr_b16 v[110:111], v5 offset:45056
v_mfma_f32_16x16x32_bf16 v[144:147], v[52:55], v[32:35], v[144:147]
ds_read_b64_tr_b16 v[100:101], v6 offset:24576
v_mfma_f32_16x16x32_bf16 v[148:151], v[52:55], v[36:39], v[148:151]
ds_read_b64_tr_b16 v[102:103], v6 offset:28672
v_mfma_f32_16x16x32_bf16 v[152:155], v[52:55], v[40:43], v[152:155]
ds_read_b64_tr_b16 v[112:113], v6 offset:40960
v_mfma_f32_16x16x32_bf16 v[156:159], v[52:55], v[44:47], v[156:159]
ds_read_b64_tr_b16 v[114:115], v6 offset:45056
v_mfma_f32_16x16x32_bf16 v[204:207], v[64:67], v[44:47], v[204:207]
ds_read_b64_tr_b16 v[104:105], v7 offset:24576
v_mfma_f32_16x16x32_bf16 v[200:203], v[64:67], v[40:43], v[200:203]
ds_read_b64_tr_b16 v[106:107], v7 offset:28672
v_mfma_f32_16x16x32_bf16 v[196:199], v[64:67], v[36:39], v[196:199]
ds_read_b64_tr_b16 v[116:117], v7 offset:40960
v_mfma_f32_16x16x32_bf16 v[192:195], v[64:67], v[32:35], v[192:195]
ds_read_b64_tr_b16 v[118:119], v7 offset:45056
v_mfma_f32_16x16x32_bf16 v[160:163], v[56:59], v[32:35], v[160:163]
v_mfma_f32_16x16x32_bf16 v[164:167], v[56:59], v[36:39], v[164:167]
v_mfma_f32_16x16x32_bf16 v[168:171], v[56:59], v[40:43], v[168:171]
v_mfma_f32_16x16x32_bf16 v[172:175], v[56:59], v[44:47], v[172:175]
v_mfma_f32_16x16x32_bf16 v[220:223], v[68:71], v[44:47], v[220:223]
v_mfma_f32_16x16x32_bf16 v[216:219], v[68:71], v[40:43], v[216:219]
v_mfma_f32_16x16x32_bf16 v[212:215], v[68:71], v[36:39], v[212:215]
v_mfma_f32_16x16x32_bf16 v[208:211], v[68:71], v[32:35], v[208:211]
s_waitcnt vmcnt(0) lgkmcnt(0)
s_barrier
v_mfma_f32_16x16x32_bf16 v[128:131], v[96:99], v[80:83], v[128:131]
ds_read_b128 v[32:35], v3 offset:0
v_mfma_f32_16x16x32_bf16 v[132:135], v[96:99], v[84:87], v[132:135]
ds_read_b64_tr_b16 v[48:49], v9 offset:16384
v_mfma_f32_16x16x32_bf16 v[136:139], v[96:99], v[88:91], v[136:139]
ds_read_b64_tr_b16 v[50:51], v9 offset:20480
v_mfma_f32_16x16x32_bf16 v[140:143], v[96:99], v[92:95], v[140:143]
ds_read_b128 v[36:39], v3 offset:256
v_mfma_f32_16x16x32_bf16 v[188:191], v[108:111], v[92:95], v[188:191]
ds_read_b128 v[40:43], v3 offset:512
v_mfma_f32_16x16x32_bf16 v[184:187], v[108:111], v[88:91], v[184:187]
ds_read_b128 v[44:47], v3 offset:768
v_mfma_f32_16x16x32_bf16 v[180:183], v[108:111], v[84:87], v[180:183]
ds_read_b64_tr_b16 v[60:61], v9 offset:32768
v_mfma_f32_16x16x32_bf16 v[176:179], v[108:111], v[80:83], v[176:179]
ds_read_b64_tr_b16 v[62:63], v9 offset:36864
v_mfma_f32_16x16x32_bf16 v[144:147], v[100:103], v[80:83], v[144:147]
ds_read_b64_tr_b16 v[52:53], v10 offset:16384
v_mfma_f32_16x16x32_bf16 v[148:151], v[100:103], v[84:87], v[148:151]
ds_read_b64_tr_b16 v[54:55], v10 offset:20480
v_mfma_f32_16x16x32_bf16 v[152:155], v[100:103], v[88:91], v[152:155]
ds_read_b64_tr_b16 v[64:65], v10 offset:32768
v_mfma_f32_16x16x32_bf16 v[156:159], v[100:103], v[92:95], v[156:159]
ds_read_b64_tr_b16 v[66:67], v10 offset:36864
v_mfma_f32_16x16x32_bf16 v[204:207], v[112:115], v[92:95], v[204:207]
ds_read_b64_tr_b16 v[56:57], v11 offset:16384
v_mfma_f32_16x16x32_bf16 v[200:203], v[112:115], v[88:91], v[200:203]
ds_read_b64_tr_b16 v[58:59], v11 offset:20480
v_mfma_f32_16x16x32_bf16 v[196:199], v[112:115], v[84:87], v[196:199]
ds_read_b64_tr_b16 v[68:69], v11 offset:32768
v_mfma_f32_16x16x32_bf16 v[192:195], v[112:115], v[80:83], v[192:195]
ds_read_b64_tr_b16 v[70:71], v11 offset:36864
v_mfma_f32_16x16x32_bf16 v[160:163], v[104:107], v[80:83], v[160:163]
v_mfma_f32_16x16x32_bf16 v[164:167], v[104:107], v[84:87], v[164:167]
v_mfma_f32_16x16x32_bf16 v[168:171], v[104:107], v[88:91], v[168:171]
v_mfma_f32_16x16x32_bf16 v[172:175], v[104:107], v[92:95], v[172:175]
v_mfma_f32_16x16x32_bf16 v[220:223], v[116:119], v[92:95], v[220:223]
v_mfma_f32_16x16x32_bf16 v[216:219], v[116:119], v[88:91], v[216:219]
v_mfma_f32_16x16x32_bf16 v[212:215], v[116:119], v[84:87], v[212:215]
v_mfma_f32_16x16x32_bf16 v[208:211], v[116:119], v[80:83], v[208:211]
s_waitcnt lgkmcnt(0)
v_mfma_f32_16x16x32_bf16 v[128:131], v[48:51], v[32:35], v[128:131]
ds_read_b128 v[80:83], v3 offset:8192
v_mfma_f32_16x16x32_bf16 v[132:135], v[48:51], v[36:39], v[132:135]
ds_read_b64_tr_b16 v[96:97], v9 offset:24576
v_mfma_f32_16x16x32_bf16 v[136:139], v[48:51], v[40:43], v[136:139]
ds_read_b64_tr_b16 v[98:99], v9 offset:28672
v_mfma_f32_16x16x32_bf16 v[140:143], v[48:51], v[44:47], v[140:143]
ds_read_b128 v[84:87], v3 offset:8448
v_mfma_f32_16x16x32_bf16 v[188:191], v[60:63], v[44:47], v[188:191]
ds_read_b128 v[88:91], v3 offset:8704
v_mfma_f32_16x16x32_bf16 v[184:187], v[60:63], v[40:43], v[184:187]
ds_read_b128 v[92:95], v3 offset:8960
v_mfma_f32_16x16x32_bf16 v[180:183], v[60:63], v[36:39], v[180:183]
ds_read_b64_tr_b16 v[108:109], v9 offset:40960
v_mfma_f32_16x16x32_bf16 v[176:179], v[60:63], v[32:35], v[176:179]
ds_read_b64_tr_b16 v[110:111], v9 offset:45056
v_mfma_f32_16x16x32_bf16 v[144:147], v[52:55], v[32:35], v[144:147]
ds_read_b64_tr_b16 v[100:101], v10 offset:24576
v_mfma_f32_16x16x32_bf16 v[148:151], v[52:55], v[36:39], v[148:151]
ds_read_b64_tr_b16 v[102:103], v10 offset:28672
v_mfma_f32_16x16x32_bf16 v[152:155], v[52:55], v[40:43], v[152:155]
ds_read_b64_tr_b16 v[112:113], v10 offset:40960
v_mfma_f32_16x16x32_bf16 v[156:159], v[52:55], v[44:47], v[156:159]
ds_read_b64_tr_b16 v[114:115], v10 offset:45056
v_mfma_f32_16x16x32_bf16 v[204:207], v[64:67], v[44:47], v[204:207]
ds_read_b64_tr_b16 v[104:105], v11 offset:24576
v_mfma_f32_16x16x32_bf16 v[200:203], v[64:67], v[40:43], v[200:203]
ds_read_b64_tr_b16 v[106:107], v11 offset:28672
v_mfma_f32_16x16x32_bf16 v[196:199], v[64:67], v[36:39], v[196:199]
ds_read_b64_tr_b16 v[116:117], v11 offset:40960
v_mfma_f32_16x16x32_bf16 v[192:195], v[64:67], v[32:35], v[192:195]
ds_read_b64_tr_b16 v[118:119], v11 offset:45056
v_mfma_f32_16x16x32_bf16 v[160:163], v[56:59], v[32:35], v[160:163]
v_mfma_f32_16x16x32_bf16 v[164:167], v[56:59], v[36:39], v[164:167]
v_mfma_f32_16x16x32_bf16 v[168:171], v[56:59], v[40:43], v[168:171]
v_mfma_f32_16x16x32_bf16 v[172:175], v[56:59], v[44:47], v[172:175]
v_mfma_f32_16x16x32_bf16 v[220:223], v[68:71], v[44:47], v[220:223]
v_mfma_f32_16x16x32_bf16 v[216:219], v[68:71], v[40:43], v[216:219]
v_mfma_f32_16x16x32_bf16 v[212:215], v[68:71], v[36:39], v[212:215]
v_mfma_f32_16x16x32_bf16 v[208:211], v[68:71], v[32:35], v[208:211]
s_waitcnt lgkmcnt(0)
s_barrier
v_mfma_f32_16x16x32_bf16 v[128:131], v[96:99], v[80:83], v[128:131]
ds_read_b128 v[32:35], v4 offset:0
v_mfma_f32_16x16x32_bf16 v[132:135], v[96:99], v[84:87], v[132:135]
ds_read_b64_tr_b16 v[48:49], v13 offset:16384
v_mfma_f32_16x16x32_bf16 v[136:139], v[96:99], v[88:91], v[136:139]
ds_read_b64_tr_b16 v[50:51], v13 offset:20480
v_mfma_f32_16x16x32_bf16 v[140:143], v[96:99], v[92:95], v[140:143]
ds_read_b128 v[36:39], v4 offset:256
v_mfma_f32_16x16x32_bf16 v[188:191], v[108:111], v[92:95], v[188:191]
ds_read_b128 v[40:43], v4 offset:512
v_mfma_f32_16x16x32_bf16 v[184:187], v[108:111], v[88:91], v[184:187]
ds_read_b128 v[44:47], v4 offset:768
v_mfma_f32_16x16x32_bf16 v[180:183], v[108:111], v[84:87], v[180:183]
ds_read_b64_tr_b16 v[60:61], v13 offset:32768
v_mfma_f32_16x16x32_bf16 v[176:179], v[108:111], v[80:83], v[176:179]
ds_read_b64_tr_b16 v[62:63], v13 offset:36864
v_mfma_f32_16x16x32_bf16 v[144:147], v[100:103], v[80:83], v[144:147]
ds_read_b64_tr_b16 v[52:53], v14 offset:16384
v_mfma_f32_16x16x32_bf16 v[148:151], v[100:103], v[84:87], v[148:151]
ds_read_b64_tr_b16 v[54:55], v14 offset:20480
v_mfma_f32_16x16x32_bf16 v[152:155], v[100:103], v[88:91], v[152:155]
ds_read_b64_tr_b16 v[64:65], v14 offset:32768
v_mfma_f32_16x16x32_bf16 v[156:159], v[100:103], v[92:95], v[156:159]
ds_read_b64_tr_b16 v[66:67], v14 offset:36864
v_mfma_f32_16x16x32_bf16 v[204:207], v[112:115], v[92:95], v[204:207]
ds_read_b64_tr_b16 v[56:57], v15 offset:16384
v_mfma_f32_16x16x32_bf16 v[200:203], v[112:115], v[88:91], v[200:203]
ds_read_b64_tr_b16 v[58:59], v15 offset:20480
v_mfma_f32_16x16x32_bf16 v[196:199], v[112:115], v[84:87], v[196:199]
ds_read_b64_tr_b16 v[68:69], v15 offset:32768
v_mfma_f32_16x16x32_bf16 v[192:195], v[112:115], v[80:83], v[192:195]
ds_read_b64_tr_b16 v[70:71], v15 offset:36864
v_mfma_f32_16x16x32_bf16 v[160:163], v[104:107], v[80:83], v[160:163]
v_mfma_f32_16x16x32_bf16 v[164:167], v[104:107], v[84:87], v[164:167]
v_mfma_f32_16x16x32_bf16 v[168:171], v[104:107], v[88:91], v[168:171]
v_mfma_f32_16x16x32_bf16 v[172:175], v[104:107], v[92:95], v[172:175]
v_mfma_f32_16x16x32_bf16 v[220:223], v[116:119], v[92:95], v[220:223]
v_mfma_f32_16x16x32_bf16 v[216:219], v[116:119], v[88:91], v[216:219]
v_mfma_f32_16x16x32_bf16 v[212:215], v[116:119], v[84:87], v[212:215]
v_mfma_f32_16x16x32_bf16 v[208:211], v[116:119], v[80:83], v[208:211]
s_waitcnt lgkmcnt(0)
v_mfma_f32_16x16x32_bf16 v[128:131], v[48:51], v[32:35], v[128:131]
ds_read_b128 v[80:83], v4 offset:8192
v_mfma_f32_16x16x32_bf16 v[132:135], v[48:51], v[36:39], v[132:135]
ds_read_b64_tr_b16 v[96:97], v13 offset:24576
v_mfma_f32_16x16x32_bf16 v[136:139], v[48:51], v[40:43], v[136:139]
ds_read_b64_tr_b16 v[98:99], v13 offset:28672
v_mfma_f32_16x16x32_bf16 v[140:143], v[48:51], v[44:47], v[140:143]
ds_read_b128 v[84:87], v4 offset:8448
v_mfma_f32_16x16x32_bf16 v[188:191], v[60:63], v[44:47], v[188:191]
ds_read_b128 v[88:91], v4 offset:8704
v_mfma_f32_16x16x32_bf16 v[184:187], v[60:63], v[40:43], v[184:187]
ds_read_b128 v[92:95], v4 offset:8960
v_mfma_f32_16x16x32_bf16 v[180:183], v[60:63], v[36:39], v[180:183]
ds_read_b64_tr_b16 v[108:109], v13 offset:40960
v_mfma_f32_16x16x32_bf16 v[176:179], v[60:63], v[32:35], v[176:179]
ds_read_b64_tr_b16 v[110:111], v13 offset:45056
v_mfma_f32_16x16x32_bf16 v[144:147], v[52:55], v[32:35], v[144:147]
ds_read_b64_tr_b16 v[100:101], v14 offset:24576
v_mfma_f32_16x16x32_bf16 v[148:151], v[52:55], v[36:39], v[148:151]
ds_read_b64_tr_b16 v[102:103], v14 offset:28672
v_mfma_f32_16x16x32_bf16 v[152:155], v[52:55], v[40:43], v[152:155]
ds_read_b64_tr_b16 v[112:113], v14 offset:40960
v_mfma_f32_16x16x32_bf16 v[156:159], v[52:55], v[44:47], v[156:159]
ds_read_b64_tr_b16 v[114:115], v14 offset:45056
v_mfma_f32_16x16x32_bf16 v[204:207], v[64:67], v[44:47], v[204:207]
ds_read_b64_tr_b16 v[104:105], v15 offset:24576
v_mfma_f32_16x16x32_bf16 v[200:203], v[64:67], v[40:43], v[200:203]
ds_read_b64_tr_b16 v[106:107], v15 offset:28672
v_mfma_f32_16x16x32_bf16 v[196:199], v[64:67], v[36:39], v[196:199]
ds_read_b64_tr_b16 v[116:117], v15 offset:40960
v_mfma_f32_16x16x32_bf16 v[192:195], v[64:67], v[32:35], v[192:195]
ds_read_b64_tr_b16 v[118:119], v15 offset:45056
v_mfma_f32_16x16x32_bf16 v[160:163], v[56:59], v[32:35], v[160:163]
v_mfma_f32_16x16x32_bf16 v[164:167], v[56:59], v[36:39], v[164:167]
v_mfma_f32_16x16x32_bf16 v[168:171], v[56:59], v[40:43], v[168:171]
v_mfma_f32_16x16x32_bf16 v[172:175], v[56:59], v[44:47], v[172:175]
v_mfma_f32_16x16x32_bf16 v[220:223], v[68:71], v[44:47], v[220:223]
v_mfma_f32_16x16x32_bf16 v[216:219], v[68:71], v[40:43], v[216:219]
v_mfma_f32_16x16x32_bf16 v[212:215], v[68:71], v[36:39], v[212:215]
v_mfma_f32_16x16x32_bf16 v[208:211], v[68:71], v[32:35], v[208:211]
s_waitcnt lgkmcnt(0)
s_barrier
v_mfma_f32_16x16x32_bf16 v[128:131], v[96:99], v[80:83], v[128:131]
ds_read_b128 v[32:35], v2 offset:0
v_mfma_f32_16x16x32_bf16 v[132:135], v[96:99], v[84:87], v[132:135]
ds_read_b64_tr_b16 v[48:49], v5 offset:16384
v_mfma_f32_16x16x32_bf16 v[136:139], v[96:99], v[88:91], v[136:139]
ds_read_b64_tr_b16 v[50:51], v5 offset:20480
v_mfma_f32_16x16x32_bf16 v[140:143], v[96:99], v[92:95], v[140:143]
ds_read_b128 v[36:39], v2 offset:256
v_mfma_f32_16x16x32_bf16 v[188:191], v[108:111], v[92:95], v[188:191]
ds_read_b128 v[40:43], v2 offset:512
v_mfma_f32_16x16x32_bf16 v[184:187], v[108:111], v[88:91], v[184:187]
ds_read_b128 v[44:47], v2 offset:768
v_mfma_f32_16x16x32_bf16 v[180:183], v[108:111], v[84:87], v[180:183]
ds_read_b64_tr_b16 v[60:61], v5 offset:32768
v_mfma_f32_16x16x32_bf16 v[176:179], v[108:111], v[80:83], v[176:179]
ds_read_b64_tr_b16 v[62:63], v5 offset:36864
v_mfma_f32_16x16x32_bf16 v[144:147], v[100:103], v[80:83], v[144:147]
ds_read_b64_tr_b16 v[52:53], v6 offset:16384
v_mfma_f32_16x16x32_bf16 v[148:151], v[100:103], v[84:87], v[148:151]
ds_read_b64_tr_b16 v[54:55], v6 offset:20480
v_mfma_f32_16x16x32_bf16 v[152:155], v[100:103], v[88:91], v[152:155]
ds_read_b64_tr_b16 v[64:65], v6 offset:32768
v_mfma_f32_16x16x32_bf16 v[156:159], v[100:103], v[92:95], v[156:159]
ds_read_b64_tr_b16 v[66:67], v6 offset:36864
v_mfma_f32_16x16x32_bf16 v[204:207], v[112:115], v[92:95], v[204:207]
ds_read_b64_tr_b16 v[56:57], v7 offset:16384
v_mfma_f32_16x16x32_bf16 v[200:203], v[112:115], v[88:91], v[200:203]
ds_read_b64_tr_b16 v[58:59], v7 offset:20480
v_mfma_f32_16x16x32_bf16 v[196:199], v[112:115], v[84:87], v[196:199]
ds_read_b64_tr_b16 v[68:69], v7 offset:32768
v_mfma_f32_16x16x32_bf16 v[192:195], v[112:115], v[80:83], v[192:195]
ds_read_b64_tr_b16 v[70:71], v7 offset:36864
v_mfma_f32_16x16x32_bf16 v[160:163], v[104:107], v[80:83], v[160:163]
v_mfma_f32_16x16x32_bf16 v[164:167], v[104:107], v[84:87], v[164:167]
v_mfma_f32_16x16x32_bf16 v[168:171], v[104:107], v[88:91], v[168:171]
v_mfma_f32_16x16x32_bf16 v[172:175], v[104:107], v[92:95], v[172:175]
v_mfma_f32_16x16x32_bf16 v[220:223], v[116:119], v[92:95], v[220:223]
v_mfma_f32_16x16x32_bf16 v[216:219], v[116:119], v[88:91], v[216:219]
v_mfma_f32_16x16x32_bf16 v[212:215], v[116:119], v[84:87], v[212:215]
v_mfma_f32_16x16x32_bf16 v[208:211], v[116:119], v[80:83], v[208:211]
s_sub_u32 s41, s41, 1
s_cmp_lg_u32 s41, 0
s_cbranch_scc1 Lk3_125
s_waitcnt lgkmcnt(0)
v_mfma_f32_16x16x32_bf16 v[128:131], v[48:51], v[32:35], v[128:131]
ds_read_b128 v[80:83], v2 offset:8192
v_mfma_f32_16x16x32_bf16 v[132:135], v[48:51], v[36:39], v[132:135]
ds_read_b64_tr_b16 v[96:97], v5 offset:24576
v_mfma_f32_16x16x32_bf16 v[136:139], v[48:51], v[40:43], v[136:139]
ds_read_b64_tr_b16 v[98:99], v5 offset:28672
v_mfma_f32_16x16x32_bf16 v[140:143], v[48:51], v[44:47], v[140:143]
ds_read_b128 v[84:87], v2 offset:8448
v_mfma_f32_16x16x32_bf16 v[188:191], v[60:63], v[44:47], v[188:191]
ds_read_b128 v[88:91], v2 offset:8704
v_mfma_f32_16x16x32_bf16 v[184:187], v[60:63], v[40:43], v[184:187]
ds_read_b128 v[92:95], v2 offset:8960
v_mfma_f32_16x16x32_bf16 v[180:183], v[60:63], v[36:39], v[180:183]
ds_read_b64_tr_b16 v[108:109], v5 offset:40960
v_mfma_f32_16x16x32_bf16 v[176:179], v[60:63], v[32:35], v[176:179]
ds_read_b64_tr_b16 v[110:111], v5 offset:45056
v_mfma_f32_16x16x32_bf16 v[144:147], v[52:55], v[32:35], v[144:147]
ds_read_b64_tr_b16 v[100:101], v6 offset:24576
v_mfma_f32_16x16x32_bf16 v[148:151], v[52:55], v[36:39], v[148:151]
ds_read_b64_tr_b16 v[102:103], v6 offset:28672
v_mfma_f32_16x16x32_bf16 v[152:155], v[52:55], v[40:43], v[152:155]
ds_read_b64_tr_b16 v[112:113], v6 offset:40960
v_mfma_f32_16x16x32_bf16 v[156:159], v[52:55], v[44:47], v[156:159]
ds_read_b64_tr_b16 v[114:115], v6 offset:45056
v_mfma_f32_16x16x32_bf16 v[204:207], v[64:67], v[44:47], v[204:207]
ds_read_b64_tr_b16 v[104:105], v7 offset:24576
v_mfma_f32_16x16x32_bf16 v[200:203], v[64:67], v[40:43], v[200:203]
ds_read_b64_tr_b16 v[106:107], v7 offset:28672
v_mfma_f32_16x16x32_bf16 v[196:199], v[64:67], v[36:39], v[196:199]
ds_read_b64_tr_b16 v[116:117], v7 offset:40960
v_mfma_f32_16x16x32_bf16 v[192:195], v[64:67], v[32:35], v[192:195]
ds_read_b64_tr_b16 v[118:119], v7 offset:45056
v_mfma_f32_16x16x32_bf16 v[160:163], v[56:59], v[32:35], v[160:163]
v_mfma_f32_16x16x32_bf16 v[164:167], v[56:59], v[36:39], v[164:167]
v_mfma_f32_16x16x32_bf16 v[168:171], v[56:59], v[40:43], v[168:171]
v_mfma_f32_16x16x32_bf16 v[172:175], v[56:59], v[44:47], v[172:175]
v_mfma_f32_16x16x32_bf16 v[220:223], v[68:71], v[44:47], v[220:223]
v_mfma_f32_16x16x32_bf16 v[216:219], v[68:71], v[40:43], v[216:219]
v_mfma_f32_16x16x32_bf16 v[212:215], v[68:71], v[36:39], v[212:215]
v_mfma_f32_16x16x32_bf16 v[208:211], v[68:71], v[32:35], v[208:211]
s_waitcnt lgkmcnt(0)
s_barrier
s_cmp_eq_u32 s36, 7
s_cbranch_scc1 L7b_126
s_add_u32 m0, s39, 0
s_add_u32 s37, s37, s40
buffer_load_dwordx4 v21, s[8:11], s37 offen sc1 lds
v_mfma_f32_16x16x32_bf16 v[128:131], v[96:99], v[80:83], v[128:131]
v_mfma_f32_16x16x32_bf16 v[132:135], v[96:99], v[84:87], v[132:135]
s_add_u32 m0, s39, 1024
s_add_u32 s37, s37, s38
buffer_load_dwordx4 v21, s[8:11], s37 offen sc1 lds
v_mfma_f32_16x16x32_bf16 v[136:139], v[96:99], v[88:91], v[136:139]
s_add_u32 m0, s39, 2048
s_add_u32 s37, s37, s38
buffer_load_dwordx4 v21, s[8:11], s37 offen sc1 lds
v_mfma_f32_16x16x32_bf16 v[140:143], v[96:99], v[92:95], v[140:143]
v_mfma_f32_16x16x32_bf16 v[188:191], v[108:111], v[92:95], v[188:191]
s_add_u32 m0, s39, 3072
s_add_u32 s37, s37, s38
buffer_load_dwordx4 v21, s[8:11], s37 offen sc1 lds
v_mfma_f32_16x16x32_bf16 v[184:187], v[108:111], v[88:91], v[184:187]
s_add_u32 m0, s39, 4096
s_add_u32 s37, s37, s55
buffer_load_dwordx4 v21, s[8:11], s37 offen sc1 lds
v_mfma_f32_16x16x32_bf16 v[180:183], v[108:111], v[84:87], v[180:183]
v_mfma_f32_16x16x32_bf16 v[176:179], v[108:111], v[80:83], v[176:179]
s_add_u32 m0, s39, 5120
s_add_u32 s37, s37, s38
buffer_load_dwordx4 v21, s[8:11], s37 offen sc1 lds
v_mfma_f32_16x16x32_bf16 v[144:147], v[100:103], v[80:83], v[144:147]
s_add_u32 m0, s39, 6144
s_add_u32 s37, s37, s38
buffer_load_dwordx4 v21, s[8:11], s37 offen sc1 lds
v_mfma_f32_16x16x32_bf16 v[148:151], v[100:103], v[84:87], v[148:151]
v_mfma_f32_16x16x32_bf16 v[152:155], v[100:103], v[88:91], v[152:155]
s_add_u32 m0, s39, 7168
s_add_u32 s37, s37, s38
buffer_load_dwordx4 v21, s[8:11], s37 offen sc1 lds
v_mfma_f32_16x16x32_bf16 v[156:159], v[100:103], v[92:95], v[156:159]
s_add_u32 m0, s39, 32768
s_add_u32 s37, s37, s40
buffer_load_dwordx4 v21, s[8:11], s37 offen sc1 lds
v_mfma_f32_16x16x32_bf16 v[204:207], v[112:115], v[92:95], v[204:207]
v_mfma_f32_16x16x32_bf16 v[200:203], v[112:115], v[88:91], v[200:203]
s_add_u32 m0, s39, 33792
s_add_u32 s37, s37, s38
buffer_load_dwordx4 v21, s[8:11], s37 offen sc1 lds
v_mfma_f32_16x16x32_bf16 v[196:199], v[112:115], v[84:87], v[196:199]
s_add_u32 m0, s39, 34816
s_add_u32 s37, s37, s38
buffer_load_dwordx4 v21, s[8:11], s37 offen sc1 lds
v_mfma_f32_16x16x32_bf16 v[192:195], v[112:115], v[80:83], v[192:195]
v_mfma_f32_16x16x32_bf16 v[160:163], v[104:107], v[80:83], v[160:163]
s_add_u32 m0, s39, 35840
s_add_u32 s37, s37, s38
buffer_load_dwordx4 v21, s[8:11], s37 offen sc1 lds
v_mfma_f32_16x16x32_bf16 v[164:167], v[104:107], v[84:87], v[164:167]
s_add_u32 m0, s39, 36864
s_add_u32 s37, s37, s55
buffer_load_dwordx4 v21, s[8:11], s37 offen sc1 lds
v_mfma_f32_16x16x32_bf16 v[168:171], v[104:107], v[88:91], v[168:171]
v_mfma_f32_16x16x32_bf16 v[172:175], v[104:107], v[92:95], v[172:175]
s_add_u32 m0, s39, 37888
s_add_u32 s37, s37, s38
buffer_load_dwordx4 v21, s[8:11], s37 offen sc1 lds
v_mfma_f32_16x16x32_bf16 v[220:223], v[116:119], v[92:95], v[220:223]
s_add_u32 m0, s39, 38912
s_add_u32 s37, s37, s38
buffer_load_dwordx4 v21, s[8:11], s37 offen sc1 lds
v_mfma_f32_16x16x32_bf16 v[216:219], v[116:119], v[88:91], v[216:219]
v_mfma_f32_16x16x32_bf16 v[212:215], v[116:119], v[84:87], v[212:215]
s_add_u32 m0, s39, 39936
s_add_u32 s37, s37, s38
buffer_load_dwordx4 v21, s[8:11], s37 offen sc1 lds
v_mfma_f32_16x16x32_bf16 v[208:211], v[116:119], v[80:83], v[208:211]
s_setprio 0
s_barrier
s_add_u32 s37, s37, s54
s_add_u32 m0, s39, 65536
s_add_u32 s37, s37, s40
buffer_load_dwordx4 v21, s[8:11], s37 offen sc1 lds
v_mul_f32 v80, v128, v128
v_mul_f32 v81, v129, v129
v_mul_f32 v82, v130, v130
v_mul_f32 v83, v131, v131
v_fma_f32 v80, v80, v232, v228
v_fma_f32 v81, v81, v232, v228
v_fma_f32 v82, v82, v232, v228
s_add_u32 m0, s39, 66560
s_add_u32 s37, s37, s38
buffer_load_dwordx4 v21, s[8:11], s37 offen sc1 lds
v_fma_f32 v83, v83, v232, v228
v_mul_f32 v80, v80, v128
v_mul_f32 v81, v81, v129
v_mul_f32 v82, v82, v130
v_mul_f32 v83, v83, v131
v_exp_f32 v80, v80
s_add_u32 m0, s39, 67584
s_add_u32 s37, s37, s38
buffer_load_dwordx4 v21, s[8:11], s37 offen sc1 lds
v_exp_f32 v81, v81
v_exp_f32 v82, v82
v_exp_f32 v83, v83
v_mul_f32 v176, v128, v176
v_mul_f32 v177, v129, v177
v_mul_f32 v178, v130, v178
v_mul_f32 v179, v131, v179
s_add_u32 m0, s39, 68608
s_add_u32 s37, s37, s38
buffer_load_dwordx4 v21, s[8:11], s37 offen sc1 lds
v_fma_f32 v80, v80, v236, v236
v_fma_f32 v81, v81, v236, v236
v_fma_f32 v82, v82, v236, v236
v_fma_f32 v83, v83, v236, v236
v_rcp_f32 v80, v80
v_rcp_f32 v81, v81
s_add_u32 m0, s39, 69632
s_add_u32 s37, s37, s55
buffer_load_dwordx4 v21, s[8:11], s37 offen sc1 lds
v_rcp_f32 v82, v82
v_rcp_f32 v83, v83
v_mul_f32 v176, v176, v80
v_mul_f32 v177, v177, v81
v_mul_f32 v178, v178, v82
v_mul_f32 v179, v179, v83
v_cvt_pk_bf16_f32 v96, v176, v177
s_add_u32 m0, s39, 70656
s_add_u32 s37, s37, s38
buffer_load_dwordx4 v21, s[8:11], s37 offen sc1 lds
v_cvt_pk_bf16_f32 v97, v178, v179
v_mul_f32 v84, v144, v144
v_mul_f32 v85, v145, v145
v_mul_f32 v86, v146, v146
v_mul_f32 v87, v147, v147
v_fma_f32 v84, v84, v232, v228
s_add_u32 m0, s39, 71680
s_add_u32 s37, s37, s38
buffer_load_dwordx4 v21, s[8:11], s37 offen sc1 lds
v_fma_f32 v85, v85, v232, v228
v_fma_f32 v86, v86, v232, v228
v_fma_f32 v87, v87, v232, v228
v_mul_f32 v84, v84, v144
v_mul_f32 v85, v85, v145
v_mul_f32 v86, v86, v146
v_mul_f32 v87, v87, v147
s_add_u32 m0, s39, 72704
s_add_u32 s37, s37, s38
buffer_load_dwordx4 v21, s[8:11], s37 offen sc1 lds
v_exp_f32 v84, v84
v_exp_f32 v85, v85
v_exp_f32 v86, v86
v_exp_f32 v87, v87
v_mul_f32 v192, v144, v192
v_mul_f32 v193, v145, v193
s_waitcnt vmcnt(16)
s_barrier
s_add_u32 m0, s39, 98304
s_add_u32 s37, s37, s40
buffer_load_dwordx4 v21, s[8:11], s37 offen sc1 lds
v_mul_f32 v194, v146, v194
v_mul_f32 v195, v147, v195
v_fma_f32 v84, v84, v236, v236
v_fma_f32 v85, v85, v236, v236
v_fma_f32 v86, v86, v236, v236
v_fma_f32 v87, v87, v236, v236
v_rcp_f32 v84, v84
s_add_u32 m0, s39, 99328
s_add_u32 s37, s37, s38
buffer_load_dwordx4 v21, s[8:11], s37 offen sc1 lds
v_rcp_f32 v85, v85
v_rcp_f32 v86, v86
v_rcp_f32 v87, v87
v_mul_f32 v192, v192, v84
v_mul_f32 v193, v193, v85
v_mul_f32 v194, v194, v86
v_mul_f32 v195, v195, v87
s_add_u32 m0, s39, 100352
s_add_u32 s37, s37, s38
buffer_load_dwordx4 v21, s[8:11], s37 offen sc1 lds
v_cvt_pk_bf16_f32 v98, v192, v193
v_cvt_pk_bf16_f32 v99, v194, v195
v_mul_f32 v80, v160, v160
v_mul_f32 v81, v161, v161
v_mul_f32 v82, v162, v162
s_add_u32 m0, s39, 101376
s_add_u32 s37, s37, s38
buffer_load_dwordx4 v21, s[8:11], s37 offen sc1 lds
v_mul_f32 v83, v163, v163
v_fma_f32 v80, v80, v232, v228
v_fma_f32 v81, v81, v232, v228
v_fma_f32 v82, v82, v232, v228
v_fma_f32 v83, v83, v232, v228
v_mul_f32 v80, v80, v160
v_mul_f32 v81, v81, v161
s_add_u32 m0, s39, 102400
s_add_u32 s37, s37, s55
buffer_load_dwordx4 v21, s[8:11], s37 offen sc1 lds
v_mul_f32 v82, v82, v162
v_mul_f32 v83, v83, v163
v_exp_f32 v80, v80
v_exp_f32 v81, v81
v_exp_f32 v82, v82
v_exp_f32 v83, v83
v_mul_f32 v208, v160, v208
s_add_u32 m0, s39, 103424
s_add_u32 s37, s37, s38
buffer_load_dwordx4 v21, s[8:11], s37 offen sc1 lds
v_mul_f32 v209, v161, v209
v_mul_f32 v210, v162, v210
v_mul_f32 v211, v163, v211
v_fma_f32 v80, v80, v236, v236
v_fma_f32 v81, v81, v236, v236
v_fma_f32 v82, v82, v236, v236
s_add_u32 m0, s39, 104448
s_add_u32 s37, s37, s38
buffer_load_dwordx4 v21, s[8:11], s37 offen sc1 lds
v_fma_f32 v83, v83, v236, v236
v_rcp_f32 v80, v80
v_rcp_f32 v81, v81
v_rcp_f32 v82, v82
v_rcp_f32 v83, v83
v_mul_f32 v208, v208, v80
v_mul_f32 v209, v209, v81
s_add_u32 m0, s39, 105472
s_add_u32 s37, s37, s38
buffer_load_dwordx4 v21, s[8:11], s37 offen sc1 lds
v_mul_f32 v210, v210, v82
v_mul_f32 v211, v211, v83
v_cvt_pk_bf16_f32 v112, v208, v209
v_cvt_pk_bf16_f32 v113, v210, v211
v_mul_f32 v80, v132, v132
v_mul_f32 v81, v133, v133
buffer_store_dwordx4 v[96:99], v27, s[24:27], 0 offen offset:0 sc1
s_waitcnt vmcnt(17)
s_barrier
s_add_u32 m0, s39, 0
s_add_u32 s37, s37, s40
buffer_load_dwordx4 v21, s[8:11], s37 offen sc1 lds
v_mul_f32 v82, v134, v134
v_mul_f32 v83, v135, v135
v_fma_f32 v80, v80, v233, v229
v_fma_f32 v81, v81, v233, v229
v_fma_f32 v82, v82, v233, v229
v_fma_f32 v83, v83, v233, v229
v_mul_f32 v80, v80, v132
s_add_u32 m0, s39, 1024
s_add_u32 s37, s37, s38
buffer_load_dwordx4 v21, s[8:11], s37 offen sc1 lds
v_mul_f32 v81, v81, v133
v_mul_f32 v82, v82, v134
v_mul_f32 v83, v83, v135
v_exp_f32 v80, v80
v_exp_f32 v81, v81
v_exp_f32 v82, v82
s_add_u32 m0, s39, 2048
s_add_u32 s37, s37, s38
buffer_load_dwordx4 v21, s[8:11], s37 offen sc1 lds
v_exp_f32 v83, v83
v_mul_f32 v180, v132, v180
v_mul_f32 v181, v133, v181
v_mul_f32 v182, v134, v182
v_mul_f32 v183, v135, v183
v_fma_f32 v80, v80, v237, v237
v_fma_f32 v81, v81, v237, v237
s_add_u32 m0, s39, 3072
s_add_u32 s37, s37, s38
buffer_load_dwordx4 v21, s[8:11], s37 offen sc1 lds
v_fma_f32 v82, v82, v237, v237
v_fma_f32 v83, v83, v237, v237
v_rcp_f32 v80, v80
v_rcp_f32 v81, v81
v_rcp_f32 v82, v82
v_rcp_f32 v83, v83
s_add_u32 m0, s39, 4096
s_add_u32 s37, s37, s55
buffer_load_dwordx4 v21, s[8:11], s37 offen sc1 lds
v_mul_f32 v180, v180, v80
v_mul_f32 v181, v181, v81
v_mul_f32 v182, v182, v82
v_mul_f32 v183, v183, v83
v_cvt_pk_bf16_f32 v100, v180, v181
v_cvt_pk_bf16_f32 v101, v182, v183
v_mul_f32 v84, v148, v148
s_add_u32 m0, s39, 5120
s_add_u32 s37, s37, s38
buffer_load_dwordx4 v21, s[8:11], s37 offen sc1 lds
v_mul_f32 v85, v149, v149
v_mul_f32 v86, v150, v150
v_mul_f32 v87, v151, v151
v_fma_f32 v84, v84, v233, v229
v_fma_f32 v85, v85, v233, v229
v_fma_f32 v86, v86, v233, v229
s_add_u32 m0, s39, 6144
s_add_u32 s37, s37, s38
buffer_load_dwordx4 v21, s[8:11], s37 offen sc1 lds
v_fma_f32 v87, v87, v233, v229
v_mul_f32 v84, v84, v148
v_mul_f32 v85, v85, v149
v_mul_f32 v86, v86, v150
v_mul_f32 v87, v87, v151
v_exp_f32 v84, v84
v_exp_f32 v85, v85
s_add_u32 m0, s39, 7168
s_add_u32 s37, s37, s38
buffer_load_dwordx4 v21, s[8:11], s37 offen sc1 lds
v_exp_f32 v86, v86
v_exp_f32 v87, v87
v_mul_f32 v196, v148, v196
v_mul_f32 v197, v149, v197
v_mul_f32 v198, v150, v198
v_mul_f32 v199, v151, v199
s_waitcnt vmcnt(17)
s_barrier
s_add_u32 m0, s39, 32768
s_add_u32 s37, s37, s40
buffer_load_dwordx4 v21, s[8:11], s37 offen sc1 lds
v_fma_f32 v84, v84, v237, v237
v_fma_f32 v85, v85, v237, v237
v_fma_f32 v86, v86, v237, v237
v_fma_f32 v87, v87, v237, v237
v_rcp_f32 v84, v84
v_rcp_f32 v85, v85
v_rcp_f32 v86, v86
s_add_u32 m0, s39, 33792
s_add_u32 s37, s37, s38
buffer_load_dwordx4 v21, s[8:11], s37 offen sc1 lds
v_rcp_f32 v87, v87
v_mul_f32 v196, v196, v84
v_mul_f32 v197, v197, v85
v_mul_f32 v198, v198, v86
v_mul_f32 v199, v199, v87
v_cvt_pk_bf16_f32 v102, v196, v197
v_cvt_pk_bf16_f32 v103, v198, v199
s_add_u32 m0, s39, 34816
s_add_u32 s37, s37, s38
buffer_load_dwordx4 v21, s[8:11], s37 offen sc1 lds
v_mul_f32 v80, v164, v164
v_mul_f32 v81, v165, v165
v_mul_f32 v82, v166, v166
v_mul_f32 v83, v167, v167
v_fma_f32 v80, v80, v233, v229
s_add_u32 m0, s39, 35840
s_add_u32 s37, s37, s38
buffer_load_dwordx4 v21, s[8:11], s37 offen sc1 lds
v_fma_f32 v81, v81, v233, v229
v_fma_f32 v82, v82, v233, v229
v_fma_f32 v83, v83, v233, v229
v_mul_f32 v80, v80, v164
v_mul_f32 v81, v81, v165
v_mul_f32 v82, v82, v166
v_mul_f32 v83, v83, v167
s_add_u32 m0, s39, 36864
s_add_u32 s37, s37, s55
buffer_load_dwordx4 v21, s[8:11], s37 offen sc1 lds
v_exp_f32 v80, v80
v_exp_f32 v81, v81
v_exp_f32 v82, v82
v_exp_f32 v83, v83
v_mul_f32 v212, v164, v212
v_mul_f32 v213, v165, v213
v_mul_f32 v214, v166, v214
s_add_u32 m0, s39, 37888
s_add_u32 s37, s37, s38
buffer_load_dwordx4 v21, s[8:11], s37 offen sc1 lds
v_mul_f32 v215, v167, v215
v_fma_f32 v80, v80, v237, v237
v_fma_f32 v81, v81, v237, v237
v_fma_f32 v82, v82, v237, v237
v_fma_f32 v83, v83, v237, v237
v_rcp_f32 v80, v80
s_add_u32 m0, s39, 38912
s_add_u32 s37, s37, s38
buffer_load_dwordx4 v21, s[8:11], s37 offen sc1 lds
v_rcp_f32 v81, v81
v_rcp_f32 v82, v82
v_rcp_f32 v83, v83
v_mul_f32 v212, v212, v80
v_mul_f32 v213, v213, v81
v_mul_f32 v214, v214, v82
v_mul_f32 v215, v215, v83
s_add_u32 m0, s39, 39936
s_add_u32 s37, s37, s38
buffer_load_dwordx4 v21, s[8:11], s37 offen sc1 lds
v_cvt_pk_bf16_f32 v114, v212, v213
v_cvt_pk_bf16_f32 v115, v214, v215
s_nop 1
v_permlane32_swap_b32 v112, v114
v_permlane32_swap_b32 v113, v115
buffer_store_dwordx4 v[100:103], v27, s[24:27], 0 offen offset:256 sc1
buffer_store_dwordx4 v[112:115], v28, s[24:27], 0 offen offset:0 sc1
s_waitcnt vmcnt(19)
s_barrier
s_add_u32 m0, s39, 65536
s_add_u32 s37, s37, s40
buffer_load_dwordx4 v21, s[8:11], s37 offen sc1 lds
v_mul_f32 v80, v136, v136
v_mul_f32 v81, v137, v137
v_mul_f32 v82, v138, v138
v_mul_f32 v83, v139, v139
v_fma_f32 v80, v80, v234, v230
v_fma_f32 v81, v81, v234, v230
v_fma_f32 v82, v82, v234, v230
s_add_u32 m0, s39, 66560
s_add_u32 s37, s37, s38
buffer_load_dwordx4 v21, s[8:11], s37 offen sc1 lds
v_fma_f32 v83, v83, v234, v230
v_mul_f32 v80, v80, v136
v_mul_f32 v81, v81, v137
v_mul_f32 v82, v82, v138
v_mul_f32 v83, v83, v139
v_exp_f32 v80, v80
s_add_u32 m0, s39, 67584
s_add_u32 s37, s37, s38
buffer_load_dwordx4 v21, s[8:11], s37 offen sc1 lds
v_exp_f32 v81, v81
v_exp_f32 v82, v82
v_exp_f32 v83, v83
v_mul_f32 v184, v136, v184
v_mul_f32 v185, v137, v185
v_mul_f32 v186, v138, v186
v_mul_f32 v187, v139, v187
s_add_u32 m0, s39, 68608
s_add_u32 s37, s37, s38
buffer_load_dwordx4 v21, s[8:11], s37 offen sc1 lds
v_fma_f32 v80, v80, v238, v238
v_fma_f32 v81, v81, v238, v238
v_fma_f32 v82, v82, v238, v238
v_fma_f32 v83, v83, v238, v238
v_rcp_f32 v80, v80
v_rcp_f32 v81, v81
s_add_u32 m0, s39, 69632
s_add_u32 s37, s37, s55
buffer_load_dwordx4 v21, s[8:11], s37 offen sc1 lds
v_rcp_f32 v82, v82
v_rcp_f32 v83, v83
v_mul_f32 v184, v184, v80
v_mul_f32 v185, v185, v81
v_mul_f32 v186, v186, v82
v_mul_f32 v187, v187, v83
v_cvt_pk_bf16_f32 v104, v184, v185
s_add_u32 m0, s39, 70656
s_add_u32 s37, s37, s38
buffer_load_dwordx4 v21, s[8:11], s37 offen sc1 lds
v_cvt_pk_bf16_f32 v105, v186, v187
v_mul_f32 v84, v152, v152
v_mul_f32 v85, v153, v153
v_mul_f32 v86, v154, v154
v_mul_f32 v87, v155, v155
v_fma_f32 v84, v84, v234, v230
s_add_u32 m0, s39, 71680
s_add_u32 s37, s37, s38
buffer_load_dwordx4 v21, s[8:11], s37 offen sc1 lds
v_fma_f32 v85, v85, v234, v230
v_fma_f32 v86, v86, v234, v230
v_fma_f32 v87, v87, v234, v230
v_mul_f32 v84, v84, v152
v_mul_f32 v85, v85, v153
v_mul_f32 v86, v86, v154
v_mul_f32 v87, v87, v155
s_add_u32 m0, s39, 72704
s_add_u32 s37, s37, s38
buffer_load_dwordx4 v21, s[8:11], s37 offen sc1 lds
v_exp_f32 v84, v84
v_exp_f32 v85, v85
v_exp_f32 v86, v86
v_exp_f32 v87, v87
v_mul_f32 v200, v152, v200
v_mul_f32 v201, v153, v201
s_waitcnt vmcnt(18)
s_barrier
s_add_u32 m0, s39, 98304
s_add_u32 s37, s37, s40
buffer_load_dwordx4 v21, s[8:11], s37 offen sc1 lds
v_mul_f32 v202, v154, v202
v_mul_f32 v203, v155, v203
v_fma_f32 v84, v84, v238, v238
v_fma_f32 v85, v85, v238, v238
v_fma_f32 v86, v86, v238, v238
v_fma_f32 v87, v87, v238, v238
v_rcp_f32 v84, v84
s_add_u32 m0, s39, 99328
s_add_u32 s37, s37, s38
buffer_load_dwordx4 v21, s[8:11], s37 offen sc1 lds
v_rcp_f32 v85, v85
v_rcp_f32 v86, v86
v_rcp_f32 v87, v87
v_mul_f32 v200, v200, v84
v_mul_f32 v201, v201, v85
v_mul_f32 v202, v202, v86
v_mul_f32 v203, v203, v87
s_add_u32 m0, s39, 100352
s_add_u32 s37, s37, s38
buffer_load_dwordx4 v21, s[8:11], s37 offen sc1 lds
v_cvt_pk_bf16_f32 v106, v200, v201
v_cvt_pk_bf16_f32 v107, v202, v203
v_mul_f32 v80, v168, v168
v_mul_f32 v81, v169, v169
v_mul_f32 v82, v170, v170
s_add_u32 m0, s39, 101376
s_add_u32 s37, s37, s38
buffer_load_dwordx4 v21, s[8:11], s37 offen sc1 lds
v_mul_f32 v83, v171, v171
v_fma_f32 v80, v80, v234, v230
v_fma_f32 v81, v81, v234, v230
v_fma_f32 v82, v82, v234, v230
v_fma_f32 v83, v83, v234, v230
v_mul_f32 v80, v80, v168
v_mul_f32 v81, v81, v169
s_add_u32 m0, s39, 102400
s_add_u32 s37, s37, s55
buffer_load_dwordx4 v21, s[8:11], s37 offen sc1 lds
v_mul_f32 v82, v82, v170
v_mul_f32 v83, v83, v171
v_exp_f32 v80, v80
v_exp_f32 v81, v81
v_exp_f32 v82, v82
v_exp_f32 v83, v83
v_mul_f32 v216, v168, v216
s_add_u32 m0, s39, 103424
s_add_u32 s37, s37, s38
buffer_load_dwordx4 v21, s[8:11], s37 offen sc1 lds
v_mul_f32 v217, v169, v217
v_mul_f32 v218, v170, v218
v_mul_f32 v219, v171, v219
v_fma_f32 v80, v80, v238, v238
v_fma_f32 v81, v81, v238, v238
v_fma_f32 v82, v82, v238, v238
s_add_u32 m0, s39, 104448
s_add_u32 s37, s37, s38
buffer_load_dwordx4 v21, s[8:11], s37 offen sc1 lds
v_fma_f32 v83, v83, v238, v238
v_rcp_f32 v80, v80
v_rcp_f32 v81, v81
v_rcp_f32 v82, v82
v_rcp_f32 v83, v83
v_mul_f32 v216, v216, v80
v_mul_f32 v217, v217, v81
s_add_u32 m0, s39, 105472
s_add_u32 s37, s37, s38
buffer_load_dwordx4 v21, s[8:11], s37 offen sc1 lds
v_mul_f32 v218, v218, v82
v_mul_f32 v219, v219, v83
v_cvt_pk_bf16_f32 v116, v216, v217
v_cvt_pk_bf16_f32 v117, v218, v219
v_mul_f32 v80, v140, v140
v_mul_f32 v81, v141, v141
buffer_store_dwordx4 v[104:107], v27, s[24:27], 0 offen offset:512 sc1
s_waitcnt vmcnt(19)
s_barrier
s_add_u32 s37, s37, s29
s_add_u32 m0, s39, 0
s_add_u32 s37, s37, s40
buffer_load_dwordx4 v21, s[8:11], s37 offen sc1 lds
v_mul_f32 v82, v142, v142
v_mul_f32 v83, v143, v143
v_fma_f32 v80, v80, v235, v231
v_fma_f32 v81, v81, v235, v231
v_fma_f32 v82, v82, v235, v231
v_fma_f32 v83, v83, v235, v231
v_mul_f32 v80, v80, v140
s_add_u32 m0, s39, 1024
s_add_u32 s37, s37, s38
buffer_load_dwordx4 v21, s[8:11], s37 offen sc1 lds
v_mul_f32 v81, v81, v141
v_mul_f32 v82, v82, v142
v_mul_f32 v83, v83, v143
v_exp_f32 v80, v80
v_exp_f32 v81, v81
v_exp_f32 v82, v82
s_add_u32 m0, s39, 2048
s_add_u32 s37, s37, s38
buffer_load_dwordx4 v21, s[8:11], s37 offen sc1 lds
v_exp_f32 v83, v83
v_mul_f32 v188, v140, v188
v_mul_f32 v189, v141, v189
v_mul_f32 v190, v142, v190
v_mul_f32 v191, v143, v191
v_fma_f32 v80, v80, v239, v239
v_fma_f32 v81, v81, v239, v239
s_add_u32 m0, s39, 3072
s_add_u32 s37, s37, s38
buffer_load_dwordx4 v21, s[8:11], s37 offen sc1 lds
v_fma_f32 v82, v82, v239, v239
v_fma_f32 v83, v83, v239, v239
v_rcp_f32 v80, v80
v_rcp_f32 v81, v81
v_rcp_f32 v82, v82
v_rcp_f32 v83, v83
s_add_u32 m0, s39, 4096
s_add_u32 s37, s37, s55
buffer_load_dwordx4 v21, s[8:11], s37 offen sc1 lds
v_mul_f32 v188, v188, v80
v_mul_f32 v189, v189, v81
v_mul_f32 v190, v190, v82
v_mul_f32 v191, v191, v83
v_cvt_pk_bf16_f32 v108, v188, v189
v_cvt_pk_bf16_f32 v109, v190, v191
v_mul_f32 v84, v156, v156
s_add_u32 m0, s39, 5120
s_add_u32 s37, s37, s38
buffer_load_dwordx4 v21, s[8:11], s37 offen sc1 lds
v_mul_f32 v85, v157, v157
v_mul_f32 v86, v158, v158
v_mul_f32 v87, v159, v159
v_fma_f32 v84, v84, v235, v231
v_fma_f32 v85, v85, v235, v231
v_fma_f32 v86, v86, v235, v231
s_add_u32 m0, s39, 6144
s_add_u32 s37, s37, s38
buffer_load_dwordx4 v21, s[8:11], s37 offen sc1 lds
v_fma_f32 v87, v87, v235, v231
v_mul_f32 v84, v84, v156
v_mul_f32 v85, v85, v157
v_mul_f32 v86, v86, v158
v_mul_f32 v87, v87, v159
v_exp_f32 v84, v84
v_exp_f32 v85, v85
s_add_u32 m0, s39, 7168
s_add_u32 s37, s37, s38
buffer_load_dwordx4 v21, s[8:11], s37 offen sc1 lds
v_exp_f32 v86, v86
v_exp_f32 v87, v87
v_mul_f32 v204, v156, v204
v_mul_f32 v205, v157, v205
v_mul_f32 v206, v158, v206
v_mul_f32 v207, v159, v207
s_waitcnt vmcnt(17)
s_barrier
s_add_u32 m0, s39, 32768
s_add_u32 s37, s37, s40
buffer_load_dwordx4 v21, s[8:11], s37 offen sc1 lds
v_fma_f32 v84, v84, v239, v239
v_fma_f32 v85, v85, v239, v239
v_fma_f32 v86, v86, v239, v239
v_fma_f32 v87, v87, v239, v239
v_rcp_f32 v84, v84
v_rcp_f32 v85, v85
v_rcp_f32 v86, v86
s_add_u32 m0, s39, 33792
s_add_u32 s37, s37, s38
buffer_load_dwordx4 v21, s[8:11], s37 offen sc1 lds
v_rcp_f32 v87, v87
v_mul_f32 v204, v204, v84
v_mul_f32 v205, v205, v85
v_mul_f32 v206, v206, v86
v_mul_f32 v207, v207, v87
v_cvt_pk_bf16_f32 v110, v204, v205
v_cvt_pk_bf16_f32 v111, v206, v207
s_add_u32 m0, s39, 34816
s_add_u32 s37, s37, s38
buffer_load_dwordx4 v21, s[8:11], s37 offen sc1 lds
v_mul_f32 v80, v172, v172
v_mul_f32 v81, v173, v173
v_mul_f32 v82, v174, v174
v_mul_f32 v83, v175, v175
v_fma_f32 v80, v80, v235, v231
s_add_u32 m0, s39, 35840
s_add_u32 s37, s37, s38
buffer_load_dwordx4 v21, s[8:11], s37 offen sc1 lds
v_fma_f32 v81, v81, v235, v231
v_fma_f32 v82, v82, v235, v231
v_fma_f32 v83, v83, v235, v231
v_mul_f32 v80, v80, v172
v_mul_f32 v81, v81, v173
v_mul_f32 v82, v82, v174
v_mul_f32 v83, v83, v175
s_add_u32 m0, s39, 36864
s_add_u32 s37, s37, s55
buffer_load_dwordx4 v21, s[8:11], s37 offen sc1 lds
v_exp_f32 v80, v80
v_exp_f32 v81, v81
v_exp_f32 v82, v82
v_exp_f32 v83, v83
v_mul_f32 v220, v172, v220
v_mul_f32 v221, v173, v221
v_mul_f32 v222, v174, v222
s_add_u32 m0, s39, 37888
s_add_u32 s37, s37, s38
buffer_load_dwordx4 v21, s[8:11], s37 offen sc1 lds
v_mul_f32 v223, v175, v223
v_fma_f32 v80, v80, v239, v239
v_fma_f32 v81, v81, v239, v239
v_fma_f32 v82, v82, v239, v239
v_fma_f32 v83, v83, v239, v239
v_rcp_f32 v80, v80
s_add_u32 m0, s39, 38912
s_add_u32 s37, s37, s38
buffer_load_dwordx4 v21, s[8:11], s37 offen sc1 lds
v_rcp_f32 v81, v81
v_rcp_f32 v82, v82
v_rcp_f32 v83, v83
v_mul_f32 v220, v220, v80
v_mul_f32 v221, v221, v81
v_mul_f32 v222, v222, v82
v_mul_f32 v223, v223, v83
s_add_u32 m0, s39, 39936
s_add_u32 s37, s37, s38
buffer_load_dwordx4 v21, s[8:11], s37 offen sc1 lds
v_cvt_pk_bf16_f32 v118, v220, v221
v_cvt_pk_bf16_f32 v119, v222, v223
s_nop 1
v_permlane32_swap_b32 v116, v118
v_permlane32_swap_b32 v117, v119
buffer_store_dwordx4 v[108:111], v27, s[24:27], 0 offen offset:768 sc1
buffer_store_dwordx4 v[116:119], v28, s[24:27], 0 offen offset:512 sc1
s_waitcnt vmcnt(19)
s_barrier
s_add_u32 m0, s39, 65536
s_add_u32 s37, s37, s40
buffer_load_dwordx4 v21, s[8:11], s37 offen sc1 lds
s_add_u32 m0, s39, 66560
s_add_u32 s37, s37, s38
buffer_load_dwordx4 v21, s[8:11], s37 offen sc1 lds
s_add_u32 m0, s39, 67584
s_add_u32 s37, s37, s38
buffer_load_dwordx4 v21, s[8:11], s37 offen sc1 lds
s_add_u32 m0, s39, 68608
s_add_u32 s37, s37, s38
buffer_load_dwordx4 v21, s[8:11], s37 offen sc1 lds
s_add_u32 m0, s39, 69632
s_add_u32 s37, s37, s55
buffer_load_dwordx4 v21, s[8:11], s37 offen sc1 lds
s_add_u32 m0, s39, 70656
s_add_u32 s37, s37, s38
buffer_load_dwordx4 v21, s[8:11], s37 offen sc1 lds
s_add_u32 m0, s39, 71680
s_add_u32 s37, s37, s38
buffer_load_dwordx4 v21, s[8:11], s37 offen sc1 lds
s_add_u32 m0, s39, 72704
s_add_u32 s37, s37, s38
buffer_load_dwordx4 v21, s[8:11], s37 offen sc1 lds
s_waitcnt vmcnt(8)
s_barrier
s_add_u32 m0, s39, 98304
s_add_u32 s37, s37, s40
buffer_load_dwordx4 v21, s[8:11], s37 offen sc1 lds
s_add_u32 m0, s39, 99328
s_add_u32 s37, s37, s38
buffer_load_dwordx4 v21, s[8:11], s37 offen sc1 lds
s_add_u32 m0, s39, 100352
s_add_u32 s37, s37, s38
buffer_load_dwordx4 v21, s[8:11], s37 offen sc1 lds
s_add_u32 m0, s39, 101376
s_add_u32 s37, s37, s38
buffer_load_dwordx4 v21, s[8:11], s37 offen sc1 lds
s_add_u32 m0, s39, 102400
s_add_u32 s37, s37, s55
buffer_load_dwordx4 v21, s[8:11], s37 offen sc1 lds
s_add_u32 m0, s39, 103424
s_add_u32 s37, s37, s38
buffer_load_dwordx4 v21, s[8:11], s37 offen sc1 lds
s_add_u32 m0, s39, 104448
s_add_u32 s37, s37, s38
buffer_load_dwordx4 v21, s[8:11], s37 offen sc1 lds
s_add_u32 m0, s39, 105472
s_add_u32 s37, s37, s38
buffer_load_dwordx4 v21, s[8:11], s37 offen sc1 lds
s_waitcnt vmcnt(18)
s_barrier
s_add_u32 m0, s39, 0
s_add_u32 s37, s37, s40
buffer_load_dwordx4 v21, s[8:11], s37 offen sc1 lds
s_add_u32 m0, s39, 1024
s_add_u32 s37, s37, s38
buffer_load_dwordx4 v21, s[8:11], s37 offen sc1 lds
s_add_u32 m0, s39, 2048
s_add_u32 s37, s37, s38
buffer_load_dwordx4 v21, s[8:11], s37 offen sc1 lds
s_add_u32 m0, s39, 3072
s_add_u32 s37, s37, s38
buffer_load_dwordx4 v21, s[8:11], s37 offen sc1 lds
s_add_u32 m0, s39, 4096
s_add_u32 s37, s37, s55
buffer_load_dwordx4 v21, s[8:11], s37 offen sc1 lds
s_add_u32 m0, s39, 5120
s_add_u32 s37, s37, s38
buffer_load_dwordx4 v21, s[8:11], s37 offen sc1 lds
s_add_u32 m0, s39, 6144
s_add_u32 s37, s37, s38
buffer_load_dwordx4 v21, s[8:11], s37 offen sc1 lds
s_add_u32 m0, s39, 7168
s_add_u32 s37, s37, s38
buffer_load_dwordx4 v21, s[8:11], s37 offen sc1 lds
s_waitcnt vmcnt(16)
s_barrier
s_add_u32 m0, s39, 32768
s_add_u32 s37, s37, s40
buffer_load_dwordx4 v21, s[8:11], s37 offen sc1 lds
s_add_u32 m0, s39, 33792
s_add_u32 s37, s37, s38
buffer_load_dwordx4 v21, s[8:11], s37 offen sc1 lds
s_add_u32 m0, s39, 34816
s_add_u32 s37, s37, s38
buffer_load_dwordx4 v21, s[8:11], s37 offen sc1 lds
s_add_u32 m0, s39, 35840
s_add_u32 s37, s37, s38
buffer_load_dwordx4 v21, s[8:11], s37 offen sc1 lds
s_add_u32 m0, s39, 36864
s_add_u32 s37, s37, s55
buffer_load_dwordx4 v21, s[8:11], s37 offen sc1 lds
s_add_u32 m0, s39, 37888
s_add_u32 s37, s37, s38
buffer_load_dwordx4 v21, s[8:11], s37 offen sc1 lds
s_add_u32 m0, s39, 38912
s_add_u32 s37, s37, s38
buffer_load_dwordx4 v21, s[8:11], s37 offen sc1 lds
s_add_u32 m0, s39, 39936
s_add_u32 s37, s37, s38
buffer_load_dwordx4 v21, s[8:11], s37 offen sc1 lds
s_waitcnt vmcnt(16)
s_barrier
s_add_u32 m0, s39, 65536
s_add_u32 s37, s37, s40
buffer_load_dwordx4 v21, s[8:11], s37 offen sc1 lds
s_add_u32 m0, s39, 66560
s_add_u32 s37, s37, s38
buffer_load_dwordx4 v21, s[8:11], s37 offen sc1 lds
s_add_u32 m0, s39, 67584
s_add_u32 s37, s37, s38
buffer_load_dwordx4 v21, s[8:11], s37 offen sc1 lds
s_add_u32 m0, s39, 68608
s_add_u32 s37, s37, s38
buffer_load_dwordx4 v21, s[8:11], s37 offen sc1 lds
s_add_u32 m0, s39, 69632
s_add_u32 s37, s37, s55
buffer_load_dwordx4 v21, s[8:11], s37 offen sc1 lds
s_add_u32 m0, s39, 70656
s_add_u32 s37, s37, s38
buffer_load_dwordx4 v21, s[8:11], s37 offen sc1 lds
s_add_u32 m0, s39, 71680
s_add_u32 s37, s37, s38
buffer_load_dwordx4 v21, s[8:11], s37 offen sc1 lds
s_add_u32 m0, s39, 72704
s_add_u32 s37, s37, s38
buffer_load_dwordx4 v21, s[8:11], s37 offen sc1 lds
s_waitcnt vmcnt(16)
s_barrier
s_add_u32 m0, s39, 98304
s_add_u32 s37, s37, s40
buffer_load_dwordx4 v21, s[8:11], s37 offen sc1 lds
s_add_u32 m0, s39, 99328
s_add_u32 s37, s37, s38
buffer_load_dwordx4 v21, s[8:11], s37 offen sc1 lds
s_add_u32 m0, s39, 100352
s_add_u32 s37, s37, s38
buffer_load_dwordx4 v21, s[8:11], s37 offen sc1 lds
s_add_u32 m0, s39, 101376
s_add_u32 s37, s37, s38
buffer_load_dwordx4 v21, s[8:11], s37 offen sc1 lds
s_add_u32 m0, s39, 102400
s_add_u32 s37, s37, s55
buffer_load_dwordx4 v21, s[8:11], s37 offen sc1 lds
s_add_u32 m0, s39, 103424
s_add_u32 s37, s37, s38
buffer_load_dwordx4 v21, s[8:11], s37 offen sc1 lds
s_add_u32 m0, s39, 104448
s_add_u32 s37, s37, s38
buffer_load_dwordx4 v21, s[8:11], s37 offen sc1 lds
s_add_u32 m0, s39, 105472
s_add_u32 s37, s37, s38
buffer_load_dwordx4 v21, s[8:11], s37 offen sc1 lds
s_waitcnt vmcnt(16)
s_barrier
s_cmp_eq_u32 s51, 2
s_cbranch_scc1 LW4_127
s_mul_i32 s40, s53, 98304
s_add_u32 m0, s39, 0
s_add_u32 s37, s40, 524288
buffer_load_dwordx4 v21, s[8:11], s37 offen sc1 lds
s_add_u32 m0, s39, 1024
s_add_u32 s37, s40, 525312
buffer_load_dwordx4 v21, s[8:11], s37 offen sc1 lds
s_add_u32 m0, s39, 2048
s_add_u32 s37, s40, 526336
buffer_load_dwordx4 v21, s[8:11], s37 offen sc1 lds
s_add_u32 m0, s39, 3072
s_add_u32 s37, s40, 527360
buffer_load_dwordx4 v21, s[8:11], s37 offen sc1 lds
s_add_u32 m0, s39, 4096
s_add_u32 s37, s40, 528384
buffer_load_dwordx4 v21, s[8:11], s37 offen sc1 lds
s_add_u32 m0, s39, 5120
s_add_u32 s37, s40, 529408
buffer_load_dwordx4 v21, s[8:11], s37 offen sc1 lds
s_add_u32 m0, s39, 6144
s_add_u32 s37, s40, 530432
buffer_load_dwordx4 v21, s[8:11], s37 offen sc1 lds
s_add_u32 m0, s39, 7168
s_add_u32 s37, s40, 531456
buffer_load_dwordx4 v21, s[8:11], s37 offen sc1 lds
s_waitcnt vmcnt(16)
s_barrier
s_add_u32 m0, s39, 32768
s_add_u32 s37, s40, 540672
buffer_load_dwordx4 v21, s[8:11], s37 offen sc1 lds
s_add_u32 m0, s39, 33792
s_add_u32 s37, s40, 541696
buffer_load_dwordx4 v21, s[8:11], s37 offen sc1 lds
s_add_u32 m0, s39, 34816
s_add_u32 s37, s40, 542720
buffer_load_dwordx4 v21, s[8:11], s37 offen sc1 lds
s_add_u32 m0, s39, 35840
s_add_u32 s37, s40, 543744
buffer_load_dwordx4 v21, s[8:11], s37 offen sc1 lds
s_add_u32 m0, s39, 36864
s_add_u32 s37, s40, 544768
buffer_load_dwordx4 v21, s[8:11], s37 offen sc1 lds
s_add_u32 m0, s39, 37888
s_add_u32 s37, s40, 545792
buffer_load_dwordx4 v21, s[8:11], s37 offen sc1 lds
s_add_u32 m0, s39, 38912
s_add_u32 s37, s40, 546816
buffer_load_dwordx4 v21, s[8:11], s37 offen sc1 lds
s_add_u32 m0, s39, 39936
s_add_u32 s37, s40, 547840
buffer_load_dwordx4 v21, s[8:11], s37 offen sc1 lds
s_waitcnt vmcnt(16)
s_barrier
s_add_u32 m0, s39, 65536
s_add_u32 s37, s40, 557056
buffer_load_dwordx4 v21, s[8:11], s37 offen sc1 lds
s_add_u32 m0, s39, 66560
s_add_u32 s37, s40, 558080
buffer_load_dwordx4 v21, s[8:11], s37 offen sc1 lds
s_add_u32 m0, s39, 67584
s_add_u32 s37, s40, 559104
buffer_load_dwordx4 v21, s[8:11], s37 offen sc1 lds
s_add_u32 m0, s39, 68608
s_add_u32 s37, s40, 560128
buffer_load_dwordx4 v21, s[8:11], s37 offen sc1 lds
s_add_u32 m0, s39, 69632
s_add_u32 s37, s40, 561152
buffer_load_dwordx4 v21, s[8:11], s37 offen sc1 lds
s_add_u32 m0, s39, 70656
s_add_u32 s37, s40, 562176
buffer_load_dwordx4 v21, s[8:11], s37 offen sc1 lds
s_add_u32 m0, s39, 71680
s_add_u32 s37, s40, 563200
buffer_load_dwordx4 v21, s[8:11], s37 offen sc1 lds
s_add_u32 m0, s39, 72704
s_add_u32 s37, s40, 564224
buffer_load_dwordx4 v21, s[8:11], s37 offen sc1 lds
s_waitcnt vmcnt(16)
s_barrier
s_add_u32 m0, s39, 98304
s_add_u32 s37, s40, 573440
buffer_load_dwordx4 v21, s[8:11], s37 offen sc1 lds
s_add_u32 m0, s39, 99328
s_add_u32 s37, s40, 574464
buffer_load_dwordx4 v21, s[8:11], s37 offen sc1 lds
s_add_u32 m0, s39, 100352
s_add_u32 s37, s40, 575488
buffer_load_dwordx4 v21, s[8:11], s37 offen sc1 lds
s_add_u32 m0, s39, 101376
s_add_u32 s37, s40, 576512
buffer_load_dwordx4 v21, s[8:11], s37 offen sc1 lds
s_add_u32 m0, s39, 102400
s_add_u32 s37, s40, 577536
buffer_load_dwordx4 v21, s[8:11], s37 offen sc1 lds
s_add_u32 m0, s39, 103424
s_add_u32 s37, s40, 578560
buffer_load_dwordx4 v21, s[8:11], s37 offen sc1 lds
s_add_u32 m0, s39, 104448
s_add_u32 s37, s40, 579584
buffer_load_dwordx4 v21, s[8:11], s37 offen sc1 lds
s_add_u32 m0, s39, 105472
s_add_u32 s37, s40, 580608
buffer_load_dwordx4 v21, s[8:11], s37 offen sc1 lds
s_waitcnt vmcnt(16)
s_barrier
s_add_u32 m0, s39, 0
s_add_u32 s37, s40, 589824
buffer_load_dwordx4 v21, s[8:11], s37 offen sc1 lds
s_add_u32 m0, s39, 1024
s_add_u32 s37, s40, 590848
buffer_load_dwordx4 v21, s[8:11], s37 offen sc1 lds
s_add_u32 m0, s39, 2048
s_add_u32 s37, s40, 591872
buffer_load_dwordx4 v21, s[8:11], s37 offen sc1 lds
s_add_u32 m0, s39, 3072
s_add_u32 s37, s40, 592896
buffer_load_dwordx4 v21, s[8:11], s37 offen sc1 lds
s_add_u32 m0, s39, 4096
s_add_u32 s37, s40, 593920
buffer_load_dwordx4 v21, s[8:11], s37 offen sc1 lds
s_add_u32 m0, s39, 5120
s_add_u32 s37, s40, 594944
buffer_load_dwordx4 v21, s[8:11], s37 offen sc1 lds
s_add_u32 m0, s39, 6144
s_add_u32 s37, s40, 595968
buffer_load_dwordx4 v21, s[8:11], s37 offen sc1 lds
s_add_u32 m0, s39, 7168
s_add_u32 s37, s40, 596992
buffer_load_dwordx4 v21, s[8:11], s37 offen sc1 lds
s_waitcnt vmcnt(16)
s_barrier
s_add_u32 m0, s39, 32768
s_add_u32 s37, s40, 606208
buffer_load_dwordx4 v21, s[8:11], s37 offen sc1 lds
s_add_u32 m0, s39, 33792
s_add_u32 s37, s40, 607232
buffer_load_dwordx4 v21, s[8:11], s37 offen sc1 lds
s_add_u32 m0, s39, 34816
s_add_u32 s37, s40, 608256
buffer_load_dwordx4 v21, s[8:11], s37 offen sc1 lds
s_add_u32 m0, s39, 35840
s_add_u32 s37, s40, 609280
buffer_load_dwordx4 v21, s[8:11], s37 offen sc1 lds
s_add_u32 m0, s39, 36864
s_add_u32 s37, s40, 610304
buffer_load_dwordx4 v21, s[8:11], s37 offen sc1 lds
s_add_u32 m0, s39, 37888
s_add_u32 s37, s40, 611328
buffer_load_dwordx4 v21, s[8:11], s37 offen sc1 lds
s_add_u32 m0, s39, 38912
s_add_u32 s37, s40, 612352
buffer_load_dwordx4 v21, s[8:11], s37 offen sc1 lds
s_add_u32 m0, s39, 39936
s_add_u32 s37, s40, 613376
buffer_load_dwordx4 v21, s[8:11], s37 offen sc1 lds
s_waitcnt vmcnt(16)
s_barrier
s_add_u32 m0, s39, 65536
s_mov_b32 s37, 720896
buffer_load_dwordx4 v21, s[8:11], s37 offen sc1 lds
s_add_u32 m0, s39, 66560
s_mov_b32 s37, 721920
buffer_load_dwordx4 v21, s[8:11], s37 offen sc1 lds
s_add_u32 m0, s39, 67584
s_mov_b32 s37, 722944
buffer_load_dwordx4 v21, s[8:11], s37 offen sc1 lds
s_add_u32 m0, s39, 68608
s_mov_b32 s37, 723968
buffer_load_dwordx4 v21, s[8:11], s37 offen sc1 lds
s_add_u32 m0, s39, 69632
s_mov_b32 s37, 724992
buffer_load_dwordx4 v21, s[8:11], s37 offen sc1 lds
s_add_u32 m0, s39, 70656
s_mov_b32 s37, 726016
buffer_load_dwordx4 v21, s[8:11], s37 offen sc1 lds
s_add_u32 m0, s39, 71680
s_mov_b32 s37, 727040
buffer_load_dwordx4 v21, s[8:11], s37 offen sc1 lds
s_add_u32 m0, s39, 72704
s_mov_b32 s37, 728064
buffer_load_dwordx4 v21, s[8:11], s37 offen sc1 lds
s_waitcnt vmcnt(16)
s_barrier
s_add_u32 m0, s39, 98304
s_mov_b32 s37, 737280
buffer_load_dwordx4 v21, s[8:11], s37 offen sc1 lds
s_add_u32 m0, s39, 99328
s_mov_b32 s37, 738304
buffer_load_dwordx4 v21, s[8:11], s37 offen sc1 lds
s_add_u32 m0, s39, 100352
s_mov_b32 s37, 739328
buffer_load_dwordx4 v21, s[8:11], s37 offen sc1 lds
s_add_u32 m0, s39, 101376
s_mov_b32 s37, 740352
buffer_load_dwordx4 v21, s[8:11], s37 offen sc1 lds
s_add_u32 m0, s39, 102400
s_mov_b32 s37, 741376
buffer_load_dwordx4 v21, s[8:11], s37 offen sc1 lds
s_add_u32 m0, s39, 103424
s_mov_b32 s37, 742400
buffer_load_dwordx4 v21, s[8:11], s37 offen sc1 lds
s_add_u32 m0, s39, 104448
s_mov_b32 s37, 743424
buffer_load_dwordx4 v21, s[8:11], s37 offen sc1 lds
s_add_u32 m0, s39, 105472
s_mov_b32 s37, 744448
buffer_load_dwordx4 v21, s[8:11], s37 offen sc1 lds
s_waitcnt vmcnt(16)
s_barrier
s_add_u32 m0, s39, 0
s_mov_b32 s37, 753664
buffer_load_dwordx4 v21, s[8:11], s37 offen sc1 lds
s_add_u32 m0, s39, 1024
s_mov_b32 s37, 754688
buffer_load_dwordx4 v21, s[8:11], s37 offen sc1 lds
s_add_u32 m0, s39, 2048
s_mov_b32 s37, 755712
buffer_load_dwordx4 v21, s[8:11], s37 offen sc1 lds
s_add_u32 m0, s39, 3072
s_mov_b32 s37, 756736
buffer_load_dwordx4 v21, s[8:11], s37 offen sc1 lds
s_add_u32 m0, s39, 4096
s_mov_b32 s37, 757760
buffer_load_dwordx4 v21, s[8:11], s37 offen sc1 lds
s_add_u32 m0, s39, 5120
s_mov_b32 s37, 758784
buffer_load_dwordx4 v21, s[8:11], s37 offen sc1 lds
s_add_u32 m0, s39, 6144
s_mov_b32 s37, 759808
buffer_load_dwordx4 v21, s[8:11], s37 offen sc1 lds
s_add_u32 m0, s39, 7168
s_mov_b32 s37, 760832
buffer_load_dwordx4 v21, s[8:11], s37 offen sc1 lds
s_waitcnt vmcnt(16)
s_barrier
s_add_u32 m0, s39, 32768
s_mov_b32 s37, 770048
buffer_load_dwordx4 v21, s[8:11], s37 offen sc1 lds
s_add_u32 m0, s39, 33792
s_mov_b32 s37, 771072
buffer_load_dwordx4 v21, s[8:11], s37 offen sc1 lds
s_add_u32 m0, s39, 34816
s_mov_b32 s37, 772096
buffer_load_dwordx4 v21, s[8:11], s37 offen sc1 lds
s_add_u32 m0, s39, 35840
s_mov_b32 s37, 773120
buffer_load_dwordx4 v21, s[8:11], s37 offen sc1 lds
s_add_u32 m0, s39, 36864
s_mov_b32 s37, 774144
buffer_load_dwordx4 v21, s[8:11], s37 offen sc1 lds
s_add_u32 m0, s39, 37888
s_mov_b32 s37, 775168
buffer_load_dwordx4 v21, s[8:11], s37 offen sc1 lds
s_add_u32 m0, s39, 38912
s_mov_b32 s37, 776192
buffer_load_dwordx4 v21, s[8:11], s37 offen sc1 lds
s_add_u32 m0, s39, 39936
s_mov_b32 s37, 777216
buffer_load_dwordx4 v21, s[8:11], s37 offen sc1 lds
s_waitcnt vmcnt(16)
s_barrier
s_add_u32 m0, s39, 65536
s_mov_b32 s37, 786432
buffer_load_dwordx4 v21, s[8:11], s37 offen sc1 lds
s_add_u32 m0, s39, 66560
s_mov_b32 s37, 787456
buffer_load_dwordx4 v21, s[8:11], s37 offen sc1 lds
s_add_u32 m0, s39, 67584
s_mov_b32 s37, 788480
buffer_load_dwordx4 v21, s[8:11], s37 offen sc1 lds
s_add_u32 m0, s39, 68608
s_mov_b32 s37, 789504
buffer_load_dwordx4 v21, s[8:11], s37 offen sc1 lds
s_add_u32 m0, s39, 69632
s_mov_b32 s37, 790528
buffer_load_dwordx4 v21, s[8:11], s37 offen sc1 lds
s_add_u32 m0, s39, 70656
s_mov_b32 s37, 791552
buffer_load_dwordx4 v21, s[8:11], s37 offen sc1 lds
s_add_u32 m0, s39, 71680
s_mov_b32 s37, 792576
buffer_load_dwordx4 v21, s[8:11], s37 offen sc1 lds
s_add_u32 m0, s39, 72704
s_mov_b32 s37, 793600
buffer_load_dwordx4 v21, s[8:11], s37 offen sc1 lds
s_waitcnt vmcnt(16)
s_barrier
s_add_u32 m0, s39, 98304
s_mov_b32 s37, 802816
buffer_load_dwordx4 v21, s[8:11], s37 offen sc1 lds
s_add_u32 m0, s39, 99328
s_mov_b32 s37, 803840
buffer_load_dwordx4 v21, s[8:11], s37 offen sc1 lds
s_add_u32 m0, s39, 100352
s_mov_b32 s37, 804864
buffer_load_dwordx4 v21, s[8:11], s37 offen sc1 lds
s_add_u32 m0, s39, 101376
s_mov_b32 s37, 805888
buffer_load_dwordx4 v21, s[8:11], s37 offen sc1 lds
s_add_u32 m0, s39, 102400
s_mov_b32 s37, 806912
buffer_load_dwordx4 v21, s[8:11], s37 offen sc1 lds
s_add_u32 m0, s39, 103424
s_mov_b32 s37, 807936
buffer_load_dwordx4 v21, s[8:11], s37 offen sc1 lds
s_add_u32 m0, s39, 104448
s_mov_b32 s37, 808960
buffer_load_dwordx4 v21, s[8:11], s37 offen sc1 lds
s_add_u32 m0, s39, 105472
s_mov_b32 s37, 809984
buffer_load_dwordx4 v21, s[8:11], s37 offen sc1 lds
s_waitcnt vmcnt(16)
s_barrier
s_add_u32 m0, s39, 0
s_mov_b32 s37, 819200
buffer_load_dwordx4 v21, s[8:11], s37 offen sc1 lds
s_add_u32 m0, s39, 1024
s_mov_b32 s37, 820224
buffer_load_dwordx4 v21, s[8:11], s37 offen sc1 lds
s_add_u32 m0, s39, 2048
s_mov_b32 s37, 821248
buffer_load_dwordx4 v21, s[8:11], s37 offen sc1 lds
s_add_u32 m0, s39, 3072
s_mov_b32 s37, 822272
buffer_load_dwordx4 v21, s[8:11], s37 offen sc1 lds
s_add_u32 m0, s39, 4096
s_mov_b32 s37, 823296
buffer_load_dwordx4 v21, s[8:11], s37 offen sc1 lds
s_add_u32 m0, s39, 5120
s_mov_b32 s37, 824320
buffer_load_dwordx4 v21, s[8:11], s37 offen sc1 lds
s_add_u32 m0, s39, 6144
s_mov_b32 s37, 825344
buffer_load_dwordx4 v21, s[8:11], s37 offen sc1 lds
s_add_u32 m0, s39, 7168
s_mov_b32 s37, 826368
buffer_load_dwordx4 v21, s[8:11], s37 offen sc1 lds
s_waitcnt vmcnt(16)
s_barrier
s_add_u32 m0, s39, 32768
s_mov_b32 s37, 835584
buffer_load_dwordx4 v21, s[8:11], s37 offen sc1 lds
s_add_u32 m0, s39, 33792
s_mov_b32 s37, 836608
buffer_load_dwordx4 v21, s[8:11], s37 offen sc1 lds
s_add_u32 m0, s39, 34816
s_mov_b32 s37, 837632
buffer_load_dwordx4 v21, s[8:11], s37 offen sc1 lds
s_add_u32 m0, s39, 35840
s_mov_b32 s37, 838656
buffer_load_dwordx4 v21, s[8:11], s37 offen sc1 lds
s_add_u32 m0, s39, 36864
s_mov_b32 s37, 839680
buffer_load_dwordx4 v21, s[8:11], s37 offen sc1 lds
s_add_u32 m0, s39, 37888
s_mov_b32 s37, 840704
buffer_load_dwordx4 v21, s[8:11], s37 offen sc1 lds
s_add_u32 m0, s39, 38912
s_mov_b32 s37, 841728
buffer_load_dwordx4 v21, s[8:11], s37 offen sc1 lds
s_add_u32 m0, s39, 39936
s_mov_b32 s37, 842752
buffer_load_dwordx4 v21, s[8:11], s37 offen sc1 lds
s_waitcnt vmcnt(16)
s_barrier
s_add_u32 m0, s39, 65536
s_mov_b32 s37, 851968
buffer_load_dwordx4 v21, s[8:11], s37 offen sc1 lds
s_add_u32 m0, s39, 66560
s_mov_b32 s37, 852992
buffer_load_dwordx4 v21, s[8:11], s37 offen sc1 lds
s_add_u32 m0, s39, 67584
s_mov_b32 s37, 854016
buffer_load_dwordx4 v21, s[8:11], s37 offen sc1 lds
s_add_u32 m0, s39, 68608
s_mov_b32 s37, 855040
buffer_load_dwordx4 v21, s[8:11], s37 offen sc1 lds
s_add_u32 m0, s39, 69632
s_mov_b32 s37, 856064
buffer_load_dwordx4 v21, s[8:11], s37 offen sc1 lds
s_add_u32 m0, s39, 70656
s_mov_b32 s37, 857088
buffer_load_dwordx4 v21, s[8:11], s37 offen sc1 lds
s_add_u32 m0, s39, 71680
s_mov_b32 s37, 858112
buffer_load_dwordx4 v21, s[8:11], s37 offen sc1 lds
s_add_u32 m0, s39, 72704
s_mov_b32 s37, 859136
buffer_load_dwordx4 v21, s[8:11], s37 offen sc1 lds
s_waitcnt vmcnt(16)
s_barrier
s_add_u32 m0, s39, 98304
s_mov_b32 s37, 868352
buffer_load_dwordx4 v21, s[8:11], s37 offen sc1 lds
s_add_u32 m0, s39, 99328
s_mov_b32 s37, 869376
buffer_load_dwordx4 v21, s[8:11], s37 offen sc1 lds
s_add_u32 m0, s39, 100352
s_mov_b32 s37, 870400
buffer_load_dwordx4 v21, s[8:11], s37 offen sc1 lds
s_add_u32 m0, s39, 101376
s_mov_b32 s37, 871424
buffer_load_dwordx4 v21, s[8:11], s37 offen sc1 lds
s_add_u32 m0, s39, 102400
s_mov_b32 s37, 872448
buffer_load_dwordx4 v21, s[8:11], s37 offen sc1 lds
s_add_u32 m0, s39, 103424
s_mov_b32 s37, 873472
buffer_load_dwordx4 v21, s[8:11], s37 offen sc1 lds
s_add_u32 m0, s39, 104448
s_mov_b32 s37, 874496
buffer_load_dwordx4 v21, s[8:11], s37 offen sc1 lds
s_add_u32 m0, s39, 105472
s_mov_b32 s37, 875520
buffer_load_dwordx4 v21, s[8:11], s37 offen sc1 lds
s_waitcnt vmcnt(16)
s_barrier
s_add_u32 m0, s39, 0
s_mov_b32 s37, 884736
buffer_load_dwordx4 v21, s[8:11], s37 offen sc1 lds
s_add_u32 m0, s39, 1024
s_mov_b32 s37, 885760
buffer_load_dwordx4 v21, s[8:11], s37 offen sc1 lds
s_add_u32 m0, s39, 2048
s_mov_b32 s37, 886784
buffer_load_dwordx4 v21, s[8:11], s37 offen sc1 lds
s_add_u32 m0, s39, 3072
s_mov_b32 s37, 887808
buffer_load_dwordx4 v21, s[8:11], s37 offen sc1 lds
s_add_u32 m0, s39, 4096
s_mov_b32 s37, 888832
buffer_load_dwordx4 v21, s[8:11], s37 offen sc1 lds
s_add_u32 m0, s39, 5120
s_mov_b32 s37, 889856
buffer_load_dwordx4 v21, s[8:11], s37 offen sc1 lds
s_add_u32 m0, s39, 6144
s_mov_b32 s37, 890880
buffer_load_dwordx4 v21, s[8:11], s37 offen sc1 lds
s_add_u32 m0, s39, 7168
s_mov_b32 s37, 891904
buffer_load_dwordx4 v21, s[8:11], s37 offen sc1 lds
s_waitcnt vmcnt(16)
s_barrier
s_add_u32 m0, s39, 32768
s_mov_b32 s37, 901120
buffer_load_dwordx4 v21, s[8:11], s37 offen sc1 lds
s_add_u32 m0, s39, 33792
s_mov_b32 s37, 902144
buffer_load_dwordx4 v21, s[8:11], s37 offen sc1 lds
s_add_u32 m0, s39, 34816
s_mov_b32 s37, 903168
buffer_load_dwordx4 v21, s[8:11], s37 offen sc1 lds
s_add_u32 m0, s39, 35840
s_mov_b32 s37, 904192
buffer_load_dwordx4 v21, s[8:11], s37 offen sc1 lds
s_add_u32 m0, s39, 36864
s_mov_b32 s37, 905216
buffer_load_dwordx4 v21, s[8:11], s37 offen sc1 lds
s_add_u32 m0, s39, 37888
s_mov_b32 s37, 906240
buffer_load_dwordx4 v21, s[8:11], s37 offen sc1 lds
s_add_u32 m0, s39, 38912
s_mov_b32 s37, 907264
buffer_load_dwordx4 v21, s[8:11], s37 offen sc1 lds
s_add_u32 m0, s39, 39936
s_mov_b32 s37, 908288
buffer_load_dwordx4 v21, s[8:11], s37 offen sc1 lds
s_waitcnt vmcnt(16)
s_barrier
s_waitcnt vmcnt(8)
s_barrier
s_waitcnt vmcnt(0)
s_barrier
s_branch Ldone_1
.p2align 6
Lw_131:
s_branch Lr_132
s_nop 0
.p2align 3
LW4_127:
s_mul_i32 s40, s53, 786432
s_add_u32 m0, s39, 0
s_add_u32 s37, s40, 4194304
buffer_load_dwordx4 v21, s[8:11], s37 offen sc1 lds
s_add_u32 m0, s39, 1024
s_add_u32 s37, s40, 4210688
buffer_load_dwordx4 v21, s[8:11], s37 offen sc1 lds
s_add_u32 m0, s39, 2048
s_add_u32 s37, s40, 4227072
buffer_load_dwordx4 v21, s[8:11], s37 offen sc1 lds
s_add_u32 m0, s39, 3072
s_add_u32 s37, s40, 4243456
buffer_load_dwordx4 v21, s[8:11], s37 offen sc1 lds
s_add_u32 m0, s39, 4096
s_add_u32 s37, s40, 4292608
buffer_load_dwordx4 v21, s[8:11], s37 offen sc1 lds
s_add_u32 m0, s39, 5120
s_add_u32 s37, s40, 4308992
buffer_load_dwordx4 v21, s[8:11], s37 offen sc1 lds
s_add_u32 m0, s39, 6144
s_add_u32 s37, s40, 4325376
buffer_load_dwordx4 v21, s[8:11], s37 offen sc1 lds
s_add_u32 m0, s39, 7168
s_add_u32 s37, s40, 4341760
buffer_load_dwordx4 v21, s[8:11], s37 offen sc1 lds
s_waitcnt vmcnt(16)
s_barrier
s_add_u32 m0, s39, 32768
s_add_u32 s37, s40, 4259840
buffer_load_dwordx4 v21, s[8:11], s37 offen sc1 lds
s_add_u32 m0, s39, 33792
s_add_u32 s37, s40, 4358144
buffer_load_dwordx4 v21, s[8:11], s37 offen sc1 lds
s_add_u32 m0, s39, 34816
s_add_u32 s37, s40, 4276224
buffer_load_dwordx4 v21, s[8:11], s37 offen sc1 lds
s_add_u32 m0, s39, 35840
s_add_u32 s37, s40, 4374528
buffer_load_dwordx4 v21, s[8:11], s37 offen sc1 lds
s_add_u32 m0, s39, 36864
s_add_u32 s37, s40, 4390912
buffer_load_dwordx4 v21, s[8:11], s37 offen sc1 lds
s_add_u32 m0, s39, 37888
s_add_u32 s37, s40, 4407296
buffer_load_dwordx4 v21, s[8:11], s37 offen sc1 lds
s_add_u32 m0, s39, 38912
s_add_u32 s37, s40, 4423680
buffer_load_dwordx4 v21, s[8:11], s37 offen sc1 lds
s_add_u32 m0, s39, 39936
s_add_u32 s37, s40, 4440064
buffer_load_dwordx4 v21, s[8:11], s37 offen sc1 lds
s_waitcnt vmcnt(16)
s_barrier
s_add_u32 m0, s39, 65536
s_add_u32 s37, s40, 4489216
buffer_load_dwordx4 v21, s[8:11], s37 offen sc1 lds
s_add_u32 m0, s39, 66560
s_add_u32 s37, s40, 4505600
buffer_load_dwordx4 v21, s[8:11], s37 offen sc1 lds
s_add_u32 m0, s39, 67584
s_add_u32 s37, s40, 4521984
buffer_load_dwordx4 v21, s[8:11], s37 offen sc1 lds
s_add_u32 m0, s39, 68608
s_add_u32 s37, s40, 4538368
buffer_load_dwordx4 v21, s[8:11], s37 offen sc1 lds
s_add_u32 m0, s39, 69632
s_add_u32 s37, s40, 4456448
buffer_load_dwordx4 v21, s[8:11], s37 offen sc1 lds
s_add_u32 m0, s39, 70656
s_add_u32 s37, s40, 4554752
buffer_load_dwordx4 v21, s[8:11], s37 offen sc1 lds
s_add_u32 m0, s39, 71680
s_add_u32 s37, s40, 4472832
buffer_load_dwordx4 v21, s[8:11], s37 offen sc1 lds
s_add_u32 m0, s39, 72704
s_add_u32 s37, s40, 4571136
buffer_load_dwordx4 v21, s[8:11], s37 offen sc1 lds
s_waitcnt vmcnt(16)
s_barrier
s_add_u32 m0, s39, 98304
s_add_u32 s37, s40, 4587520
buffer_load_dwordx4 v21, s[8:11], s37 offen sc1 lds
s_add_u32 m0, s39, 99328
s_add_u32 s37, s40, 4603904
buffer_load_dwordx4 v21, s[8:11], s37 offen sc1 lds
s_add_u32 m0, s39, 100352
s_add_u32 s37, s40, 4620288
buffer_load_dwordx4 v21, s[8:11], s37 offen sc1 lds
s_add_u32 m0, s39, 101376
s_add_u32 s37, s40, 4636672
buffer_load_dwordx4 v21, s[8:11], s37 offen sc1 lds
s_add_u32 m0, s39, 102400
s_add_u32 s37, s40, 4685824
buffer_load_dwordx4 v21, s[8:11], s37 offen sc1 lds
s_add_u32 m0, s39, 103424
s_add_u32 s37, s40, 4702208
buffer_load_dwordx4 v21, s[8:11], s37 offen sc1 lds
s_add_u32 m0, s39, 104448
s_add_u32 s37, s40, 4718592
buffer_load_dwordx4 v21, s[8:11], s37 offen sc1 lds
s_add_u32 m0, s39, 105472
s_add_u32 s37, s40, 4734976
buffer_load_dwordx4 v21, s[8:11], s37 offen sc1 lds
s_waitcnt vmcnt(16)
s_barrier
s_add_u32 m0, s39, 0
s_add_u32 s37, s40, 4653056
buffer_load_dwordx4 v21, s[8:11], s37 offen sc1 lds
s_add_u32 m0, s39, 1024
s_add_u32 s37, s40, 4751360
buffer_load_dwordx4 v21, s[8:11], s37 offen sc1 lds
s_add_u32 m0, s39, 2048
s_add_u32 s37, s40, 4669440
buffer_load_dwordx4 v21, s[8:11], s37 offen sc1 lds
s_add_u32 m0, s39, 3072
s_add_u32 s37, s40, 4767744
buffer_load_dwordx4 v21, s[8:11], s37 offen sc1 lds
s_add_u32 m0, s39, 4096
s_add_u32 s37, s40, 4784128
buffer_load_dwordx4 v21, s[8:11], s37 offen sc1 lds
s_add_u32 m0, s39, 5120
s_add_u32 s37, s40, 4800512
buffer_load_dwordx4 v21, s[8:11], s37 offen sc1 lds
s_add_u32 m0, s39, 6144
s_add_u32 s37, s40, 4816896
buffer_load_dwordx4 v21, s[8:11], s37 offen sc1 lds
s_add_u32 m0, s39, 7168
s_add_u32 s37, s40, 4833280
buffer_load_dwordx4 v21, s[8:11], s37 offen sc1 lds
s_waitcnt vmcnt(16)
s_barrier
s_add_u32 m0, s39, 32768
s_add_u32 s37, s40, 4882432
buffer_load_dwordx4 v21, s[8:11], s37 offen sc1 lds
s_add_u32 m0, s39, 33792
s_add_u32 s37, s40, 4898816
buffer_load_dwordx4 v21, s[8:11], s37 offen sc1 lds
s_add_u32 m0, s39, 34816
s_add_u32 s37, s40, 4915200
buffer_load_dwordx4 v21, s[8:11], s37 offen sc1 lds
s_add_u32 m0, s39, 35840
s_add_u32 s37, s40, 4931584
buffer_load_dwordx4 v21, s[8:11], s37 offen sc1 lds
s_add_u32 m0, s39, 36864
s_add_u32 s37, s40, 4849664
buffer_load_dwordx4 v21, s[8:11], s37 offen sc1 lds
s_add_u32 m0, s39, 37888
s_add_u32 s37, s40, 4947968
buffer_load_dwordx4 v21, s[8:11], s37 offen sc1 lds
s_add_u32 m0, s39, 38912
s_add_u32 s37, s40, 4866048
buffer_load_dwordx4 v21, s[8:11], s37 offen sc1 lds
s_add_u32 m0, s39, 39936
s_add_u32 s37, s40, 4964352
buffer_load_dwordx4 v21, s[8:11], s37 offen sc1 lds
s_waitcnt vmcnt(16)
s_barrier
s_add_u32 m0, s39, 65536
s_mov_b32 s37, 5767168
buffer_load_dwordx4 v21, s[8:11], s37 offen sc1 lds
s_add_u32 m0, s39, 66560
s_mov_b32 s37, 5783552
buffer_load_dwordx4 v21, s[8:11], s37 offen sc1 lds
s_add_u32 m0, s39, 67584
s_mov_b32 s37, 5799936
buffer_load_dwordx4 v21, s[8:11], s37 offen sc1 lds
s_add_u32 m0, s39, 68608
s_mov_b32 s37, 5816320
buffer_load_dwordx4 v21, s[8:11], s37 offen sc1 lds
s_add_u32 m0, s39, 69632
s_mov_b32 s37, 5865472
buffer_load_dwordx4 v21, s[8:11], s37 offen sc1 lds
s_add_u32 m0, s39, 70656
s_mov_b32 s37, 5881856
buffer_load_dwordx4 v21, s[8:11], s37 offen sc1 lds
s_add_u32 m0, s39, 71680
s_mov_b32 s37, 5898240
buffer_load_dwordx4 v21, s[8:11], s37 offen sc1 lds
s_add_u32 m0, s39, 72704
s_mov_b32 s37, 5914624
buffer_load_dwordx4 v21, s[8:11], s37 offen sc1 lds
s_waitcnt vmcnt(16)
s_barrier
s_add_u32 m0, s39, 98304
s_mov_b32 s37, 5832704
buffer_load_dwordx4 v21, s[8:11], s37 offen sc1 lds
s_add_u32 m0, s39, 99328
s_mov_b32 s37, 5931008
buffer_load_dwordx4 v21, s[8:11], s37 offen sc1 lds
s_add_u32 m0, s39, 100352
s_mov_b32 s37, 5849088
buffer_load_dwordx4 v21, s[8:11], s37 offen sc1 lds
s_add_u32 m0, s39, 101376
s_mov_b32 s37, 5947392
buffer_load_dwordx4 v21, s[8:11], s37 offen sc1 lds
s_add_u32 m0, s39, 102400
s_mov_b32 s37, 5963776
buffer_load_dwordx4 v21, s[8:11], s37 offen sc1 lds
s_add_u32 m0, s39, 103424
s_mov_b32 s37, 5980160
buffer_load_dwordx4 v21, s[8:11], s37 offen sc1 lds
s_add_u32 m0, s39, 104448
s_mov_b32 s37, 5996544
buffer_load_dwordx4 v21, s[8:11], s37 offen sc1 lds
s_add_u32 m0, s39, 105472
s_mov_b32 s37, 6012928
buffer_load_dwordx4 v21, s[8:11], s37 offen sc1 lds
s_waitcnt vmcnt(16)
s_barrier
s_add_u32 m0, s39, 0
s_mov_b32 s37, 6062080
buffer_load_dwordx4 v21, s[8:11], s37 offen sc1 lds
s_add_u32 m0, s39, 1024
s_mov_b32 s37, 6078464
buffer_load_dwordx4 v21, s[8:11], s37 offen sc1 lds
s_add_u32 m0, s39, 2048
s_mov_b32 s37, 6094848
buffer_load_dwordx4 v21, s[8:11], s37 offen sc1 lds
s_add_u32 m0, s39, 3072
s_mov_b32 s37, 6111232
buffer_load_dwordx4 v21, s[8:11], s37 offen sc1 lds
s_add_u32 m0, s39, 4096
s_mov_b32 s37, 6029312
buffer_load_dwordx4 v21, s[8:11], s37 offen sc1 lds
s_add_u32 m0, s39, 5120
s_mov_b32 s37, 6127616
buffer_load_dwordx4 v21, s[8:11], s37 offen sc1 lds
s_add_u32 m0, s39, 6144
s_mov_b32 s37, 6045696
buffer_load_dwordx4 v21, s[8:11], s37 offen sc1 lds
s_add_u32 m0, s39, 7168
s_mov_b32 s37, 6144000
buffer_load_dwordx4 v21, s[8:11], s37 offen sc1 lds
s_waitcnt vmcnt(16)
s_barrier
s_add_u32 m0, s39, 32768
s_mov_b32 s37, 6160384
buffer_load_dwordx4 v21, s[8:11], s37 offen sc1 lds
s_add_u32 m0, s39, 33792
s_mov_b32 s37, 6176768
buffer_load_dwordx4 v21, s[8:11], s37 offen sc1 lds
s_add_u32 m0, s39, 34816
s_mov_b32 s37, 6193152
buffer_load_dwordx4 v21, s[8:11], s37 offen sc1 lds
s_add_u32 m0, s39, 35840
s_mov_b32 s37, 6209536
buffer_load_dwordx4 v21, s[8:11], s37 offen sc1 lds
s_add_u32 m0, s39, 36864
s_mov_b32 s37, 6258688
buffer_load_dwordx4 v21, s[8:11], s37 offen sc1 lds
s_add_u32 m0, s39, 37888
s_mov_b32 s37, 6275072
buffer_load_dwordx4 v21, s[8:11], s37 offen sc1 lds
s_add_u32 m0, s39, 38912
s_mov_b32 s37, 6291456
buffer_load_dwordx4 v21, s[8:11], s37 offen sc1 lds
s_add_u32 m0, s39, 39936
s_mov_b32 s37, 6307840
buffer_load_dwordx4 v21, s[8:11], s37 offen sc1 lds
s_waitcnt vmcnt(16)
s_barrier
s_add_u32 m0, s39, 65536
s_mov_b32 s37, 6225920
buffer_load_dwordx4 v21, s[8:11], s37 offen sc1 lds
s_add_u32 m0, s39, 66560
s_mov_b32 s37, 6324224
buffer_load_dwordx4 v21, s[8:11], s37 offen sc1 lds
s_add_u32 m0, s39, 67584
s_mov_b32 s37, 6242304
buffer_load_dwordx4 v21, s[8:11], s37 offen sc1 lds
s_add_u32 m0, s39, 68608
s_mov_b32 s37, 6340608
buffer_load_dwordx4 v21, s[8:11], s37 offen sc1 lds
s_add_u32 m0, s39, 69632
s_mov_b32 s37, 6356992
buffer_load_dwordx4 v21, s[8:11], s37 offen sc1 lds
s_add_u32 m0, s39, 70656
s_mov_b32 s37, 6373376
buffer_load_dwordx4 v21, s[8:11], s37 offen sc1 lds
s_add_u32 m0, s39, 71680
s_mov_b32 s37, 6389760
buffer_load_dwordx4 v21, s[8:11], s37 offen sc1 lds
s_add_u32 m0, s39, 72704
s_mov_b32 s37, 6406144
buffer_load_dwordx4 v21, s[8:11], s37 offen sc1 lds
s_waitcnt vmcnt(16)
s_barrier
s_add_u32 m0, s39, 98304
s_mov_b32 s37, 6455296
buffer_load_dwordx4 v21, s[8:11], s37 offen sc1 lds
s_add_u32 m0, s39, 99328
s_mov_b32 s37, 6471680
buffer_load_dwordx4 v21, s[8:11], s37 offen sc1 lds
s_add_u32 m0, s39, 100352
s_mov_b32 s37, 6488064
buffer_load_dwordx4 v21, s[8:11], s37 offen sc1 lds
s_add_u32 m0, s39, 101376
s_mov_b32 s37, 6504448
buffer_load_dwordx4 v21, s[8:11], s37 offen sc1 lds
s_add_u32 m0, s39, 102400
s_mov_b32 s37, 6422528
buffer_load_dwordx4 v21, s[8:11], s37 offen sc1 lds
s_add_u32 m0, s39, 103424
s_mov_b32 s37, 6520832
buffer_load_dwordx4 v21, s[8:11], s37 offen sc1 lds
s_add_u32 m0, s39, 104448
s_mov_b32 s37, 6438912
buffer_load_dwordx4 v21, s[8:11], s37 offen sc1 lds
s_add_u32 m0, s39, 105472
s_mov_b32 s37, 6537216
buffer_load_dwordx4 v21, s[8:11], s37 offen sc1 lds
s_waitcnt vmcnt(16)
s_barrier
s_add_u32 m0, s39, 0
s_mov_b32 s37, 6553600
buffer_load_dwordx4 v21, s[8:11], s37 offen sc1 lds
s_add_u32 m0, s39, 1024
s_mov_b32 s37, 6569984
buffer_load_dwordx4 v21, s[8:11], s37 offen sc1 lds
s_add_u32 m0, s39, 2048
s_mov_b32 s37, 6586368
buffer_load_dwordx4 v21, s[8:11], s37 offen sc1 lds
s_add_u32 m0, s39, 3072
s_mov_b32 s37, 6602752
buffer_load_dwordx4 v21, s[8:11], s37 offen sc1 lds
s_add_u32 m0, s39, 4096
s_mov_b32 s37, 6651904
buffer_load_dwordx4 v21, s[8:11], s37 offen sc1 lds
s_add_u32 m0, s39, 5120
s_mov_b32 s37, 6668288
buffer_load_dwordx4 v21, s[8:11], s37 offen sc1 lds
s_add_u32 m0, s39, 6144
s_mov_b32 s37, 6684672
buffer_load_dwordx4 v21, s[8:11], s37 offen sc1 lds
s_add_u32 m0, s39, 7168
s_mov_b32 s37, 6701056
buffer_load_dwordx4 v21, s[8:11], s37 offen sc1 lds
s_waitcnt vmcnt(16)
s_barrier
s_add_u32 m0, s39, 32768
s_mov_b32 s37, 6619136
buffer_load_dwordx4 v21, s[8:11], s37 offen sc1 lds
s_add_u32 m0, s39, 33792
s_mov_b32 s37, 6717440
buffer_load_dwordx4 v21, s[8:11], s37 offen sc1 lds
s_add_u32 m0, s39, 34816
s_mov_b32 s37, 6635520
buffer_load_dwordx4 v21, s[8:11], s37 offen sc1 lds
s_add_u32 m0, s39, 35840
s_mov_b32 s37, 6733824
buffer_load_dwordx4 v21, s[8:11], s37 offen sc1 lds
s_add_u32 m0, s39, 36864
s_mov_b32 s37, 6750208
buffer_load_dwordx4 v21, s[8:11], s37 offen sc1 lds
s_add_u32 m0, s39, 37888
s_mov_b32 s37, 6766592
buffer_load_dwordx4 v21, s[8:11], s37 offen sc1 lds
s_add_u32 m0, s39, 38912
s_mov_b32 s37, 6782976
buffer_load_dwordx4 v21, s[8:11], s37 offen sc1 lds
s_add_u32 m0, s39, 39936
s_mov_b32 s37, 6799360
buffer_load_dwordx4 v21, s[8:11], s37 offen sc1 lds
s_waitcnt vmcnt(16)
s_barrier
s_add_u32 m0, s39, 65536
s_mov_b32 s37, 6848512
buffer_load_dwordx4 v21, s[8:11], s37 offen sc1 lds
s_add_u32 m0, s39, 66560
s_mov_b32 s37, 6864896
buffer_load_dwordx4 v21, s[8:11], s37 offen sc1 lds
s_add_u32 m0, s39, 67584
s_mov_b32 s37, 6881280
buffer_load_dwordx4 v21, s[8:11], s37 offen sc1 lds
s_add_u32 m0, s39, 68608
s_mov_b32 s37, 6897664
buffer_load_dwordx4 v21, s[8:11], s37 offen sc1 lds
s_add_u32 m0, s39, 69632
s_mov_b32 s37, 6815744
buffer_load_dwordx4 v21, s[8:11], s37 offen sc1 lds
s_add_u32 m0, s39, 70656
s_mov_b32 s37, 6914048
buffer_load_dwordx4 v21, s[8:11], s37 offen sc1 lds
s_add_u32 m0, s39, 71680
s_mov_b32 s37, 6832128
buffer_load_dwordx4 v21, s[8:11], s37 offen sc1 lds
s_add_u32 m0, s39, 72704
s_mov_b32 s37, 6930432
buffer_load_dwordx4 v21, s[8:11], s37 offen sc1 lds
s_waitcnt vmcnt(16)
s_barrier
s_add_u32 m0, s39, 98304
s_mov_b32 s37, 6946816
buffer_load_dwordx4 v21, s[8:11], s37 offen sc1 lds
s_add_u32 m0, s39, 99328
s_mov_b32 s37, 6963200
buffer_load_dwordx4 v21, s[8:11], s37 offen sc1 lds
s_add_u32 m0, s39, 100352
s_mov_b32 s37, 6979584
buffer_load_dwordx4 v21, s[8:11], s37 offen sc1 lds
s_add_u32 m0, s39, 101376
s_mov_b32 s37, 6995968
buffer_load_dwordx4 v21, s[8:11], s37 offen sc1 lds
s_add_u32 m0, s39, 102400
s_mov_b32 s37, 7045120
buffer_load_dwordx4 v21, s[8:11], s37 offen sc1 lds
s_add_u32 m0, s39, 103424
s_mov_b32 s37, 7061504
buffer_load_dwordx4 v21, s[8:11], s37 offen sc1 lds
s_add_u32 m0, s39, 104448
s_mov_b32 s37, 7077888
buffer_load_dwordx4 v21, s[8:11], s37 offen sc1 lds
s_add_u32 m0, s39, 105472
s_mov_b32 s37, 7094272
buffer_load_dwordx4 v21, s[8:11], s37 offen sc1 lds
s_waitcnt vmcnt(16)
s_barrier
s_add_u32 m0, s39, 0
s_mov_b32 s37, 7012352
buffer_load_dwordx4 v21, s[8:11], s37 offen sc1 lds
s_add_u32 m0, s39, 1024
s_mov_b32 s37, 7110656
buffer_load_dwordx4 v21, s[8:11], s37 offen sc1 lds
s_add_u32 m0, s39, 2048
s_mov_b32 s37, 7028736
buffer_load_dwordx4 v21, s[8:11], s37 offen sc1 lds
s_add_u32 m0, s39, 3072
s_mov_b32 s37, 7127040
buffer_load_dwordx4 v21, s[8:11], s37 offen sc1 lds
s_add_u32 m0, s39, 4096
s_mov_b32 s37, 7143424
buffer_load_dwordx4 v21, s[8:11], s37 offen sc1 lds
s_add_u32 m0, s39, 5120
s_mov_b32 s37, 7159808
buffer_load_dwordx4 v21, s[8:11], s37 offen sc1 lds
s_add_u32 m0, s39, 6144
s_mov_b32 s37, 7176192
buffer_load_dwordx4 v21, s[8:11], s37 offen sc1 lds
s_add_u32 m0, s39, 7168
s_mov_b32 s37, 7192576
buffer_load_dwordx4 v21, s[8:11], s37 offen sc1 lds
s_waitcnt vmcnt(16)
s_barrier
s_add_u32 m0, s39, 32768
s_mov_b32 s37, 7241728
buffer_load_dwordx4 v21, s[8:11], s37 offen sc1 lds
s_add_u32 m0, s39, 33792
s_mov_b32 s37, 7258112
buffer_load_dwordx4 v21, s[8:11], s37 offen sc1 lds
s_add_u32 m0, s39, 34816
s_mov_b32 s37, 7274496
buffer_load_dwordx4 v21, s[8:11], s37 offen sc1 lds
s_add_u32 m0, s39, 35840
s_mov_b32 s37, 7290880
buffer_load_dwordx4 v21, s[8:11], s37 offen sc1 lds
s_add_u32 m0, s39, 36864
s_mov_b32 s37, 7208960
buffer_load_dwordx4 v21, s[8:11], s37 offen sc1 lds
s_add_u32 m0, s39, 37888
s_mov_b32 s37, 7307264
buffer_load_dwordx4 v21, s[8:11], s37 offen sc1 lds
s_add_u32 m0, s39, 38912
s_mov_b32 s37, 7225344
buffer_load_dwordx4 v21, s[8:11], s37 offen sc1 lds
s_add_u32 m0, s39, 39936
s_mov_b32 s37, 7323648
buffer_load_dwordx4 v21, s[8:11], s37 offen sc1 lds
s_waitcnt vmcnt(16)
s_barrier
s_waitcnt vmcnt(8)
s_barrier
s_waitcnt vmcnt(0)
s_barrier
s_branch Ldone_1
.p2align 6
Lw_98:
s_branch Lr_99
s_nop 0
.p2align 3
L7b_126:
v_mfma_f32_16x16x32_bf16 v[128:131], v[96:99], v[80:83], v[128:131]
v_mfma_f32_16x16x32_bf16 v[132:135], v[96:99], v[84:87], v[132:135]
v_mfma_f32_16x16x32_bf16 v[136:139], v[96:99], v[88:91], v[136:139]
v_mfma_f32_16x16x32_bf16 v[140:143], v[96:99], v[92:95], v[140:143]
v_mfma_f32_16x16x32_bf16 v[188:191], v[108:111], v[92:95], v[188:191]
v_mfma_f32_16x16x32_bf16 v[184:187], v[108:111], v[88:91], v[184:187]
v_mfma_f32_16x16x32_bf16 v[180:183], v[108:111], v[84:87], v[180:183]
v_mfma_f32_16x16x32_bf16 v[176:179], v[108:111], v[80:83], v[176:179]
v_mfma_f32_16x16x32_bf16 v[144:147], v[100:103], v[80:83], v[144:147]
v_mfma_f32_16x16x32_bf16 v[148:151], v[100:103], v[84:87], v[148:151]
v_mfma_f32_16x16x32_bf16 v[152:155], v[100:103], v[88:91], v[152:155]
v_mfma_f32_16x16x32_bf16 v[156:159], v[100:103], v[92:95], v[156:159]
v_mfma_f32_16x16x32_bf16 v[204:207], v[112:115], v[92:95], v[204:207]
v_mfma_f32_16x16x32_bf16 v[200:203], v[112:115], v[88:91], v[200:203]
v_mfma_f32_16x16x32_bf16 v[196:199], v[112:115], v[84:87], v[196:199]
v_mfma_f32_16x16x32_bf16 v[192:195], v[112:115], v[80:83], v[192:195]
v_mfma_f32_16x16x32_bf16 v[160:163], v[104:107], v[80:83], v[160:163]
v_mfma_f32_16x16x32_bf16 v[164:167], v[104:107], v[84:87], v[164:167]
v_mfma_f32_16x16x32_bf16 v[168:171], v[104:107], v[88:91], v[168:171]
v_mfma_f32_16x16x32_bf16 v[172:175], v[104:107], v[92:95], v[172:175]
v_mfma_f32_16x16x32_bf16 v[220:223], v[116:119], v[92:95], v[220:223]
v_mfma_f32_16x16x32_bf16 v[216:219], v[116:119], v[88:91], v[216:219]
v_mfma_f32_16x16x32_bf16 v[212:215], v[116:119], v[84:87], v[212:215]
v_mfma_f32_16x16x32_bf16 v[208:211], v[116:119], v[80:83], v[208:211]
s_mul_i32 s43, s38, 32
s_add_u32 s37, s37, s43
s_setprio 0
s_barrier
s_mov_b32 s80, s60
s_mov_b32 s81, s61
s_mov_b32 s82, 7340032
s_mov_b32 s83, 0x20000
v_and_b32 v29, 31, v1
v_lshlrev_b32 v29, 11, v29
s_and_b32 s43, s35, 8
s_or_b32 s43, s43, 3
s_lshl_b32 s43, s43, 7
v_add_u32 v29, s43, v29
s_add_u32 s37, s37, s54
s_add_u32 m0, s39, 65536
s_add_u32 s37, s37, s40
buffer_load_dwordx4 v21, s[8:11], s37 offen sc1 lds
v_mul_f32 v80, v128, v128
v_mul_f32 v81, v129, v129
v_mul_f32 v82, v130, v130
v_mul_f32 v83, v131, v131
v_fma_f32 v80, v80, v232, v228
v_fma_f32 v81, v81, v232, v228
v_fma_f32 v82, v82, v232, v228
s_add_u32 m0, s39, 66560
s_add_u32 s37, s37, s38
buffer_load_dwordx4 v21, s[8:11], s37 offen sc1 lds
v_fma_f32 v83, v83, v232, v228
v_mul_f32 v80, v80, v128
v_mul_f32 v81, v81, v129
v_mul_f32 v82, v82, v130
v_mul_f32 v83, v83, v131
v_exp_f32 v80, v80
s_add_u32 m0, s39, 67584
s_add_u32 s37, s37, s38
buffer_load_dwordx4 v21, s[8:11], s37 offen sc1 lds
v_exp_f32 v81, v81
v_exp_f32 v82, v82
v_exp_f32 v83, v83
v_mul_f32 v176, v128, v176
v_mul_f32 v177, v129, v177
v_mul_f32 v178, v130, v178
v_mul_f32 v179, v131, v179
s_add_u32 m0, s39, 68608
s_add_u32 s37, s37, s38
buffer_load_dwordx4 v21, s[8:11], s37 offen sc1 lds
v_fma_f32 v80, v80, v236, v236
v_fma_f32 v81, v81, v236, v236
v_fma_f32 v82, v82, v236, v236
v_fma_f32 v83, v83, v236, v236
v_rcp_f32 v80, v80
v_rcp_f32 v81, v81
s_add_u32 m0, s39, 69632
s_add_u32 s37, s37, s55
buffer_load_dwordx4 v21, s[8:11], s37 offen sc1 lds
v_rcp_f32 v82, v82
v_rcp_f32 v83, v83
v_mul_f32 v176, v176, v80
v_mul_f32 v177, v177, v81
v_mul_f32 v178, v178, v82
v_mul_f32 v179, v179, v83
v_cvt_pk_bf16_f32 v96, v176, v177
s_add_u32 m0, s39, 70656
s_add_u32 s37, s37, s38
buffer_load_dwordx4 v21, s[8:11], s37 offen sc1 lds
v_cvt_pk_bf16_f32 v97, v178, v179
v_mul_f32 v84, v144, v144
v_mul_f32 v85, v145, v145
v_mul_f32 v86, v146, v146
v_mul_f32 v87, v147, v147
v_fma_f32 v84, v84, v232, v228
s_add_u32 m0, s39, 71680
s_add_u32 s37, s37, s38
buffer_load_dwordx4 v21, s[8:11], s37 offen sc1 lds
v_fma_f32 v85, v85, v232, v228
v_fma_f32 v86, v86, v232, v228
v_fma_f32 v87, v87, v232, v228
v_mul_f32 v84, v84, v144
v_mul_f32 v85, v85, v145
v_mul_f32 v86, v86, v146
v_mul_f32 v87, v87, v147
s_add_u32 m0, s39, 72704
s_add_u32 s37, s37, s38
buffer_load_dwordx4 v21, s[8:11], s37 offen sc1 lds
v_exp_f32 v84, v84
v_exp_f32 v85, v85
v_exp_f32 v86, v86
v_exp_f32 v87, v87
v_mul_f32 v192, v144, v192
v_mul_f32 v193, v145, v193
s_barrier
s_lshr_b32 s44, s2, 3
s_lshl_b32 s44, s44, 17
s_add_u32 s43, s44, 65536
buffer_load_dword v30, v29, s[80:83], s43 offen
s_add_u32 m0, s39, 98304
s_add_u32 s37, s37, s40
buffer_load_dwordx4 v21, s[8:11], s37 offen sc1 lds
v_mul_f32 v194, v146, v194
v_mul_f32 v195, v147, v195
v_fma_f32 v84, v84, v236, v236
v_fma_f32 v85, v85, v236, v236
v_fma_f32 v86, v86, v236, v236
v_fma_f32 v87, v87, v236, v236
v_rcp_f32 v84, v84
s_add_u32 m0, s39, 99328
s_add_u32 s37, s37, s38
buffer_load_dwordx4 v21, s[8:11], s37 offen sc1 lds
v_rcp_f32 v85, v85
v_rcp_f32 v86, v86
v_rcp_f32 v87, v87
v_mul_f32 v192, v192, v84
v_mul_f32 v193, v193, v85
v_mul_f32 v194, v194, v86
v_mul_f32 v195, v195, v87
s_add_u32 m0, s39, 100352
s_add_u32 s37, s37, s38
buffer_load_dwordx4 v21, s[8:11], s37 offen sc1 lds
v_cvt_pk_bf16_f32 v98, v192, v193
v_cvt_pk_bf16_f32 v99, v194, v195
v_mul_f32 v80, v160, v160
v_mul_f32 v81, v161, v161
v_mul_f32 v82, v162, v162
s_add_u32 m0, s39, 101376
s_add_u32 s37, s37, s38
buffer_load_dwordx4 v21, s[8:11], s37 offen sc1 lds
v_mul_f32 v83, v163, v163
v_fma_f32 v80, v80, v232, v228
v_fma_f32 v81, v81, v232, v228
v_fma_f32 v82, v82, v232, v228
v_fma_f32 v83, v83, v232, v228
v_mul_f32 v80, v80, v160
v_mul_f32 v81, v81, v161
s_add_u32 m0, s39, 102400
s_add_u32 s37, s37, s55
buffer_load_dwordx4 v21, s[8:11], s37 offen sc1 lds
v_mul_f32 v82, v82, v162
v_mul_f32 v83, v83, v163
v_exp_f32 v80, v80
v_exp_f32 v81, v81
v_exp_f32 v82, v82
v_exp_f32 v83, v83
v_mul_f32 v208, v160, v208
s_add_u32 m0, s39, 103424
s_add_u32 s37, s37, s38
buffer_load_dwordx4 v21, s[8:11], s37 offen sc1 lds
v_mul_f32 v209, v161, v209
v_mul_f32 v210, v162, v210
v_mul_f32 v211, v163, v211
v_fma_f32 v80, v80, v236, v236
v_fma_f32 v81, v81, v236, v236
v_fma_f32 v82, v82, v236, v236
s_add_u32 m0, s39, 104448
s_add_u32 s37, s37, s38
buffer_load_dwordx4 v21, s[8:11], s37 offen sc1 lds
v_fma_f32 v83, v83, v236, v236
v_rcp_f32 v80, v80
v_rcp_f32 v81, v81
v_rcp_f32 v82, v82
v_rcp_f32 v83, v83
v_mul_f32 v208, v208, v80
v_mul_f32 v209, v209, v81
s_add_u32 m0, s39, 105472
s_add_u32 s37, s37, s38
buffer_load_dwordx4 v21, s[8:11], s37 offen sc1 lds
v_mul_f32 v210, v210, v82
v_mul_f32 v211, v211, v83
v_cvt_pk_bf16_f32 v112, v208, v209
v_cvt_pk_bf16_f32 v113, v210, v211
v_mul_f32 v80, v132, v132
v_mul_f32 v81, v133, v133
buffer_store_dwordx4 v[96:99], v27, s[24:27], 0 offen offset:0 sc1
s_barrier
s_add_u32 m0, s39, 0
s_add_u32 s37, s37, s40
buffer_load_dwordx4 v21, s[8:11], s37 offen sc1 lds
v_mul_f32 v82, v134, v134
v_mul_f32 v83, v135, v135
v_fma_f32 v80, v80, v233, v229
v_fma_f32 v81, v81, v233, v229
v_fma_f32 v82, v82, v233, v229
v_fma_f32 v83, v83, v233, v229
v_mul_f32 v80, v80, v132
s_add_u32 m0, s39, 1024
s_add_u32 s37, s37, s38
buffer_load_dwordx4 v21, s[8:11], s37 offen sc1 lds
v_mul_f32 v81, v81, v133
v_mul_f32 v82, v82, v134
v_mul_f32 v83, v83, v135
v_exp_f32 v80, v80
v_exp_f32 v81, v81
v_exp_f32 v82, v82
s_add_u32 m0, s39, 2048
s_add_u32 s37, s37, s38
buffer_load_dwordx4 v21, s[8:11], s37 offen sc1 lds
v_exp_f32 v83, v83
v_mul_f32 v180, v132, v180
v_mul_f32 v181, v133, v181
v_mul_f32 v182, v134, v182
v_mul_f32 v183, v135, v183
v_fma_f32 v80, v80, v237, v237
v_fma_f32 v81, v81, v237, v237
s_add_u32 m0, s39, 3072
s_add_u32 s37, s37, s38
buffer_load_dwordx4 v21, s[8:11], s37 offen sc1 lds
v_fma_f32 v82, v82, v237, v237
v_fma_f32 v83, v83, v237, v237
v_rcp_f32 v80, v80
v_rcp_f32 v81, v81
v_rcp_f32 v82, v82
v_rcp_f32 v83, v83
s_add_u32 m0, s39, 4096
s_add_u32 s37, s37, s55
buffer_load_dwordx4 v21, s[8:11], s37 offen sc1 lds
v_mul_f32 v180, v180, v80
v_mul_f32 v181, v181, v81
v_mul_f32 v182, v182, v82
v_mul_f32 v183, v183, v83
v_cvt_pk_bf16_f32 v100, v180, v181
v_cvt_pk_bf16_f32 v101, v182, v183
v_mul_f32 v84, v148, v148
s_add_u32 m0, s39, 5120
s_add_u32 s37, s37, s38
buffer_load_dwordx4 v21, s[8:11], s37 offen sc1 lds
v_mul_f32 v85, v149, v149
v_mul_f32 v86, v150, v150
v_mul_f32 v87, v151, v151
v_fma_f32 v84, v84, v233, v229
v_fma_f32 v85, v85, v233, v229
v_fma_f32 v86, v86, v233, v229
s_add_u32 m0, s39, 6144
s_add_u32 s37, s37, s38
buffer_load_dwordx4 v21, s[8:11], s37 offen sc1 lds
v_fma_f32 v87, v87, v233, v229
v_mul_f32 v84, v84, v148
v_mul_f32 v85, v85, v149
v_mul_f32 v86, v86, v150
v_mul_f32 v87, v87, v151
v_exp_f32 v84, v84
v_exp_f32 v85, v85
s_add_u32 m0, s39, 7168
s_add_u32 s37, s37, s38
buffer_load_dwordx4 v21, s[8:11], s37 offen sc1 lds
v_exp_f32 v86, v86
v_exp_f32 v87, v87
v_mul_f32 v196, v148, v196
v_mul_f32 v197, v149, v197
v_mul_f32 v198, v150, v198
v_mul_f32 v199, v151, v199
s_waitcnt vmcnt(18)
s_barrier
s_add_u32 s43, s34, 48
s_lshl_b32 s43, s43, 7
v_mov_b32 v10, s43
v_mov_b32 v12, 16
buffer_load_dword v11, v10, s[56:59], 0 offen sc1
s_add_u32 m0, s39, 32768
s_add_u32 s37, s37, s40
buffer_load_dwordx4 v21, s[8:11], s37 offen sc1 lds
v_fma_f32 v84, v84, v237, v237
v_fma_f32 v85, v85, v237, v237
v_fma_f32 v86, v86, v237, v237
v_fma_f32 v87, v87, v237, v237
v_rcp_f32 v84, v84
v_rcp_f32 v85, v85
v_rcp_f32 v86, v86
s_add_u32 m0, s39, 33792
s_add_u32 s37, s37, s38
buffer_load_dwordx4 v21, s[8:11], s37 offen sc1 lds
v_rcp_f32 v87, v87
v_mul_f32 v196, v196, v84
v_mul_f32 v197, v197, v85
v_mul_f32 v198, v198, v86
v_mul_f32 v199, v199, v87
v_cvt_pk_bf16_f32 v102, v196, v197
v_cvt_pk_bf16_f32 v103, v198, v199
s_add_u32 m0, s39, 34816
s_add_u32 s37, s37, s38
buffer_load_dwordx4 v21, s[8:11], s37 offen sc1 lds
v_mul_f32 v80, v164, v164
v_mul_f32 v81, v165, v165
v_mul_f32 v82, v166, v166
v_mul_f32 v83, v167, v167
v_fma_f32 v80, v80, v233, v229
s_add_u32 m0, s39, 35840
s_add_u32 s37, s37, s38
buffer_load_dwordx4 v21, s[8:11], s37 offen sc1 lds
v_fma_f32 v81, v81, v233, v229
v_fma_f32 v82, v82, v233, v229
v_fma_f32 v83, v83, v233, v229
v_mul_f32 v80, v80, v164
v_mul_f32 v81, v81, v165
v_mul_f32 v82, v82, v166
v_mul_f32 v83, v83, v167
s_add_u32 m0, s39, 36864
s_add_u32 s37, s37, s55
buffer_load_dwordx4 v21, s[8:11], s37 offen sc1 lds
v_exp_f32 v80, v80
v_exp_f32 v81, v81
v_exp_f32 v82, v82
v_exp_f32 v83, v83
v_mul_f32 v212, v164, v212
v_mul_f32 v213, v165, v213
v_mul_f32 v214, v166, v214
s_add_u32 m0, s39, 37888
s_add_u32 s37, s37, s38
buffer_load_dwordx4 v21, s[8:11], s37 offen sc1 lds
v_mul_f32 v215, v167, v215
v_fma_f32 v80, v80, v237, v237
v_fma_f32 v81, v81, v237, v237
v_fma_f32 v82, v82, v237, v237
v_fma_f32 v83, v83, v237, v237
v_rcp_f32 v80, v80
s_add_u32 m0, s39, 38912
s_add_u32 s37, s37, s38
buffer_load_dwordx4 v21, s[8:11], s37 offen sc1 lds
v_rcp_f32 v81, v81
v_rcp_f32 v82, v82
v_rcp_f32 v83, v83
v_mul_f32 v212, v212, v80
v_mul_f32 v213, v213, v81
v_mul_f32 v214, v214, v82
v_mul_f32 v215, v215, v83
s_add_u32 m0, s39, 39936
s_add_u32 s37, s37, s38
buffer_load_dwordx4 v21, s[8:11], s37 offen sc1 lds
v_cvt_pk_bf16_f32 v114, v212, v213
v_cvt_pk_bf16_f32 v115, v214, v215
s_nop 1
v_permlane32_swap_b32 v112, v114
v_permlane32_swap_b32 v113, v115
buffer_store_dwordx4 v[100:103], v27, s[24:27], 0 offen offset:256 sc1
buffer_store_dwordx4 v[112:115], v28, s[24:27], 0 offen offset:0 sc1
s_waitcnt vmcnt(20)
s_barrier
s_add_u32 m0, s39, 65536
s_add_u32 s37, s37, s40
buffer_load_dwordx4 v21, s[8:11], s37 offen sc1 lds
v_mul_f32 v80, v136, v136
v_mul_f32 v81, v137, v137
v_mul_f32 v82, v138, v138
v_mul_f32 v83, v139, v139
v_fma_f32 v80, v80, v234, v230
v_fma_f32 v81, v81, v234, v230
v_fma_f32 v82, v82, v234, v230
s_add_u32 m0, s39, 66560
s_add_u32 s37, s37, s38
buffer_load_dwordx4 v21, s[8:11], s37 offen sc1 lds
v_fma_f32 v83, v83, v234, v230
v_mul_f32 v80, v80, v136
v_mul_f32 v81, v81, v137
v_mul_f32 v82, v82, v138
v_mul_f32 v83, v83, v139
v_exp_f32 v80, v80
s_add_u32 m0, s39, 67584
s_add_u32 s37, s37, s38
buffer_load_dwordx4 v21, s[8:11], s37 offen sc1 lds
v_exp_f32 v81, v81
v_exp_f32 v82, v82
v_exp_f32 v83, v83
v_mul_f32 v184, v136, v184
v_mul_f32 v185, v137, v185
v_mul_f32 v186, v138, v186
v_mul_f32 v187, v139, v187
s_add_u32 m0, s39, 68608
s_add_u32 s37, s37, s38
buffer_load_dwordx4 v21, s[8:11], s37 offen sc1 lds
v_fma_f32 v80, v80, v238, v238
v_fma_f32 v81, v81, v238, v238
v_fma_f32 v82, v82, v238, v238
v_fma_f32 v83, v83, v238, v238
v_rcp_f32 v80, v80
v_rcp_f32 v81, v81
s_add_u32 m0, s39, 69632
s_add_u32 s37, s37, s55
buffer_load_dwordx4 v21, s[8:11], s37 offen sc1 lds
v_rcp_f32 v82, v82
v_rcp_f32 v83, v83
v_mul_f32 v184, v184, v80
v_mul_f32 v185, v185, v81
v_mul_f32 v186, v186, v82
v_mul_f32 v187, v187, v83
v_cvt_pk_bf16_f32 v104, v184, v185
s_add_u32 m0, s39, 70656
s_add_u32 s37, s37, s38
buffer_load_dwordx4 v21, s[8:11], s37 offen sc1 lds
v_cvt_pk_bf16_f32 v105, v186, v187
v_mul_f32 v84, v152, v152
v_mul_f32 v85, v153, v153
v_mul_f32 v86, v154, v154
v_mul_f32 v87, v155, v155
v_fma_f32 v84, v84, v234, v230
s_add_u32 m0, s39, 71680
s_add_u32 s37, s37, s38
buffer_load_dwordx4 v21, s[8:11], s37 offen sc1 lds
v_fma_f32 v85, v85, v234, v230
v_fma_f32 v86, v86, v234, v230
v_fma_f32 v87, v87, v234, v230
v_mul_f32 v84, v84, v152
v_mul_f32 v85, v85, v153
v_mul_f32 v86, v86, v154
v_mul_f32 v87, v87, v155
s_add_u32 m0, s39, 72704
s_add_u32 s37, s37, s38
buffer_load_dwordx4 v21, s[8:11], s37 offen sc1 lds
v_exp_f32 v84, v84
v_exp_f32 v85, v85
v_exp_f32 v86, v86
v_exp_f32 v87, v87
v_mul_f32 v200, v152, v200
v_mul_f32 v201, v153, v201
s_waitcnt vmcnt(19)
s_barrier
s_add_u32 m0, s39, 98304
s_add_u32 s37, s37, s40
buffer_load_dwordx4 v21, s[8:11], s37 offen sc1 lds
v_mul_f32 v202, v154, v202
v_mul_f32 v203, v155, v203
v_fma_f32 v84, v84, v238, v238
v_fma_f32 v85, v85, v238, v238
v_fma_f32 v86, v86, v238, v238
v_fma_f32 v87, v87, v238, v238
v_rcp_f32 v84, v84
s_add_u32 m0, s39, 99328
s_add_u32 s37, s37, s38
buffer_load_dwordx4 v21, s[8:11], s37 offen sc1 lds
v_rcp_f32 v85, v85
v_rcp_f32 v86, v86
v_rcp_f32 v87, v87
v_mul_f32 v200, v200, v84
v_mul_f32 v201, v201, v85
v_mul_f32 v202, v202, v86
v_mul_f32 v203, v203, v87
s_add_u32 m0, s39, 100352
s_add_u32 s37, s37, s38
buffer_load_dwordx4 v21, s[8:11], s37 offen sc1 lds
v_cvt_pk_bf16_f32 v106, v200, v201
v_cvt_pk_bf16_f32 v107, v202, v203
v_mul_f32 v80, v168, v168
v_mul_f32 v81, v169, v169
v_mul_f32 v82, v170, v170
s_add_u32 m0, s39, 101376
s_add_u32 s37, s37, s38
buffer_load_dwordx4 v21, s[8:11], s37 offen sc1 lds
v_mul_f32 v83, v171, v171
v_fma_f32 v80, v80, v234, v230
v_fma_f32 v81, v81, v234, v230
v_fma_f32 v82, v82, v234, v230
v_fma_f32 v83, v83, v234, v230
v_mul_f32 v80, v80, v168
v_mul_f32 v81, v81, v169
s_add_u32 m0, s39, 102400
s_add_u32 s37, s37, s55
buffer_load_dwordx4 v21, s[8:11], s37 offen sc1 lds
v_mul_f32 v82, v82, v170
v_mul_f32 v83, v83, v171
v_exp_f32 v80, v80
v_exp_f32 v81, v81
v_exp_f32 v82, v82
v_exp_f32 v83, v83
v_mul_f32 v216, v168, v216
s_add_u32 m0, s39, 103424
s_add_u32 s37, s37, s38
buffer_load_dwordx4 v21, s[8:11], s37 offen sc1 lds
v_mul_f32 v217, v169, v217
v_mul_f32 v218, v170, v218
v_mul_f32 v219, v171, v219
v_fma_f32 v80, v80, v238, v238
v_fma_f32 v81, v81, v238, v238
v_fma_f32 v82, v82, v238, v238
s_add_u32 m0, s39, 104448
s_add_u32 s37, s37, s38
buffer_load_dwordx4 v21, s[8:11], s37 offen sc1 lds
v_fma_f32 v83, v83, v238, v238
v_rcp_f32 v80, v80
v_rcp_f32 v81, v81
v_rcp_f32 v82, v82
v_rcp_f32 v83, v83
v_mul_f32 v216, v216, v80
v_mul_f32 v217, v217, v81
s_add_u32 m0, s39, 105472
s_add_u32 s37, s37, s38
buffer_load_dwordx4 v21, s[8:11], s37 offen sc1 lds
v_mul_f32 v218, v218, v82
v_mul_f32 v219, v219, v83
v_cvt_pk_bf16_f32 v116, v216, v217
v_cvt_pk_bf16_f32 v117, v218, v219
v_mul_f32 v80, v140, v140
v_mul_f32 v81, v141, v141
buffer_store_dwordx4 v[104:107], v27, s[24:27], 0 offen offset:512 sc1
s_waitcnt vmcnt(19)
s_mov_b32 s41, 0x10000
s_waitcnt vmcnt(27)
s_branch Lpf_130
Lpoll_128:
s_waitcnt vmcnt(0)
Lpf_130:
v_cmp_ne_u32 vcc, v12, v11
s_nop 4
s_cbranch_vccz Lpok_129
buffer_load_dword v11, v10, s[56:59], 0 offen sc1
s_sub_u32 s41, s41, 1
s_cmp_lg_u32 s41, 0
s_cbranch_scc1 Lpoll_128
s_waitcnt vmcnt(0)
Lpok_129:
s_barrier
s_add_u32 s37, s37, s29
s_add_u32 m0, s39, 0
s_add_u32 s37, s37, s40
buffer_load_dwordx4 v21, s[8:11], s37 offen sc1 lds
v_mul_f32 v82, v142, v142
v_mul_f32 v83, v143, v143
v_fma_f32 v80, v80, v235, v231
v_fma_f32 v81, v81, v235, v231
v_fma_f32 v82, v82, v235, v231
v_fma_f32 v83, v83, v235, v231
v_mul_f32 v80, v80, v140
s_add_u32 m0, s39, 1024
s_add_u32 s37, s37, s38
buffer_load_dwordx4 v21, s[8:11], s37 offen sc1 lds
v_mul_f32 v81, v81, v141
v_mul_f32 v82, v82, v142
v_mul_f32 v83, v83, v143
v_exp_f32 v80, v80
v_exp_f32 v81, v81
v_exp_f32 v82, v82
s_add_u32 m0, s39, 2048
s_add_u32 s37, s37, s38
buffer_load_dwordx4 v21, s[8:11], s37 offen sc1 lds
v_exp_f32 v83, v83
v_mul_f32 v188, v140, v188
v_mul_f32 v189, v141, v189
v_mul_f32 v190, v142, v190
v_mul_f32 v191, v143, v191
v_fma_f32 v80, v80, v239, v239
v_fma_f32 v81, v81, v239, v239
s_add_u32 m0, s39, 3072
s_add_u32 s37, s37, s38
buffer_load_dwordx4 v21, s[8:11], s37 offen sc1 lds
v_fma_f32 v82, v82, v239, v239
v_fma_f32 v83, v83, v239, v239
v_rcp_f32 v80, v80
v_rcp_f32 v81, v81
v_rcp_f32 v82, v82
v_rcp_f32 v83, v83
s_add_u32 m0, s39, 4096
s_add_u32 s37, s37, s55
buffer_load_dwordx4 v21, s[8:11], s37 offen sc1 lds
v_mul_f32 v188, v188, v80
v_mul_f32 v189, v189, v81
v_mul_f32 v190, v190, v82
v_mul_f32 v191, v191, v83
v_cvt_pk_bf16_f32 v108, v188, v189
v_cvt_pk_bf16_f32 v109, v190, v191
v_mul_f32 v84, v156, v156
s_add_u32 m0, s39, 5120
s_add_u32 s37, s37, s38
buffer_load_dwordx4 v21, s[8:11], s37 offen sc1 lds
v_mul_f32 v85, v157, v157
v_mul_f32 v86, v158, v158
v_mul_f32 v87, v159, v159
v_fma_f32 v84, v84, v235, v231
v_fma_f32 v85, v85, v235, v231
v_fma_f32 v86, v86, v235, v231
s_add_u32 m0, s39, 6144
s_add_u32 s37, s37, s38
buffer_load_dwordx4 v21, s[8:11], s37 offen sc1 lds
v_fma_f32 v87, v87, v235, v231
v_mul_f32 v84, v84, v156
v_mul_f32 v85, v85, v157
v_mul_f32 v86, v86, v158
v_mul_f32 v87, v87, v159
v_exp_f32 v84, v84
v_exp_f32 v85, v85
s_add_u32 m0, s39, 7168
s_add_u32 s37, s37, s38
buffer_load_dwordx4 v21, s[8:11], s37 offen sc1 lds
v_exp_f32 v86, v86
v_exp_f32 v87, v87
v_mul_f32 v204, v156, v204
v_mul_f32 v205, v157, v205
v_mul_f32 v206, v158, v206
v_mul_f32 v207, v159, v207
s_waitcnt vmcnt(17)
s_barrier
s_add_u32 m0, s39, 32768
s_add_u32 s37, s37, s40
buffer_load_dwordx4 v21, s[8:11], s37 offen sc1 lds
v_fma_f32 v84, v84, v239, v239
v_fma_f32 v85, v85, v239, v239
v_fma_f32 v86, v86, v239, v239
v_fma_f32 v87, v87, v239, v239
v_rcp_f32 v84, v84
v_rcp_f32 v85, v85
v_rcp_f32 v86, v86
s_add_u32 m0, s39, 33792
s_add_u32 s37, s37, s38
buffer_load_dwordx4 v21, s[8:11], s37 offen sc1 lds
v_rcp_f32 v87, v87
v_mul_f32 v204, v204, v84
v_mul_f32 v205, v205, v85
v_mul_f32 v206, v206, v86
v_mul_f32 v207, v207, v87
v_cvt_pk_bf16_f32 v110, v204, v205
v_cvt_pk_bf16_f32 v111, v206, v207
s_add_u32 m0, s39, 34816
s_add_u32 s37, s37, s38
buffer_load_dwordx4 v21, s[8:11], s37 offen sc1 lds
v_mul_f32 v80, v172, v172
v_mul_f32 v81, v173, v173
v_mul_f32 v82, v174, v174
v_mul_f32 v83, v175, v175
v_fma_f32 v80, v80, v235, v231
s_add_u32 m0, s39, 35840
s_add_u32 s37, s37, s38
buffer_load_dwordx4 v21, s[8:11], s37 offen sc1 lds
v_fma_f32 v81, v81, v235, v231
v_fma_f32 v82, v82, v235, v231
v_fma_f32 v83, v83, v235, v231
v_mul_f32 v80, v80, v172
v_mul_f32 v81, v81, v173
v_mul_f32 v82, v82, v174
v_mul_f32 v83, v83, v175
s_add_u32 m0, s39, 36864
s_add_u32 s37, s37, s55
buffer_load_dwordx4 v21, s[8:11], s37 offen sc1 lds
v_exp_f32 v80, v80
v_exp_f32 v81, v81
v_exp_f32 v82, v82
v_exp_f32 v83, v83
v_mul_f32 v220, v172, v220
v_mul_f32 v221, v173, v221
v_mul_f32 v222, v174, v222
s_add_u32 m0, s39, 37888
s_add_u32 s37, s37, s38
buffer_load_dwordx4 v21, s[8:11], s37 offen sc1 lds
v_mul_f32 v223, v175, v223
v_fma_f32 v80, v80, v239, v239
v_fma_f32 v81, v81, v239, v239
v_fma_f32 v82, v82, v239, v239
v_fma_f32 v83, v83, v239, v239
v_rcp_f32 v80, v80
s_add_u32 m0, s39, 38912
s_add_u32 s37, s37, s38
buffer_load_dwordx4 v21, s[8:11], s37 offen sc1 lds
v_rcp_f32 v81, v81
v_rcp_f32 v82, v82
v_rcp_f32 v83, v83
v_mul_f32 v220, v220, v80
v_mul_f32 v221, v221, v81
v_mul_f32 v222, v222, v82
v_mul_f32 v223, v223, v83
s_add_u32 m0, s39, 39936
s_add_u32 s37, s37, s38
buffer_load_dwordx4 v21, s[8:11], s37 offen sc1 lds
v_cvt_pk_bf16_f32 v118, v220, v221
v_cvt_pk_bf16_f32 v119, v222, v223
s_nop 1
v_permlane32_swap_b32 v116, v118
v_permlane32_swap_b32 v117, v119
buffer_store_dwordx4 v[108:111], v27, s[24:27], 0 offen offset:768 sc1
buffer_store_dwordx4 v[116:119], v28, s[24:27], 0 offen offset:512 sc1
s_waitcnt vmcnt(19)
s_barrier
s_add_u32 m0, s39, 65536
s_add_u32 s37, s37, s40
buffer_load_dwordx4 v21, s[8:11], s37 offen sc1 lds
s_add_u32 m0, s39, 66560
s_add_u32 s37, s37, s38
buffer_load_dwordx4 v21, s[8:11], s37 offen sc1 lds
s_add_u32 m0, s39, 67584
s_add_u32 s37, s37, s38
buffer_load_dwordx4 v21, s[8:11], s37 offen sc1 lds
s_add_u32 m0, s39, 68608
s_add_u32 s37, s37, s38
buffer_load_dwordx4 v21, s[8:11], s37 offen sc1 lds
s_add_u32 m0, s39, 69632
s_add_u32 s37, s37, s55
buffer_load_dwordx4 v21, s[8:11], s37 offen sc1 lds
s_add_u32 m0, s39, 70656
s_add_u32 s37, s37, s38
buffer_load_dwordx4 v21, s[8:11], s37 offen sc1 lds
s_add_u32 m0, s39, 71680
s_add_u32 s37, s37, s38
buffer_load_dwordx4 v21, s[8:11], s37 offen sc1 lds
s_add_u32 m0, s39, 72704
s_add_u32 s37, s37, s38
buffer_load_dwordx4 v21, s[8:11], s37 offen sc1 lds
s_waitcnt vmcnt(8)
s_barrier
s_add_u32 s43, s34, 64
s_lshl_b32 s43, s43, 7
v_mov_b32 v10, s43
v_mov_b32 v11, 1
s_mov_b64 exec, 1
buffer_atomic_add v11, v10, s[56:59], 0 offen sc1
s_mov_b64 exec, -1
s_add_u32 m0, s39, 98304
s_add_u32 s37, s37, s40
buffer_load_dwordx4 v21, s[8:11], s37 offen sc1 lds
s_add_u32 m0, s39, 99328
s_add_u32 s37, s37, s38
buffer_load_dwordx4 v21, s[8:11], s37 offen sc1 lds
s_add_u32 m0, s39, 100352
s_add_u32 s37, s37, s38
buffer_load_dwordx4 v21, s[8:11], s37 offen sc1 lds
s_add_u32 m0, s39, 101376
s_add_u32 s37, s37, s38
buffer_load_dwordx4 v21, s[8:11], s37 offen sc1 lds
s_add_u32 m0, s39, 102400
s_add_u32 s37, s37, s55
buffer_load_dwordx4 v21, s[8:11], s37 offen sc1 lds
s_add_u32 m0, s39, 103424
s_add_u32 s37, s37, s38
buffer_load_dwordx4 v21, s[8:11], s37 offen sc1 lds
s_add_u32 m0, s39, 104448
s_add_u32 s37, s37, s38
buffer_load_dwordx4 v21, s[8:11], s37 offen sc1 lds
s_add_u32 m0, s39, 105472
s_add_u32 s37, s37, s38
buffer_load_dwordx4 v21, s[8:11], s37 offen sc1 lds
s_waitcnt vmcnt(19)
s_barrier
s_lshr_b32 s44, s2, 3
s_lshl_b32 s44, s44, 16
s_add_u32 s43, s44, 4194304
buffer_load_dword v30, v29, s[80:83], s43 offen
s_add_u32 m0, s39, 0
s_add_u32 s37, s37, s40
buffer_load_dwordx4 v21, s[8:11], s37 offen sc1 lds
s_add_u32 m0, s39, 1024
s_add_u32 s37, s37, s38
buffer_load_dwordx4 v21, s[8:11], s37 offen sc1 lds
s_add_u32 m0, s39, 2048
s_add_u32 s37, s37, s38
buffer_load_dwordx4 v21, s[8:11], s37 offen sc1 lds
s_add_u32 m0, s39, 3072
s_add_u32 s37, s37, s38
buffer_load_dwordx4 v21, s[8:11], s37 offen sc1 lds
s_add_u32 m0, s39, 4096
s_add_u32 s37, s37, s55
buffer_load_dwordx4 v21, s[8:11], s37 offen sc1 lds
s_add_u32 m0, s39, 5120
s_add_u32 s37, s37, s38
buffer_load_dwordx4 v21, s[8:11], s37 offen sc1 lds
s_add_u32 m0, s39, 6144
s_add_u32 s37, s37, s38
buffer_load_dwordx4 v21, s[8:11], s37 offen sc1 lds
s_add_u32 m0, s39, 7168
s_add_u32 s37, s37, s38
buffer_load_dwordx4 v21, s[8:11], s37 offen sc1 lds
s_waitcnt vmcnt(18)
s_barrier
s_add_u32 s43, s34, 64
s_lshl_b32 s43, s43, 7
v_mov_b32 v10, s43
v_mov_b32 v12, 16
buffer_load_dword v11, v10, s[56:59], 0 offen sc1
s_add_u32 m0, s39, 32768
s_add_u32 s37, s37, s40
buffer_load_dwordx4 v21, s[8:11], s37 offen sc1 lds
s_add_u32 m0, s39, 33792
s_add_u32 s37, s37, s38
buffer_load_dwordx4 v21, s[8:11], s37 offen sc1 lds
s_add_u32 m0, s39, 34816
s_add_u32 s37, s37, s38
buffer_load_dwordx4 v21, s[8:11], s37 offen sc1 lds
s_add_u32 m0, s39, 35840
s_add_u32 s37, s37, s38
buffer_load_dwordx4 v21, s[8:11], s37 offen sc1 lds
s_add_u32 m0, s39, 36864
s_add_u32 s37, s37, s55
buffer_load_dwordx4 v21, s[8:11], s37 offen sc1 lds
s_add_u32 m0, s39, 37888
s_add_u32 s37, s37, s38
buffer_load_dwordx4 v21, s[8:11], s37 offen sc1 lds
s_add_u32 m0, s39, 38912
s_add_u32 s37, s37, s38
buffer_load_dwordx4 v21, s[8:11], s37 offen sc1 lds
s_add_u32 m0, s39, 39936
s_add_u32 s37, s37, s38
buffer_load_dwordx4 v21, s[8:11], s37 offen sc1 lds
s_waitcnt vmcnt(18)
s_barrier
s_add_u32 m0, s39, 65536
s_add_u32 s37, s37, s40
buffer_load_dwordx4 v21, s[8:11], s37 offen sc1 lds
s_add_u32 m0, s39, 66560
s_add_u32 s37, s37, s38
buffer_load_dwordx4 v21, s[8:11], s37 offen sc1 lds
s_add_u32 m0, s39, 67584
s_add_u32 s37, s37, s38
buffer_load_dwordx4 v21, s[8:11], s37 offen sc1 lds
s_add_u32 m0, s39, 68608
s_add_u32 s37, s37, s38
buffer_load_dwordx4 v21, s[8:11], s37 offen sc1 lds
s_add_u32 m0, s39, 69632
s_add_u32 s37, s37, s55
buffer_load_dwordx4 v21, s[8:11], s37 offen sc1 lds
s_add_u32 m0, s39, 70656
s_add_u32 s37, s37, s38
buffer_load_dwordx4 v21, s[8:11], s37 offen sc1 lds
s_add_u32 m0, s39, 71680
s_add_u32 s37, s37, s38
buffer_load_dwordx4 v21, s[8:11], s37 offen sc1 lds
s_add_u32 m0, s39, 72704
s_add_u32 s37, s37, s38
buffer_load_dwordx4 v21, s[8:11], s37 offen sc1 lds
s_waitcnt vmcnt(17)
s_barrier
s_branch Lw_131
Lr_132:
s_add_u32 m0, s39, 98304
s_add_u32 s37, s37, s40
buffer_load_dwordx4 v21, s[8:11], s37 offen sc1 lds
s_add_u32 m0, s39, 99328
s_add_u32 s37, s37, s38
buffer_load_dwordx4 v21, s[8:11], s37 offen sc1 lds
s_add_u32 m0, s39, 100352
s_add_u32 s37, s37, s38
buffer_load_dwordx4 v21, s[8:11], s37 offen sc1 lds
s_add_u32 m0, s39, 101376
s_add_u32 s37, s37, s38
buffer_load_dwordx4 v21, s[8:11], s37 offen sc1 lds
s_add_u32 m0, s39, 102400
s_add_u32 s37, s37, s55
buffer_load_dwordx4 v21, s[8:11], s37 offen sc1 lds
s_add_u32 m0, s39, 103424
s_add_u32 s37, s37, s38
buffer_load_dwordx4 v21, s[8:11], s37 offen sc1 lds
s_add_u32 m0, s39, 104448
s_add_u32 s37, s37, s38
buffer_load_dwordx4 v21, s[8:11], s37 offen sc1 lds
s_add_u32 m0, s39, 105472
s_add_u32 s37, s37, s38
buffer_load_dwordx4 v21, s[8:11], s37 offen sc1 lds
s_waitcnt vmcnt(16)
s_mov_b32 s41, 0x10000
s_waitcnt vmcnt(24)
s_branch Lpf_135
Lpoll_133:
s_waitcnt vmcnt(0)
Lpf_135:
v_cmp_ne_u32 vcc, v12, v11
s_nop 4
s_cbranch_vccz Lpok_134
buffer_load_dword v11, v10, s[56:59], 0 offen sc1
s_sub_u32 s41, s41, 1
s_cmp_lg_u32 s41, 0
s_cbranch_scc1 Lpoll_133
s_waitcnt vmcnt(0)
Lpok_134:
s_barrier
s_mul_i32 s40, s53, 786432
s_add_u32 m0, s39, 0
s_add_u32 s37, s40, 4194304
buffer_load_dwordx4 v21, s[8:11], s37 offen sc1 lds
s_add_u32 m0, s39, 1024
s_add_u32 s37, s40, 4210688
buffer_load_dwordx4 v21, s[8:11], s37 offen sc1 lds
s_add_u32 m0, s39, 2048
s_add_u32 s37, s40, 4227072
buffer_load_dwordx4 v21, s[8:11], s37 offen sc1 lds
s_add_u32 m0, s39, 3072
s_add_u32 s37, s40, 4243456
buffer_load_dwordx4 v21, s[8:11], s37 offen sc1 lds
s_add_u32 m0, s39, 4096
s_add_u32 s37, s40, 4292608
buffer_load_dwordx4 v21, s[8:11], s37 offen sc1 lds
s_add_u32 m0, s39, 5120
s_add_u32 s37, s40, 4308992
buffer_load_dwordx4 v21, s[8:11], s37 offen sc1 lds
s_add_u32 m0, s39, 6144
s_add_u32 s37, s40, 4325376
buffer_load_dwordx4 v21, s[8:11], s37 offen sc1 lds
s_add_u32 m0, s39, 7168
s_add_u32 s37, s40, 4341760
buffer_load_dwordx4 v21, s[8:11], s37 offen sc1 lds
s_waitcnt vmcnt(16)
s_barrier
s_add_u32 m0, s39, 32768
s_add_u32 s37, s40, 4259840
buffer_load_dwordx4 v21, s[8:11], s37 offen sc1 lds
s_add_u32 m0, s39, 33792
s_add_u32 s37, s40, 4358144
buffer_load_dwordx4 v21, s[8:11], s37 offen sc1 lds
s_add_u32 m0, s39, 34816
s_add_u32 s37, s40, 4276224
buffer_load_dwordx4 v21, s[8:11], s37 offen sc1 lds
s_add_u32 m0, s39, 35840
s_add_u32 s37, s40, 4374528
buffer_load_dwordx4 v21, s[8:11], s37 offen sc1 lds
s_add_u32 m0, s39, 36864
s_add_u32 s37, s40, 4390912
buffer_load_dwordx4 v21, s[8:11], s37 offen sc1 lds
s_add_u32 m0, s39, 37888
s_add_u32 s37, s40, 4407296
buffer_load_dwordx4 v21, s[8:11], s37 offen sc1 lds
s_add_u32 m0, s39, 38912
s_add_u32 s37, s40, 4423680
buffer_load_dwordx4 v21, s[8:11], s37 offen sc1 lds
s_add_u32 m0, s39, 39936
s_add_u32 s37, s40, 4440064
buffer_load_dwordx4 v21, s[8:11], s37 offen sc1 lds
s_waitcnt vmcnt(16)
s_barrier
s_add_u32 m0, s39, 65536
s_add_u32 s37, s40, 4489216
buffer_load_dwordx4 v21, s[8:11], s37 offen sc1 lds
s_add_u32 m0, s39, 66560
s_add_u32 s37, s40, 4505600
buffer_load_dwordx4 v21, s[8:11], s37 offen sc1 lds
s_add_u32 m0, s39, 67584
s_add_u32 s37, s40, 4521984
buffer_load_dwordx4 v21, s[8:11], s37 offen sc1 lds
s_add_u32 m0, s39, 68608
s_add_u32 s37, s40, 4538368
buffer_load_dwordx4 v21, s[8:11], s37 offen sc1 lds
s_add_u32 m0, s39, 69632
s_add_u32 s37, s40, 4456448
buffer_load_dwordx4 v21, s[8:11], s37 offen sc1 lds
s_add_u32 m0, s39, 70656
s_add_u32 s37, s40, 4554752
buffer_load_dwordx4 v21, s[8:11], s37 offen sc1 lds
s_add_u32 m0, s39, 71680
s_add_u32 s37, s40, 4472832
buffer_load_dwordx4 v21, s[8:11], s37 offen sc1 lds
s_add_u32 m0, s39, 72704
s_add_u32 s37, s40, 4571136
buffer_load_dwordx4 v21, s[8:11], s37 offen sc1 lds
s_waitcnt vmcnt(16)
s_barrier
s_add_u32 m0, s39, 98304
s_add_u32 s37, s40, 4587520
buffer_load_dwordx4 v21, s[8:11], s37 offen sc1 lds
s_add_u32 m0, s39, 99328
s_add_u32 s37, s40, 4603904
buffer_load_dwordx4 v21, s[8:11], s37 offen sc1 lds
s_add_u32 m0, s39, 100352
s_add_u32 s37, s40, 4620288
buffer_load_dwordx4 v21, s[8:11], s37 offen sc1 lds
s_add_u32 m0, s39, 101376
s_add_u32 s37, s40, 4636672
buffer_load_dwordx4 v21, s[8:11], s37 offen sc1 lds
s_add_u32 m0, s39, 102400
s_add_u32 s37, s40, 4685824
buffer_load_dwordx4 v21, s[8:11], s37 offen sc1 lds
s_add_u32 m0, s39, 103424
s_add_u32 s37, s40, 4702208
buffer_load_dwordx4 v21, s[8:11], s37 offen sc1 lds
s_add_u32 m0, s39, 104448
s_add_u32 s37, s40, 4718592
buffer_load_dwordx4 v21, s[8:11], s37 offen sc1 lds
s_add_u32 m0, s39, 105472
s_add_u32 s37, s40, 4734976
buffer_load_dwordx4 v21, s[8:11], s37 offen sc1 lds
s_waitcnt vmcnt(16)
s_barrier
s_lshr_b32 s44, s2, 3
s_and_b32 s44, s44, 15
s_lshl_b32 s44, s44, 16
s_add_u32 s43, s44, 6291456
buffer_load_dword v30, v29, s[80:83], s43 offen
s_add_u32 m0, s39, 0
s_add_u32 s37, s40, 4653056
buffer_load_dwordx4 v21, s[8:11], s37 offen sc1 lds
s_add_u32 m0, s39, 1024
s_add_u32 s37, s40, 4751360
buffer_load_dwordx4 v21, s[8:11], s37 offen sc1 lds
s_add_u32 m0, s39, 2048
s_add_u32 s37, s40, 4669440
buffer_load_dwordx4 v21, s[8:11], s37 offen sc1 lds
s_add_u32 m0, s39, 3072
s_add_u32 s37, s40, 4767744
buffer_load_dwordx4 v21, s[8:11], s37 offen sc1 lds
s_add_u32 m0, s39, 4096
s_add_u32 s37, s40, 4784128
buffer_load_dwordx4 v21, s[8:11], s37 offen sc1 lds
s_add_u32 m0, s39, 5120
s_add_u32 s37, s40, 4800512
buffer_load_dwordx4 v21, s[8:11], s37 offen sc1 lds
s_add_u32 m0, s39, 6144
s_add_u32 s37, s40, 4816896
buffer_load_dwordx4 v21, s[8:11], s37 offen sc1 lds
s_add_u32 m0, s39, 7168
s_add_u32 s37, s40, 4833280
buffer_load_dwordx4 v21, s[8:11], s37 offen sc1 lds
s_waitcnt vmcnt(17)
s_barrier
s_add_u32 m0, s39, 32768
s_add_u32 s37, s40, 4882432
buffer_load_dwordx4 v21, s[8:11], s37 offen sc1 lds
s_add_u32 m0, s39, 33792
s_add_u32 s37, s40, 4898816
buffer_load_dwordx4 v21, s[8:11], s37 offen sc1 lds
s_add_u32 m0, s39, 34816
s_add_u32 s37, s40, 4915200
buffer_load_dwordx4 v21, s[8:11], s37 offen sc1 lds
s_add_u32 m0, s39, 35840
s_add_u32 s37, s40, 4931584
buffer_load_dwordx4 v21, s[8:11], s37 offen sc1 lds
s_add_u32 m0, s39, 36864
s_add_u32 s37, s40, 4849664
buffer_load_dwordx4 v21, s[8:11], s37 offen sc1 lds
s_add_u32 m0, s39, 37888
s_add_u32 s37, s40, 4947968
buffer_load_dwordx4 v21, s[8:11], s37 offen sc1 lds
s_add_u32 m0, s39, 38912
s_add_u32 s37, s40, 4866048
buffer_load_dwordx4 v21, s[8:11], s37 offen sc1 lds
s_add_u32 m0, s39, 39936
s_add_u32 s37, s40, 4964352
buffer_load_dwordx4 v21, s[8:11], s37 offen sc1 lds
s_waitcnt vmcnt(17)
s_barrier
s_waitcnt vmcnt(8)
s_barrier
s_waitcnt vmcnt(0)
s_barrier
s_barrier
s_barrier
s_barrier
s_barrier
s_barrier
s_lshl_b32 s43, s34, 4
s_add_u32 s43, s43, s35
s_and_b32 s44, s43, 1
s_lshl_b32 s44, s44, 2
s_lshr_b32 s43, s43, 1
s_add_u32 s43, s43, 128
s_lshl_b32 s43, s43, 7
s_add_u32 s43, s43, s44
v_mov_b32 v10, s43
v_mov_b32 v11, 1
s_mov_b64 exec, 1
buffer_store_dword v11, v10, s[56:59], 0 offen sc1
s_mov_b64 exec, -1
s_barrier
s_barrier
s_barrier
s_lshl_b32 s43, s34, 4
s_add_u32 s43, s43, s35
s_xor_b32 s43, s43, 1
s_and_b32 s44, s43, 1
s_lshl_b32 s44, s44, 2
s_lshr_b32 s43, s43, 1
s_add_u32 s43, s43, 128
s_lshl_b32 s43, s43, 7
s_add_u32 s43, s43, s44
v_mov_b32 v10, s43
v_mov_b32 v12, 1
buffer_load_dword v11, v10, s[56:59], 0 offen sc1
s_barrier
s_barrier
s_mov_b32 s41, 0x10000
Lpoll_136:
s_waitcnt vmcnt(0)
Lpf_138:
v_cmp_ne_u32 vcc, v12, v11
s_nop 4
s_cbranch_vccz Lpok_137
buffer_load_dword v11, v10, s[56:59], 0 offen sc1
s_sub_u32 s41, s41, 1
s_cmp_lg_u32 s41, 0
s_cbranch_scc1 Lpoll_136
s_waitcnt vmcnt(0)
Lpok_137:
s_barrier
s_branch Ldone_1
Ldone_1:
s_endpgm
.section .rodata,"a"
.p2align 6
.amdhsa_kernel sequential_preLN__sliding_local_dilated__glu_gated_geglu__prompt_kernel
  .amdhsa_next_free_vgpr 256
  .amdhsa_next_free_sgpr 100
  .amdhsa_accum_offset 256
  .amdhsa_group_segment_fixed_size 0
  .amdhsa_kernarg_size 80
  .amdhsa_user_sgpr_count 2
  .amdhsa_user_sgpr_kernarg_segment_ptr 1
  .amdhsa_system_sgpr_workgroup_id_x 1
  .amdhsa_float_denorm_mode_32 3
  .amdhsa_float_denorm_mode_16_64 3
.end_amdhsa_kernel
```

```asm
; @launch grid=(256,1,1) block=(512,1,1) lds=151552
.amdgcn_target "amdgcn-amd-amdhsa--gfx950"
.text
.globl sequential_preLN__sliding_local_dilated__glu_gated_geglu__prompt_kernel
.p2align 8
.type sequential_preLN__sliding_local_dilated__glu_gated_geglu__prompt_kernel,@function
sequential_preLN__sliding_local_dilated__glu_gated_geglu__prompt_kernel:
s_cmp_ge_u32 s2, 256
s_cbranch_scc1 Ldone_1
s_load_dwordx4 s[4:7], s[0:1], 0
s_load_dwordx2 s[32:33], s[0:1], 72
s_load_dwordx2 s[80:81], s[0:1], 32
s_and_b32 s3, s2, 7
s_lshr_b32 s42, s2, 3
s_and_b32 s48, s42, 3
s_lshr_b32 s49, s42, 2
s_and_b32 s34, s3, 3
s_lshl_b32 s34, s34, 2
s_add_u32 s34, s34, s48
s_lshr_b32 s35, s3, 2
s_lshl_b32 s35, s35, 3
s_add_u32 s35, s35, s49
v_lshrrev_b32 v12, 6, v0
v_and_b32 v1, 63, v0
v_readfirstlane_b32 s36, v12
s_nop 3
s_lshl_b32 s44, s34, 18
s_lshl_b32 s45, s35, 14
s_add_u32 s45, s45, s44
s_lshl_b32 s50, s34, 7
s_sub_u32 s50, s50, 16
s_and_b32 s47, s36, 3
s_lshl_b32 s43, s34, 7
s_lshl_b32 s44, s35, 3
s_add_u32 s43, s43, s44
s_mov_b32 s63, s43
s_lshl_b32 s44, s47, 1
s_add_u32 s51, s43, s44
v_lshlrev_b32 v10, 4, v1
v_lshrrev_b32 v14, 3, v1
v_and_b32 v15, 7, v1
v_and_b32 v16, 2, v14
v_xor_b32 v16, v15, v16
v_lshlrev_b32 v16, 4, v16
v_mul_u32_u24 v17, 6144, v14
s_lshl_b32 s43, s47, 11
v_add3_u32 v2, v17, v16, s43
v_xor_b32 v3, 64, v2
v_lshrrev_b32 v16, 1, v14
v_xor_b32 v16, v15, v16
v_lshlrev_b32 v16, 4, v16
s_lshl_b32 s43, s47, 3
s_add_u32 s43, s43, s50
v_add_u32 v17, s43, v14
s_and_b32 s44, s47, 1
s_lshl_b32 s44, s44, 6
v_add_u32 v18, 0, v17
v_max_i32 v18, 0, v18
v_lshl_add_u32 v18, v18, 11, v16
v_xor_b32 v18, s44, v18
v_mov_b32 v4, v18
v_add_u32 v18, 24, v17
v_max_i32 v18, 0, v18
v_lshl_add_u32 v18, v18, 11, v16
v_xor_b32 v18, s44, v18
v_xor_b32 v5, 64, v18
v_add_u32 v18, 48, v17
v_max_i32 v18, 0, v18
v_lshl_add_u32 v18, v18, 11, v16
v_xor_b32 v18, s44, v18
v_mov_b32 v6, v18
v_add_u32 v18, 72, v17
v_max_i32 v18, 0, v18
v_lshl_add_u32 v18, v18, 11, v16
v_xor_b32 v18, s44, v18
v_xor_b32 v7, 64, v18
v_add_u32 v18, 96, v17
v_max_i32 v18, 0, v18
v_lshl_add_u32 v18, v18, 11, v16
v_xor_b32 v18, s44, v18
v_mov_b32 v8, v18
v_add_u32 v18, 120, v17
v_max_i32 v18, 0, v18
v_lshl_add_u32 v18, v18, 11, v16
v_xor_b32 v18, s44, v18
v_xor_b32 v9, 64, v18
s_lshl_b32 s39, s47, 10
s_lshl_b32 s40, s47, 13
s_add_u32 s40, s40, 18432
s_mov_b32 s37, 0
s_mov_b32 s38, 0
s_bfm_b64 s[60:61], 56, 8
s_cmp_eq_u32 s47, 0
s_cselect_b64 s[60:61], s[60:61], -1
s_mov_b32 s53, 0x3f803f80
v_and_b32 v12, 15, v1
v_lshrrev_b32 v13, 4, v1
s_lshl_b32 s43, s35, 7
s_waitcnt lgkmcnt(0)
s_mov_b32 s8, s4
s_mov_b32 s9, s5
s_mov_b32 s10, 4194304
s_mov_b32 s11, 0x20000
s_add_u32 s12, s6, s43
s_addc_u32 s13, s7, 0
s_mov_b32 s14, 6289536
s_mov_b32 s15, 0x20000
s_add_u32 s16, s32, s45
s_addc_u32 s17, s33, 0
s_mov_b32 s18, 16384
s_mov_b32 s19, 0x20000
s_add_u32 s20, s32, 26214400
s_addc_u32 s21, s33, 0
s_mov_b32 s22, 16384
s_mov_b32 s23, 0x20000
s_cmp_lt_u32 s36, 4
s_cbranch_scc1 Lcons_2
s_cmp_eq_u32 s36, 7
s_cbranch_scc1 Lpf_3
s_add_u32 m0, s39, 0
s_mov_b64 exec, s[60:61]
buffer_load_dwordx4 v4, s[8:11], s37 offen lds
s_mov_b64 exec, -1
s_add_u32 m0, s39, 3072
s_nop 0
buffer_load_dwordx4 v5, s[8:11], s37 offen lds
s_add_u32 m0, s39, 6144
s_nop 0
buffer_load_dwordx4 v6, s[8:11], s37 offen lds
s_add_u32 m0, s39, 9216
s_nop 0
buffer_load_dwordx4 v7, s[8:11], s37 offen lds
s_add_u32 m0, s39, 12288
s_nop 0
buffer_load_dwordx4 v8, s[8:11], s37 offen lds
s_add_u32 m0, s39, 15360
s_nop 0
buffer_load_dwordx4 v9, s[8:11], s37 offen lds
s_add_u32 m0, s40, 0
s_add_u32 s43, s38, 0
buffer_load_dwordx4 v2, s[12:15], s43 offen lds
s_add_u32 m0, s40, 1024
s_add_u32 s43, s38, 49152
buffer_load_dwordx4 v3, s[12:15], s43 offen lds
s_add_u32 m0, s40, 2048
s_add_u32 s43, s38, 98304
buffer_load_dwordx4 v2, s[12:15], s43 offen lds
s_add_u32 m0, s40, 3072
s_add_u32 s43, s38, 147456
buffer_load_dwordx4 v3, s[12:15], s43 offen lds
s_add_u32 m0, s40, 4096
s_add_u32 s43, s38, 196608
buffer_load_dwordx4 v2, s[12:15], s43 offen lds
s_add_u32 m0, s40, 5120
s_add_u32 s43, s38, 245760
buffer_load_dwordx4 v3, s[12:15], s43 offen lds
s_add_u32 m0, s40, 6144
s_add_u32 s43, s38, 294912
buffer_load_dwordx4 v2, s[12:15], s43 offen lds
s_add_u32 m0, s40, 7168
s_add_u32 s43, s38, 344064
buffer_load_dwordx4 v3, s[12:15], s43 offen lds
s_add_u32 s37, s37, 128
s_add_u32 s38, s38, 393216
s_add_u32 m0, s39, 43008
s_mov_b64 exec, s[60:61]
buffer_load_dwordx4 v4, s[8:11], s37 offen lds
s_mov_b64 exec, -1
s_add_u32 m0, s39, 46080
s_nop 0
buffer_load_dwordx4 v5, s[8:11], s37 offen lds
s_add_u32 m0, s39, 49152
s_nop 0
buffer_load_dwordx4 v6, s[8:11], s37 offen lds
s_add_u32 m0, s39, 52224
s_nop 0
buffer_load_dwordx4 v7, s[8:11], s37 offen lds
s_add_u32 m0, s39, 55296
s_nop 0
buffer_load_dwordx4 v8, s[8:11], s37 offen lds
s_add_u32 m0, s39, 58368
s_nop 0
buffer_load_dwordx4 v9, s[8:11], s37 offen lds
s_add_u32 m0, s40, 43008
s_add_u32 s43, s38, 0
buffer_load_dwordx4 v2, s[12:15], s43 offen lds
s_add_u32 m0, s40, 44032
s_add_u32 s43, s38, 49152
buffer_load_dwordx4 v3, s[12:15], s43 offen lds
s_add_u32 m0, s40, 45056
s_add_u32 s43, s38, 98304
buffer_load_dwordx4 v2, s[12:15], s43 offen lds
s_add_u32 m0, s40, 46080
s_add_u32 s43, s38, 147456
buffer_load_dwordx4 v3, s[12:15], s43 offen lds
s_add_u32 m0, s40, 47104
s_add_u32 s43, s38, 196608
buffer_load_dwordx4 v2, s[12:15], s43 offen lds
s_add_u32 m0, s40, 48128
s_add_u32 s43, s38, 245760
buffer_load_dwordx4 v3, s[12:15], s43 offen lds
s_add_u32 m0, s40, 49152
s_add_u32 s43, s38, 294912
buffer_load_dwordx4 v2, s[12:15], s43 offen lds
s_add_u32 m0, s40, 50176
s_add_u32 s43, s38, 344064
buffer_load_dwordx4 v3, s[12:15], s43 offen lds
s_add_u32 s37, s37, 128
s_add_u32 s38, s38, 393216
s_waitcnt vmcnt(14)
s_barrier
s_add_u32 m0, s39, 86016
s_mov_b64 exec, s[60:61]
buffer_load_dwordx4 v4, s[8:11], s37 offen lds
s_mov_b64 exec, -1
s_add_u32 m0, s39, 89088
s_nop 0
buffer_load_dwordx4 v5, s[8:11], s37 offen lds
s_add_u32 m0, s39, 92160
s_nop 0
buffer_load_dwordx4 v6, s[8:11], s37 offen lds
s_add_u32 m0, s39, 95232
s_nop 0
buffer_load_dwordx4 v7, s[8:11], s37 offen lds
s_add_u32 m0, s39, 98304
s_nop 0
buffer_load_dwordx4 v8, s[8:11], s37 offen lds
s_add_u32 m0, s39, 101376
s_nop 0
buffer_load_dwordx4 v9, s[8:11], s37 offen lds
s_add_u32 m0, s40, 86016
s_add_u32 s43, s38, 0
buffer_load_dwordx4 v2, s[12:15], s43 offen lds
s_add_u32 m0, s40, 87040
s_add_u32 s43, s38, 49152
buffer_load_dwordx4 v3, s[12:15], s43 offen lds
s_add_u32 m0, s40, 88064
s_add_u32 s43, s38, 98304
buffer_load_dwordx4 v2, s[12:15], s43 offen lds
s_add_u32 m0, s40, 89088
s_add_u32 s43, s38, 147456
buffer_load_dwordx4 v3, s[12:15], s43 offen lds
s_add_u32 m0, s40, 90112
s_add_u32 s43, s38, 196608
buffer_load_dwordx4 v2, s[12:15], s43 offen lds
s_add_u32 m0, s40, 91136
s_add_u32 s43, s38, 245760
buffer_load_dwordx4 v3, s[12:15], s43 offen lds
s_add_u32 m0, s40, 92160
s_add_u32 s43, s38, 294912
buffer_load_dwordx4 v2, s[12:15], s43 offen lds
s_add_u32 m0, s40, 93184
s_add_u32 s43, s38, 344064
buffer_load_dwordx4 v3, s[12:15], s43 offen lds
s_add_u32 s37, s37, 128
s_add_u32 s38, s38, 393216
s_lshl_b32 s43, s51, 11
buffer_load_dwordx4 v[96:99], v10, s[8:11], s43 offen offset:0
buffer_load_dwordx4 v[100:103], v10, s[8:11], s43 offen offset:1024
buffer_load_dwordx4 v[104:107], v10, s[8:11], s43 offen offset:2048
buffer_load_dwordx4 v[108:111], v10, s[8:11], s43 offen offset:3072
s_lshr_b32 s43, s2, 5
s_cmp_eq_u32 s43, 3
s_cbranch_scc1 Lsj_15
s_cmp_gt_u32 s43, 3
s_cselect_b32 s43, 32, 0
s_sub_u32 s43, s2, s43
s_lshr_b32 s43, s43, 1
s_and_b32 s44, s2, 1
s_lshl_b32 s44, s44, 3
s_add_u32 s44, s44, 32
s_load_dwordx2 s[80:81], s[0:1], s44
s_mul_i32 s45, s43, 2341
s_lshr_b32 s45, s45, 16
s_mul_i32 s46, s45, 28
s_sub_u32 s46, s43, s46
s_lshl_b32 s45, s45, 8
s_mul_i32 s44, s47, 18
s_add_u32 s45, s45, s44
s_add_u32 s45, s45, 184
s_mul_i32 s45, s45, 7168
s_lshl_b32 s46, s46, 8
s_add_u32 s45, s45, s46
s_waitcnt lgkmcnt(0)
s_add_u32 s80, s80, s45
s_addc_u32 s81, s81, 0
Lsj_15:
s_waitcnt vmcnt(18)
s_barrier
s_add_u32 m0, s39, 0
s_mov_b64 exec, s[60:61]
buffer_load_dwordx4 v4, s[8:11], s37 offen lds
s_mov_b64 exec, -1
s_add_u32 m0, s39, 3072
s_nop 0
buffer_load_dwordx4 v5, s[8:11], s37 offen lds
s_add_u32 m0, s39, 6144
s_nop 0
buffer_load_dwordx4 v6, s[8:11], s37 offen lds
s_add_u32 m0, s39, 9216
s_nop 0
buffer_load_dwordx4 v7, s[8:11], s37 offen lds
s_add_u32 m0, s39, 12288
s_nop 0
buffer_load_dwordx4 v8, s[8:11], s37 offen lds
s_add_u32 m0, s39, 15360
s_nop 0
buffer_load_dwordx4 v9, s[8:11], s37 offen lds
s_add_u32 m0, s40, 0
s_add_u32 s43, s38, 0
buffer_load_dwordx4 v2, s[12:15], s43 offen lds
s_add_u32 m0, s40, 1024
s_add_u32 s43, s38, 49152
buffer_load_dwordx4 v3, s[12:15], s43 offen lds
s_add_u32 m0, s40, 2048
s_add_u32 s43, s38, 98304
buffer_load_dwordx4 v2, s[12:15], s43 offen lds
s_add_u32 m0, s40, 3072
s_add_u32 s43, s38, 147456
buffer_load_dwordx4 v3, s[12:15], s43 offen lds
s_add_u32 m0, s40, 4096
s_add_u32 s43, s38, 196608
buffer_load_dwordx4 v2, s[12:15], s43 offen lds
s_add_u32 m0, s40, 5120
s_add_u32 s43, s38, 245760
buffer_load_dwordx4 v3, s[12:15], s43 offen lds
s_add_u32 m0, s40, 6144
s_add_u32 s43, s38, 294912
buffer_load_dwordx4 v2, s[12:15], s43 offen lds
s_add_u32 m0, s40, 7168
s_add_u32 s43, s38, 344064
buffer_load_dwordx4 v3, s[12:15], s43 offen lds
s_add_u32 s37, s37, 128
s_add_u32 s38, s38, 393216
s_waitcnt vmcnt(14)
s_barrier
s_add_u32 m0, s39, 43008
s_mov_b64 exec, s[60:61]
buffer_load_dwordx4 v4, s[8:11], s37 offen lds
s_mov_b64 exec, -1
s_add_u32 m0, s39, 46080
s_nop 0
buffer_load_dwordx4 v5, s[8:11], s37 offen lds
s_add_u32 m0, s39, 49152
s_nop 0
buffer_load_dwordx4 v6, s[8:11], s37 offen lds
s_add_u32 m0, s39, 52224
s_nop 0
buffer_load_dwordx4 v7, s[8:11], s37 offen lds
s_add_u32 m0, s39, 55296
s_nop 0
buffer_load_dwordx4 v8, s[8:11], s37 offen lds
s_add_u32 m0, s39, 58368
s_nop 0
buffer_load_dwordx4 v9, s[8:11], s37 offen lds
s_add_u32 m0, s40, 43008
s_add_u32 s43, s38, 0
buffer_load_dwordx4 v2, s[12:15], s43 offen lds
s_add_u32 m0, s40, 44032
s_add_u32 s43, s38, 49152
buffer_load_dwordx4 v3, s[12:15], s43 offen lds
s_add_u32 m0, s40, 45056
s_add_u32 s43, s38, 98304
buffer_load_dwordx4 v2, s[12:15], s43 offen lds
s_add_u32 m0, s40, 46080
s_add_u32 s43, s38, 147456
buffer_load_dwordx4 v3, s[12:15], s43 offen lds
s_add_u32 m0, s40, 47104
s_add_u32 s43, s38, 196608
buffer_load_dwordx4 v2, s[12:15], s43 offen lds
s_add_u32 m0, s40, 48128
s_add_u32 s43, s38, 245760
buffer_load_dwordx4 v3, s[12:15], s43 offen lds
s_add_u32 m0, s40, 49152
s_add_u32 s43, s38, 294912
buffer_load_dwordx4 v2, s[12:15], s43 offen lds
s_add_u32 m0, s40, 50176
s_add_u32 s43, s38, 344064
buffer_load_dwordx4 v3, s[12:15], s43 offen lds
s_add_u32 s37, s37, 128
s_add_u32 s38, s38, 393216
v_lshlrev_b32 v116, 16, v96
v_and_b32 v117, 0xffff0000, v96
v_mul_f32 v118, v116, v116
v_mul_f32 v119, v117, v117
v_lshlrev_b32 v126, 16, v97
v_and_b32 v127, 0xffff0000, v97
v_add_f32 v116, v116, v126
v_add_f32 v117, v117, v127
v_fmac_f32 v118, v126, v126
v_fmac_f32 v119, v127, v127
v_lshlrev_b32 v124, 16, v98
v_and_b32 v125, 0xffff0000, v98
v_add_f32 v116, v116, v124
v_add_f32 v117, v117, v125
v_fmac_f32 v118, v124, v124
v_fmac_f32 v119, v125, v125
v_lshlrev_b32 v126, 16, v99
v_and_b32 v127, 0xffff0000, v99
v_add_f32 v116, v116, v126
v_add_f32 v117, v117, v127
v_fmac_f32 v118, v126, v126
v_fmac_f32 v119, v127, v127
v_lshlrev_b32 v124, 16, v100
v_and_b32 v125, 0xffff0000, v100
v_add_f32 v116, v116, v124
v_add_f32 v117, v117, v125
v_fmac_f32 v118, v124, v124
v_fmac_f32 v119, v125, v125
v_lshlrev_b32 v126, 16, v101
v_and_b32 v127, 0xffff0000, v101
v_add_f32 v116, v116, v126
v_add_f32 v117, v117, v127
v_fmac_f32 v118, v126, v126
v_fmac_f32 v119, v127, v127
v_lshlrev_b32 v124, 16, v102
v_and_b32 v125, 0xffff0000, v102
v_add_f32 v116, v116, v124
v_add_f32 v117, v117, v125
v_fmac_f32 v118, v124, v124
v_fmac_f32 v119, v125, v125
v_lshlrev_b32 v126, 16, v103
v_and_b32 v127, 0xffff0000, v103
v_add_f32 v116, v116, v126
v_add_f32 v117, v117, v127
v_fmac_f32 v118, v126, v126
v_fmac_f32 v119, v127, v127
v_lshlrev_b32 v120, 16, v104
v_and_b32 v121, 0xffff0000, v104
v_mul_f32 v122, v120, v120
v_mul_f32 v123, v121, v121
s_waitcnt vmcnt(14)
s_barrier
s_add_u32 m0, s39, 86016
s_mov_b64 exec, s[60:61]
buffer_load_dwordx4 v4, s[8:11], s37 offen lds
s_mov_b64 exec, -1
s_add_u32 m0, s39, 89088
s_nop 0
buffer_load_dwordx4 v5, s[8:11], s37 offen lds
s_add_u32 m0, s39, 92160
s_nop 0
buffer_load_dwordx4 v6, s[8:11], s37 offen lds
s_add_u32 m0, s39, 95232
s_nop 0
buffer_load_dwordx4 v7, s[8:11], s37 offen lds
s_add_u32 m0, s39, 98304
s_nop 0
buffer_load_dwordx4 v8, s[8:11], s37 offen lds
s_add_u32 m0, s39, 101376
s_nop 0
buffer_load_dwordx4 v9, s[8:11], s37 offen lds
s_add_u32 m0, s40, 86016
s_add_u32 s43, s38, 0
buffer_load_dwordx4 v2, s[12:15], s43 offen lds
s_add_u32 m0, s40, 87040
s_add_u32 s43, s38, 49152
buffer_load_dwordx4 v3, s[12:15], s43 offen lds
s_add_u32 m0, s40, 88064
s_add_u32 s43, s38, 98304
buffer_load_dwordx4 v2, s[12:15], s43 offen lds
s_add_u32 m0, s40, 89088
s_add_u32 s43, s38, 147456
buffer_load_dwordx4 v3, s[12:15], s43 offen lds
s_add_u32 m0, s40, 90112
s_add_u32 s43, s38, 196608
buffer_load_dwordx4 v2, s[12:15], s43 offen lds
s_add_u32 m0, s40, 91136
s_add_u32 s43, s38, 245760
buffer_load_dwordx4 v3, s[12:15], s43 offen lds
s_add_u32 m0, s40, 92160
s_add_u32 s43, s38, 294912
buffer_load_dwordx4 v2, s[12:15], s43 offen lds
s_add_u32 m0, s40, 93184
s_add_u32 s43, s38, 344064
buffer_load_dwordx4 v3, s[12:15], s43 offen lds
s_add_u32 s37, s37, 128
s_add_u32 s38, s38, 393216
v_lshlrev_b32 v126, 16, v105
v_and_b32 v127, 0xffff0000, v105
v_add_f32 v120, v120, v126
v_add_f32 v121, v121, v127
v_fmac_f32 v122, v126, v126
v_fmac_f32 v123, v127, v127
v_lshlrev_b32 v124, 16, v106
v_and_b32 v125, 0xffff0000, v106
v_add_f32 v120, v120, v124
v_add_f32 v121, v121, v125
v_fmac_f32 v122, v124, v124
v_fmac_f32 v123, v125, v125
v_lshlrev_b32 v126, 16, v107
v_and_b32 v127, 0xffff0000, v107
v_add_f32 v120, v120, v126
v_add_f32 v121, v121, v127
v_fmac_f32 v122, v126, v126
v_fmac_f32 v123, v127, v127
v_lshlrev_b32 v124, 16, v108
v_and_b32 v125, 0xffff0000, v108
v_add_f32 v120, v120, v124
v_add_f32 v121, v121, v125
v_fmac_f32 v122, v124, v124
v_fmac_f32 v123, v125, v125
v_lshlrev_b32 v126, 16, v109
v_and_b32 v127, 0xffff0000, v109
v_add_f32 v120, v120, v126
v_add_f32 v121, v121, v127
v_fmac_f32 v122, v126, v126
v_fmac_f32 v123, v127, v127
v_lshlrev_b32 v124, 16, v110
v_and_b32 v125, 0xffff0000, v110
v_add_f32 v120, v120, v124
v_add_f32 v121, v121, v125
v_fmac_f32 v122, v124, v124
v_fmac_f32 v123, v125, v125
v_lshlrev_b32 v126, 16, v111
v_and_b32 v127, 0xffff0000, v111
v_add_f32 v120, v120, v126
v_add_f32 v121, v121, v127
v_fmac_f32 v122, v126, v126
v_fmac_f32 v123, v127, v127
v_add_f32 v116, v116, v117
v_add_f32 v118, v118, v119
v_add_f32 v120, v120, v121
v_add_f32 v122, v122, v123
v_add_f32_dpp v116, v116, v116 row_ror:8 row_mask:0xf bank_mask:0xf
v_add_f32_dpp v118, v118, v118 row_ror:8 row_mask:0xf bank_mask:0xf
v_add_f32_dpp v120, v120, v120 row_ror:8 row_mask:0xf bank_mask:0xf
v_add_f32_dpp v122, v122, v122 row_ror:8 row_mask:0xf bank_mask:0xf
s_waitcnt vmcnt(14)
s_barrier
s_add_u32 m0, s39, 0
s_mov_b64 exec, s[60:61]
buffer_load_dwordx4 v4, s[8:11], s37 offen lds
s_mov_b64 exec, -1
s_add_u32 m0, s39, 3072
s_nop 0
buffer_load_dwordx4 v5, s[8:11], s37 offen lds
s_add_u32 m0, s39, 6144
s_nop 0
buffer_load_dwordx4 v6, s[8:11], s37 offen lds
s_add_u32 m0, s39, 9216
s_nop 0
buffer_load_dwordx4 v7, s[8:11], s37 offen lds
s_add_u32 m0, s39, 12288
s_nop 0
buffer_load_dwordx4 v8, s[8:11], s37 offen lds
s_add_u32 m0, s39, 15360
s_nop 0
buffer_load_dwordx4 v9, s[8:11], s37 offen lds
s_add_u32 m0, s40, 0
s_add_u32 s43, s38, 0
buffer_load_dwordx4 v2, s[12:15], s43 offen lds
s_add_u32 m0, s40, 1024
s_add_u32 s43, s38, 49152
buffer_load_dwordx4 v3, s[12:15], s43 offen lds
s_add_u32 m0, s40, 2048
s_add_u32 s43, s38, 98304
buffer_load_dwordx4 v2, s[12:15], s43 offen lds
s_add_u32 m0, s40, 3072
s_add_u32 s43, s38, 147456
buffer_load_dwordx4 v3, s[12:15], s43 offen lds
s_add_u32 m0, s40, 4096
s_add_u32 s43, s38, 196608
buffer_load_dwordx4 v2, s[12:15], s43 offen lds
s_add_u32 m0, s40, 5120
s_add_u32 s43, s38, 245760
buffer_load_dwordx4 v3, s[12:15], s43 offen lds
s_add_u32 m0, s40, 6144
s_add_u32 s43, s38, 294912
buffer_load_dwordx4 v2, s[12:15], s43 offen lds
s_add_u32 m0, s40, 7168
s_add_u32 s43, s38, 344064
buffer_load_dwordx4 v3, s[12:15], s43 offen lds
s_add_u32 s37, s37, 128
s_add_u32 s38, s38, 393216
v_add_f32_dpp v116, v116, v116 row_ror:4 row_mask:0xf bank_mask:0xf
v_add_f32_dpp v118, v118, v118 row_ror:4 row_mask:0xf bank_mask:0xf
v_add_f32_dpp v120, v120, v120 row_ror:4 row_mask:0xf bank_mask:0xf
v_add_f32_dpp v122, v122, v122 row_ror:4 row_mask:0xf bank_mask:0xf
v_add_f32_dpp v116, v116, v116 row_ror:2 row_mask:0xf bank_mask:0xf
v_add_f32_dpp v118, v118, v118 row_ror:2 row_mask:0xf bank_mask:0xf
v_add_f32_dpp v120, v120, v120 row_ror:2 row_mask:0xf bank_mask:0xf
v_add_f32_dpp v122, v122, v122 row_ror:2 row_mask:0xf bank_mask:0xf
v_add_f32_dpp v116, v116, v116 row_ror:1 row_mask:0xf bank_mask:0xf
v_add_f32_dpp v118, v118, v118 row_ror:1 row_mask:0xf bank_mask:0xf
v_add_f32_dpp v120, v120, v120 row_ror:1 row_mask:0xf bank_mask:0xf
v_add_f32_dpp v122, v122, v122 row_ror:1 row_mask:0xf bank_mask:0xf
v_mov_b32 v117, v116
v_mov_b32 v119, v118
v_mov_b32 v121, v120
v_mov_b32 v123, v122
s_nop 0
v_permlane16_swap_b32 v116, v117
v_permlane16_swap_b32 v118, v119
v_permlane16_swap_b32 v120, v121
v_permlane16_swap_b32 v122, v123
v_add_f32 v116, v116, v117
v_add_f32 v118, v118, v119
v_add_f32 v120, v120, v121
v_add_f32 v122, v122, v123
v_mov_b32 v117, v116
v_mov_b32 v119, v118
v_mov_b32 v121, v120
v_mov_b32 v123, v122
s_nop 0
v_permlane32_swap_b32 v116, v117
v_permlane32_swap_b32 v118, v119
v_permlane32_swap_b32 v120, v121
v_permlane32_swap_b32 v122, v123
v_add_f32 v116, v116, v117
v_add_f32 v118, v118, v119
v_add_f32 v120, v120, v121
v_add_f32 v122, v122, v123
v_mul_f32 v112, 0x3a800000, v116
v_mul_f32 v113, 0x3a800000, v118
v_fma_f32 v113, -v112, v112, v113
v_max_f32 v113, 0, v113
v_add_f32 v113, 0x3727c5ac, v113
v_rsq_f32 v113, v113
v_mul_f32 v114, 0x3a800000, v120
v_mul_f32 v115, 0x3a800000, v122
v_fma_f32 v115, -v114, v114, v115
v_max_f32 v115, 0, v115
v_add_f32 v115, 0x3727c5ac, v115
v_rsq_f32 v115, v115
s_nop 0
s_lshl_b32 s43, s47, 4
s_add_u32 s43, s43, 130176
v_mov_b32 v11, s43
ds_write_b128 v11, v[112:115]
s_waitcnt lgkmcnt(0)
s_load_dword s64, s[80:81], 0
s_load_dword s65, s[80:81], 64
s_load_dword s66, s[80:81], 128
s_load_dword s67, s[80:81], 192
s_load_dword s68, s[80:81], 7168
s_load_dword s69, s[80:81], 7232
s_load_dword s70, s[80:81], 7296
s_load_dword s71, s[80:81], 7360
s_add_u32 s80, s80, 14336
s_addc_u32 s81, s81, 0
s_waitcnt vmcnt(14)
s_barrier
s_add_u32 m0, s39, 43008
s_mov_b64 exec, s[60:61]
buffer_load_dwordx4 v4, s[8:11], s37 offen lds
s_mov_b64 exec, -1
s_add_u32 m0, s39, 46080
s_nop 0
buffer_load_dwordx4 v5, s[8:11], s37 offen lds
s_add_u32 m0, s39, 49152
s_nop 0
buffer_load_dwordx4 v6, s[8:11], s37 offen lds
s_add_u32 m0, s39, 52224
s_nop 0
buffer_load_dwordx4 v7, s[8:11], s37 offen lds
s_add_u32 m0, s39, 55296
s_nop 0
buffer_load_dwordx4 v8, s[8:11], s37 offen lds
s_add_u32 m0, s39, 58368
s_nop 0
buffer_load_dwordx4 v9, s[8:11], s37 offen lds
s_add_u32 m0, s40, 43008
s_add_u32 s43, s38, 0
buffer_load_dwordx4 v2, s[12:15], s43 offen lds
s_add_u32 m0, s40, 44032
s_add_u32 s43, s38, 49152
buffer_load_dwordx4 v3, s[12:15], s43 offen lds
s_add_u32 m0, s40, 45056
s_add_u32 s43, s38, 98304
buffer_load_dwordx4 v2, s[12:15], s43 offen lds
s_add_u32 m0, s40, 46080
s_add_u32 s43, s38, 147456
buffer_load_dwordx4 v3, s[12:15], s43 offen lds
s_add_u32 m0, s40, 47104
s_add_u32 s43, s38, 196608
buffer_load_dwordx4 v2, s[12:15], s43 offen lds
s_add_u32 m0, s40, 48128
s_add_u32 s43, s38, 245760
buffer_load_dwordx4 v3, s[12:15], s43 offen lds
s_add_u32 m0, s40, 49152
s_add_u32 s43, s38, 294912
buffer_load_dwordx4 v2, s[12:15], s43 offen lds
s_add_u32 m0, s40, 50176
s_add_u32 s43, s38, 344064
buffer_load_dwordx4 v3, s[12:15], s43 offen lds
s_add_u32 s37, s37, 128
s_add_u32 s38, s38, 393216
s_load_dword s64, s[80:81], 0
s_load_dword s65, s[80:81], 64
s_load_dword s66, s[80:81], 128
s_load_dword s67, s[80:81], 192
s_load_dword s68, s[80:81], 7168
s_load_dword s69, s[80:81], 7232
s_load_dword s70, s[80:81], 7296
s_load_dword s71, s[80:81], 7360
s_add_u32 s80, s80, 14336
s_addc_u32 s81, s81, 0
s_waitcnt vmcnt(14)
s_barrier
s_add_u32 m0, s39, 86016
s_mov_b64 exec, s[60:61]
buffer_load_dwordx4 v4, s[8:11], s37 offen lds
s_mov_b64 exec, -1
s_add_u32 m0, s39, 89088
s_nop 0
buffer_load_dwordx4 v5, s[8:11], s37 offen lds
s_add_u32 m0, s39, 92160
s_nop 0
buffer_load_dwordx4 v6, s[8:11], s37 offen lds
s_add_u32 m0, s39, 95232
s_nop 0
buffer_load_dwordx4 v7, s[8:11], s37 offen lds
s_add_u32 m0, s39, 98304
s_nop 0
buffer_load_dwordx4 v8, s[8:11], s37 offen lds
s_add_u32 m0, s39, 101376
s_nop 0
buffer_load_dwordx4 v9, s[8:11], s37 offen lds
s_add_u32 m0, s40, 86016
s_add_u32 s43, s38, 0
buffer_load_dwordx4 v2, s[12:15], s43 offen lds
s_add_u32 m0, s40, 87040
s_add_u32 s43, s38, 49152
buffer_load_dwordx4 v3, s[12:15], s43 offen lds
s_add_u32 m0, s40, 88064
s_add_u32 s43, s38, 98304
buffer_load_dwordx4 v2, s[12:15], s43 offen lds
s_add_u32 m0, s40, 89088
s_add_u32 s43, s38, 147456
buffer_load_dwordx4 v3, s[12:15], s43 offen lds
s_add_u32 m0, s40, 90112
s_add_u32 s43, s38, 196608
buffer_load_dwordx4 v2, s[12:15], s43 offen lds
s_add_u32 m0, s40, 91136
s_add_u32 s43, s38, 245760
buffer_load_dwordx4 v3, s[12:15], s43 offen lds
s_add_u32 m0, s40, 92160
s_add_u32 s43, s38, 294912
buffer_load_dwordx4 v2, s[12:15], s43 offen lds
s_add_u32 m0, s40, 93184
s_add_u32 s43, s38, 344064
buffer_load_dwordx4 v3, s[12:15], s43 offen lds
s_add_u32 s37, s37, 128
s_add_u32 s38, s38, 393216
v_mov_b32 v128, -1
v_mov_b32 v129, -1
v_mov_b32 v130, -1
v_mov_b32 v131, -1
s_add_u32 s24, s16, 4194304
s_addc_u32 s25, s17, 0
s_mov_b32 s26, 16384
s_mov_b32 s27, 0x20000
s_mul_i32 s28, s47, 5120
buffer_store_dwordx4 v[128:131], v10, s[24:27], s28 offen sc1
s_add_u32 s28, s28, 1024
s_load_dword s64, s[80:81], 0
s_load_dword s65, s[80:81], 64
s_load_dword s66, s[80:81], 128
s_load_dword s67, s[80:81], 192
s_load_dword s68, s[80:81], 7168
s_load_dword s69, s[80:81], 7232
s_load_dword s70, s[80:81], 7296
s_load_dword s71, s[80:81], 7360
s_add_u32 s80, s80, 14336
s_addc_u32 s81, s81, 0
s_waitcnt vmcnt(15)
s_barrier
s_add_u32 m0, s39, 0
s_mov_b64 exec, s[60:61]
buffer_load_dwordx4 v4, s[8:11], s37 offen lds
s_mov_b64 exec, -1
s_add_u32 m0, s39, 3072
s_nop 0
buffer_load_dwordx4 v5, s[8:11], s37 offen lds
s_add_u32 m0, s39, 6144
s_nop 0
buffer_load_dwordx4 v6, s[8:11], s37 offen lds
s_add_u32 m0, s39, 9216
s_nop 0
buffer_load_dwordx4 v7, s[8:11], s37 offen lds
s_add_u32 m0, s39, 12288
s_nop 0
buffer_load_dwordx4 v8, s[8:11], s37 offen lds
s_add_u32 m0, s39, 15360
s_nop 0
buffer_load_dwordx4 v9, s[8:11], s37 offen lds
s_add_u32 m0, s40, 0
s_add_u32 s43, s38, 0
buffer_load_dwordx4 v2, s[12:15], s43 offen lds
s_add_u32 m0, s40, 1024
s_add_u32 s43, s38, 49152
buffer_load_dwordx4 v3, s[12:15], s43 offen lds
s_add_u32 m0, s40, 2048
s_add_u32 s43, s38, 98304
buffer_load_dwordx4 v2, s[12:15], s43 offen lds
s_add_u32 m0, s40, 3072
s_add_u32 s43, s38, 147456
buffer_load_dwordx4 v3, s[12:15], s43 offen lds
s_add_u32 m0, s40, 4096
s_add_u32 s43, s38, 196608
buffer_load_dwordx4 v2, s[12:15], s43 offen lds
s_add_u32 m0, s40, 5120
s_add_u32 s43, s38, 245760
buffer_load_dwordx4 v3, s[12:15], s43 offen lds
s_add_u32 m0, s40, 6144
s_add_u32 s43, s38, 294912
buffer_load_dwordx4 v2, s[12:15], s43 offen lds
s_add_u32 m0, s40, 7168
s_add_u32 s43, s38, 344064
buffer_load_dwordx4 v3, s[12:15], s43 offen lds
s_add_u32 s37, s37, 128
s_add_u32 s38, s38, 393216
buffer_store_dwordx4 v[128:131], v10, s[24:27], s28 offen sc1
s_add_u32 s28, s28, 1024
s_load_dword s64, s[80:81], 0
s_load_dword s65, s[80:81], 64
s_load_dword s66, s[80:81], 128
s_load_dword s67, s[80:81], 192
s_load_dword s68, s[80:81], 7168
s_load_dword s69, s[80:81], 7232
s_load_dword s70, s[80:81], 7296
s_load_dword s71, s[80:81], 7360
s_add_u32 s80, s80, 14336
s_addc_u32 s81, s81, 0
s_waitcnt vmcnt(16)
s_barrier
s_add_u32 m0, s39, 43008
s_mov_b64 exec, s[60:61]
buffer_load_dwordx4 v4, s[8:11], s37 offen lds
s_mov_b64 exec, -1
s_add_u32 m0, s39, 46080
s_nop 0
buffer_load_dwordx4 v5, s[8:11], s37 offen lds
s_add_u32 m0, s39, 49152
s_nop 0
buffer_load_dwordx4 v6, s[8:11], s37 offen lds
s_add_u32 m0, s39, 52224
s_nop 0
buffer_load_dwordx4 v7, s[8:11], s37 offen lds
s_add_u32 m0, s39, 55296
s_nop 0
buffer_load_dwordx4 v8, s[8:11], s37 offen lds
s_add_u32 m0, s39, 58368
s_nop 0
buffer_load_dwordx4 v9, s[8:11], s37 offen lds
s_add_u32 m0, s40, 43008
s_add_u32 s43, s38, 0
buffer_load_dwordx4 v2, s[12:15], s43 offen lds
s_add_u32 m0, s40, 44032
s_add_u32 s43, s38, 49152
buffer_load_dwordx4 v3, s[12:15], s43 offen lds
s_add_u32 m0, s40, 45056
s_add_u32 s43, s38, 98304
buffer_load_dwordx4 v2, s[12:15], s43 offen lds
s_add_u32 m0, s40, 46080
s_add_u32 s43, s38, 147456
buffer_load_dwordx4 v3, s[12:15], s43 offen lds
s_add_u32 m0, s40, 47104
s_add_u32 s43, s38, 196608
buffer_load_dwordx4 v2, s[12:15], s43 offen lds
s_add_u32 m0, s40, 48128
s_add_u32 s43, s38, 245760
buffer_load_dwordx4 v3, s[12:15], s43 offen lds
s_add_u32 m0, s40, 49152
s_add_u32 s43, s38, 294912
buffer_load_dwordx4 v2, s[12:15], s43 offen lds
s_add_u32 m0, s40, 50176
s_add_u32 s43, s38, 344064
buffer_load_dwordx4 v3, s[12:15], s43 offen lds
s_add_u32 s37, s37, 128
s_add_u32 s38, s38, 393216
buffer_store_dwordx4 v[128:131], v10, s[24:27], s28 offen sc1
s_add_u32 s28, s28, 1024
s_load_dword s64, s[80:81], 0
s_load_dword s65, s[80:81], 64
s_load_dword s66, s[80:81], 128
s_load_dword s67, s[80:81], 192
s_load_dword s68, s[80:81], 7168
s_load_dword s69, s[80:81], 7232
s_load_dword s70, s[80:81], 7296
s_load_dword s71, s[80:81], 7360
s_add_u32 s80, s80, 14336
s_addc_u32 s81, s81, 0
s_waitcnt vmcnt(16)
s_barrier
s_add_u32 m0, s39, 86016
s_mov_b64 exec, s[60:61]
buffer_load_dwordx4 v4, s[8:11], s37 offen lds
s_mov_b64 exec, -1
s_add_u32 m0, s39, 89088
s_nop 0
buffer_load_dwordx4 v5, s[8:11], s37 offen lds
s_add_u32 m0, s39, 92160
s_nop 0
buffer_load_dwordx4 v6, s[8:11], s37 offen lds
s_add_u32 m0, s39, 95232
s_nop 0
buffer_load_dwordx4 v7, s[8:11], s37 offen lds
s_add_u32 m0, s39, 98304
s_nop 0
buffer_load_dwordx4 v8, s[8:11], s37 offen lds
s_add_u32 m0, s39, 101376
s_nop 0
buffer_load_dwordx4 v9, s[8:11], s37 offen lds
s_add_u32 m0, s40, 86016
s_add_u32 s43, s38, 0
buffer_load_dwordx4 v2, s[12:15], s43 offen lds
s_add_u32 m0, s40, 87040
s_add_u32 s43, s38, 49152
buffer_load_dwordx4 v3, s[12:15], s43 offen lds
s_add_u32 m0, s40, 88064
s_add_u32 s43, s38, 98304
buffer_load_dwordx4 v2, s[12:15], s43 offen lds
s_add_u32 m0, s40, 89088
s_add_u32 s43, s38, 147456
buffer_load_dwordx4 v3, s[12:15], s43 offen lds
s_add_u32 m0, s40, 90112
s_add_u32 s43, s38, 196608
buffer_load_dwordx4 v2, s[12:15], s43 offen lds
s_add_u32 m0, s40, 91136
s_add_u32 s43, s38, 245760
buffer_load_dwordx4 v3, s[12:15], s43 offen lds
s_add_u32 m0, s40, 92160
s_add_u32 s43, s38, 294912
buffer_load_dwordx4 v2, s[12:15], s43 offen lds
s_add_u32 m0, s40, 93184
s_add_u32 s43, s38, 344064
buffer_load_dwordx4 v3, s[12:15], s43 offen lds
s_add_u32 s37, s37, 128
s_add_u32 s38, s38, 393216
buffer_store_dwordx4 v[128:131], v10, s[24:27], s28 offen sc1
s_add_u32 s28, s28, 1024
s_load_dword s64, s[80:81], 0
s_load_dword s65, s[80:81], 64
s_load_dword s66, s[80:81], 128
s_load_dword s67, s[80:81], 192
s_load_dword s68, s[80:81], 7168
s_load_dword s69, s[80:81], 7232
s_load_dword s70, s[80:81], 7296
s_load_dword s71, s[80:81], 7360
s_add_u32 s80, s80, 14336
s_addc_u32 s81, s81, 0
s_waitcnt vmcnt(16)
s_barrier
s_add_u32 m0, s39, 0
s_mov_b64 exec, s[60:61]
buffer_load_dwordx4 v4, s[8:11], s37 offen lds
s_mov_b64 exec, -1
s_add_u32 m0, s39, 3072
s_nop 0
buffer_load_dwordx4 v5, s[8:11], s37 offen lds
s_add_u32 m0, s39, 6144
s_nop 0
buffer_load_dwordx4 v6, s[8:11], s37 offen lds
s_add_u32 m0, s39, 9216
s_nop 0
buffer_load_dwordx4 v7, s[8:11], s37 offen lds
s_add_u32 m0, s39, 12288
s_nop 0
buffer_load_dwordx4 v8, s[8:11], s37 offen lds
s_add_u32 m0, s39, 15360
s_nop 0
buffer_load_dwordx4 v9, s[8:11], s37 offen lds
s_add_u32 m0, s40, 0
s_add_u32 s43, s38, 0
buffer_load_dwordx4 v2, s[12:15], s43 offen lds
s_add_u32 m0, s40, 1024
s_add_u32 s43, s38, 49152
buffer_load_dwordx4 v3, s[12:15], s43 offen lds
s_add_u32 m0, s40, 2048
s_add_u32 s43, s38, 98304
buffer_load_dwordx4 v2, s[12:15], s43 offen lds
s_add_u32 m0, s40, 3072
s_add_u32 s43, s38, 147456
buffer_load_dwordx4 v3, s[12:15], s43 offen lds
s_add_u32 m0, s40, 4096
s_add_u32 s43, s38, 196608
buffer_load_dwordx4 v2, s[12:15], s43 offen lds
s_add_u32 m0, s40, 5120
s_add_u32 s43, s38, 245760
buffer_load_dwordx4 v3, s[12:15], s43 offen lds
s_add_u32 m0, s40, 6144
s_add_u32 s43, s38, 294912
buffer_load_dwordx4 v2, s[12:15], s43 offen lds
s_add_u32 m0, s40, 7168
s_add_u32 s43, s38, 344064
buffer_load_dwordx4 v3, s[12:15], s43 offen lds
s_add_u32 s37, s37, 128
s_add_u32 s38, s38, 393216
buffer_store_dwordx4 v[128:131], v10, s[24:27], s28 offen sc1
s_add_u32 s28, s28, 1024
s_load_dword s64, s[80:81], 0
s_load_dword s65, s[80:81], 64
s_load_dword s66, s[80:81], 128
s_load_dword s67, s[80:81], 192
s_load_dword s68, s[80:81], 7168
s_load_dword s69, s[80:81], 7232
s_load_dword s70, s[80:81], 7296
s_load_dword s71, s[80:81], 7360
s_add_u32 s80, s80, 14336
s_addc_u32 s81, s81, 0
s_waitcnt vmcnt(16)
s_barrier
s_add_u32 m0, s39, 43008
s_mov_b64 exec, s[60:61]
buffer_load_dwordx4 v4, s[8:11], s37 offen lds
s_mov_b64 exec, -1
s_add_u32 m0, s39, 46080
s_nop 0
buffer_load_dwordx4 v5, s[8:11], s37 offen lds
s_add_u32 m0, s39, 49152
s_nop 0
buffer_load_dwordx4 v6, s[8:11], s37 offen lds
s_add_u32 m0, s39, 52224
s_nop 0
buffer_load_dwordx4 v7, s[8:11], s37 offen lds
s_add_u32 m0, s39, 55296
s_nop 0
buffer_load_dwordx4 v8, s[8:11], s37 offen lds
s_add_u32 m0, s39, 58368
s_nop 0
buffer_load_dwordx4 v9, s[8:11], s37 offen lds
s_add_u32 m0, s40, 43008
s_add_u32 s43, s38, 0
buffer_load_dwordx4 v2, s[12:15], s43 offen lds
s_add_u32 m0, s40, 44032
s_add_u32 s43, s38, 49152
buffer_load_dwordx4 v3, s[12:15], s43 offen lds
s_add_u32 m0, s40, 45056
s_add_u32 s43, s38, 98304
buffer_load_dwordx4 v2, s[12:15], s43 offen lds
s_add_u32 m0, s40, 46080
s_add_u32 s43, s38, 147456
buffer_load_dwordx4 v3, s[12:15], s43 offen lds
s_add_u32 m0, s40, 47104
s_add_u32 s43, s38, 196608
buffer_load_dwordx4 v2, s[12:15], s43 offen lds
s_add_u32 m0, s40, 48128
s_add_u32 s43, s38, 245760
buffer_load_dwordx4 v3, s[12:15], s43 offen lds
s_add_u32 m0, s40, 49152
s_add_u32 s43, s38, 294912
buffer_load_dwordx4 v2, s[12:15], s43 offen lds
s_add_u32 m0, s40, 50176
s_add_u32 s43, s38, 344064
buffer_load_dwordx4 v3, s[12:15], s43 offen lds
s_add_u32 s37, s37, 128
s_add_u32 s38, s38, 393216
buffer_store_dwordx4 v[128:131], v10, s[24:27], s28 offen sc1
s_add_u32 s28, s28, 1024
s_load_dword s64, s[80:81], 0
s_load_dword s65, s[80:81], 64
s_load_dword s66, s[80:81], 128
s_load_dword s67, s[80:81], 192
s_load_dword s68, s[80:81], 7168
s_load_dword s69, s[80:81], 7232
s_load_dword s70, s[80:81], 7296
s_load_dword s71, s[80:81], 7360
s_add_u32 s80, s80, 14336
s_addc_u32 s81, s81, 0
s_waitcnt vmcnt(16)
s_barrier
s_add_u32 m0, s39, 86016
s_mov_b64 exec, s[60:61]
buffer_load_dwordx4 v4, s[8:11], s37 offen lds
s_mov_b64 exec, -1
s_add_u32 m0, s39, 89088
s_nop 0
buffer_load_dwordx4 v5, s[8:11], s37 offen lds
s_add_u32 m0, s39, 92160
s_nop 0
buffer_load_dwordx4 v6, s[8:11], s37 offen lds
s_add_u32 m0, s39, 95232
s_nop 0
buffer_load_dwordx4 v7, s[8:11], s37 offen lds
s_add_u32 m0, s39, 98304
s_nop 0
buffer_load_dwordx4 v8, s[8:11], s37 offen lds
s_add_u32 m0, s39, 101376
s_nop 0
buffer_load_dwordx4 v9, s[8:11], s37 offen lds
s_add_u32 m0, s40, 86016
s_add_u32 s43, s38, 0
buffer_load_dwordx4 v2, s[12:15], s43 offen lds
s_add_u32 m0, s40, 87040
s_add_u32 s43, s38, 49152
buffer_load_dwordx4 v3, s[12:15], s43 offen lds
s_add_u32 m0, s40, 88064
s_add_u32 s43, s38, 98304
buffer_load_dwordx4 v2, s[12:15], s43 offen lds
s_add_u32 m0, s40, 89088
s_add_u32 s43, s38, 147456
buffer_load_dwordx4 v3, s[12:15], s43 offen lds
s_add_u32 m0, s40, 90112
s_add_u32 s43, s38, 196608
buffer_load_dwordx4 v2, s[12:15], s43 offen lds
s_add_u32 m0, s40, 91136
s_add_u32 s43, s38, 245760
buffer_load_dwordx4 v3, s[12:15], s43 offen lds
s_add_u32 m0, s40, 92160
s_add_u32 s43, s38, 294912
buffer_load_dwordx4 v2, s[12:15], s43 offen lds
s_add_u32 m0, s40, 93184
s_add_u32 s43, s38, 344064
buffer_load_dwordx4 v3, s[12:15], s43 offen lds
s_add_u32 s37, s37, 128
s_add_u32 s38, s38, 393216
s_load_dword s64, s[80:81], 0
s_load_dword s65, s[80:81], 64
s_load_dword s66, s[80:81], 128
s_load_dword s67, s[80:81], 192
s_load_dword s68, s[80:81], 7168
s_load_dword s69, s[80:81], 7232
s_load_dword s70, s[80:81], 7296
s_load_dword s71, s[80:81], 7360
s_add_u32 s80, s80, 14336
s_addc_u32 s81, s81, 0
s_waitcnt vmcnt(15)
s_barrier
s_add_u32 m0, s39, 0
s_mov_b64 exec, s[60:61]
buffer_load_dwordx4 v4, s[8:11], s37 offen lds
s_mov_b64 exec, -1
s_add_u32 m0, s39, 3072
s_nop 0
buffer_load_dwordx4 v5, s[8:11], s37 offen lds
s_add_u32 m0, s39, 6144
s_nop 0
buffer_load_dwordx4 v6, s[8:11], s37 offen lds
s_add_u32 m0, s39, 9216
s_nop 0
buffer_load_dwordx4 v7, s[8:11], s37 offen lds
s_add_u32 m0, s39, 12288
s_nop 0
buffer_load_dwordx4 v8, s[8:11], s37 offen lds
s_add_u32 m0, s39, 15360
s_nop 0
buffer_load_dwordx4 v9, s[8:11], s37 offen lds
s_add_u32 m0, s40, 0
s_add_u32 s43, s38, 0
buffer_load_dwordx4 v2, s[12:15], s43 offen lds
s_add_u32 m0, s40, 1024
s_add_u32 s43, s38, 49152
buffer_load_dwordx4 v3, s[12:15], s43 offen lds
s_add_u32 m0, s40, 2048
s_add_u32 s43, s38, 98304
buffer_load_dwordx4 v2, s[12:15], s43 offen lds
s_add_u32 m0, s40, 3072
s_add_u32 s43, s38, 147456
buffer_load_dwordx4 v3, s[12:15], s43 offen lds
s_add_u32 m0, s40, 4096
s_add_u32 s43, s38, 196608
buffer_load_dwordx4 v2, s[12:15], s43 offen lds
s_add_u32 m0, s40, 5120
s_add_u32 s43, s38, 245760
buffer_load_dwordx4 v3, s[12:15], s43 offen lds
s_add_u32 m0, s40, 6144
s_add_u32 s43, s38, 294912
buffer_load_dwordx4 v2, s[12:15], s43 offen lds
s_add_u32 m0, s40, 7168
s_add_u32 s43, s38, 344064
buffer_load_dwordx4 v3, s[12:15], s43 offen lds
s_add_u32 s37, s37, 128
s_add_u32 s38, s38, 393216
s_waitcnt vmcnt(14)
s_barrier
s_waitcnt vmcnt(0)
s_barrier
s_barrier
s_cmp_eq_u32 s47, 0
s_cbranch_scc1 Lx_16
s_cmp_eq_u32 s47, 1
s_cbranch_scc1 Lx_17
s_branch Lw_19
Lr_20:
s_branch Lx_18
Lx_17:
s_branch Lw_21
Lr_22:
s_branch Lx_18
Lx_16:
s_branch Lw_23
Lr_24:
Lx_18:
s_waitcnt lgkmcnt(0)
s_and_b32 s43, s36, 1
s_lshr_b32 s44, s36, 1
s_and_b32 s44, s44, 1
s_lshr_b32 s45, s36, 2
v_lshlrev_b32 v14, 2, v13
v_sub_u32 v14, v12, v14
v_subrev_u32 v15, 0, v14
v_cmp_ge_u32 s[52:53], 7, v15
v_add_u32 v15, 16, v15
v_cmp_ge_u32 s[84:85], 7, v15
v_subrev_u32 v15, 1, v14
v_cmp_ge_u32 s[54:55], 7, v15
v_add_u32 v15, 16, v15
v_cmp_ge_u32 s[86:87], 7, v15
v_subrev_u32 v15, 2, v14
v_cmp_ge_u32 s[56:57], 7, v15
v_add_u32 v15, 16, v15
v_cmp_ge_u32 s[88:89], 7, v15
v_subrev_u32 v15, 3, v14
v_cmp_ge_u32 s[58:59], 7, v15
v_add_u32 v15, 16, v15
v_cmp_ge_u32 s[90:91], 7, v15
s_lshl_b32 s46, s45, 6
s_add_u32 s46, s46, s44
s_add_u32 s46, s46, 16
v_lshl_add_u32 v14, v12, 1, s46
s_lshl_b32 s47, s43, 6
v_lshl_add_u32 v15, v13, 4, s47
v_mul_u32_u24 v20, 400, v14
v_add_u32 v20, v20, v15
v_subrev_u32 v16, 32, v14
v_max_i32 v16, 0, v16
v_mul_u32_u24 v21, 400, v16
v_add_u32 v21, v21, v15
v_lshrrev_b32 v16, 2, v12
v_lshl_add_u32 v16, v13, 2, v16
v_lshl_add_u32 v16, v16, 1, s46
v_and_b32 v17, 3, v1
v_lshl_add_u32 v17, v17, 3, s47
v_mul_u32_u24 v22, 400, v16
v_add_u32 v22, v22, v17
v_subrev_u32 v16, 32, v16
v_max_i32 v16, 0, v16
v_mul_u32_u24 v23, 400, v16
v_add_u32 v23, v23, v17
s_lshl_b32 s60, s43, 13
s_lshl_b32 s61, s45, 10
s_add_u32 s60, s60, s61
s_lshl_b32 s61, s44, 8
s_add_u32 s60, s60, s61
v_lshlrev_b32 v27, 11, v13
v_lshl_add_u32 v27, v12, 4, v27
v_add_u32 v27, s60, v27
v_mov_b32 v28, 0xff800000
s_mov_b32 s61, 0x3e8293ee
s_nop 2
s_or_b32 s62, s34, s45
s_cmp_lg_u32 s62, 0
s_cselect_b64 s[64:65], s[84:85], 0
s_cselect_b64 s[66:67], s[86:87], 0
s_cselect_b64 s[68:69], s[88:89], 0
s_cselect_b64 s[70:71], s[90:91], 0
s_branch Latt_4
.p2align 3
Lcons_2:
s_cmp_ge_u32 s36, 2
s_cbranch_scc1 Lsp_5
s_cmp_ge_u32 s2, 128
s_cbranch_scc1 Lsp_5
s_mov_b32 s84, s6
s_mov_b32 s85, s7
s_mov_b32 s86, 6291456
s_mov_b32 s87, 0x20000
s_and_b32 s43, s35, 8
s_or_b32 s43, s43, 3
s_lshl_b32 s43, s43, 7
s_lshr_b32 s44, s2, 3
s_mul_i32 s44, s44, 196608
s_add_u32 s43, s43, s44
s_lshl_b32 s44, s36, 6
v_add_u32 v15, s44, v1
v_min_u32 v15, 95, v15
v_mul_u32_u24 v16, 21846, v15
v_lshrrev_b32 v16, 16, v16
v_mul_u32_u24 v17, 3, v16
v_sub_u32 v15, v15, v17
v_mul_u32_u24 v16, 6144, v16
v_lshl_add_u32 v15, v15, 11, v16
buffer_load_dword v31, v15, s[84:87], s43 offen
Lsp_5:
v_lshrrev_b32 v16, 1, v12
v_xor_b32 v15, v13, v16
v_lshlrev_b32 v15, 4, v15
v_lshl_add_u32 v2, v12, 7, v15
v_xor_b32 v3, 64, v2
v_add_u32 v4, 86016, v2
v_add_u32 v5, 86016, v3
v_lshrrev_b32 v15, 2, v12
v_and_b32 v16, 3, v1
v_lshl_add_u32 v19, v13, 3, v15
v_lshlrev_b32 v19, 7, v19
v_and_b32 v15, 2, v15
v_and_b32 v17, 1, v13
v_lshl_add_u32 v15, v17, 2, v15
v_lshrrev_b32 v17, 1, v16
s_lshl_b32 s43, s36, 1
v_add_u32 v17, s43, v17
v_xor_b32 v15, v15, v17
v_lshl_add_u32 v19, v15, 4, v19
v_and_b32 v16, 1, v16
v_lshl_add_u32 v19, v16, 3, v19
v_add_u32 v6, 18432, v19
v_add_u32 v7, 61440, v19
v_add_u32 v8, 104448, v19
v_mov_b32 v128, 0
v_mov_b32 v129, 0
v_mov_b32 v130, 0
v_mov_b32 v131, 0
v_mov_b32 v132, 0
v_mov_b32 v133, 0
v_mov_b32 v134, 0
v_mov_b32 v135, 0
v_mov_b32 v136, 0
v_mov_b32 v137, 0
v_mov_b32 v138, 0
v_mov_b32 v139, 0
v_mov_b32 v140, 0
v_mov_b32 v141, 0
v_mov_b32 v142, 0
v_mov_b32 v143, 0
v_mov_b32 v144, 0
v_mov_b32 v145, 0
v_mov_b32 v146, 0
v_mov_b32 v147, 0
v_mov_b32 v148, 0
v_mov_b32 v149, 0
v_mov_b32 v150, 0
v_mov_b32 v151, 0
v_mov_b32 v152, 0
v_mov_b32 v153, 0
v_mov_b32 v154, 0
v_mov_b32 v155, 0
v_mov_b32 v156, 0
v_mov_b32 v157, 0
v_mov_b32 v158, 0
v_mov_b32 v159, 0
v_mov_b32 v160, 0
v_mov_b32 v161, 0
v_mov_b32 v162, 0
v_mov_b32 v163, 0
v_mov_b32 v164, 0
v_mov_b32 v165, 0
v_mov_b32 v166, 0
v_mov_b32 v167, 0
v_mov_b32 v168, 0
v_mov_b32 v169, 0
v_mov_b32 v170, 0
v_mov_b32 v171, 0
v_mov_b32 v172, 0
v_mov_b32 v173, 0
v_mov_b32 v174, 0
v_mov_b32 v175, 0
v_mov_b32 v176, 0
v_mov_b32 v177, 0
v_mov_b32 v178, 0
v_mov_b32 v179, 0
v_mov_b32 v180, 0
v_mov_b32 v181, 0
v_mov_b32 v182, 0
v_mov_b32 v183, 0
v_mov_b32 v184, 0
v_mov_b32 v185, 0
v_mov_b32 v186, 0
v_mov_b32 v187, 0
v_mov_b32 v188, 0
v_mov_b32 v189, 0
v_mov_b32 v190, 0
v_mov_b32 v191, 0
v_mov_b32 v192, 0
v_mov_b32 v193, 0
v_mov_b32 v194, 0
v_mov_b32 v195, 0
v_mov_b32 v196, 0
v_mov_b32 v197, 0
v_mov_b32 v198, 0
v_mov_b32 v199, 0
v_mov_b32 v200, 0
v_mov_b32 v201, 0
v_mov_b32 v202, 0
v_mov_b32 v203, 0
v_mov_b32 v204, 0
v_mov_b32 v205, 0
v_mov_b32 v206, 0
v_mov_b32 v207, 0
v_mov_b32 v208, 0
v_mov_b32 v209, 0
v_mov_b32 v210, 0
v_mov_b32 v211, 0
v_mov_b32 v212, 0
v_mov_b32 v213, 0
v_mov_b32 v214, 0
v_mov_b32 v215, 0
v_mov_b32 v216, 0
v_mov_b32 v217, 0
v_mov_b32 v218, 0
v_mov_b32 v219, 0
v_mov_b32 v220, 0
v_mov_b32 v221, 0
v_mov_b32 v222, 0
v_mov_b32 v223, 0
v_mov_b32 v224, 0
v_mov_b32 v225, 0
v_mov_b32 v226, 0
v_mov_b32 v227, 0
v_mov_b32 v228, 0
v_mov_b32 v229, 0
v_mov_b32 v230, 0
v_mov_b32 v231, 0
v_mov_b32 v232, 0
v_mov_b32 v233, 0
v_mov_b32 v234, 0
v_mov_b32 v235, 0
s_and_b32 s43, s36, 1
s_lshr_b32 s44, s36, 1
s_and_b32 s44, s44, 1
s_lshr_b32 s45, s36, 2
v_lshlrev_b32 v14, 2, v13
v_sub_u32 v14, v12, v14
v_subrev_u32 v15, 0, v14
v_cmp_ge_u32 s[52:53], 7, v15
v_add_u32 v15, 16, v15
v_cmp_ge_u32 s[84:85], 7, v15
v_subrev_u32 v15, 1, v14
v_cmp_ge_u32 s[54:55], 7, v15
v_add_u32 v15, 16, v15
v_cmp_ge_u32 s[86:87], 7, v15
v_subrev_u32 v15, 2, v14
v_cmp_ge_u32 s[56:57], 7, v15
v_add_u32 v15, 16, v15
v_cmp_ge_u32 s[88:89], 7, v15
v_subrev_u32 v15, 3, v14
v_cmp_ge_u32 s[58:59], 7, v15
v_add_u32 v15, 16, v15
v_cmp_ge_u32 s[90:91], 7, v15
s_lshl_b32 s46, s45, 6
s_add_u32 s46, s46, s44
s_add_u32 s46, s46, 16
v_lshl_add_u32 v14, v12, 1, s46
s_lshl_b32 s47, s43, 6
v_lshl_add_u32 v15, v13, 4, s47
v_mul_u32_u24 v20, 400, v14
v_add_u32 v20, v20, v15
v_subrev_u32 v16, 32, v14
v_max_i32 v16, 0, v16
v_mul_u32_u24 v21, 400, v16
v_add_u32 v21, v21, v15
v_lshrrev_b32 v16, 2, v12
v_lshl_add_u32 v16, v13, 2, v16
v_lshl_add_u32 v16, v16, 1, s46
v_and_b32 v17, 3, v1
v_lshl_add_u32 v17, v17, 3, s47
v_mul_u32_u24 v22, 400, v16
v_add_u32 v22, v22, v17
v_subrev_u32 v16, 32, v16
v_max_i32 v16, 0, v16
v_mul_u32_u24 v23, 400, v16
v_add_u32 v23, v23, v17
s_lshl_b32 s60, s43, 13
s_lshl_b32 s61, s45, 10
s_add_u32 s60, s60, s61
s_lshl_b32 s61, s44, 8
s_add_u32 s60, s60, s61
v_lshlrev_b32 v27, 11, v13
v_lshl_add_u32 v27, v12, 4, v27
v_add_u32 v27, s60, v27
v_mov_b32 v28, 0xff800000
s_mov_b32 s61, 0x3e8293ee
s_nop 2
s_or_b32 s62, s34, s45
s_cmp_lg_u32 s62, 0
s_cselect_b64 s[64:65], s[84:85], 0
s_cselect_b64 s[66:67], s[86:87], 0
s_cselect_b64 s[68:69], s[88:89], 0
s_cselect_b64 s[70:71], s[90:91], 0
s_lshl_b32 s43, s36, 5
s_add_u32 s43, s43, 16
v_lshl_add_u32 v10, v12, 1, s43
v_lshlrev_b32 v10, 7, v10
v_and_b32 v16, 1, v13
v_lshlrev_b32 v16, 1, v16
v_lshrrev_b32 v17, 1, v13
v_add_u32 v16, v16, v17
v_and_b32 v17, 7, v12
v_xor_b32 v16, v16, v17
v_lshl_add_u32 v10, v16, 4, v10
s_mov_b32 s42, s35
v_lshlrev_b32 v9, 3, v12
v_add_u32 v9, 129024, v9
v_mul_u32_u24 v14, 400, v12
v_lshl_add_u32 v14, v13, 3, v14
s_lshl_b32 s43, s36, 5
v_add_u32 v14, s43, v14
s_barrier
ds_read_b128 v[32:35], v2 offset:0
ds_read_b64_tr_b16 v[72:73], v6 offset:8192
ds_read_b64_tr_b16 v[74:75], v6 offset:8704
ds_read_b64_tr_b16 v[76:77], v6 offset:16384
ds_read_b64_tr_b16 v[78:79], v6 offset:16896
ds_read_b64_tr_b16 v[68:69], v6 offset:0
ds_read_b64_tr_b16 v[70:71], v6 offset:512
ds_read_b128 v[36:39], v2 offset:2048
ds_read_b128 v[40:43], v2 offset:4096
ds_read_b128 v[44:47], v2 offset:6144
ds_read_b128 v[48:51], v2 offset:8192
ds_read_b128 v[52:55], v2 offset:10240
ds_read_b128 v[56:59], v2 offset:12288
ds_read_b128 v[60:63], v2 offset:14336
ds_read_b128 v[64:67], v2 offset:16384
s_mov_b32 s41, 5
.p2align 3
Lcl_6:
s_waitcnt lgkmcnt(0)
v_mfma_f32_16x16x32_bf16 v[164:167], v[72:75], v[32:35], v[164:167]
ds_read_b128 v[80:83], v3 offset:0
v_mfma_f32_16x16x32_bf16 v[200:203], v[76:79], v[32:35], v[200:203]
ds_read_b64_tr_b16 v[120:121], v6 offset:12288
v_mfma_f32_16x16x32_bf16 v[128:131], v[68:71], v[32:35], v[128:131]
ds_read_b64_tr_b16 v[122:123], v6 offset:12800
v_mfma_f32_16x16x32_bf16 v[168:171], v[72:75], v[36:39], v[168:171]
ds_read_b64_tr_b16 v[124:125], v6 offset:20480
v_mfma_f32_16x16x32_bf16 v[204:207], v[76:79], v[36:39], v[204:207]
ds_read_b64_tr_b16 v[126:127], v6 offset:20992
v_mfma_f32_16x16x32_bf16 v[132:135], v[68:71], v[36:39], v[132:135]
ds_read_b64_tr_b16 v[116:117], v6 offset:4096
v_mfma_f32_16x16x32_bf16 v[172:175], v[72:75], v[40:43], v[172:175]
ds_read_b64_tr_b16 v[118:119], v6 offset:4608
v_mfma_f32_16x16x32_bf16 v[208:211], v[76:79], v[40:43], v[208:211]
ds_read_b128 v[84:87], v3 offset:2048
v_mfma_f32_16x16x32_bf16 v[136:139], v[68:71], v[40:43], v[136:139]
ds_read_b128 v[88:91], v3 offset:4096
v_mfma_f32_16x16x32_bf16 v[176:179], v[72:75], v[44:47], v[176:179]
ds_read_b128 v[92:95], v3 offset:6144
v_mfma_f32_16x16x32_bf16 v[212:215], v[76:79], v[44:47], v[212:215]
ds_read_b128 v[96:99], v3 offset:8192
v_mfma_f32_16x16x32_bf16 v[140:143], v[68:71], v[44:47], v[140:143]
ds_read_b128 v[100:103], v3 offset:10240
v_mfma_f32_16x16x32_bf16 v[180:183], v[72:75], v[48:51], v[180:183]
ds_read_b128 v[104:107], v3 offset:12288
v_mfma_f32_16x16x32_bf16 v[216:219], v[76:79], v[48:51], v[216:219]
ds_read_b128 v[108:111], v3 offset:14336
v_mfma_f32_16x16x32_bf16 v[144:147], v[68:71], v[48:51], v[144:147]
ds_read_b128 v[112:115], v3 offset:16384
v_mfma_f32_16x16x32_bf16 v[184:187], v[72:75], v[52:55], v[184:187]
v_mfma_f32_16x16x32_bf16 v[220:223], v[76:79], v[52:55], v[220:223]
v_mfma_f32_16x16x32_bf16 v[148:151], v[68:71], v[52:55], v[148:151]
v_mfma_f32_16x16x32_bf16 v[188:191], v[72:75], v[56:59], v[188:191]
v_mfma_f32_16x16x32_bf16 v[224:227], v[76:79], v[56:59], v[224:227]
v_mfma_f32_16x16x32_bf16 v[152:155], v[68:71], v[56:59], v[152:155]
v_mfma_f32_16x16x32_bf16 v[192:195], v[72:75], v[60:63], v[192:195]
v_mfma_f32_16x16x32_bf16 v[228:231], v[76:79], v[60:63], v[228:231]
s_sub_u32 s42, s42, 1
s_cbranch_scc1 Lxr_7
Lxb_8:
v_mfma_f32_16x16x32_bf16 v[156:159], v[68:71], v[60:63], v[156:159]
v_mfma_f32_16x16x32_bf16 v[196:199], v[72:75], v[64:67], v[196:199]
v_mfma_f32_16x16x32_bf16 v[232:235], v[76:79], v[64:67], v[232:235]
v_mfma_f32_16x16x32_bf16 v[160:163], v[68:71], v[64:67], v[160:163]
s_waitcnt lgkmcnt(0)
s_barrier
v_mfma_f32_16x16x32_bf16 v[164:167], v[120:123], v[80:83], v[164:167]
ds_read_b128 v[32:35], v2 offset:43008
v_mfma_f32_16x16x32_bf16 v[200:203], v[124:127], v[80:83], v[200:203]
ds_read_b64_tr_b16 v[72:73], v7 offset:8192
v_mfma_f32_16x16x32_bf16 v[128:131], v[116:119], v[80:83], v[128:131]
ds_read_b64_tr_b16 v[74:75], v7 offset:8704
v_mfma_f32_16x16x32_bf16 v[168:171], v[120:123], v[84:87], v[168:171]
ds_read_b64_tr_b16 v[76:77], v7 offset:16384
v_mfma_f32_16x16x32_bf16 v[204:207], v[124:127], v[84:87], v[204:207]
ds_read_b64_tr_b16 v[78:79], v7 offset:16896
v_mfma_f32_16x16x32_bf16 v[132:135], v[116:119], v[84:87], v[132:135]
ds_read_b64_tr_b16 v[68:69], v7 offset:0
v_mfma_f32_16x16x32_bf16 v[172:175], v[120:123], v[88:91], v[172:175]
ds_read_b64_tr_b16 v[70:71], v7 offset:512
v_mfma_f32_16x16x32_bf16 v[208:211], v[124:127], v[88:91], v[208:211]
ds_read_b128 v[36:39], v2 offset:45056
v_mfma_f32_16x16x32_bf16 v[136:139], v[116:119], v[88:91], v[136:139]
ds_read_b128 v[40:43], v2 offset:47104
v_mfma_f32_16x16x32_bf16 v[176:179], v[120:123], v[92:95], v[176:179]
ds_read_b128 v[44:47], v2 offset:49152
v_mfma_f32_16x16x32_bf16 v[212:215], v[124:127], v[92:95], v[212:215]
ds_read_b128 v[48:51], v2 offset:51200
v_mfma_f32_16x16x32_bf16 v[140:143], v[116:119], v[92:95], v[140:143]
ds_read_b128 v[52:55], v2 offset:53248
v_mfma_f32_16x16x32_bf16 v[180:183], v[120:123], v[96:99], v[180:183]
ds_read_b128 v[56:59], v2 offset:55296
v_mfma_f32_16x16x32_bf16 v[216:219], v[124:127], v[96:99], v[216:219]
ds_read_b128 v[60:63], v2 offset:57344
v_mfma_f32_16x16x32_bf16 v[144:147], v[116:119], v[96:99], v[144:147]
ds_read_b128 v[64:67], v2 offset:59392
v_mfma_f32_16x16x32_bf16 v[184:187], v[120:123], v[100:103], v[184:187]
v_mfma_f32_16x16x32_bf16 v[220:223], v[124:127], v[100:103], v[220:223]
v_mfma_f32_16x16x32_bf16 v[148:151], v[116:119], v[100:103], v[148:151]
v_mfma_f32_16x16x32_bf16 v[188:191], v[120:123], v[104:107], v[188:191]
v_mfma_f32_16x16x32_bf16 v[224:227], v[124:127], v[104:107], v[224:227]
v_mfma_f32_16x16x32_bf16 v[152:155], v[116:119], v[104:107], v[152:155]
v_mfma_f32_16x16x32_bf16 v[192:195], v[120:123], v[108:111], v[192:195]
v_mfma_f32_16x16x32_bf16 v[228:231], v[124:127], v[108:111], v[228:231]
v_mfma_f32_16x16x32_bf16 v[156:159], v[116:119], v[108:111], v[156:159]
v_mfma_f32_16x16x32_bf16 v[196:199], v[120:123], v[112:115], v[196:199]
v_mfma_f32_16x16x32_bf16 v[232:235], v[124:127], v[112:115], v[232:235]
v_mfma_f32_16x16x32_bf16 v[160:163], v[116:119], v[112:115], v[160:163]
s_waitcnt lgkmcnt(0)
v_mfma_f32_16x16x32_bf16 v[164:167], v[72:75], v[32:35], v[164:167]
ds_read_b128 v[80:83], v3 offset:43008
v_mfma_f32_16x16x32_bf16 v[200:203], v[76:79], v[32:35], v[200:203]
ds_read_b64_tr_b16 v[120:121], v7 offset:12288
v_mfma_f32_16x16x32_bf16 v[128:131], v[68:71], v[32:35], v[128:131]
ds_read_b64_tr_b16 v[122:123], v7 offset:12800
v_mfma_f32_16x16x32_bf16 v[168:171], v[72:75], v[36:39], v[168:171]
ds_read_b64_tr_b16 v[124:125], v7 offset:20480
v_mfma_f32_16x16x32_bf16 v[204:207], v[76:79], v[36:39], v[204:207]
ds_read_b64_tr_b16 v[126:127], v7 offset:20992
v_mfma_f32_16x16x32_bf16 v[132:135], v[68:71], v[36:39], v[132:135]
ds_read_b64_tr_b16 v[116:117], v7 offset:4096
v_mfma_f32_16x16x32_bf16 v[172:175], v[72:75], v[40:43], v[172:175]
ds_read_b64_tr_b16 v[118:119], v7 offset:4608
v_mfma_f32_16x16x32_bf16 v[208:211], v[76:79], v[40:43], v[208:211]
ds_read_b128 v[84:87], v3 offset:45056
v_mfma_f32_16x16x32_bf16 v[136:139], v[68:71], v[40:43], v[136:139]
ds_read_b128 v[88:91], v3 offset:47104
v_mfma_f32_16x16x32_bf16 v[176:179], v[72:75], v[44:47], v[176:179]
ds_read_b128 v[92:95], v3 offset:49152
v_mfma_f32_16x16x32_bf16 v[212:215], v[76:79], v[44:47], v[212:215]
ds_read_b128 v[96:99], v3 offset:51200
v_mfma_f32_16x16x32_bf16 v[140:143], v[68:71], v[44:47], v[140:143]
ds_read_b128 v[100:103], v3 offset:53248
v_mfma_f32_16x16x32_bf16 v[180:183], v[72:75], v[48:51], v[180:183]
ds_read_b128 v[104:107], v3 offset:55296
v_mfma_f32_16x16x32_bf16 v[216:219], v[76:79], v[48:51], v[216:219]
ds_read_b128 v[108:111], v3 offset:57344
v_mfma_f32_16x16x32_bf16 v[144:147], v[68:71], v[48:51], v[144:147]
ds_read_b128 v[112:115], v3 offset:59392
v_mfma_f32_16x16x32_bf16 v[184:187], v[72:75], v[52:55], v[184:187]
v_mfma_f32_16x16x32_bf16 v[220:223], v[76:79], v[52:55], v[220:223]
v_mfma_f32_16x16x32_bf16 v[148:151], v[68:71], v[52:55], v[148:151]
v_mfma_f32_16x16x32_bf16 v[188:191], v[72:75], v[56:59], v[188:191]
v_mfma_f32_16x16x32_bf16 v[224:227], v[76:79], v[56:59], v[224:227]
v_mfma_f32_16x16x32_bf16 v[152:155], v[68:71], v[56:59], v[152:155]
v_mfma_f32_16x16x32_bf16 v[192:195], v[72:75], v[60:63], v[192:195]
v_mfma_f32_16x16x32_bf16 v[228:231], v[76:79], v[60:63], v[228:231]
s_sub_u32 s42, s42, 1
s_cbranch_scc1 Lxr_9
Lxb_10:
v_mfma_f32_16x16x32_bf16 v[156:159], v[68:71], v[60:63], v[156:159]
v_mfma_f32_16x16x32_bf16 v[196:199], v[72:75], v[64:67], v[196:199]
v_mfma_f32_16x16x32_bf16 v[232:235], v[76:79], v[64:67], v[232:235]
v_mfma_f32_16x16x32_bf16 v[160:163], v[68:71], v[64:67], v[160:163]
s_waitcnt lgkmcnt(0)
s_barrier
v_mfma_f32_16x16x32_bf16 v[164:167], v[120:123], v[80:83], v[164:167]
ds_read_b128 v[32:35], v4 offset:0
v_mfma_f32_16x16x32_bf16 v[200:203], v[124:127], v[80:83], v[200:203]
ds_read_b64_tr_b16 v[72:73], v8 offset:8192
v_mfma_f32_16x16x32_bf16 v[128:131], v[116:119], v[80:83], v[128:131]
ds_read_b64_tr_b16 v[74:75], v8 offset:8704
v_mfma_f32_16x16x32_bf16 v[168:171], v[120:123], v[84:87], v[168:171]
ds_read_b64_tr_b16 v[76:77], v8 offset:16384
v_mfma_f32_16x16x32_bf16 v[204:207], v[124:127], v[84:87], v[204:207]
ds_read_b64_tr_b16 v[78:79], v8 offset:16896
v_mfma_f32_16x16x32_bf16 v[132:135], v[116:119], v[84:87], v[132:135]
ds_read_b64_tr_b16 v[68:69], v8 offset:0
v_mfma_f32_16x16x32_bf16 v[172:175], v[120:123], v[88:91], v[172:175]
ds_read_b64_tr_b16 v[70:71], v8 offset:512
v_mfma_f32_16x16x32_bf16 v[208:211], v[124:127], v[88:91], v[208:211]
ds_read_b128 v[36:39], v4 offset:2048
v_mfma_f32_16x16x32_bf16 v[136:139], v[116:119], v[88:91], v[136:139]
ds_read_b128 v[40:43], v4 offset:4096
v_mfma_f32_16x16x32_bf16 v[176:179], v[120:123], v[92:95], v[176:179]
ds_read_b128 v[44:47], v4 offset:6144
v_mfma_f32_16x16x32_bf16 v[212:215], v[124:127], v[92:95], v[212:215]
ds_read_b128 v[48:51], v4 offset:8192
v_mfma_f32_16x16x32_bf16 v[140:143], v[116:119], v[92:95], v[140:143]
ds_read_b128 v[52:55], v4 offset:10240
v_mfma_f32_16x16x32_bf16 v[180:183], v[120:123], v[96:99], v[180:183]
ds_read_b128 v[56:59], v4 offset:12288
v_mfma_f32_16x16x32_bf16 v[216:219], v[124:127], v[96:99], v[216:219]
ds_read_b128 v[60:63], v4 offset:14336
v_mfma_f32_16x16x32_bf16 v[144:147], v[116:119], v[96:99], v[144:147]
ds_read_b128 v[64:67], v4 offset:16384
v_mfma_f32_16x16x32_bf16 v[184:187], v[120:123], v[100:103], v[184:187]
v_mfma_f32_16x16x32_bf16 v[220:223], v[124:127], v[100:103], v[220:223]
v_mfma_f32_16x16x32_bf16 v[148:151], v[116:119], v[100:103], v[148:151]
v_mfma_f32_16x16x32_bf16 v[188:191], v[120:123], v[104:107], v[188:191]
v_mfma_f32_16x16x32_bf16 v[224:227], v[124:127], v[104:107], v[224:227]
v_mfma_f32_16x16x32_bf16 v[152:155], v[116:119], v[104:107], v[152:155]
v_mfma_f32_16x16x32_bf16 v[192:195], v[120:123], v[108:111], v[192:195]
v_mfma_f32_16x16x32_bf16 v[228:231], v[124:127], v[108:111], v[228:231]
v_mfma_f32_16x16x32_bf16 v[156:159], v[116:119], v[108:111], v[156:159]
v_mfma_f32_16x16x32_bf16 v[196:199], v[120:123], v[112:115], v[196:199]
v_mfma_f32_16x16x32_bf16 v[232:235], v[124:127], v[112:115], v[232:235]
v_mfma_f32_16x16x32_bf16 v[160:163], v[116:119], v[112:115], v[160:163]
s_waitcnt lgkmcnt(0)
v_mfma_f32_16x16x32_bf16 v[164:167], v[72:75], v[32:35], v[164:167]
ds_read_b128 v[80:83], v5 offset:0
v_mfma_f32_16x16x32_bf16 v[200:203], v[76:79], v[32:35], v[200:203]
ds_read_b64_tr_b16 v[120:121], v8 offset:12288
v_mfma_f32_16x16x32_bf16 v[128:131], v[68:71], v[32:35], v[128:131]
ds_read_b64_tr_b16 v[122:123], v8 offset:12800
v_mfma_f32_16x16x32_bf16 v[168:171], v[72:75], v[36:39], v[168:171]
ds_read_b64_tr_b16 v[124:125], v8 offset:20480
v_mfma_f32_16x16x32_bf16 v[204:207], v[76:79], v[36:39], v[204:207]
ds_read_b64_tr_b16 v[126:127], v8 offset:20992
v_mfma_f32_16x16x32_bf16 v[132:135], v[68:71], v[36:39], v[132:135]
ds_read_b64_tr_b16 v[116:117], v8 offset:4096
v_mfma_f32_16x16x32_bf16 v[172:175], v[72:75], v[40:43], v[172:175]
ds_read_b64_tr_b16 v[118:119], v8 offset:4608
v_mfma_f32_16x16x32_bf16 v[208:211], v[76:79], v[40:43], v[208:211]
ds_read_b128 v[84:87], v5 offset:2048
v_mfma_f32_16x16x32_bf16 v[136:139], v[68:71], v[40:43], v[136:139]
ds_read_b128 v[88:91], v5 offset:4096
v_mfma_f32_16x16x32_bf16 v[176:179], v[72:75], v[44:47], v[176:179]
ds_read_b128 v[92:95], v5 offset:6144
v_mfma_f32_16x16x32_bf16 v[212:215], v[76:79], v[44:47], v[212:215]
ds_read_b128 v[96:99], v5 offset:8192
v_mfma_f32_16x16x32_bf16 v[140:143], v[68:71], v[44:47], v[140:143]
ds_read_b128 v[100:103], v5 offset:10240
v_mfma_f32_16x16x32_bf16 v[180:183], v[72:75], v[48:51], v[180:183]
ds_read_b128 v[104:107], v5 offset:12288
v_mfma_f32_16x16x32_bf16 v[216:219], v[76:79], v[48:51], v[216:219]
ds_read_b128 v[108:111], v5 offset:14336
v_mfma_f32_16x16x32_bf16 v[144:147], v[68:71], v[48:51], v[144:147]
ds_read_b128 v[112:115], v5 offset:16384
v_mfma_f32_16x16x32_bf16 v[184:187], v[72:75], v[52:55], v[184:187]
v_mfma_f32_16x16x32_bf16 v[220:223], v[76:79], v[52:55], v[220:223]
v_mfma_f32_16x16x32_bf16 v[148:151], v[68:71], v[52:55], v[148:151]
v_mfma_f32_16x16x32_bf16 v[188:191], v[72:75], v[56:59], v[188:191]
v_mfma_f32_16x16x32_bf16 v[224:227], v[76:79], v[56:59], v[224:227]
v_mfma_f32_16x16x32_bf16 v[152:155], v[68:71], v[56:59], v[152:155]
v_mfma_f32_16x16x32_bf16 v[192:195], v[72:75], v[60:63], v[192:195]
v_mfma_f32_16x16x32_bf16 v[228:231], v[76:79], v[60:63], v[228:231]
s_sub_u32 s42, s42, 1
s_cbranch_scc1 Lxr_11
Lxb_12:
v_mfma_f32_16x16x32_bf16 v[156:159], v[68:71], v[60:63], v[156:159]
v_mfma_f32_16x16x32_bf16 v[196:199], v[72:75], v[64:67], v[196:199]
v_mfma_f32_16x16x32_bf16 v[232:235], v[76:79], v[64:67], v[232:235]
v_mfma_f32_16x16x32_bf16 v[160:163], v[68:71], v[64:67], v[160:163]
s_waitcnt lgkmcnt(0)
s_barrier
v_mfma_f32_16x16x32_bf16 v[164:167], v[120:123], v[80:83], v[164:167]
ds_read_b128 v[32:35], v2 offset:0
v_mfma_f32_16x16x32_bf16 v[200:203], v[124:127], v[80:83], v[200:203]
ds_read_b64_tr_b16 v[72:73], v6 offset:8192
v_mfma_f32_16x16x32_bf16 v[128:131], v[116:119], v[80:83], v[128:131]
ds_read_b64_tr_b16 v[74:75], v6 offset:8704
v_mfma_f32_16x16x32_bf16 v[168:171], v[120:123], v[84:87], v[168:171]
ds_read_b64_tr_b16 v[76:77], v6 offset:16384
v_mfma_f32_16x16x32_bf16 v[204:207], v[124:127], v[84:87], v[204:207]
ds_read_b64_tr_b16 v[78:79], v6 offset:16896
v_mfma_f32_16x16x32_bf16 v[132:135], v[116:119], v[84:87], v[132:135]
ds_read_b64_tr_b16 v[68:69], v6 offset:0
v_mfma_f32_16x16x32_bf16 v[172:175], v[120:123], v[88:91], v[172:175]
ds_read_b64_tr_b16 v[70:71], v6 offset:512
v_mfma_f32_16x16x32_bf16 v[208:211], v[124:127], v[88:91], v[208:211]
ds_read_b128 v[36:39], v2 offset:2048
v_mfma_f32_16x16x32_bf16 v[136:139], v[116:119], v[88:91], v[136:139]
ds_read_b128 v[40:43], v2 offset:4096
v_mfma_f32_16x16x32_bf16 v[176:179], v[120:123], v[92:95], v[176:179]
ds_read_b128 v[44:47], v2 offset:6144
v_mfma_f32_16x16x32_bf16 v[212:215], v[124:127], v[92:95], v[212:215]
ds_read_b128 v[48:51], v2 offset:8192
v_mfma_f32_16x16x32_bf16 v[140:143], v[116:119], v[92:95], v[140:143]
ds_read_b128 v[52:55], v2 offset:10240
v_mfma_f32_16x16x32_bf16 v[180:183], v[120:123], v[96:99], v[180:183]
ds_read_b128 v[56:59], v2 offset:12288
v_mfma_f32_16x16x32_bf16 v[216:219], v[124:127], v[96:99], v[216:219]
ds_read_b128 v[60:63], v2 offset:14336
v_mfma_f32_16x16x32_bf16 v[144:147], v[116:119], v[96:99], v[144:147]
ds_read_b128 v[64:67], v2 offset:16384
v_mfma_f32_16x16x32_bf16 v[184:187], v[120:123], v[100:103], v[184:187]
v_mfma_f32_16x16x32_bf16 v[220:223], v[124:127], v[100:103], v[220:223]
v_mfma_f32_16x16x32_bf16 v[148:151], v[116:119], v[100:103], v[148:151]
v_mfma_f32_16x16x32_bf16 v[188:191], v[120:123], v[104:107], v[188:191]
v_mfma_f32_16x16x32_bf16 v[224:227], v[124:127], v[104:107], v[224:227]
v_mfma_f32_16x16x32_bf16 v[152:155], v[116:119], v[104:107], v[152:155]
v_mfma_f32_16x16x32_bf16 v[192:195], v[120:123], v[108:111], v[192:195]
v_mfma_f32_16x16x32_bf16 v[228:231], v[124:127], v[108:111], v[228:231]
v_mfma_f32_16x16x32_bf16 v[156:159], v[116:119], v[108:111], v[156:159]
v_mfma_f32_16x16x32_bf16 v[196:199], v[120:123], v[112:115], v[196:199]
v_mfma_f32_16x16x32_bf16 v[232:235], v[124:127], v[112:115], v[232:235]
v_mfma_f32_16x16x32_bf16 v[160:163], v[116:119], v[112:115], v[160:163]
s_sub_u32 s41, s41, 1
s_cmp_lg_u32 s41, 0
s_cbranch_scc1 Lcl_6
s_waitcnt lgkmcnt(0)
v_mfma_f32_16x16x32_bf16 v[164:167], v[72:75], v[32:35], v[164:167]
ds_read_b128 v[80:83], v3 offset:0
v_mfma_f32_16x16x32_bf16 v[200:203], v[76:79], v[32:35], v[200:203]
ds_read_b64_tr_b16 v[120:121], v6 offset:12288
v_mfma_f32_16x16x32_bf16 v[128:131], v[68:71], v[32:35], v[128:131]
ds_read_b64_tr_b16 v[122:123], v6 offset:12800
v_mfma_f32_16x16x32_bf16 v[168:171], v[72:75], v[36:39], v[168:171]
ds_read_b64_tr_b16 v[124:125], v6 offset:20480
v_mfma_f32_16x16x32_bf16 v[204:207], v[76:79], v[36:39], v[204:207]
ds_read_b64_tr_b16 v[126:127], v6 offset:20992
v_mfma_f32_16x16x32_bf16 v[132:135], v[68:71], v[36:39], v[132:135]
ds_read_b64_tr_b16 v[116:117], v6 offset:4096
v_mfma_f32_16x16x32_bf16 v[172:175], v[72:75], v[40:43], v[172:175]
ds_read_b64_tr_b16 v[118:119], v6 offset:4608
v_mfma_f32_16x16x32_bf16 v[208:211], v[76:79], v[40:43], v[208:211]
ds_read_b128 v[84:87], v3 offset:2048
v_mfma_f32_16x16x32_bf16 v[136:139], v[68:71], v[40:43], v[136:139]
ds_read_b128 v[88:91], v3 offset:4096
v_mfma_f32_16x16x32_bf16 v[176:179], v[72:75], v[44:47], v[176:179]
ds_read_b128 v[92:95], v3 offset:6144
v_mfma_f32_16x16x32_bf16 v[212:215], v[76:79], v[44:47], v[212:215]
ds_read_b128 v[96:99], v3 offset:8192
v_mfma_f32_16x16x32_bf16 v[140:143], v[68:71], v[44:47], v[140:143]
ds_read_b128 v[100:103], v3 offset:10240
v_mfma_f32_16x16x32_bf16 v[180:183], v[72:75], v[48:51], v[180:183]
ds_read_b128 v[104:107], v3 offset:12288
v_mfma_f32_16x16x32_bf16 v[216:219], v[76:79], v[48:51], v[216:219]
ds_read_b128 v[108:111], v3 offset:14336
v_mfma_f32_16x16x32_bf16 v[144:147], v[68:71], v[48:51], v[144:147]
ds_read_b128 v[112:115], v3 offset:16384
v_mfma_f32_16x16x32_bf16 v[184:187], v[72:75], v[52:55], v[184:187]
v_mfma_f32_16x16x32_bf16 v[220:223], v[76:79], v[52:55], v[220:223]
v_mfma_f32_16x16x32_bf16 v[148:151], v[68:71], v[52:55], v[148:151]
v_mfma_f32_16x16x32_bf16 v[188:191], v[72:75], v[56:59], v[188:191]
v_mfma_f32_16x16x32_bf16 v[224:227], v[76:79], v[56:59], v[224:227]
v_mfma_f32_16x16x32_bf16 v[152:155], v[68:71], v[56:59], v[152:155]
v_mfma_f32_16x16x32_bf16 v[192:195], v[72:75], v[60:63], v[192:195]
v_mfma_f32_16x16x32_bf16 v[228:231], v[76:79], v[60:63], v[228:231]
s_sub_u32 s42, s42, 1
s_cbranch_scc1 Lxr_13
Lxb_14:
v_mfma_f32_16x16x32_bf16 v[156:159], v[68:71], v[60:63], v[156:159]
v_mfma_f32_16x16x32_bf16 v[196:199], v[72:75], v[64:67], v[196:199]
v_mfma_f32_16x16x32_bf16 v[232:235], v[76:79], v[64:67], v[232:235]
v_mfma_f32_16x16x32_bf16 v[160:163], v[68:71], v[64:67], v[160:163]
s_waitcnt lgkmcnt(0)
s_barrier
v_mfma_f32_16x16x32_bf16 v[164:167], v[120:123], v[80:83], v[164:167]
ds_read_b64 v[32:33], v9 offset:0
v_mfma_f32_16x16x32_bf16 v[200:203], v[124:127], v[80:83], v[200:203]
ds_read_b64 v[34:35], v9 offset:128
v_mfma_f32_16x16x32_bf16 v[128:131], v[116:119], v[80:83], v[128:131]
ds_read_b64 v[36:37], v9 offset:256
v_mfma_f32_16x16x32_bf16 v[168:171], v[120:123], v[84:87], v[168:171]
ds_read_b64 v[38:39], v9 offset:384
v_mfma_f32_16x16x32_bf16 v[204:207], v[124:127], v[84:87], v[204:207]
ds_read_b64 v[40:41], v9 offset:512
v_mfma_f32_16x16x32_bf16 v[132:135], v[116:119], v[84:87], v[132:135]
ds_read_b64 v[42:43], v9 offset:640
v_mfma_f32_16x16x32_bf16 v[172:175], v[120:123], v[88:91], v[172:175]
ds_read_b64 v[44:45], v9 offset:768
v_mfma_f32_16x16x32_bf16 v[208:211], v[124:127], v[88:91], v[208:211]
ds_read_b64 v[46:47], v9 offset:896
v_mfma_f32_16x16x32_bf16 v[136:139], v[116:119], v[88:91], v[136:139]
ds_read_b64 v[48:49], v9 offset:1024
v_mfma_f32_16x16x32_bf16 v[176:179], v[120:123], v[92:95], v[176:179]
v_mov_b32_dpp v52, v128 row_newbcast:0 row_mask:0xf bank_mask:0xf
v_mov_b32_dpp v53, v129 row_newbcast:0 row_mask:0xf bank_mask:0xf
v_mfma_f32_16x16x32_bf16 v[212:215], v[124:127], v[92:95], v[212:215]
v_mov_b32_dpp v54, v130 row_newbcast:0 row_mask:0xf bank_mask:0xf
v_mov_b32_dpp v55, v131 row_newbcast:0 row_mask:0xf bank_mask:0xf
v_mfma_f32_16x16x32_bf16 v[140:143], v[116:119], v[92:95], v[140:143]
v_mov_b32_dpp v56, v164 row_newbcast:0 row_mask:0xf bank_mask:0xf
v_mov_b32_dpp v57, v165 row_newbcast:0 row_mask:0xf bank_mask:0xf
v_mfma_f32_16x16x32_bf16 v[180:183], v[120:123], v[96:99], v[180:183]
v_mov_b32_dpp v58, v166 row_newbcast:0 row_mask:0xf bank_mask:0xf
v_mov_b32_dpp v59, v167 row_newbcast:0 row_mask:0xf bank_mask:0xf
v_mfma_f32_16x16x32_bf16 v[216:219], v[124:127], v[96:99], v[216:219]
v_mov_b32_dpp v60, v200 row_newbcast:0 row_mask:0xf bank_mask:0xf
v_mov_b32_dpp v61, v201 row_newbcast:0 row_mask:0xf bank_mask:0xf
v_mfma_f32_16x16x32_bf16 v[144:147], v[116:119], v[96:99], v[144:147]
v_mov_b32_dpp v62, v202 row_newbcast:0 row_mask:0xf bank_mask:0xf
v_mov_b32_dpp v63, v203 row_newbcast:0 row_mask:0xf bank_mask:0xf
v_mfma_f32_16x16x32_bf16 v[184:187], v[120:123], v[100:103], v[184:187]
s_waitcnt lgkmcnt(0)
v_fma_f32 v164, -v32, v56, v164
v_mfma_f32_16x16x32_bf16 v[220:223], v[124:127], v[100:103], v[220:223]
v_fma_f32 v165, -v32, v57, v165
v_fma_f32 v166, -v32, v58, v166
v_mfma_f32_16x16x32_bf16 v[148:151], v[116:119], v[100:103], v[148:151]
v_fma_f32 v167, -v32, v59, v167
v_mul_f32 v164, v33, v164
v_mfma_f32_16x16x32_bf16 v[188:191], v[120:123], v[104:107], v[188:191]
v_mul_f32 v165, v33, v165
v_mul_f32 v166, v33, v166
v_mfma_f32_16x16x32_bf16 v[224:227], v[124:127], v[104:107], v[224:227]
v_mul_f32 v167, v33, v167
v_cvt_pk_bf16_f32 v164, v164, v165
v_mfma_f32_16x16x32_bf16 v[152:155], v[116:119], v[104:107], v[152:155]
v_cvt_pk_bf16_f32 v165, v166, v167
ds_write_b64 v14, v[164:165] offset:128
v_mfma_f32_16x16x32_bf16 v[192:195], v[120:123], v[108:111], v[192:195]
v_fma_f32 v200, -v32, v60, v200
v_fma_f32 v201, -v32, v61, v201
v_mfma_f32_16x16x32_bf16 v[228:231], v[124:127], v[108:111], v[228:231]
v_fma_f32 v202, -v32, v62, v202
v_fma_f32 v203, -v32, v63, v203
v_mfma_f32_16x16x32_bf16 v[156:159], v[116:119], v[108:111], v[156:159]
v_mul_f32 v200, v33, v200
v_mul_f32 v201, v33, v201
v_mfma_f32_16x16x32_bf16 v[196:199], v[120:123], v[112:115], v[196:199]
v_mul_f32 v202, v33, v202
v_mul_f32 v203, v33, v203
v_mfma_f32_16x16x32_bf16 v[232:235], v[124:127], v[112:115], v[232:235]
v_cvt_pk_bf16_f32 v200, v200, v201
v_cvt_pk_bf16_f32 v201, v202, v203
v_mfma_f32_16x16x32_bf16 v[160:163], v[116:119], v[112:115], v[160:163]
ds_write_b64 v14, v[200:201] offset:256
v_fma_f32 v132, -v34, v52, v132
v_fma_f32 v133, -v34, v53, v133
v_fma_f32 v134, -v34, v54, v134
v_fma_f32 v135, -v34, v55, v135
v_mul_f32 v132, v35, v132
v_mul_f32 v133, v35, v133
v_mul_f32 v134, v35, v134
v_mul_f32 v135, v35, v135
v_cvt_pk_bf16_f32 v132, v132, v133
v_cvt_pk_bf16_f32 v133, v134, v135
ds_write_b64 v14, v[132:133] offset:6400
v_pk_fma_f32 v[168:169], v[34:35], v[56:57], v[168:169] op_sel_hi:[0,1,1] neg_lo:[1,0,0] neg_hi:[1,0,0]
v_pk_fma_f32 v[170:171], v[34:35], v[58:59], v[170:171] op_sel_hi:[0,1,1] neg_lo:[1,0,0] neg_hi:[1,0,0]
v_pk_mul_f32 v[168:169], v[34:35], v[168:169] op_sel:[1,0] op_sel_hi:[1,1]
v_pk_mul_f32 v[170:171], v[34:35], v[170:171] op_sel:[1,0] op_sel_hi:[1,1]
v_cvt_pk_bf16_f32 v168, v168, v169
v_cvt_pk_bf16_f32 v169, v170, v171
ds_write_b64 v14, v[168:169] offset:6528
v_pk_fma_f32 v[204:205], v[34:35], v[60:61], v[204:205] op_sel_hi:[0,1,1] neg_lo:[1,0,0] neg_hi:[1,0,0]
v_pk_fma_f32 v[206:207], v[34:35], v[62:63], v[206:207] op_sel_hi:[0,1,1] neg_lo:[1,0,0] neg_hi:[1,0,0]
v_pk_mul_f32 v[204:205], v[34:35], v[204:205] op_sel:[1,0] op_sel_hi:[1,1]
v_pk_mul_f32 v[206:207], v[34:35], v[206:207] op_sel:[1,0] op_sel_hi:[1,1]
v_cvt_pk_bf16_f32 v204, v204, v205
v_cvt_pk_bf16_f32 v205, v206, v207
ds_write_b64 v14, v[204:205] offset:6656
v_pk_fma_f32 v[136:137], v[36:37], v[52:53], v[136:137] op_sel_hi:[0,1,1] neg_lo:[1,0,0] neg_hi:[1,0,0]
v_pk_fma_f32 v[138:139], v[36:37], v[54:55], v[138:139] op_sel_hi:[0,1,1] neg_lo:[1,0,0] neg_hi:[1,0,0]
v_pk_mul_f32 v[136:137], v[36:37], v[136:137] op_sel:[1,0] op_sel_hi:[1,1]
v_pk_mul_f32 v[138:139], v[36:37], v[138:139] op_sel:[1,0] op_sel_hi:[1,1]
v_cvt_pk_bf16_f32 v136, v136, v137
v_cvt_pk_bf16_f32 v137, v138, v139
ds_write_b64 v14, v[136:137] offset:12800
v_pk_fma_f32 v[172:173], v[36:37], v[56:57], v[172:173] op_sel_hi:[0,1,1] neg_lo:[1,0,0] neg_hi:[1,0,0]
v_pk_fma_f32 v[174:175], v[36:37], v[58:59], v[174:175] op_sel_hi:[0,1,1] neg_lo:[1,0,0] neg_hi:[1,0,0]
v_pk_mul_f32 v[172:173], v[36:37], v[172:173] op_sel:[1,0] op_sel_hi:[1,1]
v_pk_mul_f32 v[174:175], v[36:37], v[174:175] op_sel:[1,0] op_sel_hi:[1,1]
v_cvt_pk_bf16_f32 v172, v172, v173
v_cvt_pk_bf16_f32 v173, v174, v175
ds_write_b64 v14, v[172:173] offset:12928
v_pk_fma_f32 v[208:209], v[36:37], v[60:61], v[208:209] op_sel_hi:[0,1,1] neg_lo:[1,0,0] neg_hi:[1,0,0]
v_pk_fma_f32 v[210:211], v[36:37], v[62:63], v[210:211] op_sel_hi:[0,1,1] neg_lo:[1,0,0] neg_hi:[1,0,0]
v_pk_mul_f32 v[208:209], v[36:37], v[208:209] op_sel:[1,0] op_sel_hi:[1,1]
v_pk_mul_f32 v[210:211], v[36:37], v[210:211] op_sel:[1,0] op_sel_hi:[1,1]
v_cvt_pk_bf16_f32 v208, v208, v209
v_cvt_pk_bf16_f32 v209, v210, v211
ds_write_b64 v14, v[208:209] offset:13056
v_pk_fma_f32 v[140:141], v[38:39], v[52:53], v[140:141] op_sel_hi:[0,1,1] neg_lo:[1,0,0] neg_hi:[1,0,0]
v_pk_fma_f32 v[142:143], v[38:39], v[54:55], v[142:143] op_sel_hi:[0,1,1] neg_lo:[1,0,0] neg_hi:[1,0,0]
v_pk_mul_f32 v[140:141], v[38:39], v[140:141] op_sel:[1,0] op_sel_hi:[1,1]
v_pk_mul_f32 v[142:143], v[38:39], v[142:143] op_sel:[1,0] op_sel_hi:[1,1]
v_cvt_pk_bf16_f32 v140, v140, v141
v_cvt_pk_bf16_f32 v141, v142, v143
ds_write_b64 v14, v[140:141] offset:19200
v_pk_fma_f32 v[176:177], v[38:39], v[56:57], v[176:177] op_sel_hi:[0,1,1] neg_lo:[1,0,0] neg_hi:[1,0,0]
v_pk_fma_f32 v[178:179], v[38:39], v[58:59], v[178:179] op_sel_hi:[0,1,1] neg_lo:[1,0,0] neg_hi:[1,0,0]
v_pk_mul_f32 v[176:177], v[38:39], v[176:177] op_sel:[1,0] op_sel_hi:[1,1]
v_pk_mul_f32 v[178:179], v[38:39], v[178:179] op_sel:[1,0] op_sel_hi:[1,1]
v_cvt_pk_bf16_f32 v176, v176, v177
v_cvt_pk_bf16_f32 v177, v178, v179
ds_write_b64 v14, v[176:177] offset:19328
v_pk_fma_f32 v[212:213], v[38:39], v[60:61], v[212:213] op_sel_hi:[0,1,1] neg_lo:[1,0,0] neg_hi:[1,0,0]
v_pk_fma_f32 v[214:215], v[38:39], v[62:63], v[214:215] op_sel_hi:[0,1,1] neg_lo:[1,0,0] neg_hi:[1,0,0]
v_pk_mul_f32 v[212:213], v[38:39], v[212:213] op_sel:[1,0] op_sel_hi:[1,1]
v_pk_mul_f32 v[214:215], v[38:39], v[214:215] op_sel:[1,0] op_sel_hi:[1,1]
v_cvt_pk_bf16_f32 v212, v212, v213
v_cvt_pk_bf16_f32 v213, v214, v215
ds_write_b64 v14, v[212:213] offset:19456
v_pk_fma_f32 v[144:145], v[40:41], v[52:53], v[144:145] op_sel_hi:[0,1,1] neg_lo:[1,0,0] neg_hi:[1,0,0]
v_pk_fma_f32 v[146:147], v[40:41], v[54:55], v[146:147] op_sel_hi:[0,1,1] neg_lo:[1,0,0] neg_hi:[1,0,0]
v_pk_mul_f32 v[144:145], v[40:41], v[144:145] op_sel:[1,0] op_sel_hi:[1,1]
v_pk_mul_f32 v[146:147], v[40:41], v[146:147] op_sel:[1,0] op_sel_hi:[1,1]
v_cvt_pk_bf16_f32 v144, v144, v145
v_cvt_pk_bf16_f32 v145, v146, v147
ds_write_b64 v14, v[144:145] offset:25600
v_pk_fma_f32 v[180:181], v[40:41], v[56:57], v[180:181] op_sel_hi:[0,1,1] neg_lo:[1,0,0] neg_hi:[1,0,0]
v_pk_fma_f32 v[182:183], v[40:41], v[58:59], v[182:183] op_sel_hi:[0,1,1] neg_lo:[1,0,0] neg_hi:[1,0,0]
v_pk_mul_f32 v[180:181], v[40:41], v[180:181] op_sel:[1,0] op_sel_hi:[1,1]
v_pk_mul_f32 v[182:183], v[40:41], v[182:183] op_sel:[1,0] op_sel_hi:[1,1]
v_cvt_pk_bf16_f32 v180, v180, v181
v_cvt_pk_bf16_f32 v181, v182, v183
ds_write_b64 v14, v[180:181] offset:25728
v_pk_fma_f32 v[216:217], v[40:41], v[60:61], v[216:217] op_sel_hi:[0,1,1] neg_lo:[1,0,0] neg_hi:[1,0,0]
v_pk_fma_f32 v[218:219], v[40:41], v[62:63], v[218:219] op_sel_hi:[0,1,1] neg_lo:[1,0,0] neg_hi:[1,0,0]
v_pk_mul_f32 v[216:217], v[40:41], v[216:217] op_sel:[1,0] op_sel_hi:[1,1]
v_pk_mul_f32 v[218:219], v[40:41], v[218:219] op_sel:[1,0] op_sel_hi:[1,1]
v_cvt_pk_bf16_f32 v216, v216, v217
v_cvt_pk_bf16_f32 v217, v218, v219
ds_write_b64 v14, v[216:217] offset:25856
v_pk_fma_f32 v[148:149], v[42:43], v[52:53], v[148:149] op_sel_hi:[0,1,1] neg_lo:[1,0,0] neg_hi:[1,0,0]
v_pk_fma_f32 v[150:151], v[42:43], v[54:55], v[150:151] op_sel_hi:[0,1,1] neg_lo:[1,0,0] neg_hi:[1,0,0]
v_pk_mul_f32 v[148:149], v[42:43], v[148:149] op_sel:[1,0] op_sel_hi:[1,1]
v_pk_mul_f32 v[150:151], v[42:43], v[150:151] op_sel:[1,0] op_sel_hi:[1,1]
v_cvt_pk_bf16_f32 v148, v148, v149
v_cvt_pk_bf16_f32 v149, v150, v151
ds_write_b64 v14, v[148:149] offset:32000
v_pk_fma_f32 v[184:185], v[42:43], v[56:57], v[184:185] op_sel_hi:[0,1,1] neg_lo:[1,0,0] neg_hi:[1,0,0]
v_pk_fma_f32 v[186:187], v[42:43], v[58:59], v[186:187] op_sel_hi:[0,1,1] neg_lo:[1,0,0] neg_hi:[1,0,0]
v_pk_mul_f32 v[184:185], v[42:43], v[184:185] op_sel:[1,0] op_sel_hi:[1,1]
v_pk_mul_f32 v[186:187], v[42:43], v[186:187] op_sel:[1,0] op_sel_hi:[1,1]
v_cvt_pk_bf16_f32 v184, v184, v185
v_cvt_pk_bf16_f32 v185, v186, v187
ds_write_b64 v14, v[184:185] offset:32128
v_pk_fma_f32 v[220:221], v[42:43], v[60:61], v[220:221] op_sel_hi:[0,1,1] neg_lo:[1,0,0] neg_hi:[1,0,0]
v_pk_fma_f32 v[222:223], v[42:43], v[62:63], v[222:223] op_sel_hi:[0,1,1] neg_lo:[1,0,0] neg_hi:[1,0,0]
v_pk_mul_f32 v[220:221], v[42:43], v[220:221] op_sel:[1,0] op_sel_hi:[1,1]
v_pk_mul_f32 v[222:223], v[42:43], v[222:223] op_sel:[1,0] op_sel_hi:[1,1]
v_cvt_pk_bf16_f32 v220, v220, v221
v_cvt_pk_bf16_f32 v221, v222, v223
ds_write_b64 v14, v[220:221] offset:32256
v_pk_fma_f32 v[152:153], v[44:45], v[52:53], v[152:153] op_sel_hi:[0,1,1] neg_lo:[1,0,0] neg_hi:[1,0,0]
v_pk_fma_f32 v[154:155], v[44:45], v[54:55], v[154:155] op_sel_hi:[0,1,1] neg_lo:[1,0,0] neg_hi:[1,0,0]
v_pk_mul_f32 v[152:153], v[44:45], v[152:153] op_sel:[1,0] op_sel_hi:[1,1]
v_pk_mul_f32 v[154:155], v[44:45], v[154:155] op_sel:[1,0] op_sel_hi:[1,1]
v_cvt_pk_bf16_f32 v152, v152, v153
v_cvt_pk_bf16_f32 v153, v154, v155
ds_write_b64 v14, v[152:153] offset:38400
v_pk_fma_f32 v[188:189], v[44:45], v[56:57], v[188:189] op_sel_hi:[0,1,1] neg_lo:[1,0,0] neg_hi:[1,0,0]
v_pk_fma_f32 v[190:191], v[44:45], v[58:59], v[190:191] op_sel_hi:[0,1,1] neg_lo:[1,0,0] neg_hi:[1,0,0]
v_pk_mul_f32 v[188:189], v[44:45], v[188:189] op_sel:[1,0] op_sel_hi:[1,1]
v_pk_mul_f32 v[190:191], v[44:45], v[190:191] op_sel:[1,0] op_sel_hi:[1,1]
v_cvt_pk_bf16_f32 v188, v188, v189
v_cvt_pk_bf16_f32 v189, v190, v191
ds_write_b64 v14, v[188:189] offset:38528
v_pk_fma_f32 v[224:225], v[44:45], v[60:61], v[224:225] op_sel_hi:[0,1,1] neg_lo:[1,0,0] neg_hi:[1,0,0]
v_pk_fma_f32 v[226:227], v[44:45], v[62:63], v[226:227] op_sel_hi:[0,1,1] neg_lo:[1,0,0] neg_hi:[1,0,0]
v_pk_mul_f32 v[224:225], v[44:45], v[224:225] op_sel:[1,0] op_sel_hi:[1,1]
v_pk_mul_f32 v[226:227], v[44:45], v[226:227] op_sel:[1,0] op_sel_hi:[1,1]
v_cvt_pk_bf16_f32 v224, v224, v225
v_cvt_pk_bf16_f32 v225, v226, v227
ds_write_b64 v14, v[224:225] offset:38656
v_pk_fma_f32 v[156:157], v[46:47], v[52:53], v[156:157] op_sel_hi:[0,1,1] neg_lo:[1,0,0] neg_hi:[1,0,0]
v_pk_fma_f32 v[158:159], v[46:47], v[54:55], v[158:159] op_sel_hi:[0,1,1] neg_lo:[1,0,0] neg_hi:[1,0,0]
v_pk_mul_f32 v[156:157], v[46:47], v[156:157] op_sel:[1,0] op_sel_hi:[1,1]
v_pk_mul_f32 v[158:159], v[46:47], v[158:159] op_sel:[1,0] op_sel_hi:[1,1]
v_cvt_pk_bf16_f32 v156, v156, v157
v_cvt_pk_bf16_f32 v157, v158, v159
ds_write_b64 v14, v[156:157] offset:44800
v_pk_fma_f32 v[192:193], v[46:47], v[56:57], v[192:193] op_sel_hi:[0,1,1] neg_lo:[1,0,0] neg_hi:[1,0,0]
v_pk_fma_f32 v[194:195], v[46:47], v[58:59], v[194:195] op_sel_hi:[0,1,1] neg_lo:[1,0,0] neg_hi:[1,0,0]
v_pk_mul_f32 v[192:193], v[46:47], v[192:193] op_sel:[1,0] op_sel_hi:[1,1]
v_pk_mul_f32 v[194:195], v[46:47], v[194:195] op_sel:[1,0] op_sel_hi:[1,1]
v_cvt_pk_bf16_f32 v192, v192, v193
v_cvt_pk_bf16_f32 v193, v194, v195
ds_write_b64 v14, v[192:193] offset:44928
v_pk_fma_f32 v[228:229], v[46:47], v[60:61], v[228:229] op_sel_hi:[0,1,1] neg_lo:[1,0,0] neg_hi:[1,0,0]
v_pk_fma_f32 v[230:231], v[46:47], v[62:63], v[230:231] op_sel_hi:[0,1,1] neg_lo:[1,0,0] neg_hi:[1,0,0]
v_pk_mul_f32 v[228:229], v[46:47], v[228:229] op_sel:[1,0] op_sel_hi:[1,1]
v_pk_mul_f32 v[230:231], v[46:47], v[230:231] op_sel:[1,0] op_sel_hi:[1,1]
v_cvt_pk_bf16_f32 v228, v228, v229
v_cvt_pk_bf16_f32 v229, v230, v231
ds_write_b64 v14, v[228:229] offset:45056
v_pk_fma_f32 v[160:161], v[48:49], v[52:53], v[160:161] op_sel_hi:[0,1,1] neg_lo:[1,0,0] neg_hi:[1,0,0]
v_pk_fma_f32 v[162:163], v[48:49], v[54:55], v[162:163] op_sel_hi:[0,1,1] neg_lo:[1,0,0] neg_hi:[1,0,0]
v_pk_mul_f32 v[160:161], v[48:49], v[160:161] op_sel:[1,0] op_sel_hi:[1,1]
v_pk_mul_f32 v[162:163], v[48:49], v[162:163] op_sel:[1,0] op_sel_hi:[1,1]
v_cvt_pk_bf16_f32 v160, v160, v161
v_cvt_pk_bf16_f32 v161, v162, v163
ds_write_b64 v14, v[160:161] offset:51200
v_pk_fma_f32 v[196:197], v[48:49], v[56:57], v[196:197] op_sel_hi:[0,1,1] neg_lo:[1,0,0] neg_hi:[1,0,0]
v_pk_fma_f32 v[198:199], v[48:49], v[58:59], v[198:199] op_sel_hi:[0,1,1] neg_lo:[1,0,0] neg_hi:[1,0,0]
v_pk_mul_f32 v[196:197], v[48:49], v[196:197] op_sel:[1,0] op_sel_hi:[1,1]
v_pk_mul_f32 v[198:199], v[48:49], v[198:199] op_sel:[1,0] op_sel_hi:[1,1]
v_cvt_pk_bf16_f32 v196, v196, v197
v_cvt_pk_bf16_f32 v197, v198, v199
ds_write_b64 v14, v[196:197] offset:51328
v_pk_fma_f32 v[232:233], v[48:49], v[60:61], v[232:233] op_sel_hi:[0,1,1] neg_lo:[1,0,0] neg_hi:[1,0,0]
v_pk_fma_f32 v[234:235], v[48:49], v[62:63], v[234:235] op_sel_hi:[0,1,1] neg_lo:[1,0,0] neg_hi:[1,0,0]
v_pk_mul_f32 v[232:233], v[48:49], v[232:233] op_sel:[1,0] op_sel_hi:[1,1]
v_pk_mul_f32 v[234:235], v[48:49], v[234:235] op_sel:[1,0] op_sel_hi:[1,1]
v_cvt_pk_bf16_f32 v232, v232, v233
v_cvt_pk_bf16_f32 v233, v234, v235
ds_write_b64 v14, v[232:233] offset:51456
s_waitcnt lgkmcnt(0)
s_branch Latt_4
Lpf_3:
s_load_dwordx2 s[26:27], s[0:1], 64
s_or_b32 s43, s34, s35
s_cmp_lg_u32 s43, 0
s_cbranch_scc1 Lz_25
s_add_u32 s84, s32, 28311552
s_addc_u32 s85, s33, 0
s_mov_b32 s86, 40960
s_mov_b32 s87, 0x20000
v_lshlrev_b32 v14, 7, v1
v_mov_b32 v36, 0
v_mov_b32 v37, 0
s_mov_b32 s43, 0
buffer_store_dwordx2 v[36:37], v14, s[84:87], s43 offen sc1
s_mov_b32 s43, 8192
buffer_store_dwordx2 v[36:37], v14, s[84:87], s43 offen sc1
s_mov_b32 s43, 16384
buffer_store_dwordx2 v[36:37], v14, s[84:87], s43 offen sc1
s_mov_b32 s43, 24576
buffer_store_dwordx2 v[36:37], v14, s[84:87], s43 offen sc1
s_mov_b32 s43, 32768
buffer_store_dwordx2 v[36:37], v14, s[84:87], s43 offen sc1
Lz_25:
s_lshl_b32 s43, s51, 11
buffer_load_dwordx4 v[96:99], v10, s[8:11], s43 offen offset:0
buffer_load_dwordx4 v[100:103], v10, s[8:11], s43 offen offset:1024
buffer_load_dwordx4 v[104:107], v10, s[8:11], s43 offen offset:2048
buffer_load_dwordx4 v[108:111], v10, s[8:11], s43 offen offset:3072
v_min_u32 v14, 23, v1
v_lshrrev_b32 v15, 3, v14
v_mul_u32_u24 v15, 43008, v15
v_and_b32 v14, 7, v14
v_lshl_add_u32 v15, v14, 4, v15
v_mov_b32 v32, 0x3f803f80
v_mov_b32 v33, 0x3f803f80
v_mov_b32 v34, 0x3f803f80
v_mov_b32 v35, 0x3f803f80
ds_write_b128 v15, v[32:35]
v_add_u32 v14, 0, v1
v_min_u32 v14, 47, v14
v_mul_u32_u24 v15, 21846, v14
v_lshrrev_b32 v15, 16, v15
v_mul_u32_u24 v16, 3, v15
v_sub_u32 v16, v14, v16
s_mul_i32 s43, s48, 16
v_add_u32 v15, s43, v15
v_mul_u32_u24 v15, 6144, v15
v_lshl_add_u32 v2, v16, 11, v15
s_waitcnt lgkmcnt(0)
s_mov_b32 s56, s26
s_mov_b32 s57, s27
s_mov_b32 s58, 256
s_mov_b32 s59, 0x20000
v_lshlrev_b32 v14, 7, v1
s_barrier
s_cmp_ge_u32 s2, 128
s_cbranch_scc1 Lm_27
s_mov_b32 s84, s6
s_mov_b32 s85, s7
s_mov_b32 s86, 6291456
s_mov_b32 s87, 0x20000
s_mul_i32 s43, s2, 24576
buffer_load_dword v31, v14, s[84:87], s43 offen
s_add_u32 s43, s43, 8192
buffer_load_dword v31, v14, s[84:87], s43 offen
s_add_u32 s43, s43, 8192
buffer_load_dword v31, v14, s[84:87], s43 offen
Lm_27:
s_mov_b32 s84, s6
s_mov_b32 s85, s7
s_mov_b32 s86, 6291456
s_mov_b32 s87, 0x20000
s_lshr_b32 s44, s2, 3
s_lshr_b32 s43, s2, 5
s_cmp_eq_u32 s43, 3
s_cbranch_scc1 Lsj_28
s_cmp_gt_u32 s43, 3
s_cselect_b32 s43, 32, 0
s_sub_u32 s43, s2, s43
s_lshr_b32 s43, s43, 1
s_and_b32 s44, s2, 1
s_lshl_b32 s44, s44, 3
s_add_u32 s44, s44, 32
s_load_dwordx2 s[80:81], s[0:1], s44
s_mul_i32 s45, s43, 2341
s_lshr_b32 s45, s45, 16
s_mul_i32 s46, s45, 28
s_sub_u32 s46, s43, s46
s_lshl_b32 s45, s45, 8
s_mul_i32 s44, s47, 18
s_add_u32 s45, s45, s44
s_add_u32 s45, s45, 184
s_mul_i32 s45, s45, 7168
s_lshl_b32 s46, s46, 8
s_add_u32 s45, s45, s46
s_waitcnt lgkmcnt(0)
s_add_u32 s80, s80, s45
s_addc_u32 s81, s81, 0
Lsj_28:
s_barrier
s_cmp_ge_u32 s2, 128
s_cbranch_scc0 Lm_29
s_mov_b32 s84, s6
s_mov_b32 s85, s7
s_mov_b32 s86, 6291456
s_mov_b32 s87, 0x20000
s_mul_i32 s43, s2, 24576
buffer_load_dword v31, v14, s[84:87], s43 offen
s_add_u32 s43, s43, 8192
buffer_load_dword v31, v14, s[84:87], s43 offen
s_add_u32 s43, s43, 8192
buffer_load_dword v31, v14, s[84:87], s43 offen
Lm_29:
s_barrier
s_getpc_b64 s[88:89]
Lpc_30:
s_sub_u32 s88, s88, Lpc_30-sequential_preLN__sliding_local_dilated__glu_gated_geglu__prompt_kernel
s_subb_u32 s89, s89, 0
s_lshr_b32 s43, s2, 3
s_mul_i32 s43, s43, 3840
v_min_u32 v15, 29, v1
v_lshl_add_u32 v15, v15, 7, s43
v_min_u32 v15, Ldone_1-sequential_preLN__sliding_local_dilated__glu_gated_geglu__prompt_kernel, v15
global_load_dword v31, v15, s[88:89]
s_or_b32 s43, s34, s35
s_cmp_lg_u32 s43, 0
s_cbranch_scc1 Lz_31
s_waitcnt vmcnt(0)
v_mov_b32 v5, 1
v_mov_b32 v6, 0
s_mov_b64 exec, 1
buffer_store_dword v5, v6, s[56:59], 0 offen sc1
s_mov_b64 exec, -1
Lz_31:
s_waitcnt vmcnt(1)
v_lshlrev_b32 v116, 16, v96
v_and_b32 v117, 0xffff0000, v96
v_mul_f32 v118, v116, v116
v_mul_f32 v119, v117, v117
v_lshlrev_b32 v126, 16, v97
v_and_b32 v127, 0xffff0000, v97
v_add_f32 v116, v116, v126
v_add_f32 v117, v117, v127
v_fmac_f32 v118, v126, v126
v_fmac_f32 v119, v127, v127
v_lshlrev_b32 v124, 16, v98
v_and_b32 v125, 0xffff0000, v98
v_add_f32 v116, v116, v124
v_add_f32 v117, v117, v125
v_fmac_f32 v118, v124, v124
v_fmac_f32 v119, v125, v125
v_lshlrev_b32 v126, 16, v99
v_and_b32 v127, 0xffff0000, v99
v_add_f32 v116, v116, v126
v_add_f32 v117, v117, v127
v_fmac_f32 v118, v126, v126
v_fmac_f32 v119, v127, v127
v_lshlrev_b32 v124, 16, v100
v_and_b32 v125, 0xffff0000, v100
v_add_f32 v116, v116, v124
v_add_f32 v117, v117, v125
v_fmac_f32 v118, v124, v124
v_fmac_f32 v119, v125, v125
v_lshlrev_b32 v126, 16, v101
v_and_b32 v127, 0xffff0000, v101
v_add_f32 v116, v116, v126
v_add_f32 v117, v117, v127
v_fmac_f32 v118, v126, v126
v_fmac_f32 v119, v127, v127
v_lshlrev_b32 v124, 16, v102
v_and_b32 v125, 0xffff0000, v102
v_add_f32 v116, v116, v124
v_add_f32 v117, v117, v125
v_fmac_f32 v118, v124, v124
v_fmac_f32 v119, v125, v125
v_lshlrev_b32 v126, 16, v103
v_and_b32 v127, 0xffff0000, v103
v_add_f32 v116, v116, v126
v_add_f32 v117, v117, v127
v_fmac_f32 v118, v126, v126
v_fmac_f32 v119, v127, v127
v_lshlrev_b32 v120, 16, v104
v_and_b32 v121, 0xffff0000, v104
v_mul_f32 v122, v120, v120
v_mul_f32 v123, v121, v121
s_barrier
s_cmp_lt_u32 s2, 128
s_cbranch_scc1 Lm_32
s_mov_b32 s84, s6
s_mov_b32 s85, s7
s_mov_b32 s86, 6291456
s_mov_b32 s87, 0x20000
s_lshr_b32 s44, s2, 3
s_and_b32 s43, s35, 8
s_or_b32 s43, s43, 3
s_lshl_b32 s43, s43, 7
s_mul_i32 s45, s44, 196608
s_add_u32 s43, s43, s45
v_add_u32 v15, 0, v1
v_min_u32 v15, 95, v15
v_mul_u32_u24 v16, 21846, v15
v_lshrrev_b32 v16, 16, v16
v_mul_u32_u24 v17, 3, v16
v_sub_u32 v15, v15, v17
v_mul_u32_u24 v16, 6144, v16
v_lshl_add_u32 v15, v15, 11, v16
buffer_load_dword v31, v15, s[84:87], s43 offen
v_add_u32 v15, 64, v1
v_min_u32 v15, 95, v15
v_mul_u32_u24 v16, 21846, v15
v_lshrrev_b32 v16, 16, v16
v_mul_u32_u24 v17, 3, v16
v_sub_u32 v15, v15, v17
v_mul_u32_u24 v16, 6144, v16
v_lshl_add_u32 v15, v15, 11, v16
buffer_load_dword v31, v15, s[84:87], s43 offen
Lm_32:
v_lshlrev_b32 v126, 16, v105
v_and_b32 v127, 0xffff0000, v105
v_add_f32 v120, v120, v126
v_add_f32 v121, v121, v127
v_fmac_f32 v122, v126, v126
v_fmac_f32 v123, v127, v127
v_lshlrev_b32 v124, 16, v106
v_and_b32 v125, 0xffff0000, v106
v_add_f32 v120, v120, v124
v_add_f32 v121, v121, v125
v_fmac_f32 v122, v124, v124
v_fmac_f32 v123, v125, v125
v_lshlrev_b32 v126, 16, v107
v_and_b32 v127, 0xffff0000, v107
v_add_f32 v120, v120, v126
v_add_f32 v121, v121, v127
v_fmac_f32 v122, v126, v126
v_fmac_f32 v123, v127, v127
v_lshlrev_b32 v124, 16, v108
v_and_b32 v125, 0xffff0000, v108
v_add_f32 v120, v120, v124
v_add_f32 v121, v121, v125
v_fmac_f32 v122, v124, v124
v_fmac_f32 v123, v125, v125
v_lshlrev_b32 v126, 16, v109
v_and_b32 v127, 0xffff0000, v109
v_add_f32 v120, v120, v126
v_add_f32 v121, v121, v127
v_fmac_f32 v122, v126, v126
v_fmac_f32 v123, v127, v127
v_lshlrev_b32 v124, 16, v110
v_and_b32 v125, 0xffff0000, v110
v_add_f32 v120, v120, v124
v_add_f32 v121, v121, v125
v_fmac_f32 v122, v124, v124
v_fmac_f32 v123, v125, v125
v_lshlrev_b32 v126, 16, v111
v_and_b32 v127, 0xffff0000, v111
v_add_f32 v120, v120, v126
v_add_f32 v121, v121, v127
v_fmac_f32 v122, v126, v126
v_fmac_f32 v123, v127, v127
v_add_f32 v116, v116, v117
v_add_f32 v118, v118, v119
v_add_f32 v120, v120, v121
v_add_f32 v122, v122, v123
v_add_f32_dpp v116, v116, v116 row_ror:8 row_mask:0xf bank_mask:0xf
v_add_f32_dpp v118, v118, v118 row_ror:8 row_mask:0xf bank_mask:0xf
v_add_f32_dpp v120, v120, v120 row_ror:8 row_mask:0xf bank_mask:0xf
v_add_f32_dpp v122, v122, v122 row_ror:8 row_mask:0xf bank_mask:0xf
s_barrier
v_add_f32_dpp v116, v116, v116 row_ror:4 row_mask:0xf bank_mask:0xf
v_add_f32_dpp v118, v118, v118 row_ror:4 row_mask:0xf bank_mask:0xf
v_add_f32_dpp v120, v120, v120 row_ror:4 row_mask:0xf bank_mask:0xf
v_add_f32_dpp v122, v122, v122 row_ror:4 row_mask:0xf bank_mask:0xf
v_add_f32_dpp v116, v116, v116 row_ror:2 row_mask:0xf bank_mask:0xf
v_add_f32_dpp v118, v118, v118 row_ror:2 row_mask:0xf bank_mask:0xf
v_add_f32_dpp v120, v120, v120 row_ror:2 row_mask:0xf bank_mask:0xf
v_add_f32_dpp v122, v122, v122 row_ror:2 row_mask:0xf bank_mask:0xf
v_add_f32_dpp v116, v116, v116 row_ror:1 row_mask:0xf bank_mask:0xf
v_add_f32_dpp v118, v118, v118 row_ror:1 row_mask:0xf bank_mask:0xf
v_add_f32_dpp v120, v120, v120 row_ror:1 row_mask:0xf bank_mask:0xf
v_add_f32_dpp v122, v122, v122 row_ror:1 row_mask:0xf bank_mask:0xf
v_mov_b32 v117, v116
v_mov_b32 v119, v118
v_mov_b32 v121, v120
v_mov_b32 v123, v122
s_nop 0
v_permlane16_swap_b32 v116, v117
v_permlane16_swap_b32 v118, v119
v_permlane16_swap_b32 v120, v121
v_permlane16_swap_b32 v122, v123
v_add_f32 v116, v116, v117
v_add_f32 v118, v118, v119
v_add_f32 v120, v120, v121
v_add_f32 v122, v122, v123
v_mov_b32 v117, v116
v_mov_b32 v119, v118
v_mov_b32 v121, v120
v_mov_b32 v123, v122
s_nop 0
v_permlane32_swap_b32 v116, v117
v_permlane32_swap_b32 v118, v119
v_permlane32_swap_b32 v120, v121
v_permlane32_swap_b32 v122, v123
v_add_f32 v116, v116, v117
v_add_f32 v118, v118, v119
v_add_f32 v120, v120, v121
v_add_f32 v122, v122, v123
v_mul_f32 v112, 0x3a800000, v116
v_mul_f32 v113, 0x3a800000, v118
v_fma_f32 v113, -v112, v112, v113
v_max_f32 v113, 0, v113
v_add_f32 v113, 0x3727c5ac, v113
v_rsq_f32 v113, v113
v_mul_f32 v114, 0x3a800000, v120
v_mul_f32 v115, 0x3a800000, v122
v_fma_f32 v115, -v114, v114, v115
v_max_f32 v115, 0, v115
v_add_f32 v115, 0x3727c5ac, v115
v_rsq_f32 v115, v115
s_nop 0
s_lshl_b32 s43, s47, 4
s_add_u32 s43, s43, 130176
v_mov_b32 v11, s43
ds_write_b128 v11, v[112:115]
s_waitcnt lgkmcnt(0)
s_barrier
v_lshlrev_b32 v5, 4, v1
v_and_b32 v5, 63, v5
v_add_u32 v6, 130176, v5
ds_read_b128 v[112:115], v6
s_lshl_b32 s43, s63, 3
v_add_u32 v5, s43, v5
s_waitcnt lgkmcnt(0)
s_mov_b64 exec, 15
buffer_store_dwordx4 v[112:115], v5, s[20:23], 0 offen sc1
s_mov_b64 exec, -1
v_mov_b32 v7, 0
v_mov_b32 v9, 1
buffer_load_dword v8, v7, s[56:59], 0 offen sc1
s_load_dword s64, s[80:81], 0
s_load_dword s65, s[80:81], 64
s_load_dword s66, s[80:81], 128
s_load_dword s67, s[80:81], 192
s_load_dword s68, s[80:81], 7168
s_load_dword s69, s[80:81], 7232
s_load_dword s70, s[80:81], 7296
s_load_dword s71, s[80:81], 7360
s_add_u32 s80, s80, 14336
s_addc_u32 s81, s81, 0
s_barrier
s_load_dword s64, s[80:81], 0
s_load_dword s65, s[80:81], 64
s_load_dword s66, s[80:81], 128
s_load_dword s67, s[80:81], 192
s_load_dword s68, s[80:81], 7168
s_load_dword s69, s[80:81], 7232
s_load_dword s70, s[80:81], 7296
s_load_dword s71, s[80:81], 7360
s_add_u32 s80, s80, 14336
s_addc_u32 s81, s81, 0
s_barrier
s_mov_b32 s41, 0x10000
Lpoll_33:
s_waitcnt vmcnt(0)
Lpf_35:
v_cmp_ne_u32 vcc, v9, v8
s_nop 4
s_cbranch_vccz Lpok_34
buffer_load_dword v8, v7, s[56:59], 0 offen sc1
s_sub_u32 s41, s41, 1
s_cmp_lg_u32 s41, 0
s_cbranch_scc1 Lpoll_33
s_waitcnt vmcnt(0)
Lpok_34:
s_add_u32 s56, s32, 28311552
s_addc_u32 s57, s33, 0
s_mov_b32 s58, 40960
s_mov_b32 s59, 0x20000
s_add_u32 s43, s34, 80
s_lshl_b32 s43, s43, 7
v_mov_b32 v5, s43
v_mov_b32 v6, 1
s_mov_b64 exec, 1
buffer_atomic_add v6, v5, s[56:59], 0 offen sc1
s_mov_b64 exec, -1
s_load_dword s64, s[80:81], 0
s_load_dword s65, s[80:81], 64
s_load_dword s66, s[80:81], 128
s_load_dword s67, s[80:81], 192
s_load_dword s68, s[80:81], 7168
s_load_dword s69, s[80:81], 7232
s_load_dword s70, s[80:81], 7296
s_load_dword s71, s[80:81], 7360
s_add_u32 s80, s80, 14336
s_addc_u32 s81, s81, 0
s_barrier
s_load_dword s64, s[80:81], 0
s_load_dword s65, s[80:81], 64
s_load_dword s66, s[80:81], 128
s_load_dword s67, s[80:81], 192
s_load_dword s68, s[80:81], 7168
s_load_dword s69, s[80:81], 7232
s_load_dword s70, s[80:81], 7296
s_load_dword s71, s[80:81], 7360
s_add_u32 s80, s80, 14336
s_addc_u32 s81, s81, 0
s_barrier
s_load_dword s64, s[80:81], 0
s_load_dword s65, s[80:81], 64
s_load_dword s66, s[80:81], 128
s_load_dword s67, s[80:81], 192
s_load_dword s68, s[80:81], 7168
s_load_dword s69, s[80:81], 7232
s_load_dword s70, s[80:81], 7296
s_load_dword s71, s[80:81], 7360
s_add_u32 s80, s80, 14336
s_addc_u32 s81, s81, 0
s_barrier
s_getpc_b64 s[88:89]
Lpc_36:
s_sub_u32 s88, s88, Lpc_36-sequential_preLN__sliding_local_dilated__glu_gated_geglu__prompt_kernel
s_subb_u32 s89, s89, 0
s_lshr_b32 s43, s2, 3
s_mul_i32 s43, s43, 3840
v_min_u32 v15, 29, v1
v_lshl_add_u32 v15, v15, 7, s43
v_min_u32 v15, Ldone_1-sequential_preLN__sliding_local_dilated__glu_gated_geglu__prompt_kernel, v15
global_load_dword v31, v15, s[88:89]
s_sub_u32 s44, s34, 1
s_max_i32 s44, s44, 0
v_mov_b32 v5, s44
v_mov_b32 v6, s34
v_cmp_eq_u32 vcc, 0, v1
s_nop 1
v_cndmask_b32 v5, v5, v6, vcc
v_add_u32 v5, 80, v5
v_lshlrev_b32 v5, 7, v5
buffer_load_dword v6, v5, s[56:59], 0 offen sc1
s_load_dword s64, s[80:81], 0
s_load_dword s65, s[80:81], 64
s_load_dword s66, s[80:81], 128
s_load_dword s67, s[80:81], 192
s_load_dword s68, s[80:81], 7168
s_load_dword s69, s[80:81], 7232
s_load_dword s70, s[80:81], 7296
s_load_dword s71, s[80:81], 7360
s_add_u32 s80, s80, 14336
s_addc_u32 s81, s81, 0
s_barrier
s_load_dword s64, s[80:81], 0
s_load_dword s65, s[80:81], 64
s_load_dword s66, s[80:81], 128
s_load_dword s67, s[80:81], 192
s_load_dword s68, s[80:81], 7168
s_load_dword s69, s[80:81], 7232
s_load_dword s70, s[80:81], 7296
s_load_dword s71, s[80:81], 7360
s_add_u32 s80, s80, 14336
s_addc_u32 s81, s81, 0
s_barrier
v_mov_b32 v7, 16
s_mov_b32 s41, 0x10000
Lpoll_37:
s_waitcnt vmcnt(0)
Lpf_39:
v_cmp_ne_u32 vcc, v7, v6
s_nop 4
s_cbranch_vccz Lpok_38
buffer_load_dword v6, v5, s[56:59], 0 offen sc1
s_sub_u32 s41, s41, 1
s_cmp_lg_u32 s41, 0
s_cbranch_scc1 Lpoll_37
s_waitcnt vmcnt(0)
Lpok_38:
v_add_u32 v5, 0, v1
v_min_u32 v5, 143, v5
v_lshlrev_b32 v20, 3, v5
v_add_u32 v5, s50, v5
v_max_i32 v5, 0, v5
v_lshlrev_b32 v5, 3, v5
buffer_load_dwordx2 v[32:33], v5, s[20:23], 0 offen sc1
v_add_u32 v5, 64, v1
v_min_u32 v5, 143, v5
v_lshlrev_b32 v21, 3, v5
v_add_u32 v5, s50, v5
v_max_i32 v5, 0, v5
v_lshlrev_b32 v5, 3, v5
buffer_load_dwordx2 v[34:35], v5, s[20:23], 0 offen sc1
v_add_u32 v5, 128, v1
v_min_u32 v5, 143, v5
v_lshlrev_b32 v22, 3, v5
v_add_u32 v5, s50, v5
v_max_i32 v5, 0, v5
v_lshlrev_b32 v5, 3, v5
buffer_load_dwordx2 v[36:37], v5, s[20:23], 0 offen sc1
s_load_dword s64, s[80:81], 0
s_load_dword s65, s[80:81], 64
s_load_dword s66, s[80:81], 128
s_load_dword s67, s[80:81], 192
s_load_dword s68, s[80:81], 7168
s_load_dword s69, s[80:81], 7232
s_load_dword s70, s[80:81], 7296
s_load_dword s71, s[80:81], 7360
s_add_u32 s80, s80, 14336
s_addc_u32 s81, s81, 0
s_barrier
s_load_dwordx2 s[88:89], s[0:1], 16
v_lshlrev_b32 v29, 7, v1
s_lshl_b32 s43, s2, 13
s_waitcnt lgkmcnt(0)
s_mov_b32 s84, s88
s_mov_b32 s85, s89
s_mov_b32 s86, 2097152
s_mov_b32 s87, 0x20000
buffer_load_dword v30, v29, s[84:87], s43 offen
v_and_b32 v29, 31, v1
v_lshlrev_b32 v29, 11, v29
s_and_b32 s43, s35, 8
s_or_b32 s43, s43, 3
s_lshl_b32 s43, s43, 7
s_lshr_b32 s44, s2, 3
s_lshl_b32 s44, s44, 16
s_add_u32 s43, s43, s44
buffer_load_dword v30, v29, s[84:87], s43 offen
s_barrier
s_waitcnt vmcnt(2)
v_add_u32 v20, 129024, v20
ds_write_b64 v20, v[32:33]
v_add_u32 v21, 129024, v21
ds_write_b64 v21, v[34:35]
v_add_u32 v22, 129024, v22
ds_write_b64 v22, v[36:37]
s_waitcnt lgkmcnt(0)
s_lshr_b32 s43, s2, 5
s_cmp_eq_u32 s43, 3
s_cbranch_scc1 Lnj_40
s_cmp_gt_u32 s43, 3
s_cselect_b32 s43, 32, 0
s_sub_u32 s43, s2, s43
s_lshr_b32 s43, s43, 1
s_and_b32 s44, s2, 1
s_lshl_b32 s45, s44, 3
s_add_u32 s45, s45, 32
s_load_dwordx2 s[88:89], s[0:1], s45
s_mul_i32 s45, s43, 2341
s_lshr_b32 s45, s45, 16
s_mul_i32 s46, s45, 28
s_sub_u32 s46, s43, s46
v_lshrrev_b32 v28, 4, v1
s_lshl_b32 s43, s45, 8
v_add_u32 v28, s43, v28
v_mul_u32_u24 v28, 7168, v28
v_and_b32 v29, 15, v1
v_lshl_add_u32 v28, v29, 4, v28
s_lshl_b32 s43, s46, 8
v_add_u32 v28, s43, v28
s_waitcnt lgkmcnt(0)
s_mov_b32 s84, s88
s_mov_b32 s85, s89
s_mov_b32 s86, 7340032
s_mov_b32 s87, 0x20000
s_mov_b32 s43, 0
buffer_load_dwordx4 v[128:131], v28, s[84:87], s43 offen
s_mov_b32 s43, 28672
buffer_load_dwordx4 v[132:135], v28, s[84:87], s43 offen
s_mov_b32 s43, 57344
buffer_load_dwordx4 v[136:139], v28, s[84:87], s43 offen
s_mov_b32 s43, 86016
buffer_load_dwordx4 v[140:143], v28, s[84:87], s43 offen
s_mov_b32 s43, 114688
buffer_load_dwordx4 v[144:147], v28, s[84:87], s43 offen
s_mov_b32 s43, 143360
buffer_load_dwordx4 v[148:151], v28, s[84:87], s43 offen
s_mov_b32 s43, 172032
buffer_load_dwordx4 v[152:155], v28, s[84:87], s43 offen
s_mov_b32 s43, 200704
buffer_load_dwordx4 v[156:159], v28, s[84:87], s43 offen
s_mov_b32 s43, 229376
buffer_load_dwordx4 v[160:163], v28, s[84:87], s43 offen
s_mov_b32 s43, 258048
buffer_load_dwordx4 v[164:167], v28, s[84:87], s43 offen
s_mov_b32 s43, 286720
buffer_load_dwordx4 v[168:171], v28, s[84:87], s43 offen
s_mov_b32 s43, 315392
buffer_load_dwordx4 v[172:175], v28, s[84:87], s43 offen
s_mov_b32 s43, 344064
buffer_load_dwordx4 v[176:179], v28, s[84:87], s43 offen
s_mov_b32 s43, 372736
buffer_load_dwordx4 v[180:183], v28, s[84:87], s43 offen
s_mov_b32 s43, 401408
buffer_load_dwordx4 v[184:187], v28, s[84:87], s43 offen
s_mov_b32 s43, 430080
buffer_load_dwordx4 v[188:191], v28, s[84:87], s43 offen
Lnj_40:
s_barrier
s_lshr_b32 s43, s2, 5
s_cmp_eq_u32 s43, 3
s_cbranch_scc1 Lnj_41
s_cmp_gt_u32 s43, 3
s_cselect_b32 s43, 32, 0
s_sub_u32 s43, s2, s43
s_lshr_b32 s43, s43, 1
s_and_b32 s44, s2, 1
s_lshl_b32 s45, s44, 3
s_add_u32 s45, s45, 32
s_load_dwordx2 s[88:89], s[0:1], s45
s_mul_i32 s45, s43, 2341
s_lshr_b32 s45, s45, 16
s_mul_i32 s46, s45, 28
s_sub_u32 s46, s43, s46
v_lshrrev_b32 v28, 4, v1
s_lshl_b32 s43, s45, 8
v_add_u32 v28, s43, v28
v_mul_u32_u24 v28, 7168, v28
v_and_b32 v29, 15, v1
v_lshl_add_u32 v28, v29, 4, v28
s_lshl_b32 s43, s46, 8
v_add_u32 v28, s43, v28
s_waitcnt lgkmcnt(0)
s_mov_b32 s84, s88
s_mov_b32 s85, s89
s_mov_b32 s86, 7340032
s_mov_b32 s87, 0x20000
s_mov_b32 s43, 458752
buffer_load_dwordx4 v[192:195], v28, s[84:87], s43 offen
s_mov_b32 s43, 487424
buffer_load_dwordx4 v[196:199], v28, s[84:87], s43 offen
s_mov_b32 s43, 516096
buffer_load_dwordx4 v[200:203], v28, s[84:87], s43 offen
s_mov_b32 s43, 544768
buffer_load_dwordx4 v[204:207], v28, s[84:87], s43 offen
s_mov_b32 s43, 573440
buffer_load_dwordx4 v[208:211], v28, s[84:87], s43 offen
s_mov_b32 s43, 602112
buffer_load_dwordx4 v[212:215], v28, s[84:87], s43 offen
s_mov_b32 s43, 630784
buffer_load_dwordx4 v[216:219], v28, s[84:87], s43 offen
s_mov_b32 s43, 659456
buffer_load_dwordx4 v[220:223], v28, s[84:87], s43 offen
s_mov_b32 s43, 688128
buffer_load_dwordx4 v[224:227], v28, s[84:87], s43 offen
s_mov_b32 s43, 716800
buffer_load_dwordx4 v[228:231], v28, s[84:87], s43 offen
s_mov_b32 s43, 745472
buffer_load_dwordx4 v[232:235], v28, s[84:87], s43 offen
s_mov_b32 s43, 774144
buffer_load_dwordx4 v[236:239], v28, s[84:87], s43 offen
s_mov_b32 s43, 802816
buffer_load_dwordx4 v[240:243], v28, s[84:87], s43 offen
s_mov_b32 s43, 831488
buffer_load_dwordx4 v[244:247], v28, s[84:87], s43 offen
s_mov_b32 s43, 860160
buffer_load_dwordx4 v[248:251], v28, s[84:87], s43 offen
s_mov_b32 s43, 888832
buffer_load_dwordx4 v[252:255], v28, s[84:87], s43 offen
Lnj_41:
s_barrier
s_branch Lw_42
Lr_43:
s_branch Lw_44
Lr_45:
s_waitcnt lgkmcnt(0)
s_and_b32 s43, s36, 1
s_lshr_b32 s44, s36, 1
s_and_b32 s44, s44, 1
s_lshr_b32 s45, s36, 2
v_lshlrev_b32 v14, 2, v13
v_sub_u32 v14, v12, v14
v_subrev_u32 v15, 0, v14
v_cmp_ge_u32 s[52:53], 7, v15
v_add_u32 v15, 16, v15
v_cmp_ge_u32 s[84:85], 7, v15
v_subrev_u32 v15, 1, v14
v_cmp_ge_u32 s[54:55], 7, v15
v_add_u32 v15, 16, v15
v_cmp_ge_u32 s[86:87], 7, v15
v_subrev_u32 v15, 2, v14
v_cmp_ge_u32 s[56:57], 7, v15
v_add_u32 v15, 16, v15
v_cmp_ge_u32 s[88:89], 7, v15
v_subrev_u32 v15, 3, v14
v_cmp_ge_u32 s[58:59], 7, v15
v_add_u32 v15, 16, v15
v_cmp_ge_u32 s[90:91], 7, v15
s_lshl_b32 s46, s45, 6
s_add_u32 s46, s46, s44
s_add_u32 s46, s46, 16
v_lshl_add_u32 v14, v12, 1, s46
s_lshl_b32 s47, s43, 6
v_lshl_add_u32 v15, v13, 4, s47
v_mul_u32_u24 v20, 400, v14
v_add_u32 v20, v20, v15
v_subrev_u32 v16, 32, v14
v_max_i32 v16, 0, v16
v_mul_u32_u24 v21, 400, v16
v_add_u32 v21, v21, v15
v_lshrrev_b32 v16, 2, v12
v_lshl_add_u32 v16, v13, 2, v16
v_lshl_add_u32 v16, v16, 1, s46
v_and_b32 v17, 3, v1
v_lshl_add_u32 v17, v17, 3, s47
v_mul_u32_u24 v22, 400, v16
v_add_u32 v22, v22, v17
v_subrev_u32 v16, 32, v16
v_max_i32 v16, 0, v16
v_mul_u32_u24 v23, 400, v16
v_add_u32 v23, v23, v17
s_lshl_b32 s60, s43, 13
s_lshl_b32 s61, s45, 10
s_add_u32 s60, s60, s61
s_lshl_b32 s61, s44, 8
s_add_u32 s60, s60, s61
v_lshlrev_b32 v27, 11, v13
v_lshl_add_u32 v27, v12, 4, v27
v_add_u32 v27, s60, v27
v_mov_b32 v28, 0xff800000
s_mov_b32 s61, 0x3e8293ee
s_nop 2
s_or_b32 s62, s34, s45
s_cmp_lg_u32 s62, 0
s_cselect_b64 s[64:65], s[84:85], 0
s_cselect_b64 s[66:67], s[86:87], 0
s_cselect_b64 s[68:69], s[88:89], 0
s_cselect_b64 s[70:71], s[90:91], 0
.p2align 3
Latt_4:
s_barrier
ds_read_b128 v[32:35], v20 offset:0
ds_read_b128 v[36:39], v20 offset:128
ds_read_b128 v[40:43], v21 offset:128
ds_read_b128 v[80:83], v20 offset:12800
ds_read_b128 v[84:87], v20 offset:12928
ds_read_b128 v[88:91], v20 offset:128
ds_read_b64_tr_b16 v[44:45], v23 offset:256
ds_read_b64_tr_b16 v[46:47], v22 offset:256
ds_read_b64_tr_b16 v[48:49], v23 offset:288
ds_read_b64_tr_b16 v[50:51], v22 offset:288
ds_read_b64_tr_b16 v[92:93], v22 offset:256
ds_read_b64_tr_b16 v[94:95], v22 offset:13056
ds_read_b64_tr_b16 v[96:97], v22 offset:288
ds_read_b64_tr_b16 v[98:99], v22 offset:13088
s_waitcnt lgkmcnt(11)
v_mfma_f32_16x16x32_bf16 v[52:55], v[40:43], v[32:35], 0
v_mfma_f32_16x16x32_bf16 v[56:59], v[36:39], v[32:35], 0
s_waitcnt lgkmcnt(8)
v_mfma_f32_16x16x32_bf16 v[100:103], v[88:91], v[80:83], 0
v_mfma_f32_16x16x32_bf16 v[104:107], v[84:87], v[80:83], 0
s_nop 7
v_cndmask_b32 v52, v28, v52, s[64:65]
v_cndmask_b32 v100, v28, v100, s[84:85]
v_cndmask_b32 v53, v28, v53, s[66:67]
v_cndmask_b32 v101, v28, v101, s[86:87]
v_cndmask_b32 v54, v28, v54, s[68:69]
v_cndmask_b32 v102, v28, v102, s[88:89]
v_cndmask_b32 v55, v28, v55, s[70:71]
v_cndmask_b32 v103, v28, v103, s[90:91]
v_cndmask_b32 v56, v28, v56, s[52:53]
v_cndmask_b32 v104, v28, v104, s[52:53]
v_cndmask_b32 v57, v28, v57, s[54:55]
v_cndmask_b32 v105, v28, v105, s[54:55]
v_cndmask_b32 v58, v28, v58, s[56:57]
v_cndmask_b32 v106, v28, v106, s[56:57]
v_cndmask_b32 v59, v28, v59, s[58:59]
v_cndmask_b32 v107, v28, v107, s[58:59]
v_max3_f32 v60, v52, v53, v54
v_max3_f32 v108, v100, v101, v102
v_max3_f32 v61, v55, v56, v57
v_max3_f32 v109, v103, v104, v105
v_max3_f32 v60, v60, v58, v59
v_max3_f32 v108, v108, v106, v107
v_max_f32 v60, v60, v61
v_max_f32 v108, v108, v109
v_mov_b32 v61, v60
v_mov_b32 v109, v108
s_nop 0
v_permlane32_swap_b32 v60, v61
v_permlane32_swap_b32 v108, v109
v_max_f32 v60, v60, v61
v_max_f32 v108, v108, v109
v_mov_b32 v61, v60
v_mov_b32 v109, v108
s_nop 0
v_permlane16_swap_b32 v60, v61
v_permlane16_swap_b32 v108, v109
v_max_f32 v60, v60, v61
v_max_f32 v108, v108, v109
v_mul_f32 v60, s61, v60
v_mul_f32 v108, s61, v108
v_fma_f32 v52, v52, s61, -v60
v_fma_f32 v100, v100, s61, -v108
v_fma_f32 v53, v53, s61, -v60
v_fma_f32 v101, v101, s61, -v108
v_fma_f32 v54, v54, s61, -v60
v_fma_f32 v102, v102, s61, -v108
v_fma_f32 v55, v55, s61, -v60
v_fma_f32 v103, v103, s61, -v108
v_fma_f32 v56, v56, s61, -v60
v_fma_f32 v104, v104, s61, -v108
v_fma_f32 v57, v57, s61, -v60
v_fma_f32 v105, v105, s61, -v108
v_fma_f32 v58, v58, s61, -v60
v_fma_f32 v106, v106, s61, -v108
v_fma_f32 v59, v59, s61, -v60
v_fma_f32 v107, v107, s61, -v108
v_exp_f32 v52, v52
v_exp_f32 v100, v100
v_exp_f32 v53, v53
v_exp_f32 v101, v101
v_exp_f32 v54, v54
v_exp_f32 v102, v102
v_exp_f32 v55, v55
v_exp_f32 v103, v103
v_exp_f32 v56, v56
v_exp_f32 v104, v104
v_exp_f32 v57, v57
v_exp_f32 v105, v105
v_exp_f32 v58, v58
v_exp_f32 v106, v106
v_exp_f32 v59, v59
v_exp_f32 v107, v107
v_cvt_pk_bf16_f32 v64, v52, v53
v_cvt_pk_bf16_f32 v112, v100, v101
v_cvt_pk_bf16_f32 v65, v54, v55
v_cvt_pk_bf16_f32 v113, v102, v103
v_cvt_pk_bf16_f32 v66, v56, v57
v_cvt_pk_bf16_f32 v114, v104, v105
v_cvt_pk_bf16_f32 v67, v58, v59
v_cvt_pk_bf16_f32 v115, v106, v107
s_waitcnt lgkmcnt(0)
v_mfma_f32_16x16x32_bf16 v[68:71], v[44:47], v[64:67], 0
v_mfma_f32_16x16x32_bf16 v[72:75], v[48:51], v[64:67], 0
v_mfma_f32_16x16x32_bf16 v[116:119], v[92:95], v[112:115], 0
v_mfma_f32_16x16x32_bf16 v[120:123], v[96:99], v[112:115], 0
s_load_dwordx4 s[4:7], s[0:1], 32
s_load_dwordx2 s[28:29], s[0:1], 16
s_load_dwordx4 s[60:63], s[0:1], 48
v_add_f32 v60, v52, v53
v_add_f32 v108, v100, v101
v_add_f32 v61, v54, v55
v_add_f32 v109, v102, v103
v_add_f32 v56, v56, v57
v_add_f32 v104, v104, v105
v_add_f32 v58, v58, v59
v_add_f32 v106, v106, v107
v_add_f32 v60, v60, v61
v_add_f32 v108, v108, v109
v_add_f32 v56, v56, v58
v_add_f32 v104, v104, v106
v_add_f32 v60, v60, v56
v_add_f32 v108, v108, v104
v_mov_b32 v61, v60
v_mov_b32 v109, v108
s_nop 0
v_permlane32_swap_b32 v60, v61
v_permlane32_swap_b32 v108, v109
v_add_f32 v60, v60, v61
v_add_f32 v108, v108, v109
v_mov_b32 v61, v60
v_mov_b32 v109, v108
s_nop 0
v_permlane16_swap_b32 v60, v61
v_permlane16_swap_b32 v108, v109
v_add_f32 v60, v60, v61
v_add_f32 v108, v108, v109
v_rcp_f32 v60, v60
v_rcp_f32 v108, v108
s_nop 0
v_pk_mul_f32 v[68:69], v[60:61], v[68:69] op_sel_hi:[0,1]
v_pk_mul_f32 v[70:71], v[60:61], v[70:71] op_sel_hi:[0,1]
v_pk_mul_f32 v[72:73], v[60:61], v[72:73] op_sel_hi:[0,1]
v_pk_mul_f32 v[74:75], v[60:61], v[74:75] op_sel_hi:[0,1]
v_cvt_pk_bf16_f32 v68, v68, v69
v_cvt_pk_bf16_f32 v69, v70, v71
v_cvt_pk_bf16_f32 v70, v72, v73
v_cvt_pk_bf16_f32 v71, v74, v75
buffer_store_dwordx4 v[68:71], v27, s[16:19], 0 offen offset:0 sc1
v_pk_mul_f32 v[116:117], v[108:109], v[116:117] op_sel_hi:[0,1]
v_pk_mul_f32 v[118:119], v[108:109], v[118:119] op_sel_hi:[0,1]
v_pk_mul_f32 v[120:121], v[108:109], v[120:121] op_sel_hi:[0,1]
v_pk_mul_f32 v[122:123], v[108:109], v[122:123] op_sel_hi:[0,1]
v_cvt_pk_bf16_f32 v116, v116, v117
v_cvt_pk_bf16_f32 v117, v118, v119
v_cvt_pk_bf16_f32 v118, v120, v121
v_cvt_pk_bf16_f32 v119, v122, v123
buffer_store_dwordx4 v[116:119], v27, s[16:19], 0 offen offset:512 sc1
s_add_u32 s56, s32, 28311552
s_addc_u32 s57, s33, 0
s_mov_b32 s58, 40960
s_mov_b32 s59, 0x20000
v_and_b32 v17, 15, v1
v_lshrrev_b32 v18, 4, v1
s_lshr_b32 s46, s36, 1
s_and_b32 s46, s46, 1
s_and_b32 s47, s36, 1
s_and_b32 s51, s36, 3
s_bfe_u32 s49, s35, 0x20001
s_sub_u32 s43, 0, s49
s_and_b32 s43, s43, 3
s_cmp_ge_u32 s35, 8
s_cselect_b32 s49, s43, s49
s_lshl_b32 s49, s49, 2
s_lshr_b32 s43, s35, 3
s_lshl_b32 s43, s43, 1
s_add_u32 s49, s49, s43
s_and_b32 s43, s35, 1
s_add_u32 s49, s49, s43
s_waitcnt lgkmcnt(0)
s_cmp_ge_u32 s36, 4
s_cbranch_scc1 LG1_46
v_lshlrev_b32 v19, 11, v18
v_lshl_add_u32 v19, v17, 4, v19
s_lshl_b32 s43, s36, 9
v_add_u32 v2, s43, v19
v_add_u32 v4, 98304, v2
v_lshrrev_b32 v19, 2, v17
v_lshl_add_u32 v20, v18, 2, v19
v_bfe_u32 v21, v20, 1, 2
v_lshlrev_b32 v20, 7, v20
v_lshl_add_u32 v20, v21, 5, v20
v_and_b32 v19, 3, v1
v_lshl_add_u32 v20, v19, 3, v20
v_add_u32 v5, 0x10000, v20
v_xor_b32 v6, 32, v5
v_xor_b32 v7, 64, v5
v_xor_b32 v8, 96, v5
v_add_u32 v9, 0x10000, v5
v_add_u32 v10, 0x10000, v6
v_add_u32 v11, 0x10000, v7
v_add_u32 v12, 0x10000, v8
s_lshl_b32 s43, s34, 18
s_lshl_b32 s44, s35, 14
s_add_u32 s43, s43, s44
s_add_u32 s20, s32, s43
s_addc_u32 s21, s33, 0
s_add_u32 s20, s20, 4194304
s_addc_u32 s21, s21, 0
s_mov_b32 s22, 16384
s_mov_b32 s23, 0x20000
s_lshl_b32 s43, s34, 14
s_lshl_b32 s44, s35, 10
s_add_u32 s43, s43, s44
s_add_u32 s24, s32, s43
s_addc_u32 s25, s33, 0
s_add_u32 s24, s24, 25165824
s_addc_u32 s25, s25, 0
s_mov_b32 s26, 1024
s_mov_b32 s27, 0x20000
s_movk_i32 s50, 0x2000
v_lshrrev_b32 v19, 1, v18
v_lshl_add_u32 v19, v19, 4, v17
s_lshl_b32 s43, s36, 5
v_add_u32 v19, s43, v19
v_and_b32 v20, 1, v18
v_lshlrev_b32 v20, 2, v20
v_lshl_add_u32 v22, v19, 3, v20
s_lshl_b32 s43, s34, 18
s_add_u32 s12, s32, s43
s_addc_u32 s13, s33, 0
s_mov_b32 s14, 262144
s_mov_b32 s15, 0x20000
v_lshlrev_b32 v21, 4, v1
s_lshl_b32 s54, s36, 11
s_add_u32 s43, s35, 1
s_and_b32 s43, s43, 15
s_lshl_b32 s43, s43, 14
s_add_u32 s30, s43, s54
s_add_u32 s43, s35, 2
s_and_b32 s43, s43, 15
s_lshl_b32 s43, s43, 14
s_add_u32 s31, s43, s54
s_waitcnt vmcnt(0)
s_barrier
ds_write_b128 v27, v[68:71] offset:0
ds_write_b128 v27, v[116:119] offset:512
v_permlane16_swap_b32 v240, v242
v_permlane16_swap_b32 v241, v243
v_permlane16_swap_b32 v244, v246
v_permlane16_swap_b32 v245, v247
v_permlane16_swap_b32 v248, v250
v_permlane16_swap_b32 v249, v251
v_permlane16_swap_b32 v252, v254
v_permlane16_swap_b32 v253, v255
v_lshlrev_b32 v128, 16, v240
v_and_b32 v129, 0xffff0000, v240
v_lshlrev_b32 v130, 16, v241
v_and_b32 v131, 0xffff0000, v241
v_lshlrev_b32 v132, 16, v242
v_and_b32 v133, 0xffff0000, v242
v_lshlrev_b32 v134, 16, v243
v_and_b32 v135, 0xffff0000, v243
v_lshlrev_b32 v136, 16, v244
v_and_b32 v137, 0xffff0000, v244
v_lshlrev_b32 v138, 16, v245
v_and_b32 v139, 0xffff0000, v245
v_lshlrev_b32 v140, 16, v246
v_and_b32 v141, 0xffff0000, v246
v_lshlrev_b32 v142, 16, v247
v_and_b32 v143, 0xffff0000, v247
v_lshlrev_b32 v144, 16, v248
v_and_b32 v145, 0xffff0000, v248
v_lshlrev_b32 v146, 16, v249
v_and_b32 v147, 0xffff0000, v249
v_lshlrev_b32 v148, 16, v250
v_and_b32 v149, 0xffff0000, v250
v_lshlrev_b32 v150, 16, v251
v_and_b32 v151, 0xffff0000, v251
v_lshlrev_b32 v152, 16, v252
v_and_b32 v153, 0xffff0000, v252
v_lshlrev_b32 v154, 16, v253
v_and_b32 v155, 0xffff0000, v253
v_lshlrev_b32 v156, 16, v254
v_and_b32 v157, 0xffff0000, v254
v_lshlrev_b32 v158, 16, v255
v_and_b32 v159, 0xffff0000, v255
s_waitcnt lgkmcnt(0)
s_barrier
s_add_u32 m0, s54, 16384
s_add_u32 s43, s30, 0
buffer_load_dwordx4 v21, s[12:15], s43 offen sc1 lds
s_add_u32 m0, s54, 17408
s_add_u32 s43, s30, 1024
buffer_load_dwordx4 v21, s[12:15], s43 offen sc1 lds
s_add_u32 m0, s54, 32768
s_add_u32 s43, s31, 0
buffer_load_dwordx4 v21, s[12:15], s43 offen sc1 lds
s_add_u32 m0, s54, 33792
s_add_u32 s43, s31, 1024
buffer_load_dwordx4 v21, s[12:15], s43 offen sc1 lds
ds_read_b128 v[32:35], v2 offset:0
ds_read_b64_tr_b16 v[48:49], v5 offset:0
ds_read_b64_tr_b16 v[50:51], v5 offset:2048
ds_read_b64_tr_b16 v[52:53], v6 offset:0
ds_read_b64_tr_b16 v[54:55], v6 offset:2048
ds_read_b128 v[36:39], v2 offset:256
ds_read_b64_tr_b16 v[56:57], v7 offset:0
ds_read_b64_tr_b16 v[58:59], v7 offset:2048
ds_read_b64_tr_b16 v[60:61], v8 offset:0
ds_read_b64_tr_b16 v[62:63], v8 offset:2048
ds_read_b128 v[40:43], v2 offset:8192
ds_read_b64_tr_b16 v[64:65], v5 offset:4096
ds_read_b64_tr_b16 v[66:67], v5 offset:6144
ds_read_b64_tr_b16 v[68:69], v6 offset:4096
ds_read_b64_tr_b16 v[70:71], v6 offset:6144
ds_read_b128 v[44:47], v2 offset:8448
ds_read_b64_tr_b16 v[72:73], v7 offset:4096
ds_read_b64_tr_b16 v[74:75], v7 offset:6144
ds_read_b64_tr_b16 v[76:77], v8 offset:4096
ds_read_b64_tr_b16 v[78:79], v8 offset:6144
s_waitcnt lgkmcnt(0)
v_mfma_f32_16x16x32_bf16 v[128:131], v[48:51], v[32:35], v[128:131]
v_mfma_f32_16x16x32_bf16 v[132:135], v[52:55], v[32:35], v[132:135]
v_mfma_f32_16x16x32_bf16 v[136:139], v[56:59], v[32:35], v[136:139]
v_mfma_f32_16x16x32_bf16 v[140:143], v[60:63], v[32:35], v[140:143]
v_mfma_f32_16x16x32_bf16 v[144:147], v[48:51], v[36:39], v[144:147]
v_mfma_f32_16x16x32_bf16 v[148:151], v[52:55], v[36:39], v[148:151]
v_mfma_f32_16x16x32_bf16 v[152:155], v[56:59], v[36:39], v[152:155]
v_mfma_f32_16x16x32_bf16 v[156:159], v[60:63], v[36:39], v[156:159]
v_mfma_f32_16x16x32_bf16 v[128:131], v[64:67], v[40:43], v[128:131]
v_mfma_f32_16x16x32_bf16 v[132:135], v[68:71], v[40:43], v[132:135]
v_mfma_f32_16x16x32_bf16 v[136:139], v[72:75], v[40:43], v[136:139]
v_mfma_f32_16x16x32_bf16 v[140:143], v[76:79], v[40:43], v[140:143]
v_mfma_f32_16x16x32_bf16 v[144:147], v[64:67], v[44:47], v[144:147]
v_mfma_f32_16x16x32_bf16 v[148:151], v[68:71], v[44:47], v[148:151]
v_mfma_f32_16x16x32_bf16 v[152:155], v[72:75], v[44:47], v[152:155]
v_mfma_f32_16x16x32_bf16 v[156:159], v[76:79], v[44:47], v[156:159]
s_waitcnt vmcnt(2)
s_barrier
ds_read_b128 v[80:83], v2 offset:16384
ds_read_b64_tr_b16 v[96:97], v5 offset:8192
ds_read_b64_tr_b16 v[98:99], v5 offset:10240
ds_read_b64_tr_b16 v[100:101], v6 offset:8192
ds_read_b64_tr_b16 v[102:103], v6 offset:10240
ds_read_b128 v[84:87], v2 offset:16640
ds_read_b64_tr_b16 v[104:105], v7 offset:8192
ds_read_b64_tr_b16 v[106:107], v7 offset:10240
ds_read_b64_tr_b16 v[108:109], v8 offset:8192
ds_read_b64_tr_b16 v[110:111], v8 offset:10240
ds_read_b128 v[88:91], v2 offset:24576
ds_read_b64_tr_b16 v[112:113], v5 offset:12288
ds_read_b64_tr_b16 v[114:115], v5 offset:14336
ds_read_b64_tr_b16 v[116:117], v6 offset:12288
ds_read_b64_tr_b16 v[118:119], v6 offset:14336
ds_read_b128 v[92:95], v2 offset:24832
ds_read_b64_tr_b16 v[120:121], v7 offset:12288
ds_read_b64_tr_b16 v[122:123], v7 offset:14336
ds_read_b64_tr_b16 v[124:125], v8 offset:12288
ds_read_b64_tr_b16 v[126:127], v8 offset:14336
s_waitcnt vmcnt(0) lgkmcnt(0)
s_barrier
v_mfma_f32_16x16x32_bf16 v[128:131], v[96:99], v[80:83], v[128:131]
ds_read_b128 v[32:35], v2 offset:32768
ds_read_b64_tr_b16 v[48:49], v5 offset:16384
v_mfma_f32_16x16x32_bf16 v[132:135], v[100:103], v[80:83], v[132:135]
ds_read_b64_tr_b16 v[50:51], v5 offset:18432
v_mfma_f32_16x16x32_bf16 v[136:139], v[104:107], v[80:83], v[136:139]
ds_read_b64_tr_b16 v[52:53], v6 offset:16384
v_mfma_f32_16x16x32_bf16 v[140:143], v[108:111], v[80:83], v[140:143]
ds_read_b64_tr_b16 v[54:55], v6 offset:18432
v_mfma_f32_16x16x32_bf16 v[144:147], v[96:99], v[84:87], v[144:147]
ds_read_b128 v[36:39], v2 offset:33024
ds_read_b64_tr_b16 v[56:57], v7 offset:16384
v_mfma_f32_16x16x32_bf16 v[148:151], v[100:103], v[84:87], v[148:151]
ds_read_b64_tr_b16 v[58:59], v7 offset:18432
v_mfma_f32_16x16x32_bf16 v[152:155], v[104:107], v[84:87], v[152:155]
ds_read_b64_tr_b16 v[60:61], v8 offset:16384
v_mfma_f32_16x16x32_bf16 v[156:159], v[108:111], v[84:87], v[156:159]
ds_read_b64_tr_b16 v[62:63], v8 offset:18432
v_mfma_f32_16x16x32_bf16 v[128:131], v[112:115], v[88:91], v[128:131]
ds_read_b128 v[40:43], v2 offset:40960
ds_read_b64_tr_b16 v[64:65], v5 offset:20480
v_mfma_f32_16x16x32_bf16 v[132:135], v[116:119], v[88:91], v[132:135]
ds_read_b64_tr_b16 v[66:67], v5 offset:22528
v_mfma_f32_16x16x32_bf16 v[136:139], v[120:123], v[88:91], v[136:139]
ds_read_b64_tr_b16 v[68:69], v6 offset:20480
v_mfma_f32_16x16x32_bf16 v[140:143], v[124:127], v[88:91], v[140:143]
ds_read_b64_tr_b16 v[70:71], v6 offset:22528
v_mfma_f32_16x16x32_bf16 v[144:147], v[112:115], v[92:95], v[144:147]
ds_read_b128 v[44:47], v2 offset:41216
ds_read_b64_tr_b16 v[72:73], v7 offset:20480
v_mfma_f32_16x16x32_bf16 v[148:151], v[116:119], v[92:95], v[148:151]
ds_read_b64_tr_b16 v[74:75], v7 offset:22528
v_mfma_f32_16x16x32_bf16 v[152:155], v[120:123], v[92:95], v[152:155]
ds_read_b64_tr_b16 v[76:77], v8 offset:20480
v_mfma_f32_16x16x32_bf16 v[156:159], v[124:127], v[92:95], v[156:159]
ds_read_b64_tr_b16 v[78:79], v8 offset:22528
s_waitcnt lgkmcnt(0)
s_barrier
v_mfma_f32_16x16x32_bf16 v[128:131], v[48:51], v[32:35], v[128:131]
ds_read_b128 v[80:83], v2 offset:49152
ds_read_b64_tr_b16 v[96:97], v5 offset:24576
v_mfma_f32_16x16x32_bf16 v[132:135], v[52:55], v[32:35], v[132:135]
ds_read_b64_tr_b16 v[98:99], v5 offset:26624
v_mfma_f32_16x16x32_bf16 v[136:139], v[56:59], v[32:35], v[136:139]
ds_read_b64_tr_b16 v[100:101], v6 offset:24576
v_mfma_f32_16x16x32_bf16 v[140:143], v[60:63], v[32:35], v[140:143]
ds_read_b64_tr_b16 v[102:103], v6 offset:26624
v_mfma_f32_16x16x32_bf16 v[144:147], v[48:51], v[36:39], v[144:147]
ds_read_b128 v[84:87], v2 offset:49408
ds_read_b64_tr_b16 v[104:105], v7 offset:24576
v_mfma_f32_16x16x32_bf16 v[148:151], v[52:55], v[36:39], v[148:151]
ds_read_b64_tr_b16 v[106:107], v7 offset:26624
v_mfma_f32_16x16x32_bf16 v[152:155], v[56:59], v[36:39], v[152:155]
ds_read_b64_tr_b16 v[108:109], v8 offset:24576
v_mfma_f32_16x16x32_bf16 v[156:159], v[60:63], v[36:39], v[156:159]
ds_read_b64_tr_b16 v[110:111], v8 offset:26624
v_mfma_f32_16x16x32_bf16 v[128:131], v[64:67], v[40:43], v[128:131]
ds_read_b128 v[88:91], v2 offset:57344
ds_read_b64_tr_b16 v[112:113], v5 offset:28672
v_mfma_f32_16x16x32_bf16 v[132:135], v[68:71], v[40:43], v[132:135]
ds_read_b64_tr_b16 v[114:115], v5 offset:30720
v_mfma_f32_16x16x32_bf16 v[136:139], v[72:75], v[40:43], v[136:139]
ds_read_b64_tr_b16 v[116:117], v6 offset:28672
v_mfma_f32_16x16x32_bf16 v[140:143], v[76:79], v[40:43], v[140:143]
ds_read_b64_tr_b16 v[118:119], v6 offset:30720
v_mfma_f32_16x16x32_bf16 v[144:147], v[64:67], v[44:47], v[144:147]
ds_read_b128 v[92:95], v2 offset:57600
ds_read_b64_tr_b16 v[120:121], v7 offset:28672
v_mfma_f32_16x16x32_bf16 v[148:151], v[68:71], v[44:47], v[148:151]
ds_read_b64_tr_b16 v[122:123], v7 offset:30720
v_mfma_f32_16x16x32_bf16 v[152:155], v[72:75], v[44:47], v[152:155]
ds_read_b64_tr_b16 v[124:125], v8 offset:28672
v_mfma_f32_16x16x32_bf16 v[156:159], v[76:79], v[44:47], v[156:159]
ds_read_b64_tr_b16 v[126:127], v8 offset:30720
s_waitcnt lgkmcnt(0)
s_barrier
v_mfma_f32_16x16x32_bf16 v[128:131], v[96:99], v[80:83], v[128:131]
ds_read_b128 v[32:35], v2 offset:0
ds_read_b64_tr_b16 v[48:49], v5 offset:32768
v_mfma_f32_16x16x32_bf16 v[132:135], v[100:103], v[80:83], v[132:135]
ds_read_b64_tr_b16 v[50:51], v5 offset:34816
v_mfma_f32_16x16x32_bf16 v[136:139], v[104:107], v[80:83], v[136:139]
ds_read_b64_tr_b16 v[52:53], v6 offset:32768
v_mfma_f32_16x16x32_bf16 v[140:143], v[108:111], v[80:83], v[140:143]
ds_read_b64_tr_b16 v[54:55], v6 offset:34816
v_mfma_f32_16x16x32_bf16 v[144:147], v[96:99], v[84:87], v[144:147]
ds_read_b128 v[36:39], v2 offset:256
ds_read_b64_tr_b16 v[56:57], v7 offset:32768
v_mfma_f32_16x16x32_bf16 v[148:151], v[100:103], v[84:87], v[148:151]
ds_read_b64_tr_b16 v[58:59], v7 offset:34816
v_mfma_f32_16x16x32_bf16 v[152:155], v[104:107], v[84:87], v[152:155]
ds_read_b64_tr_b16 v[60:61], v8 offset:32768
v_mfma_f32_16x16x32_bf16 v[156:159], v[108:111], v[84:87], v[156:159]
ds_read_b64_tr_b16 v[62:63], v8 offset:34816
v_mfma_f32_16x16x32_bf16 v[128:131], v[112:115], v[88:91], v[128:131]
ds_read_b128 v[40:43], v2 offset:8192
ds_read_b64_tr_b16 v[64:65], v5 offset:36864
v_mfma_f32_16x16x32_bf16 v[132:135], v[116:119], v[88:91], v[132:135]
ds_read_b64_tr_b16 v[66:67], v5 offset:38912
v_mfma_f32_16x16x32_bf16 v[136:139], v[120:123], v[88:91], v[136:139]
ds_read_b64_tr_b16 v[68:69], v6 offset:36864
v_mfma_f32_16x16x32_bf16 v[140:143], v[124:127], v[88:91], v[140:143]
ds_read_b64_tr_b16 v[70:71], v6 offset:38912
v_mfma_f32_16x16x32_bf16 v[144:147], v[112:115], v[92:95], v[144:147]
ds_read_b128 v[44:47], v2 offset:8448
ds_read_b64_tr_b16 v[72:73], v7 offset:36864
v_mfma_f32_16x16x32_bf16 v[148:151], v[116:119], v[92:95], v[148:151]
ds_read_b64_tr_b16 v[74:75], v7 offset:38912
v_mfma_f32_16x16x32_bf16 v[152:155], v[120:123], v[92:95], v[152:155]
ds_read_b64_tr_b16 v[76:77], v8 offset:36864
v_mfma_f32_16x16x32_bf16 v[156:159], v[124:127], v[92:95], v[156:159]
ds_read_b64_tr_b16 v[78:79], v8 offset:38912
s_waitcnt lgkmcnt(0)
s_barrier
v_mfma_f32_16x16x32_bf16 v[128:131], v[48:51], v[32:35], v[128:131]
ds_read_b128 v[80:83], v2 offset:16384
ds_read_b64_tr_b16 v[96:97], v5 offset:40960
v_mfma_f32_16x16x32_bf16 v[132:135], v[52:55], v[32:35], v[132:135]
ds_read_b64_tr_b16 v[98:99], v5 offset:43008
v_mfma_f32_16x16x32_bf16 v[136:139], v[56:59], v[32:35], v[136:139]
ds_read_b64_tr_b16 v[100:101], v6 offset:40960
v_mfma_f32_16x16x32_bf16 v[140:143], v[60:63], v[32:35], v[140:143]
ds_read_b64_tr_b16 v[102:103], v6 offset:43008
v_mfma_f32_16x16x32_bf16 v[144:147], v[48:51], v[36:39], v[144:147]
ds_read_b128 v[84:87], v2 offset:16640
ds_read_b64_tr_b16 v[104:105], v7 offset:40960
v_mfma_f32_16x16x32_bf16 v[148:151], v[52:55], v[36:39], v[148:151]
ds_read_b64_tr_b16 v[106:107], v7 offset:43008
v_mfma_f32_16x16x32_bf16 v[152:155], v[56:59], v[36:39], v[152:155]
ds_read_b64_tr_b16 v[108:109], v8 offset:40960
v_mfma_f32_16x16x32_bf16 v[156:159], v[60:63], v[36:39], v[156:159]
ds_read_b64_tr_b16 v[110:111], v8 offset:43008
v_mfma_f32_16x16x32_bf16 v[128:131], v[64:67], v[40:43], v[128:131]
ds_read_b128 v[88:91], v2 offset:24576
ds_read_b64_tr_b16 v[112:113], v5 offset:45056
v_mfma_f32_16x16x32_bf16 v[132:135], v[68:71], v[40:43], v[132:135]
ds_read_b64_tr_b16 v[114:115], v5 offset:47104
v_mfma_f32_16x16x32_bf16 v[136:139], v[72:75], v[40:43], v[136:139]
ds_read_b64_tr_b16 v[116:117], v6 offset:45056
v_mfma_f32_16x16x32_bf16 v[140:143], v[76:79], v[40:43], v[140:143]
ds_read_b64_tr_b16 v[118:119], v6 offset:47104
v_mfma_f32_16x16x32_bf16 v[144:147], v[64:67], v[44:47], v[144:147]
ds_read_b128 v[92:95], v2 offset:24832
ds_read_b64_tr_b16 v[120:121], v7 offset:45056
v_mfma_f32_16x16x32_bf16 v[148:151], v[68:71], v[44:47], v[148:151]
ds_read_b64_tr_b16 v[122:123], v7 offset:47104
v_mfma_f32_16x16x32_bf16 v[152:155], v[72:75], v[44:47], v[152:155]
ds_read_b64_tr_b16 v[124:125], v8 offset:45056
v_mfma_f32_16x16x32_bf16 v[156:159], v[76:79], v[44:47], v[156:159]
ds_read_b64_tr_b16 v[126:127], v8 offset:47104
s_waitcnt lgkmcnt(0)
s_barrier
v_mfma_f32_16x16x32_bf16 v[128:131], v[96:99], v[80:83], v[128:131]
ds_read_b128 v[32:35], v2 offset:32768
ds_read_b64_tr_b16 v[48:49], v5 offset:49152
v_mfma_f32_16x16x32_bf16 v[132:135], v[100:103], v[80:83], v[132:135]
ds_read_b64_tr_b16 v[50:51], v5 offset:51200
v_mfma_f32_16x16x32_bf16 v[136:139], v[104:107], v[80:83], v[136:139]
ds_read_b64_tr_b16 v[52:53], v6 offset:49152
v_mfma_f32_16x16x32_bf16 v[140:143], v[108:111], v[80:83], v[140:143]
ds_read_b64_tr_b16 v[54:55], v6 offset:51200
v_mfma_f32_16x16x32_bf16 v[144:147], v[96:99], v[84:87], v[144:147]
ds_read_b128 v[36:39], v2 offset:33024
ds_read_b64_tr_b16 v[56:57], v7 offset:49152
v_mfma_f32_16x16x32_bf16 v[148:151], v[100:103], v[84:87], v[148:151]
ds_read_b64_tr_b16 v[58:59], v7 offset:51200
v_mfma_f32_16x16x32_bf16 v[152:155], v[104:107], v[84:87], v[152:155]
ds_read_b64_tr_b16 v[60:61], v8 offset:49152
v_mfma_f32_16x16x32_bf16 v[156:159], v[108:111], v[84:87], v[156:159]
ds_read_b64_tr_b16 v[62:63], v8 offset:51200
v_mfma_f32_16x16x32_bf16 v[128:131], v[112:115], v[88:91], v[128:131]
ds_read_b128 v[40:43], v2 offset:40960
ds_read_b64_tr_b16 v[64:65], v5 offset:53248
v_mfma_f32_16x16x32_bf16 v[132:135], v[116:119], v[88:91], v[132:135]
ds_read_b64_tr_b16 v[66:67], v5 offset:55296
v_mfma_f32_16x16x32_bf16 v[136:139], v[120:123], v[88:91], v[136:139]
ds_read_b64_tr_b16 v[68:69], v6 offset:53248
v_mfma_f32_16x16x32_bf16 v[140:143], v[124:127], v[88:91], v[140:143]
ds_read_b64_tr_b16 v[70:71], v6 offset:55296
v_mfma_f32_16x16x32_bf16 v[144:147], v[112:115], v[92:95], v[144:147]
ds_read_b128 v[44:47], v2 offset:41216
ds_read_b64_tr_b16 v[72:73], v7 offset:53248
v_mfma_f32_16x16x32_bf16 v[148:151], v[116:119], v[92:95], v[148:151]
ds_read_b64_tr_b16 v[74:75], v7 offset:55296
v_mfma_f32_16x16x32_bf16 v[152:155], v[120:123], v[92:95], v[152:155]
ds_read_b64_tr_b16 v[76:77], v8 offset:53248
v_mfma_f32_16x16x32_bf16 v[156:159], v[124:127], v[92:95], v[156:159]
ds_read_b64_tr_b16 v[78:79], v8 offset:55296
s_waitcnt lgkmcnt(0)
s_barrier
v_mfma_f32_16x16x32_bf16 v[128:131], v[48:51], v[32:35], v[128:131]
ds_read_b128 v[80:83], v2 offset:49152
ds_read_b64_tr_b16 v[96:97], v5 offset:57344
v_mfma_f32_16x16x32_bf16 v[132:135], v[52:55], v[32:35], v[132:135]
ds_read_b64_tr_b16 v[98:99], v5 offset:59392
v_mfma_f32_16x16x32_bf16 v[136:139], v[56:59], v[32:35], v[136:139]
ds_read_b64_tr_b16 v[100:101], v6 offset:57344
v_mfma_f32_16x16x32_bf16 v[140:143], v[60:63], v[32:35], v[140:143]
ds_read_b64_tr_b16 v[102:103], v6 offset:59392
v_mfma_f32_16x16x32_bf16 v[144:147], v[48:51], v[36:39], v[144:147]
ds_read_b128 v[84:87], v2 offset:49408
ds_read_b64_tr_b16 v[104:105], v7 offset:57344
v_mfma_f32_16x16x32_bf16 v[148:151], v[52:55], v[36:39], v[148:151]
ds_read_b64_tr_b16 v[106:107], v7 offset:59392
v_mfma_f32_16x16x32_bf16 v[152:155], v[56:59], v[36:39], v[152:155]
ds_read_b64_tr_b16 v[108:109], v8 offset:57344
v_mfma_f32_16x16x32_bf16 v[156:159], v[60:63], v[36:39], v[156:159]
ds_read_b64_tr_b16 v[110:111], v8 offset:59392
v_mfma_f32_16x16x32_bf16 v[128:131], v[64:67], v[40:43], v[128:131]
ds_read_b128 v[88:91], v2 offset:57344
ds_read_b64_tr_b16 v[112:113], v5 offset:61440
v_mfma_f32_16x16x32_bf16 v[132:135], v[68:71], v[40:43], v[132:135]
ds_read_b64_tr_b16 v[114:115], v5 offset:63488
v_mfma_f32_16x16x32_bf16 v[136:139], v[72:75], v[40:43], v[136:139]
ds_read_b64_tr_b16 v[116:117], v6 offset:61440
v_mfma_f32_16x16x32_bf16 v[140:143], v[76:79], v[40:43], v[140:143]
ds_read_b64_tr_b16 v[118:119], v6 offset:63488
v_mfma_f32_16x16x32_bf16 v[144:147], v[64:67], v[44:47], v[144:147]
ds_read_b128 v[92:95], v2 offset:57600
ds_read_b64_tr_b16 v[120:121], v7 offset:61440
v_mfma_f32_16x16x32_bf16 v[148:151], v[68:71], v[44:47], v[148:151]
ds_read_b64_tr_b16 v[122:123], v7 offset:63488
v_mfma_f32_16x16x32_bf16 v[152:155], v[72:75], v[44:47], v[152:155]
ds_read_b64_tr_b16 v[124:125], v8 offset:61440
v_mfma_f32_16x16x32_bf16 v[156:159], v[76:79], v[44:47], v[156:159]
ds_read_b64_tr_b16 v[126:127], v8 offset:63488
s_waitcnt lgkmcnt(0)
s_barrier
v_mfma_f32_16x16x32_bf16 v[128:131], v[96:99], v[80:83], v[128:131]
ds_read_b128 v[32:35], v2 offset:0
ds_read_b64_tr_b16 v[48:49], v9 offset:0
v_mfma_f32_16x16x32_bf16 v[132:135], v[100:103], v[80:83], v[132:135]
ds_read_b64_tr_b16 v[50:51], v9 offset:2048
v_mfma_f32_16x16x32_bf16 v[136:139], v[104:107], v[80:83], v[136:139]
ds_read_b64_tr_b16 v[52:53], v10 offset:0
v_mfma_f32_16x16x32_bf16 v[140:143], v[108:111], v[80:83], v[140:143]
ds_read_b64_tr_b16 v[54:55], v10 offset:2048
v_mfma_f32_16x16x32_bf16 v[144:147], v[96:99], v[84:87], v[144:147]
ds_read_b128 v[36:39], v2 offset:256
ds_read_b64_tr_b16 v[56:57], v11 offset:0
v_mfma_f32_16x16x32_bf16 v[148:151], v[100:103], v[84:87], v[148:151]
ds_read_b64_tr_b16 v[58:59], v11 offset:2048
v_mfma_f32_16x16x32_bf16 v[152:155], v[104:107], v[84:87], v[152:155]
ds_read_b64_tr_b16 v[60:61], v12 offset:0
v_mfma_f32_16x16x32_bf16 v[156:159], v[108:111], v[84:87], v[156:159]
ds_read_b64_tr_b16 v[62:63], v12 offset:2048
v_mfma_f32_16x16x32_bf16 v[128:131], v[112:115], v[88:91], v[128:131]
ds_read_b128 v[40:43], v2 offset:8192
ds_read_b64_tr_b16 v[64:65], v9 offset:4096
v_mfma_f32_16x16x32_bf16 v[132:135], v[116:119], v[88:91], v[132:135]
ds_read_b64_tr_b16 v[66:67], v9 offset:6144
v_mfma_f32_16x16x32_bf16 v[136:139], v[120:123], v[88:91], v[136:139]
ds_read_b64_tr_b16 v[68:69], v10 offset:4096
v_mfma_f32_16x16x32_bf16 v[140:143], v[124:127], v[88:91], v[140:143]
ds_read_b64_tr_b16 v[70:71], v10 offset:6144
v_mfma_f32_16x16x32_bf16 v[144:147], v[112:115], v[92:95], v[144:147]
ds_read_b128 v[44:47], v2 offset:8448
ds_read_b64_tr_b16 v[72:73], v11 offset:4096
v_mfma_f32_16x16x32_bf16 v[148:151], v[116:119], v[92:95], v[148:151]
ds_read_b64_tr_b16 v[74:75], v11 offset:6144
v_mfma_f32_16x16x32_bf16 v[152:155], v[120:123], v[92:95], v[152:155]
ds_read_b64_tr_b16 v[76:77], v12 offset:4096
v_mfma_f32_16x16x32_bf16 v[156:159], v[124:127], v[92:95], v[156:159]
ds_read_b64_tr_b16 v[78:79], v12 offset:6144
s_waitcnt lgkmcnt(0)
s_barrier
v_mfma_f32_16x16x32_bf16 v[128:131], v[48:51], v[32:35], v[128:131]
ds_read_b128 v[80:83], v2 offset:16384
ds_read_b64_tr_b16 v[96:97], v9 offset:8192
v_mfma_f32_16x16x32_bf16 v[132:135], v[52:55], v[32:35], v[132:135]
ds_read_b64_tr_b16 v[98:99], v9 offset:10240
v_mfma_f32_16x16x32_bf16 v[136:139], v[56:59], v[32:35], v[136:139]
ds_read_b64_tr_b16 v[100:101], v10 offset:8192
v_mfma_f32_16x16x32_bf16 v[140:143], v[60:63], v[32:35], v[140:143]
ds_read_b64_tr_b16 v[102:103], v10 offset:10240
v_mfma_f32_16x16x32_bf16 v[144:147], v[48:51], v[36:39], v[144:147]
ds_read_b128 v[84:87], v2 offset:16640
ds_read_b64_tr_b16 v[104:105], v11 offset:8192
v_mfma_f32_16x16x32_bf16 v[148:151], v[52:55], v[36:39], v[148:151]
ds_read_b64_tr_b16 v[106:107], v11 offset:10240
v_mfma_f32_16x16x32_bf16 v[152:155], v[56:59], v[36:39], v[152:155]
ds_read_b64_tr_b16 v[108:109], v12 offset:8192
v_mfma_f32_16x16x32_bf16 v[156:159], v[60:63], v[36:39], v[156:159]
ds_read_b64_tr_b16 v[110:111], v12 offset:10240
v_mfma_f32_16x16x32_bf16 v[128:131], v[64:67], v[40:43], v[128:131]
ds_read_b128 v[88:91], v2 offset:24576
ds_read_b64_tr_b16 v[112:113], v9 offset:12288
v_mfma_f32_16x16x32_bf16 v[132:135], v[68:71], v[40:43], v[132:135]
ds_read_b64_tr_b16 v[114:115], v9 offset:14336
v_mfma_f32_16x16x32_bf16 v[136:139], v[72:75], v[40:43], v[136:139]
ds_read_b64_tr_b16 v[116:117], v10 offset:12288
v_mfma_f32_16x16x32_bf16 v[140:143], v[76:79], v[40:43], v[140:143]
ds_read_b64_tr_b16 v[118:119], v10 offset:14336
v_mfma_f32_16x16x32_bf16 v[144:147], v[64:67], v[44:47], v[144:147]
ds_read_b128 v[92:95], v2 offset:24832
ds_read_b64_tr_b16 v[120:121], v11 offset:12288
v_mfma_f32_16x16x32_bf16 v[148:151], v[68:71], v[44:47], v[148:151]
ds_read_b64_tr_b16 v[122:123], v11 offset:14336
v_mfma_f32_16x16x32_bf16 v[152:155], v[72:75], v[44:47], v[152:155]
ds_read_b64_tr_b16 v[124:125], v12 offset:12288
v_mfma_f32_16x16x32_bf16 v[156:159], v[76:79], v[44:47], v[156:159]
ds_read_b64_tr_b16 v[126:127], v12 offset:14336
s_waitcnt lgkmcnt(0)
s_barrier
v_mfma_f32_16x16x32_bf16 v[128:131], v[96:99], v[80:83], v[128:131]
ds_read_b128 v[32:35], v2 offset:32768
ds_read_b64_tr_b16 v[48:49], v5 offset:0
v_mfma_f32_16x16x32_bf16 v[132:135], v[100:103], v[80:83], v[132:135]
ds_read_b64_tr_b16 v[50:51], v5 offset:2048
v_mfma_f32_16x16x32_bf16 v[136:139], v[104:107], v[80:83], v[136:139]
ds_read_b64_tr_b16 v[52:53], v6 offset:0
v_mfma_f32_16x16x32_bf16 v[140:143], v[108:111], v[80:83], v[140:143]
ds_read_b64_tr_b16 v[54:55], v6 offset:2048
v_mfma_f32_16x16x32_bf16 v[144:147], v[96:99], v[84:87], v[144:147]
ds_read_b128 v[36:39], v2 offset:33024
ds_read_b64_tr_b16 v[56:57], v7 offset:0
v_mfma_f32_16x16x32_bf16 v[148:151], v[100:103], v[84:87], v[148:151]
ds_read_b64_tr_b16 v[58:59], v7 offset:2048
v_mfma_f32_16x16x32_bf16 v[152:155], v[104:107], v[84:87], v[152:155]
ds_read_b64_tr_b16 v[60:61], v8 offset:0
v_mfma_f32_16x16x32_bf16 v[156:159], v[108:111], v[84:87], v[156:159]
ds_read_b64_tr_b16 v[62:63], v8 offset:2048
v_mfma_f32_16x16x32_bf16 v[128:131], v[112:115], v[88:91], v[128:131]
ds_read_b128 v[40:43], v2 offset:40960
ds_read_b64_tr_b16 v[64:65], v5 offset:4096
v_mfma_f32_16x16x32_bf16 v[132:135], v[116:119], v[88:91], v[132:135]
ds_read_b64_tr_b16 v[66:67], v5 offset:6144
v_mfma_f32_16x16x32_bf16 v[136:139], v[120:123], v[88:91], v[136:139]
ds_read_b64_tr_b16 v[68:69], v6 offset:4096
v_mfma_f32_16x16x32_bf16 v[140:143], v[124:127], v[88:91], v[140:143]
ds_read_b64_tr_b16 v[70:71], v6 offset:6144
v_mfma_f32_16x16x32_bf16 v[144:147], v[112:115], v[92:95], v[144:147]
ds_read_b128 v[44:47], v2 offset:41216
ds_read_b64_tr_b16 v[72:73], v7 offset:4096
v_mfma_f32_16x16x32_bf16 v[148:151], v[116:119], v[92:95], v[148:151]
ds_read_b64_tr_b16 v[74:75], v7 offset:6144
v_mfma_f32_16x16x32_bf16 v[152:155], v[120:123], v[92:95], v[152:155]
ds_read_b64_tr_b16 v[76:77], v8 offset:4096
v_mfma_f32_16x16x32_bf16 v[156:159], v[124:127], v[92:95], v[156:159]
ds_read_b64_tr_b16 v[78:79], v8 offset:6144
s_waitcnt lgkmcnt(0)
s_barrier
v_mfma_f32_16x16x32_bf16 v[128:131], v[48:51], v[32:35], v[128:131]
ds_read_b128 v[80:83], v2 offset:49152
ds_read_b64_tr_b16 v[96:97], v5 offset:8192
v_mfma_f32_16x16x32_bf16 v[132:135], v[52:55], v[32:35], v[132:135]
ds_read_b64_tr_b16 v[98:99], v5 offset:10240
v_mfma_f32_16x16x32_bf16 v[136:139], v[56:59], v[32:35], v[136:139]
ds_read_b64_tr_b16 v[100:101], v6 offset:8192
v_mfma_f32_16x16x32_bf16 v[140:143], v[60:63], v[32:35], v[140:143]
ds_read_b64_tr_b16 v[102:103], v6 offset:10240
v_mfma_f32_16x16x32_bf16 v[144:147], v[48:51], v[36:39], v[144:147]
ds_read_b128 v[84:87], v2 offset:49408
ds_read_b64_tr_b16 v[104:105], v7 offset:8192
v_mfma_f32_16x16x32_bf16 v[148:151], v[52:55], v[36:39], v[148:151]
ds_read_b64_tr_b16 v[106:107], v7 offset:10240
v_mfma_f32_16x16x32_bf16 v[152:155], v[56:59], v[36:39], v[152:155]
ds_read_b64_tr_b16 v[108:109], v8 offset:8192
v_mfma_f32_16x16x32_bf16 v[156:159], v[60:63], v[36:39], v[156:159]
ds_read_b64_tr_b16 v[110:111], v8 offset:10240
v_mfma_f32_16x16x32_bf16 v[128:131], v[64:67], v[40:43], v[128:131]
ds_read_b128 v[88:91], v2 offset:57344
ds_read_b64_tr_b16 v[112:113], v5 offset:12288
v_mfma_f32_16x16x32_bf16 v[132:135], v[68:71], v[40:43], v[132:135]
ds_read_b64_tr_b16 v[114:115], v5 offset:14336
v_mfma_f32_16x16x32_bf16 v[136:139], v[72:75], v[40:43], v[136:139]
ds_read_b64_tr_b16 v[116:117], v6 offset:12288
v_mfma_f32_16x16x32_bf16 v[140:143], v[76:79], v[40:43], v[140:143]
ds_read_b64_tr_b16 v[118:119], v6 offset:14336
v_mfma_f32_16x16x32_bf16 v[144:147], v[64:67], v[44:47], v[144:147]
ds_read_b128 v[92:95], v2 offset:57600
ds_read_b64_tr_b16 v[120:121], v7 offset:12288
v_mfma_f32_16x16x32_bf16 v[148:151], v[68:71], v[44:47], v[148:151]
ds_read_b64_tr_b16 v[122:123], v7 offset:14336
v_mfma_f32_16x16x32_bf16 v[152:155], v[72:75], v[44:47], v[152:155]
ds_read_b64_tr_b16 v[124:125], v8 offset:12288
v_mfma_f32_16x16x32_bf16 v[156:159], v[76:79], v[44:47], v[156:159]
ds_read_b64_tr_b16 v[126:127], v8 offset:14336
s_waitcnt lgkmcnt(0)
s_barrier
v_mfma_f32_16x16x32_bf16 v[128:131], v[96:99], v[80:83], v[128:131]
ds_read_b128 v[32:35], v2 offset:0
ds_read_b64_tr_b16 v[48:49], v5 offset:16384
v_mfma_f32_16x16x32_bf16 v[132:135], v[100:103], v[80:83], v[132:135]
ds_read_b64_tr_b16 v[50:51], v5 offset:18432
v_mfma_f32_16x16x32_bf16 v[136:139], v[104:107], v[80:83], v[136:139]
ds_read_b64_tr_b16 v[52:53], v6 offset:16384
v_mfma_f32_16x16x32_bf16 v[140:143], v[108:111], v[80:83], v[140:143]
ds_read_b64_tr_b16 v[54:55], v6 offset:18432
v_mfma_f32_16x16x32_bf16 v[144:147], v[96:99], v[84:87], v[144:147]
ds_read_b128 v[36:39], v2 offset:256
ds_read_b64_tr_b16 v[56:57], v7 offset:16384
v_mfma_f32_16x16x32_bf16 v[148:151], v[100:103], v[84:87], v[148:151]
ds_read_b64_tr_b16 v[58:59], v7 offset:18432
v_mfma_f32_16x16x32_bf16 v[152:155], v[104:107], v[84:87], v[152:155]
ds_read_b64_tr_b16 v[60:61], v8 offset:16384
v_mfma_f32_16x16x32_bf16 v[156:159], v[108:111], v[84:87], v[156:159]
ds_read_b64_tr_b16 v[62:63], v8 offset:18432
v_mfma_f32_16x16x32_bf16 v[128:131], v[112:115], v[88:91], v[128:131]
ds_read_b128 v[40:43], v2 offset:8192
ds_read_b64_tr_b16 v[64:65], v5 offset:20480
v_mfma_f32_16x16x32_bf16 v[132:135], v[116:119], v[88:91], v[132:135]
ds_read_b64_tr_b16 v[66:67], v5 offset:22528
v_mfma_f32_16x16x32_bf16 v[136:139], v[120:123], v[88:91], v[136:139]
ds_read_b64_tr_b16 v[68:69], v6 offset:20480
v_mfma_f32_16x16x32_bf16 v[140:143], v[124:127], v[88:91], v[140:143]
ds_read_b64_tr_b16 v[70:71], v6 offset:22528
v_mfma_f32_16x16x32_bf16 v[144:147], v[112:115], v[92:95], v[144:147]
ds_read_b128 v[44:47], v2 offset:8448
ds_read_b64_tr_b16 v[72:73], v7 offset:20480
v_mfma_f32_16x16x32_bf16 v[148:151], v[116:119], v[92:95], v[148:151]
ds_read_b64_tr_b16 v[74:75], v7 offset:22528
v_mfma_f32_16x16x32_bf16 v[152:155], v[120:123], v[92:95], v[152:155]
ds_read_b64_tr_b16 v[76:77], v8 offset:20480
v_mfma_f32_16x16x32_bf16 v[156:159], v[124:127], v[92:95], v[156:159]
ds_read_b64_tr_b16 v[78:79], v8 offset:22528
s_waitcnt lgkmcnt(0)
s_barrier
v_mfma_f32_16x16x32_bf16 v[128:131], v[48:51], v[32:35], v[128:131]
ds_read_b128 v[80:83], v2 offset:16384
ds_read_b64_tr_b16 v[96:97], v5 offset:24576
v_mfma_f32_16x16x32_bf16 v[132:135], v[52:55], v[32:35], v[132:135]
ds_read_b64_tr_b16 v[98:99], v5 offset:26624
v_mfma_f32_16x16x32_bf16 v[136:139], v[56:59], v[32:35], v[136:139]
ds_read_b64_tr_b16 v[100:101], v6 offset:24576
v_mfma_f32_16x16x32_bf16 v[140:143], v[60:63], v[32:35], v[140:143]
ds_read_b64_tr_b16 v[102:103], v6 offset:26624
v_mfma_f32_16x16x32_bf16 v[144:147], v[48:51], v[36:39], v[144:147]
ds_read_b128 v[84:87], v2 offset:16640
ds_read_b64_tr_b16 v[104:105], v7 offset:24576
v_mfma_f32_16x16x32_bf16 v[148:151], v[52:55], v[36:39], v[148:151]
ds_read_b64_tr_b16 v[106:107], v7 offset:26624
v_mfma_f32_16x16x32_bf16 v[152:155], v[56:59], v[36:39], v[152:155]
ds_read_b64_tr_b16 v[108:109], v8 offset:24576
v_mfma_f32_16x16x32_bf16 v[156:159], v[60:63], v[36:39], v[156:159]
ds_read_b64_tr_b16 v[110:111], v8 offset:26624
v_mfma_f32_16x16x32_bf16 v[128:131], v[64:67], v[40:43], v[128:131]
ds_read_b128 v[88:91], v2 offset:24576
ds_read_b64_tr_b16 v[112:113], v5 offset:28672
v_mfma_f32_16x16x32_bf16 v[132:135], v[68:71], v[40:43], v[132:135]
ds_read_b64_tr_b16 v[114:115], v5 offset:30720
v_mfma_f32_16x16x32_bf16 v[136:139], v[72:75], v[40:43], v[136:139]
ds_read_b64_tr_b16 v[116:117], v6 offset:28672
v_mfma_f32_16x16x32_bf16 v[140:143], v[76:79], v[40:43], v[140:143]
ds_read_b64_tr_b16 v[118:119], v6 offset:30720
v_mfma_f32_16x16x32_bf16 v[144:147], v[64:67], v[44:47], v[144:147]
ds_read_b128 v[92:95], v2 offset:24832
ds_read_b64_tr_b16 v[120:121], v7 offset:28672
v_mfma_f32_16x16x32_bf16 v[148:151], v[68:71], v[44:47], v[148:151]
ds_read_b64_tr_b16 v[122:123], v7 offset:30720
v_mfma_f32_16x16x32_bf16 v[152:155], v[72:75], v[44:47], v[152:155]
ds_read_b64_tr_b16 v[124:125], v8 offset:28672
v_mfma_f32_16x16x32_bf16 v[156:159], v[76:79], v[44:47], v[156:159]
ds_read_b64_tr_b16 v[126:127], v8 offset:30720
s_waitcnt lgkmcnt(0)
s_barrier
v_mfma_f32_16x16x32_bf16 v[128:131], v[96:99], v[80:83], v[128:131]
ds_read_b128 v[32:35], v2 offset:32768
ds_read_b64_tr_b16 v[48:49], v5 offset:32768
v_mfma_f32_16x16x32_bf16 v[132:135], v[100:103], v[80:83], v[132:135]
ds_read_b64_tr_b16 v[50:51], v5 offset:34816
v_mfma_f32_16x16x32_bf16 v[136:139], v[104:107], v[80:83], v[136:139]
ds_read_b64_tr_b16 v[52:53], v6 offset:32768
v_mfma_f32_16x16x32_bf16 v[140:143], v[108:111], v[80:83], v[140:143]
ds_read_b64_tr_b16 v[54:55], v6 offset:34816
v_mfma_f32_16x16x32_bf16 v[144:147], v[96:99], v[84:87], v[144:147]
ds_read_b128 v[36:39], v2 offset:33024
ds_read_b64_tr_b16 v[56:57], v7 offset:32768
v_mfma_f32_16x16x32_bf16 v[148:151], v[100:103], v[84:87], v[148:151]
ds_read_b64_tr_b16 v[58:59], v7 offset:34816
v_mfma_f32_16x16x32_bf16 v[152:155], v[104:107], v[84:87], v[152:155]
ds_read_b64_tr_b16 v[60:61], v8 offset:32768
v_mfma_f32_16x16x32_bf16 v[156:159], v[108:111], v[84:87], v[156:159]
ds_read_b64_tr_b16 v[62:63], v8 offset:34816
v_mfma_f32_16x16x32_bf16 v[128:131], v[112:115], v[88:91], v[128:131]
ds_read_b128 v[40:43], v2 offset:40960
ds_read_b64_tr_b16 v[64:65], v5 offset:36864
v_mfma_f32_16x16x32_bf16 v[132:135], v[116:119], v[88:91], v[132:135]
ds_read_b64_tr_b16 v[66:67], v5 offset:38912
v_mfma_f32_16x16x32_bf16 v[136:139], v[120:123], v[88:91], v[136:139]
ds_read_b64_tr_b16 v[68:69], v6 offset:36864
v_mfma_f32_16x16x32_bf16 v[140:143], v[124:127], v[88:91], v[140:143]
ds_read_b64_tr_b16 v[70:71], v6 offset:38912
v_mfma_f32_16x16x32_bf16 v[144:147], v[112:115], v[92:95], v[144:147]
ds_read_b128 v[44:47], v2 offset:41216
ds_read_b64_tr_b16 v[72:73], v7 offset:36864
v_mfma_f32_16x16x32_bf16 v[148:151], v[116:119], v[92:95], v[148:151]
ds_read_b64_tr_b16 v[74:75], v7 offset:38912
v_mfma_f32_16x16x32_bf16 v[152:155], v[120:123], v[92:95], v[152:155]
ds_read_b64_tr_b16 v[76:77], v8 offset:36864
v_mfma_f32_16x16x32_bf16 v[156:159], v[124:127], v[92:95], v[156:159]
ds_read_b64_tr_b16 v[78:79], v8 offset:38912
s_waitcnt lgkmcnt(0)
s_barrier
v_mfma_f32_16x16x32_bf16 v[128:131], v[48:51], v[32:35], v[128:131]
ds_read_b128 v[80:83], v2 offset:49152
ds_read_b64_tr_b16 v[96:97], v5 offset:40960
v_mfma_f32_16x16x32_bf16 v[132:135], v[52:55], v[32:35], v[132:135]
ds_read_b64_tr_b16 v[98:99], v5 offset:43008
v_mfma_f32_16x16x32_bf16 v[136:139], v[56:59], v[32:35], v[136:139]
ds_read_b64_tr_b16 v[100:101], v6 offset:40960
v_mfma_f32_16x16x32_bf16 v[140:143], v[60:63], v[32:35], v[140:143]
ds_read_b64_tr_b16 v[102:103], v6 offset:43008
v_mfma_f32_16x16x32_bf16 v[144:147], v[48:51], v[36:39], v[144:147]
ds_read_b128 v[84:87], v2 offset:49408
ds_read_b64_tr_b16 v[104:105], v7 offset:40960
v_mfma_f32_16x16x32_bf16 v[148:151], v[52:55], v[36:39], v[148:151]
ds_read_b64_tr_b16 v[106:107], v7 offset:43008
v_mfma_f32_16x16x32_bf16 v[152:155], v[56:59], v[36:39], v[152:155]
ds_read_b64_tr_b16 v[108:109], v8 offset:40960
v_mfma_f32_16x16x32_bf16 v[156:159], v[60:63], v[36:39], v[156:159]
ds_read_b64_tr_b16 v[110:111], v8 offset:43008
v_mfma_f32_16x16x32_bf16 v[128:131], v[64:67], v[40:43], v[128:131]
ds_read_b128 v[88:91], v2 offset:57344
ds_read_b64_tr_b16 v[112:113], v5 offset:45056
v_mfma_f32_16x16x32_bf16 v[132:135], v[68:71], v[40:43], v[132:135]
ds_read_b64_tr_b16 v[114:115], v5 offset:47104
v_mfma_f32_16x16x32_bf16 v[136:139], v[72:75], v[40:43], v[136:139]
ds_read_b64_tr_b16 v[116:117], v6 offset:45056
v_mfma_f32_16x16x32_bf16 v[140:143], v[76:79], v[40:43], v[140:143]
ds_read_b64_tr_b16 v[118:119], v6 offset:47104
v_mfma_f32_16x16x32_bf16 v[144:147], v[64:67], v[44:47], v[144:147]
ds_read_b128 v[92:95], v2 offset:57600
ds_read_b64_tr_b16 v[120:121], v7 offset:45056
v_mfma_f32_16x16x32_bf16 v[148:151], v[68:71], v[44:47], v[148:151]
ds_read_b64_tr_b16 v[122:123], v7 offset:47104
v_mfma_f32_16x16x32_bf16 v[152:155], v[72:75], v[44:47], v[152:155]
ds_read_b64_tr_b16 v[124:125], v8 offset:45056
v_mfma_f32_16x16x32_bf16 v[156:159], v[76:79], v[44:47], v[156:159]
ds_read_b64_tr_b16 v[126:127], v8 offset:47104
s_waitcnt lgkmcnt(0)
s_barrier
v_mfma_f32_16x16x32_bf16 v[128:131], v[96:99], v[80:83], v[128:131]
v_mfma_f32_16x16x32_bf16 v[132:135], v[100:103], v[80:83], v[132:135]
v_mfma_f32_16x16x32_bf16 v[136:139], v[104:107], v[80:83], v[136:139]
v_mfma_f32_16x16x32_bf16 v[140:143], v[108:111], v[80:83], v[140:143]
v_mfma_f32_16x16x32_bf16 v[144:147], v[96:99], v[84:87], v[144:147]
v_mfma_f32_16x16x32_bf16 v[148:151], v[100:103], v[84:87], v[148:151]
v_mfma_f32_16x16x32_bf16 v[152:155], v[104:107], v[84:87], v[152:155]
v_mfma_f32_16x16x32_bf16 v[156:159], v[108:111], v[84:87], v[156:159]
v_mfma_f32_16x16x32_bf16 v[128:131], v[112:115], v[88:91], v[128:131]
v_mfma_f32_16x16x32_bf16 v[132:135], v[116:119], v[88:91], v[132:135]
v_mfma_f32_16x16x32_bf16 v[136:139], v[120:123], v[88:91], v[136:139]
v_mfma_f32_16x16x32_bf16 v[140:143], v[124:127], v[88:91], v[140:143]
v_mfma_f32_16x16x32_bf16 v[144:147], v[112:115], v[92:95], v[144:147]
v_mfma_f32_16x16x32_bf16 v[148:151], v[116:119], v[92:95], v[148:151]
v_mfma_f32_16x16x32_bf16 v[152:155], v[120:123], v[92:95], v[152:155]
v_mfma_f32_16x16x32_bf16 v[156:159], v[124:127], v[92:95], v[156:159]
s_nop 4
v_cvt_pk_bf16_f32 v96, v128, v129
v_cvt_pk_bf16_f32 v97, v130, v131
v_cvt_pk_bf16_f32 v98, v132, v133
v_cvt_pk_bf16_f32 v99, v134, v135
buffer_store_dwordx4 v[96:99], v2, s[20:23], 0 offen offset:0 sc1
ds_write_b128 v4, v[96:99] offset:0
v_cvt_pk_bf16_f32 v100, v136, v137
v_cvt_pk_bf16_f32 v101, v138, v139
v_cvt_pk_bf16_f32 v102, v140, v141
v_cvt_pk_bf16_f32 v103, v142, v143
buffer_store_dwordx4 v[100:103], v2, s[20:23], s50 offen offset:0 sc1
ds_write_b128 v4, v[100:103] offset:8192
v_cvt_pk_bf16_f32 v104, v144, v145
v_cvt_pk_bf16_f32 v105, v146, v147
v_cvt_pk_bf16_f32 v106, v148, v149
v_cvt_pk_bf16_f32 v107, v150, v151
buffer_store_dwordx4 v[104:107], v2, s[20:23], 0 offen offset:256 sc1
ds_write_b128 v4, v[104:107] offset:256
v_cvt_pk_bf16_f32 v108, v152, v153
v_cvt_pk_bf16_f32 v109, v154, v155
v_cvt_pk_bf16_f32 v110, v156, v157
v_cvt_pk_bf16_f32 v111, v158, v159
buffer_store_dwordx4 v[108:111], v2, s[20:23], s50 offen offset:256 sc1
ds_write_b128 v4, v[108:111] offset:8448
v_pk_mul_f32 v[118:119], v[128:129], v[128:129]
v_pk_mul_f32 v[122:123], v[144:145], v[144:145]
v_pk_fma_f32 v[118:119], v[130:131], v[130:131], v[118:119]
v_pk_add_f32 v[116:117], v[130:131], v[128:129]
v_pk_fma_f32 v[122:123], v[146:147], v[146:147], v[122:123]
v_pk_add_f32 v[120:121], v[146:147], v[144:145]
v_pk_fma_f32 v[118:119], v[132:133], v[132:133], v[118:119]
v_pk_add_f32 v[116:117], v[132:133], v[116:117]
v_pk_fma_f32 v[122:123], v[148:149], v[148:149], v[122:123]
v_pk_add_f32 v[120:121], v[148:149], v[120:121]
v_pk_fma_f32 v[118:119], v[134:135], v[134:135], v[118:119]
v_pk_add_f32 v[116:117], v[134:135], v[116:117]
v_pk_fma_f32 v[122:123], v[150:151], v[150:151], v[122:123]
v_pk_add_f32 v[120:121], v[150:151], v[120:121]
v_pk_fma_f32 v[118:119], v[136:137], v[136:137], v[118:119]
v_pk_add_f32 v[116:117], v[136:137], v[116:117]
v_pk_fma_f32 v[122:123], v[152:153], v[152:153], v[122:123]
v_pk_add_f32 v[120:121], v[152:153], v[120:121]
v_pk_fma_f32 v[118:119], v[138:139], v[138:139], v[118:119]
v_pk_add_f32 v[116:117], v[138:139], v[116:117]
v_pk_fma_f32 v[122:123], v[154:155], v[154:155], v[122:123]
v_pk_add_f32 v[120:121], v[154:155], v[120:121]
v_pk_fma_f32 v[118:119], v[140:141], v[140:141], v[118:119]
v_pk_add_f32 v[116:117], v[140:141], v[116:117]
v_pk_fma_f32 v[122:123], v[156:157], v[156:157], v[122:123]
v_pk_add_f32 v[120:121], v[156:157], v[120:121]
v_pk_fma_f32 v[118:119], v[142:143], v[142:143], v[118:119]
v_pk_add_f32 v[116:117], v[142:143], v[116:117]
v_pk_fma_f32 v[122:123], v[158:159], v[158:159], v[122:123]
v_pk_add_f32 v[120:121], v[158:159], v[120:121]
v_add_f32 v112, v116, v117
v_add_f32 v113, v118, v119
v_add_f32 v114, v120, v121
v_add_f32 v115, v122, v123
s_nop 1
v_permlane32_swap_b32 v112, v114
v_permlane32_swap_b32 v113, v115
v_add_f32 v112, v112, v114
v_add_f32 v113, v113, v115
s_nop 1
v_permlane16_swap_b32 v112, v113
v_add_f32 v112, v112, v113
buffer_store_dword v112, v22, s[24:27], 0 offen sc1
s_waitcnt lgkmcnt(0)
s_barrier
s_lshl_b32 s53, s47, 2
v_lshlrev_b32 v19, 11, v18
v_lshl_add_u32 v19, v17, 4, v19
s_lshl_b32 s43, s46, 10
v_add_u32 v2, s43, v19
v_add_u32 v3, 49152, v2
v_add_u32 v4, 98304, v2
v_lshrrev_b32 v19, 2, v17
v_lshl_add_u32 v20, v18, 2, v19
v_and_b32 v21, 7, v20
v_lshlrev_b32 v20, 8, v20
v_and_b32 v19, 3, v1
v_lshl_add_u32 v20, v19, 3, v20
s_add_u32 s43, s53, 0
v_xor_b32 v19, s43, v21
v_lshl_add_u32 v5, v19, 5, v20
s_add_u32 s43, s53, 1
v_xor_b32 v19, s43, v21
v_lshl_add_u32 v6, v19, 5, v20
s_add_u32 s43, s53, 2
v_xor_b32 v19, s43, v21
v_lshl_add_u32 v7, v19, 5, v20
s_add_u32 s43, s53, 3
v_xor_b32 v19, s43, v21
v_lshl_add_u32 v8, v19, 5, v20
v_add_u32 v9, 49152, v5
v_add_u32 v10, 49152, v6
v_add_u32 v11, 49152, v7
v_add_u32 v12, 49152, v8
v_add_u32 v13, 98304, v5
v_add_u32 v14, 98304, v6
v_add_u32 v15, 98304, v7
v_add_u32 v16, 98304, v8
ds_read_b128 v[32:35], v4 offset:0
ds_read_b64_tr_b16 v[48:49], v13 offset:16384
ds_read_b64_tr_b16 v[50:51], v13 offset:20480
ds_read_b128 v[36:39], v4 offset:256
ds_read_b128 v[40:43], v4 offset:512
ds_read_b128 v[44:47], v4 offset:768
ds_read_b64_tr_b16 v[64:65], v13 offset:32768
ds_read_b64_tr_b16 v[66:67], v13 offset:36864
ds_read_b64_tr_b16 v[52:53], v14 offset:16384
ds_read_b64_tr_b16 v[54:55], v14 offset:20480
ds_read_b64_tr_b16 v[68:69], v14 offset:32768
ds_read_b64_tr_b16 v[70:71], v14 offset:36864
ds_read_b64_tr_b16 v[56:57], v15 offset:16384
ds_read_b64_tr_b16 v[58:59], v15 offset:20480
ds_read_b64_tr_b16 v[72:73], v15 offset:32768
ds_read_b64_tr_b16 v[74:75], v15 offset:36864
ds_read_b64_tr_b16 v[60:61], v16 offset:16384
ds_read_b64_tr_b16 v[62:63], v16 offset:20480
ds_read_b64_tr_b16 v[76:77], v16 offset:32768
ds_read_b64_tr_b16 v[78:79], v16 offset:36864
s_waitcnt lgkmcnt(0)
v_mfma_f32_16x16x32_bf16 v[128:131], v[48:51], v[32:35], 0
ds_read_b128 v[80:83], v4 offset:8192
v_mfma_f32_16x16x32_bf16 v[132:135], v[48:51], v[36:39], 0
ds_read_b64_tr_b16 v[96:97], v13 offset:24576
v_mfma_f32_16x16x32_bf16 v[136:139], v[48:51], v[40:43], 0
ds_read_b64_tr_b16 v[98:99], v13 offset:28672
v_mfma_f32_16x16x32_bf16 v[140:143], v[48:51], v[44:47], 0
ds_read_b128 v[84:87], v4 offset:8448
v_mfma_f32_16x16x32_bf16 v[204:207], v[64:67], v[44:47], 0
ds_read_b128 v[88:91], v4 offset:8704
v_mfma_f32_16x16x32_bf16 v[200:203], v[64:67], v[40:43], 0
ds_read_b128 v[92:95], v4 offset:8960
v_mfma_f32_16x16x32_bf16 v[196:199], v[64:67], v[36:39], 0
ds_read_b64_tr_b16 v[112:113], v13 offset:40960
v_mfma_f32_16x16x32_bf16 v[192:195], v[64:67], v[32:35], 0
ds_read_b64_tr_b16 v[114:115], v13 offset:45056
v_mfma_f32_16x16x32_bf16 v[144:147], v[52:55], v[32:35], 0
ds_read_b64_tr_b16 v[100:101], v14 offset:24576
v_mfma_f32_16x16x32_bf16 v[148:151], v[52:55], v[36:39], 0
ds_read_b64_tr_b16 v[102:103], v14 offset:28672
v_mfma_f32_16x16x32_bf16 v[152:155], v[52:55], v[40:43], 0
ds_read_b64_tr_b16 v[116:117], v14 offset:40960
v_mfma_f32_16x16x32_bf16 v[156:159], v[52:55], v[44:47], 0
ds_read_b64_tr_b16 v[118:119], v14 offset:45056
v_mfma_f32_16x16x32_bf16 v[220:223], v[68:71], v[44:47], 0
ds_read_b64_tr_b16 v[104:105], v15 offset:24576
v_mfma_f32_16x16x32_bf16 v[216:219], v[68:71], v[40:43], 0
ds_read_b64_tr_b16 v[106:107], v15 offset:28672
v_mfma_f32_16x16x32_bf16 v[212:215], v[68:71], v[36:39], 0
ds_read_b64_tr_b16 v[120:121], v15 offset:40960
v_mfma_f32_16x16x32_bf16 v[208:211], v[68:71], v[32:35], 0
ds_read_b64_tr_b16 v[122:123], v15 offset:45056
v_mfma_f32_16x16x32_bf16 v[160:163], v[56:59], v[32:35], 0
ds_read_b64_tr_b16 v[108:109], v16 offset:24576
v_mfma_f32_16x16x32_bf16 v[164:167], v[56:59], v[36:39], 0
ds_read_b64_tr_b16 v[110:111], v16 offset:28672
v_mfma_f32_16x16x32_bf16 v[168:171], v[56:59], v[40:43], 0
ds_read_b64_tr_b16 v[124:125], v16 offset:40960
v_mfma_f32_16x16x32_bf16 v[172:175], v[56:59], v[44:47], 0
ds_read_b64_tr_b16 v[126:127], v16 offset:45056
v_mfma_f32_16x16x32_bf16 v[236:239], v[72:75], v[44:47], 0
v_mfma_f32_16x16x32_bf16 v[232:235], v[72:75], v[40:43], 0
v_mfma_f32_16x16x32_bf16 v[228:231], v[72:75], v[36:39], 0
v_mfma_f32_16x16x32_bf16 v[224:227], v[72:75], v[32:35], 0
v_mfma_f32_16x16x32_bf16 v[176:179], v[60:63], v[32:35], 0
v_mfma_f32_16x16x32_bf16 v[180:183], v[60:63], v[36:39], 0
v_mfma_f32_16x16x32_bf16 v[184:187], v[60:63], v[40:43], 0
v_mfma_f32_16x16x32_bf16 v[188:191], v[60:63], v[44:47], 0
v_mfma_f32_16x16x32_bf16 v[252:255], v[76:79], v[44:47], 0
v_mfma_f32_16x16x32_bf16 v[248:251], v[76:79], v[40:43], 0
v_mfma_f32_16x16x32_bf16 v[244:247], v[76:79], v[36:39], 0
v_mfma_f32_16x16x32_bf16 v[240:243], v[76:79], v[32:35], 0
s_waitcnt lgkmcnt(0)
v_mfma_f32_16x16x32_bf16 v[128:131], v[96:99], v[80:83], v[128:131]
v_mfma_f32_16x16x32_bf16 v[132:135], v[96:99], v[84:87], v[132:135]
v_mfma_f32_16x16x32_bf16 v[136:139], v[96:99], v[88:91], v[136:139]
v_mfma_f32_16x16x32_bf16 v[140:143], v[96:99], v[92:95], v[140:143]
v_mfma_f32_16x16x32_bf16 v[204:207], v[112:115], v[92:95], v[204:207]
v_mfma_f32_16x16x32_bf16 v[200:203], v[112:115], v[88:91], v[200:203]
v_mfma_f32_16x16x32_bf16 v[196:199], v[112:115], v[84:87], v[196:199]
v_mfma_f32_16x16x32_bf16 v[192:195], v[112:115], v[80:83], v[192:195]
v_mfma_f32_16x16x32_bf16 v[144:147], v[100:103], v[80:83], v[144:147]
v_mfma_f32_16x16x32_bf16 v[148:151], v[100:103], v[84:87], v[148:151]
v_mfma_f32_16x16x32_bf16 v[152:155], v[100:103], v[88:91], v[152:155]
v_mfma_f32_16x16x32_bf16 v[156:159], v[100:103], v[92:95], v[156:159]
v_mfma_f32_16x16x32_bf16 v[220:223], v[116:119], v[92:95], v[220:223]
v_mfma_f32_16x16x32_bf16 v[216:219], v[116:119], v[88:91], v[216:219]
v_mfma_f32_16x16x32_bf16 v[212:215], v[116:119], v[84:87], v[212:215]
v_mfma_f32_16x16x32_bf16 v[208:211], v[116:119], v[80:83], v[208:211]
v_mfma_f32_16x16x32_bf16 v[160:163], v[104:107], v[80:83], v[160:163]
v_mfma_f32_16x16x32_bf16 v[164:167], v[104:107], v[84:87], v[164:167]
v_mfma_f32_16x16x32_bf16 v[168:171], v[104:107], v[88:91], v[168:171]
v_mfma_f32_16x16x32_bf16 v[172:175], v[104:107], v[92:95], v[172:175]
v_mfma_f32_16x16x32_bf16 v[236:239], v[120:123], v[92:95], v[236:239]
v_mfma_f32_16x16x32_bf16 v[232:235], v[120:123], v[88:91], v[232:235]
v_mfma_f32_16x16x32_bf16 v[228:231], v[120:123], v[84:87], v[228:231]
v_mfma_f32_16x16x32_bf16 v[224:227], v[120:123], v[80:83], v[224:227]
v_mfma_f32_16x16x32_bf16 v[176:179], v[108:111], v[80:83], v[176:179]
v_mfma_f32_16x16x32_bf16 v[180:183], v[108:111], v[84:87], v[180:183]
v_mfma_f32_16x16x32_bf16 v[184:187], v[108:111], v[88:91], v[184:187]
v_mfma_f32_16x16x32_bf16 v[188:191], v[108:111], v[92:95], v[188:191]
v_mfma_f32_16x16x32_bf16 v[252:255], v[124:127], v[92:95], v[252:255]
v_mfma_f32_16x16x32_bf16 v[248:251], v[124:127], v[88:91], v[248:251]
v_mfma_f32_16x16x32_bf16 v[244:247], v[124:127], v[84:87], v[244:247]
v_mfma_f32_16x16x32_bf16 v[240:243], v[124:127], v[80:83], v[240:243]
s_mul_i32 s43, s49, 192
s_and_b32 s43, s43, 0xffffff80
s_add_u32 s43, s43, 4096
s_cmp_eq_u32 s51, 1
s_cselect_b32 s8, s4, s6
s_cselect_b32 s9, s5, s7
s_sub_u32 s10, 7340032, s43
s_lshl_b32 s44, s34, 18
s_add_u32 s44, s44, 4194304
s_movk_i32 s38, 28672
s_cmp_eq_u32 s51, 0
s_cselect_b32 s8, s32, s8
s_cselect_b32 s9, s33, s9
s_cselect_b32 s10, 262144, s10
s_cselect_b32 s43, s44, s43
s_cselect_b32 s38, 1024, s38
s_cselect_b32 s45, 0, -1
s_add_u32 s8, s8, s43
s_addc_u32 s9, s9, 0
s_mov_b32 s11, 0x20000
s_lshl_b32 s40, s38, 4
s_add_u32 s42, s35, 17
s_lshl_b32 s39, s51, 14
v_lshrrev_b32 v19, 4, v1
v_lshlrev_b32 v20, 5, v19
v_mul_u32_u24 v19, 6912, v19
v_and_b32 v19, s45, v19
v_and_b32 v20, s45, v20
v_lshlrev_b32 v21, 4, v1
v_xor_b32 v21, v21, v20
v_add_u32 v22, v21, v19
s_and_b32 s45, s45, 128
v_xor_b32 v23, s45, v22
s_mul_i32 s43, s34, 917504
s_mul_i32 s44, s35, 16384
s_add_u32 s43, s43, s44
s_add_u32 s43, s43, 8388608
s_add_u32 s24, s32, s43
s_addc_u32 s25, s33, 0
s_mov_b32 s26, 278528
s_mov_b32 s27, 0x20000
s_mov_b32 s53, 262144
s_lshl_b32 s43, s47, 13
s_lshl_b32 s44, s46, 10
s_add_u32 s43, s43, s44
v_lshlrev_b32 v19, 11, v18
v_lshl_add_u32 v19, v17, 4, v19
v_add_u32 v27, s43, v19
s_lshl_b32 s43, s34, 18
s_lshl_b32 s44, s35, 7
s_add_u32 s43, s43, s44
s_add_u32 s16, s62, s43
s_addc_u32 s17, s63, 0
s_mov_b32 s18, 260224
s_mov_b32 s19, 0x20000
s_lshl_b32 s43, s46, 6
v_lshl_add_u32 v19, v17, 1, s43
v_lshlrev_b32 v19, 11, v19
v_and_b32 v20, 1, v18
v_lshl_add_u32 v19, v20, 5, v19
v_lshrrev_b32 v20, 1, v18
v_lshl_add_u32 v19, v20, 4, v19
s_lshl_b32 s43, s47, 6
v_add_u32 v28, s43, v19
s_lshl_b32 s43, s34, 4
s_add_u32 s43, s43, s35
s_xor_b32 s43, s43, 0
s_lshl_b32 s43, s43, 15
s_add_u32 s43, s43, 33554432
s_add_u32 s64, s32, s43
s_addc_u32 s65, s33, 0
s_mov_b32 s66, 32768
s_mov_b32 s67, 0x20000
s_lshl_b32 s43, s34, 4
s_add_u32 s43, s43, s35
s_xor_b32 s43, s43, 1
s_lshl_b32 s43, s43, 15
s_add_u32 s43, s43, 33554432
s_add_u32 s68, s32, s43
s_addc_u32 s69, s33, 0
s_mov_b32 s70, 32768
s_mov_b32 s71, 0x20000
s_lshl_b32 s43, s34, 18
s_add_u32 s12, s32, s43
s_addc_u32 s13, s33, 0
s_add_u32 s12, s12, 4194304
s_addc_u32 s13, s13, 0
s_mov_b32 s14, 262144
s_mov_b32 s15, 0x20000
v_lshlrev_b32 v21, 4, v1
s_lshl_b32 s54, s36, 11
s_add_u32 s43, s35, 1
s_and_b32 s43, s43, 15
s_lshl_b32 s43, s43, 14
s_add_u32 s30, s43, s54
s_add_u32 s43, s35, 2
s_and_b32 s43, s43, 15
s_lshl_b32 s43, s43, 14
s_add_u32 s31, s43, s54
s_waitcnt vmcnt(0)
s_barrier
s_setprio 1
ds_read_b128 v[32:35], v2 offset:0
ds_read_b64_tr_b16 v[48:49], v5 offset:16384
ds_read_b64_tr_b16 v[50:51], v5 offset:20480
ds_read_b128 v[36:39], v2 offset:256
ds_read_b128 v[40:43], v2 offset:512
ds_read_b128 v[44:47], v2 offset:768
ds_read_b64_tr_b16 v[64:65], v5 offset:32768
ds_read_b64_tr_b16 v[66:67], v5 offset:36864
ds_read_b64_tr_b16 v[52:53], v6 offset:16384
ds_read_b64_tr_b16 v[54:55], v6 offset:20480
ds_read_b64_tr_b16 v[68:69], v6 offset:32768
ds_read_b64_tr_b16 v[70:71], v6 offset:36864
ds_read_b64_tr_b16 v[56:57], v7 offset:16384
ds_read_b64_tr_b16 v[58:59], v7 offset:20480
ds_read_b64_tr_b16 v[72:73], v7 offset:32768
ds_read_b64_tr_b16 v[74:75], v7 offset:36864
ds_read_b64_tr_b16 v[60:61], v8 offset:16384
ds_read_b64_tr_b16 v[62:63], v8 offset:20480
ds_read_b64_tr_b16 v[76:77], v8 offset:32768
ds_read_b64_tr_b16 v[78:79], v8 offset:36864
s_waitcnt lgkmcnt(14)
v_max3_u32 v19, v32, v33, v34
v_max3_u32 v19, v19, v35, v36
v_max3_u32 v19, v19, v37, v38
v_max3_u32 v19, v19, v39, v40
v_max3_u32 v19, v19, v41, v42
v_max3_u32 v19, v19, v43, v44
v_max3_u32 v19, v19, v45, v46
v_max_u32 v19, v19, v47
v_cmp_eq_u32 vcc, -1, v19
s_nop 4
s_cbranch_vccnz Lfx_49
Lok_47:
s_waitcnt lgkmcnt(0)
v_mfma_f32_16x16x32_bf16 v[128:131], v[48:51], v[32:35], v[128:131]
ds_read_b128 v[80:83], v2 offset:8192
v_mfma_f32_16x16x32_bf16 v[132:135], v[48:51], v[36:39], v[132:135]
ds_read_b64_tr_b16 v[96:97], v5 offset:24576
v_mfma_f32_16x16x32_bf16 v[136:139], v[48:51], v[40:43], v[136:139]
ds_read_b64_tr_b16 v[98:99], v5 offset:28672
v_mfma_f32_16x16x32_bf16 v[140:143], v[48:51], v[44:47], v[140:143]
ds_read_b128 v[84:87], v2 offset:8448
v_mfma_f32_16x16x32_bf16 v[204:207], v[64:67], v[44:47], v[204:207]
ds_read_b128 v[88:91], v2 offset:8704
v_mfma_f32_16x16x32_bf16 v[200:203], v[64:67], v[40:43], v[200:203]
ds_read_b128 v[92:95], v2 offset:8960
v_mfma_f32_16x16x32_bf16 v[196:199], v[64:67], v[36:39], v[196:199]
ds_read_b64_tr_b16 v[112:113], v5 offset:40960
v_mfma_f32_16x16x32_bf16 v[192:195], v[64:67], v[32:35], v[192:195]
ds_read_b64_tr_b16 v[114:115], v5 offset:45056
v_mfma_f32_16x16x32_bf16 v[144:147], v[52:55], v[32:35], v[144:147]
ds_read_b64_tr_b16 v[100:101], v6 offset:24576
v_mfma_f32_16x16x32_bf16 v[148:151], v[52:55], v[36:39], v[148:151]
ds_read_b64_tr_b16 v[102:103], v6 offset:28672
v_mfma_f32_16x16x32_bf16 v[152:155], v[52:55], v[40:43], v[152:155]
ds_read_b64_tr_b16 v[116:117], v6 offset:40960
v_mfma_f32_16x16x32_bf16 v[156:159], v[52:55], v[44:47], v[156:159]
ds_read_b64_tr_b16 v[118:119], v6 offset:45056
v_mfma_f32_16x16x32_bf16 v[220:223], v[68:71], v[44:47], v[220:223]
ds_read_b64_tr_b16 v[104:105], v7 offset:24576
v_mfma_f32_16x16x32_bf16 v[216:219], v[68:71], v[40:43], v[216:219]
ds_read_b64_tr_b16 v[106:107], v7 offset:28672
v_mfma_f32_16x16x32_bf16 v[212:215], v[68:71], v[36:39], v[212:215]
ds_read_b64_tr_b16 v[120:121], v7 offset:40960
v_mfma_f32_16x16x32_bf16 v[208:211], v[68:71], v[32:35], v[208:211]
ds_read_b64_tr_b16 v[122:123], v7 offset:45056
v_mfma_f32_16x16x32_bf16 v[160:163], v[56:59], v[32:35], v[160:163]
ds_read_b64_tr_b16 v[108:109], v8 offset:24576
v_mfma_f32_16x16x32_bf16 v[164:167], v[56:59], v[36:39], v[164:167]
ds_read_b64_tr_b16 v[110:111], v8 offset:28672
v_mfma_f32_16x16x32_bf16 v[168:171], v[56:59], v[40:43], v[168:171]
ds_read_b64_tr_b16 v[124:125], v8 offset:40960
v_mfma_f32_16x16x32_bf16 v[172:175], v[56:59], v[44:47], v[172:175]
ds_read_b64_tr_b16 v[126:127], v8 offset:45056
s_waitcnt lgkmcnt(14)
v_mfma_f32_16x16x32_bf16 v[236:239], v[72:75], v[44:47], v[236:239]
v_max3_u32 v19, v80, v81, v82
v_mfma_f32_16x16x32_bf16 v[232:235], v[72:75], v[40:43], v[232:235]
v_max3_u32 v19, v19, v83, v84
v_mfma_f32_16x16x32_bf16 v[228:231], v[72:75], v[36:39], v[228:231]
v_max3_u32 v19, v19, v85, v86
v_mfma_f32_16x16x32_bf16 v[224:227], v[72:75], v[32:35], v[224:227]
v_max3_u32 v19, v19, v87, v88
v_mfma_f32_16x16x32_bf16 v[176:179], v[60:63], v[32:35], v[176:179]
v_max3_u32 v19, v19, v89, v90
v_mfma_f32_16x16x32_bf16 v[180:183], v[60:63], v[36:39], v[180:183]
v_max3_u32 v19, v19, v91, v92
v_mfma_f32_16x16x32_bf16 v[184:187], v[60:63], v[40:43], v[184:187]
v_max3_u32 v19, v19, v93, v94
v_mfma_f32_16x16x32_bf16 v[188:191], v[60:63], v[44:47], v[188:191]
v_max_u32 v19, v19, v95
v_mfma_f32_16x16x32_bf16 v[252:255], v[76:79], v[44:47], v[252:255]
v_cmp_eq_u32 vcc, -1, v19
v_mfma_f32_16x16x32_bf16 v[248:251], v[76:79], v[40:43], v[248:251]
v_mfma_f32_16x16x32_bf16 v[244:247], v[76:79], v[36:39], v[244:247]
v_mfma_f32_16x16x32_bf16 v[240:243], v[76:79], v[32:35], v[240:243]
s_nop 1
s_cbranch_vccnz Lfx_52
Lok_50:
s_waitcnt lgkmcnt(0)
s_barrier
v_mfma_f32_16x16x32_bf16 v[128:131], v[96:99], v[80:83], v[128:131]
ds_read_b128 v[32:35], v3 offset:0
v_mfma_f32_16x16x32_bf16 v[132:135], v[96:99], v[84:87], v[132:135]
ds_read_b64_tr_b16 v[48:49], v9 offset:16384
v_mfma_f32_16x16x32_bf16 v[136:139], v[96:99], v[88:91], v[136:139]
ds_read_b64_tr_b16 v[50:51], v9 offset:20480
v_mfma_f32_16x16x32_bf16 v[140:143], v[96:99], v[92:95], v[140:143]
ds_read_b128 v[36:39], v3 offset:256
v_mfma_f32_16x16x32_bf16 v[204:207], v[112:115], v[92:95], v[204:207]
ds_read_b128 v[40:43], v3 offset:512
v_mfma_f32_16x16x32_bf16 v[200:203], v[112:115], v[88:91], v[200:203]
ds_read_b128 v[44:47], v3 offset:768
v_mfma_f32_16x16x32_bf16 v[196:199], v[112:115], v[84:87], v[196:199]
ds_read_b64_tr_b16 v[64:65], v9 offset:32768
v_mfma_f32_16x16x32_bf16 v[192:195], v[112:115], v[80:83], v[192:195]
ds_read_b64_tr_b16 v[66:67], v9 offset:36864
v_mfma_f32_16x16x32_bf16 v[144:147], v[100:103], v[80:83], v[144:147]
ds_read_b64_tr_b16 v[52:53], v10 offset:16384
v_mfma_f32_16x16x32_bf16 v[148:151], v[100:103], v[84:87], v[148:151]
ds_read_b64_tr_b16 v[54:55], v10 offset:20480
v_mfma_f32_16x16x32_bf16 v[152:155], v[100:103], v[88:91], v[152:155]
ds_read_b64_tr_b16 v[68:69], v10 offset:32768
v_mfma_f32_16x16x32_bf16 v[156:159], v[100:103], v[92:95], v[156:159]
ds_read_b64_tr_b16 v[70:71], v10 offset:36864
v_mfma_f32_16x16x32_bf16 v[220:223], v[116:119], v[92:95], v[220:223]
ds_read_b64_tr_b16 v[56:57], v11 offset:16384
v_mfma_f32_16x16x32_bf16 v[216:219], v[116:119], v[88:91], v[216:219]
ds_read_b64_tr_b16 v[58:59], v11 offset:20480
v_mfma_f32_16x16x32_bf16 v[212:215], v[116:119], v[84:87], v[212:215]
ds_read_b64_tr_b16 v[72:73], v11 offset:32768
v_mfma_f32_16x16x32_bf16 v[208:211], v[116:119], v[80:83], v[208:211]
ds_read_b64_tr_b16 v[74:75], v11 offset:36864
v_mfma_f32_16x16x32_bf16 v[160:163], v[104:107], v[80:83], v[160:163]
ds_read_b64_tr_b16 v[60:61], v12 offset:16384
v_mfma_f32_16x16x32_bf16 v[164:167], v[104:107], v[84:87], v[164:167]
ds_read_b64_tr_b16 v[62:63], v12 offset:20480
v_mfma_f32_16x16x32_bf16 v[168:171], v[104:107], v[88:91], v[168:171]
ds_read_b64_tr_b16 v[76:77], v12 offset:32768
v_mfma_f32_16x16x32_bf16 v[172:175], v[104:107], v[92:95], v[172:175]
ds_read_b64_tr_b16 v[78:79], v12 offset:36864
s_waitcnt lgkmcnt(14)
v_mfma_f32_16x16x32_bf16 v[236:239], v[120:123], v[92:95], v[236:239]
v_max3_u32 v19, v32, v33, v34
v_mfma_f32_16x16x32_bf16 v[232:235], v[120:123], v[88:91], v[232:235]
v_max3_u32 v19, v19, v35, v36
v_mfma_f32_16x16x32_bf16 v[228:231], v[120:123], v[84:87], v[228:231]
v_max3_u32 v19, v19, v37, v38
v_mfma_f32_16x16x32_bf16 v[224:227], v[120:123], v[80:83], v[224:227]
v_max3_u32 v19, v19, v39, v40
v_mfma_f32_16x16x32_bf16 v[176:179], v[108:111], v[80:83], v[176:179]
v_max3_u32 v19, v19, v41, v42
v_mfma_f32_16x16x32_bf16 v[180:183], v[108:111], v[84:87], v[180:183]
v_max3_u32 v19, v19, v43, v44
v_mfma_f32_16x16x32_bf16 v[184:187], v[108:111], v[88:91], v[184:187]
v_max3_u32 v19, v19, v45, v46
v_mfma_f32_16x16x32_bf16 v[188:191], v[108:111], v[92:95], v[188:191]
v_max_u32 v19, v19, v47
v_mfma_f32_16x16x32_bf16 v[252:255], v[124:127], v[92:95], v[252:255]
v_cmp_eq_u32 vcc, -1, v19
v_mfma_f32_16x16x32_bf16 v[248:251], v[124:127], v[88:91], v[248:251]
v_mfma_f32_16x16x32_bf16 v[244:247], v[124:127], v[84:87], v[244:247]
v_mfma_f32_16x16x32_bf16 v[240:243], v[124:127], v[80:83], v[240:243]
s_nop 1
s_cbranch_vccnz Lfx_55
Lok_53:
s_waitcnt lgkmcnt(0)
v_mfma_f32_16x16x32_bf16 v[128:131], v[48:51], v[32:35], v[128:131]
ds_read_b128 v[80:83], v3 offset:8192
v_mfma_f32_16x16x32_bf16 v[132:135], v[48:51], v[36:39], v[132:135]
ds_read_b64_tr_b16 v[96:97], v9 offset:24576
v_mfma_f32_16x16x32_bf16 v[136:139], v[48:51], v[40:43], v[136:139]
ds_read_b64_tr_b16 v[98:99], v9 offset:28672
v_mfma_f32_16x16x32_bf16 v[140:143], v[48:51], v[44:47], v[140:143]
ds_read_b128 v[84:87], v3 offset:8448
v_mfma_f32_16x16x32_bf16 v[204:207], v[64:67], v[44:47], v[204:207]
ds_read_b128 v[88:91], v3 offset:8704
v_mfma_f32_16x16x32_bf16 v[200:203], v[64:67], v[40:43], v[200:203]
ds_read_b128 v[92:95], v3 offset:8960
v_mfma_f32_16x16x32_bf16 v[196:199], v[64:67], v[36:39], v[196:199]
ds_read_b64_tr_b16 v[112:113], v9 offset:40960
v_mfma_f32_16x16x32_bf16 v[192:195], v[64:67], v[32:35], v[192:195]
ds_read_b64_tr_b16 v[114:115], v9 offset:45056
v_mfma_f32_16x16x32_bf16 v[144:147], v[52:55], v[32:35], v[144:147]
ds_read_b64_tr_b16 v[100:101], v10 offset:24576
v_mfma_f32_16x16x32_bf16 v[148:151], v[52:55], v[36:39], v[148:151]
ds_read_b64_tr_b16 v[102:103], v10 offset:28672
v_mfma_f32_16x16x32_bf16 v[152:155], v[52:55], v[40:43], v[152:155]
ds_read_b64_tr_b16 v[116:117], v10 offset:40960
v_mfma_f32_16x16x32_bf16 v[156:159], v[52:55], v[44:47], v[156:159]
ds_read_b64_tr_b16 v[118:119], v10 offset:45056
v_mfma_f32_16x16x32_bf16 v[220:223], v[68:71], v[44:47], v[220:223]
ds_read_b64_tr_b16 v[104:105], v11 offset:24576
v_mfma_f32_16x16x32_bf16 v[216:219], v[68:71], v[40:43], v[216:219]
ds_read_b64_tr_b16 v[106:107], v11 offset:28672
v_mfma_f32_16x16x32_bf16 v[212:215], v[68:71], v[36:39], v[212:215]
ds_read_b64_tr_b16 v[120:121], v11 offset:40960
v_mfma_f32_16x16x32_bf16 v[208:211], v[68:71], v[32:35], v[208:211]
ds_read_b64_tr_b16 v[122:123], v11 offset:45056
v_mfma_f32_16x16x32_bf16 v[160:163], v[56:59], v[32:35], v[160:163]
ds_read_b64_tr_b16 v[108:109], v12 offset:24576
v_mfma_f32_16x16x32_bf16 v[164:167], v[56:59], v[36:39], v[164:167]
ds_read_b64_tr_b16 v[110:111], v12 offset:28672
v_mfma_f32_16x16x32_bf16 v[168:171], v[56:59], v[40:43], v[168:171]
ds_read_b64_tr_b16 v[124:125], v12 offset:40960
v_mfma_f32_16x16x32_bf16 v[172:175], v[56:59], v[44:47], v[172:175]
ds_read_b64_tr_b16 v[126:127], v12 offset:45056
s_waitcnt lgkmcnt(14)
v_mfma_f32_16x16x32_bf16 v[236:239], v[72:75], v[44:47], v[236:239]
v_max3_u32 v19, v80, v81, v82
v_mfma_f32_16x16x32_bf16 v[232:235], v[72:75], v[40:43], v[232:235]
v_max3_u32 v19, v19, v83, v84
v_mfma_f32_16x16x32_bf16 v[228:231], v[72:75], v[36:39], v[228:231]
v_max3_u32 v19, v19, v85, v86
v_mfma_f32_16x16x32_bf16 v[224:227], v[72:75], v[32:35], v[224:227]
v_max3_u32 v19, v19, v87, v88
v_mfma_f32_16x16x32_bf16 v[176:179], v[60:63], v[32:35], v[176:179]
v_max3_u32 v19, v19, v89, v90
v_mfma_f32_16x16x32_bf16 v[180:183], v[60:63], v[36:39], v[180:183]
v_max3_u32 v19, v19, v91, v92
v_mfma_f32_16x16x32_bf16 v[184:187], v[60:63], v[40:43], v[184:187]
v_max3_u32 v19, v19, v93, v94
v_mfma_f32_16x16x32_bf16 v[188:191], v[60:63], v[44:47], v[188:191]
v_max_u32 v19, v19, v95
v_mfma_f32_16x16x32_bf16 v[252:255], v[76:79], v[44:47], v[252:255]
v_cmp_eq_u32 vcc, -1, v19
v_mfma_f32_16x16x32_bf16 v[248:251], v[76:79], v[40:43], v[248:251]
v_mfma_f32_16x16x32_bf16 v[244:247], v[76:79], v[36:39], v[244:247]
v_mfma_f32_16x16x32_bf16 v[240:243], v[76:79], v[32:35], v[240:243]
s_nop 1
s_cbranch_vccnz Lfx_58
Lok_56:
s_waitcnt lgkmcnt(0)
s_barrier
v_mfma_f32_16x16x32_bf16 v[128:131], v[96:99], v[80:83], v[128:131]
ds_read_b128 v[32:35], v4 offset:0
v_mfma_f32_16x16x32_bf16 v[132:135], v[96:99], v[84:87], v[132:135]
ds_read_b64_tr_b16 v[48:49], v13 offset:16384
v_mfma_f32_16x16x32_bf16 v[136:139], v[96:99], v[88:91], v[136:139]
ds_read_b64_tr_b16 v[50:51], v13 offset:20480
v_mfma_f32_16x16x32_bf16 v[140:143], v[96:99], v[92:95], v[140:143]
ds_read_b128 v[36:39], v4 offset:256
v_mfma_f32_16x16x32_bf16 v[204:207], v[112:115], v[92:95], v[204:207]
ds_read_b128 v[40:43], v4 offset:512
v_mfma_f32_16x16x32_bf16 v[200:203], v[112:115], v[88:91], v[200:203]
ds_read_b128 v[44:47], v4 offset:768
v_mfma_f32_16x16x32_bf16 v[196:199], v[112:115], v[84:87], v[196:199]
ds_read_b64_tr_b16 v[64:65], v13 offset:32768
v_mfma_f32_16x16x32_bf16 v[192:195], v[112:115], v[80:83], v[192:195]
ds_read_b64_tr_b16 v[66:67], v13 offset:36864
v_mfma_f32_16x16x32_bf16 v[144:147], v[100:103], v[80:83], v[144:147]
ds_read_b64_tr_b16 v[52:53], v14 offset:16384
v_mfma_f32_16x16x32_bf16 v[148:151], v[100:103], v[84:87], v[148:151]
ds_read_b64_tr_b16 v[54:55], v14 offset:20480
v_mfma_f32_16x16x32_bf16 v[152:155], v[100:103], v[88:91], v[152:155]
ds_read_b64_tr_b16 v[68:69], v14 offset:32768
v_mfma_f32_16x16x32_bf16 v[156:159], v[100:103], v[92:95], v[156:159]
ds_read_b64_tr_b16 v[70:71], v14 offset:36864
v_mfma_f32_16x16x32_bf16 v[220:223], v[116:119], v[92:95], v[220:223]
ds_read_b64_tr_b16 v[56:57], v15 offset:16384
v_mfma_f32_16x16x32_bf16 v[216:219], v[116:119], v[88:91], v[216:219]
ds_read_b64_tr_b16 v[58:59], v15 offset:20480
v_mfma_f32_16x16x32_bf16 v[212:215], v[116:119], v[84:87], v[212:215]
ds_read_b64_tr_b16 v[72:73], v15 offset:32768
v_mfma_f32_16x16x32_bf16 v[208:211], v[116:119], v[80:83], v[208:211]
ds_read_b64_tr_b16 v[74:75], v15 offset:36864
v_mfma_f32_16x16x32_bf16 v[160:163], v[104:107], v[80:83], v[160:163]
ds_read_b64_tr_b16 v[60:61], v16 offset:16384
v_mfma_f32_16x16x32_bf16 v[164:167], v[104:107], v[84:87], v[164:167]
ds_read_b64_tr_b16 v[62:63], v16 offset:20480
v_mfma_f32_16x16x32_bf16 v[168:171], v[104:107], v[88:91], v[168:171]
ds_read_b64_tr_b16 v[76:77], v16 offset:32768
v_mfma_f32_16x16x32_bf16 v[172:175], v[104:107], v[92:95], v[172:175]
ds_read_b64_tr_b16 v[78:79], v16 offset:36864
s_waitcnt lgkmcnt(14)
v_mfma_f32_16x16x32_bf16 v[236:239], v[120:123], v[92:95], v[236:239]
v_max3_u32 v19, v32, v33, v34
v_mfma_f32_16x16x32_bf16 v[232:235], v[120:123], v[88:91], v[232:235]
v_max3_u32 v19, v19, v35, v36
v_mfma_f32_16x16x32_bf16 v[228:231], v[120:123], v[84:87], v[228:231]
v_max3_u32 v19, v19, v37, v38
v_mfma_f32_16x16x32_bf16 v[224:227], v[120:123], v[80:83], v[224:227]
v_max3_u32 v19, v19, v39, v40
v_mfma_f32_16x16x32_bf16 v[176:179], v[108:111], v[80:83], v[176:179]
v_max3_u32 v19, v19, v41, v42
v_mfma_f32_16x16x32_bf16 v[180:183], v[108:111], v[84:87], v[180:183]
v_max3_u32 v19, v19, v43, v44
v_mfma_f32_16x16x32_bf16 v[184:187], v[108:111], v[88:91], v[184:187]
v_max3_u32 v19, v19, v45, v46
v_mfma_f32_16x16x32_bf16 v[188:191], v[108:111], v[92:95], v[188:191]
v_max_u32 v19, v19, v47
v_mfma_f32_16x16x32_bf16 v[252:255], v[124:127], v[92:95], v[252:255]
v_cmp_eq_u32 vcc, -1, v19
v_mfma_f32_16x16x32_bf16 v[248:251], v[124:127], v[88:91], v[248:251]
v_mfma_f32_16x16x32_bf16 v[244:247], v[124:127], v[84:87], v[244:247]
v_mfma_f32_16x16x32_bf16 v[240:243], v[124:127], v[80:83], v[240:243]
s_nop 1
s_cbranch_vccnz Lfx_61
Lok_59:
s_waitcnt lgkmcnt(0)
v_mfma_f32_16x16x32_bf16 v[128:131], v[48:51], v[32:35], v[128:131]
ds_read_b128 v[80:83], v4 offset:8192
v_mfma_f32_16x16x32_bf16 v[132:135], v[48:51], v[36:39], v[132:135]
ds_read_b64_tr_b16 v[96:97], v13 offset:24576
v_mfma_f32_16x16x32_bf16 v[136:139], v[48:51], v[40:43], v[136:139]
ds_read_b64_tr_b16 v[98:99], v13 offset:28672
v_mfma_f32_16x16x32_bf16 v[140:143], v[48:51], v[44:47], v[140:143]
ds_read_b128 v[84:87], v4 offset:8448
v_mfma_f32_16x16x32_bf16 v[204:207], v[64:67], v[44:47], v[204:207]
ds_read_b128 v[88:91], v4 offset:8704
v_mfma_f32_16x16x32_bf16 v[200:203], v[64:67], v[40:43], v[200:203]
ds_read_b128 v[92:95], v4 offset:8960
v_mfma_f32_16x16x32_bf16 v[196:199], v[64:67], v[36:39], v[196:199]
ds_read_b64_tr_b16 v[112:113], v13 offset:40960
v_mfma_f32_16x16x32_bf16 v[192:195], v[64:67], v[32:35], v[192:195]
ds_read_b64_tr_b16 v[114:115], v13 offset:45056
v_mfma_f32_16x16x32_bf16 v[144:147], v[52:55], v[32:35], v[144:147]
ds_read_b64_tr_b16 v[100:101], v14 offset:24576
v_mfma_f32_16x16x32_bf16 v[148:151], v[52:55], v[36:39], v[148:151]
ds_read_b64_tr_b16 v[102:103], v14 offset:28672
v_mfma_f32_16x16x32_bf16 v[152:155], v[52:55], v[40:43], v[152:155]
ds_read_b64_tr_b16 v[116:117], v14 offset:40960
v_mfma_f32_16x16x32_bf16 v[156:159], v[52:55], v[44:47], v[156:159]
ds_read_b64_tr_b16 v[118:119], v14 offset:45056
v_mfma_f32_16x16x32_bf16 v[220:223], v[68:71], v[44:47], v[220:223]
ds_read_b64_tr_b16 v[104:105], v15 offset:24576
v_mfma_f32_16x16x32_bf16 v[216:219], v[68:71], v[40:43], v[216:219]
ds_read_b64_tr_b16 v[106:107], v15 offset:28672
v_mfma_f32_16x16x32_bf16 v[212:215], v[68:71], v[36:39], v[212:215]
ds_read_b64_tr_b16 v[120:121], v15 offset:40960
v_mfma_f32_16x16x32_bf16 v[208:211], v[68:71], v[32:35], v[208:211]
ds_read_b64_tr_b16 v[122:123], v15 offset:45056
v_mfma_f32_16x16x32_bf16 v[160:163], v[56:59], v[32:35], v[160:163]
ds_read_b64_tr_b16 v[108:109], v16 offset:24576
v_mfma_f32_16x16x32_bf16 v[164:167], v[56:59], v[36:39], v[164:167]
ds_read_b64_tr_b16 v[110:111], v16 offset:28672
v_mfma_f32_16x16x32_bf16 v[168:171], v[56:59], v[40:43], v[168:171]
ds_read_b64_tr_b16 v[124:125], v16 offset:40960
v_mfma_f32_16x16x32_bf16 v[172:175], v[56:59], v[44:47], v[172:175]
ds_read_b64_tr_b16 v[126:127], v16 offset:45056
s_waitcnt lgkmcnt(14)
v_mfma_f32_16x16x32_bf16 v[236:239], v[72:75], v[44:47], v[236:239]
v_max3_u32 v19, v80, v81, v82
v_mfma_f32_16x16x32_bf16 v[232:235], v[72:75], v[40:43], v[232:235]
v_max3_u32 v19, v19, v83, v84
v_mfma_f32_16x16x32_bf16 v[228:231], v[72:75], v[36:39], v[228:231]
v_max3_u32 v19, v19, v85, v86
v_mfma_f32_16x16x32_bf16 v[224:227], v[72:75], v[32:35], v[224:227]
v_max3_u32 v19, v19, v87, v88
v_mfma_f32_16x16x32_bf16 v[176:179], v[60:63], v[32:35], v[176:179]
v_max3_u32 v19, v19, v89, v90
v_mfma_f32_16x16x32_bf16 v[180:183], v[60:63], v[36:39], v[180:183]
v_max3_u32 v19, v19, v91, v92
v_mfma_f32_16x16x32_bf16 v[184:187], v[60:63], v[40:43], v[184:187]
v_max3_u32 v19, v19, v93, v94
v_mfma_f32_16x16x32_bf16 v[188:191], v[60:63], v[44:47], v[188:191]
v_max_u32 v19, v19, v95
v_mfma_f32_16x16x32_bf16 v[252:255], v[76:79], v[44:47], v[252:255]
v_cmp_eq_u32 vcc, -1, v19
v_mfma_f32_16x16x32_bf16 v[248:251], v[76:79], v[40:43], v[248:251]
v_mfma_f32_16x16x32_bf16 v[244:247], v[76:79], v[36:39], v[244:247]
v_mfma_f32_16x16x32_bf16 v[240:243], v[76:79], v[32:35], v[240:243]
s_nop 1
s_cbranch_vccnz Lfx_64
Lok_62:
s_waitcnt lgkmcnt(0)
s_barrier
v_mfma_f32_16x16x32_bf16 v[128:131], v[96:99], v[80:83], v[128:131]
ds_read_b128 v[32:35], v2 offset:0
v_mfma_f32_16x16x32_bf16 v[132:135], v[96:99], v[84:87], v[132:135]
ds_read_b64_tr_b16 v[48:49], v5 offset:16384
v_mfma_f32_16x16x32_bf16 v[136:139], v[96:99], v[88:91], v[136:139]
ds_read_b64_tr_b16 v[50:51], v5 offset:20480
v_mfma_f32_16x16x32_bf16 v[140:143], v[96:99], v[92:95], v[140:143]
ds_read_b128 v[36:39], v2 offset:256
v_mfma_f32_16x16x32_bf16 v[204:207], v[112:115], v[92:95], v[204:207]
ds_read_b128 v[40:43], v2 offset:512
v_mfma_f32_16x16x32_bf16 v[200:203], v[112:115], v[88:91], v[200:203]
ds_read_b128 v[44:47], v2 offset:768
v_mfma_f32_16x16x32_bf16 v[196:199], v[112:115], v[84:87], v[196:199]
ds_read_b64_tr_b16 v[64:65], v5 offset:32768
v_mfma_f32_16x16x32_bf16 v[192:195], v[112:115], v[80:83], v[192:195]
ds_read_b64_tr_b16 v[66:67], v5 offset:36864
v_mfma_f32_16x16x32_bf16 v[144:147], v[100:103], v[80:83], v[144:147]
ds_read_b64_tr_b16 v[52:53], v6 offset:16384
v_mfma_f32_16x16x32_bf16 v[148:151], v[100:103], v[84:87], v[148:151]
ds_read_b64_tr_b16 v[54:55], v6 offset:20480
v_mfma_f32_16x16x32_bf16 v[152:155], v[100:103], v[88:91], v[152:155]
ds_read_b64_tr_b16 v[68:69], v6 offset:32768
v_mfma_f32_16x16x32_bf16 v[156:159], v[100:103], v[92:95], v[156:159]
ds_read_b64_tr_b16 v[70:71], v6 offset:36864
v_mfma_f32_16x16x32_bf16 v[220:223], v[116:119], v[92:95], v[220:223]
ds_read_b64_tr_b16 v[56:57], v7 offset:16384
v_mfma_f32_16x16x32_bf16 v[216:219], v[116:119], v[88:91], v[216:219]
ds_read_b64_tr_b16 v[58:59], v7 offset:20480
v_mfma_f32_16x16x32_bf16 v[212:215], v[116:119], v[84:87], v[212:215]
ds_read_b64_tr_b16 v[72:73], v7 offset:32768
v_mfma_f32_16x16x32_bf16 v[208:211], v[116:119], v[80:83], v[208:211]
ds_read_b64_tr_b16 v[74:75], v7 offset:36864
v_mfma_f32_16x16x32_bf16 v[160:163], v[104:107], v[80:83], v[160:163]
ds_read_b64_tr_b16 v[60:61], v8 offset:16384
v_mfma_f32_16x16x32_bf16 v[164:167], v[104:107], v[84:87], v[164:167]
ds_read_b64_tr_b16 v[62:63], v8 offset:20480
v_mfma_f32_16x16x32_bf16 v[168:171], v[104:107], v[88:91], v[168:171]
ds_read_b64_tr_b16 v[76:77], v8 offset:32768
v_mfma_f32_16x16x32_bf16 v[172:175], v[104:107], v[92:95], v[172:175]
ds_read_b64_tr_b16 v[78:79], v8 offset:36864
s_waitcnt lgkmcnt(14)
v_mfma_f32_16x16x32_bf16 v[236:239], v[120:123], v[92:95], v[236:239]
v_max3_u32 v19, v32, v33, v34
v_mfma_f32_16x16x32_bf16 v[232:235], v[120:123], v[88:91], v[232:235]
v_max3_u32 v19, v19, v35, v36
v_mfma_f32_16x16x32_bf16 v[228:231], v[120:123], v[84:87], v[228:231]
v_max3_u32 v19, v19, v37, v38
v_mfma_f32_16x16x32_bf16 v[224:227], v[120:123], v[80:83], v[224:227]
v_max3_u32 v19, v19, v39, v40
v_mfma_f32_16x16x32_bf16 v[176:179], v[108:111], v[80:83], v[176:179]
v_max3_u32 v19, v19, v41, v42
v_mfma_f32_16x16x32_bf16 v[180:183], v[108:111], v[84:87], v[180:183]
v_max3_u32 v19, v19, v43, v44
v_mfma_f32_16x16x32_bf16 v[184:187], v[108:111], v[88:91], v[184:187]
v_max3_u32 v19, v19, v45, v46
v_mfma_f32_16x16x32_bf16 v[188:191], v[108:111], v[92:95], v[188:191]
v_max_u32 v19, v19, v47
v_mfma_f32_16x16x32_bf16 v[252:255], v[124:127], v[92:95], v[252:255]
v_cmp_eq_u32 vcc, -1, v19
v_mfma_f32_16x16x32_bf16 v[248:251], v[124:127], v[88:91], v[248:251]
v_mfma_f32_16x16x32_bf16 v[244:247], v[124:127], v[84:87], v[244:247]
v_mfma_f32_16x16x32_bf16 v[240:243], v[124:127], v[80:83], v[240:243]
s_nop 1
s_cbranch_vccnz Lfx_67
Lok_65:
s_waitcnt lgkmcnt(0)
v_mfma_f32_16x16x32_bf16 v[128:131], v[48:51], v[32:35], v[128:131]
ds_read_b128 v[80:83], v2 offset:8192
v_mfma_f32_16x16x32_bf16 v[132:135], v[48:51], v[36:39], v[132:135]
ds_read_b64_tr_b16 v[96:97], v5 offset:24576
v_mfma_f32_16x16x32_bf16 v[136:139], v[48:51], v[40:43], v[136:139]
ds_read_b64_tr_b16 v[98:99], v5 offset:28672
v_mfma_f32_16x16x32_bf16 v[140:143], v[48:51], v[44:47], v[140:143]
ds_read_b128 v[84:87], v2 offset:8448
v_mfma_f32_16x16x32_bf16 v[204:207], v[64:67], v[44:47], v[204:207]
ds_read_b128 v[88:91], v2 offset:8704
v_mfma_f32_16x16x32_bf16 v[200:203], v[64:67], v[40:43], v[200:203]
ds_read_b128 v[92:95], v2 offset:8960
v_mfma_f32_16x16x32_bf16 v[196:199], v[64:67], v[36:39], v[196:199]
ds_read_b64_tr_b16 v[112:113], v5 offset:40960
v_mfma_f32_16x16x32_bf16 v[192:195], v[64:67], v[32:35], v[192:195]
ds_read_b64_tr_b16 v[114:115], v5 offset:45056
v_mfma_f32_16x16x32_bf16 v[144:147], v[52:55], v[32:35], v[144:147]
ds_read_b64_tr_b16 v[100:101], v6 offset:24576
v_mfma_f32_16x16x32_bf16 v[148:151], v[52:55], v[36:39], v[148:151]
ds_read_b64_tr_b16 v[102:103], v6 offset:28672
v_mfma_f32_16x16x32_bf16 v[152:155], v[52:55], v[40:43], v[152:155]
ds_read_b64_tr_b16 v[116:117], v6 offset:40960
v_mfma_f32_16x16x32_bf16 v[156:159], v[52:55], v[44:47], v[156:159]
ds_read_b64_tr_b16 v[118:119], v6 offset:45056
v_mfma_f32_16x16x32_bf16 v[220:223], v[68:71], v[44:47], v[220:223]
ds_read_b64_tr_b16 v[104:105], v7 offset:24576
v_mfma_f32_16x16x32_bf16 v[216:219], v[68:71], v[40:43], v[216:219]
ds_read_b64_tr_b16 v[106:107], v7 offset:28672
v_mfma_f32_16x16x32_bf16 v[212:215], v[68:71], v[36:39], v[212:215]
ds_read_b64_tr_b16 v[120:121], v7 offset:40960
v_mfma_f32_16x16x32_bf16 v[208:211], v[68:71], v[32:35], v[208:211]
ds_read_b64_tr_b16 v[122:123], v7 offset:45056
v_mfma_f32_16x16x32_bf16 v[160:163], v[56:59], v[32:35], v[160:163]
ds_read_b64_tr_b16 v[108:109], v8 offset:24576
v_mfma_f32_16x16x32_bf16 v[164:167], v[56:59], v[36:39], v[164:167]
ds_read_b64_tr_b16 v[110:111], v8 offset:28672
v_mfma_f32_16x16x32_bf16 v[168:171], v[56:59], v[40:43], v[168:171]
ds_read_b64_tr_b16 v[124:125], v8 offset:40960
v_mfma_f32_16x16x32_bf16 v[172:175], v[56:59], v[44:47], v[172:175]
ds_read_b64_tr_b16 v[126:127], v8 offset:45056
s_waitcnt lgkmcnt(14)
v_mfma_f32_16x16x32_bf16 v[236:239], v[72:75], v[44:47], v[236:239]
v_max3_u32 v19, v80, v81, v82
v_mfma_f32_16x16x32_bf16 v[232:235], v[72:75], v[40:43], v[232:235]
v_max3_u32 v19, v19, v83, v84
v_mfma_f32_16x16x32_bf16 v[228:231], v[72:75], v[36:39], v[228:231]
v_max3_u32 v19, v19, v85, v86
v_mfma_f32_16x16x32_bf16 v[224:227], v[72:75], v[32:35], v[224:227]
v_max3_u32 v19, v19, v87, v88
v_mfma_f32_16x16x32_bf16 v[176:179], v[60:63], v[32:35], v[176:179]
v_max3_u32 v19, v19, v89, v90
v_mfma_f32_16x16x32_bf16 v[180:183], v[60:63], v[36:39], v[180:183]
v_max3_u32 v19, v19, v91, v92
v_mfma_f32_16x16x32_bf16 v[184:187], v[60:63], v[40:43], v[184:187]
v_max3_u32 v19, v19, v93, v94
v_mfma_f32_16x16x32_bf16 v[188:191], v[60:63], v[44:47], v[188:191]
v_max_u32 v19, v19, v95
v_mfma_f32_16x16x32_bf16 v[252:255], v[76:79], v[44:47], v[252:255]
v_cmp_eq_u32 vcc, -1, v19
v_mfma_f32_16x16x32_bf16 v[248:251], v[76:79], v[40:43], v[248:251]
v_mfma_f32_16x16x32_bf16 v[244:247], v[76:79], v[36:39], v[244:247]
v_mfma_f32_16x16x32_bf16 v[240:243], v[76:79], v[32:35], v[240:243]
s_nop 1
s_cbranch_vccnz Lfx_70
Lok_68:
s_waitcnt lgkmcnt(0)
s_barrier
v_mfma_f32_16x16x32_bf16 v[128:131], v[96:99], v[80:83], v[128:131]
ds_read_b128 v[32:35], v3 offset:0
v_mfma_f32_16x16x32_bf16 v[132:135], v[96:99], v[84:87], v[132:135]
ds_read_b64_tr_b16 v[48:49], v9 offset:16384
v_mfma_f32_16x16x32_bf16 v[136:139], v[96:99], v[88:91], v[136:139]
ds_read_b64_tr_b16 v[50:51], v9 offset:20480
v_mfma_f32_16x16x32_bf16 v[140:143], v[96:99], v[92:95], v[140:143]
ds_read_b128 v[36:39], v3 offset:256
v_mfma_f32_16x16x32_bf16 v[204:207], v[112:115], v[92:95], v[204:207]
ds_read_b128 v[40:43], v3 offset:512
v_mfma_f32_16x16x32_bf16 v[200:203], v[112:115], v[88:91], v[200:203]
ds_read_b128 v[44:47], v3 offset:768
v_mfma_f32_16x16x32_bf16 v[196:199], v[112:115], v[84:87], v[196:199]
ds_read_b64_tr_b16 v[64:65], v9 offset:32768
v_mfma_f32_16x16x32_bf16 v[192:195], v[112:115], v[80:83], v[192:195]
ds_read_b64_tr_b16 v[66:67], v9 offset:36864
v_mfma_f32_16x16x32_bf16 v[144:147], v[100:103], v[80:83], v[144:147]
ds_read_b64_tr_b16 v[52:53], v10 offset:16384
v_mfma_f32_16x16x32_bf16 v[148:151], v[100:103], v[84:87], v[148:151]
ds_read_b64_tr_b16 v[54:55], v10 offset:20480
v_mfma_f32_16x16x32_bf16 v[152:155], v[100:103], v[88:91], v[152:155]
ds_read_b64_tr_b16 v[68:69], v10 offset:32768
v_mfma_f32_16x16x32_bf16 v[156:159], v[100:103], v[92:95], v[156:159]
ds_read_b64_tr_b16 v[70:71], v10 offset:36864
v_mfma_f32_16x16x32_bf16 v[220:223], v[116:119], v[92:95], v[220:223]
ds_read_b64_tr_b16 v[56:57], v11 offset:16384
v_mfma_f32_16x16x32_bf16 v[216:219], v[116:119], v[88:91], v[216:219]
ds_read_b64_tr_b16 v[58:59], v11 offset:20480
v_mfma_f32_16x16x32_bf16 v[212:215], v[116:119], v[84:87], v[212:215]
ds_read_b64_tr_b16 v[72:73], v11 offset:32768
v_mfma_f32_16x16x32_bf16 v[208:211], v[116:119], v[80:83], v[208:211]
ds_read_b64_tr_b16 v[74:75], v11 offset:36864
v_mfma_f32_16x16x32_bf16 v[160:163], v[104:107], v[80:83], v[160:163]
ds_read_b64_tr_b16 v[60:61], v12 offset:16384
v_mfma_f32_16x16x32_bf16 v[164:167], v[104:107], v[84:87], v[164:167]
ds_read_b64_tr_b16 v[62:63], v12 offset:20480
v_mfma_f32_16x16x32_bf16 v[168:171], v[104:107], v[88:91], v[168:171]
ds_read_b64_tr_b16 v[76:77], v12 offset:32768
v_mfma_f32_16x16x32_bf16 v[172:175], v[104:107], v[92:95], v[172:175]
ds_read_b64_tr_b16 v[78:79], v12 offset:36864
s_waitcnt lgkmcnt(14)
v_mfma_f32_16x16x32_bf16 v[236:239], v[120:123], v[92:95], v[236:239]
v_max3_u32 v19, v32, v33, v34
v_mfma_f32_16x16x32_bf16 v[232:235], v[120:123], v[88:91], v[232:235]
v_max3_u32 v19, v19, v35, v36
v_mfma_f32_16x16x32_bf16 v[228:231], v[120:123], v[84:87], v[228:231]
v_max3_u32 v19, v19, v37, v38
v_mfma_f32_16x16x32_bf16 v[224:227], v[120:123], v[80:83], v[224:227]
v_max3_u32 v19, v19, v39, v40
v_mfma_f32_16x16x32_bf16 v[176:179], v[108:111], v[80:83], v[176:179]
v_max3_u32 v19, v19, v41, v42
v_mfma_f32_16x16x32_bf16 v[180:183], v[108:111], v[84:87], v[180:183]
v_max3_u32 v19, v19, v43, v44
v_mfma_f32_16x16x32_bf16 v[184:187], v[108:111], v[88:91], v[184:187]
v_max3_u32 v19, v19, v45, v46
v_mfma_f32_16x16x32_bf16 v[188:191], v[108:111], v[92:95], v[188:191]
v_max_u32 v19, v19, v47
v_mfma_f32_16x16x32_bf16 v[252:255], v[124:127], v[92:95], v[252:255]
v_cmp_eq_u32 vcc, -1, v19
v_mfma_f32_16x16x32_bf16 v[248:251], v[124:127], v[88:91], v[248:251]
v_mfma_f32_16x16x32_bf16 v[244:247], v[124:127], v[84:87], v[244:247]
v_mfma_f32_16x16x32_bf16 v[240:243], v[124:127], v[80:83], v[240:243]
s_nop 1
s_cbranch_vccnz Lfx_73
Lok_71:
s_waitcnt lgkmcnt(0)
v_mfma_f32_16x16x32_bf16 v[128:131], v[48:51], v[32:35], v[128:131]
ds_read_b128 v[80:83], v3 offset:8192
v_mfma_f32_16x16x32_bf16 v[132:135], v[48:51], v[36:39], v[132:135]
ds_read_b64_tr_b16 v[96:97], v9 offset:24576
v_mfma_f32_16x16x32_bf16 v[136:139], v[48:51], v[40:43], v[136:139]
ds_read_b64_tr_b16 v[98:99], v9 offset:28672
v_mfma_f32_16x16x32_bf16 v[140:143], v[48:51], v[44:47], v[140:143]
ds_read_b128 v[84:87], v3 offset:8448
v_mfma_f32_16x16x32_bf16 v[204:207], v[64:67], v[44:47], v[204:207]
ds_read_b128 v[88:91], v3 offset:8704
v_mfma_f32_16x16x32_bf16 v[200:203], v[64:67], v[40:43], v[200:203]
ds_read_b128 v[92:95], v3 offset:8960
v_mfma_f32_16x16x32_bf16 v[196:199], v[64:67], v[36:39], v[196:199]
ds_read_b64_tr_b16 v[112:113], v9 offset:40960
v_mfma_f32_16x16x32_bf16 v[192:195], v[64:67], v[32:35], v[192:195]
ds_read_b64_tr_b16 v[114:115], v9 offset:45056
v_mfma_f32_16x16x32_bf16 v[144:147], v[52:55], v[32:35], v[144:147]
ds_read_b64_tr_b16 v[100:101], v10 offset:24576
v_mfma_f32_16x16x32_bf16 v[148:151], v[52:55], v[36:39], v[148:151]
ds_read_b64_tr_b16 v[102:103], v10 offset:28672
v_mfma_f32_16x16x32_bf16 v[152:155], v[52:55], v[40:43], v[152:155]
ds_read_b64_tr_b16 v[116:117], v10 offset:40960
v_mfma_f32_16x16x32_bf16 v[156:159], v[52:55], v[44:47], v[156:159]
ds_read_b64_tr_b16 v[118:119], v10 offset:45056
v_mfma_f32_16x16x32_bf16 v[220:223], v[68:71], v[44:47], v[220:223]
ds_read_b64_tr_b16 v[104:105], v11 offset:24576
v_mfma_f32_16x16x32_bf16 v[216:219], v[68:71], v[40:43], v[216:219]
ds_read_b64_tr_b16 v[106:107], v11 offset:28672
v_mfma_f32_16x16x32_bf16 v[212:215], v[68:71], v[36:39], v[212:215]
ds_read_b64_tr_b16 v[120:121], v11 offset:40960
v_mfma_f32_16x16x32_bf16 v[208:211], v[68:71], v[32:35], v[208:211]
ds_read_b64_tr_b16 v[122:123], v11 offset:45056
v_mfma_f32_16x16x32_bf16 v[160:163], v[56:59], v[32:35], v[160:163]
ds_read_b64_tr_b16 v[108:109], v12 offset:24576
v_mfma_f32_16x16x32_bf16 v[164:167], v[56:59], v[36:39], v[164:167]
ds_read_b64_tr_b16 v[110:111], v12 offset:28672
v_mfma_f32_16x16x32_bf16 v[168:171], v[56:59], v[40:43], v[168:171]
ds_read_b64_tr_b16 v[124:125], v12 offset:40960
v_mfma_f32_16x16x32_bf16 v[172:175], v[56:59], v[44:47], v[172:175]
ds_read_b64_tr_b16 v[126:127], v12 offset:45056
s_waitcnt lgkmcnt(14)
v_mfma_f32_16x16x32_bf16 v[236:239], v[72:75], v[44:47], v[236:239]
v_max3_u32 v19, v80, v81, v82
v_mfma_f32_16x16x32_bf16 v[232:235], v[72:75], v[40:43], v[232:235]
v_max3_u32 v19, v19, v83, v84
v_mfma_f32_16x16x32_bf16 v[228:231], v[72:75], v[36:39], v[228:231]
v_max3_u32 v19, v19, v85, v86
v_mfma_f32_16x16x32_bf16 v[224:227], v[72:75], v[32:35], v[224:227]
v_max3_u32 v19, v19, v87, v88
v_mfma_f32_16x16x32_bf16 v[176:179], v[60:63], v[32:35], v[176:179]
v_max3_u32 v19, v19, v89, v90
v_mfma_f32_16x16x32_bf16 v[180:183], v[60:63], v[36:39], v[180:183]
v_max3_u32 v19, v19, v91, v92
v_mfma_f32_16x16x32_bf16 v[184:187], v[60:63], v[40:43], v[184:187]
v_max3_u32 v19, v19, v93, v94
v_mfma_f32_16x16x32_bf16 v[188:191], v[60:63], v[44:47], v[188:191]
v_max_u32 v19, v19, v95
v_mfma_f32_16x16x32_bf16 v[252:255], v[76:79], v[44:47], v[252:255]
v_cmp_eq_u32 vcc, -1, v19
v_mfma_f32_16x16x32_bf16 v[248:251], v[76:79], v[40:43], v[248:251]
v_mfma_f32_16x16x32_bf16 v[244:247], v[76:79], v[36:39], v[244:247]
v_mfma_f32_16x16x32_bf16 v[240:243], v[76:79], v[32:35], v[240:243]
s_nop 1
s_cbranch_vccnz Lfx_76
Lok_74:
s_waitcnt lgkmcnt(0)
s_barrier
v_mfma_f32_16x16x32_bf16 v[128:131], v[96:99], v[80:83], v[128:131]
ds_read_b128 v[32:35], v4 offset:0
v_mfma_f32_16x16x32_bf16 v[132:135], v[96:99], v[84:87], v[132:135]
ds_read_b64_tr_b16 v[48:49], v13 offset:16384
v_mfma_f32_16x16x32_bf16 v[136:139], v[96:99], v[88:91], v[136:139]
ds_read_b64_tr_b16 v[50:51], v13 offset:20480
v_mfma_f32_16x16x32_bf16 v[140:143], v[96:99], v[92:95], v[140:143]
ds_read_b128 v[36:39], v4 offset:256
v_mfma_f32_16x16x32_bf16 v[204:207], v[112:115], v[92:95], v[204:207]
ds_read_b128 v[40:43], v4 offset:512
v_mfma_f32_16x16x32_bf16 v[200:203], v[112:115], v[88:91], v[200:203]
ds_read_b128 v[44:47], v4 offset:768
v_mfma_f32_16x16x32_bf16 v[196:199], v[112:115], v[84:87], v[196:199]
ds_read_b64_tr_b16 v[64:65], v13 offset:32768
v_mfma_f32_16x16x32_bf16 v[192:195], v[112:115], v[80:83], v[192:195]
ds_read_b64_tr_b16 v[66:67], v13 offset:36864
v_mfma_f32_16x16x32_bf16 v[144:147], v[100:103], v[80:83], v[144:147]
ds_read_b64_tr_b16 v[52:53], v14 offset:16384
v_mfma_f32_16x16x32_bf16 v[148:151], v[100:103], v[84:87], v[148:151]
ds_read_b64_tr_b16 v[54:55], v14 offset:20480
v_mfma_f32_16x16x32_bf16 v[152:155], v[100:103], v[88:91], v[152:155]
ds_read_b64_tr_b16 v[68:69], v14 offset:32768
v_mfma_f32_16x16x32_bf16 v[156:159], v[100:103], v[92:95], v[156:159]
ds_read_b64_tr_b16 v[70:71], v14 offset:36864
v_mfma_f32_16x16x32_bf16 v[220:223], v[116:119], v[92:95], v[220:223]
ds_read_b64_tr_b16 v[56:57], v15 offset:16384
v_mfma_f32_16x16x32_bf16 v[216:219], v[116:119], v[88:91], v[216:219]
ds_read_b64_tr_b16 v[58:59], v15 offset:20480
v_mfma_f32_16x16x32_bf16 v[212:215], v[116:119], v[84:87], v[212:215]
ds_read_b64_tr_b16 v[72:73], v15 offset:32768
v_mfma_f32_16x16x32_bf16 v[208:211], v[116:119], v[80:83], v[208:211]
ds_read_b64_tr_b16 v[74:75], v15 offset:36864
v_mfma_f32_16x16x32_bf16 v[160:163], v[104:107], v[80:83], v[160:163]
ds_read_b64_tr_b16 v[60:61], v16 offset:16384
v_mfma_f32_16x16x32_bf16 v[164:167], v[104:107], v[84:87], v[164:167]
ds_read_b64_tr_b16 v[62:63], v16 offset:20480
v_mfma_f32_16x16x32_bf16 v[168:171], v[104:107], v[88:91], v[168:171]
ds_read_b64_tr_b16 v[76:77], v16 offset:32768
v_mfma_f32_16x16x32_bf16 v[172:175], v[104:107], v[92:95], v[172:175]
ds_read_b64_tr_b16 v[78:79], v16 offset:36864
s_waitcnt lgkmcnt(14)
v_mfma_f32_16x16x32_bf16 v[236:239], v[120:123], v[92:95], v[236:239]
v_max3_u32 v19, v32, v33, v34
v_mfma_f32_16x16x32_bf16 v[232:235], v[120:123], v[88:91], v[232:235]
v_max3_u32 v19, v19, v35, v36
v_mfma_f32_16x16x32_bf16 v[228:231], v[120:123], v[84:87], v[228:231]
v_max3_u32 v19, v19, v37, v38
v_mfma_f32_16x16x32_bf16 v[224:227], v[120:123], v[80:83], v[224:227]
v_max3_u32 v19, v19, v39, v40
v_mfma_f32_16x16x32_bf16 v[176:179], v[108:111], v[80:83], v[176:179]
v_max3_u32 v19, v19, v41, v42
v_mfma_f32_16x16x32_bf16 v[180:183], v[108:111], v[84:87], v[180:183]
v_max3_u32 v19, v19, v43, v44
v_mfma_f32_16x16x32_bf16 v[184:187], v[108:111], v[88:91], v[184:187]
v_max3_u32 v19, v19, v45, v46
v_mfma_f32_16x16x32_bf16 v[188:191], v[108:111], v[92:95], v[188:191]
v_max_u32 v19, v19, v47
v_mfma_f32_16x16x32_bf16 v[252:255], v[124:127], v[92:95], v[252:255]
v_cmp_eq_u32 vcc, -1, v19
v_mfma_f32_16x16x32_bf16 v[248:251], v[124:127], v[88:91], v[248:251]
v_mfma_f32_16x16x32_bf16 v[244:247], v[124:127], v[84:87], v[244:247]
v_mfma_f32_16x16x32_bf16 v[240:243], v[124:127], v[80:83], v[240:243]
s_nop 1
s_cbranch_vccnz Lfx_79
Lok_77:
s_waitcnt lgkmcnt(0)
v_mfma_f32_16x16x32_bf16 v[128:131], v[48:51], v[32:35], v[128:131]
ds_read_b128 v[80:83], v4 offset:8192
v_mfma_f32_16x16x32_bf16 v[132:135], v[48:51], v[36:39], v[132:135]
ds_read_b64_tr_b16 v[96:97], v13 offset:24576
v_mfma_f32_16x16x32_bf16 v[136:139], v[48:51], v[40:43], v[136:139]
ds_read_b64_tr_b16 v[98:99], v13 offset:28672
v_mfma_f32_16x16x32_bf16 v[140:143], v[48:51], v[44:47], v[140:143]
ds_read_b128 v[84:87], v4 offset:8448
v_mfma_f32_16x16x32_bf16 v[204:207], v[64:67], v[44:47], v[204:207]
ds_read_b128 v[88:91], v4 offset:8704
v_mfma_f32_16x16x32_bf16 v[200:203], v[64:67], v[40:43], v[200:203]
ds_read_b128 v[92:95], v4 offset:8960
v_mfma_f32_16x16x32_bf16 v[196:199], v[64:67], v[36:39], v[196:199]
ds_read_b64_tr_b16 v[112:113], v13 offset:40960
v_mfma_f32_16x16x32_bf16 v[192:195], v[64:67], v[32:35], v[192:195]
ds_read_b64_tr_b16 v[114:115], v13 offset:45056
v_mfma_f32_16x16x32_bf16 v[144:147], v[52:55], v[32:35], v[144:147]
ds_read_b64_tr_b16 v[100:101], v14 offset:24576
v_mfma_f32_16x16x32_bf16 v[148:151], v[52:55], v[36:39], v[148:151]
ds_read_b64_tr_b16 v[102:103], v14 offset:28672
v_mfma_f32_16x16x32_bf16 v[152:155], v[52:55], v[40:43], v[152:155]
ds_read_b64_tr_b16 v[116:117], v14 offset:40960
v_mfma_f32_16x16x32_bf16 v[156:159], v[52:55], v[44:47], v[156:159]
ds_read_b64_tr_b16 v[118:119], v14 offset:45056
v_mfma_f32_16x16x32_bf16 v[220:223], v[68:71], v[44:47], v[220:223]
ds_read_b64_tr_b16 v[104:105], v15 offset:24576
v_mfma_f32_16x16x32_bf16 v[216:219], v[68:71], v[40:43], v[216:219]
ds_read_b64_tr_b16 v[106:107], v15 offset:28672
v_mfma_f32_16x16x32_bf16 v[212:215], v[68:71], v[36:39], v[212:215]
ds_read_b64_tr_b16 v[120:121], v15 offset:40960
v_mfma_f32_16x16x32_bf16 v[208:211], v[68:71], v[32:35], v[208:211]
ds_read_b64_tr_b16 v[122:123], v15 offset:45056
v_mfma_f32_16x16x32_bf16 v[160:163], v[56:59], v[32:35], v[160:163]
ds_read_b64_tr_b16 v[108:109], v16 offset:24576
v_mfma_f32_16x16x32_bf16 v[164:167], v[56:59], v[36:39], v[164:167]
ds_read_b64_tr_b16 v[110:111], v16 offset:28672
v_mfma_f32_16x16x32_bf16 v[168:171], v[56:59], v[40:43], v[168:171]
ds_read_b64_tr_b16 v[124:125], v16 offset:40960
v_mfma_f32_16x16x32_bf16 v[172:175], v[56:59], v[44:47], v[172:175]
ds_read_b64_tr_b16 v[126:127], v16 offset:45056
s_waitcnt lgkmcnt(14)
v_mfma_f32_16x16x32_bf16 v[236:239], v[72:75], v[44:47], v[236:239]
v_max3_u32 v19, v80, v81, v82
v_mfma_f32_16x16x32_bf16 v[232:235], v[72:75], v[40:43], v[232:235]
v_max3_u32 v19, v19, v83, v84
v_mfma_f32_16x16x32_bf16 v[228:231], v[72:75], v[36:39], v[228:231]
v_max3_u32 v19, v19, v85, v86
v_mfma_f32_16x16x32_bf16 v[224:227], v[72:75], v[32:35], v[224:227]
v_max3_u32 v19, v19, v87, v88
v_mfma_f32_16x16x32_bf16 v[176:179], v[60:63], v[32:35], v[176:179]
v_max3_u32 v19, v19, v89, v90
v_mfma_f32_16x16x32_bf16 v[180:183], v[60:63], v[36:39], v[180:183]
v_max3_u32 v19, v19, v91, v92
v_mfma_f32_16x16x32_bf16 v[184:187], v[60:63], v[40:43], v[184:187]
v_max3_u32 v19, v19, v93, v94
v_mfma_f32_16x16x32_bf16 v[188:191], v[60:63], v[44:47], v[188:191]
v_max_u32 v19, v19, v95
v_mfma_f32_16x16x32_bf16 v[252:255], v[76:79], v[44:47], v[252:255]
v_cmp_eq_u32 vcc, -1, v19
v_mfma_f32_16x16x32_bf16 v[248:251], v[76:79], v[40:43], v[248:251]
v_mfma_f32_16x16x32_bf16 v[244:247], v[76:79], v[36:39], v[244:247]
v_mfma_f32_16x16x32_bf16 v[240:243], v[76:79], v[32:35], v[240:243]
s_nop 1
s_cbranch_vccnz Lfx_82
Lok_80:
s_waitcnt lgkmcnt(0)
s_barrier
v_mfma_f32_16x16x32_bf16 v[128:131], v[96:99], v[80:83], v[128:131]
ds_read_b128 v[32:35], v2 offset:0
v_mfma_f32_16x16x32_bf16 v[132:135], v[96:99], v[84:87], v[132:135]
ds_read_b64_tr_b16 v[48:49], v5 offset:16384
v_mfma_f32_16x16x32_bf16 v[136:139], v[96:99], v[88:91], v[136:139]
ds_read_b64_tr_b16 v[50:51], v5 offset:20480
v_mfma_f32_16x16x32_bf16 v[140:143], v[96:99], v[92:95], v[140:143]
ds_read_b128 v[36:39], v2 offset:256
v_mfma_f32_16x16x32_bf16 v[204:207], v[112:115], v[92:95], v[204:207]
ds_read_b128 v[40:43], v2 offset:512
v_mfma_f32_16x16x32_bf16 v[200:203], v[112:115], v[88:91], v[200:203]
ds_read_b128 v[44:47], v2 offset:768
v_mfma_f32_16x16x32_bf16 v[196:199], v[112:115], v[84:87], v[196:199]
ds_read_b64_tr_b16 v[64:65], v5 offset:32768
v_mfma_f32_16x16x32_bf16 v[192:195], v[112:115], v[80:83], v[192:195]
ds_read_b64_tr_b16 v[66:67], v5 offset:36864
v_mfma_f32_16x16x32_bf16 v[144:147], v[100:103], v[80:83], v[144:147]
ds_read_b64_tr_b16 v[52:53], v6 offset:16384
v_mfma_f32_16x16x32_bf16 v[148:151], v[100:103], v[84:87], v[148:151]
ds_read_b64_tr_b16 v[54:55], v6 offset:20480
v_mfma_f32_16x16x32_bf16 v[152:155], v[100:103], v[88:91], v[152:155]
ds_read_b64_tr_b16 v[68:69], v6 offset:32768
v_mfma_f32_16x16x32_bf16 v[156:159], v[100:103], v[92:95], v[156:159]
ds_read_b64_tr_b16 v[70:71], v6 offset:36864
v_mfma_f32_16x16x32_bf16 v[220:223], v[116:119], v[92:95], v[220:223]
ds_read_b64_tr_b16 v[56:57], v7 offset:16384
v_mfma_f32_16x16x32_bf16 v[216:219], v[116:119], v[88:91], v[216:219]
ds_read_b64_tr_b16 v[58:59], v7 offset:20480
v_mfma_f32_16x16x32_bf16 v[212:215], v[116:119], v[84:87], v[212:215]
ds_read_b64_tr_b16 v[72:73], v7 offset:32768
v_mfma_f32_16x16x32_bf16 v[208:211], v[116:119], v[80:83], v[208:211]
ds_read_b64_tr_b16 v[74:75], v7 offset:36864
v_mfma_f32_16x16x32_bf16 v[160:163], v[104:107], v[80:83], v[160:163]
ds_read_b64_tr_b16 v[60:61], v8 offset:16384
v_mfma_f32_16x16x32_bf16 v[164:167], v[104:107], v[84:87], v[164:167]
ds_read_b64_tr_b16 v[62:63], v8 offset:20480
v_mfma_f32_16x16x32_bf16 v[168:171], v[104:107], v[88:91], v[168:171]
ds_read_b64_tr_b16 v[76:77], v8 offset:32768
v_mfma_f32_16x16x32_bf16 v[172:175], v[104:107], v[92:95], v[172:175]
ds_read_b64_tr_b16 v[78:79], v8 offset:36864
s_waitcnt lgkmcnt(14)
v_mfma_f32_16x16x32_bf16 v[236:239], v[120:123], v[92:95], v[236:239]
v_max3_u32 v19, v32, v33, v34
v_mfma_f32_16x16x32_bf16 v[232:235], v[120:123], v[88:91], v[232:235]
v_max3_u32 v19, v19, v35, v36
v_mfma_f32_16x16x32_bf16 v[228:231], v[120:123], v[84:87], v[228:231]
v_max3_u32 v19, v19, v37, v38
v_mfma_f32_16x16x32_bf16 v[224:227], v[120:123], v[80:83], v[224:227]
v_max3_u32 v19, v19, v39, v40
v_mfma_f32_16x16x32_bf16 v[176:179], v[108:111], v[80:83], v[176:179]
v_max3_u32 v19, v19, v41, v42
v_mfma_f32_16x16x32_bf16 v[180:183], v[108:111], v[84:87], v[180:183]
v_max3_u32 v19, v19, v43, v44
v_mfma_f32_16x16x32_bf16 v[184:187], v[108:111], v[88:91], v[184:187]
v_max3_u32 v19, v19, v45, v46
v_mfma_f32_16x16x32_bf16 v[188:191], v[108:111], v[92:95], v[188:191]
v_max_u32 v19, v19, v47
v_mfma_f32_16x16x32_bf16 v[252:255], v[124:127], v[92:95], v[252:255]
v_cmp_eq_u32 vcc, -1, v19
v_mfma_f32_16x16x32_bf16 v[248:251], v[124:127], v[88:91], v[248:251]
v_mfma_f32_16x16x32_bf16 v[244:247], v[124:127], v[84:87], v[244:247]
v_mfma_f32_16x16x32_bf16 v[240:243], v[124:127], v[80:83], v[240:243]
s_nop 1
s_cbranch_vccnz Lfx_85
Lok_83:
s_waitcnt lgkmcnt(0)
v_mfma_f32_16x16x32_bf16 v[128:131], v[48:51], v[32:35], v[128:131]
ds_read_b128 v[80:83], v2 offset:8192
v_mfma_f32_16x16x32_bf16 v[132:135], v[48:51], v[36:39], v[132:135]
ds_read_b64_tr_b16 v[96:97], v5 offset:24576
v_mfma_f32_16x16x32_bf16 v[136:139], v[48:51], v[40:43], v[136:139]
ds_read_b64_tr_b16 v[98:99], v5 offset:28672
v_mfma_f32_16x16x32_bf16 v[140:143], v[48:51], v[44:47], v[140:143]
ds_read_b128 v[84:87], v2 offset:8448
v_mfma_f32_16x16x32_bf16 v[204:207], v[64:67], v[44:47], v[204:207]
ds_read_b128 v[88:91], v2 offset:8704
v_mfma_f32_16x16x32_bf16 v[200:203], v[64:67], v[40:43], v[200:203]
ds_read_b128 v[92:95], v2 offset:8960
v_mfma_f32_16x16x32_bf16 v[196:199], v[64:67], v[36:39], v[196:199]
ds_read_b64_tr_b16 v[112:113], v5 offset:40960
v_mfma_f32_16x16x32_bf16 v[192:195], v[64:67], v[32:35], v[192:195]
ds_read_b64_tr_b16 v[114:115], v5 offset:45056
v_mfma_f32_16x16x32_bf16 v[144:147], v[52:55], v[32:35], v[144:147]
ds_read_b64_tr_b16 v[100:101], v6 offset:24576
v_mfma_f32_16x16x32_bf16 v[148:151], v[52:55], v[36:39], v[148:151]
ds_read_b64_tr_b16 v[102:103], v6 offset:28672
v_mfma_f32_16x16x32_bf16 v[152:155], v[52:55], v[40:43], v[152:155]
ds_read_b64_tr_b16 v[116:117], v6 offset:40960
v_mfma_f32_16x16x32_bf16 v[156:159], v[52:55], v[44:47], v[156:159]
ds_read_b64_tr_b16 v[118:119], v6 offset:45056
v_mfma_f32_16x16x32_bf16 v[220:223], v[68:71], v[44:47], v[220:223]
ds_read_b64_tr_b16 v[104:105], v7 offset:24576
v_mfma_f32_16x16x32_bf16 v[216:219], v[68:71], v[40:43], v[216:219]
ds_read_b64_tr_b16 v[106:107], v7 offset:28672
v_mfma_f32_16x16x32_bf16 v[212:215], v[68:71], v[36:39], v[212:215]
ds_read_b64_tr_b16 v[120:121], v7 offset:40960
v_mfma_f32_16x16x32_bf16 v[208:211], v[68:71], v[32:35], v[208:211]
ds_read_b64_tr_b16 v[122:123], v7 offset:45056
v_mfma_f32_16x16x32_bf16 v[160:163], v[56:59], v[32:35], v[160:163]
ds_read_b64_tr_b16 v[108:109], v8 offset:24576
v_mfma_f32_16x16x32_bf16 v[164:167], v[56:59], v[36:39], v[164:167]
ds_read_b64_tr_b16 v[110:111], v8 offset:28672
v_mfma_f32_16x16x32_bf16 v[168:171], v[56:59], v[40:43], v[168:171]
ds_read_b64_tr_b16 v[124:125], v8 offset:40960
v_mfma_f32_16x16x32_bf16 v[172:175], v[56:59], v[44:47], v[172:175]
ds_read_b64_tr_b16 v[126:127], v8 offset:45056
s_waitcnt lgkmcnt(14)
v_mfma_f32_16x16x32_bf16 v[236:239], v[72:75], v[44:47], v[236:239]
v_max3_u32 v19, v80, v81, v82
v_mfma_f32_16x16x32_bf16 v[232:235], v[72:75], v[40:43], v[232:235]
v_max3_u32 v19, v19, v83, v84
v_mfma_f32_16x16x32_bf16 v[228:231], v[72:75], v[36:39], v[228:231]
v_max3_u32 v19, v19, v85, v86
v_mfma_f32_16x16x32_bf16 v[224:227], v[72:75], v[32:35], v[224:227]
v_max3_u32 v19, v19, v87, v88
v_mfma_f32_16x16x32_bf16 v[176:179], v[60:63], v[32:35], v[176:179]
v_max3_u32 v19, v19, v89, v90
v_mfma_f32_16x16x32_bf16 v[180:183], v[60:63], v[36:39], v[180:183]
v_max3_u32 v19, v19, v91, v92
v_mfma_f32_16x16x32_bf16 v[184:187], v[60:63], v[40:43], v[184:187]
v_max3_u32 v19, v19, v93, v94
v_mfma_f32_16x16x32_bf16 v[188:191], v[60:63], v[44:47], v[188:191]
v_max_u32 v19, v19, v95
v_mfma_f32_16x16x32_bf16 v[252:255], v[76:79], v[44:47], v[252:255]
v_cmp_eq_u32 vcc, -1, v19
v_mfma_f32_16x16x32_bf16 v[248:251], v[76:79], v[40:43], v[248:251]
v_mfma_f32_16x16x32_bf16 v[244:247], v[76:79], v[36:39], v[244:247]
v_mfma_f32_16x16x32_bf16 v[240:243], v[76:79], v[32:35], v[240:243]
s_nop 1
s_cbranch_vccnz Lfx_88
Lok_86:
s_waitcnt lgkmcnt(0)
s_barrier
v_mfma_f32_16x16x32_bf16 v[128:131], v[96:99], v[80:83], v[128:131]
ds_read_b128 v[32:35], v3 offset:0
v_mfma_f32_16x16x32_bf16 v[132:135], v[96:99], v[84:87], v[132:135]
ds_read_b64_tr_b16 v[48:49], v9 offset:16384
v_mfma_f32_16x16x32_bf16 v[136:139], v[96:99], v[88:91], v[136:139]
ds_read_b64_tr_b16 v[50:51], v9 offset:20480
v_mfma_f32_16x16x32_bf16 v[140:143], v[96:99], v[92:95], v[140:143]
ds_read_b128 v[36:39], v3 offset:256
v_mfma_f32_16x16x32_bf16 v[204:207], v[112:115], v[92:95], v[204:207]
ds_read_b128 v[40:43], v3 offset:512
v_mfma_f32_16x16x32_bf16 v[200:203], v[112:115], v[88:91], v[200:203]
ds_read_b128 v[44:47], v3 offset:768
v_mfma_f32_16x16x32_bf16 v[196:199], v[112:115], v[84:87], v[196:199]
ds_read_b64_tr_b16 v[64:65], v9 offset:32768
v_mfma_f32_16x16x32_bf16 v[192:195], v[112:115], v[80:83], v[192:195]
ds_read_b64_tr_b16 v[66:67], v9 offset:36864
v_mfma_f32_16x16x32_bf16 v[144:147], v[100:103], v[80:83], v[144:147]
ds_read_b64_tr_b16 v[52:53], v10 offset:16384
v_mfma_f32_16x16x32_bf16 v[148:151], v[100:103], v[84:87], v[148:151]
ds_read_b64_tr_b16 v[54:55], v10 offset:20480
v_mfma_f32_16x16x32_bf16 v[152:155], v[100:103], v[88:91], v[152:155]
ds_read_b64_tr_b16 v[68:69], v10 offset:32768
v_mfma_f32_16x16x32_bf16 v[156:159], v[100:103], v[92:95], v[156:159]
ds_read_b64_tr_b16 v[70:71], v10 offset:36864
v_mfma_f32_16x16x32_bf16 v[220:223], v[116:119], v[92:95], v[220:223]
ds_read_b64_tr_b16 v[56:57], v11 offset:16384
v_mfma_f32_16x16x32_bf16 v[216:219], v[116:119], v[88:91], v[216:219]
ds_read_b64_tr_b16 v[58:59], v11 offset:20480
v_mfma_f32_16x16x32_bf16 v[212:215], v[116:119], v[84:87], v[212:215]
ds_read_b64_tr_b16 v[72:73], v11 offset:32768
v_mfma_f32_16x16x32_bf16 v[208:211], v[116:119], v[80:83], v[208:211]
ds_read_b64_tr_b16 v[74:75], v11 offset:36864
v_mfma_f32_16x16x32_bf16 v[160:163], v[104:107], v[80:83], v[160:163]
ds_read_b64_tr_b16 v[60:61], v12 offset:16384
v_mfma_f32_16x16x32_bf16 v[164:167], v[104:107], v[84:87], v[164:167]
ds_read_b64_tr_b16 v[62:63], v12 offset:20480
v_mfma_f32_16x16x32_bf16 v[168:171], v[104:107], v[88:91], v[168:171]
ds_read_b64_tr_b16 v[76:77], v12 offset:32768
v_mfma_f32_16x16x32_bf16 v[172:175], v[104:107], v[92:95], v[172:175]
ds_read_b64_tr_b16 v[78:79], v12 offset:36864
v_mfma_f32_16x16x32_bf16 v[236:239], v[120:123], v[92:95], v[236:239]
v_mfma_f32_16x16x32_bf16 v[232:235], v[120:123], v[88:91], v[232:235]
v_mfma_f32_16x16x32_bf16 v[228:231], v[120:123], v[84:87], v[228:231]
v_mfma_f32_16x16x32_bf16 v[224:227], v[120:123], v[80:83], v[224:227]
v_mfma_f32_16x16x32_bf16 v[176:179], v[108:111], v[80:83], v[176:179]
v_mfma_f32_16x16x32_bf16 v[180:183], v[108:111], v[84:87], v[180:183]
v_mfma_f32_16x16x32_bf16 v[184:187], v[108:111], v[88:91], v[184:187]
v_mfma_f32_16x16x32_bf16 v[188:191], v[108:111], v[92:95], v[188:191]
v_mfma_f32_16x16x32_bf16 v[252:255], v[124:127], v[92:95], v[252:255]
v_mfma_f32_16x16x32_bf16 v[248:251], v[124:127], v[88:91], v[248:251]
v_mfma_f32_16x16x32_bf16 v[244:247], v[124:127], v[84:87], v[244:247]
v_mfma_f32_16x16x32_bf16 v[240:243], v[124:127], v[80:83], v[240:243]
s_mov_b32 s41, 2
.p2align 3
Lk3_89:
s_waitcnt lgkmcnt(0)
v_mfma_f32_16x16x32_bf16 v[128:131], v[48:51], v[32:35], v[128:131]
ds_read_b128 v[80:83], v3 offset:8192
v_mfma_f32_16x16x32_bf16 v[132:135], v[48:51], v[36:39], v[132:135]
ds_read_b64_tr_b16 v[96:97], v9 offset:24576
v_mfma_f32_16x16x32_bf16 v[136:139], v[48:51], v[40:43], v[136:139]
ds_read_b64_tr_b16 v[98:99], v9 offset:28672
v_mfma_f32_16x16x32_bf16 v[140:143], v[48:51], v[44:47], v[140:143]
ds_read_b128 v[84:87], v3 offset:8448
v_mfma_f32_16x16x32_bf16 v[204:207], v[64:67], v[44:47], v[204:207]
ds_read_b128 v[88:91], v3 offset:8704
v_mfma_f32_16x16x32_bf16 v[200:203], v[64:67], v[40:43], v[200:203]
ds_read_b128 v[92:95], v3 offset:8960
v_mfma_f32_16x16x32_bf16 v[196:199], v[64:67], v[36:39], v[196:199]
ds_read_b64_tr_b16 v[112:113], v9 offset:40960
v_mfma_f32_16x16x32_bf16 v[192:195], v[64:67], v[32:35], v[192:195]
ds_read_b64_tr_b16 v[114:115], v9 offset:45056
v_mfma_f32_16x16x32_bf16 v[144:147], v[52:55], v[32:35], v[144:147]
ds_read_b64_tr_b16 v[100:101], v10 offset:24576
v_mfma_f32_16x16x32_bf16 v[148:151], v[52:55], v[36:39], v[148:151]
ds_read_b64_tr_b16 v[102:103], v10 offset:28672
v_mfma_f32_16x16x32_bf16 v[152:155], v[52:55], v[40:43], v[152:155]
ds_read_b64_tr_b16 v[116:117], v10 offset:40960
v_mfma_f32_16x16x32_bf16 v[156:159], v[52:55], v[44:47], v[156:159]
ds_read_b64_tr_b16 v[118:119], v10 offset:45056
v_mfma_f32_16x16x32_bf16 v[220:223], v[68:71], v[44:47], v[220:223]
ds_read_b64_tr_b16 v[104:105], v11 offset:24576
v_mfma_f32_16x16x32_bf16 v[216:219], v[68:71], v[40:43], v[216:219]
ds_read_b64_tr_b16 v[106:107], v11 offset:28672
v_mfma_f32_16x16x32_bf16 v[212:215], v[68:71], v[36:39], v[212:215]
ds_read_b64_tr_b16 v[120:121], v11 offset:40960
v_mfma_f32_16x16x32_bf16 v[208:211], v[68:71], v[32:35], v[208:211]
ds_read_b64_tr_b16 v[122:123], v11 offset:45056
v_mfma_f32_16x16x32_bf16 v[160:163], v[56:59], v[32:35], v[160:163]
ds_read_b64_tr_b16 v[108:109], v12 offset:24576
v_mfma_f32_16x16x32_bf16 v[164:167], v[56:59], v[36:39], v[164:167]
ds_read_b64_tr_b16 v[110:111], v12 offset:28672
v_mfma_f32_16x16x32_bf16 v[168:171], v[56:59], v[40:43], v[168:171]
ds_read_b64_tr_b16 v[124:125], v12 offset:40960
v_mfma_f32_16x16x32_bf16 v[172:175], v[56:59], v[44:47], v[172:175]
ds_read_b64_tr_b16 v[126:127], v12 offset:45056
v_mfma_f32_16x16x32_bf16 v[236:239], v[72:75], v[44:47], v[236:239]
v_mfma_f32_16x16x32_bf16 v[232:235], v[72:75], v[40:43], v[232:235]
v_mfma_f32_16x16x32_bf16 v[228:231], v[72:75], v[36:39], v[228:231]
v_mfma_f32_16x16x32_bf16 v[224:227], v[72:75], v[32:35], v[224:227]
v_mfma_f32_16x16x32_bf16 v[176:179], v[60:63], v[32:35], v[176:179]
v_mfma_f32_16x16x32_bf16 v[180:183], v[60:63], v[36:39], v[180:183]
v_mfma_f32_16x16x32_bf16 v[184:187], v[60:63], v[40:43], v[184:187]
v_mfma_f32_16x16x32_bf16 v[188:191], v[60:63], v[44:47], v[188:191]
v_mfma_f32_16x16x32_bf16 v[252:255], v[76:79], v[44:47], v[252:255]
v_mfma_f32_16x16x32_bf16 v[248:251], v[76:79], v[40:43], v[248:251]
v_mfma_f32_16x16x32_bf16 v[244:247], v[76:79], v[36:39], v[244:247]
v_mfma_f32_16x16x32_bf16 v[240:243], v[76:79], v[32:35], v[240:243]
s_waitcnt lgkmcnt(0)
s_barrier
v_mfma_f32_16x16x32_bf16 v[128:131], v[96:99], v[80:83], v[128:131]
ds_read_b128 v[32:35], v4 offset:0
v_mfma_f32_16x16x32_bf16 v[132:135], v[96:99], v[84:87], v[132:135]
ds_read_b64_tr_b16 v[48:49], v13 offset:16384
v_mfma_f32_16x16x32_bf16 v[136:139], v[96:99], v[88:91], v[136:139]
ds_read_b64_tr_b16 v[50:51], v13 offset:20480
v_mfma_f32_16x16x32_bf16 v[140:143], v[96:99], v[92:95], v[140:143]
ds_read_b128 v[36:39], v4 offset:256
v_mfma_f32_16x16x32_bf16 v[204:207], v[112:115], v[92:95], v[204:207]
ds_read_b128 v[40:43], v4 offset:512
v_mfma_f32_16x16x32_bf16 v[200:203], v[112:115], v[88:91], v[200:203]
ds_read_b128 v[44:47], v4 offset:768
v_mfma_f32_16x16x32_bf16 v[196:199], v[112:115], v[84:87], v[196:199]
ds_read_b64_tr_b16 v[64:65], v13 offset:32768
v_mfma_f32_16x16x32_bf16 v[192:195], v[112:115], v[80:83], v[192:195]
ds_read_b64_tr_b16 v[66:67], v13 offset:36864
v_mfma_f32_16x16x32_bf16 v[144:147], v[100:103], v[80:83], v[144:147]
ds_read_b64_tr_b16 v[52:53], v14 offset:16384
v_mfma_f32_16x16x32_bf16 v[148:151], v[100:103], v[84:87], v[148:151]
ds_read_b64_tr_b16 v[54:55], v14 offset:20480
v_mfma_f32_16x16x32_bf16 v[152:155], v[100:103], v[88:91], v[152:155]
ds_read_b64_tr_b16 v[68:69], v14 offset:32768
v_mfma_f32_16x16x32_bf16 v[156:159], v[100:103], v[92:95], v[156:159]
ds_read_b64_tr_b16 v[70:71], v14 offset:36864
v_mfma_f32_16x16x32_bf16 v[220:223], v[116:119], v[92:95], v[220:223]
ds_read_b64_tr_b16 v[56:57], v15 offset:16384
v_mfma_f32_16x16x32_bf16 v[216:219], v[116:119], v[88:91], v[216:219]
ds_read_b64_tr_b16 v[58:59], v15 offset:20480
v_mfma_f32_16x16x32_bf16 v[212:215], v[116:119], v[84:87], v[212:215]
ds_read_b64_tr_b16 v[72:73], v15 offset:32768
v_mfma_f32_16x16x32_bf16 v[208:211], v[116:119], v[80:83], v[208:211]
ds_read_b64_tr_b16 v[74:75], v15 offset:36864
v_mfma_f32_16x16x32_bf16 v[160:163], v[104:107], v[80:83], v[160:163]
ds_read_b64_tr_b16 v[60:61], v16 offset:16384
v_mfma_f32_16x16x32_bf16 v[164:167], v[104:107], v[84:87], v[164:167]
ds_read_b64_tr_b16 v[62:63], v16 offset:20480
v_mfma_f32_16x16x32_bf16 v[168:171], v[104:107], v[88:91], v[168:171]
ds_read_b64_tr_b16 v[76:77], v16 offset:32768
v_mfma_f32_16x16x32_bf16 v[172:175], v[104:107], v[92:95], v[172:175]
ds_read_b64_tr_b16 v[78:79], v16 offset:36864
v_mfma_f32_16x16x32_bf16 v[236:239], v[120:123], v[92:95], v[236:239]
v_mfma_f32_16x16x32_bf16 v[232:235], v[120:123], v[88:91], v[232:235]
v_mfma_f32_16x16x32_bf16 v[228:231], v[120:123], v[84:87], v[228:231]
v_mfma_f32_16x16x32_bf16 v[224:227], v[120:123], v[80:83], v[224:227]
v_mfma_f32_16x16x32_bf16 v[176:179], v[108:111], v[80:83], v[176:179]
v_mfma_f32_16x16x32_bf16 v[180:183], v[108:111], v[84:87], v[180:183]
v_mfma_f32_16x16x32_bf16 v[184:187], v[108:111], v[88:91], v[184:187]
v_mfma_f32_16x16x32_bf16 v[188:191], v[108:111], v[92:95], v[188:191]
v_mfma_f32_16x16x32_bf16 v[252:255], v[124:127], v[92:95], v[252:255]
v_mfma_f32_16x16x32_bf16 v[248:251], v[124:127], v[88:91], v[248:251]
v_mfma_f32_16x16x32_bf16 v[244:247], v[124:127], v[84:87], v[244:247]
v_mfma_f32_16x16x32_bf16 v[240:243], v[124:127], v[80:83], v[240:243]
s_waitcnt lgkmcnt(0)
v_mfma_f32_16x16x32_bf16 v[128:131], v[48:51], v[32:35], v[128:131]
ds_read_b128 v[80:83], v4 offset:8192
v_mfma_f32_16x16x32_bf16 v[132:135], v[48:51], v[36:39], v[132:135]
ds_read_b64_tr_b16 v[96:97], v13 offset:24576
v_mfma_f32_16x16x32_bf16 v[136:139], v[48:51], v[40:43], v[136:139]
ds_read_b64_tr_b16 v[98:99], v13 offset:28672
v_mfma_f32_16x16x32_bf16 v[140:143], v[48:51], v[44:47], v[140:143]
ds_read_b128 v[84:87], v4 offset:8448
v_mfma_f32_16x16x32_bf16 v[204:207], v[64:67], v[44:47], v[204:207]
ds_read_b128 v[88:91], v4 offset:8704
v_mfma_f32_16x16x32_bf16 v[200:203], v[64:67], v[40:43], v[200:203]
ds_read_b128 v[92:95], v4 offset:8960
v_mfma_f32_16x16x32_bf16 v[196:199], v[64:67], v[36:39], v[196:199]
ds_read_b64_tr_b16 v[112:113], v13 offset:40960
v_mfma_f32_16x16x32_bf16 v[192:195], v[64:67], v[32:35], v[192:195]
ds_read_b64_tr_b16 v[114:115], v13 offset:45056
v_mfma_f32_16x16x32_bf16 v[144:147], v[52:55], v[32:35], v[144:147]
ds_read_b64_tr_b16 v[100:101], v14 offset:24576
v_mfma_f32_16x16x32_bf16 v[148:151], v[52:55], v[36:39], v[148:151]
ds_read_b64_tr_b16 v[102:103], v14 offset:28672
v_mfma_f32_16x16x32_bf16 v[152:155], v[52:55], v[40:43], v[152:155]
ds_read_b64_tr_b16 v[116:117], v14 offset:40960
v_mfma_f32_16x16x32_bf16 v[156:159], v[52:55], v[44:47], v[156:159]
ds_read_b64_tr_b16 v[118:119], v14 offset:45056
v_mfma_f32_16x16x32_bf16 v[220:223], v[68:71], v[44:47], v[220:223]
ds_read_b64_tr_b16 v[104:105], v15 offset:24576
v_mfma_f32_16x16x32_bf16 v[216:219], v[68:71], v[40:43], v[216:219]
ds_read_b64_tr_b16 v[106:107], v15 offset:28672
v_mfma_f32_16x16x32_bf16 v[212:215], v[68:71], v[36:39], v[212:215]
ds_read_b64_tr_b16 v[120:121], v15 offset:40960
v_mfma_f32_16x16x32_bf16 v[208:211], v[68:71], v[32:35], v[208:211]
ds_read_b64_tr_b16 v[122:123], v15 offset:45056
v_mfma_f32_16x16x32_bf16 v[160:163], v[56:59], v[32:35], v[160:163]
ds_read_b64_tr_b16 v[108:109], v16 offset:24576
v_mfma_f32_16x16x32_bf16 v[164:167], v[56:59], v[36:39], v[164:167]
ds_read_b64_tr_b16 v[110:111], v16 offset:28672
v_mfma_f32_16x16x32_bf16 v[168:171], v[56:59], v[40:43], v[168:171]
ds_read_b64_tr_b16 v[124:125], v16 offset:40960
v_mfma_f32_16x16x32_bf16 v[172:175], v[56:59], v[44:47], v[172:175]
ds_read_b64_tr_b16 v[126:127], v16 offset:45056
v_mfma_f32_16x16x32_bf16 v[236:239], v[72:75], v[44:47], v[236:239]
v_mfma_f32_16x16x32_bf16 v[232:235], v[72:75], v[40:43], v[232:235]
v_mfma_f32_16x16x32_bf16 v[228:231], v[72:75], v[36:39], v[228:231]
v_mfma_f32_16x16x32_bf16 v[224:227], v[72:75], v[32:35], v[224:227]
v_mfma_f32_16x16x32_bf16 v[176:179], v[60:63], v[32:35], v[176:179]
v_mfma_f32_16x16x32_bf16 v[180:183], v[60:63], v[36:39], v[180:183]
v_mfma_f32_16x16x32_bf16 v[184:187], v[60:63], v[40:43], v[184:187]
v_mfma_f32_16x16x32_bf16 v[188:191], v[60:63], v[44:47], v[188:191]
v_mfma_f32_16x16x32_bf16 v[252:255], v[76:79], v[44:47], v[252:255]
v_mfma_f32_16x16x32_bf16 v[248:251], v[76:79], v[40:43], v[248:251]
v_mfma_f32_16x16x32_bf16 v[244:247], v[76:79], v[36:39], v[244:247]
v_mfma_f32_16x16x32_bf16 v[240:243], v[76:79], v[32:35], v[240:243]
s_waitcnt lgkmcnt(0)
s_barrier
v_mfma_f32_16x16x32_bf16 v[128:131], v[96:99], v[80:83], v[128:131]
ds_read_b128 v[32:35], v2 offset:0
v_mfma_f32_16x16x32_bf16 v[132:135], v[96:99], v[84:87], v[132:135]
ds_read_b64_tr_b16 v[48:49], v5 offset:16384
v_mfma_f32_16x16x32_bf16 v[136:139], v[96:99], v[88:91], v[136:139]
ds_read_b64_tr_b16 v[50:51], v5 offset:20480
v_mfma_f32_16x16x32_bf16 v[140:143], v[96:99], v[92:95], v[140:143]
ds_read_b128 v[36:39], v2 offset:256
v_mfma_f32_16x16x32_bf16 v[204:207], v[112:115], v[92:95], v[204:207]
ds_read_b128 v[40:43], v2 offset:512
v_mfma_f32_16x16x32_bf16 v[200:203], v[112:115], v[88:91], v[200:203]
ds_read_b128 v[44:47], v2 offset:768
v_mfma_f32_16x16x32_bf16 v[196:199], v[112:115], v[84:87], v[196:199]
ds_read_b64_tr_b16 v[64:65], v5 offset:32768
v_mfma_f32_16x16x32_bf16 v[192:195], v[112:115], v[80:83], v[192:195]
ds_read_b64_tr_b16 v[66:67], v5 offset:36864
v_mfma_f32_16x16x32_bf16 v[144:147], v[100:103], v[80:83], v[144:147]
ds_read_b64_tr_b16 v[52:53], v6 offset:16384
v_mfma_f32_16x16x32_bf16 v[148:151], v[100:103], v[84:87], v[148:151]
ds_read_b64_tr_b16 v[54:55], v6 offset:20480
v_mfma_f32_16x16x32_bf16 v[152:155], v[100:103], v[88:91], v[152:155]
ds_read_b64_tr_b16 v[68:69], v6 offset:32768
v_mfma_f32_16x16x32_bf16 v[156:159], v[100:103], v[92:95], v[156:159]
ds_read_b64_tr_b16 v[70:71], v6 offset:36864
v_mfma_f32_16x16x32_bf16 v[220:223], v[116:119], v[92:95], v[220:223]
ds_read_b64_tr_b16 v[56:57], v7 offset:16384
v_mfma_f32_16x16x32_bf16 v[216:219], v[116:119], v[88:91], v[216:219]
ds_read_b64_tr_b16 v[58:59], v7 offset:20480
v_mfma_f32_16x16x32_bf16 v[212:215], v[116:119], v[84:87], v[212:215]
ds_read_b64_tr_b16 v[72:73], v7 offset:32768
v_mfma_f32_16x16x32_bf16 v[208:211], v[116:119], v[80:83], v[208:211]
ds_read_b64_tr_b16 v[74:75], v7 offset:36864
v_mfma_f32_16x16x32_bf16 v[160:163], v[104:107], v[80:83], v[160:163]
ds_read_b64_tr_b16 v[60:61], v8 offset:16384
v_mfma_f32_16x16x32_bf16 v[164:167], v[104:107], v[84:87], v[164:167]
ds_read_b64_tr_b16 v[62:63], v8 offset:20480
v_mfma_f32_16x16x32_bf16 v[168:171], v[104:107], v[88:91], v[168:171]
ds_read_b64_tr_b16 v[76:77], v8 offset:32768
v_mfma_f32_16x16x32_bf16 v[172:175], v[104:107], v[92:95], v[172:175]
ds_read_b64_tr_b16 v[78:79], v8 offset:36864
v_mfma_f32_16x16x32_bf16 v[236:239], v[120:123], v[92:95], v[236:239]
v_mfma_f32_16x16x32_bf16 v[232:235], v[120:123], v[88:91], v[232:235]
v_mfma_f32_16x16x32_bf16 v[228:231], v[120:123], v[84:87], v[228:231]
v_mfma_f32_16x16x32_bf16 v[224:227], v[120:123], v[80:83], v[224:227]
v_mfma_f32_16x16x32_bf16 v[176:179], v[108:111], v[80:83], v[176:179]
v_mfma_f32_16x16x32_bf16 v[180:183], v[108:111], v[84:87], v[180:183]
v_mfma_f32_16x16x32_bf16 v[184:187], v[108:111], v[88:91], v[184:187]
v_mfma_f32_16x16x32_bf16 v[188:191], v[108:111], v[92:95], v[188:191]
v_mfma_f32_16x16x32_bf16 v[252:255], v[124:127], v[92:95], v[252:255]
v_mfma_f32_16x16x32_bf16 v[248:251], v[124:127], v[88:91], v[248:251]
v_mfma_f32_16x16x32_bf16 v[244:247], v[124:127], v[84:87], v[244:247]
v_mfma_f32_16x16x32_bf16 v[240:243], v[124:127], v[80:83], v[240:243]
s_waitcnt lgkmcnt(0)
v_mfma_f32_16x16x32_bf16 v[128:131], v[48:51], v[32:35], v[128:131]
ds_read_b128 v[80:83], v2 offset:8192
v_mfma_f32_16x16x32_bf16 v[132:135], v[48:51], v[36:39], v[132:135]
ds_read_b64_tr_b16 v[96:97], v5 offset:24576
v_mfma_f32_16x16x32_bf16 v[136:139], v[48:51], v[40:43], v[136:139]
ds_read_b64_tr_b16 v[98:99], v5 offset:28672
v_mfma_f32_16x16x32_bf16 v[140:143], v[48:51], v[44:47], v[140:143]
ds_read_b128 v[84:87], v2 offset:8448
v_mfma_f32_16x16x32_bf16 v[204:207], v[64:67], v[44:47], v[204:207]
ds_read_b128 v[88:91], v2 offset:8704
v_mfma_f32_16x16x32_bf16 v[200:203], v[64:67], v[40:43], v[200:203]
ds_read_b128 v[92:95], v2 offset:8960
v_mfma_f32_16x16x32_bf16 v[196:199], v[64:67], v[36:39], v[196:199]
ds_read_b64_tr_b16 v[112:113], v5 offset:40960
v_mfma_f32_16x16x32_bf16 v[192:195], v[64:67], v[32:35], v[192:195]
ds_read_b64_tr_b16 v[114:115], v5 offset:45056
v_mfma_f32_16x16x32_bf16 v[144:147], v[52:55], v[32:35], v[144:147]
ds_read_b64_tr_b16 v[100:101], v6 offset:24576
v_mfma_f32_16x16x32_bf16 v[148:151], v[52:55], v[36:39], v[148:151]
ds_read_b64_tr_b16 v[102:103], v6 offset:28672
v_mfma_f32_16x16x32_bf16 v[152:155], v[52:55], v[40:43], v[152:155]
ds_read_b64_tr_b16 v[116:117], v6 offset:40960
v_mfma_f32_16x16x32_bf16 v[156:159], v[52:55], v[44:47], v[156:159]
ds_read_b64_tr_b16 v[118:119], v6 offset:45056
v_mfma_f32_16x16x32_bf16 v[220:223], v[68:71], v[44:47], v[220:223]
ds_read_b64_tr_b16 v[104:105], v7 offset:24576
v_mfma_f32_16x16x32_bf16 v[216:219], v[68:71], v[40:43], v[216:219]
ds_read_b64_tr_b16 v[106:107], v7 offset:28672
v_mfma_f32_16x16x32_bf16 v[212:215], v[68:71], v[36:39], v[212:215]
ds_read_b64_tr_b16 v[120:121], v7 offset:40960
v_mfma_f32_16x16x32_bf16 v[208:211], v[68:71], v[32:35], v[208:211]
ds_read_b64_tr_b16 v[122:123], v7 offset:45056
v_mfma_f32_16x16x32_bf16 v[160:163], v[56:59], v[32:35], v[160:163]
ds_read_b64_tr_b16 v[108:109], v8 offset:24576
v_mfma_f32_16x16x32_bf16 v[164:167], v[56:59], v[36:39], v[164:167]
ds_read_b64_tr_b16 v[110:111], v8 offset:28672
v_mfma_f32_16x16x32_bf16 v[168:171], v[56:59], v[40:43], v[168:171]
ds_read_b64_tr_b16 v[124:125], v8 offset:40960
v_mfma_f32_16x16x32_bf16 v[172:175], v[56:59], v[44:47], v[172:175]
ds_read_b64_tr_b16 v[126:127], v8 offset:45056
v_mfma_f32_16x16x32_bf16 v[236:239], v[72:75], v[44:47], v[236:239]
v_mfma_f32_16x16x32_bf16 v[232:235], v[72:75], v[40:43], v[232:235]
v_mfma_f32_16x16x32_bf16 v[228:231], v[72:75], v[36:39], v[228:231]
v_mfma_f32_16x16x32_bf16 v[224:227], v[72:75], v[32:35], v[224:227]
v_mfma_f32_16x16x32_bf16 v[176:179], v[60:63], v[32:35], v[176:179]
v_mfma_f32_16x16x32_bf16 v[180:183], v[60:63], v[36:39], v[180:183]
v_mfma_f32_16x16x32_bf16 v[184:187], v[60:63], v[40:43], v[184:187]
v_mfma_f32_16x16x32_bf16 v[188:191], v[60:63], v[44:47], v[188:191]
v_mfma_f32_16x16x32_bf16 v[252:255], v[76:79], v[44:47], v[252:255]
v_mfma_f32_16x16x32_bf16 v[248:251], v[76:79], v[40:43], v[248:251]
v_mfma_f32_16x16x32_bf16 v[244:247], v[76:79], v[36:39], v[244:247]
v_mfma_f32_16x16x32_bf16 v[240:243], v[76:79], v[32:35], v[240:243]
s_waitcnt lgkmcnt(0)
s_barrier
v_mfma_f32_16x16x32_bf16 v[128:131], v[96:99], v[80:83], v[128:131]
ds_read_b128 v[32:35], v3 offset:0
v_mfma_f32_16x16x32_bf16 v[132:135], v[96:99], v[84:87], v[132:135]
ds_read_b64_tr_b16 v[48:49], v9 offset:16384
v_mfma_f32_16x16x32_bf16 v[136:139], v[96:99], v[88:91], v[136:139]
ds_read_b64_tr_b16 v[50:51], v9 offset:20480
v_mfma_f32_16x16x32_bf16 v[140:143], v[96:99], v[92:95], v[140:143]
ds_read_b128 v[36:39], v3 offset:256
v_mfma_f32_16x16x32_bf16 v[204:207], v[112:115], v[92:95], v[204:207]
ds_read_b128 v[40:43], v3 offset:512
v_mfma_f32_16x16x32_bf16 v[200:203], v[112:115], v[88:91], v[200:203]
ds_read_b128 v[44:47], v3 offset:768
v_mfma_f32_16x16x32_bf16 v[196:199], v[112:115], v[84:87], v[196:199]
ds_read_b64_tr_b16 v[64:65], v9 offset:32768
v_mfma_f32_16x16x32_bf16 v[192:195], v[112:115], v[80:83], v[192:195]
ds_read_b64_tr_b16 v[66:67], v9 offset:36864
v_mfma_f32_16x16x32_bf16 v[144:147], v[100:103], v[80:83], v[144:147]
ds_read_b64_tr_b16 v[52:53], v10 offset:16384
v_mfma_f32_16x16x32_bf16 v[148:151], v[100:103], v[84:87], v[148:151]
ds_read_b64_tr_b16 v[54:55], v10 offset:20480
v_mfma_f32_16x16x32_bf16 v[152:155], v[100:103], v[88:91], v[152:155]
ds_read_b64_tr_b16 v[68:69], v10 offset:32768
v_mfma_f32_16x16x32_bf16 v[156:159], v[100:103], v[92:95], v[156:159]
ds_read_b64_tr_b16 v[70:71], v10 offset:36864
v_mfma_f32_16x16x32_bf16 v[220:223], v[116:119], v[92:95], v[220:223]
ds_read_b64_tr_b16 v[56:57], v11 offset:16384
v_mfma_f32_16x16x32_bf16 v[216:219], v[116:119], v[88:91], v[216:219]
ds_read_b64_tr_b16 v[58:59], v11 offset:20480
v_mfma_f32_16x16x32_bf16 v[212:215], v[116:119], v[84:87], v[212:215]
ds_read_b64_tr_b16 v[72:73], v11 offset:32768
v_mfma_f32_16x16x32_bf16 v[208:211], v[116:119], v[80:83], v[208:211]
ds_read_b64_tr_b16 v[74:75], v11 offset:36864
v_mfma_f32_16x16x32_bf16 v[160:163], v[104:107], v[80:83], v[160:163]
ds_read_b64_tr_b16 v[60:61], v12 offset:16384
v_mfma_f32_16x16x32_bf16 v[164:167], v[104:107], v[84:87], v[164:167]
ds_read_b64_tr_b16 v[62:63], v12 offset:20480
v_mfma_f32_16x16x32_bf16 v[168:171], v[104:107], v[88:91], v[168:171]
ds_read_b64_tr_b16 v[76:77], v12 offset:32768
v_mfma_f32_16x16x32_bf16 v[172:175], v[104:107], v[92:95], v[172:175]
ds_read_b64_tr_b16 v[78:79], v12 offset:36864
v_mfma_f32_16x16x32_bf16 v[236:239], v[120:123], v[92:95], v[236:239]
v_mfma_f32_16x16x32_bf16 v[232:235], v[120:123], v[88:91], v[232:235]
v_mfma_f32_16x16x32_bf16 v[228:231], v[120:123], v[84:87], v[228:231]
v_mfma_f32_16x16x32_bf16 v[224:227], v[120:123], v[80:83], v[224:227]
v_mfma_f32_16x16x32_bf16 v[176:179], v[108:111], v[80:83], v[176:179]
v_mfma_f32_16x16x32_bf16 v[180:183], v[108:111], v[84:87], v[180:183]
v_mfma_f32_16x16x32_bf16 v[184:187], v[108:111], v[88:91], v[184:187]
v_mfma_f32_16x16x32_bf16 v[188:191], v[108:111], v[92:95], v[188:191]
v_mfma_f32_16x16x32_bf16 v[252:255], v[124:127], v[92:95], v[252:255]
v_mfma_f32_16x16x32_bf16 v[248:251], v[124:127], v[88:91], v[248:251]
v_mfma_f32_16x16x32_bf16 v[244:247], v[124:127], v[84:87], v[244:247]
v_mfma_f32_16x16x32_bf16 v[240:243], v[124:127], v[80:83], v[240:243]
s_sub_u32 s41, s41, 1
s_cmp_lg_u32 s41, 0
s_cbranch_scc1 Lk3_89
s_waitcnt lgkmcnt(0)
v_mfma_f32_16x16x32_bf16 v[128:131], v[48:51], v[32:35], v[128:131]
ds_read_b128 v[80:83], v3 offset:8192
v_mfma_f32_16x16x32_bf16 v[132:135], v[48:51], v[36:39], v[132:135]
ds_read_b64_tr_b16 v[96:97], v9 offset:24576
v_mfma_f32_16x16x32_bf16 v[136:139], v[48:51], v[40:43], v[136:139]
ds_read_b64_tr_b16 v[98:99], v9 offset:28672
v_mfma_f32_16x16x32_bf16 v[140:143], v[48:51], v[44:47], v[140:143]
ds_read_b128 v[84:87], v3 offset:8448
v_mfma_f32_16x16x32_bf16 v[204:207], v[64:67], v[44:47], v[204:207]
ds_read_b128 v[88:91], v3 offset:8704
v_mfma_f32_16x16x32_bf16 v[200:203], v[64:67], v[40:43], v[200:203]
ds_read_b128 v[92:95], v3 offset:8960
v_mfma_f32_16x16x32_bf16 v[196:199], v[64:67], v[36:39], v[196:199]
ds_read_b64_tr_b16 v[112:113], v9 offset:40960
v_mfma_f32_16x16x32_bf16 v[192:195], v[64:67], v[32:35], v[192:195]
ds_read_b64_tr_b16 v[114:115], v9 offset:45056
v_mfma_f32_16x16x32_bf16 v[144:147], v[52:55], v[32:35], v[144:147]
ds_read_b64_tr_b16 v[100:101], v10 offset:24576
v_mfma_f32_16x16x32_bf16 v[148:151], v[52:55], v[36:39], v[148:151]
ds_read_b64_tr_b16 v[102:103], v10 offset:28672
v_mfma_f32_16x16x32_bf16 v[152:155], v[52:55], v[40:43], v[152:155]
ds_read_b64_tr_b16 v[116:117], v10 offset:40960
v_mfma_f32_16x16x32_bf16 v[156:159], v[52:55], v[44:47], v[156:159]
ds_read_b64_tr_b16 v[118:119], v10 offset:45056
v_mfma_f32_16x16x32_bf16 v[220:223], v[68:71], v[44:47], v[220:223]
ds_read_b64_tr_b16 v[104:105], v11 offset:24576
v_mfma_f32_16x16x32_bf16 v[216:219], v[68:71], v[40:43], v[216:219]
ds_read_b64_tr_b16 v[106:107], v11 offset:28672
v_mfma_f32_16x16x32_bf16 v[212:215], v[68:71], v[36:39], v[212:215]
ds_read_b64_tr_b16 v[120:121], v11 offset:40960
v_mfma_f32_16x16x32_bf16 v[208:211], v[68:71], v[32:35], v[208:211]
ds_read_b64_tr_b16 v[122:123], v11 offset:45056
v_mfma_f32_16x16x32_bf16 v[160:163], v[56:59], v[32:35], v[160:163]
ds_read_b64_tr_b16 v[108:109], v12 offset:24576
v_mfma_f32_16x16x32_bf16 v[164:167], v[56:59], v[36:39], v[164:167]
ds_read_b64_tr_b16 v[110:111], v12 offset:28672
v_mfma_f32_16x16x32_bf16 v[168:171], v[56:59], v[40:43], v[168:171]
ds_read_b64_tr_b16 v[124:125], v12 offset:40960
v_mfma_f32_16x16x32_bf16 v[172:175], v[56:59], v[44:47], v[172:175]
ds_read_b64_tr_b16 v[126:127], v12 offset:45056
v_mfma_f32_16x16x32_bf16 v[236:239], v[72:75], v[44:47], v[236:239]
v_mfma_f32_16x16x32_bf16 v[232:235], v[72:75], v[40:43], v[232:235]
v_mfma_f32_16x16x32_bf16 v[228:231], v[72:75], v[36:39], v[228:231]
v_mfma_f32_16x16x32_bf16 v[224:227], v[72:75], v[32:35], v[224:227]
v_mfma_f32_16x16x32_bf16 v[176:179], v[60:63], v[32:35], v[176:179]
v_mfma_f32_16x16x32_bf16 v[180:183], v[60:63], v[36:39], v[180:183]
v_mfma_f32_16x16x32_bf16 v[184:187], v[60:63], v[40:43], v[184:187]
v_mfma_f32_16x16x32_bf16 v[188:191], v[60:63], v[44:47], v[188:191]
v_mfma_f32_16x16x32_bf16 v[252:255], v[76:79], v[44:47], v[252:255]
v_mfma_f32_16x16x32_bf16 v[248:251], v[76:79], v[40:43], v[248:251]
v_mfma_f32_16x16x32_bf16 v[244:247], v[76:79], v[36:39], v[244:247]
v_mfma_f32_16x16x32_bf16 v[240:243], v[76:79], v[32:35], v[240:243]
s_waitcnt lgkmcnt(0)
s_barrier
v_mfma_f32_16x16x32_bf16 v[128:131], v[96:99], v[80:83], v[128:131]
ds_read_b128 v[32:35], v4 offset:0
v_mfma_f32_16x16x32_bf16 v[132:135], v[96:99], v[84:87], v[132:135]
ds_read_b64_tr_b16 v[48:49], v13 offset:16384
v_mfma_f32_16x16x32_bf16 v[136:139], v[96:99], v[88:91], v[136:139]
ds_read_b64_tr_b16 v[50:51], v13 offset:20480
v_mfma_f32_16x16x32_bf16 v[140:143], v[96:99], v[92:95], v[140:143]
ds_read_b128 v[36:39], v4 offset:256
v_mfma_f32_16x16x32_bf16 v[204:207], v[112:115], v[92:95], v[204:207]
ds_read_b128 v[40:43], v4 offset:512
v_mfma_f32_16x16x32_bf16 v[200:203], v[112:115], v[88:91], v[200:203]
ds_read_b128 v[44:47], v4 offset:768
v_mfma_f32_16x16x32_bf16 v[196:199], v[112:115], v[84:87], v[196:199]
ds_read_b64_tr_b16 v[64:65], v13 offset:32768
v_mfma_f32_16x16x32_bf16 v[192:195], v[112:115], v[80:83], v[192:195]
ds_read_b64_tr_b16 v[66:67], v13 offset:36864
v_mfma_f32_16x16x32_bf16 v[144:147], v[100:103], v[80:83], v[144:147]
ds_read_b64_tr_b16 v[52:53], v14 offset:16384
v_mfma_f32_16x16x32_bf16 v[148:151], v[100:103], v[84:87], v[148:151]
ds_read_b64_tr_b16 v[54:55], v14 offset:20480
v_mfma_f32_16x16x32_bf16 v[152:155], v[100:103], v[88:91], v[152:155]
ds_read_b64_tr_b16 v[68:69], v14 offset:32768
v_mfma_f32_16x16x32_bf16 v[156:159], v[100:103], v[92:95], v[156:159]
ds_read_b64_tr_b16 v[70:71], v14 offset:36864
v_mfma_f32_16x16x32_bf16 v[220:223], v[116:119], v[92:95], v[220:223]
ds_read_b64_tr_b16 v[56:57], v15 offset:16384
v_mfma_f32_16x16x32_bf16 v[216:219], v[116:119], v[88:91], v[216:219]
ds_read_b64_tr_b16 v[58:59], v15 offset:20480
v_mfma_f32_16x16x32_bf16 v[212:215], v[116:119], v[84:87], v[212:215]
ds_read_b64_tr_b16 v[72:73], v15 offset:32768
v_mfma_f32_16x16x32_bf16 v[208:211], v[116:119], v[80:83], v[208:211]
ds_read_b64_tr_b16 v[74:75], v15 offset:36864
v_mfma_f32_16x16x32_bf16 v[160:163], v[104:107], v[80:83], v[160:163]
ds_read_b64_tr_b16 v[60:61], v16 offset:16384
v_mfma_f32_16x16x32_bf16 v[164:167], v[104:107], v[84:87], v[164:167]
ds_read_b64_tr_b16 v[62:63], v16 offset:20480
v_mfma_f32_16x16x32_bf16 v[168:171], v[104:107], v[88:91], v[168:171]
ds_read_b64_tr_b16 v[76:77], v16 offset:32768
v_mfma_f32_16x16x32_bf16 v[172:175], v[104:107], v[92:95], v[172:175]
ds_read_b64_tr_b16 v[78:79], v16 offset:36864
v_mfma_f32_16x16x32_bf16 v[236:239], v[120:123], v[92:95], v[236:239]
v_mfma_f32_16x16x32_bf16 v[232:235], v[120:123], v[88:91], v[232:235]
v_mfma_f32_16x16x32_bf16 v[228:231], v[120:123], v[84:87], v[228:231]
v_mfma_f32_16x16x32_bf16 v[224:227], v[120:123], v[80:83], v[224:227]
v_mfma_f32_16x16x32_bf16 v[176:179], v[108:111], v[80:83], v[176:179]
v_mfma_f32_16x16x32_bf16 v[180:183], v[108:111], v[84:87], v[180:183]
v_mfma_f32_16x16x32_bf16 v[184:187], v[108:111], v[88:91], v[184:187]
v_mfma_f32_16x16x32_bf16 v[188:191], v[108:111], v[92:95], v[188:191]
v_mfma_f32_16x16x32_bf16 v[252:255], v[124:127], v[92:95], v[252:255]
v_mfma_f32_16x16x32_bf16 v[248:251], v[124:127], v[88:91], v[248:251]
v_mfma_f32_16x16x32_bf16 v[244:247], v[124:127], v[84:87], v[244:247]
v_mfma_f32_16x16x32_bf16 v[240:243], v[124:127], v[80:83], v[240:243]
s_waitcnt lgkmcnt(0)
v_mfma_f32_16x16x32_bf16 v[128:131], v[48:51], v[32:35], v[128:131]
ds_read_b128 v[80:83], v4 offset:8192
v_mfma_f32_16x16x32_bf16 v[132:135], v[48:51], v[36:39], v[132:135]
ds_read_b64_tr_b16 v[96:97], v13 offset:24576
v_mfma_f32_16x16x32_bf16 v[136:139], v[48:51], v[40:43], v[136:139]
ds_read_b64_tr_b16 v[98:99], v13 offset:28672
v_mfma_f32_16x16x32_bf16 v[140:143], v[48:51], v[44:47], v[140:143]
ds_read_b128 v[84:87], v4 offset:8448
v_mfma_f32_16x16x32_bf16 v[204:207], v[64:67], v[44:47], v[204:207]
ds_read_b128 v[88:91], v4 offset:8704
v_mfma_f32_16x16x32_bf16 v[200:203], v[64:67], v[40:43], v[200:203]
ds_read_b128 v[92:95], v4 offset:8960
v_mfma_f32_16x16x32_bf16 v[196:199], v[64:67], v[36:39], v[196:199]
ds_read_b64_tr_b16 v[112:113], v13 offset:40960
v_mfma_f32_16x16x32_bf16 v[192:195], v[64:67], v[32:35], v[192:195]
ds_read_b64_tr_b16 v[114:115], v13 offset:45056
v_mfma_f32_16x16x32_bf16 v[144:147], v[52:55], v[32:35], v[144:147]
ds_read_b64_tr_b16 v[100:101], v14 offset:24576
v_mfma_f32_16x16x32_bf16 v[148:151], v[52:55], v[36:39], v[148:151]
ds_read_b64_tr_b16 v[102:103], v14 offset:28672
v_mfma_f32_16x16x32_bf16 v[152:155], v[52:55], v[40:43], v[152:155]
ds_read_b64_tr_b16 v[116:117], v14 offset:40960
v_mfma_f32_16x16x32_bf16 v[156:159], v[52:55], v[44:47], v[156:159]
ds_read_b64_tr_b16 v[118:119], v14 offset:45056
v_mfma_f32_16x16x32_bf16 v[220:223], v[68:71], v[44:47], v[220:223]
ds_read_b64_tr_b16 v[104:105], v15 offset:24576
v_mfma_f32_16x16x32_bf16 v[216:219], v[68:71], v[40:43], v[216:219]
ds_read_b64_tr_b16 v[106:107], v15 offset:28672
v_mfma_f32_16x16x32_bf16 v[212:215], v[68:71], v[36:39], v[212:215]
ds_read_b64_tr_b16 v[120:121], v15 offset:40960
v_mfma_f32_16x16x32_bf16 v[208:211], v[68:71], v[32:35], v[208:211]
ds_read_b64_tr_b16 v[122:123], v15 offset:45056
v_mfma_f32_16x16x32_bf16 v[160:163], v[56:59], v[32:35], v[160:163]
ds_read_b64_tr_b16 v[108:109], v16 offset:24576
v_mfma_f32_16x16x32_bf16 v[164:167], v[56:59], v[36:39], v[164:167]
ds_read_b64_tr_b16 v[110:111], v16 offset:28672
v_mfma_f32_16x16x32_bf16 v[168:171], v[56:59], v[40:43], v[168:171]
ds_read_b64_tr_b16 v[124:125], v16 offset:40960
v_mfma_f32_16x16x32_bf16 v[172:175], v[56:59], v[44:47], v[172:175]
ds_read_b64_tr_b16 v[126:127], v16 offset:45056
v_mfma_f32_16x16x32_bf16 v[236:239], v[72:75], v[44:47], v[236:239]
v_mfma_f32_16x16x32_bf16 v[232:235], v[72:75], v[40:43], v[232:235]
v_mfma_f32_16x16x32_bf16 v[228:231], v[72:75], v[36:39], v[228:231]
v_mfma_f32_16x16x32_bf16 v[224:227], v[72:75], v[32:35], v[224:227]
v_mfma_f32_16x16x32_bf16 v[176:179], v[60:63], v[32:35], v[176:179]
v_mfma_f32_16x16x32_bf16 v[180:183], v[60:63], v[36:39], v[180:183]
v_mfma_f32_16x16x32_bf16 v[184:187], v[60:63], v[40:43], v[184:187]
v_mfma_f32_16x16x32_bf16 v[188:191], v[60:63], v[44:47], v[188:191]
v_mfma_f32_16x16x32_bf16 v[252:255], v[76:79], v[44:47], v[252:255]
v_mfma_f32_16x16x32_bf16 v[248:251], v[76:79], v[40:43], v[248:251]
v_mfma_f32_16x16x32_bf16 v[244:247], v[76:79], v[36:39], v[244:247]
v_mfma_f32_16x16x32_bf16 v[240:243], v[76:79], v[32:35], v[240:243]
s_waitcnt lgkmcnt(0)
s_barrier
s_cmp_eq_u32 s36, 3
s_cbranch_scc1 L3h_90
s_add_u32 s42, s42, 1
s_and_b32 s42, s42, 15
s_add_u32 m0, s39, 98304
s_mul_i32 s37, s42, s40
buffer_load_dwordx4 v22, s[8:11], s37 offen sc1 lds
v_mfma_f32_16x16x32_bf16 v[128:131], v[96:99], v[80:83], v[128:131]
s_lshl_b32 s43, s46, 9
v_mfma_f32_16x16x32_bf16 v[132:135], v[96:99], v[84:87], v[132:135]
s_add_u32 s43, s43, 147456
s_add_u32 m0, s39, 99328
s_add_u32 s37, s37, s38
buffer_load_dwordx4 v23, s[8:11], s37 offen sc1 lds
v_mfma_f32_16x16x32_bf16 v[136:139], v[96:99], v[88:91], v[136:139]
v_lshl_add_u32 v19, v17, 3, s43
v_mfma_f32_16x16x32_bf16 v[140:143], v[96:99], v[92:95], v[140:143]
s_add_u32 m0, s39, 100352
s_add_u32 s37, s37, s38
buffer_load_dwordx4 v22, s[8:11], s37 offen sc1 lds
ds_read_b64 v[2:3], v19 offset:0
v_mfma_f32_16x16x32_bf16 v[204:207], v[112:115], v[92:95], v[204:207]
ds_read_b64 v[4:5], v19 offset:128
s_add_u32 m0, s39, 101376
s_add_u32 s37, s37, s38
buffer_load_dwordx4 v23, s[8:11], s37 offen sc1 lds
v_mfma_f32_16x16x32_bf16 v[200:203], v[112:115], v[88:91], v[200:203]
ds_read_b64 v[6:7], v19 offset:256
v_mfma_f32_16x16x32_bf16 v[196:199], v[112:115], v[84:87], v[196:199]
s_add_u32 m0, s39, 102400
s_add_u32 s37, s37, s38
buffer_load_dwordx4 v22, s[8:11], s37 offen sc1 lds
ds_read_b64 v[8:9], v19 offset:384
v_mfma_f32_16x16x32_bf16 v[192:195], v[112:115], v[80:83], v[192:195]
s_mul_i32 s43, s47, 256
s_add_u32 m0, s39, 103424
s_add_u32 s37, s37, s38
buffer_load_dwordx4 v23, s[8:11], s37 offen sc1 lds
v_mfma_f32_16x16x32_bf16 v[144:147], v[100:103], v[80:83], v[144:147]
s_add_u32 s43, s43, 148480
v_mfma_f32_16x16x32_bf16 v[148:151], v[100:103], v[84:87], v[148:151]
s_add_u32 m0, s39, 104448
s_add_u32 s37, s37, s38
buffer_load_dwordx4 v22, s[8:11], s37 offen sc1 lds
v_lshl_add_u32 v19, v18, 4, s43
v_mfma_f32_16x16x32_bf16 v[152:155], v[100:103], v[88:91], v[152:155]
ds_read_b128 v[48:51], v19 offset:0
s_add_u32 m0, s39, 105472
s_add_u32 s37, s37, s38
buffer_load_dwordx4 v23, s[8:11], s37 offen sc1 lds
v_mfma_f32_16x16x32_bf16 v[156:159], v[100:103], v[92:95], v[156:159]
ds_read_b128 v[52:55], v19 offset:64
v_mfma_f32_16x16x32_bf16 v[220:223], v[116:119], v[92:95], v[220:223]
s_add_u32 m0, s39, 106496
s_add_u32 s37, s37, s38
buffer_load_dwordx4 v22, s[8:11], s37 offen sc1 lds
ds_read_b128 v[56:59], v19 offset:128
v_mfma_f32_16x16x32_bf16 v[216:219], v[116:119], v[88:91], v[216:219]
ds_read_b128 v[60:63], v19 offset:192
v_mfma_f32_16x16x32_bf16 v[212:215], v[116:119], v[84:87], v[212:215]
s_add_u32 m0, s39, 107520
s_add_u32 s37, s37, s38
buffer_load_dwordx4 v23, s[8:11], s37 offen sc1 lds
ds_read_b128 v[64:67], v19 offset:896
v_mfma_f32_16x16x32_bf16 v[208:211], v[116:119], v[80:83], v[208:211]
ds_read_b128 v[68:71], v19 offset:960
s_add_u32 m0, s39, 108544
s_add_u32 s37, s37, s38
buffer_load_dwordx4 v22, s[8:11], s37 offen sc1 lds
v_mfma_f32_16x16x32_bf16 v[160:163], v[104:107], v[80:83], v[160:163]
ds_read_b128 v[72:75], v19 offset:1024
v_mfma_f32_16x16x32_bf16 v[164:167], v[104:107], v[84:87], v[164:167]
s_add_u32 m0, s39, 109568
s_add_u32 s37, s37, s38
buffer_load_dwordx4 v23, s[8:11], s37 offen sc1 lds
ds_read_b128 v[76:79], v19 offset:1088
v_mfma_f32_16x16x32_bf16 v[168:171], v[104:107], v[88:91], v[168:171]
v_mfma_f32_16x16x32_bf16 v[172:175], v[104:107], v[92:95], v[172:175]
s_add_u32 m0, s39, 110592
s_add_u32 s37, s37, s38
buffer_load_dwordx4 v22, s[8:11], s37 offen sc1 lds
v_mfma_f32_16x16x32_bf16 v[236:239], v[120:123], v[92:95], v[236:239]
v_mfma_f32_16x16x32_bf16 v[232:235], v[120:123], v[88:91], v[232:235]
v_mfma_f32_16x16x32_bf16 v[228:231], v[120:123], v[84:87], v[228:231]
s_add_u32 m0, s39, 111616
s_add_u32 s37, s37, s38
buffer_load_dwordx4 v23, s[8:11], s37 offen sc1 lds
v_mfma_f32_16x16x32_bf16 v[224:227], v[120:123], v[80:83], v[224:227]
v_mfma_f32_16x16x32_bf16 v[176:179], v[108:111], v[80:83], v[176:179]
v_mfma_f32_16x16x32_bf16 v[180:183], v[108:111], v[84:87], v[180:183]
s_add_u32 m0, s39, 112640
s_add_u32 s37, s37, s38
buffer_load_dwordx4 v22, s[8:11], s37 offen sc1 lds
v_mfma_f32_16x16x32_bf16 v[184:187], v[108:111], v[88:91], v[184:187]
v_mfma_f32_16x16x32_bf16 v[188:191], v[108:111], v[92:95], v[188:191]
v_mfma_f32_16x16x32_bf16 v[252:255], v[124:127], v[92:95], v[252:255]
s_add_u32 m0, s39, 113664
s_add_u32 s37, s37, s38
buffer_load_dwordx4 v23, s[8:11], s37 offen sc1 lds
v_mfma_f32_16x16x32_bf16 v[248:251], v[124:127], v[88:91], v[248:251]
v_mfma_f32_16x16x32_bf16 v[244:247], v[124:127], v[84:87], v[244:247]
v_mfma_f32_16x16x32_bf16 v[240:243], v[124:127], v[80:83], v[240:243]
s_setprio 0
s_waitcnt lgkmcnt(0)
v_mov_b32 v32, v2
v_mul_f32 v88, v3, v3
v_mul_f32 v36, 0xc0135761, v3
v_mul_f32 v89, 0xbdd2d3e8, v3
v_rcp_f32 v44, v88
v_mul_f32 v40, v89, v88
v_mov_b32 v33, v4
v_mul_f32 v88, v5, v5
v_mul_f32 v37, 0xc0135761, v5
v_mul_f32 v89, 0xbdd2d3e8, v5
v_rcp_f32 v45, v88
v_mul_f32 v41, v89, v88
v_mov_b32 v34, v6
v_mul_f32 v88, v7, v7
v_mul_f32 v38, 0xc0135761, v7
v_mul_f32 v89, 0xbdd2d3e8, v7
v_rcp_f32 v46, v88
v_mul_f32 v42, v89, v88
v_mov_b32 v35, v8
v_mul_f32 v88, v9, v9
v_mul_f32 v39, 0xc0135761, v9
v_mul_f32 v89, 0xbdd2d3e8, v9
v_rcp_f32 v47, v88
v_mul_f32 v43, v89, v88
s_barrier
s_add_u32 s42, s42, 1
s_and_b32 s42, s42, 15
s_add_u32 m0, s39, 0
s_mul_i32 s37, s42, s40
buffer_load_dwordx4 v22, s[8:11], s37 offen sc1 lds
v_fma_f32 v128, -v32, v48, v128
v_fma_f32 v129, -v32, v49, v129
v_fma_f32 v130, -v32, v50, v130
v_fma_f32 v131, -v32, v51, v131
s_add_u32 m0, s39, 1024
s_add_u32 s37, s37, s38
buffer_load_dwordx4 v23, s[8:11], s37 offen sc1 lds
v_fma_f32 v192, -v32, v64, v192
v_fma_f32 v193, -v32, v65, v193
v_fma_f32 v194, -v32, v66, v194
s_add_u32 m0, s39, 2048
s_add_u32 s37, s37, s38
buffer_load_dwordx4 v22, s[8:11], s37 offen sc1 lds
v_fma_f32 v195, -v32, v67, v195
v_mul_f32 v80, v128, v128
v_mul_f32 v81, v129, v129
s_add_u32 m0, s39, 3072
s_add_u32 s37, s37, s38
buffer_load_dwordx4 v23, s[8:11], s37 offen sc1 lds
v_mul_f32 v82, v130, v130
v_mul_f32 v83, v131, v131
v_fma_f32 v80, v80, v40, v36
s_add_u32 m0, s39, 4096
s_add_u32 s37, s37, s38
buffer_load_dwordx4 v22, s[8:11], s37 offen sc1 lds
v_fma_f32 v81, v81, v40, v36
v_fma_f32 v82, v82, v40, v36
v_fma_f32 v83, v83, v40, v36
v_mul_f32 v80, v80, v128
s_add_u32 m0, s39, 5120
s_add_u32 s37, s37, s38
buffer_load_dwordx4 v23, s[8:11], s37 offen sc1 lds
v_mul_f32 v81, v81, v129
v_mul_f32 v82, v82, v130
v_mul_f32 v83, v83, v131
s_add_u32 m0, s39, 6144
s_add_u32 s37, s37, s38
buffer_load_dwordx4 v22, s[8:11], s37 offen sc1 lds
v_exp_f32 v80, v80
v_exp_f32 v81, v81
v_exp_f32 v82, v82
s_add_u32 m0, s39, 7168
s_add_u32 s37, s37, s38
buffer_load_dwordx4 v23, s[8:11], s37 offen sc1 lds
v_exp_f32 v83, v83
v_mul_f32 v192, v128, v192
v_mul_f32 v193, v129, v193
s_add_u32 m0, s39, 8192
s_add_u32 s37, s37, s38
buffer_load_dwordx4 v22, s[8:11], s37 offen sc1 lds
v_mul_f32 v194, v130, v194
v_mul_f32 v195, v131, v195
v_fma_f32 v80, v80, v44, v44
v_fma_f32 v81, v81, v44, v44
s_add_u32 m0, s39, 9216
s_add_u32 s37, s37, s38
buffer_load_dwordx4 v23, s[8:11], s37 offen sc1 lds
v_fma_f32 v82, v82, v44, v44
v_fma_f32 v83, v83, v44, v44
v_rcp_f32 v80, v80
s_add_u32 m0, s39, 10240
s_add_u32 s37, s37, s38
buffer_load_dwordx4 v22, s[8:11], s37 offen sc1 lds
v_rcp_f32 v81, v81
v_rcp_f32 v82, v82
v_rcp_f32 v83, v83
s_add_u32 m0, s39, 11264
s_add_u32 s37, s37, s38
buffer_load_dwordx4 v23, s[8:11], s37 offen sc1 lds
v_mul_f32 v192, v192, v80
v_mul_f32 v193, v193, v81
v_mul_f32 v194, v194, v82
s_add_u32 m0, s39, 12288
s_add_u32 s37, s37, s38
buffer_load_dwordx4 v22, s[8:11], s37 offen sc1 lds
v_mul_f32 v195, v195, v83
v_cvt_pk_bf16_f32 v96, v192, v193
v_cvt_pk_bf16_f32 v97, v194, v195
v_fma_f32 v144, -v32, v52, v144
s_add_u32 m0, s39, 13312
s_add_u32 s37, s37, s38
buffer_load_dwordx4 v23, s[8:11], s37 offen sc1 lds
v_fma_f32 v145, -v32, v53, v145
v_fma_f32 v146, -v32, v54, v146
v_fma_f32 v147, -v32, v55, v147
s_add_u32 m0, s39, 14336
s_add_u32 s37, s37, s38
buffer_load_dwordx4 v22, s[8:11], s37 offen sc1 lds
v_fma_f32 v208, -v32, v68, v208
v_fma_f32 v209, -v32, v69, v209
v_fma_f32 v210, -v32, v70, v210
s_add_u32 m0, s39, 15360
s_add_u32 s37, s37, s38
buffer_load_dwordx4 v23, s[8:11], s37 offen sc1 lds
v_fma_f32 v211, -v32, v71, v211
v_mul_f32 v84, v144, v144
v_mul_f32 v85, v145, v145
s_waitcnt vmcnt(16)
s_barrier
s_add_u32 s42, s42, 1
s_and_b32 s42, s42, 15
s_add_u32 m0, s39, 49152
s_mul_i32 s37, s42, s40
buffer_load_dwordx4 v22, s[8:11], s37 offen sc1 lds
v_mul_f32 v86, v146, v146
v_mul_f32 v87, v147, v147
v_fma_f32 v84, v84, v40, v36
v_fma_f32 v85, v85, v40, v36
v_fma_f32 v86, v86, v40, v36
s_add_u32 m0, s39, 50176
s_add_u32 s37, s37, s38
buffer_load_dwordx4 v23, s[8:11], s37 offen sc1 lds
v_fma_f32 v87, v87, v40, v36
v_mul_f32 v84, v84, v144
v_mul_f32 v85, v85, v145
v_mul_f32 v86, v86, v146
v_mul_f32 v87, v87, v147
s_add_u32 m0, s39, 51200
s_add_u32 s37, s37, s38
buffer_load_dwordx4 v22, s[8:11], s37 offen sc1 lds
v_exp_f32 v84, v84
v_exp_f32 v85, v85
v_exp_f32 v86, v86
v_exp_f32 v87, v87
s_add_u32 m0, s39, 52224
s_add_u32 s37, s37, s38
buffer_load_dwordx4 v23, s[8:11], s37 offen sc1 lds
v_mul_f32 v208, v144, v208
v_mul_f32 v209, v145, v209
v_mul_f32 v210, v146, v210
v_mul_f32 v211, v147, v211
v_fma_f32 v84, v84, v44, v44
s_add_u32 m0, s39, 53248
s_add_u32 s37, s37, s38
buffer_load_dwordx4 v22, s[8:11], s37 offen sc1 lds
v_fma_f32 v85, v85, v44, v44
v_fma_f32 v86, v86, v44, v44
v_fma_f32 v87, v87, v44, v44
v_rcp_f32 v84, v84
v_rcp_f32 v85, v85
s_add_u32 m0, s39, 54272
s_add_u32 s37, s37, s38
buffer_load_dwordx4 v23, s[8:11], s37 offen sc1 lds
v_rcp_f32 v86, v86
v_rcp_f32 v87, v87
v_mul_f32 v208, v208, v84
v_mul_f32 v209, v209, v85
s_add_u32 m0, s39, 55296
s_add_u32 s37, s37, s38
buffer_load_dwordx4 v22, s[8:11], s37 offen sc1 lds
v_mul_f32 v210, v210, v86
v_mul_f32 v211, v211, v87
v_cvt_pk_bf16_f32 v98, v208, v209
v_cvt_pk_bf16_f32 v99, v210, v211
s_add_u32 m0, s39, 56320
s_add_u32 s37, s37, s38
buffer_load_dwordx4 v23, s[8:11], s37 offen sc1 lds
v_fma_f32 v132, -v33, v48, v132
v_fma_f32 v133, -v33, v49, v133
v_fma_f32 v134, -v33, v50, v134
v_fma_f32 v135, -v33, v51, v135
s_add_u32 m0, s39, 57344
s_add_u32 s37, s37, s38
buffer_load_dwordx4 v22, s[8:11], s37 offen sc1 lds
v_fma_f32 v196, -v33, v64, v196
v_fma_f32 v197, -v33, v65, v197
v_fma_f32 v198, -v33, v66, v198
v_fma_f32 v199, -v33, v67, v199
v_mul_f32 v80, v132, v132
s_add_u32 m0, s39, 58368
s_add_u32 s37, s37, s38
buffer_load_dwordx4 v23, s[8:11], s37 offen sc1 lds
v_mul_f32 v81, v133, v133
v_mul_f32 v82, v134, v134
v_mul_f32 v83, v135, v135
v_fma_f32 v80, v80, v41, v37
v_fma_f32 v81, v81, v41, v37
s_add_u32 m0, s39, 59392
s_add_u32 s37, s37, s38
buffer_load_dwordx4 v22, s[8:11], s37 offen sc1 lds
v_fma_f32 v82, v82, v41, v37
v_fma_f32 v83, v83, v41, v37
v_mul_f32 v80, v80, v132
v_mul_f32 v81, v81, v133
s_add_u32 m0, s39, 60416
s_add_u32 s37, s37, s38
buffer_load_dwordx4 v23, s[8:11], s37 offen sc1 lds
v_mul_f32 v82, v82, v134
v_lshlrev_b32 v19, 11, v18
v_lshl_add_u32 v19, v17, 4, v19
s_lshl_b32 s43, s46, 10
v_add_u32 v2, s43, v19
s_add_u32 m0, s39, 61440
s_add_u32 s37, s37, s38
buffer_load_dwordx4 v22, s[8:11], s37 offen sc1 lds
v_add_u32 v3, 0x10000, v2
v_lshrrev_b32 v19, 2, v17
v_lshl_add_u32 v20, v18, 2, v19
v_bfe_u32 v21, v20, 1, 2
s_lshl_b32 s43, s47, 1
s_add_u32 m0, s39, 62464
s_add_u32 s37, s37, s38
buffer_load_dwordx4 v23, s[8:11], s37 offen sc1 lds
v_xor_b32 v21, s43, v21
v_lshlrev_b32 v20, 7, v20
v_lshl_add_u32 v20, v21, 5, v20
v_and_b32 v19, 3, v1
s_add_u32 m0, s39, 63488
s_add_u32 s37, s37, s38
buffer_load_dwordx4 v22, s[8:11], s37 offen sc1 lds
v_lshl_add_u32 v20, v19, 3, v20
v_add_u32 v5, 16384, v20
v_xor_b32 v6, 32, v5
v_add_u32 v7, 0x10000, v5
v_add_u32 v8, 0x10000, v6
s_add_u32 m0, s39, 64512
s_add_u32 s37, s37, s38
buffer_load_dwordx4 v23, s[8:11], s37 offen sc1 lds
s_lshl_b32 s43, s36, 12
v_lshl_add_u32 v9, v1, 4, s43
s_mov_b32 s54, 0x10000
s_movk_i32 s52, 0x1000
buffer_store_dwordx4 v[96:99], v27, s[24:27], 0 offen offset:0 sc1
s_waitcnt vmcnt(17)
s_barrier
s_add_u32 s42, s42, 1
s_and_b32 s42, s42, 15
s_add_u32 m0, s39, 98304
s_mul_i32 s37, s42, s40
buffer_load_dwordx4 v22, s[8:11], s37 offen sc1 lds
v_mul_f32 v83, v83, v135
v_exp_f32 v80, v80
v_exp_f32 v81, v81
v_exp_f32 v82, v82
s_add_u32 m0, s39, 99328
s_add_u32 s37, s37, s38
buffer_load_dwordx4 v23, s[8:11], s37 offen sc1 lds
v_exp_f32 v83, v83
v_mul_f32 v196, v132, v196
v_mul_f32 v197, v133, v197
s_add_u32 m0, s39, 100352
s_add_u32 s37, s37, s38
buffer_load_dwordx4 v22, s[8:11], s37 offen sc1 lds
v_mul_f32 v198, v134, v198
v_mul_f32 v199, v135, v199
v_fma_f32 v80, v80, v45, v45
s_add_u32 m0, s39, 101376
s_add_u32 s37, s37, s38
buffer_load_dwordx4 v23, s[8:11], s37 offen sc1 lds
v_fma_f32 v81, v81, v45, v45
v_fma_f32 v82, v82, v45, v45
v_fma_f32 v83, v83, v45, v45
s_add_u32 m0, s39, 102400
s_add_u32 s37, s37, s38
buffer_load_dwordx4 v22, s[8:11], s37 offen sc1 lds
v_rcp_f32 v80, v80
v_rcp_f32 v81, v81
v_rcp_f32 v82, v82
v_rcp_f32 v83, v83
s_add_u32 m0, s39, 103424
s_add_u32 s37, s37, s38
buffer_load_dwordx4 v23, s[8:11], s37 offen sc1 lds
v_mul_f32 v196, v196, v80
v_mul_f32 v197, v197, v81
v_mul_f32 v198, v198, v82
s_add_u32 m0, s39, 104448
s_add_u32 s37, s37, s38
buffer_load_dwordx4 v22, s[8:11], s37 offen sc1 lds
v_mul_f32 v199, v199, v83
v_cvt_pk_bf16_f32 v100, v196, v197
v_cvt_pk_bf16_f32 v101, v198, v199
s_add_u32 m0, s39, 105472
s_add_u32 s37, s37, s38
buffer_load_dwordx4 v23, s[8:11], s37 offen sc1 lds
v_fma_f32 v148, -v33, v52, v148
v_fma_f32 v149, -v33, v53, v149
v_fma_f32 v150, -v33, v54, v150
s_add_u32 m0, s39, 106496
s_add_u32 s37, s37, s38
buffer_load_dwordx4 v22, s[8:11], s37 offen sc1 lds
v_fma_f32 v151, -v33, v55, v151
v_fma_f32 v212, -v33, v68, v212
v_fma_f32 v213, -v33, v69, v213
v_fma_f32 v214, -v33, v70, v214
s_add_u32 m0, s39, 107520
s_add_u32 s37, s37, s38
buffer_load_dwordx4 v23, s[8:11], s37 offen sc1 lds
v_fma_f32 v215, -v33, v71, v215
v_mul_f32 v84, v148, v148
v_mul_f32 v85, v149, v149
s_add_u32 m0, s39, 108544
s_add_u32 s37, s37, s38
buffer_load_dwordx4 v22, s[8:11], s37 offen sc1 lds
v_mul_f32 v86, v150, v150
v_mul_f32 v87, v151, v151
v_fma_f32 v84, v84, v41, v37
s_add_u32 m0, s39, 109568
s_add_u32 s37, s37, s38
buffer_load_dwordx4 v23, s[8:11], s37 offen sc1 lds
v_fma_f32 v85, v85, v41, v37
v_fma_f32 v86, v86, v41, v37
v_fma_f32 v87, v87, v41, v37
s_add_u32 m0, s39, 110592
s_add_u32 s37, s37, s38
buffer_load_dwordx4 v22, s[8:11], s37 offen sc1 lds
v_mul_f32 v84, v84, v148
v_mul_f32 v85, v85, v149
v_mul_f32 v86, v86, v150
v_mul_f32 v87, v87, v151
s_add_u32 m0, s39, 111616
s_add_u32 s37, s37, s38
buffer_load_dwordx4 v23, s[8:11], s37 offen sc1 lds
v_exp_f32 v84, v84
v_exp_f32 v85, v85
v_exp_f32 v86, v86
s_add_u32 m0, s39, 112640
s_add_u32 s37, s37, s38
buffer_load_dwordx4 v22, s[8:11], s37 offen sc1 lds
v_exp_f32 v87, v87
v_mul_f32 v212, v148, v212
v_mul_f32 v213, v149, v213
s_add_u32 m0, s39, 113664
s_add_u32 s37, s37, s38
buffer_load_dwordx4 v23, s[8:11], s37 offen sc1 lds
v_mul_f32 v214, v150, v214
v_mul_f32 v215, v151, v215
v_fma_f32 v84, v84, v45, v45
s_waitcnt vmcnt(17)
s_barrier
s_add_u32 s42, s42, 1
s_and_b32 s42, s42, 15
s_add_u32 m0, s39, 0
s_mul_i32 s37, s42, s40
buffer_load_dwordx4 v22, s[8:11], s37 offen sc1 lds
v_fma_f32 v85, v85, v45, v45
v_fma_f32 v86, v86, v45, v45
v_fma_f32 v87, v87, v45, v45
v_rcp_f32 v84, v84
s_add_u32 m0, s39, 1024
s_add_u32 s37, s37, s38
buffer_load_dwordx4 v23, s[8:11], s37 offen sc1 lds
v_rcp_f32 v85, v85
v_rcp_f32 v86, v86
v_rcp_f32 v87, v87
s_add_u32 m0, s39, 2048
s_add_u32 s37, s37, s38
buffer_load_dwordx4 v22, s[8:11], s37 offen sc1 lds
v_mul_f32 v212, v212, v84
v_mul_f32 v213, v213, v85
v_mul_f32 v214, v214, v86
s_add_u32 m0, s39, 3072
s_add_u32 s37, s37, s38
buffer_load_dwordx4 v23, s[8:11], s37 offen sc1 lds
v_mul_f32 v215, v215, v87
v_cvt_pk_bf16_f32 v102, v212, v213
v_cvt_pk_bf16_f32 v103, v214, v215
s_add_u32 m0, s39, 4096
s_add_u32 s37, s37, s38
buffer_load_dwordx4 v22, s[8:11], s37 offen sc1 lds
v_fma_f32 v136, -v34, v48, v136
v_fma_f32 v137, -v34, v49, v137
v_fma_f32 v138, -v34, v50, v138
s_add_u32 m0, s39, 5120
s_add_u32 s37, s37, s38
buffer_load_dwordx4 v23, s[8:11], s37 offen sc1 lds
v_fma_f32 v139, -v34, v51, v139
v_fma_f32 v200, -v34, v64, v200
v_fma_f32 v201, -v34, v65, v201
s_add_u32 m0, s39, 6144
s_add_u32 s37, s37, s38
buffer_load_dwordx4 v22, s[8:11], s37 offen sc1 lds
v_fma_f32 v202, -v34, v66, v202
v_fma_f32 v203, -v34, v67, v203
v_mul_f32 v80, v136, v136
v_mul_f32 v81, v137, v137
s_add_u32 m0, s39, 7168
s_add_u32 s37, s37, s38
buffer_load_dwordx4 v23, s[8:11], s37 offen sc1 lds
v_mul_f32 v82, v138, v138
v_mul_f32 v83, v139, v139
v_fma_f32 v80, v80, v42, v38
s_add_u32 m0, s39, 8192
s_add_u32 s37, s37, s38
buffer_load_dwordx4 v22, s[8:11], s37 offen sc1 lds
v_fma_f32 v81, v81, v42, v38
v_fma_f32 v82, v82, v42, v38
v_fma_f32 v83, v83, v42, v38
s_add_u32 m0, s39, 9216
s_add_u32 s37, s37, s38
buffer_load_dwordx4 v23, s[8:11], s37 offen sc1 lds
v_mul_f32 v80, v80, v136
v_mul_f32 v81, v81, v137
v_mul_f32 v82, v82, v138
v_mul_f32 v83, v83, v139
s_add_u32 m0, s39, 10240
s_add_u32 s37, s37, s38
buffer_load_dwordx4 v22, s[8:11], s37 offen sc1 lds
v_exp_f32 v80, v80
v_exp_f32 v81, v81
v_exp_f32 v82, v82
s_add_u32 m0, s39, 11264
s_add_u32 s37, s37, s38
buffer_load_dwordx4 v23, s[8:11], s37 offen sc1 lds
v_exp_f32 v83, v83
v_mul_f32 v200, v136, v200
v_mul_f32 v201, v137, v201
s_add_u32 m0, s39, 12288
s_add_u32 s37, s37, s38
buffer_load_dwordx4 v22, s[8:11], s37 offen sc1 lds
v_mul_f32 v202, v138, v202
v_mul_f32 v203, v139, v203
v_fma_f32 v80, v80, v46, v46
v_fma_f32 v81, v81, v46, v46
s_add_u32 m0, s39, 13312
s_add_u32 s37, s37, s38
buffer_load_dwordx4 v23, s[8:11], s37 offen sc1 lds
v_fma_f32 v82, v82, v46, v46
v_fma_f32 v83, v83, v46, v46
v_rcp_f32 v80, v80
s_add_u32 m0, s39, 14336
s_add_u32 s37, s37, s38
buffer_load_dwordx4 v22, s[8:11], s37 offen sc1 lds
v_rcp_f32 v81, v81
v_rcp_f32 v82, v82
v_rcp_f32 v83, v83
s_add_u32 m0, s39, 15360
s_add_u32 s37, s37, s38
buffer_load_dwordx4 v23, s[8:11], s37 offen sc1 lds
v_mul_f32 v200, v200, v80
v_mul_f32 v201, v201, v81
v_mul_f32 v202, v202, v82
buffer_store_dwordx4 v[100:103], v27, s[24:27], 0 offen offset:256 sc1
s_waitcnt vmcnt(17)
s_barrier
s_add_u32 s42, s42, 1
s_and_b32 s42, s42, 15
s_add_u32 m0, s39, 49152
s_mul_i32 s37, s42, s40
buffer_load_dwordx4 v22, s[8:11], s37 offen sc1 lds
v_mul_f32 v203, v203, v83
v_cvt_pk_bf16_f32 v104, v200, v201
v_cvt_pk_bf16_f32 v105, v202, v203
v_fma_f32 v152, -v34, v52, v152
s_add_u32 m0, s39, 50176
s_add_u32 s37, s37, s38
buffer_load_dwordx4 v23, s[8:11], s37 offen sc1 lds
v_fma_f32 v153, -v34, v53, v153
v_fma_f32 v154, -v34, v54, v154
v_fma_f32 v155, -v34, v55, v155
s_add_u32 m0, s39, 51200
s_add_u32 s37, s37, s38
buffer_load_dwordx4 v22, s[8:11], s37 offen sc1 lds
v_fma_f32 v216, -v34, v68, v216
v_fma_f32 v217, -v34, v69, v217
v_fma_f32 v218, -v34, v70, v218
s_add_u32 m0, s39, 52224
s_add_u32 s37, s37, s38
buffer_load_dwordx4 v23, s[8:11], s37 offen sc1 lds
v_fma_f32 v219, -v34, v71, v219
v_mul_f32 v84, v152, v152
v_mul_f32 v85, v153, v153
s_add_u32 m0, s39, 53248
s_add_u32 s37, s37, s38
buffer_load_dwordx4 v22, s[8:11], s37 offen sc1 lds
v_mul_f32 v86, v154, v154
v_mul_f32 v87, v155, v155
v_fma_f32 v84, v84, v42, v38
v_fma_f32 v85, v85, v42, v38
s_add_u32 m0, s39, 54272
s_add_u32 s37, s37, s38
buffer_load_dwordx4 v23, s[8:11], s37 offen sc1 lds
v_fma_f32 v86, v86, v42, v38
v_fma_f32 v87, v87, v42, v38
v_mul_f32 v84, v84, v152
s_add_u32 m0, s39, 55296
s_add_u32 s37, s37, s38
buffer_load_dwordx4 v22, s[8:11], s37 offen sc1 lds
v_mul_f32 v85, v85, v153
v_mul_f32 v86, v86, v154
v_mul_f32 v87, v87, v155
s_add_u32 m0, s39, 56320
s_add_u32 s37, s37, s38
buffer_load_dwordx4 v23, s[8:11], s37 offen sc1 lds
v_exp_f32 v84, v84
v_exp_f32 v85, v85
v_exp_f32 v86, v86
s_add_u32 m0, s39, 57344
s_add_u32 s37, s37, s38
buffer_load_dwordx4 v22, s[8:11], s37 offen sc1 lds
v_exp_f32 v87, v87
v_mul_f32 v216, v152, v216
v_mul_f32 v217, v153, v217
v_mul_f32 v218, v154, v218
s_add_u32 m0, s39, 58368
s_add_u32 s37, s37, s38
buffer_load_dwordx4 v23, s[8:11], s37 offen sc1 lds
v_mul_f32 v219, v155, v219
v_fma_f32 v84, v84, v46, v46
v_fma_f32 v85, v85, v46, v46
s_add_u32 m0, s39, 59392
s_add_u32 s37, s37, s38
buffer_load_dwordx4 v22, s[8:11], s37 offen sc1 lds
v_fma_f32 v86, v86, v46, v46
v_fma_f32 v87, v87, v46, v46
v_rcp_f32 v84, v84
s_add_u32 m0, s39, 60416
s_add_u32 s37, s37, s38
buffer_load_dwordx4 v23, s[8:11], s37 offen sc1 lds
v_rcp_f32 v85, v85
v_rcp_f32 v86, v86
v_rcp_f32 v87, v87
s_add_u32 m0, s39, 61440
s_add_u32 s37, s37, s38
buffer_load_dwordx4 v22, s[8:11], s37 offen sc1 lds
v_mul_f32 v216, v216, v84
v_mul_f32 v217, v217, v85
v_mul_f32 v218, v218, v86
v_mul_f32 v219, v219, v87
s_add_u32 m0, s39, 62464
s_add_u32 s37, s37, s38
buffer_load_dwordx4 v23, s[8:11], s37 offen sc1 lds
v_cvt_pk_bf16_f32 v106, v216, v217
v_cvt_pk_bf16_f32 v107, v218, v219
s_add_u32 m0, s39, 63488
s_add_u32 s37, s37, s38
buffer_load_dwordx4 v22, s[8:11], s37 offen sc1 lds
v_fma_f32 v140, -v35, v48, v140
v_fma_f32 v141, -v35, v49, v141
v_fma_f32 v142, -v35, v50, v142
s_add_u32 m0, s39, 64512
s_add_u32 s37, s37, s38
buffer_load_dwordx4 v23, s[8:11], s37 offen sc1 lds
v_fma_f32 v143, -v35, v51, v143
v_fma_f32 v204, -v35, v64, v204
v_fma_f32 v205, -v35, v65, v205
buffer_store_dwordx4 v[104:107], v27, s[24:27], 0 offen offset:512 sc1
s_waitcnt vmcnt(18)
s_barrier
s_add_u32 s42, s42, 1
s_and_b32 s42, s42, 15
s_add_u32 m0, s39, 98304
s_mul_i32 s37, s42, s40
buffer_load_dwordx4 v22, s[8:11], s37 offen sc1 lds
v_fma_f32 v206, -v35, v66, v206
v_fma_f32 v207, -v35, v67, v207
v_mul_f32 v80, v140, v140
v_mul_f32 v81, v141, v141
s_add_u32 m0, s39, 99328
s_add_u32 s37, s37, s38
buffer_load_dwordx4 v23, s[8:11], s37 offen sc1 lds
v_mul_f32 v82, v142, v142
v_mul_f32 v83, v143, v143
v_fma_f32 v80, v80, v43, v39
s_add_u32 m0, s39, 100352
s_add_u32 s37, s37, s38
buffer_load_dwordx4 v22, s[8:11], s37 offen sc1 lds
v_fma_f32 v81, v81, v43, v39
v_fma_f32 v82, v82, v43, v39
v_fma_f32 v83, v83, v43, v39
s_add_u32 m0, s39, 101376
s_add_u32 s37, s37, s38
buffer_load_dwordx4 v23, s[8:11], s37 offen sc1 lds
v_mul_f32 v80, v80, v140
v_mul_f32 v81, v81, v141
v_mul_f32 v82, v82, v142
s_add_u32 m0, s39, 102400
s_add_u32 s37, s37, s38
buffer_load_dwordx4 v22, s[8:11], s37 offen sc1 lds
v_mul_f32 v83, v83, v143
v_exp_f32 v80, v80
v_exp_f32 v81, v81
v_exp_f32 v82, v82
s_add_u32 m0, s39, 103424
s_add_u32 s37, s37, s38
buffer_load_dwordx4 v23, s[8:11], s37 offen sc1 lds
v_exp_f32 v83, v83
v_mul_f32 v204, v140, v204
v_mul_f32 v205, v141, v205
s_add_u32 m0, s39, 104448
s_add_u32 s37, s37, s38
buffer_load_dwordx4 v22, s[8:11], s37 offen sc1 lds
v_mul_f32 v206, v142, v206
v_mul_f32 v207, v143, v207
v_fma_f32 v80, v80, v47, v47
s_add_u32 m0, s39, 105472
s_add_u32 s37, s37, s38
buffer_load_dwordx4 v23, s[8:11], s37 offen sc1 lds
v_fma_f32 v81, v81, v47, v47
v_fma_f32 v82, v82, v47, v47
v_fma_f32 v83, v83, v47, v47
s_add_u32 m0, s39, 106496
s_add_u32 s37, s37, s38
buffer_load_dwordx4 v22, s[8:11], s37 offen sc1 lds
v_rcp_f32 v80, v80
v_rcp_f32 v81, v81
v_rcp_f32 v82, v82
v_rcp_f32 v83, v83
s_add_u32 m0, s39, 107520
s_add_u32 s37, s37, s38
buffer_load_dwordx4 v23, s[8:11], s37 offen sc1 lds
v_mul_f32 v204, v204, v80
v_mul_f32 v205, v205, v81
v_mul_f32 v206, v206, v82
s_add_u32 m0, s39, 108544
s_add_u32 s37, s37, s38
buffer_load_dwordx4 v22, s[8:11], s37 offen sc1 lds
v_mul_f32 v207, v207, v83
v_cvt_pk_bf16_f32 v108, v204, v205
v_cvt_pk_bf16_f32 v109, v206, v207
s_add_u32 m0, s39, 109568
s_add_u32 s37, s37, s38
buffer_load_dwordx4 v23, s[8:11], s37 offen sc1 lds
v_fma_f32 v156, -v35, v52, v156
v_fma_f32 v157, -v35, v53, v157
v_fma_f32 v158, -v35, v54, v158
s_add_u32 m0, s39, 110592
s_add_u32 s37, s37, s38
buffer_load_dwordx4 v22, s[8:11], s37 offen sc1 lds
v_fma_f32 v159, -v35, v55, v159
v_fma_f32 v220, -v35, v68, v220
v_fma_f32 v221, -v35, v69, v221
v_fma_f32 v222, -v35, v70, v222
s_add_u32 m0, s39, 111616
s_add_u32 s37, s37, s38
buffer_load_dwordx4 v23, s[8:11], s37 offen sc1 lds
v_fma_f32 v223, -v35, v71, v223
v_mul_f32 v84, v156, v156
v_mul_f32 v85, v157, v157
s_add_u32 m0, s39, 112640
s_add_u32 s37, s37, s38
buffer_load_dwordx4 v22, s[8:11], s37 offen sc1 lds
v_mul_f32 v86, v158, v158
v_mul_f32 v87, v159, v159
v_fma_f32 v84, v84, v43, v39
s_add_u32 m0, s39, 113664
s_add_u32 s37, s37, s38
buffer_load_dwordx4 v23, s[8:11], s37 offen sc1 lds
v_fma_f32 v85, v85, v43, v39
v_fma_f32 v86, v86, v43, v39
v_fma_f32 v87, v87, v43, v39
s_waitcnt vmcnt(17)
s_barrier
s_add_u32 s42, s42, 1
s_and_b32 s42, s42, 15
s_add_u32 m0, s39, 0
s_mul_i32 s37, s42, s40
buffer_load_dwordx4 v22, s[8:11], s37 offen sc1 lds
v_mul_f32 v84, v84, v156
v_mul_f32 v85, v85, v157
v_mul_f32 v86, v86, v158
v_mul_f32 v87, v87, v159
s_add_u32 m0, s39, 1024
s_add_u32 s37, s37, s38
buffer_load_dwordx4 v23, s[8:11], s37 offen sc1 lds
v_exp_f32 v84, v84
v_exp_f32 v85, v85
v_exp_f32 v86, v86
s_add_u32 m0, s39, 2048
s_add_u32 s37, s37, s38
buffer_load_dwordx4 v22, s[8:11], s37 offen sc1 lds
v_exp_f32 v87, v87
v_mul_f32 v220, v156, v220
v_mul_f32 v221, v157, v221
s_add_u32 m0, s39, 3072
s_add_u32 s37, s37, s38
buffer_load_dwordx4 v23, s[8:11], s37 offen sc1 lds
v_mul_f32 v222, v158, v222
v_mul_f32 v223, v159, v223
v_fma_f32 v84, v84, v47, v47
v_fma_f32 v85, v85, v47, v47
s_add_u32 m0, s39, 4096
s_add_u32 s37, s37, s38
buffer_load_dwordx4 v22, s[8:11], s37 offen sc1 lds
v_fma_f32 v86, v86, v47, v47
v_fma_f32 v87, v87, v47, v47
v_rcp_f32 v84, v84
s_add_u32 m0, s39, 5120
s_add_u32 s37, s37, s38
buffer_load_dwordx4 v23, s[8:11], s37 offen sc1 lds
v_rcp_f32 v85, v85
v_rcp_f32 v86, v86
v_rcp_f32 v87, v87
s_add_u32 m0, s39, 6144
s_add_u32 s37, s37, s38
buffer_load_dwordx4 v22, s[8:11], s37 offen sc1 lds
v_mul_f32 v220, v220, v84
v_mul_f32 v221, v221, v85
v_mul_f32 v222, v222, v86
v_mul_f32 v223, v223, v87
s_add_u32 m0, s39, 7168
s_add_u32 s37, s37, s38
buffer_load_dwordx4 v23, s[8:11], s37 offen sc1 lds
v_cvt_pk_bf16_f32 v110, v220, v221
v_cvt_pk_bf16_f32 v111, v222, v223
s_add_u32 m0, s39, 8192
s_add_u32 s37, s37, s38
buffer_load_dwordx4 v22, s[8:11], s37 offen sc1 lds
v_fma_f32 v160, -v32, v56, v160
v_fma_f32 v161, -v32, v57, v161
v_fma_f32 v162, -v32, v58, v162
s_add_u32 m0, s39, 9216
s_add_u32 s37, s37, s38
buffer_load_dwordx4 v23, s[8:11], s37 offen sc1 lds
v_fma_f32 v163, -v32, v59, v163
v_fma_f32 v224, -v32, v72, v224
v_fma_f32 v225, -v32, v73, v225
v_fma_f32 v226, -v32, v74, v226
s_add_u32 m0, s39, 10240
s_add_u32 s37, s37, s38
buffer_load_dwordx4 v22, s[8:11], s37 offen sc1 lds
v_fma_f32 v227, -v32, v75, v227
v_mul_f32 v80, v160, v160
v_mul_f32 v81, v161, v161
s_add_u32 m0, s39, 11264
s_add_u32 s37, s37, s38
buffer_load_dwordx4 v23, s[8:11], s37 offen sc1 lds
v_mul_f32 v82, v162, v162
v_mul_f32 v83, v163, v163
v_fma_f32 v80, v80, v40, v36
s_add_u32 m0, s39, 12288
s_add_u32 s37, s37, s38
buffer_load_dwordx4 v22, s[8:11], s37 offen sc1 lds
v_fma_f32 v81, v81, v40, v36
v_fma_f32 v82, v82, v40, v36
v_fma_f32 v83, v83, v40, v36
v_mul_f32 v80, v80, v160
s_add_u32 m0, s39, 13312
s_add_u32 s37, s37, s38
buffer_load_dwordx4 v23, s[8:11], s37 offen sc1 lds
v_mul_f32 v81, v81, v161
v_mul_f32 v82, v82, v162
v_mul_f32 v83, v83, v163
s_add_u32 m0, s39, 14336
s_add_u32 s37, s37, s38
buffer_load_dwordx4 v22, s[8:11], s37 offen sc1 lds
v_exp_f32 v80, v80
v_exp_f32 v81, v81
v_exp_f32 v82, v82
s_add_u32 m0, s39, 15360
s_add_u32 s37, s37, s38
buffer_load_dwordx4 v23, s[8:11], s37 offen sc1 lds
v_exp_f32 v83, v83
v_mul_f32 v224, v160, v224
v_mul_f32 v225, v161, v225
buffer_store_dwordx4 v[108:111], v27, s[24:27], 0 offen offset:768 sc1
s_waitcnt vmcnt(17)
s_barrier
s_add_u32 s42, s42, 1
s_and_b32 s42, s42, 15
s_add_u32 m0, s39, 49152
s_mul_i32 s37, s42, s40
buffer_load_dwordx4 v22, s[8:11], s37 offen sc1 lds
v_mul_f32 v226, v162, v226
v_mul_f32 v227, v163, v227
v_fma_f32 v80, v80, v44, v44
v_fma_f32 v81, v81, v44, v44
s_add_u32 m0, s39, 50176
s_add_u32 s37, s37, s38
buffer_load_dwordx4 v23, s[8:11], s37 offen sc1 lds
v_fma_f32 v82, v82, v44, v44
v_fma_f32 v83, v83, v44, v44
v_rcp_f32 v80, v80
v_rcp_f32 v81, v81
s_add_u32 m0, s39, 51200
s_add_u32 s37, s37, s38
buffer_load_dwordx4 v22, s[8:11], s37 offen sc1 lds
v_rcp_f32 v82, v82
v_rcp_f32 v83, v83
v_mul_f32 v224, v224, v80
v_mul_f32 v225, v225, v81
s_add_u32 m0, s39, 52224
s_add_u32 s37, s37, s38
buffer_load_dwordx4 v23, s[8:11], s37 offen sc1 lds
v_mul_f32 v226, v226, v82
v_mul_f32 v227, v227, v83
v_cvt_pk_bf16_f32 v96, v224, v225
v_cvt_pk_bf16_f32 v97, v226, v227
s_add_u32 m0, s39, 53248
s_add_u32 s37, s37, s38
buffer_load_dwordx4 v22, s[8:11], s37 offen sc1 lds
v_fma_f32 v176, -v32, v60, v176
v_fma_f32 v177, -v32, v61, v177
v_fma_f32 v178, -v32, v62, v178
v_fma_f32 v179, -v32, v63, v179
s_add_u32 m0, s39, 54272
s_add_u32 s37, s37, s38
buffer_load_dwordx4 v23, s[8:11], s37 offen sc1 lds
v_fma_f32 v240, -v32, v76, v240
v_fma_f32 v241, -v32, v77, v241
v_fma_f32 v242, -v32, v78, v242
v_fma_f32 v243, -v32, v79, v243
s_add_u32 m0, s39, 55296
s_add_u32 s37, s37, s38
buffer_load_dwordx4 v22, s[8:11], s37 offen sc1 lds
v_mul_f32 v84, v176, v176
v_mul_f32 v85, v177, v177
v_mul_f32 v86, v178, v178
v_mul_f32 v87, v179, v179
s_add_u32 m0, s39, 56320
s_add_u32 s37, s37, s38
buffer_load_dwordx4 v23, s[8:11], s37 offen sc1 lds
v_fma_f32 v84, v84, v40, v36
v_fma_f32 v85, v85, v40, v36
v_fma_f32 v86, v86, v40, v36
s_add_u32 m0, s39, 57344
s_add_u32 s37, s37, s38
buffer_load_dwordx4 v22, s[8:11], s37 offen sc1 lds
v_fma_f32 v87, v87, v40, v36
v_mul_f32 v84, v84, v176
v_mul_f32 v85, v85, v177
v_mul_f32 v86, v86, v178
s_add_u32 m0, s39, 58368
s_add_u32 s37, s37, s38
buffer_load_dwordx4 v23, s[8:11], s37 offen sc1 lds
v_mul_f32 v87, v87, v179
v_exp_f32 v84, v84
v_exp_f32 v85, v85
v_exp_f32 v86, v86
s_add_u32 m0, s39, 59392
s_add_u32 s37, s37, s38
buffer_load_dwordx4 v22, s[8:11], s37 offen sc1 lds
v_exp_f32 v87, v87
v_mul_f32 v240, v176, v240
v_mul_f32 v241, v177, v241
v_mul_f32 v242, v178, v242
s_add_u32 m0, s39, 60416
s_add_u32 s37, s37, s38
buffer_load_dwordx4 v23, s[8:11], s37 offen sc1 lds
v_mul_f32 v243, v179, v243
v_fma_f32 v84, v84, v44, v44
v_fma_f32 v85, v85, v44, v44
v_fma_f32 v86, v86, v44, v44
s_add_u32 m0, s39, 61440
s_add_u32 s37, s37, s38
buffer_load_dwordx4 v22, s[8:11], s37 offen sc1 lds
v_fma_f32 v87, v87, v44, v44
v_rcp_f32 v84, v84
v_rcp_f32 v85, v85
v_rcp_f32 v86, v86
s_add_u32 m0, s39, 62464
s_add_u32 s37, s37, s38
buffer_load_dwordx4 v23, s[8:11], s37 offen sc1 lds
v_rcp_f32 v87, v87
v_lshlrev_b32 v19, 11, v18
v_lshl_add_u32 v19, v17, 4, v19
s_lshl_b32 s43, s46, 10
s_add_u32 m0, s39, 63488
s_add_u32 s37, s37, s38
buffer_load_dwordx4 v22, s[8:11], s37 offen sc1 lds
s_lshl_b32 s44, s47, 13
v_add3_u32 v208, v19, s43, 0
v_add_u32 v208, s44, v208
buffer_load_dwordx4 v[192:195], v208, s[20:23], 0 offen offset:0 sc1
s_add_u32 m0, s39, 64512
s_add_u32 s37, s37, s38
buffer_load_dwordx4 v23, s[8:11], s37 offen sc1 lds
buffer_load_dwordx4 v[196:199], v208, s[20:23], 0 offen offset:256 sc1
buffer_load_dwordx4 v[200:203], v208, s[20:23], 0 offen offset:512 sc1
buffer_load_dwordx4 v[204:207], v208, s[20:23], 0 offen offset:768 sc1
s_waitcnt vmcnt(20)
s_barrier
s_add_u32 s42, s42, 1
s_and_b32 s42, s42, 15
s_add_u32 m0, s39, 98304
s_mul_i32 s37, s42, s40
buffer_load_dwordx4 v22, s[8:11], s37 offen sc1 lds
v_mul_f32 v240, v240, v84
v_mul_f32 v241, v241, v85
v_mul_f32 v242, v242, v86
v_mul_f32 v243, v243, v87
s_add_u32 m0, s39, 99328
s_add_u32 s37, s37, s38
buffer_load_dwordx4 v23, s[8:11], s37 offen sc1 lds
v_cvt_pk_bf16_f32 v98, v240, v241
v_cvt_pk_bf16_f32 v99, v242, v243
s_add_u32 m0, s39, 100352
s_add_u32 s37, s37, s38
buffer_load_dwordx4 v22, s[8:11], s37 offen sc1 lds
v_fma_f32 v164, -v33, v56, v164
v_fma_f32 v165, -v33, v57, v165
v_fma_f32 v166, -v33, v58, v166
s_add_u32 m0, s39, 101376
s_add_u32 s37, s37, s38
buffer_load_dwordx4 v23, s[8:11], s37 offen sc1 lds
v_fma_f32 v167, -v33, v59, v167
v_fma_f32 v228, -v33, v72, v228
v_fma_f32 v229, -v33, v73, v229
s_add_u32 m0, s39, 102400
s_add_u32 s37, s37, s38
buffer_load_dwordx4 v22, s[8:11], s37 offen sc1 lds
v_fma_f32 v230, -v33, v74, v230
v_fma_f32 v231, -v33, v75, v231
v_mul_f32 v80, v164, v164
v_mul_f32 v81, v165, v165
s_add_u32 m0, s39, 103424
s_add_u32 s37, s37, s38
buffer_load_dwordx4 v23, s[8:11], s37 offen sc1 lds
v_mul_f32 v82, v166, v166
v_mul_f32 v83, v167, v167
v_fma_f32 v80, v80, v41, v37
s_add_u32 m0, s39, 104448
s_add_u32 s37, s37, s38
buffer_load_dwordx4 v22, s[8:11], s37 offen sc1 lds
v_fma_f32 v81, v81, v41, v37
v_fma_f32 v82, v82, v41, v37
v_fma_f32 v83, v83, v41, v37
s_add_u32 m0, s39, 105472
s_add_u32 s37, s37, s38
buffer_load_dwordx4 v23, s[8:11], s37 offen sc1 lds
v_mul_f32 v80, v80, v164
v_mul_f32 v81, v81, v165
v_mul_f32 v82, v82, v166
s_add_u32 m0, s39, 106496
s_add_u32 s37, s37, s38
buffer_load_dwordx4 v22, s[8:11], s37 offen sc1 lds
v_mul_f32 v83, v83, v167
v_exp_f32 v80, v80
v_exp_f32 v81, v81
v_exp_f32 v82, v82
s_add_u32 m0, s39, 107520
s_add_u32 s37, s37, s38
buffer_load_dwordx4 v23, s[8:11], s37 offen sc1 lds
v_exp_f32 v83, v83
v_mul_f32 v228, v164, v228
v_mul_f32 v229, v165, v229
s_add_u32 m0, s39, 108544
s_add_u32 s37, s37, s38
buffer_load_dwordx4 v22, s[8:11], s37 offen sc1 lds
v_mul_f32 v230, v166, v230
v_mul_f32 v231, v167, v231
v_fma_f32 v80, v80, v45, v45
s_add_u32 m0, s39, 109568
s_add_u32 s37, s37, s38
buffer_load_dwordx4 v23, s[8:11], s37 offen sc1 lds
v_fma_f32 v81, v81, v45, v45
v_fma_f32 v82, v82, v45, v45
v_fma_f32 v83, v83, v45, v45
s_add_u32 m0, s39, 110592
s_add_u32 s37, s37, s38
buffer_load_dwordx4 v22, s[8:11], s37 offen sc1 lds
v_rcp_f32 v80, v80
v_rcp_f32 v81, v81
v_rcp_f32 v82, v82
v_rcp_f32 v83, v83
s_add_u32 m0, s39, 111616
s_add_u32 s37, s37, s38
buffer_load_dwordx4 v23, s[8:11], s37 offen sc1 lds
v_mul_f32 v228, v228, v80
v_mul_f32 v229, v229, v81
v_mul_f32 v230, v230, v82
s_add_u32 m0, s39, 112640
s_add_u32 s37, s37, s38
buffer_load_dwordx4 v22, s[8:11], s37 offen sc1 lds
v_mul_f32 v231, v231, v83
v_cvt_pk_bf16_f32 v100, v228, v229
v_cvt_pk_bf16_f32 v101, v230, v231
s_add_u32 m0, s39, 113664
s_add_u32 s37, s37, s38
buffer_load_dwordx4 v23, s[8:11], s37 offen sc1 lds
v_fma_f32 v180, -v33, v60, v180
v_fma_f32 v181, -v33, v61, v181
v_fma_f32 v182, -v33, v62, v182
buffer_store_dwordx4 v[96:99], v27, s[24:27], s53 offen offset:0 sc1
s_waitcnt vmcnt(20)
s_barrier
s_add_u32 s42, s42, 1
s_and_b32 s42, s42, 15
s_add_u32 m0, s39, 0
s_mul_i32 s37, s42, s40
buffer_load_dwordx4 v22, s[8:11], s37 offen sc1 lds
v_fma_f32 v183, -v33, v63, v183
v_fma_f32 v244, -v33, v76, v244
v_fma_f32 v245, -v33, v77, v245
v_fma_f32 v246, -v33, v78, v246
s_add_u32 m0, s39, 1024
s_add_u32 s37, s37, s38
buffer_load_dwordx4 v23, s[8:11], s37 offen sc1 lds
v_fma_f32 v247, -v33, v79, v247
v_mul_f32 v84, v180, v180
v_mul_f32 v85, v181, v181
s_add_u32 m0, s39, 2048
s_add_u32 s37, s37, s38
buffer_load_dwordx4 v22, s[8:11], s37 offen sc1 lds
v_mul_f32 v86, v182, v182
v_mul_f32 v87, v183, v183
v_fma_f32 v84, v84, v41, v37
s_add_u32 m0, s39, 3072
s_add_u32 s37, s37, s38
buffer_load_dwordx4 v23, s[8:11], s37 offen sc1 lds
v_fma_f32 v85, v85, v41, v37
v_fma_f32 v86, v86, v41, v37
v_fma_f32 v87, v87, v41, v37
v_mul_f32 v84, v84, v180
s_add_u32 m0, s39, 4096
s_add_u32 s37, s37, s38
buffer_load_dwordx4 v22, s[8:11], s37 offen sc1 lds
v_mul_f32 v85, v85, v181
v_mul_f32 v86, v86, v182
v_mul_f32 v87, v87, v183
s_add_u32 m0, s39, 5120
s_add_u32 s37, s37, s38
buffer_load_dwordx4 v23, s[8:11], s37 offen sc1 lds
v_exp_f32 v84, v84
v_exp_f32 v85, v85
v_exp_f32 v86, v86
s_add_u32 m0, s39, 6144
s_add_u32 s37, s37, s38
buffer_load_dwordx4 v22, s[8:11], s37 offen sc1 lds
v_exp_f32 v87, v87
v_mul_f32 v244, v180, v244
v_mul_f32 v245, v181, v245
v_mul_f32 v246, v182, v246
s_add_u32 m0, s39, 7168
s_add_u32 s37, s37, s38
buffer_load_dwordx4 v23, s[8:11], s37 offen sc1 lds
v_mul_f32 v247, v183, v247
v_fma_f32 v84, v84, v45, v45
v_fma_f32 v85, v85, v45, v45
s_add_u32 m0, s39, 8192
s_add_u32 s37, s37, s38
buffer_load_dwordx4 v22, s[8:11], s37 offen sc1 lds
v_fma_f32 v86, v86, v45, v45
v_fma_f32 v87, v87, v45, v45
v_rcp_f32 v84, v84
s_add_u32 m0, s39, 9216
s_add_u32 s37, s37, s38
buffer_load_dwordx4 v23, s[8:11], s37 offen sc1 lds
v_rcp_f32 v85, v85
v_rcp_f32 v86, v86
v_rcp_f32 v87, v87
v_mul_f32 v244, v244, v84
s_add_u32 m0, s39, 10240
s_add_u32 s37, s37, s38
buffer_load_dwordx4 v22, s[8:11], s37 offen sc1 lds
v_mul_f32 v245, v245, v85
v_mul_f32 v246, v246, v86
v_mul_f32 v247, v247, v87
s_add_u32 m0, s39, 11264
s_add_u32 s37, s37, s38
buffer_load_dwordx4 v23, s[8:11], s37 offen sc1 lds
v_cvt_pk_bf16_f32 v102, v244, v245
v_cvt_pk_bf16_f32 v103, v246, v247
s_add_u32 m0, s39, 12288
s_add_u32 s37, s37, s38
buffer_load_dwordx4 v22, s[8:11], s37 offen sc1 lds
v_fma_f32 v168, -v34, v56, v168
v_fma_f32 v169, -v34, v57, v169
v_fma_f32 v170, -v34, v58, v170
v_fma_f32 v171, -v34, v59, v171
s_add_u32 m0, s39, 13312
s_add_u32 s37, s37, s38
buffer_load_dwordx4 v23, s[8:11], s37 offen sc1 lds
v_fma_f32 v232, -v34, v72, v232
v_fma_f32 v233, -v34, v73, v233
v_fma_f32 v234, -v34, v74, v234
s_add_u32 m0, s39, 14336
s_add_u32 s37, s37, s38
buffer_load_dwordx4 v22, s[8:11], s37 offen sc1 lds
v_fma_f32 v235, -v34, v75, v235
v_mul_f32 v80, v168, v168
v_mul_f32 v81, v169, v169
s_add_u32 m0, s39, 15360
s_add_u32 s37, s37, s38
buffer_load_dwordx4 v23, s[8:11], s37 offen sc1 lds
v_mul_f32 v82, v170, v170
v_mul_f32 v83, v171, v171
v_fma_f32 v80, v80, v42, v38
buffer_store_dwordx4 v[100:103], v27, s[24:27], s53 offen offset:256 sc1
s_waitcnt vmcnt(18)
s_barrier
s_add_u32 s42, s42, 1
s_and_b32 s42, s42, 15
s_add_u32 m0, s39, 49152
s_mul_i32 s37, s42, s40
buffer_load_dwordx4 v22, s[8:11], s37 offen sc1 lds
v_fma_f32 v81, v81, v42, v38
v_fma_f32 v82, v82, v42, v38
v_fma_f32 v83, v83, v42, v38
v_mul_f32 v80, v80, v168
s_add_u32 m0, s39, 50176
s_add_u32 s37, s37, s38
buffer_load_dwordx4 v23, s[8:11], s37 offen sc1 lds
v_mul_f32 v81, v81, v169
v_mul_f32 v82, v82, v170
v_mul_f32 v83, v83, v171
s_add_u32 m0, s39, 51200
s_add_u32 s37, s37, s38
buffer_load_dwordx4 v22, s[8:11], s37 offen sc1 lds
v_exp_f32 v80, v80
v_exp_f32 v81, v81
v_exp_f32 v82, v82
s_add_u32 m0, s39, 52224
s_add_u32 s37, s37, s38
buffer_load_dwordx4 v23, s[8:11], s37 offen sc1 lds
v_exp_f32 v83, v83
v_mul_f32 v232, v168, v232
v_mul_f32 v233, v169, v233
s_add_u32 m0, s39, 53248
s_add_u32 s37, s37, s38
buffer_load_dwordx4 v22, s[8:11], s37 offen sc1 lds
v_mul_f32 v234, v170, v234
v_mul_f32 v235, v171, v235
v_fma_f32 v80, v80, v46, v46
v_fma_f32 v81, v81, v46, v46
s_add_u32 m0, s39, 54272
s_add_u32 s37, s37, s38
buffer_load_dwordx4 v23, s[8:11], s37 offen sc1 lds
v_fma_f32 v82, v82, v46, v46
v_fma_f32 v83, v83, v46, v46
v_rcp_f32 v80, v80
s_add_u32 m0, s39, 55296
s_add_u32 s37, s37, s38
buffer_load_dwordx4 v22, s[8:11], s37 offen sc1 lds
v_rcp_f32 v81, v81
v_rcp_f32 v82, v82
v_rcp_f32 v83, v83
s_add_u32 m0, s39, 56320
s_add_u32 s37, s37, s38
buffer_load_dwordx4 v23, s[8:11], s37 offen sc1 lds
v_mul_f32 v232, v232, v80
v_mul_f32 v233, v233, v81
v_mul_f32 v234, v234, v82
s_add_u32 m0, s39, 57344
s_add_u32 s37, s37, s38
buffer_load_dwordx4 v22, s[8:11], s37 offen sc1 lds
v_mul_f32 v235, v235, v83
v_cvt_pk_bf16_f32 v104, v232, v233
v_cvt_pk_bf16_f32 v105, v234, v235
v_fma_f32 v184, -v34, v60, v184
s_add_u32 m0, s39, 58368
s_add_u32 s37, s37, s38
buffer_load_dwordx4 v23, s[8:11], s37 offen sc1 lds
v_fma_f32 v185, -v34, v61, v185
v_fma_f32 v186, -v34, v62, v186
v_fma_f32 v187, -v34, v63, v187
s_add_u32 m0, s39, 59392
s_add_u32 s37, s37, s38
buffer_load_dwordx4 v22, s[8:11], s37 offen sc1 lds
v_fma_f32 v248, -v34, v76, v248
v_fma_f32 v249, -v34, v77, v249
v_fma_f32 v250, -v34, v78, v250
s_add_u32 m0, s39, 60416
s_add_u32 s37, s37, s38
buffer_load_dwordx4 v23, s[8:11], s37 offen sc1 lds
v_fma_f32 v251, -v34, v79, v251
v_mul_f32 v84, v184, v184
v_mul_f32 v85, v185, v185
s_add_u32 m0, s39, 61440
s_add_u32 s37, s37, s38
buffer_load_dwordx4 v22, s[8:11], s37 offen sc1 lds
v_mul_f32 v86, v186, v186
v_mul_f32 v87, v187, v187
v_fma_f32 v84, v84, v42, v38
v_fma_f32 v85, v85, v42, v38
s_add_u32 m0, s39, 62464
s_add_u32 s37, s37, s38
buffer_load_dwordx4 v23, s[8:11], s37 offen sc1 lds
v_fma_f32 v86, v86, v42, v38
v_fma_f32 v87, v87, v42, v38
v_mul_f32 v84, v84, v184
s_add_u32 m0, s39, 63488
s_add_u32 s37, s37, s38
buffer_load_dwordx4 v22, s[8:11], s37 offen sc1 lds
v_mul_f32 v85, v85, v185
v_mul_f32 v86, v86, v186
v_mul_f32 v87, v87, v187
s_add_u32 m0, s39, 64512
s_add_u32 s37, s37, s38
buffer_load_dwordx4 v23, s[8:11], s37 offen sc1 lds
v_exp_f32 v84, v84
v_exp_f32 v85, v85
v_exp_f32 v86, v86
s_waitcnt vmcnt(17)
s_barrier
s_add_u32 s42, s42, 1
s_and_b32 s42, s42, 15
s_add_u32 m0, s39, 98304
s_mul_i32 s37, s42, s40
buffer_load_dwordx4 v22, s[8:11], s37 offen sc1 lds
v_exp_f32 v87, v87
v_mul_f32 v248, v184, v248
v_mul_f32 v249, v185, v249
v_mul_f32 v250, v186, v250
s_add_u32 m0, s39, 99328
s_add_u32 s37, s37, s38
buffer_load_dwordx4 v23, s[8:11], s37 offen sc1 lds
v_mul_f32 v251, v187, v251
v_fma_f32 v84, v84, v46, v46
v_fma_f32 v85, v85, v46, v46
s_add_u32 m0, s39, 100352
s_add_u32 s37, s37, s38
buffer_load_dwordx4 v22, s[8:11], s37 offen sc1 lds
v_fma_f32 v86, v86, v46, v46
v_fma_f32 v87, v87, v46, v46
v_rcp_f32 v84, v84
s_add_u32 m0, s39, 101376
s_add_u32 s37, s37, s38
buffer_load_dwordx4 v23, s[8:11], s37 offen sc1 lds
v_rcp_f32 v85, v85
v_rcp_f32 v86, v86
v_rcp_f32 v87, v87
s_add_u32 m0, s39, 102400
s_add_u32 s37, s37, s38
buffer_load_dwordx4 v22, s[8:11], s37 offen sc1 lds
v_mul_f32 v248, v248, v84
v_mul_f32 v249, v249, v85
v_mul_f32 v250, v250, v86
v_mul_f32 v251, v251, v87
s_add_u32 m0, s39, 103424
s_add_u32 s37, s37, s38
buffer_load_dwordx4 v23, s[8:11], s37 offen sc1 lds
v_cvt_pk_bf16_f32 v106, v248, v249
v_cvt_pk_bf16_f32 v107, v250, v251
s_add_u32 m0, s39, 104448
s_add_u32 s37, s37, s38
buffer_load_dwordx4 v22, s[8:11], s37 offen sc1 lds
v_fma_f32 v172, -v35, v56, v172
v_fma_f32 v173, -v35, v57, v173
v_fma_f32 v174, -v35, v58, v174
s_add_u32 m0, s39, 105472
s_add_u32 s37, s37, s38
buffer_load_dwordx4 v23, s[8:11], s37 offen sc1 lds
v_fma_f32 v175, -v35, v59, v175
v_fma_f32 v236, -v35, v72, v236
v_fma_f32 v237, -v35, v73, v237
s_add_u32 m0, s39, 106496
s_add_u32 s37, s37, s38
buffer_load_dwordx4 v22, s[8:11], s37 offen sc1 lds
v_fma_f32 v238, -v35, v74, v238
v_fma_f32 v239, -v35, v75, v239
v_mul_f32 v80, v172, v172
v_mul_f32 v81, v173, v173
s_add_u32 m0, s39, 107520
s_add_u32 s37, s37, s38
buffer_load_dwordx4 v23, s[8:11], s37 offen sc1 lds
v_mul_f32 v82, v174, v174
v_mul_f32 v83, v175, v175
v_fma_f32 v80, v80, v43, v39
s_add_u32 m0, s39, 108544
s_add_u32 s37, s37, s38
buffer_load_dwordx4 v22, s[8:11], s37 offen sc1 lds
v_fma_f32 v81, v81, v43, v39
v_fma_f32 v82, v82, v43, v39
v_fma_f32 v83, v83, v43, v39
s_add_u32 m0, s39, 109568
s_add_u32 s37, s37, s38
buffer_load_dwordx4 v23, s[8:11], s37 offen sc1 lds
v_mul_f32 v80, v80, v172
v_mul_f32 v81, v81, v173
v_mul_f32 v82, v82, v174
s_add_u32 m0, s39, 110592
s_add_u32 s37, s37, s38
buffer_load_dwordx4 v22, s[8:11], s37 offen sc1 lds
v_mul_f32 v83, v83, v175
v_exp_f32 v80, v80
v_exp_f32 v81, v81
v_exp_f32 v82, v82
s_add_u32 m0, s39, 111616
s_add_u32 s37, s37, s38
buffer_load_dwordx4 v23, s[8:11], s37 offen sc1 lds
v_exp_f32 v83, v83
v_mul_f32 v236, v172, v236
v_mul_f32 v237, v173, v237
s_add_u32 m0, s39, 112640
s_add_u32 s37, s37, s38
buffer_load_dwordx4 v22, s[8:11], s37 offen sc1 lds
v_mul_f32 v238, v174, v238
v_mul_f32 v239, v175, v239
v_fma_f32 v80, v80, v47, v47
s_add_u32 m0, s39, 113664
s_add_u32 s37, s37, s38
buffer_load_dwordx4 v23, s[8:11], s37 offen sc1 lds
v_fma_f32 v81, v81, v47, v47
v_fma_f32 v82, v82, v47, v47
v_fma_f32 v83, v83, v47, v47
buffer_store_dwordx4 v[104:107], v27, s[24:27], s53 offen offset:512 sc1
s_waitcnt vmcnt(17)
s_barrier
s_add_u32 s42, s42, 1
s_and_b32 s42, s42, 15
s_add_u32 m0, s39, 0
s_mul_i32 s37, s42, s40
buffer_load_dwordx4 v22, s[8:11], s37 offen sc1 lds
v_rcp_f32 v80, v80
v_rcp_f32 v81, v81
v_rcp_f32 v82, v82
v_rcp_f32 v83, v83
s_add_u32 m0, s39, 1024
s_add_u32 s37, s37, s38
buffer_load_dwordx4 v23, s[8:11], s37 offen sc1 lds
v_mul_f32 v236, v236, v80
v_mul_f32 v237, v237, v81
v_mul_f32 v238, v238, v82
s_add_u32 m0, s39, 2048
s_add_u32 s37, s37, s38
buffer_load_dwordx4 v22, s[8:11], s37 offen sc1 lds
v_mul_f32 v239, v239, v83
v_cvt_pk_bf16_f32 v108, v236, v237
v_cvt_pk_bf16_f32 v109, v238, v239
s_add_u32 m0, s39, 3072
s_add_u32 s37, s37, s38
buffer_load_dwordx4 v23, s[8:11], s37 offen sc1 lds
v_fma_f32 v188, -v35, v60, v188
v_fma_f32 v189, -v35, v61, v189
v_fma_f32 v190, -v35, v62, v190
v_fma_f32 v191, -v35, v63, v191
s_add_u32 m0, s39, 4096
s_add_u32 s37, s37, s38
buffer_load_dwordx4 v22, s[8:11], s37 offen sc1 lds
v_fma_f32 v252, -v35, v76, v252
v_fma_f32 v253, -v35, v77, v253
v_fma_f32 v254, -v35, v78, v254
s_add_u32 m0, s39, 5120
s_add_u32 s37, s37, s38
buffer_load_dwordx4 v23, s[8:11], s37 offen sc1 lds
v_fma_f32 v255, -v35, v79, v255
v_mul_f32 v84, v188, v188
v_mul_f32 v85, v189, v189
s_add_u32 m0, s39, 6144
s_add_u32 s37, s37, s38
buffer_load_dwordx4 v22, s[8:11], s37 offen sc1 lds
v_mul_f32 v86, v190, v190
v_mul_f32 v87, v191, v191
v_fma_f32 v84, v84, v43, v39
v_fma_f32 v85, v85, v43, v39
s_add_u32 m0, s39, 7168
s_add_u32 s37, s37, s38
buffer_load_dwordx4 v23, s[8:11], s37 offen sc1 lds
v_fma_f32 v86, v86, v43, v39
v_fma_f32 v87, v87, v43, v39
v_mul_f32 v84, v84, v188
s_add_u32 m0, s39, 8192
s_add_u32 s37, s37, s38
buffer_load_dwordx4 v22, s[8:11], s37 offen sc1 lds
v_mul_f32 v85, v85, v189
v_mul_f32 v86, v86, v190
v_mul_f32 v87, v87, v191
s_add_u32 m0, s39, 9216
s_add_u32 s37, s37, s38
buffer_load_dwordx4 v23, s[8:11], s37 offen sc1 lds
v_exp_f32 v84, v84
v_exp_f32 v85, v85
v_exp_f32 v86, v86
v_exp_f32 v87, v87
s_add_u32 m0, s39, 10240
s_add_u32 s37, s37, s38
buffer_load_dwordx4 v22, s[8:11], s37 offen sc1 lds
v_mul_f32 v252, v188, v252
v_mul_f32 v253, v189, v253
v_mul_f32 v254, v190, v254
s_add_u32 m0, s39, 11264
s_add_u32 s37, s37, s38
buffer_load_dwordx4 v23, s[8:11], s37 offen sc1 lds
v_mul_f32 v255, v191, v255
v_fma_f32 v84, v84, v47, v47
v_fma_f32 v85, v85, v47, v47
s_add_u32 m0, s39, 12288
s_add_u32 s37, s37, s38
buffer_load_dwordx4 v22, s[8:11], s37 offen sc1 lds
v_fma_f32 v86, v86, v47, v47
v_fma_f32 v87, v87, v47, v47
v_rcp_f32 v84, v84
v_rcp_f32 v85, v85
s_add_u32 m0, s39, 13312
s_add_u32 s37, s37, s38
buffer_load_dwordx4 v23, s[8:11], s37 offen sc1 lds
v_rcp_f32 v86, v86
v_rcp_f32 v87, v87
v_mul_f32 v252, v252, v84
s_add_u32 m0, s39, 14336
s_add_u32 s37, s37, s38
buffer_load_dwordx4 v22, s[8:11], s37 offen sc1 lds
v_mul_f32 v253, v253, v85
v_mul_f32 v254, v254, v86
v_mul_f32 v255, v255, v87
s_add_u32 m0, s39, 15360
s_add_u32 s37, s37, s38
buffer_load_dwordx4 v23, s[8:11], s37 offen sc1 lds
v_cvt_pk_bf16_f32 v110, v252, v253
v_cvt_pk_bf16_f32 v111, v254, v255
buffer_store_dwordx4 v[108:111], v27, s[24:27], s53 offen offset:768 sc1
s_waitcnt vmcnt(18)
s_barrier
s_mul_i32 s44, s34, 917504
s_lshl_b32 s39, s51, 13
s_add_u32 s44, s44, s39
s_add_u32 s44, s44, 8388608
s_and_b32 s43, s51, 1
s_xor_b32 s43, s43, s35
s_lshl_b32 s43, s43, 7
s_mov_b32 s10, 909312
s_movk_i32 s38, 1024
s_movk_i32 s40, 9216
s_movk_i32 s37, 0x4000
s_cmp_ge_u32 s51, 2
s_cselect_b32 s8, s60, s32
s_cselect_b32 s9, s61, s33
s_cselect_b32 s10, 7338112, s10
s_cselect_b32 s43, s43, s44
s_cselect_b32 s38, 16384, s38
s_cselect_b32 s40, 81920, s40
s_cselect_b32 s55, 81920, s38
s_cselect_b32 s37, 262144, s37
s_cselect_b32 s45, -1, 0
s_add_u32 s8, s8, s43
s_addc_u32 s9, s9, 0
s_mov_b32 s11, 0x20000
s_and_b32 s53, s35, 1
s_mul_i32 s54, s53, 6
s_mul_i32 s54, s54, s37
s_mul_i32 s29, s53, 2
s_add_u32 s29, s29, 6
s_mul_i32 s29, s29, s37
s_and_b32 s43, s45, 4290838528
s_add_u32 s29, s29, s43
s_mul_i32 s37, s37, 0
s_sub_u32 s37, s37, s40
v_lshrrev_b32 v19, 3, v1
v_mul_u32_u24 v19, 1920, v19
v_lshrrev_b32 v20, 4, v1
v_lshlrev_b32 v20, 5, v20
v_and_b32 v19, s45, v19
v_and_b32 v20, s45, v20
v_lshlrev_b32 v21, 4, v1
v_xor_b32 v21, v21, v20
v_add_u32 v21, v21, v19
s_mov_b64 s[72:73], -1
s_add_u32 m0, s39, 65536
s_add_u32 s37, s37, s40
buffer_load_dwordx4 v21, s[8:11], s37 offen sc1 lds
v_lshlrev_b32 v128, 16, v192
v_and_b32 v129, 0xffff0000, v192
v_lshlrev_b32 v130, 16, v193
v_and_b32 v131, 0xffff0000, v193
s_add_u32 m0, s39, 66560
s_add_u32 s37, s37, s38
buffer_load_dwordx4 v21, s[8:11], s37 offen sc1 lds
v_lshlrev_b32 v132, 16, v194
v_and_b32 v133, 0xffff0000, v194
v_lshlrev_b32 v134, 16, v195
v_and_b32 v135, 0xffff0000, v195
s_add_u32 m0, s39, 67584
s_add_u32 s37, s37, s38
buffer_load_dwordx4 v21, s[8:11], s37 offen sc1 lds
v_lshlrev_b32 v136, 16, v196
v_and_b32 v137, 0xffff0000, v196
v_lshlrev_b32 v138, 16, v197
v_and_b32 v139, 0xffff0000, v197
s_add_u32 m0, s39, 68608
s_add_u32 s37, s37, s38
buffer_load_dwordx4 v21, s[8:11], s37 offen sc1 lds
v_lshlrev_b32 v140, 16, v198
v_and_b32 v141, 0xffff0000, v198
v_lshlrev_b32 v142, 16, v199
v_and_b32 v143, 0xffff0000, v199
s_add_u32 m0, s39, 69632
s_add_u32 s37, s37, s55
buffer_load_dwordx4 v21, s[8:11], s37 offen sc1 lds
v_lshlrev_b32 v144, 16, v200
v_and_b32 v145, 0xffff0000, v200
v_lshlrev_b32 v146, 16, v201
v_and_b32 v147, 0xffff0000, v201
s_add_u32 m0, s39, 70656
s_add_u32 s37, s37, s38
buffer_load_dwordx4 v21, s[8:11], s37 offen sc1 lds
v_lshlrev_b32 v148, 16, v202
v_and_b32 v149, 0xffff0000, v202
v_lshlrev_b32 v150, 16, v203
v_and_b32 v151, 0xffff0000, v203
s_add_u32 m0, s39, 71680
s_add_u32 s37, s37, s38
buffer_load_dwordx4 v21, s[8:11], s37 offen sc1 lds
v_lshlrev_b32 v152, 16, v204
v_and_b32 v153, 0xffff0000, v204
v_lshlrev_b32 v154, 16, v205
v_and_b32 v155, 0xffff0000, v205
s_add_u32 m0, s39, 72704
s_add_u32 s37, s37, s38
buffer_load_dwordx4 v21, s[8:11], s37 offen sc1 lds
v_lshlrev_b32 v156, 16, v206
v_and_b32 v157, 0xffff0000, v206
v_lshlrev_b32 v158, 16, v207
v_and_b32 v159, 0xffff0000, v207
s_waitcnt vmcnt(8)
s_barrier
s_add_u32 m0, s39, 98304
s_add_u32 s37, s37, s40
buffer_load_dwordx4 v21, s[8:11], s37 offen sc1 lds
v_mov_b32 v192, 0
v_mov_b32 v193, 0
v_mov_b32 v194, 0
v_mov_b32 v195, 0
s_add_u32 m0, s39, 99328
s_add_u32 s37, s37, s38
buffer_load_dwordx4 v21, s[8:11], s37 offen sc1 lds
v_mov_b32 v196, 0
v_mov_b32 v197, 0
v_mov_b32 v198, 0
v_mov_b32 v199, 0
s_add_u32 m0, s39, 100352
s_add_u32 s37, s37, s38
buffer_load_dwordx4 v21, s[8:11], s37 offen sc1 lds
v_mov_b32 v200, 0
v_mov_b32 v201, 0
v_mov_b32 v202, 0
v_mov_b32 v203, 0
s_add_u32 m0, s39, 101376
s_add_u32 s37, s37, s38
buffer_load_dwordx4 v21, s[8:11], s37 offen sc1 lds
v_mov_b32 v204, 0
v_mov_b32 v205, 0
v_mov_b32 v206, 0
v_mov_b32 v207, 0
s_add_u32 m0, s39, 102400
s_add_u32 s37, s37, s55
buffer_load_dwordx4 v21, s[8:11], s37 offen sc1 lds
v_mov_b32 v208, 0
v_mov_b32 v209, 0
v_mov_b32 v210, 0
v_mov_b32 v211, 0
s_add_u32 m0, s39, 103424
s_add_u32 s37, s37, s38
buffer_load_dwordx4 v21, s[8:11], s37 offen sc1 lds
v_mov_b32 v212, 0
v_mov_b32 v213, 0
v_mov_b32 v214, 0
v_mov_b32 v215, 0
s_add_u32 m0, s39, 104448
s_add_u32 s37, s37, s38
buffer_load_dwordx4 v21, s[8:11], s37 offen sc1 lds
v_mov_b32 v216, 0
v_mov_b32 v217, 0
v_mov_b32 v218, 0
v_mov_b32 v219, 0
s_add_u32 m0, s39, 105472
s_add_u32 s37, s37, s38
buffer_load_dwordx4 v21, s[8:11], s37 offen sc1 lds
v_mov_b32 v220, 0
v_mov_b32 v221, 0
v_mov_b32 v222, 0
v_mov_b32 v223, 0
s_waitcnt vmcnt(8)
s_barrier
s_branch LK4_91
.p2align 6
Lw_118:
s_branch Lr_119
s_nop 0
.p2align 3
L3h_90:
v_mfma_f32_16x16x32_bf16 v[128:131], v[96:99], v[80:83], v[128:131]
s_lshl_b32 s43, s46, 9
v_mfma_f32_16x16x32_bf16 v[132:135], v[96:99], v[84:87], v[132:135]
s_add_u32 s43, s43, 147456
v_mfma_f32_16x16x32_bf16 v[136:139], v[96:99], v[88:91], v[136:139]
v_lshl_add_u32 v19, v17, 3, s43
v_mfma_f32_16x16x32_bf16 v[140:143], v[96:99], v[92:95], v[140:143]
ds_read_b64 v[2:3], v19 offset:0
v_mfma_f32_16x16x32_bf16 v[204:207], v[112:115], v[92:95], v[204:207]
ds_read_b64 v[4:5], v19 offset:128
v_mfma_f32_16x16x32_bf16 v[200:203], v[112:115], v[88:91], v[200:203]
ds_read_b64 v[6:7], v19 offset:256
v_mfma_f32_16x16x32_bf16 v[196:199], v[112:115], v[84:87], v[196:199]
ds_read_b64 v[8:9], v19 offset:384
v_mfma_f32_16x16x32_bf16 v[192:195], v[112:115], v[80:83], v[192:195]
s_mul_i32 s43, s47, 256
v_mfma_f32_16x16x32_bf16 v[144:147], v[100:103], v[80:83], v[144:147]
s_add_u32 s43, s43, 148480
v_mfma_f32_16x16x32_bf16 v[148:151], v[100:103], v[84:87], v[148:151]
v_lshl_add_u32 v19, v18, 4, s43
v_mfma_f32_16x16x32_bf16 v[152:155], v[100:103], v[88:91], v[152:155]
ds_read_b128 v[48:51], v19 offset:0
v_mfma_f32_16x16x32_bf16 v[156:159], v[100:103], v[92:95], v[156:159]
ds_read_b128 v[52:55], v19 offset:64
v_mfma_f32_16x16x32_bf16 v[220:223], v[116:119], v[92:95], v[220:223]
ds_read_b128 v[56:59], v19 offset:128
v_mfma_f32_16x16x32_bf16 v[216:219], v[116:119], v[88:91], v[216:219]
ds_read_b128 v[60:63], v19 offset:192
v_mfma_f32_16x16x32_bf16 v[212:215], v[116:119], v[84:87], v[212:215]
ds_read_b128 v[64:67], v19 offset:896
v_mfma_f32_16x16x32_bf16 v[208:211], v[116:119], v[80:83], v[208:211]
ds_read_b128 v[68:71], v19 offset:960
v_mfma_f32_16x16x32_bf16 v[160:163], v[104:107], v[80:83], v[160:163]
ds_read_b128 v[72:75], v19 offset:1024
v_mfma_f32_16x16x32_bf16 v[164:167], v[104:107], v[84:87], v[164:167]
ds_read_b128 v[76:79], v19 offset:1088
v_mfma_f32_16x16x32_bf16 v[168:171], v[104:107], v[88:91], v[168:171]
v_mfma_f32_16x16x32_bf16 v[172:175], v[104:107], v[92:95], v[172:175]
v_mfma_f32_16x16x32_bf16 v[236:239], v[120:123], v[92:95], v[236:239]
v_mfma_f32_16x16x32_bf16 v[232:235], v[120:123], v[88:91], v[232:235]
v_mfma_f32_16x16x32_bf16 v[228:231], v[120:123], v[84:87], v[228:231]
v_mfma_f32_16x16x32_bf16 v[224:227], v[120:123], v[80:83], v[224:227]
v_mfma_f32_16x16x32_bf16 v[176:179], v[108:111], v[80:83], v[176:179]
v_mfma_f32_16x16x32_bf16 v[180:183], v[108:111], v[84:87], v[180:183]
v_mfma_f32_16x16x32_bf16 v[184:187], v[108:111], v[88:91], v[184:187]
v_mfma_f32_16x16x32_bf16 v[188:191], v[108:111], v[92:95], v[188:191]
v_mfma_f32_16x16x32_bf16 v[252:255], v[124:127], v[92:95], v[252:255]
v_mfma_f32_16x16x32_bf16 v[248:251], v[124:127], v[88:91], v[248:251]
v_mfma_f32_16x16x32_bf16 v[244:247], v[124:127], v[84:87], v[244:247]
v_mfma_f32_16x16x32_bf16 v[240:243], v[124:127], v[80:83], v[240:243]
s_setprio 0
s_waitcnt lgkmcnt(0)
v_mov_b32 v32, v2
v_mul_f32 v88, v3, v3
v_mul_f32 v36, 0xc0135761, v3
v_mul_f32 v89, 0xbdd2d3e8, v3
v_rcp_f32 v44, v88
v_mul_f32 v40, v89, v88
v_mov_b32 v33, v4
v_mul_f32 v88, v5, v5
v_mul_f32 v37, 0xc0135761, v5
v_mul_f32 v89, 0xbdd2d3e8, v5
v_rcp_f32 v45, v88
v_mul_f32 v41, v89, v88
v_mov_b32 v34, v6
v_mul_f32 v88, v7, v7
v_mul_f32 v38, 0xc0135761, v7
v_mul_f32 v89, 0xbdd2d3e8, v7
v_rcp_f32 v46, v88
v_mul_f32 v42, v89, v88
v_mov_b32 v35, v8
v_mul_f32 v88, v9, v9
v_mul_f32 v39, 0xc0135761, v9
v_mul_f32 v89, 0xbdd2d3e8, v9
v_rcp_f32 v47, v88
v_mul_f32 v43, v89, v88
s_barrier
v_fma_f32 v128, -v32, v48, v128
v_fma_f32 v129, -v32, v49, v129
v_fma_f32 v130, -v32, v50, v130
v_fma_f32 v131, -v32, v51, v131
v_fma_f32 v192, -v32, v64, v192
v_fma_f32 v193, -v32, v65, v193
v_fma_f32 v194, -v32, v66, v194
v_fma_f32 v195, -v32, v67, v195
v_mul_f32 v80, v128, v128
v_mul_f32 v81, v129, v129
v_mul_f32 v82, v130, v130
v_mul_f32 v83, v131, v131
v_fma_f32 v80, v80, v40, v36
v_fma_f32 v81, v81, v40, v36
v_fma_f32 v82, v82, v40, v36
v_fma_f32 v83, v83, v40, v36
v_mul_f32 v80, v80, v128
v_mul_f32 v81, v81, v129
v_mul_f32 v82, v82, v130
v_mul_f32 v83, v83, v131
v_exp_f32 v80, v80
v_exp_f32 v81, v81
v_exp_f32 v82, v82
v_exp_f32 v83, v83
v_mul_f32 v192, v128, v192
v_mul_f32 v193, v129, v193
v_mul_f32 v194, v130, v194
v_mul_f32 v195, v131, v195
v_fma_f32 v80, v80, v44, v44
v_fma_f32 v81, v81, v44, v44
v_fma_f32 v82, v82, v44, v44
v_fma_f32 v83, v83, v44, v44
v_rcp_f32 v80, v80
v_rcp_f32 v81, v81
v_rcp_f32 v82, v82
v_rcp_f32 v83, v83
v_mul_f32 v192, v192, v80
v_mul_f32 v193, v193, v81
v_mul_f32 v194, v194, v82
v_mul_f32 v195, v195, v83
v_cvt_pk_bf16_f32 v96, v192, v193
v_cvt_pk_bf16_f32 v97, v194, v195
v_fma_f32 v144, -v32, v52, v144
v_fma_f32 v145, -v32, v53, v145
v_fma_f32 v146, -v32, v54, v146
v_fma_f32 v147, -v32, v55, v147
v_fma_f32 v208, -v32, v68, v208
v_fma_f32 v209, -v32, v69, v209
v_fma_f32 v210, -v32, v70, v210
v_fma_f32 v211, -v32, v71, v211
v_mul_f32 v84, v144, v144
v_mul_f32 v85, v145, v145
s_barrier
v_mul_f32 v86, v146, v146
v_mul_f32 v87, v147, v147
v_fma_f32 v84, v84, v40, v36
v_fma_f32 v85, v85, v40, v36
v_fma_f32 v86, v86, v40, v36
v_fma_f32 v87, v87, v40, v36
v_mul_f32 v84, v84, v144
v_mul_f32 v85, v85, v145
v_mul_f32 v86, v86, v146
v_mul_f32 v87, v87, v147
v_exp_f32 v84, v84
v_exp_f32 v85, v85
v_exp_f32 v86, v86
v_exp_f32 v87, v87
v_mul_f32 v208, v144, v208
v_mul_f32 v209, v145, v209
v_mul_f32 v210, v146, v210
v_mul_f32 v211, v147, v211
v_fma_f32 v84, v84, v44, v44
v_fma_f32 v85, v85, v44, v44
v_fma_f32 v86, v86, v44, v44
v_fma_f32 v87, v87, v44, v44
v_rcp_f32 v84, v84
v_rcp_f32 v85, v85
v_rcp_f32 v86, v86
v_rcp_f32 v87, v87
v_mul_f32 v208, v208, v84
v_mul_f32 v209, v209, v85
v_mul_f32 v210, v210, v86
v_mul_f32 v211, v211, v87
v_cvt_pk_bf16_f32 v98, v208, v209
v_cvt_pk_bf16_f32 v99, v210, v211
buffer_store_dwordx4 v[96:99], v27, s[24:27], 0 offen offset:0 sc1
v_fma_f32 v132, -v33, v48, v132
v_fma_f32 v133, -v33, v49, v133
v_fma_f32 v134, -v33, v50, v134
v_fma_f32 v135, -v33, v51, v135
v_fma_f32 v196, -v33, v64, v196
v_fma_f32 v197, -v33, v65, v197
v_fma_f32 v198, -v33, v66, v198
v_fma_f32 v199, -v33, v67, v199
v_mul_f32 v80, v132, v132
v_mul_f32 v81, v133, v133
v_mul_f32 v82, v134, v134
v_mul_f32 v83, v135, v135
v_fma_f32 v80, v80, v41, v37
v_fma_f32 v81, v81, v41, v37
v_fma_f32 v82, v82, v41, v37
v_fma_f32 v83, v83, v41, v37
v_mul_f32 v80, v80, v132
v_mul_f32 v81, v81, v133
v_mul_f32 v82, v82, v134
v_lshlrev_b32 v19, 11, v18
v_lshl_add_u32 v19, v17, 4, v19
s_lshl_b32 s43, s46, 10
v_add_u32 v2, s43, v19
v_add_u32 v3, 0x10000, v2
v_lshrrev_b32 v19, 2, v17
v_lshl_add_u32 v20, v18, 2, v19
v_bfe_u32 v21, v20, 1, 2
s_lshl_b32 s43, s47, 1
v_xor_b32 v21, s43, v21
v_lshlrev_b32 v20, 7, v20
v_lshl_add_u32 v20, v21, 5, v20
v_and_b32 v19, 3, v1
v_lshl_add_u32 v20, v19, 3, v20
v_add_u32 v5, 16384, v20
v_xor_b32 v6, 32, v5
v_add_u32 v7, 0x10000, v5
v_add_u32 v8, 0x10000, v6
s_lshl_b32 s43, s36, 12
v_lshl_add_u32 v9, v1, 4, s43
s_mov_b32 s54, 0x10000
s_movk_i32 s52, 0x1000
s_barrier
s_mov_b32 s88, s4
s_mov_b32 s89, s5
s_mov_b32 s90, 7340032
s_mov_b32 s91, 0x20000
s_mov_b32 s92, s6
s_mov_b32 s93, s7
s_mov_b32 s94, 7340032
s_mov_b32 s95, 0x20000
s_lshr_b32 s43, s35, 3
v_and_b32 v19, 1, v1
v_bfe_u32 v23, v1, 2, 2
s_lshl_b32 s44, s43, 1
s_add_u32 s44, s44, 6
v_add_u32 v23, s44, v23
s_mul_i32 s44, s43, 6
s_add_u32 s44, s44, 1
v_mad_u32_u24 v23, v19, s44, v23
s_lshl_b32 s44, s43, 10
s_lshl_b32 s43, s43, 11
s_sub_u32 s43, 6528, s43
s_lshr_b32 s45, s2, 3
s_mul_i32 s45, s45, 14336
s_add_u32 s43, s43, s45
v_mul_lo_u32 v31, v19, s44
v_bfe_u32 v19, v1, 1, 1
v_mul_u32_u24 v19, 7168, v19
v_add3_u32 v31, v31, v19, s43
v_add_u32 v19, 8, v23
v_and_b32 v19, 15, v19
v_mul_u32_u24 v19, 458752, v19
v_add_u32 v19, v19, v31
buffer_load_dword v30, v19, s[88:91], 0 offen
buffer_load_dword v30, v19, s[92:95], 0 offen
v_mul_f32 v83, v83, v135
v_exp_f32 v80, v80
v_exp_f32 v81, v81
v_exp_f32 v82, v82
v_exp_f32 v83, v83
v_mul_f32 v196, v132, v196
v_mul_f32 v197, v133, v197
v_mul_f32 v198, v134, v198
v_mul_f32 v199, v135, v199
v_fma_f32 v80, v80, v45, v45
v_fma_f32 v81, v81, v45, v45
v_fma_f32 v82, v82, v45, v45
v_fma_f32 v83, v83, v45, v45
v_rcp_f32 v80, v80
v_rcp_f32 v81, v81
v_rcp_f32 v82, v82
v_rcp_f32 v83, v83
v_mul_f32 v196, v196, v80
v_mul_f32 v197, v197, v81
v_mul_f32 v198, v198, v82
v_mul_f32 v199, v199, v83
v_cvt_pk_bf16_f32 v100, v196, v197
v_cvt_pk_bf16_f32 v101, v198, v199
v_fma_f32 v148, -v33, v52, v148
v_fma_f32 v149, -v33, v53, v149
v_fma_f32 v150, -v33, v54, v150
v_fma_f32 v151, -v33, v55, v151
v_fma_f32 v212, -v33, v68, v212
v_fma_f32 v213, -v33, v69, v213
v_fma_f32 v214, -v33, v70, v214
v_fma_f32 v215, -v33, v71, v215
v_mul_f32 v84, v148, v148
v_mul_f32 v85, v149, v149
v_mul_f32 v86, v150, v150
v_mul_f32 v87, v151, v151
v_fma_f32 v84, v84, v41, v37
v_fma_f32 v85, v85, v41, v37
v_fma_f32 v86, v86, v41, v37
v_fma_f32 v87, v87, v41, v37
v_mul_f32 v84, v84, v148
v_mul_f32 v85, v85, v149
v_mul_f32 v86, v86, v150
v_mul_f32 v87, v87, v151
v_exp_f32 v84, v84
v_exp_f32 v85, v85
v_exp_f32 v86, v86
v_exp_f32 v87, v87
v_mul_f32 v212, v148, v212
v_mul_f32 v213, v149, v213
v_mul_f32 v214, v150, v214
v_mul_f32 v215, v151, v215
v_fma_f32 v84, v84, v45, v45
s_barrier
v_fma_f32 v85, v85, v45, v45
v_fma_f32 v86, v86, v45, v45
v_fma_f32 v87, v87, v45, v45
v_rcp_f32 v84, v84
v_rcp_f32 v85, v85
v_rcp_f32 v86, v86
v_rcp_f32 v87, v87
v_mul_f32 v212, v212, v84
v_mul_f32 v213, v213, v85
v_mul_f32 v214, v214, v86
v_mul_f32 v215, v215, v87
v_cvt_pk_bf16_f32 v102, v212, v213
v_cvt_pk_bf16_f32 v103, v214, v215
buffer_store_dwordx4 v[100:103], v27, s[24:27], 0 offen offset:256 sc1
v_fma_f32 v136, -v34, v48, v136
v_fma_f32 v137, -v34, v49, v137
v_fma_f32 v138, -v34, v50, v138
v_fma_f32 v139, -v34, v51, v139
v_fma_f32 v200, -v34, v64, v200
v_fma_f32 v201, -v34, v65, v201
v_fma_f32 v202, -v34, v66, v202
v_fma_f32 v203, -v34, v67, v203
v_mul_f32 v80, v136, v136
v_mul_f32 v81, v137, v137
v_mul_f32 v82, v138, v138
v_mul_f32 v83, v139, v139
v_fma_f32 v80, v80, v42, v38
v_fma_f32 v81, v81, v42, v38
v_fma_f32 v82, v82, v42, v38
v_fma_f32 v83, v83, v42, v38
v_mul_f32 v80, v80, v136
v_mul_f32 v81, v81, v137
v_mul_f32 v82, v82, v138
v_mul_f32 v83, v83, v139
v_exp_f32 v80, v80
v_exp_f32 v81, v81
v_exp_f32 v82, v82
v_exp_f32 v83, v83
v_mul_f32 v200, v136, v200
v_mul_f32 v201, v137, v201
v_mul_f32 v202, v138, v202
v_mul_f32 v203, v139, v203
v_fma_f32 v80, v80, v46, v46
v_fma_f32 v81, v81, v46, v46
v_fma_f32 v82, v82, v46, v46
v_fma_f32 v83, v83, v46, v46
v_rcp_f32 v80, v80
v_rcp_f32 v81, v81
v_rcp_f32 v82, v82
v_rcp_f32 v83, v83
v_mul_f32 v200, v200, v80
v_mul_f32 v201, v201, v81
v_mul_f32 v202, v202, v82
s_barrier
v_mul_f32 v203, v203, v83
v_cvt_pk_bf16_f32 v104, v200, v201
v_cvt_pk_bf16_f32 v105, v202, v203
v_fma_f32 v152, -v34, v52, v152
v_fma_f32 v153, -v34, v53, v153
v_fma_f32 v154, -v34, v54, v154
v_fma_f32 v155, -v34, v55, v155
v_fma_f32 v216, -v34, v68, v216
v_fma_f32 v217, -v34, v69, v217
v_fma_f32 v218, -v34, v70, v218
v_fma_f32 v219, -v34, v71, v219
v_mul_f32 v84, v152, v152
v_mul_f32 v85, v153, v153
v_mul_f32 v86, v154, v154
v_mul_f32 v87, v155, v155
v_fma_f32 v84, v84, v42, v38
v_fma_f32 v85, v85, v42, v38
v_fma_f32 v86, v86, v42, v38
v_fma_f32 v87, v87, v42, v38
v_mul_f32 v84, v84, v152
v_mul_f32 v85, v85, v153
v_mul_f32 v86, v86, v154
v_mul_f32 v87, v87, v155
v_exp_f32 v84, v84
v_exp_f32 v85, v85
v_exp_f32 v86, v86
v_exp_f32 v87, v87
v_mul_f32 v216, v152, v216
v_mul_f32 v217, v153, v217
v_mul_f32 v218, v154, v218
v_mul_f32 v219, v155, v219
v_fma_f32 v84, v84, v46, v46
v_fma_f32 v85, v85, v46, v46
v_fma_f32 v86, v86, v46, v46
v_fma_f32 v87, v87, v46, v46
v_rcp_f32 v84, v84
v_rcp_f32 v85, v85
v_rcp_f32 v86, v86
v_rcp_f32 v87, v87
v_mul_f32 v216, v216, v84
v_mul_f32 v217, v217, v85
v_mul_f32 v218, v218, v86
v_mul_f32 v219, v219, v87
v_cvt_pk_bf16_f32 v106, v216, v217
v_cvt_pk_bf16_f32 v107, v218, v219
buffer_store_dwordx4 v[104:107], v27, s[24:27], 0 offen offset:512 sc1
v_fma_f32 v140, -v35, v48, v140
v_fma_f32 v141, -v35, v49, v141
v_fma_f32 v142, -v35, v50, v142
v_fma_f32 v143, -v35, v51, v143
v_fma_f32 v204, -v35, v64, v204
v_fma_f32 v205, -v35, v65, v205
s_barrier
v_fma_f32 v206, -v35, v66, v206
v_fma_f32 v207, -v35, v67, v207
v_mul_f32 v80, v140, v140
v_mul_f32 v81, v141, v141
v_mul_f32 v82, v142, v142
v_mul_f32 v83, v143, v143
v_fma_f32 v80, v80, v43, v39
v_fma_f32 v81, v81, v43, v39
v_fma_f32 v82, v82, v43, v39
v_fma_f32 v83, v83, v43, v39
v_mul_f32 v80, v80, v140
v_mul_f32 v81, v81, v141
v_mul_f32 v82, v82, v142
v_mul_f32 v83, v83, v143
v_exp_f32 v80, v80
v_exp_f32 v81, v81
v_exp_f32 v82, v82
v_exp_f32 v83, v83
v_mul_f32 v204, v140, v204
v_mul_f32 v205, v141, v205
v_mul_f32 v206, v142, v206
v_mul_f32 v207, v143, v207
v_fma_f32 v80, v80, v47, v47
v_fma_f32 v81, v81, v47, v47
v_fma_f32 v82, v82, v47, v47
v_fma_f32 v83, v83, v47, v47
v_rcp_f32 v80, v80
v_rcp_f32 v81, v81
v_rcp_f32 v82, v82
v_rcp_f32 v83, v83
v_mul_f32 v204, v204, v80
v_mul_f32 v205, v205, v81
v_mul_f32 v206, v206, v82
v_mul_f32 v207, v207, v83
v_cvt_pk_bf16_f32 v108, v204, v205
v_cvt_pk_bf16_f32 v109, v206, v207
v_fma_f32 v156, -v35, v52, v156
v_fma_f32 v157, -v35, v53, v157
v_fma_f32 v158, -v35, v54, v158
v_fma_f32 v159, -v35, v55, v159
v_fma_f32 v220, -v35, v68, v220
v_fma_f32 v221, -v35, v69, v221
v_fma_f32 v222, -v35, v70, v222
v_fma_f32 v223, -v35, v71, v223
v_mul_f32 v84, v156, v156
v_mul_f32 v85, v157, v157
v_mul_f32 v86, v158, v158
v_mul_f32 v87, v159, v159
v_fma_f32 v84, v84, v43, v39
v_fma_f32 v85, v85, v43, v39
v_fma_f32 v86, v86, v43, v39
v_fma_f32 v87, v87, v43, v39
s_barrier
s_getpc_b64 s[78:79]
Lpc_92:
s_sub_u32 s78, s78, Lpc_92-sequential_preLN__sliding_local_dilated__glu_gated_geglu__prompt_kernel
s_subb_u32 s79, s79, 0
s_lshr_b32 s43, s2, 3
s_mul_i32 s43, s43, 3840
v_min_u32 v19, 29, v1
v_lshl_add_u32 v19, v19, 7, s43
v_min_u32 v19, Ldone_1-sequential_preLN__sliding_local_dilated__glu_gated_geglu__prompt_kernel, v19
global_load_dword v30, v19, s[78:79]
s_mov_b32 s88, s4
s_mov_b32 s89, s5
s_mov_b32 s90, 7340032
s_mov_b32 s91, 0x20000
s_mov_b32 s92, s6
s_mov_b32 s93, s7
s_mov_b32 s94, 7340032
s_mov_b32 s95, 0x20000
s_lshr_b32 s43, s35, 3
v_and_b32 v19, 1, v1
v_bfe_u32 v23, v1, 2, 2
s_lshl_b32 s44, s43, 1
s_add_u32 s44, s44, 6
v_add_u32 v23, s44, v23
s_mul_i32 s44, s43, 6
s_add_u32 s44, s44, 1
v_mad_u32_u24 v23, v19, s44, v23
s_lshl_b32 s44, s43, 10
s_lshl_b32 s43, s43, 11
s_sub_u32 s43, 6528, s43
s_lshr_b32 s45, s2, 3
s_mul_i32 s45, s45, 14336
s_add_u32 s43, s43, s45
v_mul_lo_u32 v31, v19, s44
v_bfe_u32 v19, v1, 1, 1
v_mul_u32_u24 v19, 7168, v19
v_add3_u32 v31, v31, v19, s43
v_add_u32 v19, 12, v23
v_and_b32 v19, 15, v19
v_mul_u32_u24 v19, 458752, v19
v_add_u32 v19, v19, v31
buffer_load_dword v30, v19, s[88:91], 0 offen
buffer_load_dword v30, v19, s[92:95], 0 offen
v_mul_f32 v84, v84, v156
v_mul_f32 v85, v85, v157
v_mul_f32 v86, v86, v158
v_mul_f32 v87, v87, v159
v_exp_f32 v84, v84
v_exp_f32 v85, v85
v_exp_f32 v86, v86
v_exp_f32 v87, v87
v_mul_f32 v220, v156, v220
v_mul_f32 v221, v157, v221
v_mul_f32 v222, v158, v222
v_mul_f32 v223, v159, v223
v_fma_f32 v84, v84, v47, v47
v_fma_f32 v85, v85, v47, v47
v_fma_f32 v86, v86, v47, v47
v_fma_f32 v87, v87, v47, v47
v_rcp_f32 v84, v84
v_rcp_f32 v85, v85
v_rcp_f32 v86, v86
v_rcp_f32 v87, v87
v_mul_f32 v220, v220, v84
v_mul_f32 v221, v221, v85
v_mul_f32 v222, v222, v86
v_mul_f32 v223, v223, v87
v_cvt_pk_bf16_f32 v110, v220, v221
v_cvt_pk_bf16_f32 v111, v222, v223
buffer_store_dwordx4 v[108:111], v27, s[24:27], 0 offen offset:768 sc1
v_fma_f32 v160, -v32, v56, v160
v_fma_f32 v161, -v32, v57, v161
v_fma_f32 v162, -v32, v58, v162
v_fma_f32 v163, -v32, v59, v163
v_fma_f32 v224, -v32, v72, v224
v_fma_f32 v225, -v32, v73, v225
v_fma_f32 v226, -v32, v74, v226
v_fma_f32 v227, -v32, v75, v227
v_mul_f32 v80, v160, v160
v_mul_f32 v81, v161, v161
v_mul_f32 v82, v162, v162
v_mul_f32 v83, v163, v163
v_fma_f32 v80, v80, v40, v36
v_fma_f32 v81, v81, v40, v36
v_fma_f32 v82, v82, v40, v36
v_fma_f32 v83, v83, v40, v36
v_mul_f32 v80, v80, v160
v_mul_f32 v81, v81, v161
v_mul_f32 v82, v82, v162
v_mul_f32 v83, v83, v163
v_exp_f32 v80, v80
v_exp_f32 v81, v81
v_exp_f32 v82, v82
v_exp_f32 v83, v83
v_mul_f32 v224, v160, v224
v_mul_f32 v225, v161, v225
s_barrier
v_mul_f32 v226, v162, v226
v_mul_f32 v227, v163, v227
v_fma_f32 v80, v80, v44, v44
v_fma_f32 v81, v81, v44, v44
v_fma_f32 v82, v82, v44, v44
v_fma_f32 v83, v83, v44, v44
v_rcp_f32 v80, v80
v_rcp_f32 v81, v81
v_rcp_f32 v82, v82
v_rcp_f32 v83, v83
v_mul_f32 v224, v224, v80
v_mul_f32 v225, v225, v81
v_mul_f32 v226, v226, v82
v_mul_f32 v227, v227, v83
v_cvt_pk_bf16_f32 v96, v224, v225
v_cvt_pk_bf16_f32 v97, v226, v227
v_fma_f32 v176, -v32, v60, v176
v_fma_f32 v177, -v32, v61, v177
v_fma_f32 v178, -v32, v62, v178
v_fma_f32 v179, -v32, v63, v179
v_fma_f32 v240, -v32, v76, v240
v_fma_f32 v241, -v32, v77, v241
v_fma_f32 v242, -v32, v78, v242
v_fma_f32 v243, -v32, v79, v243
v_mul_f32 v84, v176, v176
v_mul_f32 v85, v177, v177
v_mul_f32 v86, v178, v178
v_mul_f32 v87, v179, v179
v_fma_f32 v84, v84, v40, v36
v_fma_f32 v85, v85, v40, v36
v_fma_f32 v86, v86, v40, v36
v_fma_f32 v87, v87, v40, v36
v_mul_f32 v84, v84, v176
v_mul_f32 v85, v85, v177
v_mul_f32 v86, v86, v178
v_mul_f32 v87, v87, v179
v_exp_f32 v84, v84
v_exp_f32 v85, v85
v_exp_f32 v86, v86
v_exp_f32 v87, v87
v_mul_f32 v240, v176, v240
v_mul_f32 v241, v177, v241
v_mul_f32 v242, v178, v242
v_mul_f32 v243, v179, v243
v_fma_f32 v84, v84, v44, v44
v_fma_f32 v85, v85, v44, v44
v_fma_f32 v86, v86, v44, v44
v_fma_f32 v87, v87, v44, v44
v_rcp_f32 v84, v84
v_rcp_f32 v85, v85
v_rcp_f32 v86, v86
v_rcp_f32 v87, v87
v_lshlrev_b32 v19, 11, v18
v_lshl_add_u32 v19, v17, 4, v19
s_lshl_b32 s43, s46, 10
s_lshl_b32 s44, s47, 13
v_add3_u32 v208, v19, s43, 0
v_add_u32 v208, s44, v208
buffer_load_dwordx4 v[192:195], v208, s[20:23], 0 offen offset:0 sc1
buffer_load_dwordx4 v[196:199], v208, s[20:23], 0 offen offset:256 sc1
buffer_load_dwordx4 v[200:203], v208, s[20:23], 0 offen offset:512 sc1
buffer_load_dwordx4 v[204:207], v208, s[20:23], 0 offen offset:768 sc1
s_waitcnt vmcnt(4)
s_barrier
s_add_u32 s43, s34, 32
s_lshl_b32 s43, s43, 7
v_mov_b32 v21, s43
v_mov_b32 v22, 1
s_mov_b64 exec, 1
buffer_atomic_add v22, v21, s[56:59], 0 offen sc1
s_mov_b64 exec, -1
v_mul_f32 v240, v240, v84
v_mul_f32 v241, v241, v85
v_mul_f32 v242, v242, v86
v_mul_f32 v243, v243, v87
v_cvt_pk_bf16_f32 v98, v240, v241
v_cvt_pk_bf16_f32 v99, v242, v243
buffer_store_dwordx4 v[96:99], v27, s[24:27], s53 offen offset:0 sc1
v_fma_f32 v164, -v33, v56, v164
v_fma_f32 v165, -v33, v57, v165
v_fma_f32 v166, -v33, v58, v166
v_fma_f32 v167, -v33, v59, v167
v_fma_f32 v228, -v33, v72, v228
v_fma_f32 v229, -v33, v73, v229
v_fma_f32 v230, -v33, v74, v230
v_fma_f32 v231, -v33, v75, v231
v_mul_f32 v80, v164, v164
v_mul_f32 v81, v165, v165
v_mul_f32 v82, v166, v166
v_mul_f32 v83, v167, v167
v_fma_f32 v80, v80, v41, v37
v_fma_f32 v81, v81, v41, v37
v_fma_f32 v82, v82, v41, v37
v_fma_f32 v83, v83, v41, v37
v_mul_f32 v80, v80, v164
v_mul_f32 v81, v81, v165
v_mul_f32 v82, v82, v166
v_mul_f32 v83, v83, v167
v_exp_f32 v80, v80
v_exp_f32 v81, v81
v_exp_f32 v82, v82
v_exp_f32 v83, v83
v_mul_f32 v228, v164, v228
v_mul_f32 v229, v165, v229
v_mul_f32 v230, v166, v230
v_mul_f32 v231, v167, v231
v_fma_f32 v80, v80, v45, v45
v_fma_f32 v81, v81, v45, v45
v_fma_f32 v82, v82, v45, v45
v_fma_f32 v83, v83, v45, v45
v_rcp_f32 v80, v80
v_rcp_f32 v81, v81
v_rcp_f32 v82, v82
v_rcp_f32 v83, v83
v_mul_f32 v228, v228, v80
v_mul_f32 v229, v229, v81
v_mul_f32 v230, v230, v82
v_mul_f32 v231, v231, v83
v_cvt_pk_bf16_f32 v100, v228, v229
v_cvt_pk_bf16_f32 v101, v230, v231
v_fma_f32 v180, -v33, v60, v180
v_fma_f32 v181, -v33, v61, v181
v_fma_f32 v182, -v33, v62, v182
s_barrier
s_mov_b32 s80, s60
s_mov_b32 s81, s61
s_mov_b32 s82, 7340032
s_mov_b32 s83, 0x20000
v_and_b32 v29, 31, v1
v_lshlrev_b32 v29, 11, v29
s_and_b32 s43, s35, 8
s_or_b32 s43, s43, 3
s_lshl_b32 s43, s43, 7
v_add_u32 v29, s43, v29
s_lshr_b32 s44, s2, 3
s_lshl_b32 s44, s44, 17
s_add_u32 s43, s44, 0
buffer_load_dword v30, v29, s[80:83], s43 offen
v_fma_f32 v183, -v33, v63, v183
v_fma_f32 v244, -v33, v76, v244
v_fma_f32 v245, -v33, v77, v245
v_fma_f32 v246, -v33, v78, v246
v_fma_f32 v247, -v33, v79, v247
v_mul_f32 v84, v180, v180
v_mul_f32 v85, v181, v181
v_mul_f32 v86, v182, v182
v_mul_f32 v87, v183, v183
v_fma_f32 v84, v84, v41, v37
v_fma_f32 v85, v85, v41, v37
v_fma_f32 v86, v86, v41, v37
v_fma_f32 v87, v87, v41, v37
v_mul_f32 v84, v84, v180
v_mul_f32 v85, v85, v181
v_mul_f32 v86, v86, v182
v_mul_f32 v87, v87, v183
v_exp_f32 v84, v84
v_exp_f32 v85, v85
v_exp_f32 v86, v86
v_exp_f32 v87, v87
v_mul_f32 v244, v180, v244
v_mul_f32 v245, v181, v245
v_mul_f32 v246, v182, v246
v_mul_f32 v247, v183, v247
v_fma_f32 v84, v84, v45, v45
v_fma_f32 v85, v85, v45, v45
v_fma_f32 v86, v86, v45, v45
v_fma_f32 v87, v87, v45, v45
v_rcp_f32 v84, v84
v_rcp_f32 v85, v85
v_rcp_f32 v86, v86
v_rcp_f32 v87, v87
v_mul_f32 v244, v244, v84
v_mul_f32 v245, v245, v85
v_mul_f32 v246, v246, v86
v_mul_f32 v247, v247, v87
v_cvt_pk_bf16_f32 v102, v244, v245
v_cvt_pk_bf16_f32 v103, v246, v247
buffer_store_dwordx4 v[100:103], v27, s[24:27], s53 offen offset:256 sc1
v_fma_f32 v168, -v34, v56, v168
v_fma_f32 v169, -v34, v57, v169
v_fma_f32 v170, -v34, v58, v170
v_fma_f32 v171, -v34, v59, v171
v_fma_f32 v232, -v34, v72, v232
v_fma_f32 v233, -v34, v73, v233
v_fma_f32 v234, -v34, v74, v234
v_fma_f32 v235, -v34, v75, v235
v_mul_f32 v80, v168, v168
v_mul_f32 v81, v169, v169
v_mul_f32 v82, v170, v170
v_mul_f32 v83, v171, v171
v_fma_f32 v80, v80, v42, v38
s_waitcnt vmcnt(2)
s_barrier
v_fma_f32 v81, v81, v42, v38
v_fma_f32 v82, v82, v42, v38
v_fma_f32 v83, v83, v42, v38
v_mul_f32 v80, v80, v168
v_mul_f32 v81, v81, v169
v_mul_f32 v82, v82, v170
v_mul_f32 v83, v83, v171
v_exp_f32 v80, v80
v_exp_f32 v81, v81
v_exp_f32 v82, v82
v_exp_f32 v83, v83
v_mul_f32 v232, v168, v232
v_mul_f32 v233, v169, v233
v_mul_f32 v234, v170, v234
v_mul_f32 v235, v171, v235
v_fma_f32 v80, v80, v46, v46
v_fma_f32 v81, v81, v46, v46
v_fma_f32 v82, v82, v46, v46
v_fma_f32 v83, v83, v46, v46
v_rcp_f32 v80, v80
v_rcp_f32 v81, v81
v_rcp_f32 v82, v82
v_rcp_f32 v83, v83
v_mul_f32 v232, v232, v80
v_mul_f32 v233, v233, v81
v_mul_f32 v234, v234, v82
v_mul_f32 v235, v235, v83
v_cvt_pk_bf16_f32 v104, v232, v233
v_cvt_pk_bf16_f32 v105, v234, v235
v_fma_f32 v184, -v34, v60, v184
v_fma_f32 v185, -v34, v61, v185
v_fma_f32 v186, -v34, v62, v186
v_fma_f32 v187, -v34, v63, v187
v_fma_f32 v248, -v34, v76, v248
v_fma_f32 v249, -v34, v77, v249
v_fma_f32 v250, -v34, v78, v250
v_fma_f32 v251, -v34, v79, v251
v_mul_f32 v84, v184, v184
v_mul_f32 v85, v185, v185
v_mul_f32 v86, v186, v186
v_mul_f32 v87, v187, v187
v_fma_f32 v84, v84, v42, v38
v_fma_f32 v85, v85, v42, v38
v_fma_f32 v86, v86, v42, v38
v_fma_f32 v87, v87, v42, v38
v_mul_f32 v84, v84, v184
v_mul_f32 v85, v85, v185
v_mul_f32 v86, v86, v186
v_mul_f32 v87, v87, v187
v_exp_f32 v84, v84
v_exp_f32 v85, v85
v_exp_f32 v86, v86
s_barrier
s_add_u32 s43, s34, 32
s_lshl_b32 s43, s43, 7
v_mov_b32 v21, s43
v_mov_b32 v23, 16
buffer_load_dword v22, v21, s[56:59], 0 offen sc1
v_exp_f32 v87, v87
v_mul_f32 v248, v184, v248
v_mul_f32 v249, v185, v249
v_mul_f32 v250, v186, v250
v_mul_f32 v251, v187, v251
v_fma_f32 v84, v84, v46, v46
v_fma_f32 v85, v85, v46, v46
v_fma_f32 v86, v86, v46, v46
v_fma_f32 v87, v87, v46, v46
v_rcp_f32 v84, v84
v_rcp_f32 v85, v85
v_rcp_f32 v86, v86
v_rcp_f32 v87, v87
v_mul_f32 v248, v248, v84
v_mul_f32 v249, v249, v85
v_mul_f32 v250, v250, v86
v_mul_f32 v251, v251, v87
v_cvt_pk_bf16_f32 v106, v248, v249
v_cvt_pk_bf16_f32 v107, v250, v251
buffer_store_dwordx4 v[104:107], v27, s[24:27], s53 offen offset:512 sc1
v_fma_f32 v172, -v35, v56, v172
v_fma_f32 v173, -v35, v57, v173
v_fma_f32 v174, -v35, v58, v174
v_fma_f32 v175, -v35, v59, v175
v_fma_f32 v236, -v35, v72, v236
v_fma_f32 v237, -v35, v73, v237
v_fma_f32 v238, -v35, v74, v238
v_fma_f32 v239, -v35, v75, v239
v_mul_f32 v80, v172, v172
v_mul_f32 v81, v173, v173
v_mul_f32 v82, v174, v174
v_mul_f32 v83, v175, v175
v_fma_f32 v80, v80, v43, v39
v_fma_f32 v81, v81, v43, v39
v_fma_f32 v82, v82, v43, v39
v_fma_f32 v83, v83, v43, v39
v_mul_f32 v80, v80, v172
v_mul_f32 v81, v81, v173
v_mul_f32 v82, v82, v174
v_mul_f32 v83, v83, v175
v_exp_f32 v80, v80
v_exp_f32 v81, v81
v_exp_f32 v82, v82
v_exp_f32 v83, v83
v_mul_f32 v236, v172, v236
v_mul_f32 v237, v173, v237
v_mul_f32 v238, v174, v238
v_mul_f32 v239, v175, v239
v_fma_f32 v80, v80, v47, v47
v_fma_f32 v81, v81, v47, v47
v_fma_f32 v82, v82, v47, v47
v_fma_f32 v83, v83, v47, v47
s_barrier
v_rcp_f32 v80, v80
v_rcp_f32 v81, v81
v_rcp_f32 v82, v82
v_rcp_f32 v83, v83
v_mul_f32 v236, v236, v80
v_mul_f32 v237, v237, v81
v_mul_f32 v238, v238, v82
v_mul_f32 v239, v239, v83
v_cvt_pk_bf16_f32 v108, v236, v237
v_cvt_pk_bf16_f32 v109, v238, v239
v_fma_f32 v188, -v35, v60, v188
v_fma_f32 v189, -v35, v61, v189
v_fma_f32 v190, -v35, v62, v190
v_fma_f32 v191, -v35, v63, v191
v_fma_f32 v252, -v35, v76, v252
v_fma_f32 v253, -v35, v77, v253
v_fma_f32 v254, -v35, v78, v254
v_fma_f32 v255, -v35, v79, v255
v_mul_f32 v84, v188, v188
v_mul_f32 v85, v189, v189
v_mul_f32 v86, v190, v190
v_mul_f32 v87, v191, v191
v_fma_f32 v84, v84, v43, v39
v_fma_f32 v85, v85, v43, v39
v_fma_f32 v86, v86, v43, v39
v_fma_f32 v87, v87, v43, v39
v_mul_f32 v84, v84, v188
v_mul_f32 v85, v85, v189
v_mul_f32 v86, v86, v190
v_mul_f32 v87, v87, v191
v_exp_f32 v84, v84
v_exp_f32 v85, v85
v_exp_f32 v86, v86
v_exp_f32 v87, v87
v_mul_f32 v252, v188, v252
v_mul_f32 v253, v189, v253
v_mul_f32 v254, v190, v254
v_mul_f32 v255, v191, v255
v_fma_f32 v84, v84, v47, v47
v_fma_f32 v85, v85, v47, v47
v_fma_f32 v86, v86, v47, v47
v_fma_f32 v87, v87, v47, v47
v_rcp_f32 v84, v84
v_rcp_f32 v85, v85
v_rcp_f32 v86, v86
v_rcp_f32 v87, v87
v_mul_f32 v252, v252, v84
v_mul_f32 v253, v253, v85
v_mul_f32 v254, v254, v86
v_mul_f32 v255, v255, v87
v_cvt_pk_bf16_f32 v110, v252, v253
v_cvt_pk_bf16_f32 v111, v254, v255
buffer_store_dwordx4 v[108:111], v27, s[24:27], s53 offen offset:768 sc1
s_mov_b32 s41, 0x10000
s_waitcnt vmcnt(2)
s_branch Lpf_95
Lpoll_93:
s_waitcnt vmcnt(0)
Lpf_95:
v_cmp_ne_u32 vcc, v23, v22
s_nop 4
s_cbranch_vccz Lpok_94
buffer_load_dword v22, v21, s[56:59], 0 offen sc1
s_sub_u32 s41, s41, 1
s_cmp_lg_u32 s41, 0
s_cbranch_scc1 Lpoll_93
s_waitcnt vmcnt(0)
Lpok_94:
s_barrier
v_lshlrev_b32 v128, 16, v192
v_and_b32 v129, 0xffff0000, v192
v_lshlrev_b32 v130, 16, v193
v_and_b32 v131, 0xffff0000, v193
v_lshlrev_b32 v132, 16, v194
v_and_b32 v133, 0xffff0000, v194
v_lshlrev_b32 v134, 16, v195
v_and_b32 v135, 0xffff0000, v195
v_lshlrev_b32 v136, 16, v196
v_and_b32 v137, 0xffff0000, v196
v_lshlrev_b32 v138, 16, v197
v_and_b32 v139, 0xffff0000, v197
v_lshlrev_b32 v140, 16, v198
v_and_b32 v141, 0xffff0000, v198
v_lshlrev_b32 v142, 16, v199
v_and_b32 v143, 0xffff0000, v199
v_lshlrev_b32 v144, 16, v200
v_and_b32 v145, 0xffff0000, v200
v_lshlrev_b32 v146, 16, v201
v_and_b32 v147, 0xffff0000, v201
v_lshlrev_b32 v148, 16, v202
v_and_b32 v149, 0xffff0000, v202
v_lshlrev_b32 v150, 16, v203
v_and_b32 v151, 0xffff0000, v203
v_lshlrev_b32 v152, 16, v204
v_and_b32 v153, 0xffff0000, v204
v_lshlrev_b32 v154, 16, v205
v_and_b32 v155, 0xffff0000, v205
v_lshlrev_b32 v156, 16, v206
v_and_b32 v157, 0xffff0000, v206
v_lshlrev_b32 v158, 16, v207
v_and_b32 v159, 0xffff0000, v207
s_waitcnt vmcnt(0)
s_barrier
s_add_u32 s43, s34, 48
s_lshl_b32 s43, s43, 7
v_mov_b32 v22, s43
v_mov_b32 v23, 1
s_mov_b64 exec, 1
buffer_atomic_add v23, v22, s[56:59], 0 offen sc1
s_mov_b64 exec, -1
s_branch Lw_96
Lr_97:
v_mov_b32 v192, 0
v_mov_b32 v193, 0
v_mov_b32 v194, 0
v_mov_b32 v195, 0
v_mov_b32 v196, 0
v_mov_b32 v197, 0
v_mov_b32 v198, 0
v_mov_b32 v199, 0
v_mov_b32 v200, 0
v_mov_b32 v201, 0
v_mov_b32 v202, 0
v_mov_b32 v203, 0
v_mov_b32 v204, 0
v_mov_b32 v205, 0
v_mov_b32 v206, 0
v_mov_b32 v207, 0
v_mov_b32 v208, 0
v_mov_b32 v209, 0
v_mov_b32 v210, 0
v_mov_b32 v211, 0
v_mov_b32 v212, 0
v_mov_b32 v213, 0
v_mov_b32 v214, 0
v_mov_b32 v215, 0
v_mov_b32 v216, 0
v_mov_b32 v217, 0
v_mov_b32 v218, 0
v_mov_b32 v219, 0
v_mov_b32 v220, 0
v_mov_b32 v221, 0
v_mov_b32 v222, 0
v_mov_b32 v223, 0
s_barrier
.p2align 3
LK4_91:
s_setprio 1
ds_read_b64_tr_b16 v[64:65], v7 offset:0
ds_read_b128 v[32:35], v3 offset:0
ds_read_b64_tr_b16 v[66:67], v7 offset:2048
ds_read_b128 v[36:39], v3 offset:256
ds_read_b64_tr_b16 v[68:69], v8 offset:0
ds_read_b128 v[40:43], v3 offset:512
ds_read_b64_tr_b16 v[70:71], v8 offset:2048
ds_read_b128 v[44:47], v3 offset:768
ds_read_b64_tr_b16 v[72:73], v7 offset:4096
ds_read_b128 v[48:51], v3 offset:8192
ds_read_b64_tr_b16 v[74:75], v7 offset:6144
ds_read_b128 v[52:55], v3 offset:8448
ds_read_b64_tr_b16 v[76:77], v8 offset:4096
ds_read_b128 v[56:59], v3 offset:8704
ds_read_b64_tr_b16 v[78:79], v8 offset:6144
ds_read_b128 v[60:63], v3 offset:8960
s_waitcnt vmcnt(0) lgkmcnt(0)
s_barrier
v_mfma_f32_16x16x32_bf16 v[128:131], v[64:67], v[32:35], v[128:131]
ds_read_b64_tr_b16 v[160:161], v7 offset:32768
v_mfma_f32_16x16x32_bf16 v[132:135], v[68:71], v[32:35], v[132:135]
ds_read_b128 v[96:99], v3 offset:32768
v_mfma_f32_16x16x32_bf16 v[136:139], v[64:67], v[36:39], v[136:139]
ds_read_b64_tr_b16 v[162:163], v7 offset:34816
v_mfma_f32_16x16x32_bf16 v[140:143], v[68:71], v[36:39], v[140:143]
ds_read_b128 v[100:103], v3 offset:33024
v_mfma_f32_16x16x32_bf16 v[144:147], v[64:67], v[40:43], v[144:147]
ds_read_b64_tr_b16 v[164:165], v8 offset:32768
v_mfma_f32_16x16x32_bf16 v[148:151], v[68:71], v[40:43], v[148:151]
ds_read_b128 v[104:107], v3 offset:33280
v_mfma_f32_16x16x32_bf16 v[152:155], v[64:67], v[44:47], v[152:155]
ds_read_b64_tr_b16 v[166:167], v8 offset:34816
v_mfma_f32_16x16x32_bf16 v[156:159], v[68:71], v[44:47], v[156:159]
ds_read_b128 v[108:111], v3 offset:33536
v_mfma_f32_16x16x32_bf16 v[128:131], v[72:75], v[48:51], v[128:131]
ds_read_b64_tr_b16 v[168:169], v7 offset:36864
v_mfma_f32_16x16x32_bf16 v[132:135], v[76:79], v[48:51], v[132:135]
ds_read_b128 v[112:115], v3 offset:40960
v_mfma_f32_16x16x32_bf16 v[136:139], v[72:75], v[52:55], v[136:139]
ds_read_b64_tr_b16 v[170:171], v7 offset:38912
v_mfma_f32_16x16x32_bf16 v[140:143], v[76:79], v[52:55], v[140:143]
ds_read_b128 v[116:119], v3 offset:41216
v_mfma_f32_16x16x32_bf16 v[144:147], v[72:75], v[56:59], v[144:147]
ds_read_b64_tr_b16 v[172:173], v8 offset:36864
v_mfma_f32_16x16x32_bf16 v[148:151], v[76:79], v[56:59], v[148:151]
ds_read_b128 v[120:123], v3 offset:41472
v_mfma_f32_16x16x32_bf16 v[152:155], v[72:75], v[60:63], v[152:155]
ds_read_b64_tr_b16 v[174:175], v8 offset:38912
v_mfma_f32_16x16x32_bf16 v[156:159], v[76:79], v[60:63], v[156:159]
ds_read_b128 v[124:127], v3 offset:41728
s_waitcnt lgkmcnt(0)
s_barrier
v_mfma_f32_16x16x32_bf16 v[128:131], v[160:163], v[96:99], v[128:131]
ds_read_b64_tr_b16 v[64:65], v5 offset:0
v_mfma_f32_16x16x32_bf16 v[132:135], v[164:167], v[96:99], v[132:135]
ds_read_b128 v[32:35], v2 offset:0
v_mfma_f32_16x16x32_bf16 v[136:139], v[160:163], v[100:103], v[136:139]
ds_read_b64_tr_b16 v[66:67], v5 offset:2048
v_mfma_f32_16x16x32_bf16 v[140:143], v[164:167], v[100:103], v[140:143]
ds_read_b128 v[36:39], v2 offset:256
v_mfma_f32_16x16x32_bf16 v[144:147], v[160:163], v[104:107], v[144:147]
ds_read_b64_tr_b16 v[68:69], v6 offset:0
v_mfma_f32_16x16x32_bf16 v[148:151], v[164:167], v[104:107], v[148:151]
ds_read_b128 v[40:43], v2 offset:512
v_mfma_f32_16x16x32_bf16 v[152:155], v[160:163], v[108:111], v[152:155]
ds_read_b64_tr_b16 v[70:71], v6 offset:2048
v_mfma_f32_16x16x32_bf16 v[156:159], v[164:167], v[108:111], v[156:159]
ds_read_b128 v[44:47], v2 offset:768
v_mfma_f32_16x16x32_bf16 v[128:131], v[168:171], v[112:115], v[128:131]
ds_read_b64_tr_b16 v[72:73], v5 offset:4096
v_mfma_f32_16x16x32_bf16 v[132:135], v[172:175], v[112:115], v[132:135]
ds_read_b128 v[48:51], v2 offset:8192
v_mfma_f32_16x16x32_bf16 v[136:139], v[168:171], v[116:119], v[136:139]
ds_read_b64_tr_b16 v[74:75], v5 offset:6144
v_mfma_f32_16x16x32_bf16 v[140:143], v[172:175], v[116:119], v[140:143]
ds_read_b128 v[52:55], v2 offset:8448
v_mfma_f32_16x16x32_bf16 v[144:147], v[168:171], v[120:123], v[144:147]
ds_read_b64_tr_b16 v[76:77], v6 offset:4096
v_mfma_f32_16x16x32_bf16 v[148:151], v[172:175], v[120:123], v[148:151]
ds_read_b128 v[56:59], v2 offset:8704
v_mfma_f32_16x16x32_bf16 v[152:155], v[168:171], v[124:127], v[152:155]
ds_read_b64_tr_b16 v[78:79], v6 offset:6144
v_mfma_f32_16x16x32_bf16 v[156:159], v[172:175], v[124:127], v[156:159]
ds_read_b128 v[60:63], v2 offset:8960
s_waitcnt lgkmcnt(0)
s_barrier
v_mfma_f32_16x16x32_bf16 v[128:131], v[64:67], v[32:35], v[128:131]
ds_read_b64_tr_b16 v[160:161], v5 offset:32768
v_mfma_f32_16x16x32_bf16 v[132:135], v[68:71], v[32:35], v[132:135]
ds_read_b128 v[96:99], v2 offset:32768
v_mfma_f32_16x16x32_bf16 v[136:139], v[64:67], v[36:39], v[136:139]
ds_read_b64_tr_b16 v[162:163], v5 offset:34816
v_mfma_f32_16x16x32_bf16 v[140:143], v[68:71], v[36:39], v[140:143]
ds_read_b128 v[100:103], v2 offset:33024
v_mfma_f32_16x16x32_bf16 v[144:147], v[64:67], v[40:43], v[144:147]
ds_read_b64_tr_b16 v[164:165], v6 offset:32768
v_mfma_f32_16x16x32_bf16 v[148:151], v[68:71], v[40:43], v[148:151]
ds_read_b128 v[104:107], v2 offset:33280
v_mfma_f32_16x16x32_bf16 v[152:155], v[64:67], v[44:47], v[152:155]
ds_read_b64_tr_b16 v[166:167], v6 offset:34816
v_mfma_f32_16x16x32_bf16 v[156:159], v[68:71], v[44:47], v[156:159]
ds_read_b128 v[108:111], v2 offset:33536
v_mfma_f32_16x16x32_bf16 v[128:131], v[72:75], v[48:51], v[128:131]
ds_read_b64_tr_b16 v[168:169], v5 offset:36864
v_mfma_f32_16x16x32_bf16 v[132:135], v[76:79], v[48:51], v[132:135]
ds_read_b128 v[112:115], v2 offset:40960
v_mfma_f32_16x16x32_bf16 v[136:139], v[72:75], v[52:55], v[136:139]
ds_read_b64_tr_b16 v[170:171], v5 offset:38912
v_mfma_f32_16x16x32_bf16 v[140:143], v[76:79], v[52:55], v[140:143]
ds_read_b128 v[116:119], v2 offset:41216
v_mfma_f32_16x16x32_bf16 v[144:147], v[72:75], v[56:59], v[144:147]
ds_read_b64_tr_b16 v[172:173], v6 offset:36864
v_mfma_f32_16x16x32_bf16 v[148:151], v[76:79], v[56:59], v[148:151]
ds_read_b128 v[120:123], v2 offset:41472
v_mfma_f32_16x16x32_bf16 v[152:155], v[72:75], v[60:63], v[152:155]
ds_read_b64_tr_b16 v[174:175], v6 offset:38912
v_mfma_f32_16x16x32_bf16 v[156:159], v[76:79], v[60:63], v[156:159]
ds_read_b128 v[124:127], v2 offset:41728
s_waitcnt lgkmcnt(0)
s_barrier
v_mfma_f32_16x16x32_bf16 v[128:131], v[160:163], v[96:99], v[128:131]
ds_read_b64_tr_b16 v[64:65], v7 offset:0
v_mfma_f32_16x16x32_bf16 v[132:135], v[164:167], v[96:99], v[132:135]
ds_read_b128 v[32:35], v3 offset:0
v_mfma_f32_16x16x32_bf16 v[136:139], v[160:163], v[100:103], v[136:139]
ds_read_b64_tr_b16 v[66:67], v7 offset:2048
v_mfma_f32_16x16x32_bf16 v[140:143], v[164:167], v[100:103], v[140:143]
ds_read_b128 v[36:39], v3 offset:256
v_mfma_f32_16x16x32_bf16 v[144:147], v[160:163], v[104:107], v[144:147]
ds_read_b64_tr_b16 v[68:69], v8 offset:0
v_mfma_f32_16x16x32_bf16 v[148:151], v[164:167], v[104:107], v[148:151]
ds_read_b128 v[40:43], v3 offset:512
v_mfma_f32_16x16x32_bf16 v[152:155], v[160:163], v[108:111], v[152:155]
ds_read_b64_tr_b16 v[70:71], v8 offset:2048
v_mfma_f32_16x16x32_bf16 v[156:159], v[164:167], v[108:111], v[156:159]
ds_read_b128 v[44:47], v3 offset:768
v_mfma_f32_16x16x32_bf16 v[128:131], v[168:171], v[112:115], v[128:131]
ds_read_b64_tr_b16 v[80:81], v7 offset:8192
v_mfma_f32_16x16x32_bf16 v[132:135], v[172:175], v[112:115], v[132:135]
ds_read_b64_tr_b16 v[82:83], v7 offset:10240
v_mfma_f32_16x16x32_bf16 v[136:139], v[168:171], v[116:119], v[136:139]
ds_read_b64_tr_b16 v[84:85], v8 offset:8192
v_mfma_f32_16x16x32_bf16 v[140:143], v[172:175], v[116:119], v[140:143]
ds_read_b64_tr_b16 v[86:87], v8 offset:10240
v_mfma_f32_16x16x32_bf16 v[144:147], v[168:171], v[120:123], v[144:147]
ds_read_b64_tr_b16 v[72:73], v7 offset:4096
v_mfma_f32_16x16x32_bf16 v[148:151], v[172:175], v[120:123], v[148:151]
ds_read_b128 v[48:51], v3 offset:8192
v_mfma_f32_16x16x32_bf16 v[152:155], v[168:171], v[124:127], v[152:155]
ds_read_b64_tr_b16 v[74:75], v7 offset:6144
v_mfma_f32_16x16x32_bf16 v[156:159], v[172:175], v[124:127], v[156:159]
ds_read_b128 v[52:55], v3 offset:8448
ds_read_b64_tr_b16 v[76:77], v8 offset:4096
ds_read_b128 v[56:59], v3 offset:8704
ds_read_b64_tr_b16 v[78:79], v8 offset:6144
ds_read_b128 v[60:63], v3 offset:8960
ds_read_b64_tr_b16 v[88:89], v7 offset:12288
ds_read_b64_tr_b16 v[90:91], v7 offset:14336
ds_read_b64_tr_b16 v[92:93], v8 offset:12288
ds_read_b64_tr_b16 v[94:95], v8 offset:14336
s_mov_b32 s41, 4
.p2align 3
Lk4_98:
s_waitcnt lgkmcnt(0)
s_barrier
v_mfma_f32_16x16x32_bf16 v[128:131], v[64:67], v[32:35], v[128:131]
ds_read_b64_tr_b16 v[160:161], v7 offset:32768
v_mfma_f32_16x16x32_bf16 v[132:135], v[68:71], v[32:35], v[132:135]
ds_read_b128 v[96:99], v3 offset:32768
v_mfma_f32_16x16x32_bf16 v[192:195], v[80:83], v[32:35], v[192:195]
ds_read_b64_tr_b16 v[162:163], v7 offset:34816
v_mfma_f32_16x16x32_bf16 v[196:199], v[84:87], v[32:35], v[196:199]
ds_read_b128 v[100:103], v3 offset:33024
v_mfma_f32_16x16x32_bf16 v[136:139], v[64:67], v[36:39], v[136:139]
ds_read_b64_tr_b16 v[164:165], v8 offset:32768
v_mfma_f32_16x16x32_bf16 v[140:143], v[68:71], v[36:39], v[140:143]
ds_read_b128 v[104:107], v3 offset:33280
v_mfma_f32_16x16x32_bf16 v[200:203], v[80:83], v[36:39], v[200:203]
ds_read_b64_tr_b16 v[166:167], v8 offset:34816
v_mfma_f32_16x16x32_bf16 v[204:207], v[84:87], v[36:39], v[204:207]
ds_read_b128 v[108:111], v3 offset:33536
v_mfma_f32_16x16x32_bf16 v[144:147], v[64:67], v[40:43], v[144:147]
ds_read_b64_tr_b16 v[176:177], v7 offset:40960
v_mfma_f32_16x16x32_bf16 v[148:151], v[68:71], v[40:43], v[148:151]
ds_read_b64_tr_b16 v[178:179], v7 offset:43008
v_mfma_f32_16x16x32_bf16 v[208:211], v[80:83], v[40:43], v[208:211]
ds_read_b64_tr_b16 v[180:181], v8 offset:40960
v_mfma_f32_16x16x32_bf16 v[212:215], v[84:87], v[40:43], v[212:215]
ds_read_b64_tr_b16 v[182:183], v8 offset:43008
v_mfma_f32_16x16x32_bf16 v[152:155], v[64:67], v[44:47], v[152:155]
ds_read_b64_tr_b16 v[168:169], v7 offset:36864
v_mfma_f32_16x16x32_bf16 v[156:159], v[68:71], v[44:47], v[156:159]
ds_read_b128 v[112:115], v3 offset:40960
v_mfma_f32_16x16x32_bf16 v[216:219], v[80:83], v[44:47], v[216:219]
ds_read_b64_tr_b16 v[170:171], v7 offset:38912
v_mfma_f32_16x16x32_bf16 v[220:223], v[84:87], v[44:47], v[220:223]
ds_read_b128 v[116:119], v3 offset:41216
v_mfma_f32_16x16x32_bf16 v[128:131], v[72:75], v[48:51], v[128:131]
ds_read_b64_tr_b16 v[172:173], v8 offset:36864
v_mfma_f32_16x16x32_bf16 v[132:135], v[76:79], v[48:51], v[132:135]
ds_read_b128 v[120:123], v3 offset:41472
v_mfma_f32_16x16x32_bf16 v[192:195], v[88:91], v[48:51], v[192:195]
ds_read_b64_tr_b16 v[174:175], v8 offset:38912
v_mfma_f32_16x16x32_bf16 v[196:199], v[92:95], v[48:51], v[196:199]
ds_read_b128 v[124:127], v3 offset:41728
v_mfma_f32_16x16x32_bf16 v[136:139], v[72:75], v[52:55], v[136:139]
ds_read_b64_tr_b16 v[184:185], v7 offset:45056
v_mfma_f32_16x16x32_bf16 v[140:143], v[76:79], v[52:55], v[140:143]
ds_read_b64_tr_b16 v[186:187], v7 offset:47104
v_mfma_f32_16x16x32_bf16 v[200:203], v[88:91], v[52:55], v[200:203]
ds_read_b64_tr_b16 v[188:189], v8 offset:45056
v_mfma_f32_16x16x32_bf16 v[204:207], v[92:95], v[52:55], v[204:207]
ds_read_b64_tr_b16 v[190:191], v8 offset:47104
v_mfma_f32_16x16x32_bf16 v[144:147], v[72:75], v[56:59], v[144:147]
v_mfma_f32_16x16x32_bf16 v[148:151], v[76:79], v[56:59], v[148:151]
v_mfma_f32_16x16x32_bf16 v[208:211], v[88:91], v[56:59], v[208:211]
v_mfma_f32_16x16x32_bf16 v[212:215], v[92:95], v[56:59], v[212:215]
v_mfma_f32_16x16x32_bf16 v[152:155], v[72:75], v[60:63], v[152:155]
v_mfma_f32_16x16x32_bf16 v[156:159], v[76:79], v[60:63], v[156:159]
v_mfma_f32_16x16x32_bf16 v[216:219], v[88:91], v[60:63], v[216:219]
v_mfma_f32_16x16x32_bf16 v[220:223], v[92:95], v[60:63], v[220:223]
s_waitcnt lgkmcnt(0)
s_barrier
v_mfma_f32_16x16x32_bf16 v[128:131], v[160:163], v[96:99], v[128:131]
ds_read_b64_tr_b16 v[64:65], v5 offset:0
v_mfma_f32_16x16x32_bf16 v[132:135], v[164:167], v[96:99], v[132:135]
ds_read_b128 v[32:35], v2 offset:0
v_mfma_f32_16x16x32_bf16 v[192:195], v[176:179], v[96:99], v[192:195]
ds_read_b64_tr_b16 v[66:67], v5 offset:2048
v_mfma_f32_16x16x32_bf16 v[196:199], v[180:183], v[96:99], v[196:199]
ds_read_b128 v[36:39], v2 offset:256
v_mfma_f32_16x16x32_bf16 v[136:139], v[160:163], v[100:103], v[136:139]
ds_read_b64_tr_b16 v[68:69], v6 offset:0
v_mfma_f32_16x16x32_bf16 v[140:143], v[164:167], v[100:103], v[140:143]
ds_read_b128 v[40:43], v2 offset:512
v_mfma_f32_16x16x32_bf16 v[200:203], v[176:179], v[100:103], v[200:203]
ds_read_b64_tr_b16 v[70:71], v6 offset:2048
v_mfma_f32_16x16x32_bf16 v[204:207], v[180:183], v[100:103], v[204:207]
ds_read_b128 v[44:47], v2 offset:768
v_mfma_f32_16x16x32_bf16 v[144:147], v[160:163], v[104:107], v[144:147]
ds_read_b64_tr_b16 v[80:81], v5 offset:8192
v_mfma_f32_16x16x32_bf16 v[148:151], v[164:167], v[104:107], v[148:151]
ds_read_b64_tr_b16 v[82:83], v5 offset:10240
v_mfma_f32_16x16x32_bf16 v[208:211], v[176:179], v[104:107], v[208:211]
ds_read_b64_tr_b16 v[84:85], v6 offset:8192
v_mfma_f32_16x16x32_bf16 v[212:215], v[180:183], v[104:107], v[212:215]
ds_read_b64_tr_b16 v[86:87], v6 offset:10240
v_mfma_f32_16x16x32_bf16 v[152:155], v[160:163], v[108:111], v[152:155]
ds_read_b64_tr_b16 v[72:73], v5 offset:4096
v_mfma_f32_16x16x32_bf16 v[156:159], v[164:167], v[108:111], v[156:159]
ds_read_b128 v[48:51], v2 offset:8192
v_mfma_f32_16x16x32_bf16 v[216:219], v[176:179], v[108:111], v[216:219]
ds_read_b64_tr_b16 v[74:75], v5 offset:6144
v_mfma_f32_16x16x32_bf16 v[220:223], v[180:183], v[108:111], v[220:223]
ds_read_b128 v[52:55], v2 offset:8448
v_mfma_f32_16x16x32_bf16 v[128:131], v[168:171], v[112:115], v[128:131]
ds_read_b64_tr_b16 v[76:77], v6 offset:4096
v_mfma_f32_16x16x32_bf16 v[132:135], v[172:175], v[112:115], v[132:135]
ds_read_b128 v[56:59], v2 offset:8704
v_mfma_f32_16x16x32_bf16 v[192:195], v[184:187], v[112:115], v[192:195]
ds_read_b64_tr_b16 v[78:79], v6 offset:6144
v_mfma_f32_16x16x32_bf16 v[196:199], v[188:191], v[112:115], v[196:199]
ds_read_b128 v[60:63], v2 offset:8960
v_mfma_f32_16x16x32_bf16 v[136:139], v[168:171], v[116:119], v[136:139]
ds_read_b64_tr_b16 v[88:89], v5 offset:12288
v_mfma_f32_16x16x32_bf16 v[140:143], v[172:175], v[116:119], v[140:143]
ds_read_b64_tr_b16 v[90:91], v5 offset:14336
v_mfma_f32_16x16x32_bf16 v[200:203], v[184:187], v[116:119], v[200:203]
ds_read_b64_tr_b16 v[92:93], v6 offset:12288
v_mfma_f32_16x16x32_bf16 v[204:207], v[188:191], v[116:119], v[204:207]
ds_read_b64_tr_b16 v[94:95], v6 offset:14336
v_mfma_f32_16x16x32_bf16 v[144:147], v[168:171], v[120:123], v[144:147]
v_mfma_f32_16x16x32_bf16 v[148:151], v[172:175], v[120:123], v[148:151]
v_mfma_f32_16x16x32_bf16 v[208:211], v[184:187], v[120:123], v[208:211]
v_mfma_f32_16x16x32_bf16 v[212:215], v[188:191], v[120:123], v[212:215]
v_mfma_f32_16x16x32_bf16 v[152:155], v[168:171], v[124:127], v[152:155]
v_mfma_f32_16x16x32_bf16 v[156:159], v[172:175], v[124:127], v[156:159]
v_mfma_f32_16x16x32_bf16 v[216:219], v[184:187], v[124:127], v[216:219]
v_mfma_f32_16x16x32_bf16 v[220:223], v[188:191], v[124:127], v[220:223]
s_waitcnt lgkmcnt(0)
s_barrier
v_mfma_f32_16x16x32_bf16 v[128:131], v[64:67], v[32:35], v[128:131]
ds_read_b64_tr_b16 v[160:161], v5 offset:32768
v_mfma_f32_16x16x32_bf16 v[132:135], v[68:71], v[32:35], v[132:135]
ds_read_b128 v[96:99], v2 offset:32768
v_mfma_f32_16x16x32_bf16 v[192:195], v[80:83], v[32:35], v[192:195]
ds_read_b64_tr_b16 v[162:163], v5 offset:34816
v_mfma_f32_16x16x32_bf16 v[196:199], v[84:87], v[32:35], v[196:199]
ds_read_b128 v[100:103], v2 offset:33024
v_mfma_f32_16x16x32_bf16 v[136:139], v[64:67], v[36:39], v[136:139]
ds_read_b64_tr_b16 v[164:165], v6 offset:32768
v_mfma_f32_16x16x32_bf16 v[140:143], v[68:71], v[36:39], v[140:143]
ds_read_b128 v[104:107], v2 offset:33280
v_mfma_f32_16x16x32_bf16 v[200:203], v[80:83], v[36:39], v[200:203]
ds_read_b64_tr_b16 v[166:167], v6 offset:34816
v_mfma_f32_16x16x32_bf16 v[204:207], v[84:87], v[36:39], v[204:207]
ds_read_b128 v[108:111], v2 offset:33536
v_mfma_f32_16x16x32_bf16 v[144:147], v[64:67], v[40:43], v[144:147]
ds_read_b64_tr_b16 v[176:177], v5 offset:40960
v_mfma_f32_16x16x32_bf16 v[148:151], v[68:71], v[40:43], v[148:151]
ds_read_b64_tr_b16 v[178:179], v5 offset:43008
v_mfma_f32_16x16x32_bf16 v[208:211], v[80:83], v[40:43], v[208:211]
ds_read_b64_tr_b16 v[180:181], v6 offset:40960
v_mfma_f32_16x16x32_bf16 v[212:215], v[84:87], v[40:43], v[212:215]
ds_read_b64_tr_b16 v[182:183], v6 offset:43008
v_mfma_f32_16x16x32_bf16 v[152:155], v[64:67], v[44:47], v[152:155]
ds_read_b64_tr_b16 v[168:169], v5 offset:36864
v_mfma_f32_16x16x32_bf16 v[156:159], v[68:71], v[44:47], v[156:159]
ds_read_b128 v[112:115], v2 offset:40960
v_mfma_f32_16x16x32_bf16 v[216:219], v[80:83], v[44:47], v[216:219]
ds_read_b64_tr_b16 v[170:171], v5 offset:38912
v_mfma_f32_16x16x32_bf16 v[220:223], v[84:87], v[44:47], v[220:223]
ds_read_b128 v[116:119], v2 offset:41216
v_mfma_f32_16x16x32_bf16 v[128:131], v[72:75], v[48:51], v[128:131]
ds_read_b64_tr_b16 v[172:173], v6 offset:36864
v_mfma_f32_16x16x32_bf16 v[132:135], v[76:79], v[48:51], v[132:135]
ds_read_b128 v[120:123], v2 offset:41472
v_mfma_f32_16x16x32_bf16 v[192:195], v[88:91], v[48:51], v[192:195]
ds_read_b64_tr_b16 v[174:175], v6 offset:38912
v_mfma_f32_16x16x32_bf16 v[196:199], v[92:95], v[48:51], v[196:199]
ds_read_b128 v[124:127], v2 offset:41728
v_mfma_f32_16x16x32_bf16 v[136:139], v[72:75], v[52:55], v[136:139]
ds_read_b64_tr_b16 v[184:185], v5 offset:45056
v_mfma_f32_16x16x32_bf16 v[140:143], v[76:79], v[52:55], v[140:143]
ds_read_b64_tr_b16 v[186:187], v5 offset:47104
v_mfma_f32_16x16x32_bf16 v[200:203], v[88:91], v[52:55], v[200:203]
ds_read_b64_tr_b16 v[188:189], v6 offset:45056
v_mfma_f32_16x16x32_bf16 v[204:207], v[92:95], v[52:55], v[204:207]
ds_read_b64_tr_b16 v[190:191], v6 offset:47104
v_mfma_f32_16x16x32_bf16 v[144:147], v[72:75], v[56:59], v[144:147]
v_mfma_f32_16x16x32_bf16 v[148:151], v[76:79], v[56:59], v[148:151]
v_mfma_f32_16x16x32_bf16 v[208:211], v[88:91], v[56:59], v[208:211]
v_mfma_f32_16x16x32_bf16 v[212:215], v[92:95], v[56:59], v[212:215]
v_mfma_f32_16x16x32_bf16 v[152:155], v[72:75], v[60:63], v[152:155]
v_mfma_f32_16x16x32_bf16 v[156:159], v[76:79], v[60:63], v[156:159]
v_mfma_f32_16x16x32_bf16 v[216:219], v[88:91], v[60:63], v[216:219]
v_mfma_f32_16x16x32_bf16 v[220:223], v[92:95], v[60:63], v[220:223]
s_waitcnt lgkmcnt(0)
s_barrier
v_mfma_f32_16x16x32_bf16 v[128:131], v[160:163], v[96:99], v[128:131]
ds_read_b64_tr_b16 v[64:65], v7 offset:0
v_mfma_f32_16x16x32_bf16 v[132:135], v[164:167], v[96:99], v[132:135]
ds_read_b128 v[32:35], v3 offset:0
v_mfma_f32_16x16x32_bf16 v[192:195], v[176:179], v[96:99], v[192:195]
ds_read_b64_tr_b16 v[66:67], v7 offset:2048
v_mfma_f32_16x16x32_bf16 v[196:199], v[180:183], v[96:99], v[196:199]
ds_read_b128 v[36:39], v3 offset:256
v_mfma_f32_16x16x32_bf16 v[136:139], v[160:163], v[100:103], v[136:139]
ds_read_b64_tr_b16 v[68:69], v8 offset:0
v_mfma_f32_16x16x32_bf16 v[140:143], v[164:167], v[100:103], v[140:143]
ds_read_b128 v[40:43], v3 offset:512
v_mfma_f32_16x16x32_bf16 v[200:203], v[176:179], v[100:103], v[200:203]
ds_read_b64_tr_b16 v[70:71], v8 offset:2048
v_mfma_f32_16x16x32_bf16 v[204:207], v[180:183], v[100:103], v[204:207]
ds_read_b128 v[44:47], v3 offset:768
v_mfma_f32_16x16x32_bf16 v[144:147], v[160:163], v[104:107], v[144:147]
ds_read_b64_tr_b16 v[80:81], v7 offset:8192
v_mfma_f32_16x16x32_bf16 v[148:151], v[164:167], v[104:107], v[148:151]
ds_read_b64_tr_b16 v[82:83], v7 offset:10240
v_mfma_f32_16x16x32_bf16 v[208:211], v[176:179], v[104:107], v[208:211]
ds_read_b64_tr_b16 v[84:85], v8 offset:8192
v_mfma_f32_16x16x32_bf16 v[212:215], v[180:183], v[104:107], v[212:215]
ds_read_b64_tr_b16 v[86:87], v8 offset:10240
v_mfma_f32_16x16x32_bf16 v[152:155], v[160:163], v[108:111], v[152:155]
ds_read_b64_tr_b16 v[72:73], v7 offset:4096
v_mfma_f32_16x16x32_bf16 v[156:159], v[164:167], v[108:111], v[156:159]
ds_read_b128 v[48:51], v3 offset:8192
v_mfma_f32_16x16x32_bf16 v[216:219], v[176:179], v[108:111], v[216:219]
ds_read_b64_tr_b16 v[74:75], v7 offset:6144
v_mfma_f32_16x16x32_bf16 v[220:223], v[180:183], v[108:111], v[220:223]
ds_read_b128 v[52:55], v3 offset:8448
v_mfma_f32_16x16x32_bf16 v[128:131], v[168:171], v[112:115], v[128:131]
ds_read_b64_tr_b16 v[76:77], v8 offset:4096
v_mfma_f32_16x16x32_bf16 v[132:135], v[172:175], v[112:115], v[132:135]
ds_read_b128 v[56:59], v3 offset:8704
v_mfma_f32_16x16x32_bf16 v[192:195], v[184:187], v[112:115], v[192:195]
ds_read_b64_tr_b16 v[78:79], v8 offset:6144
v_mfma_f32_16x16x32_bf16 v[196:199], v[188:191], v[112:115], v[196:199]
ds_read_b128 v[60:63], v3 offset:8960
v_mfma_f32_16x16x32_bf16 v[136:139], v[168:171], v[116:119], v[136:139]
ds_read_b64_tr_b16 v[88:89], v7 offset:12288
v_mfma_f32_16x16x32_bf16 v[140:143], v[172:175], v[116:119], v[140:143]
ds_read_b64_tr_b16 v[90:91], v7 offset:14336
v_mfma_f32_16x16x32_bf16 v[200:203], v[184:187], v[116:119], v[200:203]
ds_read_b64_tr_b16 v[92:93], v8 offset:12288
v_mfma_f32_16x16x32_bf16 v[204:207], v[188:191], v[116:119], v[204:207]
ds_read_b64_tr_b16 v[94:95], v8 offset:14336
v_mfma_f32_16x16x32_bf16 v[144:147], v[168:171], v[120:123], v[144:147]
v_mfma_f32_16x16x32_bf16 v[148:151], v[172:175], v[120:123], v[148:151]
v_mfma_f32_16x16x32_bf16 v[208:211], v[184:187], v[120:123], v[208:211]
v_mfma_f32_16x16x32_bf16 v[212:215], v[188:191], v[120:123], v[212:215]
v_mfma_f32_16x16x32_bf16 v[152:155], v[168:171], v[124:127], v[152:155]
v_mfma_f32_16x16x32_bf16 v[156:159], v[172:175], v[124:127], v[156:159]
v_mfma_f32_16x16x32_bf16 v[216:219], v[184:187], v[124:127], v[216:219]
v_mfma_f32_16x16x32_bf16 v[220:223], v[188:191], v[124:127], v[220:223]
s_sub_u32 s41, s41, 1
s_cmp_lg_u32 s41, 0
s_cbranch_scc1 Lk4_98
s_waitcnt lgkmcnt(0)
s_barrier
v_mfma_f32_16x16x32_bf16 v[128:131], v[64:67], v[32:35], v[128:131]
ds_read_b64_tr_b16 v[160:161], v7 offset:32768
v_mfma_f32_16x16x32_bf16 v[132:135], v[68:71], v[32:35], v[132:135]
ds_read_b128 v[96:99], v3 offset:32768
v_mfma_f32_16x16x32_bf16 v[192:195], v[80:83], v[32:35], v[192:195]
ds_read_b64_tr_b16 v[162:163], v7 offset:34816
v_mfma_f32_16x16x32_bf16 v[196:199], v[84:87], v[32:35], v[196:199]
ds_read_b128 v[100:103], v3 offset:33024
v_mfma_f32_16x16x32_bf16 v[136:139], v[64:67], v[36:39], v[136:139]
ds_read_b64_tr_b16 v[164:165], v8 offset:32768
v_mfma_f32_16x16x32_bf16 v[140:143], v[68:71], v[36:39], v[140:143]
ds_read_b128 v[104:107], v3 offset:33280
v_mfma_f32_16x16x32_bf16 v[200:203], v[80:83], v[36:39], v[200:203]
ds_read_b64_tr_b16 v[166:167], v8 offset:34816
v_mfma_f32_16x16x32_bf16 v[204:207], v[84:87], v[36:39], v[204:207]
ds_read_b128 v[108:111], v3 offset:33536
v_mfma_f32_16x16x32_bf16 v[144:147], v[64:67], v[40:43], v[144:147]
ds_read_b64_tr_b16 v[176:177], v7 offset:40960
v_mfma_f32_16x16x32_bf16 v[148:151], v[68:71], v[40:43], v[148:151]
ds_read_b64_tr_b16 v[178:179], v7 offset:43008
v_mfma_f32_16x16x32_bf16 v[208:211], v[80:83], v[40:43], v[208:211]
ds_read_b64_tr_b16 v[180:181], v8 offset:40960
v_mfma_f32_16x16x32_bf16 v[212:215], v[84:87], v[40:43], v[212:215]
ds_read_b64_tr_b16 v[182:183], v8 offset:43008
v_mfma_f32_16x16x32_bf16 v[152:155], v[64:67], v[44:47], v[152:155]
ds_read_b64_tr_b16 v[168:169], v7 offset:36864
v_mfma_f32_16x16x32_bf16 v[156:159], v[68:71], v[44:47], v[156:159]
ds_read_b128 v[112:115], v3 offset:40960
v_mfma_f32_16x16x32_bf16 v[216:219], v[80:83], v[44:47], v[216:219]
ds_read_b64_tr_b16 v[170:171], v7 offset:38912
v_mfma_f32_16x16x32_bf16 v[220:223], v[84:87], v[44:47], v[220:223]
ds_read_b128 v[116:119], v3 offset:41216
v_mfma_f32_16x16x32_bf16 v[128:131], v[72:75], v[48:51], v[128:131]
ds_read_b64_tr_b16 v[172:173], v8 offset:36864
v_mfma_f32_16x16x32_bf16 v[132:135], v[76:79], v[48:51], v[132:135]
ds_read_b128 v[120:123], v3 offset:41472
v_mfma_f32_16x16x32_bf16 v[192:195], v[88:91], v[48:51], v[192:195]
ds_read_b64_tr_b16 v[174:175], v8 offset:38912
v_mfma_f32_16x16x32_bf16 v[196:199], v[92:95], v[48:51], v[196:199]
ds_read_b128 v[124:127], v3 offset:41728
v_mfma_f32_16x16x32_bf16 v[136:139], v[72:75], v[52:55], v[136:139]
ds_read_b64_tr_b16 v[184:185], v7 offset:45056
v_mfma_f32_16x16x32_bf16 v[140:143], v[76:79], v[52:55], v[140:143]
ds_read_b64_tr_b16 v[186:187], v7 offset:47104
v_mfma_f32_16x16x32_bf16 v[200:203], v[88:91], v[52:55], v[200:203]
ds_read_b64_tr_b16 v[188:189], v8 offset:45056
v_mfma_f32_16x16x32_bf16 v[204:207], v[92:95], v[52:55], v[204:207]
ds_read_b64_tr_b16 v[190:191], v8 offset:47104
v_mfma_f32_16x16x32_bf16 v[144:147], v[72:75], v[56:59], v[144:147]
v_mfma_f32_16x16x32_bf16 v[148:151], v[76:79], v[56:59], v[148:151]
v_mfma_f32_16x16x32_bf16 v[208:211], v[88:91], v[56:59], v[208:211]
v_mfma_f32_16x16x32_bf16 v[212:215], v[92:95], v[56:59], v[212:215]
v_mfma_f32_16x16x32_bf16 v[152:155], v[72:75], v[60:63], v[152:155]
v_mfma_f32_16x16x32_bf16 v[156:159], v[76:79], v[60:63], v[156:159]
v_mfma_f32_16x16x32_bf16 v[216:219], v[88:91], v[60:63], v[216:219]
v_mfma_f32_16x16x32_bf16 v[220:223], v[92:95], v[60:63], v[220:223]
s_waitcnt lgkmcnt(0)
s_barrier
v_mfma_f32_16x16x32_bf16 v[128:131], v[160:163], v[96:99], v[128:131]
ds_read_b64_tr_b16 v[64:65], v5 offset:0
v_mfma_f32_16x16x32_bf16 v[132:135], v[164:167], v[96:99], v[132:135]
ds_read_b128 v[32:35], v2 offset:0
v_mfma_f32_16x16x32_bf16 v[192:195], v[176:179], v[96:99], v[192:195]
ds_read_b64_tr_b16 v[66:67], v5 offset:2048
v_mfma_f32_16x16x32_bf16 v[196:199], v[180:183], v[96:99], v[196:199]
ds_read_b128 v[36:39], v2 offset:256
v_mfma_f32_16x16x32_bf16 v[136:139], v[160:163], v[100:103], v[136:139]
ds_read_b64_tr_b16 v[68:69], v6 offset:0
v_mfma_f32_16x16x32_bf16 v[140:143], v[164:167], v[100:103], v[140:143]
ds_read_b128 v[40:43], v2 offset:512
v_mfma_f32_16x16x32_bf16 v[200:203], v[176:179], v[100:103], v[200:203]
ds_read_b64_tr_b16 v[70:71], v6 offset:2048
v_mfma_f32_16x16x32_bf16 v[204:207], v[180:183], v[100:103], v[204:207]
ds_read_b128 v[44:47], v2 offset:768
v_mfma_f32_16x16x32_bf16 v[144:147], v[160:163], v[104:107], v[144:147]
ds_read_b64_tr_b16 v[80:81], v5 offset:8192
v_mfma_f32_16x16x32_bf16 v[148:151], v[164:167], v[104:107], v[148:151]
ds_read_b64_tr_b16 v[82:83], v5 offset:10240
v_mfma_f32_16x16x32_bf16 v[208:211], v[176:179], v[104:107], v[208:211]
ds_read_b64_tr_b16 v[84:85], v6 offset:8192
v_mfma_f32_16x16x32_bf16 v[212:215], v[180:183], v[104:107], v[212:215]
ds_read_b64_tr_b16 v[86:87], v6 offset:10240
v_mfma_f32_16x16x32_bf16 v[152:155], v[160:163], v[108:111], v[152:155]
ds_read_b64_tr_b16 v[72:73], v5 offset:4096
v_mfma_f32_16x16x32_bf16 v[156:159], v[164:167], v[108:111], v[156:159]
ds_read_b128 v[48:51], v2 offset:8192
v_mfma_f32_16x16x32_bf16 v[216:219], v[176:179], v[108:111], v[216:219]
ds_read_b64_tr_b16 v[74:75], v5 offset:6144
v_mfma_f32_16x16x32_bf16 v[220:223], v[180:183], v[108:111], v[220:223]
ds_read_b128 v[52:55], v2 offset:8448
v_mfma_f32_16x16x32_bf16 v[128:131], v[168:171], v[112:115], v[128:131]
ds_read_b64_tr_b16 v[76:77], v6 offset:4096
v_mfma_f32_16x16x32_bf16 v[132:135], v[172:175], v[112:115], v[132:135]
ds_read_b128 v[56:59], v2 offset:8704
v_mfma_f32_16x16x32_bf16 v[192:195], v[184:187], v[112:115], v[192:195]
ds_read_b64_tr_b16 v[78:79], v6 offset:6144
v_mfma_f32_16x16x32_bf16 v[196:199], v[188:191], v[112:115], v[196:199]
ds_read_b128 v[60:63], v2 offset:8960
v_mfma_f32_16x16x32_bf16 v[136:139], v[168:171], v[116:119], v[136:139]
ds_read_b64_tr_b16 v[88:89], v5 offset:12288
v_mfma_f32_16x16x32_bf16 v[140:143], v[172:175], v[116:119], v[140:143]
ds_read_b64_tr_b16 v[90:91], v5 offset:14336
v_mfma_f32_16x16x32_bf16 v[200:203], v[184:187], v[116:119], v[200:203]
ds_read_b64_tr_b16 v[92:93], v6 offset:12288
v_mfma_f32_16x16x32_bf16 v[204:207], v[188:191], v[116:119], v[204:207]
ds_read_b64_tr_b16 v[94:95], v6 offset:14336
v_mfma_f32_16x16x32_bf16 v[144:147], v[168:171], v[120:123], v[144:147]
v_mfma_f32_16x16x32_bf16 v[148:151], v[172:175], v[120:123], v[148:151]
v_mfma_f32_16x16x32_bf16 v[208:211], v[184:187], v[120:123], v[208:211]
v_mfma_f32_16x16x32_bf16 v[212:215], v[188:191], v[120:123], v[212:215]
v_mfma_f32_16x16x32_bf16 v[152:155], v[168:171], v[124:127], v[152:155]
v_mfma_f32_16x16x32_bf16 v[156:159], v[172:175], v[124:127], v[156:159]
v_mfma_f32_16x16x32_bf16 v[216:219], v[184:187], v[124:127], v[216:219]
v_mfma_f32_16x16x32_bf16 v[220:223], v[188:191], v[124:127], v[220:223]
s_waitcnt lgkmcnt(0)
s_barrier
v_mfma_f32_16x16x32_bf16 v[128:131], v[64:67], v[32:35], v[128:131]
ds_read_b64_tr_b16 v[160:161], v5 offset:32768
v_mfma_f32_16x16x32_bf16 v[132:135], v[68:71], v[32:35], v[132:135]
ds_read_b128 v[96:99], v2 offset:32768
v_mfma_f32_16x16x32_bf16 v[192:195], v[80:83], v[32:35], v[192:195]
ds_read_b64_tr_b16 v[162:163], v5 offset:34816
v_mfma_f32_16x16x32_bf16 v[196:199], v[84:87], v[32:35], v[196:199]
ds_read_b128 v[100:103], v2 offset:33024
v_mfma_f32_16x16x32_bf16 v[136:139], v[64:67], v[36:39], v[136:139]
ds_read_b64_tr_b16 v[164:165], v6 offset:32768
v_mfma_f32_16x16x32_bf16 v[140:143], v[68:71], v[36:39], v[140:143]
ds_read_b128 v[104:107], v2 offset:33280
v_mfma_f32_16x16x32_bf16 v[200:203], v[80:83], v[36:39], v[200:203]
ds_read_b64_tr_b16 v[166:167], v6 offset:34816
v_mfma_f32_16x16x32_bf16 v[204:207], v[84:87], v[36:39], v[204:207]
ds_read_b128 v[108:111], v2 offset:33536
v_mfma_f32_16x16x32_bf16 v[144:147], v[64:67], v[40:43], v[144:147]
ds_read_b64_tr_b16 v[176:177], v5 offset:40960
v_mfma_f32_16x16x32_bf16 v[148:151], v[68:71], v[40:43], v[148:151]
ds_read_b64_tr_b16 v[178:179], v5 offset:43008
v_mfma_f32_16x16x32_bf16 v[208:211], v[80:83], v[40:43], v[208:211]
ds_read_b64_tr_b16 v[180:181], v6 offset:40960
v_mfma_f32_16x16x32_bf16 v[212:215], v[84:87], v[40:43], v[212:215]
ds_read_b64_tr_b16 v[182:183], v6 offset:43008
v_mfma_f32_16x16x32_bf16 v[152:155], v[64:67], v[44:47], v[152:155]
ds_read_b64_tr_b16 v[168:169], v5 offset:36864
v_mfma_f32_16x16x32_bf16 v[156:159], v[68:71], v[44:47], v[156:159]
ds_read_b128 v[112:115], v2 offset:40960
v_mfma_f32_16x16x32_bf16 v[216:219], v[80:83], v[44:47], v[216:219]
ds_read_b64_tr_b16 v[170:171], v5 offset:38912
v_mfma_f32_16x16x32_bf16 v[220:223], v[84:87], v[44:47], v[220:223]
ds_read_b128 v[116:119], v2 offset:41216
v_mfma_f32_16x16x32_bf16 v[128:131], v[72:75], v[48:51], v[128:131]
ds_read_b64_tr_b16 v[172:173], v6 offset:36864
v_mfma_f32_16x16x32_bf16 v[132:135], v[76:79], v[48:51], v[132:135]
ds_read_b128 v[120:123], v2 offset:41472
v_mfma_f32_16x16x32_bf16 v[192:195], v[88:91], v[48:51], v[192:195]
ds_read_b64_tr_b16 v[174:175], v6 offset:38912
v_mfma_f32_16x16x32_bf16 v[196:199], v[92:95], v[48:51], v[196:199]
ds_read_b128 v[124:127], v2 offset:41728
v_mfma_f32_16x16x32_bf16 v[136:139], v[72:75], v[52:55], v[136:139]
ds_read_b64_tr_b16 v[184:185], v5 offset:45056
v_mfma_f32_16x16x32_bf16 v[140:143], v[76:79], v[52:55], v[140:143]
ds_read_b64_tr_b16 v[186:187], v5 offset:47104
v_mfma_f32_16x16x32_bf16 v[200:203], v[88:91], v[52:55], v[200:203]
ds_read_b64_tr_b16 v[188:189], v6 offset:45056
v_mfma_f32_16x16x32_bf16 v[204:207], v[92:95], v[52:55], v[204:207]
ds_read_b64_tr_b16 v[190:191], v6 offset:47104
v_mfma_f32_16x16x32_bf16 v[144:147], v[72:75], v[56:59], v[144:147]
v_mfma_f32_16x16x32_bf16 v[148:151], v[76:79], v[56:59], v[148:151]
v_mfma_f32_16x16x32_bf16 v[208:211], v[88:91], v[56:59], v[208:211]
v_mfma_f32_16x16x32_bf16 v[212:215], v[92:95], v[56:59], v[212:215]
v_mfma_f32_16x16x32_bf16 v[152:155], v[72:75], v[60:63], v[152:155]
v_mfma_f32_16x16x32_bf16 v[156:159], v[76:79], v[60:63], v[156:159]
v_mfma_f32_16x16x32_bf16 v[216:219], v[88:91], v[60:63], v[216:219]
v_mfma_f32_16x16x32_bf16 v[220:223], v[92:95], v[60:63], v[220:223]
s_waitcnt lgkmcnt(0)
s_barrier
v_mfma_f32_16x16x32_bf16 v[128:131], v[160:163], v[96:99], v[128:131]
ds_read_b64_tr_b16 v[64:65], v7 offset:0
v_mfma_f32_16x16x32_bf16 v[132:135], v[164:167], v[96:99], v[132:135]
ds_read_b128 v[32:35], v3 offset:0
v_mfma_f32_16x16x32_bf16 v[192:195], v[176:179], v[96:99], v[192:195]
ds_read_b64_tr_b16 v[66:67], v7 offset:2048
v_mfma_f32_16x16x32_bf16 v[196:199], v[180:183], v[96:99], v[196:199]
ds_read_b128 v[36:39], v3 offset:256
v_mfma_f32_16x16x32_bf16 v[136:139], v[160:163], v[100:103], v[136:139]
ds_read_b64_tr_b16 v[68:69], v8 offset:0
v_mfma_f32_16x16x32_bf16 v[140:143], v[164:167], v[100:103], v[140:143]
ds_read_b128 v[40:43], v3 offset:512
v_mfma_f32_16x16x32_bf16 v[200:203], v[176:179], v[100:103], v[200:203]
ds_read_b64_tr_b16 v[70:71], v8 offset:2048
v_mfma_f32_16x16x32_bf16 v[204:207], v[180:183], v[100:103], v[204:207]
ds_read_b128 v[44:47], v3 offset:768
v_mfma_f32_16x16x32_bf16 v[144:147], v[160:163], v[104:107], v[144:147]
ds_read_b64_tr_b16 v[72:73], v7 offset:4096
v_mfma_f32_16x16x32_bf16 v[148:151], v[164:167], v[104:107], v[148:151]
ds_read_b128 v[48:51], v3 offset:8192
v_mfma_f32_16x16x32_bf16 v[208:211], v[176:179], v[104:107], v[208:211]
ds_read_b64_tr_b16 v[74:75], v7 offset:6144
v_mfma_f32_16x16x32_bf16 v[212:215], v[180:183], v[104:107], v[212:215]
ds_read_b128 v[52:55], v3 offset:8448
v_mfma_f32_16x16x32_bf16 v[152:155], v[160:163], v[108:111], v[152:155]
ds_read_b64_tr_b16 v[76:77], v8 offset:4096
v_mfma_f32_16x16x32_bf16 v[156:159], v[164:167], v[108:111], v[156:159]
ds_read_b128 v[56:59], v3 offset:8704
v_mfma_f32_16x16x32_bf16 v[216:219], v[176:179], v[108:111], v[216:219]
ds_read_b64_tr_b16 v[78:79], v8 offset:6144
v_mfma_f32_16x16x32_bf16 v[220:223], v[180:183], v[108:111], v[220:223]
ds_read_b128 v[60:63], v3 offset:8960
v_mfma_f32_16x16x32_bf16 v[128:131], v[168:171], v[112:115], v[128:131]
v_mfma_f32_16x16x32_bf16 v[132:135], v[172:175], v[112:115], v[132:135]
v_mfma_f32_16x16x32_bf16 v[192:195], v[184:187], v[112:115], v[192:195]
v_mfma_f32_16x16x32_bf16 v[196:199], v[188:191], v[112:115], v[196:199]
v_mfma_f32_16x16x32_bf16 v[136:139], v[168:171], v[116:119], v[136:139]
v_mfma_f32_16x16x32_bf16 v[140:143], v[172:175], v[116:119], v[140:143]
v_mfma_f32_16x16x32_bf16 v[200:203], v[184:187], v[116:119], v[200:203]
v_mfma_f32_16x16x32_bf16 v[204:207], v[188:191], v[116:119], v[204:207]
v_mfma_f32_16x16x32_bf16 v[144:147], v[168:171], v[120:123], v[144:147]
v_mfma_f32_16x16x32_bf16 v[148:151], v[172:175], v[120:123], v[148:151]
v_mfma_f32_16x16x32_bf16 v[208:211], v[184:187], v[120:123], v[208:211]
v_mfma_f32_16x16x32_bf16 v[212:215], v[188:191], v[120:123], v[212:215]
v_mfma_f32_16x16x32_bf16 v[152:155], v[168:171], v[124:127], v[152:155]
v_mfma_f32_16x16x32_bf16 v[156:159], v[172:175], v[124:127], v[156:159]
v_mfma_f32_16x16x32_bf16 v[216:219], v[184:187], v[124:127], v[216:219]
v_mfma_f32_16x16x32_bf16 v[220:223], v[188:191], v[124:127], v[220:223]
s_mov_b32 s54, 0x10000
s_waitcnt lgkmcnt(0)
s_barrier
v_mfma_f32_16x16x32_bf16 v[128:131], v[64:67], v[32:35], v[128:131]
ds_read_b64_tr_b16 v[160:161], v7 offset:32768
v_mfma_f32_16x16x32_bf16 v[132:135], v[68:71], v[32:35], v[132:135]
ds_read_b128 v[96:99], v3 offset:32768
v_mfma_f32_16x16x32_bf16 v[136:139], v[64:67], v[36:39], v[136:139]
ds_read_b64_tr_b16 v[162:163], v7 offset:34816
v_mfma_f32_16x16x32_bf16 v[140:143], v[68:71], v[36:39], v[140:143]
ds_read_b128 v[100:103], v3 offset:33024
v_cvt_pk_bf16_f32 v224, v192, v193
v_mfma_f32_16x16x32_bf16 v[144:147], v[64:67], v[40:43], v[144:147]
ds_read_b64_tr_b16 v[164:165], v8 offset:32768
v_cvt_pk_bf16_f32 v225, v194, v195
v_mfma_f32_16x16x32_bf16 v[148:151], v[68:71], v[40:43], v[148:151]
v_cvt_pk_bf16_f32 v226, v196, v197
ds_read_b128 v[104:107], v3 offset:33280
v_cvt_pk_bf16_f32 v227, v198, v199
v_mfma_f32_16x16x32_bf16 v[152:155], v[64:67], v[44:47], v[152:155]
buffer_store_dwordx4 v[224:227], v9, s[64:67], 0 offen offset:0 sc1
ds_read_b64_tr_b16 v[166:167], v8 offset:34816
v_cvt_pk_bf16_f32 v228, v200, v201
v_mfma_f32_16x16x32_bf16 v[156:159], v[68:71], v[44:47], v[156:159]
ds_read_b128 v[108:111], v3 offset:33536
v_cvt_pk_bf16_f32 v229, v202, v203
v_mfma_f32_16x16x32_bf16 v[128:131], v[72:75], v[48:51], v[128:131]
v_cvt_pk_bf16_f32 v230, v204, v205
ds_read_b64_tr_b16 v[168:169], v7 offset:36864
v_cvt_pk_bf16_f32 v231, v206, v207
v_mfma_f32_16x16x32_bf16 v[132:135], v[76:79], v[48:51], v[132:135]
buffer_store_dwordx4 v[228:231], v9, s[64:67], 0 offen offset:1024 sc1
ds_read_b128 v[112:115], v3 offset:40960
v_cvt_pk_bf16_f32 v232, v208, v209
v_mfma_f32_16x16x32_bf16 v[136:139], v[72:75], v[52:55], v[136:139]
ds_read_b64_tr_b16 v[170:171], v7 offset:38912
v_cvt_pk_bf16_f32 v233, v210, v211
v_mfma_f32_16x16x32_bf16 v[140:143], v[76:79], v[52:55], v[140:143]
v_cvt_pk_bf16_f32 v234, v212, v213
ds_read_b128 v[116:119], v3 offset:41216
v_cvt_pk_bf16_f32 v235, v214, v215
v_mfma_f32_16x16x32_bf16 v[144:147], v[72:75], v[56:59], v[144:147]
buffer_store_dwordx4 v[232:235], v9, s[64:67], 0 offen offset:2048 sc1
ds_read_b64_tr_b16 v[172:173], v8 offset:36864
v_cvt_pk_bf16_f32 v236, v216, v217
v_mfma_f32_16x16x32_bf16 v[148:151], v[76:79], v[56:59], v[148:151]
ds_read_b128 v[120:123], v3 offset:41472
v_cvt_pk_bf16_f32 v237, v218, v219
v_mfma_f32_16x16x32_bf16 v[152:155], v[72:75], v[60:63], v[152:155]
v_cvt_pk_bf16_f32 v238, v220, v221
ds_read_b64_tr_b16 v[174:175], v8 offset:38912
v_cvt_pk_bf16_f32 v239, v222, v223
v_mfma_f32_16x16x32_bf16 v[156:159], v[76:79], v[60:63], v[156:159]
buffer_store_dwordx4 v[236:239], v9, s[64:67], 0 offen offset:3072 sc1
ds_read_b128 v[124:127], v3 offset:41728
s_waitcnt lgkmcnt(0)
s_barrier
v_mfma_f32_16x16x32_bf16 v[128:131], v[160:163], v[96:99], v[128:131]
ds_read_b64_tr_b16 v[64:65], v5 offset:0
v_mfma_f32_16x16x32_bf16 v[132:135], v[164:167], v[96:99], v[132:135]
ds_read_b128 v[32:35], v2 offset:0
v_mfma_f32_16x16x32_bf16 v[136:139], v[160:163], v[100:103], v[136:139]
ds_read_b64_tr_b16 v[66:67], v5 offset:2048
v_mfma_f32_16x16x32_bf16 v[140:143], v[164:167], v[100:103], v[140:143]
ds_read_b128 v[36:39], v2 offset:256
v_mfma_f32_16x16x32_bf16 v[144:147], v[160:163], v[104:107], v[144:147]
ds_read_b64_tr_b16 v[68:69], v6 offset:0
v_mfma_f32_16x16x32_bf16 v[148:151], v[164:167], v[104:107], v[148:151]
ds_read_b128 v[40:43], v2 offset:512
v_mfma_f32_16x16x32_bf16 v[152:155], v[160:163], v[108:111], v[152:155]
ds_read_b64_tr_b16 v[70:71], v6 offset:2048
v_mfma_f32_16x16x32_bf16 v[156:159], v[164:167], v[108:111], v[156:159]
ds_read_b128 v[44:47], v2 offset:768
v_mfma_f32_16x16x32_bf16 v[128:131], v[168:171], v[112:115], v[128:131]
ds_read_b64_tr_b16 v[72:73], v5 offset:4096
v_mfma_f32_16x16x32_bf16 v[132:135], v[172:175], v[112:115], v[132:135]
ds_read_b128 v[48:51], v2 offset:8192
v_mfma_f32_16x16x32_bf16 v[136:139], v[168:171], v[116:119], v[136:139]
ds_read_b64_tr_b16 v[74:75], v5 offset:6144
v_mfma_f32_16x16x32_bf16 v[140:143], v[172:175], v[116:119], v[140:143]
ds_read_b128 v[52:55], v2 offset:8448
v_mfma_f32_16x16x32_bf16 v[144:147], v[168:171], v[120:123], v[144:147]
ds_read_b64_tr_b16 v[76:77], v6 offset:4096
v_mfma_f32_16x16x32_bf16 v[148:151], v[172:175], v[120:123], v[148:151]
ds_read_b128 v[56:59], v2 offset:8704
v_mfma_f32_16x16x32_bf16 v[152:155], v[168:171], v[124:127], v[152:155]
ds_read_b64_tr_b16 v[78:79], v6 offset:6144
v_mfma_f32_16x16x32_bf16 v[156:159], v[172:175], v[124:127], v[156:159]
ds_read_b128 v[60:63], v2 offset:8960
s_waitcnt lgkmcnt(0)
s_barrier
v_mfma_f32_16x16x32_bf16 v[128:131], v[64:67], v[32:35], v[128:131]
ds_read_b64_tr_b16 v[160:161], v5 offset:32768
v_mfma_f32_16x16x32_bf16 v[132:135], v[68:71], v[32:35], v[132:135]
ds_read_b128 v[96:99], v2 offset:32768
v_mfma_f32_16x16x32_bf16 v[136:139], v[64:67], v[36:39], v[136:139]
ds_read_b64_tr_b16 v[162:163], v5 offset:34816
v_mfma_f32_16x16x32_bf16 v[140:143], v[68:71], v[36:39], v[140:143]
ds_read_b128 v[100:103], v2 offset:33024
v_mfma_f32_16x16x32_bf16 v[144:147], v[64:67], v[40:43], v[144:147]
ds_read_b64_tr_b16 v[164:165], v6 offset:32768
v_mfma_f32_16x16x32_bf16 v[148:151], v[68:71], v[40:43], v[148:151]
ds_read_b128 v[104:107], v2 offset:33280
v_mfma_f32_16x16x32_bf16 v[152:155], v[64:67], v[44:47], v[152:155]
ds_read_b64_tr_b16 v[166:167], v6 offset:34816
v_mfma_f32_16x16x32_bf16 v[156:159], v[68:71], v[44:47], v[156:159]
ds_read_b128 v[108:111], v2 offset:33536
v_mfma_f32_16x16x32_bf16 v[128:131], v[72:75], v[48:51], v[128:131]
ds_read_b64_tr_b16 v[168:169], v5 offset:36864
v_mfma_f32_16x16x32_bf16 v[132:135], v[76:79], v[48:51], v[132:135]
ds_read_b128 v[112:115], v2 offset:40960
v_mfma_f32_16x16x32_bf16 v[136:139], v[72:75], v[52:55], v[136:139]
ds_read_b64_tr_b16 v[170:171], v5 offset:38912
v_mfma_f32_16x16x32_bf16 v[140:143], v[76:79], v[52:55], v[140:143]
ds_read_b128 v[116:119], v2 offset:41216
v_mfma_f32_16x16x32_bf16 v[144:147], v[72:75], v[56:59], v[144:147]
ds_read_b64_tr_b16 v[172:173], v6 offset:36864
v_mfma_f32_16x16x32_bf16 v[148:151], v[76:79], v[56:59], v[148:151]
ds_read_b128 v[120:123], v2 offset:41472
v_mfma_f32_16x16x32_bf16 v[152:155], v[72:75], v[60:63], v[152:155]
ds_read_b64_tr_b16 v[174:175], v6 offset:38912
v_mfma_f32_16x16x32_bf16 v[156:159], v[76:79], v[60:63], v[156:159]
ds_read_b128 v[124:127], v2 offset:41728
s_waitcnt vmcnt(0) lgkmcnt(0)
s_barrier
v_mfma_f32_16x16x32_bf16 v[128:131], v[160:163], v[96:99], v[128:131]
ds_read_b64_tr_b16 v[64:65], v7 offset:0
v_mfma_f32_16x16x32_bf16 v[132:135], v[164:167], v[96:99], v[132:135]
ds_read_b128 v[32:35], v3 offset:0
v_mfma_f32_16x16x32_bf16 v[136:139], v[160:163], v[100:103], v[136:139]
ds_read_b64_tr_b16 v[66:67], v7 offset:2048
v_mfma_f32_16x16x32_bf16 v[140:143], v[164:167], v[100:103], v[140:143]
ds_read_b128 v[36:39], v3 offset:256
v_mfma_f32_16x16x32_bf16 v[144:147], v[160:163], v[104:107], v[144:147]
ds_read_b64_tr_b16 v[68:69], v8 offset:0
v_mfma_f32_16x16x32_bf16 v[148:151], v[164:167], v[104:107], v[148:151]
ds_read_b128 v[40:43], v3 offset:512
v_mfma_f32_16x16x32_bf16 v[152:155], v[160:163], v[108:111], v[152:155]
ds_read_b64_tr_b16 v[70:71], v8 offset:2048
v_mfma_f32_16x16x32_bf16 v[156:159], v[164:167], v[108:111], v[156:159]
ds_read_b128 v[44:47], v3 offset:768
v_mfma_f32_16x16x32_bf16 v[128:131], v[168:171], v[112:115], v[128:131]
ds_read_b64_tr_b16 v[72:73], v7 offset:4096
v_mfma_f32_16x16x32_bf16 v[132:135], v[172:175], v[112:115], v[132:135]
ds_read_b128 v[48:51], v3 offset:8192
v_mfma_f32_16x16x32_bf16 v[136:139], v[168:171], v[116:119], v[136:139]
ds_read_b64_tr_b16 v[74:75], v7 offset:6144
v_mfma_f32_16x16x32_bf16 v[140:143], v[172:175], v[116:119], v[140:143]
ds_read_b128 v[52:55], v3 offset:8448
v_mfma_f32_16x16x32_bf16 v[144:147], v[168:171], v[120:123], v[144:147]
ds_read_b64_tr_b16 v[76:77], v8 offset:4096
v_mfma_f32_16x16x32_bf16 v[148:151], v[172:175], v[120:123], v[148:151]
ds_read_b128 v[56:59], v3 offset:8704
v_mfma_f32_16x16x32_bf16 v[152:155], v[168:171], v[124:127], v[152:155]
ds_read_b64_tr_b16 v[78:79], v8 offset:6144
v_mfma_f32_16x16x32_bf16 v[156:159], v[172:175], v[124:127], v[156:159]
ds_read_b128 v[60:63], v3 offset:8960
s_waitcnt lgkmcnt(0)
s_barrier
v_mfma_f32_16x16x32_bf16 v[128:131], v[64:67], v[32:35], v[128:131]
ds_read_b64_tr_b16 v[160:161], v7 offset:32768
v_mfma_f32_16x16x32_bf16 v[132:135], v[68:71], v[32:35], v[132:135]
ds_read_b128 v[96:99], v3 offset:32768
v_mfma_f32_16x16x32_bf16 v[136:139], v[64:67], v[36:39], v[136:139]
ds_read_b64_tr_b16 v[162:163], v7 offset:34816
v_mfma_f32_16x16x32_bf16 v[140:143], v[68:71], v[36:39], v[140:143]
ds_read_b128 v[100:103], v3 offset:33024
v_mfma_f32_16x16x32_bf16 v[144:147], v[64:67], v[40:43], v[144:147]
ds_read_b64_tr_b16 v[164:165], v8 offset:32768
v_mfma_f32_16x16x32_bf16 v[148:151], v[68:71], v[40:43], v[148:151]
ds_read_b128 v[104:107], v3 offset:33280
v_mfma_f32_16x16x32_bf16 v[152:155], v[64:67], v[44:47], v[152:155]
ds_read_b64_tr_b16 v[166:167], v8 offset:34816
v_mfma_f32_16x16x32_bf16 v[156:159], v[68:71], v[44:47], v[156:159]
ds_read_b128 v[108:111], v3 offset:33536
v_mfma_f32_16x16x32_bf16 v[128:131], v[72:75], v[48:51], v[128:131]
ds_read_b64_tr_b16 v[168:169], v7 offset:36864
v_mfma_f32_16x16x32_bf16 v[132:135], v[76:79], v[48:51], v[132:135]
ds_read_b128 v[112:115], v3 offset:40960
v_mfma_f32_16x16x32_bf16 v[136:139], v[72:75], v[52:55], v[136:139]
ds_read_b64_tr_b16 v[170:171], v7 offset:38912
v_mfma_f32_16x16x32_bf16 v[140:143], v[76:79], v[52:55], v[140:143]
ds_read_b128 v[116:119], v3 offset:41216
v_mfma_f32_16x16x32_bf16 v[144:147], v[72:75], v[56:59], v[144:147]
ds_read_b64_tr_b16 v[172:173], v8 offset:36864
v_mfma_f32_16x16x32_bf16 v[148:151], v[76:79], v[56:59], v[148:151]
ds_read_b128 v[120:123], v3 offset:41472
v_mfma_f32_16x16x32_bf16 v[152:155], v[72:75], v[60:63], v[152:155]
ds_read_b64_tr_b16 v[174:175], v8 offset:38912
v_mfma_f32_16x16x32_bf16 v[156:159], v[76:79], v[60:63], v[156:159]
ds_read_b128 v[124:127], v3 offset:41728
s_waitcnt lgkmcnt(0)
s_barrier
v_mfma_f32_16x16x32_bf16 v[128:131], v[160:163], v[96:99], v[128:131]
ds_read_b64_tr_b16 v[64:65], v5 offset:0
v_mfma_f32_16x16x32_bf16 v[132:135], v[164:167], v[96:99], v[132:135]
ds_read_b128 v[32:35], v2 offset:0
v_mfma_f32_16x16x32_bf16 v[136:139], v[160:163], v[100:103], v[136:139]
ds_read_b64_tr_b16 v[66:67], v5 offset:2048
v_mfma_f32_16x16x32_bf16 v[140:143], v[164:167], v[100:103], v[140:143]
ds_read_b128 v[36:39], v2 offset:256
v_mfma_f32_16x16x32_bf16 v[144:147], v[160:163], v[104:107], v[144:147]
ds_read_b64_tr_b16 v[68:69], v6 offset:0
v_mfma_f32_16x16x32_bf16 v[148:151], v[164:167], v[104:107], v[148:151]
ds_read_b128 v[40:43], v2 offset:512
v_mfma_f32_16x16x32_bf16 v[152:155], v[160:163], v[108:111], v[152:155]
ds_read_b64_tr_b16 v[70:71], v6 offset:2048
v_mfma_f32_16x16x32_bf16 v[156:159], v[164:167], v[108:111], v[156:159]
ds_read_b128 v[44:47], v2 offset:768
v_mfma_f32_16x16x32_bf16 v[128:131], v[168:171], v[112:115], v[128:131]
ds_read_b64_tr_b16 v[72:73], v5 offset:4096
v_mfma_f32_16x16x32_bf16 v[132:135], v[172:175], v[112:115], v[132:135]
ds_read_b128 v[48:51], v2 offset:8192
v_mfma_f32_16x16x32_bf16 v[136:139], v[168:171], v[116:119], v[136:139]
ds_read_b64_tr_b16 v[74:75], v5 offset:6144
v_mfma_f32_16x16x32_bf16 v[140:143], v[172:175], v[116:119], v[140:143]
ds_read_b128 v[52:55], v2 offset:8448
v_mfma_f32_16x16x32_bf16 v[144:147], v[168:171], v[120:123], v[144:147]
ds_read_b64_tr_b16 v[76:77], v6 offset:4096
v_mfma_f32_16x16x32_bf16 v[148:151], v[172:175], v[120:123], v[148:151]
ds_read_b128 v[56:59], v2 offset:8704
v_mfma_f32_16x16x32_bf16 v[152:155], v[168:171], v[124:127], v[152:155]
ds_read_b64_tr_b16 v[78:79], v6 offset:6144
v_mfma_f32_16x16x32_bf16 v[156:159], v[172:175], v[124:127], v[156:159]
ds_read_b128 v[60:63], v2 offset:8960
s_waitcnt lgkmcnt(0)
s_barrier
v_mfma_f32_16x16x32_bf16 v[128:131], v[64:67], v[32:35], v[128:131]
ds_read_b64_tr_b16 v[160:161], v5 offset:32768
v_mfma_f32_16x16x32_bf16 v[132:135], v[68:71], v[32:35], v[132:135]
ds_read_b128 v[96:99], v2 offset:32768
v_mfma_f32_16x16x32_bf16 v[136:139], v[64:67], v[36:39], v[136:139]
ds_read_b64_tr_b16 v[162:163], v5 offset:34816
v_mfma_f32_16x16x32_bf16 v[140:143], v[68:71], v[36:39], v[140:143]
ds_read_b128 v[100:103], v2 offset:33024
v_mfma_f32_16x16x32_bf16 v[144:147], v[64:67], v[40:43], v[144:147]
ds_read_b64_tr_b16 v[164:165], v6 offset:32768
v_mfma_f32_16x16x32_bf16 v[148:151], v[68:71], v[40:43], v[148:151]
ds_read_b128 v[104:107], v2 offset:33280
v_mfma_f32_16x16x32_bf16 v[152:155], v[64:67], v[44:47], v[152:155]
ds_read_b64_tr_b16 v[166:167], v6 offset:34816
v_mfma_f32_16x16x32_bf16 v[156:159], v[68:71], v[44:47], v[156:159]
ds_read_b128 v[108:111], v2 offset:33536
v_mfma_f32_16x16x32_bf16 v[128:131], v[72:75], v[48:51], v[128:131]
ds_read_b64_tr_b16 v[168:169], v5 offset:36864
v_mfma_f32_16x16x32_bf16 v[132:135], v[76:79], v[48:51], v[132:135]
ds_read_b128 v[112:115], v2 offset:40960
v_mfma_f32_16x16x32_bf16 v[136:139], v[72:75], v[52:55], v[136:139]
ds_read_b64_tr_b16 v[170:171], v5 offset:38912
v_mfma_f32_16x16x32_bf16 v[140:143], v[76:79], v[52:55], v[140:143]
ds_read_b128 v[116:119], v2 offset:41216
v_mfma_f32_16x16x32_bf16 v[144:147], v[72:75], v[56:59], v[144:147]
ds_read_b64_tr_b16 v[172:173], v6 offset:36864
v_mfma_f32_16x16x32_bf16 v[148:151], v[76:79], v[56:59], v[148:151]
ds_read_b128 v[120:123], v2 offset:41472
v_mfma_f32_16x16x32_bf16 v[152:155], v[72:75], v[60:63], v[152:155]
ds_read_b64_tr_b16 v[174:175], v6 offset:38912
v_mfma_f32_16x16x32_bf16 v[156:159], v[76:79], v[60:63], v[156:159]
ds_read_b128 v[124:127], v2 offset:41728
s_waitcnt lgkmcnt(0)
s_barrier
v_mfma_f32_16x16x32_bf16 v[128:131], v[160:163], v[96:99], v[128:131]
ds_read_b64_tr_b16 v[64:65], v7 offset:0
v_mfma_f32_16x16x32_bf16 v[132:135], v[164:167], v[96:99], v[132:135]
ds_read_b128 v[32:35], v3 offset:0
v_mfma_f32_16x16x32_bf16 v[136:139], v[160:163], v[100:103], v[136:139]
ds_read_b64_tr_b16 v[66:67], v7 offset:2048
v_mfma_f32_16x16x32_bf16 v[140:143], v[164:167], v[100:103], v[140:143]
ds_read_b128 v[36:39], v3 offset:256
v_mfma_f32_16x16x32_bf16 v[144:147], v[160:163], v[104:107], v[144:147]
ds_read_b64_tr_b16 v[68:69], v8 offset:0
v_mfma_f32_16x16x32_bf16 v[148:151], v[164:167], v[104:107], v[148:151]
ds_read_b128 v[40:43], v3 offset:512
v_mfma_f32_16x16x32_bf16 v[152:155], v[160:163], v[108:111], v[152:155]
ds_read_b64_tr_b16 v[70:71], v8 offset:2048
v_mfma_f32_16x16x32_bf16 v[156:159], v[164:167], v[108:111], v[156:159]
ds_read_b128 v[44:47], v3 offset:768
v_mfma_f32_16x16x32_bf16 v[128:131], v[168:171], v[112:115], v[128:131]
ds_read_b64_tr_b16 v[72:73], v7 offset:4096
v_mfma_f32_16x16x32_bf16 v[132:135], v[172:175], v[112:115], v[132:135]
ds_read_b128 v[48:51], v3 offset:8192
v_mfma_f32_16x16x32_bf16 v[136:139], v[168:171], v[116:119], v[136:139]
ds_read_b64_tr_b16 v[74:75], v7 offset:6144
v_mfma_f32_16x16x32_bf16 v[140:143], v[172:175], v[116:119], v[140:143]
ds_read_b128 v[52:55], v3 offset:8448
v_mfma_f32_16x16x32_bf16 v[144:147], v[168:171], v[120:123], v[144:147]
ds_read_b64_tr_b16 v[76:77], v8 offset:4096
v_mfma_f32_16x16x32_bf16 v[148:151], v[172:175], v[120:123], v[148:151]
ds_read_b128 v[56:59], v3 offset:8704
v_mfma_f32_16x16x32_bf16 v[152:155], v[168:171], v[124:127], v[152:155]
ds_read_b64_tr_b16 v[78:79], v8 offset:6144
v_mfma_f32_16x16x32_bf16 v[156:159], v[172:175], v[124:127], v[156:159]
ds_read_b128 v[60:63], v3 offset:8960
s_waitcnt lgkmcnt(0)
s_barrier
v_mfma_f32_16x16x32_bf16 v[128:131], v[64:67], v[32:35], v[128:131]
ds_read_b64_tr_b16 v[160:161], v7 offset:32768
v_mfma_f32_16x16x32_bf16 v[132:135], v[68:71], v[32:35], v[132:135]
ds_read_b128 v[96:99], v3 offset:32768
v_mfma_f32_16x16x32_bf16 v[136:139], v[64:67], v[36:39], v[136:139]
ds_read_b64_tr_b16 v[162:163], v7 offset:34816
v_mfma_f32_16x16x32_bf16 v[140:143], v[68:71], v[36:39], v[140:143]
ds_read_b128 v[100:103], v3 offset:33024
v_mfma_f32_16x16x32_bf16 v[144:147], v[64:67], v[40:43], v[144:147]
ds_read_b64_tr_b16 v[164:165], v8 offset:32768
v_mfma_f32_16x16x32_bf16 v[148:151], v[68:71], v[40:43], v[148:151]
ds_read_b128 v[104:107], v3 offset:33280
v_mfma_f32_16x16x32_bf16 v[152:155], v[64:67], v[44:47], v[152:155]
ds_read_b64_tr_b16 v[166:167], v8 offset:34816
v_mfma_f32_16x16x32_bf16 v[156:159], v[68:71], v[44:47], v[156:159]
ds_read_b128 v[108:111], v3 offset:33536
v_mfma_f32_16x16x32_bf16 v[128:131], v[72:75], v[48:51], v[128:131]
ds_read_b64_tr_b16 v[168:169], v7 offset:36864
v_mfma_f32_16x16x32_bf16 v[132:135], v[76:79], v[48:51], v[132:135]
ds_read_b128 v[112:115], v3 offset:40960
v_mfma_f32_16x16x32_bf16 v[136:139], v[72:75], v[52:55], v[136:139]
ds_read_b64_tr_b16 v[170:171], v7 offset:38912
v_mfma_f32_16x16x32_bf16 v[140:143], v[76:79], v[52:55], v[140:143]
ds_read_b128 v[116:119], v3 offset:41216
v_mfma_f32_16x16x32_bf16 v[144:147], v[72:75], v[56:59], v[144:147]
ds_read_b64_tr_b16 v[172:173], v8 offset:36864
v_mfma_f32_16x16x32_bf16 v[148:151], v[76:79], v[56:59], v[148:151]
ds_read_b128 v[120:123], v3 offset:41472
v_mfma_f32_16x16x32_bf16 v[152:155], v[72:75], v[60:63], v[152:155]
ds_read_b64_tr_b16 v[174:175], v8 offset:38912
v_mfma_f32_16x16x32_bf16 v[156:159], v[76:79], v[60:63], v[156:159]
ds_read_b128 v[124:127], v3 offset:41728
s_waitcnt lgkmcnt(0)
s_barrier
v_mfma_f32_16x16x32_bf16 v[128:131], v[160:163], v[96:99], v[128:131]
ds_read_b64_tr_b16 v[64:65], v5 offset:0
v_mfma_f32_16x16x32_bf16 v[132:135], v[164:167], v[96:99], v[132:135]
ds_read_b128 v[32:35], v2 offset:0
v_mfma_f32_16x16x32_bf16 v[136:139], v[160:163], v[100:103], v[136:139]
ds_read_b64_tr_b16 v[66:67], v5 offset:2048
v_mfma_f32_16x16x32_bf16 v[140:143], v[164:167], v[100:103], v[140:143]
ds_read_b128 v[36:39], v2 offset:256
buffer_load_dwordx4 v[192:195], v9, s[68:71], 0 offen offset:0 sc1
v_mfma_f32_16x16x32_bf16 v[144:147], v[160:163], v[104:107], v[144:147]
ds_read_b64_tr_b16 v[68:69], v6 offset:0
v_mfma_f32_16x16x32_bf16 v[148:151], v[164:167], v[104:107], v[148:151]
ds_read_b128 v[40:43], v2 offset:512
v_mfma_f32_16x16x32_bf16 v[152:155], v[160:163], v[108:111], v[152:155]
ds_read_b64_tr_b16 v[70:71], v6 offset:2048
buffer_load_dwordx4 v[196:199], v9, s[68:71], 0 offen offset:1024 sc1
v_mfma_f32_16x16x32_bf16 v[156:159], v[164:167], v[108:111], v[156:159]
ds_read_b128 v[44:47], v2 offset:768
v_mfma_f32_16x16x32_bf16 v[128:131], v[168:171], v[112:115], v[128:131]
ds_read_b64_tr_b16 v[72:73], v5 offset:4096
v_mfma_f32_16x16x32_bf16 v[132:135], v[172:175], v[112:115], v[132:135]
ds_read_b128 v[48:51], v2 offset:8192
buffer_load_dwordx4 v[200:203], v9, s[68:71], 0 offen offset:2048 sc1
v_mfma_f32_16x16x32_bf16 v[136:139], v[168:171], v[116:119], v[136:139]
ds_read_b64_tr_b16 v[74:75], v5 offset:6144
v_mfma_f32_16x16x32_bf16 v[140:143], v[172:175], v[116:119], v[140:143]
ds_read_b128 v[52:55], v2 offset:8448
v_mfma_f32_16x16x32_bf16 v[144:147], v[168:171], v[120:123], v[144:147]
ds_read_b64_tr_b16 v[76:77], v6 offset:4096
buffer_load_dwordx4 v[204:207], v9, s[68:71], 0 offen offset:3072 sc1
v_mfma_f32_16x16x32_bf16 v[148:151], v[172:175], v[120:123], v[148:151]
ds_read_b128 v[56:59], v2 offset:8704
v_mfma_f32_16x16x32_bf16 v[152:155], v[168:171], v[124:127], v[152:155]
ds_read_b64_tr_b16 v[78:79], v6 offset:6144
v_mfma_f32_16x16x32_bf16 v[156:159], v[172:175], v[124:127], v[156:159]
ds_read_b128 v[60:63], v2 offset:8960
s_waitcnt lgkmcnt(0)
s_barrier
v_mfma_f32_16x16x32_bf16 v[128:131], v[64:67], v[32:35], v[128:131]
ds_read_b64_tr_b16 v[160:161], v5 offset:32768
v_mfma_f32_16x16x32_bf16 v[132:135], v[68:71], v[32:35], v[132:135]
ds_read_b128 v[96:99], v2 offset:32768
v_mfma_f32_16x16x32_bf16 v[136:139], v[64:67], v[36:39], v[136:139]
ds_read_b64_tr_b16 v[162:163], v5 offset:34816
v_mfma_f32_16x16x32_bf16 v[140:143], v[68:71], v[36:39], v[140:143]
ds_read_b128 v[100:103], v2 offset:33024
v_mfma_f32_16x16x32_bf16 v[144:147], v[64:67], v[40:43], v[144:147]
ds_read_b64_tr_b16 v[164:165], v6 offset:32768
v_mfma_f32_16x16x32_bf16 v[148:151], v[68:71], v[40:43], v[148:151]
ds_read_b128 v[104:107], v2 offset:33280
v_mfma_f32_16x16x32_bf16 v[152:155], v[64:67], v[44:47], v[152:155]
ds_read_b64_tr_b16 v[166:167], v6 offset:34816
v_mfma_f32_16x16x32_bf16 v[156:159], v[68:71], v[44:47], v[156:159]
ds_read_b128 v[108:111], v2 offset:33536
v_mfma_f32_16x16x32_bf16 v[128:131], v[72:75], v[48:51], v[128:131]
ds_read_b64_tr_b16 v[168:169], v5 offset:36864
v_mfma_f32_16x16x32_bf16 v[132:135], v[76:79], v[48:51], v[132:135]
ds_read_b128 v[112:115], v2 offset:40960
v_mfma_f32_16x16x32_bf16 v[136:139], v[72:75], v[52:55], v[136:139]
ds_read_b64_tr_b16 v[170:171], v5 offset:38912
v_mfma_f32_16x16x32_bf16 v[140:143], v[76:79], v[52:55], v[140:143]
ds_read_b128 v[116:119], v2 offset:41216
v_mfma_f32_16x16x32_bf16 v[144:147], v[72:75], v[56:59], v[144:147]
ds_read_b64_tr_b16 v[172:173], v6 offset:36864
v_mfma_f32_16x16x32_bf16 v[148:151], v[76:79], v[56:59], v[148:151]
ds_read_b128 v[120:123], v2 offset:41472
v_mfma_f32_16x16x32_bf16 v[152:155], v[72:75], v[60:63], v[152:155]
ds_read_b64_tr_b16 v[174:175], v6 offset:38912
v_mfma_f32_16x16x32_bf16 v[156:159], v[76:79], v[60:63], v[156:159]
ds_read_b128 v[124:127], v2 offset:41728
s_waitcnt lgkmcnt(0)
s_barrier
v_mfma_f32_16x16x32_bf16 v[128:131], v[160:163], v[96:99], v[128:131]
v_mfma_f32_16x16x32_bf16 v[132:135], v[164:167], v[96:99], v[132:135]
v_mfma_f32_16x16x32_bf16 v[136:139], v[160:163], v[100:103], v[136:139]
v_mfma_f32_16x16x32_bf16 v[140:143], v[164:167], v[100:103], v[140:143]
v_mfma_f32_16x16x32_bf16 v[144:147], v[160:163], v[104:107], v[144:147]
v_mfma_f32_16x16x32_bf16 v[148:151], v[164:167], v[104:107], v[148:151]
v_mfma_f32_16x16x32_bf16 v[152:155], v[160:163], v[108:111], v[152:155]
v_mfma_f32_16x16x32_bf16 v[156:159], v[164:167], v[108:111], v[156:159]
s_waitcnt vmcnt(0)
v_mfma_f32_16x16x32_bf16 v[128:131], v[168:171], v[112:115], v[128:131]
v_lshlrev_b32 v224, 16, v192
v_and_b32 v225, 0xffff0000, v192
v_lshlrev_b32 v226, 16, v193
v_and_b32 v227, 0xffff0000, v193
v_mfma_f32_16x16x32_bf16 v[132:135], v[172:175], v[112:115], v[132:135]
v_lshlrev_b32 v228, 16, v194
v_and_b32 v229, 0xffff0000, v194
v_lshlrev_b32 v230, 16, v195
v_and_b32 v231, 0xffff0000, v195
v_mfma_f32_16x16x32_bf16 v[136:139], v[168:171], v[116:119], v[136:139]
v_lshlrev_b32 v232, 16, v196
v_and_b32 v233, 0xffff0000, v196
v_lshlrev_b32 v234, 16, v197
v_and_b32 v235, 0xffff0000, v197
v_mfma_f32_16x16x32_bf16 v[140:143], v[172:175], v[116:119], v[140:143]
v_lshlrev_b32 v236, 16, v198
v_and_b32 v237, 0xffff0000, v198
v_lshlrev_b32 v238, 16, v199
v_and_b32 v239, 0xffff0000, v199
v_mfma_f32_16x16x32_bf16 v[144:147], v[168:171], v[120:123], v[144:147]
v_lshlrev_b32 v240, 16, v200
v_and_b32 v241, 0xffff0000, v200
v_lshlrev_b32 v242, 16, v201
v_and_b32 v243, 0xffff0000, v201
v_mfma_f32_16x16x32_bf16 v[148:151], v[172:175], v[120:123], v[148:151]
v_lshlrev_b32 v244, 16, v202
v_and_b32 v245, 0xffff0000, v202
v_lshlrev_b32 v246, 16, v203
v_and_b32 v247, 0xffff0000, v203
v_mfma_f32_16x16x32_bf16 v[152:155], v[168:171], v[124:127], v[152:155]
v_lshlrev_b32 v248, 16, v204
v_and_b32 v249, 0xffff0000, v204
v_lshlrev_b32 v250, 16, v205
v_and_b32 v251, 0xffff0000, v205
v_mfma_f32_16x16x32_bf16 v[156:159], v[172:175], v[124:127], v[156:159]
v_lshlrev_b32 v252, 16, v206
v_and_b32 v253, 0xffff0000, v206
v_lshlrev_b32 v254, 16, v207
v_and_b32 v255, 0xffff0000, v207
s_waitcnt vmcnt(0)
s_nop 4
v_pk_add_f32 v[128:129], v[128:129], v[224:225]
v_pk_add_f32 v[130:131], v[130:131], v[226:227]
v_pk_add_f32 v[132:133], v[132:133], v[228:229]
v_pk_add_f32 v[134:135], v[134:135], v[230:231]
v_cvt_pk_bf16_f32 v32, v128, v129
v_cvt_pk_bf16_f32 v33, v130, v131
v_cvt_pk_bf16_f32 v34, v132, v133
v_cvt_pk_bf16_f32 v35, v134, v135
v_pk_add_f32 v[136:137], v[136:137], v[232:233]
v_pk_add_f32 v[138:139], v[138:139], v[234:235]
v_pk_add_f32 v[140:141], v[140:141], v[236:237]
v_pk_add_f32 v[142:143], v[142:143], v[238:239]
v_cvt_pk_bf16_f32 v36, v136, v137
v_cvt_pk_bf16_f32 v37, v138, v139
v_cvt_pk_bf16_f32 v38, v140, v141
v_cvt_pk_bf16_f32 v39, v142, v143
v_pk_add_f32 v[144:145], v[144:145], v[240:241]
v_pk_add_f32 v[146:147], v[146:147], v[242:243]
v_pk_add_f32 v[148:149], v[148:149], v[244:245]
v_pk_add_f32 v[150:151], v[150:151], v[246:247]
v_cvt_pk_bf16_f32 v40, v144, v145
v_cvt_pk_bf16_f32 v41, v146, v147
v_cvt_pk_bf16_f32 v42, v148, v149
v_cvt_pk_bf16_f32 v43, v150, v151
v_pk_add_f32 v[152:153], v[152:153], v[248:249]
v_pk_add_f32 v[154:155], v[154:155], v[250:251]
v_pk_add_f32 v[156:157], v[156:157], v[252:253]
v_pk_add_f32 v[158:159], v[158:159], v[254:255]
v_cvt_pk_bf16_f32 v44, v152, v153
v_cvt_pk_bf16_f32 v45, v154, v155
v_cvt_pk_bf16_f32 v46, v156, v157
v_cvt_pk_bf16_f32 v47, v158, v159
v_permlane16_swap_b32 v32, v34
v_permlane16_swap_b32 v33, v35
buffer_store_dwordx4 v[32:35], v28, s[16:19], 0 offen offset:0
v_permlane16_swap_b32 v36, v38
v_permlane16_swap_b32 v37, v39
buffer_store_dwordx4 v[36:39], v28, s[16:19], 0 offen offset:2048
v_permlane16_swap_b32 v40, v42
v_permlane16_swap_b32 v41, v43
buffer_store_dwordx4 v[40:43], v28, s[16:19], s54 offen offset:0
v_permlane16_swap_b32 v44, v46
v_permlane16_swap_b32 v45, v47
buffer_store_dwordx4 v[44:47], v28, s[16:19], s54 offen offset:2048
s_branch Ldone_1
.p2align 6
Lw_23:
s_branch Lr_24
s_nop 0
.p2align 3
LG1_46:
s_cmp_eq_u32 s36, 7
s_cbranch_scc1 L7_99
s_mul_i32 s44, s34, 262144
s_lshl_b32 s39, s51, 13
s_add_u32 s44, s44, s39
s_add_u32 s44, s44, 0
s_lshl_b32 s43, s35, 7
s_mov_b32 s10, 253952
s_movk_i32 s38, 1024
s_movk_i32 s40, 9216
s_cmp_eq_u32 s51, 2
s_cselect_b32 s8, s28, s32
s_cselect_b32 s9, s29, s33
s_cselect_b32 s10, 2095232, s10
s_cselect_b32 s43, s43, s44
s_cselect_b32 s38, 16384, s38
s_cselect_b32 s40, 16384, s40
s_cselect_b32 s55, 16384, s38
s_cselect_b32 s45, -1, 0
s_add_u32 s8, s8, s43
s_addc_u32 s9, s9, 0
s_mov_b32 s11, 0x20000
s_sub_u32 s37, 0, s40
v_lshrrev_b32 v19, 3, v1
v_mul_u32_u24 v19, 1920, v19
v_lshrrev_b32 v20, 4, v1
v_lshlrev_b32 v20, 5, v20
v_and_b32 v19, s45, v19
v_and_b32 v20, s45, v20
v_lshlrev_b32 v23, 4, v1
v_xor_b32 v23, v23, v20
v_add_u32 v23, v23, v19
s_lshl_b32 s43, s34, 18
s_add_u32 s12, s32, s43
s_addc_u32 s13, s33, 0
s_mov_b32 s14, 262144
s_mov_b32 s15, 0x20000
v_lshlrev_b32 v21, 4, v1
s_lshl_b32 s54, s36, 11
s_add_u32 s43, s35, 1
s_and_b32 s43, s43, 15
s_lshl_b32 s43, s43, 14
s_add_u32 s30, s43, s54
s_add_u32 s43, s35, 2
s_and_b32 s43, s43, 15
s_lshl_b32 s43, s43, 14
s_add_u32 s31, s43, s54
s_cmp_eq_u32 s51, 1
s_cbranch_scc1 Lp_103
s_cmp_eq_u32 s51, 2
s_cbranch_scc1 Lp_104
.p2align 3
Lp_102:
s_add_u32 s42, s35, 2
s_waitcnt vmcnt(0)
s_barrier
ds_write_b128 v27, v[68:71] offset:0
ds_write_b128 v27, v[116:119] offset:512
s_add_u32 s43, s34, 0
s_lshl_b32 s43, s43, 7
v_mov_b32 v8, s43
v_mov_b32 v10, 16
buffer_load_dword v9, v8, s[56:59], 0 offen sc1
s_mov_b32 s41, 0x10000
Lpoll_105:
s_waitcnt vmcnt(0)
Lpf_107:
v_cmp_ne_u32 vcc, v10, v9
s_nop 4
s_cbranch_vccz Lpok_106
buffer_load_dword v9, v8, s[56:59], 0 offen sc1
s_sub_u32 s41, s41, 1
s_cmp_lg_u32 s41, 0
s_cbranch_scc1 Lpoll_105
s_waitcnt vmcnt(0)
Lpok_106:
s_waitcnt lgkmcnt(0)
s_barrier
s_add_u32 m0, s54, 16384
s_add_u32 s43, s30, 0
buffer_load_dwordx4 v21, s[12:15], s43 offen sc1 lds
s_add_u32 m0, s54, 17408
s_add_u32 s43, s30, 1024
buffer_load_dwordx4 v21, s[12:15], s43 offen sc1 lds
s_add_u32 m0, s54, 32768
s_add_u32 s43, s31, 0
buffer_load_dwordx4 v21, s[12:15], s43 offen sc1 lds
s_add_u32 m0, s54, 33792
s_add_u32 s43, s31, 1024
buffer_load_dwordx4 v21, s[12:15], s43 offen sc1 lds
s_add_u32 s42, s42, 1
s_and_b32 s42, s42, 15
s_add_u32 m0, s39, 49152
s_lshl_b32 s37, s42, 14
buffer_load_dwordx4 v23, s[8:11], s37 offen sc1 lds
s_add_u32 m0, s39, 50176
s_add_u32 s37, s37, s38
buffer_load_dwordx4 v23, s[8:11], s37 offen sc1 lds
s_add_u32 m0, s39, 51200
s_add_u32 s37, s37, s38
buffer_load_dwordx4 v23, s[8:11], s37 offen sc1 lds
s_add_u32 m0, s39, 52224
s_add_u32 s37, s37, s38
buffer_load_dwordx4 v23, s[8:11], s37 offen sc1 lds
s_add_u32 m0, s39, 53248
s_add_u32 s37, s37, s38
buffer_load_dwordx4 v23, s[8:11], s37 offen sc1 lds
s_add_u32 m0, s39, 54272
s_add_u32 s37, s37, s38
buffer_load_dwordx4 v23, s[8:11], s37 offen sc1 lds
s_add_u32 m0, s39, 55296
s_add_u32 s37, s37, s38
buffer_load_dwordx4 v23, s[8:11], s37 offen sc1 lds
s_add_u32 m0, s39, 56320
s_add_u32 s37, s37, s38
buffer_load_dwordx4 v23, s[8:11], s37 offen sc1 lds
s_waitcnt vmcnt(10)
s_barrier
s_add_u32 s42, s42, 1
s_and_b32 s42, s42, 15
s_add_u32 m0, s39, 0
s_lshl_b32 s37, s42, 14
buffer_load_dwordx4 v23, s[8:11], s37 offen sc1 lds
s_add_u32 m0, s39, 1024
s_add_u32 s37, s37, s38
buffer_load_dwordx4 v23, s[8:11], s37 offen sc1 lds
s_add_u32 m0, s39, 2048
s_add_u32 s37, s37, s38
buffer_load_dwordx4 v23, s[8:11], s37 offen sc1 lds
s_add_u32 m0, s39, 3072
s_add_u32 s37, s37, s38
buffer_load_dwordx4 v23, s[8:11], s37 offen sc1 lds
s_add_u32 m0, s39, 4096
s_add_u32 s37, s37, s38
buffer_load_dwordx4 v23, s[8:11], s37 offen sc1 lds
s_add_u32 m0, s39, 5120
s_add_u32 s37, s37, s38
buffer_load_dwordx4 v23, s[8:11], s37 offen sc1 lds
s_add_u32 m0, s39, 6144
s_add_u32 s37, s37, s38
buffer_load_dwordx4 v23, s[8:11], s37 offen sc1 lds
s_add_u32 m0, s39, 7168
s_add_u32 s37, s37, s38
buffer_load_dwordx4 v23, s[8:11], s37 offen sc1 lds
s_waitcnt vmcnt(16)
s_barrier
s_add_u32 s42, s42, 1
s_and_b32 s42, s42, 15
s_add_u32 m0, s39, 16384
s_lshl_b32 s37, s42, 14
buffer_load_dwordx4 v23, s[8:11], s37 offen sc1 lds
s_add_u32 m0, s39, 17408
s_add_u32 s37, s37, s38
buffer_load_dwordx4 v23, s[8:11], s37 offen sc1 lds
s_add_u32 m0, s39, 18432
s_add_u32 s37, s37, s38
buffer_load_dwordx4 v23, s[8:11], s37 offen sc1 lds
s_add_u32 m0, s39, 19456
s_add_u32 s37, s37, s38
buffer_load_dwordx4 v23, s[8:11], s37 offen sc1 lds
s_add_u32 m0, s39, 20480
s_add_u32 s37, s37, s38
buffer_load_dwordx4 v23, s[8:11], s37 offen sc1 lds
s_add_u32 m0, s39, 21504
s_add_u32 s37, s37, s38
buffer_load_dwordx4 v23, s[8:11], s37 offen sc1 lds
s_add_u32 m0, s39, 22528
s_add_u32 s37, s37, s38
buffer_load_dwordx4 v23, s[8:11], s37 offen sc1 lds
s_add_u32 m0, s39, 23552
s_add_u32 s37, s37, s38
buffer_load_dwordx4 v23, s[8:11], s37 offen sc1 lds
s_waitcnt vmcnt(16)
s_barrier
s_add_u32 s42, s42, 1
s_and_b32 s42, s42, 15
s_add_u32 m0, s39, 32768
s_lshl_b32 s37, s42, 14
buffer_load_dwordx4 v23, s[8:11], s37 offen sc1 lds
s_add_u32 m0, s39, 33792
s_add_u32 s37, s37, s38
buffer_load_dwordx4 v23, s[8:11], s37 offen sc1 lds
s_add_u32 m0, s39, 34816
s_add_u32 s37, s37, s38
buffer_load_dwordx4 v23, s[8:11], s37 offen sc1 lds
s_add_u32 m0, s39, 35840
s_add_u32 s37, s37, s38
buffer_load_dwordx4 v23, s[8:11], s37 offen sc1 lds
s_add_u32 m0, s39, 36864
s_add_u32 s37, s37, s38
buffer_load_dwordx4 v23, s[8:11], s37 offen sc1 lds
s_add_u32 m0, s39, 37888
s_add_u32 s37, s37, s38
buffer_load_dwordx4 v23, s[8:11], s37 offen sc1 lds
s_add_u32 m0, s39, 38912
s_add_u32 s37, s37, s38
buffer_load_dwordx4 v23, s[8:11], s37 offen sc1 lds
s_add_u32 m0, s39, 39936
s_add_u32 s37, s37, s38
buffer_load_dwordx4 v23, s[8:11], s37 offen sc1 lds
s_waitcnt vmcnt(16)
s_barrier
s_add_u32 s42, s42, 1
s_and_b32 s42, s42, 15
s_add_u32 m0, s39, 49152
s_lshl_b32 s37, s42, 14
buffer_load_dwordx4 v23, s[8:11], s37 offen sc1 lds
s_add_u32 m0, s39, 50176
s_add_u32 s37, s37, s38
buffer_load_dwordx4 v23, s[8:11], s37 offen sc1 lds
s_add_u32 m0, s39, 51200
s_add_u32 s37, s37, s38
buffer_load_dwordx4 v23, s[8:11], s37 offen sc1 lds
s_add_u32 m0, s39, 52224
s_add_u32 s37, s37, s38
buffer_load_dwordx4 v23, s[8:11], s37 offen sc1 lds
s_add_u32 m0, s39, 53248
s_add_u32 s37, s37, s38
buffer_load_dwordx4 v23, s[8:11], s37 offen sc1 lds
s_add_u32 m0, s39, 54272
s_add_u32 s37, s37, s38
buffer_load_dwordx4 v23, s[8:11], s37 offen sc1 lds
s_add_u32 m0, s39, 55296
s_add_u32 s37, s37, s38
buffer_load_dwordx4 v23, s[8:11], s37 offen sc1 lds
s_add_u32 m0, s39, 56320
s_add_u32 s37, s37, s38
buffer_load_dwordx4 v23, s[8:11], s37 offen sc1 lds
s_waitcnt vmcnt(16)
s_barrier
s_add_u32 s42, s42, 1
s_and_b32 s42, s42, 15
s_add_u32 m0, s39, 0
s_lshl_b32 s37, s42, 14
buffer_load_dwordx4 v23, s[8:11], s37 offen sc1 lds
s_add_u32 m0, s39, 1024
s_add_u32 s37, s37, s38
buffer_load_dwordx4 v23, s[8:11], s37 offen sc1 lds
s_add_u32 m0, s39, 2048
s_add_u32 s37, s37, s38
buffer_load_dwordx4 v23, s[8:11], s37 offen sc1 lds
s_add_u32 m0, s39, 3072
s_add_u32 s37, s37, s38
buffer_load_dwordx4 v23, s[8:11], s37 offen sc1 lds
s_add_u32 m0, s39, 4096
s_add_u32 s37, s37, s38
buffer_load_dwordx4 v23, s[8:11], s37 offen sc1 lds
s_add_u32 m0, s39, 5120
s_add_u32 s37, s37, s38
buffer_load_dwordx4 v23, s[8:11], s37 offen sc1 lds
s_add_u32 m0, s39, 6144
s_add_u32 s37, s37, s38
buffer_load_dwordx4 v23, s[8:11], s37 offen sc1 lds
s_add_u32 m0, s39, 7168
s_add_u32 s37, s37, s38
buffer_load_dwordx4 v23, s[8:11], s37 offen sc1 lds
s_waitcnt vmcnt(16)
s_barrier
s_add_u32 s42, s42, 1
s_and_b32 s42, s42, 15
s_add_u32 m0, s39, 16384
s_lshl_b32 s37, s42, 14
buffer_load_dwordx4 v23, s[8:11], s37 offen sc1 lds
s_add_u32 m0, s39, 17408
s_add_u32 s37, s37, s38
buffer_load_dwordx4 v23, s[8:11], s37 offen sc1 lds
s_add_u32 m0, s39, 18432
s_add_u32 s37, s37, s38
buffer_load_dwordx4 v23, s[8:11], s37 offen sc1 lds
s_add_u32 m0, s39, 19456
s_add_u32 s37, s37, s38
buffer_load_dwordx4 v23, s[8:11], s37 offen sc1 lds
s_add_u32 m0, s39, 20480
s_add_u32 s37, s37, s38
buffer_load_dwordx4 v23, s[8:11], s37 offen sc1 lds
s_add_u32 m0, s39, 21504
s_add_u32 s37, s37, s38
buffer_load_dwordx4 v23, s[8:11], s37 offen sc1 lds
s_add_u32 m0, s39, 22528
s_add_u32 s37, s37, s38
buffer_load_dwordx4 v23, s[8:11], s37 offen sc1 lds
s_add_u32 m0, s39, 23552
s_add_u32 s37, s37, s38
buffer_load_dwordx4 v23, s[8:11], s37 offen sc1 lds
s_waitcnt vmcnt(16)
s_barrier
s_add_u32 s42, s42, 1
s_and_b32 s42, s42, 15
s_add_u32 m0, s39, 32768
s_lshl_b32 s37, s42, 14
buffer_load_dwordx4 v23, s[8:11], s37 offen sc1 lds
s_add_u32 m0, s39, 33792
s_add_u32 s37, s37, s38
buffer_load_dwordx4 v23, s[8:11], s37 offen sc1 lds
s_add_u32 m0, s39, 34816
s_add_u32 s37, s37, s38
buffer_load_dwordx4 v23, s[8:11], s37 offen sc1 lds
s_add_u32 m0, s39, 35840
s_add_u32 s37, s37, s38
buffer_load_dwordx4 v23, s[8:11], s37 offen sc1 lds
s_add_u32 m0, s39, 36864
s_add_u32 s37, s37, s38
buffer_load_dwordx4 v23, s[8:11], s37 offen sc1 lds
s_add_u32 m0, s39, 37888
s_add_u32 s37, s37, s38
buffer_load_dwordx4 v23, s[8:11], s37 offen sc1 lds
s_add_u32 m0, s39, 38912
s_add_u32 s37, s37, s38
buffer_load_dwordx4 v23, s[8:11], s37 offen sc1 lds
s_add_u32 m0, s39, 39936
s_add_u32 s37, s37, s38
buffer_load_dwordx4 v23, s[8:11], s37 offen sc1 lds
s_waitcnt vmcnt(16)
s_barrier
s_add_u32 s42, s42, 1
s_and_b32 s42, s42, 15
s_add_u32 m0, s39, 49152
s_lshl_b32 s37, s42, 14
buffer_load_dwordx4 v23, s[8:11], s37 offen sc1 lds
s_add_u32 m0, s39, 50176
s_add_u32 s37, s37, s38
buffer_load_dwordx4 v23, s[8:11], s37 offen sc1 lds
s_add_u32 m0, s39, 51200
s_add_u32 s37, s37, s38
buffer_load_dwordx4 v23, s[8:11], s37 offen sc1 lds
s_add_u32 m0, s39, 52224
s_add_u32 s37, s37, s38
buffer_load_dwordx4 v23, s[8:11], s37 offen sc1 lds
s_add_u32 m0, s39, 53248
s_add_u32 s37, s37, s38
buffer_load_dwordx4 v23, s[8:11], s37 offen sc1 lds
s_add_u32 m0, s39, 54272
s_add_u32 s37, s37, s38
buffer_load_dwordx4 v23, s[8:11], s37 offen sc1 lds
s_add_u32 m0, s39, 55296
s_add_u32 s37, s37, s38
buffer_load_dwordx4 v23, s[8:11], s37 offen sc1 lds
s_add_u32 m0, s39, 56320
s_add_u32 s37, s37, s38
buffer_load_dwordx4 v23, s[8:11], s37 offen sc1 lds
s_waitcnt vmcnt(16)
s_barrier
s_add_u32 s42, s42, 1
s_and_b32 s42, s42, 15
s_add_u32 m0, s39, 0
s_lshl_b32 s37, s42, 14
buffer_load_dwordx4 v23, s[8:11], s37 offen sc1 lds
s_add_u32 m0, s39, 1024
s_add_u32 s37, s37, s38
buffer_load_dwordx4 v23, s[8:11], s37 offen sc1 lds
s_add_u32 m0, s39, 2048
s_add_u32 s37, s37, s38
buffer_load_dwordx4 v23, s[8:11], s37 offen sc1 lds
s_add_u32 m0, s39, 3072
s_add_u32 s37, s37, s38
buffer_load_dwordx4 v23, s[8:11], s37 offen sc1 lds
s_add_u32 m0, s39, 4096
s_add_u32 s37, s37, s38
buffer_load_dwordx4 v23, s[8:11], s37 offen sc1 lds
s_add_u32 m0, s39, 5120
s_add_u32 s37, s37, s38
buffer_load_dwordx4 v23, s[8:11], s37 offen sc1 lds
s_add_u32 m0, s39, 6144
s_add_u32 s37, s37, s38
buffer_load_dwordx4 v23, s[8:11], s37 offen sc1 lds
s_add_u32 m0, s39, 7168
s_add_u32 s37, s37, s38
buffer_load_dwordx4 v23, s[8:11], s37 offen sc1 lds
s_waitcnt vmcnt(16)
s_barrier
s_add_u32 s42, s42, 1
s_and_b32 s42, s42, 15
s_add_u32 m0, s39, 16384
s_lshl_b32 s37, s42, 14
buffer_load_dwordx4 v23, s[8:11], s37 offen sc1 lds
s_add_u32 m0, s39, 17408
s_add_u32 s37, s37, s38
buffer_load_dwordx4 v23, s[8:11], s37 offen sc1 lds
s_add_u32 m0, s39, 18432
s_add_u32 s37, s37, s38
buffer_load_dwordx4 v23, s[8:11], s37 offen sc1 lds
s_add_u32 m0, s39, 19456
s_add_u32 s37, s37, s38
buffer_load_dwordx4 v23, s[8:11], s37 offen sc1 lds
s_add_u32 m0, s39, 20480
s_add_u32 s37, s37, s38
buffer_load_dwordx4 v23, s[8:11], s37 offen sc1 lds
s_add_u32 m0, s39, 21504
s_add_u32 s37, s37, s38
buffer_load_dwordx4 v23, s[8:11], s37 offen sc1 lds
s_add_u32 m0, s39, 22528
s_add_u32 s37, s37, s38
buffer_load_dwordx4 v23, s[8:11], s37 offen sc1 lds
s_add_u32 m0, s39, 23552
s_add_u32 s37, s37, s38
buffer_load_dwordx4 v23, s[8:11], s37 offen sc1 lds
s_waitcnt vmcnt(16)
s_barrier
s_add_u32 s42, s42, 1
s_and_b32 s42, s42, 15
s_add_u32 m0, s39, 32768
s_lshl_b32 s37, s42, 14
buffer_load_dwordx4 v23, s[8:11], s37 offen sc1 lds
s_add_u32 m0, s39, 33792
s_add_u32 s37, s37, s38
buffer_load_dwordx4 v23, s[8:11], s37 offen sc1 lds
s_add_u32 m0, s39, 34816
s_add_u32 s37, s37, s38
buffer_load_dwordx4 v23, s[8:11], s37 offen sc1 lds
s_add_u32 m0, s39, 35840
s_add_u32 s37, s37, s38
buffer_load_dwordx4 v23, s[8:11], s37 offen sc1 lds
s_add_u32 m0, s39, 36864
s_add_u32 s37, s37, s38
buffer_load_dwordx4 v23, s[8:11], s37 offen sc1 lds
s_add_u32 m0, s39, 37888
s_add_u32 s37, s37, s38
buffer_load_dwordx4 v23, s[8:11], s37 offen sc1 lds
s_add_u32 m0, s39, 38912
s_add_u32 s37, s37, s38
buffer_load_dwordx4 v23, s[8:11], s37 offen sc1 lds
s_add_u32 m0, s39, 39936
s_add_u32 s37, s37, s38
buffer_load_dwordx4 v23, s[8:11], s37 offen sc1 lds
s_waitcnt vmcnt(16)
s_barrier
s_add_u32 s42, s42, 1
s_and_b32 s42, s42, 15
s_add_u32 m0, s39, 49152
s_lshl_b32 s37, s42, 14
buffer_load_dwordx4 v23, s[8:11], s37 offen sc1 lds
s_add_u32 m0, s39, 50176
s_add_u32 s37, s37, s38
buffer_load_dwordx4 v23, s[8:11], s37 offen sc1 lds
s_add_u32 m0, s39, 51200
s_add_u32 s37, s37, s38
buffer_load_dwordx4 v23, s[8:11], s37 offen sc1 lds
s_add_u32 m0, s39, 52224
s_add_u32 s37, s37, s38
buffer_load_dwordx4 v23, s[8:11], s37 offen sc1 lds
s_add_u32 m0, s39, 53248
s_add_u32 s37, s37, s38
buffer_load_dwordx4 v23, s[8:11], s37 offen sc1 lds
s_add_u32 m0, s39, 54272
s_add_u32 s37, s37, s38
buffer_load_dwordx4 v23, s[8:11], s37 offen sc1 lds
s_add_u32 m0, s39, 55296
s_add_u32 s37, s37, s38
buffer_load_dwordx4 v23, s[8:11], s37 offen sc1 lds
s_add_u32 m0, s39, 56320
s_add_u32 s37, s37, s38
buffer_load_dwordx4 v23, s[8:11], s37 offen sc1 lds
s_lshl_b32 s43, s35, 8
s_cmp_eq_u32 s51, 1
s_cselect_b32 s8, s4, s6
s_cselect_b32 s9, s5, s7
s_sub_u32 s10, 7340032, s43
s_lshl_b32 s44, s34, 18
s_add_u32 s44, s44, 4194304
s_movk_i32 s38, 28672
s_cmp_eq_u32 s51, 0
s_cselect_b32 s8, s32, s8
s_cselect_b32 s9, s33, s9
s_cselect_b32 s10, 262144, s10
s_cselect_b32 s43, s44, s43
s_cselect_b32 s38, 1024, s38
s_cselect_b32 s45, 0, -1
s_add_u32 s8, s8, s43
s_addc_u32 s9, s9, 0
s_mov_b32 s11, 0x20000
s_lshl_b32 s40, s38, 4
s_add_u32 s42, s35, 15
s_lshl_b32 s39, s51, 14
v_lshrrev_b32 v19, 4, v1
v_lshlrev_b32 v20, 5, v19
v_mul_u32_u24 v19, 6912, v19
v_and_b32 v19, s45, v19
v_and_b32 v20, s45, v20
v_lshlrev_b32 v21, 4, v1
v_xor_b32 v21, v21, v20
v_add_u32 v22, v21, v19
s_and_b32 s45, s45, 128
v_xor_b32 v23, s45, v22
s_waitcnt vmcnt(16)
s_barrier
s_waitcnt vmcnt(8)
s_barrier
s_waitcnt vmcnt(0)
s_barrier
s_barrier
s_barrier
s_add_u32 s43, s34, 16
s_lshl_b32 s43, s43, 7
v_mov_b32 v8, s43
v_mov_b32 v10, 16
buffer_load_dword v9, v8, s[56:59], 0 offen sc1
s_waitcnt vmcnt(0)
s_add_u32 s43, s34, 16
s_lshl_b32 s43, s43, 7
v_mov_b32 v8, s43
v_mov_b32 v10, 16
buffer_load_dword v9, v8, s[56:59], 0 offen sc1
s_waitcnt vmcnt(0)
s_add_u32 s42, s42, 1
s_add_u32 s42, s42, 1
s_and_b32 s42, s42, 15
s_add_u32 m0, s39, 0
s_mul_i32 s37, s42, s40
buffer_load_dwordx4 v22, s[8:11], s37 offen sc1 lds
s_add_u32 m0, s39, 1024
s_add_u32 s37, s37, s38
buffer_load_dwordx4 v23, s[8:11], s37 offen sc1 lds
s_add_u32 m0, s39, 2048
s_add_u32 s37, s37, s38
buffer_load_dwordx4 v22, s[8:11], s37 offen sc1 lds
s_add_u32 m0, s39, 3072
s_add_u32 s37, s37, s38
buffer_load_dwordx4 v23, s[8:11], s37 offen sc1 lds
s_add_u32 m0, s39, 4096
s_add_u32 s37, s37, s38
buffer_load_dwordx4 v22, s[8:11], s37 offen sc1 lds
s_add_u32 m0, s39, 5120
s_add_u32 s37, s37, s38
buffer_load_dwordx4 v23, s[8:11], s37 offen sc1 lds
s_add_u32 m0, s39, 6144
s_add_u32 s37, s37, s38
buffer_load_dwordx4 v22, s[8:11], s37 offen sc1 lds
s_add_u32 m0, s39, 7168
s_add_u32 s37, s37, s38
buffer_load_dwordx4 v23, s[8:11], s37 offen sc1 lds
s_add_u32 m0, s39, 8192
s_add_u32 s37, s37, s38
buffer_load_dwordx4 v22, s[8:11], s37 offen sc1 lds
s_add_u32 m0, s39, 9216
s_add_u32 s37, s37, s38
buffer_load_dwordx4 v23, s[8:11], s37 offen sc1 lds
s_add_u32 m0, s39, 10240
s_add_u32 s37, s37, s38
buffer_load_dwordx4 v22, s[8:11], s37 offen sc1 lds
s_add_u32 m0, s39, 11264
s_add_u32 s37, s37, s38
buffer_load_dwordx4 v23, s[8:11], s37 offen sc1 lds
s_add_u32 m0, s39, 12288
s_add_u32 s37, s37, s38
buffer_load_dwordx4 v22, s[8:11], s37 offen sc1 lds
s_add_u32 m0, s39, 13312
s_add_u32 s37, s37, s38
buffer_load_dwordx4 v23, s[8:11], s37 offen sc1 lds
s_add_u32 m0, s39, 14336
s_add_u32 s37, s37, s38
buffer_load_dwordx4 v22, s[8:11], s37 offen sc1 lds
s_add_u32 m0, s39, 15360
s_add_u32 s37, s37, s38
buffer_load_dwordx4 v23, s[8:11], s37 offen sc1 lds
s_add_u32 s42, s42, 1
s_and_b32 s42, s42, 15
s_add_u32 m0, s39, 49152
s_mul_i32 s37, s42, s40
buffer_load_dwordx4 v22, s[8:11], s37 offen sc1 lds
s_add_u32 m0, s39, 50176
s_add_u32 s37, s37, s38
buffer_load_dwordx4 v23, s[8:11], s37 offen sc1 lds
s_add_u32 m0, s39, 51200
s_add_u32 s37, s37, s38
buffer_load_dwordx4 v22, s[8:11], s37 offen sc1 lds
s_add_u32 m0, s39, 52224
s_add_u32 s37, s37, s38
buffer_load_dwordx4 v23, s[8:11], s37 offen sc1 lds
s_add_u32 m0, s39, 53248
s_add_u32 s37, s37, s38
buffer_load_dwordx4 v22, s[8:11], s37 offen sc1 lds
s_add_u32 m0, s39, 54272
s_add_u32 s37, s37, s38
buffer_load_dwordx4 v23, s[8:11], s37 offen sc1 lds
s_add_u32 m0, s39, 55296
s_add_u32 s37, s37, s38
buffer_load_dwordx4 v22, s[8:11], s37 offen sc1 lds
s_add_u32 m0, s39, 56320
s_add_u32 s37, s37, s38
buffer_load_dwordx4 v23, s[8:11], s37 offen sc1 lds
s_add_u32 m0, s39, 57344
s_add_u32 s37, s37, s38
buffer_load_dwordx4 v22, s[8:11], s37 offen sc1 lds
s_add_u32 m0, s39, 58368
s_add_u32 s37, s37, s38
buffer_load_dwordx4 v23, s[8:11], s37 offen sc1 lds
s_add_u32 m0, s39, 59392
s_add_u32 s37, s37, s38
buffer_load_dwordx4 v22, s[8:11], s37 offen sc1 lds
s_add_u32 m0, s39, 60416
s_add_u32 s37, s37, s38
buffer_load_dwordx4 v23, s[8:11], s37 offen sc1 lds
s_add_u32 m0, s39, 61440
s_add_u32 s37, s37, s38
buffer_load_dwordx4 v22, s[8:11], s37 offen sc1 lds
s_add_u32 m0, s39, 62464
s_add_u32 s37, s37, s38
buffer_load_dwordx4 v23, s[8:11], s37 offen sc1 lds
s_add_u32 m0, s39, 63488
s_add_u32 s37, s37, s38
buffer_load_dwordx4 v22, s[8:11], s37 offen sc1 lds
s_add_u32 m0, s39, 64512
s_add_u32 s37, s37, s38
buffer_load_dwordx4 v23, s[8:11], s37 offen sc1 lds
s_branch LP3_101
.p2align 6
Lw_21:
s_branch Lr_22
s_nop 0
.p2align 3
Lp_103:
s_add_u32 s42, s35, 2
s_waitcnt vmcnt(0)
s_barrier
s_add_u32 s43, s34, 0
s_lshl_b32 s43, s43, 7
v_mov_b32 v13, s43
v_mov_b32 v14, 1
s_mov_b64 exec, 1
buffer_atomic_add v14, v13, s[56:59], 0 offen sc1
s_mov_b64 exec, -1
ds_write_b128 v27, v[68:71] offset:0
ds_write_b128 v27, v[116:119] offset:512
s_waitcnt lgkmcnt(0)
s_barrier
s_add_u32 m0, s54, 16384
s_add_u32 s43, s30, 0
buffer_load_dwordx4 v21, s[12:15], s43 offen sc1 lds
s_add_u32 m0, s54, 17408
s_add_u32 s43, s30, 1024
buffer_load_dwordx4 v21, s[12:15], s43 offen sc1 lds
s_add_u32 m0, s54, 32768
s_add_u32 s43, s31, 0
buffer_load_dwordx4 v21, s[12:15], s43 offen sc1 lds
s_add_u32 m0, s54, 33792
s_add_u32 s43, s31, 1024
buffer_load_dwordx4 v21, s[12:15], s43 offen sc1 lds
s_add_u32 s42, s42, 1
s_and_b32 s42, s42, 15
s_add_u32 m0, s39, 49152
s_lshl_b32 s37, s42, 14
buffer_load_dwordx4 v23, s[8:11], s37 offen sc1 lds
s_add_u32 m0, s39, 50176
s_add_u32 s37, s37, s38
buffer_load_dwordx4 v23, s[8:11], s37 offen sc1 lds
s_add_u32 m0, s39, 51200
s_add_u32 s37, s37, s38
buffer_load_dwordx4 v23, s[8:11], s37 offen sc1 lds
s_add_u32 m0, s39, 52224
s_add_u32 s37, s37, s38
buffer_load_dwordx4 v23, s[8:11], s37 offen sc1 lds
s_add_u32 m0, s39, 53248
s_add_u32 s37, s37, s38
buffer_load_dwordx4 v23, s[8:11], s37 offen sc1 lds
s_add_u32 m0, s39, 54272
s_add_u32 s37, s37, s38
buffer_load_dwordx4 v23, s[8:11], s37 offen sc1 lds
s_add_u32 m0, s39, 55296
s_add_u32 s37, s37, s38
buffer_load_dwordx4 v23, s[8:11], s37 offen sc1 lds
s_add_u32 m0, s39, 56320
s_add_u32 s37, s37, s38
buffer_load_dwordx4 v23, s[8:11], s37 offen sc1 lds
s_waitcnt vmcnt(10)
s_barrier
s_add_u32 s42, s42, 1
s_and_b32 s42, s42, 15
s_add_u32 m0, s39, 0
s_lshl_b32 s37, s42, 14
buffer_load_dwordx4 v23, s[8:11], s37 offen sc1 lds
s_add_u32 m0, s39, 1024
s_add_u32 s37, s37, s38
buffer_load_dwordx4 v23, s[8:11], s37 offen sc1 lds
s_add_u32 m0, s39, 2048
s_add_u32 s37, s37, s38
buffer_load_dwordx4 v23, s[8:11], s37 offen sc1 lds
s_add_u32 m0, s39, 3072
s_add_u32 s37, s37, s38
buffer_load_dwordx4 v23, s[8:11], s37 offen sc1 lds
s_add_u32 m0, s39, 4096
s_add_u32 s37, s37, s38
buffer_load_dwordx4 v23, s[8:11], s37 offen sc1 lds
s_add_u32 m0, s39, 5120
s_add_u32 s37, s37, s38
buffer_load_dwordx4 v23, s[8:11], s37 offen sc1 lds
s_add_u32 m0, s39, 6144
s_add_u32 s37, s37, s38
buffer_load_dwordx4 v23, s[8:11], s37 offen sc1 lds
s_add_u32 m0, s39, 7168
s_add_u32 s37, s37, s38
buffer_load_dwordx4 v23, s[8:11], s37 offen sc1 lds
s_waitcnt vmcnt(16)
s_barrier
s_add_u32 s42, s42, 1
s_and_b32 s42, s42, 15
s_add_u32 m0, s39, 16384
s_lshl_b32 s37, s42, 14
buffer_load_dwordx4 v23, s[8:11], s37 offen sc1 lds
s_add_u32 m0, s39, 17408
s_add_u32 s37, s37, s38
buffer_load_dwordx4 v23, s[8:11], s37 offen sc1 lds
s_add_u32 m0, s39, 18432
s_add_u32 s37, s37, s38
buffer_load_dwordx4 v23, s[8:11], s37 offen sc1 lds
s_add_u32 m0, s39, 19456
s_add_u32 s37, s37, s38
buffer_load_dwordx4 v23, s[8:11], s37 offen sc1 lds
s_add_u32 m0, s39, 20480
s_add_u32 s37, s37, s38
buffer_load_dwordx4 v23, s[8:11], s37 offen sc1 lds
s_add_u32 m0, s39, 21504
s_add_u32 s37, s37, s38
buffer_load_dwordx4 v23, s[8:11], s37 offen sc1 lds
s_add_u32 m0, s39, 22528
s_add_u32 s37, s37, s38
buffer_load_dwordx4 v23, s[8:11], s37 offen sc1 lds
s_add_u32 m0, s39, 23552
s_add_u32 s37, s37, s38
buffer_load_dwordx4 v23, s[8:11], s37 offen sc1 lds
s_waitcnt vmcnt(16)
s_barrier
s_add_u32 s42, s42, 1
s_and_b32 s42, s42, 15
s_add_u32 m0, s39, 32768
s_lshl_b32 s37, s42, 14
buffer_load_dwordx4 v23, s[8:11], s37 offen sc1 lds
s_add_u32 m0, s39, 33792
s_add_u32 s37, s37, s38
buffer_load_dwordx4 v23, s[8:11], s37 offen sc1 lds
s_add_u32 m0, s39, 34816
s_add_u32 s37, s37, s38
buffer_load_dwordx4 v23, s[8:11], s37 offen sc1 lds
s_add_u32 m0, s39, 35840
s_add_u32 s37, s37, s38
buffer_load_dwordx4 v23, s[8:11], s37 offen sc1 lds
s_add_u32 m0, s39, 36864
s_add_u32 s37, s37, s38
buffer_load_dwordx4 v23, s[8:11], s37 offen sc1 lds
s_add_u32 m0, s39, 37888
s_add_u32 s37, s37, s38
buffer_load_dwordx4 v23, s[8:11], s37 offen sc1 lds
s_add_u32 m0, s39, 38912
s_add_u32 s37, s37, s38
buffer_load_dwordx4 v23, s[8:11], s37 offen sc1 lds
s_add_u32 m0, s39, 39936
s_add_u32 s37, s37, s38
buffer_load_dwordx4 v23, s[8:11], s37 offen sc1 lds
s_waitcnt vmcnt(16)
s_barrier
s_add_u32 s42, s42, 1
s_and_b32 s42, s42, 15
s_add_u32 m0, s39, 49152
s_lshl_b32 s37, s42, 14
buffer_load_dwordx4 v23, s[8:11], s37 offen sc1 lds
s_add_u32 m0, s39, 50176
s_add_u32 s37, s37, s38
buffer_load_dwordx4 v23, s[8:11], s37 offen sc1 lds
s_add_u32 m0, s39, 51200
s_add_u32 s37, s37, s38
buffer_load_dwordx4 v23, s[8:11], s37 offen sc1 lds
s_add_u32 m0, s39, 52224
s_add_u32 s37, s37, s38
buffer_load_dwordx4 v23, s[8:11], s37 offen sc1 lds
s_add_u32 m0, s39, 53248
s_add_u32 s37, s37, s38
buffer_load_dwordx4 v23, s[8:11], s37 offen sc1 lds
s_add_u32 m0, s39, 54272
s_add_u32 s37, s37, s38
buffer_load_dwordx4 v23, s[8:11], s37 offen sc1 lds
s_add_u32 m0, s39, 55296
s_add_u32 s37, s37, s38
buffer_load_dwordx4 v23, s[8:11], s37 offen sc1 lds
s_add_u32 m0, s39, 56320
s_add_u32 s37, s37, s38
buffer_load_dwordx4 v23, s[8:11], s37 offen sc1 lds
s_waitcnt vmcnt(16)
s_barrier
s_add_u32 s42, s42, 1
s_and_b32 s42, s42, 15
s_add_u32 m0, s39, 0
s_lshl_b32 s37, s42, 14
buffer_load_dwordx4 v23, s[8:11], s37 offen sc1 lds
s_add_u32 m0, s39, 1024
s_add_u32 s37, s37, s38
buffer_load_dwordx4 v23, s[8:11], s37 offen sc1 lds
s_add_u32 m0, s39, 2048
s_add_u32 s37, s37, s38
buffer_load_dwordx4 v23, s[8:11], s37 offen sc1 lds
s_add_u32 m0, s39, 3072
s_add_u32 s37, s37, s38
buffer_load_dwordx4 v23, s[8:11], s37 offen sc1 lds
s_add_u32 m0, s39, 4096
s_add_u32 s37, s37, s38
buffer_load_dwordx4 v23, s[8:11], s37 offen sc1 lds
s_add_u32 m0, s39, 5120
s_add_u32 s37, s37, s38
buffer_load_dwordx4 v23, s[8:11], s37 offen sc1 lds
s_add_u32 m0, s39, 6144
s_add_u32 s37, s37, s38
buffer_load_dwordx4 v23, s[8:11], s37 offen sc1 lds
s_add_u32 m0, s39, 7168
s_add_u32 s37, s37, s38
buffer_load_dwordx4 v23, s[8:11], s37 offen sc1 lds
s_waitcnt vmcnt(16)
s_barrier
s_add_u32 s42, s42, 1
s_and_b32 s42, s42, 15
s_add_u32 m0, s39, 16384
s_lshl_b32 s37, s42, 14
buffer_load_dwordx4 v23, s[8:11], s37 offen sc1 lds
s_add_u32 m0, s39, 17408
s_add_u32 s37, s37, s38
buffer_load_dwordx4 v23, s[8:11], s37 offen sc1 lds
s_add_u32 m0, s39, 18432
s_add_u32 s37, s37, s38
buffer_load_dwordx4 v23, s[8:11], s37 offen sc1 lds
s_add_u32 m0, s39, 19456
s_add_u32 s37, s37, s38
buffer_load_dwordx4 v23, s[8:11], s37 offen sc1 lds
s_add_u32 m0, s39, 20480
s_add_u32 s37, s37, s38
buffer_load_dwordx4 v23, s[8:11], s37 offen sc1 lds
s_add_u32 m0, s39, 21504
s_add_u32 s37, s37, s38
buffer_load_dwordx4 v23, s[8:11], s37 offen sc1 lds
s_add_u32 m0, s39, 22528
s_add_u32 s37, s37, s38
buffer_load_dwordx4 v23, s[8:11], s37 offen sc1 lds
s_add_u32 m0, s39, 23552
s_add_u32 s37, s37, s38
buffer_load_dwordx4 v23, s[8:11], s37 offen sc1 lds
s_waitcnt vmcnt(16)
s_barrier
s_add_u32 s42, s42, 1
s_and_b32 s42, s42, 15
s_add_u32 m0, s39, 32768
s_lshl_b32 s37, s42, 14
buffer_load_dwordx4 v23, s[8:11], s37 offen sc1 lds
s_add_u32 m0, s39, 33792
s_add_u32 s37, s37, s38
buffer_load_dwordx4 v23, s[8:11], s37 offen sc1 lds
s_add_u32 m0, s39, 34816
s_add_u32 s37, s37, s38
buffer_load_dwordx4 v23, s[8:11], s37 offen sc1 lds
s_add_u32 m0, s39, 35840
s_add_u32 s37, s37, s38
buffer_load_dwordx4 v23, s[8:11], s37 offen sc1 lds
s_add_u32 m0, s39, 36864
s_add_u32 s37, s37, s38
buffer_load_dwordx4 v23, s[8:11], s37 offen sc1 lds
s_add_u32 m0, s39, 37888
s_add_u32 s37, s37, s38
buffer_load_dwordx4 v23, s[8:11], s37 offen sc1 lds
s_add_u32 m0, s39, 38912
s_add_u32 s37, s37, s38
buffer_load_dwordx4 v23, s[8:11], s37 offen sc1 lds
s_add_u32 m0, s39, 39936
s_add_u32 s37, s37, s38
buffer_load_dwordx4 v23, s[8:11], s37 offen sc1 lds
s_waitcnt vmcnt(16)
s_barrier
s_add_u32 s42, s42, 1
s_and_b32 s42, s42, 15
s_add_u32 m0, s39, 49152
s_lshl_b32 s37, s42, 14
buffer_load_dwordx4 v23, s[8:11], s37 offen sc1 lds
s_add_u32 m0, s39, 50176
s_add_u32 s37, s37, s38
buffer_load_dwordx4 v23, s[8:11], s37 offen sc1 lds
s_add_u32 m0, s39, 51200
s_add_u32 s37, s37, s38
buffer_load_dwordx4 v23, s[8:11], s37 offen sc1 lds
s_add_u32 m0, s39, 52224
s_add_u32 s37, s37, s38
buffer_load_dwordx4 v23, s[8:11], s37 offen sc1 lds
s_add_u32 m0, s39, 53248
s_add_u32 s37, s37, s38
buffer_load_dwordx4 v23, s[8:11], s37 offen sc1 lds
s_add_u32 m0, s39, 54272
s_add_u32 s37, s37, s38
buffer_load_dwordx4 v23, s[8:11], s37 offen sc1 lds
s_add_u32 m0, s39, 55296
s_add_u32 s37, s37, s38
buffer_load_dwordx4 v23, s[8:11], s37 offen sc1 lds
s_add_u32 m0, s39, 56320
s_add_u32 s37, s37, s38
buffer_load_dwordx4 v23, s[8:11], s37 offen sc1 lds
s_waitcnt vmcnt(16)
s_barrier
s_add_u32 s42, s42, 1
s_and_b32 s42, s42, 15
s_add_u32 m0, s39, 0
s_lshl_b32 s37, s42, 14
buffer_load_dwordx4 v23, s[8:11], s37 offen sc1 lds
s_add_u32 m0, s39, 1024
s_add_u32 s37, s37, s38
buffer_load_dwordx4 v23, s[8:11], s37 offen sc1 lds
s_add_u32 m0, s39, 2048
s_add_u32 s37, s37, s38
buffer_load_dwordx4 v23, s[8:11], s37 offen sc1 lds
s_add_u32 m0, s39, 3072
s_add_u32 s37, s37, s38
buffer_load_dwordx4 v23, s[8:11], s37 offen sc1 lds
s_add_u32 m0, s39, 4096
s_add_u32 s37, s37, s38
buffer_load_dwordx4 v23, s[8:11], s37 offen sc1 lds
s_add_u32 m0, s39, 5120
s_add_u32 s37, s37, s38
buffer_load_dwordx4 v23, s[8:11], s37 offen sc1 lds
s_add_u32 m0, s39, 6144
s_add_u32 s37, s37, s38
buffer_load_dwordx4 v23, s[8:11], s37 offen sc1 lds
s_add_u32 m0, s39, 7168
s_add_u32 s37, s37, s38
buffer_load_dwordx4 v23, s[8:11], s37 offen sc1 lds
s_waitcnt vmcnt(16)
s_barrier
s_add_u32 s42, s42, 1
s_and_b32 s42, s42, 15
s_add_u32 m0, s39, 16384
s_lshl_b32 s37, s42, 14
buffer_load_dwordx4 v23, s[8:11], s37 offen sc1 lds
s_add_u32 m0, s39, 17408
s_add_u32 s37, s37, s38
buffer_load_dwordx4 v23, s[8:11], s37 offen sc1 lds
s_add_u32 m0, s39, 18432
s_add_u32 s37, s37, s38
buffer_load_dwordx4 v23, s[8:11], s37 offen sc1 lds
s_add_u32 m0, s39, 19456
s_add_u32 s37, s37, s38
buffer_load_dwordx4 v23, s[8:11], s37 offen sc1 lds
s_add_u32 m0, s39, 20480
s_add_u32 s37, s37, s38
buffer_load_dwordx4 v23, s[8:11], s37 offen sc1 lds
s_add_u32 m0, s39, 21504
s_add_u32 s37, s37, s38
buffer_load_dwordx4 v23, s[8:11], s37 offen sc1 lds
s_add_u32 m0, s39, 22528
s_add_u32 s37, s37, s38
buffer_load_dwordx4 v23, s[8:11], s37 offen sc1 lds
s_add_u32 m0, s39, 23552
s_add_u32 s37, s37, s38
buffer_load_dwordx4 v23, s[8:11], s37 offen sc1 lds
s_waitcnt vmcnt(16)
s_barrier
s_add_u32 s42, s42, 1
s_and_b32 s42, s42, 15
s_add_u32 m0, s39, 32768
s_lshl_b32 s37, s42, 14
buffer_load_dwordx4 v23, s[8:11], s37 offen sc1 lds
s_add_u32 m0, s39, 33792
s_add_u32 s37, s37, s38
buffer_load_dwordx4 v23, s[8:11], s37 offen sc1 lds
s_add_u32 m0, s39, 34816
s_add_u32 s37, s37, s38
buffer_load_dwordx4 v23, s[8:11], s37 offen sc1 lds
s_add_u32 m0, s39, 35840
s_add_u32 s37, s37, s38
buffer_load_dwordx4 v23, s[8:11], s37 offen sc1 lds
s_add_u32 m0, s39, 36864
s_add_u32 s37, s37, s38
buffer_load_dwordx4 v23, s[8:11], s37 offen sc1 lds
s_add_u32 m0, s39, 37888
s_add_u32 s37, s37, s38
buffer_load_dwordx4 v23, s[8:11], s37 offen sc1 lds
s_add_u32 m0, s39, 38912
s_add_u32 s37, s37, s38
buffer_load_dwordx4 v23, s[8:11], s37 offen sc1 lds
s_add_u32 m0, s39, 39936
s_add_u32 s37, s37, s38
buffer_load_dwordx4 v23, s[8:11], s37 offen sc1 lds
s_waitcnt vmcnt(16)
s_barrier
s_add_u32 s42, s42, 1
s_and_b32 s42, s42, 15
s_add_u32 m0, s39, 49152
s_lshl_b32 s37, s42, 14
buffer_load_dwordx4 v23, s[8:11], s37 offen sc1 lds
s_add_u32 m0, s39, 50176
s_add_u32 s37, s37, s38
buffer_load_dwordx4 v23, s[8:11], s37 offen sc1 lds
s_add_u32 m0, s39, 51200
s_add_u32 s37, s37, s38
buffer_load_dwordx4 v23, s[8:11], s37 offen sc1 lds
s_add_u32 m0, s39, 52224
s_add_u32 s37, s37, s38
buffer_load_dwordx4 v23, s[8:11], s37 offen sc1 lds
s_add_u32 m0, s39, 53248
s_add_u32 s37, s37, s38
buffer_load_dwordx4 v23, s[8:11], s37 offen sc1 lds
s_add_u32 m0, s39, 54272
s_add_u32 s37, s37, s38
buffer_load_dwordx4 v23, s[8:11], s37 offen sc1 lds
s_add_u32 m0, s39, 55296
s_add_u32 s37, s37, s38
buffer_load_dwordx4 v23, s[8:11], s37 offen sc1 lds
s_add_u32 m0, s39, 56320
s_add_u32 s37, s37, s38
buffer_load_dwordx4 v23, s[8:11], s37 offen sc1 lds
s_lshl_b32 s43, s35, 8
s_cmp_eq_u32 s51, 1
s_cselect_b32 s8, s4, s6
s_cselect_b32 s9, s5, s7
s_sub_u32 s10, 7340032, s43
s_lshl_b32 s44, s34, 18
s_add_u32 s44, s44, 4194304
s_movk_i32 s38, 28672
s_cmp_eq_u32 s51, 0
s_cselect_b32 s8, s32, s8
s_cselect_b32 s9, s33, s9
s_cselect_b32 s10, 262144, s10
s_cselect_b32 s43, s44, s43
s_cselect_b32 s38, 1024, s38
s_cselect_b32 s45, 0, -1
s_add_u32 s8, s8, s43
s_addc_u32 s9, s9, 0
s_mov_b32 s11, 0x20000
s_lshl_b32 s40, s38, 4
s_add_u32 s42, s35, 15
s_lshl_b32 s39, s51, 14
v_lshrrev_b32 v19, 4, v1
v_lshlrev_b32 v20, 5, v19
v_mul_u32_u24 v19, 6912, v19
v_and_b32 v19, s45, v19
v_and_b32 v20, s45, v20
v_lshlrev_b32 v21, 4, v1
v_xor_b32 v21, v21, v20
v_add_u32 v22, v21, v19
s_and_b32 s45, s45, 128
v_xor_b32 v23, s45, v22
s_waitcnt vmcnt(16)
s_barrier
s_add_u32 s42, s42, 1
s_and_b32 s42, s42, 15
s_add_u32 m0, s39, 98304
s_mul_i32 s37, s42, s40
buffer_load_dwordx4 v22, s[8:11], s37 offen sc1 lds
s_add_u32 m0, s39, 99328
s_add_u32 s37, s37, s38
buffer_load_dwordx4 v23, s[8:11], s37 offen sc1 lds
s_add_u32 m0, s39, 100352
s_add_u32 s37, s37, s38
buffer_load_dwordx4 v22, s[8:11], s37 offen sc1 lds
s_add_u32 m0, s39, 101376
s_add_u32 s37, s37, s38
buffer_load_dwordx4 v23, s[8:11], s37 offen sc1 lds
s_add_u32 m0, s39, 102400
s_add_u32 s37, s37, s38
buffer_load_dwordx4 v22, s[8:11], s37 offen sc1 lds
s_add_u32 m0, s39, 103424
s_add_u32 s37, s37, s38
buffer_load_dwordx4 v23, s[8:11], s37 offen sc1 lds
s_add_u32 m0, s39, 104448
s_add_u32 s37, s37, s38
buffer_load_dwordx4 v22, s[8:11], s37 offen sc1 lds
s_add_u32 m0, s39, 105472
s_add_u32 s37, s37, s38
buffer_load_dwordx4 v23, s[8:11], s37 offen sc1 lds
s_add_u32 m0, s39, 106496
s_add_u32 s37, s37, s38
buffer_load_dwordx4 v22, s[8:11], s37 offen sc1 lds
s_add_u32 m0, s39, 107520
s_add_u32 s37, s37, s38
buffer_load_dwordx4 v23, s[8:11], s37 offen sc1 lds
s_add_u32 m0, s39, 108544
s_add_u32 s37, s37, s38
buffer_load_dwordx4 v22, s[8:11], s37 offen sc1 lds
s_add_u32 m0, s39, 109568
s_add_u32 s37, s37, s38
buffer_load_dwordx4 v23, s[8:11], s37 offen sc1 lds
s_add_u32 m0, s39, 110592
s_add_u32 s37, s37, s38
buffer_load_dwordx4 v22, s[8:11], s37 offen sc1 lds
s_add_u32 m0, s39, 111616
s_add_u32 s37, s37, s38
buffer_load_dwordx4 v23, s[8:11], s37 offen sc1 lds
s_add_u32 m0, s39, 112640
s_add_u32 s37, s37, s38
buffer_load_dwordx4 v22, s[8:11], s37 offen sc1 lds
s_add_u32 m0, s39, 113664
s_add_u32 s37, s37, s38
buffer_load_dwordx4 v23, s[8:11], s37 offen sc1 lds
s_waitcnt vmcnt(24)
s_barrier
s_waitcnt vmcnt(16)
s_barrier
s_add_u32 s42, s42, 1
s_and_b32 s42, s42, 15
s_add_u32 m0, s39, 0
s_mul_i32 s37, s42, s40
buffer_load_dwordx4 v22, s[8:11], s37 offen sc1 lds
s_add_u32 m0, s39, 1024
s_add_u32 s37, s37, s38
buffer_load_dwordx4 v23, s[8:11], s37 offen sc1 lds
s_add_u32 m0, s39, 2048
s_add_u32 s37, s37, s38
buffer_load_dwordx4 v22, s[8:11], s37 offen sc1 lds
s_add_u32 m0, s39, 3072
s_add_u32 s37, s37, s38
buffer_load_dwordx4 v23, s[8:11], s37 offen sc1 lds
s_add_u32 m0, s39, 4096
s_add_u32 s37, s37, s38
buffer_load_dwordx4 v22, s[8:11], s37 offen sc1 lds
s_add_u32 m0, s39, 5120
s_add_u32 s37, s37, s38
buffer_load_dwordx4 v23, s[8:11], s37 offen sc1 lds
s_add_u32 m0, s39, 6144
s_add_u32 s37, s37, s38
buffer_load_dwordx4 v22, s[8:11], s37 offen sc1 lds
s_add_u32 m0, s39, 7168
s_add_u32 s37, s37, s38
buffer_load_dwordx4 v23, s[8:11], s37 offen sc1 lds
s_add_u32 m0, s39, 8192
s_add_u32 s37, s37, s38
buffer_load_dwordx4 v22, s[8:11], s37 offen sc1 lds
s_add_u32 m0, s39, 9216
s_add_u32 s37, s37, s38
buffer_load_dwordx4 v23, s[8:11], s37 offen sc1 lds
s_add_u32 m0, s39, 10240
s_add_u32 s37, s37, s38
buffer_load_dwordx4 v22, s[8:11], s37 offen sc1 lds
s_add_u32 m0, s39, 11264
s_add_u32 s37, s37, s38
buffer_load_dwordx4 v23, s[8:11], s37 offen sc1 lds
s_add_u32 m0, s39, 12288
s_add_u32 s37, s37, s38
buffer_load_dwordx4 v22, s[8:11], s37 offen sc1 lds
s_add_u32 m0, s39, 13312
s_add_u32 s37, s37, s38
buffer_load_dwordx4 v23, s[8:11], s37 offen sc1 lds
s_add_u32 m0, s39, 14336
s_add_u32 s37, s37, s38
buffer_load_dwordx4 v22, s[8:11], s37 offen sc1 lds
s_add_u32 m0, s39, 15360
s_add_u32 s37, s37, s38
buffer_load_dwordx4 v23, s[8:11], s37 offen sc1 lds
s_barrier
s_waitcnt vmcnt(16)
s_barrier
s_add_u32 s42, s42, 1
s_and_b32 s42, s42, 15
s_add_u32 m0, s39, 49152
s_mul_i32 s37, s42, s40
buffer_load_dwordx4 v22, s[8:11], s37 offen sc1 lds
s_add_u32 m0, s39, 50176
s_add_u32 s37, s37, s38
buffer_load_dwordx4 v23, s[8:11], s37 offen sc1 lds
s_add_u32 m0, s39, 51200
s_add_u32 s37, s37, s38
buffer_load_dwordx4 v22, s[8:11], s37 offen sc1 lds
s_add_u32 m0, s39, 52224
s_add_u32 s37, s37, s38
buffer_load_dwordx4 v23, s[8:11], s37 offen sc1 lds
s_add_u32 m0, s39, 53248
s_add_u32 s37, s37, s38
buffer_load_dwordx4 v22, s[8:11], s37 offen sc1 lds
s_add_u32 m0, s39, 54272
s_add_u32 s37, s37, s38
buffer_load_dwordx4 v23, s[8:11], s37 offen sc1 lds
s_add_u32 m0, s39, 55296
s_add_u32 s37, s37, s38
buffer_load_dwordx4 v22, s[8:11], s37 offen sc1 lds
s_add_u32 m0, s39, 56320
s_add_u32 s37, s37, s38
buffer_load_dwordx4 v23, s[8:11], s37 offen sc1 lds
s_add_u32 m0, s39, 57344
s_add_u32 s37, s37, s38
buffer_load_dwordx4 v22, s[8:11], s37 offen sc1 lds
s_add_u32 m0, s39, 58368
s_add_u32 s37, s37, s38
buffer_load_dwordx4 v23, s[8:11], s37 offen sc1 lds
s_add_u32 m0, s39, 59392
s_add_u32 s37, s37, s38
buffer_load_dwordx4 v22, s[8:11], s37 offen sc1 lds
s_add_u32 m0, s39, 60416
s_add_u32 s37, s37, s38
buffer_load_dwordx4 v23, s[8:11], s37 offen sc1 lds
s_add_u32 m0, s39, 61440
s_add_u32 s37, s37, s38
buffer_load_dwordx4 v22, s[8:11], s37 offen sc1 lds
s_add_u32 m0, s39, 62464
s_add_u32 s37, s37, s38
buffer_load_dwordx4 v23, s[8:11], s37 offen sc1 lds
s_add_u32 m0, s39, 63488
s_add_u32 s37, s37, s38
buffer_load_dwordx4 v22, s[8:11], s37 offen sc1 lds
s_add_u32 m0, s39, 64512
s_add_u32 s37, s37, s38
buffer_load_dwordx4 v23, s[8:11], s37 offen sc1 lds
s_branch LP3_101
.p2align 6
Lw_19:
s_branch Lr_20
s_nop 0
.p2align 3
Lp_104:
s_add_u32 s42, s35, 15
s_waitcnt vmcnt(0)
s_barrier
ds_write_b128 v27, v[68:71] offset:0
ds_write_b128 v27, v[116:119] offset:512
s_add_u32 s42, s42, 1
s_and_b32 s42, s42, 15
s_add_u32 m0, s39, 49152
s_lshl_b32 s37, s42, 17
buffer_load_dwordx4 v23, s[8:11], s37 offen sc1 lds
s_add_u32 m0, s39, 50176
s_add_u32 s37, s37, s38
buffer_load_dwordx4 v23, s[8:11], s37 offen sc1 lds
s_add_u32 m0, s39, 51200
s_add_u32 s37, s37, s38
buffer_load_dwordx4 v23, s[8:11], s37 offen sc1 lds
s_add_u32 m0, s39, 52224
s_add_u32 s37, s37, s38
buffer_load_dwordx4 v23, s[8:11], s37 offen sc1 lds
s_add_u32 m0, s39, 53248
s_add_u32 s37, s37, s38
buffer_load_dwordx4 v23, s[8:11], s37 offen sc1 lds
s_add_u32 m0, s39, 54272
s_add_u32 s37, s37, s38
buffer_load_dwordx4 v23, s[8:11], s37 offen sc1 lds
s_add_u32 m0, s39, 55296
s_add_u32 s37, s37, s38
buffer_load_dwordx4 v23, s[8:11], s37 offen sc1 lds
s_add_u32 m0, s39, 56320
s_add_u32 s37, s37, s38
buffer_load_dwordx4 v23, s[8:11], s37 offen sc1 lds
s_add_u32 s42, s42, 1
s_and_b32 s42, s42, 15
s_add_u32 m0, s39, 57344
s_lshl_b32 s37, s42, 17
buffer_load_dwordx4 v23, s[8:11], s37 offen sc1 lds
s_add_u32 m0, s39, 58368
s_add_u32 s37, s37, s38
buffer_load_dwordx4 v23, s[8:11], s37 offen sc1 lds
s_add_u32 m0, s39, 59392
s_add_u32 s37, s37, s38
buffer_load_dwordx4 v23, s[8:11], s37 offen sc1 lds
s_add_u32 m0, s39, 60416
s_add_u32 s37, s37, s38
buffer_load_dwordx4 v23, s[8:11], s37 offen sc1 lds
s_add_u32 m0, s39, 61440
s_add_u32 s37, s37, s38
buffer_load_dwordx4 v23, s[8:11], s37 offen sc1 lds
s_add_u32 m0, s39, 62464
s_add_u32 s37, s37, s38
buffer_load_dwordx4 v23, s[8:11], s37 offen sc1 lds
s_add_u32 m0, s39, 63488
s_add_u32 s37, s37, s38
buffer_load_dwordx4 v23, s[8:11], s37 offen sc1 lds
s_add_u32 m0, s39, 64512
s_add_u32 s37, s37, s38
buffer_load_dwordx4 v23, s[8:11], s37 offen sc1 lds
s_add_u32 s42, s42, 1
s_and_b32 s42, s42, 15
s_add_u32 m0, s39, 65536
s_lshl_b32 s37, s42, 17
buffer_load_dwordx4 v23, s[8:11], s37 offen sc1 lds
s_add_u32 m0, s39, 66560
s_add_u32 s37, s37, s38
buffer_load_dwordx4 v23, s[8:11], s37 offen sc1 lds
s_add_u32 m0, s39, 67584
s_add_u32 s37, s37, s38
buffer_load_dwordx4 v23, s[8:11], s37 offen sc1 lds
s_add_u32 m0, s39, 68608
s_add_u32 s37, s37, s38
buffer_load_dwordx4 v23, s[8:11], s37 offen sc1 lds
s_add_u32 m0, s39, 69632
s_add_u32 s37, s37, s38
buffer_load_dwordx4 v23, s[8:11], s37 offen sc1 lds
s_add_u32 m0, s39, 70656
s_add_u32 s37, s37, s38
buffer_load_dwordx4 v23, s[8:11], s37 offen sc1 lds
s_add_u32 m0, s39, 71680
s_add_u32 s37, s37, s38
buffer_load_dwordx4 v23, s[8:11], s37 offen sc1 lds
s_add_u32 m0, s39, 72704
s_add_u32 s37, s37, s38
buffer_load_dwordx4 v23, s[8:11], s37 offen sc1 lds
s_add_u32 s42, s42, 1
s_and_b32 s42, s42, 15
s_add_u32 m0, s39, 73728
s_lshl_b32 s37, s42, 17
buffer_load_dwordx4 v23, s[8:11], s37 offen sc1 lds
s_add_u32 m0, s39, 74752
s_add_u32 s37, s37, s38
buffer_load_dwordx4 v23, s[8:11], s37 offen sc1 lds
s_add_u32 m0, s39, 75776
s_add_u32 s37, s37, s38
buffer_load_dwordx4 v23, s[8:11], s37 offen sc1 lds
s_add_u32 m0, s39, 76800
s_add_u32 s37, s37, s38
buffer_load_dwordx4 v23, s[8:11], s37 offen sc1 lds
s_add_u32 m0, s39, 77824
s_add_u32 s37, s37, s38
buffer_load_dwordx4 v23, s[8:11], s37 offen sc1 lds
s_add_u32 m0, s39, 78848
s_add_u32 s37, s37, s38
buffer_load_dwordx4 v23, s[8:11], s37 offen sc1 lds
s_add_u32 m0, s39, 79872
s_add_u32 s37, s37, s38
buffer_load_dwordx4 v23, s[8:11], s37 offen sc1 lds
s_add_u32 m0, s39, 80896
s_add_u32 s37, s37, s38
buffer_load_dwordx4 v23, s[8:11], s37 offen sc1 lds
s_waitcnt vmcnt(24)
s_waitcnt lgkmcnt(0)
s_barrier
s_add_u32 m0, s54, 16384
s_add_u32 s43, s30, 0
buffer_load_dwordx4 v21, s[12:15], s43 offen sc1 lds
s_add_u32 m0, s54, 17408
s_add_u32 s43, s30, 1024
buffer_load_dwordx4 v21, s[12:15], s43 offen sc1 lds
s_add_u32 m0, s54, 32768
s_add_u32 s43, s31, 0
buffer_load_dwordx4 v21, s[12:15], s43 offen sc1 lds
s_add_u32 m0, s54, 33792
s_add_u32 s43, s31, 1024
buffer_load_dwordx4 v21, s[12:15], s43 offen sc1 lds
s_add_u32 s42, s42, 1
s_and_b32 s42, s42, 15
s_add_u32 m0, s39, 81920
s_lshl_b32 s37, s42, 17
buffer_load_dwordx4 v23, s[8:11], s37 offen sc1 lds
s_add_u32 m0, s39, 82944
s_add_u32 s37, s37, s38
buffer_load_dwordx4 v23, s[8:11], s37 offen sc1 lds
s_add_u32 m0, s39, 83968
s_add_u32 s37, s37, s38
buffer_load_dwordx4 v23, s[8:11], s37 offen sc1 lds
s_add_u32 m0, s39, 84992
s_add_u32 s37, s37, s38
buffer_load_dwordx4 v23, s[8:11], s37 offen sc1 lds
s_add_u32 m0, s39, 86016
s_add_u32 s37, s37, s38
buffer_load_dwordx4 v23, s[8:11], s37 offen sc1 lds
s_add_u32 m0, s39, 87040
s_add_u32 s37, s37, s38
buffer_load_dwordx4 v23, s[8:11], s37 offen sc1 lds
s_add_u32 m0, s39, 88064
s_add_u32 s37, s37, s38
buffer_load_dwordx4 v23, s[8:11], s37 offen sc1 lds
s_add_u32 m0, s39, 89088
s_add_u32 s37, s37, s38
buffer_load_dwordx4 v23, s[8:11], s37 offen sc1 lds
s_waitcnt vmcnt(10)
s_barrier
s_add_u32 s42, s42, 1
s_and_b32 s42, s42, 15
s_add_u32 m0, s39, 90112
s_lshl_b32 s37, s42, 17
buffer_load_dwordx4 v23, s[8:11], s37 offen sc1 lds
s_add_u32 m0, s39, 91136
s_add_u32 s37, s37, s38
buffer_load_dwordx4 v23, s[8:11], s37 offen sc1 lds
s_add_u32 m0, s39, 92160
s_add_u32 s37, s37, s38
buffer_load_dwordx4 v23, s[8:11], s37 offen sc1 lds
s_add_u32 m0, s39, 93184
s_add_u32 s37, s37, s38
buffer_load_dwordx4 v23, s[8:11], s37 offen sc1 lds
s_add_u32 m0, s39, 94208
s_add_u32 s37, s37, s38
buffer_load_dwordx4 v23, s[8:11], s37 offen sc1 lds
s_add_u32 m0, s39, 95232
s_add_u32 s37, s37, s38
buffer_load_dwordx4 v23, s[8:11], s37 offen sc1 lds
s_add_u32 m0, s39, 96256
s_add_u32 s37, s37, s38
buffer_load_dwordx4 v23, s[8:11], s37 offen sc1 lds
s_add_u32 m0, s39, 97280
s_add_u32 s37, s37, s38
buffer_load_dwordx4 v23, s[8:11], s37 offen sc1 lds
s_waitcnt vmcnt(16)
s_barrier
s_add_u32 s42, s42, 1
s_and_b32 s42, s42, 15
s_add_u32 m0, s39, 98304
s_lshl_b32 s37, s42, 17
buffer_load_dwordx4 v23, s[8:11], s37 offen sc1 lds
s_add_u32 m0, s39, 99328
s_add_u32 s37, s37, s38
buffer_load_dwordx4 v23, s[8:11], s37 offen sc1 lds
s_add_u32 m0, s39, 100352
s_add_u32 s37, s37, s38
buffer_load_dwordx4 v23, s[8:11], s37 offen sc1 lds
s_add_u32 m0, s39, 101376
s_add_u32 s37, s37, s38
buffer_load_dwordx4 v23, s[8:11], s37 offen sc1 lds
s_add_u32 m0, s39, 102400
s_add_u32 s37, s37, s38
buffer_load_dwordx4 v23, s[8:11], s37 offen sc1 lds
s_add_u32 m0, s39, 103424
s_add_u32 s37, s37, s38
buffer_load_dwordx4 v23, s[8:11], s37 offen sc1 lds
s_add_u32 m0, s39, 104448
s_add_u32 s37, s37, s38
buffer_load_dwordx4 v23, s[8:11], s37 offen sc1 lds
s_add_u32 m0, s39, 105472
s_add_u32 s37, s37, s38
buffer_load_dwordx4 v23, s[8:11], s37 offen sc1 lds
s_waitcnt vmcnt(28)
s_barrier
s_add_u32 s42, s42, 1
s_and_b32 s42, s42, 15
s_add_u32 m0, s39, 106496
s_lshl_b32 s37, s42, 17
buffer_load_dwordx4 v23, s[8:11], s37 offen sc1 lds
s_add_u32 m0, s39, 107520
s_add_u32 s37, s37, s38
buffer_load_dwordx4 v23, s[8:11], s37 offen sc1 lds
s_add_u32 m0, s39, 108544
s_add_u32 s37, s37, s38
buffer_load_dwordx4 v23, s[8:11], s37 offen sc1 lds
s_add_u32 m0, s39, 109568
s_add_u32 s37, s37, s38
buffer_load_dwordx4 v23, s[8:11], s37 offen sc1 lds
s_add_u32 m0, s39, 110592
s_add_u32 s37, s37, s38
buffer_load_dwordx4 v23, s[8:11], s37 offen sc1 lds
s_add_u32 m0, s39, 111616
s_add_u32 s37, s37, s38
buffer_load_dwordx4 v23, s[8:11], s37 offen sc1 lds
s_add_u32 m0, s39, 112640
s_add_u32 s37, s37, s38
buffer_load_dwordx4 v23, s[8:11], s37 offen sc1 lds
s_add_u32 m0, s39, 113664
s_add_u32 s37, s37, s38
buffer_load_dwordx4 v23, s[8:11], s37 offen sc1 lds
s_waitcnt vmcnt(24)
s_barrier
s_add_u32 s42, s42, 1
s_and_b32 s42, s42, 15
s_add_u32 m0, s39, 114688
s_lshl_b32 s37, s42, 17
buffer_load_dwordx4 v23, s[8:11], s37 offen sc1 lds
s_add_u32 m0, s39, 115712
s_add_u32 s37, s37, s38
buffer_load_dwordx4 v23, s[8:11], s37 offen sc1 lds
s_add_u32 m0, s39, 116736
s_add_u32 s37, s37, s38
buffer_load_dwordx4 v23, s[8:11], s37 offen sc1 lds
s_add_u32 m0, s39, 117760
s_add_u32 s37, s37, s38
buffer_load_dwordx4 v23, s[8:11], s37 offen sc1 lds
s_add_u32 m0, s39, 118784
s_add_u32 s37, s37, s38
buffer_load_dwordx4 v23, s[8:11], s37 offen sc1 lds
s_add_u32 m0, s39, 119808
s_add_u32 s37, s37, s38
buffer_load_dwordx4 v23, s[8:11], s37 offen sc1 lds
s_add_u32 m0, s39, 120832
s_add_u32 s37, s37, s38
buffer_load_dwordx4 v23, s[8:11], s37 offen sc1 lds
s_add_u32 m0, s39, 121856
s_add_u32 s37, s37, s38
buffer_load_dwordx4 v23, s[8:11], s37 offen sc1 lds
s_waitcnt vmcnt(24)
s_barrier
s_add_u32 s42, s42, 1
s_and_b32 s42, s42, 15
s_add_u32 m0, s39, 122880
s_lshl_b32 s37, s42, 17
buffer_load_dwordx4 v23, s[8:11], s37 offen sc1 lds
s_add_u32 m0, s39, 123904
s_add_u32 s37, s37, s38
buffer_load_dwordx4 v23, s[8:11], s37 offen sc1 lds
s_add_u32 m0, s39, 124928
s_add_u32 s37, s37, s38
buffer_load_dwordx4 v23, s[8:11], s37 offen sc1 lds
s_add_u32 m0, s39, 125952
s_add_u32 s37, s37, s38
buffer_load_dwordx4 v23, s[8:11], s37 offen sc1 lds
s_add_u32 m0, s39, 126976
s_add_u32 s37, s37, s38
buffer_load_dwordx4 v23, s[8:11], s37 offen sc1 lds
s_add_u32 m0, s39, 128000
s_add_u32 s37, s37, s38
buffer_load_dwordx4 v23, s[8:11], s37 offen sc1 lds
s_add_u32 m0, s39, 129024
s_add_u32 s37, s37, s38
buffer_load_dwordx4 v23, s[8:11], s37 offen sc1 lds
s_add_u32 m0, s39, 130048
s_add_u32 s37, s37, s38
buffer_load_dwordx4 v23, s[8:11], s37 offen sc1 lds
s_waitcnt vmcnt(24)
s_barrier
s_add_u32 s42, s42, 1
s_and_b32 s42, s42, 15
s_add_u32 m0, s39, 49152
s_lshl_b32 s37, s42, 17
buffer_load_dwordx4 v23, s[8:11], s37 offen sc1 lds
s_add_u32 m0, s39, 50176
s_add_u32 s37, s37, s38
buffer_load_dwordx4 v23, s[8:11], s37 offen sc1 lds
s_add_u32 m0, s39, 51200
s_add_u32 s37, s37, s38
buffer_load_dwordx4 v23, s[8:11], s37 offen sc1 lds
s_add_u32 m0, s39, 52224
s_add_u32 s37, s37, s38
buffer_load_dwordx4 v23, s[8:11], s37 offen sc1 lds
s_add_u32 m0, s39, 53248
s_add_u32 s37, s37, s38
buffer_load_dwordx4 v23, s[8:11], s37 offen sc1 lds
s_add_u32 m0, s39, 54272
s_add_u32 s37, s37, s38
buffer_load_dwordx4 v23, s[8:11], s37 offen sc1 lds
s_add_u32 m0, s39, 55296
s_add_u32 s37, s37, s38
buffer_load_dwordx4 v23, s[8:11], s37 offen sc1 lds
s_add_u32 m0, s39, 56320
s_add_u32 s37, s37, s38
buffer_load_dwordx4 v23, s[8:11], s37 offen sc1 lds
s_waitcnt vmcnt(24)
s_barrier
s_add_u32 s42, s42, 1
s_and_b32 s42, s42, 15
s_add_u32 m0, s39, 57344
s_lshl_b32 s37, s42, 17
buffer_load_dwordx4 v23, s[8:11], s37 offen sc1 lds
s_add_u32 m0, s39, 58368
s_add_u32 s37, s37, s38
buffer_load_dwordx4 v23, s[8:11], s37 offen sc1 lds
s_add_u32 m0, s39, 59392
s_add_u32 s37, s37, s38
buffer_load_dwordx4 v23, s[8:11], s37 offen sc1 lds
s_add_u32 m0, s39, 60416
s_add_u32 s37, s37, s38
buffer_load_dwordx4 v23, s[8:11], s37 offen sc1 lds
s_add_u32 m0, s39, 61440
s_add_u32 s37, s37, s38
buffer_load_dwordx4 v23, s[8:11], s37 offen sc1 lds
s_add_u32 m0, s39, 62464
s_add_u32 s37, s37, s38
buffer_load_dwordx4 v23, s[8:11], s37 offen sc1 lds
s_add_u32 m0, s39, 63488
s_add_u32 s37, s37, s38
buffer_load_dwordx4 v23, s[8:11], s37 offen sc1 lds
s_add_u32 m0, s39, 64512
s_add_u32 s37, s37, s38
buffer_load_dwordx4 v23, s[8:11], s37 offen sc1 lds
s_waitcnt vmcnt(24)
s_barrier
s_add_u32 s42, s42, 1
s_and_b32 s42, s42, 15
s_add_u32 m0, s39, 65536
s_lshl_b32 s37, s42, 17
buffer_load_dwordx4 v23, s[8:11], s37 offen sc1 lds
s_add_u32 m0, s39, 66560
s_add_u32 s37, s37, s38
buffer_load_dwordx4 v23, s[8:11], s37 offen sc1 lds
s_add_u32 m0, s39, 67584
s_add_u32 s37, s37, s38
buffer_load_dwordx4 v23, s[8:11], s37 offen sc1 lds
s_add_u32 m0, s39, 68608
s_add_u32 s37, s37, s38
buffer_load_dwordx4 v23, s[8:11], s37 offen sc1 lds
s_add_u32 m0, s39, 69632
s_add_u32 s37, s37, s38
buffer_load_dwordx4 v23, s[8:11], s37 offen sc1 lds
s_add_u32 m0, s39, 70656
s_add_u32 s37, s37, s38
buffer_load_dwordx4 v23, s[8:11], s37 offen sc1 lds
s_add_u32 m0, s39, 71680
s_add_u32 s37, s37, s38
buffer_load_dwordx4 v23, s[8:11], s37 offen sc1 lds
s_add_u32 m0, s39, 72704
s_add_u32 s37, s37, s38
buffer_load_dwordx4 v23, s[8:11], s37 offen sc1 lds
s_waitcnt vmcnt(24)
s_barrier
s_add_u32 s42, s42, 1
s_and_b32 s42, s42, 15
s_add_u32 m0, s39, 73728
s_lshl_b32 s37, s42, 17
buffer_load_dwordx4 v23, s[8:11], s37 offen sc1 lds
s_add_u32 m0, s39, 74752
s_add_u32 s37, s37, s38
buffer_load_dwordx4 v23, s[8:11], s37 offen sc1 lds
s_add_u32 m0, s39, 75776
s_add_u32 s37, s37, s38
buffer_load_dwordx4 v23, s[8:11], s37 offen sc1 lds
s_add_u32 m0, s39, 76800
s_add_u32 s37, s37, s38
buffer_load_dwordx4 v23, s[8:11], s37 offen sc1 lds
s_add_u32 m0, s39, 77824
s_add_u32 s37, s37, s38
buffer_load_dwordx4 v23, s[8:11], s37 offen sc1 lds
s_add_u32 m0, s39, 78848
s_add_u32 s37, s37, s38
buffer_load_dwordx4 v23, s[8:11], s37 offen sc1 lds
s_add_u32 m0, s39, 79872
s_add_u32 s37, s37, s38
buffer_load_dwordx4 v23, s[8:11], s37 offen sc1 lds
s_add_u32 m0, s39, 80896
s_add_u32 s37, s37, s38
buffer_load_dwordx4 v23, s[8:11], s37 offen sc1 lds
s_waitcnt vmcnt(24)
s_barrier
s_add_u32 s42, s42, 1
s_and_b32 s42, s42, 15
s_add_u32 m0, s39, 81920
s_lshl_b32 s37, s42, 17
buffer_load_dwordx4 v23, s[8:11], s37 offen sc1 lds
s_add_u32 m0, s39, 82944
s_add_u32 s37, s37, s38
buffer_load_dwordx4 v23, s[8:11], s37 offen sc1 lds
s_add_u32 m0, s39, 83968
s_add_u32 s37, s37, s38
buffer_load_dwordx4 v23, s[8:11], s37 offen sc1 lds
s_add_u32 m0, s39, 84992
s_add_u32 s37, s37, s38
buffer_load_dwordx4 v23, s[8:11], s37 offen sc1 lds
s_add_u32 m0, s39, 86016
s_add_u32 s37, s37, s38
buffer_load_dwordx4 v23, s[8:11], s37 offen sc1 lds
s_add_u32 m0, s39, 87040
s_add_u32 s37, s37, s38
buffer_load_dwordx4 v23, s[8:11], s37 offen sc1 lds
s_add_u32 m0, s39, 88064
s_add_u32 s37, s37, s38
buffer_load_dwordx4 v23, s[8:11], s37 offen sc1 lds
s_add_u32 m0, s39, 89088
s_add_u32 s37, s37, s38
buffer_load_dwordx4 v23, s[8:11], s37 offen sc1 lds
s_waitcnt vmcnt(24)
s_barrier
s_add_u32 s42, s42, 1
s_and_b32 s42, s42, 15
s_add_u32 m0, s39, 90112
s_lshl_b32 s37, s42, 17
buffer_load_dwordx4 v23, s[8:11], s37 offen sc1 lds
s_add_u32 m0, s39, 91136
s_add_u32 s37, s37, s38
buffer_load_dwordx4 v23, s[8:11], s37 offen sc1 lds
s_add_u32 m0, s39, 92160
s_add_u32 s37, s37, s38
buffer_load_dwordx4 v23, s[8:11], s37 offen sc1 lds
s_add_u32 m0, s39, 93184
s_add_u32 s37, s37, s38
buffer_load_dwordx4 v23, s[8:11], s37 offen sc1 lds
s_add_u32 m0, s39, 94208
s_add_u32 s37, s37, s38
buffer_load_dwordx4 v23, s[8:11], s37 offen sc1 lds
s_add_u32 m0, s39, 95232
s_add_u32 s37, s37, s38
buffer_load_dwordx4 v23, s[8:11], s37 offen sc1 lds
s_add_u32 m0, s39, 96256
s_add_u32 s37, s37, s38
buffer_load_dwordx4 v23, s[8:11], s37 offen sc1 lds
s_add_u32 m0, s39, 97280
s_add_u32 s37, s37, s38
buffer_load_dwordx4 v23, s[8:11], s37 offen sc1 lds
s_waitcnt vmcnt(24)
s_barrier
s_lshl_b32 s43, s35, 8
s_cmp_eq_u32 s51, 1
s_cselect_b32 s8, s4, s6
s_cselect_b32 s9, s5, s7
s_sub_u32 s10, 7340032, s43
s_lshl_b32 s44, s34, 18
s_add_u32 s44, s44, 4194304
s_movk_i32 s38, 28672
s_cmp_eq_u32 s51, 0
s_cselect_b32 s8, s32, s8
s_cselect_b32 s9, s33, s9
s_cselect_b32 s10, 262144, s10
s_cselect_b32 s43, s44, s43
s_cselect_b32 s38, 1024, s38
s_cselect_b32 s45, 0, -1
s_add_u32 s8, s8, s43
s_addc_u32 s9, s9, 0
s_mov_b32 s11, 0x20000
s_lshl_b32 s40, s38, 4
s_add_u32 s42, s35, 15
s_lshl_b32 s39, s51, 14
v_lshrrev_b32 v19, 4, v1
v_lshlrev_b32 v20, 5, v19
v_mul_u32_u24 v19, 6912, v19
v_and_b32 v19, s45, v19
v_and_b32 v20, s45, v20
v_lshlrev_b32 v21, 4, v1
v_xor_b32 v21, v21, v20
v_add_u32 v22, v21, v19
s_and_b32 s45, s45, 128
v_xor_b32 v23, s45, v22
s_waitcnt vmcnt(16)
s_barrier
s_add_u32 s42, s42, 1
s_and_b32 s42, s42, 15
s_add_u32 m0, s39, 98304
s_mul_i32 s37, s42, s40
buffer_load_dwordx4 v22, s[8:11], s37 offen sc1 lds
s_add_u32 m0, s39, 99328
s_add_u32 s37, s37, s38
buffer_load_dwordx4 v23, s[8:11], s37 offen sc1 lds
s_add_u32 m0, s39, 100352
s_add_u32 s37, s37, s38
buffer_load_dwordx4 v22, s[8:11], s37 offen sc1 lds
s_add_u32 m0, s39, 101376
s_add_u32 s37, s37, s38
buffer_load_dwordx4 v23, s[8:11], s37 offen sc1 lds
s_add_u32 m0, s39, 102400
s_add_u32 s37, s37, s38
buffer_load_dwordx4 v22, s[8:11], s37 offen sc1 lds
s_add_u32 m0, s39, 103424
s_add_u32 s37, s37, s38
buffer_load_dwordx4 v23, s[8:11], s37 offen sc1 lds
s_add_u32 m0, s39, 104448
s_add_u32 s37, s37, s38
buffer_load_dwordx4 v22, s[8:11], s37 offen sc1 lds
s_add_u32 m0, s39, 105472
s_add_u32 s37, s37, s38
buffer_load_dwordx4 v23, s[8:11], s37 offen sc1 lds
s_add_u32 m0, s39, 106496
s_add_u32 s37, s37, s38
buffer_load_dwordx4 v22, s[8:11], s37 offen sc1 lds
s_add_u32 m0, s39, 107520
s_add_u32 s37, s37, s38
buffer_load_dwordx4 v23, s[8:11], s37 offen sc1 lds
s_add_u32 m0, s39, 108544
s_add_u32 s37, s37, s38
buffer_load_dwordx4 v22, s[8:11], s37 offen sc1 lds
s_add_u32 m0, s39, 109568
s_add_u32 s37, s37, s38
buffer_load_dwordx4 v23, s[8:11], s37 offen sc1 lds
s_add_u32 m0, s39, 110592
s_add_u32 s37, s37, s38
buffer_load_dwordx4 v22, s[8:11], s37 offen sc1 lds
s_add_u32 m0, s39, 111616
s_add_u32 s37, s37, s38
buffer_load_dwordx4 v23, s[8:11], s37 offen sc1 lds
s_add_u32 m0, s39, 112640
s_add_u32 s37, s37, s38
buffer_load_dwordx4 v22, s[8:11], s37 offen sc1 lds
s_add_u32 m0, s39, 113664
s_add_u32 s37, s37, s38
buffer_load_dwordx4 v23, s[8:11], s37 offen sc1 lds
s_waitcnt vmcnt(24)
s_barrier
s_waitcnt vmcnt(16)
s_barrier
s_add_u32 s42, s42, 1
s_and_b32 s42, s42, 15
s_add_u32 m0, s39, 0
s_mul_i32 s37, s42, s40
buffer_load_dwordx4 v22, s[8:11], s37 offen sc1 lds
s_add_u32 m0, s39, 1024
s_add_u32 s37, s37, s38
buffer_load_dwordx4 v23, s[8:11], s37 offen sc1 lds
s_add_u32 m0, s39, 2048
s_add_u32 s37, s37, s38
buffer_load_dwordx4 v22, s[8:11], s37 offen sc1 lds
s_add_u32 m0, s39, 3072
s_add_u32 s37, s37, s38
buffer_load_dwordx4 v23, s[8:11], s37 offen sc1 lds
s_add_u32 m0, s39, 4096
s_add_u32 s37, s37, s38
buffer_load_dwordx4 v22, s[8:11], s37 offen sc1 lds
s_add_u32 m0, s39, 5120
s_add_u32 s37, s37, s38
buffer_load_dwordx4 v23, s[8:11], s37 offen sc1 lds
s_add_u32 m0, s39, 6144
s_add_u32 s37, s37, s38
buffer_load_dwordx4 v22, s[8:11], s37 offen sc1 lds
s_add_u32 m0, s39, 7168
s_add_u32 s37, s37, s38
buffer_load_dwordx4 v23, s[8:11], s37 offen sc1 lds
s_add_u32 m0, s39, 8192
s_add_u32 s37, s37, s38
buffer_load_dwordx4 v22, s[8:11], s37 offen sc1 lds
s_add_u32 m0, s39, 9216
s_add_u32 s37, s37, s38
buffer_load_dwordx4 v23, s[8:11], s37 offen sc1 lds
s_add_u32 m0, s39, 10240
s_add_u32 s37, s37, s38
buffer_load_dwordx4 v22, s[8:11], s37 offen sc1 lds
s_add_u32 m0, s39, 11264
s_add_u32 s37, s37, s38
buffer_load_dwordx4 v23, s[8:11], s37 offen sc1 lds
s_add_u32 m0, s39, 12288
s_add_u32 s37, s37, s38
buffer_load_dwordx4 v22, s[8:11], s37 offen sc1 lds
s_add_u32 m0, s39, 13312
s_add_u32 s37, s37, s38
buffer_load_dwordx4 v23, s[8:11], s37 offen sc1 lds
s_add_u32 m0, s39, 14336
s_add_u32 s37, s37, s38
buffer_load_dwordx4 v22, s[8:11], s37 offen sc1 lds
s_add_u32 m0, s39, 15360
s_add_u32 s37, s37, s38
buffer_load_dwordx4 v23, s[8:11], s37 offen sc1 lds
s_barrier
s_waitcnt vmcnt(16)
s_barrier
s_add_u32 s42, s42, 1
s_and_b32 s42, s42, 15
s_add_u32 m0, s39, 49152
s_mul_i32 s37, s42, s40
buffer_load_dwordx4 v22, s[8:11], s37 offen sc1 lds
s_add_u32 m0, s39, 50176
s_add_u32 s37, s37, s38
buffer_load_dwordx4 v23, s[8:11], s37 offen sc1 lds
s_add_u32 m0, s39, 51200
s_add_u32 s37, s37, s38
buffer_load_dwordx4 v22, s[8:11], s37 offen sc1 lds
s_add_u32 m0, s39, 52224
s_add_u32 s37, s37, s38
buffer_load_dwordx4 v23, s[8:11], s37 offen sc1 lds
s_add_u32 m0, s39, 53248
s_add_u32 s37, s37, s38
buffer_load_dwordx4 v22, s[8:11], s37 offen sc1 lds
s_add_u32 m0, s39, 54272
s_add_u32 s37, s37, s38
buffer_load_dwordx4 v23, s[8:11], s37 offen sc1 lds
s_add_u32 m0, s39, 55296
s_add_u32 s37, s37, s38
buffer_load_dwordx4 v22, s[8:11], s37 offen sc1 lds
s_add_u32 m0, s39, 56320
s_add_u32 s37, s37, s38
buffer_load_dwordx4 v23, s[8:11], s37 offen sc1 lds
s_add_u32 m0, s39, 57344
s_add_u32 s37, s37, s38
buffer_load_dwordx4 v22, s[8:11], s37 offen sc1 lds
s_add_u32 m0, s39, 58368
s_add_u32 s37, s37, s38
buffer_load_dwordx4 v23, s[8:11], s37 offen sc1 lds
s_add_u32 m0, s39, 59392
s_add_u32 s37, s37, s38
buffer_load_dwordx4 v22, s[8:11], s37 offen sc1 lds
s_add_u32 m0, s39, 60416
s_add_u32 s37, s37, s38
buffer_load_dwordx4 v23, s[8:11], s37 offen sc1 lds
s_add_u32 m0, s39, 61440
s_add_u32 s37, s37, s38
buffer_load_dwordx4 v22, s[8:11], s37 offen sc1 lds
s_add_u32 m0, s39, 62464
s_add_u32 s37, s37, s38
buffer_load_dwordx4 v23, s[8:11], s37 offen sc1 lds
s_add_u32 m0, s39, 63488
s_add_u32 s37, s37, s38
buffer_load_dwordx4 v22, s[8:11], s37 offen sc1 lds
s_add_u32 m0, s39, 64512
s_add_u32 s37, s37, s38
buffer_load_dwordx4 v23, s[8:11], s37 offen sc1 lds
.p2align 3
LP3_101:
s_mul_i32 s43, s2, 28672
s_mul_i32 s44, s51, 7168
s_add_u32 s43, s43, s44
s_add_u32 s80, s60, s43
s_addc_u32 s81, s61, 0
s_waitcnt vmcnt(16)
s_barrier
s_add_u32 s42, s42, 1
s_and_b32 s42, s42, 15
s_add_u32 m0, s39, 98304
s_mul_i32 s37, s42, s40
buffer_load_dwordx4 v22, s[8:11], s37 offen sc1 lds
s_add_u32 m0, s39, 99328
s_add_u32 s37, s37, s38
buffer_load_dwordx4 v23, s[8:11], s37 offen sc1 lds
s_add_u32 m0, s39, 100352
s_add_u32 s37, s37, s38
buffer_load_dwordx4 v22, s[8:11], s37 offen sc1 lds
s_add_u32 m0, s39, 101376
s_add_u32 s37, s37, s38
buffer_load_dwordx4 v23, s[8:11], s37 offen sc1 lds
s_add_u32 m0, s39, 102400
s_add_u32 s37, s37, s38
buffer_load_dwordx4 v22, s[8:11], s37 offen sc1 lds
s_add_u32 m0, s39, 103424
s_add_u32 s37, s37, s38
buffer_load_dwordx4 v23, s[8:11], s37 offen sc1 lds
s_add_u32 m0, s39, 104448
s_add_u32 s37, s37, s38
buffer_load_dwordx4 v22, s[8:11], s37 offen sc1 lds
s_add_u32 m0, s39, 105472
s_add_u32 s37, s37, s38
buffer_load_dwordx4 v23, s[8:11], s37 offen sc1 lds
s_add_u32 m0, s39, 106496
s_add_u32 s37, s37, s38
buffer_load_dwordx4 v22, s[8:11], s37 offen sc1 lds
s_add_u32 m0, s39, 107520
s_add_u32 s37, s37, s38
buffer_load_dwordx4 v23, s[8:11], s37 offen sc1 lds
s_add_u32 m0, s39, 108544
s_add_u32 s37, s37, s38
buffer_load_dwordx4 v22, s[8:11], s37 offen sc1 lds
s_add_u32 m0, s39, 109568
s_add_u32 s37, s37, s38
buffer_load_dwordx4 v23, s[8:11], s37 offen sc1 lds
s_add_u32 m0, s39, 110592
s_add_u32 s37, s37, s38
buffer_load_dwordx4 v22, s[8:11], s37 offen sc1 lds
s_add_u32 m0, s39, 111616
s_add_u32 s37, s37, s38
buffer_load_dwordx4 v23, s[8:11], s37 offen sc1 lds
s_add_u32 m0, s39, 112640
s_add_u32 s37, s37, s38
buffer_load_dwordx4 v22, s[8:11], s37 offen sc1 lds
s_add_u32 m0, s39, 113664
s_add_u32 s37, s37, s38
buffer_load_dwordx4 v23, s[8:11], s37 offen sc1 lds
s_load_dword s64, s[80:81], 0
s_load_dword s65, s[80:81], 64
s_load_dword s66, s[80:81], 128
s_load_dword s67, s[80:81], 192
s_load_dword s68, s[80:81], 256
s_load_dword s69, s[80:81], 320
s_load_dword s70, s[80:81], 384
s_load_dword s71, s[80:81], 448
s_load_dword s72, s[80:81], 512
s_add_u32 s80, s80, 576
s_addc_u32 s81, s81, 0
s_waitcnt vmcnt(16)
s_barrier
s_mov_b32 s41, 2
.p2align 3
Lp3_108:
s_add_u32 s42, s42, 1
s_and_b32 s42, s42, 15
s_add_u32 m0, s39, 0
s_mul_i32 s37, s42, s40
buffer_load_dwordx4 v22, s[8:11], s37 offen sc1 lds
s_add_u32 m0, s39, 1024
s_add_u32 s37, s37, s38
buffer_load_dwordx4 v23, s[8:11], s37 offen sc1 lds
s_add_u32 m0, s39, 2048
s_add_u32 s37, s37, s38
buffer_load_dwordx4 v22, s[8:11], s37 offen sc1 lds
s_add_u32 m0, s39, 3072
s_add_u32 s37, s37, s38
buffer_load_dwordx4 v23, s[8:11], s37 offen sc1 lds
s_add_u32 m0, s39, 4096
s_add_u32 s37, s37, s38
buffer_load_dwordx4 v22, s[8:11], s37 offen sc1 lds
s_add_u32 m0, s39, 5120
s_add_u32 s37, s37, s38
buffer_load_dwordx4 v23, s[8:11], s37 offen sc1 lds
s_add_u32 m0, s39, 6144
s_add_u32 s37, s37, s38
buffer_load_dwordx4 v22, s[8:11], s37 offen sc1 lds
s_add_u32 m0, s39, 7168
s_add_u32 s37, s37, s38
buffer_load_dwordx4 v23, s[8:11], s37 offen sc1 lds
s_add_u32 m0, s39, 8192
s_add_u32 s37, s37, s38
buffer_load_dwordx4 v22, s[8:11], s37 offen sc1 lds
s_add_u32 m0, s39, 9216
s_add_u32 s37, s37, s38
buffer_load_dwordx4 v23, s[8:11], s37 offen sc1 lds
s_add_u32 m0, s39, 10240
s_add_u32 s37, s37, s38
buffer_load_dwordx4 v22, s[8:11], s37 offen sc1 lds
s_add_u32 m0, s39, 11264
s_add_u32 s37, s37, s38
buffer_load_dwordx4 v23, s[8:11], s37 offen sc1 lds
s_add_u32 m0, s39, 12288
s_add_u32 s37, s37, s38
buffer_load_dwordx4 v22, s[8:11], s37 offen sc1 lds
s_add_u32 m0, s39, 13312
s_add_u32 s37, s37, s38
buffer_load_dwordx4 v23, s[8:11], s37 offen sc1 lds
s_add_u32 m0, s39, 14336
s_add_u32 s37, s37, s38
buffer_load_dwordx4 v22, s[8:11], s37 offen sc1 lds
s_add_u32 m0, s39, 15360
s_add_u32 s37, s37, s38
buffer_load_dwordx4 v23, s[8:11], s37 offen sc1 lds
s_load_dword s64, s[80:81], 0
s_load_dword s65, s[80:81], 64
s_load_dword s66, s[80:81], 128
s_load_dword s67, s[80:81], 192
s_load_dword s68, s[80:81], 256
s_load_dword s69, s[80:81], 320
s_load_dword s70, s[80:81], 384
s_load_dword s71, s[80:81], 448
s_load_dword s72, s[80:81], 512
s_add_u32 s80, s80, 576
s_addc_u32 s81, s81, 0
s_waitcnt vmcnt(16)
s_barrier
s_add_u32 s42, s42, 1
s_and_b32 s42, s42, 15
s_add_u32 m0, s39, 49152
s_mul_i32 s37, s42, s40
buffer_load_dwordx4 v22, s[8:11], s37 offen sc1 lds
s_add_u32 m0, s39, 50176
s_add_u32 s37, s37, s38
buffer_load_dwordx4 v23, s[8:11], s37 offen sc1 lds
s_add_u32 m0, s39, 51200
s_add_u32 s37, s37, s38
buffer_load_dwordx4 v22, s[8:11], s37 offen sc1 lds
s_add_u32 m0, s39, 52224
s_add_u32 s37, s37, s38
buffer_load_dwordx4 v23, s[8:11], s37 offen sc1 lds
s_add_u32 m0, s39, 53248
s_add_u32 s37, s37, s38
buffer_load_dwordx4 v22, s[8:11], s37 offen sc1 lds
s_add_u32 m0, s39, 54272
s_add_u32 s37, s37, s38
buffer_load_dwordx4 v23, s[8:11], s37 offen sc1 lds
s_add_u32 m0, s39, 55296
s_add_u32 s37, s37, s38
buffer_load_dwordx4 v22, s[8:11], s37 offen sc1 lds
s_add_u32 m0, s39, 56320
s_add_u32 s37, s37, s38
buffer_load_dwordx4 v23, s[8:11], s37 offen sc1 lds
s_add_u32 m0, s39, 57344
s_add_u32 s37, s37, s38
buffer_load_dwordx4 v22, s[8:11], s37 offen sc1 lds
s_add_u32 m0, s39, 58368
s_add_u32 s37, s37, s38
buffer_load_dwordx4 v23, s[8:11], s37 offen sc1 lds
s_add_u32 m0, s39, 59392
s_add_u32 s37, s37, s38
buffer_load_dwordx4 v22, s[8:11], s37 offen sc1 lds
s_add_u32 m0, s39, 60416
s_add_u32 s37, s37, s38
buffer_load_dwordx4 v23, s[8:11], s37 offen sc1 lds
s_add_u32 m0, s39, 61440
s_add_u32 s37, s37, s38
buffer_load_dwordx4 v22, s[8:11], s37 offen sc1 lds
s_add_u32 m0, s39, 62464
s_add_u32 s37, s37, s38
buffer_load_dwordx4 v23, s[8:11], s37 offen sc1 lds
s_add_u32 m0, s39, 63488
s_add_u32 s37, s37, s38
buffer_load_dwordx4 v22, s[8:11], s37 offen sc1 lds
s_add_u32 m0, s39, 64512
s_add_u32 s37, s37, s38
buffer_load_dwordx4 v23, s[8:11], s37 offen sc1 lds
s_load_dword s64, s[80:81], 0
s_load_dword s65, s[80:81], 64
s_load_dword s66, s[80:81], 128
s_load_dword s67, s[80:81], 192
s_load_dword s68, s[80:81], 256
s_load_dword s69, s[80:81], 320
s_load_dword s70, s[80:81], 384
s_load_dword s71, s[80:81], 448
s_load_dword s72, s[80:81], 512
s_add_u32 s80, s80, 576
s_addc_u32 s81, s81, 0
s_waitcnt vmcnt(16)
s_barrier
s_add_u32 s42, s42, 1
s_and_b32 s42, s42, 15
s_add_u32 m0, s39, 98304
s_mul_i32 s37, s42, s40
buffer_load_dwordx4 v22, s[8:11], s37 offen sc1 lds
s_add_u32 m0, s39, 99328
s_add_u32 s37, s37, s38
buffer_load_dwordx4 v23, s[8:11], s37 offen sc1 lds
s_add_u32 m0, s39, 100352
s_add_u32 s37, s37, s38
buffer_load_dwordx4 v22, s[8:11], s37 offen sc1 lds
s_add_u32 m0, s39, 101376
s_add_u32 s37, s37, s38
buffer_load_dwordx4 v23, s[8:11], s37 offen sc1 lds
s_add_u32 m0, s39, 102400
s_add_u32 s37, s37, s38
buffer_load_dwordx4 v22, s[8:11], s37 offen sc1 lds
s_add_u32 m0, s39, 103424
s_add_u32 s37, s37, s38
buffer_load_dwordx4 v23, s[8:11], s37 offen sc1 lds
s_add_u32 m0, s39, 104448
s_add_u32 s37, s37, s38
buffer_load_dwordx4 v22, s[8:11], s37 offen sc1 lds
s_add_u32 m0, s39, 105472
s_add_u32 s37, s37, s38
buffer_load_dwordx4 v23, s[8:11], s37 offen sc1 lds
s_add_u32 m0, s39, 106496
s_add_u32 s37, s37, s38
buffer_load_dwordx4 v22, s[8:11], s37 offen sc1 lds
s_add_u32 m0, s39, 107520
s_add_u32 s37, s37, s38
buffer_load_dwordx4 v23, s[8:11], s37 offen sc1 lds
s_add_u32 m0, s39, 108544
s_add_u32 s37, s37, s38
buffer_load_dwordx4 v22, s[8:11], s37 offen sc1 lds
s_add_u32 m0, s39, 109568
s_add_u32 s37, s37, s38
buffer_load_dwordx4 v23, s[8:11], s37 offen sc1 lds
s_add_u32 m0, s39, 110592
s_add_u32 s37, s37, s38
buffer_load_dwordx4 v22, s[8:11], s37 offen sc1 lds
s_add_u32 m0, s39, 111616
s_add_u32 s37, s37, s38
buffer_load_dwordx4 v23, s[8:11], s37 offen sc1 lds
s_add_u32 m0, s39, 112640
s_add_u32 s37, s37, s38
buffer_load_dwordx4 v22, s[8:11], s37 offen sc1 lds
s_add_u32 m0, s39, 113664
s_add_u32 s37, s37, s38
buffer_load_dwordx4 v23, s[8:11], s37 offen sc1 lds
s_load_dword s64, s[80:81], 0
s_load_dword s65, s[80:81], 64
s_load_dword s66, s[80:81], 128
s_load_dword s67, s[80:81], 192
s_load_dword s68, s[80:81], 256
s_load_dword s69, s[80:81], 320
s_load_dword s70, s[80:81], 384
s_load_dword s71, s[80:81], 448
s_load_dword s72, s[80:81], 512
s_add_u32 s80, s80, 576
s_addc_u32 s81, s81, 0
s_waitcnt vmcnt(16)
s_barrier
s_sub_u32 s41, s41, 1
s_cmp_lg_u32 s41, 0
s_cbranch_scc1 Lp3_108
s_add_u32 s42, s42, 1
s_and_b32 s42, s42, 15
s_add_u32 m0, s39, 0
s_mul_i32 s37, s42, s40
buffer_load_dwordx4 v22, s[8:11], s37 offen sc1 lds
s_add_u32 m0, s39, 1024
s_add_u32 s37, s37, s38
buffer_load_dwordx4 v23, s[8:11], s37 offen sc1 lds
s_add_u32 m0, s39, 2048
s_add_u32 s37, s37, s38
buffer_load_dwordx4 v22, s[8:11], s37 offen sc1 lds
s_add_u32 m0, s39, 3072
s_add_u32 s37, s37, s38
buffer_load_dwordx4 v23, s[8:11], s37 offen sc1 lds
s_add_u32 m0, s39, 4096
s_add_u32 s37, s37, s38
buffer_load_dwordx4 v22, s[8:11], s37 offen sc1 lds
s_add_u32 m0, s39, 5120
s_add_u32 s37, s37, s38
buffer_load_dwordx4 v23, s[8:11], s37 offen sc1 lds
s_add_u32 m0, s39, 6144
s_add_u32 s37, s37, s38
buffer_load_dwordx4 v22, s[8:11], s37 offen sc1 lds
s_add_u32 m0, s39, 7168
s_add_u32 s37, s37, s38
buffer_load_dwordx4 v23, s[8:11], s37 offen sc1 lds
s_add_u32 m0, s39, 8192
s_add_u32 s37, s37, s38
buffer_load_dwordx4 v22, s[8:11], s37 offen sc1 lds
s_add_u32 m0, s39, 9216
s_add_u32 s37, s37, s38
buffer_load_dwordx4 v23, s[8:11], s37 offen sc1 lds
s_add_u32 m0, s39, 10240
s_add_u32 s37, s37, s38
buffer_load_dwordx4 v22, s[8:11], s37 offen sc1 lds
s_add_u32 m0, s39, 11264
s_add_u32 s37, s37, s38
buffer_load_dwordx4 v23, s[8:11], s37 offen sc1 lds
s_add_u32 m0, s39, 12288
s_add_u32 s37, s37, s38
buffer_load_dwordx4 v22, s[8:11], s37 offen sc1 lds
s_add_u32 m0, s39, 13312
s_add_u32 s37, s37, s38
buffer_load_dwordx4 v23, s[8:11], s37 offen sc1 lds
s_add_u32 m0, s39, 14336
s_add_u32 s37, s37, s38
buffer_load_dwordx4 v22, s[8:11], s37 offen sc1 lds
s_add_u32 m0, s39, 15360
s_add_u32 s37, s37, s38
buffer_load_dwordx4 v23, s[8:11], s37 offen sc1 lds
s_load_dword s64, s[80:81], 0
s_load_dword s65, s[80:81], 64
s_load_dword s66, s[80:81], 128
s_load_dword s67, s[80:81], 192
s_load_dword s68, s[80:81], 256
s_load_dword s69, s[80:81], 320
s_load_dword s70, s[80:81], 384
s_load_dword s71, s[80:81], 448
s_load_dword s72, s[80:81], 512
s_add_u32 s80, s80, 576
s_addc_u32 s81, s81, 0
s_waitcnt vmcnt(16)
s_barrier
s_add_u32 s42, s42, 1
s_and_b32 s42, s42, 15
s_add_u32 m0, s39, 49152
s_mul_i32 s37, s42, s40
buffer_load_dwordx4 v22, s[8:11], s37 offen sc1 lds
s_add_u32 m0, s39, 50176
s_add_u32 s37, s37, s38
buffer_load_dwordx4 v23, s[8:11], s37 offen sc1 lds
s_add_u32 m0, s39, 51200
s_add_u32 s37, s37, s38
buffer_load_dwordx4 v22, s[8:11], s37 offen sc1 lds
s_add_u32 m0, s39, 52224
s_add_u32 s37, s37, s38
buffer_load_dwordx4 v23, s[8:11], s37 offen sc1 lds
s_add_u32 m0, s39, 53248
s_add_u32 s37, s37, s38
buffer_load_dwordx4 v22, s[8:11], s37 offen sc1 lds
s_add_u32 m0, s39, 54272
s_add_u32 s37, s37, s38
buffer_load_dwordx4 v23, s[8:11], s37 offen sc1 lds
s_add_u32 m0, s39, 55296
s_add_u32 s37, s37, s38
buffer_load_dwordx4 v22, s[8:11], s37 offen sc1 lds
s_add_u32 m0, s39, 56320
s_add_u32 s37, s37, s38
buffer_load_dwordx4 v23, s[8:11], s37 offen sc1 lds
s_add_u32 m0, s39, 57344
s_add_u32 s37, s37, s38
buffer_load_dwordx4 v22, s[8:11], s37 offen sc1 lds
s_add_u32 m0, s39, 58368
s_add_u32 s37, s37, s38
buffer_load_dwordx4 v23, s[8:11], s37 offen sc1 lds
s_add_u32 m0, s39, 59392
s_add_u32 s37, s37, s38
buffer_load_dwordx4 v22, s[8:11], s37 offen sc1 lds
s_add_u32 m0, s39, 60416
s_add_u32 s37, s37, s38
buffer_load_dwordx4 v23, s[8:11], s37 offen sc1 lds
s_add_u32 m0, s39, 61440
s_add_u32 s37, s37, s38
buffer_load_dwordx4 v22, s[8:11], s37 offen sc1 lds
s_add_u32 m0, s39, 62464
s_add_u32 s37, s37, s38
buffer_load_dwordx4 v23, s[8:11], s37 offen sc1 lds
s_add_u32 m0, s39, 63488
s_add_u32 s37, s37, s38
buffer_load_dwordx4 v22, s[8:11], s37 offen sc1 lds
s_add_u32 m0, s39, 64512
s_add_u32 s37, s37, s38
buffer_load_dwordx4 v23, s[8:11], s37 offen sc1 lds
s_load_dword s64, s[80:81], 0
s_load_dword s65, s[80:81], 64
s_load_dword s66, s[80:81], 128
s_load_dword s67, s[80:81], 192
s_load_dword s68, s[80:81], 256
s_load_dword s69, s[80:81], 320
s_load_dword s70, s[80:81], 384
s_load_dword s71, s[80:81], 448
s_load_dword s72, s[80:81], 512
s_add_u32 s80, s80, 576
s_addc_u32 s81, s81, 0
s_waitcnt vmcnt(16)
s_barrier
s_add_u32 s42, s42, 1
s_and_b32 s42, s42, 15
s_add_u32 m0, s39, 98304
s_mul_i32 s37, s42, s40
buffer_load_dwordx4 v22, s[8:11], s37 offen sc1 lds
s_and_b32 s53, s35, 1
s_lshl_b32 s53, s53, 1
s_mul_i32 s43, s47, 3
s_add_u32 m0, s39, 99328
s_add_u32 s37, s37, s38
buffer_load_dwordx4 v23, s[8:11], s37 offen sc1 lds
s_add_u32 s53, s53, s43
v_lshlrev_b32 v19, 11, v18
v_lshl_add_u32 v19, v17, 4, v19
s_add_u32 m0, s39, 100352
s_add_u32 s37, s37, s38
buffer_load_dwordx4 v22, s[8:11], s37 offen sc1 lds
s_lshl_b32 s43, s46, 10
v_add_u32 v2, s43, v19
v_add_u32 v3, 49152, v2
s_add_u32 m0, s39, 101376
s_add_u32 s37, s37, s38
buffer_load_dwordx4 v23, s[8:11], s37 offen sc1 lds
v_add_u32 v4, 98304, v2
v_lshrrev_b32 v19, 2, v17
v_lshl_add_u32 v20, v18, 2, v19
s_add_u32 m0, s39, 102400
s_add_u32 s37, s37, s38
buffer_load_dwordx4 v22, s[8:11], s37 offen sc1 lds
v_and_b32 v21, 7, v20
v_lshlrev_b32 v20, 8, v20
v_and_b32 v19, 3, v1
s_add_u32 m0, s39, 103424
s_add_u32 s37, s37, s38
buffer_load_dwordx4 v23, s[8:11], s37 offen sc1 lds
v_lshl_add_u32 v20, v19, 3, v20
s_add_u32 s43, s53, 0
v_xor_b32 v19, s43, v21
s_add_u32 m0, s39, 104448
s_add_u32 s37, s37, s38
buffer_load_dwordx4 v22, s[8:11], s37 offen sc1 lds
v_lshl_add_u32 v5, v19, 5, v20
s_add_u32 s43, s53, 1
v_xor_b32 v19, s43, v21
s_add_u32 m0, s39, 105472
s_add_u32 s37, s37, s38
buffer_load_dwordx4 v23, s[8:11], s37 offen sc1 lds
v_lshl_add_u32 v6, v19, 5, v20
s_add_u32 s43, s53, 2
v_xor_b32 v19, s43, v21
s_add_u32 m0, s39, 106496
s_add_u32 s37, s37, s38
buffer_load_dwordx4 v22, s[8:11], s37 offen sc1 lds
v_lshl_add_u32 v7, v19, 5, v20
v_add_u32 v9, 49152, v5
v_add_u32 v10, 49152, v6
s_add_u32 m0, s39, 107520
s_add_u32 s37, s37, s38
buffer_load_dwordx4 v23, s[8:11], s37 offen sc1 lds
v_add_u32 v11, 49152, v7
v_add_u32 v13, 98304, v5
v_add_u32 v14, 98304, v6
s_add_u32 m0, s39, 108544
s_add_u32 s37, s37, s38
buffer_load_dwordx4 v22, s[8:11], s37 offen sc1 lds
v_add_u32 v15, 98304, v7
s_lshl_b32 s43, s46, 9
s_add_u32 s43, s43, 147456
s_add_u32 m0, s39, 109568
s_add_u32 s37, s37, s38
buffer_load_dwordx4 v23, s[8:11], s37 offen sc1 lds
v_lshl_add_u32 v19, v17, 3, s43
ds_read_b64 v[80:81], v19 offset:0
ds_read_b64 v[82:83], v19 offset:128
s_add_u32 m0, s39, 110592
s_add_u32 s37, s37, s38
buffer_load_dwordx4 v22, s[8:11], s37 offen sc1 lds
ds_read_b64 v[84:85], v19 offset:256
ds_read_b64 v[86:87], v19 offset:384
s_mul_i32 s43, s47, 192
s_add_u32 m0, s39, 111616
s_add_u32 s37, s37, s38
buffer_load_dwordx4 v23, s[8:11], s37 offen sc1 lds
s_add_u32 s43, s43, 148992
v_lshl_add_u32 v19, v18, 4, s43
ds_read_b128 v[48:51], v19 offset:0
s_add_u32 m0, s39, 112640
s_add_u32 s37, s37, s38
buffer_load_dwordx4 v22, s[8:11], s37 offen sc1 lds
ds_read_b128 v[52:55], v19 offset:64
ds_read_b128 v[56:59], v19 offset:128
ds_read_b128 v[60:63], v19 offset:896
s_add_u32 m0, s39, 113664
s_add_u32 s37, s37, s38
buffer_load_dwordx4 v23, s[8:11], s37 offen sc1 lds
ds_read_b128 v[64:67], v19 offset:960
ds_read_b128 v[68:71], v19 offset:1024
s_waitcnt vmcnt(16)
s_barrier
s_add_u32 s42, s42, 1
s_and_b32 s42, s42, 15
s_add_u32 m0, s39, 0
s_mul_i32 s37, s42, s40
buffer_load_dwordx4 v22, s[8:11], s37 offen sc1 lds
s_waitcnt lgkmcnt(0)
v_mul_f32 v88, v81, v81
s_add_u32 m0, s39, 1024
s_add_u32 s37, s37, s38
buffer_load_dwordx4 v23, s[8:11], s37 offen sc1 lds
v_mul_f32 v228, 0xc0135761, v81
s_add_u32 m0, s39, 2048
s_add_u32 s37, s37, s38
buffer_load_dwordx4 v22, s[8:11], s37 offen sc1 lds
v_mul_f32 v89, 0xbdd2d3e8, v81
s_add_u32 m0, s39, 3072
s_add_u32 s37, s37, s38
buffer_load_dwordx4 v23, s[8:11], s37 offen sc1 lds
v_rcp_f32 v236, v88
v_mul_f32 v232, v89, v88
s_add_u32 m0, s39, 4096
s_add_u32 s37, s37, s38
buffer_load_dwordx4 v22, s[8:11], s37 offen sc1 lds
v_mul_f32 v88, v83, v83
s_add_u32 m0, s39, 5120
s_add_u32 s37, s37, s38
buffer_load_dwordx4 v23, s[8:11], s37 offen sc1 lds
v_mul_f32 v229, 0xc0135761, v83
s_add_u32 m0, s39, 6144
s_add_u32 s37, s37, s38
buffer_load_dwordx4 v22, s[8:11], s37 offen sc1 lds
v_mul_f32 v89, 0xbdd2d3e8, v83
v_rcp_f32 v237, v88
s_add_u32 m0, s39, 7168
s_add_u32 s37, s37, s38
buffer_load_dwordx4 v23, s[8:11], s37 offen sc1 lds
v_mul_f32 v233, v89, v88
s_add_u32 m0, s39, 8192
s_add_u32 s37, s37, s38
buffer_load_dwordx4 v22, s[8:11], s37 offen sc1 lds
v_mul_f32 v88, v85, v85
s_add_u32 m0, s39, 9216
s_add_u32 s37, s37, s38
buffer_load_dwordx4 v23, s[8:11], s37 offen sc1 lds
v_mul_f32 v230, 0xc0135761, v85
v_mul_f32 v89, 0xbdd2d3e8, v85
s_add_u32 m0, s39, 10240
s_add_u32 s37, s37, s38
buffer_load_dwordx4 v22, s[8:11], s37 offen sc1 lds
v_rcp_f32 v238, v88
s_add_u32 m0, s39, 11264
s_add_u32 s37, s37, s38
buffer_load_dwordx4 v23, s[8:11], s37 offen sc1 lds
v_mul_f32 v234, v89, v88
s_add_u32 m0, s39, 12288
s_add_u32 s37, s37, s38
buffer_load_dwordx4 v22, s[8:11], s37 offen sc1 lds
v_mul_f32 v88, v87, v87
v_mul_f32 v231, 0xc0135761, v87
s_add_u32 m0, s39, 13312
s_add_u32 s37, s37, s38
buffer_load_dwordx4 v23, s[8:11], s37 offen sc1 lds
v_mul_f32 v89, 0xbdd2d3e8, v87
s_add_u32 m0, s39, 14336
s_add_u32 s37, s37, s38
buffer_load_dwordx4 v22, s[8:11], s37 offen sc1 lds
v_rcp_f32 v239, v88
s_add_u32 m0, s39, 15360
s_add_u32 s37, s37, s38
buffer_load_dwordx4 v23, s[8:11], s37 offen sc1 lds
v_mul_f32 v235, v89, v88
s_mul_i32 s43, s34, 917504
s_mov_b32 s44, 3577949200
s_mov_b32 s45, 3137247350
s_lshl_b32 s50, s49, 2
s_lshr_b64 s[44:45], s[44:45], s50
s_and_b32 s50, s44, 15
s_mul_i32 s44, s50, 24576
s_add_u32 s43, s43, s44
s_add_u32 s43, s43, 8912896
s_add_u32 s24, s32, s43
s_addc_u32 s25, s33, 0
s_mov_b32 s26, 24576
s_mov_b32 s27, 0x20000
s_mov_b32 s53, 262144
s_lshl_b32 s43, s47, 13
s_lshl_b32 s44, s46, 10
s_add_u32 s43, s43, s44
v_lshlrev_b32 v19, 11, v18
v_lshl_add_u32 v19, v17, 4, v19
v_add_u32 v27, s43, v19
s_lshl_b32 s43, s47, 12
s_add_u32 s43, s43, s44
s_add_u32 s43, s43, 16384
v_and_b32 v19, 1, v18
v_lshlrev_b32 v19, 11, v19
v_lshrrev_b32 v20, 1, v18
v_lshl_add_u32 v19, v20, 8, v19
v_lshl_add_u32 v19, v17, 4, v19
v_add_u32 v28, s43, v19
s_load_dword s64, s[80:81], 0
s_load_dword s65, s[80:81], 64
s_load_dword s66, s[80:81], 128
s_load_dword s67, s[80:81], 192
s_load_dword s68, s[80:81], 256
s_load_dword s69, s[80:81], 320
s_load_dword s70, s[80:81], 384
s_load_dword s71, s[80:81], 448
s_add_u32 s80, s80, 512
s_addc_u32 s81, s81, 0
s_waitcnt vmcnt(16)
s_barrier
s_add_u32 s42, s42, 1
s_and_b32 s42, s42, 15
s_add_u32 m0, s39, 49152
s_mul_i32 s37, s42, s40
buffer_load_dwordx4 v22, s[8:11], s37 offen sc1 lds
v_mul_f32 v128, -v80, v48
v_mul_f32 v129, -v80, v49
s_add_u32 m0, s39, 50176
s_add_u32 s37, s37, s38
buffer_load_dwordx4 v23, s[8:11], s37 offen sc1 lds
v_mul_f32 v130, -v80, v50
v_mul_f32 v131, -v80, v51
s_add_u32 m0, s39, 51200
s_add_u32 s37, s37, s38
buffer_load_dwordx4 v22, s[8:11], s37 offen sc1 lds
v_mul_f32 v132, -v82, v48
v_mul_f32 v133, -v82, v49
s_add_u32 m0, s39, 52224
s_add_u32 s37, s37, s38
buffer_load_dwordx4 v23, s[8:11], s37 offen sc1 lds
v_mul_f32 v134, -v82, v50
v_mul_f32 v135, -v82, v51
s_add_u32 m0, s39, 53248
s_add_u32 s37, s37, s38
buffer_load_dwordx4 v22, s[8:11], s37 offen sc1 lds
v_mul_f32 v136, -v84, v48
v_mul_f32 v137, -v84, v49
s_add_u32 m0, s39, 54272
s_add_u32 s37, s37, s38
buffer_load_dwordx4 v23, s[8:11], s37 offen sc1 lds
v_mul_f32 v138, -v84, v50
v_mul_f32 v139, -v84, v51
s_add_u32 m0, s39, 55296
s_add_u32 s37, s37, s38
buffer_load_dwordx4 v22, s[8:11], s37 offen sc1 lds
v_mul_f32 v140, -v86, v48
v_mul_f32 v141, -v86, v49
s_add_u32 m0, s39, 56320
s_add_u32 s37, s37, s38
buffer_load_dwordx4 v23, s[8:11], s37 offen sc1 lds
v_mul_f32 v142, -v86, v50
v_mul_f32 v143, -v86, v51
s_add_u32 m0, s39, 57344
s_add_u32 s37, s37, s38
buffer_load_dwordx4 v22, s[8:11], s37 offen sc1 lds
v_mul_f32 v144, -v80, v52
v_mul_f32 v145, -v80, v53
s_add_u32 m0, s39, 58368
s_add_u32 s37, s37, s38
buffer_load_dwordx4 v23, s[8:11], s37 offen sc1 lds
v_mul_f32 v146, -v80, v54
v_mul_f32 v147, -v80, v55
s_add_u32 m0, s39, 59392
s_add_u32 s37, s37, s38
buffer_load_dwordx4 v22, s[8:11], s37 offen sc1 lds
v_mul_f32 v148, -v82, v52
v_mul_f32 v149, -v82, v53
s_add_u32 m0, s39, 60416
s_add_u32 s37, s37, s38
buffer_load_dwordx4 v23, s[8:11], s37 offen sc1 lds
v_mul_f32 v150, -v82, v54
v_mul_f32 v151, -v82, v55
s_add_u32 m0, s39, 61440
s_add_u32 s37, s37, s38
buffer_load_dwordx4 v22, s[8:11], s37 offen sc1 lds
v_mul_f32 v152, -v84, v52
v_mul_f32 v153, -v84, v53
s_add_u32 m0, s39, 62464
s_add_u32 s37, s37, s38
buffer_load_dwordx4 v23, s[8:11], s37 offen sc1 lds
v_mul_f32 v154, -v84, v54
v_mul_f32 v155, -v84, v55
s_add_u32 m0, s39, 63488
s_add_u32 s37, s37, s38
buffer_load_dwordx4 v22, s[8:11], s37 offen sc1 lds
v_mul_f32 v156, -v86, v52
v_mul_f32 v157, -v86, v53
s_add_u32 m0, s39, 64512
s_add_u32 s37, s37, s38
buffer_load_dwordx4 v23, s[8:11], s37 offen sc1 lds
v_mul_f32 v158, -v86, v54
v_mul_f32 v159, -v86, v55
s_load_dword s64, s[80:81], 0
s_load_dword s65, s[80:81], 64
s_load_dword s66, s[80:81], 128
s_load_dword s67, s[80:81], 192
s_load_dword s68, s[80:81], 256
s_load_dword s69, s[80:81], 320
s_load_dword s70, s[80:81], 384
s_load_dword s71, s[80:81], 448
s_add_u32 s80, s80, 512
s_addc_u32 s81, s81, 0
s_waitcnt vmcnt(16)
s_barrier
s_add_u32 s42, s42, 1
s_and_b32 s42, s42, 15
s_add_u32 m0, s39, 98304
s_mul_i32 s37, s42, s40
buffer_load_dwordx4 v22, s[8:11], s37 offen sc1 lds
v_mul_f32 v160, -v80, v56
v_mul_f32 v161, -v80, v57
s_add_u32 m0, s39, 99328
s_add_u32 s37, s37, s38
buffer_load_dwordx4 v23, s[8:11], s37 offen sc1 lds
v_mul_f32 v162, -v80, v58
v_mul_f32 v163, -v80, v59
s_add_u32 m0, s39, 100352
s_add_u32 s37, s37, s38
buffer_load_dwordx4 v22, s[8:11], s37 offen sc1 lds
v_mul_f32 v164, -v82, v56
v_mul_f32 v165, -v82, v57
s_add_u32 m0, s39, 101376
s_add_u32 s37, s37, s38
buffer_load_dwordx4 v23, s[8:11], s37 offen sc1 lds
v_mul_f32 v166, -v82, v58
v_mul_f32 v167, -v82, v59
s_add_u32 m0, s39, 102400
s_add_u32 s37, s37, s38
buffer_load_dwordx4 v22, s[8:11], s37 offen sc1 lds
v_mul_f32 v168, -v84, v56
v_mul_f32 v169, -v84, v57
s_add_u32 m0, s39, 103424
s_add_u32 s37, s37, s38
buffer_load_dwordx4 v23, s[8:11], s37 offen sc1 lds
v_mul_f32 v170, -v84, v58
v_mul_f32 v171, -v84, v59
s_add_u32 m0, s39, 104448
s_add_u32 s37, s37, s38
buffer_load_dwordx4 v22, s[8:11], s37 offen sc1 lds
v_mul_f32 v172, -v86, v56
v_mul_f32 v173, -v86, v57
s_add_u32 m0, s39, 105472
s_add_u32 s37, s37, s38
buffer_load_dwordx4 v23, s[8:11], s37 offen sc1 lds
v_mul_f32 v174, -v86, v58
v_mul_f32 v175, -v86, v59
s_add_u32 m0, s39, 106496
s_add_u32 s37, s37, s38
buffer_load_dwordx4 v22, s[8:11], s37 offen sc1 lds
v_mul_f32 v176, -v80, v60
v_mul_f32 v177, -v80, v61
s_add_u32 m0, s39, 107520
s_add_u32 s37, s37, s38
buffer_load_dwordx4 v23, s[8:11], s37 offen sc1 lds
v_mul_f32 v178, -v80, v62
v_mul_f32 v179, -v80, v63
s_add_u32 m0, s39, 108544
s_add_u32 s37, s37, s38
buffer_load_dwordx4 v22, s[8:11], s37 offen sc1 lds
v_mul_f32 v180, -v82, v60
v_mul_f32 v181, -v82, v61
s_add_u32 m0, s39, 109568
s_add_u32 s37, s37, s38
buffer_load_dwordx4 v23, s[8:11], s37 offen sc1 lds
v_mul_f32 v182, -v82, v62
v_mul_f32 v183, -v82, v63
s_add_u32 m0, s39, 110592
s_add_u32 s37, s37, s38
buffer_load_dwordx4 v22, s[8:11], s37 offen sc1 lds
v_mul_f32 v184, -v84, v60
v_mul_f32 v185, -v84, v61
s_add_u32 m0, s39, 111616
s_add_u32 s37, s37, s38
buffer_load_dwordx4 v23, s[8:11], s37 offen sc1 lds
v_mul_f32 v186, -v84, v62
v_mul_f32 v187, -v84, v63
s_add_u32 m0, s39, 112640
s_add_u32 s37, s37, s38
buffer_load_dwordx4 v22, s[8:11], s37 offen sc1 lds
v_mul_f32 v188, -v86, v60
v_mul_f32 v189, -v86, v61
s_add_u32 m0, s39, 113664
s_add_u32 s37, s37, s38
buffer_load_dwordx4 v23, s[8:11], s37 offen sc1 lds
v_mul_f32 v190, -v86, v62
v_mul_f32 v191, -v86, v63
s_load_dword s64, s[80:81], 0
s_load_dword s65, s[80:81], 64
s_load_dword s66, s[80:81], 128
s_load_dword s67, s[80:81], 192
s_load_dword s68, s[80:81], 256
s_load_dword s69, s[80:81], 320
s_load_dword s70, s[80:81], 384
s_load_dword s71, s[80:81], 448
s_add_u32 s80, s80, 512
s_addc_u32 s81, s81, 0
s_waitcnt vmcnt(16)
s_barrier
s_mul_i32 s43, s49, 192
s_and_b32 s43, s43, 0xffffff80
s_add_u32 s43, s43, 4096
s_cmp_eq_u32 s51, 1
s_cselect_b32 s8, s4, s6
s_cselect_b32 s9, s5, s7
s_sub_u32 s10, 7340032, s43
s_lshl_b32 s44, s34, 18
s_add_u32 s44, s44, 4194304
s_movk_i32 s38, 28672
s_cmp_eq_u32 s51, 0
s_cselect_b32 s8, s32, s8
s_cselect_b32 s9, s33, s9
s_cselect_b32 s10, 262144, s10
s_cselect_b32 s43, s44, s43
s_cselect_b32 s38, 1024, s38
s_cselect_b32 s45, 0, -1
s_add_u32 s8, s8, s43
s_addc_u32 s9, s9, 0
s_mov_b32 s11, 0x20000
s_lshl_b32 s40, s38, 4
s_add_u32 s42, s35, 15
s_lshl_b32 s39, s51, 14
v_lshrrev_b32 v19, 4, v1
v_lshlrev_b32 v20, 5, v19
v_mul_u32_u24 v19, 6912, v19
v_and_b32 v19, s45, v19
v_and_b32 v20, s45, v20
v_lshlrev_b32 v21, 4, v1
v_xor_b32 v21, v21, v20
v_add_u32 v22, v21, v19
s_and_b32 s45, s45, 128
v_xor_b32 v23, s45, v22
s_add_u32 s42, s42, 1
s_and_b32 s42, s42, 15
s_add_u32 m0, s39, 0
s_mul_i32 s37, s42, s40
buffer_load_dwordx4 v22, s[8:11], s37 offen sc1 lds
v_mul_f32 v192, -v80, v64
v_mul_f32 v193, -v80, v65
s_add_u32 m0, s39, 1024
s_add_u32 s37, s37, s38
buffer_load_dwordx4 v23, s[8:11], s37 offen sc1 lds
v_mul_f32 v194, -v80, v66
v_mul_f32 v195, -v80, v67
s_add_u32 m0, s39, 2048
s_add_u32 s37, s37, s38
buffer_load_dwordx4 v22, s[8:11], s37 offen sc1 lds
v_mul_f32 v196, -v82, v64
v_mul_f32 v197, -v82, v65
s_add_u32 m0, s39, 3072
s_add_u32 s37, s37, s38
buffer_load_dwordx4 v23, s[8:11], s37 offen sc1 lds
v_mul_f32 v198, -v82, v66
v_mul_f32 v199, -v82, v67
s_add_u32 m0, s39, 4096
s_add_u32 s37, s37, s38
buffer_load_dwordx4 v22, s[8:11], s37 offen sc1 lds
v_mul_f32 v200, -v84, v64
v_mul_f32 v201, -v84, v65
s_add_u32 m0, s39, 5120
s_add_u32 s37, s37, s38
buffer_load_dwordx4 v23, s[8:11], s37 offen sc1 lds
v_mul_f32 v202, -v84, v66
v_mul_f32 v203, -v84, v67
s_add_u32 m0, s39, 6144
s_add_u32 s37, s37, s38
buffer_load_dwordx4 v22, s[8:11], s37 offen sc1 lds
v_mul_f32 v204, -v86, v64
v_mul_f32 v205, -v86, v65
s_add_u32 m0, s39, 7168
s_add_u32 s37, s37, s38
buffer_load_dwordx4 v23, s[8:11], s37 offen sc1 lds
v_mul_f32 v206, -v86, v66
v_mul_f32 v207, -v86, v67
s_add_u32 m0, s39, 8192
s_add_u32 s37, s37, s38
buffer_load_dwordx4 v22, s[8:11], s37 offen sc1 lds
v_mul_f32 v208, -v80, v68
v_mul_f32 v209, -v80, v69
s_add_u32 m0, s39, 9216
s_add_u32 s37, s37, s38
buffer_load_dwordx4 v23, s[8:11], s37 offen sc1 lds
v_mul_f32 v210, -v80, v70
v_mul_f32 v211, -v80, v71
s_add_u32 m0, s39, 10240
s_add_u32 s37, s37, s38
buffer_load_dwordx4 v22, s[8:11], s37 offen sc1 lds
v_mul_f32 v212, -v82, v68
v_mul_f32 v213, -v82, v69
s_add_u32 m0, s39, 11264
s_add_u32 s37, s37, s38
buffer_load_dwordx4 v23, s[8:11], s37 offen sc1 lds
v_mul_f32 v214, -v82, v70
v_mul_f32 v215, -v82, v71
s_add_u32 m0, s39, 12288
s_add_u32 s37, s37, s38
buffer_load_dwordx4 v22, s[8:11], s37 offen sc1 lds
v_mul_f32 v216, -v84, v68
v_mul_f32 v217, -v84, v69
s_add_u32 m0, s39, 13312
s_add_u32 s37, s37, s38
buffer_load_dwordx4 v23, s[8:11], s37 offen sc1 lds
v_mul_f32 v218, -v84, v70
v_mul_f32 v219, -v84, v71
s_add_u32 m0, s39, 14336
s_add_u32 s37, s37, s38
buffer_load_dwordx4 v22, s[8:11], s37 offen sc1 lds
v_mul_f32 v220, -v86, v68
v_mul_f32 v221, -v86, v69
s_add_u32 m0, s39, 15360
s_add_u32 s37, s37, s38
buffer_load_dwordx4 v23, s[8:11], s37 offen sc1 lds
v_mul_f32 v222, -v86, v70
v_mul_f32 v223, -v86, v71
s_load_dword s64, s[80:81], 0
s_load_dword s65, s[80:81], 64
s_load_dword s66, s[80:81], 128
s_load_dword s67, s[80:81], 192
s_load_dword s68, s[80:81], 256
s_load_dword s69, s[80:81], 320
s_load_dword s70, s[80:81], 384
s_add_u32 s80, s80, 448
s_addc_u32 s81, s81, 0
s_waitcnt vmcnt(16)
s_barrier
s_add_u32 s42, s42, 1
s_and_b32 s42, s42, 15
s_add_u32 m0, s39, 49152
s_mul_i32 s37, s42, s40
buffer_load_dwordx4 v22, s[8:11], s37 offen sc1 lds
s_add_u32 m0, s39, 50176
s_add_u32 s37, s37, s38
buffer_load_dwordx4 v23, s[8:11], s37 offen sc1 lds
s_add_u32 m0, s39, 51200
s_add_u32 s37, s37, s38
buffer_load_dwordx4 v22, s[8:11], s37 offen sc1 lds
s_add_u32 m0, s39, 52224
s_add_u32 s37, s37, s38
buffer_load_dwordx4 v23, s[8:11], s37 offen sc1 lds
s_add_u32 m0, s39, 53248
s_add_u32 s37, s37, s38
buffer_load_dwordx4 v22, s[8:11], s37 offen sc1 lds
s_add_u32 m0, s39, 54272
s_add_u32 s37, s37, s38
buffer_load_dwordx4 v23, s[8:11], s37 offen sc1 lds
s_add_u32 m0, s39, 55296
s_add_u32 s37, s37, s38
buffer_load_dwordx4 v22, s[8:11], s37 offen sc1 lds
s_add_u32 m0, s39, 56320
s_add_u32 s37, s37, s38
buffer_load_dwordx4 v23, s[8:11], s37 offen sc1 lds
s_add_u32 m0, s39, 57344
s_add_u32 s37, s37, s38
buffer_load_dwordx4 v22, s[8:11], s37 offen sc1 lds
s_add_u32 m0, s39, 58368
s_add_u32 s37, s37, s38
buffer_load_dwordx4 v23, s[8:11], s37 offen sc1 lds
s_add_u32 m0, s39, 59392
s_add_u32 s37, s37, s38
buffer_load_dwordx4 v22, s[8:11], s37 offen sc1 lds
s_add_u32 m0, s39, 60416
s_add_u32 s37, s37, s38
buffer_load_dwordx4 v23, s[8:11], s37 offen sc1 lds
s_add_u32 m0, s39, 61440
s_add_u32 s37, s37, s38
buffer_load_dwordx4 v22, s[8:11], s37 offen sc1 lds
s_add_u32 m0, s39, 62464
s_add_u32 s37, s37, s38
buffer_load_dwordx4 v23, s[8:11], s37 offen sc1 lds
s_add_u32 m0, s39, 63488
s_add_u32 s37, s37, s38
buffer_load_dwordx4 v22, s[8:11], s37 offen sc1 lds
s_add_u32 m0, s39, 64512
s_add_u32 s37, s37, s38
buffer_load_dwordx4 v23, s[8:11], s37 offen sc1 lds
s_mul_i32 s44, s34, 917504
s_lshl_b32 s39, s51, 13
s_add_u32 s44, s44, s39
s_add_u32 s44, s44, 8388608
s_and_b32 s43, s51, 1
s_xor_b32 s43, s43, s35
s_lshl_b32 s43, s43, 7
s_mov_b32 s10, 909312
s_movk_i32 s38, 1024
s_movk_i32 s40, 9216
s_movk_i32 s37, 0x4000
s_cmp_ge_u32 s51, 2
s_cselect_b32 s8, s60, s32
s_cselect_b32 s9, s61, s33
s_cselect_b32 s10, 7338112, s10
s_cselect_b32 s43, s43, s44
s_cselect_b32 s38, 16384, s38
s_cselect_b32 s40, 81920, s40
s_cselect_b32 s55, 81920, s38
s_cselect_b32 s37, 262144, s37
s_cselect_b32 s45, -1, 0
s_add_u32 s8, s8, s43
s_addc_u32 s9, s9, 0
s_mov_b32 s11, 0x20000
s_and_b32 s53, s35, 1
s_mul_i32 s54, s53, 6
s_mul_i32 s54, s54, s37
s_mul_i32 s29, s53, 2
s_add_u32 s29, s29, 6
s_mul_i32 s29, s29, s37
s_and_b32 s43, s45, 4290838528
s_add_u32 s29, s29, s43
s_mul_i32 s37, s37, 2
s_sub_u32 s37, s37, s40
v_lshrrev_b32 v19, 3, v1
v_mul_u32_u24 v19, 1920, v19
v_lshrrev_b32 v20, 4, v1
v_lshlrev_b32 v20, 5, v20
v_and_b32 v19, s45, v19
v_and_b32 v20, s45, v20
v_lshlrev_b32 v21, 4, v1
v_xor_b32 v21, v21, v20
v_add_u32 v21, v21, v19
s_waitcnt vmcnt(16)
s_barrier
s_branch LK3b_100
.p2align 6
Lw_42:
s_branch Lr_43
s_nop 0
.p2align 3
L7_99:
s_lshr_b32 s43, s2, 5
s_cmp_eq_u32 s43, 3
s_cbranch_scc1 Lnojob_109
s_cmp_gt_u32 s43, 3
s_cselect_b32 s43, 32, 0
s_sub_u32 s43, s2, s43
s_lshr_b32 s43, s43, 1
s_and_b32 s44, s2, 1
s_cmp_eq_u32 s44, 0
s_cselect_b32 s68, s4, s6
s_cselect_b32 s69, s5, s7
s_mul_i32 s45, s43, 2341
s_lshr_b32 s45, s45, 16
s_mul_i32 s46, s45, 28
s_sub_u32 s46, s43, s46
v_lshrrev_b32 v4, 4, v1
s_lshl_b32 s43, s45, 8
v_add_u32 v4, s43, v4
v_mul_u32_u24 v4, 7168, v4
v_and_b32 v5, 15, v1
v_lshl_add_u32 v4, v5, 4, v4
s_lshl_b32 s43, s46, 8
v_add_u32 v4, s43, v4
s_mov_b32 s64, s68
s_mov_b32 s65, s69
s_mov_b32 s66, 7340032
s_mov_b32 s67, 0x20000
s_lshl_b32 s55, s45, 1
s_add_u32 s55, s55, s44
s_mul_i32 s55, s55, 14336
s_lshl_b32 s45, s46, 9
s_mov_b32 s50, s46
s_add_u32 s55, s55, s45
v_lshl_add_u32 v5, v5, 5, s55
s_add_u32 s72, s32, 27262976
s_addc_u32 s73, s33, 0
s_mov_b32 s74, 114688
s_mov_b32 s75, 0x20000
v_mov_b32 v32, 0
v_mov_b32 v33, 0
v_mov_b32 v34, 0
v_mov_b32 v35, 0
v_mov_b32 v36, 0
v_mov_b32 v37, 0
v_mov_b32 v38, 0
v_mov_b32 v39, 0
s_lshl_b32 s43, s34, 18
s_add_u32 s12, s32, s43
s_addc_u32 s13, s33, 0
s_mov_b32 s14, 262144
s_mov_b32 s15, 0x20000
v_lshlrev_b32 v21, 4, v1
s_lshl_b32 s54, s36, 11
s_add_u32 s43, s35, 1
s_and_b32 s43, s43, 15
s_lshl_b32 s43, s43, 14
s_add_u32 s30, s43, s54
s_add_u32 s43, s35, 2
s_and_b32 s43, s43, 15
s_lshl_b32 s43, s43, 14
s_add_u32 s31, s43, s54
s_waitcnt vmcnt(0)
s_barrier
ds_write_b128 v27, v[68:71] offset:0
ds_write_b128 v27, v[116:119] offset:512
s_mov_b32 s43, 917504
buffer_load_dwordx4 v[56:59], v4, s[64:67], s43 offen
s_mov_b32 s43, 946176
buffer_load_dwordx4 v[60:63], v4, s[64:67], s43 offen
s_mov_b32 s43, 974848
buffer_load_dwordx4 v[64:67], v4, s[64:67], s43 offen
s_mov_b32 s43, 1003520
buffer_load_dwordx4 v[72:75], v4, s[64:67], s43 offen
s_mov_b32 s43, 1032192
buffer_load_dwordx4 v[76:79], v4, s[64:67], s43 offen
s_mov_b32 s43, 1060864
buffer_load_dwordx4 v[80:83], v4, s[64:67], s43 offen
s_mov_b32 s43, 1089536
buffer_load_dwordx4 v[84:87], v4, s[64:67], s43 offen
s_mov_b32 s43, 1118208
buffer_load_dwordx4 v[88:91], v4, s[64:67], s43 offen
s_mov_b32 s43, 1146880
buffer_load_dwordx4 v[92:95], v4, s[64:67], s43 offen
s_mov_b32 s43, 1175552
buffer_load_dwordx4 v[96:99], v4, s[64:67], s43 offen
s_mov_b32 s43, 1204224
buffer_load_dwordx4 v[100:103], v4, s[64:67], s43 offen
s_mov_b32 s43, 1232896
buffer_load_dwordx4 v[104:107], v4, s[64:67], s43 offen
s_mov_b32 s43, 1261568
buffer_load_dwordx4 v[108:111], v4, s[64:67], s43 offen
s_mov_b32 s43, 1290240
buffer_load_dwordx4 v[112:115], v4, s[64:67], s43 offen
s_mov_b32 s43, 1318912
buffer_load_dwordx4 v[120:123], v4, s[64:67], s43 offen
s_mov_b32 s43, 1347584
buffer_load_dwordx4 v[124:127], v4, s[64:67], s43 offen
v_lshlrev_b32 v40, 16, v128
v_and_b32 v41, 0xffff0000, v128
v_lshlrev_b32 v42, 16, v129
v_and_b32 v43, 0xffff0000, v129
v_lshlrev_b32 v44, 16, v130
v_and_b32 v45, 0xffff0000, v130
v_lshlrev_b32 v46, 16, v131
v_and_b32 v47, 0xffff0000, v131
v_pk_add_f32 v[32:33], v[32:33], v[40:41]
v_pk_add_f32 v[34:35], v[34:35], v[42:43]
v_pk_add_f32 v[36:37], v[36:37], v[44:45]
v_pk_add_f32 v[38:39], v[38:39], v[46:47]
v_lshlrev_b32 v48, 16, v132
v_and_b32 v49, 0xffff0000, v132
v_lshlrev_b32 v50, 16, v133
v_and_b32 v51, 0xffff0000, v133
v_lshlrev_b32 v52, 16, v134
v_and_b32 v53, 0xffff0000, v134
v_lshlrev_b32 v54, 16, v135
v_and_b32 v55, 0xffff0000, v135
v_pk_add_f32 v[32:33], v[32:33], v[48:49]
v_pk_add_f32 v[34:35], v[34:35], v[50:51]
v_pk_add_f32 v[36:37], v[36:37], v[52:53]
v_pk_add_f32 v[38:39], v[38:39], v[54:55]
v_lshlrev_b32 v40, 16, v136
v_and_b32 v41, 0xffff0000, v136
v_lshlrev_b32 v42, 16, v137
v_and_b32 v43, 0xffff0000, v137
v_lshlrev_b32 v44, 16, v138
v_and_b32 v45, 0xffff0000, v138
v_lshlrev_b32 v46, 16, v139
v_and_b32 v47, 0xffff0000, v139
v_pk_add_f32 v[32:33], v[32:33], v[40:41]
v_pk_add_f32 v[34:35], v[34:35], v[42:43]
v_pk_add_f32 v[36:37], v[36:37], v[44:45]
v_pk_add_f32 v[38:39], v[38:39], v[46:47]
v_lshlrev_b32 v48, 16, v140
v_and_b32 v49, 0xffff0000, v140
v_lshlrev_b32 v50, 16, v141
v_and_b32 v51, 0xffff0000, v141
v_lshlrev_b32 v52, 16, v142
v_and_b32 v53, 0xffff0000, v142
v_lshlrev_b32 v54, 16, v143
v_and_b32 v55, 0xffff0000, v143
v_pk_add_f32 v[32:33], v[32:33], v[48:49]
v_pk_add_f32 v[34:35], v[34:35], v[50:51]
v_pk_add_f32 v[36:37], v[36:37], v[52:53]
v_pk_add_f32 v[38:39], v[38:39], v[54:55]
v_lshlrev_b32 v40, 16, v144
v_and_b32 v41, 0xffff0000, v144
v_lshlrev_b32 v42, 16, v145
v_and_b32 v43, 0xffff0000, v145
v_lshlrev_b32 v44, 16, v146
v_and_b32 v45, 0xffff0000, v146
v_lshlrev_b32 v46, 16, v147
v_and_b32 v47, 0xffff0000, v147
v_pk_add_f32 v[32:33], v[32:33], v[40:41]
v_pk_add_f32 v[34:35], v[34:35], v[42:43]
v_pk_add_f32 v[36:37], v[36:37], v[44:45]
v_pk_add_f32 v[38:39], v[38:39], v[46:47]
v_lshlrev_b32 v48, 16, v148
v_and_b32 v49, 0xffff0000, v148
v_lshlrev_b32 v50, 16, v149
v_and_b32 v51, 0xffff0000, v149
v_lshlrev_b32 v52, 16, v150
v_and_b32 v53, 0xffff0000, v150
v_lshlrev_b32 v54, 16, v151
v_and_b32 v55, 0xffff0000, v151
v_pk_add_f32 v[32:33], v[32:33], v[48:49]
v_pk_add_f32 v[34:35], v[34:35], v[50:51]
v_pk_add_f32 v[36:37], v[36:37], v[52:53]
v_pk_add_f32 v[38:39], v[38:39], v[54:55]
v_lshlrev_b32 v40, 16, v152
v_and_b32 v41, 0xffff0000, v152
v_lshlrev_b32 v42, 16, v153
v_and_b32 v43, 0xffff0000, v153
v_lshlrev_b32 v44, 16, v154
v_and_b32 v45, 0xffff0000, v154
v_lshlrev_b32 v46, 16, v155
v_and_b32 v47, 0xffff0000, v155
v_pk_add_f32 v[32:33], v[32:33], v[40:41]
v_pk_add_f32 v[34:35], v[34:35], v[42:43]
v_pk_add_f32 v[36:37], v[36:37], v[44:45]
v_pk_add_f32 v[38:39], v[38:39], v[46:47]
v_lshlrev_b32 v48, 16, v156
v_and_b32 v49, 0xffff0000, v156
v_lshlrev_b32 v50, 16, v157
v_and_b32 v51, 0xffff0000, v157
v_lshlrev_b32 v52, 16, v158
v_and_b32 v53, 0xffff0000, v158
v_lshlrev_b32 v54, 16, v159
v_and_b32 v55, 0xffff0000, v159
v_pk_add_f32 v[32:33], v[32:33], v[48:49]
v_pk_add_f32 v[34:35], v[34:35], v[50:51]
v_pk_add_f32 v[36:37], v[36:37], v[52:53]
v_pk_add_f32 v[38:39], v[38:39], v[54:55]
s_waitcnt lgkmcnt(0)
s_barrier
s_add_u32 m0, s54, 16384
s_add_u32 s43, s30, 0
buffer_load_dwordx4 v21, s[12:15], s43 offen sc1 lds
s_add_u32 m0, s54, 17408
s_add_u32 s43, s30, 1024
buffer_load_dwordx4 v21, s[12:15], s43 offen sc1 lds
s_add_u32 m0, s54, 32768
s_add_u32 s43, s31, 0
buffer_load_dwordx4 v21, s[12:15], s43 offen sc1 lds
s_add_u32 m0, s54, 33792
s_add_u32 s43, s31, 1024
buffer_load_dwordx4 v21, s[12:15], s43 offen sc1 lds
s_waitcnt vmcnt(2)
s_barrier
s_waitcnt vmcnt(0)
s_barrier
v_lshlrev_b32 v40, 16, v160
v_and_b32 v41, 0xffff0000, v160
v_lshlrev_b32 v42, 16, v161
v_and_b32 v43, 0xffff0000, v161
v_lshlrev_b32 v44, 16, v162
v_and_b32 v45, 0xffff0000, v162
v_lshlrev_b32 v46, 16, v163
v_and_b32 v47, 0xffff0000, v163
v_pk_add_f32 v[32:33], v[32:33], v[40:41]
v_pk_add_f32 v[34:35], v[34:35], v[42:43]
v_pk_add_f32 v[36:37], v[36:37], v[44:45]
v_pk_add_f32 v[38:39], v[38:39], v[46:47]
v_lshlrev_b32 v48, 16, v164
v_and_b32 v49, 0xffff0000, v164
v_lshlrev_b32 v50, 16, v165
v_and_b32 v51, 0xffff0000, v165
v_lshlrev_b32 v52, 16, v166
v_and_b32 v53, 0xffff0000, v166
v_lshlrev_b32 v54, 16, v167
v_and_b32 v55, 0xffff0000, v167
v_pk_add_f32 v[32:33], v[32:33], v[48:49]
v_pk_add_f32 v[34:35], v[34:35], v[50:51]
v_pk_add_f32 v[36:37], v[36:37], v[52:53]
v_pk_add_f32 v[38:39], v[38:39], v[54:55]
v_lshlrev_b32 v40, 16, v168
v_and_b32 v41, 0xffff0000, v168
v_lshlrev_b32 v42, 16, v169
v_and_b32 v43, 0xffff0000, v169
v_lshlrev_b32 v44, 16, v170
v_and_b32 v45, 0xffff0000, v170
v_lshlrev_b32 v46, 16, v171
v_and_b32 v47, 0xffff0000, v171
v_pk_add_f32 v[32:33], v[32:33], v[40:41]
v_pk_add_f32 v[34:35], v[34:35], v[42:43]
v_pk_add_f32 v[36:37], v[36:37], v[44:45]
v_pk_add_f32 v[38:39], v[38:39], v[46:47]
v_lshlrev_b32 v48, 16, v172
v_and_b32 v49, 0xffff0000, v172
v_lshlrev_b32 v50, 16, v173
v_and_b32 v51, 0xffff0000, v173
v_lshlrev_b32 v52, 16, v174
v_and_b32 v53, 0xffff0000, v174
v_lshlrev_b32 v54, 16, v175
v_and_b32 v55, 0xffff0000, v175
v_pk_add_f32 v[32:33], v[32:33], v[48:49]
v_pk_add_f32 v[34:35], v[34:35], v[50:51]
v_pk_add_f32 v[36:37], v[36:37], v[52:53]
v_pk_add_f32 v[38:39], v[38:39], v[54:55]
s_barrier
v_lshlrev_b32 v40, 16, v176
v_and_b32 v41, 0xffff0000, v176
v_lshlrev_b32 v42, 16, v177
v_and_b32 v43, 0xffff0000, v177
v_lshlrev_b32 v44, 16, v178
v_and_b32 v45, 0xffff0000, v178
v_lshlrev_b32 v46, 16, v179
v_and_b32 v47, 0xffff0000, v179
v_pk_add_f32 v[32:33], v[32:33], v[40:41]
v_pk_add_f32 v[34:35], v[34:35], v[42:43]
v_pk_add_f32 v[36:37], v[36:37], v[44:45]
v_pk_add_f32 v[38:39], v[38:39], v[46:47]
v_lshlrev_b32 v48, 16, v180
v_and_b32 v49, 0xffff0000, v180
v_lshlrev_b32 v50, 16, v181
v_and_b32 v51, 0xffff0000, v181
v_lshlrev_b32 v52, 16, v182
v_and_b32 v53, 0xffff0000, v182
v_lshlrev_b32 v54, 16, v183
v_and_b32 v55, 0xffff0000, v183
v_pk_add_f32 v[32:33], v[32:33], v[48:49]
v_pk_add_f32 v[34:35], v[34:35], v[50:51]
v_pk_add_f32 v[36:37], v[36:37], v[52:53]
v_pk_add_f32 v[38:39], v[38:39], v[54:55]
v_lshlrev_b32 v40, 16, v184
v_and_b32 v41, 0xffff0000, v184
v_lshlrev_b32 v42, 16, v185
v_and_b32 v43, 0xffff0000, v185
v_lshlrev_b32 v44, 16, v186
v_and_b32 v45, 0xffff0000, v186
v_lshlrev_b32 v46, 16, v187
v_and_b32 v47, 0xffff0000, v187
v_pk_add_f32 v[32:33], v[32:33], v[40:41]
v_pk_add_f32 v[34:35], v[34:35], v[42:43]
v_pk_add_f32 v[36:37], v[36:37], v[44:45]
v_pk_add_f32 v[38:39], v[38:39], v[46:47]
v_lshlrev_b32 v48, 16, v188
v_and_b32 v49, 0xffff0000, v188
v_lshlrev_b32 v50, 16, v189
v_and_b32 v51, 0xffff0000, v189
v_lshlrev_b32 v52, 16, v190
v_and_b32 v53, 0xffff0000, v190
v_lshlrev_b32 v54, 16, v191
v_and_b32 v55, 0xffff0000, v191
v_pk_add_f32 v[32:33], v[32:33], v[48:49]
v_pk_add_f32 v[34:35], v[34:35], v[50:51]
v_pk_add_f32 v[36:37], v[36:37], v[52:53]
v_pk_add_f32 v[38:39], v[38:39], v[54:55]
s_barrier
v_lshlrev_b32 v40, 16, v192
v_and_b32 v41, 0xffff0000, v192
v_lshlrev_b32 v42, 16, v193
v_and_b32 v43, 0xffff0000, v193
v_lshlrev_b32 v44, 16, v194
v_and_b32 v45, 0xffff0000, v194
v_lshlrev_b32 v46, 16, v195
v_and_b32 v47, 0xffff0000, v195
v_pk_add_f32 v[32:33], v[32:33], v[40:41]
v_pk_add_f32 v[34:35], v[34:35], v[42:43]
v_pk_add_f32 v[36:37], v[36:37], v[44:45]
v_pk_add_f32 v[38:39], v[38:39], v[46:47]
v_lshlrev_b32 v48, 16, v196
v_and_b32 v49, 0xffff0000, v196
v_lshlrev_b32 v50, 16, v197
v_and_b32 v51, 0xffff0000, v197
v_lshlrev_b32 v52, 16, v198
v_and_b32 v53, 0xffff0000, v198
v_lshlrev_b32 v54, 16, v199
v_and_b32 v55, 0xffff0000, v199
v_pk_add_f32 v[32:33], v[32:33], v[48:49]
v_pk_add_f32 v[34:35], v[34:35], v[50:51]
v_pk_add_f32 v[36:37], v[36:37], v[52:53]
v_pk_add_f32 v[38:39], v[38:39], v[54:55]
v_lshlrev_b32 v40, 16, v200
v_and_b32 v41, 0xffff0000, v200
v_lshlrev_b32 v42, 16, v201
v_and_b32 v43, 0xffff0000, v201
v_lshlrev_b32 v44, 16, v202
v_and_b32 v45, 0xffff0000, v202
v_lshlrev_b32 v46, 16, v203
v_and_b32 v47, 0xffff0000, v203
v_pk_add_f32 v[32:33], v[32:33], v[40:41]
v_pk_add_f32 v[34:35], v[34:35], v[42:43]
v_pk_add_f32 v[36:37], v[36:37], v[44:45]
v_pk_add_f32 v[38:39], v[38:39], v[46:47]
v_lshlrev_b32 v48, 16, v204
v_and_b32 v49, 0xffff0000, v204
v_lshlrev_b32 v50, 16, v205
v_and_b32 v51, 0xffff0000, v205
v_lshlrev_b32 v52, 16, v206
v_and_b32 v53, 0xffff0000, v206
v_lshlrev_b32 v54, 16, v207
v_and_b32 v55, 0xffff0000, v207
v_pk_add_f32 v[32:33], v[32:33], v[48:49]
v_pk_add_f32 v[34:35], v[34:35], v[50:51]
v_pk_add_f32 v[36:37], v[36:37], v[52:53]
v_pk_add_f32 v[38:39], v[38:39], v[54:55]
s_barrier
v_lshlrev_b32 v40, 16, v208
v_and_b32 v41, 0xffff0000, v208
v_lshlrev_b32 v42, 16, v209
v_and_b32 v43, 0xffff0000, v209
v_lshlrev_b32 v44, 16, v210
v_and_b32 v45, 0xffff0000, v210
v_lshlrev_b32 v46, 16, v211
v_and_b32 v47, 0xffff0000, v211
v_pk_add_f32 v[32:33], v[32:33], v[40:41]
v_pk_add_f32 v[34:35], v[34:35], v[42:43]
v_pk_add_f32 v[36:37], v[36:37], v[44:45]
v_pk_add_f32 v[38:39], v[38:39], v[46:47]
v_lshlrev_b32 v48, 16, v212
v_and_b32 v49, 0xffff0000, v212
v_lshlrev_b32 v50, 16, v213
v_and_b32 v51, 0xffff0000, v213
v_lshlrev_b32 v52, 16, v214
v_and_b32 v53, 0xffff0000, v214
v_lshlrev_b32 v54, 16, v215
v_and_b32 v55, 0xffff0000, v215
v_pk_add_f32 v[32:33], v[32:33], v[48:49]
v_pk_add_f32 v[34:35], v[34:35], v[50:51]
v_pk_add_f32 v[36:37], v[36:37], v[52:53]
v_pk_add_f32 v[38:39], v[38:39], v[54:55]
v_lshlrev_b32 v40, 16, v216
v_and_b32 v41, 0xffff0000, v216
v_lshlrev_b32 v42, 16, v217
v_and_b32 v43, 0xffff0000, v217
v_lshlrev_b32 v44, 16, v218
v_and_b32 v45, 0xffff0000, v218
v_lshlrev_b32 v46, 16, v219
v_and_b32 v47, 0xffff0000, v219
v_pk_add_f32 v[32:33], v[32:33], v[40:41]
v_pk_add_f32 v[34:35], v[34:35], v[42:43]
v_pk_add_f32 v[36:37], v[36:37], v[44:45]
v_pk_add_f32 v[38:39], v[38:39], v[46:47]
v_lshlrev_b32 v48, 16, v220
v_and_b32 v49, 0xffff0000, v220
v_lshlrev_b32 v50, 16, v221
v_and_b32 v51, 0xffff0000, v221
v_lshlrev_b32 v52, 16, v222
v_and_b32 v53, 0xffff0000, v222
v_lshlrev_b32 v54, 16, v223
v_and_b32 v55, 0xffff0000, v223
v_pk_add_f32 v[32:33], v[32:33], v[48:49]
v_pk_add_f32 v[34:35], v[34:35], v[50:51]
v_pk_add_f32 v[36:37], v[36:37], v[52:53]
v_pk_add_f32 v[38:39], v[38:39], v[54:55]
s_barrier
v_lshlrev_b32 v40, 16, v224
v_and_b32 v41, 0xffff0000, v224
v_lshlrev_b32 v42, 16, v225
v_and_b32 v43, 0xffff0000, v225
v_lshlrev_b32 v44, 16, v226
v_and_b32 v45, 0xffff0000, v226
v_lshlrev_b32 v46, 16, v227
v_and_b32 v47, 0xffff0000, v227
v_pk_add_f32 v[32:33], v[32:33], v[40:41]
v_pk_add_f32 v[34:35], v[34:35], v[42:43]
v_pk_add_f32 v[36:37], v[36:37], v[44:45]
v_pk_add_f32 v[38:39], v[38:39], v[46:47]
v_lshlrev_b32 v48, 16, v228
v_and_b32 v49, 0xffff0000, v228
v_lshlrev_b32 v50, 16, v229
v_and_b32 v51, 0xffff0000, v229
v_lshlrev_b32 v52, 16, v230
v_and_b32 v53, 0xffff0000, v230
v_lshlrev_b32 v54, 16, v231
v_and_b32 v55, 0xffff0000, v231
v_pk_add_f32 v[32:33], v[32:33], v[48:49]
v_pk_add_f32 v[34:35], v[34:35], v[50:51]
v_pk_add_f32 v[36:37], v[36:37], v[52:53]
v_pk_add_f32 v[38:39], v[38:39], v[54:55]
v_lshlrev_b32 v40, 16, v232
v_and_b32 v41, 0xffff0000, v232
v_lshlrev_b32 v42, 16, v233
v_and_b32 v43, 0xffff0000, v233
v_lshlrev_b32 v44, 16, v234
v_and_b32 v45, 0xffff0000, v234
v_lshlrev_b32 v46, 16, v235
v_and_b32 v47, 0xffff0000, v235
v_pk_add_f32 v[32:33], v[32:33], v[40:41]
v_pk_add_f32 v[34:35], v[34:35], v[42:43]
v_pk_add_f32 v[36:37], v[36:37], v[44:45]
v_pk_add_f32 v[38:39], v[38:39], v[46:47]
v_lshlrev_b32 v48, 16, v236
v_and_b32 v49, 0xffff0000, v236
v_lshlrev_b32 v50, 16, v237
v_and_b32 v51, 0xffff0000, v237
v_lshlrev_b32 v52, 16, v238
v_and_b32 v53, 0xffff0000, v238
v_lshlrev_b32 v54, 16, v239
v_and_b32 v55, 0xffff0000, v239
v_pk_add_f32 v[32:33], v[32:33], v[48:49]
v_pk_add_f32 v[34:35], v[34:35], v[50:51]
v_pk_add_f32 v[36:37], v[36:37], v[52:53]
v_pk_add_f32 v[38:39], v[38:39], v[54:55]
s_barrier
v_lshlrev_b32 v40, 16, v240
v_and_b32 v41, 0xffff0000, v240
v_lshlrev_b32 v42, 16, v241
v_and_b32 v43, 0xffff0000, v241
v_lshlrev_b32 v44, 16, v242
v_and_b32 v45, 0xffff0000, v242
v_lshlrev_b32 v46, 16, v243
v_and_b32 v47, 0xffff0000, v243
v_pk_add_f32 v[32:33], v[32:33], v[40:41]
v_pk_add_f32 v[34:35], v[34:35], v[42:43]
v_pk_add_f32 v[36:37], v[36:37], v[44:45]
v_pk_add_f32 v[38:39], v[38:39], v[46:47]
v_lshlrev_b32 v48, 16, v244
v_and_b32 v49, 0xffff0000, v244
v_lshlrev_b32 v50, 16, v245
v_and_b32 v51, 0xffff0000, v245
v_lshlrev_b32 v52, 16, v246
v_and_b32 v53, 0xffff0000, v246
v_lshlrev_b32 v54, 16, v247
v_and_b32 v55, 0xffff0000, v247
v_pk_add_f32 v[32:33], v[32:33], v[48:49]
v_pk_add_f32 v[34:35], v[34:35], v[50:51]
v_pk_add_f32 v[36:37], v[36:37], v[52:53]
v_pk_add_f32 v[38:39], v[38:39], v[54:55]
v_lshlrev_b32 v40, 16, v248
v_and_b32 v41, 0xffff0000, v248
v_lshlrev_b32 v42, 16, v249
v_and_b32 v43, 0xffff0000, v249
v_lshlrev_b32 v44, 16, v250
v_and_b32 v45, 0xffff0000, v250
v_lshlrev_b32 v46, 16, v251
v_and_b32 v47, 0xffff0000, v251
v_pk_add_f32 v[32:33], v[32:33], v[40:41]
v_pk_add_f32 v[34:35], v[34:35], v[42:43]
v_pk_add_f32 v[36:37], v[36:37], v[44:45]
v_pk_add_f32 v[38:39], v[38:39], v[46:47]
v_lshlrev_b32 v48, 16, v252
v_and_b32 v49, 0xffff0000, v252
v_lshlrev_b32 v50, 16, v253
v_and_b32 v51, 0xffff0000, v253
v_lshlrev_b32 v52, 16, v254
v_and_b32 v53, 0xffff0000, v254
v_lshlrev_b32 v54, 16, v255
v_and_b32 v55, 0xffff0000, v255
v_pk_add_f32 v[32:33], v[32:33], v[48:49]
v_pk_add_f32 v[34:35], v[34:35], v[50:51]
v_pk_add_f32 v[36:37], v[36:37], v[52:53]
v_pk_add_f32 v[38:39], v[38:39], v[54:55]
s_barrier
s_mov_b32 s43, 1376256
buffer_load_dwordx4 v[128:131], v4, s[64:67], s43 offen
s_mov_b32 s43, 1404928
buffer_load_dwordx4 v[132:135], v4, s[64:67], s43 offen
s_mov_b32 s43, 1433600
buffer_load_dwordx4 v[136:139], v4, s[64:67], s43 offen
s_mov_b32 s43, 1462272
buffer_load_dwordx4 v[140:143], v4, s[64:67], s43 offen
s_mov_b32 s43, 1490944
buffer_load_dwordx4 v[144:147], v4, s[64:67], s43 offen
s_mov_b32 s43, 1519616
buffer_load_dwordx4 v[148:151], v4, s[64:67], s43 offen
s_mov_b32 s43, 1548288
buffer_load_dwordx4 v[152:155], v4, s[64:67], s43 offen
s_mov_b32 s43, 1576960
buffer_load_dwordx4 v[156:159], v4, s[64:67], s43 offen
s_mov_b32 s43, 1605632
buffer_load_dwordx4 v[160:163], v4, s[64:67], s43 offen
s_mov_b32 s43, 1634304
buffer_load_dwordx4 v[164:167], v4, s[64:67], s43 offen
s_mov_b32 s43, 1662976
buffer_load_dwordx4 v[168:171], v4, s[64:67], s43 offen
s_mov_b32 s43, 1691648
buffer_load_dwordx4 v[172:175], v4, s[64:67], s43 offen
s_mov_b32 s43, 1720320
buffer_load_dwordx4 v[176:179], v4, s[64:67], s43 offen
s_mov_b32 s43, 1748992
buffer_load_dwordx4 v[180:183], v4, s[64:67], s43 offen
s_mov_b32 s43, 1777664
buffer_load_dwordx4 v[184:187], v4, s[64:67], s43 offen
s_mov_b32 s43, 1806336
buffer_load_dwordx4 v[188:191], v4, s[64:67], s43 offen
s_barrier
v_lshlrev_b32 v40, 16, v56
v_and_b32 v41, 0xffff0000, v56
v_lshlrev_b32 v42, 16, v57
v_and_b32 v43, 0xffff0000, v57
v_lshlrev_b32 v44, 16, v58
v_and_b32 v45, 0xffff0000, v58
v_lshlrev_b32 v46, 16, v59
v_and_b32 v47, 0xffff0000, v59
v_pk_add_f32 v[32:33], v[32:33], v[40:41]
v_pk_add_f32 v[34:35], v[34:35], v[42:43]
v_pk_add_f32 v[36:37], v[36:37], v[44:45]
v_pk_add_f32 v[38:39], v[38:39], v[46:47]
v_lshlrev_b32 v48, 16, v60
v_and_b32 v49, 0xffff0000, v60
v_lshlrev_b32 v50, 16, v61
v_and_b32 v51, 0xffff0000, v61
v_lshlrev_b32 v52, 16, v62
v_and_b32 v53, 0xffff0000, v62
v_lshlrev_b32 v54, 16, v63
v_and_b32 v55, 0xffff0000, v63
v_pk_add_f32 v[32:33], v[32:33], v[48:49]
v_pk_add_f32 v[34:35], v[34:35], v[50:51]
v_pk_add_f32 v[36:37], v[36:37], v[52:53]
v_pk_add_f32 v[38:39], v[38:39], v[54:55]
v_lshlrev_b32 v40, 16, v64
v_and_b32 v41, 0xffff0000, v64
v_lshlrev_b32 v42, 16, v65
v_and_b32 v43, 0xffff0000, v65
v_lshlrev_b32 v44, 16, v66
v_and_b32 v45, 0xffff0000, v66
v_lshlrev_b32 v46, 16, v67
v_and_b32 v47, 0xffff0000, v67
v_pk_add_f32 v[32:33], v[32:33], v[40:41]
v_pk_add_f32 v[34:35], v[34:35], v[42:43]
v_pk_add_f32 v[36:37], v[36:37], v[44:45]
v_pk_add_f32 v[38:39], v[38:39], v[46:47]
v_lshlrev_b32 v48, 16, v72
v_and_b32 v49, 0xffff0000, v72
v_lshlrev_b32 v50, 16, v73
v_and_b32 v51, 0xffff0000, v73
v_lshlrev_b32 v52, 16, v74
v_and_b32 v53, 0xffff0000, v74
v_lshlrev_b32 v54, 16, v75
v_and_b32 v55, 0xffff0000, v75
v_pk_add_f32 v[32:33], v[32:33], v[48:49]
v_pk_add_f32 v[34:35], v[34:35], v[50:51]
v_pk_add_f32 v[36:37], v[36:37], v[52:53]
v_pk_add_f32 v[38:39], v[38:39], v[54:55]
s_barrier
v_lshlrev_b32 v40, 16, v76
v_and_b32 v41, 0xffff0000, v76
v_lshlrev_b32 v42, 16, v77
v_and_b32 v43, 0xffff0000, v77
v_lshlrev_b32 v44, 16, v78
v_and_b32 v45, 0xffff0000, v78
v_lshlrev_b32 v46, 16, v79
v_and_b32 v47, 0xffff0000, v79
v_pk_add_f32 v[32:33], v[32:33], v[40:41]
v_pk_add_f32 v[34:35], v[34:35], v[42:43]
v_pk_add_f32 v[36:37], v[36:37], v[44:45]
v_pk_add_f32 v[38:39], v[38:39], v[46:47]
v_lshlrev_b32 v48, 16, v80
v_and_b32 v49, 0xffff0000, v80
v_lshlrev_b32 v50, 16, v81
v_and_b32 v51, 0xffff0000, v81
v_lshlrev_b32 v52, 16, v82
v_and_b32 v53, 0xffff0000, v82
v_lshlrev_b32 v54, 16, v83
v_and_b32 v55, 0xffff0000, v83
v_pk_add_f32 v[32:33], v[32:33], v[48:49]
v_pk_add_f32 v[34:35], v[34:35], v[50:51]
v_pk_add_f32 v[36:37], v[36:37], v[52:53]
v_pk_add_f32 v[38:39], v[38:39], v[54:55]
v_lshlrev_b32 v40, 16, v84
v_and_b32 v41, 0xffff0000, v84
v_lshlrev_b32 v42, 16, v85
v_and_b32 v43, 0xffff0000, v85
v_lshlrev_b32 v44, 16, v86
v_and_b32 v45, 0xffff0000, v86
v_lshlrev_b32 v46, 16, v87
v_and_b32 v47, 0xffff0000, v87
v_pk_add_f32 v[32:33], v[32:33], v[40:41]
v_pk_add_f32 v[34:35], v[34:35], v[42:43]
v_pk_add_f32 v[36:37], v[36:37], v[44:45]
v_pk_add_f32 v[38:39], v[38:39], v[46:47]
v_lshlrev_b32 v48, 16, v88
v_and_b32 v49, 0xffff0000, v88
v_lshlrev_b32 v50, 16, v89
v_and_b32 v51, 0xffff0000, v89
v_lshlrev_b32 v52, 16, v90
v_and_b32 v53, 0xffff0000, v90
v_lshlrev_b32 v54, 16, v91
v_and_b32 v55, 0xffff0000, v91
v_pk_add_f32 v[32:33], v[32:33], v[48:49]
v_pk_add_f32 v[34:35], v[34:35], v[50:51]
v_pk_add_f32 v[36:37], v[36:37], v[52:53]
v_pk_add_f32 v[38:39], v[38:39], v[54:55]
s_barrier
v_lshlrev_b32 v40, 16, v92
v_and_b32 v41, 0xffff0000, v92
v_lshlrev_b32 v42, 16, v93
v_and_b32 v43, 0xffff0000, v93
v_lshlrev_b32 v44, 16, v94
v_and_b32 v45, 0xffff0000, v94
v_lshlrev_b32 v46, 16, v95
v_and_b32 v47, 0xffff0000, v95
v_pk_add_f32 v[32:33], v[32:33], v[40:41]
v_pk_add_f32 v[34:35], v[34:35], v[42:43]
v_pk_add_f32 v[36:37], v[36:37], v[44:45]
v_pk_add_f32 v[38:39], v[38:39], v[46:47]
v_lshlrev_b32 v48, 16, v96
v_and_b32 v49, 0xffff0000, v96
v_lshlrev_b32 v50, 16, v97
v_and_b32 v51, 0xffff0000, v97
v_lshlrev_b32 v52, 16, v98
v_and_b32 v53, 0xffff0000, v98
v_lshlrev_b32 v54, 16, v99
v_and_b32 v55, 0xffff0000, v99
v_pk_add_f32 v[32:33], v[32:33], v[48:49]
v_pk_add_f32 v[34:35], v[34:35], v[50:51]
v_pk_add_f32 v[36:37], v[36:37], v[52:53]
v_pk_add_f32 v[38:39], v[38:39], v[54:55]
v_lshlrev_b32 v40, 16, v100
v_and_b32 v41, 0xffff0000, v100
v_lshlrev_b32 v42, 16, v101
v_and_b32 v43, 0xffff0000, v101
v_lshlrev_b32 v44, 16, v102
v_and_b32 v45, 0xffff0000, v102
v_lshlrev_b32 v46, 16, v103
v_and_b32 v47, 0xffff0000, v103
v_pk_add_f32 v[32:33], v[32:33], v[40:41]
v_pk_add_f32 v[34:35], v[34:35], v[42:43]
v_pk_add_f32 v[36:37], v[36:37], v[44:45]
v_pk_add_f32 v[38:39], v[38:39], v[46:47]
v_lshlrev_b32 v48, 16, v104
v_and_b32 v49, 0xffff0000, v104
v_lshlrev_b32 v50, 16, v105
v_and_b32 v51, 0xffff0000, v105
v_lshlrev_b32 v52, 16, v106
v_and_b32 v53, 0xffff0000, v106
v_lshlrev_b32 v54, 16, v107
v_and_b32 v55, 0xffff0000, v107
v_pk_add_f32 v[32:33], v[32:33], v[48:49]
v_pk_add_f32 v[34:35], v[34:35], v[50:51]
v_pk_add_f32 v[36:37], v[36:37], v[52:53]
v_pk_add_f32 v[38:39], v[38:39], v[54:55]
s_barrier
v_lshlrev_b32 v40, 16, v108
v_and_b32 v41, 0xffff0000, v108
v_lshlrev_b32 v42, 16, v109
v_and_b32 v43, 0xffff0000, v109
v_lshlrev_b32 v44, 16, v110
v_and_b32 v45, 0xffff0000, v110
v_lshlrev_b32 v46, 16, v111
v_and_b32 v47, 0xffff0000, v111
v_pk_add_f32 v[32:33], v[32:33], v[40:41]
v_pk_add_f32 v[34:35], v[34:35], v[42:43]
v_pk_add_f32 v[36:37], v[36:37], v[44:45]
v_pk_add_f32 v[38:39], v[38:39], v[46:47]
v_lshlrev_b32 v48, 16, v112
v_and_b32 v49, 0xffff0000, v112
v_lshlrev_b32 v50, 16, v113
v_and_b32 v51, 0xffff0000, v113
v_lshlrev_b32 v52, 16, v114
v_and_b32 v53, 0xffff0000, v114
v_lshlrev_b32 v54, 16, v115
v_and_b32 v55, 0xffff0000, v115
v_pk_add_f32 v[32:33], v[32:33], v[48:49]
v_pk_add_f32 v[34:35], v[34:35], v[50:51]
v_pk_add_f32 v[36:37], v[36:37], v[52:53]
v_pk_add_f32 v[38:39], v[38:39], v[54:55]
v_lshlrev_b32 v40, 16, v120
v_and_b32 v41, 0xffff0000, v120
v_lshlrev_b32 v42, 16, v121
v_and_b32 v43, 0xffff0000, v121
v_lshlrev_b32 v44, 16, v122
v_and_b32 v45, 0xffff0000, v122
v_lshlrev_b32 v46, 16, v123
v_and_b32 v47, 0xffff0000, v123
v_pk_add_f32 v[32:33], v[32:33], v[40:41]
v_pk_add_f32 v[34:35], v[34:35], v[42:43]
v_pk_add_f32 v[36:37], v[36:37], v[44:45]
v_pk_add_f32 v[38:39], v[38:39], v[46:47]
v_lshlrev_b32 v48, 16, v124
v_and_b32 v49, 0xffff0000, v124
v_lshlrev_b32 v50, 16, v125
v_and_b32 v51, 0xffff0000, v125
v_lshlrev_b32 v52, 16, v126
v_and_b32 v53, 0xffff0000, v126
v_lshlrev_b32 v54, 16, v127
v_and_b32 v55, 0xffff0000, v127
v_pk_add_f32 v[32:33], v[32:33], v[48:49]
v_pk_add_f32 v[34:35], v[34:35], v[50:51]
v_pk_add_f32 v[36:37], v[36:37], v[52:53]
v_pk_add_f32 v[38:39], v[38:39], v[54:55]
s_barrier
s_waitcnt vmcnt(0)
v_lshlrev_b32 v40, 16, v128
v_and_b32 v41, 0xffff0000, v128
v_lshlrev_b32 v42, 16, v129
v_and_b32 v43, 0xffff0000, v129
v_lshlrev_b32 v44, 16, v130
v_and_b32 v45, 0xffff0000, v130
v_lshlrev_b32 v46, 16, v131
v_and_b32 v47, 0xffff0000, v131
v_pk_add_f32 v[32:33], v[32:33], v[40:41]
v_pk_add_f32 v[34:35], v[34:35], v[42:43]
v_pk_add_f32 v[36:37], v[36:37], v[44:45]
v_pk_add_f32 v[38:39], v[38:39], v[46:47]
v_lshlrev_b32 v48, 16, v132
v_and_b32 v49, 0xffff0000, v132
v_lshlrev_b32 v50, 16, v133
v_and_b32 v51, 0xffff0000, v133
v_lshlrev_b32 v52, 16, v134
v_and_b32 v53, 0xffff0000, v134
v_lshlrev_b32 v54, 16, v135
v_and_b32 v55, 0xffff0000, v135
v_pk_add_f32 v[32:33], v[32:33], v[48:49]
v_pk_add_f32 v[34:35], v[34:35], v[50:51]
v_pk_add_f32 v[36:37], v[36:37], v[52:53]
v_pk_add_f32 v[38:39], v[38:39], v[54:55]
v_lshlrev_b32 v40, 16, v136
v_and_b32 v41, 0xffff0000, v136
v_lshlrev_b32 v42, 16, v137
v_and_b32 v43, 0xffff0000, v137
v_lshlrev_b32 v44, 16, v138
v_and_b32 v45, 0xffff0000, v138
v_lshlrev_b32 v46, 16, v139
v_and_b32 v47, 0xffff0000, v139
v_pk_add_f32 v[32:33], v[32:33], v[40:41]
v_pk_add_f32 v[34:35], v[34:35], v[42:43]
v_pk_add_f32 v[36:37], v[36:37], v[44:45]
v_pk_add_f32 v[38:39], v[38:39], v[46:47]
v_lshlrev_b32 v48, 16, v140
v_and_b32 v49, 0xffff0000, v140
v_lshlrev_b32 v50, 16, v141
v_and_b32 v51, 0xffff0000, v141
v_lshlrev_b32 v52, 16, v142
v_and_b32 v53, 0xffff0000, v142
v_lshlrev_b32 v54, 16, v143
v_and_b32 v55, 0xffff0000, v143
v_pk_add_f32 v[32:33], v[32:33], v[48:49]
v_pk_add_f32 v[34:35], v[34:35], v[50:51]
v_pk_add_f32 v[36:37], v[36:37], v[52:53]
v_pk_add_f32 v[38:39], v[38:39], v[54:55]
s_barrier
v_lshlrev_b32 v40, 16, v144
v_and_b32 v41, 0xffff0000, v144
v_lshlrev_b32 v42, 16, v145
v_and_b32 v43, 0xffff0000, v145
v_lshlrev_b32 v44, 16, v146
v_and_b32 v45, 0xffff0000, v146
v_lshlrev_b32 v46, 16, v147
v_and_b32 v47, 0xffff0000, v147
v_pk_add_f32 v[32:33], v[32:33], v[40:41]
v_pk_add_f32 v[34:35], v[34:35], v[42:43]
v_pk_add_f32 v[36:37], v[36:37], v[44:45]
v_pk_add_f32 v[38:39], v[38:39], v[46:47]
v_lshlrev_b32 v48, 16, v148
v_and_b32 v49, 0xffff0000, v148
v_lshlrev_b32 v50, 16, v149
v_and_b32 v51, 0xffff0000, v149
v_lshlrev_b32 v52, 16, v150
v_and_b32 v53, 0xffff0000, v150
v_lshlrev_b32 v54, 16, v151
v_and_b32 v55, 0xffff0000, v151
v_pk_add_f32 v[32:33], v[32:33], v[48:49]
v_pk_add_f32 v[34:35], v[34:35], v[50:51]
v_pk_add_f32 v[36:37], v[36:37], v[52:53]
v_pk_add_f32 v[38:39], v[38:39], v[54:55]
v_lshlrev_b32 v40, 16, v152
v_and_b32 v41, 0xffff0000, v152
v_lshlrev_b32 v42, 16, v153
v_and_b32 v43, 0xffff0000, v153
v_lshlrev_b32 v44, 16, v154
v_and_b32 v45, 0xffff0000, v154
v_lshlrev_b32 v46, 16, v155
v_and_b32 v47, 0xffff0000, v155
v_pk_add_f32 v[32:33], v[32:33], v[40:41]
v_pk_add_f32 v[34:35], v[34:35], v[42:43]
v_pk_add_f32 v[36:37], v[36:37], v[44:45]
v_pk_add_f32 v[38:39], v[38:39], v[46:47]
v_lshlrev_b32 v48, 16, v156
v_and_b32 v49, 0xffff0000, v156
v_lshlrev_b32 v50, 16, v157
v_and_b32 v51, 0xffff0000, v157
v_lshlrev_b32 v52, 16, v158
v_and_b32 v53, 0xffff0000, v158
v_lshlrev_b32 v54, 16, v159
v_and_b32 v55, 0xffff0000, v159
v_pk_add_f32 v[32:33], v[32:33], v[48:49]
v_pk_add_f32 v[34:35], v[34:35], v[50:51]
v_pk_add_f32 v[36:37], v[36:37], v[52:53]
v_pk_add_f32 v[38:39], v[38:39], v[54:55]
s_barrier
v_lshlrev_b32 v40, 16, v160
v_and_b32 v41, 0xffff0000, v160
v_lshlrev_b32 v42, 16, v161
v_and_b32 v43, 0xffff0000, v161
v_lshlrev_b32 v44, 16, v162
v_and_b32 v45, 0xffff0000, v162
v_lshlrev_b32 v46, 16, v163
v_and_b32 v47, 0xffff0000, v163
v_pk_add_f32 v[32:33], v[32:33], v[40:41]
v_pk_add_f32 v[34:35], v[34:35], v[42:43]
v_pk_add_f32 v[36:37], v[36:37], v[44:45]
v_pk_add_f32 v[38:39], v[38:39], v[46:47]
v_lshlrev_b32 v48, 16, v164
v_and_b32 v49, 0xffff0000, v164
v_lshlrev_b32 v50, 16, v165
v_and_b32 v51, 0xffff0000, v165
v_lshlrev_b32 v52, 16, v166
v_and_b32 v53, 0xffff0000, v166
v_lshlrev_b32 v54, 16, v167
v_and_b32 v55, 0xffff0000, v167
v_pk_add_f32 v[32:33], v[32:33], v[48:49]
v_pk_add_f32 v[34:35], v[34:35], v[50:51]
v_pk_add_f32 v[36:37], v[36:37], v[52:53]
v_pk_add_f32 v[38:39], v[38:39], v[54:55]
v_lshlrev_b32 v40, 16, v168
v_and_b32 v41, 0xffff0000, v168
v_lshlrev_b32 v42, 16, v169
v_and_b32 v43, 0xffff0000, v169
v_lshlrev_b32 v44, 16, v170
v_and_b32 v45, 0xffff0000, v170
v_lshlrev_b32 v46, 16, v171
v_and_b32 v47, 0xffff0000, v171
v_pk_add_f32 v[32:33], v[32:33], v[40:41]
v_pk_add_f32 v[34:35], v[34:35], v[42:43]
v_pk_add_f32 v[36:37], v[36:37], v[44:45]
v_pk_add_f32 v[38:39], v[38:39], v[46:47]
v_lshlrev_b32 v48, 16, v172
v_and_b32 v49, 0xffff0000, v172
v_lshlrev_b32 v50, 16, v173
v_and_b32 v51, 0xffff0000, v173
v_lshlrev_b32 v52, 16, v174
v_and_b32 v53, 0xffff0000, v174
v_lshlrev_b32 v54, 16, v175
v_and_b32 v55, 0xffff0000, v175
v_pk_add_f32 v[32:33], v[32:33], v[48:49]
v_pk_add_f32 v[34:35], v[34:35], v[50:51]
v_pk_add_f32 v[36:37], v[36:37], v[52:53]
v_pk_add_f32 v[38:39], v[38:39], v[54:55]
s_barrier
v_lshlrev_b32 v40, 16, v176
v_and_b32 v41, 0xffff0000, v176
v_lshlrev_b32 v42, 16, v177
v_and_b32 v43, 0xffff0000, v177
v_lshlrev_b32 v44, 16, v178
v_and_b32 v45, 0xffff0000, v178
v_lshlrev_b32 v46, 16, v179
v_and_b32 v47, 0xffff0000, v179
v_pk_add_f32 v[32:33], v[32:33], v[40:41]
v_pk_add_f32 v[34:35], v[34:35], v[42:43]
v_pk_add_f32 v[36:37], v[36:37], v[44:45]
v_pk_add_f32 v[38:39], v[38:39], v[46:47]
v_lshlrev_b32 v48, 16, v180
v_and_b32 v49, 0xffff0000, v180
v_lshlrev_b32 v50, 16, v181
v_and_b32 v51, 0xffff0000, v181
v_lshlrev_b32 v52, 16, v182
v_and_b32 v53, 0xffff0000, v182
v_lshlrev_b32 v54, 16, v183
v_and_b32 v55, 0xffff0000, v183
v_pk_add_f32 v[32:33], v[32:33], v[48:49]
v_pk_add_f32 v[34:35], v[34:35], v[50:51]
v_pk_add_f32 v[36:37], v[36:37], v[52:53]
v_pk_add_f32 v[38:39], v[38:39], v[54:55]
v_lshlrev_b32 v40, 16, v184
v_and_b32 v41, 0xffff0000, v184
v_lshlrev_b32 v42, 16, v185
v_and_b32 v43, 0xffff0000, v185
v_lshlrev_b32 v44, 16, v186
v_and_b32 v45, 0xffff0000, v186
v_lshlrev_b32 v46, 16, v187
v_and_b32 v47, 0xffff0000, v187
v_pk_add_f32 v[32:33], v[32:33], v[40:41]
v_pk_add_f32 v[34:35], v[34:35], v[42:43]
v_pk_add_f32 v[36:37], v[36:37], v[44:45]
v_pk_add_f32 v[38:39], v[38:39], v[46:47]
v_lshlrev_b32 v48, 16, v188
v_and_b32 v49, 0xffff0000, v188
v_lshlrev_b32 v50, 16, v189
v_and_b32 v51, 0xffff0000, v189
v_lshlrev_b32 v52, 16, v190
v_and_b32 v53, 0xffff0000, v190
v_lshlrev_b32 v54, 16, v191
v_and_b32 v55, 0xffff0000, v191
v_pk_add_f32 v[32:33], v[32:33], v[48:49]
v_pk_add_f32 v[34:35], v[34:35], v[50:51]
v_pk_add_f32 v[36:37], v[36:37], v[52:53]
v_pk_add_f32 v[38:39], v[38:39], v[54:55]
s_barrier
s_nop 2
v_mov_b32 v40, v32
v_mov_b32 v41, v33
v_mov_b32 v42, v34
v_mov_b32 v43, v35
v_mov_b32 v44, v36
v_mov_b32 v45, v37
v_mov_b32 v46, v38
v_mov_b32 v47, v39
s_nop 0
v_permlane16_swap_b32 v32, v40
v_permlane16_swap_b32 v33, v41
v_permlane16_swap_b32 v34, v42
v_permlane16_swap_b32 v35, v43
v_permlane16_swap_b32 v36, v44
v_permlane16_swap_b32 v37, v45
v_permlane16_swap_b32 v38, v46
v_permlane16_swap_b32 v39, v47
v_add_f32 v32, v32, v40
v_add_f32 v33, v33, v41
v_add_f32 v34, v34, v42
v_add_f32 v35, v35, v43
v_add_f32 v36, v36, v44
v_add_f32 v37, v37, v45
v_add_f32 v38, v38, v46
v_add_f32 v39, v39, v47
v_mov_b32 v40, v32
v_mov_b32 v41, v33
v_mov_b32 v42, v34
v_mov_b32 v43, v35
v_mov_b32 v44, v36
v_mov_b32 v45, v37
v_mov_b32 v46, v38
v_mov_b32 v47, v39
s_nop 0
v_permlane32_swap_b32 v32, v40
v_permlane32_swap_b32 v33, v41
v_permlane32_swap_b32 v34, v42
v_permlane32_swap_b32 v35, v43
v_permlane32_swap_b32 v36, v44
v_permlane32_swap_b32 v37, v45
v_permlane32_swap_b32 v38, v46
v_permlane32_swap_b32 v39, v47
v_add_f32 v32, v32, v40
v_add_f32 v33, v33, v41
v_add_f32 v34, v34, v42
v_add_f32 v35, v35, v43
v_add_f32 v36, v36, v44
v_add_f32 v37, v37, v45
v_add_f32 v38, v38, v46
v_add_f32 v39, v39, v47
s_mov_b64 exec, 0xffff
buffer_store_dwordx4 v[32:35], v5, s[72:75], 0 offen sc1
buffer_store_dwordx4 v[36:39], v5, s[72:75], 0 offen offset:16 sc1
s_mov_b64 exec, -1
s_waitcnt vmcnt(0)
s_add_u32 s43, s50, 96
s_lshl_b32 s43, s43, 7
v_mov_b32 v12, s43
v_mov_b32 v13, 1
s_mov_b64 exec, 1
buffer_atomic_add v13, v12, s[56:59], 0 offen sc1
s_mov_b64 exec, -1
s_branch Lcsd_110
.p2align 6
Lw_44:
s_branch Lr_45
s_nop 0
Lnojob_109:
s_lshl_b32 s43, s34, 18
s_add_u32 s12, s32, s43
s_addc_u32 s13, s33, 0
s_mov_b32 s14, 262144
s_mov_b32 s15, 0x20000
v_lshlrev_b32 v21, 4, v1
s_lshl_b32 s54, s36, 11
s_add_u32 s43, s35, 1
s_and_b32 s43, s43, 15
s_lshl_b32 s43, s43, 14
s_add_u32 s30, s43, s54
s_add_u32 s43, s35, 2
s_and_b32 s43, s43, 15
s_lshl_b32 s43, s43, 14
s_add_u32 s31, s43, s54
s_waitcnt vmcnt(0)
s_barrier
ds_write_b128 v27, v[68:71] offset:0
ds_write_b128 v27, v[116:119] offset:512
s_waitcnt lgkmcnt(0)
s_barrier
s_add_u32 m0, s54, 16384
s_add_u32 s43, s30, 0
buffer_load_dwordx4 v21, s[12:15], s43 offen sc1 lds
s_add_u32 m0, s54, 17408
s_add_u32 s43, s30, 1024
buffer_load_dwordx4 v21, s[12:15], s43 offen sc1 lds
s_add_u32 m0, s54, 32768
s_add_u32 s43, s31, 0
buffer_load_dwordx4 v21, s[12:15], s43 offen sc1 lds
s_add_u32 m0, s54, 33792
s_add_u32 s43, s31, 1024
buffer_load_dwordx4 v21, s[12:15], s43 offen sc1 lds
s_waitcnt vmcnt(2)
s_barrier
s_waitcnt vmcnt(0)
s_barrier
s_barrier
s_barrier
s_barrier
s_barrier
s_barrier
s_barrier
s_barrier
s_barrier
s_barrier
s_barrier
s_barrier
s_barrier
s_barrier
s_barrier
s_barrier
.p2align 3
Lcsd_110:
s_mov_b32 s46, 1
s_lshl_b32 s43, s34, 18
s_add_u32 s12, s32, s43
s_addc_u32 s13, s33, 0
s_add_u32 s12, s12, 4194304
s_addc_u32 s13, s13, 0
s_mov_b32 s14, 262144
s_mov_b32 s15, 0x20000
v_lshlrev_b32 v21, 4, v1
s_lshl_b32 s54, s36, 11
s_add_u32 s43, s35, 1
s_and_b32 s43, s43, 15
s_lshl_b32 s43, s43, 14
s_add_u32 s30, s43, s54
s_add_u32 s43, s35, 2
s_and_b32 s43, s43, 15
s_lshl_b32 s43, s43, 14
s_add_u32 s31, s43, s54
s_mov_b32 s88, s4
s_mov_b32 s89, s5
s_mov_b32 s90, 7340032
s_mov_b32 s91, 0x20000
s_mov_b32 s92, s6
s_mov_b32 s93, s7
s_mov_b32 s94, 7340032
s_mov_b32 s95, 0x20000
s_lshr_b32 s43, s35, 3
v_and_b32 v19, 1, v1
v_bfe_u32 v23, v1, 2, 2
s_lshl_b32 s44, s43, 3
s_add_u32 s44, s44, 1
v_lshl_add_u32 v23, v19, 2, v23
v_add_u32 v23, s44, v23
s_lshl_b32 s43, s43, 11
s_add_u32 s43, s43, 384
s_movk_i32 s44, 1024
s_lshr_b32 s45, s2, 3
s_mul_i32 s45, s45, 14336
s_add_u32 s43, s43, s45
v_mul_lo_u32 v31, v19, s44
v_bfe_u32 v19, v1, 1, 1
v_mul_u32_u24 v19, 7168, v19
v_add3_u32 v31, v31, v19, s43
v_add_u32 v19, 3, v23
v_and_b32 v19, 15, v19
v_mul_u32_u24 v19, 458752, v19
v_add_u32 v19, v19, v31
buffer_load_dword v30, v19, s[88:91], 0 offen
buffer_load_dword v30, v19, s[92:95], 0 offen
s_lshl_b32 s43, s34, 14
s_add_u32 s64, s32, s43
s_addc_u32 s65, s33, 0
s_add_u32 s64, s64, 25165824
s_addc_u32 s65, s65, 0
s_mov_b32 s66, 16384
s_mov_b32 s67, 0x20000
s_add_u32 s72, s32, 27262976
s_addc_u32 s73, s33, 0
s_mov_b32 s74, 114688
s_mov_b32 s75, 0x20000
s_barrier
s_add_u32 s43, s34, 16
s_lshl_b32 s43, s43, 7
v_mov_b32 v8, s43
v_mov_b32 v9, 1
s_mov_b64 exec, 1
buffer_atomic_add v9, v8, s[56:59], 0 offen sc1
s_mov_b64 exec, -1
s_mul_i32 s43, s2, 28672
s_mul_i32 s44, s51, 7168
s_add_u32 s43, s43, s44
s_add_u32 s80, s60, s43
s_addc_u32 s81, s61, 0
s_load_dword s82, s[80:81], 0
s_load_dword s83, s[80:81], 64
s_load_dword s84, s[80:81], 128
s_load_dword s85, s[80:81], 192
s_load_dword s86, s[80:81], 256
s_load_dword s87, s[80:81], 320
s_load_dword s82, s[80:81], 384
s_load_dword s83, s[80:81], 448
s_load_dword s84, s[80:81], 512
s_load_dword s85, s[80:81], 576
s_load_dword s86, s[80:81], 640
s_add_u32 s80, s80, 704
s_addc_u32 s81, s81, 0
s_barrier
s_load_dword s82, s[80:81], 0
s_load_dword s83, s[80:81], 64
s_load_dword s84, s[80:81], 128
s_load_dword s85, s[80:81], 192
s_load_dword s86, s[80:81], 256
s_load_dword s87, s[80:81], 320
s_load_dword s82, s[80:81], 384
s_load_dword s83, s[80:81], 448
s_load_dword s84, s[80:81], 512
s_load_dword s85, s[80:81], 576
s_load_dword s86, s[80:81], 640
s_add_u32 s80, s80, 704
s_addc_u32 s81, s81, 0
s_barrier
v_add_u32 v19, 7, v23
v_and_b32 v19, 15, v19
v_mul_u32_u24 v19, 458752, v19
v_add_u32 v19, v19, v31
buffer_load_dword v30, v19, s[88:91], 0 offen
buffer_load_dword v30, v19, s[92:95], 0 offen
s_mul_i32 s43, s49, 96
s_add_u32 s44, s43, 95
s_lshr_b32 s43, s43, 7
s_lshr_b32 s44, s44, 7
s_add_u32 s43, s43, 16
s_add_u32 s44, s44, 16
v_mov_b32 v12, s44
v_writelane_b32 v12, s35, 0
v_writelane_b32 v12, s43, 1
v_add_u32 v12, 96, v12
v_lshlrev_b32 v12, 7, v12
v_mov_b32 v14, 8
buffer_load_dword v13, v12, s[56:59], 0 offen sc1
s_load_dword s82, s[80:81], 0
s_load_dword s83, s[80:81], 64
s_load_dword s84, s[80:81], 128
s_load_dword s85, s[80:81], 192
s_load_dword s86, s[80:81], 256
s_load_dword s87, s[80:81], 320
s_load_dword s82, s[80:81], 384
s_load_dword s83, s[80:81], 448
s_load_dword s84, s[80:81], 512
s_load_dword s85, s[80:81], 576
s_load_dword s86, s[80:81], 640
s_add_u32 s80, s80, 704
s_addc_u32 s81, s81, 0
s_barrier
s_add_u32 s43, s34, 16
s_lshl_b32 s43, s43, 7
v_mov_b32 v8, s43
v_mov_b32 v10, 16
buffer_load_dword v9, v8, s[56:59], 0 offen sc1
s_load_dword s82, s[80:81], 0
s_load_dword s83, s[80:81], 64
s_load_dword s84, s[80:81], 128
s_load_dword s85, s[80:81], 192
s_load_dword s86, s[80:81], 256
s_load_dword s87, s[80:81], 320
s_load_dword s82, s[80:81], 384
s_load_dword s83, s[80:81], 448
s_load_dword s84, s[80:81], 512
s_load_dword s85, s[80:81], 576
s_load_dword s86, s[80:81], 640
s_add_u32 s80, s80, 704
s_addc_u32 s81, s81, 0
s_barrier
s_mov_b32 s41, 0x10000
Lpoll_111:
s_waitcnt vmcnt(0)
Lpf_113:
v_cmp_ne_u32 vcc, v10, v9
s_nop 4
s_cbranch_vccz Lpok_112
buffer_load_dword v9, v8, s[56:59], 0 offen sc1
s_sub_u32 s41, s41, 1
s_cmp_lg_u32 s41, 0
s_cbranch_scc1 Lpoll_111
s_waitcnt vmcnt(0)
Lpok_112:
s_mov_b32 s41, 0x10000
Lpoll_114:
s_waitcnt vmcnt(0)
Lpf_116:
v_cmp_ne_u32 vcc, v14, v13
s_nop 4
s_cbranch_vccz Lpok_115
buffer_load_dword v13, v12, s[56:59], 0 offen sc1
s_sub_u32 s41, s41, 1
s_cmp_lg_u32 s41, 0
s_cbranch_scc1 Lpoll_114
s_waitcnt vmcnt(0)
Lpok_115:
v_min_u32 v12, 55, v1
v_lshlrev_b32 v13, 4, v12
s_lshl_b32 s43, s35, 9
s_mul_i32 s44, s49, 384
s_add_u32 s44, s44, 7680
v_mov_b32 v14, s44
v_mov_b32 v15, s43
v_cmp_gt_u32 vcc, 32, v12
s_nop 1
v_cndmask_b32 v14, v14, v15, vcc
v_add_u32 v14, v14, v13
v_add_u32 v13, 148480, v13
s_mov_b32 s43, 0
buffer_load_dwordx4 v[192:195], v14, s[72:75], s43 offen sc1
s_mov_b32 s43, 28672
buffer_load_dwordx4 v[196:199], v14, s[72:75], s43 offen sc1
s_mov_b32 s43, 57344
buffer_load_dwordx4 v[200:203], v14, s[72:75], s43 offen sc1
s_mov_b32 s43, 86016
buffer_load_dwordx4 v[204:207], v14, s[72:75], s43 offen sc1
s_mov_b32 s43, 14336
buffer_load_dwordx4 v[208:211], v14, s[72:75], s43 offen sc1
s_mov_b32 s43, 43008
buffer_load_dwordx4 v[212:215], v14, s[72:75], s43 offen sc1
s_mov_b32 s43, 71680
buffer_load_dwordx4 v[216:219], v14, s[72:75], s43 offen sc1
s_mov_b32 s43, 100352
buffer_load_dwordx4 v[220:223], v14, s[72:75], s43 offen sc1
s_load_dword s82, s[80:81], 0
s_load_dword s83, s[80:81], 64
s_load_dword s84, s[80:81], 128
s_load_dword s85, s[80:81], 192
s_load_dword s86, s[80:81], 256
s_load_dword s87, s[80:81], 320
s_load_dword s82, s[80:81], 384
s_load_dword s83, s[80:81], 448
s_load_dword s84, s[80:81], 512
s_load_dword s85, s[80:81], 576
s_load_dword s86, s[80:81], 640
s_add_u32 s80, s80, 704
s_addc_u32 s81, s81, 0
s_barrier
s_getpc_b64 s[78:79]
Lpc_117:
s_sub_u32 s78, s78, Lpc_117-sequential_preLN__sliding_local_dilated__glu_gated_geglu__prompt_kernel
s_subb_u32 s79, s79, 0
s_lshr_b32 s43, s2, 3
s_mul_i32 s43, s43, 3840
v_min_u32 v19, 29, v1
v_lshl_add_u32 v19, v19, 7, s43
v_min_u32 v19, Ldone_1-sequential_preLN__sliding_local_dilated__glu_gated_geglu__prompt_kernel, v19
global_load_dword v30, v19, s[78:79]
s_mov_b32 s43, 0
buffer_load_dwordx4 v[128:131], v21, s[64:67], s43 offen sc1
s_mov_b32 s43, 1024
buffer_load_dwordx4 v[132:135], v21, s[64:67], s43 offen sc1
s_mov_b32 s43, 2048
buffer_load_dwordx4 v[136:139], v21, s[64:67], s43 offen sc1
s_mov_b32 s43, 3072
buffer_load_dwordx4 v[140:143], v21, s[64:67], s43 offen sc1
s_mov_b32 s43, 4096
buffer_load_dwordx4 v[144:147], v21, s[64:67], s43 offen sc1
s_mov_b32 s43, 5120
buffer_load_dwordx4 v[148:151], v21, s[64:67], s43 offen sc1
s_mov_b32 s43, 6144
buffer_load_dwordx4 v[152:155], v21, s[64:67], s43 offen sc1
s_mov_b32 s43, 7168
buffer_load_dwordx4 v[156:159], v21, s[64:67], s43 offen sc1
s_mov_b32 s43, 8192
buffer_load_dwordx4 v[160:163], v21, s[64:67], s43 offen sc1
s_mov_b32 s43, 9216
buffer_load_dwordx4 v[164:167], v21, s[64:67], s43 offen sc1
s_mov_b32 s43, 10240
buffer_load_dwordx4 v[168:171], v21, s[64:67], s43 offen sc1
s_mov_b32 s43, 11264
buffer_load_dwordx4 v[172:175], v21, s[64:67], s43 offen sc1
s_mov_b32 s43, 12288
buffer_load_dwordx4 v[176:179], v21, s[64:67], s43 offen sc1
s_mov_b32 s43, 13312
buffer_load_dwordx4 v[180:183], v21, s[64:67], s43 offen sc1
s_mov_b32 s43, 14336
buffer_load_dwordx4 v[184:187], v21, s[64:67], s43 offen sc1
s_mov_b32 s43, 15360
buffer_load_dwordx4 v[188:191], v21, s[64:67], s43 offen sc1
s_load_dword s82, s[80:81], 0
s_load_dword s83, s[80:81], 64
s_load_dword s84, s[80:81], 128
s_load_dword s85, s[80:81], 192
s_load_dword s86, s[80:81], 256
s_load_dword s87, s[80:81], 320
s_load_dword s82, s[80:81], 384
s_load_dword s83, s[80:81], 448
s_load_dword s84, s[80:81], 512
s_load_dword s85, s[80:81], 576
s_load_dword s86, s[80:81], 640
s_add_u32 s80, s80, 704
s_addc_u32 s81, s81, 0
s_barrier
v_add_u32 v19, 11, v23
v_and_b32 v19, 15, v19
v_mul_u32_u24 v19, 458752, v19
v_add_u32 v19, v19, v31
buffer_load_dword v30, v19, s[88:91], 0 offen
buffer_load_dword v30, v19, s[92:95], 0 offen
s_waitcnt vmcnt(16)
v_add_f32 v192, v192, v196
v_add_f32 v200, v200, v204
v_add_f32 v193, v193, v197
v_add_f32 v201, v201, v205
v_add_f32 v194, v194, v198
v_add_f32 v202, v202, v206
v_add_f32 v195, v195, v199
v_add_f32 v203, v203, v207
v_add_f32 v192, v192, v200
v_add_f32 v193, v193, v201
v_add_f32 v194, v194, v202
v_add_f32 v195, v195, v203
ds_write_b128 v13, v[192:195] offset:0
v_add_f32 v208, v208, v212
v_add_f32 v216, v216, v220
v_add_f32 v209, v209, v213
v_add_f32 v217, v217, v221
v_add_f32 v210, v210, v214
v_add_f32 v218, v218, v222
v_add_f32 v211, v211, v215
v_add_f32 v219, v219, v223
v_add_f32 v208, v208, v216
v_add_f32 v209, v209, v217
v_add_f32 v210, v210, v218
v_add_f32 v211, v211, v219
ds_write_b128 v13, v[208:211] offset:896
s_barrier
s_waitcnt vmcnt(0)
v_add_f32 v128, v128, v132
v_add_f32 v129, v129, v133
v_add_f32 v130, v130, v134
v_add_f32 v131, v131, v135
v_add_f32 v128, v128, v136
v_add_f32 v129, v129, v137
v_add_f32 v130, v130, v138
v_add_f32 v131, v131, v139
v_add_f32 v128, v128, v140
v_add_f32 v129, v129, v141
v_add_f32 v130, v130, v142
v_add_f32 v131, v131, v143
v_add_f32 v128, v128, v144
v_add_f32 v129, v129, v145
v_add_f32 v130, v130, v146
v_add_f32 v131, v131, v147
v_add_f32 v128, v128, v148
v_add_f32 v129, v129, v149
v_add_f32 v130, v130, v150
v_add_f32 v131, v131, v151
v_add_f32 v128, v128, v152
v_add_f32 v129, v129, v153
v_add_f32 v130, v130, v154
v_add_f32 v131, v131, v155
v_add_f32 v128, v128, v156
v_add_f32 v129, v129, v157
v_add_f32 v130, v130, v158
v_add_f32 v131, v131, v159
v_add_f32 v128, v128, v160
v_add_f32 v129, v129, v161
v_add_f32 v130, v130, v162
v_add_f32 v131, v131, v163
v_add_f32 v128, v128, v164
v_add_f32 v129, v129, v165
v_add_f32 v130, v130, v166
v_add_f32 v131, v131, v167
v_add_f32 v128, v128, v168
v_add_f32 v129, v129, v169
v_add_f32 v130, v130, v170
v_add_f32 v131, v131, v171
v_add_f32 v128, v128, v172
v_add_f32 v129, v129, v173
v_add_f32 v130, v130, v174
v_add_f32 v131, v131, v175
v_add_f32 v128, v128, v176
v_add_f32 v129, v129, v177
v_add_f32 v130, v130, v178
v_add_f32 v131, v131, v179
v_add_f32 v128, v128, v180
v_add_f32 v129, v129, v181
v_add_f32 v130, v130, v182
v_add_f32 v131, v131, v183
v_add_f32 v128, v128, v184
v_add_f32 v129, v129, v185
v_add_f32 v130, v130, v186
v_add_f32 v131, v131, v187
v_add_f32 v128, v128, v188
v_add_f32 v129, v129, v189
v_add_f32 v130, v130, v190
v_add_f32 v131, v131, v191
v_mul_f32 v128, 0x3a800000, v128
v_mul_f32 v129, 0x3a800000, v129
v_fma_f32 v129, -v128, v128, v129
v_max_f32 v129, 0, v129
v_add_f32 v129, 0x3727c5ac, v129
v_rsq_f32 v129, v129
v_mul_f32 v130, 0x3a800000, v130
v_mul_f32 v131, 0x3a800000, v131
v_fma_f32 v131, -v130, v130, v131
v_max_f32 v131, 0, v131
v_add_f32 v131, 0x3727c5ac, v131
v_rsq_f32 v131, v131
v_add_u32 v19, 147456, v21
ds_write_b128 v19, v[128:131]
s_waitcnt lgkmcnt(0)
s_load_dword s82, s[80:81], 0
s_load_dword s83, s[80:81], 64
s_load_dword s84, s[80:81], 128
s_load_dword s85, s[80:81], 192
s_load_dword s86, s[80:81], 256
s_load_dword s87, s[80:81], 320
s_load_dword s82, s[80:81], 384
s_load_dword s83, s[80:81], 448
s_load_dword s84, s[80:81], 512
s_load_dword s85, s[80:81], 576
s_load_dword s86, s[80:81], 640
s_add_u32 s80, s80, 704
s_addc_u32 s81, s81, 0
s_barrier
s_load_dword s82, s[80:81], 0
s_load_dword s83, s[80:81], 64
s_load_dword s84, s[80:81], 128
s_load_dword s85, s[80:81], 192
s_load_dword s86, s[80:81], 256
s_load_dword s87, s[80:81], 320
s_load_dword s82, s[80:81], 384
s_load_dword s83, s[80:81], 448
s_load_dword s84, s[80:81], 512
s_load_dword s85, s[80:81], 576
s_load_dword s86, s[80:81], 640
s_add_u32 s80, s80, 704
s_addc_u32 s81, s81, 0
s_barrier
v_add_u32 v19, 15, v23
v_and_b32 v19, 15, v19
v_mul_u32_u24 v19, 458752, v19
v_add_u32 v19, v19, v31
buffer_load_dword v30, v19, s[88:91], 0 offen
buffer_load_dword v30, v19, s[92:95], 0 offen
s_and_b32 s53, s35, 1
s_lshl_b32 s53, s53, 1
s_mul_i32 s43, s47, 3
s_add_u32 s53, s53, s43
v_lshlrev_b32 v19, 11, v18
v_lshl_add_u32 v19, v17, 4, v19
s_lshl_b32 s43, s46, 10
v_add_u32 v2, s43, v19
v_add_u32 v3, 49152, v2
v_add_u32 v4, 98304, v2
v_lshrrev_b32 v19, 2, v17
v_lshl_add_u32 v20, v18, 2, v19
v_and_b32 v21, 7, v20
v_lshlrev_b32 v20, 8, v20
v_and_b32 v19, 3, v1
v_lshl_add_u32 v20, v19, 3, v20
s_add_u32 s43, s53, 0
v_xor_b32 v19, s43, v21
v_lshl_add_u32 v5, v19, 5, v20
s_add_u32 s43, s53, 1
v_xor_b32 v19, s43, v21
v_lshl_add_u32 v6, v19, 5, v20
s_add_u32 s43, s53, 2
v_xor_b32 v19, s43, v21
v_lshl_add_u32 v7, v19, 5, v20
v_add_u32 v9, 49152, v5
v_add_u32 v10, 49152, v6
v_add_u32 v11, 49152, v7
v_add_u32 v13, 98304, v5
v_add_u32 v14, 98304, v6
v_add_u32 v15, 98304, v7
s_lshl_b32 s43, s46, 9
s_add_u32 s43, s43, 147456
v_lshl_add_u32 v19, v17, 3, s43
ds_read_b64 v[80:81], v19 offset:0
ds_read_b64 v[82:83], v19 offset:128
ds_read_b64 v[84:85], v19 offset:256
ds_read_b64 v[86:87], v19 offset:384
s_mul_i32 s43, s47, 192
s_add_u32 s43, s43, 148992
v_lshl_add_u32 v19, v18, 4, s43
ds_read_b128 v[48:51], v19 offset:0
ds_read_b128 v[52:55], v19 offset:64
ds_read_b128 v[56:59], v19 offset:128
ds_read_b128 v[60:63], v19 offset:896
ds_read_b128 v[64:67], v19 offset:960
ds_read_b128 v[68:71], v19 offset:1024
s_barrier
s_mov_b32 s88, s4
s_mov_b32 s89, s5
s_mov_b32 s90, 7340032
s_mov_b32 s91, 0x20000
s_mov_b32 s92, s6
s_mov_b32 s93, s7
s_mov_b32 s94, 7340032
s_mov_b32 s95, 0x20000
s_lshr_b32 s43, s35, 3
v_and_b32 v19, 1, v1
v_bfe_u32 v23, v1, 2, 2
s_lshl_b32 s44, s43, 1
s_add_u32 s44, s44, 6
v_add_u32 v23, s44, v23
s_mul_i32 s44, s43, 6
s_add_u32 s44, s44, 1
v_mad_u32_u24 v23, v19, s44, v23
s_lshl_b32 s44, s43, 10
s_lshl_b32 s43, s43, 11
s_sub_u32 s43, 6528, s43
s_lshr_b32 s45, s2, 3
s_mul_i32 s45, s45, 14336
s_add_u32 s43, s43, s45
v_mul_lo_u32 v31, v19, s44
v_bfe_u32 v19, v1, 1, 1
v_mul_u32_u24 v19, 7168, v19
v_add3_u32 v31, v31, v19, s43
v_add_u32 v19, 0, v23
v_and_b32 v19, 15, v19
v_mul_u32_u24 v19, 458752, v19
v_add_u32 v19, v19, v31
buffer_load_dword v30, v19, s[88:91], 0 offen
buffer_load_dword v30, v19, s[92:95], 0 offen
s_waitcnt lgkmcnt(0)
v_mul_f32 v88, v81, v81
v_mul_f32 v228, 0xc0135761, v81
v_mul_f32 v89, 0xbdd2d3e8, v81
v_rcp_f32 v236, v88
v_mul_f32 v232, v89, v88
v_mul_f32 v88, v83, v83
v_mul_f32 v229, 0xc0135761, v83
v_mul_f32 v89, 0xbdd2d3e8, v83
v_rcp_f32 v237, v88
v_mul_f32 v233, v89, v88
v_mul_f32 v88, v85, v85
v_mul_f32 v230, 0xc0135761, v85
v_mul_f32 v89, 0xbdd2d3e8, v85
v_rcp_f32 v238, v88
v_mul_f32 v234, v89, v88
v_mul_f32 v88, v87, v87
v_mul_f32 v231, 0xc0135761, v87
v_mul_f32 v89, 0xbdd2d3e8, v87
v_rcp_f32 v239, v88
v_mul_f32 v235, v89, v88
s_mul_i32 s43, s34, 917504
s_mov_b32 s44, 3577949200
s_mov_b32 s45, 3137247350
s_lshl_b32 s50, s49, 2
s_lshr_b64 s[44:45], s[44:45], s50
s_and_b32 s50, s44, 15
s_mul_i32 s44, s50, 24576
s_add_u32 s43, s43, s44
s_add_u32 s43, s43, 8912896
s_add_u32 s24, s32, s43
s_addc_u32 s25, s33, 0
s_mov_b32 s26, 24576
s_mov_b32 s27, 0x20000
s_mov_b32 s53, 262144
s_lshl_b32 s43, s47, 13
s_lshl_b32 s44, s46, 10
s_add_u32 s43, s43, s44
v_lshlrev_b32 v19, 11, v18
v_lshl_add_u32 v19, v17, 4, v19
v_add_u32 v27, s43, v19
s_lshl_b32 s43, s47, 12
s_add_u32 s43, s43, s44
s_add_u32 s43, s43, 16384
v_and_b32 v19, 1, v18
v_lshlrev_b32 v19, 11, v19
v_lshrrev_b32 v20, 1, v18
v_lshl_add_u32 v19, v20, 8, v19
v_lshl_add_u32 v19, v17, 4, v19
v_add_u32 v28, s43, v19
s_load_dword s82, s[80:81], 0
s_load_dword s83, s[80:81], 64
s_load_dword s84, s[80:81], 128
s_load_dword s85, s[80:81], 192
s_load_dword s86, s[80:81], 256
s_load_dword s87, s[80:81], 320
s_load_dword s82, s[80:81], 384
s_load_dword s83, s[80:81], 448
s_add_u32 s80, s80, 512
s_addc_u32 s81, s81, 0
s_barrier
v_mul_f32 v128, -v80, v48
v_mul_f32 v129, -v80, v49
v_mul_f32 v130, -v80, v50
v_mul_f32 v131, -v80, v51
v_mul_f32 v132, -v82, v48
v_mul_f32 v133, -v82, v49
v_mul_f32 v134, -v82, v50
v_mul_f32 v135, -v82, v51
v_mul_f32 v136, -v84, v48
v_mul_f32 v137, -v84, v49
v_mul_f32 v138, -v84, v50
v_mul_f32 v139, -v84, v51
v_mul_f32 v140, -v86, v48
v_mul_f32 v141, -v86, v49
v_mul_f32 v142, -v86, v50
v_mul_f32 v143, -v86, v51
v_mul_f32 v144, -v80, v52
v_mul_f32 v145, -v80, v53
v_mul_f32 v146, -v80, v54
v_mul_f32 v147, -v80, v55
v_mul_f32 v148, -v82, v52
v_mul_f32 v149, -v82, v53
v_mul_f32 v150, -v82, v54
v_mul_f32 v151, -v82, v55
v_mul_f32 v152, -v84, v52
v_mul_f32 v153, -v84, v53
v_mul_f32 v154, -v84, v54
v_mul_f32 v155, -v84, v55
v_mul_f32 v156, -v86, v52
v_mul_f32 v157, -v86, v53
v_mul_f32 v158, -v86, v54
v_mul_f32 v159, -v86, v55
s_load_dword s82, s[80:81], 0
s_load_dword s83, s[80:81], 64
s_load_dword s84, s[80:81], 128
s_load_dword s85, s[80:81], 192
s_load_dword s86, s[80:81], 256
s_load_dword s87, s[80:81], 320
s_load_dword s82, s[80:81], 384
s_load_dword s83, s[80:81], 448
s_add_u32 s80, s80, 512
s_addc_u32 s81, s81, 0
s_barrier
v_mul_f32 v160, -v80, v56
v_mul_f32 v161, -v80, v57
v_mul_f32 v162, -v80, v58
v_mul_f32 v163, -v80, v59
v_mul_f32 v164, -v82, v56
v_mul_f32 v165, -v82, v57
v_mul_f32 v166, -v82, v58
v_mul_f32 v167, -v82, v59
v_mul_f32 v168, -v84, v56
v_mul_f32 v169, -v84, v57
v_mul_f32 v170, -v84, v58
v_mul_f32 v171, -v84, v59
v_mul_f32 v172, -v86, v56
v_mul_f32 v173, -v86, v57
v_mul_f32 v174, -v86, v58
v_mul_f32 v175, -v86, v59
v_mul_f32 v176, -v80, v60
v_mul_f32 v177, -v80, v61
v_mul_f32 v178, -v80, v62
v_mul_f32 v179, -v80, v63
v_mul_f32 v180, -v82, v60
v_mul_f32 v181, -v82, v61
v_mul_f32 v182, -v82, v62
v_mul_f32 v183, -v82, v63
v_mul_f32 v184, -v84, v60
v_mul_f32 v185, -v84, v61
v_mul_f32 v186, -v84, v62
v_mul_f32 v187, -v84, v63
v_mul_f32 v188, -v86, v60
v_mul_f32 v189, -v86, v61
v_mul_f32 v190, -v86, v62
v_mul_f32 v191, -v86, v63
s_load_dword s82, s[80:81], 0
s_load_dword s83, s[80:81], 64
s_load_dword s84, s[80:81], 128
s_load_dword s85, s[80:81], 192
s_load_dword s86, s[80:81], 256
s_load_dword s87, s[80:81], 320
s_load_dword s82, s[80:81], 384
s_load_dword s83, s[80:81], 448
s_add_u32 s80, s80, 512
s_addc_u32 s81, s81, 0
s_barrier
v_mul_f32 v192, -v80, v64
v_mul_f32 v193, -v80, v65
v_mul_f32 v194, -v80, v66
v_mul_f32 v195, -v80, v67
v_mul_f32 v196, -v82, v64
v_mul_f32 v197, -v82, v65
v_mul_f32 v198, -v82, v66
v_mul_f32 v199, -v82, v67
v_mul_f32 v200, -v84, v64
v_mul_f32 v201, -v84, v65
v_mul_f32 v202, -v84, v66
v_mul_f32 v203, -v84, v67
v_mul_f32 v204, -v86, v64
v_mul_f32 v205, -v86, v65
v_mul_f32 v206, -v86, v66
v_mul_f32 v207, -v86, v67
v_mul_f32 v208, -v80, v68
v_mul_f32 v209, -v80, v69
v_mul_f32 v210, -v80, v70
v_mul_f32 v211, -v80, v71
v_mul_f32 v212, -v82, v68
v_mul_f32 v213, -v82, v69
v_mul_f32 v214, -v82, v70
v_mul_f32 v215, -v82, v71
v_mul_f32 v216, -v84, v68
v_mul_f32 v217, -v84, v69
v_mul_f32 v218, -v84, v70
v_mul_f32 v219, -v84, v71
v_mul_f32 v220, -v86, v68
v_mul_f32 v221, -v86, v69
v_mul_f32 v222, -v86, v70
v_mul_f32 v223, -v86, v71
s_barrier
s_branch Lw_118
Lr_119:
v_add_u32 v19, 4, v23
v_and_b32 v19, 15, v19
v_mul_u32_u24 v19, 458752, v19
v_add_u32 v19, v19, v31
buffer_load_dword v30, v19, s[88:91], 0 offen
buffer_load_dword v30, v19, s[92:95], 0 offen
s_mul_i32 s44, s34, 917504
s_lshl_b32 s39, s51, 13
s_add_u32 s44, s44, s39
s_add_u32 s44, s44, 8388608
s_and_b32 s43, s51, 1
s_xor_b32 s43, s43, s35
s_lshl_b32 s43, s43, 7
s_mov_b32 s10, 909312
s_movk_i32 s38, 1024
s_movk_i32 s40, 9216
s_movk_i32 s37, 0x4000
s_cmp_ge_u32 s51, 2
s_cselect_b32 s8, s60, s32
s_cselect_b32 s9, s61, s33
s_cselect_b32 s10, 7338112, s10
s_cselect_b32 s43, s43, s44
s_cselect_b32 s38, 16384, s38
s_cselect_b32 s40, 81920, s40
s_cselect_b32 s55, 81920, s38
s_cselect_b32 s37, 262144, s37
s_cselect_b32 s45, -1, 0
s_add_u32 s8, s8, s43
s_addc_u32 s9, s9, 0
s_mov_b32 s11, 0x20000
s_and_b32 s53, s35, 1
s_mul_i32 s54, s53, 6
s_mul_i32 s54, s54, s37
s_mul_i32 s29, s53, 2
s_add_u32 s29, s29, 6
s_mul_i32 s29, s29, s37
s_and_b32 s43, s45, 4290838528
s_add_u32 s29, s29, s43
s_mul_i32 s37, s37, 2
s_sub_u32 s37, s37, s40
v_lshrrev_b32 v19, 3, v1
v_mul_u32_u24 v19, 1920, v19
v_lshrrev_b32 v20, 4, v1
v_lshlrev_b32 v20, 5, v20
v_and_b32 v19, s45, v19
v_and_b32 v20, s45, v20
v_lshlrev_b32 v21, 4, v1
v_xor_b32 v21, v21, v20
v_add_u32 v21, v21, v19
s_barrier
.p2align 3
LK3b_100:
s_setprio 1
ds_read_b128 v[32:35], v2 offset:0
ds_read_b64_tr_b16 v[48:49], v5 offset:16384
ds_read_b64_tr_b16 v[50:51], v5 offset:20480
ds_read_b128 v[36:39], v2 offset:256
ds_read_b128 v[40:43], v2 offset:512
ds_read_b128 v[44:47], v2 offset:768
ds_read_b64_tr_b16 v[60:61], v5 offset:32768
ds_read_b64_tr_b16 v[62:63], v5 offset:36864
ds_read_b64_tr_b16 v[52:53], v6 offset:16384
ds_read_b64_tr_b16 v[54:55], v6 offset:20480
ds_read_b64_tr_b16 v[64:65], v6 offset:32768
ds_read_b64_tr_b16 v[66:67], v6 offset:36864
ds_read_b64_tr_b16 v[56:57], v7 offset:16384
ds_read_b64_tr_b16 v[58:59], v7 offset:20480
ds_read_b64_tr_b16 v[68:69], v7 offset:32768
ds_read_b64_tr_b16 v[70:71], v7 offset:36864
s_mov_b32 s41, 5
.p2align 3
Lk3_120:
s_waitcnt lgkmcnt(0)
v_mfma_f32_16x16x32_bf16 v[128:131], v[48:51], v[32:35], v[128:131]
ds_read_b128 v[80:83], v2 offset:8192
v_mfma_f32_16x16x32_bf16 v[132:135], v[48:51], v[36:39], v[132:135]
ds_read_b64_tr_b16 v[96:97], v5 offset:24576
v_mfma_f32_16x16x32_bf16 v[136:139], v[48:51], v[40:43], v[136:139]
ds_read_b64_tr_b16 v[98:99], v5 offset:28672
v_mfma_f32_16x16x32_bf16 v[140:143], v[48:51], v[44:47], v[140:143]
ds_read_b128 v[84:87], v2 offset:8448
v_mfma_f32_16x16x32_bf16 v[188:191], v[60:63], v[44:47], v[188:191]
ds_read_b128 v[88:91], v2 offset:8704
v_mfma_f32_16x16x32_bf16 v[184:187], v[60:63], v[40:43], v[184:187]
ds_read_b128 v[92:95], v2 offset:8960
v_mfma_f32_16x16x32_bf16 v[180:183], v[60:63], v[36:39], v[180:183]
ds_read_b64_tr_b16 v[108:109], v5 offset:40960
v_mfma_f32_16x16x32_bf16 v[176:179], v[60:63], v[32:35], v[176:179]
ds_read_b64_tr_b16 v[110:111], v5 offset:45056
v_mfma_f32_16x16x32_bf16 v[144:147], v[52:55], v[32:35], v[144:147]
ds_read_b64_tr_b16 v[100:101], v6 offset:24576
v_mfma_f32_16x16x32_bf16 v[148:151], v[52:55], v[36:39], v[148:151]
ds_read_b64_tr_b16 v[102:103], v6 offset:28672
v_mfma_f32_16x16x32_bf16 v[152:155], v[52:55], v[40:43], v[152:155]
ds_read_b64_tr_b16 v[112:113], v6 offset:40960
v_mfma_f32_16x16x32_bf16 v[156:159], v[52:55], v[44:47], v[156:159]
ds_read_b64_tr_b16 v[114:115], v6 offset:45056
v_mfma_f32_16x16x32_bf16 v[204:207], v[64:67], v[44:47], v[204:207]
ds_read_b64_tr_b16 v[104:105], v7 offset:24576
v_mfma_f32_16x16x32_bf16 v[200:203], v[64:67], v[40:43], v[200:203]
ds_read_b64_tr_b16 v[106:107], v7 offset:28672
v_mfma_f32_16x16x32_bf16 v[196:199], v[64:67], v[36:39], v[196:199]
ds_read_b64_tr_b16 v[116:117], v7 offset:40960
v_mfma_f32_16x16x32_bf16 v[192:195], v[64:67], v[32:35], v[192:195]
ds_read_b64_tr_b16 v[118:119], v7 offset:45056
v_mfma_f32_16x16x32_bf16 v[160:163], v[56:59], v[32:35], v[160:163]
v_mfma_f32_16x16x32_bf16 v[164:167], v[56:59], v[36:39], v[164:167]
v_mfma_f32_16x16x32_bf16 v[168:171], v[56:59], v[40:43], v[168:171]
v_mfma_f32_16x16x32_bf16 v[172:175], v[56:59], v[44:47], v[172:175]
v_mfma_f32_16x16x32_bf16 v[220:223], v[68:71], v[44:47], v[220:223]
v_mfma_f32_16x16x32_bf16 v[216:219], v[68:71], v[40:43], v[216:219]
v_mfma_f32_16x16x32_bf16 v[212:215], v[68:71], v[36:39], v[212:215]
v_mfma_f32_16x16x32_bf16 v[208:211], v[68:71], v[32:35], v[208:211]
s_waitcnt vmcnt(0) lgkmcnt(0)
s_barrier
v_mfma_f32_16x16x32_bf16 v[128:131], v[96:99], v[80:83], v[128:131]
ds_read_b128 v[32:35], v3 offset:0
v_mfma_f32_16x16x32_bf16 v[132:135], v[96:99], v[84:87], v[132:135]
ds_read_b64_tr_b16 v[48:49], v9 offset:16384
v_mfma_f32_16x16x32_bf16 v[136:139], v[96:99], v[88:91], v[136:139]
ds_read_b64_tr_b16 v[50:51], v9 offset:20480
v_mfma_f32_16x16x32_bf16 v[140:143], v[96:99], v[92:95], v[140:143]
ds_read_b128 v[36:39], v3 offset:256
v_mfma_f32_16x16x32_bf16 v[188:191], v[108:111], v[92:95], v[188:191]
ds_read_b128 v[40:43], v3 offset:512
v_mfma_f32_16x16x32_bf16 v[184:187], v[108:111], v[88:91], v[184:187]
ds_read_b128 v[44:47], v3 offset:768
v_mfma_f32_16x16x32_bf16 v[180:183], v[108:111], v[84:87], v[180:183]
ds_read_b64_tr_b16 v[60:61], v9 offset:32768
v_mfma_f32_16x16x32_bf16 v[176:179], v[108:111], v[80:83], v[176:179]
ds_read_b64_tr_b16 v[62:63], v9 offset:36864
v_mfma_f32_16x16x32_bf16 v[144:147], v[100:103], v[80:83], v[144:147]
ds_read_b64_tr_b16 v[52:53], v10 offset:16384
v_mfma_f32_16x16x32_bf16 v[148:151], v[100:103], v[84:87], v[148:151]
ds_read_b64_tr_b16 v[54:55], v10 offset:20480
v_mfma_f32_16x16x32_bf16 v[152:155], v[100:103], v[88:91], v[152:155]
ds_read_b64_tr_b16 v[64:65], v10 offset:32768
v_mfma_f32_16x16x32_bf16 v[156:159], v[100:103], v[92:95], v[156:159]
ds_read_b64_tr_b16 v[66:67], v10 offset:36864
v_mfma_f32_16x16x32_bf16 v[204:207], v[112:115], v[92:95], v[204:207]
ds_read_b64_tr_b16 v[56:57], v11 offset:16384
v_mfma_f32_16x16x32_bf16 v[200:203], v[112:115], v[88:91], v[200:203]
ds_read_b64_tr_b16 v[58:59], v11 offset:20480
v_mfma_f32_16x16x32_bf16 v[196:199], v[112:115], v[84:87], v[196:199]
ds_read_b64_tr_b16 v[68:69], v11 offset:32768
v_mfma_f32_16x16x32_bf16 v[192:195], v[112:115], v[80:83], v[192:195]
ds_read_b64_tr_b16 v[70:71], v11 offset:36864
v_mfma_f32_16x16x32_bf16 v[160:163], v[104:107], v[80:83], v[160:163]
v_mfma_f32_16x16x32_bf16 v[164:167], v[104:107], v[84:87], v[164:167]
v_mfma_f32_16x16x32_bf16 v[168:171], v[104:107], v[88:91], v[168:171]
v_mfma_f32_16x16x32_bf16 v[172:175], v[104:107], v[92:95], v[172:175]
v_mfma_f32_16x16x32_bf16 v[220:223], v[116:119], v[92:95], v[220:223]
v_mfma_f32_16x16x32_bf16 v[216:219], v[116:119], v[88:91], v[216:219]
v_mfma_f32_16x16x32_bf16 v[212:215], v[116:119], v[84:87], v[212:215]
v_mfma_f32_16x16x32_bf16 v[208:211], v[116:119], v[80:83], v[208:211]
s_waitcnt lgkmcnt(0)
v_mfma_f32_16x16x32_bf16 v[128:131], v[48:51], v[32:35], v[128:131]
ds_read_b128 v[80:83], v3 offset:8192
v_mfma_f32_16x16x32_bf16 v[132:135], v[48:51], v[36:39], v[132:135]
ds_read_b64_tr_b16 v[96:97], v9 offset:24576
v_mfma_f32_16x16x32_bf16 v[136:139], v[48:51], v[40:43], v[136:139]
ds_read_b64_tr_b16 v[98:99], v9 offset:28672
v_mfma_f32_16x16x32_bf16 v[140:143], v[48:51], v[44:47], v[140:143]
ds_read_b128 v[84:87], v3 offset:8448
v_mfma_f32_16x16x32_bf16 v[188:191], v[60:63], v[44:47], v[188:191]
ds_read_b128 v[88:91], v3 offset:8704
v_mfma_f32_16x16x32_bf16 v[184:187], v[60:63], v[40:43], v[184:187]
ds_read_b128 v[92:95], v3 offset:8960
v_mfma_f32_16x16x32_bf16 v[180:183], v[60:63], v[36:39], v[180:183]
ds_read_b64_tr_b16 v[108:109], v9 offset:40960
v_mfma_f32_16x16x32_bf16 v[176:179], v[60:63], v[32:35], v[176:179]
ds_read_b64_tr_b16 v[110:111], v9 offset:45056
v_mfma_f32_16x16x32_bf16 v[144:147], v[52:55], v[32:35], v[144:147]
ds_read_b64_tr_b16 v[100:101], v10 offset:24576
v_mfma_f32_16x16x32_bf16 v[148:151], v[52:55], v[36:39], v[148:151]
ds_read_b64_tr_b16 v[102:103], v10 offset:28672
v_mfma_f32_16x16x32_bf16 v[152:155], v[52:55], v[40:43], v[152:155]
ds_read_b64_tr_b16 v[112:113], v10 offset:40960
v_mfma_f32_16x16x32_bf16 v[156:159], v[52:55], v[44:47], v[156:159]
ds_read_b64_tr_b16 v[114:115], v10 offset:45056
v_mfma_f32_16x16x32_bf16 v[204:207], v[64:67], v[44:47], v[204:207]
ds_read_b64_tr_b16 v[104:105], v11 offset:24576
v_mfma_f32_16x16x32_bf16 v[200:203], v[64:67], v[40:43], v[200:203]
ds_read_b64_tr_b16 v[106:107], v11 offset:28672
v_mfma_f32_16x16x32_bf16 v[196:199], v[64:67], v[36:39], v[196:199]
ds_read_b64_tr_b16 v[116:117], v11 offset:40960
v_mfma_f32_16x16x32_bf16 v[192:195], v[64:67], v[32:35], v[192:195]
ds_read_b64_tr_b16 v[118:119], v11 offset:45056
v_mfma_f32_16x16x32_bf16 v[160:163], v[56:59], v[32:35], v[160:163]
v_mfma_f32_16x16x32_bf16 v[164:167], v[56:59], v[36:39], v[164:167]
v_mfma_f32_16x16x32_bf16 v[168:171], v[56:59], v[40:43], v[168:171]
v_mfma_f32_16x16x32_bf16 v[172:175], v[56:59], v[44:47], v[172:175]
v_mfma_f32_16x16x32_bf16 v[220:223], v[68:71], v[44:47], v[220:223]
v_mfma_f32_16x16x32_bf16 v[216:219], v[68:71], v[40:43], v[216:219]
v_mfma_f32_16x16x32_bf16 v[212:215], v[68:71], v[36:39], v[212:215]
v_mfma_f32_16x16x32_bf16 v[208:211], v[68:71], v[32:35], v[208:211]
s_waitcnt lgkmcnt(0)
s_barrier
v_mfma_f32_16x16x32_bf16 v[128:131], v[96:99], v[80:83], v[128:131]
ds_read_b128 v[32:35], v4 offset:0
v_mfma_f32_16x16x32_bf16 v[132:135], v[96:99], v[84:87], v[132:135]
ds_read_b64_tr_b16 v[48:49], v13 offset:16384
v_mfma_f32_16x16x32_bf16 v[136:139], v[96:99], v[88:91], v[136:139]
ds_read_b64_tr_b16 v[50:51], v13 offset:20480
v_mfma_f32_16x16x32_bf16 v[140:143], v[96:99], v[92:95], v[140:143]
ds_read_b128 v[36:39], v4 offset:256
v_mfma_f32_16x16x32_bf16 v[188:191], v[108:111], v[92:95], v[188:191]
ds_read_b128 v[40:43], v4 offset:512
v_mfma_f32_16x16x32_bf16 v[184:187], v[108:111], v[88:91], v[184:187]
ds_read_b128 v[44:47], v4 offset:768
v_mfma_f32_16x16x32_bf16 v[180:183], v[108:111], v[84:87], v[180:183]
ds_read_b64_tr_b16 v[60:61], v13 offset:32768
v_mfma_f32_16x16x32_bf16 v[176:179], v[108:111], v[80:83], v[176:179]
ds_read_b64_tr_b16 v[62:63], v13 offset:36864
v_mfma_f32_16x16x32_bf16 v[144:147], v[100:103], v[80:83], v[144:147]
ds_read_b64_tr_b16 v[52:53], v14 offset:16384
v_mfma_f32_16x16x32_bf16 v[148:151], v[100:103], v[84:87], v[148:151]
ds_read_b64_tr_b16 v[54:55], v14 offset:20480
v_mfma_f32_16x16x32_bf16 v[152:155], v[100:103], v[88:91], v[152:155]
ds_read_b64_tr_b16 v[64:65], v14 offset:32768
v_mfma_f32_16x16x32_bf16 v[156:159], v[100:103], v[92:95], v[156:159]
ds_read_b64_tr_b16 v[66:67], v14 offset:36864
v_mfma_f32_16x16x32_bf16 v[204:207], v[112:115], v[92:95], v[204:207]
ds_read_b64_tr_b16 v[56:57], v15 offset:16384
v_mfma_f32_16x16x32_bf16 v[200:203], v[112:115], v[88:91], v[200:203]
ds_read_b64_tr_b16 v[58:59], v15 offset:20480
v_mfma_f32_16x16x32_bf16 v[196:199], v[112:115], v[84:87], v[196:199]
ds_read_b64_tr_b16 v[68:69], v15 offset:32768
v_mfma_f32_16x16x32_bf16 v[192:195], v[112:115], v[80:83], v[192:195]
ds_read_b64_tr_b16 v[70:71], v15 offset:36864
v_mfma_f32_16x16x32_bf16 v[160:163], v[104:107], v[80:83], v[160:163]
v_mfma_f32_16x16x32_bf16 v[164:167], v[104:107], v[84:87], v[164:167]
v_mfma_f32_16x16x32_bf16 v[168:171], v[104:107], v[88:91], v[168:171]
v_mfma_f32_16x16x32_bf16 v[172:175], v[104:107], v[92:95], v[172:175]
v_mfma_f32_16x16x32_bf16 v[220:223], v[116:119], v[92:95], v[220:223]
v_mfma_f32_16x16x32_bf16 v[216:219], v[116:119], v[88:91], v[216:219]
v_mfma_f32_16x16x32_bf16 v[212:215], v[116:119], v[84:87], v[212:215]
v_mfma_f32_16x16x32_bf16 v[208:211], v[116:119], v[80:83], v[208:211]
s_waitcnt lgkmcnt(0)
v_mfma_f32_16x16x32_bf16 v[128:131], v[48:51], v[32:35], v[128:131]
ds_read_b128 v[80:83], v4 offset:8192
v_mfma_f32_16x16x32_bf16 v[132:135], v[48:51], v[36:39], v[132:135]
ds_read_b64_tr_b16 v[96:97], v13 offset:24576
v_mfma_f32_16x16x32_bf16 v[136:139], v[48:51], v[40:43], v[136:139]
ds_read_b64_tr_b16 v[98:99], v13 offset:28672
v_mfma_f32_16x16x32_bf16 v[140:143], v[48:51], v[44:47], v[140:143]
ds_read_b128 v[84:87], v4 offset:8448
v_mfma_f32_16x16x32_bf16 v[188:191], v[60:63], v[44:47], v[188:191]
ds_read_b128 v[88:91], v4 offset:8704
v_mfma_f32_16x16x32_bf16 v[184:187], v[60:63], v[40:43], v[184:187]
ds_read_b128 v[92:95], v4 offset:8960
v_mfma_f32_16x16x32_bf16 v[180:183], v[60:63], v[36:39], v[180:183]
ds_read_b64_tr_b16 v[108:109], v13 offset:40960
v_mfma_f32_16x16x32_bf16 v[176:179], v[60:63], v[32:35], v[176:179]
ds_read_b64_tr_b16 v[110:111], v13 offset:45056
v_mfma_f32_16x16x32_bf16 v[144:147], v[52:55], v[32:35], v[144:147]
ds_read_b64_tr_b16 v[100:101], v14 offset:24576
v_mfma_f32_16x16x32_bf16 v[148:151], v[52:55], v[36:39], v[148:151]
ds_read_b64_tr_b16 v[102:103], v14 offset:28672
v_mfma_f32_16x16x32_bf16 v[152:155], v[52:55], v[40:43], v[152:155]
ds_read_b64_tr_b16 v[112:113], v14 offset:40960
v_mfma_f32_16x16x32_bf16 v[156:159], v[52:55], v[44:47], v[156:159]
ds_read_b64_tr_b16 v[114:115], v14 offset:45056
v_mfma_f32_16x16x32_bf16 v[204:207], v[64:67], v[44:47], v[204:207]
ds_read_b64_tr_b16 v[104:105], v15 offset:24576
v_mfma_f32_16x16x32_bf16 v[200:203], v[64:67], v[40:43], v[200:203]
ds_read_b64_tr_b16 v[106:107], v15 offset:28672
v_mfma_f32_16x16x32_bf16 v[196:199], v[64:67], v[36:39], v[196:199]
ds_read_b64_tr_b16 v[116:117], v15 offset:40960
v_mfma_f32_16x16x32_bf16 v[192:195], v[64:67], v[32:35], v[192:195]
ds_read_b64_tr_b16 v[118:119], v15 offset:45056
v_mfma_f32_16x16x32_bf16 v[160:163], v[56:59], v[32:35], v[160:163]
v_mfma_f32_16x16x32_bf16 v[164:167], v[56:59], v[36:39], v[164:167]
v_mfma_f32_16x16x32_bf16 v[168:171], v[56:59], v[40:43], v[168:171]
v_mfma_f32_16x16x32_bf16 v[172:175], v[56:59], v[44:47], v[172:175]
v_mfma_f32_16x16x32_bf16 v[220:223], v[68:71], v[44:47], v[220:223]
v_mfma_f32_16x16x32_bf16 v[216:219], v[68:71], v[40:43], v[216:219]
v_mfma_f32_16x16x32_bf16 v[212:215], v[68:71], v[36:39], v[212:215]
v_mfma_f32_16x16x32_bf16 v[208:211], v[68:71], v[32:35], v[208:211]
s_waitcnt lgkmcnt(0)
s_barrier
v_mfma_f32_16x16x32_bf16 v[128:131], v[96:99], v[80:83], v[128:131]
ds_read_b128 v[32:35], v2 offset:0
v_mfma_f32_16x16x32_bf16 v[132:135], v[96:99], v[84:87], v[132:135]
ds_read_b64_tr_b16 v[48:49], v5 offset:16384
v_mfma_f32_16x16x32_bf16 v[136:139], v[96:99], v[88:91], v[136:139]
ds_read_b64_tr_b16 v[50:51], v5 offset:20480
v_mfma_f32_16x16x32_bf16 v[140:143], v[96:99], v[92:95], v[140:143]
ds_read_b128 v[36:39], v2 offset:256
v_mfma_f32_16x16x32_bf16 v[188:191], v[108:111], v[92:95], v[188:191]
ds_read_b128 v[40:43], v2 offset:512
v_mfma_f32_16x16x32_bf16 v[184:187], v[108:111], v[88:91], v[184:187]
ds_read_b128 v[44:47], v2 offset:768
v_mfma_f32_16x16x32_bf16 v[180:183], v[108:111], v[84:87], v[180:183]
ds_read_b64_tr_b16 v[60:61], v5 offset:32768
v_mfma_f32_16x16x32_bf16 v[176:179], v[108:111], v[80:83], v[176:179]
ds_read_b64_tr_b16 v[62:63], v5 offset:36864
v_mfma_f32_16x16x32_bf16 v[144:147], v[100:103], v[80:83], v[144:147]
ds_read_b64_tr_b16 v[52:53], v6 offset:16384
v_mfma_f32_16x16x32_bf16 v[148:151], v[100:103], v[84:87], v[148:151]
ds_read_b64_tr_b16 v[54:55], v6 offset:20480
v_mfma_f32_16x16x32_bf16 v[152:155], v[100:103], v[88:91], v[152:155]
ds_read_b64_tr_b16 v[64:65], v6 offset:32768
v_mfma_f32_16x16x32_bf16 v[156:159], v[100:103], v[92:95], v[156:159]
ds_read_b64_tr_b16 v[66:67], v6 offset:36864
v_mfma_f32_16x16x32_bf16 v[204:207], v[112:115], v[92:95], v[204:207]
ds_read_b64_tr_b16 v[56:57], v7 offset:16384
v_mfma_f32_16x16x32_bf16 v[200:203], v[112:115], v[88:91], v[200:203]
ds_read_b64_tr_b16 v[58:59], v7 offset:20480
v_mfma_f32_16x16x32_bf16 v[196:199], v[112:115], v[84:87], v[196:199]
ds_read_b64_tr_b16 v[68:69], v7 offset:32768
v_mfma_f32_16x16x32_bf16 v[192:195], v[112:115], v[80:83], v[192:195]
ds_read_b64_tr_b16 v[70:71], v7 offset:36864
v_mfma_f32_16x16x32_bf16 v[160:163], v[104:107], v[80:83], v[160:163]
v_mfma_f32_16x16x32_bf16 v[164:167], v[104:107], v[84:87], v[164:167]
v_mfma_f32_16x16x32_bf16 v[168:171], v[104:107], v[88:91], v[168:171]
v_mfma_f32_16x16x32_bf16 v[172:175], v[104:107], v[92:95], v[172:175]
v_mfma_f32_16x16x32_bf16 v[220:223], v[116:119], v[92:95], v[220:223]
v_mfma_f32_16x16x32_bf16 v[216:219], v[116:119], v[88:91], v[216:219]
v_mfma_f32_16x16x32_bf16 v[212:215], v[116:119], v[84:87], v[212:215]
v_mfma_f32_16x16x32_bf16 v[208:211], v[116:119], v[80:83], v[208:211]
s_sub_u32 s41, s41, 1
s_cmp_lg_u32 s41, 0
s_cbranch_scc1 Lk3_120
s_waitcnt lgkmcnt(0)
v_mfma_f32_16x16x32_bf16 v[128:131], v[48:51], v[32:35], v[128:131]
ds_read_b128 v[80:83], v2 offset:8192
v_mfma_f32_16x16x32_bf16 v[132:135], v[48:51], v[36:39], v[132:135]
ds_read_b64_tr_b16 v[96:97], v5 offset:24576
v_mfma_f32_16x16x32_bf16 v[136:139], v[48:51], v[40:43], v[136:139]
ds_read_b64_tr_b16 v[98:99], v5 offset:28672
v_mfma_f32_16x16x32_bf16 v[140:143], v[48:51], v[44:47], v[140:143]
ds_read_b128 v[84:87], v2 offset:8448
v_mfma_f32_16x16x32_bf16 v[188:191], v[60:63], v[44:47], v[188:191]
ds_read_b128 v[88:91], v2 offset:8704
v_mfma_f32_16x16x32_bf16 v[184:187], v[60:63], v[40:43], v[184:187]
ds_read_b128 v[92:95], v2 offset:8960
v_mfma_f32_16x16x32_bf16 v[180:183], v[60:63], v[36:39], v[180:183]
ds_read_b64_tr_b16 v[108:109], v5 offset:40960
v_mfma_f32_16x16x32_bf16 v[176:179], v[60:63], v[32:35], v[176:179]
ds_read_b64_tr_b16 v[110:111], v5 offset:45056
v_mfma_f32_16x16x32_bf16 v[144:147], v[52:55], v[32:35], v[144:147]
ds_read_b64_tr_b16 v[100:101], v6 offset:24576
v_mfma_f32_16x16x32_bf16 v[148:151], v[52:55], v[36:39], v[148:151]
ds_read_b64_tr_b16 v[102:103], v6 offset:28672
v_mfma_f32_16x16x32_bf16 v[152:155], v[52:55], v[40:43], v[152:155]
ds_read_b64_tr_b16 v[112:113], v6 offset:40960
v_mfma_f32_16x16x32_bf16 v[156:159], v[52:55], v[44:47], v[156:159]
ds_read_b64_tr_b16 v[114:115], v6 offset:45056
v_mfma_f32_16x16x32_bf16 v[204:207], v[64:67], v[44:47], v[204:207]
ds_read_b64_tr_b16 v[104:105], v7 offset:24576
v_mfma_f32_16x16x32_bf16 v[200:203], v[64:67], v[40:43], v[200:203]
ds_read_b64_tr_b16 v[106:107], v7 offset:28672
v_mfma_f32_16x16x32_bf16 v[196:199], v[64:67], v[36:39], v[196:199]
ds_read_b64_tr_b16 v[116:117], v7 offset:40960
v_mfma_f32_16x16x32_bf16 v[192:195], v[64:67], v[32:35], v[192:195]
ds_read_b64_tr_b16 v[118:119], v7 offset:45056
v_mfma_f32_16x16x32_bf16 v[160:163], v[56:59], v[32:35], v[160:163]
v_mfma_f32_16x16x32_bf16 v[164:167], v[56:59], v[36:39], v[164:167]
v_mfma_f32_16x16x32_bf16 v[168:171], v[56:59], v[40:43], v[168:171]
v_mfma_f32_16x16x32_bf16 v[172:175], v[56:59], v[44:47], v[172:175]
v_mfma_f32_16x16x32_bf16 v[220:223], v[68:71], v[44:47], v[220:223]
v_mfma_f32_16x16x32_bf16 v[216:219], v[68:71], v[40:43], v[216:219]
v_mfma_f32_16x16x32_bf16 v[212:215], v[68:71], v[36:39], v[212:215]
v_mfma_f32_16x16x32_bf16 v[208:211], v[68:71], v[32:35], v[208:211]
s_waitcnt lgkmcnt(0)
s_barrier
s_cmp_eq_u32 s36, 7
s_cbranch_scc1 L7b_121
s_add_u32 m0, s39, 0
s_add_u32 s37, s37, s40
buffer_load_dwordx4 v21, s[8:11], s37 offen sc1 lds
v_mfma_f32_16x16x32_bf16 v[128:131], v[96:99], v[80:83], v[128:131]
v_mfma_f32_16x16x32_bf16 v[132:135], v[96:99], v[84:87], v[132:135]
s_add_u32 m0, s39, 1024
s_add_u32 s37, s37, s38
buffer_load_dwordx4 v21, s[8:11], s37 offen sc1 lds
v_mfma_f32_16x16x32_bf16 v[136:139], v[96:99], v[88:91], v[136:139]
s_add_u32 m0, s39, 2048
s_add_u32 s37, s37, s38
buffer_load_dwordx4 v21, s[8:11], s37 offen sc1 lds
v_mfma_f32_16x16x32_bf16 v[140:143], v[96:99], v[92:95], v[140:143]
v_mfma_f32_16x16x32_bf16 v[188:191], v[108:111], v[92:95], v[188:191]
s_add_u32 m0, s39, 3072
s_add_u32 s37, s37, s38
buffer_load_dwordx4 v21, s[8:11], s37 offen sc1 lds
v_mfma_f32_16x16x32_bf16 v[184:187], v[108:111], v[88:91], v[184:187]
s_add_u32 m0, s39, 4096
s_add_u32 s37, s37, s55
buffer_load_dwordx4 v21, s[8:11], s37 offen sc1 lds
v_mfma_f32_16x16x32_bf16 v[180:183], v[108:111], v[84:87], v[180:183]
v_mfma_f32_16x16x32_bf16 v[176:179], v[108:111], v[80:83], v[176:179]
s_add_u32 m0, s39, 5120
s_add_u32 s37, s37, s38
buffer_load_dwordx4 v21, s[8:11], s37 offen sc1 lds
v_mfma_f32_16x16x32_bf16 v[144:147], v[100:103], v[80:83], v[144:147]
s_add_u32 m0, s39, 6144
s_add_u32 s37, s37, s38
buffer_load_dwordx4 v21, s[8:11], s37 offen sc1 lds
v_mfma_f32_16x16x32_bf16 v[148:151], v[100:103], v[84:87], v[148:151]
v_mfma_f32_16x16x32_bf16 v[152:155], v[100:103], v[88:91], v[152:155]
s_add_u32 m0, s39, 7168
s_add_u32 s37, s37, s38
buffer_load_dwordx4 v21, s[8:11], s37 offen sc1 lds
v_mfma_f32_16x16x32_bf16 v[156:159], v[100:103], v[92:95], v[156:159]
s_add_u32 m0, s39, 32768
s_add_u32 s37, s37, s40
buffer_load_dwordx4 v21, s[8:11], s37 offen sc1 lds
v_mfma_f32_16x16x32_bf16 v[204:207], v[112:115], v[92:95], v[204:207]
v_mfma_f32_16x16x32_bf16 v[200:203], v[112:115], v[88:91], v[200:203]
s_add_u32 m0, s39, 33792
s_add_u32 s37, s37, s38
buffer_load_dwordx4 v21, s[8:11], s37 offen sc1 lds
v_mfma_f32_16x16x32_bf16 v[196:199], v[112:115], v[84:87], v[196:199]
s_add_u32 m0, s39, 34816
s_add_u32 s37, s37, s38
buffer_load_dwordx4 v21, s[8:11], s37 offen sc1 lds
v_mfma_f32_16x16x32_bf16 v[192:195], v[112:115], v[80:83], v[192:195]
v_mfma_f32_16x16x32_bf16 v[160:163], v[104:107], v[80:83], v[160:163]
s_add_u32 m0, s39, 35840
s_add_u32 s37, s37, s38
buffer_load_dwordx4 v21, s[8:11], s37 offen sc1 lds
v_mfma_f32_16x16x32_bf16 v[164:167], v[104:107], v[84:87], v[164:167]
s_add_u32 m0, s39, 36864
s_add_u32 s37, s37, s55
buffer_load_dwordx4 v21, s[8:11], s37 offen sc1 lds
v_mfma_f32_16x16x32_bf16 v[168:171], v[104:107], v[88:91], v[168:171]
v_mfma_f32_16x16x32_bf16 v[172:175], v[104:107], v[92:95], v[172:175]
s_add_u32 m0, s39, 37888
s_add_u32 s37, s37, s38
buffer_load_dwordx4 v21, s[8:11], s37 offen sc1 lds
v_mfma_f32_16x16x32_bf16 v[220:223], v[116:119], v[92:95], v[220:223]
s_add_u32 m0, s39, 38912
s_add_u32 s37, s37, s38
buffer_load_dwordx4 v21, s[8:11], s37 offen sc1 lds
v_mfma_f32_16x16x32_bf16 v[216:219], v[116:119], v[88:91], v[216:219]
v_mfma_f32_16x16x32_bf16 v[212:215], v[116:119], v[84:87], v[212:215]
s_add_u32 m0, s39, 39936
s_add_u32 s37, s37, s38
buffer_load_dwordx4 v21, s[8:11], s37 offen sc1 lds
v_mfma_f32_16x16x32_bf16 v[208:211], v[116:119], v[80:83], v[208:211]
s_setprio 0
s_barrier
s_add_u32 s37, s37, s54
s_add_u32 m0, s39, 65536
s_add_u32 s37, s37, s40
buffer_load_dwordx4 v21, s[8:11], s37 offen sc1 lds
v_mul_f32 v80, v128, v128
v_mul_f32 v81, v129, v129
v_mul_f32 v82, v130, v130
v_mul_f32 v83, v131, v131
v_fma_f32 v80, v80, v232, v228
v_fma_f32 v81, v81, v232, v228
v_fma_f32 v82, v82, v232, v228
s_add_u32 m0, s39, 66560
s_add_u32 s37, s37, s38
buffer_load_dwordx4 v21, s[8:11], s37 offen sc1 lds
v_fma_f32 v83, v83, v232, v228
v_mul_f32 v80, v80, v128
v_mul_f32 v81, v81, v129
v_mul_f32 v82, v82, v130
v_mul_f32 v83, v83, v131
v_exp_f32 v80, v80
s_add_u32 m0, s39, 67584
s_add_u32 s37, s37, s38
buffer_load_dwordx4 v21, s[8:11], s37 offen sc1 lds
v_exp_f32 v81, v81
v_exp_f32 v82, v82
v_exp_f32 v83, v83
v_mul_f32 v176, v128, v176
v_mul_f32 v177, v129, v177
v_mul_f32 v178, v130, v178
v_mul_f32 v179, v131, v179
s_add_u32 m0, s39, 68608
s_add_u32 s37, s37, s38
buffer_load_dwordx4 v21, s[8:11], s37 offen sc1 lds
v_fma_f32 v80, v80, v236, v236
v_fma_f32 v81, v81, v236, v236
v_fma_f32 v82, v82, v236, v236
v_fma_f32 v83, v83, v236, v236
v_rcp_f32 v80, v80
v_rcp_f32 v81, v81
s_add_u32 m0, s39, 69632
s_add_u32 s37, s37, s55
buffer_load_dwordx4 v21, s[8:11], s37 offen sc1 lds
v_rcp_f32 v82, v82
v_rcp_f32 v83, v83
v_mul_f32 v176, v176, v80
v_mul_f32 v177, v177, v81
v_mul_f32 v178, v178, v82
v_mul_f32 v179, v179, v83
v_cvt_pk_bf16_f32 v96, v176, v177
s_add_u32 m0, s39, 70656
s_add_u32 s37, s37, s38
buffer_load_dwordx4 v21, s[8:11], s37 offen sc1 lds
v_cvt_pk_bf16_f32 v97, v178, v179
v_mul_f32 v84, v144, v144
v_mul_f32 v85, v145, v145
v_mul_f32 v86, v146, v146
v_mul_f32 v87, v147, v147
v_fma_f32 v84, v84, v232, v228
s_add_u32 m0, s39, 71680
s_add_u32 s37, s37, s38
buffer_load_dwordx4 v21, s[8:11], s37 offen sc1 lds
v_fma_f32 v85, v85, v232, v228
v_fma_f32 v86, v86, v232, v228
v_fma_f32 v87, v87, v232, v228
v_mul_f32 v84, v84, v144
v_mul_f32 v85, v85, v145
v_mul_f32 v86, v86, v146
v_mul_f32 v87, v87, v147
s_add_u32 m0, s39, 72704
s_add_u32 s37, s37, s38
buffer_load_dwordx4 v21, s[8:11], s37 offen sc1 lds
v_exp_f32 v84, v84
v_exp_f32 v85, v85
v_exp_f32 v86, v86
v_exp_f32 v87, v87
v_mul_f32 v192, v144, v192
v_mul_f32 v193, v145, v193
s_waitcnt vmcnt(16)
s_barrier
s_add_u32 m0, s39, 98304
s_add_u32 s37, s37, s40
buffer_load_dwordx4 v21, s[8:11], s37 offen sc1 lds
v_mul_f32 v194, v146, v194
v_mul_f32 v195, v147, v195
v_fma_f32 v84, v84, v236, v236
v_fma_f32 v85, v85, v236, v236
v_fma_f32 v86, v86, v236, v236
v_fma_f32 v87, v87, v236, v236
v_rcp_f32 v84, v84
s_add_u32 m0, s39, 99328
s_add_u32 s37, s37, s38
buffer_load_dwordx4 v21, s[8:11], s37 offen sc1 lds
v_rcp_f32 v85, v85
v_rcp_f32 v86, v86
v_rcp_f32 v87, v87
v_mul_f32 v192, v192, v84
v_mul_f32 v193, v193, v85
v_mul_f32 v194, v194, v86
v_mul_f32 v195, v195, v87
s_add_u32 m0, s39, 100352
s_add_u32 s37, s37, s38
buffer_load_dwordx4 v21, s[8:11], s37 offen sc1 lds
v_cvt_pk_bf16_f32 v98, v192, v193
v_cvt_pk_bf16_f32 v99, v194, v195
v_mul_f32 v80, v160, v160
v_mul_f32 v81, v161, v161
v_mul_f32 v82, v162, v162
s_add_u32 m0, s39, 101376
s_add_u32 s37, s37, s38
buffer_load_dwordx4 v21, s[8:11], s37 offen sc1 lds
v_mul_f32 v83, v163, v163
v_fma_f32 v80, v80, v232, v228
v_fma_f32 v81, v81, v232, v228
v_fma_f32 v82, v82, v232, v228
v_fma_f32 v83, v83, v232, v228
v_mul_f32 v80, v80, v160
v_mul_f32 v81, v81, v161
s_add_u32 m0, s39, 102400
s_add_u32 s37, s37, s55
buffer_load_dwordx4 v21, s[8:11], s37 offen sc1 lds
v_mul_f32 v82, v82, v162
v_mul_f32 v83, v83, v163
v_exp_f32 v80, v80
v_exp_f32 v81, v81
v_exp_f32 v82, v82
v_exp_f32 v83, v83
v_mul_f32 v208, v160, v208
s_add_u32 m0, s39, 103424
s_add_u32 s37, s37, s38
buffer_load_dwordx4 v21, s[8:11], s37 offen sc1 lds
v_mul_f32 v209, v161, v209
v_mul_f32 v210, v162, v210
v_mul_f32 v211, v163, v211
v_fma_f32 v80, v80, v236, v236
v_fma_f32 v81, v81, v236, v236
v_fma_f32 v82, v82, v236, v236
s_add_u32 m0, s39, 104448
s_add_u32 s37, s37, s38
buffer_load_dwordx4 v21, s[8:11], s37 offen sc1 lds
v_fma_f32 v83, v83, v236, v236
v_rcp_f32 v80, v80
v_rcp_f32 v81, v81
v_rcp_f32 v82, v82
v_rcp_f32 v83, v83
v_mul_f32 v208, v208, v80
v_mul_f32 v209, v209, v81
s_add_u32 m0, s39, 105472
s_add_u32 s37, s37, s38
buffer_load_dwordx4 v21, s[8:11], s37 offen sc1 lds
v_mul_f32 v210, v210, v82
v_mul_f32 v211, v211, v83
v_cvt_pk_bf16_f32 v112, v208, v209
v_cvt_pk_bf16_f32 v113, v210, v211
v_mul_f32 v80, v132, v132
v_mul_f32 v81, v133, v133
buffer_store_dwordx4 v[96:99], v27, s[24:27], 0 offen offset:0 sc1
s_waitcnt vmcnt(17)
s_barrier
s_add_u32 m0, s39, 0
s_add_u32 s37, s37, s40
buffer_load_dwordx4 v21, s[8:11], s37 offen sc1 lds
v_mul_f32 v82, v134, v134
v_mul_f32 v83, v135, v135
v_fma_f32 v80, v80, v233, v229
v_fma_f32 v81, v81, v233, v229
v_fma_f32 v82, v82, v233, v229
v_fma_f32 v83, v83, v233, v229
v_mul_f32 v80, v80, v132
s_add_u32 m0, s39, 1024
s_add_u32 s37, s37, s38
buffer_load_dwordx4 v21, s[8:11], s37 offen sc1 lds
v_mul_f32 v81, v81, v133
v_mul_f32 v82, v82, v134
v_mul_f32 v83, v83, v135
v_exp_f32 v80, v80
v_exp_f32 v81, v81
v_exp_f32 v82, v82
s_add_u32 m0, s39, 2048
s_add_u32 s37, s37, s38
buffer_load_dwordx4 v21, s[8:11], s37 offen sc1 lds
v_exp_f32 v83, v83
v_mul_f32 v180, v132, v180
v_mul_f32 v181, v133, v181
v_mul_f32 v182, v134, v182
v_mul_f32 v183, v135, v183
v_fma_f32 v80, v80, v237, v237
v_fma_f32 v81, v81, v237, v237
s_add_u32 m0, s39, 3072
s_add_u32 s37, s37, s38
buffer_load_dwordx4 v21, s[8:11], s37 offen sc1 lds
v_fma_f32 v82, v82, v237, v237
v_fma_f32 v83, v83, v237, v237
v_rcp_f32 v80, v80
v_rcp_f32 v81, v81
v_rcp_f32 v82, v82
v_rcp_f32 v83, v83
s_add_u32 m0, s39, 4096
s_add_u32 s37, s37, s55
buffer_load_dwordx4 v21, s[8:11], s37 offen sc1 lds
v_mul_f32 v180, v180, v80
v_mul_f32 v181, v181, v81
v_mul_f32 v182, v182, v82
v_mul_f32 v183, v183, v83
v_cvt_pk_bf16_f32 v100, v180, v181
v_cvt_pk_bf16_f32 v101, v182, v183
v_mul_f32 v84, v148, v148
s_add_u32 m0, s39, 5120
s_add_u32 s37, s37, s38
buffer_load_dwordx4 v21, s[8:11], s37 offen sc1 lds
v_mul_f32 v85, v149, v149
v_mul_f32 v86, v150, v150
v_mul_f32 v87, v151, v151
v_fma_f32 v84, v84, v233, v229
v_fma_f32 v85, v85, v233, v229
v_fma_f32 v86, v86, v233, v229
s_add_u32 m0, s39, 6144
s_add_u32 s37, s37, s38
buffer_load_dwordx4 v21, s[8:11], s37 offen sc1 lds
v_fma_f32 v87, v87, v233, v229
v_mul_f32 v84, v84, v148
v_mul_f32 v85, v85, v149
v_mul_f32 v86, v86, v150
v_mul_f32 v87, v87, v151
v_exp_f32 v84, v84
v_exp_f32 v85, v85
s_add_u32 m0, s39, 7168
s_add_u32 s37, s37, s38
buffer_load_dwordx4 v21, s[8:11], s37 offen sc1 lds
v_exp_f32 v86, v86
v_exp_f32 v87, v87
v_mul_f32 v196, v148, v196
v_mul_f32 v197, v149, v197
v_mul_f32 v198, v150, v198
v_mul_f32 v199, v151, v199
s_waitcnt vmcnt(17)
s_barrier
s_add_u32 m0, s39, 32768
s_add_u32 s37, s37, s40
buffer_load_dwordx4 v21, s[8:11], s37 offen sc1 lds
v_fma_f32 v84, v84, v237, v237
v_fma_f32 v85, v85, v237, v237
v_fma_f32 v86, v86, v237, v237
v_fma_f32 v87, v87, v237, v237
v_rcp_f32 v84, v84
v_rcp_f32 v85, v85
v_rcp_f32 v86, v86
s_add_u32 m0, s39, 33792
s_add_u32 s37, s37, s38
buffer_load_dwordx4 v21, s[8:11], s37 offen sc1 lds
v_rcp_f32 v87, v87
v_mul_f32 v196, v196, v84
v_mul_f32 v197, v197, v85
v_mul_f32 v198, v198, v86
v_mul_f32 v199, v199, v87
v_cvt_pk_bf16_f32 v102, v196, v197
v_cvt_pk_bf16_f32 v103, v198, v199
s_add_u32 m0, s39, 34816
s_add_u32 s37, s37, s38
buffer_load_dwordx4 v21, s[8:11], s37 offen sc1 lds
v_mul_f32 v80, v164, v164
v_mul_f32 v81, v165, v165
v_mul_f32 v82, v166, v166
v_mul_f32 v83, v167, v167
v_fma_f32 v80, v80, v233, v229
s_add_u32 m0, s39, 35840
s_add_u32 s37, s37, s38
buffer_load_dwordx4 v21, s[8:11], s37 offen sc1 lds
v_fma_f32 v81, v81, v233, v229
v_fma_f32 v82, v82, v233, v229
v_fma_f32 v83, v83, v233, v229
v_mul_f32 v80, v80, v164
v_mul_f32 v81, v81, v165
v_mul_f32 v82, v82, v166
v_mul_f32 v83, v83, v167
s_add_u32 m0, s39, 36864
s_add_u32 s37, s37, s55
buffer_load_dwordx4 v21, s[8:11], s37 offen sc1 lds
v_exp_f32 v80, v80
v_exp_f32 v81, v81
v_exp_f32 v82, v82
v_exp_f32 v83, v83
v_mul_f32 v212, v164, v212
v_mul_f32 v213, v165, v213
v_mul_f32 v214, v166, v214
s_add_u32 m0, s39, 37888
s_add_u32 s37, s37, s38
buffer_load_dwordx4 v21, s[8:11], s37 offen sc1 lds
v_mul_f32 v215, v167, v215
v_fma_f32 v80, v80, v237, v237
v_fma_f32 v81, v81, v237, v237
v_fma_f32 v82, v82, v237, v237
v_fma_f32 v83, v83, v237, v237
v_rcp_f32 v80, v80
s_add_u32 m0, s39, 38912
s_add_u32 s37, s37, s38
buffer_load_dwordx4 v21, s[8:11], s37 offen sc1 lds
v_rcp_f32 v81, v81
v_rcp_f32 v82, v82
v_rcp_f32 v83, v83
v_mul_f32 v212, v212, v80
v_mul_f32 v213, v213, v81
v_mul_f32 v214, v214, v82
v_mul_f32 v215, v215, v83
s_add_u32 m0, s39, 39936
s_add_u32 s37, s37, s38
buffer_load_dwordx4 v21, s[8:11], s37 offen sc1 lds
v_cvt_pk_bf16_f32 v114, v212, v213
v_cvt_pk_bf16_f32 v115, v214, v215
s_nop 1
v_permlane32_swap_b32 v112, v114
v_permlane32_swap_b32 v113, v115
buffer_store_dwordx4 v[100:103], v27, s[24:27], 0 offen offset:256 sc1
buffer_store_dwordx4 v[112:115], v28, s[24:27], 0 offen offset:0 sc1
s_waitcnt vmcnt(19)
s_barrier
s_add_u32 m0, s39, 65536
s_add_u32 s37, s37, s40
buffer_load_dwordx4 v21, s[8:11], s37 offen sc1 lds
v_mul_f32 v80, v136, v136
v_mul_f32 v81, v137, v137
v_mul_f32 v82, v138, v138
v_mul_f32 v83, v139, v139
v_fma_f32 v80, v80, v234, v230
v_fma_f32 v81, v81, v234, v230
v_fma_f32 v82, v82, v234, v230
s_add_u32 m0, s39, 66560
s_add_u32 s37, s37, s38
buffer_load_dwordx4 v21, s[8:11], s37 offen sc1 lds
v_fma_f32 v83, v83, v234, v230
v_mul_f32 v80, v80, v136
v_mul_f32 v81, v81, v137
v_mul_f32 v82, v82, v138
v_mul_f32 v83, v83, v139
v_exp_f32 v80, v80
s_add_u32 m0, s39, 67584
s_add_u32 s37, s37, s38
buffer_load_dwordx4 v21, s[8:11], s37 offen sc1 lds
v_exp_f32 v81, v81
v_exp_f32 v82, v82
v_exp_f32 v83, v83
v_mul_f32 v184, v136, v184
v_mul_f32 v185, v137, v185
v_mul_f32 v186, v138, v186
v_mul_f32 v187, v139, v187
s_add_u32 m0, s39, 68608
s_add_u32 s37, s37, s38
buffer_load_dwordx4 v21, s[8:11], s37 offen sc1 lds
v_fma_f32 v80, v80, v238, v238
v_fma_f32 v81, v81, v238, v238
v_fma_f32 v82, v82, v238, v238
v_fma_f32 v83, v83, v238, v238
v_rcp_f32 v80, v80
v_rcp_f32 v81, v81
s_add_u32 m0, s39, 69632
s_add_u32 s37, s37, s55
buffer_load_dwordx4 v21, s[8:11], s37 offen sc1 lds
v_rcp_f32 v82, v82
v_rcp_f32 v83, v83
v_mul_f32 v184, v184, v80
v_mul_f32 v185, v185, v81
v_mul_f32 v186, v186, v82
v_mul_f32 v187, v187, v83
v_cvt_pk_bf16_f32 v104, v184, v185
s_add_u32 m0, s39, 70656
s_add_u32 s37, s37, s38
buffer_load_dwordx4 v21, s[8:11], s37 offen sc1 lds
v_cvt_pk_bf16_f32 v105, v186, v187
v_mul_f32 v84, v152, v152
v_mul_f32 v85, v153, v153
v_mul_f32 v86, v154, v154
v_mul_f32 v87, v155, v155
v_fma_f32 v84, v84, v234, v230
s_add_u32 m0, s39, 71680
s_add_u32 s37, s37, s38
buffer_load_dwordx4 v21, s[8:11], s37 offen sc1 lds
v_fma_f32 v85, v85, v234, v230
v_fma_f32 v86, v86, v234, v230
v_fma_f32 v87, v87, v234, v230
v_mul_f32 v84, v84, v152
v_mul_f32 v85, v85, v153
v_mul_f32 v86, v86, v154
v_mul_f32 v87, v87, v155
s_add_u32 m0, s39, 72704
s_add_u32 s37, s37, s38
buffer_load_dwordx4 v21, s[8:11], s37 offen sc1 lds
v_exp_f32 v84, v84
v_exp_f32 v85, v85
v_exp_f32 v86, v86
v_exp_f32 v87, v87
v_mul_f32 v200, v152, v200
v_mul_f32 v201, v153, v201
s_waitcnt vmcnt(18)
s_barrier
s_add_u32 m0, s39, 98304
s_add_u32 s37, s37, s40
buffer_load_dwordx4 v21, s[8:11], s37 offen sc1 lds
v_mul_f32 v202, v154, v202
v_mul_f32 v203, v155, v203
v_fma_f32 v84, v84, v238, v238
v_fma_f32 v85, v85, v238, v238
v_fma_f32 v86, v86, v238, v238
v_fma_f32 v87, v87, v238, v238
v_rcp_f32 v84, v84
s_add_u32 m0, s39, 99328
s_add_u32 s37, s37, s38
buffer_load_dwordx4 v21, s[8:11], s37 offen sc1 lds
v_rcp_f32 v85, v85
v_rcp_f32 v86, v86
v_rcp_f32 v87, v87
v_mul_f32 v200, v200, v84
v_mul_f32 v201, v201, v85
v_mul_f32 v202, v202, v86
v_mul_f32 v203, v203, v87
s_add_u32 m0, s39, 100352
s_add_u32 s37, s37, s38
buffer_load_dwordx4 v21, s[8:11], s37 offen sc1 lds
v_cvt_pk_bf16_f32 v106, v200, v201
v_cvt_pk_bf16_f32 v107, v202, v203
v_mul_f32 v80, v168, v168
v_mul_f32 v81, v169, v169
v_mul_f32 v82, v170, v170
s_add_u32 m0, s39, 101376
s_add_u32 s37, s37, s38
buffer_load_dwordx4 v21, s[8:11], s37 offen sc1 lds
v_mul_f32 v83, v171, v171
v_fma_f32 v80, v80, v234, v230
v_fma_f32 v81, v81, v234, v230
v_fma_f32 v82, v82, v234, v230
v_fma_f32 v83, v83, v234, v230
v_mul_f32 v80, v80, v168
v_mul_f32 v81, v81, v169
s_add_u32 m0, s39, 102400
s_add_u32 s37, s37, s55
buffer_load_dwordx4 v21, s[8:11], s37 offen sc1 lds
v_mul_f32 v82, v82, v170
v_mul_f32 v83, v83, v171
v_exp_f32 v80, v80
v_exp_f32 v81, v81
v_exp_f32 v82, v82
v_exp_f32 v83, v83
v_mul_f32 v216, v168, v216
s_add_u32 m0, s39, 103424
s_add_u32 s37, s37, s38
buffer_load_dwordx4 v21, s[8:11], s37 offen sc1 lds
v_mul_f32 v217, v169, v217
v_mul_f32 v218, v170, v218
v_mul_f32 v219, v171, v219
v_fma_f32 v80, v80, v238, v238
v_fma_f32 v81, v81, v238, v238
v_fma_f32 v82, v82, v238, v238
s_add_u32 m0, s39, 104448
s_add_u32 s37, s37, s38
buffer_load_dwordx4 v21, s[8:11], s37 offen sc1 lds
v_fma_f32 v83, v83, v238, v238
v_rcp_f32 v80, v80
v_rcp_f32 v81, v81
v_rcp_f32 v82, v82
v_rcp_f32 v83, v83
v_mul_f32 v216, v216, v80
v_mul_f32 v217, v217, v81
s_add_u32 m0, s39, 105472
s_add_u32 s37, s37, s38
buffer_load_dwordx4 v21, s[8:11], s37 offen sc1 lds
v_mul_f32 v218, v218, v82
v_mul_f32 v219, v219, v83
v_cvt_pk_bf16_f32 v116, v216, v217
v_cvt_pk_bf16_f32 v117, v218, v219
v_mul_f32 v80, v140, v140
v_mul_f32 v81, v141, v141
buffer_store_dwordx4 v[104:107], v27, s[24:27], 0 offen offset:512 sc1
s_waitcnt vmcnt(19)
s_barrier
s_add_u32 s37, s37, s29
s_add_u32 m0, s39, 0
s_add_u32 s37, s37, s40
buffer_load_dwordx4 v21, s[8:11], s37 offen sc1 lds
v_mul_f32 v82, v142, v142
v_mul_f32 v83, v143, v143
v_fma_f32 v80, v80, v235, v231
v_fma_f32 v81, v81, v235, v231
v_fma_f32 v82, v82, v235, v231
v_fma_f32 v83, v83, v235, v231
v_mul_f32 v80, v80, v140
s_add_u32 m0, s39, 1024
s_add_u32 s37, s37, s38
buffer_load_dwordx4 v21, s[8:11], s37 offen sc1 lds
v_mul_f32 v81, v81, v141
v_mul_f32 v82, v82, v142
v_mul_f32 v83, v83, v143
v_exp_f32 v80, v80
v_exp_f32 v81, v81
v_exp_f32 v82, v82
s_add_u32 m0, s39, 2048
s_add_u32 s37, s37, s38
buffer_load_dwordx4 v21, s[8:11], s37 offen sc1 lds
v_exp_f32 v83, v83
v_mul_f32 v188, v140, v188
v_mul_f32 v189, v141, v189
v_mul_f32 v190, v142, v190
v_mul_f32 v191, v143, v191
v_fma_f32 v80, v80, v239, v239
v_fma_f32 v81, v81, v239, v239
s_add_u32 m0, s39, 3072
s_add_u32 s37, s37, s38
buffer_load_dwordx4 v21, s[8:11], s37 offen sc1 lds
v_fma_f32 v82, v82, v239, v239
v_fma_f32 v83, v83, v239, v239
v_rcp_f32 v80, v80
v_rcp_f32 v81, v81
v_rcp_f32 v82, v82
v_rcp_f32 v83, v83
s_add_u32 m0, s39, 4096
s_add_u32 s37, s37, s55
buffer_load_dwordx4 v21, s[8:11], s37 offen sc1 lds
v_mul_f32 v188, v188, v80
v_mul_f32 v189, v189, v81
v_mul_f32 v190, v190, v82
v_mul_f32 v191, v191, v83
v_cvt_pk_bf16_f32 v108, v188, v189
v_cvt_pk_bf16_f32 v109, v190, v191
v_mul_f32 v84, v156, v156
s_add_u32 m0, s39, 5120
s_add_u32 s37, s37, s38
buffer_load_dwordx4 v21, s[8:11], s37 offen sc1 lds
v_mul_f32 v85, v157, v157
v_mul_f32 v86, v158, v158
v_mul_f32 v87, v159, v159
v_fma_f32 v84, v84, v235, v231
v_fma_f32 v85, v85, v235, v231
v_fma_f32 v86, v86, v235, v231
s_add_u32 m0, s39, 6144
s_add_u32 s37, s37, s38
buffer_load_dwordx4 v21, s[8:11], s37 offen sc1 lds
v_fma_f32 v87, v87, v235, v231
v_mul_f32 v84, v84, v156
v_mul_f32 v85, v85, v157
v_mul_f32 v86, v86, v158
v_mul_f32 v87, v87, v159
v_exp_f32 v84, v84
v_exp_f32 v85, v85
s_add_u32 m0, s39, 7168
s_add_u32 s37, s37, s38
buffer_load_dwordx4 v21, s[8:11], s37 offen sc1 lds
v_exp_f32 v86, v86
v_exp_f32 v87, v87
v_mul_f32 v204, v156, v204
v_mul_f32 v205, v157, v205
v_mul_f32 v206, v158, v206
v_mul_f32 v207, v159, v207
s_waitcnt vmcnt(17)
s_barrier
s_add_u32 m0, s39, 32768
s_add_u32 s37, s37, s40
buffer_load_dwordx4 v21, s[8:11], s37 offen sc1 lds
v_fma_f32 v84, v84, v239, v239
v_fma_f32 v85, v85, v239, v239
v_fma_f32 v86, v86, v239, v239
v_fma_f32 v87, v87, v239, v239
v_rcp_f32 v84, v84
v_rcp_f32 v85, v85
v_rcp_f32 v86, v86
s_add_u32 m0, s39, 33792
s_add_u32 s37, s37, s38
buffer_load_dwordx4 v21, s[8:11], s37 offen sc1 lds
v_rcp_f32 v87, v87
v_mul_f32 v204, v204, v84
v_mul_f32 v205, v205, v85
v_mul_f32 v206, v206, v86
v_mul_f32 v207, v207, v87
v_cvt_pk_bf16_f32 v110, v204, v205
v_cvt_pk_bf16_f32 v111, v206, v207
s_add_u32 m0, s39, 34816
s_add_u32 s37, s37, s38
buffer_load_dwordx4 v21, s[8:11], s37 offen sc1 lds
v_mul_f32 v80, v172, v172
v_mul_f32 v81, v173, v173
v_mul_f32 v82, v174, v174
v_mul_f32 v83, v175, v175
v_fma_f32 v80, v80, v235, v231
s_add_u32 m0, s39, 35840
s_add_u32 s37, s37, s38
buffer_load_dwordx4 v21, s[8:11], s37 offen sc1 lds
v_fma_f32 v81, v81, v235, v231
v_fma_f32 v82, v82, v235, v231
v_fma_f32 v83, v83, v235, v231
v_mul_f32 v80, v80, v172
v_mul_f32 v81, v81, v173
v_mul_f32 v82, v82, v174
v_mul_f32 v83, v83, v175
s_add_u32 m0, s39, 36864
s_add_u32 s37, s37, s55
buffer_load_dwordx4 v21, s[8:11], s37 offen sc1 lds
v_exp_f32 v80, v80
v_exp_f32 v81, v81
v_exp_f32 v82, v82
v_exp_f32 v83, v83
v_mul_f32 v220, v172, v220
v_mul_f32 v221, v173, v221
v_mul_f32 v222, v174, v222
s_add_u32 m0, s39, 37888
s_add_u32 s37, s37, s38
buffer_load_dwordx4 v21, s[8:11], s37 offen sc1 lds
v_mul_f32 v223, v175, v223
v_fma_f32 v80, v80, v239, v239
v_fma_f32 v81, v81, v239, v239
v_fma_f32 v82, v82, v239, v239
v_fma_f32 v83, v83, v239, v239
v_rcp_f32 v80, v80
s_add_u32 m0, s39, 38912
s_add_u32 s37, s37, s38
buffer_load_dwordx4 v21, s[8:11], s37 offen sc1 lds
v_rcp_f32 v81, v81
v_rcp_f32 v82, v82
v_rcp_f32 v83, v83
v_mul_f32 v220, v220, v80
v_mul_f32 v221, v221, v81
v_mul_f32 v222, v222, v82
v_mul_f32 v223, v223, v83
s_add_u32 m0, s39, 39936
s_add_u32 s37, s37, s38
buffer_load_dwordx4 v21, s[8:11], s37 offen sc1 lds
v_cvt_pk_bf16_f32 v118, v220, v221
v_cvt_pk_bf16_f32 v119, v222, v223
s_nop 1
v_permlane32_swap_b32 v116, v118
v_permlane32_swap_b32 v117, v119
buffer_store_dwordx4 v[108:111], v27, s[24:27], 0 offen offset:768 sc1
buffer_store_dwordx4 v[116:119], v28, s[24:27], 0 offen offset:512 sc1
s_waitcnt vmcnt(19)
s_barrier
s_add_u32 m0, s39, 65536
s_add_u32 s37, s37, s40
buffer_load_dwordx4 v21, s[8:11], s37 offen sc1 lds
s_add_u32 m0, s39, 66560
s_add_u32 s37, s37, s38
buffer_load_dwordx4 v21, s[8:11], s37 offen sc1 lds
s_add_u32 m0, s39, 67584
s_add_u32 s37, s37, s38
buffer_load_dwordx4 v21, s[8:11], s37 offen sc1 lds
s_add_u32 m0, s39, 68608
s_add_u32 s37, s37, s38
buffer_load_dwordx4 v21, s[8:11], s37 offen sc1 lds
s_add_u32 m0, s39, 69632
s_add_u32 s37, s37, s55
buffer_load_dwordx4 v21, s[8:11], s37 offen sc1 lds
s_add_u32 m0, s39, 70656
s_add_u32 s37, s37, s38
buffer_load_dwordx4 v21, s[8:11], s37 offen sc1 lds
s_add_u32 m0, s39, 71680
s_add_u32 s37, s37, s38
buffer_load_dwordx4 v21, s[8:11], s37 offen sc1 lds
s_add_u32 m0, s39, 72704
s_add_u32 s37, s37, s38
buffer_load_dwordx4 v21, s[8:11], s37 offen sc1 lds
s_waitcnt vmcnt(8)
s_barrier
s_add_u32 m0, s39, 98304
s_add_u32 s37, s37, s40
buffer_load_dwordx4 v21, s[8:11], s37 offen sc1 lds
s_add_u32 m0, s39, 99328
s_add_u32 s37, s37, s38
buffer_load_dwordx4 v21, s[8:11], s37 offen sc1 lds
s_add_u32 m0, s39, 100352
s_add_u32 s37, s37, s38
buffer_load_dwordx4 v21, s[8:11], s37 offen sc1 lds
s_add_u32 m0, s39, 101376
s_add_u32 s37, s37, s38
buffer_load_dwordx4 v21, s[8:11], s37 offen sc1 lds
s_add_u32 m0, s39, 102400
s_add_u32 s37, s37, s55
buffer_load_dwordx4 v21, s[8:11], s37 offen sc1 lds
s_add_u32 m0, s39, 103424
s_add_u32 s37, s37, s38
buffer_load_dwordx4 v21, s[8:11], s37 offen sc1 lds
s_add_u32 m0, s39, 104448
s_add_u32 s37, s37, s38
buffer_load_dwordx4 v21, s[8:11], s37 offen sc1 lds
s_add_u32 m0, s39, 105472
s_add_u32 s37, s37, s38
buffer_load_dwordx4 v21, s[8:11], s37 offen sc1 lds
s_waitcnt vmcnt(18)
s_barrier
s_add_u32 m0, s39, 0
s_add_u32 s37, s37, s40
buffer_load_dwordx4 v21, s[8:11], s37 offen sc1 lds
s_add_u32 m0, s39, 1024
s_add_u32 s37, s37, s38
buffer_load_dwordx4 v21, s[8:11], s37 offen sc1 lds
s_add_u32 m0, s39, 2048
s_add_u32 s37, s37, s38
buffer_load_dwordx4 v21, s[8:11], s37 offen sc1 lds
s_add_u32 m0, s39, 3072
s_add_u32 s37, s37, s38
buffer_load_dwordx4 v21, s[8:11], s37 offen sc1 lds
s_add_u32 m0, s39, 4096
s_add_u32 s37, s37, s55
buffer_load_dwordx4 v21, s[8:11], s37 offen sc1 lds
s_add_u32 m0, s39, 5120
s_add_u32 s37, s37, s38
buffer_load_dwordx4 v21, s[8:11], s37 offen sc1 lds
s_add_u32 m0, s39, 6144
s_add_u32 s37, s37, s38
buffer_load_dwordx4 v21, s[8:11], s37 offen sc1 lds
s_add_u32 m0, s39, 7168
s_add_u32 s37, s37, s38
buffer_load_dwordx4 v21, s[8:11], s37 offen sc1 lds
s_waitcnt vmcnt(16)
s_barrier
s_add_u32 m0, s39, 32768
s_add_u32 s37, s37, s40
buffer_load_dwordx4 v21, s[8:11], s37 offen sc1 lds
s_add_u32 m0, s39, 33792
s_add_u32 s37, s37, s38
buffer_load_dwordx4 v21, s[8:11], s37 offen sc1 lds
s_add_u32 m0, s39, 34816
s_add_u32 s37, s37, s38
buffer_load_dwordx4 v21, s[8:11], s37 offen sc1 lds
s_add_u32 m0, s39, 35840
s_add_u32 s37, s37, s38
buffer_load_dwordx4 v21, s[8:11], s37 offen sc1 lds
s_add_u32 m0, s39, 36864
s_add_u32 s37, s37, s55
buffer_load_dwordx4 v21, s[8:11], s37 offen sc1 lds
s_add_u32 m0, s39, 37888
s_add_u32 s37, s37, s38
buffer_load_dwordx4 v21, s[8:11], s37 offen sc1 lds
s_add_u32 m0, s39, 38912
s_add_u32 s37, s37, s38
buffer_load_dwordx4 v21, s[8:11], s37 offen sc1 lds
s_add_u32 m0, s39, 39936
s_add_u32 s37, s37, s38
buffer_load_dwordx4 v21, s[8:11], s37 offen sc1 lds
s_waitcnt vmcnt(16)
s_barrier
s_add_u32 m0, s39, 65536
s_add_u32 s37, s37, s40
buffer_load_dwordx4 v21, s[8:11], s37 offen sc1 lds
s_add_u32 m0, s39, 66560
s_add_u32 s37, s37, s38
buffer_load_dwordx4 v21, s[8:11], s37 offen sc1 lds
s_add_u32 m0, s39, 67584
s_add_u32 s37, s37, s38
buffer_load_dwordx4 v21, s[8:11], s37 offen sc1 lds
s_add_u32 m0, s39, 68608
s_add_u32 s37, s37, s38
buffer_load_dwordx4 v21, s[8:11], s37 offen sc1 lds
s_add_u32 m0, s39, 69632
s_add_u32 s37, s37, s55
buffer_load_dwordx4 v21, s[8:11], s37 offen sc1 lds
s_add_u32 m0, s39, 70656
s_add_u32 s37, s37, s38
buffer_load_dwordx4 v21, s[8:11], s37 offen sc1 lds
s_add_u32 m0, s39, 71680
s_add_u32 s37, s37, s38
buffer_load_dwordx4 v21, s[8:11], s37 offen sc1 lds
s_add_u32 m0, s39, 72704
s_add_u32 s37, s37, s38
buffer_load_dwordx4 v21, s[8:11], s37 offen sc1 lds
s_waitcnt vmcnt(16)
s_barrier
s_add_u32 m0, s39, 98304
s_add_u32 s37, s37, s40
buffer_load_dwordx4 v21, s[8:11], s37 offen sc1 lds
s_add_u32 m0, s39, 99328
s_add_u32 s37, s37, s38
buffer_load_dwordx4 v21, s[8:11], s37 offen sc1 lds
s_add_u32 m0, s39, 100352
s_add_u32 s37, s37, s38
buffer_load_dwordx4 v21, s[8:11], s37 offen sc1 lds
s_add_u32 m0, s39, 101376
s_add_u32 s37, s37, s38
buffer_load_dwordx4 v21, s[8:11], s37 offen sc1 lds
s_add_u32 m0, s39, 102400
s_add_u32 s37, s37, s55
buffer_load_dwordx4 v21, s[8:11], s37 offen sc1 lds
s_add_u32 m0, s39, 103424
s_add_u32 s37, s37, s38
buffer_load_dwordx4 v21, s[8:11], s37 offen sc1 lds
s_add_u32 m0, s39, 104448
s_add_u32 s37, s37, s38
buffer_load_dwordx4 v21, s[8:11], s37 offen sc1 lds
s_add_u32 m0, s39, 105472
s_add_u32 s37, s37, s38
buffer_load_dwordx4 v21, s[8:11], s37 offen sc1 lds
s_waitcnt vmcnt(16)
s_barrier
s_cmp_eq_u32 s51, 2
s_cbranch_scc1 LW4_122
s_mul_i32 s40, s53, 98304
s_add_u32 m0, s39, 0
s_add_u32 s37, s40, 524288
buffer_load_dwordx4 v21, s[8:11], s37 offen sc1 lds
s_add_u32 m0, s39, 1024
s_add_u32 s37, s40, 525312
buffer_load_dwordx4 v21, s[8:11], s37 offen sc1 lds
s_add_u32 m0, s39, 2048
s_add_u32 s37, s40, 526336
buffer_load_dwordx4 v21, s[8:11], s37 offen sc1 lds
s_add_u32 m0, s39, 3072
s_add_u32 s37, s40, 527360
buffer_load_dwordx4 v21, s[8:11], s37 offen sc1 lds
s_add_u32 m0, s39, 4096
s_add_u32 s37, s40, 528384
buffer_load_dwordx4 v21, s[8:11], s37 offen sc1 lds
s_add_u32 m0, s39, 5120
s_add_u32 s37, s40, 529408
buffer_load_dwordx4 v21, s[8:11], s37 offen sc1 lds
s_add_u32 m0, s39, 6144
s_add_u32 s37, s40, 530432
buffer_load_dwordx4 v21, s[8:11], s37 offen sc1 lds
s_add_u32 m0, s39, 7168
s_add_u32 s37, s40, 531456
buffer_load_dwordx4 v21, s[8:11], s37 offen sc1 lds
s_waitcnt vmcnt(16)
s_barrier
s_add_u32 m0, s39, 32768
s_add_u32 s37, s40, 540672
buffer_load_dwordx4 v21, s[8:11], s37 offen sc1 lds
s_add_u32 m0, s39, 33792
s_add_u32 s37, s40, 541696
buffer_load_dwordx4 v21, s[8:11], s37 offen sc1 lds
s_add_u32 m0, s39, 34816
s_add_u32 s37, s40, 542720
buffer_load_dwordx4 v21, s[8:11], s37 offen sc1 lds
s_add_u32 m0, s39, 35840
s_add_u32 s37, s40, 543744
buffer_load_dwordx4 v21, s[8:11], s37 offen sc1 lds
s_add_u32 m0, s39, 36864
s_add_u32 s37, s40, 544768
buffer_load_dwordx4 v21, s[8:11], s37 offen sc1 lds
s_add_u32 m0, s39, 37888
s_add_u32 s37, s40, 545792
buffer_load_dwordx4 v21, s[8:11], s37 offen sc1 lds
s_add_u32 m0, s39, 38912
s_add_u32 s37, s40, 546816
buffer_load_dwordx4 v21, s[8:11], s37 offen sc1 lds
s_add_u32 m0, s39, 39936
s_add_u32 s37, s40, 547840
buffer_load_dwordx4 v21, s[8:11], s37 offen sc1 lds
s_waitcnt vmcnt(16)
s_barrier
s_add_u32 m0, s39, 65536
s_add_u32 s37, s40, 557056
buffer_load_dwordx4 v21, s[8:11], s37 offen sc1 lds
s_add_u32 m0, s39, 66560
s_add_u32 s37, s40, 558080
buffer_load_dwordx4 v21, s[8:11], s37 offen sc1 lds
s_add_u32 m0, s39, 67584
s_add_u32 s37, s40, 559104
buffer_load_dwordx4 v21, s[8:11], s37 offen sc1 lds
s_add_u32 m0, s39, 68608
s_add_u32 s37, s40, 560128
buffer_load_dwordx4 v21, s[8:11], s37 offen sc1 lds
s_add_u32 m0, s39, 69632
s_add_u32 s37, s40, 561152
buffer_load_dwordx4 v21, s[8:11], s37 offen sc1 lds
s_add_u32 m0, s39, 70656
s_add_u32 s37, s40, 562176
buffer_load_dwordx4 v21, s[8:11], s37 offen sc1 lds
s_add_u32 m0, s39, 71680
s_add_u32 s37, s40, 563200
buffer_load_dwordx4 v21, s[8:11], s37 offen sc1 lds
s_add_u32 m0, s39, 72704
s_add_u32 s37, s40, 564224
buffer_load_dwordx4 v21, s[8:11], s37 offen sc1 lds
s_waitcnt vmcnt(16)
s_barrier
s_add_u32 m0, s39, 98304
s_add_u32 s37, s40, 573440
buffer_load_dwordx4 v21, s[8:11], s37 offen sc1 lds
s_add_u32 m0, s39, 99328
s_add_u32 s37, s40, 574464
buffer_load_dwordx4 v21, s[8:11], s37 offen sc1 lds
s_add_u32 m0, s39, 100352
s_add_u32 s37, s40, 575488
buffer_load_dwordx4 v21, s[8:11], s37 offen sc1 lds
s_add_u32 m0, s39, 101376
s_add_u32 s37, s40, 576512
buffer_load_dwordx4 v21, s[8:11], s37 offen sc1 lds
s_add_u32 m0, s39, 102400
s_add_u32 s37, s40, 577536
buffer_load_dwordx4 v21, s[8:11], s37 offen sc1 lds
s_add_u32 m0, s39, 103424
s_add_u32 s37, s40, 578560
buffer_load_dwordx4 v21, s[8:11], s37 offen sc1 lds
s_add_u32 m0, s39, 104448
s_add_u32 s37, s40, 579584
buffer_load_dwordx4 v21, s[8:11], s37 offen sc1 lds
s_add_u32 m0, s39, 105472
s_add_u32 s37, s40, 580608
buffer_load_dwordx4 v21, s[8:11], s37 offen sc1 lds
s_waitcnt vmcnt(16)
s_barrier
s_add_u32 m0, s39, 0
s_add_u32 s37, s40, 589824
buffer_load_dwordx4 v21, s[8:11], s37 offen sc1 lds
s_add_u32 m0, s39, 1024
s_add_u32 s37, s40, 590848
buffer_load_dwordx4 v21, s[8:11], s37 offen sc1 lds
s_add_u32 m0, s39, 2048
s_add_u32 s37, s40, 591872
buffer_load_dwordx4 v21, s[8:11], s37 offen sc1 lds
s_add_u32 m0, s39, 3072
s_add_u32 s37, s40, 592896
buffer_load_dwordx4 v21, s[8:11], s37 offen sc1 lds
s_add_u32 m0, s39, 4096
s_add_u32 s37, s40, 593920
buffer_load_dwordx4 v21, s[8:11], s37 offen sc1 lds
s_add_u32 m0, s39, 5120
s_add_u32 s37, s40, 594944
buffer_load_dwordx4 v21, s[8:11], s37 offen sc1 lds
s_add_u32 m0, s39, 6144
s_add_u32 s37, s40, 595968
buffer_load_dwordx4 v21, s[8:11], s37 offen sc1 lds
s_add_u32 m0, s39, 7168
s_add_u32 s37, s40, 596992
buffer_load_dwordx4 v21, s[8:11], s37 offen sc1 lds
s_waitcnt vmcnt(16)
s_barrier
s_add_u32 m0, s39, 32768
s_add_u32 s37, s40, 606208
buffer_load_dwordx4 v21, s[8:11], s37 offen sc1 lds
s_add_u32 m0, s39, 33792
s_add_u32 s37, s40, 607232
buffer_load_dwordx4 v21, s[8:11], s37 offen sc1 lds
s_add_u32 m0, s39, 34816
s_add_u32 s37, s40, 608256
buffer_load_dwordx4 v21, s[8:11], s37 offen sc1 lds
s_add_u32 m0, s39, 35840
s_add_u32 s37, s40, 609280
buffer_load_dwordx4 v21, s[8:11], s37 offen sc1 lds
s_add_u32 m0, s39, 36864
s_add_u32 s37, s40, 610304
buffer_load_dwordx4 v21, s[8:11], s37 offen sc1 lds
s_add_u32 m0, s39, 37888
s_add_u32 s37, s40, 611328
buffer_load_dwordx4 v21, s[8:11], s37 offen sc1 lds
s_add_u32 m0, s39, 38912
s_add_u32 s37, s40, 612352
buffer_load_dwordx4 v21, s[8:11], s37 offen sc1 lds
s_add_u32 m0, s39, 39936
s_add_u32 s37, s40, 613376
buffer_load_dwordx4 v21, s[8:11], s37 offen sc1 lds
s_waitcnt vmcnt(16)
s_barrier
s_add_u32 m0, s39, 65536
s_mov_b32 s37, 720896
buffer_load_dwordx4 v21, s[8:11], s37 offen sc1 lds
s_add_u32 m0, s39, 66560
s_mov_b32 s37, 721920
buffer_load_dwordx4 v21, s[8:11], s37 offen sc1 lds
s_add_u32 m0, s39, 67584
s_mov_b32 s37, 722944
buffer_load_dwordx4 v21, s[8:11], s37 offen sc1 lds
s_add_u32 m0, s39, 68608
s_mov_b32 s37, 723968
buffer_load_dwordx4 v21, s[8:11], s37 offen sc1 lds
s_add_u32 m0, s39, 69632
s_mov_b32 s37, 724992
buffer_load_dwordx4 v21, s[8:11], s37 offen sc1 lds
s_add_u32 m0, s39, 70656
s_mov_b32 s37, 726016
buffer_load_dwordx4 v21, s[8:11], s37 offen sc1 lds
s_add_u32 m0, s39, 71680
s_mov_b32 s37, 727040
buffer_load_dwordx4 v21, s[8:11], s37 offen sc1 lds
s_add_u32 m0, s39, 72704
s_mov_b32 s37, 728064
buffer_load_dwordx4 v21, s[8:11], s37 offen sc1 lds
s_waitcnt vmcnt(16)
s_barrier
s_add_u32 m0, s39, 98304
s_mov_b32 s37, 737280
buffer_load_dwordx4 v21, s[8:11], s37 offen sc1 lds
s_add_u32 m0, s39, 99328
s_mov_b32 s37, 738304
buffer_load_dwordx4 v21, s[8:11], s37 offen sc1 lds
s_add_u32 m0, s39, 100352
s_mov_b32 s37, 739328
buffer_load_dwordx4 v21, s[8:11], s37 offen sc1 lds
s_add_u32 m0, s39, 101376
s_mov_b32 s37, 740352
buffer_load_dwordx4 v21, s[8:11], s37 offen sc1 lds
s_add_u32 m0, s39, 102400
s_mov_b32 s37, 741376
buffer_load_dwordx4 v21, s[8:11], s37 offen sc1 lds
s_add_u32 m0, s39, 103424
s_mov_b32 s37, 742400
buffer_load_dwordx4 v21, s[8:11], s37 offen sc1 lds
s_add_u32 m0, s39, 104448
s_mov_b32 s37, 743424
buffer_load_dwordx4 v21, s[8:11], s37 offen sc1 lds
s_add_u32 m0, s39, 105472
s_mov_b32 s37, 744448
buffer_load_dwordx4 v21, s[8:11], s37 offen sc1 lds
s_waitcnt vmcnt(16)
s_barrier
s_add_u32 m0, s39, 0
s_mov_b32 s37, 753664
buffer_load_dwordx4 v21, s[8:11], s37 offen sc1 lds
s_add_u32 m0, s39, 1024
s_mov_b32 s37, 754688
buffer_load_dwordx4 v21, s[8:11], s37 offen sc1 lds
s_add_u32 m0, s39, 2048
s_mov_b32 s37, 755712
buffer_load_dwordx4 v21, s[8:11], s37 offen sc1 lds
s_add_u32 m0, s39, 3072
s_mov_b32 s37, 756736
buffer_load_dwordx4 v21, s[8:11], s37 offen sc1 lds
s_add_u32 m0, s39, 4096
s_mov_b32 s37, 757760
buffer_load_dwordx4 v21, s[8:11], s37 offen sc1 lds
s_add_u32 m0, s39, 5120
s_mov_b32 s37, 758784
buffer_load_dwordx4 v21, s[8:11], s37 offen sc1 lds
s_add_u32 m0, s39, 6144
s_mov_b32 s37, 759808
buffer_load_dwordx4 v21, s[8:11], s37 offen sc1 lds
s_add_u32 m0, s39, 7168
s_mov_b32 s37, 760832
buffer_load_dwordx4 v21, s[8:11], s37 offen sc1 lds
s_waitcnt vmcnt(16)
s_barrier
s_add_u32 m0, s39, 32768
s_mov_b32 s37, 770048
buffer_load_dwordx4 v21, s[8:11], s37 offen sc1 lds
s_add_u32 m0, s39, 33792
s_mov_b32 s37, 771072
buffer_load_dwordx4 v21, s[8:11], s37 offen sc1 lds
s_add_u32 m0, s39, 34816
s_mov_b32 s37, 772096
buffer_load_dwordx4 v21, s[8:11], s37 offen sc1 lds
s_add_u32 m0, s39, 35840
s_mov_b32 s37, 773120
buffer_load_dwordx4 v21, s[8:11], s37 offen sc1 lds
s_add_u32 m0, s39, 36864
s_mov_b32 s37, 774144
buffer_load_dwordx4 v21, s[8:11], s37 offen sc1 lds
s_add_u32 m0, s39, 37888
s_mov_b32 s37, 775168
buffer_load_dwordx4 v21, s[8:11], s37 offen sc1 lds
s_add_u32 m0, s39, 38912
s_mov_b32 s37, 776192
buffer_load_dwordx4 v21, s[8:11], s37 offen sc1 lds
s_add_u32 m0, s39, 39936
s_mov_b32 s37, 777216
buffer_load_dwordx4 v21, s[8:11], s37 offen sc1 lds
s_waitcnt vmcnt(16)
s_barrier
s_add_u32 m0, s39, 65536
s_mov_b32 s37, 786432
buffer_load_dwordx4 v21, s[8:11], s37 offen sc1 lds
s_add_u32 m0, s39, 66560
s_mov_b32 s37, 787456
buffer_load_dwordx4 v21, s[8:11], s37 offen sc1 lds
s_add_u32 m0, s39, 67584
s_mov_b32 s37, 788480
buffer_load_dwordx4 v21, s[8:11], s37 offen sc1 lds
s_add_u32 m0, s39, 68608
s_mov_b32 s37, 789504
buffer_load_dwordx4 v21, s[8:11], s37 offen sc1 lds
s_add_u32 m0, s39, 69632
s_mov_b32 s37, 790528
buffer_load_dwordx4 v21, s[8:11], s37 offen sc1 lds
s_add_u32 m0, s39, 70656
s_mov_b32 s37, 791552
buffer_load_dwordx4 v21, s[8:11], s37 offen sc1 lds
s_add_u32 m0, s39, 71680
s_mov_b32 s37, 792576
buffer_load_dwordx4 v21, s[8:11], s37 offen sc1 lds
s_add_u32 m0, s39, 72704
s_mov_b32 s37, 793600
buffer_load_dwordx4 v21, s[8:11], s37 offen sc1 lds
s_waitcnt vmcnt(16)
s_barrier
s_add_u32 m0, s39, 98304
s_mov_b32 s37, 802816
buffer_load_dwordx4 v21, s[8:11], s37 offen sc1 lds
s_add_u32 m0, s39, 99328
s_mov_b32 s37, 803840
buffer_load_dwordx4 v21, s[8:11], s37 offen sc1 lds
s_add_u32 m0, s39, 100352
s_mov_b32 s37, 804864
buffer_load_dwordx4 v21, s[8:11], s37 offen sc1 lds
s_add_u32 m0, s39, 101376
s_mov_b32 s37, 805888
buffer_load_dwordx4 v21, s[8:11], s37 offen sc1 lds
s_add_u32 m0, s39, 102400
s_mov_b32 s37, 806912
buffer_load_dwordx4 v21, s[8:11], s37 offen sc1 lds
s_add_u32 m0, s39, 103424
s_mov_b32 s37, 807936
buffer_load_dwordx4 v21, s[8:11], s37 offen sc1 lds
s_add_u32 m0, s39, 104448
s_mov_b32 s37, 808960
buffer_load_dwordx4 v21, s[8:11], s37 offen sc1 lds
s_add_u32 m0, s39, 105472
s_mov_b32 s37, 809984
buffer_load_dwordx4 v21, s[8:11], s37 offen sc1 lds
s_waitcnt vmcnt(16)
s_barrier
s_add_u32 m0, s39, 0
s_mov_b32 s37, 819200
buffer_load_dwordx4 v21, s[8:11], s37 offen sc1 lds
s_add_u32 m0, s39, 1024
s_mov_b32 s37, 820224
buffer_load_dwordx4 v21, s[8:11], s37 offen sc1 lds
s_add_u32 m0, s39, 2048
s_mov_b32 s37, 821248
buffer_load_dwordx4 v21, s[8:11], s37 offen sc1 lds
s_add_u32 m0, s39, 3072
s_mov_b32 s37, 822272
buffer_load_dwordx4 v21, s[8:11], s37 offen sc1 lds
s_add_u32 m0, s39, 4096
s_mov_b32 s37, 823296
buffer_load_dwordx4 v21, s[8:11], s37 offen sc1 lds
s_add_u32 m0, s39, 5120
s_mov_b32 s37, 824320
buffer_load_dwordx4 v21, s[8:11], s37 offen sc1 lds
s_add_u32 m0, s39, 6144
s_mov_b32 s37, 825344
buffer_load_dwordx4 v21, s[8:11], s37 offen sc1 lds
s_add_u32 m0, s39, 7168
s_mov_b32 s37, 826368
buffer_load_dwordx4 v21, s[8:11], s37 offen sc1 lds
s_waitcnt vmcnt(16)
s_barrier
s_add_u32 m0, s39, 32768
s_mov_b32 s37, 835584
buffer_load_dwordx4 v21, s[8:11], s37 offen sc1 lds
s_add_u32 m0, s39, 33792
s_mov_b32 s37, 836608
buffer_load_dwordx4 v21, s[8:11], s37 offen sc1 lds
s_add_u32 m0, s39, 34816
s_mov_b32 s37, 837632
buffer_load_dwordx4 v21, s[8:11], s37 offen sc1 lds
s_add_u32 m0, s39, 35840
s_mov_b32 s37, 838656
buffer_load_dwordx4 v21, s[8:11], s37 offen sc1 lds
s_add_u32 m0, s39, 36864
s_mov_b32 s37, 839680
buffer_load_dwordx4 v21, s[8:11], s37 offen sc1 lds
s_add_u32 m0, s39, 37888
s_mov_b32 s37, 840704
buffer_load_dwordx4 v21, s[8:11], s37 offen sc1 lds
s_add_u32 m0, s39, 38912
s_mov_b32 s37, 841728
buffer_load_dwordx4 v21, s[8:11], s37 offen sc1 lds
s_add_u32 m0, s39, 39936
s_mov_b32 s37, 842752
buffer_load_dwordx4 v21, s[8:11], s37 offen sc1 lds
s_waitcnt vmcnt(16)
s_barrier
s_add_u32 m0, s39, 65536
s_mov_b32 s37, 851968
buffer_load_dwordx4 v21, s[8:11], s37 offen sc1 lds
s_add_u32 m0, s39, 66560
s_mov_b32 s37, 852992
buffer_load_dwordx4 v21, s[8:11], s37 offen sc1 lds
s_add_u32 m0, s39, 67584
s_mov_b32 s37, 854016
buffer_load_dwordx4 v21, s[8:11], s37 offen sc1 lds
s_add_u32 m0, s39, 68608
s_mov_b32 s37, 855040
buffer_load_dwordx4 v21, s[8:11], s37 offen sc1 lds
s_add_u32 m0, s39, 69632
s_mov_b32 s37, 856064
buffer_load_dwordx4 v21, s[8:11], s37 offen sc1 lds
s_add_u32 m0, s39, 70656
s_mov_b32 s37, 857088
buffer_load_dwordx4 v21, s[8:11], s37 offen sc1 lds
s_add_u32 m0, s39, 71680
s_mov_b32 s37, 858112
buffer_load_dwordx4 v21, s[8:11], s37 offen sc1 lds
s_add_u32 m0, s39, 72704
s_mov_b32 s37, 859136
buffer_load_dwordx4 v21, s[8:11], s37 offen sc1 lds
s_waitcnt vmcnt(16)
s_barrier
s_add_u32 m0, s39, 98304
s_mov_b32 s37, 868352
buffer_load_dwordx4 v21, s[8:11], s37 offen sc1 lds
s_add_u32 m0, s39, 99328
s_mov_b32 s37, 869376
buffer_load_dwordx4 v21, s[8:11], s37 offen sc1 lds
s_add_u32 m0, s39, 100352
s_mov_b32 s37, 870400
buffer_load_dwordx4 v21, s[8:11], s37 offen sc1 lds
s_add_u32 m0, s39, 101376
s_mov_b32 s37, 871424
buffer_load_dwordx4 v21, s[8:11], s37 offen sc1 lds
s_add_u32 m0, s39, 102400
s_mov_b32 s37, 872448
buffer_load_dwordx4 v21, s[8:11], s37 offen sc1 lds
s_add_u32 m0, s39, 103424
s_mov_b32 s37, 873472
buffer_load_dwordx4 v21, s[8:11], s37 offen sc1 lds
s_add_u32 m0, s39, 104448
s_mov_b32 s37, 874496
buffer_load_dwordx4 v21, s[8:11], s37 offen sc1 lds
s_add_u32 m0, s39, 105472
s_mov_b32 s37, 875520
buffer_load_dwordx4 v21, s[8:11], s37 offen sc1 lds
s_waitcnt vmcnt(16)
s_barrier
s_add_u32 m0, s39, 0
s_mov_b32 s37, 884736
buffer_load_dwordx4 v21, s[8:11], s37 offen sc1 lds
s_add_u32 m0, s39, 1024
s_mov_b32 s37, 885760
buffer_load_dwordx4 v21, s[8:11], s37 offen sc1 lds
s_add_u32 m0, s39, 2048
s_mov_b32 s37, 886784
buffer_load_dwordx4 v21, s[8:11], s37 offen sc1 lds
s_add_u32 m0, s39, 3072
s_mov_b32 s37, 887808
buffer_load_dwordx4 v21, s[8:11], s37 offen sc1 lds
s_add_u32 m0, s39, 4096
s_mov_b32 s37, 888832
buffer_load_dwordx4 v21, s[8:11], s37 offen sc1 lds
s_add_u32 m0, s39, 5120
s_mov_b32 s37, 889856
buffer_load_dwordx4 v21, s[8:11], s37 offen sc1 lds
s_add_u32 m0, s39, 6144
s_mov_b32 s37, 890880
buffer_load_dwordx4 v21, s[8:11], s37 offen sc1 lds
s_add_u32 m0, s39, 7168
s_mov_b32 s37, 891904
buffer_load_dwordx4 v21, s[8:11], s37 offen sc1 lds
s_waitcnt vmcnt(16)
s_barrier
s_add_u32 m0, s39, 32768
s_mov_b32 s37, 901120
buffer_load_dwordx4 v21, s[8:11], s37 offen sc1 lds
s_add_u32 m0, s39, 33792
s_mov_b32 s37, 902144
buffer_load_dwordx4 v21, s[8:11], s37 offen sc1 lds
s_add_u32 m0, s39, 34816
s_mov_b32 s37, 903168
buffer_load_dwordx4 v21, s[8:11], s37 offen sc1 lds
s_add_u32 m0, s39, 35840
s_mov_b32 s37, 904192
buffer_load_dwordx4 v21, s[8:11], s37 offen sc1 lds
s_add_u32 m0, s39, 36864
s_mov_b32 s37, 905216
buffer_load_dwordx4 v21, s[8:11], s37 offen sc1 lds
s_add_u32 m0, s39, 37888
s_mov_b32 s37, 906240
buffer_load_dwordx4 v21, s[8:11], s37 offen sc1 lds
s_add_u32 m0, s39, 38912
s_mov_b32 s37, 907264
buffer_load_dwordx4 v21, s[8:11], s37 offen sc1 lds
s_add_u32 m0, s39, 39936
s_mov_b32 s37, 908288
buffer_load_dwordx4 v21, s[8:11], s37 offen sc1 lds
s_waitcnt vmcnt(16)
s_barrier
s_waitcnt vmcnt(8)
s_barrier
s_waitcnt vmcnt(0)
s_barrier
s_branch Ldone_1
.p2align 6
Lw_126:
s_branch Lr_127
s_nop 0
.p2align 3
LW4_122:
s_mul_i32 s40, s53, 983040
s_add_u32 m0, s39, 0
s_add_u32 s37, s40, 4194304
buffer_load_dwordx4 v21, s[8:11], s37 offen sc1 lds
s_add_u32 m0, s39, 1024
s_add_u32 s37, s40, 4210688
buffer_load_dwordx4 v21, s[8:11], s37 offen sc1 lds
s_add_u32 m0, s39, 2048
s_add_u32 s37, s40, 4227072
buffer_load_dwordx4 v21, s[8:11], s37 offen sc1 lds
s_add_u32 m0, s39, 3072
s_add_u32 s37, s40, 4243456
buffer_load_dwordx4 v21, s[8:11], s37 offen sc1 lds
s_add_u32 m0, s39, 4096
s_add_u32 s37, s40, 4292608
buffer_load_dwordx4 v21, s[8:11], s37 offen sc1 lds
s_add_u32 m0, s39, 5120
s_add_u32 s37, s40, 4308992
buffer_load_dwordx4 v21, s[8:11], s37 offen sc1 lds
s_add_u32 m0, s39, 6144
s_add_u32 s37, s40, 4325376
buffer_load_dwordx4 v21, s[8:11], s37 offen sc1 lds
s_add_u32 m0, s39, 7168
s_add_u32 s37, s40, 4341760
buffer_load_dwordx4 v21, s[8:11], s37 offen sc1 lds
s_waitcnt vmcnt(16)
s_barrier
s_add_u32 m0, s39, 32768
s_add_u32 s37, s40, 4259840
buffer_load_dwordx4 v21, s[8:11], s37 offen sc1 lds
s_add_u32 m0, s39, 33792
s_add_u32 s37, s40, 4358144
buffer_load_dwordx4 v21, s[8:11], s37 offen sc1 lds
s_add_u32 m0, s39, 34816
s_add_u32 s37, s40, 4276224
buffer_load_dwordx4 v21, s[8:11], s37 offen sc1 lds
s_add_u32 m0, s39, 35840
s_add_u32 s37, s40, 4374528
buffer_load_dwordx4 v21, s[8:11], s37 offen sc1 lds
s_add_u32 m0, s39, 36864
s_add_u32 s37, s40, 4390912
buffer_load_dwordx4 v21, s[8:11], s37 offen sc1 lds
s_add_u32 m0, s39, 37888
s_add_u32 s37, s40, 4407296
buffer_load_dwordx4 v21, s[8:11], s37 offen sc1 lds
s_add_u32 m0, s39, 38912
s_add_u32 s37, s40, 4423680
buffer_load_dwordx4 v21, s[8:11], s37 offen sc1 lds
s_add_u32 m0, s39, 39936
s_add_u32 s37, s40, 4440064
buffer_load_dwordx4 v21, s[8:11], s37 offen sc1 lds
s_waitcnt vmcnt(16)
s_barrier
s_add_u32 m0, s39, 65536
s_add_u32 s37, s40, 4489216
buffer_load_dwordx4 v21, s[8:11], s37 offen sc1 lds
s_add_u32 m0, s39, 66560
s_add_u32 s37, s40, 4505600
buffer_load_dwordx4 v21, s[8:11], s37 offen sc1 lds
s_add_u32 m0, s39, 67584
s_add_u32 s37, s40, 4521984
buffer_load_dwordx4 v21, s[8:11], s37 offen sc1 lds
s_add_u32 m0, s39, 68608
s_add_u32 s37, s40, 4538368
buffer_load_dwordx4 v21, s[8:11], s37 offen sc1 lds
s_add_u32 m0, s39, 69632
s_add_u32 s37, s40, 4456448
buffer_load_dwordx4 v21, s[8:11], s37 offen sc1 lds
s_add_u32 m0, s39, 70656
s_add_u32 s37, s40, 4554752
buffer_load_dwordx4 v21, s[8:11], s37 offen sc1 lds
s_add_u32 m0, s39, 71680
s_add_u32 s37, s40, 4472832
buffer_load_dwordx4 v21, s[8:11], s37 offen sc1 lds
s_add_u32 m0, s39, 72704
s_add_u32 s37, s40, 4571136
buffer_load_dwordx4 v21, s[8:11], s37 offen sc1 lds
s_waitcnt vmcnt(16)
s_barrier
s_add_u32 m0, s39, 98304
s_add_u32 s37, s40, 4784128
buffer_load_dwordx4 v21, s[8:11], s37 offen sc1 lds
s_add_u32 m0, s39, 99328
s_add_u32 s37, s40, 4800512
buffer_load_dwordx4 v21, s[8:11], s37 offen sc1 lds
s_add_u32 m0, s39, 100352
s_add_u32 s37, s40, 4816896
buffer_load_dwordx4 v21, s[8:11], s37 offen sc1 lds
s_add_u32 m0, s39, 101376
s_add_u32 s37, s40, 4833280
buffer_load_dwordx4 v21, s[8:11], s37 offen sc1 lds
s_add_u32 m0, s39, 102400
s_add_u32 s37, s40, 4882432
buffer_load_dwordx4 v21, s[8:11], s37 offen sc1 lds
s_add_u32 m0, s39, 103424
s_add_u32 s37, s40, 4898816
buffer_load_dwordx4 v21, s[8:11], s37 offen sc1 lds
s_add_u32 m0, s39, 104448
s_add_u32 s37, s40, 4915200
buffer_load_dwordx4 v21, s[8:11], s37 offen sc1 lds
s_add_u32 m0, s39, 105472
s_add_u32 s37, s40, 4931584
buffer_load_dwordx4 v21, s[8:11], s37 offen sc1 lds
s_waitcnt vmcnt(16)
s_barrier
s_add_u32 m0, s39, 0
s_add_u32 s37, s40, 4849664
buffer_load_dwordx4 v21, s[8:11], s37 offen sc1 lds
s_add_u32 m0, s39, 1024
s_add_u32 s37, s40, 4947968
buffer_load_dwordx4 v21, s[8:11], s37 offen sc1 lds
s_add_u32 m0, s39, 2048
s_add_u32 s37, s40, 4866048
buffer_load_dwordx4 v21, s[8:11], s37 offen sc1 lds
s_add_u32 m0, s39, 3072
s_add_u32 s37, s40, 4964352
buffer_load_dwordx4 v21, s[8:11], s37 offen sc1 lds
s_add_u32 m0, s39, 4096
s_add_u32 s37, s40, 4980736
buffer_load_dwordx4 v21, s[8:11], s37 offen sc1 lds
s_add_u32 m0, s39, 5120
s_add_u32 s37, s40, 4997120
buffer_load_dwordx4 v21, s[8:11], s37 offen sc1 lds
s_add_u32 m0, s39, 6144
s_add_u32 s37, s40, 5013504
buffer_load_dwordx4 v21, s[8:11], s37 offen sc1 lds
s_add_u32 m0, s39, 7168
s_add_u32 s37, s40, 5029888
buffer_load_dwordx4 v21, s[8:11], s37 offen sc1 lds
s_waitcnt vmcnt(16)
s_barrier
s_add_u32 m0, s39, 32768
s_add_u32 s37, s40, 5079040
buffer_load_dwordx4 v21, s[8:11], s37 offen sc1 lds
s_add_u32 m0, s39, 33792
s_add_u32 s37, s40, 5095424
buffer_load_dwordx4 v21, s[8:11], s37 offen sc1 lds
s_add_u32 m0, s39, 34816
s_add_u32 s37, s40, 5111808
buffer_load_dwordx4 v21, s[8:11], s37 offen sc1 lds
s_add_u32 m0, s39, 35840
s_add_u32 s37, s40, 5128192
buffer_load_dwordx4 v21, s[8:11], s37 offen sc1 lds
s_add_u32 m0, s39, 36864
s_add_u32 s37, s40, 5046272
buffer_load_dwordx4 v21, s[8:11], s37 offen sc1 lds
s_add_u32 m0, s39, 37888
s_add_u32 s37, s40, 5144576
buffer_load_dwordx4 v21, s[8:11], s37 offen sc1 lds
s_add_u32 m0, s39, 38912
s_add_u32 s37, s40, 5062656
buffer_load_dwordx4 v21, s[8:11], s37 offen sc1 lds
s_add_u32 m0, s39, 39936
s_add_u32 s37, s40, 5160960
buffer_load_dwordx4 v21, s[8:11], s37 offen sc1 lds
s_waitcnt vmcnt(16)
s_barrier
s_add_u32 m0, s39, 65536
s_mov_b32 s37, 6160384
buffer_load_dwordx4 v21, s[8:11], s37 offen sc1 lds
s_add_u32 m0, s39, 66560
s_mov_b32 s37, 6176768
buffer_load_dwordx4 v21, s[8:11], s37 offen sc1 lds
s_add_u32 m0, s39, 67584
s_mov_b32 s37, 6193152
buffer_load_dwordx4 v21, s[8:11], s37 offen sc1 lds
s_add_u32 m0, s39, 68608
s_mov_b32 s37, 6209536
buffer_load_dwordx4 v21, s[8:11], s37 offen sc1 lds
s_add_u32 m0, s39, 69632
s_mov_b32 s37, 6258688
buffer_load_dwordx4 v21, s[8:11], s37 offen sc1 lds
s_add_u32 m0, s39, 70656
s_mov_b32 s37, 6275072
buffer_load_dwordx4 v21, s[8:11], s37 offen sc1 lds
s_add_u32 m0, s39, 71680
s_mov_b32 s37, 6291456
buffer_load_dwordx4 v21, s[8:11], s37 offen sc1 lds
s_add_u32 m0, s39, 72704
s_mov_b32 s37, 6307840
buffer_load_dwordx4 v21, s[8:11], s37 offen sc1 lds
s_waitcnt vmcnt(16)
s_barrier
s_add_u32 m0, s39, 98304
s_mov_b32 s37, 6225920
buffer_load_dwordx4 v21, s[8:11], s37 offen sc1 lds
s_add_u32 m0, s39, 99328
s_mov_b32 s37, 6324224
buffer_load_dwordx4 v21, s[8:11], s37 offen sc1 lds
s_add_u32 m0, s39, 100352
s_mov_b32 s37, 6242304
buffer_load_dwordx4 v21, s[8:11], s37 offen sc1 lds
s_add_u32 m0, s39, 101376
s_mov_b32 s37, 6340608
buffer_load_dwordx4 v21, s[8:11], s37 offen sc1 lds
s_add_u32 m0, s39, 102400
s_mov_b32 s37, 6356992
buffer_load_dwordx4 v21, s[8:11], s37 offen sc1 lds
s_add_u32 m0, s39, 103424
s_mov_b32 s37, 6373376
buffer_load_dwordx4 v21, s[8:11], s37 offen sc1 lds
s_add_u32 m0, s39, 104448
s_mov_b32 s37, 6389760
buffer_load_dwordx4 v21, s[8:11], s37 offen sc1 lds
s_add_u32 m0, s39, 105472
s_mov_b32 s37, 6406144
buffer_load_dwordx4 v21, s[8:11], s37 offen sc1 lds
s_waitcnt vmcnt(16)
s_barrier
s_add_u32 m0, s39, 0
s_mov_b32 s37, 6455296
buffer_load_dwordx4 v21, s[8:11], s37 offen sc1 lds
s_add_u32 m0, s39, 1024
s_mov_b32 s37, 6471680
buffer_load_dwordx4 v21, s[8:11], s37 offen sc1 lds
s_add_u32 m0, s39, 2048
s_mov_b32 s37, 6488064
buffer_load_dwordx4 v21, s[8:11], s37 offen sc1 lds
s_add_u32 m0, s39, 3072
s_mov_b32 s37, 6504448
buffer_load_dwordx4 v21, s[8:11], s37 offen sc1 lds
s_add_u32 m0, s39, 4096
s_mov_b32 s37, 6422528
buffer_load_dwordx4 v21, s[8:11], s37 offen sc1 lds
s_add_u32 m0, s39, 5120
s_mov_b32 s37, 6520832
buffer_load_dwordx4 v21, s[8:11], s37 offen sc1 lds
s_add_u32 m0, s39, 6144
s_mov_b32 s37, 6438912
buffer_load_dwordx4 v21, s[8:11], s37 offen sc1 lds
s_add_u32 m0, s39, 7168
s_mov_b32 s37, 6537216
buffer_load_dwordx4 v21, s[8:11], s37 offen sc1 lds
s_waitcnt vmcnt(16)
s_barrier
s_add_u32 m0, s39, 32768
s_mov_b32 s37, 6946816
buffer_load_dwordx4 v21, s[8:11], s37 offen sc1 lds
s_add_u32 m0, s39, 33792
s_mov_b32 s37, 6963200
buffer_load_dwordx4 v21, s[8:11], s37 offen sc1 lds
s_add_u32 m0, s39, 34816
s_mov_b32 s37, 6979584
buffer_load_dwordx4 v21, s[8:11], s37 offen sc1 lds
s_add_u32 m0, s39, 35840
s_mov_b32 s37, 6995968
buffer_load_dwordx4 v21, s[8:11], s37 offen sc1 lds
s_add_u32 m0, s39, 36864
s_mov_b32 s37, 7045120
buffer_load_dwordx4 v21, s[8:11], s37 offen sc1 lds
s_add_u32 m0, s39, 37888
s_mov_b32 s37, 7061504
buffer_load_dwordx4 v21, s[8:11], s37 offen sc1 lds
s_add_u32 m0, s39, 38912
s_mov_b32 s37, 7077888
buffer_load_dwordx4 v21, s[8:11], s37 offen sc1 lds
s_add_u32 m0, s39, 39936
s_mov_b32 s37, 7094272
buffer_load_dwordx4 v21, s[8:11], s37 offen sc1 lds
s_waitcnt vmcnt(16)
s_barrier
s_add_u32 m0, s39, 65536
s_mov_b32 s37, 7012352
buffer_load_dwordx4 v21, s[8:11], s37 offen sc1 lds
s_add_u32 m0, s39, 66560
s_mov_b32 s37, 7110656
buffer_load_dwordx4 v21, s[8:11], s37 offen sc1 lds
s_add_u32 m0, s39, 67584
s_mov_b32 s37, 7028736
buffer_load_dwordx4 v21, s[8:11], s37 offen sc1 lds
s_add_u32 m0, s39, 68608
s_mov_b32 s37, 7127040
buffer_load_dwordx4 v21, s[8:11], s37 offen sc1 lds
s_add_u32 m0, s39, 69632
s_mov_b32 s37, 7143424
buffer_load_dwordx4 v21, s[8:11], s37 offen sc1 lds
s_add_u32 m0, s39, 70656
s_mov_b32 s37, 7159808
buffer_load_dwordx4 v21, s[8:11], s37 offen sc1 lds
s_add_u32 m0, s39, 71680
s_mov_b32 s37, 7176192
buffer_load_dwordx4 v21, s[8:11], s37 offen sc1 lds
s_add_u32 m0, s39, 72704
s_mov_b32 s37, 7192576
buffer_load_dwordx4 v21, s[8:11], s37 offen sc1 lds
s_waitcnt vmcnt(16)
s_barrier
s_add_u32 m0, s39, 98304
s_mov_b32 s37, 7241728
buffer_load_dwordx4 v21, s[8:11], s37 offen sc1 lds
s_add_u32 m0, s39, 99328
s_mov_b32 s37, 7258112
buffer_load_dwordx4 v21, s[8:11], s37 offen sc1 lds
s_add_u32 m0, s39, 100352
s_mov_b32 s37, 7274496
buffer_load_dwordx4 v21, s[8:11], s37 offen sc1 lds
s_add_u32 m0, s39, 101376
s_mov_b32 s37, 7290880
buffer_load_dwordx4 v21, s[8:11], s37 offen sc1 lds
s_add_u32 m0, s39, 102400
s_mov_b32 s37, 7208960
buffer_load_dwordx4 v21, s[8:11], s37 offen sc1 lds
s_add_u32 m0, s39, 103424
s_mov_b32 s37, 7307264
buffer_load_dwordx4 v21, s[8:11], s37 offen sc1 lds
s_add_u32 m0, s39, 104448
s_mov_b32 s37, 7225344
buffer_load_dwordx4 v21, s[8:11], s37 offen sc1 lds
s_add_u32 m0, s39, 105472
s_mov_b32 s37, 7323648
buffer_load_dwordx4 v21, s[8:11], s37 offen sc1 lds
s_waitcnt vmcnt(16)
s_barrier
s_add_u32 m0, s39, 0
s_mov_b32 s37, 4587520
buffer_load_dwordx4 v21, s[8:11], s37 offen sc1 lds
s_add_u32 m0, s39, 1024
s_mov_b32 s37, 4603904
buffer_load_dwordx4 v21, s[8:11], s37 offen sc1 lds
s_add_u32 m0, s39, 2048
s_mov_b32 s37, 4620288
buffer_load_dwordx4 v21, s[8:11], s37 offen sc1 lds
s_add_u32 m0, s39, 3072
s_mov_b32 s37, 4636672
buffer_load_dwordx4 v21, s[8:11], s37 offen sc1 lds
s_add_u32 m0, s39, 4096
s_mov_b32 s37, 4685824
buffer_load_dwordx4 v21, s[8:11], s37 offen sc1 lds
s_add_u32 m0, s39, 5120
s_mov_b32 s37, 4702208
buffer_load_dwordx4 v21, s[8:11], s37 offen sc1 lds
s_add_u32 m0, s39, 6144
s_mov_b32 s37, 4718592
buffer_load_dwordx4 v21, s[8:11], s37 offen sc1 lds
s_add_u32 m0, s39, 7168
s_mov_b32 s37, 4734976
buffer_load_dwordx4 v21, s[8:11], s37 offen sc1 lds
s_waitcnt vmcnt(16)
s_barrier
s_add_u32 m0, s39, 32768
s_mov_b32 s37, 4653056
buffer_load_dwordx4 v21, s[8:11], s37 offen sc1 lds
s_add_u32 m0, s39, 33792
s_mov_b32 s37, 4751360
buffer_load_dwordx4 v21, s[8:11], s37 offen sc1 lds
s_add_u32 m0, s39, 34816
s_mov_b32 s37, 4669440
buffer_load_dwordx4 v21, s[8:11], s37 offen sc1 lds
s_add_u32 m0, s39, 35840
s_mov_b32 s37, 4767744
buffer_load_dwordx4 v21, s[8:11], s37 offen sc1 lds
s_add_u32 m0, s39, 36864
s_mov_b32 s37, 5570560
buffer_load_dwordx4 v21, s[8:11], s37 offen sc1 lds
s_add_u32 m0, s39, 37888
s_mov_b32 s37, 5586944
buffer_load_dwordx4 v21, s[8:11], s37 offen sc1 lds
s_add_u32 m0, s39, 38912
s_mov_b32 s37, 5603328
buffer_load_dwordx4 v21, s[8:11], s37 offen sc1 lds
s_add_u32 m0, s39, 39936
s_mov_b32 s37, 5619712
buffer_load_dwordx4 v21, s[8:11], s37 offen sc1 lds
s_waitcnt vmcnt(16)
s_barrier
s_add_u32 m0, s39, 65536
s_mov_b32 s37, 5668864
buffer_load_dwordx4 v21, s[8:11], s37 offen sc1 lds
s_add_u32 m0, s39, 66560
s_mov_b32 s37, 5685248
buffer_load_dwordx4 v21, s[8:11], s37 offen sc1 lds
s_add_u32 m0, s39, 67584
s_mov_b32 s37, 5701632
buffer_load_dwordx4 v21, s[8:11], s37 offen sc1 lds
s_add_u32 m0, s39, 68608
s_mov_b32 s37, 5718016
buffer_load_dwordx4 v21, s[8:11], s37 offen sc1 lds
s_add_u32 m0, s39, 69632
s_mov_b32 s37, 5636096
buffer_load_dwordx4 v21, s[8:11], s37 offen sc1 lds
s_add_u32 m0, s39, 70656
s_mov_b32 s37, 5734400
buffer_load_dwordx4 v21, s[8:11], s37 offen sc1 lds
s_add_u32 m0, s39, 71680
s_mov_b32 s37, 5652480
buffer_load_dwordx4 v21, s[8:11], s37 offen sc1 lds
s_add_u32 m0, s39, 72704
s_mov_b32 s37, 5750784
buffer_load_dwordx4 v21, s[8:11], s37 offen sc1 lds
s_waitcnt vmcnt(16)
s_barrier
s_add_u32 m0, s39, 98304
s_mov_b32 s37, 6553600
buffer_load_dwordx4 v21, s[8:11], s37 offen sc1 lds
s_add_u32 m0, s39, 99328
s_mov_b32 s37, 6569984
buffer_load_dwordx4 v21, s[8:11], s37 offen sc1 lds
s_add_u32 m0, s39, 100352
s_mov_b32 s37, 6586368
buffer_load_dwordx4 v21, s[8:11], s37 offen sc1 lds
s_add_u32 m0, s39, 101376
s_mov_b32 s37, 6602752
buffer_load_dwordx4 v21, s[8:11], s37 offen sc1 lds
s_add_u32 m0, s39, 102400
s_mov_b32 s37, 6651904
buffer_load_dwordx4 v21, s[8:11], s37 offen sc1 lds
s_add_u32 m0, s39, 103424
s_mov_b32 s37, 6668288
buffer_load_dwordx4 v21, s[8:11], s37 offen sc1 lds
s_add_u32 m0, s39, 104448
s_mov_b32 s37, 6684672
buffer_load_dwordx4 v21, s[8:11], s37 offen sc1 lds
s_add_u32 m0, s39, 105472
s_mov_b32 s37, 6701056
buffer_load_dwordx4 v21, s[8:11], s37 offen sc1 lds
s_waitcnt vmcnt(16)
s_barrier
s_add_u32 m0, s39, 0
s_mov_b32 s37, 6619136
buffer_load_dwordx4 v21, s[8:11], s37 offen sc1 lds
s_add_u32 m0, s39, 1024
s_mov_b32 s37, 6717440
buffer_load_dwordx4 v21, s[8:11], s37 offen sc1 lds
s_add_u32 m0, s39, 2048
s_mov_b32 s37, 6635520
buffer_load_dwordx4 v21, s[8:11], s37 offen sc1 lds
s_add_u32 m0, s39, 3072
s_mov_b32 s37, 6733824
buffer_load_dwordx4 v21, s[8:11], s37 offen sc1 lds
s_add_u32 m0, s39, 4096
s_mov_b32 s37, 6750208
buffer_load_dwordx4 v21, s[8:11], s37 offen sc1 lds
s_add_u32 m0, s39, 5120
s_mov_b32 s37, 6766592
buffer_load_dwordx4 v21, s[8:11], s37 offen sc1 lds
s_add_u32 m0, s39, 6144
s_mov_b32 s37, 6782976
buffer_load_dwordx4 v21, s[8:11], s37 offen sc1 lds
s_add_u32 m0, s39, 7168
s_mov_b32 s37, 6799360
buffer_load_dwordx4 v21, s[8:11], s37 offen sc1 lds
s_waitcnt vmcnt(16)
s_barrier
s_add_u32 m0, s39, 32768
s_mov_b32 s37, 6848512
buffer_load_dwordx4 v21, s[8:11], s37 offen sc1 lds
s_add_u32 m0, s39, 33792
s_mov_b32 s37, 6864896
buffer_load_dwordx4 v21, s[8:11], s37 offen sc1 lds
s_add_u32 m0, s39, 34816
s_mov_b32 s37, 6881280
buffer_load_dwordx4 v21, s[8:11], s37 offen sc1 lds
s_add_u32 m0, s39, 35840
s_mov_b32 s37, 6897664
buffer_load_dwordx4 v21, s[8:11], s37 offen sc1 lds
s_add_u32 m0, s39, 36864
s_mov_b32 s37, 6815744
buffer_load_dwordx4 v21, s[8:11], s37 offen sc1 lds
s_add_u32 m0, s39, 37888
s_mov_b32 s37, 6914048
buffer_load_dwordx4 v21, s[8:11], s37 offen sc1 lds
s_add_u32 m0, s39, 38912
s_mov_b32 s37, 6832128
buffer_load_dwordx4 v21, s[8:11], s37 offen sc1 lds
s_add_u32 m0, s39, 39936
s_mov_b32 s37, 6930432
buffer_load_dwordx4 v21, s[8:11], s37 offen sc1 lds
s_waitcnt vmcnt(16)
s_barrier
s_waitcnt vmcnt(8)
s_barrier
s_waitcnt vmcnt(0)
s_barrier
s_branch Ldone_1
.p2align 6
Lw_96:
s_branch Lr_97
s_nop 0
.p2align 3
L7b_121:
v_mfma_f32_16x16x32_bf16 v[128:131], v[96:99], v[80:83], v[128:131]
v_mfma_f32_16x16x32_bf16 v[132:135], v[96:99], v[84:87], v[132:135]
v_mfma_f32_16x16x32_bf16 v[136:139], v[96:99], v[88:91], v[136:139]
v_mfma_f32_16x16x32_bf16 v[140:143], v[96:99], v[92:95], v[140:143]
v_mfma_f32_16x16x32_bf16 v[188:191], v[108:111], v[92:95], v[188:191]
v_mfma_f32_16x16x32_bf16 v[184:187], v[108:111], v[88:91], v[184:187]
v_mfma_f32_16x16x32_bf16 v[180:183], v[108:111], v[84:87], v[180:183]
v_mfma_f32_16x16x32_bf16 v[176:179], v[108:111], v[80:83], v[176:179]
v_mfma_f32_16x16x32_bf16 v[144:147], v[100:103], v[80:83], v[144:147]
v_mfma_f32_16x16x32_bf16 v[148:151], v[100:103], v[84:87], v[148:151]
v_mfma_f32_16x16x32_bf16 v[152:155], v[100:103], v[88:91], v[152:155]
v_mfma_f32_16x16x32_bf16 v[156:159], v[100:103], v[92:95], v[156:159]
v_mfma_f32_16x16x32_bf16 v[204:207], v[112:115], v[92:95], v[204:207]
v_mfma_f32_16x16x32_bf16 v[200:203], v[112:115], v[88:91], v[200:203]
v_mfma_f32_16x16x32_bf16 v[196:199], v[112:115], v[84:87], v[196:199]
v_mfma_f32_16x16x32_bf16 v[192:195], v[112:115], v[80:83], v[192:195]
v_mfma_f32_16x16x32_bf16 v[160:163], v[104:107], v[80:83], v[160:163]
v_mfma_f32_16x16x32_bf16 v[164:167], v[104:107], v[84:87], v[164:167]
v_mfma_f32_16x16x32_bf16 v[168:171], v[104:107], v[88:91], v[168:171]
v_mfma_f32_16x16x32_bf16 v[172:175], v[104:107], v[92:95], v[172:175]
v_mfma_f32_16x16x32_bf16 v[220:223], v[116:119], v[92:95], v[220:223]
v_mfma_f32_16x16x32_bf16 v[216:219], v[116:119], v[88:91], v[216:219]
v_mfma_f32_16x16x32_bf16 v[212:215], v[116:119], v[84:87], v[212:215]
v_mfma_f32_16x16x32_bf16 v[208:211], v[116:119], v[80:83], v[208:211]
s_mul_i32 s43, s38, 32
s_add_u32 s37, s37, s43
s_setprio 0
s_barrier
s_mov_b32 s80, s60
s_mov_b32 s81, s61
s_mov_b32 s82, 7340032
s_mov_b32 s83, 0x20000
v_and_b32 v29, 31, v1
v_lshlrev_b32 v29, 11, v29
s_and_b32 s43, s35, 8
s_or_b32 s43, s43, 3
s_lshl_b32 s43, s43, 7
v_add_u32 v29, s43, v29
s_add_u32 s37, s37, s54
s_add_u32 m0, s39, 65536
s_add_u32 s37, s37, s40
buffer_load_dwordx4 v21, s[8:11], s37 offen sc1 lds
v_mul_f32 v80, v128, v128
v_mul_f32 v81, v129, v129
v_mul_f32 v82, v130, v130
v_mul_f32 v83, v131, v131
v_fma_f32 v80, v80, v232, v228
v_fma_f32 v81, v81, v232, v228
v_fma_f32 v82, v82, v232, v228
s_add_u32 m0, s39, 66560
s_add_u32 s37, s37, s38
buffer_load_dwordx4 v21, s[8:11], s37 offen sc1 lds
v_fma_f32 v83, v83, v232, v228
v_mul_f32 v80, v80, v128
v_mul_f32 v81, v81, v129
v_mul_f32 v82, v82, v130
v_mul_f32 v83, v83, v131
v_exp_f32 v80, v80
s_add_u32 m0, s39, 67584
s_add_u32 s37, s37, s38
buffer_load_dwordx4 v21, s[8:11], s37 offen sc1 lds
v_exp_f32 v81, v81
v_exp_f32 v82, v82
v_exp_f32 v83, v83
v_mul_f32 v176, v128, v176
v_mul_f32 v177, v129, v177
v_mul_f32 v178, v130, v178
v_mul_f32 v179, v131, v179
s_add_u32 m0, s39, 68608
s_add_u32 s37, s37, s38
buffer_load_dwordx4 v21, s[8:11], s37 offen sc1 lds
v_fma_f32 v80, v80, v236, v236
v_fma_f32 v81, v81, v236, v236
v_fma_f32 v82, v82, v236, v236
v_fma_f32 v83, v83, v236, v236
v_rcp_f32 v80, v80
v_rcp_f32 v81, v81
s_add_u32 m0, s39, 69632
s_add_u32 s37, s37, s55
buffer_load_dwordx4 v21, s[8:11], s37 offen sc1 lds
v_rcp_f32 v82, v82
v_rcp_f32 v83, v83
v_mul_f32 v176, v176, v80
v_mul_f32 v177, v177, v81
v_mul_f32 v178, v178, v82
v_mul_f32 v179, v179, v83
v_cvt_pk_bf16_f32 v96, v176, v177
s_add_u32 m0, s39, 70656
s_add_u32 s37, s37, s38
buffer_load_dwordx4 v21, s[8:11], s37 offen sc1 lds
v_cvt_pk_bf16_f32 v97, v178, v179
v_mul_f32 v84, v144, v144
v_mul_f32 v85, v145, v145
v_mul_f32 v86, v146, v146
v_mul_f32 v87, v147, v147
v_fma_f32 v84, v84, v232, v228
s_add_u32 m0, s39, 71680
s_add_u32 s37, s37, s38
buffer_load_dwordx4 v21, s[8:11], s37 offen sc1 lds
v_fma_f32 v85, v85, v232, v228
v_fma_f32 v86, v86, v232, v228
v_fma_f32 v87, v87, v232, v228
v_mul_f32 v84, v84, v144
v_mul_f32 v85, v85, v145
v_mul_f32 v86, v86, v146
v_mul_f32 v87, v87, v147
s_add_u32 m0, s39, 72704
s_add_u32 s37, s37, s38
buffer_load_dwordx4 v21, s[8:11], s37 offen sc1 lds
v_exp_f32 v84, v84
v_exp_f32 v85, v85
v_exp_f32 v86, v86
v_exp_f32 v87, v87
v_mul_f32 v192, v144, v192
v_mul_f32 v193, v145, v193
s_barrier
s_lshr_b32 s44, s2, 3
s_lshl_b32 s44, s44, 17
s_add_u32 s43, s44, 65536
buffer_load_dword v30, v29, s[80:83], s43 offen
s_add_u32 m0, s39, 98304
s_add_u32 s37, s37, s40
buffer_load_dwordx4 v21, s[8:11], s37 offen sc1 lds
v_mul_f32 v194, v146, v194
v_mul_f32 v195, v147, v195
v_fma_f32 v84, v84, v236, v236
v_fma_f32 v85, v85, v236, v236
v_fma_f32 v86, v86, v236, v236
v_fma_f32 v87, v87, v236, v236
v_rcp_f32 v84, v84
s_add_u32 m0, s39, 99328
s_add_u32 s37, s37, s38
buffer_load_dwordx4 v21, s[8:11], s37 offen sc1 lds
v_rcp_f32 v85, v85
v_rcp_f32 v86, v86
v_rcp_f32 v87, v87
v_mul_f32 v192, v192, v84
v_mul_f32 v193, v193, v85
v_mul_f32 v194, v194, v86
v_mul_f32 v195, v195, v87
s_add_u32 m0, s39, 100352
s_add_u32 s37, s37, s38
buffer_load_dwordx4 v21, s[8:11], s37 offen sc1 lds
v_cvt_pk_bf16_f32 v98, v192, v193
v_cvt_pk_bf16_f32 v99, v194, v195
v_mul_f32 v80, v160, v160
v_mul_f32 v81, v161, v161
v_mul_f32 v82, v162, v162
s_add_u32 m0, s39, 101376
s_add_u32 s37, s37, s38
buffer_load_dwordx4 v21, s[8:11], s37 offen sc1 lds
v_mul_f32 v83, v163, v163
v_fma_f32 v80, v80, v232, v228
v_fma_f32 v81, v81, v232, v228
v_fma_f32 v82, v82, v232, v228
v_fma_f32 v83, v83, v232, v228
v_mul_f32 v80, v80, v160
v_mul_f32 v81, v81, v161
s_add_u32 m0, s39, 102400
s_add_u32 s37, s37, s55
buffer_load_dwordx4 v21, s[8:11], s37 offen sc1 lds
v_mul_f32 v82, v82, v162
v_mul_f32 v83, v83, v163
v_exp_f32 v80, v80
v_exp_f32 v81, v81
v_exp_f32 v82, v82
v_exp_f32 v83, v83
v_mul_f32 v208, v160, v208
s_add_u32 m0, s39, 103424
s_add_u32 s37, s37, s38
buffer_load_dwordx4 v21, s[8:11], s37 offen sc1 lds
v_mul_f32 v209, v161, v209
v_mul_f32 v210, v162, v210
v_mul_f32 v211, v163, v211
v_fma_f32 v80, v80, v236, v236
v_fma_f32 v81, v81, v236, v236
v_fma_f32 v82, v82, v236, v236
s_add_u32 m0, s39, 104448
s_add_u32 s37, s37, s38
buffer_load_dwordx4 v21, s[8:11], s37 offen sc1 lds
v_fma_f32 v83, v83, v236, v236
v_rcp_f32 v80, v80
v_rcp_f32 v81, v81
v_rcp_f32 v82, v82
v_rcp_f32 v83, v83
v_mul_f32 v208, v208, v80
v_mul_f32 v209, v209, v81
s_add_u32 m0, s39, 105472
s_add_u32 s37, s37, s38
buffer_load_dwordx4 v21, s[8:11], s37 offen sc1 lds
v_mul_f32 v210, v210, v82
v_mul_f32 v211, v211, v83
v_cvt_pk_bf16_f32 v112, v208, v209
v_cvt_pk_bf16_f32 v113, v210, v211
v_mul_f32 v80, v132, v132
v_mul_f32 v81, v133, v133
buffer_store_dwordx4 v[96:99], v27, s[24:27], 0 offen offset:0 sc1
s_barrier
s_add_u32 m0, s39, 0
s_add_u32 s37, s37, s40
buffer_load_dwordx4 v21, s[8:11], s37 offen sc1 lds
v_mul_f32 v82, v134, v134
v_mul_f32 v83, v135, v135
v_fma_f32 v80, v80, v233, v229
v_fma_f32 v81, v81, v233, v229
v_fma_f32 v82, v82, v233, v229
v_fma_f32 v83, v83, v233, v229
v_mul_f32 v80, v80, v132
s_add_u32 m0, s39, 1024
s_add_u32 s37, s37, s38
buffer_load_dwordx4 v21, s[8:11], s37 offen sc1 lds
v_mul_f32 v81, v81, v133
v_mul_f32 v82, v82, v134
v_mul_f32 v83, v83, v135
v_exp_f32 v80, v80
v_exp_f32 v81, v81
v_exp_f32 v82, v82
s_add_u32 m0, s39, 2048
s_add_u32 s37, s37, s38
buffer_load_dwordx4 v21, s[8:11], s37 offen sc1 lds
v_exp_f32 v83, v83
v_mul_f32 v180, v132, v180
v_mul_f32 v181, v133, v181
v_mul_f32 v182, v134, v182
v_mul_f32 v183, v135, v183
v_fma_f32 v80, v80, v237, v237
v_fma_f32 v81, v81, v237, v237
s_add_u32 m0, s39, 3072
s_add_u32 s37, s37, s38
buffer_load_dwordx4 v21, s[8:11], s37 offen sc1 lds
v_fma_f32 v82, v82, v237, v237
v_fma_f32 v83, v83, v237, v237
v_rcp_f32 v80, v80
v_rcp_f32 v81, v81
v_rcp_f32 v82, v82
v_rcp_f32 v83, v83
s_add_u32 m0, s39, 4096
s_add_u32 s37, s37, s55
buffer_load_dwordx4 v21, s[8:11], s37 offen sc1 lds
v_mul_f32 v180, v180, v80
v_mul_f32 v181, v181, v81
v_mul_f32 v182, v182, v82
v_mul_f32 v183, v183, v83
v_cvt_pk_bf16_f32 v100, v180, v181
v_cvt_pk_bf16_f32 v101, v182, v183
v_mul_f32 v84, v148, v148
s_add_u32 m0, s39, 5120
s_add_u32 s37, s37, s38
buffer_load_dwordx4 v21, s[8:11], s37 offen sc1 lds
v_mul_f32 v85, v149, v149
v_mul_f32 v86, v150, v150
v_mul_f32 v87, v151, v151
v_fma_f32 v84, v84, v233, v229
v_fma_f32 v85, v85, v233, v229
v_fma_f32 v86, v86, v233, v229
s_add_u32 m0, s39, 6144
s_add_u32 s37, s37, s38
buffer_load_dwordx4 v21, s[8:11], s37 offen sc1 lds
v_fma_f32 v87, v87, v233, v229
v_mul_f32 v84, v84, v148
v_mul_f32 v85, v85, v149
v_mul_f32 v86, v86, v150
v_mul_f32 v87, v87, v151
v_exp_f32 v84, v84
v_exp_f32 v85, v85
s_add_u32 m0, s39, 7168
s_add_u32 s37, s37, s38
buffer_load_dwordx4 v21, s[8:11], s37 offen sc1 lds
v_exp_f32 v86, v86
v_exp_f32 v87, v87
v_mul_f32 v196, v148, v196
v_mul_f32 v197, v149, v197
v_mul_f32 v198, v150, v198
v_mul_f32 v199, v151, v199
s_waitcnt vmcnt(18)
s_barrier
s_add_u32 s43, s34, 48
s_lshl_b32 s43, s43, 7
v_mov_b32 v10, s43
v_mov_b32 v12, 16
buffer_load_dword v11, v10, s[56:59], 0 offen sc1
s_add_u32 m0, s39, 32768
s_add_u32 s37, s37, s40
buffer_load_dwordx4 v21, s[8:11], s37 offen sc1 lds
v_fma_f32 v84, v84, v237, v237
v_fma_f32 v85, v85, v237, v237
v_fma_f32 v86, v86, v237, v237
v_fma_f32 v87, v87, v237, v237
v_rcp_f32 v84, v84
v_rcp_f32 v85, v85
v_rcp_f32 v86, v86
s_add_u32 m0, s39, 33792
s_add_u32 s37, s37, s38
buffer_load_dwordx4 v21, s[8:11], s37 offen sc1 lds
v_rcp_f32 v87, v87
v_mul_f32 v196, v196, v84
v_mul_f32 v197, v197, v85
v_mul_f32 v198, v198, v86
v_mul_f32 v199, v199, v87
v_cvt_pk_bf16_f32 v102, v196, v197
v_cvt_pk_bf16_f32 v103, v198, v199
s_add_u32 m0, s39, 34816
s_add_u32 s37, s37, s38
buffer_load_dwordx4 v21, s[8:11], s37 offen sc1 lds
v_mul_f32 v80, v164, v164
v_mul_f32 v81, v165, v165
v_mul_f32 v82, v166, v166
v_mul_f32 v83, v167, v167
v_fma_f32 v80, v80, v233, v229
s_add_u32 m0, s39, 35840
s_add_u32 s37, s37, s38
buffer_load_dwordx4 v21, s[8:11], s37 offen sc1 lds
v_fma_f32 v81, v81, v233, v229
v_fma_f32 v82, v82, v233, v229
v_fma_f32 v83, v83, v233, v229
v_mul_f32 v80, v80, v164
v_mul_f32 v81, v81, v165
v_mul_f32 v82, v82, v166
v_mul_f32 v83, v83, v167
s_add_u32 m0, s39, 36864
s_add_u32 s37, s37, s55
buffer_load_dwordx4 v21, s[8:11], s37 offen sc1 lds
v_exp_f32 v80, v80
v_exp_f32 v81, v81
v_exp_f32 v82, v82
v_exp_f32 v83, v83
v_mul_f32 v212, v164, v212
v_mul_f32 v213, v165, v213
v_mul_f32 v214, v166, v214
s_add_u32 m0, s39, 37888
s_add_u32 s37, s37, s38
buffer_load_dwordx4 v21, s[8:11], s37 offen sc1 lds
v_mul_f32 v215, v167, v215
v_fma_f32 v80, v80, v237, v237
v_fma_f32 v81, v81, v237, v237
v_fma_f32 v82, v82, v237, v237
v_fma_f32 v83, v83, v237, v237
v_rcp_f32 v80, v80
s_add_u32 m0, s39, 38912
s_add_u32 s37, s37, s38
buffer_load_dwordx4 v21, s[8:11], s37 offen sc1 lds
v_rcp_f32 v81, v81
v_rcp_f32 v82, v82
v_rcp_f32 v83, v83
v_mul_f32 v212, v212, v80
v_mul_f32 v213, v213, v81
v_mul_f32 v214, v214, v82
v_mul_f32 v215, v215, v83
s_add_u32 m0, s39, 39936
s_add_u32 s37, s37, s38
buffer_load_dwordx4 v21, s[8:11], s37 offen sc1 lds
v_cvt_pk_bf16_f32 v114, v212, v213
v_cvt_pk_bf16_f32 v115, v214, v215
s_nop 1
v_permlane32_swap_b32 v112, v114
v_permlane32_swap_b32 v113, v115
buffer_store_dwordx4 v[100:103], v27, s[24:27], 0 offen offset:256 sc1
buffer_store_dwordx4 v[112:115], v28, s[24:27], 0 offen offset:0 sc1
s_waitcnt vmcnt(20)
s_barrier
s_add_u32 m0, s39, 65536
s_add_u32 s37, s37, s40
buffer_load_dwordx4 v21, s[8:11], s37 offen sc1 lds
v_mul_f32 v80, v136, v136
v_mul_f32 v81, v137, v137
v_mul_f32 v82, v138, v138
v_mul_f32 v83, v139, v139
v_fma_f32 v80, v80, v234, v230
v_fma_f32 v81, v81, v234, v230
v_fma_f32 v82, v82, v234, v230
s_add_u32 m0, s39, 66560
s_add_u32 s37, s37, s38
buffer_load_dwordx4 v21, s[8:11], s37 offen sc1 lds
v_fma_f32 v83, v83, v234, v230
v_mul_f32 v80, v80, v136
v_mul_f32 v81, v81, v137
v_mul_f32 v82, v82, v138
v_mul_f32 v83, v83, v139
v_exp_f32 v80, v80
s_add_u32 m0, s39, 67584
s_add_u32 s37, s37, s38
buffer_load_dwordx4 v21, s[8:11], s37 offen sc1 lds
v_exp_f32 v81, v81
v_exp_f32 v82, v82
v_exp_f32 v83, v83
v_mul_f32 v184, v136, v184
v_mul_f32 v185, v137, v185
v_mul_f32 v186, v138, v186
v_mul_f32 v187, v139, v187
s_add_u32 m0, s39, 68608
s_add_u32 s37, s37, s38
buffer_load_dwordx4 v21, s[8:11], s37 offen sc1 lds
v_fma_f32 v80, v80, v238, v238
v_fma_f32 v81, v81, v238, v238
v_fma_f32 v82, v82, v238, v238
v_fma_f32 v83, v83, v238, v238
v_rcp_f32 v80, v80
v_rcp_f32 v81, v81
s_add_u32 m0, s39, 69632
s_add_u32 s37, s37, s55
buffer_load_dwordx4 v21, s[8:11], s37 offen sc1 lds
v_rcp_f32 v82, v82
v_rcp_f32 v83, v83
v_mul_f32 v184, v184, v80
v_mul_f32 v185, v185, v81
v_mul_f32 v186, v186, v82
v_mul_f32 v187, v187, v83
v_cvt_pk_bf16_f32 v104, v184, v185
s_add_u32 m0, s39, 70656
s_add_u32 s37, s37, s38
buffer_load_dwordx4 v21, s[8:11], s37 offen sc1 lds
v_cvt_pk_bf16_f32 v105, v186, v187
v_mul_f32 v84, v152, v152
v_mul_f32 v85, v153, v153
v_mul_f32 v86, v154, v154
v_mul_f32 v87, v155, v155
v_fma_f32 v84, v84, v234, v230
s_add_u32 m0, s39, 71680
s_add_u32 s37, s37, s38
buffer_load_dwordx4 v21, s[8:11], s37 offen sc1 lds
v_fma_f32 v85, v85, v234, v230
v_fma_f32 v86, v86, v234, v230
v_fma_f32 v87, v87, v234, v230
v_mul_f32 v84, v84, v152
v_mul_f32 v85, v85, v153
v_mul_f32 v86, v86, v154
v_mul_f32 v87, v87, v155
s_add_u32 m0, s39, 72704
s_add_u32 s37, s37, s38
buffer_load_dwordx4 v21, s[8:11], s37 offen sc1 lds
v_exp_f32 v84, v84
v_exp_f32 v85, v85
v_exp_f32 v86, v86
v_exp_f32 v87, v87
v_mul_f32 v200, v152, v200
v_mul_f32 v201, v153, v201
s_waitcnt vmcnt(19)
s_barrier
s_add_u32 m0, s39, 98304
s_add_u32 s37, s37, s40
buffer_load_dwordx4 v21, s[8:11], s37 offen sc1 lds
v_mul_f32 v202, v154, v202
v_mul_f32 v203, v155, v203
v_fma_f32 v84, v84, v238, v238
v_fma_f32 v85, v85, v238, v238
v_fma_f32 v86, v86, v238, v238
v_fma_f32 v87, v87, v238, v238
v_rcp_f32 v84, v84
s_add_u32 m0, s39, 99328
s_add_u32 s37, s37, s38
buffer_load_dwordx4 v21, s[8:11], s37 offen sc1 lds
v_rcp_f32 v85, v85
v_rcp_f32 v86, v86
v_rcp_f32 v87, v87
v_mul_f32 v200, v200, v84
v_mul_f32 v201, v201, v85
v_mul_f32 v202, v202, v86
v_mul_f32 v203, v203, v87
s_add_u32 m0, s39, 100352
s_add_u32 s37, s37, s38
buffer_load_dwordx4 v21, s[8:11], s37 offen sc1 lds
v_cvt_pk_bf16_f32 v106, v200, v201
v_cvt_pk_bf16_f32 v107, v202, v203
v_mul_f32 v80, v168, v168
v_mul_f32 v81, v169, v169
v_mul_f32 v82, v170, v170
s_add_u32 m0, s39, 101376
s_add_u32 s37, s37, s38
buffer_load_dwordx4 v21, s[8:11], s37 offen sc1 lds
v_mul_f32 v83, v171, v171
v_fma_f32 v80, v80, v234, v230
v_fma_f32 v81, v81, v234, v230
v_fma_f32 v82, v82, v234, v230
v_fma_f32 v83, v83, v234, v230
v_mul_f32 v80, v80, v168
v_mul_f32 v81, v81, v169
s_add_u32 m0, s39, 102400
s_add_u32 s37, s37, s55
buffer_load_dwordx4 v21, s[8:11], s37 offen sc1 lds
v_mul_f32 v82, v82, v170
v_mul_f32 v83, v83, v171
v_exp_f32 v80, v80
v_exp_f32 v81, v81
v_exp_f32 v82, v82
v_exp_f32 v83, v83
v_mul_f32 v216, v168, v216
s_add_u32 m0, s39, 103424
s_add_u32 s37, s37, s38
buffer_load_dwordx4 v21, s[8:11], s37 offen sc1 lds
v_mul_f32 v217, v169, v217
v_mul_f32 v218, v170, v218
v_mul_f32 v219, v171, v219
v_fma_f32 v80, v80, v238, v238
v_fma_f32 v81, v81, v238, v238
v_fma_f32 v82, v82, v238, v238
s_add_u32 m0, s39, 104448
s_add_u32 s37, s37, s38
buffer_load_dwordx4 v21, s[8:11], s37 offen sc1 lds
v_fma_f32 v83, v83, v238, v238
v_rcp_f32 v80, v80
v_rcp_f32 v81, v81
v_rcp_f32 v82, v82
v_rcp_f32 v83, v83
v_mul_f32 v216, v216, v80
v_mul_f32 v217, v217, v81
s_add_u32 m0, s39, 105472
s_add_u32 s37, s37, s38
buffer_load_dwordx4 v21, s[8:11], s37 offen sc1 lds
v_mul_f32 v218, v218, v82
v_mul_f32 v219, v219, v83
v_cvt_pk_bf16_f32 v116, v216, v217
v_cvt_pk_bf16_f32 v117, v218, v219
v_mul_f32 v80, v140, v140
v_mul_f32 v81, v141, v141
buffer_store_dwordx4 v[104:107], v27, s[24:27], 0 offen offset:512 sc1
s_waitcnt vmcnt(19)
s_mov_b32 s41, 0x10000
s_waitcnt vmcnt(27)
s_branch Lpf_125
Lpoll_123:
s_waitcnt vmcnt(0)
Lpf_125:
v_cmp_ne_u32 vcc, v12, v11
s_nop 4
s_cbranch_vccz Lpok_124
buffer_load_dword v11, v10, s[56:59], 0 offen sc1
s_sub_u32 s41, s41, 1
s_cmp_lg_u32 s41, 0
s_cbranch_scc1 Lpoll_123
s_waitcnt vmcnt(0)
Lpok_124:
s_barrier
s_add_u32 s37, s37, s29
s_add_u32 m0, s39, 0
s_add_u32 s37, s37, s40
buffer_load_dwordx4 v21, s[8:11], s37 offen sc1 lds
v_mul_f32 v82, v142, v142
v_mul_f32 v83, v143, v143
v_fma_f32 v80, v80, v235, v231
v_fma_f32 v81, v81, v235, v231
v_fma_f32 v82, v82, v235, v231
v_fma_f32 v83, v83, v235, v231
v_mul_f32 v80, v80, v140
s_add_u32 m0, s39, 1024
s_add_u32 s37, s37, s38
buffer_load_dwordx4 v21, s[8:11], s37 offen sc1 lds
v_mul_f32 v81, v81, v141
v_mul_f32 v82, v82, v142
v_mul_f32 v83, v83, v143
v_exp_f32 v80, v80
v_exp_f32 v81, v81
v_exp_f32 v82, v82
s_add_u32 m0, s39, 2048
s_add_u32 s37, s37, s38
buffer_load_dwordx4 v21, s[8:11], s37 offen sc1 lds
v_exp_f32 v83, v83
v_mul_f32 v188, v140, v188
v_mul_f32 v189, v141, v189
v_mul_f32 v190, v142, v190
v_mul_f32 v191, v143, v191
v_fma_f32 v80, v80, v239, v239
v_fma_f32 v81, v81, v239, v239
s_add_u32 m0, s39, 3072
s_add_u32 s37, s37, s38
buffer_load_dwordx4 v21, s[8:11], s37 offen sc1 lds
v_fma_f32 v82, v82, v239, v239
v_fma_f32 v83, v83, v239, v239
v_rcp_f32 v80, v80
v_rcp_f32 v81, v81
v_rcp_f32 v82, v82
v_rcp_f32 v83, v83
s_add_u32 m0, s39, 4096
s_add_u32 s37, s37, s55
buffer_load_dwordx4 v21, s[8:11], s37 offen sc1 lds
v_mul_f32 v188, v188, v80
v_mul_f32 v189, v189, v81
v_mul_f32 v190, v190, v82
v_mul_f32 v191, v191, v83
v_cvt_pk_bf16_f32 v108, v188, v189
v_cvt_pk_bf16_f32 v109, v190, v191
v_mul_f32 v84, v156, v156
s_add_u32 m0, s39, 5120
s_add_u32 s37, s37, s38
buffer_load_dwordx4 v21, s[8:11], s37 offen sc1 lds
v_mul_f32 v85, v157, v157
v_mul_f32 v86, v158, v158
v_mul_f32 v87, v159, v159
v_fma_f32 v84, v84, v235, v231
v_fma_f32 v85, v85, v235, v231
v_fma_f32 v86, v86, v235, v231
s_add_u32 m0, s39, 6144
s_add_u32 s37, s37, s38
buffer_load_dwordx4 v21, s[8:11], s37 offen sc1 lds
v_fma_f32 v87, v87, v235, v231
v_mul_f32 v84, v84, v156
v_mul_f32 v85, v85, v157
v_mul_f32 v86, v86, v158
v_mul_f32 v87, v87, v159
v_exp_f32 v84, v84
v_exp_f32 v85, v85
s_add_u32 m0, s39, 7168
s_add_u32 s37, s37, s38
buffer_load_dwordx4 v21, s[8:11], s37 offen sc1 lds
v_exp_f32 v86, v86
v_exp_f32 v87, v87
v_mul_f32 v204, v156, v204
v_mul_f32 v205, v157, v205
v_mul_f32 v206, v158, v206
v_mul_f32 v207, v159, v207
s_waitcnt vmcnt(17)
s_barrier
s_add_u32 m0, s39, 32768
s_add_u32 s37, s37, s40
buffer_load_dwordx4 v21, s[8:11], s37 offen sc1 lds
v_fma_f32 v84, v84, v239, v239
v_fma_f32 v85, v85, v239, v239
v_fma_f32 v86, v86, v239, v239
v_fma_f32 v87, v87, v239, v239
v_rcp_f32 v84, v84
v_rcp_f32 v85, v85
v_rcp_f32 v86, v86
s_add_u32 m0, s39, 33792
s_add_u32 s37, s37, s38
buffer_load_dwordx4 v21, s[8:11], s37 offen sc1 lds
v_rcp_f32 v87, v87
v_mul_f32 v204, v204, v84
v_mul_f32 v205, v205, v85
v_mul_f32 v206, v206, v86
v_mul_f32 v207, v207, v87
v_cvt_pk_bf16_f32 v110, v204, v205
v_cvt_pk_bf16_f32 v111, v206, v207
s_add_u32 m0, s39, 34816
s_add_u32 s37, s37, s38
buffer_load_dwordx4 v21, s[8:11], s37 offen sc1 lds
v_mul_f32 v80, v172, v172
v_mul_f32 v81, v173, v173
v_mul_f32 v82, v174, v174
v_mul_f32 v83, v175, v175
v_fma_f32 v80, v80, v235, v231
s_add_u32 m0, s39, 35840
s_add_u32 s37, s37, s38
buffer_load_dwordx4 v21, s[8:11], s37 offen sc1 lds
v_fma_f32 v81, v81, v235, v231
v_fma_f32 v82, v82, v235, v231
v_fma_f32 v83, v83, v235, v231
v_mul_f32 v80, v80, v172
v_mul_f32 v81, v81, v173
v_mul_f32 v82, v82, v174
v_mul_f32 v83, v83, v175
s_add_u32 m0, s39, 36864
s_add_u32 s37, s37, s55
buffer_load_dwordx4 v21, s[8:11], s37 offen sc1 lds
v_exp_f32 v80, v80
v_exp_f32 v81, v81
v_exp_f32 v82, v82
v_exp_f32 v83, v83
v_mul_f32 v220, v172, v220
v_mul_f32 v221, v173, v221
v_mul_f32 v222, v174, v222
s_add_u32 m0, s39, 37888
s_add_u32 s37, s37, s38
buffer_load_dwordx4 v21, s[8:11], s37 offen sc1 lds
v_mul_f32 v223, v175, v223
v_fma_f32 v80, v80, v239, v239
v_fma_f32 v81, v81, v239, v239
v_fma_f32 v82, v82, v239, v239
v_fma_f32 v83, v83, v239, v239
v_rcp_f32 v80, v80
s_add_u32 m0, s39, 38912
s_add_u32 s37, s37, s38
buffer_load_dwordx4 v21, s[8:11], s37 offen sc1 lds
v_rcp_f32 v81, v81
v_rcp_f32 v82, v82
v_rcp_f32 v83, v83
v_mul_f32 v220, v220, v80
v_mul_f32 v221, v221, v81
v_mul_f32 v222, v222, v82
v_mul_f32 v223, v223, v83
s_add_u32 m0, s39, 39936
s_add_u32 s37, s37, s38
buffer_load_dwordx4 v21, s[8:11], s37 offen sc1 lds
v_cvt_pk_bf16_f32 v118, v220, v221
v_cvt_pk_bf16_f32 v119, v222, v223
s_nop 1
v_permlane32_swap_b32 v116, v118
v_permlane32_swap_b32 v117, v119
buffer_store_dwordx4 v[108:111], v27, s[24:27], 0 offen offset:768 sc1
buffer_store_dwordx4 v[116:119], v28, s[24:27], 0 offen offset:512 sc1
s_waitcnt vmcnt(19)
s_barrier
s_add_u32 m0, s39, 65536
s_add_u32 s37, s37, s40
buffer_load_dwordx4 v21, s[8:11], s37 offen sc1 lds
s_add_u32 m0, s39, 66560
s_add_u32 s37, s37, s38
buffer_load_dwordx4 v21, s[8:11], s37 offen sc1 lds
s_add_u32 m0, s39, 67584
s_add_u32 s37, s37, s38
buffer_load_dwordx4 v21, s[8:11], s37 offen sc1 lds
s_add_u32 m0, s39, 68608
s_add_u32 s37, s37, s38
buffer_load_dwordx4 v21, s[8:11], s37 offen sc1 lds
s_add_u32 m0, s39, 69632
s_add_u32 s37, s37, s55
buffer_load_dwordx4 v21, s[8:11], s37 offen sc1 lds
s_add_u32 m0, s39, 70656
s_add_u32 s37, s37, s38
buffer_load_dwordx4 v21, s[8:11], s37 offen sc1 lds
s_add_u32 m0, s39, 71680
s_add_u32 s37, s37, s38
buffer_load_dwordx4 v21, s[8:11], s37 offen sc1 lds
s_add_u32 m0, s39, 72704
s_add_u32 s37, s37, s38
buffer_load_dwordx4 v21, s[8:11], s37 offen sc1 lds
s_waitcnt vmcnt(8)
s_barrier
s_cmp_ge_u32 s50, 12
s_cselect_b32 s44, 64, 0
s_add_u32 s44, s44, s34
s_add_u32 s43, s44, 64
s_lshl_b32 s43, s43, 7
v_mov_b32 v10, s43
v_mov_b32 v11, 1
s_mov_b64 exec, 1
buffer_atomic_add v11, v10, s[56:59], 0 offen sc1
s_mov_b64 exec, -1
s_add_u32 m0, s39, 98304
s_add_u32 s37, s37, s40
buffer_load_dwordx4 v21, s[8:11], s37 offen sc1 lds
s_add_u32 m0, s39, 99328
s_add_u32 s37, s37, s38
buffer_load_dwordx4 v21, s[8:11], s37 offen sc1 lds
s_add_u32 m0, s39, 100352
s_add_u32 s37, s37, s38
buffer_load_dwordx4 v21, s[8:11], s37 offen sc1 lds
s_add_u32 m0, s39, 101376
s_add_u32 s37, s37, s38
buffer_load_dwordx4 v21, s[8:11], s37 offen sc1 lds
s_add_u32 m0, s39, 102400
s_add_u32 s37, s37, s55
buffer_load_dwordx4 v21, s[8:11], s37 offen sc1 lds
s_add_u32 m0, s39, 103424
s_add_u32 s37, s37, s38
buffer_load_dwordx4 v21, s[8:11], s37 offen sc1 lds
s_add_u32 m0, s39, 104448
s_add_u32 s37, s37, s38
buffer_load_dwordx4 v21, s[8:11], s37 offen sc1 lds
s_add_u32 m0, s39, 105472
s_add_u32 s37, s37, s38
buffer_load_dwordx4 v21, s[8:11], s37 offen sc1 lds
s_waitcnt vmcnt(19)
s_barrier
s_lshr_b32 s44, s2, 3
s_lshl_b32 s44, s44, 16
s_add_u32 s43, s44, 4194304
buffer_load_dword v30, v29, s[80:83], s43 offen
s_add_u32 m0, s39, 0
s_add_u32 s37, s37, s40
buffer_load_dwordx4 v21, s[8:11], s37 offen sc1 lds
s_add_u32 m0, s39, 1024
s_add_u32 s37, s37, s38
buffer_load_dwordx4 v21, s[8:11], s37 offen sc1 lds
s_add_u32 m0, s39, 2048
s_add_u32 s37, s37, s38
buffer_load_dwordx4 v21, s[8:11], s37 offen sc1 lds
s_add_u32 m0, s39, 3072
s_add_u32 s37, s37, s38
buffer_load_dwordx4 v21, s[8:11], s37 offen sc1 lds
s_add_u32 m0, s39, 4096
s_add_u32 s37, s37, s55
buffer_load_dwordx4 v21, s[8:11], s37 offen sc1 lds
s_add_u32 m0, s39, 5120
s_add_u32 s37, s37, s38
buffer_load_dwordx4 v21, s[8:11], s37 offen sc1 lds
s_add_u32 m0, s39, 6144
s_add_u32 s37, s37, s38
buffer_load_dwordx4 v21, s[8:11], s37 offen sc1 lds
s_add_u32 m0, s39, 7168
s_add_u32 s37, s37, s38
buffer_load_dwordx4 v21, s[8:11], s37 offen sc1 lds
s_waitcnt vmcnt(18)
s_barrier
s_add_u32 s43, s34, 64
s_lshl_b32 s43, s43, 7
v_mov_b32 v10, s43
v_mov_b32 v12, 12
buffer_load_dword v11, v10, s[56:59], 0 offen sc1
s_add_u32 m0, s39, 32768
s_add_u32 s37, s37, s40
buffer_load_dwordx4 v21, s[8:11], s37 offen sc1 lds
s_add_u32 m0, s39, 33792
s_add_u32 s37, s37, s38
buffer_load_dwordx4 v21, s[8:11], s37 offen sc1 lds
s_add_u32 m0, s39, 34816
s_add_u32 s37, s37, s38
buffer_load_dwordx4 v21, s[8:11], s37 offen sc1 lds
s_add_u32 m0, s39, 35840
s_add_u32 s37, s37, s38
buffer_load_dwordx4 v21, s[8:11], s37 offen sc1 lds
s_add_u32 m0, s39, 36864
s_add_u32 s37, s37, s55
buffer_load_dwordx4 v21, s[8:11], s37 offen sc1 lds
s_add_u32 m0, s39, 37888
s_add_u32 s37, s37, s38
buffer_load_dwordx4 v21, s[8:11], s37 offen sc1 lds
s_add_u32 m0, s39, 38912
s_add_u32 s37, s37, s38
buffer_load_dwordx4 v21, s[8:11], s37 offen sc1 lds
s_add_u32 m0, s39, 39936
s_add_u32 s37, s37, s38
buffer_load_dwordx4 v21, s[8:11], s37 offen sc1 lds
s_waitcnt vmcnt(18)
s_barrier
s_add_u32 m0, s39, 65536
s_add_u32 s37, s37, s40
buffer_load_dwordx4 v21, s[8:11], s37 offen sc1 lds
s_add_u32 m0, s39, 66560
s_add_u32 s37, s37, s38
buffer_load_dwordx4 v21, s[8:11], s37 offen sc1 lds
s_add_u32 m0, s39, 67584
s_add_u32 s37, s37, s38
buffer_load_dwordx4 v21, s[8:11], s37 offen sc1 lds
s_add_u32 m0, s39, 68608
s_add_u32 s37, s37, s38
buffer_load_dwordx4 v21, s[8:11], s37 offen sc1 lds
s_add_u32 m0, s39, 69632
s_add_u32 s37, s37, s55
buffer_load_dwordx4 v21, s[8:11], s37 offen sc1 lds
s_add_u32 m0, s39, 70656
s_add_u32 s37, s37, s38
buffer_load_dwordx4 v21, s[8:11], s37 offen sc1 lds
s_add_u32 m0, s39, 71680
s_add_u32 s37, s37, s38
buffer_load_dwordx4 v21, s[8:11], s37 offen sc1 lds
s_add_u32 m0, s39, 72704
s_add_u32 s37, s37, s38
buffer_load_dwordx4 v21, s[8:11], s37 offen sc1 lds
s_waitcnt vmcnt(17)
s_barrier
s_branch Lw_126
Lr_127:
s_add_u32 m0, s39, 98304
s_add_u32 s37, s37, s40
buffer_load_dwordx4 v21, s[8:11], s37 offen sc1 lds
s_add_u32 m0, s39, 99328
s_add_u32 s37, s37, s38
buffer_load_dwordx4 v21, s[8:11], s37 offen sc1 lds
s_add_u32 m0, s39, 100352
s_add_u32 s37, s37, s38
buffer_load_dwordx4 v21, s[8:11], s37 offen sc1 lds
s_add_u32 m0, s39, 101376
s_add_u32 s37, s37, s38
buffer_load_dwordx4 v21, s[8:11], s37 offen sc1 lds
s_add_u32 m0, s39, 102400
s_add_u32 s37, s37, s55
buffer_load_dwordx4 v21, s[8:11], s37 offen sc1 lds
s_add_u32 m0, s39, 103424
s_add_u32 s37, s37, s38
buffer_load_dwordx4 v21, s[8:11], s37 offen sc1 lds
s_add_u32 m0, s39, 104448
s_add_u32 s37, s37, s38
buffer_load_dwordx4 v21, s[8:11], s37 offen sc1 lds
s_add_u32 m0, s39, 105472
s_add_u32 s37, s37, s38
buffer_load_dwordx4 v21, s[8:11], s37 offen sc1 lds
s_waitcnt vmcnt(16)
s_mov_b32 s41, 0x10000
s_waitcnt vmcnt(24)
s_branch Lpf_130
Lpoll_128:
s_waitcnt vmcnt(0)
Lpf_130:
v_cmp_ne_u32 vcc, v12, v11
s_nop 4
s_cbranch_vccz Lpok_129
buffer_load_dword v11, v10, s[56:59], 0 offen sc1
s_sub_u32 s41, s41, 1
s_cmp_lg_u32 s41, 0
s_cbranch_scc1 Lpoll_128
s_waitcnt vmcnt(0)
Lpok_129:
s_barrier
s_mul_i32 s40, s53, 983040
s_add_u32 m0, s39, 0
s_add_u32 s37, s40, 4194304
buffer_load_dwordx4 v21, s[8:11], s37 offen sc1 lds
s_add_u32 m0, s39, 1024
s_add_u32 s37, s40, 4210688
buffer_load_dwordx4 v21, s[8:11], s37 offen sc1 lds
s_add_u32 m0, s39, 2048
s_add_u32 s37, s40, 4227072
buffer_load_dwordx4 v21, s[8:11], s37 offen sc1 lds
s_add_u32 m0, s39, 3072
s_add_u32 s37, s40, 4243456
buffer_load_dwordx4 v21, s[8:11], s37 offen sc1 lds
s_add_u32 m0, s39, 4096
s_add_u32 s37, s40, 4292608
buffer_load_dwordx4 v21, s[8:11], s37 offen sc1 lds
s_add_u32 m0, s39, 5120
s_add_u32 s37, s40, 4308992
buffer_load_dwordx4 v21, s[8:11], s37 offen sc1 lds
s_add_u32 m0, s39, 6144
s_add_u32 s37, s40, 4325376
buffer_load_dwordx4 v21, s[8:11], s37 offen sc1 lds
s_add_u32 m0, s39, 7168
s_add_u32 s37, s40, 4341760
buffer_load_dwordx4 v21, s[8:11], s37 offen sc1 lds
s_waitcnt vmcnt(16)
s_barrier
s_add_u32 m0, s39, 32768
s_add_u32 s37, s40, 4259840
buffer_load_dwordx4 v21, s[8:11], s37 offen sc1 lds
s_add_u32 m0, s39, 33792
s_add_u32 s37, s40, 4358144
buffer_load_dwordx4 v21, s[8:11], s37 offen sc1 lds
s_add_u32 m0, s39, 34816
s_add_u32 s37, s40, 4276224
buffer_load_dwordx4 v21, s[8:11], s37 offen sc1 lds
s_add_u32 m0, s39, 35840
s_add_u32 s37, s40, 4374528
buffer_load_dwordx4 v21, s[8:11], s37 offen sc1 lds
s_add_u32 m0, s39, 36864
s_add_u32 s37, s40, 4390912
buffer_load_dwordx4 v21, s[8:11], s37 offen sc1 lds
s_add_u32 m0, s39, 37888
s_add_u32 s37, s40, 4407296
buffer_load_dwordx4 v21, s[8:11], s37 offen sc1 lds
s_add_u32 m0, s39, 38912
s_add_u32 s37, s40, 4423680
buffer_load_dwordx4 v21, s[8:11], s37 offen sc1 lds
s_add_u32 m0, s39, 39936
s_add_u32 s37, s40, 4440064
buffer_load_dwordx4 v21, s[8:11], s37 offen sc1 lds
s_waitcnt vmcnt(16)
s_barrier
s_add_u32 m0, s39, 65536
s_add_u32 s37, s40, 4489216
buffer_load_dwordx4 v21, s[8:11], s37 offen sc1 lds
s_add_u32 m0, s39, 66560
s_add_u32 s37, s40, 4505600
buffer_load_dwordx4 v21, s[8:11], s37 offen sc1 lds
s_add_u32 m0, s39, 67584
s_add_u32 s37, s40, 4521984
buffer_load_dwordx4 v21, s[8:11], s37 offen sc1 lds
s_add_u32 m0, s39, 68608
s_add_u32 s37, s40, 4538368
buffer_load_dwordx4 v21, s[8:11], s37 offen sc1 lds
s_add_u32 m0, s39, 69632
s_add_u32 s37, s40, 4456448
buffer_load_dwordx4 v21, s[8:11], s37 offen sc1 lds
s_add_u32 m0, s39, 70656
s_add_u32 s37, s40, 4554752
buffer_load_dwordx4 v21, s[8:11], s37 offen sc1 lds
s_add_u32 m0, s39, 71680
s_add_u32 s37, s40, 4472832
buffer_load_dwordx4 v21, s[8:11], s37 offen sc1 lds
s_add_u32 m0, s39, 72704
s_add_u32 s37, s40, 4571136
buffer_load_dwordx4 v21, s[8:11], s37 offen sc1 lds
s_waitcnt vmcnt(16)
s_barrier
s_add_u32 m0, s39, 98304
s_add_u32 s37, s40, 4784128
buffer_load_dwordx4 v21, s[8:11], s37 offen sc1 lds
s_add_u32 m0, s39, 99328
s_add_u32 s37, s40, 4800512
buffer_load_dwordx4 v21, s[8:11], s37 offen sc1 lds
s_add_u32 m0, s39, 100352
s_add_u32 s37, s40, 4816896
buffer_load_dwordx4 v21, s[8:11], s37 offen sc1 lds
s_add_u32 m0, s39, 101376
s_add_u32 s37, s40, 4833280
buffer_load_dwordx4 v21, s[8:11], s37 offen sc1 lds
s_add_u32 m0, s39, 102400
s_add_u32 s37, s40, 4882432
buffer_load_dwordx4 v21, s[8:11], s37 offen sc1 lds
s_add_u32 m0, s39, 103424
s_add_u32 s37, s40, 4898816
buffer_load_dwordx4 v21, s[8:11], s37 offen sc1 lds
s_add_u32 m0, s39, 104448
s_add_u32 s37, s40, 4915200
buffer_load_dwordx4 v21, s[8:11], s37 offen sc1 lds
s_add_u32 m0, s39, 105472
s_add_u32 s37, s40, 4931584
buffer_load_dwordx4 v21, s[8:11], s37 offen sc1 lds
s_waitcnt vmcnt(16)
s_barrier
s_lshr_b32 s44, s2, 3
s_and_b32 s44, s44, 15
s_lshl_b32 s44, s44, 16
s_add_u32 s43, s44, 6291456
buffer_load_dword v30, v29, s[80:83], s43 offen
s_add_u32 m0, s39, 0
s_add_u32 s37, s40, 4849664
buffer_load_dwordx4 v21, s[8:11], s37 offen sc1 lds
s_add_u32 m0, s39, 1024
s_add_u32 s37, s40, 4947968
buffer_load_dwordx4 v21, s[8:11], s37 offen sc1 lds
s_add_u32 m0, s39, 2048
s_add_u32 s37, s40, 4866048
buffer_load_dwordx4 v21, s[8:11], s37 offen sc1 lds
s_add_u32 m0, s39, 3072
s_add_u32 s37, s40, 4964352
buffer_load_dwordx4 v21, s[8:11], s37 offen sc1 lds
s_add_u32 m0, s39, 4096
s_add_u32 s37, s40, 4980736
buffer_load_dwordx4 v21, s[8:11], s37 offen sc1 lds
s_add_u32 m0, s39, 5120
s_add_u32 s37, s40, 4997120
buffer_load_dwordx4 v21, s[8:11], s37 offen sc1 lds
s_add_u32 m0, s39, 6144
s_add_u32 s37, s40, 5013504
buffer_load_dwordx4 v21, s[8:11], s37 offen sc1 lds
s_add_u32 m0, s39, 7168
s_add_u32 s37, s40, 5029888
buffer_load_dwordx4 v21, s[8:11], s37 offen sc1 lds
s_waitcnt vmcnt(17)
s_barrier
s_add_u32 m0, s39, 32768
s_add_u32 s37, s40, 5079040
buffer_load_dwordx4 v21, s[8:11], s37 offen sc1 lds
s_add_u32 m0, s39, 33792
s_add_u32 s37, s40, 5095424
buffer_load_dwordx4 v21, s[8:11], s37 offen sc1 lds
s_add_u32 m0, s39, 34816
s_add_u32 s37, s40, 5111808
buffer_load_dwordx4 v21, s[8:11], s37 offen sc1 lds
s_add_u32 m0, s39, 35840
s_add_u32 s37, s40, 5128192
buffer_load_dwordx4 v21, s[8:11], s37 offen sc1 lds
s_add_u32 m0, s39, 36864
s_add_u32 s37, s40, 5046272
buffer_load_dwordx4 v21, s[8:11], s37 offen sc1 lds
s_add_u32 m0, s39, 37888
s_add_u32 s37, s40, 5144576
buffer_load_dwordx4 v21, s[8:11], s37 offen sc1 lds
s_add_u32 m0, s39, 38912
s_add_u32 s37, s40, 5062656
buffer_load_dwordx4 v21, s[8:11], s37 offen sc1 lds
s_add_u32 m0, s39, 39936
s_add_u32 s37, s40, 5160960
buffer_load_dwordx4 v21, s[8:11], s37 offen sc1 lds
s_waitcnt vmcnt(17)
s_barrier
s_waitcnt vmcnt(8)
s_barrier
s_waitcnt vmcnt(0)
s_barrier
s_barrier
s_add_u32 s43, s34, 128
s_lshl_b32 s43, s43, 7
v_mov_b32 v13, s43
v_mov_b32 v15, 4
buffer_load_dword v14, v13, s[56:59], 0 offen sc1
s_barrier
s_barrier
s_mov_b32 s41, 0x10000
Lpoll_131:
s_waitcnt vmcnt(0)
Lpf_133:
v_cmp_ne_u32 vcc, v15, v14
s_nop 4
s_cbranch_vccz Lpok_132
buffer_load_dword v14, v13, s[56:59], 0 offen sc1
s_sub_u32 s41, s41, 1
s_cmp_lg_u32 s41, 0
s_cbranch_scc1 Lpoll_131
s_waitcnt vmcnt(0)
Lpok_132:
s_barrier
s_barrier
s_lshl_b32 s43, s34, 4
s_add_u32 s43, s43, s35
s_and_b32 s44, s43, 1
s_lshl_b32 s44, s44, 2
s_lshr_b32 s43, s43, 1
s_add_u32 s43, s43, 144
s_lshl_b32 s43, s43, 7
s_add_u32 s43, s43, s44
v_mov_b32 v10, s43
v_mov_b32 v11, 1
s_mov_b64 exec, 1
buffer_store_dword v11, v10, s[56:59], 0 offen sc1
s_mov_b64 exec, -1
s_barrier
s_barrier
s_barrier
s_lshl_b32 s43, s34, 4
s_add_u32 s43, s43, s35
s_xor_b32 s43, s43, 1
s_and_b32 s44, s43, 1
s_lshl_b32 s44, s44, 2
s_lshr_b32 s43, s43, 1
s_add_u32 s43, s43, 144
s_lshl_b32 s43, s43, 7
s_add_u32 s43, s43, s44
v_mov_b32 v10, s43
v_mov_b32 v12, 1
buffer_load_dword v11, v10, s[56:59], 0 offen sc1
s_barrier
s_barrier
s_mov_b32 s41, 0x10000
Lpoll_134:
s_waitcnt vmcnt(0)
Lpf_136:
v_cmp_ne_u32 vcc, v12, v11
s_nop 4
s_cbranch_vccz Lpok_135
buffer_load_dword v11, v10, s[56:59], 0 offen sc1
s_sub_u32 s41, s41, 1
s_cmp_lg_u32 s41, 0
s_cbranch_scc1 Lpoll_134
s_waitcnt vmcnt(0)
Lpok_135:
s_barrier
s_branch Ldone_1
Lxr_7:
v_add_u32 v15, 0, v10
v_xor_b32 v16, 64, v15
ds_read_b128 v[240:243], v15 offset:0
ds_read_b128 v[244:247], v16 offset:0
ds_read_b128 v[248:251], v15 offset:128
ds_read_b128 v[252:255], v16 offset:128
s_branch Lxb_8
Lxr_9:
v_add_u32 v15, 43008, v10
v_xor_b32 v16, 64, v15
ds_read_b128 v[240:243], v15 offset:0
ds_read_b128 v[244:247], v16 offset:0
ds_read_b128 v[248:251], v15 offset:128
ds_read_b128 v[252:255], v16 offset:128
s_branch Lxb_10
Lxr_11:
v_add_u32 v15, 86016, v10
v_xor_b32 v16, 64, v15
ds_read_b128 v[240:243], v15 offset:0
ds_read_b128 v[244:247], v16 offset:0
ds_read_b128 v[248:251], v15 offset:128
ds_read_b128 v[252:255], v16 offset:128
s_branch Lxb_12
Lxr_13:
v_add_u32 v15, 0, v10
v_xor_b32 v16, 64, v15
ds_read_b128 v[240:243], v15 offset:0
ds_read_b128 v[244:247], v16 offset:0
ds_read_b128 v[248:251], v15 offset:128
ds_read_b128 v[252:255], v16 offset:128
s_branch Lxb_14
Lfx_49:
s_add_u32 s44, s35, 1
s_and_b32 s44, s44, 15
s_lshl_b32 s44, s44, 14
s_add_u32 s44, s44, 0
s_mov_b32 s45, 0x20000
Lre_48:
buffer_load_dwordx4 v[32:35], v2, s[12:15], s44 offen offset:0 sc1
buffer_load_dwordx4 v[36:39], v2, s[12:15], s44 offen offset:256 sc1
buffer_load_dwordx4 v[40:43], v2, s[12:15], s44 offen offset:512 sc1
buffer_load_dwordx4 v[44:47], v2, s[12:15], s44 offen offset:768 sc1
s_waitcnt vmcnt(0)
v_max3_u32 v19, v32, v33, v34
v_max3_u32 v19, v19, v35, v36
v_max3_u32 v19, v19, v37, v38
v_max3_u32 v19, v19, v39, v40
v_max3_u32 v19, v19, v41, v42
v_max3_u32 v19, v19, v43, v44
v_max3_u32 v19, v19, v45, v46
v_max_u32 v19, v19, v47
v_cmp_eq_u32 vcc, -1, v19
s_sub_u32 s45, s45, 1
s_cmp_eq_u32 s45, 0
s_cbranch_scc1 Lok_47
s_nop 2
s_cbranch_vccnz Lre_48
s_branch Lok_47
Lfx_52:
s_add_u32 s44, s35, 1
s_and_b32 s44, s44, 15
s_lshl_b32 s44, s44, 14
s_add_u32 s44, s44, 8192
s_mov_b32 s45, 0x20000
Lre_51:
buffer_load_dwordx4 v[80:83], v2, s[12:15], s44 offen offset:0 sc1
buffer_load_dwordx4 v[84:87], v2, s[12:15], s44 offen offset:256 sc1
buffer_load_dwordx4 v[88:91], v2, s[12:15], s44 offen offset:512 sc1
buffer_load_dwordx4 v[92:95], v2, s[12:15], s44 offen offset:768 sc1
s_waitcnt vmcnt(0)
v_max3_u32 v19, v80, v81, v82
v_max3_u32 v19, v19, v83, v84
v_max3_u32 v19, v19, v85, v86
v_max3_u32 v19, v19, v87, v88
v_max3_u32 v19, v19, v89, v90
v_max3_u32 v19, v19, v91, v92
v_max3_u32 v19, v19, v93, v94
v_max_u32 v19, v19, v95
v_cmp_eq_u32 vcc, -1, v19
s_sub_u32 s45, s45, 1
s_cmp_eq_u32 s45, 0
s_cbranch_scc1 Lok_50
s_nop 2
s_cbranch_vccnz Lre_51
s_branch Lok_50
Lfx_55:
s_add_u32 s44, s35, 2
s_and_b32 s44, s44, 15
s_lshl_b32 s44, s44, 14
s_add_u32 s44, s44, 0
s_mov_b32 s45, 0x20000
Lre_54:
buffer_load_dwordx4 v[32:35], v2, s[12:15], s44 offen offset:0 sc1
buffer_load_dwordx4 v[36:39], v2, s[12:15], s44 offen offset:256 sc1
buffer_load_dwordx4 v[40:43], v2, s[12:15], s44 offen offset:512 sc1
buffer_load_dwordx4 v[44:47], v2, s[12:15], s44 offen offset:768 sc1
s_waitcnt vmcnt(0)
v_max3_u32 v19, v32, v33, v34
v_max3_u32 v19, v19, v35, v36
v_max3_u32 v19, v19, v37, v38
v_max3_u32 v19, v19, v39, v40
v_max3_u32 v19, v19, v41, v42
v_max3_u32 v19, v19, v43, v44
v_max3_u32 v19, v19, v45, v46
v_max_u32 v19, v19, v47
v_cmp_eq_u32 vcc, -1, v19
s_sub_u32 s45, s45, 1
s_cmp_eq_u32 s45, 0
s_cbranch_scc1 Lok_53
s_nop 2
s_cbranch_vccnz Lre_54
s_branch Lok_53
Lfx_58:
s_add_u32 s44, s35, 2
s_and_b32 s44, s44, 15
s_lshl_b32 s44, s44, 14
s_add_u32 s44, s44, 8192
s_mov_b32 s45, 0x20000
Lre_57:
buffer_load_dwordx4 v[80:83], v2, s[12:15], s44 offen offset:0 sc1
buffer_load_dwordx4 v[84:87], v2, s[12:15], s44 offen offset:256 sc1
buffer_load_dwordx4 v[88:91], v2, s[12:15], s44 offen offset:512 sc1
buffer_load_dwordx4 v[92:95], v2, s[12:15], s44 offen offset:768 sc1
s_waitcnt vmcnt(0)
v_max3_u32 v19, v80, v81, v82
v_max3_u32 v19, v19, v83, v84
v_max3_u32 v19, v19, v85, v86
v_max3_u32 v19, v19, v87, v88
v_max3_u32 v19, v19, v89, v90
v_max3_u32 v19, v19, v91, v92
v_max3_u32 v19, v19, v93, v94
v_max_u32 v19, v19, v95
v_cmp_eq_u32 vcc, -1, v19
s_sub_u32 s45, s45, 1
s_cmp_eq_u32 s45, 0
s_cbranch_scc1 Lok_56
s_nop 2
s_cbranch_vccnz Lre_57
s_branch Lok_56
Lfx_61:
s_add_u32 s44, s35, 3
s_and_b32 s44, s44, 15
s_lshl_b32 s44, s44, 14
s_add_u32 s44, s44, 0
s_mov_b32 s45, 0x20000
Lre_60:
buffer_load_dwordx4 v[32:35], v2, s[12:15], s44 offen offset:0 sc1
buffer_load_dwordx4 v[36:39], v2, s[12:15], s44 offen offset:256 sc1
buffer_load_dwordx4 v[40:43], v2, s[12:15], s44 offen offset:512 sc1
buffer_load_dwordx4 v[44:47], v2, s[12:15], s44 offen offset:768 sc1
s_waitcnt vmcnt(0)
v_max3_u32 v19, v32, v33, v34
v_max3_u32 v19, v19, v35, v36
v_max3_u32 v19, v19, v37, v38
v_max3_u32 v19, v19, v39, v40
v_max3_u32 v19, v19, v41, v42
v_max3_u32 v19, v19, v43, v44
v_max3_u32 v19, v19, v45, v46
v_max_u32 v19, v19, v47
v_cmp_eq_u32 vcc, -1, v19
s_sub_u32 s45, s45, 1
s_cmp_eq_u32 s45, 0
s_cbranch_scc1 Lok_59
s_nop 2
s_cbranch_vccnz Lre_60
s_branch Lok_59
Lfx_64:
s_add_u32 s44, s35, 3
s_and_b32 s44, s44, 15
s_lshl_b32 s44, s44, 14
s_add_u32 s44, s44, 8192
s_mov_b32 s45, 0x20000
Lre_63:
buffer_load_dwordx4 v[80:83], v2, s[12:15], s44 offen offset:0 sc1
buffer_load_dwordx4 v[84:87], v2, s[12:15], s44 offen offset:256 sc1
buffer_load_dwordx4 v[88:91], v2, s[12:15], s44 offen offset:512 sc1
buffer_load_dwordx4 v[92:95], v2, s[12:15], s44 offen offset:768 sc1
s_waitcnt vmcnt(0)
v_max3_u32 v19, v80, v81, v82
v_max3_u32 v19, v19, v83, v84
v_max3_u32 v19, v19, v85, v86
v_max3_u32 v19, v19, v87, v88
v_max3_u32 v19, v19, v89, v90
v_max3_u32 v19, v19, v91, v92
v_max3_u32 v19, v19, v93, v94
v_max_u32 v19, v19, v95
v_cmp_eq_u32 vcc, -1, v19
s_sub_u32 s45, s45, 1
s_cmp_eq_u32 s45, 0
s_cbranch_scc1 Lok_62
s_nop 2
s_cbranch_vccnz Lre_63
s_branch Lok_62
Lfx_67:
s_add_u32 s44, s35, 4
s_and_b32 s44, s44, 15
s_lshl_b32 s44, s44, 14
s_add_u32 s44, s44, 0
s_mov_b32 s45, 0x20000
Lre_66:
buffer_load_dwordx4 v[32:35], v2, s[12:15], s44 offen offset:0 sc1
buffer_load_dwordx4 v[36:39], v2, s[12:15], s44 offen offset:256 sc1
buffer_load_dwordx4 v[40:43], v2, s[12:15], s44 offen offset:512 sc1
buffer_load_dwordx4 v[44:47], v2, s[12:15], s44 offen offset:768 sc1
s_waitcnt vmcnt(0)
v_max3_u32 v19, v32, v33, v34
v_max3_u32 v19, v19, v35, v36
v_max3_u32 v19, v19, v37, v38
v_max3_u32 v19, v19, v39, v40
v_max3_u32 v19, v19, v41, v42
v_max3_u32 v19, v19, v43, v44
v_max3_u32 v19, v19, v45, v46
v_max_u32 v19, v19, v47
v_cmp_eq_u32 vcc, -1, v19
s_sub_u32 s45, s45, 1
s_cmp_eq_u32 s45, 0
s_cbranch_scc1 Lok_65
s_nop 2
s_cbranch_vccnz Lre_66
s_branch Lok_65
Lfx_70:
s_add_u32 s44, s35, 4
s_and_b32 s44, s44, 15
s_lshl_b32 s44, s44, 14
s_add_u32 s44, s44, 8192
s_mov_b32 s45, 0x20000
Lre_69:
buffer_load_dwordx4 v[80:83], v2, s[12:15], s44 offen offset:0 sc1
buffer_load_dwordx4 v[84:87], v2, s[12:15], s44 offen offset:256 sc1
buffer_load_dwordx4 v[88:91], v2, s[12:15], s44 offen offset:512 sc1
buffer_load_dwordx4 v[92:95], v2, s[12:15], s44 offen offset:768 sc1
s_waitcnt vmcnt(0)
v_max3_u32 v19, v80, v81, v82
v_max3_u32 v19, v19, v83, v84
v_max3_u32 v19, v19, v85, v86
v_max3_u32 v19, v19, v87, v88
v_max3_u32 v19, v19, v89, v90
v_max3_u32 v19, v19, v91, v92
v_max3_u32 v19, v19, v93, v94
v_max_u32 v19, v19, v95
v_cmp_eq_u32 vcc, -1, v19
s_sub_u32 s45, s45, 1
s_cmp_eq_u32 s45, 0
s_cbranch_scc1 Lok_68
s_nop 2
s_cbranch_vccnz Lre_69
s_branch Lok_68
Lfx_73:
s_add_u32 s44, s35, 5
s_and_b32 s44, s44, 15
s_lshl_b32 s44, s44, 14
s_add_u32 s44, s44, 0
s_mov_b32 s45, 0x20000
Lre_72:
buffer_load_dwordx4 v[32:35], v2, s[12:15], s44 offen offset:0 sc1
buffer_load_dwordx4 v[36:39], v2, s[12:15], s44 offen offset:256 sc1
buffer_load_dwordx4 v[40:43], v2, s[12:15], s44 offen offset:512 sc1
buffer_load_dwordx4 v[44:47], v2, s[12:15], s44 offen offset:768 sc1
s_waitcnt vmcnt(0)
v_max3_u32 v19, v32, v33, v34
v_max3_u32 v19, v19, v35, v36
v_max3_u32 v19, v19, v37, v38
v_max3_u32 v19, v19, v39, v40
v_max3_u32 v19, v19, v41, v42
v_max3_u32 v19, v19, v43, v44
v_max3_u32 v19, v19, v45, v46
v_max_u32 v19, v19, v47
v_cmp_eq_u32 vcc, -1, v19
s_sub_u32 s45, s45, 1
s_cmp_eq_u32 s45, 0
s_cbranch_scc1 Lok_71
s_nop 2
s_cbranch_vccnz Lre_72
s_branch Lok_71
Lfx_76:
s_add_u32 s44, s35, 5
s_and_b32 s44, s44, 15
s_lshl_b32 s44, s44, 14
s_add_u32 s44, s44, 8192
s_mov_b32 s45, 0x20000
Lre_75:
buffer_load_dwordx4 v[80:83], v2, s[12:15], s44 offen offset:0 sc1
buffer_load_dwordx4 v[84:87], v2, s[12:15], s44 offen offset:256 sc1
buffer_load_dwordx4 v[88:91], v2, s[12:15], s44 offen offset:512 sc1
buffer_load_dwordx4 v[92:95], v2, s[12:15], s44 offen offset:768 sc1
s_waitcnt vmcnt(0)
v_max3_u32 v19, v80, v81, v82
v_max3_u32 v19, v19, v83, v84
v_max3_u32 v19, v19, v85, v86
v_max3_u32 v19, v19, v87, v88
v_max3_u32 v19, v19, v89, v90
v_max3_u32 v19, v19, v91, v92
v_max3_u32 v19, v19, v93, v94
v_max_u32 v19, v19, v95
v_cmp_eq_u32 vcc, -1, v19
s_sub_u32 s45, s45, 1
s_cmp_eq_u32 s45, 0
s_cbranch_scc1 Lok_74
s_nop 2
s_cbranch_vccnz Lre_75
s_branch Lok_74
Lfx_79:
s_add_u32 s44, s35, 6
s_and_b32 s44, s44, 15
s_lshl_b32 s44, s44, 14
s_add_u32 s44, s44, 0
s_mov_b32 s45, 0x20000
Lre_78:
buffer_load_dwordx4 v[32:35], v2, s[12:15], s44 offen offset:0 sc1
buffer_load_dwordx4 v[36:39], v2, s[12:15], s44 offen offset:256 sc1
buffer_load_dwordx4 v[40:43], v2, s[12:15], s44 offen offset:512 sc1
buffer_load_dwordx4 v[44:47], v2, s[12:15], s44 offen offset:768 sc1
s_waitcnt vmcnt(0)
v_max3_u32 v19, v32, v33, v34
v_max3_u32 v19, v19, v35, v36
v_max3_u32 v19, v19, v37, v38
v_max3_u32 v19, v19, v39, v40
v_max3_u32 v19, v19, v41, v42
v_max3_u32 v19, v19, v43, v44
v_max3_u32 v19, v19, v45, v46
v_max_u32 v19, v19, v47
v_cmp_eq_u32 vcc, -1, v19
s_sub_u32 s45, s45, 1
s_cmp_eq_u32 s45, 0
s_cbranch_scc1 Lok_77
s_nop 2
s_cbranch_vccnz Lre_78
s_branch Lok_77
Lfx_82:
s_add_u32 s44, s35, 6
s_and_b32 s44, s44, 15
s_lshl_b32 s44, s44, 14
s_add_u32 s44, s44, 8192
s_mov_b32 s45, 0x20000
Lre_81:
buffer_load_dwordx4 v[80:83], v2, s[12:15], s44 offen offset:0 sc1
buffer_load_dwordx4 v[84:87], v2, s[12:15], s44 offen offset:256 sc1
buffer_load_dwordx4 v[88:91], v2, s[12:15], s44 offen offset:512 sc1
buffer_load_dwordx4 v[92:95], v2, s[12:15], s44 offen offset:768 sc1
s_waitcnt vmcnt(0)
v_max3_u32 v19, v80, v81, v82
v_max3_u32 v19, v19, v83, v84
v_max3_u32 v19, v19, v85, v86
v_max3_u32 v19, v19, v87, v88
v_max3_u32 v19, v19, v89, v90
v_max3_u32 v19, v19, v91, v92
v_max3_u32 v19, v19, v93, v94
v_max_u32 v19, v19, v95
v_cmp_eq_u32 vcc, -1, v19
s_sub_u32 s45, s45, 1
s_cmp_eq_u32 s45, 0
s_cbranch_scc1 Lok_80
s_nop 2
s_cbranch_vccnz Lre_81
s_branch Lok_80
Lfx_85:
s_add_u32 s44, s35, 7
s_and_b32 s44, s44, 15
s_lshl_b32 s44, s44, 14
s_add_u32 s44, s44, 0
s_mov_b32 s45, 0x20000
Lre_84:
buffer_load_dwordx4 v[32:35], v2, s[12:15], s44 offen offset:0 sc1
buffer_load_dwordx4 v[36:39], v2, s[12:15], s44 offen offset:256 sc1
buffer_load_dwordx4 v[40:43], v2, s[12:15], s44 offen offset:512 sc1
buffer_load_dwordx4 v[44:47], v2, s[12:15], s44 offen offset:768 sc1
s_waitcnt vmcnt(0)
v_max3_u32 v19, v32, v33, v34
v_max3_u32 v19, v19, v35, v36
v_max3_u32 v19, v19, v37, v38
v_max3_u32 v19, v19, v39, v40
v_max3_u32 v19, v19, v41, v42
v_max3_u32 v19, v19, v43, v44
v_max3_u32 v19, v19, v45, v46
v_max_u32 v19, v19, v47
v_cmp_eq_u32 vcc, -1, v19
s_sub_u32 s45, s45, 1
s_cmp_eq_u32 s45, 0
s_cbranch_scc1 Lok_83
s_nop 2
s_cbranch_vccnz Lre_84
s_branch Lok_83
Lfx_88:
s_add_u32 s44, s35, 7
s_and_b32 s44, s44, 15
s_lshl_b32 s44, s44, 14
s_add_u32 s44, s44, 8192
s_mov_b32 s45, 0x20000
Lre_87:
buffer_load_dwordx4 v[80:83], v2, s[12:15], s44 offen offset:0 sc1
buffer_load_dwordx4 v[84:87], v2, s[12:15], s44 offen offset:256 sc1
buffer_load_dwordx4 v[88:91], v2, s[12:15], s44 offen offset:512 sc1
buffer_load_dwordx4 v[92:95], v2, s[12:15], s44 offen offset:768 sc1
s_waitcnt vmcnt(0)
v_max3_u32 v19, v80, v81, v82
v_max3_u32 v19, v19, v83, v84
v_max3_u32 v19, v19, v85, v86
v_max3_u32 v19, v19, v87, v88
v_max3_u32 v19, v19, v89, v90
v_max3_u32 v19, v19, v91, v92
v_max3_u32 v19, v19, v93, v94
v_max_u32 v19, v19, v95
v_cmp_eq_u32 vcc, -1, v19
s_sub_u32 s45, s45, 1
s_cmp_eq_u32 s45, 0
s_cbranch_scc1 Lok_86
s_nop 2
s_cbranch_vccnz Lre_87
s_branch Lok_86
Ldone_1:
s_endpgm
.section .rodata,"a"
.p2align 6
.amdhsa_kernel sequential_preLN__sliding_local_dilated__glu_gated_geglu__prompt_kernel
  .amdhsa_next_free_vgpr 256
  .amdhsa_next_free_sgpr 100
  .amdhsa_accum_offset 256
  .amdhsa_group_segment_fixed_size 0
  .amdhsa_kernarg_size 80
  .amdhsa_user_sgpr_count 2
  .amdhsa_user_sgpr_kernarg_segment_ptr 1
  .amdhsa_system_sgpr_workgroup_id_x 1
  .amdhsa_float_denorm_mode_32 3
  .amdhsa_float_denorm_mode_16_64 3
.end_amdhsa_kernel
```

```asm
; @launch grid=(256,1,1) block=(512,1,1) lds=151552
.amdgcn_target "amdgcn-amd-amdhsa--gfx950"
.text
.globl sequential_preLN__sliding_local_dilated__glu_gated_geglu__prompt_kernel
.p2align 8
.type sequential_preLN__sliding_local_dilated__glu_gated_geglu__prompt_kernel,@function
sequential_preLN__sliding_local_dilated__glu_gated_geglu__prompt_kernel:
s_cmp_ge_u32 s2, 256
s_cbranch_scc1 Ldone_1
s_load_dwordx4 s[4:7], s[0:1], 0
s_load_dwordx2 s[32:33], s[0:1], 72
s_load_dwordx2 s[80:81], s[0:1], 32
s_and_b32 s3, s2, 7
s_lshr_b32 s42, s2, 3
s_and_b32 s48, s42, 3
s_lshr_b32 s49, s42, 2
s_and_b32 s34, s3, 3
s_lshl_b32 s34, s34, 2
s_add_u32 s34, s34, s48
s_lshr_b32 s35, s3, 2
s_lshl_b32 s35, s35, 3
s_add_u32 s35, s35, s49
v_lshrrev_b32 v12, 6, v0
v_and_b32 v1, 63, v0
v_readfirstlane_b32 s36, v12
s_nop 3
s_lshl_b32 s44, s34, 18
s_lshl_b32 s45, s35, 14
s_add_u32 s45, s45, s44
s_lshl_b32 s50, s34, 7
s_sub_u32 s50, s50, 16
s_and_b32 s47, s36, 3
s_lshl_b32 s43, s34, 7
s_lshl_b32 s44, s35, 3
s_add_u32 s43, s43, s44
s_mov_b32 s63, s43
s_lshl_b32 s44, s47, 1
s_add_u32 s51, s43, s44
v_lshlrev_b32 v10, 4, v1
v_lshrrev_b32 v14, 3, v1
v_and_b32 v15, 7, v1
v_and_b32 v16, 2, v14
v_xor_b32 v16, v15, v16
v_lshlrev_b32 v16, 4, v16
v_mul_u32_u24 v17, 6144, v14
s_lshl_b32 s43, s47, 11
v_add3_u32 v2, v17, v16, s43
v_xor_b32 v3, 64, v2
v_lshrrev_b32 v16, 1, v14
v_xor_b32 v16, v15, v16
v_lshlrev_b32 v16, 4, v16
s_lshl_b32 s43, s47, 3
s_add_u32 s43, s43, s50
v_add_u32 v17, s43, v14
s_and_b32 s44, s47, 1
s_lshl_b32 s44, s44, 6
v_add_u32 v18, 0, v17
v_max_i32 v18, 0, v18
v_lshl_add_u32 v18, v18, 11, v16
v_xor_b32 v18, s44, v18
v_mov_b32 v4, v18
v_add_u32 v18, 24, v17
v_max_i32 v18, 0, v18
v_lshl_add_u32 v18, v18, 11, v16
v_xor_b32 v18, s44, v18
v_xor_b32 v5, 64, v18
v_add_u32 v18, 48, v17
v_max_i32 v18, 0, v18
v_lshl_add_u32 v18, v18, 11, v16
v_xor_b32 v18, s44, v18
v_mov_b32 v6, v18
v_add_u32 v18, 72, v17
v_max_i32 v18, 0, v18
v_lshl_add_u32 v18, v18, 11, v16
v_xor_b32 v18, s44, v18
v_xor_b32 v7, 64, v18
v_add_u32 v18, 96, v17
v_max_i32 v18, 0, v18
v_lshl_add_u32 v18, v18, 11, v16
v_xor_b32 v18, s44, v18
v_mov_b32 v8, v18
v_add_u32 v18, 120, v17
v_max_i32 v18, 0, v18
v_lshl_add_u32 v18, v18, 11, v16
v_xor_b32 v18, s44, v18
v_xor_b32 v9, 64, v18
s_lshl_b32 s39, s47, 10
s_lshl_b32 s40, s47, 13
s_add_u32 s40, s40, 18432
s_mov_b32 s37, 0
s_mov_b32 s38, 0
s_bfm_b64 s[60:61], 56, 8
s_cmp_eq_u32 s47, 0
s_cselect_b64 s[60:61], s[60:61], -1
s_mov_b32 s53, 0x3f803f80
v_and_b32 v12, 15, v1
v_lshrrev_b32 v13, 4, v1
s_lshl_b32 s43, s35, 7
s_waitcnt lgkmcnt(0)
s_mov_b32 s8, s4
s_mov_b32 s9, s5
s_mov_b32 s10, 4194304
s_mov_b32 s11, 0x20000
s_add_u32 s12, s6, s43
s_addc_u32 s13, s7, 0
s_mov_b32 s14, 6289536
s_mov_b32 s15, 0x20000
s_add_u32 s16, s32, s45
s_addc_u32 s17, s33, 0
s_mov_b32 s18, 16384
s_mov_b32 s19, 0x20000
s_add_u32 s20, s32, 26214400
s_addc_u32 s21, s33, 0
s_mov_b32 s22, 16384
s_mov_b32 s23, 0x20000
s_cmp_lt_u32 s36, 4
s_cbranch_scc1 Lcons_2
s_cmp_eq_u32 s36, 7
s_cbranch_scc1 Lpf_3
s_add_u32 m0, s39, 0
s_mov_b64 exec, s[60:61]
buffer_load_dwordx4 v4, s[8:11], s37 offen lds
s_mov_b64 exec, -1
s_add_u32 m0, s39, 3072
s_nop 0
buffer_load_dwordx4 v5, s[8:11], s37 offen lds
s_add_u32 m0, s39, 6144
s_nop 0
buffer_load_dwordx4 v6, s[8:11], s37 offen lds
s_add_u32 m0, s39, 9216
s_nop 0
buffer_load_dwordx4 v7, s[8:11], s37 offen lds
s_add_u32 m0, s39, 12288
s_nop 0
buffer_load_dwordx4 v8, s[8:11], s37 offen lds
s_add_u32 m0, s39, 15360
s_nop 0
buffer_load_dwordx4 v9, s[8:11], s37 offen lds
s_add_u32 m0, s40, 0
s_add_u32 s43, s38, 0
buffer_load_dwordx4 v2, s[12:15], s43 offen lds
s_add_u32 m0, s40, 1024
s_add_u32 s43, s38, 49152
buffer_load_dwordx4 v3, s[12:15], s43 offen lds
s_add_u32 m0, s40, 2048
s_add_u32 s43, s38, 98304
buffer_load_dwordx4 v2, s[12:15], s43 offen lds
s_add_u32 m0, s40, 3072
s_add_u32 s43, s38, 147456
buffer_load_dwordx4 v3, s[12:15], s43 offen lds
s_add_u32 m0, s40, 4096
s_add_u32 s43, s38, 196608
buffer_load_dwordx4 v2, s[12:15], s43 offen lds
s_add_u32 m0, s40, 5120
s_add_u32 s43, s38, 245760
buffer_load_dwordx4 v3, s[12:15], s43 offen lds
s_add_u32 m0, s40, 6144
s_add_u32 s43, s38, 294912
buffer_load_dwordx4 v2, s[12:15], s43 offen lds
s_add_u32 m0, s40, 7168
s_add_u32 s43, s38, 344064
buffer_load_dwordx4 v3, s[12:15], s43 offen lds
s_add_u32 s37, s37, 128
s_add_u32 s38, s38, 393216
s_add_u32 m0, s39, 43008
s_mov_b64 exec, s[60:61]
buffer_load_dwordx4 v4, s[8:11], s37 offen lds
s_mov_b64 exec, -1
s_add_u32 m0, s39, 46080
s_nop 0
buffer_load_dwordx4 v5, s[8:11], s37 offen lds
s_add_u32 m0, s39, 49152
s_nop 0
buffer_load_dwordx4 v6, s[8:11], s37 offen lds
s_add_u32 m0, s39, 52224
s_nop 0
buffer_load_dwordx4 v7, s[8:11], s37 offen lds
s_add_u32 m0, s39, 55296
s_nop 0
buffer_load_dwordx4 v8, s[8:11], s37 offen lds
s_add_u32 m0, s39, 58368
s_nop 0
buffer_load_dwordx4 v9, s[8:11], s37 offen lds
s_add_u32 m0, s40, 43008
s_add_u32 s43, s38, 0
buffer_load_dwordx4 v2, s[12:15], s43 offen lds
s_add_u32 m0, s40, 44032
s_add_u32 s43, s38, 49152
buffer_load_dwordx4 v3, s[12:15], s43 offen lds
s_add_u32 m0, s40, 45056
s_add_u32 s43, s38, 98304
buffer_load_dwordx4 v2, s[12:15], s43 offen lds
s_add_u32 m0, s40, 46080
s_add_u32 s43, s38, 147456
buffer_load_dwordx4 v3, s[12:15], s43 offen lds
s_add_u32 m0, s40, 47104
s_add_u32 s43, s38, 196608
buffer_load_dwordx4 v2, s[12:15], s43 offen lds
s_add_u32 m0, s40, 48128
s_add_u32 s43, s38, 245760
buffer_load_dwordx4 v3, s[12:15], s43 offen lds
s_add_u32 m0, s40, 49152
s_add_u32 s43, s38, 294912
buffer_load_dwordx4 v2, s[12:15], s43 offen lds
s_add_u32 m0, s40, 50176
s_add_u32 s43, s38, 344064
buffer_load_dwordx4 v3, s[12:15], s43 offen lds
s_add_u32 s37, s37, 128
s_add_u32 s38, s38, 393216
s_waitcnt vmcnt(14)
s_barrier
s_add_u32 m0, s39, 86016
s_mov_b64 exec, s[60:61]
buffer_load_dwordx4 v4, s[8:11], s37 offen lds
s_mov_b64 exec, -1
s_add_u32 m0, s39, 89088
s_nop 0
buffer_load_dwordx4 v5, s[8:11], s37 offen lds
s_add_u32 m0, s39, 92160
s_nop 0
buffer_load_dwordx4 v6, s[8:11], s37 offen lds
s_add_u32 m0, s39, 95232
s_nop 0
buffer_load_dwordx4 v7, s[8:11], s37 offen lds
s_add_u32 m0, s39, 98304
s_nop 0
buffer_load_dwordx4 v8, s[8:11], s37 offen lds
s_add_u32 m0, s39, 101376
s_nop 0
buffer_load_dwordx4 v9, s[8:11], s37 offen lds
s_add_u32 m0, s40, 86016
s_add_u32 s43, s38, 0
buffer_load_dwordx4 v2, s[12:15], s43 offen lds
s_add_u32 m0, s40, 87040
s_add_u32 s43, s38, 49152
buffer_load_dwordx4 v3, s[12:15], s43 offen lds
s_add_u32 m0, s40, 88064
s_add_u32 s43, s38, 98304
buffer_load_dwordx4 v2, s[12:15], s43 offen lds
s_add_u32 m0, s40, 89088
s_add_u32 s43, s38, 147456
buffer_load_dwordx4 v3, s[12:15], s43 offen lds
s_add_u32 m0, s40, 90112
s_add_u32 s43, s38, 196608
buffer_load_dwordx4 v2, s[12:15], s43 offen lds
s_add_u32 m0, s40, 91136
s_add_u32 s43, s38, 245760
buffer_load_dwordx4 v3, s[12:15], s43 offen lds
s_add_u32 m0, s40, 92160
s_add_u32 s43, s38, 294912
buffer_load_dwordx4 v2, s[12:15], s43 offen lds
s_add_u32 m0, s40, 93184
s_add_u32 s43, s38, 344064
buffer_load_dwordx4 v3, s[12:15], s43 offen lds
s_add_u32 s37, s37, 128
s_add_u32 s38, s38, 393216
s_lshl_b32 s43, s51, 11
buffer_load_dwordx4 v[96:99], v10, s[8:11], s43 offen offset:0
buffer_load_dwordx4 v[100:103], v10, s[8:11], s43 offen offset:1024
buffer_load_dwordx4 v[104:107], v10, s[8:11], s43 offen offset:2048
buffer_load_dwordx4 v[108:111], v10, s[8:11], s43 offen offset:3072
s_lshr_b32 s43, s2, 5
s_cmp_eq_u32 s43, 3
s_cbranch_scc1 Lsj_16
s_cmp_gt_u32 s43, 3
s_cselect_b32 s43, 32, 0
s_sub_u32 s43, s2, s43
s_lshr_b32 s43, s43, 1
s_and_b32 s44, s2, 1
s_lshl_b32 s44, s44, 3
s_add_u32 s44, s44, 32
s_load_dwordx2 s[80:81], s[0:1], s44
s_mul_i32 s45, s43, 2341
s_lshr_b32 s45, s45, 16
s_mul_i32 s46, s45, 28
s_sub_u32 s46, s43, s46
s_lshl_b32 s45, s45, 8
s_mul_i32 s44, s47, 18
s_add_u32 s45, s45, s44
s_add_u32 s45, s45, 184
s_mul_i32 s45, s45, 7168
s_lshl_b32 s46, s46, 8
s_add_u32 s45, s45, s46
s_waitcnt lgkmcnt(0)
s_add_u32 s80, s80, s45
s_addc_u32 s81, s81, 0
Lsj_16:
s_waitcnt vmcnt(18)
s_barrier
s_add_u32 m0, s39, 0
s_mov_b64 exec, s[60:61]
buffer_load_dwordx4 v4, s[8:11], s37 offen lds
s_mov_b64 exec, -1
s_add_u32 m0, s39, 3072
s_nop 0
buffer_load_dwordx4 v5, s[8:11], s37 offen lds
s_add_u32 m0, s39, 6144
s_nop 0
buffer_load_dwordx4 v6, s[8:11], s37 offen lds
s_add_u32 m0, s39, 9216
s_nop 0
buffer_load_dwordx4 v7, s[8:11], s37 offen lds
s_add_u32 m0, s39, 12288
s_nop 0
buffer_load_dwordx4 v8, s[8:11], s37 offen lds
s_add_u32 m0, s39, 15360
s_nop 0
buffer_load_dwordx4 v9, s[8:11], s37 offen lds
s_add_u32 m0, s40, 0
s_add_u32 s43, s38, 0
buffer_load_dwordx4 v2, s[12:15], s43 offen lds
s_add_u32 m0, s40, 1024
s_add_u32 s43, s38, 49152
buffer_load_dwordx4 v3, s[12:15], s43 offen lds
s_add_u32 m0, s40, 2048
s_add_u32 s43, s38, 98304
buffer_load_dwordx4 v2, s[12:15], s43 offen lds
s_add_u32 m0, s40, 3072
s_add_u32 s43, s38, 147456
buffer_load_dwordx4 v3, s[12:15], s43 offen lds
s_add_u32 m0, s40, 4096
s_add_u32 s43, s38, 196608
buffer_load_dwordx4 v2, s[12:15], s43 offen lds
s_add_u32 m0, s40, 5120
s_add_u32 s43, s38, 245760
buffer_load_dwordx4 v3, s[12:15], s43 offen lds
s_add_u32 m0, s40, 6144
s_add_u32 s43, s38, 294912
buffer_load_dwordx4 v2, s[12:15], s43 offen lds
s_add_u32 m0, s40, 7168
s_add_u32 s43, s38, 344064
buffer_load_dwordx4 v3, s[12:15], s43 offen lds
s_add_u32 s37, s37, 128
s_add_u32 s38, s38, 393216
s_waitcnt vmcnt(14)
s_barrier
s_add_u32 m0, s39, 43008
s_mov_b64 exec, s[60:61]
buffer_load_dwordx4 v4, s[8:11], s37 offen lds
s_mov_b64 exec, -1
s_add_u32 m0, s39, 46080
s_nop 0
buffer_load_dwordx4 v5, s[8:11], s37 offen lds
s_add_u32 m0, s39, 49152
s_nop 0
buffer_load_dwordx4 v6, s[8:11], s37 offen lds
s_add_u32 m0, s39, 52224
s_nop 0
buffer_load_dwordx4 v7, s[8:11], s37 offen lds
s_add_u32 m0, s39, 55296
s_nop 0
buffer_load_dwordx4 v8, s[8:11], s37 offen lds
s_add_u32 m0, s39, 58368
s_nop 0
buffer_load_dwordx4 v9, s[8:11], s37 offen lds
s_add_u32 m0, s40, 43008
s_add_u32 s43, s38, 0
buffer_load_dwordx4 v2, s[12:15], s43 offen lds
s_add_u32 m0, s40, 44032
s_add_u32 s43, s38, 49152
buffer_load_dwordx4 v3, s[12:15], s43 offen lds
s_add_u32 m0, s40, 45056
s_add_u32 s43, s38, 98304
buffer_load_dwordx4 v2, s[12:15], s43 offen lds
s_add_u32 m0, s40, 46080
s_add_u32 s43, s38, 147456
buffer_load_dwordx4 v3, s[12:15], s43 offen lds
s_add_u32 m0, s40, 47104
s_add_u32 s43, s38, 196608
buffer_load_dwordx4 v2, s[12:15], s43 offen lds
s_add_u32 m0, s40, 48128
s_add_u32 s43, s38, 245760
buffer_load_dwordx4 v3, s[12:15], s43 offen lds
s_add_u32 m0, s40, 49152
s_add_u32 s43, s38, 294912
buffer_load_dwordx4 v2, s[12:15], s43 offen lds
s_add_u32 m0, s40, 50176
s_add_u32 s43, s38, 344064
buffer_load_dwordx4 v3, s[12:15], s43 offen lds
s_add_u32 s37, s37, 128
s_add_u32 s38, s38, 393216
v_lshlrev_b32 v116, 16, v96
v_and_b32 v117, 0xffff0000, v96
v_mul_f32 v118, v116, v116
v_mul_f32 v119, v117, v117
v_lshlrev_b32 v126, 16, v97
v_and_b32 v127, 0xffff0000, v97
v_add_f32 v116, v116, v126
v_add_f32 v117, v117, v127
v_fmac_f32 v118, v126, v126
v_fmac_f32 v119, v127, v127
v_lshlrev_b32 v124, 16, v98
v_and_b32 v125, 0xffff0000, v98
v_add_f32 v116, v116, v124
v_add_f32 v117, v117, v125
v_fmac_f32 v118, v124, v124
v_fmac_f32 v119, v125, v125
v_lshlrev_b32 v126, 16, v99
v_and_b32 v127, 0xffff0000, v99
v_add_f32 v116, v116, v126
v_add_f32 v117, v117, v127
v_fmac_f32 v118, v126, v126
v_fmac_f32 v119, v127, v127
v_lshlrev_b32 v124, 16, v100
v_and_b32 v125, 0xffff0000, v100
v_add_f32 v116, v116, v124
v_add_f32 v117, v117, v125
v_fmac_f32 v118, v124, v124
v_fmac_f32 v119, v125, v125
v_lshlrev_b32 v126, 16, v101
v_and_b32 v127, 0xffff0000, v101
v_add_f32 v116, v116, v126
v_add_f32 v117, v117, v127
v_fmac_f32 v118, v126, v126
v_fmac_f32 v119, v127, v127
v_lshlrev_b32 v124, 16, v102
v_and_b32 v125, 0xffff0000, v102
v_add_f32 v116, v116, v124
v_add_f32 v117, v117, v125
v_fmac_f32 v118, v124, v124
v_fmac_f32 v119, v125, v125
v_lshlrev_b32 v126, 16, v103
v_and_b32 v127, 0xffff0000, v103
v_add_f32 v116, v116, v126
v_add_f32 v117, v117, v127
v_fmac_f32 v118, v126, v126
v_fmac_f32 v119, v127, v127
v_lshlrev_b32 v120, 16, v104
v_and_b32 v121, 0xffff0000, v104
v_mul_f32 v122, v120, v120
v_mul_f32 v123, v121, v121
s_waitcnt vmcnt(14)
s_barrier
s_add_u32 m0, s39, 86016
s_mov_b64 exec, s[60:61]
buffer_load_dwordx4 v4, s[8:11], s37 offen lds
s_mov_b64 exec, -1
s_add_u32 m0, s39, 89088
s_nop 0
buffer_load_dwordx4 v5, s[8:11], s37 offen lds
s_add_u32 m0, s39, 92160
s_nop 0
buffer_load_dwordx4 v6, s[8:11], s37 offen lds
s_add_u32 m0, s39, 95232
s_nop 0
buffer_load_dwordx4 v7, s[8:11], s37 offen lds
s_add_u32 m0, s39, 98304
s_nop 0
buffer_load_dwordx4 v8, s[8:11], s37 offen lds
s_add_u32 m0, s39, 101376
s_nop 0
buffer_load_dwordx4 v9, s[8:11], s37 offen lds
s_add_u32 m0, s40, 86016
s_add_u32 s43, s38, 0
buffer_load_dwordx4 v2, s[12:15], s43 offen lds
s_add_u32 m0, s40, 87040
s_add_u32 s43, s38, 49152
buffer_load_dwordx4 v3, s[12:15], s43 offen lds
s_add_u32 m0, s40, 88064
s_add_u32 s43, s38, 98304
buffer_load_dwordx4 v2, s[12:15], s43 offen lds
s_add_u32 m0, s40, 89088
s_add_u32 s43, s38, 147456
buffer_load_dwordx4 v3, s[12:15], s43 offen lds
s_add_u32 m0, s40, 90112
s_add_u32 s43, s38, 196608
buffer_load_dwordx4 v2, s[12:15], s43 offen lds
s_add_u32 m0, s40, 91136
s_add_u32 s43, s38, 245760
buffer_load_dwordx4 v3, s[12:15], s43 offen lds
s_add_u32 m0, s40, 92160
s_add_u32 s43, s38, 294912
buffer_load_dwordx4 v2, s[12:15], s43 offen lds
s_add_u32 m0, s40, 93184
s_add_u32 s43, s38, 344064
buffer_load_dwordx4 v3, s[12:15], s43 offen lds
s_add_u32 s37, s37, 128
s_add_u32 s38, s38, 393216
v_lshlrev_b32 v126, 16, v105
v_and_b32 v127, 0xffff0000, v105
v_add_f32 v120, v120, v126
v_add_f32 v121, v121, v127
v_fmac_f32 v122, v126, v126
v_fmac_f32 v123, v127, v127
v_lshlrev_b32 v124, 16, v106
v_and_b32 v125, 0xffff0000, v106
v_add_f32 v120, v120, v124
v_add_f32 v121, v121, v125
v_fmac_f32 v122, v124, v124
v_fmac_f32 v123, v125, v125
v_lshlrev_b32 v126, 16, v107
v_and_b32 v127, 0xffff0000, v107
v_add_f32 v120, v120, v126
v_add_f32 v121, v121, v127
v_fmac_f32 v122, v126, v126
v_fmac_f32 v123, v127, v127
v_lshlrev_b32 v124, 16, v108
v_and_b32 v125, 0xffff0000, v108
v_add_f32 v120, v120, v124
v_add_f32 v121, v121, v125
v_fmac_f32 v122, v124, v124
v_fmac_f32 v123, v125, v125
v_lshlrev_b32 v126, 16, v109
v_and_b32 v127, 0xffff0000, v109
v_add_f32 v120, v120, v126
v_add_f32 v121, v121, v127
v_fmac_f32 v122, v126, v126
v_fmac_f32 v123, v127, v127
v_lshlrev_b32 v124, 16, v110
v_and_b32 v125, 0xffff0000, v110
v_add_f32 v120, v120, v124
v_add_f32 v121, v121, v125
v_fmac_f32 v122, v124, v124
v_fmac_f32 v123, v125, v125
v_lshlrev_b32 v126, 16, v111
v_and_b32 v127, 0xffff0000, v111
v_add_f32 v120, v120, v126
v_add_f32 v121, v121, v127
v_fmac_f32 v122, v126, v126
v_fmac_f32 v123, v127, v127
v_add_f32 v116, v116, v117
v_add_f32 v118, v118, v119
v_add_f32 v120, v120, v121
v_add_f32 v122, v122, v123
v_add_f32_dpp v116, v116, v116 row_ror:8 row_mask:0xf bank_mask:0xf
v_add_f32_dpp v118, v118, v118 row_ror:8 row_mask:0xf bank_mask:0xf
v_add_f32_dpp v120, v120, v120 row_ror:8 row_mask:0xf bank_mask:0xf
v_add_f32_dpp v122, v122, v122 row_ror:8 row_mask:0xf bank_mask:0xf
v_mov_b32 v128, -1
v_mov_b32 v129, -1
v_mov_b32 v130, -1
v_mov_b32 v131, -1
s_mul_i32 s28, s47, 5120
buffer_store_dwordx4 v[128:131], v10, s[16:19], s28 offen sc1
s_add_u32 s28, s28, 1024
buffer_store_dwordx4 v[128:131], v10, s[16:19], s28 offen sc1
s_add_u32 s28, s28, 1024
s_waitcnt vmcnt(16)
s_barrier
s_add_u32 m0, s39, 0
s_mov_b64 exec, s[60:61]
buffer_load_dwordx4 v4, s[8:11], s37 offen lds
s_mov_b64 exec, -1
s_add_u32 m0, s39, 3072
s_nop 0
buffer_load_dwordx4 v5, s[8:11], s37 offen lds
s_add_u32 m0, s39, 6144
s_nop 0
buffer_load_dwordx4 v6, s[8:11], s37 offen lds
s_add_u32 m0, s39, 9216
s_nop 0
buffer_load_dwordx4 v7, s[8:11], s37 offen lds
s_add_u32 m0, s39, 12288
s_nop 0
buffer_load_dwordx4 v8, s[8:11], s37 offen lds
s_add_u32 m0, s39, 15360
s_nop 0
buffer_load_dwordx4 v9, s[8:11], s37 offen lds
s_add_u32 m0, s40, 0
s_add_u32 s43, s38, 0
buffer_load_dwordx4 v2, s[12:15], s43 offen lds
s_add_u32 m0, s40, 1024
s_add_u32 s43, s38, 49152
buffer_load_dwordx4 v3, s[12:15], s43 offen lds
s_add_u32 m0, s40, 2048
s_add_u32 s43, s38, 98304
buffer_load_dwordx4 v2, s[12:15], s43 offen lds
s_add_u32 m0, s40, 3072
s_add_u32 s43, s38, 147456
buffer_load_dwordx4 v3, s[12:15], s43 offen lds
s_add_u32 m0, s40, 4096
s_add_u32 s43, s38, 196608
buffer_load_dwordx4 v2, s[12:15], s43 offen lds
s_add_u32 m0, s40, 5120
s_add_u32 s43, s38, 245760
buffer_load_dwordx4 v3, s[12:15], s43 offen lds
s_add_u32 m0, s40, 6144
s_add_u32 s43, s38, 294912
buffer_load_dwordx4 v2, s[12:15], s43 offen lds
s_add_u32 m0, s40, 7168
s_add_u32 s43, s38, 344064
buffer_load_dwordx4 v3, s[12:15], s43 offen lds
s_add_u32 s37, s37, 128
s_add_u32 s38, s38, 393216
v_add_f32_dpp v116, v116, v116 row_ror:4 row_mask:0xf bank_mask:0xf
v_add_f32_dpp v118, v118, v118 row_ror:4 row_mask:0xf bank_mask:0xf
v_add_f32_dpp v120, v120, v120 row_ror:4 row_mask:0xf bank_mask:0xf
v_add_f32_dpp v122, v122, v122 row_ror:4 row_mask:0xf bank_mask:0xf
v_add_f32_dpp v116, v116, v116 row_ror:2 row_mask:0xf bank_mask:0xf
v_add_f32_dpp v118, v118, v118 row_ror:2 row_mask:0xf bank_mask:0xf
v_add_f32_dpp v120, v120, v120 row_ror:2 row_mask:0xf bank_mask:0xf
v_add_f32_dpp v122, v122, v122 row_ror:2 row_mask:0xf bank_mask:0xf
v_add_f32_dpp v116, v116, v116 row_ror:1 row_mask:0xf bank_mask:0xf
v_add_f32_dpp v118, v118, v118 row_ror:1 row_mask:0xf bank_mask:0xf
v_add_f32_dpp v120, v120, v120 row_ror:1 row_mask:0xf bank_mask:0xf
v_add_f32_dpp v122, v122, v122 row_ror:1 row_mask:0xf bank_mask:0xf
v_mov_b32 v117, v116
v_mov_b32 v119, v118
v_mov_b32 v121, v120
v_mov_b32 v123, v122
s_nop 0
v_permlane16_swap_b32 v116, v117
v_permlane16_swap_b32 v118, v119
v_permlane16_swap_b32 v120, v121
v_permlane16_swap_b32 v122, v123
v_add_f32 v116, v116, v117
v_add_f32 v118, v118, v119
v_add_f32 v120, v120, v121
v_add_f32 v122, v122, v123
v_mov_b32 v117, v116
v_mov_b32 v119, v118
v_mov_b32 v121, v120
v_mov_b32 v123, v122
s_nop 0
v_permlane32_swap_b32 v116, v117
v_permlane32_swap_b32 v118, v119
v_permlane32_swap_b32 v120, v121
v_permlane32_swap_b32 v122, v123
v_add_f32 v116, v116, v117
v_add_f32 v118, v118, v119
v_add_f32 v120, v120, v121
v_add_f32 v122, v122, v123
v_mul_f32 v112, 0x3a800000, v116
v_mul_f32 v113, 0x3a800000, v118
v_fma_f32 v113, -v112, v112, v113
v_max_f32 v113, 0, v113
v_add_f32 v113, 0x3727c5ac, v113
v_rsq_f32 v113, v113
v_mul_f32 v114, 0x3a800000, v120
v_mul_f32 v115, 0x3a800000, v122
v_fma_f32 v115, -v114, v114, v115
v_max_f32 v115, 0, v115
v_add_f32 v115, 0x3727c5ac, v115
v_rsq_f32 v115, v115
s_nop 0
s_lshl_b32 s43, s47, 4
s_add_u32 s43, s43, 130176
v_mov_b32 v11, s43
ds_write_b128 v11, v[112:115]
s_waitcnt lgkmcnt(0)
buffer_store_dwordx4 v[128:131], v10, s[16:19], s28 offen sc1
s_add_u32 s28, s28, 1024
buffer_store_dwordx4 v[128:131], v10, s[16:19], s28 offen sc1
s_add_u32 s28, s28, 1024
s_load_dword s64, s[80:81], 0
s_load_dword s65, s[80:81], 64
s_load_dword s66, s[80:81], 128
s_load_dword s67, s[80:81], 192
s_load_dword s68, s[80:81], 7168
s_load_dword s69, s[80:81], 7232
s_load_dword s70, s[80:81], 7296
s_load_dword s71, s[80:81], 7360
s_add_u32 s80, s80, 14336
s_addc_u32 s81, s81, 0
s_waitcnt vmcnt(18)
s_barrier
s_add_u32 m0, s39, 43008
s_mov_b64 exec, s[60:61]
buffer_load_dwordx4 v4, s[8:11], s37 offen lds
s_mov_b64 exec, -1
s_add_u32 m0, s39, 46080
s_nop 0
buffer_load_dwordx4 v5, s[8:11], s37 offen lds
s_add_u32 m0, s39, 49152
s_nop 0
buffer_load_dwordx4 v6, s[8:11], s37 offen lds
s_add_u32 m0, s39, 52224
s_nop 0
buffer_load_dwordx4 v7, s[8:11], s37 offen lds
s_add_u32 m0, s39, 55296
s_nop 0
buffer_load_dwordx4 v8, s[8:11], s37 offen lds
s_add_u32 m0, s39, 58368
s_nop 0
buffer_load_dwordx4 v9, s[8:11], s37 offen lds
s_add_u32 m0, s40, 43008
s_add_u32 s43, s38, 0
buffer_load_dwordx4 v2, s[12:15], s43 offen lds
s_add_u32 m0, s40, 44032
s_add_u32 s43, s38, 49152
buffer_load_dwordx4 v3, s[12:15], s43 offen lds
s_add_u32 m0, s40, 45056
s_add_u32 s43, s38, 98304
buffer_load_dwordx4 v2, s[12:15], s43 offen lds
s_add_u32 m0, s40, 46080
s_add_u32 s43, s38, 147456
buffer_load_dwordx4 v3, s[12:15], s43 offen lds
s_add_u32 m0, s40, 47104
s_add_u32 s43, s38, 196608
buffer_load_dwordx4 v2, s[12:15], s43 offen lds
s_add_u32 m0, s40, 48128
s_add_u32 s43, s38, 245760
buffer_load_dwordx4 v3, s[12:15], s43 offen lds
s_add_u32 m0, s40, 49152
s_add_u32 s43, s38, 294912
buffer_load_dwordx4 v2, s[12:15], s43 offen lds
s_add_u32 m0, s40, 50176
s_add_u32 s43, s38, 344064
buffer_load_dwordx4 v3, s[12:15], s43 offen lds
s_add_u32 s37, s37, 128
s_add_u32 s38, s38, 393216
buffer_store_dwordx4 v[128:131], v10, s[16:19], s28 offen sc1
s_add_u32 s28, s28, 1024
buffer_store_dwordx4 v[128:131], v10, s[16:19], s28 offen sc1
s_add_u32 s28, s28, 1024
s_load_dword s64, s[80:81], 0
s_load_dword s65, s[80:81], 64
s_load_dword s66, s[80:81], 128
s_load_dword s67, s[80:81], 192
s_load_dword s68, s[80:81], 7168
s_load_dword s69, s[80:81], 7232
s_load_dword s70, s[80:81], 7296
s_load_dword s71, s[80:81], 7360
s_add_u32 s80, s80, 14336
s_addc_u32 s81, s81, 0
s_waitcnt vmcnt(18)
s_barrier
s_add_u32 m0, s39, 86016
s_mov_b64 exec, s[60:61]
buffer_load_dwordx4 v4, s[8:11], s37 offen lds
s_mov_b64 exec, -1
s_add_u32 m0, s39, 89088
s_nop 0
buffer_load_dwordx4 v5, s[8:11], s37 offen lds
s_add_u32 m0, s39, 92160
s_nop 0
buffer_load_dwordx4 v6, s[8:11], s37 offen lds
s_add_u32 m0, s39, 95232
s_nop 0
buffer_load_dwordx4 v7, s[8:11], s37 offen lds
s_add_u32 m0, s39, 98304
s_nop 0
buffer_load_dwordx4 v8, s[8:11], s37 offen lds
s_add_u32 m0, s39, 101376
s_nop 0
buffer_load_dwordx4 v9, s[8:11], s37 offen lds
s_add_u32 m0, s40, 86016
s_add_u32 s43, s38, 0
buffer_load_dwordx4 v2, s[12:15], s43 offen lds
s_add_u32 m0, s40, 87040
s_add_u32 s43, s38, 49152
buffer_load_dwordx4 v3, s[12:15], s43 offen lds
s_add_u32 m0, s40, 88064
s_add_u32 s43, s38, 98304
buffer_load_dwordx4 v2, s[12:15], s43 offen lds
s_add_u32 m0, s40, 89088
s_add_u32 s43, s38, 147456
buffer_load_dwordx4 v3, s[12:15], s43 offen lds
s_add_u32 m0, s40, 90112
s_add_u32 s43, s38, 196608
buffer_load_dwordx4 v2, s[12:15], s43 offen lds
s_add_u32 m0, s40, 91136
s_add_u32 s43, s38, 245760
buffer_load_dwordx4 v3, s[12:15], s43 offen lds
s_add_u32 m0, s40, 92160
s_add_u32 s43, s38, 294912
buffer_load_dwordx4 v2, s[12:15], s43 offen lds
s_add_u32 m0, s40, 93184
s_add_u32 s43, s38, 344064
buffer_load_dwordx4 v3, s[12:15], s43 offen lds
s_add_u32 s37, s37, 128
s_add_u32 s38, s38, 393216
s_add_u32 s24, s16, 4194304
s_addc_u32 s25, s17, 0
s_mov_b32 s26, 16384
s_mov_b32 s27, 0x20000
s_mul_i32 s28, s47, 5120
buffer_store_dwordx4 v[128:131], v10, s[24:27], s28 offen sc1
s_add_u32 s28, s28, 1024
s_load_dword s64, s[80:81], 0
s_load_dword s65, s[80:81], 64
s_load_dword s66, s[80:81], 128
s_load_dword s67, s[80:81], 192
s_load_dword s68, s[80:81], 7168
s_load_dword s69, s[80:81], 7232
s_load_dword s70, s[80:81], 7296
s_load_dword s71, s[80:81], 7360
s_add_u32 s80, s80, 14336
s_addc_u32 s81, s81, 0
s_waitcnt vmcnt(17)
s_barrier
s_add_u32 m0, s39, 0
s_mov_b64 exec, s[60:61]
buffer_load_dwordx4 v4, s[8:11], s37 offen lds
s_mov_b64 exec, -1
s_add_u32 m0, s39, 3072
s_nop 0
buffer_load_dwordx4 v5, s[8:11], s37 offen lds
s_add_u32 m0, s39, 6144
s_nop 0
buffer_load_dwordx4 v6, s[8:11], s37 offen lds
s_add_u32 m0, s39, 9216
s_nop 0
buffer_load_dwordx4 v7, s[8:11], s37 offen lds
s_add_u32 m0, s39, 12288
s_nop 0
buffer_load_dwordx4 v8, s[8:11], s37 offen lds
s_add_u32 m0, s39, 15360
s_nop 0
buffer_load_dwordx4 v9, s[8:11], s37 offen lds
s_add_u32 m0, s40, 0
s_add_u32 s43, s38, 0
buffer_load_dwordx4 v2, s[12:15], s43 offen lds
s_add_u32 m0, s40, 1024
s_add_u32 s43, s38, 49152
buffer_load_dwordx4 v3, s[12:15], s43 offen lds
s_add_u32 m0, s40, 2048
s_add_u32 s43, s38, 98304
buffer_load_dwordx4 v2, s[12:15], s43 offen lds
s_add_u32 m0, s40, 3072
s_add_u32 s43, s38, 147456
buffer_load_dwordx4 v3, s[12:15], s43 offen lds
s_add_u32 m0, s40, 4096
s_add_u32 s43, s38, 196608
buffer_load_dwordx4 v2, s[12:15], s43 offen lds
s_add_u32 m0, s40, 5120
s_add_u32 s43, s38, 245760
buffer_load_dwordx4 v3, s[12:15], s43 offen lds
s_add_u32 m0, s40, 6144
s_add_u32 s43, s38, 294912
buffer_load_dwordx4 v2, s[12:15], s43 offen lds
s_add_u32 m0, s40, 7168
s_add_u32 s43, s38, 344064
buffer_load_dwordx4 v3, s[12:15], s43 offen lds
s_add_u32 s37, s37, 128
s_add_u32 s38, s38, 393216
buffer_store_dwordx4 v[128:131], v10, s[24:27], s28 offen sc1
s_add_u32 s28, s28, 1024
s_load_dword s64, s[80:81], 0
s_load_dword s65, s[80:81], 64
s_load_dword s66, s[80:81], 128
s_load_dword s67, s[80:81], 192
s_load_dword s68, s[80:81], 7168
s_load_dword s69, s[80:81], 7232
s_load_dword s70, s[80:81], 7296
s_load_dword s71, s[80:81], 7360
s_add_u32 s80, s80, 14336
s_addc_u32 s81, s81, 0
s_waitcnt vmcnt(16)
s_barrier
s_add_u32 m0, s39, 43008
s_mov_b64 exec, s[60:61]
buffer_load_dwordx4 v4, s[8:11], s37 offen lds
s_mov_b64 exec, -1
s_add_u32 m0, s39, 46080
s_nop 0
buffer_load_dwordx4 v5, s[8:11], s37 offen lds
s_add_u32 m0, s39, 49152
s_nop 0
buffer_load_dwordx4 v6, s[8:11], s37 offen lds
s_add_u32 m0, s39, 52224
s_nop 0
buffer_load_dwordx4 v7, s[8:11], s37 offen lds
s_add_u32 m0, s39, 55296
s_nop 0
buffer_load_dwordx4 v8, s[8:11], s37 offen lds
s_add_u32 m0, s39, 58368
s_nop 0
buffer_load_dwordx4 v9, s[8:11], s37 offen lds
s_add_u32 m0, s40, 43008
s_add_u32 s43, s38, 0
buffer_load_dwordx4 v2, s[12:15], s43 offen lds
s_add_u32 m0, s40, 44032
s_add_u32 s43, s38, 49152
buffer_load_dwordx4 v3, s[12:15], s43 offen lds
s_add_u32 m0, s40, 45056
s_add_u32 s43, s38, 98304
buffer_load_dwordx4 v2, s[12:15], s43 offen lds
s_add_u32 m0, s40, 46080
s_add_u32 s43, s38, 147456
buffer_load_dwordx4 v3, s[12:15], s43 offen lds
s_add_u32 m0, s40, 47104
s_add_u32 s43, s38, 196608
buffer_load_dwordx4 v2, s[12:15], s43 offen lds
s_add_u32 m0, s40, 48128
s_add_u32 s43, s38, 245760
buffer_load_dwordx4 v3, s[12:15], s43 offen lds
s_add_u32 m0, s40, 49152
s_add_u32 s43, s38, 294912
buffer_load_dwordx4 v2, s[12:15], s43 offen lds
s_add_u32 m0, s40, 50176
s_add_u32 s43, s38, 344064
buffer_load_dwordx4 v3, s[12:15], s43 offen lds
s_add_u32 s37, s37, 128
s_add_u32 s38, s38, 393216
buffer_store_dwordx4 v[128:131], v10, s[24:27], s28 offen sc1
s_add_u32 s28, s28, 1024
s_load_dword s64, s[80:81], 0
s_load_dword s65, s[80:81], 64
s_load_dword s66, s[80:81], 128
s_load_dword s67, s[80:81], 192
s_load_dword s68, s[80:81], 7168
s_load_dword s69, s[80:81], 7232
s_load_dword s70, s[80:81], 7296
s_load_dword s71, s[80:81], 7360
s_add_u32 s80, s80, 14336
s_addc_u32 s81, s81, 0
s_waitcnt vmcnt(16)
s_barrier
s_add_u32 m0, s39, 86016
s_mov_b64 exec, s[60:61]
buffer_load_dwordx4 v4, s[8:11], s37 offen lds
s_mov_b64 exec, -1
s_add_u32 m0, s39, 89088
s_nop 0
buffer_load_dwordx4 v5, s[8:11], s37 offen lds
s_add_u32 m0, s39, 92160
s_nop 0
buffer_load_dwordx4 v6, s[8:11], s37 offen lds
s_add_u32 m0, s39, 95232
s_nop 0
buffer_load_dwordx4 v7, s[8:11], s37 offen lds
s_add_u32 m0, s39, 98304
s_nop 0
buffer_load_dwordx4 v8, s[8:11], s37 offen lds
s_add_u32 m0, s39, 101376
s_nop 0
buffer_load_dwordx4 v9, s[8:11], s37 offen lds
s_add_u32 m0, s40, 86016
s_add_u32 s43, s38, 0
buffer_load_dwordx4 v2, s[12:15], s43 offen lds
s_add_u32 m0, s40, 87040
s_add_u32 s43, s38, 49152
buffer_load_dwordx4 v3, s[12:15], s43 offen lds
s_add_u32 m0, s40, 88064
s_add_u32 s43, s38, 98304
buffer_load_dwordx4 v2, s[12:15], s43 offen lds
s_add_u32 m0, s40, 89088
s_add_u32 s43, s38, 147456
buffer_load_dwordx4 v3, s[12:15], s43 offen lds
s_add_u32 m0, s40, 90112
s_add_u32 s43, s38, 196608
buffer_load_dwordx4 v2, s[12:15], s43 offen lds
s_add_u32 m0, s40, 91136
s_add_u32 s43, s38, 245760
buffer_load_dwordx4 v3, s[12:15], s43 offen lds
s_add_u32 m0, s40, 92160
s_add_u32 s43, s38, 294912
buffer_load_dwordx4 v2, s[12:15], s43 offen lds
s_add_u32 m0, s40, 93184
s_add_u32 s43, s38, 344064
buffer_load_dwordx4 v3, s[12:15], s43 offen lds
s_add_u32 s37, s37, 128
s_add_u32 s38, s38, 393216
buffer_store_dwordx4 v[128:131], v10, s[24:27], s28 offen sc1
s_add_u32 s28, s28, 1024
s_load_dword s64, s[80:81], 0
s_load_dword s65, s[80:81], 64
s_load_dword s66, s[80:81], 128
s_load_dword s67, s[80:81], 192
s_load_dword s68, s[80:81], 7168
s_load_dword s69, s[80:81], 7232
s_load_dword s70, s[80:81], 7296
s_load_dword s71, s[80:81], 7360
s_add_u32 s80, s80, 14336
s_addc_u32 s81, s81, 0
s_waitcnt vmcnt(16)
s_barrier
s_add_u32 m0, s39, 0
s_mov_b64 exec, s[60:61]
buffer_load_dwordx4 v4, s[8:11], s37 offen lds
s_mov_b64 exec, -1
s_add_u32 m0, s39, 3072
s_nop 0
buffer_load_dwordx4 v5, s[8:11], s37 offen lds
s_add_u32 m0, s39, 6144
s_nop 0
buffer_load_dwordx4 v6, s[8:11], s37 offen lds
s_add_u32 m0, s39, 9216
s_nop 0
buffer_load_dwordx4 v7, s[8:11], s37 offen lds
s_add_u32 m0, s39, 12288
s_nop 0
buffer_load_dwordx4 v8, s[8:11], s37 offen lds
s_add_u32 m0, s39, 15360
s_nop 0
buffer_load_dwordx4 v9, s[8:11], s37 offen lds
s_add_u32 m0, s40, 0
s_add_u32 s43, s38, 0
buffer_load_dwordx4 v2, s[12:15], s43 offen lds
s_add_u32 m0, s40, 1024
s_add_u32 s43, s38, 49152
buffer_load_dwordx4 v3, s[12:15], s43 offen lds
s_add_u32 m0, s40, 2048
s_add_u32 s43, s38, 98304
buffer_load_dwordx4 v2, s[12:15], s43 offen lds
s_add_u32 m0, s40, 3072
s_add_u32 s43, s38, 147456
buffer_load_dwordx4 v3, s[12:15], s43 offen lds
s_add_u32 m0, s40, 4096
s_add_u32 s43, s38, 196608
buffer_load_dwordx4 v2, s[12:15], s43 offen lds
s_add_u32 m0, s40, 5120
s_add_u32 s43, s38, 245760
buffer_load_dwordx4 v3, s[12:15], s43 offen lds
s_add_u32 m0, s40, 6144
s_add_u32 s43, s38, 294912
buffer_load_dwordx4 v2, s[12:15], s43 offen lds
s_add_u32 m0, s40, 7168
s_add_u32 s43, s38, 344064
buffer_load_dwordx4 v3, s[12:15], s43 offen lds
s_add_u32 s37, s37, 128
s_add_u32 s38, s38, 393216
buffer_store_dwordx4 v[128:131], v10, s[24:27], s28 offen sc1
s_add_u32 s28, s28, 1024
s_load_dword s64, s[80:81], 0
s_load_dword s65, s[80:81], 64
s_load_dword s66, s[80:81], 128
s_load_dword s67, s[80:81], 192
s_load_dword s68, s[80:81], 7168
s_load_dword s69, s[80:81], 7232
s_load_dword s70, s[80:81], 7296
s_load_dword s71, s[80:81], 7360
s_add_u32 s80, s80, 14336
s_addc_u32 s81, s81, 0
s_waitcnt vmcnt(16)
s_barrier
s_add_u32 m0, s39, 43008
s_mov_b64 exec, s[60:61]
buffer_load_dwordx4 v4, s[8:11], s37 offen lds
s_mov_b64 exec, -1
s_add_u32 m0, s39, 46080
s_nop 0
buffer_load_dwordx4 v5, s[8:11], s37 offen lds
s_add_u32 m0, s39, 49152
s_nop 0
buffer_load_dwordx4 v6, s[8:11], s37 offen lds
s_add_u32 m0, s39, 52224
s_nop 0
buffer_load_dwordx4 v7, s[8:11], s37 offen lds
s_add_u32 m0, s39, 55296
s_nop 0
buffer_load_dwordx4 v8, s[8:11], s37 offen lds
s_add_u32 m0, s39, 58368
s_nop 0
buffer_load_dwordx4 v9, s[8:11], s37 offen lds
s_add_u32 m0, s40, 43008
s_add_u32 s43, s38, 0
buffer_load_dwordx4 v2, s[12:15], s43 offen lds
s_add_u32 m0, s40, 44032
s_add_u32 s43, s38, 49152
buffer_load_dwordx4 v3, s[12:15], s43 offen lds
s_add_u32 m0, s40, 45056
s_add_u32 s43, s38, 98304
buffer_load_dwordx4 v2, s[12:15], s43 offen lds
s_add_u32 m0, s40, 46080
s_add_u32 s43, s38, 147456
buffer_load_dwordx4 v3, s[12:15], s43 offen lds
s_add_u32 m0, s40, 47104
s_add_u32 s43, s38, 196608
buffer_load_dwordx4 v2, s[12:15], s43 offen lds
s_add_u32 m0, s40, 48128
s_add_u32 s43, s38, 245760
buffer_load_dwordx4 v3, s[12:15], s43 offen lds
s_add_u32 m0, s40, 49152
s_add_u32 s43, s38, 294912
buffer_load_dwordx4 v2, s[12:15], s43 offen lds
s_add_u32 m0, s40, 50176
s_add_u32 s43, s38, 344064
buffer_load_dwordx4 v3, s[12:15], s43 offen lds
s_add_u32 s37, s37, 128
s_add_u32 s38, s38, 393216
buffer_store_dwordx4 v[128:131], v10, s[24:27], s28 offen sc1
s_add_u32 s28, s28, 1024
s_load_dword s64, s[80:81], 0
s_load_dword s65, s[80:81], 64
s_load_dword s66, s[80:81], 128
s_load_dword s67, s[80:81], 192
s_load_dword s68, s[80:81], 7168
s_load_dword s69, s[80:81], 7232
s_load_dword s70, s[80:81], 7296
s_load_dword s71, s[80:81], 7360
s_add_u32 s80, s80, 14336
s_addc_u32 s81, s81, 0
s_waitcnt vmcnt(16)
s_barrier
s_add_u32 m0, s39, 86016
s_mov_b64 exec, s[60:61]
buffer_load_dwordx4 v4, s[8:11], s37 offen lds
s_mov_b64 exec, -1
s_add_u32 m0, s39, 89088
s_nop 0
buffer_load_dwordx4 v5, s[8:11], s37 offen lds
s_add_u32 m0, s39, 92160
s_nop 0
buffer_load_dwordx4 v6, s[8:11], s37 offen lds
s_add_u32 m0, s39, 95232
s_nop 0
buffer_load_dwordx4 v7, s[8:11], s37 offen lds
s_add_u32 m0, s39, 98304
s_nop 0
buffer_load_dwordx4 v8, s[8:11], s37 offen lds
s_add_u32 m0, s39, 101376
s_nop 0
buffer_load_dwordx4 v9, s[8:11], s37 offen lds
s_add_u32 m0, s40, 86016
s_add_u32 s43, s38, 0
buffer_load_dwordx4 v2, s[12:15], s43 offen lds
s_add_u32 m0, s40, 87040
s_add_u32 s43, s38, 49152
buffer_load_dwordx4 v3, s[12:15], s43 offen lds
s_add_u32 m0, s40, 88064
s_add_u32 s43, s38, 98304
buffer_load_dwordx4 v2, s[12:15], s43 offen lds
s_add_u32 m0, s40, 89088
s_add_u32 s43, s38, 147456
buffer_load_dwordx4 v3, s[12:15], s43 offen lds
s_add_u32 m0, s40, 90112
s_add_u32 s43, s38, 196608
buffer_load_dwordx4 v2, s[12:15], s43 offen lds
s_add_u32 m0, s40, 91136
s_add_u32 s43, s38, 245760
buffer_load_dwordx4 v3, s[12:15], s43 offen lds
s_add_u32 m0, s40, 92160
s_add_u32 s43, s38, 294912
buffer_load_dwordx4 v2, s[12:15], s43 offen lds
s_add_u32 m0, s40, 93184
s_add_u32 s43, s38, 344064
buffer_load_dwordx4 v3, s[12:15], s43 offen lds
s_add_u32 s37, s37, 128
s_add_u32 s38, s38, 393216
s_load_dword s64, s[80:81], 0
s_load_dword s65, s[80:81], 64
s_load_dword s66, s[80:81], 128
s_load_dword s67, s[80:81], 192
s_load_dword s68, s[80:81], 7168
s_load_dword s69, s[80:81], 7232
s_load_dword s70, s[80:81], 7296
s_load_dword s71, s[80:81], 7360
s_add_u32 s80, s80, 14336
s_addc_u32 s81, s81, 0
s_waitcnt vmcnt(15)
s_barrier
s_add_u32 m0, s39, 0
s_mov_b64 exec, s[60:61]
buffer_load_dwordx4 v4, s[8:11], s37 offen lds
s_mov_b64 exec, -1
s_add_u32 m0, s39, 3072
s_nop 0
buffer_load_dwordx4 v5, s[8:11], s37 offen lds
s_add_u32 m0, s39, 6144
s_nop 0
buffer_load_dwordx4 v6, s[8:11], s37 offen lds
s_add_u32 m0, s39, 9216
s_nop 0
buffer_load_dwordx4 v7, s[8:11], s37 offen lds
s_add_u32 m0, s39, 12288
s_nop 0
buffer_load_dwordx4 v8, s[8:11], s37 offen lds
s_add_u32 m0, s39, 15360
s_nop 0
buffer_load_dwordx4 v9, s[8:11], s37 offen lds
s_add_u32 m0, s40, 0
s_add_u32 s43, s38, 0
buffer_load_dwordx4 v2, s[12:15], s43 offen lds
s_add_u32 m0, s40, 1024
s_add_u32 s43, s38, 49152
buffer_load_dwordx4 v3, s[12:15], s43 offen lds
s_add_u32 m0, s40, 2048
s_add_u32 s43, s38, 98304
buffer_load_dwordx4 v2, s[12:15], s43 offen lds
s_add_u32 m0, s40, 3072
s_add_u32 s43, s38, 147456
buffer_load_dwordx4 v3, s[12:15], s43 offen lds
s_add_u32 m0, s40, 4096
s_add_u32 s43, s38, 196608
buffer_load_dwordx4 v2, s[12:15], s43 offen lds
s_add_u32 m0, s40, 5120
s_add_u32 s43, s38, 245760
buffer_load_dwordx4 v3, s[12:15], s43 offen lds
s_add_u32 m0, s40, 6144
s_add_u32 s43, s38, 294912
buffer_load_dwordx4 v2, s[12:15], s43 offen lds
s_add_u32 m0, s40, 7168
s_add_u32 s43, s38, 344064
buffer_load_dwordx4 v3, s[12:15], s43 offen lds
s_add_u32 s37, s37, 128
s_add_u32 s38, s38, 393216
s_waitcnt vmcnt(14)
s_barrier
s_waitcnt vmcnt(0)
s_barrier
s_barrier
s_cmp_eq_u32 s47, 0
s_cbranch_scc1 Lx_17
s_cmp_eq_u32 s47, 1
s_cbranch_scc1 Lx_18
s_branch Lw_20
Lr_21:
s_branch Lx_19
Lx_18:
s_branch Lw_22
Lr_23:
s_branch Lx_19
Lx_17:
s_branch Lw_24
Lr_25:
Lx_19:
s_waitcnt lgkmcnt(0)
s_and_b32 s43, s36, 1
s_lshr_b32 s44, s36, 1
s_and_b32 s44, s44, 1
s_lshr_b32 s45, s36, 2
s_xor_b32 s45, s45, 1
v_lshlrev_b32 v14, 2, v13
v_sub_u32 v14, v12, v14
v_subrev_u32 v15, 0, v14
v_cmp_ge_u32 s[52:53], 7, v15
v_add_u32 v15, 16, v15
v_cmp_ge_u32 s[84:85], 7, v15
v_subrev_u32 v15, 1, v14
v_cmp_ge_u32 s[54:55], 7, v15
v_add_u32 v15, 16, v15
v_cmp_ge_u32 s[86:87], 7, v15
v_subrev_u32 v15, 2, v14
v_cmp_ge_u32 s[56:57], 7, v15
v_add_u32 v15, 16, v15
v_cmp_ge_u32 s[88:89], 7, v15
v_subrev_u32 v15, 3, v14
v_cmp_ge_u32 s[58:59], 7, v15
v_add_u32 v15, 16, v15
v_cmp_ge_u32 s[90:91], 7, v15
s_lshl_b32 s46, s45, 6
s_add_u32 s46, s46, s44
s_add_u32 s46, s46, 16
v_lshl_add_u32 v14, v12, 1, s46
s_lshl_b32 s47, s43, 6
v_lshl_add_u32 v15, v13, 4, s47
v_mul_u32_u24 v20, 400, v14
v_add_u32 v20, v20, v15
v_subrev_u32 v16, 32, v14
v_max_i32 v16, 0, v16
v_mul_u32_u24 v21, 400, v16
v_add_u32 v21, v21, v15
v_lshrrev_b32 v16, 2, v12
v_lshl_add_u32 v16, v13, 2, v16
v_lshl_add_u32 v16, v16, 1, s46
v_and_b32 v17, 3, v1
v_lshl_add_u32 v17, v17, 3, s47
v_mul_u32_u24 v22, 400, v16
v_add_u32 v22, v22, v17
v_subrev_u32 v16, 32, v16
v_max_i32 v16, 0, v16
v_mul_u32_u24 v23, 400, v16
v_add_u32 v23, v23, v17
s_lshl_b32 s60, s43, 13
s_lshl_b32 s61, s45, 10
s_add_u32 s60, s60, s61
s_lshl_b32 s61, s44, 8
s_add_u32 s60, s60, s61
v_lshlrev_b32 v27, 11, v13
v_lshl_add_u32 v27, v12, 4, v27
v_add_u32 v27, s60, v27
v_mov_b32 v28, 0xff800000
s_mov_b32 s61, 0x3e8293ee
s_nop 2
s_or_b32 s62, s34, s45
s_cmp_lg_u32 s62, 0
s_cselect_b64 s[64:65], s[84:85], 0
s_cselect_b64 s[66:67], s[86:87], 0
s_cselect_b64 s[68:69], s[88:89], 0
s_cselect_b64 s[70:71], s[90:91], 0
s_branch Latt_5
.p2align 3
Lcons_2:
s_lshr_b32 s44, s2, 3
s_lshr_b32 s43, s36, 1
s_lshl_b32 s43, s43, 2
s_add_u32 s43, s43, s44
s_lshr_b32 s46, s43, 2
s_cmp_eq_u32 s46, 3
s_cselect_b32 s46, 1, 0
s_lshr_b32 s44, s36, 1
s_cmp_lg_u32 s46, s44
s_cbranch_scc1 Lsp_6
s_mov_b32 s44, s43
s_cmp_ge_u32 s2, 128
s_cbranch_scc1 Lsp_6
s_mov_b32 s84, s6
s_mov_b32 s85, s7
s_mov_b32 s86, 6291456
s_mov_b32 s87, 0x20000
s_and_b32 s43, s35, 8
s_or_b32 s43, s43, 3
s_lshl_b32 s43, s43, 7
s_mul_i32 s44, s44, 196608
s_add_u32 s43, s43, s44
s_and_b32 s44, s36, 1
s_lshl_b32 s44, s44, 6
v_add_u32 v15, s44, v1
v_min_u32 v15, 95, v15
v_mul_u32_u24 v16, 21846, v15
v_lshrrev_b32 v16, 16, v16
v_mul_u32_u24 v17, 3, v16
v_sub_u32 v15, v15, v17
v_mul_u32_u24 v16, 6144, v16
v_lshl_add_u32 v15, v15, 11, v16
buffer_load_dword v31, v15, s[84:87], s43 offen
Lsp_6:
v_lshrrev_b32 v16, 1, v12
v_xor_b32 v15, v13, v16
v_lshlrev_b32 v15, 4, v15
v_lshl_add_u32 v2, v12, 7, v15
v_xor_b32 v3, 64, v2
v_add_u32 v4, 86016, v2
v_add_u32 v5, 86016, v3
v_lshrrev_b32 v15, 2, v12
v_and_b32 v16, 3, v1
v_lshl_add_u32 v19, v13, 3, v15
v_lshlrev_b32 v19, 7, v19
v_and_b32 v15, 2, v15
v_and_b32 v17, 1, v13
v_lshl_add_u32 v15, v17, 2, v15
v_lshrrev_b32 v17, 1, v16
s_lshl_b32 s43, s36, 1
v_add_u32 v17, s43, v17
v_xor_b32 v15, v15, v17
v_lshl_add_u32 v19, v15, 4, v19
v_and_b32 v16, 1, v16
v_lshl_add_u32 v19, v16, 3, v19
v_add_u32 v6, 18432, v19
v_add_u32 v7, 61440, v19
v_add_u32 v8, 104448, v19
v_mov_b32 v128, 0
v_mov_b32 v129, 0
v_mov_b32 v130, 0
v_mov_b32 v131, 0
v_mov_b32 v132, 0
v_mov_b32 v133, 0
v_mov_b32 v134, 0
v_mov_b32 v135, 0
v_mov_b32 v136, 0
v_mov_b32 v137, 0
v_mov_b32 v138, 0
v_mov_b32 v139, 0
v_mov_b32 v140, 0
v_mov_b32 v141, 0
v_mov_b32 v142, 0
v_mov_b32 v143, 0
v_mov_b32 v144, 0
v_mov_b32 v145, 0
v_mov_b32 v146, 0
v_mov_b32 v147, 0
v_mov_b32 v148, 0
v_mov_b32 v149, 0
v_mov_b32 v150, 0
v_mov_b32 v151, 0
v_mov_b32 v152, 0
v_mov_b32 v153, 0
v_mov_b32 v154, 0
v_mov_b32 v155, 0
v_mov_b32 v156, 0
v_mov_b32 v157, 0
v_mov_b32 v158, 0
v_mov_b32 v159, 0
v_mov_b32 v160, 0
v_mov_b32 v161, 0
v_mov_b32 v162, 0
v_mov_b32 v163, 0
v_mov_b32 v164, 0
v_mov_b32 v165, 0
v_mov_b32 v166, 0
v_mov_b32 v167, 0
v_mov_b32 v168, 0
v_mov_b32 v169, 0
v_mov_b32 v170, 0
v_mov_b32 v171, 0
v_mov_b32 v172, 0
v_mov_b32 v173, 0
v_mov_b32 v174, 0
v_mov_b32 v175, 0
v_mov_b32 v176, 0
v_mov_b32 v177, 0
v_mov_b32 v178, 0
v_mov_b32 v179, 0
v_mov_b32 v180, 0
v_mov_b32 v181, 0
v_mov_b32 v182, 0
v_mov_b32 v183, 0
v_mov_b32 v184, 0
v_mov_b32 v185, 0
v_mov_b32 v186, 0
v_mov_b32 v187, 0
v_mov_b32 v188, 0
v_mov_b32 v189, 0
v_mov_b32 v190, 0
v_mov_b32 v191, 0
v_mov_b32 v192, 0
v_mov_b32 v193, 0
v_mov_b32 v194, 0
v_mov_b32 v195, 0
v_mov_b32 v196, 0
v_mov_b32 v197, 0
v_mov_b32 v198, 0
v_mov_b32 v199, 0
v_mov_b32 v200, 0
v_mov_b32 v201, 0
v_mov_b32 v202, 0
v_mov_b32 v203, 0
v_mov_b32 v204, 0
v_mov_b32 v205, 0
v_mov_b32 v206, 0
v_mov_b32 v207, 0
v_mov_b32 v208, 0
v_mov_b32 v209, 0
v_mov_b32 v210, 0
v_mov_b32 v211, 0
v_mov_b32 v212, 0
v_mov_b32 v213, 0
v_mov_b32 v214, 0
v_mov_b32 v215, 0
v_mov_b32 v216, 0
v_mov_b32 v217, 0
v_mov_b32 v218, 0
v_mov_b32 v219, 0
v_mov_b32 v220, 0
v_mov_b32 v221, 0
v_mov_b32 v222, 0
v_mov_b32 v223, 0
v_mov_b32 v224, 0
v_mov_b32 v225, 0
v_mov_b32 v226, 0
v_mov_b32 v227, 0
v_mov_b32 v228, 0
v_mov_b32 v229, 0
v_mov_b32 v230, 0
v_mov_b32 v231, 0
v_mov_b32 v232, 0
v_mov_b32 v233, 0
v_mov_b32 v234, 0
v_mov_b32 v235, 0
s_and_b32 s43, s36, 1
s_lshr_b32 s44, s36, 1
s_and_b32 s44, s44, 1
s_lshr_b32 s45, s36, 2
s_xor_b32 s45, s45, 1
v_lshlrev_b32 v14, 2, v13
v_sub_u32 v14, v12, v14
v_subrev_u32 v15, 0, v14
v_cmp_ge_u32 s[52:53], 7, v15
v_add_u32 v15, 16, v15
v_cmp_ge_u32 s[84:85], 7, v15
v_subrev_u32 v15, 1, v14
v_cmp_ge_u32 s[54:55], 7, v15
v_add_u32 v15, 16, v15
v_cmp_ge_u32 s[86:87], 7, v15
v_subrev_u32 v15, 2, v14
v_cmp_ge_u32 s[56:57], 7, v15
v_add_u32 v15, 16, v15
v_cmp_ge_u32 s[88:89], 7, v15
v_subrev_u32 v15, 3, v14
v_cmp_ge_u32 s[58:59], 7, v15
v_add_u32 v15, 16, v15
v_cmp_ge_u32 s[90:91], 7, v15
s_lshl_b32 s46, s45, 6
s_add_u32 s46, s46, s44
s_add_u32 s46, s46, 16
v_lshl_add_u32 v14, v12, 1, s46
s_lshl_b32 s47, s43, 6
v_lshl_add_u32 v15, v13, 4, s47
v_mul_u32_u24 v20, 400, v14
v_add_u32 v20, v20, v15
v_subrev_u32 v16, 32, v14
v_max_i32 v16, 0, v16
v_mul_u32_u24 v21, 400, v16
v_add_u32 v21, v21, v15
v_lshrrev_b32 v16, 2, v12
v_lshl_add_u32 v16, v13, 2, v16
v_lshl_add_u32 v16, v16, 1, s46
v_and_b32 v17, 3, v1
v_lshl_add_u32 v17, v17, 3, s47
v_mul_u32_u24 v22, 400, v16
v_add_u32 v22, v22, v17
v_subrev_u32 v16, 32, v16
v_max_i32 v16, 0, v16
v_mul_u32_u24 v23, 400, v16
v_add_u32 v23, v23, v17
s_lshl_b32 s60, s43, 13
s_lshl_b32 s61, s45, 10
s_add_u32 s60, s60, s61
s_lshl_b32 s61, s44, 8
s_add_u32 s60, s60, s61
v_lshlrev_b32 v27, 11, v13
v_lshl_add_u32 v27, v12, 4, v27
v_add_u32 v27, s60, v27
v_mov_b32 v28, 0xff800000
s_mov_b32 s61, 0x3e8293ee
s_nop 2
s_or_b32 s62, s34, s45
s_cmp_lg_u32 s62, 0
s_cselect_b64 s[64:65], s[84:85], 0
s_cselect_b64 s[66:67], s[86:87], 0
s_cselect_b64 s[68:69], s[88:89], 0
s_cselect_b64 s[70:71], s[90:91], 0
s_lshl_b32 s43, s36, 5
s_add_u32 s43, s43, 16
v_lshl_add_u32 v10, v12, 1, s43
v_lshlrev_b32 v10, 7, v10
v_and_b32 v16, 1, v13
v_lshlrev_b32 v16, 1, v16
v_lshrrev_b32 v17, 1, v13
v_add_u32 v16, v16, v17
v_and_b32 v17, 7, v12
v_xor_b32 v16, v16, v17
v_lshl_add_u32 v10, v16, 4, v10
s_mov_b32 s42, s35
v_lshlrev_b32 v9, 3, v12
v_add_u32 v9, 129024, v9
v_mul_u32_u24 v14, 400, v12
v_lshl_add_u32 v14, v13, 3, v14
s_lshl_b32 s43, s36, 5
v_add_u32 v14, s43, v14
s_barrier
ds_read_b128 v[32:35], v2 offset:0
ds_read_b64_tr_b16 v[72:73], v6 offset:8192
ds_read_b64_tr_b16 v[74:75], v6 offset:8704
ds_read_b64_tr_b16 v[76:77], v6 offset:16384
ds_read_b64_tr_b16 v[78:79], v6 offset:16896
ds_read_b64_tr_b16 v[68:69], v6 offset:0
ds_read_b64_tr_b16 v[70:71], v6 offset:512
ds_read_b128 v[36:39], v2 offset:2048
ds_read_b128 v[40:43], v2 offset:4096
ds_read_b128 v[44:47], v2 offset:6144
ds_read_b128 v[48:51], v2 offset:8192
ds_read_b128 v[52:55], v2 offset:10240
ds_read_b128 v[56:59], v2 offset:12288
ds_read_b128 v[60:63], v2 offset:14336
ds_read_b128 v[64:67], v2 offset:16384
s_mov_b32 s41, 5
.p2align 3
Lcl_7:
s_waitcnt lgkmcnt(0)
v_mfma_f32_16x16x32_bf16 v[164:167], v[72:75], v[32:35], v[164:167]
ds_read_b128 v[80:83], v3 offset:0
v_mfma_f32_16x16x32_bf16 v[200:203], v[76:79], v[32:35], v[200:203]
ds_read_b64_tr_b16 v[120:121], v6 offset:12288
v_mfma_f32_16x16x32_bf16 v[128:131], v[68:71], v[32:35], v[128:131]
ds_read_b64_tr_b16 v[122:123], v6 offset:12800
v_mfma_f32_16x16x32_bf16 v[168:171], v[72:75], v[36:39], v[168:171]
ds_read_b64_tr_b16 v[124:125], v6 offset:20480
v_mfma_f32_16x16x32_bf16 v[204:207], v[76:79], v[36:39], v[204:207]
ds_read_b64_tr_b16 v[126:127], v6 offset:20992
v_mfma_f32_16x16x32_bf16 v[132:135], v[68:71], v[36:39], v[132:135]
ds_read_b64_tr_b16 v[116:117], v6 offset:4096
v_mfma_f32_16x16x32_bf16 v[172:175], v[72:75], v[40:43], v[172:175]
ds_read_b64_tr_b16 v[118:119], v6 offset:4608
v_mfma_f32_16x16x32_bf16 v[208:211], v[76:79], v[40:43], v[208:211]
ds_read_b128 v[84:87], v3 offset:2048
v_mfma_f32_16x16x32_bf16 v[136:139], v[68:71], v[40:43], v[136:139]
ds_read_b128 v[88:91], v3 offset:4096
v_mfma_f32_16x16x32_bf16 v[176:179], v[72:75], v[44:47], v[176:179]
ds_read_b128 v[92:95], v3 offset:6144
v_mfma_f32_16x16x32_bf16 v[212:215], v[76:79], v[44:47], v[212:215]
ds_read_b128 v[96:99], v3 offset:8192
v_mfma_f32_16x16x32_bf16 v[140:143], v[68:71], v[44:47], v[140:143]
ds_read_b128 v[100:103], v3 offset:10240
v_mfma_f32_16x16x32_bf16 v[180:183], v[72:75], v[48:51], v[180:183]
ds_read_b128 v[104:107], v3 offset:12288
v_mfma_f32_16x16x32_bf16 v[216:219], v[76:79], v[48:51], v[216:219]
ds_read_b128 v[108:111], v3 offset:14336
v_mfma_f32_16x16x32_bf16 v[144:147], v[68:71], v[48:51], v[144:147]
ds_read_b128 v[112:115], v3 offset:16384
v_mfma_f32_16x16x32_bf16 v[184:187], v[72:75], v[52:55], v[184:187]
v_mfma_f32_16x16x32_bf16 v[220:223], v[76:79], v[52:55], v[220:223]
v_mfma_f32_16x16x32_bf16 v[148:151], v[68:71], v[52:55], v[148:151]
v_mfma_f32_16x16x32_bf16 v[188:191], v[72:75], v[56:59], v[188:191]
v_mfma_f32_16x16x32_bf16 v[224:227], v[76:79], v[56:59], v[224:227]
v_mfma_f32_16x16x32_bf16 v[152:155], v[68:71], v[56:59], v[152:155]
v_mfma_f32_16x16x32_bf16 v[192:195], v[72:75], v[60:63], v[192:195]
v_mfma_f32_16x16x32_bf16 v[228:231], v[76:79], v[60:63], v[228:231]
s_sub_u32 s42, s42, 1
s_cbranch_scc1 Lxr_8
Lxb_9:
v_mfma_f32_16x16x32_bf16 v[156:159], v[68:71], v[60:63], v[156:159]
v_mfma_f32_16x16x32_bf16 v[196:199], v[72:75], v[64:67], v[196:199]
v_mfma_f32_16x16x32_bf16 v[232:235], v[76:79], v[64:67], v[232:235]
v_mfma_f32_16x16x32_bf16 v[160:163], v[68:71], v[64:67], v[160:163]
s_waitcnt lgkmcnt(0)
s_barrier
v_mfma_f32_16x16x32_bf16 v[164:167], v[120:123], v[80:83], v[164:167]
ds_read_b128 v[32:35], v2 offset:43008
v_mfma_f32_16x16x32_bf16 v[200:203], v[124:127], v[80:83], v[200:203]
ds_read_b64_tr_b16 v[72:73], v7 offset:8192
v_mfma_f32_16x16x32_bf16 v[128:131], v[116:119], v[80:83], v[128:131]
ds_read_b64_tr_b16 v[74:75], v7 offset:8704
v_mfma_f32_16x16x32_bf16 v[168:171], v[120:123], v[84:87], v[168:171]
ds_read_b64_tr_b16 v[76:77], v7 offset:16384
v_mfma_f32_16x16x32_bf16 v[204:207], v[124:127], v[84:87], v[204:207]
ds_read_b64_tr_b16 v[78:79], v7 offset:16896
v_mfma_f32_16x16x32_bf16 v[132:135], v[116:119], v[84:87], v[132:135]
ds_read_b64_tr_b16 v[68:69], v7 offset:0
v_mfma_f32_16x16x32_bf16 v[172:175], v[120:123], v[88:91], v[172:175]
ds_read_b64_tr_b16 v[70:71], v7 offset:512
v_mfma_f32_16x16x32_bf16 v[208:211], v[124:127], v[88:91], v[208:211]
ds_read_b128 v[36:39], v2 offset:45056
v_mfma_f32_16x16x32_bf16 v[136:139], v[116:119], v[88:91], v[136:139]
ds_read_b128 v[40:43], v2 offset:47104
v_mfma_f32_16x16x32_bf16 v[176:179], v[120:123], v[92:95], v[176:179]
ds_read_b128 v[44:47], v2 offset:49152
v_mfma_f32_16x16x32_bf16 v[212:215], v[124:127], v[92:95], v[212:215]
ds_read_b128 v[48:51], v2 offset:51200
v_mfma_f32_16x16x32_bf16 v[140:143], v[116:119], v[92:95], v[140:143]
ds_read_b128 v[52:55], v2 offset:53248
v_mfma_f32_16x16x32_bf16 v[180:183], v[120:123], v[96:99], v[180:183]
ds_read_b128 v[56:59], v2 offset:55296
v_mfma_f32_16x16x32_bf16 v[216:219], v[124:127], v[96:99], v[216:219]
ds_read_b128 v[60:63], v2 offset:57344
v_mfma_f32_16x16x32_bf16 v[144:147], v[116:119], v[96:99], v[144:147]
ds_read_b128 v[64:67], v2 offset:59392
v_mfma_f32_16x16x32_bf16 v[184:187], v[120:123], v[100:103], v[184:187]
v_mfma_f32_16x16x32_bf16 v[220:223], v[124:127], v[100:103], v[220:223]
v_mfma_f32_16x16x32_bf16 v[148:151], v[116:119], v[100:103], v[148:151]
v_mfma_f32_16x16x32_bf16 v[188:191], v[120:123], v[104:107], v[188:191]
v_mfma_f32_16x16x32_bf16 v[224:227], v[124:127], v[104:107], v[224:227]
v_mfma_f32_16x16x32_bf16 v[152:155], v[116:119], v[104:107], v[152:155]
v_mfma_f32_16x16x32_bf16 v[192:195], v[120:123], v[108:111], v[192:195]
v_mfma_f32_16x16x32_bf16 v[228:231], v[124:127], v[108:111], v[228:231]
v_mfma_f32_16x16x32_bf16 v[156:159], v[116:119], v[108:111], v[156:159]
v_mfma_f32_16x16x32_bf16 v[196:199], v[120:123], v[112:115], v[196:199]
v_mfma_f32_16x16x32_bf16 v[232:235], v[124:127], v[112:115], v[232:235]
v_mfma_f32_16x16x32_bf16 v[160:163], v[116:119], v[112:115], v[160:163]
s_waitcnt lgkmcnt(0)
v_mfma_f32_16x16x32_bf16 v[164:167], v[72:75], v[32:35], v[164:167]
ds_read_b128 v[80:83], v3 offset:43008
v_mfma_f32_16x16x32_bf16 v[200:203], v[76:79], v[32:35], v[200:203]
ds_read_b64_tr_b16 v[120:121], v7 offset:12288
v_mfma_f32_16x16x32_bf16 v[128:131], v[68:71], v[32:35], v[128:131]
ds_read_b64_tr_b16 v[122:123], v7 offset:12800
v_mfma_f32_16x16x32_bf16 v[168:171], v[72:75], v[36:39], v[168:171]
ds_read_b64_tr_b16 v[124:125], v7 offset:20480
v_mfma_f32_16x16x32_bf16 v[204:207], v[76:79], v[36:39], v[204:207]
ds_read_b64_tr_b16 v[126:127], v7 offset:20992
v_mfma_f32_16x16x32_bf16 v[132:135], v[68:71], v[36:39], v[132:135]
ds_read_b64_tr_b16 v[116:117], v7 offset:4096
v_mfma_f32_16x16x32_bf16 v[172:175], v[72:75], v[40:43], v[172:175]
ds_read_b64_tr_b16 v[118:119], v7 offset:4608
v_mfma_f32_16x16x32_bf16 v[208:211], v[76:79], v[40:43], v[208:211]
ds_read_b128 v[84:87], v3 offset:45056
v_mfma_f32_16x16x32_bf16 v[136:139], v[68:71], v[40:43], v[136:139]
ds_read_b128 v[88:91], v3 offset:47104
v_mfma_f32_16x16x32_bf16 v[176:179], v[72:75], v[44:47], v[176:179]
ds_read_b128 v[92:95], v3 offset:49152
v_mfma_f32_16x16x32_bf16 v[212:215], v[76:79], v[44:47], v[212:215]
ds_read_b128 v[96:99], v3 offset:51200
v_mfma_f32_16x16x32_bf16 v[140:143], v[68:71], v[44:47], v[140:143]
ds_read_b128 v[100:103], v3 offset:53248
v_mfma_f32_16x16x32_bf16 v[180:183], v[72:75], v[48:51], v[180:183]
ds_read_b128 v[104:107], v3 offset:55296
v_mfma_f32_16x16x32_bf16 v[216:219], v[76:79], v[48:51], v[216:219]
ds_read_b128 v[108:111], v3 offset:57344
v_mfma_f32_16x16x32_bf16 v[144:147], v[68:71], v[48:51], v[144:147]
ds_read_b128 v[112:115], v3 offset:59392
v_mfma_f32_16x16x32_bf16 v[184:187], v[72:75], v[52:55], v[184:187]
v_mfma_f32_16x16x32_bf16 v[220:223], v[76:79], v[52:55], v[220:223]
v_mfma_f32_16x16x32_bf16 v[148:151], v[68:71], v[52:55], v[148:151]
v_mfma_f32_16x16x32_bf16 v[188:191], v[72:75], v[56:59], v[188:191]
v_mfma_f32_16x16x32_bf16 v[224:227], v[76:79], v[56:59], v[224:227]
v_mfma_f32_16x16x32_bf16 v[152:155], v[68:71], v[56:59], v[152:155]
v_mfma_f32_16x16x32_bf16 v[192:195], v[72:75], v[60:63], v[192:195]
v_mfma_f32_16x16x32_bf16 v[228:231], v[76:79], v[60:63], v[228:231]
s_sub_u32 s42, s42, 1
s_cbranch_scc1 Lxr_10
Lxb_11:
v_mfma_f32_16x16x32_bf16 v[156:159], v[68:71], v[60:63], v[156:159]
v_mfma_f32_16x16x32_bf16 v[196:199], v[72:75], v[64:67], v[196:199]
v_mfma_f32_16x16x32_bf16 v[232:235], v[76:79], v[64:67], v[232:235]
v_mfma_f32_16x16x32_bf16 v[160:163], v[68:71], v[64:67], v[160:163]
s_waitcnt lgkmcnt(0)
s_barrier
v_mfma_f32_16x16x32_bf16 v[164:167], v[120:123], v[80:83], v[164:167]
ds_read_b128 v[32:35], v4 offset:0
v_mfma_f32_16x16x32_bf16 v[200:203], v[124:127], v[80:83], v[200:203]
ds_read_b64_tr_b16 v[72:73], v8 offset:8192
v_mfma_f32_16x16x32_bf16 v[128:131], v[116:119], v[80:83], v[128:131]
ds_read_b64_tr_b16 v[74:75], v8 offset:8704
v_mfma_f32_16x16x32_bf16 v[168:171], v[120:123], v[84:87], v[168:171]
ds_read_b64_tr_b16 v[76:77], v8 offset:16384
v_mfma_f32_16x16x32_bf16 v[204:207], v[124:127], v[84:87], v[204:207]
ds_read_b64_tr_b16 v[78:79], v8 offset:16896
v_mfma_f32_16x16x32_bf16 v[132:135], v[116:119], v[84:87], v[132:135]
ds_read_b64_tr_b16 v[68:69], v8 offset:0
v_mfma_f32_16x16x32_bf16 v[172:175], v[120:123], v[88:91], v[172:175]
ds_read_b64_tr_b16 v[70:71], v8 offset:512
v_mfma_f32_16x16x32_bf16 v[208:211], v[124:127], v[88:91], v[208:211]
ds_read_b128 v[36:39], v4 offset:2048
v_mfma_f32_16x16x32_bf16 v[136:139], v[116:119], v[88:91], v[136:139]
ds_read_b128 v[40:43], v4 offset:4096
v_mfma_f32_16x16x32_bf16 v[176:179], v[120:123], v[92:95], v[176:179]
ds_read_b128 v[44:47], v4 offset:6144
v_mfma_f32_16x16x32_bf16 v[212:215], v[124:127], v[92:95], v[212:215]
ds_read_b128 v[48:51], v4 offset:8192
v_mfma_f32_16x16x32_bf16 v[140:143], v[116:119], v[92:95], v[140:143]
ds_read_b128 v[52:55], v4 offset:10240
v_mfma_f32_16x16x32_bf16 v[180:183], v[120:123], v[96:99], v[180:183]
ds_read_b128 v[56:59], v4 offset:12288
v_mfma_f32_16x16x32_bf16 v[216:219], v[124:127], v[96:99], v[216:219]
ds_read_b128 v[60:63], v4 offset:14336
v_mfma_f32_16x16x32_bf16 v[144:147], v[116:119], v[96:99], v[144:147]
ds_read_b128 v[64:67], v4 offset:16384
v_mfma_f32_16x16x32_bf16 v[184:187], v[120:123], v[100:103], v[184:187]
v_mfma_f32_16x16x32_bf16 v[220:223], v[124:127], v[100:103], v[220:223]
v_mfma_f32_16x16x32_bf16 v[148:151], v[116:119], v[100:103], v[148:151]
v_mfma_f32_16x16x32_bf16 v[188:191], v[120:123], v[104:107], v[188:191]
v_mfma_f32_16x16x32_bf16 v[224:227], v[124:127], v[104:107], v[224:227]
v_mfma_f32_16x16x32_bf16 v[152:155], v[116:119], v[104:107], v[152:155]
v_mfma_f32_16x16x32_bf16 v[192:195], v[120:123], v[108:111], v[192:195]
v_mfma_f32_16x16x32_bf16 v[228:231], v[124:127], v[108:111], v[228:231]
v_mfma_f32_16x16x32_bf16 v[156:159], v[116:119], v[108:111], v[156:159]
v_mfma_f32_16x16x32_bf16 v[196:199], v[120:123], v[112:115], v[196:199]
v_mfma_f32_16x16x32_bf16 v[232:235], v[124:127], v[112:115], v[232:235]
v_mfma_f32_16x16x32_bf16 v[160:163], v[116:119], v[112:115], v[160:163]
s_waitcnt lgkmcnt(0)
v_mfma_f32_16x16x32_bf16 v[164:167], v[72:75], v[32:35], v[164:167]
ds_read_b128 v[80:83], v5 offset:0
v_mfma_f32_16x16x32_bf16 v[200:203], v[76:79], v[32:35], v[200:203]
ds_read_b64_tr_b16 v[120:121], v8 offset:12288
v_mfma_f32_16x16x32_bf16 v[128:131], v[68:71], v[32:35], v[128:131]
ds_read_b64_tr_b16 v[122:123], v8 offset:12800
v_mfma_f32_16x16x32_bf16 v[168:171], v[72:75], v[36:39], v[168:171]
ds_read_b64_tr_b16 v[124:125], v8 offset:20480
v_mfma_f32_16x16x32_bf16 v[204:207], v[76:79], v[36:39], v[204:207]
ds_read_b64_tr_b16 v[126:127], v8 offset:20992
v_mfma_f32_16x16x32_bf16 v[132:135], v[68:71], v[36:39], v[132:135]
ds_read_b64_tr_b16 v[116:117], v8 offset:4096
v_mfma_f32_16x16x32_bf16 v[172:175], v[72:75], v[40:43], v[172:175]
ds_read_b64_tr_b16 v[118:119], v8 offset:4608
v_mfma_f32_16x16x32_bf16 v[208:211], v[76:79], v[40:43], v[208:211]
ds_read_b128 v[84:87], v5 offset:2048
v_mfma_f32_16x16x32_bf16 v[136:139], v[68:71], v[40:43], v[136:139]
ds_read_b128 v[88:91], v5 offset:4096
v_mfma_f32_16x16x32_bf16 v[176:179], v[72:75], v[44:47], v[176:179]
ds_read_b128 v[92:95], v5 offset:6144
v_mfma_f32_16x16x32_bf16 v[212:215], v[76:79], v[44:47], v[212:215]
ds_read_b128 v[96:99], v5 offset:8192
v_mfma_f32_16x16x32_bf16 v[140:143], v[68:71], v[44:47], v[140:143]
ds_read_b128 v[100:103], v5 offset:10240
v_mfma_f32_16x16x32_bf16 v[180:183], v[72:75], v[48:51], v[180:183]
ds_read_b128 v[104:107], v5 offset:12288
v_mfma_f32_16x16x32_bf16 v[216:219], v[76:79], v[48:51], v[216:219]
ds_read_b128 v[108:111], v5 offset:14336
v_mfma_f32_16x16x32_bf16 v[144:147], v[68:71], v[48:51], v[144:147]
ds_read_b128 v[112:115], v5 offset:16384
v_mfma_f32_16x16x32_bf16 v[184:187], v[72:75], v[52:55], v[184:187]
v_mfma_f32_16x16x32_bf16 v[220:223], v[76:79], v[52:55], v[220:223]
v_mfma_f32_16x16x32_bf16 v[148:151], v[68:71], v[52:55], v[148:151]
v_mfma_f32_16x16x32_bf16 v[188:191], v[72:75], v[56:59], v[188:191]
v_mfma_f32_16x16x32_bf16 v[224:227], v[76:79], v[56:59], v[224:227]
v_mfma_f32_16x16x32_bf16 v[152:155], v[68:71], v[56:59], v[152:155]
v_mfma_f32_16x16x32_bf16 v[192:195], v[72:75], v[60:63], v[192:195]
v_mfma_f32_16x16x32_bf16 v[228:231], v[76:79], v[60:63], v[228:231]
s_sub_u32 s42, s42, 1
s_cbranch_scc1 Lxr_12
Lxb_13:
v_mfma_f32_16x16x32_bf16 v[156:159], v[68:71], v[60:63], v[156:159]
v_mfma_f32_16x16x32_bf16 v[196:199], v[72:75], v[64:67], v[196:199]
v_mfma_f32_16x16x32_bf16 v[232:235], v[76:79], v[64:67], v[232:235]
v_mfma_f32_16x16x32_bf16 v[160:163], v[68:71], v[64:67], v[160:163]
s_waitcnt lgkmcnt(0)
s_barrier
v_mfma_f32_16x16x32_bf16 v[164:167], v[120:123], v[80:83], v[164:167]
ds_read_b128 v[32:35], v2 offset:0
v_mfma_f32_16x16x32_bf16 v[200:203], v[124:127], v[80:83], v[200:203]
ds_read_b64_tr_b16 v[72:73], v6 offset:8192
v_mfma_f32_16x16x32_bf16 v[128:131], v[116:119], v[80:83], v[128:131]
ds_read_b64_tr_b16 v[74:75], v6 offset:8704
v_mfma_f32_16x16x32_bf16 v[168:171], v[120:123], v[84:87], v[168:171]
ds_read_b64_tr_b16 v[76:77], v6 offset:16384
v_mfma_f32_16x16x32_bf16 v[204:207], v[124:127], v[84:87], v[204:207]
ds_read_b64_tr_b16 v[78:79], v6 offset:16896
v_mfma_f32_16x16x32_bf16 v[132:135], v[116:119], v[84:87], v[132:135]
ds_read_b64_tr_b16 v[68:69], v6 offset:0
v_mfma_f32_16x16x32_bf16 v[172:175], v[120:123], v[88:91], v[172:175]
ds_read_b64_tr_b16 v[70:71], v6 offset:512
v_mfma_f32_16x16x32_bf16 v[208:211], v[124:127], v[88:91], v[208:211]
ds_read_b128 v[36:39], v2 offset:2048
v_mfma_f32_16x16x32_bf16 v[136:139], v[116:119], v[88:91], v[136:139]
ds_read_b128 v[40:43], v2 offset:4096
v_mfma_f32_16x16x32_bf16 v[176:179], v[120:123], v[92:95], v[176:179]
ds_read_b128 v[44:47], v2 offset:6144
v_mfma_f32_16x16x32_bf16 v[212:215], v[124:127], v[92:95], v[212:215]
ds_read_b128 v[48:51], v2 offset:8192
v_mfma_f32_16x16x32_bf16 v[140:143], v[116:119], v[92:95], v[140:143]
ds_read_b128 v[52:55], v2 offset:10240
v_mfma_f32_16x16x32_bf16 v[180:183], v[120:123], v[96:99], v[180:183]
ds_read_b128 v[56:59], v2 offset:12288
v_mfma_f32_16x16x32_bf16 v[216:219], v[124:127], v[96:99], v[216:219]
ds_read_b128 v[60:63], v2 offset:14336
v_mfma_f32_16x16x32_bf16 v[144:147], v[116:119], v[96:99], v[144:147]
ds_read_b128 v[64:67], v2 offset:16384
v_mfma_f32_16x16x32_bf16 v[184:187], v[120:123], v[100:103], v[184:187]
v_mfma_f32_16x16x32_bf16 v[220:223], v[124:127], v[100:103], v[220:223]
v_mfma_f32_16x16x32_bf16 v[148:151], v[116:119], v[100:103], v[148:151]
v_mfma_f32_16x16x32_bf16 v[188:191], v[120:123], v[104:107], v[188:191]
v_mfma_f32_16x16x32_bf16 v[224:227], v[124:127], v[104:107], v[224:227]
v_mfma_f32_16x16x32_bf16 v[152:155], v[116:119], v[104:107], v[152:155]
v_mfma_f32_16x16x32_bf16 v[192:195], v[120:123], v[108:111], v[192:195]
v_mfma_f32_16x16x32_bf16 v[228:231], v[124:127], v[108:111], v[228:231]
v_mfma_f32_16x16x32_bf16 v[156:159], v[116:119], v[108:111], v[156:159]
v_mfma_f32_16x16x32_bf16 v[196:199], v[120:123], v[112:115], v[196:199]
v_mfma_f32_16x16x32_bf16 v[232:235], v[124:127], v[112:115], v[232:235]
v_mfma_f32_16x16x32_bf16 v[160:163], v[116:119], v[112:115], v[160:163]
s_sub_u32 s41, s41, 1
s_cmp_lg_u32 s41, 0
s_cbranch_scc1 Lcl_7
s_waitcnt lgkmcnt(0)
v_mfma_f32_16x16x32_bf16 v[164:167], v[72:75], v[32:35], v[164:167]
ds_read_b128 v[80:83], v3 offset:0
v_mfma_f32_16x16x32_bf16 v[200:203], v[76:79], v[32:35], v[200:203]
ds_read_b64_tr_b16 v[120:121], v6 offset:12288
v_mfma_f32_16x16x32_bf16 v[128:131], v[68:71], v[32:35], v[128:131]
ds_read_b64_tr_b16 v[122:123], v6 offset:12800
v_mfma_f32_16x16x32_bf16 v[168:171], v[72:75], v[36:39], v[168:171]
ds_read_b64_tr_b16 v[124:125], v6 offset:20480
v_mfma_f32_16x16x32_bf16 v[204:207], v[76:79], v[36:39], v[204:207]
ds_read_b64_tr_b16 v[126:127], v6 offset:20992
v_mfma_f32_16x16x32_bf16 v[132:135], v[68:71], v[36:39], v[132:135]
ds_read_b64_tr_b16 v[116:117], v6 offset:4096
v_mfma_f32_16x16x32_bf16 v[172:175], v[72:75], v[40:43], v[172:175]
ds_read_b64_tr_b16 v[118:119], v6 offset:4608
v_mfma_f32_16x16x32_bf16 v[208:211], v[76:79], v[40:43], v[208:211]
ds_read_b128 v[84:87], v3 offset:2048
v_mfma_f32_16x16x32_bf16 v[136:139], v[68:71], v[40:43], v[136:139]
ds_read_b128 v[88:91], v3 offset:4096
v_mfma_f32_16x16x32_bf16 v[176:179], v[72:75], v[44:47], v[176:179]
ds_read_b128 v[92:95], v3 offset:6144
v_mfma_f32_16x16x32_bf16 v[212:215], v[76:79], v[44:47], v[212:215]
ds_read_b128 v[96:99], v3 offset:8192
v_mfma_f32_16x16x32_bf16 v[140:143], v[68:71], v[44:47], v[140:143]
ds_read_b128 v[100:103], v3 offset:10240
v_mfma_f32_16x16x32_bf16 v[180:183], v[72:75], v[48:51], v[180:183]
ds_read_b128 v[104:107], v3 offset:12288
v_mfma_f32_16x16x32_bf16 v[216:219], v[76:79], v[48:51], v[216:219]
ds_read_b128 v[108:111], v3 offset:14336
v_mfma_f32_16x16x32_bf16 v[144:147], v[68:71], v[48:51], v[144:147]
ds_read_b128 v[112:115], v3 offset:16384
v_mfma_f32_16x16x32_bf16 v[184:187], v[72:75], v[52:55], v[184:187]
v_mfma_f32_16x16x32_bf16 v[220:223], v[76:79], v[52:55], v[220:223]
v_mfma_f32_16x16x32_bf16 v[148:151], v[68:71], v[52:55], v[148:151]
v_mfma_f32_16x16x32_bf16 v[188:191], v[72:75], v[56:59], v[188:191]
v_mfma_f32_16x16x32_bf16 v[224:227], v[76:79], v[56:59], v[224:227]
v_mfma_f32_16x16x32_bf16 v[152:155], v[68:71], v[56:59], v[152:155]
v_mfma_f32_16x16x32_bf16 v[192:195], v[72:75], v[60:63], v[192:195]
v_mfma_f32_16x16x32_bf16 v[228:231], v[76:79], v[60:63], v[228:231]
s_sub_u32 s42, s42, 1
s_cbranch_scc1 Lxr_14
Lxb_15:
v_mfma_f32_16x16x32_bf16 v[156:159], v[68:71], v[60:63], v[156:159]
v_mfma_f32_16x16x32_bf16 v[196:199], v[72:75], v[64:67], v[196:199]
v_mfma_f32_16x16x32_bf16 v[232:235], v[76:79], v[64:67], v[232:235]
v_mfma_f32_16x16x32_bf16 v[160:163], v[68:71], v[64:67], v[160:163]
s_waitcnt lgkmcnt(0)
s_barrier
v_mfma_f32_16x16x32_bf16 v[164:167], v[120:123], v[80:83], v[164:167]
ds_read_b64 v[32:33], v9 offset:0
v_mfma_f32_16x16x32_bf16 v[200:203], v[124:127], v[80:83], v[200:203]
ds_read_b64 v[34:35], v9 offset:128
v_mfma_f32_16x16x32_bf16 v[128:131], v[116:119], v[80:83], v[128:131]
ds_read_b64 v[36:37], v9 offset:256
v_mfma_f32_16x16x32_bf16 v[168:171], v[120:123], v[84:87], v[168:171]
ds_read_b64 v[38:39], v9 offset:384
v_mfma_f32_16x16x32_bf16 v[204:207], v[124:127], v[84:87], v[204:207]
ds_read_b64 v[40:41], v9 offset:512
v_mfma_f32_16x16x32_bf16 v[132:135], v[116:119], v[84:87], v[132:135]
ds_read_b64 v[42:43], v9 offset:640
v_mfma_f32_16x16x32_bf16 v[172:175], v[120:123], v[88:91], v[172:175]
ds_read_b64 v[44:45], v9 offset:768
v_mfma_f32_16x16x32_bf16 v[208:211], v[124:127], v[88:91], v[208:211]
ds_read_b64 v[46:47], v9 offset:896
v_mfma_f32_16x16x32_bf16 v[136:139], v[116:119], v[88:91], v[136:139]
ds_read_b64 v[48:49], v9 offset:1024
v_mfma_f32_16x16x32_bf16 v[176:179], v[120:123], v[92:95], v[176:179]
v_mov_b32_dpp v52, v128 row_newbcast:0 row_mask:0xf bank_mask:0xf
v_mov_b32_dpp v53, v129 row_newbcast:0 row_mask:0xf bank_mask:0xf
v_mfma_f32_16x16x32_bf16 v[212:215], v[124:127], v[92:95], v[212:215]
v_mov_b32_dpp v54, v130 row_newbcast:0 row_mask:0xf bank_mask:0xf
v_mov_b32_dpp v55, v131 row_newbcast:0 row_mask:0xf bank_mask:0xf
v_mfma_f32_16x16x32_bf16 v[140:143], v[116:119], v[92:95], v[140:143]
v_mov_b32_dpp v56, v164 row_newbcast:0 row_mask:0xf bank_mask:0xf
v_mov_b32_dpp v57, v165 row_newbcast:0 row_mask:0xf bank_mask:0xf
v_mfma_f32_16x16x32_bf16 v[180:183], v[120:123], v[96:99], v[180:183]
v_mov_b32_dpp v58, v166 row_newbcast:0 row_mask:0xf bank_mask:0xf
v_mov_b32_dpp v59, v167 row_newbcast:0 row_mask:0xf bank_mask:0xf
v_mfma_f32_16x16x32_bf16 v[216:219], v[124:127], v[96:99], v[216:219]
v_mov_b32_dpp v60, v200 row_newbcast:0 row_mask:0xf bank_mask:0xf
v_mov_b32_dpp v61, v201 row_newbcast:0 row_mask:0xf bank_mask:0xf
v_mfma_f32_16x16x32_bf16 v[144:147], v[116:119], v[96:99], v[144:147]
v_mov_b32_dpp v62, v202 row_newbcast:0 row_mask:0xf bank_mask:0xf
v_mov_b32_dpp v63, v203 row_newbcast:0 row_mask:0xf bank_mask:0xf
v_mfma_f32_16x16x32_bf16 v[184:187], v[120:123], v[100:103], v[184:187]
s_waitcnt lgkmcnt(0)
v_fma_f32 v164, -v32, v56, v164
v_mfma_f32_16x16x32_bf16 v[220:223], v[124:127], v[100:103], v[220:223]
v_fma_f32 v165, -v32, v57, v165
v_fma_f32 v166, -v32, v58, v166
v_mfma_f32_16x16x32_bf16 v[148:151], v[116:119], v[100:103], v[148:151]
v_fma_f32 v167, -v32, v59, v167
v_mul_f32 v164, v33, v164
v_mfma_f32_16x16x32_bf16 v[188:191], v[120:123], v[104:107], v[188:191]
v_mul_f32 v165, v33, v165
v_mul_f32 v166, v33, v166
v_mfma_f32_16x16x32_bf16 v[224:227], v[124:127], v[104:107], v[224:227]
v_mul_f32 v167, v33, v167
v_cvt_pk_bf16_f32 v164, v164, v165
v_mfma_f32_16x16x32_bf16 v[152:155], v[116:119], v[104:107], v[152:155]
v_cvt_pk_bf16_f32 v165, v166, v167
ds_write_b64 v14, v[164:165] offset:128
v_mfma_f32_16x16x32_bf16 v[192:195], v[120:123], v[108:111], v[192:195]
v_fma_f32 v200, -v32, v60, v200
v_fma_f32 v201, -v32, v61, v201
v_mfma_f32_16x16x32_bf16 v[228:231], v[124:127], v[108:111], v[228:231]
v_fma_f32 v202, -v32, v62, v202
v_fma_f32 v203, -v32, v63, v203
v_mfma_f32_16x16x32_bf16 v[156:159], v[116:119], v[108:111], v[156:159]
v_mul_f32 v200, v33, v200
v_mul_f32 v201, v33, v201
v_mfma_f32_16x16x32_bf16 v[196:199], v[120:123], v[112:115], v[196:199]
v_mul_f32 v202, v33, v202
v_mul_f32 v203, v33, v203
v_mfma_f32_16x16x32_bf16 v[232:235], v[124:127], v[112:115], v[232:235]
v_cvt_pk_bf16_f32 v200, v200, v201
v_cvt_pk_bf16_f32 v201, v202, v203
v_mfma_f32_16x16x32_bf16 v[160:163], v[116:119], v[112:115], v[160:163]
ds_write_b64 v14, v[200:201] offset:256
v_fma_f32 v132, -v34, v52, v132
v_fma_f32 v133, -v34, v53, v133
v_fma_f32 v134, -v34, v54, v134
v_fma_f32 v135, -v34, v55, v135
v_mul_f32 v132, v35, v132
v_mul_f32 v133, v35, v133
v_mul_f32 v134, v35, v134
v_mul_f32 v135, v35, v135
v_cvt_pk_bf16_f32 v132, v132, v133
v_cvt_pk_bf16_f32 v133, v134, v135
ds_write_b64 v14, v[132:133] offset:6400
v_pk_fma_f32 v[168:169], v[34:35], v[56:57], v[168:169] op_sel_hi:[0,1,1] neg_lo:[1,0,0] neg_hi:[1,0,0]
v_pk_fma_f32 v[170:171], v[34:35], v[58:59], v[170:171] op_sel_hi:[0,1,1] neg_lo:[1,0,0] neg_hi:[1,0,0]
v_pk_mul_f32 v[168:169], v[34:35], v[168:169] op_sel:[1,0] op_sel_hi:[1,1]
v_pk_mul_f32 v[170:171], v[34:35], v[170:171] op_sel:[1,0] op_sel_hi:[1,1]
v_cvt_pk_bf16_f32 v168, v168, v169
v_cvt_pk_bf16_f32 v169, v170, v171
ds_write_b64 v14, v[168:169] offset:6528
v_pk_fma_f32 v[204:205], v[34:35], v[60:61], v[204:205] op_sel_hi:[0,1,1] neg_lo:[1,0,0] neg_hi:[1,0,0]
v_pk_fma_f32 v[206:207], v[34:35], v[62:63], v[206:207] op_sel_hi:[0,1,1] neg_lo:[1,0,0] neg_hi:[1,0,0]
v_pk_mul_f32 v[204:205], v[34:35], v[204:205] op_sel:[1,0] op_sel_hi:[1,1]
v_pk_mul_f32 v[206:207], v[34:35], v[206:207] op_sel:[1,0] op_sel_hi:[1,1]
v_cvt_pk_bf16_f32 v204, v204, v205
v_cvt_pk_bf16_f32 v205, v206, v207
ds_write_b64 v14, v[204:205] offset:6656
v_pk_fma_f32 v[136:137], v[36:37], v[52:53], v[136:137] op_sel_hi:[0,1,1] neg_lo:[1,0,0] neg_hi:[1,0,0]
v_pk_fma_f32 v[138:139], v[36:37], v[54:55], v[138:139] op_sel_hi:[0,1,1] neg_lo:[1,0,0] neg_hi:[1,0,0]
v_pk_mul_f32 v[136:137], v[36:37], v[136:137] op_sel:[1,0] op_sel_hi:[1,1]
v_pk_mul_f32 v[138:139], v[36:37], v[138:139] op_sel:[1,0] op_sel_hi:[1,1]
v_cvt_pk_bf16_f32 v136, v136, v137
v_cvt_pk_bf16_f32 v137, v138, v139
ds_write_b64 v14, v[136:137] offset:12800
v_pk_fma_f32 v[172:173], v[36:37], v[56:57], v[172:173] op_sel_hi:[0,1,1] neg_lo:[1,0,0] neg_hi:[1,0,0]
v_pk_fma_f32 v[174:175], v[36:37], v[58:59], v[174:175] op_sel_hi:[0,1,1] neg_lo:[1,0,0] neg_hi:[1,0,0]
v_pk_mul_f32 v[172:173], v[36:37], v[172:173] op_sel:[1,0] op_sel_hi:[1,1]
v_pk_mul_f32 v[174:175], v[36:37], v[174:175] op_sel:[1,0] op_sel_hi:[1,1]
v_cvt_pk_bf16_f32 v172, v172, v173
v_cvt_pk_bf16_f32 v173, v174, v175
ds_write_b64 v14, v[172:173] offset:12928
v_pk_fma_f32 v[208:209], v[36:37], v[60:61], v[208:209] op_sel_hi:[0,1,1] neg_lo:[1,0,0] neg_hi:[1,0,0]
v_pk_fma_f32 v[210:211], v[36:37], v[62:63], v[210:211] op_sel_hi:[0,1,1] neg_lo:[1,0,0] neg_hi:[1,0,0]
v_pk_mul_f32 v[208:209], v[36:37], v[208:209] op_sel:[1,0] op_sel_hi:[1,1]
v_pk_mul_f32 v[210:211], v[36:37], v[210:211] op_sel:[1,0] op_sel_hi:[1,1]
v_cvt_pk_bf16_f32 v208, v208, v209
v_cvt_pk_bf16_f32 v209, v210, v211
ds_write_b64 v14, v[208:209] offset:13056
v_pk_fma_f32 v[140:141], v[38:39], v[52:53], v[140:141] op_sel_hi:[0,1,1] neg_lo:[1,0,0] neg_hi:[1,0,0]
v_pk_fma_f32 v[142:143], v[38:39], v[54:55], v[142:143] op_sel_hi:[0,1,1] neg_lo:[1,0,0] neg_hi:[1,0,0]
v_pk_mul_f32 v[140:141], v[38:39], v[140:141] op_sel:[1,0] op_sel_hi:[1,1]
v_pk_mul_f32 v[142:143], v[38:39], v[142:143] op_sel:[1,0] op_sel_hi:[1,1]
v_cvt_pk_bf16_f32 v140, v140, v141
v_cvt_pk_bf16_f32 v141, v142, v143
ds_write_b64 v14, v[140:141] offset:19200
v_pk_fma_f32 v[176:177], v[38:39], v[56:57], v[176:177] op_sel_hi:[0,1,1] neg_lo:[1,0,0] neg_hi:[1,0,0]
v_pk_fma_f32 v[178:179], v[38:39], v[58:59], v[178:179] op_sel_hi:[0,1,1] neg_lo:[1,0,0] neg_hi:[1,0,0]
v_pk_mul_f32 v[176:177], v[38:39], v[176:177] op_sel:[1,0] op_sel_hi:[1,1]
v_pk_mul_f32 v[178:179], v[38:39], v[178:179] op_sel:[1,0] op_sel_hi:[1,1]
v_cvt_pk_bf16_f32 v176, v176, v177
v_cvt_pk_bf16_f32 v177, v178, v179
ds_write_b64 v14, v[176:177] offset:19328
v_pk_fma_f32 v[212:213], v[38:39], v[60:61], v[212:213] op_sel_hi:[0,1,1] neg_lo:[1,0,0] neg_hi:[1,0,0]
v_pk_fma_f32 v[214:215], v[38:39], v[62:63], v[214:215] op_sel_hi:[0,1,1] neg_lo:[1,0,0] neg_hi:[1,0,0]
v_pk_mul_f32 v[212:213], v[38:39], v[212:213] op_sel:[1,0] op_sel_hi:[1,1]
v_pk_mul_f32 v[214:215], v[38:39], v[214:215] op_sel:[1,0] op_sel_hi:[1,1]
v_cvt_pk_bf16_f32 v212, v212, v213
v_cvt_pk_bf16_f32 v213, v214, v215
ds_write_b64 v14, v[212:213] offset:19456
v_pk_fma_f32 v[144:145], v[40:41], v[52:53], v[144:145] op_sel_hi:[0,1,1] neg_lo:[1,0,0] neg_hi:[1,0,0]
v_pk_fma_f32 v[146:147], v[40:41], v[54:55], v[146:147] op_sel_hi:[0,1,1] neg_lo:[1,0,0] neg_hi:[1,0,0]
v_pk_mul_f32 v[144:145], v[40:41], v[144:145] op_sel:[1,0] op_sel_hi:[1,1]
v_pk_mul_f32 v[146:147], v[40:41], v[146:147] op_sel:[1,0] op_sel_hi:[1,1]
v_cvt_pk_bf16_f32 v144, v144, v145
v_cvt_pk_bf16_f32 v145, v146, v147
ds_write_b64 v14, v[144:145] offset:25600
v_pk_fma_f32 v[180:181], v[40:41], v[56:57], v[180:181] op_sel_hi:[0,1,1] neg_lo:[1,0,0] neg_hi:[1,0,0]
v_pk_fma_f32 v[182:183], v[40:41], v[58:59], v[182:183] op_sel_hi:[0,1,1] neg_lo:[1,0,0] neg_hi:[1,0,0]
v_pk_mul_f32 v[180:181], v[40:41], v[180:181] op_sel:[1,0] op_sel_hi:[1,1]
v_pk_mul_f32 v[182:183], v[40:41], v[182:183] op_sel:[1,0] op_sel_hi:[1,1]
v_cvt_pk_bf16_f32 v180, v180, v181
v_cvt_pk_bf16_f32 v181, v182, v183
ds_write_b64 v14, v[180:181] offset:25728
v_pk_fma_f32 v[216:217], v[40:41], v[60:61], v[216:217] op_sel_hi:[0,1,1] neg_lo:[1,0,0] neg_hi:[1,0,0]
v_pk_fma_f32 v[218:219], v[40:41], v[62:63], v[218:219] op_sel_hi:[0,1,1] neg_lo:[1,0,0] neg_hi:[1,0,0]
v_pk_mul_f32 v[216:217], v[40:41], v[216:217] op_sel:[1,0] op_sel_hi:[1,1]
v_pk_mul_f32 v[218:219], v[40:41], v[218:219] op_sel:[1,0] op_sel_hi:[1,1]
v_cvt_pk_bf16_f32 v216, v216, v217
v_cvt_pk_bf16_f32 v217, v218, v219
ds_write_b64 v14, v[216:217] offset:25856
s_waitcnt lgkmcnt(0)
s_barrier
v_pk_fma_f32 v[148:149], v[42:43], v[52:53], v[148:149] op_sel_hi:[0,1,1] neg_lo:[1,0,0] neg_hi:[1,0,0]
v_pk_fma_f32 v[150:151], v[42:43], v[54:55], v[150:151] op_sel_hi:[0,1,1] neg_lo:[1,0,0] neg_hi:[1,0,0]
v_pk_mul_f32 v[148:149], v[42:43], v[148:149] op_sel:[1,0] op_sel_hi:[1,1]
v_pk_mul_f32 v[150:151], v[42:43], v[150:151] op_sel:[1,0] op_sel_hi:[1,1]
v_cvt_pk_bf16_f32 v148, v148, v149
v_cvt_pk_bf16_f32 v149, v150, v151
ds_write_b64 v14, v[148:149] offset:32000
v_pk_fma_f32 v[184:185], v[42:43], v[56:57], v[184:185] op_sel_hi:[0,1,1] neg_lo:[1,0,0] neg_hi:[1,0,0]
v_pk_fma_f32 v[186:187], v[42:43], v[58:59], v[186:187] op_sel_hi:[0,1,1] neg_lo:[1,0,0] neg_hi:[1,0,0]
v_pk_mul_f32 v[184:185], v[42:43], v[184:185] op_sel:[1,0] op_sel_hi:[1,1]
v_pk_mul_f32 v[186:187], v[42:43], v[186:187] op_sel:[1,0] op_sel_hi:[1,1]
v_cvt_pk_bf16_f32 v184, v184, v185
v_cvt_pk_bf16_f32 v185, v186, v187
ds_write_b64 v14, v[184:185] offset:32128
v_pk_fma_f32 v[220:221], v[42:43], v[60:61], v[220:221] op_sel_hi:[0,1,1] neg_lo:[1,0,0] neg_hi:[1,0,0]
v_pk_fma_f32 v[222:223], v[42:43], v[62:63], v[222:223] op_sel_hi:[0,1,1] neg_lo:[1,0,0] neg_hi:[1,0,0]
v_pk_mul_f32 v[220:221], v[42:43], v[220:221] op_sel:[1,0] op_sel_hi:[1,1]
v_pk_mul_f32 v[222:223], v[42:43], v[222:223] op_sel:[1,0] op_sel_hi:[1,1]
v_cvt_pk_bf16_f32 v220, v220, v221
v_cvt_pk_bf16_f32 v221, v222, v223
ds_write_b64 v14, v[220:221] offset:32256
v_pk_fma_f32 v[152:153], v[44:45], v[52:53], v[152:153] op_sel_hi:[0,1,1] neg_lo:[1,0,0] neg_hi:[1,0,0]
v_pk_fma_f32 v[154:155], v[44:45], v[54:55], v[154:155] op_sel_hi:[0,1,1] neg_lo:[1,0,0] neg_hi:[1,0,0]
v_pk_mul_f32 v[152:153], v[44:45], v[152:153] op_sel:[1,0] op_sel_hi:[1,1]
v_pk_mul_f32 v[154:155], v[44:45], v[154:155] op_sel:[1,0] op_sel_hi:[1,1]
v_cvt_pk_bf16_f32 v152, v152, v153
v_cvt_pk_bf16_f32 v153, v154, v155
ds_write_b64 v14, v[152:153] offset:38400
v_pk_fma_f32 v[188:189], v[44:45], v[56:57], v[188:189] op_sel_hi:[0,1,1] neg_lo:[1,0,0] neg_hi:[1,0,0]
v_pk_fma_f32 v[190:191], v[44:45], v[58:59], v[190:191] op_sel_hi:[0,1,1] neg_lo:[1,0,0] neg_hi:[1,0,0]
v_pk_mul_f32 v[188:189], v[44:45], v[188:189] op_sel:[1,0] op_sel_hi:[1,1]
v_pk_mul_f32 v[190:191], v[44:45], v[190:191] op_sel:[1,0] op_sel_hi:[1,1]
v_cvt_pk_bf16_f32 v188, v188, v189
v_cvt_pk_bf16_f32 v189, v190, v191
ds_write_b64 v14, v[188:189] offset:38528
v_pk_fma_f32 v[224:225], v[44:45], v[60:61], v[224:225] op_sel_hi:[0,1,1] neg_lo:[1,0,0] neg_hi:[1,0,0]
v_pk_fma_f32 v[226:227], v[44:45], v[62:63], v[226:227] op_sel_hi:[0,1,1] neg_lo:[1,0,0] neg_hi:[1,0,0]
v_pk_mul_f32 v[224:225], v[44:45], v[224:225] op_sel:[1,0] op_sel_hi:[1,1]
v_pk_mul_f32 v[226:227], v[44:45], v[226:227] op_sel:[1,0] op_sel_hi:[1,1]
v_cvt_pk_bf16_f32 v224, v224, v225
v_cvt_pk_bf16_f32 v225, v226, v227
ds_write_b64 v14, v[224:225] offset:38656
v_pk_fma_f32 v[156:157], v[46:47], v[52:53], v[156:157] op_sel_hi:[0,1,1] neg_lo:[1,0,0] neg_hi:[1,0,0]
v_pk_fma_f32 v[158:159], v[46:47], v[54:55], v[158:159] op_sel_hi:[0,1,1] neg_lo:[1,0,0] neg_hi:[1,0,0]
v_pk_mul_f32 v[156:157], v[46:47], v[156:157] op_sel:[1,0] op_sel_hi:[1,1]
v_pk_mul_f32 v[158:159], v[46:47], v[158:159] op_sel:[1,0] op_sel_hi:[1,1]
v_cvt_pk_bf16_f32 v156, v156, v157
v_cvt_pk_bf16_f32 v157, v158, v159
ds_write_b64 v14, v[156:157] offset:44800
v_pk_fma_f32 v[192:193], v[46:47], v[56:57], v[192:193] op_sel_hi:[0,1,1] neg_lo:[1,0,0] neg_hi:[1,0,0]
v_pk_fma_f32 v[194:195], v[46:47], v[58:59], v[194:195] op_sel_hi:[0,1,1] neg_lo:[1,0,0] neg_hi:[1,0,0]
v_pk_mul_f32 v[192:193], v[46:47], v[192:193] op_sel:[1,0] op_sel_hi:[1,1]
v_pk_mul_f32 v[194:195], v[46:47], v[194:195] op_sel:[1,0] op_sel_hi:[1,1]
v_cvt_pk_bf16_f32 v192, v192, v193
v_cvt_pk_bf16_f32 v193, v194, v195
ds_write_b64 v14, v[192:193] offset:44928
v_pk_fma_f32 v[228:229], v[46:47], v[60:61], v[228:229] op_sel_hi:[0,1,1] neg_lo:[1,0,0] neg_hi:[1,0,0]
v_pk_fma_f32 v[230:231], v[46:47], v[62:63], v[230:231] op_sel_hi:[0,1,1] neg_lo:[1,0,0] neg_hi:[1,0,0]
v_pk_mul_f32 v[228:229], v[46:47], v[228:229] op_sel:[1,0] op_sel_hi:[1,1]
v_pk_mul_f32 v[230:231], v[46:47], v[230:231] op_sel:[1,0] op_sel_hi:[1,1]
v_cvt_pk_bf16_f32 v228, v228, v229
v_cvt_pk_bf16_f32 v229, v230, v231
ds_write_b64 v14, v[228:229] offset:45056
v_pk_fma_f32 v[160:161], v[48:49], v[52:53], v[160:161] op_sel_hi:[0,1,1] neg_lo:[1,0,0] neg_hi:[1,0,0]
v_pk_fma_f32 v[162:163], v[48:49], v[54:55], v[162:163] op_sel_hi:[0,1,1] neg_lo:[1,0,0] neg_hi:[1,0,0]
v_pk_mul_f32 v[160:161], v[48:49], v[160:161] op_sel:[1,0] op_sel_hi:[1,1]
v_pk_mul_f32 v[162:163], v[48:49], v[162:163] op_sel:[1,0] op_sel_hi:[1,1]
v_cvt_pk_bf16_f32 v160, v160, v161
v_cvt_pk_bf16_f32 v161, v162, v163
ds_write_b64 v14, v[160:161] offset:51200
v_pk_fma_f32 v[196:197], v[48:49], v[56:57], v[196:197] op_sel_hi:[0,1,1] neg_lo:[1,0,0] neg_hi:[1,0,0]
v_pk_fma_f32 v[198:199], v[48:49], v[58:59], v[198:199] op_sel_hi:[0,1,1] neg_lo:[1,0,0] neg_hi:[1,0,0]
v_pk_mul_f32 v[196:197], v[48:49], v[196:197] op_sel:[1,0] op_sel_hi:[1,1]
v_pk_mul_f32 v[198:199], v[48:49], v[198:199] op_sel:[1,0] op_sel_hi:[1,1]
v_cvt_pk_bf16_f32 v196, v196, v197
v_cvt_pk_bf16_f32 v197, v198, v199
ds_write_b64 v14, v[196:197] offset:51328
v_pk_fma_f32 v[232:233], v[48:49], v[60:61], v[232:233] op_sel_hi:[0,1,1] neg_lo:[1,0,0] neg_hi:[1,0,0]
v_pk_fma_f32 v[234:235], v[48:49], v[62:63], v[234:235] op_sel_hi:[0,1,1] neg_lo:[1,0,0] neg_hi:[1,0,0]
v_pk_mul_f32 v[232:233], v[48:49], v[232:233] op_sel:[1,0] op_sel_hi:[1,1]
v_pk_mul_f32 v[234:235], v[48:49], v[234:235] op_sel:[1,0] op_sel_hi:[1,1]
v_cvt_pk_bf16_f32 v232, v232, v233
v_cvt_pk_bf16_f32 v233, v234, v235
ds_write_b64 v14, v[232:233] offset:51456
s_waitcnt lgkmcnt(0)
s_branch Latt_4
Lpf_3:
s_load_dwordx2 s[26:27], s[0:1], 64
s_or_b32 s43, s34, s35
s_cmp_lg_u32 s43, 0
s_cbranch_scc1 Lz_26
s_add_u32 s84, s32, 28311552
s_addc_u32 s85, s33, 0
s_mov_b32 s86, 40960
s_mov_b32 s87, 0x20000
v_lshlrev_b32 v14, 7, v1
v_mov_b32 v36, 0
v_mov_b32 v37, 0
s_mov_b32 s43, 0
buffer_store_dwordx2 v[36:37], v14, s[84:87], s43 offen sc1
s_mov_b32 s43, 8192
buffer_store_dwordx2 v[36:37], v14, s[84:87], s43 offen sc1
s_mov_b32 s43, 16384
buffer_store_dwordx2 v[36:37], v14, s[84:87], s43 offen sc1
s_mov_b32 s43, 24576
buffer_store_dwordx2 v[36:37], v14, s[84:87], s43 offen sc1
s_mov_b32 s43, 32768
buffer_store_dwordx2 v[36:37], v14, s[84:87], s43 offen sc1
Lz_26:
s_lshl_b32 s43, s51, 11
buffer_load_dwordx4 v[96:99], v10, s[8:11], s43 offen offset:0
buffer_load_dwordx4 v[100:103], v10, s[8:11], s43 offen offset:1024
buffer_load_dwordx4 v[104:107], v10, s[8:11], s43 offen offset:2048
buffer_load_dwordx4 v[108:111], v10, s[8:11], s43 offen offset:3072
v_min_u32 v14, 23, v1
v_lshrrev_b32 v15, 3, v14
v_mul_u32_u24 v15, 43008, v15
v_and_b32 v14, 7, v14
v_lshl_add_u32 v15, v14, 4, v15
v_mov_b32 v32, 0x3f803f80
v_mov_b32 v33, 0x3f803f80
v_mov_b32 v34, 0x3f803f80
v_mov_b32 v35, 0x3f803f80
ds_write_b128 v15, v[32:35]
v_add_u32 v14, 0, v1
v_min_u32 v14, 47, v14
v_mul_u32_u24 v15, 21846, v14
v_lshrrev_b32 v15, 16, v15
v_mul_u32_u24 v16, 3, v15
v_sub_u32 v16, v14, v16
s_mul_i32 s43, s48, 16
v_add_u32 v15, s43, v15
v_mul_u32_u24 v15, 6144, v15
v_lshl_add_u32 v2, v16, 11, v15
s_waitcnt lgkmcnt(0)
s_mov_b32 s56, s26
s_mov_b32 s57, s27
s_mov_b32 s58, 256
s_mov_b32 s59, 0x20000
v_lshlrev_b32 v14, 7, v1
s_barrier
s_cmp_ge_u32 s2, 128
s_cbranch_scc1 Lm_28
s_lshr_b32 s44, s2, 4
s_cmp_eq_u32 s44, 2
s_cbranch_scc1 Lm_28
s_lshr_b32 s44, s2, 5
s_cmp_eq_u32 s44, 3
s_cbranch_scc1 Lm_28
s_mov_b32 s84, s6
s_mov_b32 s85, s7
s_mov_b32 s86, 6291456
s_mov_b32 s87, 0x20000
s_cmp_lt_u32 s2, 32
s_cselect_b32 s43, 96, 0
s_add_u32 s43, s43, s2
s_mul_i32 s43, s43, 24576
buffer_load_dword v31, v14, s[84:87], s43 offen
s_add_u32 s43, s43, 8192
buffer_load_dword v31, v14, s[84:87], s43 offen
s_add_u32 s43, s43, 8192
buffer_load_dword v31, v14, s[84:87], s43 offen
Lm_28:
s_mov_b32 s84, s6
s_mov_b32 s85, s7
s_mov_b32 s86, 6291456
s_mov_b32 s87, 0x20000
s_lshr_b32 s44, s2, 3
s_lshr_b32 s43, s2, 5
s_cmp_eq_u32 s43, 3
s_cbranch_scc1 Lsj_29
s_cmp_gt_u32 s43, 3
s_cselect_b32 s43, 32, 0
s_sub_u32 s43, s2, s43
s_lshr_b32 s43, s43, 1
s_and_b32 s44, s2, 1
s_lshl_b32 s44, s44, 3
s_add_u32 s44, s44, 32
s_load_dwordx2 s[80:81], s[0:1], s44
s_mul_i32 s45, s43, 2341
s_lshr_b32 s45, s45, 16
s_mul_i32 s46, s45, 28
s_sub_u32 s46, s43, s46
s_lshl_b32 s45, s45, 8
s_mul_i32 s44, s47, 18
s_add_u32 s45, s45, s44
s_add_u32 s45, s45, 184
s_mul_i32 s45, s45, 7168
s_lshl_b32 s46, s46, 8
s_add_u32 s45, s45, s46
s_waitcnt lgkmcnt(0)
s_add_u32 s80, s80, s45
s_addc_u32 s81, s81, 0
Lsj_29:
s_barrier
s_cmp_ge_u32 s2, 128
s_cbranch_scc0 Lm_30
s_mov_b32 s84, s6
s_mov_b32 s85, s7
s_mov_b32 s86, 6291456
s_mov_b32 s87, 0x20000
s_cmp_lt_u32 s2, 32
s_cselect_b32 s43, 96, 0
s_add_u32 s43, s43, s2
s_mul_i32 s43, s43, 24576
buffer_load_dword v31, v14, s[84:87], s43 offen
s_add_u32 s43, s43, 8192
buffer_load_dword v31, v14, s[84:87], s43 offen
s_add_u32 s43, s43, 8192
buffer_load_dword v31, v14, s[84:87], s43 offen
Lm_30:
s_barrier
s_getpc_b64 s[88:89]
Lpc_31:
s_sub_u32 s88, s88, Lpc_31-sequential_preLN__sliding_local_dilated__glu_gated_geglu__prompt_kernel
s_subb_u32 s89, s89, 0
s_lshr_b32 s43, s2, 3
s_mul_i32 s43, s43, 3840
v_min_u32 v15, 29, v1
v_lshl_add_u32 v15, v15, 7, s43
v_min_u32 v15, Ldone_1-sequential_preLN__sliding_local_dilated__glu_gated_geglu__prompt_kernel, v15
global_load_dword v31, v15, s[88:89]
s_or_b32 s43, s34, s35
s_cmp_lg_u32 s43, 0
s_cbranch_scc1 Lz_32
s_waitcnt vmcnt(0)
v_mov_b32 v5, 1
v_mov_b32 v6, 0
s_mov_b64 exec, 1
buffer_store_dword v5, v6, s[56:59], 0 offen sc1
s_mov_b64 exec, -1
Lz_32:
s_waitcnt vmcnt(1)
v_lshlrev_b32 v116, 16, v96
v_and_b32 v117, 0xffff0000, v96
v_mul_f32 v118, v116, v116
v_mul_f32 v119, v117, v117
v_lshlrev_b32 v126, 16, v97
v_and_b32 v127, 0xffff0000, v97
v_add_f32 v116, v116, v126
v_add_f32 v117, v117, v127
v_fmac_f32 v118, v126, v126
v_fmac_f32 v119, v127, v127
v_lshlrev_b32 v124, 16, v98
v_and_b32 v125, 0xffff0000, v98
v_add_f32 v116, v116, v124
v_add_f32 v117, v117, v125
v_fmac_f32 v118, v124, v124
v_fmac_f32 v119, v125, v125
v_lshlrev_b32 v126, 16, v99
v_and_b32 v127, 0xffff0000, v99
v_add_f32 v116, v116, v126
v_add_f32 v117, v117, v127
v_fmac_f32 v118, v126, v126
v_fmac_f32 v119, v127, v127
v_lshlrev_b32 v124, 16, v100
v_and_b32 v125, 0xffff0000, v100
v_add_f32 v116, v116, v124
v_add_f32 v117, v117, v125
v_fmac_f32 v118, v124, v124
v_fmac_f32 v119, v125, v125
v_lshlrev_b32 v126, 16, v101
v_and_b32 v127, 0xffff0000, v101
v_add_f32 v116, v116, v126
v_add_f32 v117, v117, v127
v_fmac_f32 v118, v126, v126
v_fmac_f32 v119, v127, v127
v_lshlrev_b32 v124, 16, v102
v_and_b32 v125, 0xffff0000, v102
v_add_f32 v116, v116, v124
v_add_f32 v117, v117, v125
v_fmac_f32 v118, v124, v124
v_fmac_f32 v119, v125, v125
v_lshlrev_b32 v126, 16, v103
v_and_b32 v127, 0xffff0000, v103
v_add_f32 v116, v116, v126
v_add_f32 v117, v117, v127
v_fmac_f32 v118, v126, v126
v_fmac_f32 v119, v127, v127
v_lshlrev_b32 v120, 16, v104
v_and_b32 v121, 0xffff0000, v104
v_mul_f32 v122, v120, v120
v_mul_f32 v123, v121, v121
s_barrier
s_cmp_lt_u32 s2, 128
s_cbranch_scc1 Lm_33
s_mov_b32 s84, s6
s_mov_b32 s85, s7
s_mov_b32 s86, 6291456
s_mov_b32 s87, 0x20000
s_lshr_b32 s44, s2, 3
s_and_b32 s43, s35, 8
s_or_b32 s43, s43, 3
s_lshl_b32 s43, s43, 7
s_mul_i32 s45, s44, 196608
s_add_u32 s43, s43, s45
v_add_u32 v15, 0, v1
v_min_u32 v15, 95, v15
v_mul_u32_u24 v16, 21846, v15
v_lshrrev_b32 v16, 16, v16
v_mul_u32_u24 v17, 3, v16
v_sub_u32 v15, v15, v17
v_mul_u32_u24 v16, 6144, v16
v_lshl_add_u32 v15, v15, 11, v16
buffer_load_dword v31, v15, s[84:87], s43 offen
v_add_u32 v15, 64, v1
v_min_u32 v15, 95, v15
v_mul_u32_u24 v16, 21846, v15
v_lshrrev_b32 v16, 16, v16
v_mul_u32_u24 v17, 3, v16
v_sub_u32 v15, v15, v17
v_mul_u32_u24 v16, 6144, v16
v_lshl_add_u32 v15, v15, 11, v16
buffer_load_dword v31, v15, s[84:87], s43 offen
Lm_33:
v_lshlrev_b32 v126, 16, v105
v_and_b32 v127, 0xffff0000, v105
v_add_f32 v120, v120, v126
v_add_f32 v121, v121, v127
v_fmac_f32 v122, v126, v126
v_fmac_f32 v123, v127, v127
v_lshlrev_b32 v124, 16, v106
v_and_b32 v125, 0xffff0000, v106
v_add_f32 v120, v120, v124
v_add_f32 v121, v121, v125
v_fmac_f32 v122, v124, v124
v_fmac_f32 v123, v125, v125
v_lshlrev_b32 v126, 16, v107
v_and_b32 v127, 0xffff0000, v107
v_add_f32 v120, v120, v126
v_add_f32 v121, v121, v127
v_fmac_f32 v122, v126, v126
v_fmac_f32 v123, v127, v127
v_lshlrev_b32 v124, 16, v108
v_and_b32 v125, 0xffff0000, v108
v_add_f32 v120, v120, v124
v_add_f32 v121, v121, v125
v_fmac_f32 v122, v124, v124
v_fmac_f32 v123, v125, v125
v_lshlrev_b32 v126, 16, v109
v_and_b32 v127, 0xffff0000, v109
v_add_f32 v120, v120, v126
v_add_f32 v121, v121, v127
v_fmac_f32 v122, v126, v126
v_fmac_f32 v123, v127, v127
v_lshlrev_b32 v124, 16, v110
v_and_b32 v125, 0xffff0000, v110
v_add_f32 v120, v120, v124
v_add_f32 v121, v121, v125
v_fmac_f32 v122, v124, v124
v_fmac_f32 v123, v125, v125
v_lshlrev_b32 v126, 16, v111
v_and_b32 v127, 0xffff0000, v111
v_add_f32 v120, v120, v126
v_add_f32 v121, v121, v127
v_fmac_f32 v122, v126, v126
v_fmac_f32 v123, v127, v127
v_add_f32 v116, v116, v117
v_add_f32 v118, v118, v119
v_add_f32 v120, v120, v121
v_add_f32 v122, v122, v123
v_add_f32_dpp v116, v116, v116 row_ror:8 row_mask:0xf bank_mask:0xf
v_add_f32_dpp v118, v118, v118 row_ror:8 row_mask:0xf bank_mask:0xf
v_add_f32_dpp v120, v120, v120 row_ror:8 row_mask:0xf bank_mask:0xf
v_add_f32_dpp v122, v122, v122 row_ror:8 row_mask:0xf bank_mask:0xf
s_barrier
v_add_f32_dpp v116, v116, v116 row_ror:4 row_mask:0xf bank_mask:0xf
v_add_f32_dpp v118, v118, v118 row_ror:4 row_mask:0xf bank_mask:0xf
v_add_f32_dpp v120, v120, v120 row_ror:4 row_mask:0xf bank_mask:0xf
v_add_f32_dpp v122, v122, v122 row_ror:4 row_mask:0xf bank_mask:0xf
v_add_f32_dpp v116, v116, v116 row_ror:2 row_mask:0xf bank_mask:0xf
v_add_f32_dpp v118, v118, v118 row_ror:2 row_mask:0xf bank_mask:0xf
v_add_f32_dpp v120, v120, v120 row_ror:2 row_mask:0xf bank_mask:0xf
v_add_f32_dpp v122, v122, v122 row_ror:2 row_mask:0xf bank_mask:0xf
v_add_f32_dpp v116, v116, v116 row_ror:1 row_mask:0xf bank_mask:0xf
v_add_f32_dpp v118, v118, v118 row_ror:1 row_mask:0xf bank_mask:0xf
v_add_f32_dpp v120, v120, v120 row_ror:1 row_mask:0xf bank_mask:0xf
v_add_f32_dpp v122, v122, v122 row_ror:1 row_mask:0xf bank_mask:0xf
v_mov_b32 v117, v116
v_mov_b32 v119, v118
v_mov_b32 v121, v120
v_mov_b32 v123, v122
s_nop 0
v_permlane16_swap_b32 v116, v117
v_permlane16_swap_b32 v118, v119
v_permlane16_swap_b32 v120, v121
v_permlane16_swap_b32 v122, v123
v_add_f32 v116, v116, v117
v_add_f32 v118, v118, v119
v_add_f32 v120, v120, v121
v_add_f32 v122, v122, v123
v_mov_b32 v117, v116
v_mov_b32 v119, v118
v_mov_b32 v121, v120
v_mov_b32 v123, v122
s_nop 0
v_permlane32_swap_b32 v116, v117
v_permlane32_swap_b32 v118, v119
v_permlane32_swap_b32 v120, v121
v_permlane32_swap_b32 v122, v123
v_add_f32 v116, v116, v117
v_add_f32 v118, v118, v119
v_add_f32 v120, v120, v121
v_add_f32 v122, v122, v123
v_mul_f32 v112, 0x3a800000, v116
v_mul_f32 v113, 0x3a800000, v118
v_fma_f32 v113, -v112, v112, v113
v_max_f32 v113, 0, v113
v_add_f32 v113, 0x3727c5ac, v113
v_rsq_f32 v113, v113
v_mul_f32 v114, 0x3a800000, v120
v_mul_f32 v115, 0x3a800000, v122
v_fma_f32 v115, -v114, v114, v115
v_max_f32 v115, 0, v115
v_add_f32 v115, 0x3727c5ac, v115
v_rsq_f32 v115, v115
s_nop 0
s_lshl_b32 s43, s47, 4
s_add_u32 s43, s43, 130176
v_mov_b32 v11, s43
ds_write_b128 v11, v[112:115]
s_waitcnt lgkmcnt(0)
s_barrier
v_lshlrev_b32 v5, 4, v1
v_and_b32 v5, 63, v5
v_add_u32 v6, 130176, v5
ds_read_b128 v[112:115], v6
s_lshl_b32 s43, s63, 3
v_add_u32 v5, s43, v5
s_waitcnt lgkmcnt(0)
s_mov_b64 exec, 15
buffer_store_dwordx4 v[112:115], v5, s[20:23], 0 offen sc1
s_mov_b64 exec, -1
s_load_dword s64, s[80:81], 0
s_load_dword s65, s[80:81], 64
s_load_dword s66, s[80:81], 128
s_load_dword s67, s[80:81], 192
s_load_dword s68, s[80:81], 7168
s_load_dword s69, s[80:81], 7232
s_load_dword s70, s[80:81], 7296
s_load_dword s71, s[80:81], 7360
s_add_u32 s80, s80, 14336
s_addc_u32 s81, s81, 0
s_barrier
v_mov_b32 v7, 0
v_mov_b32 v9, 1
buffer_load_dword v8, v7, s[56:59], 0 offen sc1
s_load_dword s64, s[80:81], 0
s_load_dword s65, s[80:81], 64
s_load_dword s66, s[80:81], 128
s_load_dword s67, s[80:81], 192
s_load_dword s68, s[80:81], 7168
s_load_dword s69, s[80:81], 7232
s_load_dword s70, s[80:81], 7296
s_load_dword s71, s[80:81], 7360
s_add_u32 s80, s80, 14336
s_addc_u32 s81, s81, 0
s_barrier
s_load_dword s64, s[80:81], 0
s_load_dword s65, s[80:81], 64
s_load_dword s66, s[80:81], 128
s_load_dword s67, s[80:81], 192
s_load_dword s68, s[80:81], 7168
s_load_dword s69, s[80:81], 7232
s_load_dword s70, s[80:81], 7296
s_load_dword s71, s[80:81], 7360
s_add_u32 s80, s80, 14336
s_addc_u32 s81, s81, 0
s_barrier
s_mov_b32 s41, 0x10000
Lpoll_34:
s_waitcnt vmcnt(0)
Lpf_36:
v_cmp_ne_u32 vcc, v9, v8
s_nop 4
s_cbranch_vccz Lpok_35
buffer_load_dword v8, v7, s[56:59], 0 offen sc1
s_sub_u32 s41, s41, 1
s_cmp_lg_u32 s41, 0
s_cbranch_scc1 Lpoll_34
s_waitcnt vmcnt(0)
Lpok_35:
s_add_u32 s56, s32, 28311552
s_addc_u32 s57, s33, 0
s_mov_b32 s58, 40960
s_mov_b32 s59, 0x20000
s_add_u32 s43, s34, 80
s_lshl_b32 s43, s43, 7
v_mov_b32 v5, s43
v_mov_b32 v6, 1
s_mov_b64 exec, 1
buffer_atomic_add v6, v5, s[56:59], 0 offen sc1
s_mov_b64 exec, -1
s_load_dword s64, s[80:81], 0
s_load_dword s65, s[80:81], 64
s_load_dword s66, s[80:81], 128
s_load_dword s67, s[80:81], 192
s_load_dword s68, s[80:81], 7168
s_load_dword s69, s[80:81], 7232
s_load_dword s70, s[80:81], 7296
s_load_dword s71, s[80:81], 7360
s_add_u32 s80, s80, 14336
s_addc_u32 s81, s81, 0
s_barrier
s_load_dword s64, s[80:81], 0
s_load_dword s65, s[80:81], 64
s_load_dword s66, s[80:81], 128
s_load_dword s67, s[80:81], 192
s_load_dword s68, s[80:81], 7168
s_load_dword s69, s[80:81], 7232
s_load_dword s70, s[80:81], 7296
s_load_dword s71, s[80:81], 7360
s_add_u32 s80, s80, 14336
s_addc_u32 s81, s81, 0
s_barrier
s_getpc_b64 s[88:89]
Lpc_37:
s_sub_u32 s88, s88, Lpc_37-sequential_preLN__sliding_local_dilated__glu_gated_geglu__prompt_kernel
s_subb_u32 s89, s89, 0
s_lshr_b32 s43, s2, 3
s_mul_i32 s43, s43, 3840
v_min_u32 v15, 29, v1
v_lshl_add_u32 v15, v15, 7, s43
v_min_u32 v15, Ldone_1-sequential_preLN__sliding_local_dilated__glu_gated_geglu__prompt_kernel, v15
global_load_dword v31, v15, s[88:89]
s_sub_u32 s44, s34, 1
s_max_i32 s44, s44, 0
v_mov_b32 v5, s44
v_mov_b32 v6, s34
v_cmp_eq_u32 vcc, 0, v1
s_nop 1
v_cndmask_b32 v5, v5, v6, vcc
v_add_u32 v5, 80, v5
v_lshlrev_b32 v5, 7, v5
buffer_load_dword v6, v5, s[56:59], 0 offen sc1
s_load_dword s64, s[80:81], 0
s_load_dword s65, s[80:81], 64
s_load_dword s66, s[80:81], 128
s_load_dword s67, s[80:81], 192
s_load_dword s68, s[80:81], 7168
s_load_dword s69, s[80:81], 7232
s_load_dword s70, s[80:81], 7296
s_load_dword s71, s[80:81], 7360
s_add_u32 s80, s80, 14336
s_addc_u32 s81, s81, 0
s_barrier
s_load_dword s64, s[80:81], 0
s_load_dword s65, s[80:81], 64
s_load_dword s66, s[80:81], 128
s_load_dword s67, s[80:81], 192
s_load_dword s68, s[80:81], 7168
s_load_dword s69, s[80:81], 7232
s_load_dword s70, s[80:81], 7296
s_load_dword s71, s[80:81], 7360
s_add_u32 s80, s80, 14336
s_addc_u32 s81, s81, 0
s_barrier
v_mov_b32 v7, 16
s_mov_b32 s41, 0x10000
Lpoll_38:
s_waitcnt vmcnt(0)
Lpf_40:
v_cmp_ne_u32 vcc, v7, v6
s_nop 4
s_cbranch_vccz Lpok_39
buffer_load_dword v6, v5, s[56:59], 0 offen sc1
s_sub_u32 s41, s41, 1
s_cmp_lg_u32 s41, 0
s_cbranch_scc1 Lpoll_38
s_waitcnt vmcnt(0)
Lpok_39:
v_add_u32 v5, 0, v1
v_min_u32 v5, 143, v5
v_lshlrev_b32 v20, 3, v5
v_add_u32 v5, s50, v5
v_max_i32 v5, 0, v5
v_lshlrev_b32 v5, 3, v5
buffer_load_dwordx2 v[32:33], v5, s[20:23], 0 offen sc1
v_add_u32 v5, 64, v1
v_min_u32 v5, 143, v5
v_lshlrev_b32 v21, 3, v5
v_add_u32 v5, s50, v5
v_max_i32 v5, 0, v5
v_lshlrev_b32 v5, 3, v5
buffer_load_dwordx2 v[34:35], v5, s[20:23], 0 offen sc1
v_add_u32 v5, 128, v1
v_min_u32 v5, 143, v5
v_lshlrev_b32 v22, 3, v5
v_add_u32 v5, s50, v5
v_max_i32 v5, 0, v5
v_lshlrev_b32 v5, 3, v5
buffer_load_dwordx2 v[36:37], v5, s[20:23], 0 offen sc1
s_load_dword s64, s[80:81], 0
s_load_dword s65, s[80:81], 64
s_load_dword s66, s[80:81], 128
s_load_dword s67, s[80:81], 192
s_load_dword s68, s[80:81], 7168
s_load_dword s69, s[80:81], 7232
s_load_dword s70, s[80:81], 7296
s_load_dword s71, s[80:81], 7360
s_add_u32 s80, s80, 14336
s_addc_u32 s81, s81, 0
s_barrier
s_load_dwordx2 s[88:89], s[0:1], 16
v_lshlrev_b32 v29, 7, v1
s_lshl_b32 s43, s2, 13
s_waitcnt lgkmcnt(0)
s_mov_b32 s84, s88
s_mov_b32 s85, s89
s_mov_b32 s86, 2097152
s_mov_b32 s87, 0x20000
buffer_load_dword v30, v29, s[84:87], s43 offen
v_and_b32 v29, 31, v1
v_lshlrev_b32 v29, 11, v29
s_and_b32 s43, s35, 8
s_or_b32 s43, s43, 3
s_lshl_b32 s43, s43, 7
s_lshr_b32 s44, s2, 3
s_lshl_b32 s44, s44, 16
s_add_u32 s43, s43, s44
buffer_load_dword v30, v29, s[84:87], s43 offen
s_barrier
s_waitcnt vmcnt(2)
v_add_u32 v20, 129024, v20
ds_write_b64 v20, v[32:33]
v_add_u32 v21, 129024, v21
ds_write_b64 v21, v[34:35]
v_add_u32 v22, 129024, v22
ds_write_b64 v22, v[36:37]
s_waitcnt lgkmcnt(0)
s_lshr_b32 s43, s2, 5
s_cmp_eq_u32 s43, 3
s_cbranch_scc1 Lnj_41
s_cmp_gt_u32 s43, 3
s_cselect_b32 s43, 32, 0
s_sub_u32 s43, s2, s43
s_lshr_b32 s43, s43, 1
s_and_b32 s44, s2, 1
s_lshl_b32 s45, s44, 3
s_add_u32 s45, s45, 32
s_load_dwordx2 s[88:89], s[0:1], s45
s_mul_i32 s45, s43, 2341
s_lshr_b32 s45, s45, 16
s_mul_i32 s46, s45, 28
s_sub_u32 s46, s43, s46
v_lshrrev_b32 v28, 4, v1
s_lshl_b32 s43, s45, 8
v_add_u32 v28, s43, v28
v_mul_u32_u24 v28, 7168, v28
v_and_b32 v29, 15, v1
v_lshl_add_u32 v28, v29, 4, v28
s_lshl_b32 s43, s46, 8
v_add_u32 v28, s43, v28
s_waitcnt lgkmcnt(0)
s_mov_b32 s84, s88
s_mov_b32 s85, s89
s_mov_b32 s86, 7340032
s_mov_b32 s87, 0x20000
s_mov_b32 s43, 0
buffer_load_dwordx4 v[128:131], v28, s[84:87], s43 offen
s_mov_b32 s43, 28672
buffer_load_dwordx4 v[132:135], v28, s[84:87], s43 offen
s_mov_b32 s43, 57344
buffer_load_dwordx4 v[136:139], v28, s[84:87], s43 offen
s_mov_b32 s43, 86016
buffer_load_dwordx4 v[140:143], v28, s[84:87], s43 offen
s_mov_b32 s43, 114688
buffer_load_dwordx4 v[144:147], v28, s[84:87], s43 offen
s_mov_b32 s43, 143360
buffer_load_dwordx4 v[148:151], v28, s[84:87], s43 offen
s_mov_b32 s43, 172032
buffer_load_dwordx4 v[152:155], v28, s[84:87], s43 offen
s_mov_b32 s43, 200704
buffer_load_dwordx4 v[156:159], v28, s[84:87], s43 offen
s_mov_b32 s43, 229376
buffer_load_dwordx4 v[160:163], v28, s[84:87], s43 offen
s_mov_b32 s43, 258048
buffer_load_dwordx4 v[164:167], v28, s[84:87], s43 offen
s_mov_b32 s43, 286720
buffer_load_dwordx4 v[168:171], v28, s[84:87], s43 offen
s_mov_b32 s43, 315392
buffer_load_dwordx4 v[172:175], v28, s[84:87], s43 offen
s_mov_b32 s43, 344064
buffer_load_dwordx4 v[176:179], v28, s[84:87], s43 offen
s_mov_b32 s43, 372736
buffer_load_dwordx4 v[180:183], v28, s[84:87], s43 offen
s_mov_b32 s43, 401408
buffer_load_dwordx4 v[184:187], v28, s[84:87], s43 offen
s_mov_b32 s43, 430080
buffer_load_dwordx4 v[188:191], v28, s[84:87], s43 offen
Lnj_41:
s_barrier
s_lshr_b32 s43, s2, 5
s_cmp_eq_u32 s43, 3
s_cbranch_scc1 Lnj_42
s_cmp_gt_u32 s43, 3
s_cselect_b32 s43, 32, 0
s_sub_u32 s43, s2, s43
s_lshr_b32 s43, s43, 1
s_and_b32 s44, s2, 1
s_lshl_b32 s45, s44, 3
s_add_u32 s45, s45, 32
s_load_dwordx2 s[88:89], s[0:1], s45
s_mul_i32 s45, s43, 2341
s_lshr_b32 s45, s45, 16
s_mul_i32 s46, s45, 28
s_sub_u32 s46, s43, s46
v_lshrrev_b32 v28, 4, v1
s_lshl_b32 s43, s45, 8
v_add_u32 v28, s43, v28
v_mul_u32_u24 v28, 7168, v28
v_and_b32 v29, 15, v1
v_lshl_add_u32 v28, v29, 4, v28
s_lshl_b32 s43, s46, 8
v_add_u32 v28, s43, v28
s_waitcnt lgkmcnt(0)
s_mov_b32 s84, s88
s_mov_b32 s85, s89
s_mov_b32 s86, 7340032
s_mov_b32 s87, 0x20000
s_mov_b32 s43, 458752
buffer_load_dwordx4 v[192:195], v28, s[84:87], s43 offen
s_mov_b32 s43, 487424
buffer_load_dwordx4 v[196:199], v28, s[84:87], s43 offen
s_mov_b32 s43, 516096
buffer_load_dwordx4 v[200:203], v28, s[84:87], s43 offen
s_mov_b32 s43, 544768
buffer_load_dwordx4 v[204:207], v28, s[84:87], s43 offen
s_mov_b32 s43, 573440
buffer_load_dwordx4 v[208:211], v28, s[84:87], s43 offen
s_mov_b32 s43, 602112
buffer_load_dwordx4 v[212:215], v28, s[84:87], s43 offen
s_mov_b32 s43, 630784
buffer_load_dwordx4 v[216:219], v28, s[84:87], s43 offen
s_mov_b32 s43, 659456
buffer_load_dwordx4 v[220:223], v28, s[84:87], s43 offen
s_mov_b32 s43, 688128
buffer_load_dwordx4 v[224:227], v28, s[84:87], s43 offen
s_mov_b32 s43, 716800
buffer_load_dwordx4 v[228:231], v28, s[84:87], s43 offen
s_mov_b32 s43, 745472
buffer_load_dwordx4 v[232:235], v28, s[84:87], s43 offen
s_mov_b32 s43, 774144
buffer_load_dwordx4 v[236:239], v28, s[84:87], s43 offen
s_mov_b32 s43, 802816
buffer_load_dwordx4 v[240:243], v28, s[84:87], s43 offen
s_mov_b32 s43, 831488
buffer_load_dwordx4 v[244:247], v28, s[84:87], s43 offen
s_mov_b32 s43, 860160
buffer_load_dwordx4 v[248:251], v28, s[84:87], s43 offen
s_mov_b32 s43, 888832
buffer_load_dwordx4 v[252:255], v28, s[84:87], s43 offen
Lnj_42:
s_barrier
s_branch Lw_43
Lr_44:
s_branch Lw_45
Lr_46:
s_branch Lw_47
Lr_48:
s_waitcnt lgkmcnt(0)
s_and_b32 s43, s36, 1
s_lshr_b32 s44, s36, 1
s_and_b32 s44, s44, 1
s_lshr_b32 s45, s36, 2
s_xor_b32 s45, s45, 1
v_lshlrev_b32 v14, 2, v13
v_sub_u32 v14, v12, v14
v_subrev_u32 v15, 0, v14
v_cmp_ge_u32 s[52:53], 7, v15
v_add_u32 v15, 16, v15
v_cmp_ge_u32 s[84:85], 7, v15
v_subrev_u32 v15, 1, v14
v_cmp_ge_u32 s[54:55], 7, v15
v_add_u32 v15, 16, v15
v_cmp_ge_u32 s[86:87], 7, v15
v_subrev_u32 v15, 2, v14
v_cmp_ge_u32 s[56:57], 7, v15
v_add_u32 v15, 16, v15
v_cmp_ge_u32 s[88:89], 7, v15
v_subrev_u32 v15, 3, v14
v_cmp_ge_u32 s[58:59], 7, v15
v_add_u32 v15, 16, v15
v_cmp_ge_u32 s[90:91], 7, v15
s_lshl_b32 s46, s45, 6
s_add_u32 s46, s46, s44
s_add_u32 s46, s46, 16
v_lshl_add_u32 v14, v12, 1, s46
s_lshl_b32 s47, s43, 6
v_lshl_add_u32 v15, v13, 4, s47
v_mul_u32_u24 v20, 400, v14
v_add_u32 v20, v20, v15
v_subrev_u32 v16, 32, v14
v_max_i32 v16, 0, v16
v_mul_u32_u24 v21, 400, v16
v_add_u32 v21, v21, v15
v_lshrrev_b32 v16, 2, v12
v_lshl_add_u32 v16, v13, 2, v16
v_lshl_add_u32 v16, v16, 1, s46
v_and_b32 v17, 3, v1
v_lshl_add_u32 v17, v17, 3, s47
v_mul_u32_u24 v22, 400, v16
v_add_u32 v22, v22, v17
v_subrev_u32 v16, 32, v16
v_max_i32 v16, 0, v16
v_mul_u32_u24 v23, 400, v16
v_add_u32 v23, v23, v17
s_lshl_b32 s60, s43, 13
s_lshl_b32 s61, s45, 10
s_add_u32 s60, s60, s61
s_lshl_b32 s61, s44, 8
s_add_u32 s60, s60, s61
v_lshlrev_b32 v27, 11, v13
v_lshl_add_u32 v27, v12, 4, v27
v_add_u32 v27, s60, v27
v_mov_b32 v28, 0xff800000
s_mov_b32 s61, 0x3e8293ee
s_nop 2
s_or_b32 s62, s34, s45
s_cmp_lg_u32 s62, 0
s_cselect_b64 s[64:65], s[84:85], 0
s_cselect_b64 s[66:67], s[86:87], 0
s_cselect_b64 s[68:69], s[88:89], 0
s_cselect_b64 s[70:71], s[90:91], 0
.p2align 3
Latt_5:
s_barrier
ds_read_b128 v[32:35], v20 offset:0
ds_read_b128 v[36:39], v20 offset:128
ds_read_b128 v[40:43], v21 offset:128
ds_read_b128 v[80:83], v20 offset:12800
ds_read_b128 v[84:87], v20 offset:12928
ds_read_b128 v[88:91], v20 offset:128
ds_read_b64_tr_b16 v[44:45], v23 offset:256
ds_read_b64_tr_b16 v[46:47], v22 offset:256
ds_read_b64_tr_b16 v[48:49], v23 offset:288
ds_read_b64_tr_b16 v[50:51], v22 offset:288
ds_read_b64_tr_b16 v[92:93], v22 offset:256
ds_read_b64_tr_b16 v[94:95], v22 offset:13056
ds_read_b64_tr_b16 v[96:97], v22 offset:288
ds_read_b64_tr_b16 v[98:99], v22 offset:13088
s_waitcnt lgkmcnt(11)
v_mfma_f32_16x16x32_bf16 v[52:55], v[40:43], v[32:35], 0
v_mfma_f32_16x16x32_bf16 v[56:59], v[36:39], v[32:35], 0
s_waitcnt lgkmcnt(8)
v_mfma_f32_16x16x32_bf16 v[100:103], v[88:91], v[80:83], 0
v_mfma_f32_16x16x32_bf16 v[104:107], v[84:87], v[80:83], 0
s_nop 7
v_cndmask_b32 v52, v28, v52, s[64:65]
v_cndmask_b32 v100, v28, v100, s[84:85]
v_cndmask_b32 v53, v28, v53, s[66:67]
v_cndmask_b32 v101, v28, v101, s[86:87]
v_cndmask_b32 v54, v28, v54, s[68:69]
v_cndmask_b32 v102, v28, v102, s[88:89]
v_cndmask_b32 v55, v28, v55, s[70:71]
v_cndmask_b32 v103, v28, v103, s[90:91]
v_cndmask_b32 v56, v28, v56, s[52:53]
v_cndmask_b32 v104, v28, v104, s[52:53]
v_cndmask_b32 v57, v28, v57, s[54:55]
v_cndmask_b32 v105, v28, v105, s[54:55]
v_cndmask_b32 v58, v28, v58, s[56:57]
v_cndmask_b32 v106, v28, v106, s[56:57]
v_cndmask_b32 v59, v28, v59, s[58:59]
v_cndmask_b32 v107, v28, v107, s[58:59]
v_max3_f32 v60, v52, v53, v54
v_max3_f32 v108, v100, v101, v102
v_max3_f32 v61, v55, v56, v57
v_max3_f32 v109, v103, v104, v105
v_max3_f32 v60, v60, v58, v59
v_max3_f32 v108, v108, v106, v107
v_max_f32 v60, v60, v61
v_max_f32 v108, v108, v109
v_mov_b32 v61, v60
v_mov_b32 v109, v108
s_nop 0
v_permlane32_swap_b32 v60, v61
v_permlane32_swap_b32 v108, v109
v_max_f32 v60, v60, v61
v_max_f32 v108, v108, v109
v_mov_b32 v61, v60
v_mov_b32 v109, v108
s_nop 0
v_permlane16_swap_b32 v60, v61
v_permlane16_swap_b32 v108, v109
v_max_f32 v60, v60, v61
v_max_f32 v108, v108, v109
v_mul_f32 v60, s61, v60
v_mul_f32 v108, s61, v108
v_fma_f32 v52, v52, s61, -v60
v_fma_f32 v100, v100, s61, -v108
v_fma_f32 v53, v53, s61, -v60
v_fma_f32 v101, v101, s61, -v108
v_fma_f32 v54, v54, s61, -v60
v_fma_f32 v102, v102, s61, -v108
v_fma_f32 v55, v55, s61, -v60
v_fma_f32 v103, v103, s61, -v108
v_fma_f32 v56, v56, s61, -v60
v_fma_f32 v104, v104, s61, -v108
v_fma_f32 v57, v57, s61, -v60
v_fma_f32 v105, v105, s61, -v108
v_fma_f32 v58, v58, s61, -v60
v_fma_f32 v106, v106, s61, -v108
v_fma_f32 v59, v59, s61, -v60
v_fma_f32 v107, v107, s61, -v108
v_exp_f32 v52, v52
v_exp_f32 v100, v100
s_barrier
v_exp_f32 v53, v53
v_exp_f32 v101, v101
v_exp_f32 v54, v54
v_exp_f32 v102, v102
v_exp_f32 v55, v55
v_exp_f32 v103, v103
v_exp_f32 v56, v56
v_exp_f32 v104, v104
v_exp_f32 v57, v57
v_exp_f32 v105, v105
v_exp_f32 v58, v58
v_exp_f32 v106, v106
v_exp_f32 v59, v59
v_exp_f32 v107, v107
v_cvt_pk_bf16_f32 v64, v52, v53
v_cvt_pk_bf16_f32 v112, v100, v101
v_cvt_pk_bf16_f32 v65, v54, v55
v_cvt_pk_bf16_f32 v113, v102, v103
v_cvt_pk_bf16_f32 v66, v56, v57
v_cvt_pk_bf16_f32 v114, v104, v105
v_cvt_pk_bf16_f32 v67, v58, v59
v_cvt_pk_bf16_f32 v115, v106, v107
s_waitcnt lgkmcnt(0)
v_mfma_f32_16x16x32_bf16 v[68:71], v[44:47], v[64:67], 0
v_mfma_f32_16x16x32_bf16 v[72:75], v[48:51], v[64:67], 0
v_mfma_f32_16x16x32_bf16 v[116:119], v[92:95], v[112:115], 0
v_mfma_f32_16x16x32_bf16 v[120:123], v[96:99], v[112:115], 0
s_load_dwordx4 s[4:7], s[0:1], 32
s_load_dwordx2 s[28:29], s[0:1], 16
s_load_dwordx4 s[60:63], s[0:1], 48
v_add_f32 v60, v52, v53
v_add_f32 v108, v100, v101
v_add_f32 v61, v54, v55
v_add_f32 v109, v102, v103
v_add_f32 v56, v56, v57
v_add_f32 v104, v104, v105
v_add_f32 v58, v58, v59
v_add_f32 v106, v106, v107
v_add_f32 v60, v60, v61
v_add_f32 v108, v108, v109
v_add_f32 v56, v56, v58
v_add_f32 v104, v104, v106
v_add_f32 v60, v60, v56
v_add_f32 v108, v108, v104
v_mov_b32 v61, v60
v_mov_b32 v109, v108
s_nop 0
v_permlane32_swap_b32 v60, v61
v_permlane32_swap_b32 v108, v109
v_add_f32 v60, v60, v61
v_add_f32 v108, v108, v109
v_mov_b32 v61, v60
v_mov_b32 v109, v108
s_nop 0
v_permlane16_swap_b32 v60, v61
v_permlane16_swap_b32 v108, v109
v_add_f32 v60, v60, v61
v_add_f32 v108, v108, v109
v_rcp_f32 v60, v60
v_rcp_f32 v108, v108
s_nop 0
v_pk_mul_f32 v[68:69], v[60:61], v[68:69] op_sel_hi:[0,1]
v_pk_mul_f32 v[70:71], v[60:61], v[70:71] op_sel_hi:[0,1]
v_pk_mul_f32 v[72:73], v[60:61], v[72:73] op_sel_hi:[0,1]
v_pk_mul_f32 v[74:75], v[60:61], v[74:75] op_sel_hi:[0,1]
v_cvt_pk_bf16_f32 v68, v68, v69
v_cvt_pk_bf16_f32 v69, v70, v71
v_cvt_pk_bf16_f32 v70, v72, v73
v_cvt_pk_bf16_f32 v71, v74, v75
buffer_store_dwordx4 v[68:71], v27, s[16:19], 0 offen offset:0 sc1
v_pk_mul_f32 v[116:117], v[108:109], v[116:117] op_sel_hi:[0,1]
v_pk_mul_f32 v[118:119], v[108:109], v[118:119] op_sel_hi:[0,1]
v_pk_mul_f32 v[120:121], v[108:109], v[120:121] op_sel_hi:[0,1]
v_pk_mul_f32 v[122:123], v[108:109], v[122:123] op_sel_hi:[0,1]
v_cvt_pk_bf16_f32 v116, v116, v117
v_cvt_pk_bf16_f32 v117, v118, v119
v_cvt_pk_bf16_f32 v118, v120, v121
v_cvt_pk_bf16_f32 v119, v122, v123
buffer_store_dwordx4 v[116:119], v27, s[16:19], 0 offen offset:512 sc1
s_branch Lk1e_49
.p2align 6
Lw_47:
s_branch Lr_48
s_nop 0
.p2align 3
Latt_4:
s_barrier
ds_read_b128 v[32:35], v20 offset:0
ds_read_b128 v[36:39], v20 offset:128
ds_read_b128 v[40:43], v21 offset:128
ds_read_b128 v[80:83], v20 offset:12800
ds_read_b128 v[84:87], v20 offset:12928
ds_read_b128 v[88:91], v20 offset:128
ds_read_b64_tr_b16 v[44:45], v23 offset:256
ds_read_b64_tr_b16 v[46:47], v22 offset:256
ds_read_b64_tr_b16 v[48:49], v23 offset:288
ds_read_b64_tr_b16 v[50:51], v22 offset:288
ds_read_b64_tr_b16 v[92:93], v22 offset:256
ds_read_b64_tr_b16 v[94:95], v22 offset:13056
ds_read_b64_tr_b16 v[96:97], v22 offset:288
ds_read_b64_tr_b16 v[98:99], v22 offset:13088
s_waitcnt lgkmcnt(11)
v_mfma_f32_16x16x32_bf16 v[52:55], v[40:43], v[32:35], 0
v_mfma_f32_16x16x32_bf16 v[56:59], v[36:39], v[32:35], 0
s_waitcnt lgkmcnt(8)
v_mfma_f32_16x16x32_bf16 v[100:103], v[88:91], v[80:83], 0
v_mfma_f32_16x16x32_bf16 v[104:107], v[84:87], v[80:83], 0
s_nop 7
v_cndmask_b32 v52, v28, v52, s[64:65]
v_cndmask_b32 v100, v28, v100, s[84:85]
v_cndmask_b32 v53, v28, v53, s[66:67]
v_cndmask_b32 v101, v28, v101, s[86:87]
v_cndmask_b32 v54, v28, v54, s[68:69]
v_cndmask_b32 v102, v28, v102, s[88:89]
v_cndmask_b32 v55, v28, v55, s[70:71]
v_cndmask_b32 v103, v28, v103, s[90:91]
v_cndmask_b32 v56, v28, v56, s[52:53]
v_cndmask_b32 v104, v28, v104, s[52:53]
v_cndmask_b32 v57, v28, v57, s[54:55]
v_cndmask_b32 v105, v28, v105, s[54:55]
v_cndmask_b32 v58, v28, v58, s[56:57]
v_cndmask_b32 v106, v28, v106, s[56:57]
v_cndmask_b32 v59, v28, v59, s[58:59]
v_cndmask_b32 v107, v28, v107, s[58:59]
v_max3_f32 v60, v52, v53, v54
v_max3_f32 v108, v100, v101, v102
v_max3_f32 v61, v55, v56, v57
v_max3_f32 v109, v103, v104, v105
v_max3_f32 v60, v60, v58, v59
v_max3_f32 v108, v108, v106, v107
v_max_f32 v60, v60, v61
v_max_f32 v108, v108, v109
v_mov_b32 v61, v60
v_mov_b32 v109, v108
s_nop 0
v_permlane32_swap_b32 v60, v61
v_permlane32_swap_b32 v108, v109
v_max_f32 v60, v60, v61
v_max_f32 v108, v108, v109
v_mov_b32 v61, v60
v_mov_b32 v109, v108
s_nop 0
v_permlane16_swap_b32 v60, v61
v_permlane16_swap_b32 v108, v109
v_max_f32 v60, v60, v61
v_max_f32 v108, v108, v109
v_mul_f32 v60, s61, v60
v_mul_f32 v108, s61, v108
v_fma_f32 v52, v52, s61, -v60
v_fma_f32 v100, v100, s61, -v108
v_fma_f32 v53, v53, s61, -v60
v_fma_f32 v101, v101, s61, -v108
v_fma_f32 v54, v54, s61, -v60
v_fma_f32 v102, v102, s61, -v108
v_fma_f32 v55, v55, s61, -v60
v_fma_f32 v103, v103, s61, -v108
v_fma_f32 v56, v56, s61, -v60
v_fma_f32 v104, v104, s61, -v108
v_fma_f32 v57, v57, s61, -v60
v_fma_f32 v105, v105, s61, -v108
v_fma_f32 v58, v58, s61, -v60
v_fma_f32 v106, v106, s61, -v108
v_fma_f32 v59, v59, s61, -v60
v_fma_f32 v107, v107, s61, -v108
v_exp_f32 v52, v52
v_exp_f32 v100, v100
v_exp_f32 v53, v53
v_exp_f32 v101, v101
v_exp_f32 v54, v54
v_exp_f32 v102, v102
v_exp_f32 v55, v55
v_exp_f32 v103, v103
v_exp_f32 v56, v56
v_exp_f32 v104, v104
v_exp_f32 v57, v57
v_exp_f32 v105, v105
v_exp_f32 v58, v58
v_exp_f32 v106, v106
v_exp_f32 v59, v59
v_exp_f32 v107, v107
v_cvt_pk_bf16_f32 v64, v52, v53
v_cvt_pk_bf16_f32 v112, v100, v101
v_cvt_pk_bf16_f32 v65, v54, v55
v_cvt_pk_bf16_f32 v113, v102, v103
v_cvt_pk_bf16_f32 v66, v56, v57
v_cvt_pk_bf16_f32 v114, v104, v105
v_cvt_pk_bf16_f32 v67, v58, v59
v_cvt_pk_bf16_f32 v115, v106, v107
s_waitcnt lgkmcnt(0)
v_mfma_f32_16x16x32_bf16 v[68:71], v[44:47], v[64:67], 0
v_mfma_f32_16x16x32_bf16 v[72:75], v[48:51], v[64:67], 0
v_mfma_f32_16x16x32_bf16 v[116:119], v[92:95], v[112:115], 0
v_mfma_f32_16x16x32_bf16 v[120:123], v[96:99], v[112:115], 0
s_load_dwordx4 s[4:7], s[0:1], 32
s_load_dwordx2 s[28:29], s[0:1], 16
s_load_dwordx4 s[60:63], s[0:1], 48
v_add_f32 v60, v52, v53
v_add_f32 v108, v100, v101
v_add_f32 v61, v54, v55
v_add_f32 v109, v102, v103
v_add_f32 v56, v56, v57
v_add_f32 v104, v104, v105
v_add_f32 v58, v58, v59
v_add_f32 v106, v106, v107
v_add_f32 v60, v60, v61
v_add_f32 v108, v108, v109
v_add_f32 v56, v56, v58
v_add_f32 v104, v104, v106
v_add_f32 v60, v60, v56
v_add_f32 v108, v108, v104
v_mov_b32 v61, v60
v_mov_b32 v109, v108
s_nop 0
v_permlane32_swap_b32 v60, v61
v_permlane32_swap_b32 v108, v109
v_add_f32 v60, v60, v61
v_add_f32 v108, v108, v109
v_mov_b32 v61, v60
v_mov_b32 v109, v108
s_nop 0
v_permlane16_swap_b32 v60, v61
v_permlane16_swap_b32 v108, v109
v_add_f32 v60, v60, v61
v_add_f32 v108, v108, v109
v_rcp_f32 v60, v60
v_rcp_f32 v108, v108
s_nop 0
v_pk_mul_f32 v[68:69], v[60:61], v[68:69] op_sel_hi:[0,1]
v_pk_mul_f32 v[70:71], v[60:61], v[70:71] op_sel_hi:[0,1]
v_pk_mul_f32 v[72:73], v[60:61], v[72:73] op_sel_hi:[0,1]
v_pk_mul_f32 v[74:75], v[60:61], v[74:75] op_sel_hi:[0,1]
v_cvt_pk_bf16_f32 v68, v68, v69
v_cvt_pk_bf16_f32 v69, v70, v71
v_cvt_pk_bf16_f32 v70, v72, v73
v_cvt_pk_bf16_f32 v71, v74, v75
buffer_store_dwordx4 v[68:71], v27, s[16:19], 0 offen offset:0 sc1
v_pk_mul_f32 v[116:117], v[108:109], v[116:117] op_sel_hi:[0,1]
v_pk_mul_f32 v[118:119], v[108:109], v[118:119] op_sel_hi:[0,1]
v_pk_mul_f32 v[120:121], v[108:109], v[120:121] op_sel_hi:[0,1]
v_pk_mul_f32 v[122:123], v[108:109], v[122:123] op_sel_hi:[0,1]
v_cvt_pk_bf16_f32 v116, v116, v117
v_cvt_pk_bf16_f32 v117, v118, v119
v_cvt_pk_bf16_f32 v118, v120, v121
v_cvt_pk_bf16_f32 v119, v122, v123
buffer_store_dwordx4 v[116:119], v27, s[16:19], 0 offen offset:512 sc1
Lk1e_49:
s_add_u32 s56, s32, 28311552
s_addc_u32 s57, s33, 0
s_mov_b32 s58, 40960
s_mov_b32 s59, 0x20000
v_and_b32 v17, 15, v1
v_lshrrev_b32 v18, 4, v1
s_lshr_b32 s46, s36, 1
s_and_b32 s46, s46, 1
s_and_b32 s47, s36, 1
s_and_b32 s51, s36, 3
s_bfe_u32 s49, s35, 0x20001
s_sub_u32 s43, 0, s49
s_and_b32 s43, s43, 3
s_cmp_ge_u32 s35, 8
s_cselect_b32 s49, s43, s49
s_lshl_b32 s49, s49, 2
s_lshr_b32 s43, s35, 3
s_lshl_b32 s43, s43, 1
s_add_u32 s49, s49, s43
s_and_b32 s43, s35, 1
s_add_u32 s49, s49, s43
s_waitcnt lgkmcnt(0)
s_cmp_ge_u32 s36, 4
s_cbranch_scc1 LG1_50
v_lshlrev_b32 v19, 11, v18
v_lshl_add_u32 v19, v17, 4, v19
s_lshl_b32 s43, s36, 9
v_add_u32 v2, s43, v19
v_add_u32 v4, 98304, v2
v_lshrrev_b32 v19, 2, v17
v_lshl_add_u32 v20, v18, 2, v19
v_bfe_u32 v21, v20, 1, 2
v_lshlrev_b32 v20, 7, v20
v_lshl_add_u32 v20, v21, 5, v20
v_and_b32 v19, 3, v1
v_lshl_add_u32 v20, v19, 3, v20
v_add_u32 v5, 0x10000, v20
v_xor_b32 v6, 32, v5
v_xor_b32 v7, 64, v5
v_xor_b32 v8, 96, v5
v_add_u32 v9, 0x10000, v5
v_add_u32 v10, 0x10000, v6
v_add_u32 v11, 0x10000, v7
v_add_u32 v12, 0x10000, v8
s_lshl_b32 s43, s34, 18
s_lshl_b32 s44, s35, 14
s_add_u32 s43, s43, s44
s_add_u32 s20, s32, s43
s_addc_u32 s21, s33, 0
s_add_u32 s20, s20, 4194304
s_addc_u32 s21, s21, 0
s_mov_b32 s22, 16384
s_mov_b32 s23, 0x20000
s_lshl_b32 s43, s34, 14
s_lshl_b32 s44, s35, 10
s_add_u32 s43, s43, s44
s_add_u32 s24, s32, s43
s_addc_u32 s25, s33, 0
s_add_u32 s24, s24, 25165824
s_addc_u32 s25, s25, 0
s_mov_b32 s26, 1024
s_mov_b32 s27, 0x20000
s_movk_i32 s50, 0x2000
v_lshrrev_b32 v19, 1, v18
v_lshl_add_u32 v19, v19, 4, v17
s_lshl_b32 s43, s36, 5
v_add_u32 v19, s43, v19
v_and_b32 v20, 1, v18
v_lshlrev_b32 v20, 2, v20
v_lshl_add_u32 v22, v19, 3, v20
s_lshl_b32 s43, s34, 18
s_add_u32 s12, s32, s43
s_addc_u32 s13, s33, 0
s_mov_b32 s14, 262144
s_mov_b32 s15, 0x20000
v_lshlrev_b32 v21, 4, v1
s_lshl_b32 s54, s36, 11
s_add_u32 s43, s35, 1
s_and_b32 s43, s43, 15
s_lshl_b32 s43, s43, 14
s_add_u32 s30, s43, s54
s_add_u32 s43, s35, 2
s_and_b32 s43, s43, 15
s_lshl_b32 s43, s43, 14
s_add_u32 s31, s43, s54
s_waitcnt vmcnt(0)
s_barrier
ds_write_b128 v27, v[68:71] offset:0
ds_write_b128 v27, v[116:119] offset:512
v_permlane16_swap_b32 v240, v242
v_permlane16_swap_b32 v241, v243
v_permlane16_swap_b32 v244, v246
v_permlane16_swap_b32 v245, v247
v_permlane16_swap_b32 v248, v250
v_permlane16_swap_b32 v249, v251
v_permlane16_swap_b32 v252, v254
v_permlane16_swap_b32 v253, v255
v_lshlrev_b32 v128, 16, v240
v_and_b32 v129, 0xffff0000, v240
v_lshlrev_b32 v130, 16, v241
v_and_b32 v131, 0xffff0000, v241
v_lshlrev_b32 v132, 16, v242
v_and_b32 v133, 0xffff0000, v242
v_lshlrev_b32 v134, 16, v243
v_and_b32 v135, 0xffff0000, v243
v_lshlrev_b32 v136, 16, v244
v_and_b32 v137, 0xffff0000, v244
v_lshlrev_b32 v138, 16, v245
v_and_b32 v139, 0xffff0000, v245
v_lshlrev_b32 v140, 16, v246
v_and_b32 v141, 0xffff0000, v246
v_lshlrev_b32 v142, 16, v247
v_and_b32 v143, 0xffff0000, v247
v_lshlrev_b32 v144, 16, v248
v_and_b32 v145, 0xffff0000, v248
v_lshlrev_b32 v146, 16, v249
v_and_b32 v147, 0xffff0000, v249
v_lshlrev_b32 v148, 16, v250
v_and_b32 v149, 0xffff0000, v250
v_lshlrev_b32 v150, 16, v251
v_and_b32 v151, 0xffff0000, v251
v_lshlrev_b32 v152, 16, v252
v_and_b32 v153, 0xffff0000, v252
v_lshlrev_b32 v154, 16, v253
v_and_b32 v155, 0xffff0000, v253
v_lshlrev_b32 v156, 16, v254
v_and_b32 v157, 0xffff0000, v254
v_lshlrev_b32 v158, 16, v255
v_and_b32 v159, 0xffff0000, v255
s_waitcnt lgkmcnt(0)
s_barrier
s_add_u32 m0, s54, 16384
s_add_u32 s43, s30, 0
buffer_load_dwordx4 v21, s[12:15], s43 offen sc1 lds
s_add_u32 m0, s54, 17408
s_add_u32 s43, s30, 1024
buffer_load_dwordx4 v21, s[12:15], s43 offen sc1 lds
s_add_u32 m0, s54, 32768
s_add_u32 s43, s31, 0
buffer_load_dwordx4 v21, s[12:15], s43 offen sc1 lds
s_add_u32 m0, s54, 33792
s_add_u32 s43, s31, 1024
buffer_load_dwordx4 v21, s[12:15], s43 offen sc1 lds
ds_read_b128 v[32:35], v2 offset:0
ds_read_b64_tr_b16 v[48:49], v5 offset:0
ds_read_b64_tr_b16 v[50:51], v5 offset:2048
ds_read_b64_tr_b16 v[52:53], v6 offset:0
ds_read_b64_tr_b16 v[54:55], v6 offset:2048
ds_read_b128 v[36:39], v2 offset:256
ds_read_b64_tr_b16 v[56:57], v7 offset:0
ds_read_b64_tr_b16 v[58:59], v7 offset:2048
ds_read_b64_tr_b16 v[60:61], v8 offset:0
ds_read_b64_tr_b16 v[62:63], v8 offset:2048
ds_read_b128 v[40:43], v2 offset:8192
ds_read_b64_tr_b16 v[64:65], v5 offset:4096
ds_read_b64_tr_b16 v[66:67], v5 offset:6144
ds_read_b64_tr_b16 v[68:69], v6 offset:4096
ds_read_b64_tr_b16 v[70:71], v6 offset:6144
ds_read_b128 v[44:47], v2 offset:8448
ds_read_b64_tr_b16 v[72:73], v7 offset:4096
ds_read_b64_tr_b16 v[74:75], v7 offset:6144
ds_read_b64_tr_b16 v[76:77], v8 offset:4096
ds_read_b64_tr_b16 v[78:79], v8 offset:6144
s_waitcnt lgkmcnt(0)
v_mfma_f32_16x16x32_bf16 v[128:131], v[48:51], v[32:35], v[128:131]
v_mfma_f32_16x16x32_bf16 v[132:135], v[52:55], v[32:35], v[132:135]
v_mfma_f32_16x16x32_bf16 v[136:139], v[56:59], v[32:35], v[136:139]
v_mfma_f32_16x16x32_bf16 v[140:143], v[60:63], v[32:35], v[140:143]
v_mfma_f32_16x16x32_bf16 v[144:147], v[48:51], v[36:39], v[144:147]
v_mfma_f32_16x16x32_bf16 v[148:151], v[52:55], v[36:39], v[148:151]
v_mfma_f32_16x16x32_bf16 v[152:155], v[56:59], v[36:39], v[152:155]
v_mfma_f32_16x16x32_bf16 v[156:159], v[60:63], v[36:39], v[156:159]
v_mfma_f32_16x16x32_bf16 v[128:131], v[64:67], v[40:43], v[128:131]
v_mfma_f32_16x16x32_bf16 v[132:135], v[68:71], v[40:43], v[132:135]
v_mfma_f32_16x16x32_bf16 v[136:139], v[72:75], v[40:43], v[136:139]
v_mfma_f32_16x16x32_bf16 v[140:143], v[76:79], v[40:43], v[140:143]
v_mfma_f32_16x16x32_bf16 v[144:147], v[64:67], v[44:47], v[144:147]
v_mfma_f32_16x16x32_bf16 v[148:151], v[68:71], v[44:47], v[148:151]
v_mfma_f32_16x16x32_bf16 v[152:155], v[72:75], v[44:47], v[152:155]
v_mfma_f32_16x16x32_bf16 v[156:159], v[76:79], v[44:47], v[156:159]
s_waitcnt vmcnt(2)
s_barrier
ds_read_b128 v[80:83], v2 offset:16384
ds_read_b64_tr_b16 v[96:97], v5 offset:8192
ds_read_b64_tr_b16 v[98:99], v5 offset:10240
ds_read_b64_tr_b16 v[100:101], v6 offset:8192
ds_read_b64_tr_b16 v[102:103], v6 offset:10240
ds_read_b128 v[84:87], v2 offset:16640
ds_read_b64_tr_b16 v[104:105], v7 offset:8192
ds_read_b64_tr_b16 v[106:107], v7 offset:10240
ds_read_b64_tr_b16 v[108:109], v8 offset:8192
ds_read_b64_tr_b16 v[110:111], v8 offset:10240
ds_read_b128 v[88:91], v2 offset:24576
ds_read_b64_tr_b16 v[112:113], v5 offset:12288
ds_read_b64_tr_b16 v[114:115], v5 offset:14336
ds_read_b64_tr_b16 v[116:117], v6 offset:12288
ds_read_b64_tr_b16 v[118:119], v6 offset:14336
ds_read_b128 v[92:95], v2 offset:24832
ds_read_b64_tr_b16 v[120:121], v7 offset:12288
ds_read_b64_tr_b16 v[122:123], v7 offset:14336
ds_read_b64_tr_b16 v[124:125], v8 offset:12288
ds_read_b64_tr_b16 v[126:127], v8 offset:14336
s_waitcnt vmcnt(0) lgkmcnt(0)
v_max3_u32 v19, v80, v81, v82
v_max3_u32 v19, v19, v83, v84
v_max3_u32 v19, v19, v85, v86
v_max3_u32 v19, v19, v87, v88
v_max3_u32 v19, v19, v89, v90
v_max3_u32 v19, v19, v91, v92
v_max3_u32 v19, v19, v93, v94
v_max_u32 v19, v19, v95
v_cmp_eq_u32 vcc, -1, v19
s_nop 4
s_cbranch_vccnz Lfx_53
Lok_51:
s_barrier
v_mfma_f32_16x16x32_bf16 v[128:131], v[96:99], v[80:83], v[128:131]
ds_read_b128 v[32:35], v2 offset:32768
ds_read_b64_tr_b16 v[48:49], v5 offset:16384
v_mfma_f32_16x16x32_bf16 v[132:135], v[100:103], v[80:83], v[132:135]
ds_read_b64_tr_b16 v[50:51], v5 offset:18432
v_mfma_f32_16x16x32_bf16 v[136:139], v[104:107], v[80:83], v[136:139]
ds_read_b64_tr_b16 v[52:53], v6 offset:16384
v_mfma_f32_16x16x32_bf16 v[140:143], v[108:111], v[80:83], v[140:143]
ds_read_b64_tr_b16 v[54:55], v6 offset:18432
v_mfma_f32_16x16x32_bf16 v[144:147], v[96:99], v[84:87], v[144:147]
ds_read_b128 v[36:39], v2 offset:33024
ds_read_b64_tr_b16 v[56:57], v7 offset:16384
v_mfma_f32_16x16x32_bf16 v[148:151], v[100:103], v[84:87], v[148:151]
ds_read_b64_tr_b16 v[58:59], v7 offset:18432
v_mfma_f32_16x16x32_bf16 v[152:155], v[104:107], v[84:87], v[152:155]
ds_read_b64_tr_b16 v[60:61], v8 offset:16384
v_mfma_f32_16x16x32_bf16 v[156:159], v[108:111], v[84:87], v[156:159]
ds_read_b64_tr_b16 v[62:63], v8 offset:18432
v_mfma_f32_16x16x32_bf16 v[128:131], v[112:115], v[88:91], v[128:131]
ds_read_b128 v[40:43], v2 offset:40960
ds_read_b64_tr_b16 v[64:65], v5 offset:20480
v_mfma_f32_16x16x32_bf16 v[132:135], v[116:119], v[88:91], v[132:135]
ds_read_b64_tr_b16 v[66:67], v5 offset:22528
v_mfma_f32_16x16x32_bf16 v[136:139], v[120:123], v[88:91], v[136:139]
ds_read_b64_tr_b16 v[68:69], v6 offset:20480
v_mfma_f32_16x16x32_bf16 v[140:143], v[124:127], v[88:91], v[140:143]
ds_read_b64_tr_b16 v[70:71], v6 offset:22528
v_mfma_f32_16x16x32_bf16 v[144:147], v[112:115], v[92:95], v[144:147]
ds_read_b128 v[44:47], v2 offset:41216
ds_read_b64_tr_b16 v[72:73], v7 offset:20480
v_mfma_f32_16x16x32_bf16 v[148:151], v[116:119], v[92:95], v[148:151]
ds_read_b64_tr_b16 v[74:75], v7 offset:22528
v_mfma_f32_16x16x32_bf16 v[152:155], v[120:123], v[92:95], v[152:155]
ds_read_b64_tr_b16 v[76:77], v8 offset:20480
v_mfma_f32_16x16x32_bf16 v[156:159], v[124:127], v[92:95], v[156:159]
ds_read_b64_tr_b16 v[78:79], v8 offset:22528
s_waitcnt lgkmcnt(0)
v_max3_u32 v19, v32, v33, v34
v_max3_u32 v19, v19, v35, v36
v_max3_u32 v19, v19, v37, v38
v_max3_u32 v19, v19, v39, v40
v_max3_u32 v19, v19, v41, v42
v_max3_u32 v19, v19, v43, v44
v_max3_u32 v19, v19, v45, v46
v_max_u32 v19, v19, v47
v_cmp_eq_u32 vcc, -1, v19
s_nop 4
s_cbranch_vccnz Lfx_56
Lok_54:
s_barrier
v_mfma_f32_16x16x32_bf16 v[128:131], v[48:51], v[32:35], v[128:131]
ds_read_b128 v[80:83], v2 offset:49152
ds_read_b64_tr_b16 v[96:97], v5 offset:24576
v_mfma_f32_16x16x32_bf16 v[132:135], v[52:55], v[32:35], v[132:135]
ds_read_b64_tr_b16 v[98:99], v5 offset:26624
v_mfma_f32_16x16x32_bf16 v[136:139], v[56:59], v[32:35], v[136:139]
ds_read_b64_tr_b16 v[100:101], v6 offset:24576
v_mfma_f32_16x16x32_bf16 v[140:143], v[60:63], v[32:35], v[140:143]
ds_read_b64_tr_b16 v[102:103], v6 offset:26624
v_mfma_f32_16x16x32_bf16 v[144:147], v[48:51], v[36:39], v[144:147]
ds_read_b128 v[84:87], v2 offset:49408
ds_read_b64_tr_b16 v[104:105], v7 offset:24576
v_mfma_f32_16x16x32_bf16 v[148:151], v[52:55], v[36:39], v[148:151]
ds_read_b64_tr_b16 v[106:107], v7 offset:26624
v_mfma_f32_16x16x32_bf16 v[152:155], v[56:59], v[36:39], v[152:155]
ds_read_b64_tr_b16 v[108:109], v8 offset:24576
v_mfma_f32_16x16x32_bf16 v[156:159], v[60:63], v[36:39], v[156:159]
ds_read_b64_tr_b16 v[110:111], v8 offset:26624
v_mfma_f32_16x16x32_bf16 v[128:131], v[64:67], v[40:43], v[128:131]
ds_read_b128 v[88:91], v2 offset:57344
ds_read_b64_tr_b16 v[112:113], v5 offset:28672
v_mfma_f32_16x16x32_bf16 v[132:135], v[68:71], v[40:43], v[132:135]
ds_read_b64_tr_b16 v[114:115], v5 offset:30720
v_mfma_f32_16x16x32_bf16 v[136:139], v[72:75], v[40:43], v[136:139]
ds_read_b64_tr_b16 v[116:117], v6 offset:28672
v_mfma_f32_16x16x32_bf16 v[140:143], v[76:79], v[40:43], v[140:143]
ds_read_b64_tr_b16 v[118:119], v6 offset:30720
v_mfma_f32_16x16x32_bf16 v[144:147], v[64:67], v[44:47], v[144:147]
ds_read_b128 v[92:95], v2 offset:57600
ds_read_b64_tr_b16 v[120:121], v7 offset:28672
v_mfma_f32_16x16x32_bf16 v[148:151], v[68:71], v[44:47], v[148:151]
ds_read_b64_tr_b16 v[122:123], v7 offset:30720
v_mfma_f32_16x16x32_bf16 v[152:155], v[72:75], v[44:47], v[152:155]
ds_read_b64_tr_b16 v[124:125], v8 offset:28672
v_mfma_f32_16x16x32_bf16 v[156:159], v[76:79], v[44:47], v[156:159]
ds_read_b64_tr_b16 v[126:127], v8 offset:30720
s_waitcnt lgkmcnt(0)
v_max3_u32 v19, v80, v81, v82
v_max3_u32 v19, v19, v83, v84
v_max3_u32 v19, v19, v85, v86
v_max3_u32 v19, v19, v87, v88
v_max3_u32 v19, v19, v89, v90
v_max3_u32 v19, v19, v91, v92
v_max3_u32 v19, v19, v93, v94
v_max_u32 v19, v19, v95
v_cmp_eq_u32 vcc, -1, v19
s_nop 4
s_cbranch_vccnz Lfx_59
Lok_57:
s_barrier
v_mfma_f32_16x16x32_bf16 v[128:131], v[96:99], v[80:83], v[128:131]
ds_read_b128 v[32:35], v2 offset:0
ds_read_b64_tr_b16 v[48:49], v5 offset:32768
v_mfma_f32_16x16x32_bf16 v[132:135], v[100:103], v[80:83], v[132:135]
ds_read_b64_tr_b16 v[50:51], v5 offset:34816
v_mfma_f32_16x16x32_bf16 v[136:139], v[104:107], v[80:83], v[136:139]
ds_read_b64_tr_b16 v[52:53], v6 offset:32768
v_mfma_f32_16x16x32_bf16 v[140:143], v[108:111], v[80:83], v[140:143]
ds_read_b64_tr_b16 v[54:55], v6 offset:34816
v_mfma_f32_16x16x32_bf16 v[144:147], v[96:99], v[84:87], v[144:147]
ds_read_b128 v[36:39], v2 offset:256
ds_read_b64_tr_b16 v[56:57], v7 offset:32768
v_mfma_f32_16x16x32_bf16 v[148:151], v[100:103], v[84:87], v[148:151]
ds_read_b64_tr_b16 v[58:59], v7 offset:34816
v_mfma_f32_16x16x32_bf16 v[152:155], v[104:107], v[84:87], v[152:155]
ds_read_b64_tr_b16 v[60:61], v8 offset:32768
v_mfma_f32_16x16x32_bf16 v[156:159], v[108:111], v[84:87], v[156:159]
ds_read_b64_tr_b16 v[62:63], v8 offset:34816
v_mfma_f32_16x16x32_bf16 v[128:131], v[112:115], v[88:91], v[128:131]
ds_read_b128 v[40:43], v2 offset:8192
ds_read_b64_tr_b16 v[64:65], v5 offset:36864
v_mfma_f32_16x16x32_bf16 v[132:135], v[116:119], v[88:91], v[132:135]
ds_read_b64_tr_b16 v[66:67], v5 offset:38912
v_mfma_f32_16x16x32_bf16 v[136:139], v[120:123], v[88:91], v[136:139]
ds_read_b64_tr_b16 v[68:69], v6 offset:36864
v_mfma_f32_16x16x32_bf16 v[140:143], v[124:127], v[88:91], v[140:143]
ds_read_b64_tr_b16 v[70:71], v6 offset:38912
v_mfma_f32_16x16x32_bf16 v[144:147], v[112:115], v[92:95], v[144:147]
ds_read_b128 v[44:47], v2 offset:8448
ds_read_b64_tr_b16 v[72:73], v7 offset:36864
v_mfma_f32_16x16x32_bf16 v[148:151], v[116:119], v[92:95], v[148:151]
ds_read_b64_tr_b16 v[74:75], v7 offset:38912
v_mfma_f32_16x16x32_bf16 v[152:155], v[120:123], v[92:95], v[152:155]
ds_read_b64_tr_b16 v[76:77], v8 offset:36864
v_mfma_f32_16x16x32_bf16 v[156:159], v[124:127], v[92:95], v[156:159]
ds_read_b64_tr_b16 v[78:79], v8 offset:38912
s_waitcnt lgkmcnt(0)
v_max3_u32 v19, v32, v33, v34
v_max3_u32 v19, v19, v35, v36
v_max3_u32 v19, v19, v37, v38
v_max3_u32 v19, v19, v39, v40
v_max3_u32 v19, v19, v41, v42
v_max3_u32 v19, v19, v43, v44
v_max3_u32 v19, v19, v45, v46
v_max_u32 v19, v19, v47
v_cmp_eq_u32 vcc, -1, v19
s_nop 4
s_cbranch_vccnz Lfx_62
Lok_60:
s_barrier
v_mfma_f32_16x16x32_bf16 v[128:131], v[48:51], v[32:35], v[128:131]
ds_read_b128 v[80:83], v2 offset:16384
ds_read_b64_tr_b16 v[96:97], v5 offset:40960
v_mfma_f32_16x16x32_bf16 v[132:135], v[52:55], v[32:35], v[132:135]
ds_read_b64_tr_b16 v[98:99], v5 offset:43008
v_mfma_f32_16x16x32_bf16 v[136:139], v[56:59], v[32:35], v[136:139]
ds_read_b64_tr_b16 v[100:101], v6 offset:40960
v_mfma_f32_16x16x32_bf16 v[140:143], v[60:63], v[32:35], v[140:143]
ds_read_b64_tr_b16 v[102:103], v6 offset:43008
v_mfma_f32_16x16x32_bf16 v[144:147], v[48:51], v[36:39], v[144:147]
ds_read_b128 v[84:87], v2 offset:16640
ds_read_b64_tr_b16 v[104:105], v7 offset:40960
v_mfma_f32_16x16x32_bf16 v[148:151], v[52:55], v[36:39], v[148:151]
ds_read_b64_tr_b16 v[106:107], v7 offset:43008
v_mfma_f32_16x16x32_bf16 v[152:155], v[56:59], v[36:39], v[152:155]
ds_read_b64_tr_b16 v[108:109], v8 offset:40960
v_mfma_f32_16x16x32_bf16 v[156:159], v[60:63], v[36:39], v[156:159]
ds_read_b64_tr_b16 v[110:111], v8 offset:43008
v_mfma_f32_16x16x32_bf16 v[128:131], v[64:67], v[40:43], v[128:131]
ds_read_b128 v[88:91], v2 offset:24576
ds_read_b64_tr_b16 v[112:113], v5 offset:45056
v_mfma_f32_16x16x32_bf16 v[132:135], v[68:71], v[40:43], v[132:135]
ds_read_b64_tr_b16 v[114:115], v5 offset:47104
v_mfma_f32_16x16x32_bf16 v[136:139], v[72:75], v[40:43], v[136:139]
ds_read_b64_tr_b16 v[116:117], v6 offset:45056
v_mfma_f32_16x16x32_bf16 v[140:143], v[76:79], v[40:43], v[140:143]
ds_read_b64_tr_b16 v[118:119], v6 offset:47104
v_mfma_f32_16x16x32_bf16 v[144:147], v[64:67], v[44:47], v[144:147]
ds_read_b128 v[92:95], v2 offset:24832
ds_read_b64_tr_b16 v[120:121], v7 offset:45056
v_mfma_f32_16x16x32_bf16 v[148:151], v[68:71], v[44:47], v[148:151]
ds_read_b64_tr_b16 v[122:123], v7 offset:47104
v_mfma_f32_16x16x32_bf16 v[152:155], v[72:75], v[44:47], v[152:155]
ds_read_b64_tr_b16 v[124:125], v8 offset:45056
v_mfma_f32_16x16x32_bf16 v[156:159], v[76:79], v[44:47], v[156:159]
ds_read_b64_tr_b16 v[126:127], v8 offset:47104
s_waitcnt lgkmcnt(0)
v_max3_u32 v19, v80, v81, v82
v_max3_u32 v19, v19, v83, v84
v_max3_u32 v19, v19, v85, v86
v_max3_u32 v19, v19, v87, v88
v_max3_u32 v19, v19, v89, v90
v_max3_u32 v19, v19, v91, v92
v_max3_u32 v19, v19, v93, v94
v_max_u32 v19, v19, v95
v_cmp_eq_u32 vcc, -1, v19
s_nop 4
s_cbranch_vccnz Lfx_65
Lok_63:
s_barrier
v_mfma_f32_16x16x32_bf16 v[128:131], v[96:99], v[80:83], v[128:131]
ds_read_b128 v[32:35], v2 offset:32768
ds_read_b64_tr_b16 v[48:49], v5 offset:49152
v_mfma_f32_16x16x32_bf16 v[132:135], v[100:103], v[80:83], v[132:135]
ds_read_b64_tr_b16 v[50:51], v5 offset:51200
v_mfma_f32_16x16x32_bf16 v[136:139], v[104:107], v[80:83], v[136:139]
ds_read_b64_tr_b16 v[52:53], v6 offset:49152
v_mfma_f32_16x16x32_bf16 v[140:143], v[108:111], v[80:83], v[140:143]
ds_read_b64_tr_b16 v[54:55], v6 offset:51200
v_mfma_f32_16x16x32_bf16 v[144:147], v[96:99], v[84:87], v[144:147]
ds_read_b128 v[36:39], v2 offset:33024
ds_read_b64_tr_b16 v[56:57], v7 offset:49152
v_mfma_f32_16x16x32_bf16 v[148:151], v[100:103], v[84:87], v[148:151]
ds_read_b64_tr_b16 v[58:59], v7 offset:51200
v_mfma_f32_16x16x32_bf16 v[152:155], v[104:107], v[84:87], v[152:155]
ds_read_b64_tr_b16 v[60:61], v8 offset:49152
v_mfma_f32_16x16x32_bf16 v[156:159], v[108:111], v[84:87], v[156:159]
ds_read_b64_tr_b16 v[62:63], v8 offset:51200
v_mfma_f32_16x16x32_bf16 v[128:131], v[112:115], v[88:91], v[128:131]
ds_read_b128 v[40:43], v2 offset:40960
ds_read_b64_tr_b16 v[64:65], v5 offset:53248
v_mfma_f32_16x16x32_bf16 v[132:135], v[116:119], v[88:91], v[132:135]
ds_read_b64_tr_b16 v[66:67], v5 offset:55296
v_mfma_f32_16x16x32_bf16 v[136:139], v[120:123], v[88:91], v[136:139]
ds_read_b64_tr_b16 v[68:69], v6 offset:53248
v_mfma_f32_16x16x32_bf16 v[140:143], v[124:127], v[88:91], v[140:143]
ds_read_b64_tr_b16 v[70:71], v6 offset:55296
v_mfma_f32_16x16x32_bf16 v[144:147], v[112:115], v[92:95], v[144:147]
ds_read_b128 v[44:47], v2 offset:41216
ds_read_b64_tr_b16 v[72:73], v7 offset:53248
v_mfma_f32_16x16x32_bf16 v[148:151], v[116:119], v[92:95], v[148:151]
ds_read_b64_tr_b16 v[74:75], v7 offset:55296
v_mfma_f32_16x16x32_bf16 v[152:155], v[120:123], v[92:95], v[152:155]
ds_read_b64_tr_b16 v[76:77], v8 offset:53248
v_mfma_f32_16x16x32_bf16 v[156:159], v[124:127], v[92:95], v[156:159]
ds_read_b64_tr_b16 v[78:79], v8 offset:55296
s_waitcnt lgkmcnt(0)
v_max3_u32 v19, v32, v33, v34
v_max3_u32 v19, v19, v35, v36
v_max3_u32 v19, v19, v37, v38
v_max3_u32 v19, v19, v39, v40
v_max3_u32 v19, v19, v41, v42
v_max3_u32 v19, v19, v43, v44
v_max3_u32 v19, v19, v45, v46
v_max_u32 v19, v19, v47
v_cmp_eq_u32 vcc, -1, v19
s_nop 4
s_cbranch_vccnz Lfx_68
Lok_66:
s_barrier
v_mfma_f32_16x16x32_bf16 v[128:131], v[48:51], v[32:35], v[128:131]
ds_read_b128 v[80:83], v2 offset:49152
ds_read_b64_tr_b16 v[96:97], v5 offset:57344
v_mfma_f32_16x16x32_bf16 v[132:135], v[52:55], v[32:35], v[132:135]
ds_read_b64_tr_b16 v[98:99], v5 offset:59392
v_mfma_f32_16x16x32_bf16 v[136:139], v[56:59], v[32:35], v[136:139]
ds_read_b64_tr_b16 v[100:101], v6 offset:57344
v_mfma_f32_16x16x32_bf16 v[140:143], v[60:63], v[32:35], v[140:143]
ds_read_b64_tr_b16 v[102:103], v6 offset:59392
v_mfma_f32_16x16x32_bf16 v[144:147], v[48:51], v[36:39], v[144:147]
ds_read_b128 v[84:87], v2 offset:49408
ds_read_b64_tr_b16 v[104:105], v7 offset:57344
v_mfma_f32_16x16x32_bf16 v[148:151], v[52:55], v[36:39], v[148:151]
ds_read_b64_tr_b16 v[106:107], v7 offset:59392
v_mfma_f32_16x16x32_bf16 v[152:155], v[56:59], v[36:39], v[152:155]
ds_read_b64_tr_b16 v[108:109], v8 offset:57344
v_mfma_f32_16x16x32_bf16 v[156:159], v[60:63], v[36:39], v[156:159]
ds_read_b64_tr_b16 v[110:111], v8 offset:59392
v_mfma_f32_16x16x32_bf16 v[128:131], v[64:67], v[40:43], v[128:131]
ds_read_b128 v[88:91], v2 offset:57344
ds_read_b64_tr_b16 v[112:113], v5 offset:61440
v_mfma_f32_16x16x32_bf16 v[132:135], v[68:71], v[40:43], v[132:135]
ds_read_b64_tr_b16 v[114:115], v5 offset:63488
v_mfma_f32_16x16x32_bf16 v[136:139], v[72:75], v[40:43], v[136:139]
ds_read_b64_tr_b16 v[116:117], v6 offset:61440
v_mfma_f32_16x16x32_bf16 v[140:143], v[76:79], v[40:43], v[140:143]
ds_read_b64_tr_b16 v[118:119], v6 offset:63488
v_mfma_f32_16x16x32_bf16 v[144:147], v[64:67], v[44:47], v[144:147]
ds_read_b128 v[92:95], v2 offset:57600
ds_read_b64_tr_b16 v[120:121], v7 offset:61440
v_mfma_f32_16x16x32_bf16 v[148:151], v[68:71], v[44:47], v[148:151]
ds_read_b64_tr_b16 v[122:123], v7 offset:63488
v_mfma_f32_16x16x32_bf16 v[152:155], v[72:75], v[44:47], v[152:155]
ds_read_b64_tr_b16 v[124:125], v8 offset:61440
v_mfma_f32_16x16x32_bf16 v[156:159], v[76:79], v[44:47], v[156:159]
ds_read_b64_tr_b16 v[126:127], v8 offset:63488
s_waitcnt lgkmcnt(0)
v_max3_u32 v19, v80, v81, v82
v_max3_u32 v19, v19, v83, v84
v_max3_u32 v19, v19, v85, v86
v_max3_u32 v19, v19, v87, v88
v_max3_u32 v19, v19, v89, v90
v_max3_u32 v19, v19, v91, v92
v_max3_u32 v19, v19, v93, v94
v_max_u32 v19, v19, v95
v_cmp_eq_u32 vcc, -1, v19
s_nop 4
s_cbranch_vccnz Lfx_71
Lok_69:
s_barrier
v_mfma_f32_16x16x32_bf16 v[128:131], v[96:99], v[80:83], v[128:131]
ds_read_b128 v[32:35], v2 offset:0
ds_read_b64_tr_b16 v[48:49], v9 offset:0
v_mfma_f32_16x16x32_bf16 v[132:135], v[100:103], v[80:83], v[132:135]
ds_read_b64_tr_b16 v[50:51], v9 offset:2048
v_mfma_f32_16x16x32_bf16 v[136:139], v[104:107], v[80:83], v[136:139]
ds_read_b64_tr_b16 v[52:53], v10 offset:0
v_mfma_f32_16x16x32_bf16 v[140:143], v[108:111], v[80:83], v[140:143]
ds_read_b64_tr_b16 v[54:55], v10 offset:2048
v_mfma_f32_16x16x32_bf16 v[144:147], v[96:99], v[84:87], v[144:147]
ds_read_b128 v[36:39], v2 offset:256
ds_read_b64_tr_b16 v[56:57], v11 offset:0
v_mfma_f32_16x16x32_bf16 v[148:151], v[100:103], v[84:87], v[148:151]
ds_read_b64_tr_b16 v[58:59], v11 offset:2048
v_mfma_f32_16x16x32_bf16 v[152:155], v[104:107], v[84:87], v[152:155]
ds_read_b64_tr_b16 v[60:61], v12 offset:0
v_mfma_f32_16x16x32_bf16 v[156:159], v[108:111], v[84:87], v[156:159]
ds_read_b64_tr_b16 v[62:63], v12 offset:2048
v_mfma_f32_16x16x32_bf16 v[128:131], v[112:115], v[88:91], v[128:131]
ds_read_b128 v[40:43], v2 offset:8192
ds_read_b64_tr_b16 v[64:65], v9 offset:4096
v_mfma_f32_16x16x32_bf16 v[132:135], v[116:119], v[88:91], v[132:135]
ds_read_b64_tr_b16 v[66:67], v9 offset:6144
v_mfma_f32_16x16x32_bf16 v[136:139], v[120:123], v[88:91], v[136:139]
ds_read_b64_tr_b16 v[68:69], v10 offset:4096
v_mfma_f32_16x16x32_bf16 v[140:143], v[124:127], v[88:91], v[140:143]
ds_read_b64_tr_b16 v[70:71], v10 offset:6144
v_mfma_f32_16x16x32_bf16 v[144:147], v[112:115], v[92:95], v[144:147]
ds_read_b128 v[44:47], v2 offset:8448
ds_read_b64_tr_b16 v[72:73], v11 offset:4096
v_mfma_f32_16x16x32_bf16 v[148:151], v[116:119], v[92:95], v[148:151]
ds_read_b64_tr_b16 v[74:75], v11 offset:6144
v_mfma_f32_16x16x32_bf16 v[152:155], v[120:123], v[92:95], v[152:155]
ds_read_b64_tr_b16 v[76:77], v12 offset:4096
v_mfma_f32_16x16x32_bf16 v[156:159], v[124:127], v[92:95], v[156:159]
ds_read_b64_tr_b16 v[78:79], v12 offset:6144
s_waitcnt lgkmcnt(0)
v_max3_u32 v19, v32, v33, v34
v_max3_u32 v19, v19, v35, v36
v_max3_u32 v19, v19, v37, v38
v_max3_u32 v19, v19, v39, v40
v_max3_u32 v19, v19, v41, v42
v_max3_u32 v19, v19, v43, v44
v_max3_u32 v19, v19, v45, v46
v_max_u32 v19, v19, v47
v_cmp_eq_u32 vcc, -1, v19
s_nop 4
s_cbranch_vccnz Lfx_74
Lok_72:
s_barrier
v_mfma_f32_16x16x32_bf16 v[128:131], v[48:51], v[32:35], v[128:131]
ds_read_b128 v[80:83], v2 offset:16384
ds_read_b64_tr_b16 v[96:97], v9 offset:8192
v_mfma_f32_16x16x32_bf16 v[132:135], v[52:55], v[32:35], v[132:135]
ds_read_b64_tr_b16 v[98:99], v9 offset:10240
v_mfma_f32_16x16x32_bf16 v[136:139], v[56:59], v[32:35], v[136:139]
ds_read_b64_tr_b16 v[100:101], v10 offset:8192
v_mfma_f32_16x16x32_bf16 v[140:143], v[60:63], v[32:35], v[140:143]
ds_read_b64_tr_b16 v[102:103], v10 offset:10240
v_mfma_f32_16x16x32_bf16 v[144:147], v[48:51], v[36:39], v[144:147]
ds_read_b128 v[84:87], v2 offset:16640
ds_read_b64_tr_b16 v[104:105], v11 offset:8192
v_mfma_f32_16x16x32_bf16 v[148:151], v[52:55], v[36:39], v[148:151]
ds_read_b64_tr_b16 v[106:107], v11 offset:10240
v_mfma_f32_16x16x32_bf16 v[152:155], v[56:59], v[36:39], v[152:155]
ds_read_b64_tr_b16 v[108:109], v12 offset:8192
v_mfma_f32_16x16x32_bf16 v[156:159], v[60:63], v[36:39], v[156:159]
ds_read_b64_tr_b16 v[110:111], v12 offset:10240
v_mfma_f32_16x16x32_bf16 v[128:131], v[64:67], v[40:43], v[128:131]
ds_read_b128 v[88:91], v2 offset:24576
ds_read_b64_tr_b16 v[112:113], v9 offset:12288
v_mfma_f32_16x16x32_bf16 v[132:135], v[68:71], v[40:43], v[132:135]
ds_read_b64_tr_b16 v[114:115], v9 offset:14336
v_mfma_f32_16x16x32_bf16 v[136:139], v[72:75], v[40:43], v[136:139]
ds_read_b64_tr_b16 v[116:117], v10 offset:12288
v_mfma_f32_16x16x32_bf16 v[140:143], v[76:79], v[40:43], v[140:143]
ds_read_b64_tr_b16 v[118:119], v10 offset:14336
v_mfma_f32_16x16x32_bf16 v[144:147], v[64:67], v[44:47], v[144:147]
ds_read_b128 v[92:95], v2 offset:24832
ds_read_b64_tr_b16 v[120:121], v11 offset:12288
v_mfma_f32_16x16x32_bf16 v[148:151], v[68:71], v[44:47], v[148:151]
ds_read_b64_tr_b16 v[122:123], v11 offset:14336
v_mfma_f32_16x16x32_bf16 v[152:155], v[72:75], v[44:47], v[152:155]
ds_read_b64_tr_b16 v[124:125], v12 offset:12288
v_mfma_f32_16x16x32_bf16 v[156:159], v[76:79], v[44:47], v[156:159]
ds_read_b64_tr_b16 v[126:127], v12 offset:14336
s_waitcnt lgkmcnt(0)
v_max3_u32 v19, v80, v81, v82
v_max3_u32 v19, v19, v83, v84
v_max3_u32 v19, v19, v85, v86
v_max3_u32 v19, v19, v87, v88
v_max3_u32 v19, v19, v89, v90
v_max3_u32 v19, v19, v91, v92
v_max3_u32 v19, v19, v93, v94
v_max_u32 v19, v19, v95
v_cmp_eq_u32 vcc, -1, v19
s_nop 4
s_cbranch_vccnz Lfx_77
Lok_75:
s_barrier
v_mfma_f32_16x16x32_bf16 v[128:131], v[96:99], v[80:83], v[128:131]
ds_read_b128 v[32:35], v2 offset:32768
ds_read_b64_tr_b16 v[48:49], v5 offset:0
v_mfma_f32_16x16x32_bf16 v[132:135], v[100:103], v[80:83], v[132:135]
ds_read_b64_tr_b16 v[50:51], v5 offset:2048
v_mfma_f32_16x16x32_bf16 v[136:139], v[104:107], v[80:83], v[136:139]
ds_read_b64_tr_b16 v[52:53], v6 offset:0
v_mfma_f32_16x16x32_bf16 v[140:143], v[108:111], v[80:83], v[140:143]
ds_read_b64_tr_b16 v[54:55], v6 offset:2048
v_mfma_f32_16x16x32_bf16 v[144:147], v[96:99], v[84:87], v[144:147]
ds_read_b128 v[36:39], v2 offset:33024
ds_read_b64_tr_b16 v[56:57], v7 offset:0
v_mfma_f32_16x16x32_bf16 v[148:151], v[100:103], v[84:87], v[148:151]
ds_read_b64_tr_b16 v[58:59], v7 offset:2048
v_mfma_f32_16x16x32_bf16 v[152:155], v[104:107], v[84:87], v[152:155]
ds_read_b64_tr_b16 v[60:61], v8 offset:0
v_mfma_f32_16x16x32_bf16 v[156:159], v[108:111], v[84:87], v[156:159]
ds_read_b64_tr_b16 v[62:63], v8 offset:2048
v_mfma_f32_16x16x32_bf16 v[128:131], v[112:115], v[88:91], v[128:131]
ds_read_b128 v[40:43], v2 offset:40960
ds_read_b64_tr_b16 v[64:65], v5 offset:4096
v_mfma_f32_16x16x32_bf16 v[132:135], v[116:119], v[88:91], v[132:135]
ds_read_b64_tr_b16 v[66:67], v5 offset:6144
v_mfma_f32_16x16x32_bf16 v[136:139], v[120:123], v[88:91], v[136:139]
ds_read_b64_tr_b16 v[68:69], v6 offset:4096
v_mfma_f32_16x16x32_bf16 v[140:143], v[124:127], v[88:91], v[140:143]
ds_read_b64_tr_b16 v[70:71], v6 offset:6144
v_mfma_f32_16x16x32_bf16 v[144:147], v[112:115], v[92:95], v[144:147]
ds_read_b128 v[44:47], v2 offset:41216
ds_read_b64_tr_b16 v[72:73], v7 offset:4096
v_mfma_f32_16x16x32_bf16 v[148:151], v[116:119], v[92:95], v[148:151]
ds_read_b64_tr_b16 v[74:75], v7 offset:6144
v_mfma_f32_16x16x32_bf16 v[152:155], v[120:123], v[92:95], v[152:155]
ds_read_b64_tr_b16 v[76:77], v8 offset:4096
v_mfma_f32_16x16x32_bf16 v[156:159], v[124:127], v[92:95], v[156:159]
ds_read_b64_tr_b16 v[78:79], v8 offset:6144
s_waitcnt lgkmcnt(0)
v_max3_u32 v19, v32, v33, v34
v_max3_u32 v19, v19, v35, v36
v_max3_u32 v19, v19, v37, v38
v_max3_u32 v19, v19, v39, v40
v_max3_u32 v19, v19, v41, v42
v_max3_u32 v19, v19, v43, v44
v_max3_u32 v19, v19, v45, v46
v_max_u32 v19, v19, v47
v_cmp_eq_u32 vcc, -1, v19
s_nop 4
s_cbranch_vccnz Lfx_80
Lok_78:
s_barrier
v_mfma_f32_16x16x32_bf16 v[128:131], v[48:51], v[32:35], v[128:131]
ds_read_b128 v[80:83], v2 offset:49152
ds_read_b64_tr_b16 v[96:97], v5 offset:8192
v_mfma_f32_16x16x32_bf16 v[132:135], v[52:55], v[32:35], v[132:135]
ds_read_b64_tr_b16 v[98:99], v5 offset:10240
v_mfma_f32_16x16x32_bf16 v[136:139], v[56:59], v[32:35], v[136:139]
ds_read_b64_tr_b16 v[100:101], v6 offset:8192
v_mfma_f32_16x16x32_bf16 v[140:143], v[60:63], v[32:35], v[140:143]
ds_read_b64_tr_b16 v[102:103], v6 offset:10240
v_mfma_f32_16x16x32_bf16 v[144:147], v[48:51], v[36:39], v[144:147]
ds_read_b128 v[84:87], v2 offset:49408
ds_read_b64_tr_b16 v[104:105], v7 offset:8192
v_mfma_f32_16x16x32_bf16 v[148:151], v[52:55], v[36:39], v[148:151]
ds_read_b64_tr_b16 v[106:107], v7 offset:10240
v_mfma_f32_16x16x32_bf16 v[152:155], v[56:59], v[36:39], v[152:155]
ds_read_b64_tr_b16 v[108:109], v8 offset:8192
v_mfma_f32_16x16x32_bf16 v[156:159], v[60:63], v[36:39], v[156:159]
ds_read_b64_tr_b16 v[110:111], v8 offset:10240
v_mfma_f32_16x16x32_bf16 v[128:131], v[64:67], v[40:43], v[128:131]
ds_read_b128 v[88:91], v2 offset:57344
ds_read_b64_tr_b16 v[112:113], v5 offset:12288
v_mfma_f32_16x16x32_bf16 v[132:135], v[68:71], v[40:43], v[132:135]
ds_read_b64_tr_b16 v[114:115], v5 offset:14336
v_mfma_f32_16x16x32_bf16 v[136:139], v[72:75], v[40:43], v[136:139]
ds_read_b64_tr_b16 v[116:117], v6 offset:12288
v_mfma_f32_16x16x32_bf16 v[140:143], v[76:79], v[40:43], v[140:143]
ds_read_b64_tr_b16 v[118:119], v6 offset:14336
v_mfma_f32_16x16x32_bf16 v[144:147], v[64:67], v[44:47], v[144:147]
ds_read_b128 v[92:95], v2 offset:57600
ds_read_b64_tr_b16 v[120:121], v7 offset:12288
v_mfma_f32_16x16x32_bf16 v[148:151], v[68:71], v[44:47], v[148:151]
ds_read_b64_tr_b16 v[122:123], v7 offset:14336
v_mfma_f32_16x16x32_bf16 v[152:155], v[72:75], v[44:47], v[152:155]
ds_read_b64_tr_b16 v[124:125], v8 offset:12288
v_mfma_f32_16x16x32_bf16 v[156:159], v[76:79], v[44:47], v[156:159]
ds_read_b64_tr_b16 v[126:127], v8 offset:14336
s_waitcnt lgkmcnt(0)
s_barrier
v_mfma_f32_16x16x32_bf16 v[128:131], v[96:99], v[80:83], v[128:131]
ds_read_b128 v[32:35], v2 offset:0
ds_read_b64_tr_b16 v[48:49], v5 offset:16384
v_mfma_f32_16x16x32_bf16 v[132:135], v[100:103], v[80:83], v[132:135]
ds_read_b64_tr_b16 v[50:51], v5 offset:18432
v_mfma_f32_16x16x32_bf16 v[136:139], v[104:107], v[80:83], v[136:139]
ds_read_b64_tr_b16 v[52:53], v6 offset:16384
v_mfma_f32_16x16x32_bf16 v[140:143], v[108:111], v[80:83], v[140:143]
ds_read_b64_tr_b16 v[54:55], v6 offset:18432
v_mfma_f32_16x16x32_bf16 v[144:147], v[96:99], v[84:87], v[144:147]
ds_read_b128 v[36:39], v2 offset:256
ds_read_b64_tr_b16 v[56:57], v7 offset:16384
v_mfma_f32_16x16x32_bf16 v[148:151], v[100:103], v[84:87], v[148:151]
ds_read_b64_tr_b16 v[58:59], v7 offset:18432
v_mfma_f32_16x16x32_bf16 v[152:155], v[104:107], v[84:87], v[152:155]
ds_read_b64_tr_b16 v[60:61], v8 offset:16384
v_mfma_f32_16x16x32_bf16 v[156:159], v[108:111], v[84:87], v[156:159]
ds_read_b64_tr_b16 v[62:63], v8 offset:18432
v_mfma_f32_16x16x32_bf16 v[128:131], v[112:115], v[88:91], v[128:131]
ds_read_b128 v[40:43], v2 offset:8192
ds_read_b64_tr_b16 v[64:65], v5 offset:20480
v_mfma_f32_16x16x32_bf16 v[132:135], v[116:119], v[88:91], v[132:135]
ds_read_b64_tr_b16 v[66:67], v5 offset:22528
v_mfma_f32_16x16x32_bf16 v[136:139], v[120:123], v[88:91], v[136:139]
ds_read_b64_tr_b16 v[68:69], v6 offset:20480
v_mfma_f32_16x16x32_bf16 v[140:143], v[124:127], v[88:91], v[140:143]
ds_read_b64_tr_b16 v[70:71], v6 offset:22528
v_mfma_f32_16x16x32_bf16 v[144:147], v[112:115], v[92:95], v[144:147]
ds_read_b128 v[44:47], v2 offset:8448
ds_read_b64_tr_b16 v[72:73], v7 offset:20480
v_mfma_f32_16x16x32_bf16 v[148:151], v[116:119], v[92:95], v[148:151]
ds_read_b64_tr_b16 v[74:75], v7 offset:22528
v_mfma_f32_16x16x32_bf16 v[152:155], v[120:123], v[92:95], v[152:155]
ds_read_b64_tr_b16 v[76:77], v8 offset:20480
v_mfma_f32_16x16x32_bf16 v[156:159], v[124:127], v[92:95], v[156:159]
ds_read_b64_tr_b16 v[78:79], v8 offset:22528
s_waitcnt lgkmcnt(0)
s_barrier
v_mfma_f32_16x16x32_bf16 v[128:131], v[48:51], v[32:35], v[128:131]
ds_read_b128 v[80:83], v2 offset:16384
ds_read_b64_tr_b16 v[96:97], v5 offset:24576
v_mfma_f32_16x16x32_bf16 v[132:135], v[52:55], v[32:35], v[132:135]
ds_read_b64_tr_b16 v[98:99], v5 offset:26624
v_mfma_f32_16x16x32_bf16 v[136:139], v[56:59], v[32:35], v[136:139]
ds_read_b64_tr_b16 v[100:101], v6 offset:24576
v_mfma_f32_16x16x32_bf16 v[140:143], v[60:63], v[32:35], v[140:143]
ds_read_b64_tr_b16 v[102:103], v6 offset:26624
v_mfma_f32_16x16x32_bf16 v[144:147], v[48:51], v[36:39], v[144:147]
ds_read_b128 v[84:87], v2 offset:16640
ds_read_b64_tr_b16 v[104:105], v7 offset:24576
v_mfma_f32_16x16x32_bf16 v[148:151], v[52:55], v[36:39], v[148:151]
ds_read_b64_tr_b16 v[106:107], v7 offset:26624
v_mfma_f32_16x16x32_bf16 v[152:155], v[56:59], v[36:39], v[152:155]
ds_read_b64_tr_b16 v[108:109], v8 offset:24576
v_mfma_f32_16x16x32_bf16 v[156:159], v[60:63], v[36:39], v[156:159]
ds_read_b64_tr_b16 v[110:111], v8 offset:26624
v_mfma_f32_16x16x32_bf16 v[128:131], v[64:67], v[40:43], v[128:131]
ds_read_b128 v[88:91], v2 offset:24576
ds_read_b64_tr_b16 v[112:113], v5 offset:28672
v_mfma_f32_16x16x32_bf16 v[132:135], v[68:71], v[40:43], v[132:135]
ds_read_b64_tr_b16 v[114:115], v5 offset:30720
v_mfma_f32_16x16x32_bf16 v[136:139], v[72:75], v[40:43], v[136:139]
ds_read_b64_tr_b16 v[116:117], v6 offset:28672
v_mfma_f32_16x16x32_bf16 v[140:143], v[76:79], v[40:43], v[140:143]
ds_read_b64_tr_b16 v[118:119], v6 offset:30720
v_mfma_f32_16x16x32_bf16 v[144:147], v[64:67], v[44:47], v[144:147]
ds_read_b128 v[92:95], v2 offset:24832
ds_read_b64_tr_b16 v[120:121], v7 offset:28672
v_mfma_f32_16x16x32_bf16 v[148:151], v[68:71], v[44:47], v[148:151]
ds_read_b64_tr_b16 v[122:123], v7 offset:30720
v_mfma_f32_16x16x32_bf16 v[152:155], v[72:75], v[44:47], v[152:155]
ds_read_b64_tr_b16 v[124:125], v8 offset:28672
v_mfma_f32_16x16x32_bf16 v[156:159], v[76:79], v[44:47], v[156:159]
ds_read_b64_tr_b16 v[126:127], v8 offset:30720
s_waitcnt lgkmcnt(0)
s_barrier
v_mfma_f32_16x16x32_bf16 v[128:131], v[96:99], v[80:83], v[128:131]
ds_read_b128 v[32:35], v2 offset:32768
ds_read_b64_tr_b16 v[48:49], v5 offset:32768
v_mfma_f32_16x16x32_bf16 v[132:135], v[100:103], v[80:83], v[132:135]
ds_read_b64_tr_b16 v[50:51], v5 offset:34816
v_mfma_f32_16x16x32_bf16 v[136:139], v[104:107], v[80:83], v[136:139]
ds_read_b64_tr_b16 v[52:53], v6 offset:32768
v_mfma_f32_16x16x32_bf16 v[140:143], v[108:111], v[80:83], v[140:143]
ds_read_b64_tr_b16 v[54:55], v6 offset:34816
v_mfma_f32_16x16x32_bf16 v[144:147], v[96:99], v[84:87], v[144:147]
ds_read_b128 v[36:39], v2 offset:33024
ds_read_b64_tr_b16 v[56:57], v7 offset:32768
v_mfma_f32_16x16x32_bf16 v[148:151], v[100:103], v[84:87], v[148:151]
ds_read_b64_tr_b16 v[58:59], v7 offset:34816
v_mfma_f32_16x16x32_bf16 v[152:155], v[104:107], v[84:87], v[152:155]
ds_read_b64_tr_b16 v[60:61], v8 offset:32768
v_mfma_f32_16x16x32_bf16 v[156:159], v[108:111], v[84:87], v[156:159]
ds_read_b64_tr_b16 v[62:63], v8 offset:34816
v_mfma_f32_16x16x32_bf16 v[128:131], v[112:115], v[88:91], v[128:131]
ds_read_b128 v[40:43], v2 offset:40960
ds_read_b64_tr_b16 v[64:65], v5 offset:36864
v_mfma_f32_16x16x32_bf16 v[132:135], v[116:119], v[88:91], v[132:135]
ds_read_b64_tr_b16 v[66:67], v5 offset:38912
v_mfma_f32_16x16x32_bf16 v[136:139], v[120:123], v[88:91], v[136:139]
ds_read_b64_tr_b16 v[68:69], v6 offset:36864
v_mfma_f32_16x16x32_bf16 v[140:143], v[124:127], v[88:91], v[140:143]
ds_read_b64_tr_b16 v[70:71], v6 offset:38912
v_mfma_f32_16x16x32_bf16 v[144:147], v[112:115], v[92:95], v[144:147]
ds_read_b128 v[44:47], v2 offset:41216
ds_read_b64_tr_b16 v[72:73], v7 offset:36864
v_mfma_f32_16x16x32_bf16 v[148:151], v[116:119], v[92:95], v[148:151]
ds_read_b64_tr_b16 v[74:75], v7 offset:38912
v_mfma_f32_16x16x32_bf16 v[152:155], v[120:123], v[92:95], v[152:155]
ds_read_b64_tr_b16 v[76:77], v8 offset:36864
v_mfma_f32_16x16x32_bf16 v[156:159], v[124:127], v[92:95], v[156:159]
ds_read_b64_tr_b16 v[78:79], v8 offset:38912
s_waitcnt lgkmcnt(0)
s_barrier
v_mfma_f32_16x16x32_bf16 v[128:131], v[48:51], v[32:35], v[128:131]
ds_read_b128 v[80:83], v2 offset:49152
ds_read_b64_tr_b16 v[96:97], v5 offset:40960
v_mfma_f32_16x16x32_bf16 v[132:135], v[52:55], v[32:35], v[132:135]
ds_read_b64_tr_b16 v[98:99], v5 offset:43008
v_mfma_f32_16x16x32_bf16 v[136:139], v[56:59], v[32:35], v[136:139]
ds_read_b64_tr_b16 v[100:101], v6 offset:40960
v_mfma_f32_16x16x32_bf16 v[140:143], v[60:63], v[32:35], v[140:143]
ds_read_b64_tr_b16 v[102:103], v6 offset:43008
v_mfma_f32_16x16x32_bf16 v[144:147], v[48:51], v[36:39], v[144:147]
ds_read_b128 v[84:87], v2 offset:49408
ds_read_b64_tr_b16 v[104:105], v7 offset:40960
v_mfma_f32_16x16x32_bf16 v[148:151], v[52:55], v[36:39], v[148:151]
ds_read_b64_tr_b16 v[106:107], v7 offset:43008
v_mfma_f32_16x16x32_bf16 v[152:155], v[56:59], v[36:39], v[152:155]
ds_read_b64_tr_b16 v[108:109], v8 offset:40960
v_mfma_f32_16x16x32_bf16 v[156:159], v[60:63], v[36:39], v[156:159]
ds_read_b64_tr_b16 v[110:111], v8 offset:43008
v_mfma_f32_16x16x32_bf16 v[128:131], v[64:67], v[40:43], v[128:131]
ds_read_b128 v[88:91], v2 offset:57344
ds_read_b64_tr_b16 v[112:113], v5 offset:45056
v_mfma_f32_16x16x32_bf16 v[132:135], v[68:71], v[40:43], v[132:135]
ds_read_b64_tr_b16 v[114:115], v5 offset:47104
v_mfma_f32_16x16x32_bf16 v[136:139], v[72:75], v[40:43], v[136:139]
ds_read_b64_tr_b16 v[116:117], v6 offset:45056
v_mfma_f32_16x16x32_bf16 v[140:143], v[76:79], v[40:43], v[140:143]
ds_read_b64_tr_b16 v[118:119], v6 offset:47104
v_mfma_f32_16x16x32_bf16 v[144:147], v[64:67], v[44:47], v[144:147]
ds_read_b128 v[92:95], v2 offset:57600
ds_read_b64_tr_b16 v[120:121], v7 offset:45056
v_mfma_f32_16x16x32_bf16 v[148:151], v[68:71], v[44:47], v[148:151]
ds_read_b64_tr_b16 v[122:123], v7 offset:47104
v_mfma_f32_16x16x32_bf16 v[152:155], v[72:75], v[44:47], v[152:155]
ds_read_b64_tr_b16 v[124:125], v8 offset:45056
v_mfma_f32_16x16x32_bf16 v[156:159], v[76:79], v[44:47], v[156:159]
ds_read_b64_tr_b16 v[126:127], v8 offset:47104
s_waitcnt lgkmcnt(0)
s_barrier
v_mfma_f32_16x16x32_bf16 v[128:131], v[96:99], v[80:83], v[128:131]
v_mfma_f32_16x16x32_bf16 v[132:135], v[100:103], v[80:83], v[132:135]
v_mfma_f32_16x16x32_bf16 v[136:139], v[104:107], v[80:83], v[136:139]
v_mfma_f32_16x16x32_bf16 v[140:143], v[108:111], v[80:83], v[140:143]
v_mfma_f32_16x16x32_bf16 v[144:147], v[96:99], v[84:87], v[144:147]
v_mfma_f32_16x16x32_bf16 v[148:151], v[100:103], v[84:87], v[148:151]
v_mfma_f32_16x16x32_bf16 v[152:155], v[104:107], v[84:87], v[152:155]
v_mfma_f32_16x16x32_bf16 v[156:159], v[108:111], v[84:87], v[156:159]
v_mfma_f32_16x16x32_bf16 v[128:131], v[112:115], v[88:91], v[128:131]
v_mfma_f32_16x16x32_bf16 v[132:135], v[116:119], v[88:91], v[132:135]
v_mfma_f32_16x16x32_bf16 v[136:139], v[120:123], v[88:91], v[136:139]
v_mfma_f32_16x16x32_bf16 v[140:143], v[124:127], v[88:91], v[140:143]
v_mfma_f32_16x16x32_bf16 v[144:147], v[112:115], v[92:95], v[144:147]
v_mfma_f32_16x16x32_bf16 v[148:151], v[116:119], v[92:95], v[148:151]
v_mfma_f32_16x16x32_bf16 v[152:155], v[120:123], v[92:95], v[152:155]
v_mfma_f32_16x16x32_bf16 v[156:159], v[124:127], v[92:95], v[156:159]
s_nop 4
v_cvt_pk_bf16_f32 v96, v128, v129
v_cvt_pk_bf16_f32 v97, v130, v131
v_cvt_pk_bf16_f32 v98, v132, v133
v_cvt_pk_bf16_f32 v99, v134, v135
buffer_store_dwordx4 v[96:99], v2, s[20:23], 0 offen offset:0 sc1
ds_write_b128 v4, v[96:99] offset:0
v_cvt_pk_bf16_f32 v100, v136, v137
v_cvt_pk_bf16_f32 v101, v138, v139
v_cvt_pk_bf16_f32 v102, v140, v141
v_cvt_pk_bf16_f32 v103, v142, v143
buffer_store_dwordx4 v[100:103], v2, s[20:23], s50 offen offset:0 sc1
ds_write_b128 v4, v[100:103] offset:8192
v_cvt_pk_bf16_f32 v104, v144, v145
v_cvt_pk_bf16_f32 v105, v146, v147
v_cvt_pk_bf16_f32 v106, v148, v149
v_cvt_pk_bf16_f32 v107, v150, v151
buffer_store_dwordx4 v[104:107], v2, s[20:23], 0 offen offset:256 sc1
ds_write_b128 v4, v[104:107] offset:256
v_cvt_pk_bf16_f32 v108, v152, v153
v_cvt_pk_bf16_f32 v109, v154, v155
v_cvt_pk_bf16_f32 v110, v156, v157
v_cvt_pk_bf16_f32 v111, v158, v159
buffer_store_dwordx4 v[108:111], v2, s[20:23], s50 offen offset:256 sc1
ds_write_b128 v4, v[108:111] offset:8448
v_pk_mul_f32 v[118:119], v[128:129], v[128:129]
v_pk_mul_f32 v[122:123], v[144:145], v[144:145]
v_pk_fma_f32 v[118:119], v[130:131], v[130:131], v[118:119]
v_pk_add_f32 v[116:117], v[130:131], v[128:129]
v_pk_fma_f32 v[122:123], v[146:147], v[146:147], v[122:123]
v_pk_add_f32 v[120:121], v[146:147], v[144:145]
v_pk_fma_f32 v[118:119], v[132:133], v[132:133], v[118:119]
v_pk_add_f32 v[116:117], v[132:133], v[116:117]
v_pk_fma_f32 v[122:123], v[148:149], v[148:149], v[122:123]
v_pk_add_f32 v[120:121], v[148:149], v[120:121]
v_pk_fma_f32 v[118:119], v[134:135], v[134:135], v[118:119]
v_pk_add_f32 v[116:117], v[134:135], v[116:117]
v_pk_fma_f32 v[122:123], v[150:151], v[150:151], v[122:123]
v_pk_add_f32 v[120:121], v[150:151], v[120:121]
v_pk_fma_f32 v[118:119], v[136:137], v[136:137], v[118:119]
v_pk_add_f32 v[116:117], v[136:137], v[116:117]
v_pk_fma_f32 v[122:123], v[152:153], v[152:153], v[122:123]
v_pk_add_f32 v[120:121], v[152:153], v[120:121]
v_pk_fma_f32 v[118:119], v[138:139], v[138:139], v[118:119]
v_pk_add_f32 v[116:117], v[138:139], v[116:117]
v_pk_fma_f32 v[122:123], v[154:155], v[154:155], v[122:123]
v_pk_add_f32 v[120:121], v[154:155], v[120:121]
v_pk_fma_f32 v[118:119], v[140:141], v[140:141], v[118:119]
v_pk_add_f32 v[116:117], v[140:141], v[116:117]
v_pk_fma_f32 v[122:123], v[156:157], v[156:157], v[122:123]
v_pk_add_f32 v[120:121], v[156:157], v[120:121]
v_pk_fma_f32 v[118:119], v[142:143], v[142:143], v[118:119]
v_pk_add_f32 v[116:117], v[142:143], v[116:117]
v_pk_fma_f32 v[122:123], v[158:159], v[158:159], v[122:123]
v_pk_add_f32 v[120:121], v[158:159], v[120:121]
v_add_f32 v112, v116, v117
v_add_f32 v113, v118, v119
v_add_f32 v114, v120, v121
v_add_f32 v115, v122, v123
s_nop 1
v_permlane32_swap_b32 v112, v114
v_permlane32_swap_b32 v113, v115
v_add_f32 v112, v112, v114
v_add_f32 v113, v113, v115
s_nop 1
v_permlane16_swap_b32 v112, v113
v_add_f32 v112, v112, v113
buffer_store_dword v112, v22, s[24:27], 0 offen sc1
s_waitcnt lgkmcnt(0)
s_barrier
s_lshl_b32 s53, s47, 2
v_lshlrev_b32 v19, 11, v18
v_lshl_add_u32 v19, v17, 4, v19
s_lshl_b32 s43, s46, 10
v_add_u32 v2, s43, v19
v_add_u32 v3, 49152, v2
v_add_u32 v4, 98304, v2
v_lshrrev_b32 v19, 2, v17
v_lshl_add_u32 v20, v18, 2, v19
v_and_b32 v21, 7, v20
v_lshlrev_b32 v20, 8, v20
v_and_b32 v19, 3, v1
v_lshl_add_u32 v20, v19, 3, v20
s_add_u32 s43, s53, 0
v_xor_b32 v19, s43, v21
v_lshl_add_u32 v5, v19, 5, v20
s_add_u32 s43, s53, 1
v_xor_b32 v19, s43, v21
v_lshl_add_u32 v6, v19, 5, v20
s_add_u32 s43, s53, 2
v_xor_b32 v19, s43, v21
v_lshl_add_u32 v7, v19, 5, v20
s_add_u32 s43, s53, 3
v_xor_b32 v19, s43, v21
v_lshl_add_u32 v8, v19, 5, v20
v_add_u32 v9, 49152, v5
v_add_u32 v10, 49152, v6
v_add_u32 v11, 49152, v7
v_add_u32 v12, 49152, v8
v_add_u32 v13, 98304, v5
v_add_u32 v14, 98304, v6
v_add_u32 v15, 98304, v7
v_add_u32 v16, 98304, v8
ds_read_b128 v[32:35], v4 offset:0
ds_read_b64_tr_b16 v[48:49], v13 offset:16384
ds_read_b64_tr_b16 v[50:51], v13 offset:20480
ds_read_b128 v[36:39], v4 offset:256
ds_read_b128 v[40:43], v4 offset:512
ds_read_b128 v[44:47], v4 offset:768
ds_read_b64_tr_b16 v[64:65], v13 offset:32768
ds_read_b64_tr_b16 v[66:67], v13 offset:36864
ds_read_b64_tr_b16 v[52:53], v14 offset:16384
ds_read_b64_tr_b16 v[54:55], v14 offset:20480
ds_read_b64_tr_b16 v[68:69], v14 offset:32768
ds_read_b64_tr_b16 v[70:71], v14 offset:36864
ds_read_b64_tr_b16 v[56:57], v15 offset:16384
ds_read_b64_tr_b16 v[58:59], v15 offset:20480
ds_read_b64_tr_b16 v[72:73], v15 offset:32768
ds_read_b64_tr_b16 v[74:75], v15 offset:36864
ds_read_b64_tr_b16 v[60:61], v16 offset:16384
ds_read_b64_tr_b16 v[62:63], v16 offset:20480
ds_read_b64_tr_b16 v[76:77], v16 offset:32768
ds_read_b64_tr_b16 v[78:79], v16 offset:36864
s_waitcnt lgkmcnt(0)
v_mfma_f32_16x16x32_bf16 v[128:131], v[48:51], v[32:35], 0
ds_read_b128 v[80:83], v4 offset:8192
v_mfma_f32_16x16x32_bf16 v[132:135], v[48:51], v[36:39], 0
ds_read_b64_tr_b16 v[96:97], v13 offset:24576
v_mfma_f32_16x16x32_bf16 v[136:139], v[48:51], v[40:43], 0
ds_read_b64_tr_b16 v[98:99], v13 offset:28672
v_mfma_f32_16x16x32_bf16 v[140:143], v[48:51], v[44:47], 0
ds_read_b128 v[84:87], v4 offset:8448
v_mfma_f32_16x16x32_bf16 v[204:207], v[64:67], v[44:47], 0
ds_read_b128 v[88:91], v4 offset:8704
v_mfma_f32_16x16x32_bf16 v[200:203], v[64:67], v[40:43], 0
ds_read_b128 v[92:95], v4 offset:8960
v_mfma_f32_16x16x32_bf16 v[196:199], v[64:67], v[36:39], 0
ds_read_b64_tr_b16 v[112:113], v13 offset:40960
v_mfma_f32_16x16x32_bf16 v[192:195], v[64:67], v[32:35], 0
ds_read_b64_tr_b16 v[114:115], v13 offset:45056
v_mfma_f32_16x16x32_bf16 v[144:147], v[52:55], v[32:35], 0
ds_read_b64_tr_b16 v[100:101], v14 offset:24576
v_mfma_f32_16x16x32_bf16 v[148:151], v[52:55], v[36:39], 0
ds_read_b64_tr_b16 v[102:103], v14 offset:28672
v_mfma_f32_16x16x32_bf16 v[152:155], v[52:55], v[40:43], 0
ds_read_b64_tr_b16 v[116:117], v14 offset:40960
v_mfma_f32_16x16x32_bf16 v[156:159], v[52:55], v[44:47], 0
ds_read_b64_tr_b16 v[118:119], v14 offset:45056
v_mfma_f32_16x16x32_bf16 v[220:223], v[68:71], v[44:47], 0
ds_read_b64_tr_b16 v[104:105], v15 offset:24576
v_mfma_f32_16x16x32_bf16 v[216:219], v[68:71], v[40:43], 0
ds_read_b64_tr_b16 v[106:107], v15 offset:28672
v_mfma_f32_16x16x32_bf16 v[212:215], v[68:71], v[36:39], 0
ds_read_b64_tr_b16 v[120:121], v15 offset:40960
v_mfma_f32_16x16x32_bf16 v[208:211], v[68:71], v[32:35], 0
ds_read_b64_tr_b16 v[122:123], v15 offset:45056
v_mfma_f32_16x16x32_bf16 v[160:163], v[56:59], v[32:35], 0
ds_read_b64_tr_b16 v[108:109], v16 offset:24576
v_mfma_f32_16x16x32_bf16 v[164:167], v[56:59], v[36:39], 0
ds_read_b64_tr_b16 v[110:111], v16 offset:28672
v_mfma_f32_16x16x32_bf16 v[168:171], v[56:59], v[40:43], 0
ds_read_b64_tr_b16 v[124:125], v16 offset:40960
v_mfma_f32_16x16x32_bf16 v[172:175], v[56:59], v[44:47], 0
ds_read_b64_tr_b16 v[126:127], v16 offset:45056
v_mfma_f32_16x16x32_bf16 v[236:239], v[72:75], v[44:47], 0
v_mfma_f32_16x16x32_bf16 v[232:235], v[72:75], v[40:43], 0
v_mfma_f32_16x16x32_bf16 v[228:231], v[72:75], v[36:39], 0
v_mfma_f32_16x16x32_bf16 v[224:227], v[72:75], v[32:35], 0
v_mfma_f32_16x16x32_bf16 v[176:179], v[60:63], v[32:35], 0
v_mfma_f32_16x16x32_bf16 v[180:183], v[60:63], v[36:39], 0
v_mfma_f32_16x16x32_bf16 v[184:187], v[60:63], v[40:43], 0
v_mfma_f32_16x16x32_bf16 v[188:191], v[60:63], v[44:47], 0
v_mfma_f32_16x16x32_bf16 v[252:255], v[76:79], v[44:47], 0
v_mfma_f32_16x16x32_bf16 v[248:251], v[76:79], v[40:43], 0
v_mfma_f32_16x16x32_bf16 v[244:247], v[76:79], v[36:39], 0
v_mfma_f32_16x16x32_bf16 v[240:243], v[76:79], v[32:35], 0
s_waitcnt lgkmcnt(0)
v_mfma_f32_16x16x32_bf16 v[128:131], v[96:99], v[80:83], v[128:131]
v_mfma_f32_16x16x32_bf16 v[132:135], v[96:99], v[84:87], v[132:135]
v_mfma_f32_16x16x32_bf16 v[136:139], v[96:99], v[88:91], v[136:139]
v_mfma_f32_16x16x32_bf16 v[140:143], v[96:99], v[92:95], v[140:143]
v_mfma_f32_16x16x32_bf16 v[204:207], v[112:115], v[92:95], v[204:207]
v_mfma_f32_16x16x32_bf16 v[200:203], v[112:115], v[88:91], v[200:203]
v_mfma_f32_16x16x32_bf16 v[196:199], v[112:115], v[84:87], v[196:199]
v_mfma_f32_16x16x32_bf16 v[192:195], v[112:115], v[80:83], v[192:195]
v_mfma_f32_16x16x32_bf16 v[144:147], v[100:103], v[80:83], v[144:147]
v_mfma_f32_16x16x32_bf16 v[148:151], v[100:103], v[84:87], v[148:151]
v_mfma_f32_16x16x32_bf16 v[152:155], v[100:103], v[88:91], v[152:155]
v_mfma_f32_16x16x32_bf16 v[156:159], v[100:103], v[92:95], v[156:159]
v_mfma_f32_16x16x32_bf16 v[220:223], v[116:119], v[92:95], v[220:223]
v_mfma_f32_16x16x32_bf16 v[216:219], v[116:119], v[88:91], v[216:219]
v_mfma_f32_16x16x32_bf16 v[212:215], v[116:119], v[84:87], v[212:215]
v_mfma_f32_16x16x32_bf16 v[208:211], v[116:119], v[80:83], v[208:211]
v_mfma_f32_16x16x32_bf16 v[160:163], v[104:107], v[80:83], v[160:163]
v_mfma_f32_16x16x32_bf16 v[164:167], v[104:107], v[84:87], v[164:167]
v_mfma_f32_16x16x32_bf16 v[168:171], v[104:107], v[88:91], v[168:171]
v_mfma_f32_16x16x32_bf16 v[172:175], v[104:107], v[92:95], v[172:175]
v_mfma_f32_16x16x32_bf16 v[236:239], v[120:123], v[92:95], v[236:239]
v_mfma_f32_16x16x32_bf16 v[232:235], v[120:123], v[88:91], v[232:235]
v_mfma_f32_16x16x32_bf16 v[228:231], v[120:123], v[84:87], v[228:231]
v_mfma_f32_16x16x32_bf16 v[224:227], v[120:123], v[80:83], v[224:227]
v_mfma_f32_16x16x32_bf16 v[176:179], v[108:111], v[80:83], v[176:179]
v_mfma_f32_16x16x32_bf16 v[180:183], v[108:111], v[84:87], v[180:183]
v_mfma_f32_16x16x32_bf16 v[184:187], v[108:111], v[88:91], v[184:187]
v_mfma_f32_16x16x32_bf16 v[188:191], v[108:111], v[92:95], v[188:191]
v_mfma_f32_16x16x32_bf16 v[252:255], v[124:127], v[92:95], v[252:255]
v_mfma_f32_16x16x32_bf16 v[248:251], v[124:127], v[88:91], v[248:251]
v_mfma_f32_16x16x32_bf16 v[244:247], v[124:127], v[84:87], v[244:247]
v_mfma_f32_16x16x32_bf16 v[240:243], v[124:127], v[80:83], v[240:243]
s_mul_i32 s43, s49, 192
s_and_b32 s43, s43, 0xffffff80
s_add_u32 s43, s43, 4096
s_cmp_eq_u32 s51, 1
s_cselect_b32 s8, s4, s6
s_cselect_b32 s9, s5, s7
s_sub_u32 s10, 7340032, s43
s_lshl_b32 s44, s34, 18
s_add_u32 s44, s44, 4194304
s_movk_i32 s38, 28672
s_cmp_eq_u32 s51, 0
s_cselect_b32 s8, s32, s8
s_cselect_b32 s9, s33, s9
s_cselect_b32 s10, 262144, s10
s_cselect_b32 s43, s44, s43
s_cselect_b32 s38, 1024, s38
s_cselect_b32 s45, 0, -1
s_add_u32 s8, s8, s43
s_addc_u32 s9, s9, 0
s_mov_b32 s11, 0x20000
s_lshl_b32 s40, s38, 4
s_add_u32 s42, s35, 17
s_lshl_b32 s39, s51, 14
v_lshrrev_b32 v19, 4, v1
v_lshlrev_b32 v20, 5, v19
v_mul_u32_u24 v19, 6912, v19
v_and_b32 v19, s45, v19
v_and_b32 v20, s45, v20
v_lshlrev_b32 v21, 4, v1
v_xor_b32 v21, v21, v20
v_add_u32 v22, v21, v19
s_and_b32 s45, s45, 128
v_xor_b32 v23, s45, v22
s_mul_i32 s43, s34, 917504
s_mul_i32 s44, s35, 16384
s_add_u32 s43, s43, s44
s_add_u32 s43, s43, 8388608
s_add_u32 s24, s32, s43
s_addc_u32 s25, s33, 0
s_mov_b32 s26, 278528
s_mov_b32 s27, 0x20000
s_mov_b32 s53, 262144
s_lshl_b32 s43, s47, 13
s_lshl_b32 s44, s46, 10
s_add_u32 s43, s43, s44
v_lshlrev_b32 v19, 11, v18
v_lshl_add_u32 v19, v17, 4, v19
v_add_u32 v27, s43, v19
s_lshl_b32 s43, s34, 18
s_lshl_b32 s44, s35, 7
s_add_u32 s43, s43, s44
s_add_u32 s16, s62, s43
s_addc_u32 s17, s63, 0
s_mov_b32 s18, 260224
s_mov_b32 s19, 0x20000
s_lshl_b32 s43, s46, 6
v_lshl_add_u32 v19, v17, 1, s43
v_lshlrev_b32 v19, 11, v19
v_and_b32 v20, 1, v18
v_lshl_add_u32 v19, v20, 5, v19
v_lshrrev_b32 v20, 1, v18
v_lshl_add_u32 v19, v20, 4, v19
s_lshl_b32 s43, s47, 6
v_add_u32 v28, s43, v19
s_lshl_b32 s43, s34, 4
s_add_u32 s43, s43, s35
s_xor_b32 s43, s43, 0
s_lshl_b32 s43, s43, 15
s_add_u32 s43, s43, 33554432
s_add_u32 s64, s32, s43
s_addc_u32 s65, s33, 0
s_mov_b32 s66, 32768
s_mov_b32 s67, 0x20000
s_lshl_b32 s43, s34, 4
s_add_u32 s43, s43, s35
s_xor_b32 s43, s43, 1
s_lshl_b32 s43, s43, 15
s_add_u32 s43, s43, 33554432
s_add_u32 s68, s32, s43
s_addc_u32 s69, s33, 0
s_mov_b32 s70, 32768
s_mov_b32 s71, 0x20000
s_lshl_b32 s43, s34, 18
s_add_u32 s12, s32, s43
s_addc_u32 s13, s33, 0
s_add_u32 s12, s12, 4194304
s_addc_u32 s13, s13, 0
s_mov_b32 s14, 262144
s_mov_b32 s15, 0x20000
v_lshlrev_b32 v21, 4, v1
s_lshl_b32 s54, s36, 11
s_add_u32 s43, s35, 1
s_and_b32 s43, s43, 15
s_lshl_b32 s43, s43, 14
s_add_u32 s30, s43, s54
s_add_u32 s43, s35, 2
s_and_b32 s43, s43, 15
s_lshl_b32 s43, s43, 14
s_add_u32 s31, s43, s54
s_waitcnt vmcnt(0)
s_barrier
s_setprio 1
ds_read_b128 v[32:35], v2 offset:0
ds_read_b64_tr_b16 v[48:49], v5 offset:16384
ds_read_b64_tr_b16 v[50:51], v5 offset:20480
ds_read_b128 v[36:39], v2 offset:256
ds_read_b128 v[40:43], v2 offset:512
ds_read_b128 v[44:47], v2 offset:768
ds_read_b64_tr_b16 v[64:65], v5 offset:32768
ds_read_b64_tr_b16 v[66:67], v5 offset:36864
ds_read_b64_tr_b16 v[52:53], v6 offset:16384
ds_read_b64_tr_b16 v[54:55], v6 offset:20480
ds_read_b64_tr_b16 v[68:69], v6 offset:32768
ds_read_b64_tr_b16 v[70:71], v6 offset:36864
ds_read_b64_tr_b16 v[56:57], v7 offset:16384
ds_read_b64_tr_b16 v[58:59], v7 offset:20480
ds_read_b64_tr_b16 v[72:73], v7 offset:32768
ds_read_b64_tr_b16 v[74:75], v7 offset:36864
ds_read_b64_tr_b16 v[60:61], v8 offset:16384
ds_read_b64_tr_b16 v[62:63], v8 offset:20480
ds_read_b64_tr_b16 v[76:77], v8 offset:32768
ds_read_b64_tr_b16 v[78:79], v8 offset:36864
s_waitcnt lgkmcnt(14)
v_max3_u32 v19, v32, v33, v34
v_max3_u32 v19, v19, v35, v36
v_max3_u32 v19, v19, v37, v38
v_max3_u32 v19, v19, v39, v40
v_max3_u32 v19, v19, v41, v42
v_max3_u32 v19, v19, v43, v44
v_max3_u32 v19, v19, v45, v46
v_max_u32 v19, v19, v47
v_cmp_eq_u32 vcc, -1, v19
s_nop 4
s_cbranch_vccnz Lfx_83
Lok_81:
s_waitcnt lgkmcnt(0)
v_mfma_f32_16x16x32_bf16 v[128:131], v[48:51], v[32:35], v[128:131]
ds_read_b128 v[80:83], v2 offset:8192
v_mfma_f32_16x16x32_bf16 v[132:135], v[48:51], v[36:39], v[132:135]
ds_read_b64_tr_b16 v[96:97], v5 offset:24576
v_mfma_f32_16x16x32_bf16 v[136:139], v[48:51], v[40:43], v[136:139]
ds_read_b64_tr_b16 v[98:99], v5 offset:28672
v_mfma_f32_16x16x32_bf16 v[140:143], v[48:51], v[44:47], v[140:143]
ds_read_b128 v[84:87], v2 offset:8448
v_mfma_f32_16x16x32_bf16 v[204:207], v[64:67], v[44:47], v[204:207]
ds_read_b128 v[88:91], v2 offset:8704
v_mfma_f32_16x16x32_bf16 v[200:203], v[64:67], v[40:43], v[200:203]
ds_read_b128 v[92:95], v2 offset:8960
v_mfma_f32_16x16x32_bf16 v[196:199], v[64:67], v[36:39], v[196:199]
ds_read_b64_tr_b16 v[112:113], v5 offset:40960
v_mfma_f32_16x16x32_bf16 v[192:195], v[64:67], v[32:35], v[192:195]
ds_read_b64_tr_b16 v[114:115], v5 offset:45056
v_mfma_f32_16x16x32_bf16 v[144:147], v[52:55], v[32:35], v[144:147]
ds_read_b64_tr_b16 v[100:101], v6 offset:24576
v_mfma_f32_16x16x32_bf16 v[148:151], v[52:55], v[36:39], v[148:151]
ds_read_b64_tr_b16 v[102:103], v6 offset:28672
v_mfma_f32_16x16x32_bf16 v[152:155], v[52:55], v[40:43], v[152:155]
ds_read_b64_tr_b16 v[116:117], v6 offset:40960
v_mfma_f32_16x16x32_bf16 v[156:159], v[52:55], v[44:47], v[156:159]
ds_read_b64_tr_b16 v[118:119], v6 offset:45056
v_mfma_f32_16x16x32_bf16 v[220:223], v[68:71], v[44:47], v[220:223]
ds_read_b64_tr_b16 v[104:105], v7 offset:24576
v_mfma_f32_16x16x32_bf16 v[216:219], v[68:71], v[40:43], v[216:219]
ds_read_b64_tr_b16 v[106:107], v7 offset:28672
v_mfma_f32_16x16x32_bf16 v[212:215], v[68:71], v[36:39], v[212:215]
ds_read_b64_tr_b16 v[120:121], v7 offset:40960
v_mfma_f32_16x16x32_bf16 v[208:211], v[68:71], v[32:35], v[208:211]
ds_read_b64_tr_b16 v[122:123], v7 offset:45056
v_mfma_f32_16x16x32_bf16 v[160:163], v[56:59], v[32:35], v[160:163]
ds_read_b64_tr_b16 v[108:109], v8 offset:24576
v_mfma_f32_16x16x32_bf16 v[164:167], v[56:59], v[36:39], v[164:167]
ds_read_b64_tr_b16 v[110:111], v8 offset:28672
v_mfma_f32_16x16x32_bf16 v[168:171], v[56:59], v[40:43], v[168:171]
ds_read_b64_tr_b16 v[124:125], v8 offset:40960
v_mfma_f32_16x16x32_bf16 v[172:175], v[56:59], v[44:47], v[172:175]
ds_read_b64_tr_b16 v[126:127], v8 offset:45056
s_waitcnt lgkmcnt(14)
v_mfma_f32_16x16x32_bf16 v[236:239], v[72:75], v[44:47], v[236:239]
v_max3_u32 v19, v80, v81, v82
v_mfma_f32_16x16x32_bf16 v[232:235], v[72:75], v[40:43], v[232:235]
v_max3_u32 v19, v19, v83, v84
v_mfma_f32_16x16x32_bf16 v[228:231], v[72:75], v[36:39], v[228:231]
v_max3_u32 v19, v19, v85, v86
v_mfma_f32_16x16x32_bf16 v[224:227], v[72:75], v[32:35], v[224:227]
v_max3_u32 v19, v19, v87, v88
v_mfma_f32_16x16x32_bf16 v[176:179], v[60:63], v[32:35], v[176:179]
v_max3_u32 v19, v19, v89, v90
v_mfma_f32_16x16x32_bf16 v[180:183], v[60:63], v[36:39], v[180:183]
v_max3_u32 v19, v19, v91, v92
v_mfma_f32_16x16x32_bf16 v[184:187], v[60:63], v[40:43], v[184:187]
v_max3_u32 v19, v19, v93, v94
v_mfma_f32_16x16x32_bf16 v[188:191], v[60:63], v[44:47], v[188:191]
v_max_u32 v19, v19, v95
v_mfma_f32_16x16x32_bf16 v[252:255], v[76:79], v[44:47], v[252:255]
v_cmp_eq_u32 vcc, -1, v19
v_mfma_f32_16x16x32_bf16 v[248:251], v[76:79], v[40:43], v[248:251]
v_mfma_f32_16x16x32_bf16 v[244:247], v[76:79], v[36:39], v[244:247]
v_mfma_f32_16x16x32_bf16 v[240:243], v[76:79], v[32:35], v[240:243]
s_nop 1
s_cbranch_vccnz Lfx_86
Lok_84:
s_waitcnt lgkmcnt(0)
s_barrier
v_mfma_f32_16x16x32_bf16 v[128:131], v[96:99], v[80:83], v[128:131]
ds_read_b128 v[32:35], v3 offset:0
v_mfma_f32_16x16x32_bf16 v[132:135], v[96:99], v[84:87], v[132:135]
ds_read_b64_tr_b16 v[48:49], v9 offset:16384
v_mfma_f32_16x16x32_bf16 v[136:139], v[96:99], v[88:91], v[136:139]
ds_read_b64_tr_b16 v[50:51], v9 offset:20480
v_mfma_f32_16x16x32_bf16 v[140:143], v[96:99], v[92:95], v[140:143]
ds_read_b128 v[36:39], v3 offset:256
v_mfma_f32_16x16x32_bf16 v[204:207], v[112:115], v[92:95], v[204:207]
ds_read_b128 v[40:43], v3 offset:512
v_mfma_f32_16x16x32_bf16 v[200:203], v[112:115], v[88:91], v[200:203]
ds_read_b128 v[44:47], v3 offset:768
v_mfma_f32_16x16x32_bf16 v[196:199], v[112:115], v[84:87], v[196:199]
ds_read_b64_tr_b16 v[64:65], v9 offset:32768
v_mfma_f32_16x16x32_bf16 v[192:195], v[112:115], v[80:83], v[192:195]
ds_read_b64_tr_b16 v[66:67], v9 offset:36864
v_mfma_f32_16x16x32_bf16 v[144:147], v[100:103], v[80:83], v[144:147]
ds_read_b64_tr_b16 v[52:53], v10 offset:16384
v_mfma_f32_16x16x32_bf16 v[148:151], v[100:103], v[84:87], v[148:151]
ds_read_b64_tr_b16 v[54:55], v10 offset:20480
v_mfma_f32_16x16x32_bf16 v[152:155], v[100:103], v[88:91], v[152:155]
ds_read_b64_tr_b16 v[68:69], v10 offset:32768
v_mfma_f32_16x16x32_bf16 v[156:159], v[100:103], v[92:95], v[156:159]
ds_read_b64_tr_b16 v[70:71], v10 offset:36864
v_mfma_f32_16x16x32_bf16 v[220:223], v[116:119], v[92:95], v[220:223]
ds_read_b64_tr_b16 v[56:57], v11 offset:16384
v_mfma_f32_16x16x32_bf16 v[216:219], v[116:119], v[88:91], v[216:219]
ds_read_b64_tr_b16 v[58:59], v11 offset:20480
v_mfma_f32_16x16x32_bf16 v[212:215], v[116:119], v[84:87], v[212:215]
ds_read_b64_tr_b16 v[72:73], v11 offset:32768
v_mfma_f32_16x16x32_bf16 v[208:211], v[116:119], v[80:83], v[208:211]
ds_read_b64_tr_b16 v[74:75], v11 offset:36864
v_mfma_f32_16x16x32_bf16 v[160:163], v[104:107], v[80:83], v[160:163]
ds_read_b64_tr_b16 v[60:61], v12 offset:16384
v_mfma_f32_16x16x32_bf16 v[164:167], v[104:107], v[84:87], v[164:167]
ds_read_b64_tr_b16 v[62:63], v12 offset:20480
v_mfma_f32_16x16x32_bf16 v[168:171], v[104:107], v[88:91], v[168:171]
ds_read_b64_tr_b16 v[76:77], v12 offset:32768
v_mfma_f32_16x16x32_bf16 v[172:175], v[104:107], v[92:95], v[172:175]
ds_read_b64_tr_b16 v[78:79], v12 offset:36864
s_waitcnt lgkmcnt(14)
v_mfma_f32_16x16x32_bf16 v[236:239], v[120:123], v[92:95], v[236:239]
v_max3_u32 v19, v32, v33, v34
v_mfma_f32_16x16x32_bf16 v[232:235], v[120:123], v[88:91], v[232:235]
v_max3_u32 v19, v19, v35, v36
v_mfma_f32_16x16x32_bf16 v[228:231], v[120:123], v[84:87], v[228:231]
v_max3_u32 v19, v19, v37, v38
v_mfma_f32_16x16x32_bf16 v[224:227], v[120:123], v[80:83], v[224:227]
v_max3_u32 v19, v19, v39, v40
v_mfma_f32_16x16x32_bf16 v[176:179], v[108:111], v[80:83], v[176:179]
v_max3_u32 v19, v19, v41, v42
v_mfma_f32_16x16x32_bf16 v[180:183], v[108:111], v[84:87], v[180:183]
v_max3_u32 v19, v19, v43, v44
v_mfma_f32_16x16x32_bf16 v[184:187], v[108:111], v[88:91], v[184:187]
v_max3_u32 v19, v19, v45, v46
v_mfma_f32_16x16x32_bf16 v[188:191], v[108:111], v[92:95], v[188:191]
v_max_u32 v19, v19, v47
v_mfma_f32_16x16x32_bf16 v[252:255], v[124:127], v[92:95], v[252:255]
v_cmp_eq_u32 vcc, -1, v19
v_mfma_f32_16x16x32_bf16 v[248:251], v[124:127], v[88:91], v[248:251]
v_mfma_f32_16x16x32_bf16 v[244:247], v[124:127], v[84:87], v[244:247]
v_mfma_f32_16x16x32_bf16 v[240:243], v[124:127], v[80:83], v[240:243]
s_nop 1
s_cbranch_vccnz Lfx_89
Lok_87:
s_waitcnt lgkmcnt(0)
v_mfma_f32_16x16x32_bf16 v[128:131], v[48:51], v[32:35], v[128:131]
ds_read_b128 v[80:83], v3 offset:8192
v_mfma_f32_16x16x32_bf16 v[132:135], v[48:51], v[36:39], v[132:135]
ds_read_b64_tr_b16 v[96:97], v9 offset:24576
v_mfma_f32_16x16x32_bf16 v[136:139], v[48:51], v[40:43], v[136:139]
ds_read_b64_tr_b16 v[98:99], v9 offset:28672
v_mfma_f32_16x16x32_bf16 v[140:143], v[48:51], v[44:47], v[140:143]
ds_read_b128 v[84:87], v3 offset:8448
v_mfma_f32_16x16x32_bf16 v[204:207], v[64:67], v[44:47], v[204:207]
ds_read_b128 v[88:91], v3 offset:8704
v_mfma_f32_16x16x32_bf16 v[200:203], v[64:67], v[40:43], v[200:203]
ds_read_b128 v[92:95], v3 offset:8960
v_mfma_f32_16x16x32_bf16 v[196:199], v[64:67], v[36:39], v[196:199]
ds_read_b64_tr_b16 v[112:113], v9 offset:40960
v_mfma_f32_16x16x32_bf16 v[192:195], v[64:67], v[32:35], v[192:195]
ds_read_b64_tr_b16 v[114:115], v9 offset:45056
v_mfma_f32_16x16x32_bf16 v[144:147], v[52:55], v[32:35], v[144:147]
ds_read_b64_tr_b16 v[100:101], v10 offset:24576
v_mfma_f32_16x16x32_bf16 v[148:151], v[52:55], v[36:39], v[148:151]
ds_read_b64_tr_b16 v[102:103], v10 offset:28672
v_mfma_f32_16x16x32_bf16 v[152:155], v[52:55], v[40:43], v[152:155]
ds_read_b64_tr_b16 v[116:117], v10 offset:40960
v_mfma_f32_16x16x32_bf16 v[156:159], v[52:55], v[44:47], v[156:159]
ds_read_b64_tr_b16 v[118:119], v10 offset:45056
v_mfma_f32_16x16x32_bf16 v[220:223], v[68:71], v[44:47], v[220:223]
ds_read_b64_tr_b16 v[104:105], v11 offset:24576
v_mfma_f32_16x16x32_bf16 v[216:219], v[68:71], v[40:43], v[216:219]
ds_read_b64_tr_b16 v[106:107], v11 offset:28672
v_mfma_f32_16x16x32_bf16 v[212:215], v[68:71], v[36:39], v[212:215]
ds_read_b64_tr_b16 v[120:121], v11 offset:40960
v_mfma_f32_16x16x32_bf16 v[208:211], v[68:71], v[32:35], v[208:211]
ds_read_b64_tr_b16 v[122:123], v11 offset:45056
v_mfma_f32_16x16x32_bf16 v[160:163], v[56:59], v[32:35], v[160:163]
ds_read_b64_tr_b16 v[108:109], v12 offset:24576
v_mfma_f32_16x16x32_bf16 v[164:167], v[56:59], v[36:39], v[164:167]
ds_read_b64_tr_b16 v[110:111], v12 offset:28672
v_mfma_f32_16x16x32_bf16 v[168:171], v[56:59], v[40:43], v[168:171]
ds_read_b64_tr_b16 v[124:125], v12 offset:40960
v_mfma_f32_16x16x32_bf16 v[172:175], v[56:59], v[44:47], v[172:175]
ds_read_b64_tr_b16 v[126:127], v12 offset:45056
s_waitcnt lgkmcnt(14)
v_mfma_f32_16x16x32_bf16 v[236:239], v[72:75], v[44:47], v[236:239]
v_max3_u32 v19, v80, v81, v82
v_mfma_f32_16x16x32_bf16 v[232:235], v[72:75], v[40:43], v[232:235]
v_max3_u32 v19, v19, v83, v84
v_mfma_f32_16x16x32_bf16 v[228:231], v[72:75], v[36:39], v[228:231]
v_max3_u32 v19, v19, v85, v86
v_mfma_f32_16x16x32_bf16 v[224:227], v[72:75], v[32:35], v[224:227]
v_max3_u32 v19, v19, v87, v88
v_mfma_f32_16x16x32_bf16 v[176:179], v[60:63], v[32:35], v[176:179]
v_max3_u32 v19, v19, v89, v90
v_mfma_f32_16x16x32_bf16 v[180:183], v[60:63], v[36:39], v[180:183]
v_max3_u32 v19, v19, v91, v92
v_mfma_f32_16x16x32_bf16 v[184:187], v[60:63], v[40:43], v[184:187]
v_max3_u32 v19, v19, v93, v94
v_mfma_f32_16x16x32_bf16 v[188:191], v[60:63], v[44:47], v[188:191]
v_max_u32 v19, v19, v95
v_mfma_f32_16x16x32_bf16 v[252:255], v[76:79], v[44:47], v[252:255]
v_cmp_eq_u32 vcc, -1, v19
v_mfma_f32_16x16x32_bf16 v[248:251], v[76:79], v[40:43], v[248:251]
v_mfma_f32_16x16x32_bf16 v[244:247], v[76:79], v[36:39], v[244:247]
v_mfma_f32_16x16x32_bf16 v[240:243], v[76:79], v[32:35], v[240:243]
s_nop 1
s_cbranch_vccnz Lfx_92
Lok_90:
s_waitcnt lgkmcnt(0)
s_barrier
v_mfma_f32_16x16x32_bf16 v[128:131], v[96:99], v[80:83], v[128:131]
ds_read_b128 v[32:35], v4 offset:0
v_mfma_f32_16x16x32_bf16 v[132:135], v[96:99], v[84:87], v[132:135]
ds_read_b64_tr_b16 v[48:49], v13 offset:16384
v_mfma_f32_16x16x32_bf16 v[136:139], v[96:99], v[88:91], v[136:139]
ds_read_b64_tr_b16 v[50:51], v13 offset:20480
v_mfma_f32_16x16x32_bf16 v[140:143], v[96:99], v[92:95], v[140:143]
ds_read_b128 v[36:39], v4 offset:256
v_mfma_f32_16x16x32_bf16 v[204:207], v[112:115], v[92:95], v[204:207]
ds_read_b128 v[40:43], v4 offset:512
v_mfma_f32_16x16x32_bf16 v[200:203], v[112:115], v[88:91], v[200:203]
ds_read_b128 v[44:47], v4 offset:768
v_mfma_f32_16x16x32_bf16 v[196:199], v[112:115], v[84:87], v[196:199]
ds_read_b64_tr_b16 v[64:65], v13 offset:32768
v_mfma_f32_16x16x32_bf16 v[192:195], v[112:115], v[80:83], v[192:195]
ds_read_b64_tr_b16 v[66:67], v13 offset:36864
v_mfma_f32_16x16x32_bf16 v[144:147], v[100:103], v[80:83], v[144:147]
ds_read_b64_tr_b16 v[52:53], v14 offset:16384
v_mfma_f32_16x16x32_bf16 v[148:151], v[100:103], v[84:87], v[148:151]
ds_read_b64_tr_b16 v[54:55], v14 offset:20480
v_mfma_f32_16x16x32_bf16 v[152:155], v[100:103], v[88:91], v[152:155]
ds_read_b64_tr_b16 v[68:69], v14 offset:32768
v_mfma_f32_16x16x32_bf16 v[156:159], v[100:103], v[92:95], v[156:159]
ds_read_b64_tr_b16 v[70:71], v14 offset:36864
v_mfma_f32_16x16x32_bf16 v[220:223], v[116:119], v[92:95], v[220:223]
ds_read_b64_tr_b16 v[56:57], v15 offset:16384
v_mfma_f32_16x16x32_bf16 v[216:219], v[116:119], v[88:91], v[216:219]
ds_read_b64_tr_b16 v[58:59], v15 offset:20480
v_mfma_f32_16x16x32_bf16 v[212:215], v[116:119], v[84:87], v[212:215]
ds_read_b64_tr_b16 v[72:73], v15 offset:32768
v_mfma_f32_16x16x32_bf16 v[208:211], v[116:119], v[80:83], v[208:211]
ds_read_b64_tr_b16 v[74:75], v15 offset:36864
v_mfma_f32_16x16x32_bf16 v[160:163], v[104:107], v[80:83], v[160:163]
ds_read_b64_tr_b16 v[60:61], v16 offset:16384
v_mfma_f32_16x16x32_bf16 v[164:167], v[104:107], v[84:87], v[164:167]
ds_read_b64_tr_b16 v[62:63], v16 offset:20480
v_mfma_f32_16x16x32_bf16 v[168:171], v[104:107], v[88:91], v[168:171]
ds_read_b64_tr_b16 v[76:77], v16 offset:32768
v_mfma_f32_16x16x32_bf16 v[172:175], v[104:107], v[92:95], v[172:175]
ds_read_b64_tr_b16 v[78:79], v16 offset:36864
s_waitcnt lgkmcnt(14)
v_mfma_f32_16x16x32_bf16 v[236:239], v[120:123], v[92:95], v[236:239]
v_max3_u32 v19, v32, v33, v34
v_mfma_f32_16x16x32_bf16 v[232:235], v[120:123], v[88:91], v[232:235]
v_max3_u32 v19, v19, v35, v36
v_mfma_f32_16x16x32_bf16 v[228:231], v[120:123], v[84:87], v[228:231]
v_max3_u32 v19, v19, v37, v38
v_mfma_f32_16x16x32_bf16 v[224:227], v[120:123], v[80:83], v[224:227]
v_max3_u32 v19, v19, v39, v40
v_mfma_f32_16x16x32_bf16 v[176:179], v[108:111], v[80:83], v[176:179]
v_max3_u32 v19, v19, v41, v42
v_mfma_f32_16x16x32_bf16 v[180:183], v[108:111], v[84:87], v[180:183]
v_max3_u32 v19, v19, v43, v44
v_mfma_f32_16x16x32_bf16 v[184:187], v[108:111], v[88:91], v[184:187]
v_max3_u32 v19, v19, v45, v46
v_mfma_f32_16x16x32_bf16 v[188:191], v[108:111], v[92:95], v[188:191]
v_max_u32 v19, v19, v47
v_mfma_f32_16x16x32_bf16 v[252:255], v[124:127], v[92:95], v[252:255]
v_cmp_eq_u32 vcc, -1, v19
v_mfma_f32_16x16x32_bf16 v[248:251], v[124:127], v[88:91], v[248:251]
v_mfma_f32_16x16x32_bf16 v[244:247], v[124:127], v[84:87], v[244:247]
v_mfma_f32_16x16x32_bf16 v[240:243], v[124:127], v[80:83], v[240:243]
s_nop 1
s_cbranch_vccnz Lfx_95
Lok_93:
s_waitcnt lgkmcnt(0)
v_mfma_f32_16x16x32_bf16 v[128:131], v[48:51], v[32:35], v[128:131]
ds_read_b128 v[80:83], v4 offset:8192
v_mfma_f32_16x16x32_bf16 v[132:135], v[48:51], v[36:39], v[132:135]
ds_read_b64_tr_b16 v[96:97], v13 offset:24576
v_mfma_f32_16x16x32_bf16 v[136:139], v[48:51], v[40:43], v[136:139]
ds_read_b64_tr_b16 v[98:99], v13 offset:28672
v_mfma_f32_16x16x32_bf16 v[140:143], v[48:51], v[44:47], v[140:143]
ds_read_b128 v[84:87], v4 offset:8448
v_mfma_f32_16x16x32_bf16 v[204:207], v[64:67], v[44:47], v[204:207]
ds_read_b128 v[88:91], v4 offset:8704
v_mfma_f32_16x16x32_bf16 v[200:203], v[64:67], v[40:43], v[200:203]
ds_read_b128 v[92:95], v4 offset:8960
v_mfma_f32_16x16x32_bf16 v[196:199], v[64:67], v[36:39], v[196:199]
ds_read_b64_tr_b16 v[112:113], v13 offset:40960
v_mfma_f32_16x16x32_bf16 v[192:195], v[64:67], v[32:35], v[192:195]
ds_read_b64_tr_b16 v[114:115], v13 offset:45056
v_mfma_f32_16x16x32_bf16 v[144:147], v[52:55], v[32:35], v[144:147]
ds_read_b64_tr_b16 v[100:101], v14 offset:24576
v_mfma_f32_16x16x32_bf16 v[148:151], v[52:55], v[36:39], v[148:151]
ds_read_b64_tr_b16 v[102:103], v14 offset:28672
v_mfma_f32_16x16x32_bf16 v[152:155], v[52:55], v[40:43], v[152:155]
ds_read_b64_tr_b16 v[116:117], v14 offset:40960
v_mfma_f32_16x16x32_bf16 v[156:159], v[52:55], v[44:47], v[156:159]
ds_read_b64_tr_b16 v[118:119], v14 offset:45056
v_mfma_f32_16x16x32_bf16 v[220:223], v[68:71], v[44:47], v[220:223]
ds_read_b64_tr_b16 v[104:105], v15 offset:24576
v_mfma_f32_16x16x32_bf16 v[216:219], v[68:71], v[40:43], v[216:219]
ds_read_b64_tr_b16 v[106:107], v15 offset:28672
v_mfma_f32_16x16x32_bf16 v[212:215], v[68:71], v[36:39], v[212:215]
ds_read_b64_tr_b16 v[120:121], v15 offset:40960
v_mfma_f32_16x16x32_bf16 v[208:211], v[68:71], v[32:35], v[208:211]
ds_read_b64_tr_b16 v[122:123], v15 offset:45056
v_mfma_f32_16x16x32_bf16 v[160:163], v[56:59], v[32:35], v[160:163]
ds_read_b64_tr_b16 v[108:109], v16 offset:24576
v_mfma_f32_16x16x32_bf16 v[164:167], v[56:59], v[36:39], v[164:167]
ds_read_b64_tr_b16 v[110:111], v16 offset:28672
v_mfma_f32_16x16x32_bf16 v[168:171], v[56:59], v[40:43], v[168:171]
ds_read_b64_tr_b16 v[124:125], v16 offset:40960
v_mfma_f32_16x16x32_bf16 v[172:175], v[56:59], v[44:47], v[172:175]
ds_read_b64_tr_b16 v[126:127], v16 offset:45056
s_waitcnt lgkmcnt(14)
v_mfma_f32_16x16x32_bf16 v[236:239], v[72:75], v[44:47], v[236:239]
v_max3_u32 v19, v80, v81, v82
v_mfma_f32_16x16x32_bf16 v[232:235], v[72:75], v[40:43], v[232:235]
v_max3_u32 v19, v19, v83, v84
v_mfma_f32_16x16x32_bf16 v[228:231], v[72:75], v[36:39], v[228:231]
v_max3_u32 v19, v19, v85, v86
v_mfma_f32_16x16x32_bf16 v[224:227], v[72:75], v[32:35], v[224:227]
v_max3_u32 v19, v19, v87, v88
v_mfma_f32_16x16x32_bf16 v[176:179], v[60:63], v[32:35], v[176:179]
v_max3_u32 v19, v19, v89, v90
v_mfma_f32_16x16x32_bf16 v[180:183], v[60:63], v[36:39], v[180:183]
v_max3_u32 v19, v19, v91, v92
v_mfma_f32_16x16x32_bf16 v[184:187], v[60:63], v[40:43], v[184:187]
v_max3_u32 v19, v19, v93, v94
v_mfma_f32_16x16x32_bf16 v[188:191], v[60:63], v[44:47], v[188:191]
v_max_u32 v19, v19, v95
v_mfma_f32_16x16x32_bf16 v[252:255], v[76:79], v[44:47], v[252:255]
v_cmp_eq_u32 vcc, -1, v19
v_mfma_f32_16x16x32_bf16 v[248:251], v[76:79], v[40:43], v[248:251]
v_mfma_f32_16x16x32_bf16 v[244:247], v[76:79], v[36:39], v[244:247]
v_mfma_f32_16x16x32_bf16 v[240:243], v[76:79], v[32:35], v[240:243]
s_nop 1
s_cbranch_vccnz Lfx_98
Lok_96:
s_waitcnt lgkmcnt(0)
s_barrier
v_mfma_f32_16x16x32_bf16 v[128:131], v[96:99], v[80:83], v[128:131]
ds_read_b128 v[32:35], v2 offset:0
v_mfma_f32_16x16x32_bf16 v[132:135], v[96:99], v[84:87], v[132:135]
ds_read_b64_tr_b16 v[48:49], v5 offset:16384
v_mfma_f32_16x16x32_bf16 v[136:139], v[96:99], v[88:91], v[136:139]
ds_read_b64_tr_b16 v[50:51], v5 offset:20480
v_mfma_f32_16x16x32_bf16 v[140:143], v[96:99], v[92:95], v[140:143]
ds_read_b128 v[36:39], v2 offset:256
v_mfma_f32_16x16x32_bf16 v[204:207], v[112:115], v[92:95], v[204:207]
ds_read_b128 v[40:43], v2 offset:512
v_mfma_f32_16x16x32_bf16 v[200:203], v[112:115], v[88:91], v[200:203]
ds_read_b128 v[44:47], v2 offset:768
v_mfma_f32_16x16x32_bf16 v[196:199], v[112:115], v[84:87], v[196:199]
ds_read_b64_tr_b16 v[64:65], v5 offset:32768
v_mfma_f32_16x16x32_bf16 v[192:195], v[112:115], v[80:83], v[192:195]
ds_read_b64_tr_b16 v[66:67], v5 offset:36864
v_mfma_f32_16x16x32_bf16 v[144:147], v[100:103], v[80:83], v[144:147]
ds_read_b64_tr_b16 v[52:53], v6 offset:16384
v_mfma_f32_16x16x32_bf16 v[148:151], v[100:103], v[84:87], v[148:151]
ds_read_b64_tr_b16 v[54:55], v6 offset:20480
v_mfma_f32_16x16x32_bf16 v[152:155], v[100:103], v[88:91], v[152:155]
ds_read_b64_tr_b16 v[68:69], v6 offset:32768
v_mfma_f32_16x16x32_bf16 v[156:159], v[100:103], v[92:95], v[156:159]
ds_read_b64_tr_b16 v[70:71], v6 offset:36864
v_mfma_f32_16x16x32_bf16 v[220:223], v[116:119], v[92:95], v[220:223]
ds_read_b64_tr_b16 v[56:57], v7 offset:16384
v_mfma_f32_16x16x32_bf16 v[216:219], v[116:119], v[88:91], v[216:219]
ds_read_b64_tr_b16 v[58:59], v7 offset:20480
v_mfma_f32_16x16x32_bf16 v[212:215], v[116:119], v[84:87], v[212:215]
ds_read_b64_tr_b16 v[72:73], v7 offset:32768
v_mfma_f32_16x16x32_bf16 v[208:211], v[116:119], v[80:83], v[208:211]
ds_read_b64_tr_b16 v[74:75], v7 offset:36864
v_mfma_f32_16x16x32_bf16 v[160:163], v[104:107], v[80:83], v[160:163]
ds_read_b64_tr_b16 v[60:61], v8 offset:16384
v_mfma_f32_16x16x32_bf16 v[164:167], v[104:107], v[84:87], v[164:167]
ds_read_b64_tr_b16 v[62:63], v8 offset:20480
v_mfma_f32_16x16x32_bf16 v[168:171], v[104:107], v[88:91], v[168:171]
ds_read_b64_tr_b16 v[76:77], v8 offset:32768
v_mfma_f32_16x16x32_bf16 v[172:175], v[104:107], v[92:95], v[172:175]
ds_read_b64_tr_b16 v[78:79], v8 offset:36864
s_waitcnt lgkmcnt(14)
v_mfma_f32_16x16x32_bf16 v[236:239], v[120:123], v[92:95], v[236:239]
v_max3_u32 v19, v32, v33, v34
v_mfma_f32_16x16x32_bf16 v[232:235], v[120:123], v[88:91], v[232:235]
v_max3_u32 v19, v19, v35, v36
v_mfma_f32_16x16x32_bf16 v[228:231], v[120:123], v[84:87], v[228:231]
v_max3_u32 v19, v19, v37, v38
v_mfma_f32_16x16x32_bf16 v[224:227], v[120:123], v[80:83], v[224:227]
v_max3_u32 v19, v19, v39, v40
v_mfma_f32_16x16x32_bf16 v[176:179], v[108:111], v[80:83], v[176:179]
v_max3_u32 v19, v19, v41, v42
v_mfma_f32_16x16x32_bf16 v[180:183], v[108:111], v[84:87], v[180:183]
v_max3_u32 v19, v19, v43, v44
v_mfma_f32_16x16x32_bf16 v[184:187], v[108:111], v[88:91], v[184:187]
v_max3_u32 v19, v19, v45, v46
v_mfma_f32_16x16x32_bf16 v[188:191], v[108:111], v[92:95], v[188:191]
v_max_u32 v19, v19, v47
v_mfma_f32_16x16x32_bf16 v[252:255], v[124:127], v[92:95], v[252:255]
v_cmp_eq_u32 vcc, -1, v19
v_mfma_f32_16x16x32_bf16 v[248:251], v[124:127], v[88:91], v[248:251]
v_mfma_f32_16x16x32_bf16 v[244:247], v[124:127], v[84:87], v[244:247]
v_mfma_f32_16x16x32_bf16 v[240:243], v[124:127], v[80:83], v[240:243]
s_nop 1
s_cbranch_vccnz Lfx_101
Lok_99:
s_waitcnt lgkmcnt(0)
v_mfma_f32_16x16x32_bf16 v[128:131], v[48:51], v[32:35], v[128:131]
ds_read_b128 v[80:83], v2 offset:8192
v_mfma_f32_16x16x32_bf16 v[132:135], v[48:51], v[36:39], v[132:135]
ds_read_b64_tr_b16 v[96:97], v5 offset:24576
v_mfma_f32_16x16x32_bf16 v[136:139], v[48:51], v[40:43], v[136:139]
ds_read_b64_tr_b16 v[98:99], v5 offset:28672
v_mfma_f32_16x16x32_bf16 v[140:143], v[48:51], v[44:47], v[140:143]
ds_read_b128 v[84:87], v2 offset:8448
v_mfma_f32_16x16x32_bf16 v[204:207], v[64:67], v[44:47], v[204:207]
ds_read_b128 v[88:91], v2 offset:8704
v_mfma_f32_16x16x32_bf16 v[200:203], v[64:67], v[40:43], v[200:203]
ds_read_b128 v[92:95], v2 offset:8960
v_mfma_f32_16x16x32_bf16 v[196:199], v[64:67], v[36:39], v[196:199]
ds_read_b64_tr_b16 v[112:113], v5 offset:40960
v_mfma_f32_16x16x32_bf16 v[192:195], v[64:67], v[32:35], v[192:195]
ds_read_b64_tr_b16 v[114:115], v5 offset:45056
v_mfma_f32_16x16x32_bf16 v[144:147], v[52:55], v[32:35], v[144:147]
ds_read_b64_tr_b16 v[100:101], v6 offset:24576
v_mfma_f32_16x16x32_bf16 v[148:151], v[52:55], v[36:39], v[148:151]
ds_read_b64_tr_b16 v[102:103], v6 offset:28672
v_mfma_f32_16x16x32_bf16 v[152:155], v[52:55], v[40:43], v[152:155]
ds_read_b64_tr_b16 v[116:117], v6 offset:40960
v_mfma_f32_16x16x32_bf16 v[156:159], v[52:55], v[44:47], v[156:159]
ds_read_b64_tr_b16 v[118:119], v6 offset:45056
v_mfma_f32_16x16x32_bf16 v[220:223], v[68:71], v[44:47], v[220:223]
ds_read_b64_tr_b16 v[104:105], v7 offset:24576
v_mfma_f32_16x16x32_bf16 v[216:219], v[68:71], v[40:43], v[216:219]
ds_read_b64_tr_b16 v[106:107], v7 offset:28672
v_mfma_f32_16x16x32_bf16 v[212:215], v[68:71], v[36:39], v[212:215]
ds_read_b64_tr_b16 v[120:121], v7 offset:40960
v_mfma_f32_16x16x32_bf16 v[208:211], v[68:71], v[32:35], v[208:211]
ds_read_b64_tr_b16 v[122:123], v7 offset:45056
v_mfma_f32_16x16x32_bf16 v[160:163], v[56:59], v[32:35], v[160:163]
ds_read_b64_tr_b16 v[108:109], v8 offset:24576
v_mfma_f32_16x16x32_bf16 v[164:167], v[56:59], v[36:39], v[164:167]
ds_read_b64_tr_b16 v[110:111], v8 offset:28672
v_mfma_f32_16x16x32_bf16 v[168:171], v[56:59], v[40:43], v[168:171]
ds_read_b64_tr_b16 v[124:125], v8 offset:40960
v_mfma_f32_16x16x32_bf16 v[172:175], v[56:59], v[44:47], v[172:175]
ds_read_b64_tr_b16 v[126:127], v8 offset:45056
s_waitcnt lgkmcnt(14)
v_mfma_f32_16x16x32_bf16 v[236:239], v[72:75], v[44:47], v[236:239]
v_max3_u32 v19, v80, v81, v82
v_mfma_f32_16x16x32_bf16 v[232:235], v[72:75], v[40:43], v[232:235]
v_max3_u32 v19, v19, v83, v84
v_mfma_f32_16x16x32_bf16 v[228:231], v[72:75], v[36:39], v[228:231]
v_max3_u32 v19, v19, v85, v86
v_mfma_f32_16x16x32_bf16 v[224:227], v[72:75], v[32:35], v[224:227]
v_max3_u32 v19, v19, v87, v88
v_mfma_f32_16x16x32_bf16 v[176:179], v[60:63], v[32:35], v[176:179]
v_max3_u32 v19, v19, v89, v90
v_mfma_f32_16x16x32_bf16 v[180:183], v[60:63], v[36:39], v[180:183]
v_max3_u32 v19, v19, v91, v92
v_mfma_f32_16x16x32_bf16 v[184:187], v[60:63], v[40:43], v[184:187]
v_max3_u32 v19, v19, v93, v94
v_mfma_f32_16x16x32_bf16 v[188:191], v[60:63], v[44:47], v[188:191]
v_max_u32 v19, v19, v95
v_mfma_f32_16x16x32_bf16 v[252:255], v[76:79], v[44:47], v[252:255]
v_cmp_eq_u32 vcc, -1, v19
v_mfma_f32_16x16x32_bf16 v[248:251], v[76:79], v[40:43], v[248:251]
v_mfma_f32_16x16x32_bf16 v[244:247], v[76:79], v[36:39], v[244:247]
v_mfma_f32_16x16x32_bf16 v[240:243], v[76:79], v[32:35], v[240:243]
s_nop 1
s_cbranch_vccnz Lfx_104
Lok_102:
s_waitcnt lgkmcnt(0)
s_barrier
v_mfma_f32_16x16x32_bf16 v[128:131], v[96:99], v[80:83], v[128:131]
ds_read_b128 v[32:35], v3 offset:0
v_mfma_f32_16x16x32_bf16 v[132:135], v[96:99], v[84:87], v[132:135]
ds_read_b64_tr_b16 v[48:49], v9 offset:16384
v_mfma_f32_16x16x32_bf16 v[136:139], v[96:99], v[88:91], v[136:139]
ds_read_b64_tr_b16 v[50:51], v9 offset:20480
v_mfma_f32_16x16x32_bf16 v[140:143], v[96:99], v[92:95], v[140:143]
ds_read_b128 v[36:39], v3 offset:256
v_mfma_f32_16x16x32_bf16 v[204:207], v[112:115], v[92:95], v[204:207]
ds_read_b128 v[40:43], v3 offset:512
v_mfma_f32_16x16x32_bf16 v[200:203], v[112:115], v[88:91], v[200:203]
ds_read_b128 v[44:47], v3 offset:768
v_mfma_f32_16x16x32_bf16 v[196:199], v[112:115], v[84:87], v[196:199]
ds_read_b64_tr_b16 v[64:65], v9 offset:32768
v_mfma_f32_16x16x32_bf16 v[192:195], v[112:115], v[80:83], v[192:195]
ds_read_b64_tr_b16 v[66:67], v9 offset:36864
v_mfma_f32_16x16x32_bf16 v[144:147], v[100:103], v[80:83], v[144:147]
ds_read_b64_tr_b16 v[52:53], v10 offset:16384
v_mfma_f32_16x16x32_bf16 v[148:151], v[100:103], v[84:87], v[148:151]
ds_read_b64_tr_b16 v[54:55], v10 offset:20480
v_mfma_f32_16x16x32_bf16 v[152:155], v[100:103], v[88:91], v[152:155]
ds_read_b64_tr_b16 v[68:69], v10 offset:32768
v_mfma_f32_16x16x32_bf16 v[156:159], v[100:103], v[92:95], v[156:159]
ds_read_b64_tr_b16 v[70:71], v10 offset:36864
v_mfma_f32_16x16x32_bf16 v[220:223], v[116:119], v[92:95], v[220:223]
ds_read_b64_tr_b16 v[56:57], v11 offset:16384
v_mfma_f32_16x16x32_bf16 v[216:219], v[116:119], v[88:91], v[216:219]
ds_read_b64_tr_b16 v[58:59], v11 offset:20480
v_mfma_f32_16x16x32_bf16 v[212:215], v[116:119], v[84:87], v[212:215]
ds_read_b64_tr_b16 v[72:73], v11 offset:32768
v_mfma_f32_16x16x32_bf16 v[208:211], v[116:119], v[80:83], v[208:211]
ds_read_b64_tr_b16 v[74:75], v11 offset:36864
v_mfma_f32_16x16x32_bf16 v[160:163], v[104:107], v[80:83], v[160:163]
ds_read_b64_tr_b16 v[60:61], v12 offset:16384
v_mfma_f32_16x16x32_bf16 v[164:167], v[104:107], v[84:87], v[164:167]
ds_read_b64_tr_b16 v[62:63], v12 offset:20480
v_mfma_f32_16x16x32_bf16 v[168:171], v[104:107], v[88:91], v[168:171]
ds_read_b64_tr_b16 v[76:77], v12 offset:32768
v_mfma_f32_16x16x32_bf16 v[172:175], v[104:107], v[92:95], v[172:175]
ds_read_b64_tr_b16 v[78:79], v12 offset:36864
s_waitcnt lgkmcnt(14)
v_mfma_f32_16x16x32_bf16 v[236:239], v[120:123], v[92:95], v[236:239]
v_max3_u32 v19, v32, v33, v34
v_mfma_f32_16x16x32_bf16 v[232:235], v[120:123], v[88:91], v[232:235]
v_max3_u32 v19, v19, v35, v36
v_mfma_f32_16x16x32_bf16 v[228:231], v[120:123], v[84:87], v[228:231]
v_max3_u32 v19, v19, v37, v38
v_mfma_f32_16x16x32_bf16 v[224:227], v[120:123], v[80:83], v[224:227]
v_max3_u32 v19, v19, v39, v40
v_mfma_f32_16x16x32_bf16 v[176:179], v[108:111], v[80:83], v[176:179]
v_max3_u32 v19, v19, v41, v42
v_mfma_f32_16x16x32_bf16 v[180:183], v[108:111], v[84:87], v[180:183]
v_max3_u32 v19, v19, v43, v44
v_mfma_f32_16x16x32_bf16 v[184:187], v[108:111], v[88:91], v[184:187]
v_max3_u32 v19, v19, v45, v46
v_mfma_f32_16x16x32_bf16 v[188:191], v[108:111], v[92:95], v[188:191]
v_max_u32 v19, v19, v47
v_mfma_f32_16x16x32_bf16 v[252:255], v[124:127], v[92:95], v[252:255]
v_cmp_eq_u32 vcc, -1, v19
v_mfma_f32_16x16x32_bf16 v[248:251], v[124:127], v[88:91], v[248:251]
v_mfma_f32_16x16x32_bf16 v[244:247], v[124:127], v[84:87], v[244:247]
v_mfma_f32_16x16x32_bf16 v[240:243], v[124:127], v[80:83], v[240:243]
s_nop 1
s_cbranch_vccnz Lfx_107
Lok_105:
s_waitcnt lgkmcnt(0)
v_mfma_f32_16x16x32_bf16 v[128:131], v[48:51], v[32:35], v[128:131]
ds_read_b128 v[80:83], v3 offset:8192
v_mfma_f32_16x16x32_bf16 v[132:135], v[48:51], v[36:39], v[132:135]
ds_read_b64_tr_b16 v[96:97], v9 offset:24576
v_mfma_f32_16x16x32_bf16 v[136:139], v[48:51], v[40:43], v[136:139]
ds_read_b64_tr_b16 v[98:99], v9 offset:28672
v_mfma_f32_16x16x32_bf16 v[140:143], v[48:51], v[44:47], v[140:143]
ds_read_b128 v[84:87], v3 offset:8448
v_mfma_f32_16x16x32_bf16 v[204:207], v[64:67], v[44:47], v[204:207]
ds_read_b128 v[88:91], v3 offset:8704
v_mfma_f32_16x16x32_bf16 v[200:203], v[64:67], v[40:43], v[200:203]
ds_read_b128 v[92:95], v3 offset:8960
v_mfma_f32_16x16x32_bf16 v[196:199], v[64:67], v[36:39], v[196:199]
ds_read_b64_tr_b16 v[112:113], v9 offset:40960
v_mfma_f32_16x16x32_bf16 v[192:195], v[64:67], v[32:35], v[192:195]
ds_read_b64_tr_b16 v[114:115], v9 offset:45056
v_mfma_f32_16x16x32_bf16 v[144:147], v[52:55], v[32:35], v[144:147]
ds_read_b64_tr_b16 v[100:101], v10 offset:24576
v_mfma_f32_16x16x32_bf16 v[148:151], v[52:55], v[36:39], v[148:151]
ds_read_b64_tr_b16 v[102:103], v10 offset:28672
v_mfma_f32_16x16x32_bf16 v[152:155], v[52:55], v[40:43], v[152:155]
ds_read_b64_tr_b16 v[116:117], v10 offset:40960
v_mfma_f32_16x16x32_bf16 v[156:159], v[52:55], v[44:47], v[156:159]
ds_read_b64_tr_b16 v[118:119], v10 offset:45056
v_mfma_f32_16x16x32_bf16 v[220:223], v[68:71], v[44:47], v[220:223]
ds_read_b64_tr_b16 v[104:105], v11 offset:24576
v_mfma_f32_16x16x32_bf16 v[216:219], v[68:71], v[40:43], v[216:219]
ds_read_b64_tr_b16 v[106:107], v11 offset:28672
v_mfma_f32_16x16x32_bf16 v[212:215], v[68:71], v[36:39], v[212:215]
ds_read_b64_tr_b16 v[120:121], v11 offset:40960
v_mfma_f32_16x16x32_bf16 v[208:211], v[68:71], v[32:35], v[208:211]
ds_read_b64_tr_b16 v[122:123], v11 offset:45056
v_mfma_f32_16x16x32_bf16 v[160:163], v[56:59], v[32:35], v[160:163]
ds_read_b64_tr_b16 v[108:109], v12 offset:24576
v_mfma_f32_16x16x32_bf16 v[164:167], v[56:59], v[36:39], v[164:167]
ds_read_b64_tr_b16 v[110:111], v12 offset:28672
v_mfma_f32_16x16x32_bf16 v[168:171], v[56:59], v[40:43], v[168:171]
ds_read_b64_tr_b16 v[124:125], v12 offset:40960
v_mfma_f32_16x16x32_bf16 v[172:175], v[56:59], v[44:47], v[172:175]
ds_read_b64_tr_b16 v[126:127], v12 offset:45056
s_waitcnt lgkmcnt(14)
v_mfma_f32_16x16x32_bf16 v[236:239], v[72:75], v[44:47], v[236:239]
v_max3_u32 v19, v80, v81, v82
v_mfma_f32_16x16x32_bf16 v[232:235], v[72:75], v[40:43], v[232:235]
v_max3_u32 v19, v19, v83, v84
v_mfma_f32_16x16x32_bf16 v[228:231], v[72:75], v[36:39], v[228:231]
v_max3_u32 v19, v19, v85, v86
v_mfma_f32_16x16x32_bf16 v[224:227], v[72:75], v[32:35], v[224:227]
v_max3_u32 v19, v19, v87, v88
v_mfma_f32_16x16x32_bf16 v[176:179], v[60:63], v[32:35], v[176:179]
v_max3_u32 v19, v19, v89, v90
v_mfma_f32_16x16x32_bf16 v[180:183], v[60:63], v[36:39], v[180:183]
v_max3_u32 v19, v19, v91, v92
v_mfma_f32_16x16x32_bf16 v[184:187], v[60:63], v[40:43], v[184:187]
v_max3_u32 v19, v19, v93, v94
v_mfma_f32_16x16x32_bf16 v[188:191], v[60:63], v[44:47], v[188:191]
v_max_u32 v19, v19, v95
v_mfma_f32_16x16x32_bf16 v[252:255], v[76:79], v[44:47], v[252:255]
v_cmp_eq_u32 vcc, -1, v19
v_mfma_f32_16x16x32_bf16 v[248:251], v[76:79], v[40:43], v[248:251]
v_mfma_f32_16x16x32_bf16 v[244:247], v[76:79], v[36:39], v[244:247]
v_mfma_f32_16x16x32_bf16 v[240:243], v[76:79], v[32:35], v[240:243]
s_nop 1
s_cbranch_vccnz Lfx_110
Lok_108:
s_waitcnt lgkmcnt(0)
s_barrier
v_mfma_f32_16x16x32_bf16 v[128:131], v[96:99], v[80:83], v[128:131]
ds_read_b128 v[32:35], v4 offset:0
v_mfma_f32_16x16x32_bf16 v[132:135], v[96:99], v[84:87], v[132:135]
ds_read_b64_tr_b16 v[48:49], v13 offset:16384
v_mfma_f32_16x16x32_bf16 v[136:139], v[96:99], v[88:91], v[136:139]
ds_read_b64_tr_b16 v[50:51], v13 offset:20480
v_mfma_f32_16x16x32_bf16 v[140:143], v[96:99], v[92:95], v[140:143]
ds_read_b128 v[36:39], v4 offset:256
v_mfma_f32_16x16x32_bf16 v[204:207], v[112:115], v[92:95], v[204:207]
ds_read_b128 v[40:43], v4 offset:512
v_mfma_f32_16x16x32_bf16 v[200:203], v[112:115], v[88:91], v[200:203]
ds_read_b128 v[44:47], v4 offset:768
v_mfma_f32_16x16x32_bf16 v[196:199], v[112:115], v[84:87], v[196:199]
ds_read_b64_tr_b16 v[64:65], v13 offset:32768
v_mfma_f32_16x16x32_bf16 v[192:195], v[112:115], v[80:83], v[192:195]
ds_read_b64_tr_b16 v[66:67], v13 offset:36864
v_mfma_f32_16x16x32_bf16 v[144:147], v[100:103], v[80:83], v[144:147]
ds_read_b64_tr_b16 v[52:53], v14 offset:16384
v_mfma_f32_16x16x32_bf16 v[148:151], v[100:103], v[84:87], v[148:151]
ds_read_b64_tr_b16 v[54:55], v14 offset:20480
v_mfma_f32_16x16x32_bf16 v[152:155], v[100:103], v[88:91], v[152:155]
ds_read_b64_tr_b16 v[68:69], v14 offset:32768
v_mfma_f32_16x16x32_bf16 v[156:159], v[100:103], v[92:95], v[156:159]
ds_read_b64_tr_b16 v[70:71], v14 offset:36864
v_mfma_f32_16x16x32_bf16 v[220:223], v[116:119], v[92:95], v[220:223]
ds_read_b64_tr_b16 v[56:57], v15 offset:16384
v_mfma_f32_16x16x32_bf16 v[216:219], v[116:119], v[88:91], v[216:219]
ds_read_b64_tr_b16 v[58:59], v15 offset:20480
v_mfma_f32_16x16x32_bf16 v[212:215], v[116:119], v[84:87], v[212:215]
ds_read_b64_tr_b16 v[72:73], v15 offset:32768
v_mfma_f32_16x16x32_bf16 v[208:211], v[116:119], v[80:83], v[208:211]
ds_read_b64_tr_b16 v[74:75], v15 offset:36864
v_mfma_f32_16x16x32_bf16 v[160:163], v[104:107], v[80:83], v[160:163]
ds_read_b64_tr_b16 v[60:61], v16 offset:16384
v_mfma_f32_16x16x32_bf16 v[164:167], v[104:107], v[84:87], v[164:167]
ds_read_b64_tr_b16 v[62:63], v16 offset:20480
v_mfma_f32_16x16x32_bf16 v[168:171], v[104:107], v[88:91], v[168:171]
ds_read_b64_tr_b16 v[76:77], v16 offset:32768
v_mfma_f32_16x16x32_bf16 v[172:175], v[104:107], v[92:95], v[172:175]
ds_read_b64_tr_b16 v[78:79], v16 offset:36864
s_waitcnt lgkmcnt(14)
v_mfma_f32_16x16x32_bf16 v[236:239], v[120:123], v[92:95], v[236:239]
v_max3_u32 v19, v32, v33, v34
v_mfma_f32_16x16x32_bf16 v[232:235], v[120:123], v[88:91], v[232:235]
v_max3_u32 v19, v19, v35, v36
v_mfma_f32_16x16x32_bf16 v[228:231], v[120:123], v[84:87], v[228:231]
v_max3_u32 v19, v19, v37, v38
v_mfma_f32_16x16x32_bf16 v[224:227], v[120:123], v[80:83], v[224:227]
v_max3_u32 v19, v19, v39, v40
v_mfma_f32_16x16x32_bf16 v[176:179], v[108:111], v[80:83], v[176:179]
v_max3_u32 v19, v19, v41, v42
v_mfma_f32_16x16x32_bf16 v[180:183], v[108:111], v[84:87], v[180:183]
v_max3_u32 v19, v19, v43, v44
v_mfma_f32_16x16x32_bf16 v[184:187], v[108:111], v[88:91], v[184:187]
v_max3_u32 v19, v19, v45, v46
v_mfma_f32_16x16x32_bf16 v[188:191], v[108:111], v[92:95], v[188:191]
v_max_u32 v19, v19, v47
v_mfma_f32_16x16x32_bf16 v[252:255], v[124:127], v[92:95], v[252:255]
v_cmp_eq_u32 vcc, -1, v19
v_mfma_f32_16x16x32_bf16 v[248:251], v[124:127], v[88:91], v[248:251]
v_mfma_f32_16x16x32_bf16 v[244:247], v[124:127], v[84:87], v[244:247]
v_mfma_f32_16x16x32_bf16 v[240:243], v[124:127], v[80:83], v[240:243]
s_nop 1
s_cbranch_vccnz Lfx_113
Lok_111:
s_waitcnt lgkmcnt(0)
v_mfma_f32_16x16x32_bf16 v[128:131], v[48:51], v[32:35], v[128:131]
ds_read_b128 v[80:83], v4 offset:8192
v_mfma_f32_16x16x32_bf16 v[132:135], v[48:51], v[36:39], v[132:135]
ds_read_b64_tr_b16 v[96:97], v13 offset:24576
v_mfma_f32_16x16x32_bf16 v[136:139], v[48:51], v[40:43], v[136:139]
ds_read_b64_tr_b16 v[98:99], v13 offset:28672
v_mfma_f32_16x16x32_bf16 v[140:143], v[48:51], v[44:47], v[140:143]
ds_read_b128 v[84:87], v4 offset:8448
v_mfma_f32_16x16x32_bf16 v[204:207], v[64:67], v[44:47], v[204:207]
ds_read_b128 v[88:91], v4 offset:8704
v_mfma_f32_16x16x32_bf16 v[200:203], v[64:67], v[40:43], v[200:203]
ds_read_b128 v[92:95], v4 offset:8960
v_mfma_f32_16x16x32_bf16 v[196:199], v[64:67], v[36:39], v[196:199]
ds_read_b64_tr_b16 v[112:113], v13 offset:40960
v_mfma_f32_16x16x32_bf16 v[192:195], v[64:67], v[32:35], v[192:195]
ds_read_b64_tr_b16 v[114:115], v13 offset:45056
v_mfma_f32_16x16x32_bf16 v[144:147], v[52:55], v[32:35], v[144:147]
ds_read_b64_tr_b16 v[100:101], v14 offset:24576
v_mfma_f32_16x16x32_bf16 v[148:151], v[52:55], v[36:39], v[148:151]
ds_read_b64_tr_b16 v[102:103], v14 offset:28672
v_mfma_f32_16x16x32_bf16 v[152:155], v[52:55], v[40:43], v[152:155]
ds_read_b64_tr_b16 v[116:117], v14 offset:40960
v_mfma_f32_16x16x32_bf16 v[156:159], v[52:55], v[44:47], v[156:159]
ds_read_b64_tr_b16 v[118:119], v14 offset:45056
v_mfma_f32_16x16x32_bf16 v[220:223], v[68:71], v[44:47], v[220:223]
ds_read_b64_tr_b16 v[104:105], v15 offset:24576
v_mfma_f32_16x16x32_bf16 v[216:219], v[68:71], v[40:43], v[216:219]
ds_read_b64_tr_b16 v[106:107], v15 offset:28672
v_mfma_f32_16x16x32_bf16 v[212:215], v[68:71], v[36:39], v[212:215]
ds_read_b64_tr_b16 v[120:121], v15 offset:40960
v_mfma_f32_16x16x32_bf16 v[208:211], v[68:71], v[32:35], v[208:211]
ds_read_b64_tr_b16 v[122:123], v15 offset:45056
v_mfma_f32_16x16x32_bf16 v[160:163], v[56:59], v[32:35], v[160:163]
ds_read_b64_tr_b16 v[108:109], v16 offset:24576
v_mfma_f32_16x16x32_bf16 v[164:167], v[56:59], v[36:39], v[164:167]
ds_read_b64_tr_b16 v[110:111], v16 offset:28672
v_mfma_f32_16x16x32_bf16 v[168:171], v[56:59], v[40:43], v[168:171]
ds_read_b64_tr_b16 v[124:125], v16 offset:40960
v_mfma_f32_16x16x32_bf16 v[172:175], v[56:59], v[44:47], v[172:175]
ds_read_b64_tr_b16 v[126:127], v16 offset:45056
s_waitcnt lgkmcnt(14)
v_mfma_f32_16x16x32_bf16 v[236:239], v[72:75], v[44:47], v[236:239]
v_max3_u32 v19, v80, v81, v82
v_mfma_f32_16x16x32_bf16 v[232:235], v[72:75], v[40:43], v[232:235]
v_max3_u32 v19, v19, v83, v84
v_mfma_f32_16x16x32_bf16 v[228:231], v[72:75], v[36:39], v[228:231]
v_max3_u32 v19, v19, v85, v86
v_mfma_f32_16x16x32_bf16 v[224:227], v[72:75], v[32:35], v[224:227]
v_max3_u32 v19, v19, v87, v88
v_mfma_f32_16x16x32_bf16 v[176:179], v[60:63], v[32:35], v[176:179]
v_max3_u32 v19, v19, v89, v90
v_mfma_f32_16x16x32_bf16 v[180:183], v[60:63], v[36:39], v[180:183]
v_max3_u32 v19, v19, v91, v92
v_mfma_f32_16x16x32_bf16 v[184:187], v[60:63], v[40:43], v[184:187]
v_max3_u32 v19, v19, v93, v94
v_mfma_f32_16x16x32_bf16 v[188:191], v[60:63], v[44:47], v[188:191]
v_max_u32 v19, v19, v95
v_mfma_f32_16x16x32_bf16 v[252:255], v[76:79], v[44:47], v[252:255]
v_cmp_eq_u32 vcc, -1, v19
v_mfma_f32_16x16x32_bf16 v[248:251], v[76:79], v[40:43], v[248:251]
v_mfma_f32_16x16x32_bf16 v[244:247], v[76:79], v[36:39], v[244:247]
v_mfma_f32_16x16x32_bf16 v[240:243], v[76:79], v[32:35], v[240:243]
s_nop 1
s_cbranch_vccnz Lfx_116
Lok_114:
s_waitcnt lgkmcnt(0)
s_barrier
v_mfma_f32_16x16x32_bf16 v[128:131], v[96:99], v[80:83], v[128:131]
ds_read_b128 v[32:35], v2 offset:0
v_mfma_f32_16x16x32_bf16 v[132:135], v[96:99], v[84:87], v[132:135]
ds_read_b64_tr_b16 v[48:49], v5 offset:16384
v_mfma_f32_16x16x32_bf16 v[136:139], v[96:99], v[88:91], v[136:139]
ds_read_b64_tr_b16 v[50:51], v5 offset:20480
v_mfma_f32_16x16x32_bf16 v[140:143], v[96:99], v[92:95], v[140:143]
ds_read_b128 v[36:39], v2 offset:256
v_mfma_f32_16x16x32_bf16 v[204:207], v[112:115], v[92:95], v[204:207]
ds_read_b128 v[40:43], v2 offset:512
v_mfma_f32_16x16x32_bf16 v[200:203], v[112:115], v[88:91], v[200:203]
ds_read_b128 v[44:47], v2 offset:768
v_mfma_f32_16x16x32_bf16 v[196:199], v[112:115], v[84:87], v[196:199]
ds_read_b64_tr_b16 v[64:65], v5 offset:32768
v_mfma_f32_16x16x32_bf16 v[192:195], v[112:115], v[80:83], v[192:195]
ds_read_b64_tr_b16 v[66:67], v5 offset:36864
v_mfma_f32_16x16x32_bf16 v[144:147], v[100:103], v[80:83], v[144:147]
ds_read_b64_tr_b16 v[52:53], v6 offset:16384
v_mfma_f32_16x16x32_bf16 v[148:151], v[100:103], v[84:87], v[148:151]
ds_read_b64_tr_b16 v[54:55], v6 offset:20480
v_mfma_f32_16x16x32_bf16 v[152:155], v[100:103], v[88:91], v[152:155]
ds_read_b64_tr_b16 v[68:69], v6 offset:32768
v_mfma_f32_16x16x32_bf16 v[156:159], v[100:103], v[92:95], v[156:159]
ds_read_b64_tr_b16 v[70:71], v6 offset:36864
v_mfma_f32_16x16x32_bf16 v[220:223], v[116:119], v[92:95], v[220:223]
ds_read_b64_tr_b16 v[56:57], v7 offset:16384
v_mfma_f32_16x16x32_bf16 v[216:219], v[116:119], v[88:91], v[216:219]
ds_read_b64_tr_b16 v[58:59], v7 offset:20480
v_mfma_f32_16x16x32_bf16 v[212:215], v[116:119], v[84:87], v[212:215]
ds_read_b64_tr_b16 v[72:73], v7 offset:32768
v_mfma_f32_16x16x32_bf16 v[208:211], v[116:119], v[80:83], v[208:211]
ds_read_b64_tr_b16 v[74:75], v7 offset:36864
v_mfma_f32_16x16x32_bf16 v[160:163], v[104:107], v[80:83], v[160:163]
ds_read_b64_tr_b16 v[60:61], v8 offset:16384
v_mfma_f32_16x16x32_bf16 v[164:167], v[104:107], v[84:87], v[164:167]
ds_read_b64_tr_b16 v[62:63], v8 offset:20480
v_mfma_f32_16x16x32_bf16 v[168:171], v[104:107], v[88:91], v[168:171]
ds_read_b64_tr_b16 v[76:77], v8 offset:32768
v_mfma_f32_16x16x32_bf16 v[172:175], v[104:107], v[92:95], v[172:175]
ds_read_b64_tr_b16 v[78:79], v8 offset:36864
s_waitcnt lgkmcnt(14)
v_mfma_f32_16x16x32_bf16 v[236:239], v[120:123], v[92:95], v[236:239]
v_max3_u32 v19, v32, v33, v34
v_mfma_f32_16x16x32_bf16 v[232:235], v[120:123], v[88:91], v[232:235]
v_max3_u32 v19, v19, v35, v36
v_mfma_f32_16x16x32_bf16 v[228:231], v[120:123], v[84:87], v[228:231]
v_max3_u32 v19, v19, v37, v38
v_mfma_f32_16x16x32_bf16 v[224:227], v[120:123], v[80:83], v[224:227]
v_max3_u32 v19, v19, v39, v40
v_mfma_f32_16x16x32_bf16 v[176:179], v[108:111], v[80:83], v[176:179]
v_max3_u32 v19, v19, v41, v42
v_mfma_f32_16x16x32_bf16 v[180:183], v[108:111], v[84:87], v[180:183]
v_max3_u32 v19, v19, v43, v44
v_mfma_f32_16x16x32_bf16 v[184:187], v[108:111], v[88:91], v[184:187]
v_max3_u32 v19, v19, v45, v46
v_mfma_f32_16x16x32_bf16 v[188:191], v[108:111], v[92:95], v[188:191]
v_max_u32 v19, v19, v47
v_mfma_f32_16x16x32_bf16 v[252:255], v[124:127], v[92:95], v[252:255]
v_cmp_eq_u32 vcc, -1, v19
v_mfma_f32_16x16x32_bf16 v[248:251], v[124:127], v[88:91], v[248:251]
v_mfma_f32_16x16x32_bf16 v[244:247], v[124:127], v[84:87], v[244:247]
v_mfma_f32_16x16x32_bf16 v[240:243], v[124:127], v[80:83], v[240:243]
s_nop 1
s_cbranch_vccnz Lfx_119
Lok_117:
s_waitcnt lgkmcnt(0)
v_mfma_f32_16x16x32_bf16 v[128:131], v[48:51], v[32:35], v[128:131]
ds_read_b128 v[80:83], v2 offset:8192
v_mfma_f32_16x16x32_bf16 v[132:135], v[48:51], v[36:39], v[132:135]
ds_read_b64_tr_b16 v[96:97], v5 offset:24576
v_mfma_f32_16x16x32_bf16 v[136:139], v[48:51], v[40:43], v[136:139]
ds_read_b64_tr_b16 v[98:99], v5 offset:28672
v_mfma_f32_16x16x32_bf16 v[140:143], v[48:51], v[44:47], v[140:143]
ds_read_b128 v[84:87], v2 offset:8448
v_mfma_f32_16x16x32_bf16 v[204:207], v[64:67], v[44:47], v[204:207]
ds_read_b128 v[88:91], v2 offset:8704
v_mfma_f32_16x16x32_bf16 v[200:203], v[64:67], v[40:43], v[200:203]
ds_read_b128 v[92:95], v2 offset:8960
v_mfma_f32_16x16x32_bf16 v[196:199], v[64:67], v[36:39], v[196:199]
ds_read_b64_tr_b16 v[112:113], v5 offset:40960
v_mfma_f32_16x16x32_bf16 v[192:195], v[64:67], v[32:35], v[192:195]
ds_read_b64_tr_b16 v[114:115], v5 offset:45056
v_mfma_f32_16x16x32_bf16 v[144:147], v[52:55], v[32:35], v[144:147]
ds_read_b64_tr_b16 v[100:101], v6 offset:24576
v_mfma_f32_16x16x32_bf16 v[148:151], v[52:55], v[36:39], v[148:151]
ds_read_b64_tr_b16 v[102:103], v6 offset:28672
v_mfma_f32_16x16x32_bf16 v[152:155], v[52:55], v[40:43], v[152:155]
ds_read_b64_tr_b16 v[116:117], v6 offset:40960
v_mfma_f32_16x16x32_bf16 v[156:159], v[52:55], v[44:47], v[156:159]
ds_read_b64_tr_b16 v[118:119], v6 offset:45056
v_mfma_f32_16x16x32_bf16 v[220:223], v[68:71], v[44:47], v[220:223]
ds_read_b64_tr_b16 v[104:105], v7 offset:24576
v_mfma_f32_16x16x32_bf16 v[216:219], v[68:71], v[40:43], v[216:219]
ds_read_b64_tr_b16 v[106:107], v7 offset:28672
v_mfma_f32_16x16x32_bf16 v[212:215], v[68:71], v[36:39], v[212:215]
ds_read_b64_tr_b16 v[120:121], v7 offset:40960
v_mfma_f32_16x16x32_bf16 v[208:211], v[68:71], v[32:35], v[208:211]
ds_read_b64_tr_b16 v[122:123], v7 offset:45056
v_mfma_f32_16x16x32_bf16 v[160:163], v[56:59], v[32:35], v[160:163]
ds_read_b64_tr_b16 v[108:109], v8 offset:24576
v_mfma_f32_16x16x32_bf16 v[164:167], v[56:59], v[36:39], v[164:167]
ds_read_b64_tr_b16 v[110:111], v8 offset:28672
v_mfma_f32_16x16x32_bf16 v[168:171], v[56:59], v[40:43], v[168:171]
ds_read_b64_tr_b16 v[124:125], v8 offset:40960
v_mfma_f32_16x16x32_bf16 v[172:175], v[56:59], v[44:47], v[172:175]
ds_read_b64_tr_b16 v[126:127], v8 offset:45056
s_waitcnt lgkmcnt(14)
v_mfma_f32_16x16x32_bf16 v[236:239], v[72:75], v[44:47], v[236:239]
v_max3_u32 v19, v80, v81, v82
v_mfma_f32_16x16x32_bf16 v[232:235], v[72:75], v[40:43], v[232:235]
v_max3_u32 v19, v19, v83, v84
v_mfma_f32_16x16x32_bf16 v[228:231], v[72:75], v[36:39], v[228:231]
v_max3_u32 v19, v19, v85, v86
v_mfma_f32_16x16x32_bf16 v[224:227], v[72:75], v[32:35], v[224:227]
v_max3_u32 v19, v19, v87, v88
v_mfma_f32_16x16x32_bf16 v[176:179], v[60:63], v[32:35], v[176:179]
v_max3_u32 v19, v19, v89, v90
v_mfma_f32_16x16x32_bf16 v[180:183], v[60:63], v[36:39], v[180:183]
v_max3_u32 v19, v19, v91, v92
v_mfma_f32_16x16x32_bf16 v[184:187], v[60:63], v[40:43], v[184:187]
v_max3_u32 v19, v19, v93, v94
v_mfma_f32_16x16x32_bf16 v[188:191], v[60:63], v[44:47], v[188:191]
v_max_u32 v19, v19, v95
v_mfma_f32_16x16x32_bf16 v[252:255], v[76:79], v[44:47], v[252:255]
v_cmp_eq_u32 vcc, -1, v19
v_mfma_f32_16x16x32_bf16 v[248:251], v[76:79], v[40:43], v[248:251]
v_mfma_f32_16x16x32_bf16 v[244:247], v[76:79], v[36:39], v[244:247]
v_mfma_f32_16x16x32_bf16 v[240:243], v[76:79], v[32:35], v[240:243]
s_nop 1
s_cbranch_vccnz Lfx_122
Lok_120:
s_waitcnt lgkmcnt(0)
s_barrier
v_mfma_f32_16x16x32_bf16 v[128:131], v[96:99], v[80:83], v[128:131]
ds_read_b128 v[32:35], v3 offset:0
v_mfma_f32_16x16x32_bf16 v[132:135], v[96:99], v[84:87], v[132:135]
ds_read_b64_tr_b16 v[48:49], v9 offset:16384
v_mfma_f32_16x16x32_bf16 v[136:139], v[96:99], v[88:91], v[136:139]
ds_read_b64_tr_b16 v[50:51], v9 offset:20480
v_mfma_f32_16x16x32_bf16 v[140:143], v[96:99], v[92:95], v[140:143]
ds_read_b128 v[36:39], v3 offset:256
v_mfma_f32_16x16x32_bf16 v[204:207], v[112:115], v[92:95], v[204:207]
ds_read_b128 v[40:43], v3 offset:512
v_mfma_f32_16x16x32_bf16 v[200:203], v[112:115], v[88:91], v[200:203]
ds_read_b128 v[44:47], v3 offset:768
v_mfma_f32_16x16x32_bf16 v[196:199], v[112:115], v[84:87], v[196:199]
ds_read_b64_tr_b16 v[64:65], v9 offset:32768
v_mfma_f32_16x16x32_bf16 v[192:195], v[112:115], v[80:83], v[192:195]
ds_read_b64_tr_b16 v[66:67], v9 offset:36864
v_mfma_f32_16x16x32_bf16 v[144:147], v[100:103], v[80:83], v[144:147]
ds_read_b64_tr_b16 v[52:53], v10 offset:16384
v_mfma_f32_16x16x32_bf16 v[148:151], v[100:103], v[84:87], v[148:151]
ds_read_b64_tr_b16 v[54:55], v10 offset:20480
v_mfma_f32_16x16x32_bf16 v[152:155], v[100:103], v[88:91], v[152:155]
ds_read_b64_tr_b16 v[68:69], v10 offset:32768
v_mfma_f32_16x16x32_bf16 v[156:159], v[100:103], v[92:95], v[156:159]
ds_read_b64_tr_b16 v[70:71], v10 offset:36864
v_mfma_f32_16x16x32_bf16 v[220:223], v[116:119], v[92:95], v[220:223]
ds_read_b64_tr_b16 v[56:57], v11 offset:16384
v_mfma_f32_16x16x32_bf16 v[216:219], v[116:119], v[88:91], v[216:219]
ds_read_b64_tr_b16 v[58:59], v11 offset:20480
v_mfma_f32_16x16x32_bf16 v[212:215], v[116:119], v[84:87], v[212:215]
ds_read_b64_tr_b16 v[72:73], v11 offset:32768
v_mfma_f32_16x16x32_bf16 v[208:211], v[116:119], v[80:83], v[208:211]
ds_read_b64_tr_b16 v[74:75], v11 offset:36864
v_mfma_f32_16x16x32_bf16 v[160:163], v[104:107], v[80:83], v[160:163]
ds_read_b64_tr_b16 v[60:61], v12 offset:16384
v_mfma_f32_16x16x32_bf16 v[164:167], v[104:107], v[84:87], v[164:167]
ds_read_b64_tr_b16 v[62:63], v12 offset:20480
v_mfma_f32_16x16x32_bf16 v[168:171], v[104:107], v[88:91], v[168:171]
ds_read_b64_tr_b16 v[76:77], v12 offset:32768
v_mfma_f32_16x16x32_bf16 v[172:175], v[104:107], v[92:95], v[172:175]
ds_read_b64_tr_b16 v[78:79], v12 offset:36864
v_mfma_f32_16x16x32_bf16 v[236:239], v[120:123], v[92:95], v[236:239]
v_mfma_f32_16x16x32_bf16 v[232:235], v[120:123], v[88:91], v[232:235]
v_mfma_f32_16x16x32_bf16 v[228:231], v[120:123], v[84:87], v[228:231]
v_mfma_f32_16x16x32_bf16 v[224:227], v[120:123], v[80:83], v[224:227]
v_mfma_f32_16x16x32_bf16 v[176:179], v[108:111], v[80:83], v[176:179]
v_mfma_f32_16x16x32_bf16 v[180:183], v[108:111], v[84:87], v[180:183]
v_mfma_f32_16x16x32_bf16 v[184:187], v[108:111], v[88:91], v[184:187]
v_mfma_f32_16x16x32_bf16 v[188:191], v[108:111], v[92:95], v[188:191]
v_mfma_f32_16x16x32_bf16 v[252:255], v[124:127], v[92:95], v[252:255]
v_mfma_f32_16x16x32_bf16 v[248:251], v[124:127], v[88:91], v[248:251]
v_mfma_f32_16x16x32_bf16 v[244:247], v[124:127], v[84:87], v[244:247]
v_mfma_f32_16x16x32_bf16 v[240:243], v[124:127], v[80:83], v[240:243]
s_mov_b32 s41, 2
.p2align 3
Lk3_123:
s_waitcnt lgkmcnt(0)
v_mfma_f32_16x16x32_bf16 v[128:131], v[48:51], v[32:35], v[128:131]
ds_read_b128 v[80:83], v3 offset:8192
v_mfma_f32_16x16x32_bf16 v[132:135], v[48:51], v[36:39], v[132:135]
ds_read_b64_tr_b16 v[96:97], v9 offset:24576
v_mfma_f32_16x16x32_bf16 v[136:139], v[48:51], v[40:43], v[136:139]
ds_read_b64_tr_b16 v[98:99], v9 offset:28672
v_mfma_f32_16x16x32_bf16 v[140:143], v[48:51], v[44:47], v[140:143]
ds_read_b128 v[84:87], v3 offset:8448
v_mfma_f32_16x16x32_bf16 v[204:207], v[64:67], v[44:47], v[204:207]
ds_read_b128 v[88:91], v3 offset:8704
v_mfma_f32_16x16x32_bf16 v[200:203], v[64:67], v[40:43], v[200:203]
ds_read_b128 v[92:95], v3 offset:8960
v_mfma_f32_16x16x32_bf16 v[196:199], v[64:67], v[36:39], v[196:199]
ds_read_b64_tr_b16 v[112:113], v9 offset:40960
v_mfma_f32_16x16x32_bf16 v[192:195], v[64:67], v[32:35], v[192:195]
ds_read_b64_tr_b16 v[114:115], v9 offset:45056
v_mfma_f32_16x16x32_bf16 v[144:147], v[52:55], v[32:35], v[144:147]
ds_read_b64_tr_b16 v[100:101], v10 offset:24576
v_mfma_f32_16x16x32_bf16 v[148:151], v[52:55], v[36:39], v[148:151]
ds_read_b64_tr_b16 v[102:103], v10 offset:28672
v_mfma_f32_16x16x32_bf16 v[152:155], v[52:55], v[40:43], v[152:155]
ds_read_b64_tr_b16 v[116:117], v10 offset:40960
v_mfma_f32_16x16x32_bf16 v[156:159], v[52:55], v[44:47], v[156:159]
ds_read_b64_tr_b16 v[118:119], v10 offset:45056
v_mfma_f32_16x16x32_bf16 v[220:223], v[68:71], v[44:47], v[220:223]
ds_read_b64_tr_b16 v[104:105], v11 offset:24576
v_mfma_f32_16x16x32_bf16 v[216:219], v[68:71], v[40:43], v[216:219]
ds_read_b64_tr_b16 v[106:107], v11 offset:28672
v_mfma_f32_16x16x32_bf16 v[212:215], v[68:71], v[36:39], v[212:215]
ds_read_b64_tr_b16 v[120:121], v11 offset:40960
v_mfma_f32_16x16x32_bf16 v[208:211], v[68:71], v[32:35], v[208:211]
ds_read_b64_tr_b16 v[122:123], v11 offset:45056
v_mfma_f32_16x16x32_bf16 v[160:163], v[56:59], v[32:35], v[160:163]
ds_read_b64_tr_b16 v[108:109], v12 offset:24576
v_mfma_f32_16x16x32_bf16 v[164:167], v[56:59], v[36:39], v[164:167]
ds_read_b64_tr_b16 v[110:111], v12 offset:28672
v_mfma_f32_16x16x32_bf16 v[168:171], v[56:59], v[40:43], v[168:171]
ds_read_b64_tr_b16 v[124:125], v12 offset:40960
v_mfma_f32_16x16x32_bf16 v[172:175], v[56:59], v[44:47], v[172:175]
ds_read_b64_tr_b16 v[126:127], v12 offset:45056
v_mfma_f32_16x16x32_bf16 v[236:239], v[72:75], v[44:47], v[236:239]
v_mfma_f32_16x16x32_bf16 v[232:235], v[72:75], v[40:43], v[232:235]
v_mfma_f32_16x16x32_bf16 v[228:231], v[72:75], v[36:39], v[228:231]
v_mfma_f32_16x16x32_bf16 v[224:227], v[72:75], v[32:35], v[224:227]
v_mfma_f32_16x16x32_bf16 v[176:179], v[60:63], v[32:35], v[176:179]
v_mfma_f32_16x16x32_bf16 v[180:183], v[60:63], v[36:39], v[180:183]
v_mfma_f32_16x16x32_bf16 v[184:187], v[60:63], v[40:43], v[184:187]
v_mfma_f32_16x16x32_bf16 v[188:191], v[60:63], v[44:47], v[188:191]
v_mfma_f32_16x16x32_bf16 v[252:255], v[76:79], v[44:47], v[252:255]
v_mfma_f32_16x16x32_bf16 v[248:251], v[76:79], v[40:43], v[248:251]
v_mfma_f32_16x16x32_bf16 v[244:247], v[76:79], v[36:39], v[244:247]
v_mfma_f32_16x16x32_bf16 v[240:243], v[76:79], v[32:35], v[240:243]
s_waitcnt lgkmcnt(0)
s_barrier
v_mfma_f32_16x16x32_bf16 v[128:131], v[96:99], v[80:83], v[128:131]
ds_read_b128 v[32:35], v4 offset:0
v_mfma_f32_16x16x32_bf16 v[132:135], v[96:99], v[84:87], v[132:135]
ds_read_b64_tr_b16 v[48:49], v13 offset:16384
v_mfma_f32_16x16x32_bf16 v[136:139], v[96:99], v[88:91], v[136:139]
ds_read_b64_tr_b16 v[50:51], v13 offset:20480
v_mfma_f32_16x16x32_bf16 v[140:143], v[96:99], v[92:95], v[140:143]
ds_read_b128 v[36:39], v4 offset:256
v_mfma_f32_16x16x32_bf16 v[204:207], v[112:115], v[92:95], v[204:207]
ds_read_b128 v[40:43], v4 offset:512
v_mfma_f32_16x16x32_bf16 v[200:203], v[112:115], v[88:91], v[200:203]
ds_read_b128 v[44:47], v4 offset:768
v_mfma_f32_16x16x32_bf16 v[196:199], v[112:115], v[84:87], v[196:199]
ds_read_b64_tr_b16 v[64:65], v13 offset:32768
v_mfma_f32_16x16x32_bf16 v[192:195], v[112:115], v[80:83], v[192:195]
ds_read_b64_tr_b16 v[66:67], v13 offset:36864
v_mfma_f32_16x16x32_bf16 v[144:147], v[100:103], v[80:83], v[144:147]
ds_read_b64_tr_b16 v[52:53], v14 offset:16384
v_mfma_f32_16x16x32_bf16 v[148:151], v[100:103], v[84:87], v[148:151]
ds_read_b64_tr_b16 v[54:55], v14 offset:20480
v_mfma_f32_16x16x32_bf16 v[152:155], v[100:103], v[88:91], v[152:155]
ds_read_b64_tr_b16 v[68:69], v14 offset:32768
v_mfma_f32_16x16x32_bf16 v[156:159], v[100:103], v[92:95], v[156:159]
ds_read_b64_tr_b16 v[70:71], v14 offset:36864
v_mfma_f32_16x16x32_bf16 v[220:223], v[116:119], v[92:95], v[220:223]
ds_read_b64_tr_b16 v[56:57], v15 offset:16384
v_mfma_f32_16x16x32_bf16 v[216:219], v[116:119], v[88:91], v[216:219]
ds_read_b64_tr_b16 v[58:59], v15 offset:20480
v_mfma_f32_16x16x32_bf16 v[212:215], v[116:119], v[84:87], v[212:215]
ds_read_b64_tr_b16 v[72:73], v15 offset:32768
v_mfma_f32_16x16x32_bf16 v[208:211], v[116:119], v[80:83], v[208:211]
ds_read_b64_tr_b16 v[74:75], v15 offset:36864
v_mfma_f32_16x16x32_bf16 v[160:163], v[104:107], v[80:83], v[160:163]
ds_read_b64_tr_b16 v[60:61], v16 offset:16384
v_mfma_f32_16x16x32_bf16 v[164:167], v[104:107], v[84:87], v[164:167]
ds_read_b64_tr_b16 v[62:63], v16 offset:20480
v_mfma_f32_16x16x32_bf16 v[168:171], v[104:107], v[88:91], v[168:171]
ds_read_b64_tr_b16 v[76:77], v16 offset:32768
v_mfma_f32_16x16x32_bf16 v[172:175], v[104:107], v[92:95], v[172:175]
ds_read_b64_tr_b16 v[78:79], v16 offset:36864
v_mfma_f32_16x16x32_bf16 v[236:239], v[120:123], v[92:95], v[236:239]
v_mfma_f32_16x16x32_bf16 v[232:235], v[120:123], v[88:91], v[232:235]
v_mfma_f32_16x16x32_bf16 v[228:231], v[120:123], v[84:87], v[228:231]
v_mfma_f32_16x16x32_bf16 v[224:227], v[120:123], v[80:83], v[224:227]
v_mfma_f32_16x16x32_bf16 v[176:179], v[108:111], v[80:83], v[176:179]
v_mfma_f32_16x16x32_bf16 v[180:183], v[108:111], v[84:87], v[180:183]
v_mfma_f32_16x16x32_bf16 v[184:187], v[108:111], v[88:91], v[184:187]
v_mfma_f32_16x16x32_bf16 v[188:191], v[108:111], v[92:95], v[188:191]
v_mfma_f32_16x16x32_bf16 v[252:255], v[124:127], v[92:95], v[252:255]
v_mfma_f32_16x16x32_bf16 v[248:251], v[124:127], v[88:91], v[248:251]
v_mfma_f32_16x16x32_bf16 v[244:247], v[124:127], v[84:87], v[244:247]
v_mfma_f32_16x16x32_bf16 v[240:243], v[124:127], v[80:83], v[240:243]
s_waitcnt lgkmcnt(0)
v_mfma_f32_16x16x32_bf16 v[128:131], v[48:51], v[32:35], v[128:131]
ds_read_b128 v[80:83], v4 offset:8192
v_mfma_f32_16x16x32_bf16 v[132:135], v[48:51], v[36:39], v[132:135]
ds_read_b64_tr_b16 v[96:97], v13 offset:24576
v_mfma_f32_16x16x32_bf16 v[136:139], v[48:51], v[40:43], v[136:139]
ds_read_b64_tr_b16 v[98:99], v13 offset:28672
v_mfma_f32_16x16x32_bf16 v[140:143], v[48:51], v[44:47], v[140:143]
ds_read_b128 v[84:87], v4 offset:8448
v_mfma_f32_16x16x32_bf16 v[204:207], v[64:67], v[44:47], v[204:207]
ds_read_b128 v[88:91], v4 offset:8704
v_mfma_f32_16x16x32_bf16 v[200:203], v[64:67], v[40:43], v[200:203]
ds_read_b128 v[92:95], v4 offset:8960
v_mfma_f32_16x16x32_bf16 v[196:199], v[64:67], v[36:39], v[196:199]
ds_read_b64_tr_b16 v[112:113], v13 offset:40960
v_mfma_f32_16x16x32_bf16 v[192:195], v[64:67], v[32:35], v[192:195]
ds_read_b64_tr_b16 v[114:115], v13 offset:45056
v_mfma_f32_16x16x32_bf16 v[144:147], v[52:55], v[32:35], v[144:147]
ds_read_b64_tr_b16 v[100:101], v14 offset:24576
v_mfma_f32_16x16x32_bf16 v[148:151], v[52:55], v[36:39], v[148:151]
ds_read_b64_tr_b16 v[102:103], v14 offset:28672
v_mfma_f32_16x16x32_bf16 v[152:155], v[52:55], v[40:43], v[152:155]
ds_read_b64_tr_b16 v[116:117], v14 offset:40960
v_mfma_f32_16x16x32_bf16 v[156:159], v[52:55], v[44:47], v[156:159]
ds_read_b64_tr_b16 v[118:119], v14 offset:45056
v_mfma_f32_16x16x32_bf16 v[220:223], v[68:71], v[44:47], v[220:223]
ds_read_b64_tr_b16 v[104:105], v15 offset:24576
v_mfma_f32_16x16x32_bf16 v[216:219], v[68:71], v[40:43], v[216:219]
ds_read_b64_tr_b16 v[106:107], v15 offset:28672
v_mfma_f32_16x16x32_bf16 v[212:215], v[68:71], v[36:39], v[212:215]
ds_read_b64_tr_b16 v[120:121], v15 offset:40960
v_mfma_f32_16x16x32_bf16 v[208:211], v[68:71], v[32:35], v[208:211]
ds_read_b64_tr_b16 v[122:123], v15 offset:45056
v_mfma_f32_16x16x32_bf16 v[160:163], v[56:59], v[32:35], v[160:163]
ds_read_b64_tr_b16 v[108:109], v16 offset:24576
v_mfma_f32_16x16x32_bf16 v[164:167], v[56:59], v[36:39], v[164:167]
ds_read_b64_tr_b16 v[110:111], v16 offset:28672
v_mfma_f32_16x16x32_bf16 v[168:171], v[56:59], v[40:43], v[168:171]
ds_read_b64_tr_b16 v[124:125], v16 offset:40960
v_mfma_f32_16x16x32_bf16 v[172:175], v[56:59], v[44:47], v[172:175]
ds_read_b64_tr_b16 v[126:127], v16 offset:45056
v_mfma_f32_16x16x32_bf16 v[236:239], v[72:75], v[44:47], v[236:239]
v_mfma_f32_16x16x32_bf16 v[232:235], v[72:75], v[40:43], v[232:235]
v_mfma_f32_16x16x32_bf16 v[228:231], v[72:75], v[36:39], v[228:231]
v_mfma_f32_16x16x32_bf16 v[224:227], v[72:75], v[32:35], v[224:227]
v_mfma_f32_16x16x32_bf16 v[176:179], v[60:63], v[32:35], v[176:179]
v_mfma_f32_16x16x32_bf16 v[180:183], v[60:63], v[36:39], v[180:183]
v_mfma_f32_16x16x32_bf16 v[184:187], v[60:63], v[40:43], v[184:187]
v_mfma_f32_16x16x32_bf16 v[188:191], v[60:63], v[44:47], v[188:191]
v_mfma_f32_16x16x32_bf16 v[252:255], v[76:79], v[44:47], v[252:255]
v_mfma_f32_16x16x32_bf16 v[248:251], v[76:79], v[40:43], v[248:251]
v_mfma_f32_16x16x32_bf16 v[244:247], v[76:79], v[36:39], v[244:247]
v_mfma_f32_16x16x32_bf16 v[240:243], v[76:79], v[32:35], v[240:243]
s_waitcnt lgkmcnt(0)
s_barrier
v_mfma_f32_16x16x32_bf16 v[128:131], v[96:99], v[80:83], v[128:131]
ds_read_b128 v[32:35], v2 offset:0
v_mfma_f32_16x16x32_bf16 v[132:135], v[96:99], v[84:87], v[132:135]
ds_read_b64_tr_b16 v[48:49], v5 offset:16384
v_mfma_f32_16x16x32_bf16 v[136:139], v[96:99], v[88:91], v[136:139]
ds_read_b64_tr_b16 v[50:51], v5 offset:20480
v_mfma_f32_16x16x32_bf16 v[140:143], v[96:99], v[92:95], v[140:143]
ds_read_b128 v[36:39], v2 offset:256
v_mfma_f32_16x16x32_bf16 v[204:207], v[112:115], v[92:95], v[204:207]
ds_read_b128 v[40:43], v2 offset:512
v_mfma_f32_16x16x32_bf16 v[200:203], v[112:115], v[88:91], v[200:203]
ds_read_b128 v[44:47], v2 offset:768
v_mfma_f32_16x16x32_bf16 v[196:199], v[112:115], v[84:87], v[196:199]
ds_read_b64_tr_b16 v[64:65], v5 offset:32768
v_mfma_f32_16x16x32_bf16 v[192:195], v[112:115], v[80:83], v[192:195]
ds_read_b64_tr_b16 v[66:67], v5 offset:36864
v_mfma_f32_16x16x32_bf16 v[144:147], v[100:103], v[80:83], v[144:147]
ds_read_b64_tr_b16 v[52:53], v6 offset:16384
v_mfma_f32_16x16x32_bf16 v[148:151], v[100:103], v[84:87], v[148:151]
ds_read_b64_tr_b16 v[54:55], v6 offset:20480
v_mfma_f32_16x16x32_bf16 v[152:155], v[100:103], v[88:91], v[152:155]
ds_read_b64_tr_b16 v[68:69], v6 offset:32768
v_mfma_f32_16x16x32_bf16 v[156:159], v[100:103], v[92:95], v[156:159]
ds_read_b64_tr_b16 v[70:71], v6 offset:36864
v_mfma_f32_16x16x32_bf16 v[220:223], v[116:119], v[92:95], v[220:223]
ds_read_b64_tr_b16 v[56:57], v7 offset:16384
v_mfma_f32_16x16x32_bf16 v[216:219], v[116:119], v[88:91], v[216:219]
ds_read_b64_tr_b16 v[58:59], v7 offset:20480
v_mfma_f32_16x16x32_bf16 v[212:215], v[116:119], v[84:87], v[212:215]
ds_read_b64_tr_b16 v[72:73], v7 offset:32768
v_mfma_f32_16x16x32_bf16 v[208:211], v[116:119], v[80:83], v[208:211]
ds_read_b64_tr_b16 v[74:75], v7 offset:36864
v_mfma_f32_16x16x32_bf16 v[160:163], v[104:107], v[80:83], v[160:163]
ds_read_b64_tr_b16 v[60:61], v8 offset:16384
v_mfma_f32_16x16x32_bf16 v[164:167], v[104:107], v[84:87], v[164:167]
ds_read_b64_tr_b16 v[62:63], v8 offset:20480
v_mfma_f32_16x16x32_bf16 v[168:171], v[104:107], v[88:91], v[168:171]
ds_read_b64_tr_b16 v[76:77], v8 offset:32768
v_mfma_f32_16x16x32_bf16 v[172:175], v[104:107], v[92:95], v[172:175]
ds_read_b64_tr_b16 v[78:79], v8 offset:36864
v_mfma_f32_16x16x32_bf16 v[236:239], v[120:123], v[92:95], v[236:239]
v_mfma_f32_16x16x32_bf16 v[232:235], v[120:123], v[88:91], v[232:235]
v_mfma_f32_16x16x32_bf16 v[228:231], v[120:123], v[84:87], v[228:231]
v_mfma_f32_16x16x32_bf16 v[224:227], v[120:123], v[80:83], v[224:227]
v_mfma_f32_16x16x32_bf16 v[176:179], v[108:111], v[80:83], v[176:179]
v_mfma_f32_16x16x32_bf16 v[180:183], v[108:111], v[84:87], v[180:183]
v_mfma_f32_16x16x32_bf16 v[184:187], v[108:111], v[88:91], v[184:187]
v_mfma_f32_16x16x32_bf16 v[188:191], v[108:111], v[92:95], v[188:191]
v_mfma_f32_16x16x32_bf16 v[252:255], v[124:127], v[92:95], v[252:255]
v_mfma_f32_16x16x32_bf16 v[248:251], v[124:127], v[88:91], v[248:251]
v_mfma_f32_16x16x32_bf16 v[244:247], v[124:127], v[84:87], v[244:247]
v_mfma_f32_16x16x32_bf16 v[240:243], v[124:127], v[80:83], v[240:243]
s_waitcnt lgkmcnt(0)
v_mfma_f32_16x16x32_bf16 v[128:131], v[48:51], v[32:35], v[128:131]
ds_read_b128 v[80:83], v2 offset:8192
v_mfma_f32_16x16x32_bf16 v[132:135], v[48:51], v[36:39], v[132:135]
ds_read_b64_tr_b16 v[96:97], v5 offset:24576
v_mfma_f32_16x16x32_bf16 v[136:139], v[48:51], v[40:43], v[136:139]
ds_read_b64_tr_b16 v[98:99], v5 offset:28672
v_mfma_f32_16x16x32_bf16 v[140:143], v[48:51], v[44:47], v[140:143]
ds_read_b128 v[84:87], v2 offset:8448
v_mfma_f32_16x16x32_bf16 v[204:207], v[64:67], v[44:47], v[204:207]
ds_read_b128 v[88:91], v2 offset:8704
v_mfma_f32_16x16x32_bf16 v[200:203], v[64:67], v[40:43], v[200:203]
ds_read_b128 v[92:95], v2 offset:8960
v_mfma_f32_16x16x32_bf16 v[196:199], v[64:67], v[36:39], v[196:199]
ds_read_b64_tr_b16 v[112:113], v5 offset:40960
v_mfma_f32_16x16x32_bf16 v[192:195], v[64:67], v[32:35], v[192:195]
ds_read_b64_tr_b16 v[114:115], v5 offset:45056
v_mfma_f32_16x16x32_bf16 v[144:147], v[52:55], v[32:35], v[144:147]
ds_read_b64_tr_b16 v[100:101], v6 offset:24576
v_mfma_f32_16x16x32_bf16 v[148:151], v[52:55], v[36:39], v[148:151]
ds_read_b64_tr_b16 v[102:103], v6 offset:28672
v_mfma_f32_16x16x32_bf16 v[152:155], v[52:55], v[40:43], v[152:155]
ds_read_b64_tr_b16 v[116:117], v6 offset:40960
v_mfma_f32_16x16x32_bf16 v[156:159], v[52:55], v[44:47], v[156:159]
ds_read_b64_tr_b16 v[118:119], v6 offset:45056
v_mfma_f32_16x16x32_bf16 v[220:223], v[68:71], v[44:47], v[220:223]
ds_read_b64_tr_b16 v[104:105], v7 offset:24576
v_mfma_f32_16x16x32_bf16 v[216:219], v[68:71], v[40:43], v[216:219]
ds_read_b64_tr_b16 v[106:107], v7 offset:28672
v_mfma_f32_16x16x32_bf16 v[212:215], v[68:71], v[36:39], v[212:215]
ds_read_b64_tr_b16 v[120:121], v7 offset:40960
v_mfma_f32_16x16x32_bf16 v[208:211], v[68:71], v[32:35], v[208:211]
ds_read_b64_tr_b16 v[122:123], v7 offset:45056
v_mfma_f32_16x16x32_bf16 v[160:163], v[56:59], v[32:35], v[160:163]
ds_read_b64_tr_b16 v[108:109], v8 offset:24576
v_mfma_f32_16x16x32_bf16 v[164:167], v[56:59], v[36:39], v[164:167]
ds_read_b64_tr_b16 v[110:111], v8 offset:28672
v_mfma_f32_16x16x32_bf16 v[168:171], v[56:59], v[40:43], v[168:171]
ds_read_b64_tr_b16 v[124:125], v8 offset:40960
v_mfma_f32_16x16x32_bf16 v[172:175], v[56:59], v[44:47], v[172:175]
ds_read_b64_tr_b16 v[126:127], v8 offset:45056
v_mfma_f32_16x16x32_bf16 v[236:239], v[72:75], v[44:47], v[236:239]
v_mfma_f32_16x16x32_bf16 v[232:235], v[72:75], v[40:43], v[232:235]
v_mfma_f32_16x16x32_bf16 v[228:231], v[72:75], v[36:39], v[228:231]
v_mfma_f32_16x16x32_bf16 v[224:227], v[72:75], v[32:35], v[224:227]
v_mfma_f32_16x16x32_bf16 v[176:179], v[60:63], v[32:35], v[176:179]
v_mfma_f32_16x16x32_bf16 v[180:183], v[60:63], v[36:39], v[180:183]
v_mfma_f32_16x16x32_bf16 v[184:187], v[60:63], v[40:43], v[184:187]
v_mfma_f32_16x16x32_bf16 v[188:191], v[60:63], v[44:47], v[188:191]
v_mfma_f32_16x16x32_bf16 v[252:255], v[76:79], v[44:47], v[252:255]
v_mfma_f32_16x16x32_bf16 v[248:251], v[76:79], v[40:43], v[248:251]
v_mfma_f32_16x16x32_bf16 v[244:247], v[76:79], v[36:39], v[244:247]
v_mfma_f32_16x16x32_bf16 v[240:243], v[76:79], v[32:35], v[240:243]
s_waitcnt lgkmcnt(0)
s_barrier
v_mfma_f32_16x16x32_bf16 v[128:131], v[96:99], v[80:83], v[128:131]
ds_read_b128 v[32:35], v3 offset:0
v_mfma_f32_16x16x32_bf16 v[132:135], v[96:99], v[84:87], v[132:135]
ds_read_b64_tr_b16 v[48:49], v9 offset:16384
v_mfma_f32_16x16x32_bf16 v[136:139], v[96:99], v[88:91], v[136:139]
ds_read_b64_tr_b16 v[50:51], v9 offset:20480
v_mfma_f32_16x16x32_bf16 v[140:143], v[96:99], v[92:95], v[140:143]
ds_read_b128 v[36:39], v3 offset:256
v_mfma_f32_16x16x32_bf16 v[204:207], v[112:115], v[92:95], v[204:207]
ds_read_b128 v[40:43], v3 offset:512
v_mfma_f32_16x16x32_bf16 v[200:203], v[112:115], v[88:91], v[200:203]
ds_read_b128 v[44:47], v3 offset:768
v_mfma_f32_16x16x32_bf16 v[196:199], v[112:115], v[84:87], v[196:199]
ds_read_b64_tr_b16 v[64:65], v9 offset:32768
v_mfma_f32_16x16x32_bf16 v[192:195], v[112:115], v[80:83], v[192:195]
ds_read_b64_tr_b16 v[66:67], v9 offset:36864
v_mfma_f32_16x16x32_bf16 v[144:147], v[100:103], v[80:83], v[144:147]
ds_read_b64_tr_b16 v[52:53], v10 offset:16384
v_mfma_f32_16x16x32_bf16 v[148:151], v[100:103], v[84:87], v[148:151]
ds_read_b64_tr_b16 v[54:55], v10 offset:20480
v_mfma_f32_16x16x32_bf16 v[152:155], v[100:103], v[88:91], v[152:155]
ds_read_b64_tr_b16 v[68:69], v10 offset:32768
v_mfma_f32_16x16x32_bf16 v[156:159], v[100:103], v[92:95], v[156:159]
ds_read_b64_tr_b16 v[70:71], v10 offset:36864
v_mfma_f32_16x16x32_bf16 v[220:223], v[116:119], v[92:95], v[220:223]
ds_read_b64_tr_b16 v[56:57], v11 offset:16384
v_mfma_f32_16x16x32_bf16 v[216:219], v[116:119], v[88:91], v[216:219]
ds_read_b64_tr_b16 v[58:59], v11 offset:20480
v_mfma_f32_16x16x32_bf16 v[212:215], v[116:119], v[84:87], v[212:215]
ds_read_b64_tr_b16 v[72:73], v11 offset:32768
v_mfma_f32_16x16x32_bf16 v[208:211], v[116:119], v[80:83], v[208:211]
ds_read_b64_tr_b16 v[74:75], v11 offset:36864
v_mfma_f32_16x16x32_bf16 v[160:163], v[104:107], v[80:83], v[160:163]
ds_read_b64_tr_b16 v[60:61], v12 offset:16384
v_mfma_f32_16x16x32_bf16 v[164:167], v[104:107], v[84:87], v[164:167]
ds_read_b64_tr_b16 v[62:63], v12 offset:20480
v_mfma_f32_16x16x32_bf16 v[168:171], v[104:107], v[88:91], v[168:171]
ds_read_b64_tr_b16 v[76:77], v12 offset:32768
v_mfma_f32_16x16x32_bf16 v[172:175], v[104:107], v[92:95], v[172:175]
ds_read_b64_tr_b16 v[78:79], v12 offset:36864
v_mfma_f32_16x16x32_bf16 v[236:239], v[120:123], v[92:95], v[236:239]
v_mfma_f32_16x16x32_bf16 v[232:235], v[120:123], v[88:91], v[232:235]
v_mfma_f32_16x16x32_bf16 v[228:231], v[120:123], v[84:87], v[228:231]
v_mfma_f32_16x16x32_bf16 v[224:227], v[120:123], v[80:83], v[224:227]
v_mfma_f32_16x16x32_bf16 v[176:179], v[108:111], v[80:83], v[176:179]
v_mfma_f32_16x16x32_bf16 v[180:183], v[108:111], v[84:87], v[180:183]
v_mfma_f32_16x16x32_bf16 v[184:187], v[108:111], v[88:91], v[184:187]
v_mfma_f32_16x16x32_bf16 v[188:191], v[108:111], v[92:95], v[188:191]
v_mfma_f32_16x16x32_bf16 v[252:255], v[124:127], v[92:95], v[252:255]
v_mfma_f32_16x16x32_bf16 v[248:251], v[124:127], v[88:91], v[248:251]
v_mfma_f32_16x16x32_bf16 v[244:247], v[124:127], v[84:87], v[244:247]
v_mfma_f32_16x16x32_bf16 v[240:243], v[124:127], v[80:83], v[240:243]
s_sub_u32 s41, s41, 1
s_cmp_lg_u32 s41, 0
s_cbranch_scc1 Lk3_123
s_waitcnt lgkmcnt(0)
v_mfma_f32_16x16x32_bf16 v[128:131], v[48:51], v[32:35], v[128:131]
ds_read_b128 v[80:83], v3 offset:8192
v_mfma_f32_16x16x32_bf16 v[132:135], v[48:51], v[36:39], v[132:135]
ds_read_b64_tr_b16 v[96:97], v9 offset:24576
v_mfma_f32_16x16x32_bf16 v[136:139], v[48:51], v[40:43], v[136:139]
ds_read_b64_tr_b16 v[98:99], v9 offset:28672
v_mfma_f32_16x16x32_bf16 v[140:143], v[48:51], v[44:47], v[140:143]
ds_read_b128 v[84:87], v3 offset:8448
v_mfma_f32_16x16x32_bf16 v[204:207], v[64:67], v[44:47], v[204:207]
ds_read_b128 v[88:91], v3 offset:8704
v_mfma_f32_16x16x32_bf16 v[200:203], v[64:67], v[40:43], v[200:203]
ds_read_b128 v[92:95], v3 offset:8960
v_mfma_f32_16x16x32_bf16 v[196:199], v[64:67], v[36:39], v[196:199]
ds_read_b64_tr_b16 v[112:113], v9 offset:40960
v_mfma_f32_16x16x32_bf16 v[192:195], v[64:67], v[32:35], v[192:195]
ds_read_b64_tr_b16 v[114:115], v9 offset:45056
v_mfma_f32_16x16x32_bf16 v[144:147], v[52:55], v[32:35], v[144:147]
ds_read_b64_tr_b16 v[100:101], v10 offset:24576
v_mfma_f32_16x16x32_bf16 v[148:151], v[52:55], v[36:39], v[148:151]
ds_read_b64_tr_b16 v[102:103], v10 offset:28672
v_mfma_f32_16x16x32_bf16 v[152:155], v[52:55], v[40:43], v[152:155]
ds_read_b64_tr_b16 v[116:117], v10 offset:40960
v_mfma_f32_16x16x32_bf16 v[156:159], v[52:55], v[44:47], v[156:159]
ds_read_b64_tr_b16 v[118:119], v10 offset:45056
v_mfma_f32_16x16x32_bf16 v[220:223], v[68:71], v[44:47], v[220:223]
ds_read_b64_tr_b16 v[104:105], v11 offset:24576
v_mfma_f32_16x16x32_bf16 v[216:219], v[68:71], v[40:43], v[216:219]
ds_read_b64_tr_b16 v[106:107], v11 offset:28672
v_mfma_f32_16x16x32_bf16 v[212:215], v[68:71], v[36:39], v[212:215]
ds_read_b64_tr_b16 v[120:121], v11 offset:40960
v_mfma_f32_16x16x32_bf16 v[208:211], v[68:71], v[32:35], v[208:211]
ds_read_b64_tr_b16 v[122:123], v11 offset:45056
v_mfma_f32_16x16x32_bf16 v[160:163], v[56:59], v[32:35], v[160:163]
ds_read_b64_tr_b16 v[108:109], v12 offset:24576
v_mfma_f32_16x16x32_bf16 v[164:167], v[56:59], v[36:39], v[164:167]
ds_read_b64_tr_b16 v[110:111], v12 offset:28672
v_mfma_f32_16x16x32_bf16 v[168:171], v[56:59], v[40:43], v[168:171]
ds_read_b64_tr_b16 v[124:125], v12 offset:40960
v_mfma_f32_16x16x32_bf16 v[172:175], v[56:59], v[44:47], v[172:175]
ds_read_b64_tr_b16 v[126:127], v12 offset:45056
v_mfma_f32_16x16x32_bf16 v[236:239], v[72:75], v[44:47], v[236:239]
v_mfma_f32_16x16x32_bf16 v[232:235], v[72:75], v[40:43], v[232:235]
v_mfma_f32_16x16x32_bf16 v[228:231], v[72:75], v[36:39], v[228:231]
v_mfma_f32_16x16x32_bf16 v[224:227], v[72:75], v[32:35], v[224:227]
v_mfma_f32_16x16x32_bf16 v[176:179], v[60:63], v[32:35], v[176:179]
v_mfma_f32_16x16x32_bf16 v[180:183], v[60:63], v[36:39], v[180:183]
v_mfma_f32_16x16x32_bf16 v[184:187], v[60:63], v[40:43], v[184:187]
v_mfma_f32_16x16x32_bf16 v[188:191], v[60:63], v[44:47], v[188:191]
v_mfma_f32_16x16x32_bf16 v[252:255], v[76:79], v[44:47], v[252:255]
v_mfma_f32_16x16x32_bf16 v[248:251], v[76:79], v[40:43], v[248:251]
v_mfma_f32_16x16x32_bf16 v[244:247], v[76:79], v[36:39], v[244:247]
v_mfma_f32_16x16x32_bf16 v[240:243], v[76:79], v[32:35], v[240:243]
s_waitcnt lgkmcnt(0)
s_barrier
v_mfma_f32_16x16x32_bf16 v[128:131], v[96:99], v[80:83], v[128:131]
ds_read_b128 v[32:35], v4 offset:0
v_mfma_f32_16x16x32_bf16 v[132:135], v[96:99], v[84:87], v[132:135]
ds_read_b64_tr_b16 v[48:49], v13 offset:16384
v_mfma_f32_16x16x32_bf16 v[136:139], v[96:99], v[88:91], v[136:139]
ds_read_b64_tr_b16 v[50:51], v13 offset:20480
v_mfma_f32_16x16x32_bf16 v[140:143], v[96:99], v[92:95], v[140:143]
ds_read_b128 v[36:39], v4 offset:256
v_mfma_f32_16x16x32_bf16 v[204:207], v[112:115], v[92:95], v[204:207]
ds_read_b128 v[40:43], v4 offset:512
v_mfma_f32_16x16x32_bf16 v[200:203], v[112:115], v[88:91], v[200:203]
ds_read_b128 v[44:47], v4 offset:768
v_mfma_f32_16x16x32_bf16 v[196:199], v[112:115], v[84:87], v[196:199]
ds_read_b64_tr_b16 v[64:65], v13 offset:32768
v_mfma_f32_16x16x32_bf16 v[192:195], v[112:115], v[80:83], v[192:195]
ds_read_b64_tr_b16 v[66:67], v13 offset:36864
v_mfma_f32_16x16x32_bf16 v[144:147], v[100:103], v[80:83], v[144:147]
ds_read_b64_tr_b16 v[52:53], v14 offset:16384
v_mfma_f32_16x16x32_bf16 v[148:151], v[100:103], v[84:87], v[148:151]
ds_read_b64_tr_b16 v[54:55], v14 offset:20480
v_mfma_f32_16x16x32_bf16 v[152:155], v[100:103], v[88:91], v[152:155]
ds_read_b64_tr_b16 v[68:69], v14 offset:32768
v_mfma_f32_16x16x32_bf16 v[156:159], v[100:103], v[92:95], v[156:159]
ds_read_b64_tr_b16 v[70:71], v14 offset:36864
v_mfma_f32_16x16x32_bf16 v[220:223], v[116:119], v[92:95], v[220:223]
ds_read_b64_tr_b16 v[56:57], v15 offset:16384
v_mfma_f32_16x16x32_bf16 v[216:219], v[116:119], v[88:91], v[216:219]
ds_read_b64_tr_b16 v[58:59], v15 offset:20480
v_mfma_f32_16x16x32_bf16 v[212:215], v[116:119], v[84:87], v[212:215]
ds_read_b64_tr_b16 v[72:73], v15 offset:32768
v_mfma_f32_16x16x32_bf16 v[208:211], v[116:119], v[80:83], v[208:211]
ds_read_b64_tr_b16 v[74:75], v15 offset:36864
v_mfma_f32_16x16x32_bf16 v[160:163], v[104:107], v[80:83], v[160:163]
ds_read_b64_tr_b16 v[60:61], v16 offset:16384
v_mfma_f32_16x16x32_bf16 v[164:167], v[104:107], v[84:87], v[164:167]
ds_read_b64_tr_b16 v[62:63], v16 offset:20480
v_mfma_f32_16x16x32_bf16 v[168:171], v[104:107], v[88:91], v[168:171]
ds_read_b64_tr_b16 v[76:77], v16 offset:32768
v_mfma_f32_16x16x32_bf16 v[172:175], v[104:107], v[92:95], v[172:175]
ds_read_b64_tr_b16 v[78:79], v16 offset:36864
v_mfma_f32_16x16x32_bf16 v[236:239], v[120:123], v[92:95], v[236:239]
v_mfma_f32_16x16x32_bf16 v[232:235], v[120:123], v[88:91], v[232:235]
v_mfma_f32_16x16x32_bf16 v[228:231], v[120:123], v[84:87], v[228:231]
v_mfma_f32_16x16x32_bf16 v[224:227], v[120:123], v[80:83], v[224:227]
v_mfma_f32_16x16x32_bf16 v[176:179], v[108:111], v[80:83], v[176:179]
v_mfma_f32_16x16x32_bf16 v[180:183], v[108:111], v[84:87], v[180:183]
v_mfma_f32_16x16x32_bf16 v[184:187], v[108:111], v[88:91], v[184:187]
v_mfma_f32_16x16x32_bf16 v[188:191], v[108:111], v[92:95], v[188:191]
v_mfma_f32_16x16x32_bf16 v[252:255], v[124:127], v[92:95], v[252:255]
v_mfma_f32_16x16x32_bf16 v[248:251], v[124:127], v[88:91], v[248:251]
v_mfma_f32_16x16x32_bf16 v[244:247], v[124:127], v[84:87], v[244:247]
v_mfma_f32_16x16x32_bf16 v[240:243], v[124:127], v[80:83], v[240:243]
s_waitcnt lgkmcnt(0)
v_mfma_f32_16x16x32_bf16 v[128:131], v[48:51], v[32:35], v[128:131]
ds_read_b128 v[80:83], v4 offset:8192
v_mfma_f32_16x16x32_bf16 v[132:135], v[48:51], v[36:39], v[132:135]
ds_read_b64_tr_b16 v[96:97], v13 offset:24576
v_mfma_f32_16x16x32_bf16 v[136:139], v[48:51], v[40:43], v[136:139]
ds_read_b64_tr_b16 v[98:99], v13 offset:28672
v_mfma_f32_16x16x32_bf16 v[140:143], v[48:51], v[44:47], v[140:143]
ds_read_b128 v[84:87], v4 offset:8448
v_mfma_f32_16x16x32_bf16 v[204:207], v[64:67], v[44:47], v[204:207]
ds_read_b128 v[88:91], v4 offset:8704
v_mfma_f32_16x16x32_bf16 v[200:203], v[64:67], v[40:43], v[200:203]
ds_read_b128 v[92:95], v4 offset:8960
v_mfma_f32_16x16x32_bf16 v[196:199], v[64:67], v[36:39], v[196:199]
ds_read_b64_tr_b16 v[112:113], v13 offset:40960
v_mfma_f32_16x16x32_bf16 v[192:195], v[64:67], v[32:35], v[192:195]
ds_read_b64_tr_b16 v[114:115], v13 offset:45056
v_mfma_f32_16x16x32_bf16 v[144:147], v[52:55], v[32:35], v[144:147]
ds_read_b64_tr_b16 v[100:101], v14 offset:24576
v_mfma_f32_16x16x32_bf16 v[148:151], v[52:55], v[36:39], v[148:151]
ds_read_b64_tr_b16 v[102:103], v14 offset:28672
v_mfma_f32_16x16x32_bf16 v[152:155], v[52:55], v[40:43], v[152:155]
ds_read_b64_tr_b16 v[116:117], v14 offset:40960
v_mfma_f32_16x16x32_bf16 v[156:159], v[52:55], v[44:47], v[156:159]
ds_read_b64_tr_b16 v[118:119], v14 offset:45056
v_mfma_f32_16x16x32_bf16 v[220:223], v[68:71], v[44:47], v[220:223]
ds_read_b64_tr_b16 v[104:105], v15 offset:24576
v_mfma_f32_16x16x32_bf16 v[216:219], v[68:71], v[40:43], v[216:219]
ds_read_b64_tr_b16 v[106:107], v15 offset:28672
v_mfma_f32_16x16x32_bf16 v[212:215], v[68:71], v[36:39], v[212:215]
ds_read_b64_tr_b16 v[120:121], v15 offset:40960
v_mfma_f32_16x16x32_bf16 v[208:211], v[68:71], v[32:35], v[208:211]
ds_read_b64_tr_b16 v[122:123], v15 offset:45056
v_mfma_f32_16x16x32_bf16 v[160:163], v[56:59], v[32:35], v[160:163]
ds_read_b64_tr_b16 v[108:109], v16 offset:24576
v_mfma_f32_16x16x32_bf16 v[164:167], v[56:59], v[36:39], v[164:167]
ds_read_b64_tr_b16 v[110:111], v16 offset:28672
v_mfma_f32_16x16x32_bf16 v[168:171], v[56:59], v[40:43], v[168:171]
ds_read_b64_tr_b16 v[124:125], v16 offset:40960
v_mfma_f32_16x16x32_bf16 v[172:175], v[56:59], v[44:47], v[172:175]
ds_read_b64_tr_b16 v[126:127], v16 offset:45056
v_mfma_f32_16x16x32_bf16 v[236:239], v[72:75], v[44:47], v[236:239]
v_mfma_f32_16x16x32_bf16 v[232:235], v[72:75], v[40:43], v[232:235]
v_mfma_f32_16x16x32_bf16 v[228:231], v[72:75], v[36:39], v[228:231]
v_mfma_f32_16x16x32_bf16 v[224:227], v[72:75], v[32:35], v[224:227]
v_mfma_f32_16x16x32_bf16 v[176:179], v[60:63], v[32:35], v[176:179]
v_mfma_f32_16x16x32_bf16 v[180:183], v[60:63], v[36:39], v[180:183]
v_mfma_f32_16x16x32_bf16 v[184:187], v[60:63], v[40:43], v[184:187]
v_mfma_f32_16x16x32_bf16 v[188:191], v[60:63], v[44:47], v[188:191]
v_mfma_f32_16x16x32_bf16 v[252:255], v[76:79], v[44:47], v[252:255]
v_mfma_f32_16x16x32_bf16 v[248:251], v[76:79], v[40:43], v[248:251]
v_mfma_f32_16x16x32_bf16 v[244:247], v[76:79], v[36:39], v[244:247]
v_mfma_f32_16x16x32_bf16 v[240:243], v[76:79], v[32:35], v[240:243]
s_waitcnt lgkmcnt(0)
s_barrier
s_cmp_eq_u32 s36, 3
s_cbranch_scc1 L3h_124
s_add_u32 s42, s42, 1
s_and_b32 s42, s42, 15
s_add_u32 m0, s39, 98304
s_mul_i32 s37, s42, s40
buffer_load_dwordx4 v22, s[8:11], s37 offen sc1 lds
v_mfma_f32_16x16x32_bf16 v[128:131], v[96:99], v[80:83], v[128:131]
s_lshl_b32 s43, s46, 9
v_mfma_f32_16x16x32_bf16 v[132:135], v[96:99], v[84:87], v[132:135]
s_add_u32 s43, s43, 147456
s_add_u32 m0, s39, 99328
s_add_u32 s37, s37, s38
buffer_load_dwordx4 v23, s[8:11], s37 offen sc1 lds
v_mfma_f32_16x16x32_bf16 v[136:139], v[96:99], v[88:91], v[136:139]
v_lshl_add_u32 v19, v17, 3, s43
v_mfma_f32_16x16x32_bf16 v[140:143], v[96:99], v[92:95], v[140:143]
s_add_u32 m0, s39, 100352
s_add_u32 s37, s37, s38
buffer_load_dwordx4 v22, s[8:11], s37 offen sc1 lds
ds_read_b64 v[2:3], v19 offset:0
v_mfma_f32_16x16x32_bf16 v[204:207], v[112:115], v[92:95], v[204:207]
ds_read_b64 v[4:5], v19 offset:128
s_add_u32 m0, s39, 101376
s_add_u32 s37, s37, s38
buffer_load_dwordx4 v23, s[8:11], s37 offen sc1 lds
v_mfma_f32_16x16x32_bf16 v[200:203], v[112:115], v[88:91], v[200:203]
ds_read_b64 v[6:7], v19 offset:256
v_mfma_f32_16x16x32_bf16 v[196:199], v[112:115], v[84:87], v[196:199]
s_add_u32 m0, s39, 102400
s_add_u32 s37, s37, s38
buffer_load_dwordx4 v22, s[8:11], s37 offen sc1 lds
ds_read_b64 v[8:9], v19 offset:384
v_mfma_f32_16x16x32_bf16 v[192:195], v[112:115], v[80:83], v[192:195]
s_mul_i32 s43, s47, 256
s_add_u32 m0, s39, 103424
s_add_u32 s37, s37, s38
buffer_load_dwordx4 v23, s[8:11], s37 offen sc1 lds
v_mfma_f32_16x16x32_bf16 v[144:147], v[100:103], v[80:83], v[144:147]
s_add_u32 s43, s43, 148480
v_mfma_f32_16x16x32_bf16 v[148:151], v[100:103], v[84:87], v[148:151]
s_add_u32 m0, s39, 104448
s_add_u32 s37, s37, s38
buffer_load_dwordx4 v22, s[8:11], s37 offen sc1 lds
v_lshl_add_u32 v19, v18, 4, s43
v_mfma_f32_16x16x32_bf16 v[152:155], v[100:103], v[88:91], v[152:155]
ds_read_b128 v[48:51], v19 offset:0
s_add_u32 m0, s39, 105472
s_add_u32 s37, s37, s38
buffer_load_dwordx4 v23, s[8:11], s37 offen sc1 lds
v_mfma_f32_16x16x32_bf16 v[156:159], v[100:103], v[92:95], v[156:159]
ds_read_b128 v[52:55], v19 offset:64
v_mfma_f32_16x16x32_bf16 v[220:223], v[116:119], v[92:95], v[220:223]
s_add_u32 m0, s39, 106496
s_add_u32 s37, s37, s38
buffer_load_dwordx4 v22, s[8:11], s37 offen sc1 lds
ds_read_b128 v[56:59], v19 offset:128
v_mfma_f32_16x16x32_bf16 v[216:219], v[116:119], v[88:91], v[216:219]
ds_read_b128 v[60:63], v19 offset:192
v_mfma_f32_16x16x32_bf16 v[212:215], v[116:119], v[84:87], v[212:215]
s_add_u32 m0, s39, 107520
s_add_u32 s37, s37, s38
buffer_load_dwordx4 v23, s[8:11], s37 offen sc1 lds
ds_read_b128 v[64:67], v19 offset:896
v_mfma_f32_16x16x32_bf16 v[208:211], v[116:119], v[80:83], v[208:211]
ds_read_b128 v[68:71], v19 offset:960
s_add_u32 m0, s39, 108544
s_add_u32 s37, s37, s38
buffer_load_dwordx4 v22, s[8:11], s37 offen sc1 lds
v_mfma_f32_16x16x32_bf16 v[160:163], v[104:107], v[80:83], v[160:163]
ds_read_b128 v[72:75], v19 offset:1024
v_mfma_f32_16x16x32_bf16 v[164:167], v[104:107], v[84:87], v[164:167]
s_add_u32 m0, s39, 109568
s_add_u32 s37, s37, s38
buffer_load_dwordx4 v23, s[8:11], s37 offen sc1 lds
ds_read_b128 v[76:79], v19 offset:1088
v_mfma_f32_16x16x32_bf16 v[168:171], v[104:107], v[88:91], v[168:171]
v_mfma_f32_16x16x32_bf16 v[172:175], v[104:107], v[92:95], v[172:175]
s_add_u32 m0, s39, 110592
s_add_u32 s37, s37, s38
buffer_load_dwordx4 v22, s[8:11], s37 offen sc1 lds
v_mfma_f32_16x16x32_bf16 v[236:239], v[120:123], v[92:95], v[236:239]
v_mfma_f32_16x16x32_bf16 v[232:235], v[120:123], v[88:91], v[232:235]
v_mfma_f32_16x16x32_bf16 v[228:231], v[120:123], v[84:87], v[228:231]
s_add_u32 m0, s39, 111616
s_add_u32 s37, s37, s38
buffer_load_dwordx4 v23, s[8:11], s37 offen sc1 lds
v_mfma_f32_16x16x32_bf16 v[224:227], v[120:123], v[80:83], v[224:227]
v_mfma_f32_16x16x32_bf16 v[176:179], v[108:111], v[80:83], v[176:179]
v_mfma_f32_16x16x32_bf16 v[180:183], v[108:111], v[84:87], v[180:183]
s_add_u32 m0, s39, 112640
s_add_u32 s37, s37, s38
buffer_load_dwordx4 v22, s[8:11], s37 offen sc1 lds
v_mfma_f32_16x16x32_bf16 v[184:187], v[108:111], v[88:91], v[184:187]
v_mfma_f32_16x16x32_bf16 v[188:191], v[108:111], v[92:95], v[188:191]
v_mfma_f32_16x16x32_bf16 v[252:255], v[124:127], v[92:95], v[252:255]
s_add_u32 m0, s39, 113664
s_add_u32 s37, s37, s38
buffer_load_dwordx4 v23, s[8:11], s37 offen sc1 lds
v_mfma_f32_16x16x32_bf16 v[248:251], v[124:127], v[88:91], v[248:251]
v_mfma_f32_16x16x32_bf16 v[244:247], v[124:127], v[84:87], v[244:247]
v_mfma_f32_16x16x32_bf16 v[240:243], v[124:127], v[80:83], v[240:243]
s_setprio 0
s_waitcnt lgkmcnt(0)
v_mov_b32 v32, v2
v_mul_f32 v88, v3, v3
v_mul_f32 v36, 0xc0135761, v3
v_mul_f32 v89, 0xbdd2d3e8, v3
v_rcp_f32 v44, v88
v_mul_f32 v40, v89, v88
v_mov_b32 v33, v4
v_mul_f32 v88, v5, v5
v_mul_f32 v37, 0xc0135761, v5
v_mul_f32 v89, 0xbdd2d3e8, v5
v_rcp_f32 v45, v88
v_mul_f32 v41, v89, v88
v_mov_b32 v34, v6
v_mul_f32 v88, v7, v7
v_mul_f32 v38, 0xc0135761, v7
v_mul_f32 v89, 0xbdd2d3e8, v7
v_rcp_f32 v46, v88
v_mul_f32 v42, v89, v88
v_mov_b32 v35, v8
v_mul_f32 v88, v9, v9
v_mul_f32 v39, 0xc0135761, v9
v_mul_f32 v89, 0xbdd2d3e8, v9
v_rcp_f32 v47, v88
v_mul_f32 v43, v89, v88
s_barrier
s_add_u32 s42, s42, 1
s_and_b32 s42, s42, 15
s_add_u32 m0, s39, 0
s_mul_i32 s37, s42, s40
buffer_load_dwordx4 v22, s[8:11], s37 offen sc1 lds
v_fma_f32 v128, -v32, v48, v128
v_fma_f32 v129, -v32, v49, v129
v_fma_f32 v130, -v32, v50, v130
v_fma_f32 v131, -v32, v51, v131
s_add_u32 m0, s39, 1024
s_add_u32 s37, s37, s38
buffer_load_dwordx4 v23, s[8:11], s37 offen sc1 lds
v_fma_f32 v192, -v32, v64, v192
v_fma_f32 v193, -v32, v65, v193
v_fma_f32 v194, -v32, v66, v194
s_add_u32 m0, s39, 2048
s_add_u32 s37, s37, s38
buffer_load_dwordx4 v22, s[8:11], s37 offen sc1 lds
v_fma_f32 v195, -v32, v67, v195
v_mul_f32 v80, v128, v128
v_mul_f32 v81, v129, v129
s_add_u32 m0, s39, 3072
s_add_u32 s37, s37, s38
buffer_load_dwordx4 v23, s[8:11], s37 offen sc1 lds
v_mul_f32 v82, v130, v130
v_mul_f32 v83, v131, v131
v_fma_f32 v80, v80, v40, v36
s_add_u32 m0, s39, 4096
s_add_u32 s37, s37, s38
buffer_load_dwordx4 v22, s[8:11], s37 offen sc1 lds
v_fma_f32 v81, v81, v40, v36
v_fma_f32 v82, v82, v40, v36
v_fma_f32 v83, v83, v40, v36
v_mul_f32 v80, v80, v128
s_add_u32 m0, s39, 5120
s_add_u32 s37, s37, s38
buffer_load_dwordx4 v23, s[8:11], s37 offen sc1 lds
v_mul_f32 v81, v81, v129
v_mul_f32 v82, v82, v130
v_mul_f32 v83, v83, v131
s_add_u32 m0, s39, 6144
s_add_u32 s37, s37, s38
buffer_load_dwordx4 v22, s[8:11], s37 offen sc1 lds
v_exp_f32 v80, v80
v_exp_f32 v81, v81
v_exp_f32 v82, v82
s_add_u32 m0, s39, 7168
s_add_u32 s37, s37, s38
buffer_load_dwordx4 v23, s[8:11], s37 offen sc1 lds
v_exp_f32 v83, v83
v_mul_f32 v192, v128, v192
v_mul_f32 v193, v129, v193
s_add_u32 m0, s39, 8192
s_add_u32 s37, s37, s38
buffer_load_dwordx4 v22, s[8:11], s37 offen sc1 lds
v_mul_f32 v194, v130, v194
v_mul_f32 v195, v131, v195
v_fma_f32 v80, v80, v44, v44
v_fma_f32 v81, v81, v44, v44
s_add_u32 m0, s39, 9216
s_add_u32 s37, s37, s38
buffer_load_dwordx4 v23, s[8:11], s37 offen sc1 lds
v_fma_f32 v82, v82, v44, v44
v_fma_f32 v83, v83, v44, v44
v_rcp_f32 v80, v80
s_add_u32 m0, s39, 10240
s_add_u32 s37, s37, s38
buffer_load_dwordx4 v22, s[8:11], s37 offen sc1 lds
v_rcp_f32 v81, v81
v_rcp_f32 v82, v82
v_rcp_f32 v83, v83
s_add_u32 m0, s39, 11264
s_add_u32 s37, s37, s38
buffer_load_dwordx4 v23, s[8:11], s37 offen sc1 lds
v_mul_f32 v192, v192, v80
v_mul_f32 v193, v193, v81
v_mul_f32 v194, v194, v82
s_add_u32 m0, s39, 12288
s_add_u32 s37, s37, s38
buffer_load_dwordx4 v22, s[8:11], s37 offen sc1 lds
v_mul_f32 v195, v195, v83
v_cvt_pk_bf16_f32 v96, v192, v193
v_cvt_pk_bf16_f32 v97, v194, v195
v_fma_f32 v144, -v32, v52, v144
s_add_u32 m0, s39, 13312
s_add_u32 s37, s37, s38
buffer_load_dwordx4 v23, s[8:11], s37 offen sc1 lds
v_fma_f32 v145, -v32, v53, v145
v_fma_f32 v146, -v32, v54, v146
v_fma_f32 v147, -v32, v55, v147
s_add_u32 m0, s39, 14336
s_add_u32 s37, s37, s38
buffer_load_dwordx4 v22, s[8:11], s37 offen sc1 lds
v_fma_f32 v208, -v32, v68, v208
v_fma_f32 v209, -v32, v69, v209
v_fma_f32 v210, -v32, v70, v210
s_add_u32 m0, s39, 15360
s_add_u32 s37, s37, s38
buffer_load_dwordx4 v23, s[8:11], s37 offen sc1 lds
v_fma_f32 v211, -v32, v71, v211
v_mul_f32 v84, v144, v144
v_mul_f32 v85, v145, v145
s_waitcnt vmcnt(16)
s_barrier
s_add_u32 s42, s42, 1
s_and_b32 s42, s42, 15
s_add_u32 m0, s39, 49152
s_mul_i32 s37, s42, s40
buffer_load_dwordx4 v22, s[8:11], s37 offen sc1 lds
v_mul_f32 v86, v146, v146
v_mul_f32 v87, v147, v147
v_fma_f32 v84, v84, v40, v36
v_fma_f32 v85, v85, v40, v36
v_fma_f32 v86, v86, v40, v36
s_add_u32 m0, s39, 50176
s_add_u32 s37, s37, s38
buffer_load_dwordx4 v23, s[8:11], s37 offen sc1 lds
v_fma_f32 v87, v87, v40, v36
v_mul_f32 v84, v84, v144
v_mul_f32 v85, v85, v145
v_mul_f32 v86, v86, v146
v_mul_f32 v87, v87, v147
s_add_u32 m0, s39, 51200
s_add_u32 s37, s37, s38
buffer_load_dwordx4 v22, s[8:11], s37 offen sc1 lds
v_exp_f32 v84, v84
v_exp_f32 v85, v85
v_exp_f32 v86, v86
v_exp_f32 v87, v87
s_add_u32 m0, s39, 52224
s_add_u32 s37, s37, s38
buffer_load_dwordx4 v23, s[8:11], s37 offen sc1 lds
v_mul_f32 v208, v144, v208
v_mul_f32 v209, v145, v209
v_mul_f32 v210, v146, v210
v_mul_f32 v211, v147, v211
v_fma_f32 v84, v84, v44, v44
s_add_u32 m0, s39, 53248
s_add_u32 s37, s37, s38
buffer_load_dwordx4 v22, s[8:11], s37 offen sc1 lds
v_fma_f32 v85, v85, v44, v44
v_fma_f32 v86, v86, v44, v44
v_fma_f32 v87, v87, v44, v44
v_rcp_f32 v84, v84
v_rcp_f32 v85, v85
s_add_u32 m0, s39, 54272
s_add_u32 s37, s37, s38
buffer_load_dwordx4 v23, s[8:11], s37 offen sc1 lds
v_rcp_f32 v86, v86
v_rcp_f32 v87, v87
v_mul_f32 v208, v208, v84
v_mul_f32 v209, v209, v85
s_add_u32 m0, s39, 55296
s_add_u32 s37, s37, s38
buffer_load_dwordx4 v22, s[8:11], s37 offen sc1 lds
v_mul_f32 v210, v210, v86
v_mul_f32 v211, v211, v87
v_cvt_pk_bf16_f32 v98, v208, v209
v_cvt_pk_bf16_f32 v99, v210, v211
s_add_u32 m0, s39, 56320
s_add_u32 s37, s37, s38
buffer_load_dwordx4 v23, s[8:11], s37 offen sc1 lds
v_fma_f32 v132, -v33, v48, v132
v_fma_f32 v133, -v33, v49, v133
v_fma_f32 v134, -v33, v50, v134
v_fma_f32 v135, -v33, v51, v135
s_add_u32 m0, s39, 57344
s_add_u32 s37, s37, s38
buffer_load_dwordx4 v22, s[8:11], s37 offen sc1 lds
v_fma_f32 v196, -v33, v64, v196
v_fma_f32 v197, -v33, v65, v197
v_fma_f32 v198, -v33, v66, v198
v_fma_f32 v199, -v33, v67, v199
v_mul_f32 v80, v132, v132
s_add_u32 m0, s39, 58368
s_add_u32 s37, s37, s38
buffer_load_dwordx4 v23, s[8:11], s37 offen sc1 lds
v_mul_f32 v81, v133, v133
v_mul_f32 v82, v134, v134
v_mul_f32 v83, v135, v135
v_fma_f32 v80, v80, v41, v37
v_fma_f32 v81, v81, v41, v37
s_add_u32 m0, s39, 59392
s_add_u32 s37, s37, s38
buffer_load_dwordx4 v22, s[8:11], s37 offen sc1 lds
v_fma_f32 v82, v82, v41, v37
v_fma_f32 v83, v83, v41, v37
v_mul_f32 v80, v80, v132
v_mul_f32 v81, v81, v133
s_add_u32 m0, s39, 60416
s_add_u32 s37, s37, s38
buffer_load_dwordx4 v23, s[8:11], s37 offen sc1 lds
v_mul_f32 v82, v82, v134
v_lshlrev_b32 v19, 11, v18
v_lshl_add_u32 v19, v17, 4, v19
s_lshl_b32 s43, s46, 10
v_add_u32 v2, s43, v19
s_add_u32 m0, s39, 61440
s_add_u32 s37, s37, s38
buffer_load_dwordx4 v22, s[8:11], s37 offen sc1 lds
v_add_u32 v3, 0x10000, v2
v_lshrrev_b32 v19, 2, v17
v_lshl_add_u32 v20, v18, 2, v19
v_bfe_u32 v21, v20, 1, 2
s_lshl_b32 s43, s47, 1
s_add_u32 m0, s39, 62464
s_add_u32 s37, s37, s38
buffer_load_dwordx4 v23, s[8:11], s37 offen sc1 lds
v_xor_b32 v21, s43, v21
v_lshlrev_b32 v20, 7, v20
v_lshl_add_u32 v20, v21, 5, v20
v_and_b32 v19, 3, v1
s_add_u32 m0, s39, 63488
s_add_u32 s37, s37, s38
buffer_load_dwordx4 v22, s[8:11], s37 offen sc1 lds
v_lshl_add_u32 v20, v19, 3, v20
v_add_u32 v5, 16384, v20
v_xor_b32 v6, 32, v5
v_add_u32 v7, 0x10000, v5
v_add_u32 v8, 0x10000, v6
s_add_u32 m0, s39, 64512
s_add_u32 s37, s37, s38
buffer_load_dwordx4 v23, s[8:11], s37 offen sc1 lds
s_lshl_b32 s43, s36, 12
v_lshl_add_u32 v9, v1, 4, s43
s_mov_b32 s54, 0x10000
s_movk_i32 s52, 0x1000
buffer_store_dwordx4 v[96:99], v27, s[24:27], 0 offen offset:0 sc1
s_waitcnt vmcnt(17)
s_barrier
s_add_u32 s42, s42, 1
s_and_b32 s42, s42, 15
s_add_u32 m0, s39, 98304
s_mul_i32 s37, s42, s40
buffer_load_dwordx4 v22, s[8:11], s37 offen sc1 lds
v_mul_f32 v83, v83, v135
v_exp_f32 v80, v80
v_exp_f32 v81, v81
v_exp_f32 v82, v82
s_add_u32 m0, s39, 99328
s_add_u32 s37, s37, s38
buffer_load_dwordx4 v23, s[8:11], s37 offen sc1 lds
v_exp_f32 v83, v83
v_mul_f32 v196, v132, v196
v_mul_f32 v197, v133, v197
s_add_u32 m0, s39, 100352
s_add_u32 s37, s37, s38
buffer_load_dwordx4 v22, s[8:11], s37 offen sc1 lds
v_mul_f32 v198, v134, v198
v_mul_f32 v199, v135, v199
v_fma_f32 v80, v80, v45, v45
s_add_u32 m0, s39, 101376
s_add_u32 s37, s37, s38
buffer_load_dwordx4 v23, s[8:11], s37 offen sc1 lds
v_fma_f32 v81, v81, v45, v45
v_fma_f32 v82, v82, v45, v45
v_fma_f32 v83, v83, v45, v45
s_add_u32 m0, s39, 102400
s_add_u32 s37, s37, s38
buffer_load_dwordx4 v22, s[8:11], s37 offen sc1 lds
v_rcp_f32 v80, v80
v_rcp_f32 v81, v81
v_rcp_f32 v82, v82
v_rcp_f32 v83, v83
s_add_u32 m0, s39, 103424
s_add_u32 s37, s37, s38
buffer_load_dwordx4 v23, s[8:11], s37 offen sc1 lds
v_mul_f32 v196, v196, v80
v_mul_f32 v197, v197, v81
v_mul_f32 v198, v198, v82
s_add_u32 m0, s39, 104448
s_add_u32 s37, s37, s38
buffer_load_dwordx4 v22, s[8:11], s37 offen sc1 lds
v_mul_f32 v199, v199, v83
v_cvt_pk_bf16_f32 v100, v196, v197
v_cvt_pk_bf16_f32 v101, v198, v199
s_add_u32 m0, s39, 105472
s_add_u32 s37, s37, s38
buffer_load_dwordx4 v23, s[8:11], s37 offen sc1 lds
v_fma_f32 v148, -v33, v52, v148
v_fma_f32 v149, -v33, v53, v149
v_fma_f32 v150, -v33, v54, v150
s_add_u32 m0, s39, 106496
s_add_u32 s37, s37, s38
buffer_load_dwordx4 v22, s[8:11], s37 offen sc1 lds
v_fma_f32 v151, -v33, v55, v151
v_fma_f32 v212, -v33, v68, v212
v_fma_f32 v213, -v33, v69, v213
v_fma_f32 v214, -v33, v70, v214
s_add_u32 m0, s39, 107520
s_add_u32 s37, s37, s38
buffer_load_dwordx4 v23, s[8:11], s37 offen sc1 lds
v_fma_f32 v215, -v33, v71, v215
v_mul_f32 v84, v148, v148
v_mul_f32 v85, v149, v149
s_add_u32 m0, s39, 108544
s_add_u32 s37, s37, s38
buffer_load_dwordx4 v22, s[8:11], s37 offen sc1 lds
v_mul_f32 v86, v150, v150
v_mul_f32 v87, v151, v151
v_fma_f32 v84, v84, v41, v37
s_add_u32 m0, s39, 109568
s_add_u32 s37, s37, s38
buffer_load_dwordx4 v23, s[8:11], s37 offen sc1 lds
v_fma_f32 v85, v85, v41, v37
v_fma_f32 v86, v86, v41, v37
v_fma_f32 v87, v87, v41, v37
s_add_u32 m0, s39, 110592
s_add_u32 s37, s37, s38
buffer_load_dwordx4 v22, s[8:11], s37 offen sc1 lds
v_mul_f32 v84, v84, v148
v_mul_f32 v85, v85, v149
v_mul_f32 v86, v86, v150
v_mul_f32 v87, v87, v151
s_add_u32 m0, s39, 111616
s_add_u32 s37, s37, s38
buffer_load_dwordx4 v23, s[8:11], s37 offen sc1 lds
v_exp_f32 v84, v84
v_exp_f32 v85, v85
v_exp_f32 v86, v86
s_add_u32 m0, s39, 112640
s_add_u32 s37, s37, s38
buffer_load_dwordx4 v22, s[8:11], s37 offen sc1 lds
v_exp_f32 v87, v87
v_mul_f32 v212, v148, v212
v_mul_f32 v213, v149, v213
s_add_u32 m0, s39, 113664
s_add_u32 s37, s37, s38
buffer_load_dwordx4 v23, s[8:11], s37 offen sc1 lds
v_mul_f32 v214, v150, v214
v_mul_f32 v215, v151, v215
v_fma_f32 v84, v84, v45, v45
s_waitcnt vmcnt(17)
s_barrier
s_add_u32 s42, s42, 1
s_and_b32 s42, s42, 15
s_add_u32 m0, s39, 0
s_mul_i32 s37, s42, s40
buffer_load_dwordx4 v22, s[8:11], s37 offen sc1 lds
v_fma_f32 v85, v85, v45, v45
v_fma_f32 v86, v86, v45, v45
v_fma_f32 v87, v87, v45, v45
v_rcp_f32 v84, v84
s_add_u32 m0, s39, 1024
s_add_u32 s37, s37, s38
buffer_load_dwordx4 v23, s[8:11], s37 offen sc1 lds
v_rcp_f32 v85, v85
v_rcp_f32 v86, v86
v_rcp_f32 v87, v87
s_add_u32 m0, s39, 2048
s_add_u32 s37, s37, s38
buffer_load_dwordx4 v22, s[8:11], s37 offen sc1 lds
v_mul_f32 v212, v212, v84
v_mul_f32 v213, v213, v85
v_mul_f32 v214, v214, v86
s_add_u32 m0, s39, 3072
s_add_u32 s37, s37, s38
buffer_load_dwordx4 v23, s[8:11], s37 offen sc1 lds
v_mul_f32 v215, v215, v87
v_cvt_pk_bf16_f32 v102, v212, v213
v_cvt_pk_bf16_f32 v103, v214, v215
s_add_u32 m0, s39, 4096
s_add_u32 s37, s37, s38
buffer_load_dwordx4 v22, s[8:11], s37 offen sc1 lds
v_fma_f32 v136, -v34, v48, v136
v_fma_f32 v137, -v34, v49, v137
v_fma_f32 v138, -v34, v50, v138
s_add_u32 m0, s39, 5120
s_add_u32 s37, s37, s38
buffer_load_dwordx4 v23, s[8:11], s37 offen sc1 lds
v_fma_f32 v139, -v34, v51, v139
v_fma_f32 v200, -v34, v64, v200
v_fma_f32 v201, -v34, v65, v201
s_add_u32 m0, s39, 6144
s_add_u32 s37, s37, s38
buffer_load_dwordx4 v22, s[8:11], s37 offen sc1 lds
v_fma_f32 v202, -v34, v66, v202
v_fma_f32 v203, -v34, v67, v203
v_mul_f32 v80, v136, v136
v_mul_f32 v81, v137, v137
s_add_u32 m0, s39, 7168
s_add_u32 s37, s37, s38
buffer_load_dwordx4 v23, s[8:11], s37 offen sc1 lds
v_mul_f32 v82, v138, v138
v_mul_f32 v83, v139, v139
v_fma_f32 v80, v80, v42, v38
s_add_u32 m0, s39, 8192
s_add_u32 s37, s37, s38
buffer_load_dwordx4 v22, s[8:11], s37 offen sc1 lds
v_fma_f32 v81, v81, v42, v38
v_fma_f32 v82, v82, v42, v38
v_fma_f32 v83, v83, v42, v38
s_add_u32 m0, s39, 9216
s_add_u32 s37, s37, s38
buffer_load_dwordx4 v23, s[8:11], s37 offen sc1 lds
v_mul_f32 v80, v80, v136
v_mul_f32 v81, v81, v137
v_mul_f32 v82, v82, v138
v_mul_f32 v83, v83, v139
s_add_u32 m0, s39, 10240
s_add_u32 s37, s37, s38
buffer_load_dwordx4 v22, s[8:11], s37 offen sc1 lds
v_exp_f32 v80, v80
v_exp_f32 v81, v81
v_exp_f32 v82, v82
s_add_u32 m0, s39, 11264
s_add_u32 s37, s37, s38
buffer_load_dwordx4 v23, s[8:11], s37 offen sc1 lds
v_exp_f32 v83, v83
v_mul_f32 v200, v136, v200
v_mul_f32 v201, v137, v201
s_add_u32 m0, s39, 12288
s_add_u32 s37, s37, s38
buffer_load_dwordx4 v22, s[8:11], s37 offen sc1 lds
v_mul_f32 v202, v138, v202
v_mul_f32 v203, v139, v203
v_fma_f32 v80, v80, v46, v46
v_fma_f32 v81, v81, v46, v46
s_add_u32 m0, s39, 13312
s_add_u32 s37, s37, s38
buffer_load_dwordx4 v23, s[8:11], s37 offen sc1 lds
v_fma_f32 v82, v82, v46, v46
v_fma_f32 v83, v83, v46, v46
v_rcp_f32 v80, v80
s_add_u32 m0, s39, 14336
s_add_u32 s37, s37, s38
buffer_load_dwordx4 v22, s[8:11], s37 offen sc1 lds
v_rcp_f32 v81, v81
v_rcp_f32 v82, v82
v_rcp_f32 v83, v83
s_add_u32 m0, s39, 15360
s_add_u32 s37, s37, s38
buffer_load_dwordx4 v23, s[8:11], s37 offen sc1 lds
v_mul_f32 v200, v200, v80
v_mul_f32 v201, v201, v81
v_mul_f32 v202, v202, v82
buffer_store_dwordx4 v[100:103], v27, s[24:27], 0 offen offset:256 sc1
s_waitcnt vmcnt(17)
s_barrier
s_add_u32 s42, s42, 1
s_and_b32 s42, s42, 15
s_add_u32 m0, s39, 49152
s_mul_i32 s37, s42, s40
buffer_load_dwordx4 v22, s[8:11], s37 offen sc1 lds
v_mul_f32 v203, v203, v83
v_cvt_pk_bf16_f32 v104, v200, v201
v_cvt_pk_bf16_f32 v105, v202, v203
v_fma_f32 v152, -v34, v52, v152
s_add_u32 m0, s39, 50176
s_add_u32 s37, s37, s38
buffer_load_dwordx4 v23, s[8:11], s37 offen sc1 lds
v_fma_f32 v153, -v34, v53, v153
v_fma_f32 v154, -v34, v54, v154
v_fma_f32 v155, -v34, v55, v155
s_add_u32 m0, s39, 51200
s_add_u32 s37, s37, s38
buffer_load_dwordx4 v22, s[8:11], s37 offen sc1 lds
v_fma_f32 v216, -v34, v68, v216
v_fma_f32 v217, -v34, v69, v217
v_fma_f32 v218, -v34, v70, v218
s_add_u32 m0, s39, 52224
s_add_u32 s37, s37, s38
buffer_load_dwordx4 v23, s[8:11], s37 offen sc1 lds
v_fma_f32 v219, -v34, v71, v219
v_mul_f32 v84, v152, v152
v_mul_f32 v85, v153, v153
s_add_u32 m0, s39, 53248
s_add_u32 s37, s37, s38
buffer_load_dwordx4 v22, s[8:11], s37 offen sc1 lds
v_mul_f32 v86, v154, v154
v_mul_f32 v87, v155, v155
v_fma_f32 v84, v84, v42, v38
v_fma_f32 v85, v85, v42, v38
s_add_u32 m0, s39, 54272
s_add_u32 s37, s37, s38
buffer_load_dwordx4 v23, s[8:11], s37 offen sc1 lds
v_fma_f32 v86, v86, v42, v38
v_fma_f32 v87, v87, v42, v38
v_mul_f32 v84, v84, v152
s_add_u32 m0, s39, 55296
s_add_u32 s37, s37, s38
buffer_load_dwordx4 v22, s[8:11], s37 offen sc1 lds
v_mul_f32 v85, v85, v153
v_mul_f32 v86, v86, v154
v_mul_f32 v87, v87, v155
s_add_u32 m0, s39, 56320
s_add_u32 s37, s37, s38
buffer_load_dwordx4 v23, s[8:11], s37 offen sc1 lds
v_exp_f32 v84, v84
v_exp_f32 v85, v85
v_exp_f32 v86, v86
s_add_u32 m0, s39, 57344
s_add_u32 s37, s37, s38
buffer_load_dwordx4 v22, s[8:11], s37 offen sc1 lds
v_exp_f32 v87, v87
v_mul_f32 v216, v152, v216
v_mul_f32 v217, v153, v217
v_mul_f32 v218, v154, v218
s_add_u32 m0, s39, 58368
s_add_u32 s37, s37, s38
buffer_load_dwordx4 v23, s[8:11], s37 offen sc1 lds
v_mul_f32 v219, v155, v219
v_fma_f32 v84, v84, v46, v46
v_fma_f32 v85, v85, v46, v46
s_add_u32 m0, s39, 59392
s_add_u32 s37, s37, s38
buffer_load_dwordx4 v22, s[8:11], s37 offen sc1 lds
v_fma_f32 v86, v86, v46, v46
v_fma_f32 v87, v87, v46, v46
v_rcp_f32 v84, v84
s_add_u32 m0, s39, 60416
s_add_u32 s37, s37, s38
buffer_load_dwordx4 v23, s[8:11], s37 offen sc1 lds
v_rcp_f32 v85, v85
v_rcp_f32 v86, v86
v_rcp_f32 v87, v87
s_add_u32 m0, s39, 61440
s_add_u32 s37, s37, s38
buffer_load_dwordx4 v22, s[8:11], s37 offen sc1 lds
v_mul_f32 v216, v216, v84
v_mul_f32 v217, v217, v85
v_mul_f32 v218, v218, v86
v_mul_f32 v219, v219, v87
s_add_u32 m0, s39, 62464
s_add_u32 s37, s37, s38
buffer_load_dwordx4 v23, s[8:11], s37 offen sc1 lds
v_cvt_pk_bf16_f32 v106, v216, v217
v_cvt_pk_bf16_f32 v107, v218, v219
s_add_u32 m0, s39, 63488
s_add_u32 s37, s37, s38
buffer_load_dwordx4 v22, s[8:11], s37 offen sc1 lds
v_fma_f32 v140, -v35, v48, v140
v_fma_f32 v141, -v35, v49, v141
v_fma_f32 v142, -v35, v50, v142
s_add_u32 m0, s39, 64512
s_add_u32 s37, s37, s38
buffer_load_dwordx4 v23, s[8:11], s37 offen sc1 lds
v_fma_f32 v143, -v35, v51, v143
v_fma_f32 v204, -v35, v64, v204
v_fma_f32 v205, -v35, v65, v205
buffer_store_dwordx4 v[104:107], v27, s[24:27], 0 offen offset:512 sc1
s_waitcnt vmcnt(18)
s_barrier
s_add_u32 s42, s42, 1
s_and_b32 s42, s42, 15
s_add_u32 m0, s39, 98304
s_mul_i32 s37, s42, s40
buffer_load_dwordx4 v22, s[8:11], s37 offen sc1 lds
v_fma_f32 v206, -v35, v66, v206
v_fma_f32 v207, -v35, v67, v207
v_mul_f32 v80, v140, v140
v_mul_f32 v81, v141, v141
s_add_u32 m0, s39, 99328
s_add_u32 s37, s37, s38
buffer_load_dwordx4 v23, s[8:11], s37 offen sc1 lds
v_mul_f32 v82, v142, v142
v_mul_f32 v83, v143, v143
v_fma_f32 v80, v80, v43, v39
s_add_u32 m0, s39, 100352
s_add_u32 s37, s37, s38
buffer_load_dwordx4 v22, s[8:11], s37 offen sc1 lds
v_fma_f32 v81, v81, v43, v39
v_fma_f32 v82, v82, v43, v39
v_fma_f32 v83, v83, v43, v39
s_add_u32 m0, s39, 101376
s_add_u32 s37, s37, s38
buffer_load_dwordx4 v23, s[8:11], s37 offen sc1 lds
v_mul_f32 v80, v80, v140
v_mul_f32 v81, v81, v141
v_mul_f32 v82, v82, v142
s_add_u32 m0, s39, 102400
s_add_u32 s37, s37, s38
buffer_load_dwordx4 v22, s[8:11], s37 offen sc1 lds
v_mul_f32 v83, v83, v143
v_exp_f32 v80, v80
v_exp_f32 v81, v81
v_exp_f32 v82, v82
s_add_u32 m0, s39, 103424
s_add_u32 s37, s37, s38
buffer_load_dwordx4 v23, s[8:11], s37 offen sc1 lds
v_exp_f32 v83, v83
v_mul_f32 v204, v140, v204
v_mul_f32 v205, v141, v205
s_add_u32 m0, s39, 104448
s_add_u32 s37, s37, s38
buffer_load_dwordx4 v22, s[8:11], s37 offen sc1 lds
v_mul_f32 v206, v142, v206
v_mul_f32 v207, v143, v207
v_fma_f32 v80, v80, v47, v47
s_add_u32 m0, s39, 105472
s_add_u32 s37, s37, s38
buffer_load_dwordx4 v23, s[8:11], s37 offen sc1 lds
v_fma_f32 v81, v81, v47, v47
v_fma_f32 v82, v82, v47, v47
v_fma_f32 v83, v83, v47, v47
s_add_u32 m0, s39, 106496
s_add_u32 s37, s37, s38
buffer_load_dwordx4 v22, s[8:11], s37 offen sc1 lds
v_rcp_f32 v80, v80
v_rcp_f32 v81, v81
v_rcp_f32 v82, v82
v_rcp_f32 v83, v83
s_add_u32 m0, s39, 107520
s_add_u32 s37, s37, s38
buffer_load_dwordx4 v23, s[8:11], s37 offen sc1 lds
v_mul_f32 v204, v204, v80
v_mul_f32 v205, v205, v81
v_mul_f32 v206, v206, v82
s_add_u32 m0, s39, 108544
s_add_u32 s37, s37, s38
buffer_load_dwordx4 v22, s[8:11], s37 offen sc1 lds
v_mul_f32 v207, v207, v83
v_cvt_pk_bf16_f32 v108, v204, v205
v_cvt_pk_bf16_f32 v109, v206, v207
s_add_u32 m0, s39, 109568
s_add_u32 s37, s37, s38
buffer_load_dwordx4 v23, s[8:11], s37 offen sc1 lds
v_fma_f32 v156, -v35, v52, v156
v_fma_f32 v157, -v35, v53, v157
v_fma_f32 v158, -v35, v54, v158
s_add_u32 m0, s39, 110592
s_add_u32 s37, s37, s38
buffer_load_dwordx4 v22, s[8:11], s37 offen sc1 lds
v_fma_f32 v159, -v35, v55, v159
v_fma_f32 v220, -v35, v68, v220
v_fma_f32 v221, -v35, v69, v221
v_fma_f32 v222, -v35, v70, v222
s_add_u32 m0, s39, 111616
s_add_u32 s37, s37, s38
buffer_load_dwordx4 v23, s[8:11], s37 offen sc1 lds
v_fma_f32 v223, -v35, v71, v223
v_mul_f32 v84, v156, v156
v_mul_f32 v85, v157, v157
s_add_u32 m0, s39, 112640
s_add_u32 s37, s37, s38
buffer_load_dwordx4 v22, s[8:11], s37 offen sc1 lds
v_mul_f32 v86, v158, v158
v_mul_f32 v87, v159, v159
v_fma_f32 v84, v84, v43, v39
s_add_u32 m0, s39, 113664
s_add_u32 s37, s37, s38
buffer_load_dwordx4 v23, s[8:11], s37 offen sc1 lds
v_fma_f32 v85, v85, v43, v39
v_fma_f32 v86, v86, v43, v39
v_fma_f32 v87, v87, v43, v39
s_waitcnt vmcnt(17)
s_barrier
s_add_u32 s42, s42, 1
s_and_b32 s42, s42, 15
s_add_u32 m0, s39, 0
s_mul_i32 s37, s42, s40
buffer_load_dwordx4 v22, s[8:11], s37 offen sc1 lds
v_mul_f32 v84, v84, v156
v_mul_f32 v85, v85, v157
v_mul_f32 v86, v86, v158
v_mul_f32 v87, v87, v159
s_add_u32 m0, s39, 1024
s_add_u32 s37, s37, s38
buffer_load_dwordx4 v23, s[8:11], s37 offen sc1 lds
v_exp_f32 v84, v84
v_exp_f32 v85, v85
v_exp_f32 v86, v86
s_add_u32 m0, s39, 2048
s_add_u32 s37, s37, s38
buffer_load_dwordx4 v22, s[8:11], s37 offen sc1 lds
v_exp_f32 v87, v87
v_mul_f32 v220, v156, v220
v_mul_f32 v221, v157, v221
s_add_u32 m0, s39, 3072
s_add_u32 s37, s37, s38
buffer_load_dwordx4 v23, s[8:11], s37 offen sc1 lds
v_mul_f32 v222, v158, v222
v_mul_f32 v223, v159, v223
v_fma_f32 v84, v84, v47, v47
v_fma_f32 v85, v85, v47, v47
s_add_u32 m0, s39, 4096
s_add_u32 s37, s37, s38
buffer_load_dwordx4 v22, s[8:11], s37 offen sc1 lds
v_fma_f32 v86, v86, v47, v47
v_fma_f32 v87, v87, v47, v47
v_rcp_f32 v84, v84
s_add_u32 m0, s39, 5120
s_add_u32 s37, s37, s38
buffer_load_dwordx4 v23, s[8:11], s37 offen sc1 lds
v_rcp_f32 v85, v85
v_rcp_f32 v86, v86
v_rcp_f32 v87, v87
s_add_u32 m0, s39, 6144
s_add_u32 s37, s37, s38
buffer_load_dwordx4 v22, s[8:11], s37 offen sc1 lds
v_mul_f32 v220, v220, v84
v_mul_f32 v221, v221, v85
v_mul_f32 v222, v222, v86
v_mul_f32 v223, v223, v87
s_add_u32 m0, s39, 7168
s_add_u32 s37, s37, s38
buffer_load_dwordx4 v23, s[8:11], s37 offen sc1 lds
v_cvt_pk_bf16_f32 v110, v220, v221
v_cvt_pk_bf16_f32 v111, v222, v223
s_add_u32 m0, s39, 8192
s_add_u32 s37, s37, s38
buffer_load_dwordx4 v22, s[8:11], s37 offen sc1 lds
v_fma_f32 v160, -v32, v56, v160
v_fma_f32 v161, -v32, v57, v161
v_fma_f32 v162, -v32, v58, v162
s_add_u32 m0, s39, 9216
s_add_u32 s37, s37, s38
buffer_load_dwordx4 v23, s[8:11], s37 offen sc1 lds
v_fma_f32 v163, -v32, v59, v163
v_fma_f32 v224, -v32, v72, v224
v_fma_f32 v225, -v32, v73, v225
v_fma_f32 v226, -v32, v74, v226
s_add_u32 m0, s39, 10240
s_add_u32 s37, s37, s38
buffer_load_dwordx4 v22, s[8:11], s37 offen sc1 lds
v_fma_f32 v227, -v32, v75, v227
v_mul_f32 v80, v160, v160
v_mul_f32 v81, v161, v161
s_add_u32 m0, s39, 11264
s_add_u32 s37, s37, s38
buffer_load_dwordx4 v23, s[8:11], s37 offen sc1 lds
v_mul_f32 v82, v162, v162
v_mul_f32 v83, v163, v163
v_fma_f32 v80, v80, v40, v36
s_add_u32 m0, s39, 12288
s_add_u32 s37, s37, s38
buffer_load_dwordx4 v22, s[8:11], s37 offen sc1 lds
v_fma_f32 v81, v81, v40, v36
v_fma_f32 v82, v82, v40, v36
v_fma_f32 v83, v83, v40, v36
v_mul_f32 v80, v80, v160
s_add_u32 m0, s39, 13312
s_add_u32 s37, s37, s38
buffer_load_dwordx4 v23, s[8:11], s37 offen sc1 lds
v_mul_f32 v81, v81, v161
v_mul_f32 v82, v82, v162
v_mul_f32 v83, v83, v163
s_add_u32 m0, s39, 14336
s_add_u32 s37, s37, s38
buffer_load_dwordx4 v22, s[8:11], s37 offen sc1 lds
v_exp_f32 v80, v80
v_exp_f32 v81, v81
v_exp_f32 v82, v82
s_add_u32 m0, s39, 15360
s_add_u32 s37, s37, s38
buffer_load_dwordx4 v23, s[8:11], s37 offen sc1 lds
v_exp_f32 v83, v83
v_mul_f32 v224, v160, v224
v_mul_f32 v225, v161, v225
buffer_store_dwordx4 v[108:111], v27, s[24:27], 0 offen offset:768 sc1
s_waitcnt vmcnt(17)
s_barrier
s_add_u32 s42, s42, 1
s_and_b32 s42, s42, 15
s_add_u32 m0, s39, 49152
s_mul_i32 s37, s42, s40
buffer_load_dwordx4 v22, s[8:11], s37 offen sc1 lds
v_mul_f32 v226, v162, v226
v_mul_f32 v227, v163, v227
v_fma_f32 v80, v80, v44, v44
v_fma_f32 v81, v81, v44, v44
s_add_u32 m0, s39, 50176
s_add_u32 s37, s37, s38
buffer_load_dwordx4 v23, s[8:11], s37 offen sc1 lds
v_fma_f32 v82, v82, v44, v44
v_fma_f32 v83, v83, v44, v44
v_rcp_f32 v80, v80
v_rcp_f32 v81, v81
s_add_u32 m0, s39, 51200
s_add_u32 s37, s37, s38
buffer_load_dwordx4 v22, s[8:11], s37 offen sc1 lds
v_rcp_f32 v82, v82
v_rcp_f32 v83, v83
v_mul_f32 v224, v224, v80
v_mul_f32 v225, v225, v81
s_add_u32 m0, s39, 52224
s_add_u32 s37, s37, s38
buffer_load_dwordx4 v23, s[8:11], s37 offen sc1 lds
v_mul_f32 v226, v226, v82
v_mul_f32 v227, v227, v83
v_cvt_pk_bf16_f32 v96, v224, v225
v_cvt_pk_bf16_f32 v97, v226, v227
s_add_u32 m0, s39, 53248
s_add_u32 s37, s37, s38
buffer_load_dwordx4 v22, s[8:11], s37 offen sc1 lds
v_fma_f32 v176, -v32, v60, v176
v_fma_f32 v177, -v32, v61, v177
v_fma_f32 v178, -v32, v62, v178
v_fma_f32 v179, -v32, v63, v179
s_add_u32 m0, s39, 54272
s_add_u32 s37, s37, s38
buffer_load_dwordx4 v23, s[8:11], s37 offen sc1 lds
v_fma_f32 v240, -v32, v76, v240
v_fma_f32 v241, -v32, v77, v241
v_fma_f32 v242, -v32, v78, v242
v_fma_f32 v243, -v32, v79, v243
s_add_u32 m0, s39, 55296
s_add_u32 s37, s37, s38
buffer_load_dwordx4 v22, s[8:11], s37 offen sc1 lds
v_mul_f32 v84, v176, v176
v_mul_f32 v85, v177, v177
v_mul_f32 v86, v178, v178
v_mul_f32 v87, v179, v179
s_add_u32 m0, s39, 56320
s_add_u32 s37, s37, s38
buffer_load_dwordx4 v23, s[8:11], s37 offen sc1 lds
v_fma_f32 v84, v84, v40, v36
v_fma_f32 v85, v85, v40, v36
v_fma_f32 v86, v86, v40, v36
s_add_u32 m0, s39, 57344
s_add_u32 s37, s37, s38
buffer_load_dwordx4 v22, s[8:11], s37 offen sc1 lds
v_fma_f32 v87, v87, v40, v36
v_mul_f32 v84, v84, v176
v_mul_f32 v85, v85, v177
v_mul_f32 v86, v86, v178
s_add_u32 m0, s39, 58368
s_add_u32 s37, s37, s38
buffer_load_dwordx4 v23, s[8:11], s37 offen sc1 lds
v_mul_f32 v87, v87, v179
v_exp_f32 v84, v84
v_exp_f32 v85, v85
v_exp_f32 v86, v86
s_add_u32 m0, s39, 59392
s_add_u32 s37, s37, s38
buffer_load_dwordx4 v22, s[8:11], s37 offen sc1 lds
v_exp_f32 v87, v87
v_mul_f32 v240, v176, v240
v_mul_f32 v241, v177, v241
v_mul_f32 v242, v178, v242
s_add_u32 m0, s39, 60416
s_add_u32 s37, s37, s38
buffer_load_dwordx4 v23, s[8:11], s37 offen sc1 lds
v_mul_f32 v243, v179, v243
v_fma_f32 v84, v84, v44, v44
v_fma_f32 v85, v85, v44, v44
v_fma_f32 v86, v86, v44, v44
s_add_u32 m0, s39, 61440
s_add_u32 s37, s37, s38
buffer_load_dwordx4 v22, s[8:11], s37 offen sc1 lds
v_fma_f32 v87, v87, v44, v44
v_rcp_f32 v84, v84
v_rcp_f32 v85, v85
v_rcp_f32 v86, v86
s_add_u32 m0, s39, 62464
s_add_u32 s37, s37, s38
buffer_load_dwordx4 v23, s[8:11], s37 offen sc1 lds
v_rcp_f32 v87, v87
v_lshlrev_b32 v19, 11, v18
v_lshl_add_u32 v19, v17, 4, v19
s_lshl_b32 s43, s46, 10
s_add_u32 m0, s39, 63488
s_add_u32 s37, s37, s38
buffer_load_dwordx4 v22, s[8:11], s37 offen sc1 lds
s_lshl_b32 s44, s47, 13
v_add3_u32 v208, v19, s43, 0
v_add_u32 v208, s44, v208
buffer_load_dwordx4 v[192:195], v208, s[20:23], 0 offen offset:0 sc1
s_add_u32 m0, s39, 64512
s_add_u32 s37, s37, s38
buffer_load_dwordx4 v23, s[8:11], s37 offen sc1 lds
buffer_load_dwordx4 v[196:199], v208, s[20:23], 0 offen offset:256 sc1
buffer_load_dwordx4 v[200:203], v208, s[20:23], 0 offen offset:512 sc1
buffer_load_dwordx4 v[204:207], v208, s[20:23], 0 offen offset:768 sc1
s_waitcnt vmcnt(20)
s_barrier
s_add_u32 s42, s42, 1
s_and_b32 s42, s42, 15
s_add_u32 m0, s39, 98304
s_mul_i32 s37, s42, s40
buffer_load_dwordx4 v22, s[8:11], s37 offen sc1 lds
v_mul_f32 v240, v240, v84
v_mul_f32 v241, v241, v85
v_mul_f32 v242, v242, v86
v_mul_f32 v243, v243, v87
s_add_u32 m0, s39, 99328
s_add_u32 s37, s37, s38
buffer_load_dwordx4 v23, s[8:11], s37 offen sc1 lds
v_cvt_pk_bf16_f32 v98, v240, v241
v_cvt_pk_bf16_f32 v99, v242, v243
s_add_u32 m0, s39, 100352
s_add_u32 s37, s37, s38
buffer_load_dwordx4 v22, s[8:11], s37 offen sc1 lds
v_fma_f32 v164, -v33, v56, v164
v_fma_f32 v165, -v33, v57, v165
v_fma_f32 v166, -v33, v58, v166
s_add_u32 m0, s39, 101376
s_add_u32 s37, s37, s38
buffer_load_dwordx4 v23, s[8:11], s37 offen sc1 lds
v_fma_f32 v167, -v33, v59, v167
v_fma_f32 v228, -v33, v72, v228
v_fma_f32 v229, -v33, v73, v229
s_add_u32 m0, s39, 102400
s_add_u32 s37, s37, s38
buffer_load_dwordx4 v22, s[8:11], s37 offen sc1 lds
v_fma_f32 v230, -v33, v74, v230
v_fma_f32 v231, -v33, v75, v231
v_mul_f32 v80, v164, v164
v_mul_f32 v81, v165, v165
s_add_u32 m0, s39, 103424
s_add_u32 s37, s37, s38
buffer_load_dwordx4 v23, s[8:11], s37 offen sc1 lds
v_mul_f32 v82, v166, v166
v_mul_f32 v83, v167, v167
v_fma_f32 v80, v80, v41, v37
s_add_u32 m0, s39, 104448
s_add_u32 s37, s37, s38
buffer_load_dwordx4 v22, s[8:11], s37 offen sc1 lds
v_fma_f32 v81, v81, v41, v37
v_fma_f32 v82, v82, v41, v37
v_fma_f32 v83, v83, v41, v37
s_add_u32 m0, s39, 105472
s_add_u32 s37, s37, s38
buffer_load_dwordx4 v23, s[8:11], s37 offen sc1 lds
v_mul_f32 v80, v80, v164
v_mul_f32 v81, v81, v165
v_mul_f32 v82, v82, v166
s_add_u32 m0, s39, 106496
s_add_u32 s37, s37, s38
buffer_load_dwordx4 v22, s[8:11], s37 offen sc1 lds
v_mul_f32 v83, v83, v167
v_exp_f32 v80, v80
v_exp_f32 v81, v81
v_exp_f32 v82, v82
s_add_u32 m0, s39, 107520
s_add_u32 s37, s37, s38
buffer_load_dwordx4 v23, s[8:11], s37 offen sc1 lds
v_exp_f32 v83, v83
v_mul_f32 v228, v164, v228
v_mul_f32 v229, v165, v229
s_add_u32 m0, s39, 108544
s_add_u32 s37, s37, s38
buffer_load_dwordx4 v22, s[8:11], s37 offen sc1 lds
v_mul_f32 v230, v166, v230
v_mul_f32 v231, v167, v231
v_fma_f32 v80, v80, v45, v45
s_add_u32 m0, s39, 109568
s_add_u32 s37, s37, s38
buffer_load_dwordx4 v23, s[8:11], s37 offen sc1 lds
v_fma_f32 v81, v81, v45, v45
v_fma_f32 v82, v82, v45, v45
v_fma_f32 v83, v83, v45, v45
s_add_u32 m0, s39, 110592
s_add_u32 s37, s37, s38
buffer_load_dwordx4 v22, s[8:11], s37 offen sc1 lds
v_rcp_f32 v80, v80
v_rcp_f32 v81, v81
v_rcp_f32 v82, v82
v_rcp_f32 v83, v83
s_add_u32 m0, s39, 111616
s_add_u32 s37, s37, s38
buffer_load_dwordx4 v23, s[8:11], s37 offen sc1 lds
v_mul_f32 v228, v228, v80
v_mul_f32 v229, v229, v81
v_mul_f32 v230, v230, v82
s_add_u32 m0, s39, 112640
s_add_u32 s37, s37, s38
buffer_load_dwordx4 v22, s[8:11], s37 offen sc1 lds
v_mul_f32 v231, v231, v83
v_cvt_pk_bf16_f32 v100, v228, v229
v_cvt_pk_bf16_f32 v101, v230, v231
s_add_u32 m0, s39, 113664
s_add_u32 s37, s37, s38
buffer_load_dwordx4 v23, s[8:11], s37 offen sc1 lds
v_fma_f32 v180, -v33, v60, v180
v_fma_f32 v181, -v33, v61, v181
v_fma_f32 v182, -v33, v62, v182
buffer_store_dwordx4 v[96:99], v27, s[24:27], s53 offen offset:0 sc1
s_waitcnt vmcnt(20)
s_barrier
s_add_u32 s42, s42, 1
s_and_b32 s42, s42, 15
s_add_u32 m0, s39, 0
s_mul_i32 s37, s42, s40
buffer_load_dwordx4 v22, s[8:11], s37 offen sc1 lds
v_fma_f32 v183, -v33, v63, v183
v_fma_f32 v244, -v33, v76, v244
v_fma_f32 v245, -v33, v77, v245
v_fma_f32 v246, -v33, v78, v246
s_add_u32 m0, s39, 1024
s_add_u32 s37, s37, s38
buffer_load_dwordx4 v23, s[8:11], s37 offen sc1 lds
v_fma_f32 v247, -v33, v79, v247
v_mul_f32 v84, v180, v180
v_mul_f32 v85, v181, v181
s_add_u32 m0, s39, 2048
s_add_u32 s37, s37, s38
buffer_load_dwordx4 v22, s[8:11], s37 offen sc1 lds
v_mul_f32 v86, v182, v182
v_mul_f32 v87, v183, v183
v_fma_f32 v84, v84, v41, v37
s_add_u32 m0, s39, 3072
s_add_u32 s37, s37, s38
buffer_load_dwordx4 v23, s[8:11], s37 offen sc1 lds
v_fma_f32 v85, v85, v41, v37
v_fma_f32 v86, v86, v41, v37
v_fma_f32 v87, v87, v41, v37
v_mul_f32 v84, v84, v180
s_add_u32 m0, s39, 4096
s_add_u32 s37, s37, s38
buffer_load_dwordx4 v22, s[8:11], s37 offen sc1 lds
v_mul_f32 v85, v85, v181
v_mul_f32 v86, v86, v182
v_mul_f32 v87, v87, v183
s_add_u32 m0, s39, 5120
s_add_u32 s37, s37, s38
buffer_load_dwordx4 v23, s[8:11], s37 offen sc1 lds
v_exp_f32 v84, v84
v_exp_f32 v85, v85
v_exp_f32 v86, v86
s_add_u32 m0, s39, 6144
s_add_u32 s37, s37, s38
buffer_load_dwordx4 v22, s[8:11], s37 offen sc1 lds
v_exp_f32 v87, v87
v_mul_f32 v244, v180, v244
v_mul_f32 v245, v181, v245
v_mul_f32 v246, v182, v246
s_add_u32 m0, s39, 7168
s_add_u32 s37, s37, s38
buffer_load_dwordx4 v23, s[8:11], s37 offen sc1 lds
v_mul_f32 v247, v183, v247
v_fma_f32 v84, v84, v45, v45
v_fma_f32 v85, v85, v45, v45
s_add_u32 m0, s39, 8192
s_add_u32 s37, s37, s38
buffer_load_dwordx4 v22, s[8:11], s37 offen sc1 lds
v_fma_f32 v86, v86, v45, v45
v_fma_f32 v87, v87, v45, v45
v_rcp_f32 v84, v84
s_add_u32 m0, s39, 9216
s_add_u32 s37, s37, s38
buffer_load_dwordx4 v23, s[8:11], s37 offen sc1 lds
v_rcp_f32 v85, v85
v_rcp_f32 v86, v86
v_rcp_f32 v87, v87
v_mul_f32 v244, v244, v84
s_add_u32 m0, s39, 10240
s_add_u32 s37, s37, s38
buffer_load_dwordx4 v22, s[8:11], s37 offen sc1 lds
v_mul_f32 v245, v245, v85
v_mul_f32 v246, v246, v86
v_mul_f32 v247, v247, v87
s_add_u32 m0, s39, 11264
s_add_u32 s37, s37, s38
buffer_load_dwordx4 v23, s[8:11], s37 offen sc1 lds
v_cvt_pk_bf16_f32 v102, v244, v245
v_cvt_pk_bf16_f32 v103, v246, v247
s_add_u32 m0, s39, 12288
s_add_u32 s37, s37, s38
buffer_load_dwordx4 v22, s[8:11], s37 offen sc1 lds
v_fma_f32 v168, -v34, v56, v168
v_fma_f32 v169, -v34, v57, v169
v_fma_f32 v170, -v34, v58, v170
v_fma_f32 v171, -v34, v59, v171
s_add_u32 m0, s39, 13312
s_add_u32 s37, s37, s38
buffer_load_dwordx4 v23, s[8:11], s37 offen sc1 lds
v_fma_f32 v232, -v34, v72, v232
v_fma_f32 v233, -v34, v73, v233
v_fma_f32 v234, -v34, v74, v234
s_add_u32 m0, s39, 14336
s_add_u32 s37, s37, s38
buffer_load_dwordx4 v22, s[8:11], s37 offen sc1 lds
v_fma_f32 v235, -v34, v75, v235
v_mul_f32 v80, v168, v168
v_mul_f32 v81, v169, v169
s_add_u32 m0, s39, 15360
s_add_u32 s37, s37, s38
buffer_load_dwordx4 v23, s[8:11], s37 offen sc1 lds
v_mul_f32 v82, v170, v170
v_mul_f32 v83, v171, v171
v_fma_f32 v80, v80, v42, v38
buffer_store_dwordx4 v[100:103], v27, s[24:27], s53 offen offset:256 sc1
s_waitcnt vmcnt(18)
s_barrier
s_add_u32 s42, s42, 1
s_and_b32 s42, s42, 15
s_add_u32 m0, s39, 49152
s_mul_i32 s37, s42, s40
buffer_load_dwordx4 v22, s[8:11], s37 offen sc1 lds
v_fma_f32 v81, v81, v42, v38
v_fma_f32 v82, v82, v42, v38
v_fma_f32 v83, v83, v42, v38
v_mul_f32 v80, v80, v168
s_add_u32 m0, s39, 50176
s_add_u32 s37, s37, s38
buffer_load_dwordx4 v23, s[8:11], s37 offen sc1 lds
v_mul_f32 v81, v81, v169
v_mul_f32 v82, v82, v170
v_mul_f32 v83, v83, v171
s_add_u32 m0, s39, 51200
s_add_u32 s37, s37, s38
buffer_load_dwordx4 v22, s[8:11], s37 offen sc1 lds
v_exp_f32 v80, v80
v_exp_f32 v81, v81
v_exp_f32 v82, v82
s_add_u32 m0, s39, 52224
s_add_u32 s37, s37, s38
buffer_load_dwordx4 v23, s[8:11], s37 offen sc1 lds
v_exp_f32 v83, v83
v_mul_f32 v232, v168, v232
v_mul_f32 v233, v169, v233
s_add_u32 m0, s39, 53248
s_add_u32 s37, s37, s38
buffer_load_dwordx4 v22, s[8:11], s37 offen sc1 lds
v_mul_f32 v234, v170, v234
v_mul_f32 v235, v171, v235
v_fma_f32 v80, v80, v46, v46
v_fma_f32 v81, v81, v46, v46
s_add_u32 m0, s39, 54272
s_add_u32 s37, s37, s38
buffer_load_dwordx4 v23, s[8:11], s37 offen sc1 lds
v_fma_f32 v82, v82, v46, v46
v_fma_f32 v83, v83, v46, v46
v_rcp_f32 v80, v80
s_add_u32 m0, s39, 55296
s_add_u32 s37, s37, s38
buffer_load_dwordx4 v22, s[8:11], s37 offen sc1 lds
v_rcp_f32 v81, v81
v_rcp_f32 v82, v82
v_rcp_f32 v83, v83
s_add_u32 m0, s39, 56320
s_add_u32 s37, s37, s38
buffer_load_dwordx4 v23, s[8:11], s37 offen sc1 lds
v_mul_f32 v232, v232, v80
v_mul_f32 v233, v233, v81
v_mul_f32 v234, v234, v82
s_add_u32 m0, s39, 57344
s_add_u32 s37, s37, s38
buffer_load_dwordx4 v22, s[8:11], s37 offen sc1 lds
v_mul_f32 v235, v235, v83
v_cvt_pk_bf16_f32 v104, v232, v233
v_cvt_pk_bf16_f32 v105, v234, v235
v_fma_f32 v184, -v34, v60, v184
s_add_u32 m0, s39, 58368
s_add_u32 s37, s37, s38
buffer_load_dwordx4 v23, s[8:11], s37 offen sc1 lds
v_fma_f32 v185, -v34, v61, v185
v_fma_f32 v186, -v34, v62, v186
v_fma_f32 v187, -v34, v63, v187
s_add_u32 m0, s39, 59392
s_add_u32 s37, s37, s38
buffer_load_dwordx4 v22, s[8:11], s37 offen sc1 lds
v_fma_f32 v248, -v34, v76, v248
v_fma_f32 v249, -v34, v77, v249
v_fma_f32 v250, -v34, v78, v250
s_add_u32 m0, s39, 60416
s_add_u32 s37, s37, s38
buffer_load_dwordx4 v23, s[8:11], s37 offen sc1 lds
v_fma_f32 v251, -v34, v79, v251
v_mul_f32 v84, v184, v184
v_mul_f32 v85, v185, v185
s_add_u32 m0, s39, 61440
s_add_u32 s37, s37, s38
buffer_load_dwordx4 v22, s[8:11], s37 offen sc1 lds
v_mul_f32 v86, v186, v186
v_mul_f32 v87, v187, v187
v_fma_f32 v84, v84, v42, v38
v_fma_f32 v85, v85, v42, v38
s_add_u32 m0, s39, 62464
s_add_u32 s37, s37, s38
buffer_load_dwordx4 v23, s[8:11], s37 offen sc1 lds
v_fma_f32 v86, v86, v42, v38
v_fma_f32 v87, v87, v42, v38
v_mul_f32 v84, v84, v184
s_add_u32 m0, s39, 63488
s_add_u32 s37, s37, s38
buffer_load_dwordx4 v22, s[8:11], s37 offen sc1 lds
v_mul_f32 v85, v85, v185
v_mul_f32 v86, v86, v186
v_mul_f32 v87, v87, v187
s_add_u32 m0, s39, 64512
s_add_u32 s37, s37, s38
buffer_load_dwordx4 v23, s[8:11], s37 offen sc1 lds
v_exp_f32 v84, v84
v_exp_f32 v85, v85
v_exp_f32 v86, v86
s_waitcnt vmcnt(17)
s_barrier
s_add_u32 s42, s42, 1
s_and_b32 s42, s42, 15
s_add_u32 m0, s39, 98304
s_mul_i32 s37, s42, s40
buffer_load_dwordx4 v22, s[8:11], s37 offen sc1 lds
v_exp_f32 v87, v87
v_mul_f32 v248, v184, v248
v_mul_f32 v249, v185, v249
v_mul_f32 v250, v186, v250
s_add_u32 m0, s39, 99328
s_add_u32 s37, s37, s38
buffer_load_dwordx4 v23, s[8:11], s37 offen sc1 lds
v_mul_f32 v251, v187, v251
v_fma_f32 v84, v84, v46, v46
v_fma_f32 v85, v85, v46, v46
s_add_u32 m0, s39, 100352
s_add_u32 s37, s37, s38
buffer_load_dwordx4 v22, s[8:11], s37 offen sc1 lds
v_fma_f32 v86, v86, v46, v46
v_fma_f32 v87, v87, v46, v46
v_rcp_f32 v84, v84
s_add_u32 m0, s39, 101376
s_add_u32 s37, s37, s38
buffer_load_dwordx4 v23, s[8:11], s37 offen sc1 lds
v_rcp_f32 v85, v85
v_rcp_f32 v86, v86
v_rcp_f32 v87, v87
s_add_u32 m0, s39, 102400
s_add_u32 s37, s37, s38
buffer_load_dwordx4 v22, s[8:11], s37 offen sc1 lds
v_mul_f32 v248, v248, v84
v_mul_f32 v249, v249, v85
v_mul_f32 v250, v250, v86
v_mul_f32 v251, v251, v87
s_add_u32 m0, s39, 103424
s_add_u32 s37, s37, s38
buffer_load_dwordx4 v23, s[8:11], s37 offen sc1 lds
v_cvt_pk_bf16_f32 v106, v248, v249
v_cvt_pk_bf16_f32 v107, v250, v251
s_add_u32 m0, s39, 104448
s_add_u32 s37, s37, s38
buffer_load_dwordx4 v22, s[8:11], s37 offen sc1 lds
v_fma_f32 v172, -v35, v56, v172
v_fma_f32 v173, -v35, v57, v173
v_fma_f32 v174, -v35, v58, v174
s_add_u32 m0, s39, 105472
s_add_u32 s37, s37, s38
buffer_load_dwordx4 v23, s[8:11], s37 offen sc1 lds
v_fma_f32 v175, -v35, v59, v175
v_fma_f32 v236, -v35, v72, v236
v_fma_f32 v237, -v35, v73, v237
s_add_u32 m0, s39, 106496
s_add_u32 s37, s37, s38
buffer_load_dwordx4 v22, s[8:11], s37 offen sc1 lds
v_fma_f32 v238, -v35, v74, v238
v_fma_f32 v239, -v35, v75, v239
v_mul_f32 v80, v172, v172
v_mul_f32 v81, v173, v173
s_add_u32 m0, s39, 107520
s_add_u32 s37, s37, s38
buffer_load_dwordx4 v23, s[8:11], s37 offen sc1 lds
v_mul_f32 v82, v174, v174
v_mul_f32 v83, v175, v175
v_fma_f32 v80, v80, v43, v39
s_add_u32 m0, s39, 108544
s_add_u32 s37, s37, s38
buffer_load_dwordx4 v22, s[8:11], s37 offen sc1 lds
v_fma_f32 v81, v81, v43, v39
v_fma_f32 v82, v82, v43, v39
v_fma_f32 v83, v83, v43, v39
s_add_u32 m0, s39, 109568
s_add_u32 s37, s37, s38
buffer_load_dwordx4 v23, s[8:11], s37 offen sc1 lds
v_mul_f32 v80, v80, v172
v_mul_f32 v81, v81, v173
v_mul_f32 v82, v82, v174
s_add_u32 m0, s39, 110592
s_add_u32 s37, s37, s38
buffer_load_dwordx4 v22, s[8:11], s37 offen sc1 lds
v_mul_f32 v83, v83, v175
v_exp_f32 v80, v80
v_exp_f32 v81, v81
v_exp_f32 v82, v82
s_add_u32 m0, s39, 111616
s_add_u32 s37, s37, s38
buffer_load_dwordx4 v23, s[8:11], s37 offen sc1 lds
v_exp_f32 v83, v83
v_mul_f32 v236, v172, v236
v_mul_f32 v237, v173, v237
s_add_u32 m0, s39, 112640
s_add_u32 s37, s37, s38
buffer_load_dwordx4 v22, s[8:11], s37 offen sc1 lds
v_mul_f32 v238, v174, v238
v_mul_f32 v239, v175, v239
v_fma_f32 v80, v80, v47, v47
s_add_u32 m0, s39, 113664
s_add_u32 s37, s37, s38
buffer_load_dwordx4 v23, s[8:11], s37 offen sc1 lds
v_fma_f32 v81, v81, v47, v47
v_fma_f32 v82, v82, v47, v47
v_fma_f32 v83, v83, v47, v47
buffer_store_dwordx4 v[104:107], v27, s[24:27], s53 offen offset:512 sc1
s_waitcnt vmcnt(17)
s_barrier
s_add_u32 s42, s42, 1
s_and_b32 s42, s42, 15
s_add_u32 m0, s39, 0
s_mul_i32 s37, s42, s40
buffer_load_dwordx4 v22, s[8:11], s37 offen sc1 lds
v_rcp_f32 v80, v80
v_rcp_f32 v81, v81
v_rcp_f32 v82, v82
v_rcp_f32 v83, v83
s_add_u32 m0, s39, 1024
s_add_u32 s37, s37, s38
buffer_load_dwordx4 v23, s[8:11], s37 offen sc1 lds
v_mul_f32 v236, v236, v80
v_mul_f32 v237, v237, v81
v_mul_f32 v238, v238, v82
s_add_u32 m0, s39, 2048
s_add_u32 s37, s37, s38
buffer_load_dwordx4 v22, s[8:11], s37 offen sc1 lds
v_mul_f32 v239, v239, v83
v_cvt_pk_bf16_f32 v108, v236, v237
v_cvt_pk_bf16_f32 v109, v238, v239
s_add_u32 m0, s39, 3072
s_add_u32 s37, s37, s38
buffer_load_dwordx4 v23, s[8:11], s37 offen sc1 lds
v_fma_f32 v188, -v35, v60, v188
v_fma_f32 v189, -v35, v61, v189
v_fma_f32 v190, -v35, v62, v190
v_fma_f32 v191, -v35, v63, v191
s_add_u32 m0, s39, 4096
s_add_u32 s37, s37, s38
buffer_load_dwordx4 v22, s[8:11], s37 offen sc1 lds
v_fma_f32 v252, -v35, v76, v252
v_fma_f32 v253, -v35, v77, v253
v_fma_f32 v254, -v35, v78, v254
s_add_u32 m0, s39, 5120
s_add_u32 s37, s37, s38
buffer_load_dwordx4 v23, s[8:11], s37 offen sc1 lds
v_fma_f32 v255, -v35, v79, v255
v_mul_f32 v84, v188, v188
v_mul_f32 v85, v189, v189
s_add_u32 m0, s39, 6144
s_add_u32 s37, s37, s38
buffer_load_dwordx4 v22, s[8:11], s37 offen sc1 lds
v_mul_f32 v86, v190, v190
v_mul_f32 v87, v191, v191
v_fma_f32 v84, v84, v43, v39
v_fma_f32 v85, v85, v43, v39
s_add_u32 m0, s39, 7168
s_add_u32 s37, s37, s38
buffer_load_dwordx4 v23, s[8:11], s37 offen sc1 lds
v_fma_f32 v86, v86, v43, v39
v_fma_f32 v87, v87, v43, v39
v_mul_f32 v84, v84, v188
s_add_u32 m0, s39, 8192
s_add_u32 s37, s37, s38
buffer_load_dwordx4 v22, s[8:11], s37 offen sc1 lds
v_mul_f32 v85, v85, v189
v_mul_f32 v86, v86, v190
v_mul_f32 v87, v87, v191
s_add_u32 m0, s39, 9216
s_add_u32 s37, s37, s38
buffer_load_dwordx4 v23, s[8:11], s37 offen sc1 lds
v_exp_f32 v84, v84
v_exp_f32 v85, v85
v_exp_f32 v86, v86
v_exp_f32 v87, v87
s_add_u32 m0, s39, 10240
s_add_u32 s37, s37, s38
buffer_load_dwordx4 v22, s[8:11], s37 offen sc1 lds
v_mul_f32 v252, v188, v252
v_mul_f32 v253, v189, v253
v_mul_f32 v254, v190, v254
s_add_u32 m0, s39, 11264
s_add_u32 s37, s37, s38
buffer_load_dwordx4 v23, s[8:11], s37 offen sc1 lds
v_mul_f32 v255, v191, v255
v_fma_f32 v84, v84, v47, v47
v_fma_f32 v85, v85, v47, v47
s_add_u32 m0, s39, 12288
s_add_u32 s37, s37, s38
buffer_load_dwordx4 v22, s[8:11], s37 offen sc1 lds
v_fma_f32 v86, v86, v47, v47
v_fma_f32 v87, v87, v47, v47
v_rcp_f32 v84, v84
v_rcp_f32 v85, v85
s_add_u32 m0, s39, 13312
s_add_u32 s37, s37, s38
buffer_load_dwordx4 v23, s[8:11], s37 offen sc1 lds
v_rcp_f32 v86, v86
v_rcp_f32 v87, v87
v_mul_f32 v252, v252, v84
s_add_u32 m0, s39, 14336
s_add_u32 s37, s37, s38
buffer_load_dwordx4 v22, s[8:11], s37 offen sc1 lds
v_mul_f32 v253, v253, v85
v_mul_f32 v254, v254, v86
v_mul_f32 v255, v255, v87
s_add_u32 m0, s39, 15360
s_add_u32 s37, s37, s38
buffer_load_dwordx4 v23, s[8:11], s37 offen sc1 lds
v_cvt_pk_bf16_f32 v110, v252, v253
v_cvt_pk_bf16_f32 v111, v254, v255
buffer_store_dwordx4 v[108:111], v27, s[24:27], s53 offen offset:768 sc1
s_waitcnt vmcnt(18)
s_barrier
s_mul_i32 s44, s34, 917504
s_lshl_b32 s39, s51, 13
s_add_u32 s44, s44, s39
s_add_u32 s44, s44, 8388608
s_and_b32 s43, s51, 1
s_xor_b32 s43, s43, s35
s_lshl_b32 s43, s43, 7
s_mov_b32 s10, 909312
s_movk_i32 s38, 1024
s_movk_i32 s40, 9216
s_movk_i32 s37, 0x4000
s_cmp_ge_u32 s51, 2
s_cselect_b32 s8, s60, s32
s_cselect_b32 s9, s61, s33
s_cselect_b32 s10, 7338112, s10
s_cselect_b32 s43, s43, s44
s_cselect_b32 s38, 16384, s38
s_cselect_b32 s40, 81920, s40
s_cselect_b32 s55, 81920, s38
s_cselect_b32 s37, 262144, s37
s_cselect_b32 s45, -1, 0
s_add_u32 s8, s8, s43
s_addc_u32 s9, s9, 0
s_mov_b32 s11, 0x20000
s_and_b32 s53, s35, 1
s_mul_i32 s54, s53, 6
s_mul_i32 s54, s54, s37
s_mul_i32 s29, s53, 2
s_add_u32 s29, s29, 6
s_mul_i32 s29, s29, s37
s_and_b32 s43, s45, 4290838528
s_add_u32 s29, s29, s43
s_mul_i32 s37, s37, 0
s_sub_u32 s37, s37, s40
v_lshrrev_b32 v19, 3, v1
v_mul_u32_u24 v19, 1920, v19
v_lshrrev_b32 v20, 4, v1
v_lshlrev_b32 v20, 5, v20
v_and_b32 v19, s45, v19
v_and_b32 v20, s45, v20
v_lshlrev_b32 v21, 4, v1
v_xor_b32 v21, v21, v20
v_add_u32 v21, v21, v19
s_mov_b64 s[72:73], -1
s_add_u32 m0, s39, 65536
s_add_u32 s37, s37, s40
buffer_load_dwordx4 v21, s[8:11], s37 offen sc1 lds
v_lshlrev_b32 v128, 16, v192
v_and_b32 v129, 0xffff0000, v192
v_lshlrev_b32 v130, 16, v193
v_and_b32 v131, 0xffff0000, v193
s_add_u32 m0, s39, 66560
s_add_u32 s37, s37, s38
buffer_load_dwordx4 v21, s[8:11], s37 offen sc1 lds
v_lshlrev_b32 v132, 16, v194
v_and_b32 v133, 0xffff0000, v194
v_lshlrev_b32 v134, 16, v195
v_and_b32 v135, 0xffff0000, v195
s_add_u32 m0, s39, 67584
s_add_u32 s37, s37, s38
buffer_load_dwordx4 v21, s[8:11], s37 offen sc1 lds
v_lshlrev_b32 v136, 16, v196
v_and_b32 v137, 0xffff0000, v196
v_lshlrev_b32 v138, 16, v197
v_and_b32 v139, 0xffff0000, v197
s_add_u32 m0, s39, 68608
s_add_u32 s37, s37, s38
buffer_load_dwordx4 v21, s[8:11], s37 offen sc1 lds
v_lshlrev_b32 v140, 16, v198
v_and_b32 v141, 0xffff0000, v198
v_lshlrev_b32 v142, 16, v199
v_and_b32 v143, 0xffff0000, v199
s_add_u32 m0, s39, 69632
s_add_u32 s37, s37, s55
buffer_load_dwordx4 v21, s[8:11], s37 offen sc1 lds
v_lshlrev_b32 v144, 16, v200
v_and_b32 v145, 0xffff0000, v200
v_lshlrev_b32 v146, 16, v201
v_and_b32 v147, 0xffff0000, v201
s_add_u32 m0, s39, 70656
s_add_u32 s37, s37, s38
buffer_load_dwordx4 v21, s[8:11], s37 offen sc1 lds
v_lshlrev_b32 v148, 16, v202
v_and_b32 v149, 0xffff0000, v202
v_lshlrev_b32 v150, 16, v203
v_and_b32 v151, 0xffff0000, v203
s_add_u32 m0, s39, 71680
s_add_u32 s37, s37, s38
buffer_load_dwordx4 v21, s[8:11], s37 offen sc1 lds
v_lshlrev_b32 v152, 16, v204
v_and_b32 v153, 0xffff0000, v204
v_lshlrev_b32 v154, 16, v205
v_and_b32 v155, 0xffff0000, v205
s_add_u32 m0, s39, 72704
s_add_u32 s37, s37, s38
buffer_load_dwordx4 v21, s[8:11], s37 offen sc1 lds
v_lshlrev_b32 v156, 16, v206
v_and_b32 v157, 0xffff0000, v206
v_lshlrev_b32 v158, 16, v207
v_and_b32 v159, 0xffff0000, v207
s_waitcnt vmcnt(8)
s_barrier
s_add_u32 m0, s39, 98304
s_add_u32 s37, s37, s40
buffer_load_dwordx4 v21, s[8:11], s37 offen sc1 lds
v_mov_b32 v192, 0
v_mov_b32 v193, 0
v_mov_b32 v194, 0
v_mov_b32 v195, 0
s_add_u32 m0, s39, 99328
s_add_u32 s37, s37, s38
buffer_load_dwordx4 v21, s[8:11], s37 offen sc1 lds
v_mov_b32 v196, 0
v_mov_b32 v197, 0
v_mov_b32 v198, 0
v_mov_b32 v199, 0
s_add_u32 m0, s39, 100352
s_add_u32 s37, s37, s38
buffer_load_dwordx4 v21, s[8:11], s37 offen sc1 lds
v_mov_b32 v200, 0
v_mov_b32 v201, 0
v_mov_b32 v202, 0
v_mov_b32 v203, 0
s_add_u32 m0, s39, 101376
s_add_u32 s37, s37, s38
buffer_load_dwordx4 v21, s[8:11], s37 offen sc1 lds
v_mov_b32 v204, 0
v_mov_b32 v205, 0
v_mov_b32 v206, 0
v_mov_b32 v207, 0
s_add_u32 m0, s39, 102400
s_add_u32 s37, s37, s55
buffer_load_dwordx4 v21, s[8:11], s37 offen sc1 lds
v_mov_b32 v208, 0
v_mov_b32 v209, 0
v_mov_b32 v210, 0
v_mov_b32 v211, 0
s_add_u32 m0, s39, 103424
s_add_u32 s37, s37, s38
buffer_load_dwordx4 v21, s[8:11], s37 offen sc1 lds
v_mov_b32 v212, 0
v_mov_b32 v213, 0
v_mov_b32 v214, 0
v_mov_b32 v215, 0
s_add_u32 m0, s39, 104448
s_add_u32 s37, s37, s38
buffer_load_dwordx4 v21, s[8:11], s37 offen sc1 lds
v_mov_b32 v216, 0
v_mov_b32 v217, 0
v_mov_b32 v218, 0
v_mov_b32 v219, 0
s_add_u32 m0, s39, 105472
s_add_u32 s37, s37, s38
buffer_load_dwordx4 v21, s[8:11], s37 offen sc1 lds
v_mov_b32 v220, 0
v_mov_b32 v221, 0
v_mov_b32 v222, 0
v_mov_b32 v223, 0
s_waitcnt vmcnt(8)
s_barrier
s_branch LK4_125
.p2align 6
Lw_155:
s_branch Lr_156
s_nop 0
.p2align 3
L3h_124:
v_mfma_f32_16x16x32_bf16 v[128:131], v[96:99], v[80:83], v[128:131]
s_lshl_b32 s43, s46, 9
v_mfma_f32_16x16x32_bf16 v[132:135], v[96:99], v[84:87], v[132:135]
s_add_u32 s43, s43, 147456
v_mfma_f32_16x16x32_bf16 v[136:139], v[96:99], v[88:91], v[136:139]
v_lshl_add_u32 v19, v17, 3, s43
v_mfma_f32_16x16x32_bf16 v[140:143], v[96:99], v[92:95], v[140:143]
ds_read_b64 v[2:3], v19 offset:0
v_mfma_f32_16x16x32_bf16 v[204:207], v[112:115], v[92:95], v[204:207]
ds_read_b64 v[4:5], v19 offset:128
v_mfma_f32_16x16x32_bf16 v[200:203], v[112:115], v[88:91], v[200:203]
ds_read_b64 v[6:7], v19 offset:256
v_mfma_f32_16x16x32_bf16 v[196:199], v[112:115], v[84:87], v[196:199]
ds_read_b64 v[8:9], v19 offset:384
v_mfma_f32_16x16x32_bf16 v[192:195], v[112:115], v[80:83], v[192:195]
s_mul_i32 s43, s47, 256
v_mfma_f32_16x16x32_bf16 v[144:147], v[100:103], v[80:83], v[144:147]
s_add_u32 s43, s43, 148480
v_mfma_f32_16x16x32_bf16 v[148:151], v[100:103], v[84:87], v[148:151]
v_lshl_add_u32 v19, v18, 4, s43
v_mfma_f32_16x16x32_bf16 v[152:155], v[100:103], v[88:91], v[152:155]
ds_read_b128 v[48:51], v19 offset:0
v_mfma_f32_16x16x32_bf16 v[156:159], v[100:103], v[92:95], v[156:159]
ds_read_b128 v[52:55], v19 offset:64
v_mfma_f32_16x16x32_bf16 v[220:223], v[116:119], v[92:95], v[220:223]
ds_read_b128 v[56:59], v19 offset:128
v_mfma_f32_16x16x32_bf16 v[216:219], v[116:119], v[88:91], v[216:219]
ds_read_b128 v[60:63], v19 offset:192
v_mfma_f32_16x16x32_bf16 v[212:215], v[116:119], v[84:87], v[212:215]
ds_read_b128 v[64:67], v19 offset:896
v_mfma_f32_16x16x32_bf16 v[208:211], v[116:119], v[80:83], v[208:211]
ds_read_b128 v[68:71], v19 offset:960
v_mfma_f32_16x16x32_bf16 v[160:163], v[104:107], v[80:83], v[160:163]
ds_read_b128 v[72:75], v19 offset:1024
v_mfma_f32_16x16x32_bf16 v[164:167], v[104:107], v[84:87], v[164:167]
ds_read_b128 v[76:79], v19 offset:1088
v_mfma_f32_16x16x32_bf16 v[168:171], v[104:107], v[88:91], v[168:171]
v_mfma_f32_16x16x32_bf16 v[172:175], v[104:107], v[92:95], v[172:175]
v_mfma_f32_16x16x32_bf16 v[236:239], v[120:123], v[92:95], v[236:239]
v_mfma_f32_16x16x32_bf16 v[232:235], v[120:123], v[88:91], v[232:235]
v_mfma_f32_16x16x32_bf16 v[228:231], v[120:123], v[84:87], v[228:231]
v_mfma_f32_16x16x32_bf16 v[224:227], v[120:123], v[80:83], v[224:227]
v_mfma_f32_16x16x32_bf16 v[176:179], v[108:111], v[80:83], v[176:179]
v_mfma_f32_16x16x32_bf16 v[180:183], v[108:111], v[84:87], v[180:183]
v_mfma_f32_16x16x32_bf16 v[184:187], v[108:111], v[88:91], v[184:187]
v_mfma_f32_16x16x32_bf16 v[188:191], v[108:111], v[92:95], v[188:191]
v_mfma_f32_16x16x32_bf16 v[252:255], v[124:127], v[92:95], v[252:255]
v_mfma_f32_16x16x32_bf16 v[248:251], v[124:127], v[88:91], v[248:251]
v_mfma_f32_16x16x32_bf16 v[244:247], v[124:127], v[84:87], v[244:247]
v_mfma_f32_16x16x32_bf16 v[240:243], v[124:127], v[80:83], v[240:243]
s_setprio 0
s_waitcnt lgkmcnt(0)
v_mov_b32 v32, v2
v_mul_f32 v88, v3, v3
v_mul_f32 v36, 0xc0135761, v3
v_mul_f32 v89, 0xbdd2d3e8, v3
v_rcp_f32 v44, v88
v_mul_f32 v40, v89, v88
v_mov_b32 v33, v4
v_mul_f32 v88, v5, v5
v_mul_f32 v37, 0xc0135761, v5
v_mul_f32 v89, 0xbdd2d3e8, v5
v_rcp_f32 v45, v88
v_mul_f32 v41, v89, v88
v_mov_b32 v34, v6
v_mul_f32 v88, v7, v7
v_mul_f32 v38, 0xc0135761, v7
v_mul_f32 v89, 0xbdd2d3e8, v7
v_rcp_f32 v46, v88
v_mul_f32 v42, v89, v88
v_mov_b32 v35, v8
v_mul_f32 v88, v9, v9
v_mul_f32 v39, 0xc0135761, v9
v_mul_f32 v89, 0xbdd2d3e8, v9
v_rcp_f32 v47, v88
v_mul_f32 v43, v89, v88
s_barrier
v_fma_f32 v128, -v32, v48, v128
v_fma_f32 v129, -v32, v49, v129
v_fma_f32 v130, -v32, v50, v130
v_fma_f32 v131, -v32, v51, v131
v_fma_f32 v192, -v32, v64, v192
v_fma_f32 v193, -v32, v65, v193
v_fma_f32 v194, -v32, v66, v194
v_fma_f32 v195, -v32, v67, v195
v_mul_f32 v80, v128, v128
v_mul_f32 v81, v129, v129
v_mul_f32 v82, v130, v130
v_mul_f32 v83, v131, v131
v_fma_f32 v80, v80, v40, v36
v_fma_f32 v81, v81, v40, v36
v_fma_f32 v82, v82, v40, v36
v_fma_f32 v83, v83, v40, v36
v_mul_f32 v80, v80, v128
v_mul_f32 v81, v81, v129
v_mul_f32 v82, v82, v130
v_mul_f32 v83, v83, v131
v_exp_f32 v80, v80
v_exp_f32 v81, v81
v_exp_f32 v82, v82
v_exp_f32 v83, v83
v_mul_f32 v192, v128, v192
v_mul_f32 v193, v129, v193
v_mul_f32 v194, v130, v194
v_mul_f32 v195, v131, v195
v_fma_f32 v80, v80, v44, v44
v_fma_f32 v81, v81, v44, v44
v_fma_f32 v82, v82, v44, v44
v_fma_f32 v83, v83, v44, v44
v_rcp_f32 v80, v80
v_rcp_f32 v81, v81
v_rcp_f32 v82, v82
v_rcp_f32 v83, v83
v_mul_f32 v192, v192, v80
v_mul_f32 v193, v193, v81
v_mul_f32 v194, v194, v82
v_mul_f32 v195, v195, v83
v_cvt_pk_bf16_f32 v96, v192, v193
v_cvt_pk_bf16_f32 v97, v194, v195
v_fma_f32 v144, -v32, v52, v144
v_fma_f32 v145, -v32, v53, v145
v_fma_f32 v146, -v32, v54, v146
v_fma_f32 v147, -v32, v55, v147
v_fma_f32 v208, -v32, v68, v208
v_fma_f32 v209, -v32, v69, v209
v_fma_f32 v210, -v32, v70, v210
v_fma_f32 v211, -v32, v71, v211
v_mul_f32 v84, v144, v144
v_mul_f32 v85, v145, v145
s_barrier
v_mul_f32 v86, v146, v146
v_mul_f32 v87, v147, v147
v_fma_f32 v84, v84, v40, v36
v_fma_f32 v85, v85, v40, v36
v_fma_f32 v86, v86, v40, v36
v_fma_f32 v87, v87, v40, v36
v_mul_f32 v84, v84, v144
v_mul_f32 v85, v85, v145
v_mul_f32 v86, v86, v146
v_mul_f32 v87, v87, v147
v_exp_f32 v84, v84
v_exp_f32 v85, v85
v_exp_f32 v86, v86
v_exp_f32 v87, v87
v_mul_f32 v208, v144, v208
v_mul_f32 v209, v145, v209
v_mul_f32 v210, v146, v210
v_mul_f32 v211, v147, v211
v_fma_f32 v84, v84, v44, v44
v_fma_f32 v85, v85, v44, v44
v_fma_f32 v86, v86, v44, v44
v_fma_f32 v87, v87, v44, v44
v_rcp_f32 v84, v84
v_rcp_f32 v85, v85
v_rcp_f32 v86, v86
v_rcp_f32 v87, v87
v_mul_f32 v208, v208, v84
v_mul_f32 v209, v209, v85
v_mul_f32 v210, v210, v86
v_mul_f32 v211, v211, v87
v_cvt_pk_bf16_f32 v98, v208, v209
v_cvt_pk_bf16_f32 v99, v210, v211
buffer_store_dwordx4 v[96:99], v27, s[24:27], 0 offen offset:0 sc1
v_fma_f32 v132, -v33, v48, v132
v_fma_f32 v133, -v33, v49, v133
v_fma_f32 v134, -v33, v50, v134
v_fma_f32 v135, -v33, v51, v135
v_fma_f32 v196, -v33, v64, v196
v_fma_f32 v197, -v33, v65, v197
v_fma_f32 v198, -v33, v66, v198
v_fma_f32 v199, -v33, v67, v199
v_mul_f32 v80, v132, v132
v_mul_f32 v81, v133, v133
v_mul_f32 v82, v134, v134
v_mul_f32 v83, v135, v135
v_fma_f32 v80, v80, v41, v37
v_fma_f32 v81, v81, v41, v37
v_fma_f32 v82, v82, v41, v37
v_fma_f32 v83, v83, v41, v37
v_mul_f32 v80, v80, v132
v_mul_f32 v81, v81, v133
v_mul_f32 v82, v82, v134
v_lshlrev_b32 v19, 11, v18
v_lshl_add_u32 v19, v17, 4, v19
s_lshl_b32 s43, s46, 10
v_add_u32 v2, s43, v19
v_add_u32 v3, 0x10000, v2
v_lshrrev_b32 v19, 2, v17
v_lshl_add_u32 v20, v18, 2, v19
v_bfe_u32 v21, v20, 1, 2
s_lshl_b32 s43, s47, 1
v_xor_b32 v21, s43, v21
v_lshlrev_b32 v20, 7, v20
v_lshl_add_u32 v20, v21, 5, v20
v_and_b32 v19, 3, v1
v_lshl_add_u32 v20, v19, 3, v20
v_add_u32 v5, 16384, v20
v_xor_b32 v6, 32, v5
v_add_u32 v7, 0x10000, v5
v_add_u32 v8, 0x10000, v6
s_lshl_b32 s43, s36, 12
v_lshl_add_u32 v9, v1, 4, s43
s_mov_b32 s54, 0x10000
s_movk_i32 s52, 0x1000
s_barrier
s_mov_b32 s88, s4
s_mov_b32 s89, s5
s_mov_b32 s90, 7340032
s_mov_b32 s91, 0x20000
s_mov_b32 s92, s6
s_mov_b32 s93, s7
s_mov_b32 s94, 7340032
s_mov_b32 s95, 0x20000
s_lshr_b32 s43, s35, 3
v_and_b32 v19, 1, v1
v_bfe_u32 v23, v1, 2, 2
s_lshl_b32 s44, s43, 1
s_add_u32 s44, s44, 6
v_add_u32 v23, s44, v23
s_mul_i32 s44, s43, 6
s_add_u32 s44, s44, 1
v_mad_u32_u24 v23, v19, s44, v23
s_lshl_b32 s44, s43, 10
s_lshl_b32 s43, s43, 11
s_sub_u32 s43, 6528, s43
s_lshr_b32 s45, s2, 3
s_mul_i32 s45, s45, 14336
s_add_u32 s43, s43, s45
v_mul_lo_u32 v31, v19, s44
v_bfe_u32 v19, v1, 1, 1
v_mul_u32_u24 v19, 7168, v19
v_add3_u32 v31, v31, v19, s43
v_add_u32 v19, 8, v23
v_and_b32 v19, 15, v19
v_mul_u32_u24 v19, 458752, v19
v_add_u32 v19, v19, v31
buffer_load_dword v30, v19, s[88:91], 0 offen
buffer_load_dword v30, v19, s[92:95], 0 offen
v_mul_f32 v83, v83, v135
v_exp_f32 v80, v80
v_exp_f32 v81, v81
v_exp_f32 v82, v82
v_exp_f32 v83, v83
v_mul_f32 v196, v132, v196
v_mul_f32 v197, v133, v197
v_mul_f32 v198, v134, v198
v_mul_f32 v199, v135, v199
v_fma_f32 v80, v80, v45, v45
v_fma_f32 v81, v81, v45, v45
v_fma_f32 v82, v82, v45, v45
v_fma_f32 v83, v83, v45, v45
v_rcp_f32 v80, v80
v_rcp_f32 v81, v81
v_rcp_f32 v82, v82
v_rcp_f32 v83, v83
v_mul_f32 v196, v196, v80
v_mul_f32 v197, v197, v81
v_mul_f32 v198, v198, v82
v_mul_f32 v199, v199, v83
v_cvt_pk_bf16_f32 v100, v196, v197
v_cvt_pk_bf16_f32 v101, v198, v199
v_fma_f32 v148, -v33, v52, v148
v_fma_f32 v149, -v33, v53, v149
v_fma_f32 v150, -v33, v54, v150
v_fma_f32 v151, -v33, v55, v151
v_fma_f32 v212, -v33, v68, v212
v_fma_f32 v213, -v33, v69, v213
v_fma_f32 v214, -v33, v70, v214
v_fma_f32 v215, -v33, v71, v215
v_mul_f32 v84, v148, v148
v_mul_f32 v85, v149, v149
v_mul_f32 v86, v150, v150
v_mul_f32 v87, v151, v151
v_fma_f32 v84, v84, v41, v37
v_fma_f32 v85, v85, v41, v37
v_fma_f32 v86, v86, v41, v37
v_fma_f32 v87, v87, v41, v37
v_mul_f32 v84, v84, v148
v_mul_f32 v85, v85, v149
v_mul_f32 v86, v86, v150
v_mul_f32 v87, v87, v151
v_exp_f32 v84, v84
v_exp_f32 v85, v85
v_exp_f32 v86, v86
v_exp_f32 v87, v87
v_mul_f32 v212, v148, v212
v_mul_f32 v213, v149, v213
v_mul_f32 v214, v150, v214
v_mul_f32 v215, v151, v215
v_fma_f32 v84, v84, v45, v45
s_barrier
v_fma_f32 v85, v85, v45, v45
v_fma_f32 v86, v86, v45, v45
v_fma_f32 v87, v87, v45, v45
v_rcp_f32 v84, v84
v_rcp_f32 v85, v85
v_rcp_f32 v86, v86
v_rcp_f32 v87, v87
v_mul_f32 v212, v212, v84
v_mul_f32 v213, v213, v85
v_mul_f32 v214, v214, v86
v_mul_f32 v215, v215, v87
v_cvt_pk_bf16_f32 v102, v212, v213
v_cvt_pk_bf16_f32 v103, v214, v215
buffer_store_dwordx4 v[100:103], v27, s[24:27], 0 offen offset:256 sc1
v_fma_f32 v136, -v34, v48, v136
v_fma_f32 v137, -v34, v49, v137
v_fma_f32 v138, -v34, v50, v138
v_fma_f32 v139, -v34, v51, v139
v_fma_f32 v200, -v34, v64, v200
v_fma_f32 v201, -v34, v65, v201
v_fma_f32 v202, -v34, v66, v202
v_fma_f32 v203, -v34, v67, v203
v_mul_f32 v80, v136, v136
v_mul_f32 v81, v137, v137
v_mul_f32 v82, v138, v138
v_mul_f32 v83, v139, v139
v_fma_f32 v80, v80, v42, v38
v_fma_f32 v81, v81, v42, v38
v_fma_f32 v82, v82, v42, v38
v_fma_f32 v83, v83, v42, v38
v_mul_f32 v80, v80, v136
v_mul_f32 v81, v81, v137
v_mul_f32 v82, v82, v138
v_mul_f32 v83, v83, v139
v_exp_f32 v80, v80
v_exp_f32 v81, v81
v_exp_f32 v82, v82
v_exp_f32 v83, v83
v_mul_f32 v200, v136, v200
v_mul_f32 v201, v137, v201
v_mul_f32 v202, v138, v202
v_mul_f32 v203, v139, v203
v_fma_f32 v80, v80, v46, v46
v_fma_f32 v81, v81, v46, v46
v_fma_f32 v82, v82, v46, v46
v_fma_f32 v83, v83, v46, v46
v_rcp_f32 v80, v80
v_rcp_f32 v81, v81
v_rcp_f32 v82, v82
v_rcp_f32 v83, v83
v_mul_f32 v200, v200, v80
v_mul_f32 v201, v201, v81
v_mul_f32 v202, v202, v82
s_barrier
v_mul_f32 v203, v203, v83
v_cvt_pk_bf16_f32 v104, v200, v201
v_cvt_pk_bf16_f32 v105, v202, v203
v_fma_f32 v152, -v34, v52, v152
v_fma_f32 v153, -v34, v53, v153
v_fma_f32 v154, -v34, v54, v154
v_fma_f32 v155, -v34, v55, v155
v_fma_f32 v216, -v34, v68, v216
v_fma_f32 v217, -v34, v69, v217
v_fma_f32 v218, -v34, v70, v218
v_fma_f32 v219, -v34, v71, v219
v_mul_f32 v84, v152, v152
v_mul_f32 v85, v153, v153
v_mul_f32 v86, v154, v154
v_mul_f32 v87, v155, v155
v_fma_f32 v84, v84, v42, v38
v_fma_f32 v85, v85, v42, v38
v_fma_f32 v86, v86, v42, v38
v_fma_f32 v87, v87, v42, v38
v_mul_f32 v84, v84, v152
v_mul_f32 v85, v85, v153
v_mul_f32 v86, v86, v154
v_mul_f32 v87, v87, v155
v_exp_f32 v84, v84
v_exp_f32 v85, v85
v_exp_f32 v86, v86
v_exp_f32 v87, v87
v_mul_f32 v216, v152, v216
v_mul_f32 v217, v153, v217
v_mul_f32 v218, v154, v218
v_mul_f32 v219, v155, v219
v_fma_f32 v84, v84, v46, v46
v_fma_f32 v85, v85, v46, v46
v_fma_f32 v86, v86, v46, v46
v_fma_f32 v87, v87, v46, v46
v_rcp_f32 v84, v84
v_rcp_f32 v85, v85
v_rcp_f32 v86, v86
v_rcp_f32 v87, v87
v_mul_f32 v216, v216, v84
v_mul_f32 v217, v217, v85
v_mul_f32 v218, v218, v86
v_mul_f32 v219, v219, v87
v_cvt_pk_bf16_f32 v106, v216, v217
v_cvt_pk_bf16_f32 v107, v218, v219
buffer_store_dwordx4 v[104:107], v27, s[24:27], 0 offen offset:512 sc1
v_fma_f32 v140, -v35, v48, v140
v_fma_f32 v141, -v35, v49, v141
v_fma_f32 v142, -v35, v50, v142
v_fma_f32 v143, -v35, v51, v143
v_fma_f32 v204, -v35, v64, v204
v_fma_f32 v205, -v35, v65, v205
s_barrier
v_fma_f32 v206, -v35, v66, v206
v_fma_f32 v207, -v35, v67, v207
v_mul_f32 v80, v140, v140
v_mul_f32 v81, v141, v141
v_mul_f32 v82, v142, v142
v_mul_f32 v83, v143, v143
v_fma_f32 v80, v80, v43, v39
v_fma_f32 v81, v81, v43, v39
v_fma_f32 v82, v82, v43, v39
v_fma_f32 v83, v83, v43, v39
v_mul_f32 v80, v80, v140
v_mul_f32 v81, v81, v141
v_mul_f32 v82, v82, v142
v_mul_f32 v83, v83, v143
v_exp_f32 v80, v80
v_exp_f32 v81, v81
v_exp_f32 v82, v82
v_exp_f32 v83, v83
v_mul_f32 v204, v140, v204
v_mul_f32 v205, v141, v205
v_mul_f32 v206, v142, v206
v_mul_f32 v207, v143, v207
v_fma_f32 v80, v80, v47, v47
v_fma_f32 v81, v81, v47, v47
v_fma_f32 v82, v82, v47, v47
v_fma_f32 v83, v83, v47, v47
v_rcp_f32 v80, v80
v_rcp_f32 v81, v81
v_rcp_f32 v82, v82
v_rcp_f32 v83, v83
v_mul_f32 v204, v204, v80
v_mul_f32 v205, v205, v81
v_mul_f32 v206, v206, v82
v_mul_f32 v207, v207, v83
v_cvt_pk_bf16_f32 v108, v204, v205
v_cvt_pk_bf16_f32 v109, v206, v207
v_fma_f32 v156, -v35, v52, v156
v_fma_f32 v157, -v35, v53, v157
v_fma_f32 v158, -v35, v54, v158
v_fma_f32 v159, -v35, v55, v159
v_fma_f32 v220, -v35, v68, v220
v_fma_f32 v221, -v35, v69, v221
v_fma_f32 v222, -v35, v70, v222
v_fma_f32 v223, -v35, v71, v223
v_mul_f32 v84, v156, v156
v_mul_f32 v85, v157, v157
v_mul_f32 v86, v158, v158
v_mul_f32 v87, v159, v159
v_fma_f32 v84, v84, v43, v39
v_fma_f32 v85, v85, v43, v39
v_fma_f32 v86, v86, v43, v39
v_fma_f32 v87, v87, v43, v39
s_barrier
s_getpc_b64 s[78:79]
Lpc_126:
s_sub_u32 s78, s78, Lpc_126-sequential_preLN__sliding_local_dilated__glu_gated_geglu__prompt_kernel
s_subb_u32 s79, s79, 0
s_lshr_b32 s43, s2, 3
s_mul_i32 s43, s43, 3840
v_min_u32 v19, 29, v1
v_lshl_add_u32 v19, v19, 7, s43
v_min_u32 v19, Ldone_1-sequential_preLN__sliding_local_dilated__glu_gated_geglu__prompt_kernel, v19
global_load_dword v30, v19, s[78:79]
s_mov_b32 s88, s4
s_mov_b32 s89, s5
s_mov_b32 s90, 7340032
s_mov_b32 s91, 0x20000
s_mov_b32 s92, s6
s_mov_b32 s93, s7
s_mov_b32 s94, 7340032
s_mov_b32 s95, 0x20000
s_lshr_b32 s43, s35, 3
v_and_b32 v19, 1, v1
v_bfe_u32 v23, v1, 2, 2
s_lshl_b32 s44, s43, 1
s_add_u32 s44, s44, 6
v_add_u32 v23, s44, v23
s_mul_i32 s44, s43, 6
s_add_u32 s44, s44, 1
v_mad_u32_u24 v23, v19, s44, v23
s_lshl_b32 s44, s43, 10
s_lshl_b32 s43, s43, 11
s_sub_u32 s43, 6528, s43
s_lshr_b32 s45, s2, 3
s_mul_i32 s45, s45, 14336
s_add_u32 s43, s43, s45
v_mul_lo_u32 v31, v19, s44
v_bfe_u32 v19, v1, 1, 1
v_mul_u32_u24 v19, 7168, v19
v_add3_u32 v31, v31, v19, s43
v_add_u32 v19, 12, v23
v_and_b32 v19, 15, v19
v_mul_u32_u24 v19, 458752, v19
v_add_u32 v19, v19, v31
buffer_load_dword v30, v19, s[88:91], 0 offen
buffer_load_dword v30, v19, s[92:95], 0 offen
v_mul_f32 v84, v84, v156
v_mul_f32 v85, v85, v157
v_mul_f32 v86, v86, v158
v_mul_f32 v87, v87, v159
v_exp_f32 v84, v84
v_exp_f32 v85, v85
v_exp_f32 v86, v86
v_exp_f32 v87, v87
v_mul_f32 v220, v156, v220
v_mul_f32 v221, v157, v221
v_mul_f32 v222, v158, v222
v_mul_f32 v223, v159, v223
v_fma_f32 v84, v84, v47, v47
v_fma_f32 v85, v85, v47, v47
v_fma_f32 v86, v86, v47, v47
v_fma_f32 v87, v87, v47, v47
v_rcp_f32 v84, v84
v_rcp_f32 v85, v85
v_rcp_f32 v86, v86
v_rcp_f32 v87, v87
v_mul_f32 v220, v220, v84
v_mul_f32 v221, v221, v85
v_mul_f32 v222, v222, v86
v_mul_f32 v223, v223, v87
v_cvt_pk_bf16_f32 v110, v220, v221
v_cvt_pk_bf16_f32 v111, v222, v223
buffer_store_dwordx4 v[108:111], v27, s[24:27], 0 offen offset:768 sc1
v_fma_f32 v160, -v32, v56, v160
v_fma_f32 v161, -v32, v57, v161
v_fma_f32 v162, -v32, v58, v162
v_fma_f32 v163, -v32, v59, v163
v_fma_f32 v224, -v32, v72, v224
v_fma_f32 v225, -v32, v73, v225
v_fma_f32 v226, -v32, v74, v226
v_fma_f32 v227, -v32, v75, v227
v_mul_f32 v80, v160, v160
v_mul_f32 v81, v161, v161
v_mul_f32 v82, v162, v162
v_mul_f32 v83, v163, v163
v_fma_f32 v80, v80, v40, v36
v_fma_f32 v81, v81, v40, v36
v_fma_f32 v82, v82, v40, v36
v_fma_f32 v83, v83, v40, v36
v_mul_f32 v80, v80, v160
v_mul_f32 v81, v81, v161
v_mul_f32 v82, v82, v162
v_mul_f32 v83, v83, v163
v_exp_f32 v80, v80
v_exp_f32 v81, v81
v_exp_f32 v82, v82
v_exp_f32 v83, v83
v_mul_f32 v224, v160, v224
v_mul_f32 v225, v161, v225
s_barrier
v_mul_f32 v226, v162, v226
v_mul_f32 v227, v163, v227
v_fma_f32 v80, v80, v44, v44
v_fma_f32 v81, v81, v44, v44
v_fma_f32 v82, v82, v44, v44
v_fma_f32 v83, v83, v44, v44
v_rcp_f32 v80, v80
v_rcp_f32 v81, v81
v_rcp_f32 v82, v82
v_rcp_f32 v83, v83
v_mul_f32 v224, v224, v80
v_mul_f32 v225, v225, v81
v_mul_f32 v226, v226, v82
v_mul_f32 v227, v227, v83
v_cvt_pk_bf16_f32 v96, v224, v225
v_cvt_pk_bf16_f32 v97, v226, v227
v_fma_f32 v176, -v32, v60, v176
v_fma_f32 v177, -v32, v61, v177
v_fma_f32 v178, -v32, v62, v178
v_fma_f32 v179, -v32, v63, v179
v_fma_f32 v240, -v32, v76, v240
v_fma_f32 v241, -v32, v77, v241
v_fma_f32 v242, -v32, v78, v242
v_fma_f32 v243, -v32, v79, v243
v_mul_f32 v84, v176, v176
v_mul_f32 v85, v177, v177
v_mul_f32 v86, v178, v178
v_mul_f32 v87, v179, v179
v_fma_f32 v84, v84, v40, v36
v_fma_f32 v85, v85, v40, v36
v_fma_f32 v86, v86, v40, v36
v_fma_f32 v87, v87, v40, v36
v_mul_f32 v84, v84, v176
v_mul_f32 v85, v85, v177
v_mul_f32 v86, v86, v178
v_mul_f32 v87, v87, v179
v_exp_f32 v84, v84
v_exp_f32 v85, v85
v_exp_f32 v86, v86
v_exp_f32 v87, v87
v_mul_f32 v240, v176, v240
v_mul_f32 v241, v177, v241
v_mul_f32 v242, v178, v242
v_mul_f32 v243, v179, v243
v_fma_f32 v84, v84, v44, v44
v_fma_f32 v85, v85, v44, v44
v_fma_f32 v86, v86, v44, v44
v_fma_f32 v87, v87, v44, v44
v_rcp_f32 v84, v84
v_rcp_f32 v85, v85
v_rcp_f32 v86, v86
v_rcp_f32 v87, v87
v_lshlrev_b32 v19, 11, v18
v_lshl_add_u32 v19, v17, 4, v19
s_lshl_b32 s43, s46, 10
s_lshl_b32 s44, s47, 13
v_add3_u32 v208, v19, s43, 0
v_add_u32 v208, s44, v208
buffer_load_dwordx4 v[192:195], v208, s[20:23], 0 offen offset:0 sc1
buffer_load_dwordx4 v[196:199], v208, s[20:23], 0 offen offset:256 sc1
buffer_load_dwordx4 v[200:203], v208, s[20:23], 0 offen offset:512 sc1
buffer_load_dwordx4 v[204:207], v208, s[20:23], 0 offen offset:768 sc1
s_waitcnt vmcnt(4)
s_barrier
s_add_u32 s43, s34, 32
s_lshl_b32 s43, s43, 7
v_mov_b32 v21, s43
v_mov_b32 v22, 1
s_mov_b64 exec, 1
buffer_atomic_add v22, v21, s[56:59], 0 offen sc1
s_mov_b64 exec, -1
v_mul_f32 v240, v240, v84
v_mul_f32 v241, v241, v85
v_mul_f32 v242, v242, v86
v_mul_f32 v243, v243, v87
v_cvt_pk_bf16_f32 v98, v240, v241
v_cvt_pk_bf16_f32 v99, v242, v243
buffer_store_dwordx4 v[96:99], v27, s[24:27], s53 offen offset:0 sc1
v_fma_f32 v164, -v33, v56, v164
v_fma_f32 v165, -v33, v57, v165
v_fma_f32 v166, -v33, v58, v166
v_fma_f32 v167, -v33, v59, v167
v_fma_f32 v228, -v33, v72, v228
v_fma_f32 v229, -v33, v73, v229
v_fma_f32 v230, -v33, v74, v230
v_fma_f32 v231, -v33, v75, v231
v_mul_f32 v80, v164, v164
v_mul_f32 v81, v165, v165
v_mul_f32 v82, v166, v166
v_mul_f32 v83, v167, v167
v_fma_f32 v80, v80, v41, v37
v_fma_f32 v81, v81, v41, v37
v_fma_f32 v82, v82, v41, v37
v_fma_f32 v83, v83, v41, v37
v_mul_f32 v80, v80, v164
v_mul_f32 v81, v81, v165
v_mul_f32 v82, v82, v166
v_mul_f32 v83, v83, v167
v_exp_f32 v80, v80
v_exp_f32 v81, v81
v_exp_f32 v82, v82
v_exp_f32 v83, v83
v_mul_f32 v228, v164, v228
v_mul_f32 v229, v165, v229
v_mul_f32 v230, v166, v230
v_mul_f32 v231, v167, v231
v_fma_f32 v80, v80, v45, v45
v_fma_f32 v81, v81, v45, v45
v_fma_f32 v82, v82, v45, v45
v_fma_f32 v83, v83, v45, v45
v_rcp_f32 v80, v80
v_rcp_f32 v81, v81
v_rcp_f32 v82, v82
v_rcp_f32 v83, v83
v_mul_f32 v228, v228, v80
v_mul_f32 v229, v229, v81
v_mul_f32 v230, v230, v82
v_mul_f32 v231, v231, v83
v_cvt_pk_bf16_f32 v100, v228, v229
v_cvt_pk_bf16_f32 v101, v230, v231
v_fma_f32 v180, -v33, v60, v180
v_fma_f32 v181, -v33, v61, v181
v_fma_f32 v182, -v33, v62, v182
s_barrier
s_mov_b32 s80, s60
s_mov_b32 s81, s61
s_mov_b32 s82, 7340032
s_mov_b32 s83, 0x20000
v_and_b32 v29, 31, v1
v_lshlrev_b32 v29, 11, v29
s_and_b32 s43, s35, 8
s_or_b32 s43, s43, 3
s_lshl_b32 s43, s43, 7
v_add_u32 v29, s43, v29
s_lshr_b32 s44, s2, 3
s_lshl_b32 s44, s44, 17
s_add_u32 s43, s44, 0
buffer_load_dword v30, v29, s[80:83], s43 offen
v_fma_f32 v183, -v33, v63, v183
v_fma_f32 v244, -v33, v76, v244
v_fma_f32 v245, -v33, v77, v245
v_fma_f32 v246, -v33, v78, v246
v_fma_f32 v247, -v33, v79, v247
v_mul_f32 v84, v180, v180
v_mul_f32 v85, v181, v181
v_mul_f32 v86, v182, v182
v_mul_f32 v87, v183, v183
v_fma_f32 v84, v84, v41, v37
v_fma_f32 v85, v85, v41, v37
v_fma_f32 v86, v86, v41, v37
v_fma_f32 v87, v87, v41, v37
v_mul_f32 v84, v84, v180
v_mul_f32 v85, v85, v181
v_mul_f32 v86, v86, v182
v_mul_f32 v87, v87, v183
v_exp_f32 v84, v84
v_exp_f32 v85, v85
v_exp_f32 v86, v86
v_exp_f32 v87, v87
v_mul_f32 v244, v180, v244
v_mul_f32 v245, v181, v245
v_mul_f32 v246, v182, v246
v_mul_f32 v247, v183, v247
v_fma_f32 v84, v84, v45, v45
v_fma_f32 v85, v85, v45, v45
v_fma_f32 v86, v86, v45, v45
v_fma_f32 v87, v87, v45, v45
v_rcp_f32 v84, v84
v_rcp_f32 v85, v85
v_rcp_f32 v86, v86
v_rcp_f32 v87, v87
v_mul_f32 v244, v244, v84
v_mul_f32 v245, v245, v85
v_mul_f32 v246, v246, v86
v_mul_f32 v247, v247, v87
v_cvt_pk_bf16_f32 v102, v244, v245
v_cvt_pk_bf16_f32 v103, v246, v247
buffer_store_dwordx4 v[100:103], v27, s[24:27], s53 offen offset:256 sc1
v_fma_f32 v168, -v34, v56, v168
v_fma_f32 v169, -v34, v57, v169
v_fma_f32 v170, -v34, v58, v170
v_fma_f32 v171, -v34, v59, v171
v_fma_f32 v232, -v34, v72, v232
v_fma_f32 v233, -v34, v73, v233
v_fma_f32 v234, -v34, v74, v234
v_fma_f32 v235, -v34, v75, v235
v_mul_f32 v80, v168, v168
v_mul_f32 v81, v169, v169
v_mul_f32 v82, v170, v170
v_mul_f32 v83, v171, v171
v_fma_f32 v80, v80, v42, v38
s_waitcnt vmcnt(2)
s_barrier
v_fma_f32 v81, v81, v42, v38
v_fma_f32 v82, v82, v42, v38
v_fma_f32 v83, v83, v42, v38
v_mul_f32 v80, v80, v168
v_mul_f32 v81, v81, v169
v_mul_f32 v82, v82, v170
v_mul_f32 v83, v83, v171
v_exp_f32 v80, v80
v_exp_f32 v81, v81
v_exp_f32 v82, v82
v_exp_f32 v83, v83
v_mul_f32 v232, v168, v232
v_mul_f32 v233, v169, v233
v_mul_f32 v234, v170, v234
v_mul_f32 v235, v171, v235
v_fma_f32 v80, v80, v46, v46
v_fma_f32 v81, v81, v46, v46
v_fma_f32 v82, v82, v46, v46
v_fma_f32 v83, v83, v46, v46
v_rcp_f32 v80, v80
v_rcp_f32 v81, v81
v_rcp_f32 v82, v82
v_rcp_f32 v83, v83
v_mul_f32 v232, v232, v80
v_mul_f32 v233, v233, v81
v_mul_f32 v234, v234, v82
v_mul_f32 v235, v235, v83
v_cvt_pk_bf16_f32 v104, v232, v233
v_cvt_pk_bf16_f32 v105, v234, v235
v_fma_f32 v184, -v34, v60, v184
v_fma_f32 v185, -v34, v61, v185
v_fma_f32 v186, -v34, v62, v186
v_fma_f32 v187, -v34, v63, v187
v_fma_f32 v248, -v34, v76, v248
v_fma_f32 v249, -v34, v77, v249
v_fma_f32 v250, -v34, v78, v250
v_fma_f32 v251, -v34, v79, v251
v_mul_f32 v84, v184, v184
v_mul_f32 v85, v185, v185
v_mul_f32 v86, v186, v186
v_mul_f32 v87, v187, v187
v_fma_f32 v84, v84, v42, v38
v_fma_f32 v85, v85, v42, v38
v_fma_f32 v86, v86, v42, v38
v_fma_f32 v87, v87, v42, v38
v_mul_f32 v84, v84, v184
v_mul_f32 v85, v85, v185
v_mul_f32 v86, v86, v186
v_mul_f32 v87, v87, v187
v_exp_f32 v84, v84
v_exp_f32 v85, v85
v_exp_f32 v86, v86
s_barrier
s_add_u32 s43, s34, 32
s_lshl_b32 s43, s43, 7
v_mov_b32 v21, s43
v_mov_b32 v23, 16
buffer_load_dword v22, v21, s[56:59], 0 offen sc1
v_exp_f32 v87, v87
v_mul_f32 v248, v184, v248
v_mul_f32 v249, v185, v249
v_mul_f32 v250, v186, v250
v_mul_f32 v251, v187, v251
v_fma_f32 v84, v84, v46, v46
v_fma_f32 v85, v85, v46, v46
v_fma_f32 v86, v86, v46, v46
v_fma_f32 v87, v87, v46, v46
v_rcp_f32 v84, v84
v_rcp_f32 v85, v85
v_rcp_f32 v86, v86
v_rcp_f32 v87, v87
v_mul_f32 v248, v248, v84
v_mul_f32 v249, v249, v85
v_mul_f32 v250, v250, v86
v_mul_f32 v251, v251, v87
v_cvt_pk_bf16_f32 v106, v248, v249
v_cvt_pk_bf16_f32 v107, v250, v251
buffer_store_dwordx4 v[104:107], v27, s[24:27], s53 offen offset:512 sc1
v_fma_f32 v172, -v35, v56, v172
v_fma_f32 v173, -v35, v57, v173
v_fma_f32 v174, -v35, v58, v174
v_fma_f32 v175, -v35, v59, v175
v_fma_f32 v236, -v35, v72, v236
v_fma_f32 v237, -v35, v73, v237
v_fma_f32 v238, -v35, v74, v238
v_fma_f32 v239, -v35, v75, v239
v_mul_f32 v80, v172, v172
v_mul_f32 v81, v173, v173
v_mul_f32 v82, v174, v174
v_mul_f32 v83, v175, v175
v_fma_f32 v80, v80, v43, v39
v_fma_f32 v81, v81, v43, v39
v_fma_f32 v82, v82, v43, v39
v_fma_f32 v83, v83, v43, v39
v_mul_f32 v80, v80, v172
v_mul_f32 v81, v81, v173
v_mul_f32 v82, v82, v174
v_mul_f32 v83, v83, v175
v_exp_f32 v80, v80
v_exp_f32 v81, v81
v_exp_f32 v82, v82
v_exp_f32 v83, v83
v_mul_f32 v236, v172, v236
v_mul_f32 v237, v173, v237
v_mul_f32 v238, v174, v238
v_mul_f32 v239, v175, v239
v_fma_f32 v80, v80, v47, v47
v_fma_f32 v81, v81, v47, v47
v_fma_f32 v82, v82, v47, v47
v_fma_f32 v83, v83, v47, v47
s_barrier
v_rcp_f32 v80, v80
v_rcp_f32 v81, v81
v_rcp_f32 v82, v82
v_rcp_f32 v83, v83
v_mul_f32 v236, v236, v80
v_mul_f32 v237, v237, v81
v_mul_f32 v238, v238, v82
v_mul_f32 v239, v239, v83
v_cvt_pk_bf16_f32 v108, v236, v237
v_cvt_pk_bf16_f32 v109, v238, v239
v_fma_f32 v188, -v35, v60, v188
v_fma_f32 v189, -v35, v61, v189
v_fma_f32 v190, -v35, v62, v190
v_fma_f32 v191, -v35, v63, v191
v_fma_f32 v252, -v35, v76, v252
v_fma_f32 v253, -v35, v77, v253
v_fma_f32 v254, -v35, v78, v254
v_fma_f32 v255, -v35, v79, v255
v_mul_f32 v84, v188, v188
v_mul_f32 v85, v189, v189
v_mul_f32 v86, v190, v190
v_mul_f32 v87, v191, v191
v_fma_f32 v84, v84, v43, v39
v_fma_f32 v85, v85, v43, v39
v_fma_f32 v86, v86, v43, v39
v_fma_f32 v87, v87, v43, v39
v_mul_f32 v84, v84, v188
v_mul_f32 v85, v85, v189
v_mul_f32 v86, v86, v190
v_mul_f32 v87, v87, v191
v_exp_f32 v84, v84
v_exp_f32 v85, v85
v_exp_f32 v86, v86
v_exp_f32 v87, v87
v_mul_f32 v252, v188, v252
v_mul_f32 v253, v189, v253
v_mul_f32 v254, v190, v254
v_mul_f32 v255, v191, v255
v_fma_f32 v84, v84, v47, v47
v_fma_f32 v85, v85, v47, v47
v_fma_f32 v86, v86, v47, v47
v_fma_f32 v87, v87, v47, v47
v_rcp_f32 v84, v84
v_rcp_f32 v85, v85
v_rcp_f32 v86, v86
v_rcp_f32 v87, v87
v_mul_f32 v252, v252, v84
v_mul_f32 v253, v253, v85
v_mul_f32 v254, v254, v86
v_mul_f32 v255, v255, v87
v_cvt_pk_bf16_f32 v110, v252, v253
v_cvt_pk_bf16_f32 v111, v254, v255
buffer_store_dwordx4 v[108:111], v27, s[24:27], s53 offen offset:768 sc1
s_mov_b32 s41, 0x10000
s_waitcnt vmcnt(2)
s_branch Lpf_129
Lpoll_127:
s_waitcnt vmcnt(0)
Lpf_129:
v_cmp_ne_u32 vcc, v23, v22
s_nop 4
s_cbranch_vccz Lpok_128
buffer_load_dword v22, v21, s[56:59], 0 offen sc1
s_sub_u32 s41, s41, 1
s_cmp_lg_u32 s41, 0
s_cbranch_scc1 Lpoll_127
s_waitcnt vmcnt(0)
Lpok_128:
s_barrier
v_lshlrev_b32 v128, 16, v192
v_and_b32 v129, 0xffff0000, v192
v_lshlrev_b32 v130, 16, v193
v_and_b32 v131, 0xffff0000, v193
v_lshlrev_b32 v132, 16, v194
v_and_b32 v133, 0xffff0000, v194
v_lshlrev_b32 v134, 16, v195
v_and_b32 v135, 0xffff0000, v195
v_lshlrev_b32 v136, 16, v196
v_and_b32 v137, 0xffff0000, v196
v_lshlrev_b32 v138, 16, v197
v_and_b32 v139, 0xffff0000, v197
v_lshlrev_b32 v140, 16, v198
v_and_b32 v141, 0xffff0000, v198
v_lshlrev_b32 v142, 16, v199
v_and_b32 v143, 0xffff0000, v199
v_lshlrev_b32 v144, 16, v200
v_and_b32 v145, 0xffff0000, v200
v_lshlrev_b32 v146, 16, v201
v_and_b32 v147, 0xffff0000, v201
v_lshlrev_b32 v148, 16, v202
v_and_b32 v149, 0xffff0000, v202
v_lshlrev_b32 v150, 16, v203
v_and_b32 v151, 0xffff0000, v203
v_lshlrev_b32 v152, 16, v204
v_and_b32 v153, 0xffff0000, v204
v_lshlrev_b32 v154, 16, v205
v_and_b32 v155, 0xffff0000, v205
v_lshlrev_b32 v156, 16, v206
v_and_b32 v157, 0xffff0000, v206
v_lshlrev_b32 v158, 16, v207
v_and_b32 v159, 0xffff0000, v207
s_waitcnt vmcnt(0)
s_barrier
s_add_u32 s43, s34, 48
s_lshl_b32 s43, s43, 7
v_mov_b32 v22, s43
v_mov_b32 v23, 1
s_mov_b64 exec, 1
buffer_atomic_add v23, v22, s[56:59], 0 offen sc1
s_mov_b64 exec, -1
s_branch Lw_130
Lr_131:
v_mov_b32 v192, 0
v_mov_b32 v193, 0
v_mov_b32 v194, 0
v_mov_b32 v195, 0
v_mov_b32 v196, 0
v_mov_b32 v197, 0
v_mov_b32 v198, 0
v_mov_b32 v199, 0
v_mov_b32 v200, 0
v_mov_b32 v201, 0
v_mov_b32 v202, 0
v_mov_b32 v203, 0
v_mov_b32 v204, 0
v_mov_b32 v205, 0
v_mov_b32 v206, 0
v_mov_b32 v207, 0
v_mov_b32 v208, 0
v_mov_b32 v209, 0
v_mov_b32 v210, 0
v_mov_b32 v211, 0
v_mov_b32 v212, 0
v_mov_b32 v213, 0
v_mov_b32 v214, 0
v_mov_b32 v215, 0
v_mov_b32 v216, 0
v_mov_b32 v217, 0
v_mov_b32 v218, 0
v_mov_b32 v219, 0
v_mov_b32 v220, 0
v_mov_b32 v221, 0
v_mov_b32 v222, 0
v_mov_b32 v223, 0
s_barrier
.p2align 3
LK4_125:
s_setprio 1
ds_read_b64_tr_b16 v[64:65], v7 offset:0
ds_read_b128 v[32:35], v3 offset:0
ds_read_b64_tr_b16 v[66:67], v7 offset:2048
ds_read_b128 v[36:39], v3 offset:256
ds_read_b64_tr_b16 v[68:69], v8 offset:0
ds_read_b128 v[40:43], v3 offset:512
ds_read_b64_tr_b16 v[70:71], v8 offset:2048
ds_read_b128 v[44:47], v3 offset:768
ds_read_b64_tr_b16 v[72:73], v7 offset:4096
ds_read_b128 v[48:51], v3 offset:8192
ds_read_b64_tr_b16 v[74:75], v7 offset:6144
ds_read_b128 v[52:55], v3 offset:8448
ds_read_b64_tr_b16 v[76:77], v8 offset:4096
ds_read_b128 v[56:59], v3 offset:8704
ds_read_b64_tr_b16 v[78:79], v8 offset:6144
ds_read_b128 v[60:63], v3 offset:8960
s_waitcnt vmcnt(0) lgkmcnt(0)
s_barrier
v_mfma_f32_16x16x32_bf16 v[128:131], v[64:67], v[32:35], v[128:131]
ds_read_b64_tr_b16 v[160:161], v7 offset:32768
v_mfma_f32_16x16x32_bf16 v[132:135], v[68:71], v[32:35], v[132:135]
ds_read_b128 v[96:99], v3 offset:32768
v_mfma_f32_16x16x32_bf16 v[136:139], v[64:67], v[36:39], v[136:139]
ds_read_b64_tr_b16 v[162:163], v7 offset:34816
v_mfma_f32_16x16x32_bf16 v[140:143], v[68:71], v[36:39], v[140:143]
ds_read_b128 v[100:103], v3 offset:33024
v_mfma_f32_16x16x32_bf16 v[144:147], v[64:67], v[40:43], v[144:147]
ds_read_b64_tr_b16 v[164:165], v8 offset:32768
v_mfma_f32_16x16x32_bf16 v[148:151], v[68:71], v[40:43], v[148:151]
ds_read_b128 v[104:107], v3 offset:33280
v_mfma_f32_16x16x32_bf16 v[152:155], v[64:67], v[44:47], v[152:155]
ds_read_b64_tr_b16 v[166:167], v8 offset:34816
v_mfma_f32_16x16x32_bf16 v[156:159], v[68:71], v[44:47], v[156:159]
ds_read_b128 v[108:111], v3 offset:33536
v_mfma_f32_16x16x32_bf16 v[128:131], v[72:75], v[48:51], v[128:131]
ds_read_b64_tr_b16 v[168:169], v7 offset:36864
v_mfma_f32_16x16x32_bf16 v[132:135], v[76:79], v[48:51], v[132:135]
ds_read_b128 v[112:115], v3 offset:40960
v_mfma_f32_16x16x32_bf16 v[136:139], v[72:75], v[52:55], v[136:139]
ds_read_b64_tr_b16 v[170:171], v7 offset:38912
v_mfma_f32_16x16x32_bf16 v[140:143], v[76:79], v[52:55], v[140:143]
ds_read_b128 v[116:119], v3 offset:41216
v_mfma_f32_16x16x32_bf16 v[144:147], v[72:75], v[56:59], v[144:147]
ds_read_b64_tr_b16 v[172:173], v8 offset:36864
v_mfma_f32_16x16x32_bf16 v[148:151], v[76:79], v[56:59], v[148:151]
ds_read_b128 v[120:123], v3 offset:41472
v_mfma_f32_16x16x32_bf16 v[152:155], v[72:75], v[60:63], v[152:155]
ds_read_b64_tr_b16 v[174:175], v8 offset:38912
v_mfma_f32_16x16x32_bf16 v[156:159], v[76:79], v[60:63], v[156:159]
ds_read_b128 v[124:127], v3 offset:41728
s_waitcnt lgkmcnt(0)
s_barrier
v_mfma_f32_16x16x32_bf16 v[128:131], v[160:163], v[96:99], v[128:131]
ds_read_b64_tr_b16 v[64:65], v5 offset:0
v_mfma_f32_16x16x32_bf16 v[132:135], v[164:167], v[96:99], v[132:135]
ds_read_b128 v[32:35], v2 offset:0
v_mfma_f32_16x16x32_bf16 v[136:139], v[160:163], v[100:103], v[136:139]
ds_read_b64_tr_b16 v[66:67], v5 offset:2048
v_mfma_f32_16x16x32_bf16 v[140:143], v[164:167], v[100:103], v[140:143]
ds_read_b128 v[36:39], v2 offset:256
v_mfma_f32_16x16x32_bf16 v[144:147], v[160:163], v[104:107], v[144:147]
ds_read_b64_tr_b16 v[68:69], v6 offset:0
v_mfma_f32_16x16x32_bf16 v[148:151], v[164:167], v[104:107], v[148:151]
ds_read_b128 v[40:43], v2 offset:512
v_mfma_f32_16x16x32_bf16 v[152:155], v[160:163], v[108:111], v[152:155]
ds_read_b64_tr_b16 v[70:71], v6 offset:2048
v_mfma_f32_16x16x32_bf16 v[156:159], v[164:167], v[108:111], v[156:159]
ds_read_b128 v[44:47], v2 offset:768
v_mfma_f32_16x16x32_bf16 v[128:131], v[168:171], v[112:115], v[128:131]
ds_read_b64_tr_b16 v[72:73], v5 offset:4096
v_mfma_f32_16x16x32_bf16 v[132:135], v[172:175], v[112:115], v[132:135]
ds_read_b128 v[48:51], v2 offset:8192
v_mfma_f32_16x16x32_bf16 v[136:139], v[168:171], v[116:119], v[136:139]
ds_read_b64_tr_b16 v[74:75], v5 offset:6144
v_mfma_f32_16x16x32_bf16 v[140:143], v[172:175], v[116:119], v[140:143]
ds_read_b128 v[52:55], v2 offset:8448
v_mfma_f32_16x16x32_bf16 v[144:147], v[168:171], v[120:123], v[144:147]
ds_read_b64_tr_b16 v[76:77], v6 offset:4096
v_mfma_f32_16x16x32_bf16 v[148:151], v[172:175], v[120:123], v[148:151]
ds_read_b128 v[56:59], v2 offset:8704
v_mfma_f32_16x16x32_bf16 v[152:155], v[168:171], v[124:127], v[152:155]
ds_read_b64_tr_b16 v[78:79], v6 offset:6144
v_mfma_f32_16x16x32_bf16 v[156:159], v[172:175], v[124:127], v[156:159]
ds_read_b128 v[60:63], v2 offset:8960
s_waitcnt lgkmcnt(0)
s_barrier
v_mfma_f32_16x16x32_bf16 v[128:131], v[64:67], v[32:35], v[128:131]
ds_read_b64_tr_b16 v[160:161], v5 offset:32768
v_mfma_f32_16x16x32_bf16 v[132:135], v[68:71], v[32:35], v[132:135]
ds_read_b128 v[96:99], v2 offset:32768
v_mfma_f32_16x16x32_bf16 v[136:139], v[64:67], v[36:39], v[136:139]
ds_read_b64_tr_b16 v[162:163], v5 offset:34816
v_mfma_f32_16x16x32_bf16 v[140:143], v[68:71], v[36:39], v[140:143]
ds_read_b128 v[100:103], v2 offset:33024
v_mfma_f32_16x16x32_bf16 v[144:147], v[64:67], v[40:43], v[144:147]
ds_read_b64_tr_b16 v[164:165], v6 offset:32768
v_mfma_f32_16x16x32_bf16 v[148:151], v[68:71], v[40:43], v[148:151]
ds_read_b128 v[104:107], v2 offset:33280
v_mfma_f32_16x16x32_bf16 v[152:155], v[64:67], v[44:47], v[152:155]
ds_read_b64_tr_b16 v[166:167], v6 offset:34816
v_mfma_f32_16x16x32_bf16 v[156:159], v[68:71], v[44:47], v[156:159]
ds_read_b128 v[108:111], v2 offset:33536
v_mfma_f32_16x16x32_bf16 v[128:131], v[72:75], v[48:51], v[128:131]
ds_read_b64_tr_b16 v[168:169], v5 offset:36864
v_mfma_f32_16x16x32_bf16 v[132:135], v[76:79], v[48:51], v[132:135]
ds_read_b128 v[112:115], v2 offset:40960
v_mfma_f32_16x16x32_bf16 v[136:139], v[72:75], v[52:55], v[136:139]
ds_read_b64_tr_b16 v[170:171], v5 offset:38912
v_mfma_f32_16x16x32_bf16 v[140:143], v[76:79], v[52:55], v[140:143]
ds_read_b128 v[116:119], v2 offset:41216
v_mfma_f32_16x16x32_bf16 v[144:147], v[72:75], v[56:59], v[144:147]
ds_read_b64_tr_b16 v[172:173], v6 offset:36864
v_mfma_f32_16x16x32_bf16 v[148:151], v[76:79], v[56:59], v[148:151]
ds_read_b128 v[120:123], v2 offset:41472
v_mfma_f32_16x16x32_bf16 v[152:155], v[72:75], v[60:63], v[152:155]
ds_read_b64_tr_b16 v[174:175], v6 offset:38912
v_mfma_f32_16x16x32_bf16 v[156:159], v[76:79], v[60:63], v[156:159]
ds_read_b128 v[124:127], v2 offset:41728
s_waitcnt lgkmcnt(0)
s_barrier
v_mfma_f32_16x16x32_bf16 v[128:131], v[160:163], v[96:99], v[128:131]
ds_read_b64_tr_b16 v[64:65], v7 offset:0
v_mfma_f32_16x16x32_bf16 v[132:135], v[164:167], v[96:99], v[132:135]
ds_read_b128 v[32:35], v3 offset:0
v_mfma_f32_16x16x32_bf16 v[136:139], v[160:163], v[100:103], v[136:139]
ds_read_b64_tr_b16 v[66:67], v7 offset:2048
v_mfma_f32_16x16x32_bf16 v[140:143], v[164:167], v[100:103], v[140:143]
ds_read_b128 v[36:39], v3 offset:256
v_mfma_f32_16x16x32_bf16 v[144:147], v[160:163], v[104:107], v[144:147]
ds_read_b64_tr_b16 v[68:69], v8 offset:0
v_mfma_f32_16x16x32_bf16 v[148:151], v[164:167], v[104:107], v[148:151]
ds_read_b128 v[40:43], v3 offset:512
v_mfma_f32_16x16x32_bf16 v[152:155], v[160:163], v[108:111], v[152:155]
ds_read_b64_tr_b16 v[70:71], v8 offset:2048
v_mfma_f32_16x16x32_bf16 v[156:159], v[164:167], v[108:111], v[156:159]
ds_read_b128 v[44:47], v3 offset:768
v_mfma_f32_16x16x32_bf16 v[128:131], v[168:171], v[112:115], v[128:131]
ds_read_b64_tr_b16 v[80:81], v7 offset:8192
v_mfma_f32_16x16x32_bf16 v[132:135], v[172:175], v[112:115], v[132:135]
ds_read_b64_tr_b16 v[82:83], v7 offset:10240
v_mfma_f32_16x16x32_bf16 v[136:139], v[168:171], v[116:119], v[136:139]
ds_read_b64_tr_b16 v[84:85], v8 offset:8192
v_mfma_f32_16x16x32_bf16 v[140:143], v[172:175], v[116:119], v[140:143]
ds_read_b64_tr_b16 v[86:87], v8 offset:10240
v_mfma_f32_16x16x32_bf16 v[144:147], v[168:171], v[120:123], v[144:147]
ds_read_b64_tr_b16 v[72:73], v7 offset:4096
v_mfma_f32_16x16x32_bf16 v[148:151], v[172:175], v[120:123], v[148:151]
ds_read_b128 v[48:51], v3 offset:8192
v_mfma_f32_16x16x32_bf16 v[152:155], v[168:171], v[124:127], v[152:155]
ds_read_b64_tr_b16 v[74:75], v7 offset:6144
v_mfma_f32_16x16x32_bf16 v[156:159], v[172:175], v[124:127], v[156:159]
ds_read_b128 v[52:55], v3 offset:8448
ds_read_b64_tr_b16 v[76:77], v8 offset:4096
ds_read_b128 v[56:59], v3 offset:8704
ds_read_b64_tr_b16 v[78:79], v8 offset:6144
ds_read_b128 v[60:63], v3 offset:8960
ds_read_b64_tr_b16 v[88:89], v7 offset:12288
ds_read_b64_tr_b16 v[90:91], v7 offset:14336
ds_read_b64_tr_b16 v[92:93], v8 offset:12288
ds_read_b64_tr_b16 v[94:95], v8 offset:14336
s_mov_b32 s41, 4
.p2align 3
Lk4_132:
s_waitcnt lgkmcnt(0)
s_barrier
v_mfma_f32_16x16x32_bf16 v[128:131], v[64:67], v[32:35], v[128:131]
ds_read_b64_tr_b16 v[160:161], v7 offset:32768
v_mfma_f32_16x16x32_bf16 v[132:135], v[68:71], v[32:35], v[132:135]
ds_read_b128 v[96:99], v3 offset:32768
v_mfma_f32_16x16x32_bf16 v[192:195], v[80:83], v[32:35], v[192:195]
ds_read_b64_tr_b16 v[162:163], v7 offset:34816
v_mfma_f32_16x16x32_bf16 v[196:199], v[84:87], v[32:35], v[196:199]
ds_read_b128 v[100:103], v3 offset:33024
v_mfma_f32_16x16x32_bf16 v[136:139], v[64:67], v[36:39], v[136:139]
ds_read_b64_tr_b16 v[164:165], v8 offset:32768
v_mfma_f32_16x16x32_bf16 v[140:143], v[68:71], v[36:39], v[140:143]
ds_read_b128 v[104:107], v3 offset:33280
v_mfma_f32_16x16x32_bf16 v[200:203], v[80:83], v[36:39], v[200:203]
ds_read_b64_tr_b16 v[166:167], v8 offset:34816
v_mfma_f32_16x16x32_bf16 v[204:207], v[84:87], v[36:39], v[204:207]
ds_read_b128 v[108:111], v3 offset:33536
v_mfma_f32_16x16x32_bf16 v[144:147], v[64:67], v[40:43], v[144:147]
ds_read_b64_tr_b16 v[176:177], v7 offset:40960
v_mfma_f32_16x16x32_bf16 v[148:151], v[68:71], v[40:43], v[148:151]
ds_read_b64_tr_b16 v[178:179], v7 offset:43008
v_mfma_f32_16x16x32_bf16 v[208:211], v[80:83], v[40:43], v[208:211]
ds_read_b64_tr_b16 v[180:181], v8 offset:40960
v_mfma_f32_16x16x32_bf16 v[212:215], v[84:87], v[40:43], v[212:215]
ds_read_b64_tr_b16 v[182:183], v8 offset:43008
v_mfma_f32_16x16x32_bf16 v[152:155], v[64:67], v[44:47], v[152:155]
ds_read_b64_tr_b16 v[168:169], v7 offset:36864
v_mfma_f32_16x16x32_bf16 v[156:159], v[68:71], v[44:47], v[156:159]
ds_read_b128 v[112:115], v3 offset:40960
v_mfma_f32_16x16x32_bf16 v[216:219], v[80:83], v[44:47], v[216:219]
ds_read_b64_tr_b16 v[170:171], v7 offset:38912
v_mfma_f32_16x16x32_bf16 v[220:223], v[84:87], v[44:47], v[220:223]
ds_read_b128 v[116:119], v3 offset:41216
v_mfma_f32_16x16x32_bf16 v[128:131], v[72:75], v[48:51], v[128:131]
ds_read_b64_tr_b16 v[172:173], v8 offset:36864
v_mfma_f32_16x16x32_bf16 v[132:135], v[76:79], v[48:51], v[132:135]
ds_read_b128 v[120:123], v3 offset:41472
v_mfma_f32_16x16x32_bf16 v[192:195], v[88:91], v[48:51], v[192:195]
ds_read_b64_tr_b16 v[174:175], v8 offset:38912
v_mfma_f32_16x16x32_bf16 v[196:199], v[92:95], v[48:51], v[196:199]
ds_read_b128 v[124:127], v3 offset:41728
v_mfma_f32_16x16x32_bf16 v[136:139], v[72:75], v[52:55], v[136:139]
ds_read_b64_tr_b16 v[184:185], v7 offset:45056
v_mfma_f32_16x16x32_bf16 v[140:143], v[76:79], v[52:55], v[140:143]
ds_read_b64_tr_b16 v[186:187], v7 offset:47104
v_mfma_f32_16x16x32_bf16 v[200:203], v[88:91], v[52:55], v[200:203]
ds_read_b64_tr_b16 v[188:189], v8 offset:45056
v_mfma_f32_16x16x32_bf16 v[204:207], v[92:95], v[52:55], v[204:207]
ds_read_b64_tr_b16 v[190:191], v8 offset:47104
v_mfma_f32_16x16x32_bf16 v[144:147], v[72:75], v[56:59], v[144:147]
v_mfma_f32_16x16x32_bf16 v[148:151], v[76:79], v[56:59], v[148:151]
v_mfma_f32_16x16x32_bf16 v[208:211], v[88:91], v[56:59], v[208:211]
v_mfma_f32_16x16x32_bf16 v[212:215], v[92:95], v[56:59], v[212:215]
v_mfma_f32_16x16x32_bf16 v[152:155], v[72:75], v[60:63], v[152:155]
v_mfma_f32_16x16x32_bf16 v[156:159], v[76:79], v[60:63], v[156:159]
v_mfma_f32_16x16x32_bf16 v[216:219], v[88:91], v[60:63], v[216:219]
v_mfma_f32_16x16x32_bf16 v[220:223], v[92:95], v[60:63], v[220:223]
s_waitcnt lgkmcnt(0)
s_barrier
v_mfma_f32_16x16x32_bf16 v[128:131], v[160:163], v[96:99], v[128:131]
ds_read_b64_tr_b16 v[64:65], v5 offset:0
v_mfma_f32_16x16x32_bf16 v[132:135], v[164:167], v[96:99], v[132:135]
ds_read_b128 v[32:35], v2 offset:0
v_mfma_f32_16x16x32_bf16 v[192:195], v[176:179], v[96:99], v[192:195]
ds_read_b64_tr_b16 v[66:67], v5 offset:2048
v_mfma_f32_16x16x32_bf16 v[196:199], v[180:183], v[96:99], v[196:199]
ds_read_b128 v[36:39], v2 offset:256
v_mfma_f32_16x16x32_bf16 v[136:139], v[160:163], v[100:103], v[136:139]
ds_read_b64_tr_b16 v[68:69], v6 offset:0
v_mfma_f32_16x16x32_bf16 v[140:143], v[164:167], v[100:103], v[140:143]
ds_read_b128 v[40:43], v2 offset:512
v_mfma_f32_16x16x32_bf16 v[200:203], v[176:179], v[100:103], v[200:203]
ds_read_b64_tr_b16 v[70:71], v6 offset:2048
v_mfma_f32_16x16x32_bf16 v[204:207], v[180:183], v[100:103], v[204:207]
ds_read_b128 v[44:47], v2 offset:768
v_mfma_f32_16x16x32_bf16 v[144:147], v[160:163], v[104:107], v[144:147]
ds_read_b64_tr_b16 v[80:81], v5 offset:8192
v_mfma_f32_16x16x32_bf16 v[148:151], v[164:167], v[104:107], v[148:151]
ds_read_b64_tr_b16 v[82:83], v5 offset:10240
v_mfma_f32_16x16x32_bf16 v[208:211], v[176:179], v[104:107], v[208:211]
ds_read_b64_tr_b16 v[84:85], v6 offset:8192
v_mfma_f32_16x16x32_bf16 v[212:215], v[180:183], v[104:107], v[212:215]
ds_read_b64_tr_b16 v[86:87], v6 offset:10240
v_mfma_f32_16x16x32_bf16 v[152:155], v[160:163], v[108:111], v[152:155]
ds_read_b64_tr_b16 v[72:73], v5 offset:4096
v_mfma_f32_16x16x32_bf16 v[156:159], v[164:167], v[108:111], v[156:159]
ds_read_b128 v[48:51], v2 offset:8192
v_mfma_f32_16x16x32_bf16 v[216:219], v[176:179], v[108:111], v[216:219]
ds_read_b64_tr_b16 v[74:75], v5 offset:6144
v_mfma_f32_16x16x32_bf16 v[220:223], v[180:183], v[108:111], v[220:223]
ds_read_b128 v[52:55], v2 offset:8448
v_mfma_f32_16x16x32_bf16 v[128:131], v[168:171], v[112:115], v[128:131]
ds_read_b64_tr_b16 v[76:77], v6 offset:4096
v_mfma_f32_16x16x32_bf16 v[132:135], v[172:175], v[112:115], v[132:135]
ds_read_b128 v[56:59], v2 offset:8704
v_mfma_f32_16x16x32_bf16 v[192:195], v[184:187], v[112:115], v[192:195]
ds_read_b64_tr_b16 v[78:79], v6 offset:6144
v_mfma_f32_16x16x32_bf16 v[196:199], v[188:191], v[112:115], v[196:199]
ds_read_b128 v[60:63], v2 offset:8960
v_mfma_f32_16x16x32_bf16 v[136:139], v[168:171], v[116:119], v[136:139]
ds_read_b64_tr_b16 v[88:89], v5 offset:12288
v_mfma_f32_16x16x32_bf16 v[140:143], v[172:175], v[116:119], v[140:143]
ds_read_b64_tr_b16 v[90:91], v5 offset:14336
v_mfma_f32_16x16x32_bf16 v[200:203], v[184:187], v[116:119], v[200:203]
ds_read_b64_tr_b16 v[92:93], v6 offset:12288
v_mfma_f32_16x16x32_bf16 v[204:207], v[188:191], v[116:119], v[204:207]
ds_read_b64_tr_b16 v[94:95], v6 offset:14336
v_mfma_f32_16x16x32_bf16 v[144:147], v[168:171], v[120:123], v[144:147]
v_mfma_f32_16x16x32_bf16 v[148:151], v[172:175], v[120:123], v[148:151]
v_mfma_f32_16x16x32_bf16 v[208:211], v[184:187], v[120:123], v[208:211]
v_mfma_f32_16x16x32_bf16 v[212:215], v[188:191], v[120:123], v[212:215]
v_mfma_f32_16x16x32_bf16 v[152:155], v[168:171], v[124:127], v[152:155]
v_mfma_f32_16x16x32_bf16 v[156:159], v[172:175], v[124:127], v[156:159]
v_mfma_f32_16x16x32_bf16 v[216:219], v[184:187], v[124:127], v[216:219]
v_mfma_f32_16x16x32_bf16 v[220:223], v[188:191], v[124:127], v[220:223]
s_waitcnt lgkmcnt(0)
s_barrier
v_mfma_f32_16x16x32_bf16 v[128:131], v[64:67], v[32:35], v[128:131]
ds_read_b64_tr_b16 v[160:161], v5 offset:32768
v_mfma_f32_16x16x32_bf16 v[132:135], v[68:71], v[32:35], v[132:135]
ds_read_b128 v[96:99], v2 offset:32768
v_mfma_f32_16x16x32_bf16 v[192:195], v[80:83], v[32:35], v[192:195]
ds_read_b64_tr_b16 v[162:163], v5 offset:34816
v_mfma_f32_16x16x32_bf16 v[196:199], v[84:87], v[32:35], v[196:199]
ds_read_b128 v[100:103], v2 offset:33024
v_mfma_f32_16x16x32_bf16 v[136:139], v[64:67], v[36:39], v[136:139]
ds_read_b64_tr_b16 v[164:165], v6 offset:32768
v_mfma_f32_16x16x32_bf16 v[140:143], v[68:71], v[36:39], v[140:143]
ds_read_b128 v[104:107], v2 offset:33280
v_mfma_f32_16x16x32_bf16 v[200:203], v[80:83], v[36:39], v[200:203]
ds_read_b64_tr_b16 v[166:167], v6 offset:34816
v_mfma_f32_16x16x32_bf16 v[204:207], v[84:87], v[36:39], v[204:207]
ds_read_b128 v[108:111], v2 offset:33536
v_mfma_f32_16x16x32_bf16 v[144:147], v[64:67], v[40:43], v[144:147]
ds_read_b64_tr_b16 v[176:177], v5 offset:40960
v_mfma_f32_16x16x32_bf16 v[148:151], v[68:71], v[40:43], v[148:151]
ds_read_b64_tr_b16 v[178:179], v5 offset:43008
v_mfma_f32_16x16x32_bf16 v[208:211], v[80:83], v[40:43], v[208:211]
ds_read_b64_tr_b16 v[180:181], v6 offset:40960
v_mfma_f32_16x16x32_bf16 v[212:215], v[84:87], v[40:43], v[212:215]
ds_read_b64_tr_b16 v[182:183], v6 offset:43008
v_mfma_f32_16x16x32_bf16 v[152:155], v[64:67], v[44:47], v[152:155]
ds_read_b64_tr_b16 v[168:169], v5 offset:36864
v_mfma_f32_16x16x32_bf16 v[156:159], v[68:71], v[44:47], v[156:159]
ds_read_b128 v[112:115], v2 offset:40960
v_mfma_f32_16x16x32_bf16 v[216:219], v[80:83], v[44:47], v[216:219]
ds_read_b64_tr_b16 v[170:171], v5 offset:38912
v_mfma_f32_16x16x32_bf16 v[220:223], v[84:87], v[44:47], v[220:223]
ds_read_b128 v[116:119], v2 offset:41216
v_mfma_f32_16x16x32_bf16 v[128:131], v[72:75], v[48:51], v[128:131]
ds_read_b64_tr_b16 v[172:173], v6 offset:36864
v_mfma_f32_16x16x32_bf16 v[132:135], v[76:79], v[48:51], v[132:135]
ds_read_b128 v[120:123], v2 offset:41472
v_mfma_f32_16x16x32_bf16 v[192:195], v[88:91], v[48:51], v[192:195]
ds_read_b64_tr_b16 v[174:175], v6 offset:38912
v_mfma_f32_16x16x32_bf16 v[196:199], v[92:95], v[48:51], v[196:199]
ds_read_b128 v[124:127], v2 offset:41728
v_mfma_f32_16x16x32_bf16 v[136:139], v[72:75], v[52:55], v[136:139]
ds_read_b64_tr_b16 v[184:185], v5 offset:45056
v_mfma_f32_16x16x32_bf16 v[140:143], v[76:79], v[52:55], v[140:143]
ds_read_b64_tr_b16 v[186:187], v5 offset:47104
v_mfma_f32_16x16x32_bf16 v[200:203], v[88:91], v[52:55], v[200:203]
ds_read_b64_tr_b16 v[188:189], v6 offset:45056
v_mfma_f32_16x16x32_bf16 v[204:207], v[92:95], v[52:55], v[204:207]
ds_read_b64_tr_b16 v[190:191], v6 offset:47104
v_mfma_f32_16x16x32_bf16 v[144:147], v[72:75], v[56:59], v[144:147]
v_mfma_f32_16x16x32_bf16 v[148:151], v[76:79], v[56:59], v[148:151]
v_mfma_f32_16x16x32_bf16 v[208:211], v[88:91], v[56:59], v[208:211]
v_mfma_f32_16x16x32_bf16 v[212:215], v[92:95], v[56:59], v[212:215]
v_mfma_f32_16x16x32_bf16 v[152:155], v[72:75], v[60:63], v[152:155]
v_mfma_f32_16x16x32_bf16 v[156:159], v[76:79], v[60:63], v[156:159]
v_mfma_f32_16x16x32_bf16 v[216:219], v[88:91], v[60:63], v[216:219]
v_mfma_f32_16x16x32_bf16 v[220:223], v[92:95], v[60:63], v[220:223]
s_waitcnt lgkmcnt(0)
s_barrier
v_mfma_f32_16x16x32_bf16 v[128:131], v[160:163], v[96:99], v[128:131]
ds_read_b64_tr_b16 v[64:65], v7 offset:0
v_mfma_f32_16x16x32_bf16 v[132:135], v[164:167], v[96:99], v[132:135]
ds_read_b128 v[32:35], v3 offset:0
v_mfma_f32_16x16x32_bf16 v[192:195], v[176:179], v[96:99], v[192:195]
ds_read_b64_tr_b16 v[66:67], v7 offset:2048
v_mfma_f32_16x16x32_bf16 v[196:199], v[180:183], v[96:99], v[196:199]
ds_read_b128 v[36:39], v3 offset:256
v_mfma_f32_16x16x32_bf16 v[136:139], v[160:163], v[100:103], v[136:139]
ds_read_b64_tr_b16 v[68:69], v8 offset:0
v_mfma_f32_16x16x32_bf16 v[140:143], v[164:167], v[100:103], v[140:143]
ds_read_b128 v[40:43], v3 offset:512
v_mfma_f32_16x16x32_bf16 v[200:203], v[176:179], v[100:103], v[200:203]
ds_read_b64_tr_b16 v[70:71], v8 offset:2048
v_mfma_f32_16x16x32_bf16 v[204:207], v[180:183], v[100:103], v[204:207]
ds_read_b128 v[44:47], v3 offset:768
v_mfma_f32_16x16x32_bf16 v[144:147], v[160:163], v[104:107], v[144:147]
ds_read_b64_tr_b16 v[80:81], v7 offset:8192
v_mfma_f32_16x16x32_bf16 v[148:151], v[164:167], v[104:107], v[148:151]
ds_read_b64_tr_b16 v[82:83], v7 offset:10240
v_mfma_f32_16x16x32_bf16 v[208:211], v[176:179], v[104:107], v[208:211]
ds_read_b64_tr_b16 v[84:85], v8 offset:8192
v_mfma_f32_16x16x32_bf16 v[212:215], v[180:183], v[104:107], v[212:215]
ds_read_b64_tr_b16 v[86:87], v8 offset:10240
v_mfma_f32_16x16x32_bf16 v[152:155], v[160:163], v[108:111], v[152:155]
ds_read_b64_tr_b16 v[72:73], v7 offset:4096
v_mfma_f32_16x16x32_bf16 v[156:159], v[164:167], v[108:111], v[156:159]
ds_read_b128 v[48:51], v3 offset:8192
v_mfma_f32_16x16x32_bf16 v[216:219], v[176:179], v[108:111], v[216:219]
ds_read_b64_tr_b16 v[74:75], v7 offset:6144
v_mfma_f32_16x16x32_bf16 v[220:223], v[180:183], v[108:111], v[220:223]
ds_read_b128 v[52:55], v3 offset:8448
v_mfma_f32_16x16x32_bf16 v[128:131], v[168:171], v[112:115], v[128:131]
ds_read_b64_tr_b16 v[76:77], v8 offset:4096
v_mfma_f32_16x16x32_bf16 v[132:135], v[172:175], v[112:115], v[132:135]
ds_read_b128 v[56:59], v3 offset:8704
v_mfma_f32_16x16x32_bf16 v[192:195], v[184:187], v[112:115], v[192:195]
ds_read_b64_tr_b16 v[78:79], v8 offset:6144
v_mfma_f32_16x16x32_bf16 v[196:199], v[188:191], v[112:115], v[196:199]
ds_read_b128 v[60:63], v3 offset:8960
v_mfma_f32_16x16x32_bf16 v[136:139], v[168:171], v[116:119], v[136:139]
ds_read_b64_tr_b16 v[88:89], v7 offset:12288
v_mfma_f32_16x16x32_bf16 v[140:143], v[172:175], v[116:119], v[140:143]
ds_read_b64_tr_b16 v[90:91], v7 offset:14336
v_mfma_f32_16x16x32_bf16 v[200:203], v[184:187], v[116:119], v[200:203]
ds_read_b64_tr_b16 v[92:93], v8 offset:12288
v_mfma_f32_16x16x32_bf16 v[204:207], v[188:191], v[116:119], v[204:207]
ds_read_b64_tr_b16 v[94:95], v8 offset:14336
v_mfma_f32_16x16x32_bf16 v[144:147], v[168:171], v[120:123], v[144:147]
v_mfma_f32_16x16x32_bf16 v[148:151], v[172:175], v[120:123], v[148:151]
v_mfma_f32_16x16x32_bf16 v[208:211], v[184:187], v[120:123], v[208:211]
v_mfma_f32_16x16x32_bf16 v[212:215], v[188:191], v[120:123], v[212:215]
v_mfma_f32_16x16x32_bf16 v[152:155], v[168:171], v[124:127], v[152:155]
v_mfma_f32_16x16x32_bf16 v[156:159], v[172:175], v[124:127], v[156:159]
v_mfma_f32_16x16x32_bf16 v[216:219], v[184:187], v[124:127], v[216:219]
v_mfma_f32_16x16x32_bf16 v[220:223], v[188:191], v[124:127], v[220:223]
s_sub_u32 s41, s41, 1
s_cmp_lg_u32 s41, 0
s_cbranch_scc1 Lk4_132
s_waitcnt lgkmcnt(0)
s_barrier
v_mfma_f32_16x16x32_bf16 v[128:131], v[64:67], v[32:35], v[128:131]
ds_read_b64_tr_b16 v[160:161], v7 offset:32768
v_mfma_f32_16x16x32_bf16 v[132:135], v[68:71], v[32:35], v[132:135]
ds_read_b128 v[96:99], v3 offset:32768
v_mfma_f32_16x16x32_bf16 v[192:195], v[80:83], v[32:35], v[192:195]
ds_read_b64_tr_b16 v[162:163], v7 offset:34816
v_mfma_f32_16x16x32_bf16 v[196:199], v[84:87], v[32:35], v[196:199]
ds_read_b128 v[100:103], v3 offset:33024
v_mfma_f32_16x16x32_bf16 v[136:139], v[64:67], v[36:39], v[136:139]
ds_read_b64_tr_b16 v[164:165], v8 offset:32768
v_mfma_f32_16x16x32_bf16 v[140:143], v[68:71], v[36:39], v[140:143]
ds_read_b128 v[104:107], v3 offset:33280
v_mfma_f32_16x16x32_bf16 v[200:203], v[80:83], v[36:39], v[200:203]
ds_read_b64_tr_b16 v[166:167], v8 offset:34816
v_mfma_f32_16x16x32_bf16 v[204:207], v[84:87], v[36:39], v[204:207]
ds_read_b128 v[108:111], v3 offset:33536
v_mfma_f32_16x16x32_bf16 v[144:147], v[64:67], v[40:43], v[144:147]
ds_read_b64_tr_b16 v[176:177], v7 offset:40960
v_mfma_f32_16x16x32_bf16 v[148:151], v[68:71], v[40:43], v[148:151]
ds_read_b64_tr_b16 v[178:179], v7 offset:43008
v_mfma_f32_16x16x32_bf16 v[208:211], v[80:83], v[40:43], v[208:211]
ds_read_b64_tr_b16 v[180:181], v8 offset:40960
v_mfma_f32_16x16x32_bf16 v[212:215], v[84:87], v[40:43], v[212:215]
ds_read_b64_tr_b16 v[182:183], v8 offset:43008
v_mfma_f32_16x16x32_bf16 v[152:155], v[64:67], v[44:47], v[152:155]
ds_read_b64_tr_b16 v[168:169], v7 offset:36864
v_mfma_f32_16x16x32_bf16 v[156:159], v[68:71], v[44:47], v[156:159]
ds_read_b128 v[112:115], v3 offset:40960
v_mfma_f32_16x16x32_bf16 v[216:219], v[80:83], v[44:47], v[216:219]
ds_read_b64_tr_b16 v[170:171], v7 offset:38912
v_mfma_f32_16x16x32_bf16 v[220:223], v[84:87], v[44:47], v[220:223]
ds_read_b128 v[116:119], v3 offset:41216
v_mfma_f32_16x16x32_bf16 v[128:131], v[72:75], v[48:51], v[128:131]
ds_read_b64_tr_b16 v[172:173], v8 offset:36864
v_mfma_f32_16x16x32_bf16 v[132:135], v[76:79], v[48:51], v[132:135]
ds_read_b128 v[120:123], v3 offset:41472
v_mfma_f32_16x16x32_bf16 v[192:195], v[88:91], v[48:51], v[192:195]
ds_read_b64_tr_b16 v[174:175], v8 offset:38912
v_mfma_f32_16x16x32_bf16 v[196:199], v[92:95], v[48:51], v[196:199]
ds_read_b128 v[124:127], v3 offset:41728
v_mfma_f32_16x16x32_bf16 v[136:139], v[72:75], v[52:55], v[136:139]
ds_read_b64_tr_b16 v[184:185], v7 offset:45056
v_mfma_f32_16x16x32_bf16 v[140:143], v[76:79], v[52:55], v[140:143]
ds_read_b64_tr_b16 v[186:187], v7 offset:47104
v_mfma_f32_16x16x32_bf16 v[200:203], v[88:91], v[52:55], v[200:203]
ds_read_b64_tr_b16 v[188:189], v8 offset:45056
v_mfma_f32_16x16x32_bf16 v[204:207], v[92:95], v[52:55], v[204:207]
ds_read_b64_tr_b16 v[190:191], v8 offset:47104
v_mfma_f32_16x16x32_bf16 v[144:147], v[72:75], v[56:59], v[144:147]
v_mfma_f32_16x16x32_bf16 v[148:151], v[76:79], v[56:59], v[148:151]
v_mfma_f32_16x16x32_bf16 v[208:211], v[88:91], v[56:59], v[208:211]
v_mfma_f32_16x16x32_bf16 v[212:215], v[92:95], v[56:59], v[212:215]
v_mfma_f32_16x16x32_bf16 v[152:155], v[72:75], v[60:63], v[152:155]
v_mfma_f32_16x16x32_bf16 v[156:159], v[76:79], v[60:63], v[156:159]
v_mfma_f32_16x16x32_bf16 v[216:219], v[88:91], v[60:63], v[216:219]
v_mfma_f32_16x16x32_bf16 v[220:223], v[92:95], v[60:63], v[220:223]
s_waitcnt lgkmcnt(0)
s_barrier
v_mfma_f32_16x16x32_bf16 v[128:131], v[160:163], v[96:99], v[128:131]
ds_read_b64_tr_b16 v[64:65], v5 offset:0
v_mfma_f32_16x16x32_bf16 v[132:135], v[164:167], v[96:99], v[132:135]
ds_read_b128 v[32:35], v2 offset:0
v_mfma_f32_16x16x32_bf16 v[192:195], v[176:179], v[96:99], v[192:195]
ds_read_b64_tr_b16 v[66:67], v5 offset:2048
v_mfma_f32_16x16x32_bf16 v[196:199], v[180:183], v[96:99], v[196:199]
ds_read_b128 v[36:39], v2 offset:256
v_mfma_f32_16x16x32_bf16 v[136:139], v[160:163], v[100:103], v[136:139]
ds_read_b64_tr_b16 v[68:69], v6 offset:0
v_mfma_f32_16x16x32_bf16 v[140:143], v[164:167], v[100:103], v[140:143]
ds_read_b128 v[40:43], v2 offset:512
v_mfma_f32_16x16x32_bf16 v[200:203], v[176:179], v[100:103], v[200:203]
ds_read_b64_tr_b16 v[70:71], v6 offset:2048
v_mfma_f32_16x16x32_bf16 v[204:207], v[180:183], v[100:103], v[204:207]
ds_read_b128 v[44:47], v2 offset:768
v_mfma_f32_16x16x32_bf16 v[144:147], v[160:163], v[104:107], v[144:147]
ds_read_b64_tr_b16 v[80:81], v5 offset:8192
v_mfma_f32_16x16x32_bf16 v[148:151], v[164:167], v[104:107], v[148:151]
ds_read_b64_tr_b16 v[82:83], v5 offset:10240
v_mfma_f32_16x16x32_bf16 v[208:211], v[176:179], v[104:107], v[208:211]
ds_read_b64_tr_b16 v[84:85], v6 offset:8192
v_mfma_f32_16x16x32_bf16 v[212:215], v[180:183], v[104:107], v[212:215]
ds_read_b64_tr_b16 v[86:87], v6 offset:10240
v_mfma_f32_16x16x32_bf16 v[152:155], v[160:163], v[108:111], v[152:155]
ds_read_b64_tr_b16 v[72:73], v5 offset:4096
v_mfma_f32_16x16x32_bf16 v[156:159], v[164:167], v[108:111], v[156:159]
ds_read_b128 v[48:51], v2 offset:8192
v_mfma_f32_16x16x32_bf16 v[216:219], v[176:179], v[108:111], v[216:219]
ds_read_b64_tr_b16 v[74:75], v5 offset:6144
v_mfma_f32_16x16x32_bf16 v[220:223], v[180:183], v[108:111], v[220:223]
ds_read_b128 v[52:55], v2 offset:8448
v_mfma_f32_16x16x32_bf16 v[128:131], v[168:171], v[112:115], v[128:131]
ds_read_b64_tr_b16 v[76:77], v6 offset:4096
v_mfma_f32_16x16x32_bf16 v[132:135], v[172:175], v[112:115], v[132:135]
ds_read_b128 v[56:59], v2 offset:8704
v_mfma_f32_16x16x32_bf16 v[192:195], v[184:187], v[112:115], v[192:195]
ds_read_b64_tr_b16 v[78:79], v6 offset:6144
v_mfma_f32_16x16x32_bf16 v[196:199], v[188:191], v[112:115], v[196:199]
ds_read_b128 v[60:63], v2 offset:8960
v_mfma_f32_16x16x32_bf16 v[136:139], v[168:171], v[116:119], v[136:139]
ds_read_b64_tr_b16 v[88:89], v5 offset:12288
v_mfma_f32_16x16x32_bf16 v[140:143], v[172:175], v[116:119], v[140:143]
ds_read_b64_tr_b16 v[90:91], v5 offset:14336
v_mfma_f32_16x16x32_bf16 v[200:203], v[184:187], v[116:119], v[200:203]
ds_read_b64_tr_b16 v[92:93], v6 offset:12288
v_mfma_f32_16x16x32_bf16 v[204:207], v[188:191], v[116:119], v[204:207]
ds_read_b64_tr_b16 v[94:95], v6 offset:14336
v_mfma_f32_16x16x32_bf16 v[144:147], v[168:171], v[120:123], v[144:147]
v_mfma_f32_16x16x32_bf16 v[148:151], v[172:175], v[120:123], v[148:151]
v_mfma_f32_16x16x32_bf16 v[208:211], v[184:187], v[120:123], v[208:211]
v_mfma_f32_16x16x32_bf16 v[212:215], v[188:191], v[120:123], v[212:215]
v_mfma_f32_16x16x32_bf16 v[152:155], v[168:171], v[124:127], v[152:155]
v_mfma_f32_16x16x32_bf16 v[156:159], v[172:175], v[124:127], v[156:159]
v_mfma_f32_16x16x32_bf16 v[216:219], v[184:187], v[124:127], v[216:219]
v_mfma_f32_16x16x32_bf16 v[220:223], v[188:191], v[124:127], v[220:223]
s_waitcnt lgkmcnt(0)
s_barrier
v_mfma_f32_16x16x32_bf16 v[128:131], v[64:67], v[32:35], v[128:131]
ds_read_b64_tr_b16 v[160:161], v5 offset:32768
v_mfma_f32_16x16x32_bf16 v[132:135], v[68:71], v[32:35], v[132:135]
ds_read_b128 v[96:99], v2 offset:32768
v_mfma_f32_16x16x32_bf16 v[192:195], v[80:83], v[32:35], v[192:195]
ds_read_b64_tr_b16 v[162:163], v5 offset:34816
v_mfma_f32_16x16x32_bf16 v[196:199], v[84:87], v[32:35], v[196:199]
ds_read_b128 v[100:103], v2 offset:33024
v_mfma_f32_16x16x32_bf16 v[136:139], v[64:67], v[36:39], v[136:139]
ds_read_b64_tr_b16 v[164:165], v6 offset:32768
v_mfma_f32_16x16x32_bf16 v[140:143], v[68:71], v[36:39], v[140:143]
ds_read_b128 v[104:107], v2 offset:33280
v_mfma_f32_16x16x32_bf16 v[200:203], v[80:83], v[36:39], v[200:203]
ds_read_b64_tr_b16 v[166:167], v6 offset:34816
v_mfma_f32_16x16x32_bf16 v[204:207], v[84:87], v[36:39], v[204:207]
ds_read_b128 v[108:111], v2 offset:33536
v_mfma_f32_16x16x32_bf16 v[144:147], v[64:67], v[40:43], v[144:147]
ds_read_b64_tr_b16 v[176:177], v5 offset:40960
v_mfma_f32_16x16x32_bf16 v[148:151], v[68:71], v[40:43], v[148:151]
ds_read_b64_tr_b16 v[178:179], v5 offset:43008
v_mfma_f32_16x16x32_bf16 v[208:211], v[80:83], v[40:43], v[208:211]
ds_read_b64_tr_b16 v[180:181], v6 offset:40960
v_mfma_f32_16x16x32_bf16 v[212:215], v[84:87], v[40:43], v[212:215]
ds_read_b64_tr_b16 v[182:183], v6 offset:43008
v_mfma_f32_16x16x32_bf16 v[152:155], v[64:67], v[44:47], v[152:155]
ds_read_b64_tr_b16 v[168:169], v5 offset:36864
v_mfma_f32_16x16x32_bf16 v[156:159], v[68:71], v[44:47], v[156:159]
ds_read_b128 v[112:115], v2 offset:40960
v_mfma_f32_16x16x32_bf16 v[216:219], v[80:83], v[44:47], v[216:219]
ds_read_b64_tr_b16 v[170:171], v5 offset:38912
v_mfma_f32_16x16x32_bf16 v[220:223], v[84:87], v[44:47], v[220:223]
ds_read_b128 v[116:119], v2 offset:41216
v_mfma_f32_16x16x32_bf16 v[128:131], v[72:75], v[48:51], v[128:131]
ds_read_b64_tr_b16 v[172:173], v6 offset:36864
v_mfma_f32_16x16x32_bf16 v[132:135], v[76:79], v[48:51], v[132:135]
ds_read_b128 v[120:123], v2 offset:41472
v_mfma_f32_16x16x32_bf16 v[192:195], v[88:91], v[48:51], v[192:195]
ds_read_b64_tr_b16 v[174:175], v6 offset:38912
v_mfma_f32_16x16x32_bf16 v[196:199], v[92:95], v[48:51], v[196:199]
ds_read_b128 v[124:127], v2 offset:41728
v_mfma_f32_16x16x32_bf16 v[136:139], v[72:75], v[52:55], v[136:139]
ds_read_b64_tr_b16 v[184:185], v5 offset:45056
v_mfma_f32_16x16x32_bf16 v[140:143], v[76:79], v[52:55], v[140:143]
ds_read_b64_tr_b16 v[186:187], v5 offset:47104
v_mfma_f32_16x16x32_bf16 v[200:203], v[88:91], v[52:55], v[200:203]
ds_read_b64_tr_b16 v[188:189], v6 offset:45056
v_mfma_f32_16x16x32_bf16 v[204:207], v[92:95], v[52:55], v[204:207]
ds_read_b64_tr_b16 v[190:191], v6 offset:47104
v_mfma_f32_16x16x32_bf16 v[144:147], v[72:75], v[56:59], v[144:147]
v_mfma_f32_16x16x32_bf16 v[148:151], v[76:79], v[56:59], v[148:151]
v_mfma_f32_16x16x32_bf16 v[208:211], v[88:91], v[56:59], v[208:211]
v_mfma_f32_16x16x32_bf16 v[212:215], v[92:95], v[56:59], v[212:215]
v_mfma_f32_16x16x32_bf16 v[152:155], v[72:75], v[60:63], v[152:155]
v_mfma_f32_16x16x32_bf16 v[156:159], v[76:79], v[60:63], v[156:159]
v_mfma_f32_16x16x32_bf16 v[216:219], v[88:91], v[60:63], v[216:219]
v_mfma_f32_16x16x32_bf16 v[220:223], v[92:95], v[60:63], v[220:223]
s_waitcnt lgkmcnt(0)
s_barrier
v_mfma_f32_16x16x32_bf16 v[128:131], v[160:163], v[96:99], v[128:131]
ds_read_b64_tr_b16 v[64:65], v7 offset:0
v_mfma_f32_16x16x32_bf16 v[132:135], v[164:167], v[96:99], v[132:135]
ds_read_b128 v[32:35], v3 offset:0
v_mfma_f32_16x16x32_bf16 v[192:195], v[176:179], v[96:99], v[192:195]
ds_read_b64_tr_b16 v[66:67], v7 offset:2048
v_mfma_f32_16x16x32_bf16 v[196:199], v[180:183], v[96:99], v[196:199]
ds_read_b128 v[36:39], v3 offset:256
v_mfma_f32_16x16x32_bf16 v[136:139], v[160:163], v[100:103], v[136:139]
ds_read_b64_tr_b16 v[68:69], v8 offset:0
v_mfma_f32_16x16x32_bf16 v[140:143], v[164:167], v[100:103], v[140:143]
ds_read_b128 v[40:43], v3 offset:512
v_mfma_f32_16x16x32_bf16 v[200:203], v[176:179], v[100:103], v[200:203]
ds_read_b64_tr_b16 v[70:71], v8 offset:2048
v_mfma_f32_16x16x32_bf16 v[204:207], v[180:183], v[100:103], v[204:207]
ds_read_b128 v[44:47], v3 offset:768
v_mfma_f32_16x16x32_bf16 v[144:147], v[160:163], v[104:107], v[144:147]
ds_read_b64_tr_b16 v[72:73], v7 offset:4096
v_mfma_f32_16x16x32_bf16 v[148:151], v[164:167], v[104:107], v[148:151]
ds_read_b128 v[48:51], v3 offset:8192
v_mfma_f32_16x16x32_bf16 v[208:211], v[176:179], v[104:107], v[208:211]
ds_read_b64_tr_b16 v[74:75], v7 offset:6144
v_mfma_f32_16x16x32_bf16 v[212:215], v[180:183], v[104:107], v[212:215]
ds_read_b128 v[52:55], v3 offset:8448
v_mfma_f32_16x16x32_bf16 v[152:155], v[160:163], v[108:111], v[152:155]
ds_read_b64_tr_b16 v[76:77], v8 offset:4096
v_mfma_f32_16x16x32_bf16 v[156:159], v[164:167], v[108:111], v[156:159]
ds_read_b128 v[56:59], v3 offset:8704
v_mfma_f32_16x16x32_bf16 v[216:219], v[176:179], v[108:111], v[216:219]
ds_read_b64_tr_b16 v[78:79], v8 offset:6144
v_mfma_f32_16x16x32_bf16 v[220:223], v[180:183], v[108:111], v[220:223]
ds_read_b128 v[60:63], v3 offset:8960
v_mfma_f32_16x16x32_bf16 v[128:131], v[168:171], v[112:115], v[128:131]
v_mfma_f32_16x16x32_bf16 v[132:135], v[172:175], v[112:115], v[132:135]
v_mfma_f32_16x16x32_bf16 v[192:195], v[184:187], v[112:115], v[192:195]
v_mfma_f32_16x16x32_bf16 v[196:199], v[188:191], v[112:115], v[196:199]
v_mfma_f32_16x16x32_bf16 v[136:139], v[168:171], v[116:119], v[136:139]
v_mfma_f32_16x16x32_bf16 v[140:143], v[172:175], v[116:119], v[140:143]
v_mfma_f32_16x16x32_bf16 v[200:203], v[184:187], v[116:119], v[200:203]
v_mfma_f32_16x16x32_bf16 v[204:207], v[188:191], v[116:119], v[204:207]
v_mfma_f32_16x16x32_bf16 v[144:147], v[168:171], v[120:123], v[144:147]
v_mfma_f32_16x16x32_bf16 v[148:151], v[172:175], v[120:123], v[148:151]
v_mfma_f32_16x16x32_bf16 v[208:211], v[184:187], v[120:123], v[208:211]
v_mfma_f32_16x16x32_bf16 v[212:215], v[188:191], v[120:123], v[212:215]
v_mfma_f32_16x16x32_bf16 v[152:155], v[168:171], v[124:127], v[152:155]
v_mfma_f32_16x16x32_bf16 v[156:159], v[172:175], v[124:127], v[156:159]
v_mfma_f32_16x16x32_bf16 v[216:219], v[184:187], v[124:127], v[216:219]
v_mfma_f32_16x16x32_bf16 v[220:223], v[188:191], v[124:127], v[220:223]
s_mov_b32 s54, 0x10000
s_waitcnt lgkmcnt(0)
s_barrier
v_mfma_f32_16x16x32_bf16 v[128:131], v[64:67], v[32:35], v[128:131]
ds_read_b64_tr_b16 v[160:161], v7 offset:32768
v_mfma_f32_16x16x32_bf16 v[132:135], v[68:71], v[32:35], v[132:135]
ds_read_b128 v[96:99], v3 offset:32768
v_mfma_f32_16x16x32_bf16 v[136:139], v[64:67], v[36:39], v[136:139]
ds_read_b64_tr_b16 v[162:163], v7 offset:34816
v_mfma_f32_16x16x32_bf16 v[140:143], v[68:71], v[36:39], v[140:143]
ds_read_b128 v[100:103], v3 offset:33024
v_cvt_pk_bf16_f32 v224, v192, v193
v_mfma_f32_16x16x32_bf16 v[144:147], v[64:67], v[40:43], v[144:147]
ds_read_b64_tr_b16 v[164:165], v8 offset:32768
v_cvt_pk_bf16_f32 v225, v194, v195
v_mfma_f32_16x16x32_bf16 v[148:151], v[68:71], v[40:43], v[148:151]
v_cvt_pk_bf16_f32 v226, v196, v197
ds_read_b128 v[104:107], v3 offset:33280
v_cvt_pk_bf16_f32 v227, v198, v199
v_mfma_f32_16x16x32_bf16 v[152:155], v[64:67], v[44:47], v[152:155]
buffer_store_dwordx4 v[224:227], v9, s[64:67], 0 offen offset:0 sc1
ds_read_b64_tr_b16 v[166:167], v8 offset:34816
v_cvt_pk_bf16_f32 v228, v200, v201
v_mfma_f32_16x16x32_bf16 v[156:159], v[68:71], v[44:47], v[156:159]
ds_read_b128 v[108:111], v3 offset:33536
v_cvt_pk_bf16_f32 v229, v202, v203
v_mfma_f32_16x16x32_bf16 v[128:131], v[72:75], v[48:51], v[128:131]
v_cvt_pk_bf16_f32 v230, v204, v205
ds_read_b64_tr_b16 v[168:169], v7 offset:36864
v_cvt_pk_bf16_f32 v231, v206, v207
v_mfma_f32_16x16x32_bf16 v[132:135], v[76:79], v[48:51], v[132:135]
buffer_store_dwordx4 v[228:231], v9, s[64:67], 0 offen offset:1024 sc1
ds_read_b128 v[112:115], v3 offset:40960
v_cvt_pk_bf16_f32 v232, v208, v209
v_mfma_f32_16x16x32_bf16 v[136:139], v[72:75], v[52:55], v[136:139]
ds_read_b64_tr_b16 v[170:171], v7 offset:38912
v_cvt_pk_bf16_f32 v233, v210, v211
v_mfma_f32_16x16x32_bf16 v[140:143], v[76:79], v[52:55], v[140:143]
v_cvt_pk_bf16_f32 v234, v212, v213
ds_read_b128 v[116:119], v3 offset:41216
v_cvt_pk_bf16_f32 v235, v214, v215
v_mfma_f32_16x16x32_bf16 v[144:147], v[72:75], v[56:59], v[144:147]
buffer_store_dwordx4 v[232:235], v9, s[64:67], 0 offen offset:2048 sc1
ds_read_b64_tr_b16 v[172:173], v8 offset:36864
v_cvt_pk_bf16_f32 v236, v216, v217
v_mfma_f32_16x16x32_bf16 v[148:151], v[76:79], v[56:59], v[148:151]
ds_read_b128 v[120:123], v3 offset:41472
v_cvt_pk_bf16_f32 v237, v218, v219
v_mfma_f32_16x16x32_bf16 v[152:155], v[72:75], v[60:63], v[152:155]
v_cvt_pk_bf16_f32 v238, v220, v221
ds_read_b64_tr_b16 v[174:175], v8 offset:38912
v_cvt_pk_bf16_f32 v239, v222, v223
v_mfma_f32_16x16x32_bf16 v[156:159], v[76:79], v[60:63], v[156:159]
buffer_store_dwordx4 v[236:239], v9, s[64:67], 0 offen offset:3072 sc1
ds_read_b128 v[124:127], v3 offset:41728
s_waitcnt lgkmcnt(0)
s_barrier
v_mfma_f32_16x16x32_bf16 v[128:131], v[160:163], v[96:99], v[128:131]
ds_read_b64_tr_b16 v[64:65], v5 offset:0
v_mfma_f32_16x16x32_bf16 v[132:135], v[164:167], v[96:99], v[132:135]
ds_read_b128 v[32:35], v2 offset:0
v_mfma_f32_16x16x32_bf16 v[136:139], v[160:163], v[100:103], v[136:139]
ds_read_b64_tr_b16 v[66:67], v5 offset:2048
v_mfma_f32_16x16x32_bf16 v[140:143], v[164:167], v[100:103], v[140:143]
ds_read_b128 v[36:39], v2 offset:256
v_mfma_f32_16x16x32_bf16 v[144:147], v[160:163], v[104:107], v[144:147]
ds_read_b64_tr_b16 v[68:69], v6 offset:0
v_mfma_f32_16x16x32_bf16 v[148:151], v[164:167], v[104:107], v[148:151]
ds_read_b128 v[40:43], v2 offset:512
v_mfma_f32_16x16x32_bf16 v[152:155], v[160:163], v[108:111], v[152:155]
ds_read_b64_tr_b16 v[70:71], v6 offset:2048
v_mfma_f32_16x16x32_bf16 v[156:159], v[164:167], v[108:111], v[156:159]
ds_read_b128 v[44:47], v2 offset:768
v_mfma_f32_16x16x32_bf16 v[128:131], v[168:171], v[112:115], v[128:131]
ds_read_b64_tr_b16 v[72:73], v5 offset:4096
v_mfma_f32_16x16x32_bf16 v[132:135], v[172:175], v[112:115], v[132:135]
ds_read_b128 v[48:51], v2 offset:8192
v_mfma_f32_16x16x32_bf16 v[136:139], v[168:171], v[116:119], v[136:139]
ds_read_b64_tr_b16 v[74:75], v5 offset:6144
v_mfma_f32_16x16x32_bf16 v[140:143], v[172:175], v[116:119], v[140:143]
ds_read_b128 v[52:55], v2 offset:8448
v_mfma_f32_16x16x32_bf16 v[144:147], v[168:171], v[120:123], v[144:147]
ds_read_b64_tr_b16 v[76:77], v6 offset:4096
v_mfma_f32_16x16x32_bf16 v[148:151], v[172:175], v[120:123], v[148:151]
ds_read_b128 v[56:59], v2 offset:8704
v_mfma_f32_16x16x32_bf16 v[152:155], v[168:171], v[124:127], v[152:155]
ds_read_b64_tr_b16 v[78:79], v6 offset:6144
v_mfma_f32_16x16x32_bf16 v[156:159], v[172:175], v[124:127], v[156:159]
ds_read_b128 v[60:63], v2 offset:8960
s_waitcnt lgkmcnt(0)
s_barrier
v_mfma_f32_16x16x32_bf16 v[128:131], v[64:67], v[32:35], v[128:131]
ds_read_b64_tr_b16 v[160:161], v5 offset:32768
v_mfma_f32_16x16x32_bf16 v[132:135], v[68:71], v[32:35], v[132:135]
ds_read_b128 v[96:99], v2 offset:32768
v_mfma_f32_16x16x32_bf16 v[136:139], v[64:67], v[36:39], v[136:139]
ds_read_b64_tr_b16 v[162:163], v5 offset:34816
v_mfma_f32_16x16x32_bf16 v[140:143], v[68:71], v[36:39], v[140:143]
ds_read_b128 v[100:103], v2 offset:33024
v_mfma_f32_16x16x32_bf16 v[144:147], v[64:67], v[40:43], v[144:147]
ds_read_b64_tr_b16 v[164:165], v6 offset:32768
v_mfma_f32_16x16x32_bf16 v[148:151], v[68:71], v[40:43], v[148:151]
ds_read_b128 v[104:107], v2 offset:33280
v_mfma_f32_16x16x32_bf16 v[152:155], v[64:67], v[44:47], v[152:155]
ds_read_b64_tr_b16 v[166:167], v6 offset:34816
v_mfma_f32_16x16x32_bf16 v[156:159], v[68:71], v[44:47], v[156:159]
ds_read_b128 v[108:111], v2 offset:33536
v_mfma_f32_16x16x32_bf16 v[128:131], v[72:75], v[48:51], v[128:131]
ds_read_b64_tr_b16 v[168:169], v5 offset:36864
v_mfma_f32_16x16x32_bf16 v[132:135], v[76:79], v[48:51], v[132:135]
ds_read_b128 v[112:115], v2 offset:40960
v_mfma_f32_16x16x32_bf16 v[136:139], v[72:75], v[52:55], v[136:139]
ds_read_b64_tr_b16 v[170:171], v5 offset:38912
v_mfma_f32_16x16x32_bf16 v[140:143], v[76:79], v[52:55], v[140:143]
ds_read_b128 v[116:119], v2 offset:41216
v_mfma_f32_16x16x32_bf16 v[144:147], v[72:75], v[56:59], v[144:147]
ds_read_b64_tr_b16 v[172:173], v6 offset:36864
v_mfma_f32_16x16x32_bf16 v[148:151], v[76:79], v[56:59], v[148:151]
ds_read_b128 v[120:123], v2 offset:41472
v_mfma_f32_16x16x32_bf16 v[152:155], v[72:75], v[60:63], v[152:155]
ds_read_b64_tr_b16 v[174:175], v6 offset:38912
v_mfma_f32_16x16x32_bf16 v[156:159], v[76:79], v[60:63], v[156:159]
ds_read_b128 v[124:127], v2 offset:41728
s_waitcnt vmcnt(0) lgkmcnt(0)
s_barrier
v_mfma_f32_16x16x32_bf16 v[128:131], v[160:163], v[96:99], v[128:131]
ds_read_b64_tr_b16 v[64:65], v7 offset:0
v_mfma_f32_16x16x32_bf16 v[132:135], v[164:167], v[96:99], v[132:135]
ds_read_b128 v[32:35], v3 offset:0
v_mfma_f32_16x16x32_bf16 v[136:139], v[160:163], v[100:103], v[136:139]
ds_read_b64_tr_b16 v[66:67], v7 offset:2048
v_mfma_f32_16x16x32_bf16 v[140:143], v[164:167], v[100:103], v[140:143]
ds_read_b128 v[36:39], v3 offset:256
v_mfma_f32_16x16x32_bf16 v[144:147], v[160:163], v[104:107], v[144:147]
ds_read_b64_tr_b16 v[68:69], v8 offset:0
v_mfma_f32_16x16x32_bf16 v[148:151], v[164:167], v[104:107], v[148:151]
ds_read_b128 v[40:43], v3 offset:512
v_mfma_f32_16x16x32_bf16 v[152:155], v[160:163], v[108:111], v[152:155]
ds_read_b64_tr_b16 v[70:71], v8 offset:2048
v_mfma_f32_16x16x32_bf16 v[156:159], v[164:167], v[108:111], v[156:159]
ds_read_b128 v[44:47], v3 offset:768
v_mfma_f32_16x16x32_bf16 v[128:131], v[168:171], v[112:115], v[128:131]
ds_read_b64_tr_b16 v[72:73], v7 offset:4096
v_mfma_f32_16x16x32_bf16 v[132:135], v[172:175], v[112:115], v[132:135]
ds_read_b128 v[48:51], v3 offset:8192
v_mfma_f32_16x16x32_bf16 v[136:139], v[168:171], v[116:119], v[136:139]
ds_read_b64_tr_b16 v[74:75], v7 offset:6144
v_mfma_f32_16x16x32_bf16 v[140:143], v[172:175], v[116:119], v[140:143]
ds_read_b128 v[52:55], v3 offset:8448
v_mfma_f32_16x16x32_bf16 v[144:147], v[168:171], v[120:123], v[144:147]
ds_read_b64_tr_b16 v[76:77], v8 offset:4096
v_mfma_f32_16x16x32_bf16 v[148:151], v[172:175], v[120:123], v[148:151]
ds_read_b128 v[56:59], v3 offset:8704
v_mfma_f32_16x16x32_bf16 v[152:155], v[168:171], v[124:127], v[152:155]
ds_read_b64_tr_b16 v[78:79], v8 offset:6144
v_mfma_f32_16x16x32_bf16 v[156:159], v[172:175], v[124:127], v[156:159]
ds_read_b128 v[60:63], v3 offset:8960
s_waitcnt lgkmcnt(0)
s_barrier
v_mfma_f32_16x16x32_bf16 v[128:131], v[64:67], v[32:35], v[128:131]
ds_read_b64_tr_b16 v[160:161], v7 offset:32768
v_mfma_f32_16x16x32_bf16 v[132:135], v[68:71], v[32:35], v[132:135]
ds_read_b128 v[96:99], v3 offset:32768
v_mfma_f32_16x16x32_bf16 v[136:139], v[64:67], v[36:39], v[136:139]
ds_read_b64_tr_b16 v[162:163], v7 offset:34816
v_mfma_f32_16x16x32_bf16 v[140:143], v[68:71], v[36:39], v[140:143]
ds_read_b128 v[100:103], v3 offset:33024
v_mfma_f32_16x16x32_bf16 v[144:147], v[64:67], v[40:43], v[144:147]
ds_read_b64_tr_b16 v[164:165], v8 offset:32768
v_mfma_f32_16x16x32_bf16 v[148:151], v[68:71], v[40:43], v[148:151]
ds_read_b128 v[104:107], v3 offset:33280
v_mfma_f32_16x16x32_bf16 v[152:155], v[64:67], v[44:47], v[152:155]
ds_read_b64_tr_b16 v[166:167], v8 offset:34816
v_mfma_f32_16x16x32_bf16 v[156:159], v[68:71], v[44:47], v[156:159]
ds_read_b128 v[108:111], v3 offset:33536
v_mfma_f32_16x16x32_bf16 v[128:131], v[72:75], v[48:51], v[128:131]
ds_read_b64_tr_b16 v[168:169], v7 offset:36864
v_mfma_f32_16x16x32_bf16 v[132:135], v[76:79], v[48:51], v[132:135]
ds_read_b128 v[112:115], v3 offset:40960
v_mfma_f32_16x16x32_bf16 v[136:139], v[72:75], v[52:55], v[136:139]
ds_read_b64_tr_b16 v[170:171], v7 offset:38912
v_mfma_f32_16x16x32_bf16 v[140:143], v[76:79], v[52:55], v[140:143]
ds_read_b128 v[116:119], v3 offset:41216
v_mfma_f32_16x16x32_bf16 v[144:147], v[72:75], v[56:59], v[144:147]
ds_read_b64_tr_b16 v[172:173], v8 offset:36864
v_mfma_f32_16x16x32_bf16 v[148:151], v[76:79], v[56:59], v[148:151]
ds_read_b128 v[120:123], v3 offset:41472
v_mfma_f32_16x16x32_bf16 v[152:155], v[72:75], v[60:63], v[152:155]
ds_read_b64_tr_b16 v[174:175], v8 offset:38912
v_mfma_f32_16x16x32_bf16 v[156:159], v[76:79], v[60:63], v[156:159]
ds_read_b128 v[124:127], v3 offset:41728
s_waitcnt lgkmcnt(0)
s_barrier
v_mfma_f32_16x16x32_bf16 v[128:131], v[160:163], v[96:99], v[128:131]
ds_read_b64_tr_b16 v[64:65], v5 offset:0
v_mfma_f32_16x16x32_bf16 v[132:135], v[164:167], v[96:99], v[132:135]
ds_read_b128 v[32:35], v2 offset:0
v_mfma_f32_16x16x32_bf16 v[136:139], v[160:163], v[100:103], v[136:139]
ds_read_b64_tr_b16 v[66:67], v5 offset:2048
v_mfma_f32_16x16x32_bf16 v[140:143], v[164:167], v[100:103], v[140:143]
ds_read_b128 v[36:39], v2 offset:256
v_mfma_f32_16x16x32_bf16 v[144:147], v[160:163], v[104:107], v[144:147]
ds_read_b64_tr_b16 v[68:69], v6 offset:0
v_mfma_f32_16x16x32_bf16 v[148:151], v[164:167], v[104:107], v[148:151]
ds_read_b128 v[40:43], v2 offset:512
v_mfma_f32_16x16x32_bf16 v[152:155], v[160:163], v[108:111], v[152:155]
ds_read_b64_tr_b16 v[70:71], v6 offset:2048
v_mfma_f32_16x16x32_bf16 v[156:159], v[164:167], v[108:111], v[156:159]
ds_read_b128 v[44:47], v2 offset:768
v_mfma_f32_16x16x32_bf16 v[128:131], v[168:171], v[112:115], v[128:131]
ds_read_b64_tr_b16 v[72:73], v5 offset:4096
v_mfma_f32_16x16x32_bf16 v[132:135], v[172:175], v[112:115], v[132:135]
ds_read_b128 v[48:51], v2 offset:8192
v_mfma_f32_16x16x32_bf16 v[136:139], v[168:171], v[116:119], v[136:139]
ds_read_b64_tr_b16 v[74:75], v5 offset:6144
v_mfma_f32_16x16x32_bf16 v[140:143], v[172:175], v[116:119], v[140:143]
ds_read_b128 v[52:55], v2 offset:8448
v_mfma_f32_16x16x32_bf16 v[144:147], v[168:171], v[120:123], v[144:147]
ds_read_b64_tr_b16 v[76:77], v6 offset:4096
v_mfma_f32_16x16x32_bf16 v[148:151], v[172:175], v[120:123], v[148:151]
ds_read_b128 v[56:59], v2 offset:8704
v_mfma_f32_16x16x32_bf16 v[152:155], v[168:171], v[124:127], v[152:155]
ds_read_b64_tr_b16 v[78:79], v6 offset:6144
v_mfma_f32_16x16x32_bf16 v[156:159], v[172:175], v[124:127], v[156:159]
ds_read_b128 v[60:63], v2 offset:8960
s_waitcnt lgkmcnt(0)
s_barrier
v_mfma_f32_16x16x32_bf16 v[128:131], v[64:67], v[32:35], v[128:131]
ds_read_b64_tr_b16 v[160:161], v5 offset:32768
v_mfma_f32_16x16x32_bf16 v[132:135], v[68:71], v[32:35], v[132:135]
ds_read_b128 v[96:99], v2 offset:32768
v_mfma_f32_16x16x32_bf16 v[136:139], v[64:67], v[36:39], v[136:139]
ds_read_b64_tr_b16 v[162:163], v5 offset:34816
v_mfma_f32_16x16x32_bf16 v[140:143], v[68:71], v[36:39], v[140:143]
ds_read_b128 v[100:103], v2 offset:33024
v_mfma_f32_16x16x32_bf16 v[144:147], v[64:67], v[40:43], v[144:147]
ds_read_b64_tr_b16 v[164:165], v6 offset:32768
v_mfma_f32_16x16x32_bf16 v[148:151], v[68:71], v[40:43], v[148:151]
ds_read_b128 v[104:107], v2 offset:33280
v_mfma_f32_16x16x32_bf16 v[152:155], v[64:67], v[44:47], v[152:155]
ds_read_b64_tr_b16 v[166:167], v6 offset:34816
v_mfma_f32_16x16x32_bf16 v[156:159], v[68:71], v[44:47], v[156:159]
ds_read_b128 v[108:111], v2 offset:33536
v_mfma_f32_16x16x32_bf16 v[128:131], v[72:75], v[48:51], v[128:131]
ds_read_b64_tr_b16 v[168:169], v5 offset:36864
v_mfma_f32_16x16x32_bf16 v[132:135], v[76:79], v[48:51], v[132:135]
ds_read_b128 v[112:115], v2 offset:40960
v_mfma_f32_16x16x32_bf16 v[136:139], v[72:75], v[52:55], v[136:139]
ds_read_b64_tr_b16 v[170:171], v5 offset:38912
v_mfma_f32_16x16x32_bf16 v[140:143], v[76:79], v[52:55], v[140:143]
ds_read_b128 v[116:119], v2 offset:41216
v_mfma_f32_16x16x32_bf16 v[144:147], v[72:75], v[56:59], v[144:147]
ds_read_b64_tr_b16 v[172:173], v6 offset:36864
v_mfma_f32_16x16x32_bf16 v[148:151], v[76:79], v[56:59], v[148:151]
ds_read_b128 v[120:123], v2 offset:41472
v_mfma_f32_16x16x32_bf16 v[152:155], v[72:75], v[60:63], v[152:155]
ds_read_b64_tr_b16 v[174:175], v6 offset:38912
v_mfma_f32_16x16x32_bf16 v[156:159], v[76:79], v[60:63], v[156:159]
ds_read_b128 v[124:127], v2 offset:41728
s_waitcnt lgkmcnt(0)
s_barrier
v_mfma_f32_16x16x32_bf16 v[128:131], v[160:163], v[96:99], v[128:131]
ds_read_b64_tr_b16 v[64:65], v7 offset:0
v_mfma_f32_16x16x32_bf16 v[132:135], v[164:167], v[96:99], v[132:135]
ds_read_b128 v[32:35], v3 offset:0
v_mfma_f32_16x16x32_bf16 v[136:139], v[160:163], v[100:103], v[136:139]
ds_read_b64_tr_b16 v[66:67], v7 offset:2048
v_mfma_f32_16x16x32_bf16 v[140:143], v[164:167], v[100:103], v[140:143]
ds_read_b128 v[36:39], v3 offset:256
v_mfma_f32_16x16x32_bf16 v[144:147], v[160:163], v[104:107], v[144:147]
ds_read_b64_tr_b16 v[68:69], v8 offset:0
v_mfma_f32_16x16x32_bf16 v[148:151], v[164:167], v[104:107], v[148:151]
ds_read_b128 v[40:43], v3 offset:512
v_mfma_f32_16x16x32_bf16 v[152:155], v[160:163], v[108:111], v[152:155]
ds_read_b64_tr_b16 v[70:71], v8 offset:2048
v_mfma_f32_16x16x32_bf16 v[156:159], v[164:167], v[108:111], v[156:159]
ds_read_b128 v[44:47], v3 offset:768
v_mfma_f32_16x16x32_bf16 v[128:131], v[168:171], v[112:115], v[128:131]
ds_read_b64_tr_b16 v[72:73], v7 offset:4096
v_mfma_f32_16x16x32_bf16 v[132:135], v[172:175], v[112:115], v[132:135]
ds_read_b128 v[48:51], v3 offset:8192
v_mfma_f32_16x16x32_bf16 v[136:139], v[168:171], v[116:119], v[136:139]
ds_read_b64_tr_b16 v[74:75], v7 offset:6144
v_mfma_f32_16x16x32_bf16 v[140:143], v[172:175], v[116:119], v[140:143]
ds_read_b128 v[52:55], v3 offset:8448
v_mfma_f32_16x16x32_bf16 v[144:147], v[168:171], v[120:123], v[144:147]
ds_read_b64_tr_b16 v[76:77], v8 offset:4096
v_mfma_f32_16x16x32_bf16 v[148:151], v[172:175], v[120:123], v[148:151]
ds_read_b128 v[56:59], v3 offset:8704
v_mfma_f32_16x16x32_bf16 v[152:155], v[168:171], v[124:127], v[152:155]
ds_read_b64_tr_b16 v[78:79], v8 offset:6144
v_mfma_f32_16x16x32_bf16 v[156:159], v[172:175], v[124:127], v[156:159]
ds_read_b128 v[60:63], v3 offset:8960
s_waitcnt lgkmcnt(0)
s_barrier
v_mfma_f32_16x16x32_bf16 v[128:131], v[64:67], v[32:35], v[128:131]
ds_read_b64_tr_b16 v[160:161], v7 offset:32768
v_mfma_f32_16x16x32_bf16 v[132:135], v[68:71], v[32:35], v[132:135]
ds_read_b128 v[96:99], v3 offset:32768
v_mfma_f32_16x16x32_bf16 v[136:139], v[64:67], v[36:39], v[136:139]
ds_read_b64_tr_b16 v[162:163], v7 offset:34816
v_mfma_f32_16x16x32_bf16 v[140:143], v[68:71], v[36:39], v[140:143]
ds_read_b128 v[100:103], v3 offset:33024
v_mfma_f32_16x16x32_bf16 v[144:147], v[64:67], v[40:43], v[144:147]
ds_read_b64_tr_b16 v[164:165], v8 offset:32768
v_mfma_f32_16x16x32_bf16 v[148:151], v[68:71], v[40:43], v[148:151]
ds_read_b128 v[104:107], v3 offset:33280
v_mfma_f32_16x16x32_bf16 v[152:155], v[64:67], v[44:47], v[152:155]
ds_read_b64_tr_b16 v[166:167], v8 offset:34816
v_mfma_f32_16x16x32_bf16 v[156:159], v[68:71], v[44:47], v[156:159]
ds_read_b128 v[108:111], v3 offset:33536
v_mfma_f32_16x16x32_bf16 v[128:131], v[72:75], v[48:51], v[128:131]
ds_read_b64_tr_b16 v[168:169], v7 offset:36864
v_mfma_f32_16x16x32_bf16 v[132:135], v[76:79], v[48:51], v[132:135]
ds_read_b128 v[112:115], v3 offset:40960
v_mfma_f32_16x16x32_bf16 v[136:139], v[72:75], v[52:55], v[136:139]
ds_read_b64_tr_b16 v[170:171], v7 offset:38912
v_mfma_f32_16x16x32_bf16 v[140:143], v[76:79], v[52:55], v[140:143]
ds_read_b128 v[116:119], v3 offset:41216
v_mfma_f32_16x16x32_bf16 v[144:147], v[72:75], v[56:59], v[144:147]
ds_read_b64_tr_b16 v[172:173], v8 offset:36864
v_mfma_f32_16x16x32_bf16 v[148:151], v[76:79], v[56:59], v[148:151]
ds_read_b128 v[120:123], v3 offset:41472
v_mfma_f32_16x16x32_bf16 v[152:155], v[72:75], v[60:63], v[152:155]
ds_read_b64_tr_b16 v[174:175], v8 offset:38912
v_mfma_f32_16x16x32_bf16 v[156:159], v[76:79], v[60:63], v[156:159]
ds_read_b128 v[124:127], v3 offset:41728
s_waitcnt lgkmcnt(0)
s_barrier
v_mfma_f32_16x16x32_bf16 v[128:131], v[160:163], v[96:99], v[128:131]
ds_read_b64_tr_b16 v[64:65], v5 offset:0
v_mfma_f32_16x16x32_bf16 v[132:135], v[164:167], v[96:99], v[132:135]
ds_read_b128 v[32:35], v2 offset:0
v_mfma_f32_16x16x32_bf16 v[136:139], v[160:163], v[100:103], v[136:139]
ds_read_b64_tr_b16 v[66:67], v5 offset:2048
v_mfma_f32_16x16x32_bf16 v[140:143], v[164:167], v[100:103], v[140:143]
ds_read_b128 v[36:39], v2 offset:256
buffer_load_dwordx4 v[192:195], v9, s[68:71], 0 offen offset:0 sc1
v_mfma_f32_16x16x32_bf16 v[144:147], v[160:163], v[104:107], v[144:147]
ds_read_b64_tr_b16 v[68:69], v6 offset:0
v_mfma_f32_16x16x32_bf16 v[148:151], v[164:167], v[104:107], v[148:151]
ds_read_b128 v[40:43], v2 offset:512
v_mfma_f32_16x16x32_bf16 v[152:155], v[160:163], v[108:111], v[152:155]
ds_read_b64_tr_b16 v[70:71], v6 offset:2048
buffer_load_dwordx4 v[196:199], v9, s[68:71], 0 offen offset:1024 sc1
v_mfma_f32_16x16x32_bf16 v[156:159], v[164:167], v[108:111], v[156:159]
ds_read_b128 v[44:47], v2 offset:768
v_mfma_f32_16x16x32_bf16 v[128:131], v[168:171], v[112:115], v[128:131]
ds_read_b64_tr_b16 v[72:73], v5 offset:4096
v_mfma_f32_16x16x32_bf16 v[132:135], v[172:175], v[112:115], v[132:135]
ds_read_b128 v[48:51], v2 offset:8192
buffer_load_dwordx4 v[200:203], v9, s[68:71], 0 offen offset:2048 sc1
v_mfma_f32_16x16x32_bf16 v[136:139], v[168:171], v[116:119], v[136:139]
ds_read_b64_tr_b16 v[74:75], v5 offset:6144
v_mfma_f32_16x16x32_bf16 v[140:143], v[172:175], v[116:119], v[140:143]
ds_read_b128 v[52:55], v2 offset:8448
v_mfma_f32_16x16x32_bf16 v[144:147], v[168:171], v[120:123], v[144:147]
ds_read_b64_tr_b16 v[76:77], v6 offset:4096
buffer_load_dwordx4 v[204:207], v9, s[68:71], 0 offen offset:3072 sc1
v_mfma_f32_16x16x32_bf16 v[148:151], v[172:175], v[120:123], v[148:151]
ds_read_b128 v[56:59], v2 offset:8704
v_mfma_f32_16x16x32_bf16 v[152:155], v[168:171], v[124:127], v[152:155]
ds_read_b64_tr_b16 v[78:79], v6 offset:6144
v_mfma_f32_16x16x32_bf16 v[156:159], v[172:175], v[124:127], v[156:159]
ds_read_b128 v[60:63], v2 offset:8960
s_waitcnt lgkmcnt(0)
s_barrier
v_mfma_f32_16x16x32_bf16 v[128:131], v[64:67], v[32:35], v[128:131]
ds_read_b64_tr_b16 v[160:161], v5 offset:32768
v_mfma_f32_16x16x32_bf16 v[132:135], v[68:71], v[32:35], v[132:135]
ds_read_b128 v[96:99], v2 offset:32768
v_mfma_f32_16x16x32_bf16 v[136:139], v[64:67], v[36:39], v[136:139]
ds_read_b64_tr_b16 v[162:163], v5 offset:34816
v_mfma_f32_16x16x32_bf16 v[140:143], v[68:71], v[36:39], v[140:143]
ds_read_b128 v[100:103], v2 offset:33024
v_mfma_f32_16x16x32_bf16 v[144:147], v[64:67], v[40:43], v[144:147]
ds_read_b64_tr_b16 v[164:165], v6 offset:32768
v_mfma_f32_16x16x32_bf16 v[148:151], v[68:71], v[40:43], v[148:151]
ds_read_b128 v[104:107], v2 offset:33280
v_mfma_f32_16x16x32_bf16 v[152:155], v[64:67], v[44:47], v[152:155]
ds_read_b64_tr_b16 v[166:167], v6 offset:34816
v_mfma_f32_16x16x32_bf16 v[156:159], v[68:71], v[44:47], v[156:159]
ds_read_b128 v[108:111], v2 offset:33536
v_mfma_f32_16x16x32_bf16 v[128:131], v[72:75], v[48:51], v[128:131]
ds_read_b64_tr_b16 v[168:169], v5 offset:36864
v_mfma_f32_16x16x32_bf16 v[132:135], v[76:79], v[48:51], v[132:135]
ds_read_b128 v[112:115], v2 offset:40960
v_mfma_f32_16x16x32_bf16 v[136:139], v[72:75], v[52:55], v[136:139]
ds_read_b64_tr_b16 v[170:171], v5 offset:38912
v_mfma_f32_16x16x32_bf16 v[140:143], v[76:79], v[52:55], v[140:143]
ds_read_b128 v[116:119], v2 offset:41216
v_mfma_f32_16x16x32_bf16 v[144:147], v[72:75], v[56:59], v[144:147]
ds_read_b64_tr_b16 v[172:173], v6 offset:36864
v_mfma_f32_16x16x32_bf16 v[148:151], v[76:79], v[56:59], v[148:151]
ds_read_b128 v[120:123], v2 offset:41472
v_mfma_f32_16x16x32_bf16 v[152:155], v[72:75], v[60:63], v[152:155]
ds_read_b64_tr_b16 v[174:175], v6 offset:38912
v_mfma_f32_16x16x32_bf16 v[156:159], v[76:79], v[60:63], v[156:159]
ds_read_b128 v[124:127], v2 offset:41728
s_waitcnt lgkmcnt(0)
s_barrier
v_mfma_f32_16x16x32_bf16 v[128:131], v[160:163], v[96:99], v[128:131]
v_mfma_f32_16x16x32_bf16 v[132:135], v[164:167], v[96:99], v[132:135]
v_mfma_f32_16x16x32_bf16 v[136:139], v[160:163], v[100:103], v[136:139]
v_mfma_f32_16x16x32_bf16 v[140:143], v[164:167], v[100:103], v[140:143]
v_mfma_f32_16x16x32_bf16 v[144:147], v[160:163], v[104:107], v[144:147]
v_mfma_f32_16x16x32_bf16 v[148:151], v[164:167], v[104:107], v[148:151]
v_mfma_f32_16x16x32_bf16 v[152:155], v[160:163], v[108:111], v[152:155]
v_mfma_f32_16x16x32_bf16 v[156:159], v[164:167], v[108:111], v[156:159]
s_waitcnt vmcnt(0)
v_mfma_f32_16x16x32_bf16 v[128:131], v[168:171], v[112:115], v[128:131]
v_lshlrev_b32 v224, 16, v192
v_and_b32 v225, 0xffff0000, v192
v_lshlrev_b32 v226, 16, v193
v_and_b32 v227, 0xffff0000, v193
v_mfma_f32_16x16x32_bf16 v[132:135], v[172:175], v[112:115], v[132:135]
v_lshlrev_b32 v228, 16, v194
v_and_b32 v229, 0xffff0000, v194
v_lshlrev_b32 v230, 16, v195
v_and_b32 v231, 0xffff0000, v195
v_mfma_f32_16x16x32_bf16 v[136:139], v[168:171], v[116:119], v[136:139]
v_lshlrev_b32 v232, 16, v196
v_and_b32 v233, 0xffff0000, v196
v_lshlrev_b32 v234, 16, v197
v_and_b32 v235, 0xffff0000, v197
v_mfma_f32_16x16x32_bf16 v[140:143], v[172:175], v[116:119], v[140:143]
v_lshlrev_b32 v236, 16, v198
v_and_b32 v237, 0xffff0000, v198
v_lshlrev_b32 v238, 16, v199
v_and_b32 v239, 0xffff0000, v199
v_mfma_f32_16x16x32_bf16 v[144:147], v[168:171], v[120:123], v[144:147]
v_lshlrev_b32 v240, 16, v200
v_and_b32 v241, 0xffff0000, v200
v_lshlrev_b32 v242, 16, v201
v_and_b32 v243, 0xffff0000, v201
v_mfma_f32_16x16x32_bf16 v[148:151], v[172:175], v[120:123], v[148:151]
v_lshlrev_b32 v244, 16, v202
v_and_b32 v245, 0xffff0000, v202
v_lshlrev_b32 v246, 16, v203
v_and_b32 v247, 0xffff0000, v203
v_mfma_f32_16x16x32_bf16 v[152:155], v[168:171], v[124:127], v[152:155]
v_lshlrev_b32 v248, 16, v204
v_and_b32 v249, 0xffff0000, v204
v_lshlrev_b32 v250, 16, v205
v_and_b32 v251, 0xffff0000, v205
v_mfma_f32_16x16x32_bf16 v[156:159], v[172:175], v[124:127], v[156:159]
v_lshlrev_b32 v252, 16, v206
v_and_b32 v253, 0xffff0000, v206
v_lshlrev_b32 v254, 16, v207
v_and_b32 v255, 0xffff0000, v207
s_waitcnt vmcnt(0)
s_nop 4
v_pk_add_f32 v[128:129], v[128:129], v[224:225]
v_pk_add_f32 v[130:131], v[130:131], v[226:227]
v_pk_add_f32 v[132:133], v[132:133], v[228:229]
v_pk_add_f32 v[134:135], v[134:135], v[230:231]
v_cvt_pk_bf16_f32 v32, v128, v129
v_cvt_pk_bf16_f32 v33, v130, v131
v_cvt_pk_bf16_f32 v34, v132, v133
v_cvt_pk_bf16_f32 v35, v134, v135
v_pk_add_f32 v[136:137], v[136:137], v[232:233]
v_pk_add_f32 v[138:139], v[138:139], v[234:235]
v_pk_add_f32 v[140:141], v[140:141], v[236:237]
v_pk_add_f32 v[142:143], v[142:143], v[238:239]
v_cvt_pk_bf16_f32 v36, v136, v137
v_cvt_pk_bf16_f32 v37, v138, v139
v_cvt_pk_bf16_f32 v38, v140, v141
v_cvt_pk_bf16_f32 v39, v142, v143
v_pk_add_f32 v[144:145], v[144:145], v[240:241]
v_pk_add_f32 v[146:147], v[146:147], v[242:243]
v_pk_add_f32 v[148:149], v[148:149], v[244:245]
v_pk_add_f32 v[150:151], v[150:151], v[246:247]
v_cvt_pk_bf16_f32 v40, v144, v145
v_cvt_pk_bf16_f32 v41, v146, v147
v_cvt_pk_bf16_f32 v42, v148, v149
v_cvt_pk_bf16_f32 v43, v150, v151
v_pk_add_f32 v[152:153], v[152:153], v[248:249]
v_pk_add_f32 v[154:155], v[154:155], v[250:251]
v_pk_add_f32 v[156:157], v[156:157], v[252:253]
v_pk_add_f32 v[158:159], v[158:159], v[254:255]
v_cvt_pk_bf16_f32 v44, v152, v153
v_cvt_pk_bf16_f32 v45, v154, v155
v_cvt_pk_bf16_f32 v46, v156, v157
v_cvt_pk_bf16_f32 v47, v158, v159
v_permlane16_swap_b32 v32, v34
v_permlane16_swap_b32 v33, v35
buffer_store_dwordx4 v[32:35], v28, s[16:19], 0 offen offset:0
v_permlane16_swap_b32 v36, v38
v_permlane16_swap_b32 v37, v39
buffer_store_dwordx4 v[36:39], v28, s[16:19], 0 offen offset:2048
v_permlane16_swap_b32 v40, v42
v_permlane16_swap_b32 v41, v43
buffer_store_dwordx4 v[40:43], v28, s[16:19], s54 offen offset:0
v_permlane16_swap_b32 v44, v46
v_permlane16_swap_b32 v45, v47
buffer_store_dwordx4 v[44:47], v28, s[16:19], s54 offen offset:2048
s_branch Ldone_1
.p2align 6
Lw_24:
s_branch Lr_25
s_nop 0
.p2align 3
LG1_50:
s_cmp_eq_u32 s36, 7
s_cbranch_scc1 L7_133
s_mul_i32 s44, s34, 262144
s_lshl_b32 s39, s51, 13
s_add_u32 s44, s44, s39
s_add_u32 s44, s44, 0
s_lshl_b32 s43, s35, 7
s_mov_b32 s10, 253952
s_movk_i32 s38, 1024
s_movk_i32 s40, 9216
s_cmp_eq_u32 s51, 2
s_cselect_b32 s8, s28, s32
s_cselect_b32 s9, s29, s33
s_cselect_b32 s10, 2095232, s10
s_cselect_b32 s43, s43, s44
s_cselect_b32 s38, 16384, s38
s_cselect_b32 s40, 16384, s40
s_cselect_b32 s55, 16384, s38
s_cselect_b32 s45, -1, 0
s_add_u32 s8, s8, s43
s_addc_u32 s9, s9, 0
s_mov_b32 s11, 0x20000
s_sub_u32 s37, 0, s40
v_lshrrev_b32 v19, 3, v1
v_mul_u32_u24 v19, 1920, v19
v_lshrrev_b32 v20, 4, v1
v_lshlrev_b32 v20, 5, v20
v_and_b32 v19, s45, v19
v_and_b32 v20, s45, v20
v_lshlrev_b32 v23, 4, v1
v_xor_b32 v23, v23, v20
v_add_u32 v23, v23, v19
s_lshl_b32 s43, s34, 18
s_add_u32 s12, s32, s43
s_addc_u32 s13, s33, 0
s_mov_b32 s14, 262144
s_mov_b32 s15, 0x20000
v_lshlrev_b32 v21, 4, v1
s_lshl_b32 s54, s36, 11
s_add_u32 s43, s35, 1
s_and_b32 s43, s43, 15
s_lshl_b32 s43, s43, 14
s_add_u32 s30, s43, s54
s_add_u32 s43, s35, 2
s_and_b32 s43, s43, 15
s_lshl_b32 s43, s43, 14
s_add_u32 s31, s43, s54
s_cmp_eq_u32 s51, 1
s_cbranch_scc1 Lp_137
s_cmp_eq_u32 s51, 2
s_cbranch_scc1 Lp_138
.p2align 3
Lp_136:
s_add_u32 s42, s35, 2
s_waitcnt vmcnt(0)
s_barrier
ds_write_b128 v27, v[68:71] offset:0
ds_write_b128 v27, v[116:119] offset:512
s_waitcnt lgkmcnt(0)
s_barrier
s_add_u32 m0, s54, 16384
s_add_u32 s43, s30, 0
buffer_load_dwordx4 v21, s[12:15], s43 offen sc1 lds
s_add_u32 m0, s54, 17408
s_add_u32 s43, s30, 1024
buffer_load_dwordx4 v21, s[12:15], s43 offen sc1 lds
s_add_u32 m0, s54, 32768
s_add_u32 s43, s31, 0
buffer_load_dwordx4 v21, s[12:15], s43 offen sc1 lds
s_add_u32 m0, s54, 33792
s_add_u32 s43, s31, 1024
buffer_load_dwordx4 v21, s[12:15], s43 offen sc1 lds
s_add_u32 s42, s42, 1
s_and_b32 s42, s42, 15
s_add_u32 m0, s39, 49152
s_lshl_b32 s37, s42, 14
buffer_load_dwordx4 v23, s[8:11], s37 offen sc1 lds
s_add_u32 m0, s39, 50176
s_add_u32 s37, s37, s38
buffer_load_dwordx4 v23, s[8:11], s37 offen sc1 lds
s_add_u32 m0, s39, 51200
s_add_u32 s37, s37, s38
buffer_load_dwordx4 v23, s[8:11], s37 offen sc1 lds
s_add_u32 m0, s39, 52224
s_add_u32 s37, s37, s38
buffer_load_dwordx4 v23, s[8:11], s37 offen sc1 lds
s_add_u32 m0, s39, 53248
s_add_u32 s37, s37, s38
buffer_load_dwordx4 v23, s[8:11], s37 offen sc1 lds
s_add_u32 m0, s39, 54272
s_add_u32 s37, s37, s38
buffer_load_dwordx4 v23, s[8:11], s37 offen sc1 lds
s_add_u32 m0, s39, 55296
s_add_u32 s37, s37, s38
buffer_load_dwordx4 v23, s[8:11], s37 offen sc1 lds
s_add_u32 m0, s39, 56320
s_add_u32 s37, s37, s38
buffer_load_dwordx4 v23, s[8:11], s37 offen sc1 lds
s_waitcnt vmcnt(10)
s_barrier
s_add_u32 s42, s42, 1
s_and_b32 s42, s42, 15
s_add_u32 m0, s39, 0
s_lshl_b32 s37, s42, 14
buffer_load_dwordx4 v23, s[8:11], s37 offen sc1 lds
s_add_u32 m0, s39, 1024
s_add_u32 s37, s37, s38
buffer_load_dwordx4 v23, s[8:11], s37 offen sc1 lds
s_add_u32 m0, s39, 2048
s_add_u32 s37, s37, s38
buffer_load_dwordx4 v23, s[8:11], s37 offen sc1 lds
s_add_u32 m0, s39, 3072
s_add_u32 s37, s37, s38
buffer_load_dwordx4 v23, s[8:11], s37 offen sc1 lds
s_add_u32 m0, s39, 4096
s_add_u32 s37, s37, s38
buffer_load_dwordx4 v23, s[8:11], s37 offen sc1 lds
s_add_u32 m0, s39, 5120
s_add_u32 s37, s37, s38
buffer_load_dwordx4 v23, s[8:11], s37 offen sc1 lds
s_add_u32 m0, s39, 6144
s_add_u32 s37, s37, s38
buffer_load_dwordx4 v23, s[8:11], s37 offen sc1 lds
s_add_u32 m0, s39, 7168
s_add_u32 s37, s37, s38
buffer_load_dwordx4 v23, s[8:11], s37 offen sc1 lds
s_waitcnt vmcnt(16)
s_barrier
s_add_u32 s42, s42, 1
s_and_b32 s42, s42, 15
s_add_u32 m0, s39, 16384
s_lshl_b32 s37, s42, 14
buffer_load_dwordx4 v23, s[8:11], s37 offen sc1 lds
s_add_u32 m0, s39, 17408
s_add_u32 s37, s37, s38
buffer_load_dwordx4 v23, s[8:11], s37 offen sc1 lds
s_add_u32 m0, s39, 18432
s_add_u32 s37, s37, s38
buffer_load_dwordx4 v23, s[8:11], s37 offen sc1 lds
s_add_u32 m0, s39, 19456
s_add_u32 s37, s37, s38
buffer_load_dwordx4 v23, s[8:11], s37 offen sc1 lds
s_add_u32 m0, s39, 20480
s_add_u32 s37, s37, s38
buffer_load_dwordx4 v23, s[8:11], s37 offen sc1 lds
s_add_u32 m0, s39, 21504
s_add_u32 s37, s37, s38
buffer_load_dwordx4 v23, s[8:11], s37 offen sc1 lds
s_add_u32 m0, s39, 22528
s_add_u32 s37, s37, s38
buffer_load_dwordx4 v23, s[8:11], s37 offen sc1 lds
s_add_u32 m0, s39, 23552
s_add_u32 s37, s37, s38
buffer_load_dwordx4 v23, s[8:11], s37 offen sc1 lds
s_waitcnt vmcnt(16)
s_barrier
s_add_u32 s42, s42, 1
s_and_b32 s42, s42, 15
s_add_u32 m0, s39, 32768
s_lshl_b32 s37, s42, 14
buffer_load_dwordx4 v23, s[8:11], s37 offen sc1 lds
s_add_u32 m0, s39, 33792
s_add_u32 s37, s37, s38
buffer_load_dwordx4 v23, s[8:11], s37 offen sc1 lds
s_add_u32 m0, s39, 34816
s_add_u32 s37, s37, s38
buffer_load_dwordx4 v23, s[8:11], s37 offen sc1 lds
s_add_u32 m0, s39, 35840
s_add_u32 s37, s37, s38
buffer_load_dwordx4 v23, s[8:11], s37 offen sc1 lds
s_add_u32 m0, s39, 36864
s_add_u32 s37, s37, s38
buffer_load_dwordx4 v23, s[8:11], s37 offen sc1 lds
s_add_u32 m0, s39, 37888
s_add_u32 s37, s37, s38
buffer_load_dwordx4 v23, s[8:11], s37 offen sc1 lds
s_add_u32 m0, s39, 38912
s_add_u32 s37, s37, s38
buffer_load_dwordx4 v23, s[8:11], s37 offen sc1 lds
s_add_u32 m0, s39, 39936
s_add_u32 s37, s37, s38
buffer_load_dwordx4 v23, s[8:11], s37 offen sc1 lds
s_waitcnt vmcnt(16)
s_barrier
s_add_u32 s42, s42, 1
s_and_b32 s42, s42, 15
s_add_u32 m0, s39, 49152
s_lshl_b32 s37, s42, 14
buffer_load_dwordx4 v23, s[8:11], s37 offen sc1 lds
s_add_u32 m0, s39, 50176
s_add_u32 s37, s37, s38
buffer_load_dwordx4 v23, s[8:11], s37 offen sc1 lds
s_add_u32 m0, s39, 51200
s_add_u32 s37, s37, s38
buffer_load_dwordx4 v23, s[8:11], s37 offen sc1 lds
s_add_u32 m0, s39, 52224
s_add_u32 s37, s37, s38
buffer_load_dwordx4 v23, s[8:11], s37 offen sc1 lds
s_add_u32 m0, s39, 53248
s_add_u32 s37, s37, s38
buffer_load_dwordx4 v23, s[8:11], s37 offen sc1 lds
s_add_u32 m0, s39, 54272
s_add_u32 s37, s37, s38
buffer_load_dwordx4 v23, s[8:11], s37 offen sc1 lds
s_add_u32 m0, s39, 55296
s_add_u32 s37, s37, s38
buffer_load_dwordx4 v23, s[8:11], s37 offen sc1 lds
s_add_u32 m0, s39, 56320
s_add_u32 s37, s37, s38
buffer_load_dwordx4 v23, s[8:11], s37 offen sc1 lds
s_waitcnt vmcnt(16)
s_barrier
s_add_u32 s42, s42, 1
s_and_b32 s42, s42, 15
s_add_u32 m0, s39, 0
s_lshl_b32 s37, s42, 14
buffer_load_dwordx4 v23, s[8:11], s37 offen sc1 lds
s_add_u32 m0, s39, 1024
s_add_u32 s37, s37, s38
buffer_load_dwordx4 v23, s[8:11], s37 offen sc1 lds
s_add_u32 m0, s39, 2048
s_add_u32 s37, s37, s38
buffer_load_dwordx4 v23, s[8:11], s37 offen sc1 lds
s_add_u32 m0, s39, 3072
s_add_u32 s37, s37, s38
buffer_load_dwordx4 v23, s[8:11], s37 offen sc1 lds
s_add_u32 m0, s39, 4096
s_add_u32 s37, s37, s38
buffer_load_dwordx4 v23, s[8:11], s37 offen sc1 lds
s_add_u32 m0, s39, 5120
s_add_u32 s37, s37, s38
buffer_load_dwordx4 v23, s[8:11], s37 offen sc1 lds
s_add_u32 m0, s39, 6144
s_add_u32 s37, s37, s38
buffer_load_dwordx4 v23, s[8:11], s37 offen sc1 lds
s_add_u32 m0, s39, 7168
s_add_u32 s37, s37, s38
buffer_load_dwordx4 v23, s[8:11], s37 offen sc1 lds
s_waitcnt vmcnt(16)
s_barrier
s_add_u32 s42, s42, 1
s_and_b32 s42, s42, 15
s_add_u32 m0, s39, 16384
s_lshl_b32 s37, s42, 14
buffer_load_dwordx4 v23, s[8:11], s37 offen sc1 lds
s_add_u32 m0, s39, 17408
s_add_u32 s37, s37, s38
buffer_load_dwordx4 v23, s[8:11], s37 offen sc1 lds
s_add_u32 m0, s39, 18432
s_add_u32 s37, s37, s38
buffer_load_dwordx4 v23, s[8:11], s37 offen sc1 lds
s_add_u32 m0, s39, 19456
s_add_u32 s37, s37, s38
buffer_load_dwordx4 v23, s[8:11], s37 offen sc1 lds
s_add_u32 m0, s39, 20480
s_add_u32 s37, s37, s38
buffer_load_dwordx4 v23, s[8:11], s37 offen sc1 lds
s_add_u32 m0, s39, 21504
s_add_u32 s37, s37, s38
buffer_load_dwordx4 v23, s[8:11], s37 offen sc1 lds
s_add_u32 m0, s39, 22528
s_add_u32 s37, s37, s38
buffer_load_dwordx4 v23, s[8:11], s37 offen sc1 lds
s_add_u32 m0, s39, 23552
s_add_u32 s37, s37, s38
buffer_load_dwordx4 v23, s[8:11], s37 offen sc1 lds
s_waitcnt vmcnt(16)
s_barrier
s_add_u32 s42, s42, 1
s_and_b32 s42, s42, 15
s_add_u32 m0, s39, 32768
s_lshl_b32 s37, s42, 14
buffer_load_dwordx4 v23, s[8:11], s37 offen sc1 lds
s_add_u32 m0, s39, 33792
s_add_u32 s37, s37, s38
buffer_load_dwordx4 v23, s[8:11], s37 offen sc1 lds
s_add_u32 m0, s39, 34816
s_add_u32 s37, s37, s38
buffer_load_dwordx4 v23, s[8:11], s37 offen sc1 lds
s_add_u32 m0, s39, 35840
s_add_u32 s37, s37, s38
buffer_load_dwordx4 v23, s[8:11], s37 offen sc1 lds
s_add_u32 m0, s39, 36864
s_add_u32 s37, s37, s38
buffer_load_dwordx4 v23, s[8:11], s37 offen sc1 lds
s_add_u32 m0, s39, 37888
s_add_u32 s37, s37, s38
buffer_load_dwordx4 v23, s[8:11], s37 offen sc1 lds
s_add_u32 m0, s39, 38912
s_add_u32 s37, s37, s38
buffer_load_dwordx4 v23, s[8:11], s37 offen sc1 lds
s_add_u32 m0, s39, 39936
s_add_u32 s37, s37, s38
buffer_load_dwordx4 v23, s[8:11], s37 offen sc1 lds
s_waitcnt vmcnt(16)
s_barrier
s_add_u32 s42, s42, 1
s_and_b32 s42, s42, 15
s_add_u32 m0, s39, 49152
s_lshl_b32 s37, s42, 14
buffer_load_dwordx4 v23, s[8:11], s37 offen sc1 lds
s_add_u32 m0, s39, 50176
s_add_u32 s37, s37, s38
buffer_load_dwordx4 v23, s[8:11], s37 offen sc1 lds
s_add_u32 m0, s39, 51200
s_add_u32 s37, s37, s38
buffer_load_dwordx4 v23, s[8:11], s37 offen sc1 lds
s_add_u32 m0, s39, 52224
s_add_u32 s37, s37, s38
buffer_load_dwordx4 v23, s[8:11], s37 offen sc1 lds
s_add_u32 m0, s39, 53248
s_add_u32 s37, s37, s38
buffer_load_dwordx4 v23, s[8:11], s37 offen sc1 lds
s_add_u32 m0, s39, 54272
s_add_u32 s37, s37, s38
buffer_load_dwordx4 v23, s[8:11], s37 offen sc1 lds
s_add_u32 m0, s39, 55296
s_add_u32 s37, s37, s38
buffer_load_dwordx4 v23, s[8:11], s37 offen sc1 lds
s_add_u32 m0, s39, 56320
s_add_u32 s37, s37, s38
buffer_load_dwordx4 v23, s[8:11], s37 offen sc1 lds
s_waitcnt vmcnt(16)
s_barrier
s_add_u32 s42, s42, 1
s_and_b32 s42, s42, 15
s_add_u32 m0, s39, 0
s_lshl_b32 s37, s42, 14
buffer_load_dwordx4 v23, s[8:11], s37 offen sc1 lds
s_add_u32 m0, s39, 1024
s_add_u32 s37, s37, s38
buffer_load_dwordx4 v23, s[8:11], s37 offen sc1 lds
s_add_u32 m0, s39, 2048
s_add_u32 s37, s37, s38
buffer_load_dwordx4 v23, s[8:11], s37 offen sc1 lds
s_add_u32 m0, s39, 3072
s_add_u32 s37, s37, s38
buffer_load_dwordx4 v23, s[8:11], s37 offen sc1 lds
s_add_u32 m0, s39, 4096
s_add_u32 s37, s37, s38
buffer_load_dwordx4 v23, s[8:11], s37 offen sc1 lds
s_add_u32 m0, s39, 5120
s_add_u32 s37, s37, s38
buffer_load_dwordx4 v23, s[8:11], s37 offen sc1 lds
s_add_u32 m0, s39, 6144
s_add_u32 s37, s37, s38
buffer_load_dwordx4 v23, s[8:11], s37 offen sc1 lds
s_add_u32 m0, s39, 7168
s_add_u32 s37, s37, s38
buffer_load_dwordx4 v23, s[8:11], s37 offen sc1 lds
s_waitcnt vmcnt(16)
s_barrier
s_add_u32 s42, s42, 1
s_and_b32 s42, s42, 15
s_add_u32 m0, s39, 16384
s_lshl_b32 s37, s42, 14
buffer_load_dwordx4 v23, s[8:11], s37 offen sc1 lds
s_add_u32 m0, s39, 17408
s_add_u32 s37, s37, s38
buffer_load_dwordx4 v23, s[8:11], s37 offen sc1 lds
s_add_u32 m0, s39, 18432
s_add_u32 s37, s37, s38
buffer_load_dwordx4 v23, s[8:11], s37 offen sc1 lds
s_add_u32 m0, s39, 19456
s_add_u32 s37, s37, s38
buffer_load_dwordx4 v23, s[8:11], s37 offen sc1 lds
s_add_u32 m0, s39, 20480
s_add_u32 s37, s37, s38
buffer_load_dwordx4 v23, s[8:11], s37 offen sc1 lds
s_add_u32 m0, s39, 21504
s_add_u32 s37, s37, s38
buffer_load_dwordx4 v23, s[8:11], s37 offen sc1 lds
s_add_u32 m0, s39, 22528
s_add_u32 s37, s37, s38
buffer_load_dwordx4 v23, s[8:11], s37 offen sc1 lds
s_add_u32 m0, s39, 23552
s_add_u32 s37, s37, s38
buffer_load_dwordx4 v23, s[8:11], s37 offen sc1 lds
s_waitcnt vmcnt(16)
s_barrier
s_add_u32 s42, s42, 1
s_and_b32 s42, s42, 15
s_add_u32 m0, s39, 32768
s_lshl_b32 s37, s42, 14
buffer_load_dwordx4 v23, s[8:11], s37 offen sc1 lds
s_add_u32 m0, s39, 33792
s_add_u32 s37, s37, s38
buffer_load_dwordx4 v23, s[8:11], s37 offen sc1 lds
s_add_u32 m0, s39, 34816
s_add_u32 s37, s37, s38
buffer_load_dwordx4 v23, s[8:11], s37 offen sc1 lds
s_add_u32 m0, s39, 35840
s_add_u32 s37, s37, s38
buffer_load_dwordx4 v23, s[8:11], s37 offen sc1 lds
s_add_u32 m0, s39, 36864
s_add_u32 s37, s37, s38
buffer_load_dwordx4 v23, s[8:11], s37 offen sc1 lds
s_add_u32 m0, s39, 37888
s_add_u32 s37, s37, s38
buffer_load_dwordx4 v23, s[8:11], s37 offen sc1 lds
s_add_u32 m0, s39, 38912
s_add_u32 s37, s37, s38
buffer_load_dwordx4 v23, s[8:11], s37 offen sc1 lds
s_add_u32 m0, s39, 39936
s_add_u32 s37, s37, s38
buffer_load_dwordx4 v23, s[8:11], s37 offen sc1 lds
s_waitcnt vmcnt(16)
s_barrier
s_add_u32 s42, s42, 1
s_and_b32 s42, s42, 15
s_add_u32 m0, s39, 49152
s_lshl_b32 s37, s42, 14
buffer_load_dwordx4 v23, s[8:11], s37 offen sc1 lds
s_add_u32 m0, s39, 50176
s_add_u32 s37, s37, s38
buffer_load_dwordx4 v23, s[8:11], s37 offen sc1 lds
s_add_u32 m0, s39, 51200
s_add_u32 s37, s37, s38
buffer_load_dwordx4 v23, s[8:11], s37 offen sc1 lds
s_add_u32 m0, s39, 52224
s_add_u32 s37, s37, s38
buffer_load_dwordx4 v23, s[8:11], s37 offen sc1 lds
s_add_u32 m0, s39, 53248
s_add_u32 s37, s37, s38
buffer_load_dwordx4 v23, s[8:11], s37 offen sc1 lds
s_add_u32 m0, s39, 54272
s_add_u32 s37, s37, s38
buffer_load_dwordx4 v23, s[8:11], s37 offen sc1 lds
s_add_u32 m0, s39, 55296
s_add_u32 s37, s37, s38
buffer_load_dwordx4 v23, s[8:11], s37 offen sc1 lds
s_add_u32 m0, s39, 56320
s_add_u32 s37, s37, s38
buffer_load_dwordx4 v23, s[8:11], s37 offen sc1 lds
s_lshl_b32 s43, s35, 8
s_cmp_eq_u32 s51, 1
s_cselect_b32 s8, s4, s6
s_cselect_b32 s9, s5, s7
s_sub_u32 s10, 7340032, s43
s_lshl_b32 s44, s34, 18
s_add_u32 s44, s44, 4194304
s_movk_i32 s38, 28672
s_cmp_eq_u32 s51, 0
s_cselect_b32 s8, s32, s8
s_cselect_b32 s9, s33, s9
s_cselect_b32 s10, 262144, s10
s_cselect_b32 s43, s44, s43
s_cselect_b32 s38, 1024, s38
s_cselect_b32 s45, 0, -1
s_add_u32 s8, s8, s43
s_addc_u32 s9, s9, 0
s_mov_b32 s11, 0x20000
s_lshl_b32 s40, s38, 4
s_add_u32 s42, s35, 15
s_lshl_b32 s39, s51, 14
v_lshrrev_b32 v19, 4, v1
v_lshlrev_b32 v20, 5, v19
v_mul_u32_u24 v19, 6912, v19
v_and_b32 v19, s45, v19
v_and_b32 v20, s45, v20
v_lshlrev_b32 v21, 4, v1
v_xor_b32 v21, v21, v20
v_add_u32 v22, v21, v19
s_and_b32 s45, s45, 128
v_xor_b32 v23, s45, v22
s_waitcnt vmcnt(16)
s_barrier
s_waitcnt vmcnt(8)
s_barrier
s_waitcnt vmcnt(0)
s_barrier
s_barrier
s_barrier
s_add_u32 s43, s34, 16
s_lshl_b32 s43, s43, 7
v_mov_b32 v8, s43
v_mov_b32 v10, 16
buffer_load_dword v9, v8, s[56:59], 0 offen sc1
s_waitcnt vmcnt(0)
s_add_u32 s43, s34, 16
s_lshl_b32 s43, s43, 7
v_mov_b32 v8, s43
v_mov_b32 v10, 16
buffer_load_dword v9, v8, s[56:59], 0 offen sc1
s_waitcnt vmcnt(0)
s_add_u32 s42, s42, 1
s_add_u32 s42, s42, 1
s_and_b32 s42, s42, 15
s_add_u32 m0, s39, 0
s_mul_i32 s37, s42, s40
buffer_load_dwordx4 v22, s[8:11], s37 offen sc1 lds
s_add_u32 m0, s39, 1024
s_add_u32 s37, s37, s38
buffer_load_dwordx4 v23, s[8:11], s37 offen sc1 lds
s_add_u32 m0, s39, 2048
s_add_u32 s37, s37, s38
buffer_load_dwordx4 v22, s[8:11], s37 offen sc1 lds
s_add_u32 m0, s39, 3072
s_add_u32 s37, s37, s38
buffer_load_dwordx4 v23, s[8:11], s37 offen sc1 lds
s_add_u32 m0, s39, 4096
s_add_u32 s37, s37, s38
buffer_load_dwordx4 v22, s[8:11], s37 offen sc1 lds
s_add_u32 m0, s39, 5120
s_add_u32 s37, s37, s38
buffer_load_dwordx4 v23, s[8:11], s37 offen sc1 lds
s_add_u32 m0, s39, 6144
s_add_u32 s37, s37, s38
buffer_load_dwordx4 v22, s[8:11], s37 offen sc1 lds
s_add_u32 m0, s39, 7168
s_add_u32 s37, s37, s38
buffer_load_dwordx4 v23, s[8:11], s37 offen sc1 lds
s_add_u32 m0, s39, 8192
s_add_u32 s37, s37, s38
buffer_load_dwordx4 v22, s[8:11], s37 offen sc1 lds
s_add_u32 m0, s39, 9216
s_add_u32 s37, s37, s38
buffer_load_dwordx4 v23, s[8:11], s37 offen sc1 lds
s_add_u32 m0, s39, 10240
s_add_u32 s37, s37, s38
buffer_load_dwordx4 v22, s[8:11], s37 offen sc1 lds
s_add_u32 m0, s39, 11264
s_add_u32 s37, s37, s38
buffer_load_dwordx4 v23, s[8:11], s37 offen sc1 lds
s_add_u32 m0, s39, 12288
s_add_u32 s37, s37, s38
buffer_load_dwordx4 v22, s[8:11], s37 offen sc1 lds
s_add_u32 m0, s39, 13312
s_add_u32 s37, s37, s38
buffer_load_dwordx4 v23, s[8:11], s37 offen sc1 lds
s_add_u32 m0, s39, 14336
s_add_u32 s37, s37, s38
buffer_load_dwordx4 v22, s[8:11], s37 offen sc1 lds
s_add_u32 m0, s39, 15360
s_add_u32 s37, s37, s38
buffer_load_dwordx4 v23, s[8:11], s37 offen sc1 lds
s_add_u32 s42, s42, 1
s_and_b32 s42, s42, 15
s_add_u32 m0, s39, 49152
s_mul_i32 s37, s42, s40
buffer_load_dwordx4 v22, s[8:11], s37 offen sc1 lds
s_add_u32 m0, s39, 50176
s_add_u32 s37, s37, s38
buffer_load_dwordx4 v23, s[8:11], s37 offen sc1 lds
s_add_u32 m0, s39, 51200
s_add_u32 s37, s37, s38
buffer_load_dwordx4 v22, s[8:11], s37 offen sc1 lds
s_add_u32 m0, s39, 52224
s_add_u32 s37, s37, s38
buffer_load_dwordx4 v23, s[8:11], s37 offen sc1 lds
s_add_u32 m0, s39, 53248
s_add_u32 s37, s37, s38
buffer_load_dwordx4 v22, s[8:11], s37 offen sc1 lds
s_add_u32 m0, s39, 54272
s_add_u32 s37, s37, s38
buffer_load_dwordx4 v23, s[8:11], s37 offen sc1 lds
s_add_u32 m0, s39, 55296
s_add_u32 s37, s37, s38
buffer_load_dwordx4 v22, s[8:11], s37 offen sc1 lds
s_add_u32 m0, s39, 56320
s_add_u32 s37, s37, s38
buffer_load_dwordx4 v23, s[8:11], s37 offen sc1 lds
s_add_u32 m0, s39, 57344
s_add_u32 s37, s37, s38
buffer_load_dwordx4 v22, s[8:11], s37 offen sc1 lds
s_add_u32 m0, s39, 58368
s_add_u32 s37, s37, s38
buffer_load_dwordx4 v23, s[8:11], s37 offen sc1 lds
s_add_u32 m0, s39, 59392
s_add_u32 s37, s37, s38
buffer_load_dwordx4 v22, s[8:11], s37 offen sc1 lds
s_add_u32 m0, s39, 60416
s_add_u32 s37, s37, s38
buffer_load_dwordx4 v23, s[8:11], s37 offen sc1 lds
s_add_u32 m0, s39, 61440
s_add_u32 s37, s37, s38
buffer_load_dwordx4 v22, s[8:11], s37 offen sc1 lds
s_add_u32 m0, s39, 62464
s_add_u32 s37, s37, s38
buffer_load_dwordx4 v23, s[8:11], s37 offen sc1 lds
s_add_u32 m0, s39, 63488
s_add_u32 s37, s37, s38
buffer_load_dwordx4 v22, s[8:11], s37 offen sc1 lds
s_add_u32 m0, s39, 64512
s_add_u32 s37, s37, s38
buffer_load_dwordx4 v23, s[8:11], s37 offen sc1 lds
s_branch LP3_135
.p2align 6
Lw_22:
s_branch Lr_23
s_nop 0
.p2align 3
Lp_137:
s_add_u32 s42, s35, 2
s_waitcnt vmcnt(0)
s_barrier
s_add_u32 s43, s34, 0
s_lshl_b32 s43, s43, 7
v_mov_b32 v13, s43
v_mov_b32 v14, 1
s_mov_b64 exec, 1
buffer_atomic_add v14, v13, s[56:59], 0 offen sc1
s_mov_b64 exec, -1
ds_write_b128 v27, v[68:71] offset:0
ds_write_b128 v27, v[116:119] offset:512
s_waitcnt lgkmcnt(0)
s_barrier
s_add_u32 m0, s54, 16384
s_add_u32 s43, s30, 0
buffer_load_dwordx4 v21, s[12:15], s43 offen sc1 lds
s_add_u32 m0, s54, 17408
s_add_u32 s43, s30, 1024
buffer_load_dwordx4 v21, s[12:15], s43 offen sc1 lds
s_add_u32 m0, s54, 32768
s_add_u32 s43, s31, 0
buffer_load_dwordx4 v21, s[12:15], s43 offen sc1 lds
s_add_u32 m0, s54, 33792
s_add_u32 s43, s31, 1024
buffer_load_dwordx4 v21, s[12:15], s43 offen sc1 lds
s_add_u32 s42, s42, 1
s_and_b32 s42, s42, 15
s_add_u32 m0, s39, 49152
s_lshl_b32 s37, s42, 14
buffer_load_dwordx4 v23, s[8:11], s37 offen sc1 lds
s_add_u32 m0, s39, 50176
s_add_u32 s37, s37, s38
buffer_load_dwordx4 v23, s[8:11], s37 offen sc1 lds
s_add_u32 m0, s39, 51200
s_add_u32 s37, s37, s38
buffer_load_dwordx4 v23, s[8:11], s37 offen sc1 lds
s_add_u32 m0, s39, 52224
s_add_u32 s37, s37, s38
buffer_load_dwordx4 v23, s[8:11], s37 offen sc1 lds
s_add_u32 m0, s39, 53248
s_add_u32 s37, s37, s38
buffer_load_dwordx4 v23, s[8:11], s37 offen sc1 lds
s_add_u32 m0, s39, 54272
s_add_u32 s37, s37, s38
buffer_load_dwordx4 v23, s[8:11], s37 offen sc1 lds
s_add_u32 m0, s39, 55296
s_add_u32 s37, s37, s38
buffer_load_dwordx4 v23, s[8:11], s37 offen sc1 lds
s_add_u32 m0, s39, 56320
s_add_u32 s37, s37, s38
buffer_load_dwordx4 v23, s[8:11], s37 offen sc1 lds
s_waitcnt vmcnt(10)
s_barrier
s_add_u32 s42, s42, 1
s_and_b32 s42, s42, 15
s_add_u32 m0, s39, 0
s_lshl_b32 s37, s42, 14
buffer_load_dwordx4 v23, s[8:11], s37 offen sc1 lds
s_add_u32 m0, s39, 1024
s_add_u32 s37, s37, s38
buffer_load_dwordx4 v23, s[8:11], s37 offen sc1 lds
s_add_u32 m0, s39, 2048
s_add_u32 s37, s37, s38
buffer_load_dwordx4 v23, s[8:11], s37 offen sc1 lds
s_add_u32 m0, s39, 3072
s_add_u32 s37, s37, s38
buffer_load_dwordx4 v23, s[8:11], s37 offen sc1 lds
s_add_u32 m0, s39, 4096
s_add_u32 s37, s37, s38
buffer_load_dwordx4 v23, s[8:11], s37 offen sc1 lds
s_add_u32 m0, s39, 5120
s_add_u32 s37, s37, s38
buffer_load_dwordx4 v23, s[8:11], s37 offen sc1 lds
s_add_u32 m0, s39, 6144
s_add_u32 s37, s37, s38
buffer_load_dwordx4 v23, s[8:11], s37 offen sc1 lds
s_add_u32 m0, s39, 7168
s_add_u32 s37, s37, s38
buffer_load_dwordx4 v23, s[8:11], s37 offen sc1 lds
s_waitcnt vmcnt(16)
s_barrier
s_add_u32 s42, s42, 1
s_and_b32 s42, s42, 15
s_add_u32 m0, s39, 16384
s_lshl_b32 s37, s42, 14
buffer_load_dwordx4 v23, s[8:11], s37 offen sc1 lds
s_add_u32 m0, s39, 17408
s_add_u32 s37, s37, s38
buffer_load_dwordx4 v23, s[8:11], s37 offen sc1 lds
s_add_u32 m0, s39, 18432
s_add_u32 s37, s37, s38
buffer_load_dwordx4 v23, s[8:11], s37 offen sc1 lds
s_add_u32 m0, s39, 19456
s_add_u32 s37, s37, s38
buffer_load_dwordx4 v23, s[8:11], s37 offen sc1 lds
s_add_u32 m0, s39, 20480
s_add_u32 s37, s37, s38
buffer_load_dwordx4 v23, s[8:11], s37 offen sc1 lds
s_add_u32 m0, s39, 21504
s_add_u32 s37, s37, s38
buffer_load_dwordx4 v23, s[8:11], s37 offen sc1 lds
s_add_u32 m0, s39, 22528
s_add_u32 s37, s37, s38
buffer_load_dwordx4 v23, s[8:11], s37 offen sc1 lds
s_add_u32 m0, s39, 23552
s_add_u32 s37, s37, s38
buffer_load_dwordx4 v23, s[8:11], s37 offen sc1 lds
s_waitcnt vmcnt(16)
s_barrier
s_add_u32 s42, s42, 1
s_and_b32 s42, s42, 15
s_add_u32 m0, s39, 32768
s_lshl_b32 s37, s42, 14
buffer_load_dwordx4 v23, s[8:11], s37 offen sc1 lds
s_add_u32 m0, s39, 33792
s_add_u32 s37, s37, s38
buffer_load_dwordx4 v23, s[8:11], s37 offen sc1 lds
s_add_u32 m0, s39, 34816
s_add_u32 s37, s37, s38
buffer_load_dwordx4 v23, s[8:11], s37 offen sc1 lds
s_add_u32 m0, s39, 35840
s_add_u32 s37, s37, s38
buffer_load_dwordx4 v23, s[8:11], s37 offen sc1 lds
s_add_u32 m0, s39, 36864
s_add_u32 s37, s37, s38
buffer_load_dwordx4 v23, s[8:11], s37 offen sc1 lds
s_add_u32 m0, s39, 37888
s_add_u32 s37, s37, s38
buffer_load_dwordx4 v23, s[8:11], s37 offen sc1 lds
s_add_u32 m0, s39, 38912
s_add_u32 s37, s37, s38
buffer_load_dwordx4 v23, s[8:11], s37 offen sc1 lds
s_add_u32 m0, s39, 39936
s_add_u32 s37, s37, s38
buffer_load_dwordx4 v23, s[8:11], s37 offen sc1 lds
s_waitcnt vmcnt(16)
s_barrier
s_add_u32 s42, s42, 1
s_and_b32 s42, s42, 15
s_add_u32 m0, s39, 49152
s_lshl_b32 s37, s42, 14
buffer_load_dwordx4 v23, s[8:11], s37 offen sc1 lds
s_add_u32 m0, s39, 50176
s_add_u32 s37, s37, s38
buffer_load_dwordx4 v23, s[8:11], s37 offen sc1 lds
s_add_u32 m0, s39, 51200
s_add_u32 s37, s37, s38
buffer_load_dwordx4 v23, s[8:11], s37 offen sc1 lds
s_add_u32 m0, s39, 52224
s_add_u32 s37, s37, s38
buffer_load_dwordx4 v23, s[8:11], s37 offen sc1 lds
s_add_u32 m0, s39, 53248
s_add_u32 s37, s37, s38
buffer_load_dwordx4 v23, s[8:11], s37 offen sc1 lds
s_add_u32 m0, s39, 54272
s_add_u32 s37, s37, s38
buffer_load_dwordx4 v23, s[8:11], s37 offen sc1 lds
s_add_u32 m0, s39, 55296
s_add_u32 s37, s37, s38
buffer_load_dwordx4 v23, s[8:11], s37 offen sc1 lds
s_add_u32 m0, s39, 56320
s_add_u32 s37, s37, s38
buffer_load_dwordx4 v23, s[8:11], s37 offen sc1 lds
s_waitcnt vmcnt(16)
s_barrier
s_add_u32 s42, s42, 1
s_and_b32 s42, s42, 15
s_add_u32 m0, s39, 0
s_lshl_b32 s37, s42, 14
buffer_load_dwordx4 v23, s[8:11], s37 offen sc1 lds
s_add_u32 m0, s39, 1024
s_add_u32 s37, s37, s38
buffer_load_dwordx4 v23, s[8:11], s37 offen sc1 lds
s_add_u32 m0, s39, 2048
s_add_u32 s37, s37, s38
buffer_load_dwordx4 v23, s[8:11], s37 offen sc1 lds
s_add_u32 m0, s39, 3072
s_add_u32 s37, s37, s38
buffer_load_dwordx4 v23, s[8:11], s37 offen sc1 lds
s_add_u32 m0, s39, 4096
s_add_u32 s37, s37, s38
buffer_load_dwordx4 v23, s[8:11], s37 offen sc1 lds
s_add_u32 m0, s39, 5120
s_add_u32 s37, s37, s38
buffer_load_dwordx4 v23, s[8:11], s37 offen sc1 lds
s_add_u32 m0, s39, 6144
s_add_u32 s37, s37, s38
buffer_load_dwordx4 v23, s[8:11], s37 offen sc1 lds
s_add_u32 m0, s39, 7168
s_add_u32 s37, s37, s38
buffer_load_dwordx4 v23, s[8:11], s37 offen sc1 lds
s_waitcnt vmcnt(16)
s_barrier
s_add_u32 s42, s42, 1
s_and_b32 s42, s42, 15
s_add_u32 m0, s39, 16384
s_lshl_b32 s37, s42, 14
buffer_load_dwordx4 v23, s[8:11], s37 offen sc1 lds
s_add_u32 m0, s39, 17408
s_add_u32 s37, s37, s38
buffer_load_dwordx4 v23, s[8:11], s37 offen sc1 lds
s_add_u32 m0, s39, 18432
s_add_u32 s37, s37, s38
buffer_load_dwordx4 v23, s[8:11], s37 offen sc1 lds
s_add_u32 m0, s39, 19456
s_add_u32 s37, s37, s38
buffer_load_dwordx4 v23, s[8:11], s37 offen sc1 lds
s_add_u32 m0, s39, 20480
s_add_u32 s37, s37, s38
buffer_load_dwordx4 v23, s[8:11], s37 offen sc1 lds
s_add_u32 m0, s39, 21504
s_add_u32 s37, s37, s38
buffer_load_dwordx4 v23, s[8:11], s37 offen sc1 lds
s_add_u32 m0, s39, 22528
s_add_u32 s37, s37, s38
buffer_load_dwordx4 v23, s[8:11], s37 offen sc1 lds
s_add_u32 m0, s39, 23552
s_add_u32 s37, s37, s38
buffer_load_dwordx4 v23, s[8:11], s37 offen sc1 lds
s_waitcnt vmcnt(16)
s_barrier
s_add_u32 s42, s42, 1
s_and_b32 s42, s42, 15
s_add_u32 m0, s39, 32768
s_lshl_b32 s37, s42, 14
buffer_load_dwordx4 v23, s[8:11], s37 offen sc1 lds
s_add_u32 m0, s39, 33792
s_add_u32 s37, s37, s38
buffer_load_dwordx4 v23, s[8:11], s37 offen sc1 lds
s_add_u32 m0, s39, 34816
s_add_u32 s37, s37, s38
buffer_load_dwordx4 v23, s[8:11], s37 offen sc1 lds
s_add_u32 m0, s39, 35840
s_add_u32 s37, s37, s38
buffer_load_dwordx4 v23, s[8:11], s37 offen sc1 lds
s_add_u32 m0, s39, 36864
s_add_u32 s37, s37, s38
buffer_load_dwordx4 v23, s[8:11], s37 offen sc1 lds
s_add_u32 m0, s39, 37888
s_add_u32 s37, s37, s38
buffer_load_dwordx4 v23, s[8:11], s37 offen sc1 lds
s_add_u32 m0, s39, 38912
s_add_u32 s37, s37, s38
buffer_load_dwordx4 v23, s[8:11], s37 offen sc1 lds
s_add_u32 m0, s39, 39936
s_add_u32 s37, s37, s38
buffer_load_dwordx4 v23, s[8:11], s37 offen sc1 lds
s_waitcnt vmcnt(16)
s_barrier
s_add_u32 s42, s42, 1
s_and_b32 s42, s42, 15
s_add_u32 m0, s39, 49152
s_lshl_b32 s37, s42, 14
buffer_load_dwordx4 v23, s[8:11], s37 offen sc1 lds
s_add_u32 m0, s39, 50176
s_add_u32 s37, s37, s38
buffer_load_dwordx4 v23, s[8:11], s37 offen sc1 lds
s_add_u32 m0, s39, 51200
s_add_u32 s37, s37, s38
buffer_load_dwordx4 v23, s[8:11], s37 offen sc1 lds
s_add_u32 m0, s39, 52224
s_add_u32 s37, s37, s38
buffer_load_dwordx4 v23, s[8:11], s37 offen sc1 lds
s_add_u32 m0, s39, 53248
s_add_u32 s37, s37, s38
buffer_load_dwordx4 v23, s[8:11], s37 offen sc1 lds
s_add_u32 m0, s39, 54272
s_add_u32 s37, s37, s38
buffer_load_dwordx4 v23, s[8:11], s37 offen sc1 lds
s_add_u32 m0, s39, 55296
s_add_u32 s37, s37, s38
buffer_load_dwordx4 v23, s[8:11], s37 offen sc1 lds
s_add_u32 m0, s39, 56320
s_add_u32 s37, s37, s38
buffer_load_dwordx4 v23, s[8:11], s37 offen sc1 lds
s_waitcnt vmcnt(16)
s_barrier
s_add_u32 s42, s42, 1
s_and_b32 s42, s42, 15
s_add_u32 m0, s39, 0
s_lshl_b32 s37, s42, 14
buffer_load_dwordx4 v23, s[8:11], s37 offen sc1 lds
s_add_u32 m0, s39, 1024
s_add_u32 s37, s37, s38
buffer_load_dwordx4 v23, s[8:11], s37 offen sc1 lds
s_add_u32 m0, s39, 2048
s_add_u32 s37, s37, s38
buffer_load_dwordx4 v23, s[8:11], s37 offen sc1 lds
s_add_u32 m0, s39, 3072
s_add_u32 s37, s37, s38
buffer_load_dwordx4 v23, s[8:11], s37 offen sc1 lds
s_add_u32 m0, s39, 4096
s_add_u32 s37, s37, s38
buffer_load_dwordx4 v23, s[8:11], s37 offen sc1 lds
s_add_u32 m0, s39, 5120
s_add_u32 s37, s37, s38
buffer_load_dwordx4 v23, s[8:11], s37 offen sc1 lds
s_add_u32 m0, s39, 6144
s_add_u32 s37, s37, s38
buffer_load_dwordx4 v23, s[8:11], s37 offen sc1 lds
s_add_u32 m0, s39, 7168
s_add_u32 s37, s37, s38
buffer_load_dwordx4 v23, s[8:11], s37 offen sc1 lds
s_waitcnt vmcnt(16)
s_barrier
s_add_u32 s42, s42, 1
s_and_b32 s42, s42, 15
s_add_u32 m0, s39, 16384
s_lshl_b32 s37, s42, 14
buffer_load_dwordx4 v23, s[8:11], s37 offen sc1 lds
s_add_u32 m0, s39, 17408
s_add_u32 s37, s37, s38
buffer_load_dwordx4 v23, s[8:11], s37 offen sc1 lds
s_add_u32 m0, s39, 18432
s_add_u32 s37, s37, s38
buffer_load_dwordx4 v23, s[8:11], s37 offen sc1 lds
s_add_u32 m0, s39, 19456
s_add_u32 s37, s37, s38
buffer_load_dwordx4 v23, s[8:11], s37 offen sc1 lds
s_add_u32 m0, s39, 20480
s_add_u32 s37, s37, s38
buffer_load_dwordx4 v23, s[8:11], s37 offen sc1 lds
s_add_u32 m0, s39, 21504
s_add_u32 s37, s37, s38
buffer_load_dwordx4 v23, s[8:11], s37 offen sc1 lds
s_add_u32 m0, s39, 22528
s_add_u32 s37, s37, s38
buffer_load_dwordx4 v23, s[8:11], s37 offen sc1 lds
s_add_u32 m0, s39, 23552
s_add_u32 s37, s37, s38
buffer_load_dwordx4 v23, s[8:11], s37 offen sc1 lds
s_waitcnt vmcnt(16)
s_barrier
s_add_u32 s42, s42, 1
s_and_b32 s42, s42, 15
s_add_u32 m0, s39, 32768
s_lshl_b32 s37, s42, 14
buffer_load_dwordx4 v23, s[8:11], s37 offen sc1 lds
s_add_u32 m0, s39, 33792
s_add_u32 s37, s37, s38
buffer_load_dwordx4 v23, s[8:11], s37 offen sc1 lds
s_add_u32 m0, s39, 34816
s_add_u32 s37, s37, s38
buffer_load_dwordx4 v23, s[8:11], s37 offen sc1 lds
s_add_u32 m0, s39, 35840
s_add_u32 s37, s37, s38
buffer_load_dwordx4 v23, s[8:11], s37 offen sc1 lds
s_add_u32 m0, s39, 36864
s_add_u32 s37, s37, s38
buffer_load_dwordx4 v23, s[8:11], s37 offen sc1 lds
s_add_u32 m0, s39, 37888
s_add_u32 s37, s37, s38
buffer_load_dwordx4 v23, s[8:11], s37 offen sc1 lds
s_add_u32 m0, s39, 38912
s_add_u32 s37, s37, s38
buffer_load_dwordx4 v23, s[8:11], s37 offen sc1 lds
s_add_u32 m0, s39, 39936
s_add_u32 s37, s37, s38
buffer_load_dwordx4 v23, s[8:11], s37 offen sc1 lds
s_waitcnt vmcnt(16)
s_barrier
s_add_u32 s42, s42, 1
s_and_b32 s42, s42, 15
s_add_u32 m0, s39, 49152
s_lshl_b32 s37, s42, 14
buffer_load_dwordx4 v23, s[8:11], s37 offen sc1 lds
s_add_u32 m0, s39, 50176
s_add_u32 s37, s37, s38
buffer_load_dwordx4 v23, s[8:11], s37 offen sc1 lds
s_add_u32 m0, s39, 51200
s_add_u32 s37, s37, s38
buffer_load_dwordx4 v23, s[8:11], s37 offen sc1 lds
s_add_u32 m0, s39, 52224
s_add_u32 s37, s37, s38
buffer_load_dwordx4 v23, s[8:11], s37 offen sc1 lds
s_add_u32 m0, s39, 53248
s_add_u32 s37, s37, s38
buffer_load_dwordx4 v23, s[8:11], s37 offen sc1 lds
s_add_u32 m0, s39, 54272
s_add_u32 s37, s37, s38
buffer_load_dwordx4 v23, s[8:11], s37 offen sc1 lds
s_add_u32 m0, s39, 55296
s_add_u32 s37, s37, s38
buffer_load_dwordx4 v23, s[8:11], s37 offen sc1 lds
s_add_u32 m0, s39, 56320
s_add_u32 s37, s37, s38
buffer_load_dwordx4 v23, s[8:11], s37 offen sc1 lds
s_lshl_b32 s43, s35, 8
s_cmp_eq_u32 s51, 1
s_cselect_b32 s8, s4, s6
s_cselect_b32 s9, s5, s7
s_sub_u32 s10, 7340032, s43
s_lshl_b32 s44, s34, 18
s_add_u32 s44, s44, 4194304
s_movk_i32 s38, 28672
s_cmp_eq_u32 s51, 0
s_cselect_b32 s8, s32, s8
s_cselect_b32 s9, s33, s9
s_cselect_b32 s10, 262144, s10
s_cselect_b32 s43, s44, s43
s_cselect_b32 s38, 1024, s38
s_cselect_b32 s45, 0, -1
s_add_u32 s8, s8, s43
s_addc_u32 s9, s9, 0
s_mov_b32 s11, 0x20000
s_lshl_b32 s40, s38, 4
s_add_u32 s42, s35, 15
s_lshl_b32 s39, s51, 14
v_lshrrev_b32 v19, 4, v1
v_lshlrev_b32 v20, 5, v19
v_mul_u32_u24 v19, 6912, v19
v_and_b32 v19, s45, v19
v_and_b32 v20, s45, v20
v_lshlrev_b32 v21, 4, v1
v_xor_b32 v21, v21, v20
v_add_u32 v22, v21, v19
s_and_b32 s45, s45, 128
v_xor_b32 v23, s45, v22
s_waitcnt vmcnt(16)
s_barrier
s_add_u32 s42, s42, 1
s_and_b32 s42, s42, 15
s_add_u32 m0, s39, 98304
s_mul_i32 s37, s42, s40
buffer_load_dwordx4 v22, s[8:11], s37 offen sc1 lds
s_add_u32 m0, s39, 99328
s_add_u32 s37, s37, s38
buffer_load_dwordx4 v23, s[8:11], s37 offen sc1 lds
s_add_u32 m0, s39, 100352
s_add_u32 s37, s37, s38
buffer_load_dwordx4 v22, s[8:11], s37 offen sc1 lds
s_add_u32 m0, s39, 101376
s_add_u32 s37, s37, s38
buffer_load_dwordx4 v23, s[8:11], s37 offen sc1 lds
s_add_u32 m0, s39, 102400
s_add_u32 s37, s37, s38
buffer_load_dwordx4 v22, s[8:11], s37 offen sc1 lds
s_add_u32 m0, s39, 103424
s_add_u32 s37, s37, s38
buffer_load_dwordx4 v23, s[8:11], s37 offen sc1 lds
s_add_u32 m0, s39, 104448
s_add_u32 s37, s37, s38
buffer_load_dwordx4 v22, s[8:11], s37 offen sc1 lds
s_add_u32 m0, s39, 105472
s_add_u32 s37, s37, s38
buffer_load_dwordx4 v23, s[8:11], s37 offen sc1 lds
s_add_u32 m0, s39, 106496
s_add_u32 s37, s37, s38
buffer_load_dwordx4 v22, s[8:11], s37 offen sc1 lds
s_add_u32 m0, s39, 107520
s_add_u32 s37, s37, s38
buffer_load_dwordx4 v23, s[8:11], s37 offen sc1 lds
s_add_u32 m0, s39, 108544
s_add_u32 s37, s37, s38
buffer_load_dwordx4 v22, s[8:11], s37 offen sc1 lds
s_add_u32 m0, s39, 109568
s_add_u32 s37, s37, s38
buffer_load_dwordx4 v23, s[8:11], s37 offen sc1 lds
s_add_u32 m0, s39, 110592
s_add_u32 s37, s37, s38
buffer_load_dwordx4 v22, s[8:11], s37 offen sc1 lds
s_add_u32 m0, s39, 111616
s_add_u32 s37, s37, s38
buffer_load_dwordx4 v23, s[8:11], s37 offen sc1 lds
s_add_u32 m0, s39, 112640
s_add_u32 s37, s37, s38
buffer_load_dwordx4 v22, s[8:11], s37 offen sc1 lds
s_add_u32 m0, s39, 113664
s_add_u32 s37, s37, s38
buffer_load_dwordx4 v23, s[8:11], s37 offen sc1 lds
s_waitcnt vmcnt(24)
s_barrier
s_waitcnt vmcnt(16)
s_barrier
s_add_u32 s42, s42, 1
s_and_b32 s42, s42, 15
s_add_u32 m0, s39, 0
s_mul_i32 s37, s42, s40
buffer_load_dwordx4 v22, s[8:11], s37 offen sc1 lds
s_add_u32 m0, s39, 1024
s_add_u32 s37, s37, s38
buffer_load_dwordx4 v23, s[8:11], s37 offen sc1 lds
s_add_u32 m0, s39, 2048
s_add_u32 s37, s37, s38
buffer_load_dwordx4 v22, s[8:11], s37 offen sc1 lds
s_add_u32 m0, s39, 3072
s_add_u32 s37, s37, s38
buffer_load_dwordx4 v23, s[8:11], s37 offen sc1 lds
s_add_u32 m0, s39, 4096
s_add_u32 s37, s37, s38
buffer_load_dwordx4 v22, s[8:11], s37 offen sc1 lds
s_add_u32 m0, s39, 5120
s_add_u32 s37, s37, s38
buffer_load_dwordx4 v23, s[8:11], s37 offen sc1 lds
s_add_u32 m0, s39, 6144
s_add_u32 s37, s37, s38
buffer_load_dwordx4 v22, s[8:11], s37 offen sc1 lds
s_add_u32 m0, s39, 7168
s_add_u32 s37, s37, s38
buffer_load_dwordx4 v23, s[8:11], s37 offen sc1 lds
s_add_u32 m0, s39, 8192
s_add_u32 s37, s37, s38
buffer_load_dwordx4 v22, s[8:11], s37 offen sc1 lds
s_add_u32 m0, s39, 9216
s_add_u32 s37, s37, s38
buffer_load_dwordx4 v23, s[8:11], s37 offen sc1 lds
s_add_u32 m0, s39, 10240
s_add_u32 s37, s37, s38
buffer_load_dwordx4 v22, s[8:11], s37 offen sc1 lds
s_add_u32 m0, s39, 11264
s_add_u32 s37, s37, s38
buffer_load_dwordx4 v23, s[8:11], s37 offen sc1 lds
s_add_u32 m0, s39, 12288
s_add_u32 s37, s37, s38
buffer_load_dwordx4 v22, s[8:11], s37 offen sc1 lds
s_add_u32 m0, s39, 13312
s_add_u32 s37, s37, s38
buffer_load_dwordx4 v23, s[8:11], s37 offen sc1 lds
s_add_u32 m0, s39, 14336
s_add_u32 s37, s37, s38
buffer_load_dwordx4 v22, s[8:11], s37 offen sc1 lds
s_add_u32 m0, s39, 15360
s_add_u32 s37, s37, s38
buffer_load_dwordx4 v23, s[8:11], s37 offen sc1 lds
s_barrier
s_waitcnt vmcnt(16)
s_barrier
s_add_u32 s42, s42, 1
s_and_b32 s42, s42, 15
s_add_u32 m0, s39, 49152
s_mul_i32 s37, s42, s40
buffer_load_dwordx4 v22, s[8:11], s37 offen sc1 lds
s_add_u32 m0, s39, 50176
s_add_u32 s37, s37, s38
buffer_load_dwordx4 v23, s[8:11], s37 offen sc1 lds
s_add_u32 m0, s39, 51200
s_add_u32 s37, s37, s38
buffer_load_dwordx4 v22, s[8:11], s37 offen sc1 lds
s_add_u32 m0, s39, 52224
s_add_u32 s37, s37, s38
buffer_load_dwordx4 v23, s[8:11], s37 offen sc1 lds
s_add_u32 m0, s39, 53248
s_add_u32 s37, s37, s38
buffer_load_dwordx4 v22, s[8:11], s37 offen sc1 lds
s_add_u32 m0, s39, 54272
s_add_u32 s37, s37, s38
buffer_load_dwordx4 v23, s[8:11], s37 offen sc1 lds
s_add_u32 m0, s39, 55296
s_add_u32 s37, s37, s38
buffer_load_dwordx4 v22, s[8:11], s37 offen sc1 lds
s_add_u32 m0, s39, 56320
s_add_u32 s37, s37, s38
buffer_load_dwordx4 v23, s[8:11], s37 offen sc1 lds
s_add_u32 m0, s39, 57344
s_add_u32 s37, s37, s38
buffer_load_dwordx4 v22, s[8:11], s37 offen sc1 lds
s_add_u32 m0, s39, 58368
s_add_u32 s37, s37, s38
buffer_load_dwordx4 v23, s[8:11], s37 offen sc1 lds
s_add_u32 m0, s39, 59392
s_add_u32 s37, s37, s38
buffer_load_dwordx4 v22, s[8:11], s37 offen sc1 lds
s_add_u32 m0, s39, 60416
s_add_u32 s37, s37, s38
buffer_load_dwordx4 v23, s[8:11], s37 offen sc1 lds
s_add_u32 m0, s39, 61440
s_add_u32 s37, s37, s38
buffer_load_dwordx4 v22, s[8:11], s37 offen sc1 lds
s_add_u32 m0, s39, 62464
s_add_u32 s37, s37, s38
buffer_load_dwordx4 v23, s[8:11], s37 offen sc1 lds
s_add_u32 m0, s39, 63488
s_add_u32 s37, s37, s38
buffer_load_dwordx4 v22, s[8:11], s37 offen sc1 lds
s_add_u32 m0, s39, 64512
s_add_u32 s37, s37, s38
buffer_load_dwordx4 v23, s[8:11], s37 offen sc1 lds
s_branch LP3_135
.p2align 6
Lw_20:
s_branch Lr_21
s_nop 0
.p2align 3
Lp_138:
s_add_u32 s42, s35, 15
s_waitcnt vmcnt(0)
s_barrier
ds_write_b128 v27, v[68:71] offset:0
ds_write_b128 v27, v[116:119] offset:512
s_add_u32 s42, s42, 1
s_and_b32 s42, s42, 15
s_add_u32 m0, s39, 49152
s_lshl_b32 s37, s42, 17
buffer_load_dwordx4 v23, s[8:11], s37 offen sc1 lds
s_add_u32 m0, s39, 50176
s_add_u32 s37, s37, s38
buffer_load_dwordx4 v23, s[8:11], s37 offen sc1 lds
s_add_u32 m0, s39, 51200
s_add_u32 s37, s37, s38
buffer_load_dwordx4 v23, s[8:11], s37 offen sc1 lds
s_add_u32 m0, s39, 52224
s_add_u32 s37, s37, s38
buffer_load_dwordx4 v23, s[8:11], s37 offen sc1 lds
s_add_u32 m0, s39, 53248
s_add_u32 s37, s37, s38
buffer_load_dwordx4 v23, s[8:11], s37 offen sc1 lds
s_add_u32 m0, s39, 54272
s_add_u32 s37, s37, s38
buffer_load_dwordx4 v23, s[8:11], s37 offen sc1 lds
s_add_u32 m0, s39, 55296
s_add_u32 s37, s37, s38
buffer_load_dwordx4 v23, s[8:11], s37 offen sc1 lds
s_add_u32 m0, s39, 56320
s_add_u32 s37, s37, s38
buffer_load_dwordx4 v23, s[8:11], s37 offen sc1 lds
s_add_u32 s42, s42, 1
s_and_b32 s42, s42, 15
s_add_u32 m0, s39, 57344
s_lshl_b32 s37, s42, 17
buffer_load_dwordx4 v23, s[8:11], s37 offen sc1 lds
s_add_u32 m0, s39, 58368
s_add_u32 s37, s37, s38
buffer_load_dwordx4 v23, s[8:11], s37 offen sc1 lds
s_add_u32 m0, s39, 59392
s_add_u32 s37, s37, s38
buffer_load_dwordx4 v23, s[8:11], s37 offen sc1 lds
s_add_u32 m0, s39, 60416
s_add_u32 s37, s37, s38
buffer_load_dwordx4 v23, s[8:11], s37 offen sc1 lds
s_add_u32 m0, s39, 61440
s_add_u32 s37, s37, s38
buffer_load_dwordx4 v23, s[8:11], s37 offen sc1 lds
s_add_u32 m0, s39, 62464
s_add_u32 s37, s37, s38
buffer_load_dwordx4 v23, s[8:11], s37 offen sc1 lds
s_add_u32 m0, s39, 63488
s_add_u32 s37, s37, s38
buffer_load_dwordx4 v23, s[8:11], s37 offen sc1 lds
s_add_u32 m0, s39, 64512
s_add_u32 s37, s37, s38
buffer_load_dwordx4 v23, s[8:11], s37 offen sc1 lds
s_waitcnt vmcnt(8)
s_waitcnt lgkmcnt(0)
s_barrier
s_add_u32 m0, s54, 16384
s_add_u32 s43, s30, 0
buffer_load_dwordx4 v21, s[12:15], s43 offen sc1 lds
s_add_u32 m0, s54, 17408
s_add_u32 s43, s30, 1024
buffer_load_dwordx4 v21, s[12:15], s43 offen sc1 lds
s_add_u32 m0, s54, 32768
s_add_u32 s43, s31, 0
buffer_load_dwordx4 v21, s[12:15], s43 offen sc1 lds
s_add_u32 m0, s54, 33792
s_add_u32 s43, s31, 1024
buffer_load_dwordx4 v21, s[12:15], s43 offen sc1 lds
s_add_u32 s42, s42, 1
s_and_b32 s42, s42, 15
s_add_u32 m0, s39, 65536
s_lshl_b32 s37, s42, 17
buffer_load_dwordx4 v23, s[8:11], s37 offen sc1 lds
s_add_u32 m0, s39, 66560
s_add_u32 s37, s37, s38
buffer_load_dwordx4 v23, s[8:11], s37 offen sc1 lds
s_add_u32 m0, s39, 67584
s_add_u32 s37, s37, s38
buffer_load_dwordx4 v23, s[8:11], s37 offen sc1 lds
s_add_u32 m0, s39, 68608
s_add_u32 s37, s37, s38
buffer_load_dwordx4 v23, s[8:11], s37 offen sc1 lds
s_add_u32 m0, s39, 69632
s_add_u32 s37, s37, s38
buffer_load_dwordx4 v23, s[8:11], s37 offen sc1 lds
s_add_u32 m0, s39, 70656
s_add_u32 s37, s37, s38
buffer_load_dwordx4 v23, s[8:11], s37 offen sc1 lds
s_add_u32 m0, s39, 71680
s_add_u32 s37, s37, s38
buffer_load_dwordx4 v23, s[8:11], s37 offen sc1 lds
s_add_u32 m0, s39, 72704
s_add_u32 s37, s37, s38
buffer_load_dwordx4 v23, s[8:11], s37 offen sc1 lds
s_waitcnt vmcnt(10)
s_barrier
s_add_u32 s42, s42, 1
s_and_b32 s42, s42, 15
s_add_u32 m0, s39, 73728
s_lshl_b32 s37, s42, 17
buffer_load_dwordx4 v23, s[8:11], s37 offen sc1 lds
s_add_u32 m0, s39, 74752
s_add_u32 s37, s37, s38
buffer_load_dwordx4 v23, s[8:11], s37 offen sc1 lds
s_add_u32 m0, s39, 75776
s_add_u32 s37, s37, s38
buffer_load_dwordx4 v23, s[8:11], s37 offen sc1 lds
s_add_u32 m0, s39, 76800
s_add_u32 s37, s37, s38
buffer_load_dwordx4 v23, s[8:11], s37 offen sc1 lds
s_add_u32 m0, s39, 77824
s_add_u32 s37, s37, s38
buffer_load_dwordx4 v23, s[8:11], s37 offen sc1 lds
s_add_u32 m0, s39, 78848
s_add_u32 s37, s37, s38
buffer_load_dwordx4 v23, s[8:11], s37 offen sc1 lds
s_add_u32 m0, s39, 79872
s_add_u32 s37, s37, s38
buffer_load_dwordx4 v23, s[8:11], s37 offen sc1 lds
s_add_u32 m0, s39, 80896
s_add_u32 s37, s37, s38
buffer_load_dwordx4 v23, s[8:11], s37 offen sc1 lds
s_waitcnt vmcnt(8)
s_barrier
s_add_u32 s42, s42, 1
s_and_b32 s42, s42, 15
s_add_u32 m0, s39, 81920
s_lshl_b32 s37, s42, 17
buffer_load_dwordx4 v23, s[8:11], s37 offen sc1 lds
s_add_u32 m0, s39, 82944
s_add_u32 s37, s37, s38
buffer_load_dwordx4 v23, s[8:11], s37 offen sc1 lds
s_add_u32 m0, s39, 83968
s_add_u32 s37, s37, s38
buffer_load_dwordx4 v23, s[8:11], s37 offen sc1 lds
s_add_u32 m0, s39, 84992
s_add_u32 s37, s37, s38
buffer_load_dwordx4 v23, s[8:11], s37 offen sc1 lds
s_add_u32 m0, s39, 86016
s_add_u32 s37, s37, s38
buffer_load_dwordx4 v23, s[8:11], s37 offen sc1 lds
s_add_u32 m0, s39, 87040
s_add_u32 s37, s37, s38
buffer_load_dwordx4 v23, s[8:11], s37 offen sc1 lds
s_add_u32 m0, s39, 88064
s_add_u32 s37, s37, s38
buffer_load_dwordx4 v23, s[8:11], s37 offen sc1 lds
s_add_u32 m0, s39, 89088
s_add_u32 s37, s37, s38
buffer_load_dwordx4 v23, s[8:11], s37 offen sc1 lds
s_add_u32 s42, s42, 1
s_and_b32 s42, s42, 15
s_add_u32 m0, s39, 90112
s_lshl_b32 s37, s42, 17
buffer_load_dwordx4 v23, s[8:11], s37 offen sc1 lds
s_add_u32 m0, s39, 91136
s_add_u32 s37, s37, s38
buffer_load_dwordx4 v23, s[8:11], s37 offen sc1 lds
s_add_u32 m0, s39, 92160
s_add_u32 s37, s37, s38
buffer_load_dwordx4 v23, s[8:11], s37 offen sc1 lds
s_add_u32 m0, s39, 93184
s_add_u32 s37, s37, s38
buffer_load_dwordx4 v23, s[8:11], s37 offen sc1 lds
s_add_u32 m0, s39, 94208
s_add_u32 s37, s37, s38
buffer_load_dwordx4 v23, s[8:11], s37 offen sc1 lds
s_add_u32 m0, s39, 95232
s_add_u32 s37, s37, s38
buffer_load_dwordx4 v23, s[8:11], s37 offen sc1 lds
s_add_u32 m0, s39, 96256
s_add_u32 s37, s37, s38
buffer_load_dwordx4 v23, s[8:11], s37 offen sc1 lds
s_add_u32 m0, s39, 97280
s_add_u32 s37, s37, s38
buffer_load_dwordx4 v23, s[8:11], s37 offen sc1 lds
s_waitcnt vmcnt(16)
s_barrier
s_add_u32 s42, s42, 1
s_and_b32 s42, s42, 15
s_add_u32 m0, s39, 98304
s_lshl_b32 s37, s42, 17
buffer_load_dwordx4 v23, s[8:11], s37 offen sc1 lds
s_add_u32 m0, s39, 99328
s_add_u32 s37, s37, s38
buffer_load_dwordx4 v23, s[8:11], s37 offen sc1 lds
s_add_u32 m0, s39, 100352
s_add_u32 s37, s37, s38
buffer_load_dwordx4 v23, s[8:11], s37 offen sc1 lds
s_add_u32 m0, s39, 101376
s_add_u32 s37, s37, s38
buffer_load_dwordx4 v23, s[8:11], s37 offen sc1 lds
s_add_u32 m0, s39, 102400
s_add_u32 s37, s37, s38
buffer_load_dwordx4 v23, s[8:11], s37 offen sc1 lds
s_add_u32 m0, s39, 103424
s_add_u32 s37, s37, s38
buffer_load_dwordx4 v23, s[8:11], s37 offen sc1 lds
s_add_u32 m0, s39, 104448
s_add_u32 s37, s37, s38
buffer_load_dwordx4 v23, s[8:11], s37 offen sc1 lds
s_add_u32 m0, s39, 105472
s_add_u32 s37, s37, s38
buffer_load_dwordx4 v23, s[8:11], s37 offen sc1 lds
s_add_u32 s42, s42, 1
s_and_b32 s42, s42, 15
s_add_u32 m0, s39, 106496
s_lshl_b32 s37, s42, 17
buffer_load_dwordx4 v23, s[8:11], s37 offen sc1 lds
s_add_u32 m0, s39, 107520
s_add_u32 s37, s37, s38
buffer_load_dwordx4 v23, s[8:11], s37 offen sc1 lds
s_add_u32 m0, s39, 108544
s_add_u32 s37, s37, s38
buffer_load_dwordx4 v23, s[8:11], s37 offen sc1 lds
s_add_u32 m0, s39, 109568
s_add_u32 s37, s37, s38
buffer_load_dwordx4 v23, s[8:11], s37 offen sc1 lds
s_add_u32 m0, s39, 110592
s_add_u32 s37, s37, s38
buffer_load_dwordx4 v23, s[8:11], s37 offen sc1 lds
s_add_u32 m0, s39, 111616
s_add_u32 s37, s37, s38
buffer_load_dwordx4 v23, s[8:11], s37 offen sc1 lds
s_add_u32 m0, s39, 112640
s_add_u32 s37, s37, s38
buffer_load_dwordx4 v23, s[8:11], s37 offen sc1 lds
s_add_u32 m0, s39, 113664
s_add_u32 s37, s37, s38
buffer_load_dwordx4 v23, s[8:11], s37 offen sc1 lds
s_waitcnt vmcnt(24)
s_barrier
s_add_u32 s42, s42, 1
s_and_b32 s42, s42, 15
s_add_u32 m0, s39, 114688
s_lshl_b32 s37, s42, 17
buffer_load_dwordx4 v23, s[8:11], s37 offen sc1 lds
s_add_u32 m0, s39, 115712
s_add_u32 s37, s37, s38
buffer_load_dwordx4 v23, s[8:11], s37 offen sc1 lds
s_add_u32 m0, s39, 116736
s_add_u32 s37, s37, s38
buffer_load_dwordx4 v23, s[8:11], s37 offen sc1 lds
s_add_u32 m0, s39, 117760
s_add_u32 s37, s37, s38
buffer_load_dwordx4 v23, s[8:11], s37 offen sc1 lds
s_add_u32 m0, s39, 118784
s_add_u32 s37, s37, s38
buffer_load_dwordx4 v23, s[8:11], s37 offen sc1 lds
s_add_u32 m0, s39, 119808
s_add_u32 s37, s37, s38
buffer_load_dwordx4 v23, s[8:11], s37 offen sc1 lds
s_add_u32 m0, s39, 120832
s_add_u32 s37, s37, s38
buffer_load_dwordx4 v23, s[8:11], s37 offen sc1 lds
s_add_u32 m0, s39, 121856
s_add_u32 s37, s37, s38
buffer_load_dwordx4 v23, s[8:11], s37 offen sc1 lds
s_add_u32 s42, s42, 1
s_and_b32 s42, s42, 15
s_add_u32 m0, s39, 122880
s_lshl_b32 s37, s42, 17
buffer_load_dwordx4 v23, s[8:11], s37 offen sc1 lds
s_add_u32 m0, s39, 123904
s_add_u32 s37, s37, s38
buffer_load_dwordx4 v23, s[8:11], s37 offen sc1 lds
s_add_u32 m0, s39, 124928
s_add_u32 s37, s37, s38
buffer_load_dwordx4 v23, s[8:11], s37 offen sc1 lds
s_add_u32 m0, s39, 125952
s_add_u32 s37, s37, s38
buffer_load_dwordx4 v23, s[8:11], s37 offen sc1 lds
s_add_u32 m0, s39, 126976
s_add_u32 s37, s37, s38
buffer_load_dwordx4 v23, s[8:11], s37 offen sc1 lds
s_add_u32 m0, s39, 128000
s_add_u32 s37, s37, s38
buffer_load_dwordx4 v23, s[8:11], s37 offen sc1 lds
s_add_u32 m0, s39, 129024
s_add_u32 s37, s37, s38
buffer_load_dwordx4 v23, s[8:11], s37 offen sc1 lds
s_add_u32 m0, s39, 130048
s_add_u32 s37, s37, s38
buffer_load_dwordx4 v23, s[8:11], s37 offen sc1 lds
s_waitcnt vmcnt(32)
s_barrier
s_add_u32 s42, s42, 1
s_and_b32 s42, s42, 15
s_add_u32 m0, s39, 49152
s_lshl_b32 s37, s42, 17
buffer_load_dwordx4 v23, s[8:11], s37 offen sc1 lds
s_add_u32 m0, s39, 50176
s_add_u32 s37, s37, s38
buffer_load_dwordx4 v23, s[8:11], s37 offen sc1 lds
s_add_u32 m0, s39, 51200
s_add_u32 s37, s37, s38
buffer_load_dwordx4 v23, s[8:11], s37 offen sc1 lds
s_add_u32 m0, s39, 52224
s_add_u32 s37, s37, s38
buffer_load_dwordx4 v23, s[8:11], s37 offen sc1 lds
s_add_u32 m0, s39, 53248
s_add_u32 s37, s37, s38
buffer_load_dwordx4 v23, s[8:11], s37 offen sc1 lds
s_add_u32 m0, s39, 54272
s_add_u32 s37, s37, s38
buffer_load_dwordx4 v23, s[8:11], s37 offen sc1 lds
s_add_u32 m0, s39, 55296
s_add_u32 s37, s37, s38
buffer_load_dwordx4 v23, s[8:11], s37 offen sc1 lds
s_add_u32 m0, s39, 56320
s_add_u32 s37, s37, s38
buffer_load_dwordx4 v23, s[8:11], s37 offen sc1 lds
s_add_u32 s42, s42, 1
s_and_b32 s42, s42, 15
s_add_u32 m0, s39, 57344
s_lshl_b32 s37, s42, 17
buffer_load_dwordx4 v23, s[8:11], s37 offen sc1 lds
s_add_u32 m0, s39, 58368
s_add_u32 s37, s37, s38
buffer_load_dwordx4 v23, s[8:11], s37 offen sc1 lds
s_add_u32 m0, s39, 59392
s_add_u32 s37, s37, s38
buffer_load_dwordx4 v23, s[8:11], s37 offen sc1 lds
s_add_u32 m0, s39, 60416
s_add_u32 s37, s37, s38
buffer_load_dwordx4 v23, s[8:11], s37 offen sc1 lds
s_add_u32 m0, s39, 61440
s_add_u32 s37, s37, s38
buffer_load_dwordx4 v23, s[8:11], s37 offen sc1 lds
s_add_u32 m0, s39, 62464
s_add_u32 s37, s37, s38
buffer_load_dwordx4 v23, s[8:11], s37 offen sc1 lds
s_add_u32 m0, s39, 63488
s_add_u32 s37, s37, s38
buffer_load_dwordx4 v23, s[8:11], s37 offen sc1 lds
s_add_u32 m0, s39, 64512
s_add_u32 s37, s37, s38
buffer_load_dwordx4 v23, s[8:11], s37 offen sc1 lds
s_waitcnt vmcnt(40)
s_barrier
s_add_u32 s42, s42, 1
s_and_b32 s42, s42, 15
s_add_u32 m0, s39, 65536
s_lshl_b32 s37, s42, 17
buffer_load_dwordx4 v23, s[8:11], s37 offen sc1 lds
s_add_u32 m0, s39, 66560
s_add_u32 s37, s37, s38
buffer_load_dwordx4 v23, s[8:11], s37 offen sc1 lds
s_add_u32 m0, s39, 67584
s_add_u32 s37, s37, s38
buffer_load_dwordx4 v23, s[8:11], s37 offen sc1 lds
s_add_u32 m0, s39, 68608
s_add_u32 s37, s37, s38
buffer_load_dwordx4 v23, s[8:11], s37 offen sc1 lds
s_add_u32 m0, s39, 69632
s_add_u32 s37, s37, s38
buffer_load_dwordx4 v23, s[8:11], s37 offen sc1 lds
s_add_u32 m0, s39, 70656
s_add_u32 s37, s37, s38
buffer_load_dwordx4 v23, s[8:11], s37 offen sc1 lds
s_add_u32 m0, s39, 71680
s_add_u32 s37, s37, s38
buffer_load_dwordx4 v23, s[8:11], s37 offen sc1 lds
s_add_u32 m0, s39, 72704
s_add_u32 s37, s37, s38
buffer_load_dwordx4 v23, s[8:11], s37 offen sc1 lds
s_add_u32 s42, s42, 1
s_and_b32 s42, s42, 15
s_add_u32 m0, s39, 73728
s_lshl_b32 s37, s42, 17
buffer_load_dwordx4 v23, s[8:11], s37 offen sc1 lds
s_add_u32 m0, s39, 74752
s_add_u32 s37, s37, s38
buffer_load_dwordx4 v23, s[8:11], s37 offen sc1 lds
s_add_u32 m0, s39, 75776
s_add_u32 s37, s37, s38
buffer_load_dwordx4 v23, s[8:11], s37 offen sc1 lds
s_add_u32 m0, s39, 76800
s_add_u32 s37, s37, s38
buffer_load_dwordx4 v23, s[8:11], s37 offen sc1 lds
s_add_u32 m0, s39, 77824
s_add_u32 s37, s37, s38
buffer_load_dwordx4 v23, s[8:11], s37 offen sc1 lds
s_add_u32 m0, s39, 78848
s_add_u32 s37, s37, s38
buffer_load_dwordx4 v23, s[8:11], s37 offen sc1 lds
s_add_u32 m0, s39, 79872
s_add_u32 s37, s37, s38
buffer_load_dwordx4 v23, s[8:11], s37 offen sc1 lds
s_add_u32 m0, s39, 80896
s_add_u32 s37, s37, s38
buffer_load_dwordx4 v23, s[8:11], s37 offen sc1 lds
s_waitcnt vmcnt(48)
s_barrier
s_add_u32 s42, s42, 1
s_and_b32 s42, s42, 15
s_add_u32 m0, s39, 81920
s_lshl_b32 s37, s42, 17
buffer_load_dwordx4 v23, s[8:11], s37 offen sc1 lds
s_add_u32 m0, s39, 82944
s_add_u32 s37, s37, s38
buffer_load_dwordx4 v23, s[8:11], s37 offen sc1 lds
s_add_u32 m0, s39, 83968
s_add_u32 s37, s37, s38
buffer_load_dwordx4 v23, s[8:11], s37 offen sc1 lds
s_add_u32 m0, s39, 84992
s_add_u32 s37, s37, s38
buffer_load_dwordx4 v23, s[8:11], s37 offen sc1 lds
s_add_u32 m0, s39, 86016
s_add_u32 s37, s37, s38
buffer_load_dwordx4 v23, s[8:11], s37 offen sc1 lds
s_add_u32 m0, s39, 87040
s_add_u32 s37, s37, s38
buffer_load_dwordx4 v23, s[8:11], s37 offen sc1 lds
s_add_u32 m0, s39, 88064
s_add_u32 s37, s37, s38
buffer_load_dwordx4 v23, s[8:11], s37 offen sc1 lds
s_add_u32 m0, s39, 89088
s_add_u32 s37, s37, s38
buffer_load_dwordx4 v23, s[8:11], s37 offen sc1 lds
s_add_u32 s42, s42, 1
s_and_b32 s42, s42, 15
s_add_u32 m0, s39, 90112
s_lshl_b32 s37, s42, 17
buffer_load_dwordx4 v23, s[8:11], s37 offen sc1 lds
s_add_u32 m0, s39, 91136
s_add_u32 s37, s37, s38
buffer_load_dwordx4 v23, s[8:11], s37 offen sc1 lds
s_add_u32 m0, s39, 92160
s_add_u32 s37, s37, s38
buffer_load_dwordx4 v23, s[8:11], s37 offen sc1 lds
s_add_u32 m0, s39, 93184
s_add_u32 s37, s37, s38
buffer_load_dwordx4 v23, s[8:11], s37 offen sc1 lds
s_add_u32 m0, s39, 94208
s_add_u32 s37, s37, s38
buffer_load_dwordx4 v23, s[8:11], s37 offen sc1 lds
s_add_u32 m0, s39, 95232
s_add_u32 s37, s37, s38
buffer_load_dwordx4 v23, s[8:11], s37 offen sc1 lds
s_add_u32 m0, s39, 96256
s_add_u32 s37, s37, s38
buffer_load_dwordx4 v23, s[8:11], s37 offen sc1 lds
s_add_u32 m0, s39, 97280
s_add_u32 s37, s37, s38
buffer_load_dwordx4 v23, s[8:11], s37 offen sc1 lds
s_waitcnt vmcnt(56)
s_barrier
s_waitcnt vmcnt(48)
s_barrier
s_waitcnt vmcnt(40)
s_barrier
s_waitcnt vmcnt(32)
s_barrier
s_waitcnt vmcnt(24)
s_barrier
s_lshl_b32 s43, s35, 8
s_cmp_eq_u32 s51, 1
s_cselect_b32 s8, s4, s6
s_cselect_b32 s9, s5, s7
s_sub_u32 s10, 7340032, s43
s_lshl_b32 s44, s34, 18
s_add_u32 s44, s44, 4194304
s_movk_i32 s38, 28672
s_cmp_eq_u32 s51, 0
s_cselect_b32 s8, s32, s8
s_cselect_b32 s9, s33, s9
s_cselect_b32 s10, 262144, s10
s_cselect_b32 s43, s44, s43
s_cselect_b32 s38, 1024, s38
s_cselect_b32 s45, 0, -1
s_add_u32 s8, s8, s43
s_addc_u32 s9, s9, 0
s_mov_b32 s11, 0x20000
s_lshl_b32 s40, s38, 4
s_add_u32 s42, s35, 15
s_lshl_b32 s39, s51, 14
v_lshrrev_b32 v19, 4, v1
v_lshlrev_b32 v20, 5, v19
v_mul_u32_u24 v19, 6912, v19
v_and_b32 v19, s45, v19
v_and_b32 v20, s45, v20
v_lshlrev_b32 v21, 4, v1
v_xor_b32 v21, v21, v20
v_add_u32 v22, v21, v19
s_and_b32 s45, s45, 128
v_xor_b32 v23, s45, v22
s_waitcnt vmcnt(16)
s_barrier
s_add_u32 s42, s42, 1
s_and_b32 s42, s42, 15
s_add_u32 m0, s39, 98304
s_mul_i32 s37, s42, s40
buffer_load_dwordx4 v22, s[8:11], s37 offen sc1 lds
s_add_u32 m0, s39, 99328
s_add_u32 s37, s37, s38
buffer_load_dwordx4 v23, s[8:11], s37 offen sc1 lds
s_add_u32 m0, s39, 100352
s_add_u32 s37, s37, s38
buffer_load_dwordx4 v22, s[8:11], s37 offen sc1 lds
s_add_u32 m0, s39, 101376
s_add_u32 s37, s37, s38
buffer_load_dwordx4 v23, s[8:11], s37 offen sc1 lds
s_add_u32 m0, s39, 102400
s_add_u32 s37, s37, s38
buffer_load_dwordx4 v22, s[8:11], s37 offen sc1 lds
s_add_u32 m0, s39, 103424
s_add_u32 s37, s37, s38
buffer_load_dwordx4 v23, s[8:11], s37 offen sc1 lds
s_add_u32 m0, s39, 104448
s_add_u32 s37, s37, s38
buffer_load_dwordx4 v22, s[8:11], s37 offen sc1 lds
s_add_u32 m0, s39, 105472
s_add_u32 s37, s37, s38
buffer_load_dwordx4 v23, s[8:11], s37 offen sc1 lds
s_add_u32 m0, s39, 106496
s_add_u32 s37, s37, s38
buffer_load_dwordx4 v22, s[8:11], s37 offen sc1 lds
s_add_u32 m0, s39, 107520
s_add_u32 s37, s37, s38
buffer_load_dwordx4 v23, s[8:11], s37 offen sc1 lds
s_add_u32 m0, s39, 108544
s_add_u32 s37, s37, s38
buffer_load_dwordx4 v22, s[8:11], s37 offen sc1 lds
s_add_u32 m0, s39, 109568
s_add_u32 s37, s37, s38
buffer_load_dwordx4 v23, s[8:11], s37 offen sc1 lds
s_add_u32 m0, s39, 110592
s_add_u32 s37, s37, s38
buffer_load_dwordx4 v22, s[8:11], s37 offen sc1 lds
s_add_u32 m0, s39, 111616
s_add_u32 s37, s37, s38
buffer_load_dwordx4 v23, s[8:11], s37 offen sc1 lds
s_add_u32 m0, s39, 112640
s_add_u32 s37, s37, s38
buffer_load_dwordx4 v22, s[8:11], s37 offen sc1 lds
s_add_u32 m0, s39, 113664
s_add_u32 s37, s37, s38
buffer_load_dwordx4 v23, s[8:11], s37 offen sc1 lds
s_waitcnt vmcnt(24)
s_barrier
s_waitcnt vmcnt(16)
s_barrier
s_add_u32 s42, s42, 1
s_and_b32 s42, s42, 15
s_add_u32 m0, s39, 0
s_mul_i32 s37, s42, s40
buffer_load_dwordx4 v22, s[8:11], s37 offen sc1 lds
s_add_u32 m0, s39, 1024
s_add_u32 s37, s37, s38
buffer_load_dwordx4 v23, s[8:11], s37 offen sc1 lds
s_add_u32 m0, s39, 2048
s_add_u32 s37, s37, s38
buffer_load_dwordx4 v22, s[8:11], s37 offen sc1 lds
s_add_u32 m0, s39, 3072
s_add_u32 s37, s37, s38
buffer_load_dwordx4 v23, s[8:11], s37 offen sc1 lds
s_add_u32 m0, s39, 4096
s_add_u32 s37, s37, s38
buffer_load_dwordx4 v22, s[8:11], s37 offen sc1 lds
s_add_u32 m0, s39, 5120
s_add_u32 s37, s37, s38
buffer_load_dwordx4 v23, s[8:11], s37 offen sc1 lds
s_add_u32 m0, s39, 6144
s_add_u32 s37, s37, s38
buffer_load_dwordx4 v22, s[8:11], s37 offen sc1 lds
s_add_u32 m0, s39, 7168
s_add_u32 s37, s37, s38
buffer_load_dwordx4 v23, s[8:11], s37 offen sc1 lds
s_add_u32 m0, s39, 8192
s_add_u32 s37, s37, s38
buffer_load_dwordx4 v22, s[8:11], s37 offen sc1 lds
s_add_u32 m0, s39, 9216
s_add_u32 s37, s37, s38
buffer_load_dwordx4 v23, s[8:11], s37 offen sc1 lds
s_add_u32 m0, s39, 10240
s_add_u32 s37, s37, s38
buffer_load_dwordx4 v22, s[8:11], s37 offen sc1 lds
s_add_u32 m0, s39, 11264
s_add_u32 s37, s37, s38
buffer_load_dwordx4 v23, s[8:11], s37 offen sc1 lds
s_add_u32 m0, s39, 12288
s_add_u32 s37, s37, s38
buffer_load_dwordx4 v22, s[8:11], s37 offen sc1 lds
s_add_u32 m0, s39, 13312
s_add_u32 s37, s37, s38
buffer_load_dwordx4 v23, s[8:11], s37 offen sc1 lds
s_add_u32 m0, s39, 14336
s_add_u32 s37, s37, s38
buffer_load_dwordx4 v22, s[8:11], s37 offen sc1 lds
s_add_u32 m0, s39, 15360
s_add_u32 s37, s37, s38
buffer_load_dwordx4 v23, s[8:11], s37 offen sc1 lds
s_barrier
s_waitcnt vmcnt(16)
s_barrier
s_add_u32 s42, s42, 1
s_and_b32 s42, s42, 15
s_add_u32 m0, s39, 49152
s_mul_i32 s37, s42, s40
buffer_load_dwordx4 v22, s[8:11], s37 offen sc1 lds
s_add_u32 m0, s39, 50176
s_add_u32 s37, s37, s38
buffer_load_dwordx4 v23, s[8:11], s37 offen sc1 lds
s_add_u32 m0, s39, 51200
s_add_u32 s37, s37, s38
buffer_load_dwordx4 v22, s[8:11], s37 offen sc1 lds
s_add_u32 m0, s39, 52224
s_add_u32 s37, s37, s38
buffer_load_dwordx4 v23, s[8:11], s37 offen sc1 lds
s_add_u32 m0, s39, 53248
s_add_u32 s37, s37, s38
buffer_load_dwordx4 v22, s[8:11], s37 offen sc1 lds
s_add_u32 m0, s39, 54272
s_add_u32 s37, s37, s38
buffer_load_dwordx4 v23, s[8:11], s37 offen sc1 lds
s_add_u32 m0, s39, 55296
s_add_u32 s37, s37, s38
buffer_load_dwordx4 v22, s[8:11], s37 offen sc1 lds
s_add_u32 m0, s39, 56320
s_add_u32 s37, s37, s38
buffer_load_dwordx4 v23, s[8:11], s37 offen sc1 lds
s_add_u32 m0, s39, 57344
s_add_u32 s37, s37, s38
buffer_load_dwordx4 v22, s[8:11], s37 offen sc1 lds
s_add_u32 m0, s39, 58368
s_add_u32 s37, s37, s38
buffer_load_dwordx4 v23, s[8:11], s37 offen sc1 lds
s_add_u32 m0, s39, 59392
s_add_u32 s37, s37, s38
buffer_load_dwordx4 v22, s[8:11], s37 offen sc1 lds
s_add_u32 m0, s39, 60416
s_add_u32 s37, s37, s38
buffer_load_dwordx4 v23, s[8:11], s37 offen sc1 lds
s_add_u32 m0, s39, 61440
s_add_u32 s37, s37, s38
buffer_load_dwordx4 v22, s[8:11], s37 offen sc1 lds
s_add_u32 m0, s39, 62464
s_add_u32 s37, s37, s38
buffer_load_dwordx4 v23, s[8:11], s37 offen sc1 lds
s_add_u32 m0, s39, 63488
s_add_u32 s37, s37, s38
buffer_load_dwordx4 v22, s[8:11], s37 offen sc1 lds
s_add_u32 m0, s39, 64512
s_add_u32 s37, s37, s38
buffer_load_dwordx4 v23, s[8:11], s37 offen sc1 lds
.p2align 3
LP3_135:
s_mul_i32 s43, s2, 28672
s_mul_i32 s44, s51, 7168
s_add_u32 s43, s43, s44
s_add_u32 s80, s60, s43
s_addc_u32 s81, s61, 0
s_waitcnt vmcnt(16)
s_barrier
s_add_u32 s42, s42, 1
s_and_b32 s42, s42, 15
s_add_u32 m0, s39, 98304
s_mul_i32 s37, s42, s40
buffer_load_dwordx4 v22, s[8:11], s37 offen sc1 lds
s_add_u32 m0, s39, 99328
s_add_u32 s37, s37, s38
buffer_load_dwordx4 v23, s[8:11], s37 offen sc1 lds
s_add_u32 m0, s39, 100352
s_add_u32 s37, s37, s38
buffer_load_dwordx4 v22, s[8:11], s37 offen sc1 lds
s_add_u32 m0, s39, 101376
s_add_u32 s37, s37, s38
buffer_load_dwordx4 v23, s[8:11], s37 offen sc1 lds
s_add_u32 m0, s39, 102400
s_add_u32 s37, s37, s38
buffer_load_dwordx4 v22, s[8:11], s37 offen sc1 lds
s_add_u32 m0, s39, 103424
s_add_u32 s37, s37, s38
buffer_load_dwordx4 v23, s[8:11], s37 offen sc1 lds
s_add_u32 m0, s39, 104448
s_add_u32 s37, s37, s38
buffer_load_dwordx4 v22, s[8:11], s37 offen sc1 lds
s_add_u32 m0, s39, 105472
s_add_u32 s37, s37, s38
buffer_load_dwordx4 v23, s[8:11], s37 offen sc1 lds
s_add_u32 m0, s39, 106496
s_add_u32 s37, s37, s38
buffer_load_dwordx4 v22, s[8:11], s37 offen sc1 lds
s_add_u32 m0, s39, 107520
s_add_u32 s37, s37, s38
buffer_load_dwordx4 v23, s[8:11], s37 offen sc1 lds
s_add_u32 m0, s39, 108544
s_add_u32 s37, s37, s38
buffer_load_dwordx4 v22, s[8:11], s37 offen sc1 lds
s_add_u32 m0, s39, 109568
s_add_u32 s37, s37, s38
buffer_load_dwordx4 v23, s[8:11], s37 offen sc1 lds
s_add_u32 m0, s39, 110592
s_add_u32 s37, s37, s38
buffer_load_dwordx4 v22, s[8:11], s37 offen sc1 lds
s_add_u32 m0, s39, 111616
s_add_u32 s37, s37, s38
buffer_load_dwordx4 v23, s[8:11], s37 offen sc1 lds
s_add_u32 m0, s39, 112640
s_add_u32 s37, s37, s38
buffer_load_dwordx4 v22, s[8:11], s37 offen sc1 lds
s_add_u32 m0, s39, 113664
s_add_u32 s37, s37, s38
buffer_load_dwordx4 v23, s[8:11], s37 offen sc1 lds
s_load_dword s64, s[80:81], 0
s_load_dword s65, s[80:81], 64
s_load_dword s66, s[80:81], 128
s_load_dword s67, s[80:81], 192
s_load_dword s68, s[80:81], 256
s_load_dword s69, s[80:81], 320
s_load_dword s70, s[80:81], 384
s_load_dword s71, s[80:81], 448
s_load_dword s72, s[80:81], 512
s_add_u32 s80, s80, 576
s_addc_u32 s81, s81, 0
s_waitcnt vmcnt(16)
s_barrier
s_mov_b32 s41, 2
.p2align 3
Lp3_139:
s_add_u32 s42, s42, 1
s_and_b32 s42, s42, 15
s_add_u32 m0, s39, 0
s_mul_i32 s37, s42, s40
buffer_load_dwordx4 v22, s[8:11], s37 offen sc1 lds
s_add_u32 m0, s39, 1024
s_add_u32 s37, s37, s38
buffer_load_dwordx4 v23, s[8:11], s37 offen sc1 lds
s_add_u32 m0, s39, 2048
s_add_u32 s37, s37, s38
buffer_load_dwordx4 v22, s[8:11], s37 offen sc1 lds
s_add_u32 m0, s39, 3072
s_add_u32 s37, s37, s38
buffer_load_dwordx4 v23, s[8:11], s37 offen sc1 lds
s_add_u32 m0, s39, 4096
s_add_u32 s37, s37, s38
buffer_load_dwordx4 v22, s[8:11], s37 offen sc1 lds
s_add_u32 m0, s39, 5120
s_add_u32 s37, s37, s38
buffer_load_dwordx4 v23, s[8:11], s37 offen sc1 lds
s_add_u32 m0, s39, 6144
s_add_u32 s37, s37, s38
buffer_load_dwordx4 v22, s[8:11], s37 offen sc1 lds
s_add_u32 m0, s39, 7168
s_add_u32 s37, s37, s38
buffer_load_dwordx4 v23, s[8:11], s37 offen sc1 lds
s_add_u32 m0, s39, 8192
s_add_u32 s37, s37, s38
buffer_load_dwordx4 v22, s[8:11], s37 offen sc1 lds
s_add_u32 m0, s39, 9216
s_add_u32 s37, s37, s38
buffer_load_dwordx4 v23, s[8:11], s37 offen sc1 lds
s_add_u32 m0, s39, 10240
s_add_u32 s37, s37, s38
buffer_load_dwordx4 v22, s[8:11], s37 offen sc1 lds
s_add_u32 m0, s39, 11264
s_add_u32 s37, s37, s38
buffer_load_dwordx4 v23, s[8:11], s37 offen sc1 lds
s_add_u32 m0, s39, 12288
s_add_u32 s37, s37, s38
buffer_load_dwordx4 v22, s[8:11], s37 offen sc1 lds
s_add_u32 m0, s39, 13312
s_add_u32 s37, s37, s38
buffer_load_dwordx4 v23, s[8:11], s37 offen sc1 lds
s_add_u32 m0, s39, 14336
s_add_u32 s37, s37, s38
buffer_load_dwordx4 v22, s[8:11], s37 offen sc1 lds
s_add_u32 m0, s39, 15360
s_add_u32 s37, s37, s38
buffer_load_dwordx4 v23, s[8:11], s37 offen sc1 lds
s_load_dword s64, s[80:81], 0
s_load_dword s65, s[80:81], 64
s_load_dword s66, s[80:81], 128
s_load_dword s67, s[80:81], 192
s_load_dword s68, s[80:81], 256
s_load_dword s69, s[80:81], 320
s_load_dword s70, s[80:81], 384
s_load_dword s71, s[80:81], 448
s_load_dword s72, s[80:81], 512
s_add_u32 s80, s80, 576
s_addc_u32 s81, s81, 0
s_waitcnt vmcnt(16)
s_barrier
s_add_u32 s42, s42, 1
s_and_b32 s42, s42, 15
s_add_u32 m0, s39, 49152
s_mul_i32 s37, s42, s40
buffer_load_dwordx4 v22, s[8:11], s37 offen sc1 lds
s_add_u32 m0, s39, 50176
s_add_u32 s37, s37, s38
buffer_load_dwordx4 v23, s[8:11], s37 offen sc1 lds
s_add_u32 m0, s39, 51200
s_add_u32 s37, s37, s38
buffer_load_dwordx4 v22, s[8:11], s37 offen sc1 lds
s_add_u32 m0, s39, 52224
s_add_u32 s37, s37, s38
buffer_load_dwordx4 v23, s[8:11], s37 offen sc1 lds
s_add_u32 m0, s39, 53248
s_add_u32 s37, s37, s38
buffer_load_dwordx4 v22, s[8:11], s37 offen sc1 lds
s_add_u32 m0, s39, 54272
s_add_u32 s37, s37, s38
buffer_load_dwordx4 v23, s[8:11], s37 offen sc1 lds
s_add_u32 m0, s39, 55296
s_add_u32 s37, s37, s38
buffer_load_dwordx4 v22, s[8:11], s37 offen sc1 lds
s_add_u32 m0, s39, 56320
s_add_u32 s37, s37, s38
buffer_load_dwordx4 v23, s[8:11], s37 offen sc1 lds
s_add_u32 m0, s39, 57344
s_add_u32 s37, s37, s38
buffer_load_dwordx4 v22, s[8:11], s37 offen sc1 lds
s_add_u32 m0, s39, 58368
s_add_u32 s37, s37, s38
buffer_load_dwordx4 v23, s[8:11], s37 offen sc1 lds
s_add_u32 m0, s39, 59392
s_add_u32 s37, s37, s38
buffer_load_dwordx4 v22, s[8:11], s37 offen sc1 lds
s_add_u32 m0, s39, 60416
s_add_u32 s37, s37, s38
buffer_load_dwordx4 v23, s[8:11], s37 offen sc1 lds
s_add_u32 m0, s39, 61440
s_add_u32 s37, s37, s38
buffer_load_dwordx4 v22, s[8:11], s37 offen sc1 lds
s_add_u32 m0, s39, 62464
s_add_u32 s37, s37, s38
buffer_load_dwordx4 v23, s[8:11], s37 offen sc1 lds
s_add_u32 m0, s39, 63488
s_add_u32 s37, s37, s38
buffer_load_dwordx4 v22, s[8:11], s37 offen sc1 lds
s_add_u32 m0, s39, 64512
s_add_u32 s37, s37, s38
buffer_load_dwordx4 v23, s[8:11], s37 offen sc1 lds
s_load_dword s64, s[80:81], 0
s_load_dword s65, s[80:81], 64
s_load_dword s66, s[80:81], 128
s_load_dword s67, s[80:81], 192
s_load_dword s68, s[80:81], 256
s_load_dword s69, s[80:81], 320
s_load_dword s70, s[80:81], 384
s_load_dword s71, s[80:81], 448
s_load_dword s72, s[80:81], 512
s_add_u32 s80, s80, 576
s_addc_u32 s81, s81, 0
s_waitcnt vmcnt(16)
s_barrier
s_add_u32 s42, s42, 1
s_and_b32 s42, s42, 15
s_add_u32 m0, s39, 98304
s_mul_i32 s37, s42, s40
buffer_load_dwordx4 v22, s[8:11], s37 offen sc1 lds
s_add_u32 m0, s39, 99328
s_add_u32 s37, s37, s38
buffer_load_dwordx4 v23, s[8:11], s37 offen sc1 lds
s_add_u32 m0, s39, 100352
s_add_u32 s37, s37, s38
buffer_load_dwordx4 v22, s[8:11], s37 offen sc1 lds
s_add_u32 m0, s39, 101376
s_add_u32 s37, s37, s38
buffer_load_dwordx4 v23, s[8:11], s37 offen sc1 lds
s_add_u32 m0, s39, 102400
s_add_u32 s37, s37, s38
buffer_load_dwordx4 v22, s[8:11], s37 offen sc1 lds
s_add_u32 m0, s39, 103424
s_add_u32 s37, s37, s38
buffer_load_dwordx4 v23, s[8:11], s37 offen sc1 lds
s_add_u32 m0, s39, 104448
s_add_u32 s37, s37, s38
buffer_load_dwordx4 v22, s[8:11], s37 offen sc1 lds
s_add_u32 m0, s39, 105472
s_add_u32 s37, s37, s38
buffer_load_dwordx4 v23, s[8:11], s37 offen sc1 lds
s_add_u32 m0, s39, 106496
s_add_u32 s37, s37, s38
buffer_load_dwordx4 v22, s[8:11], s37 offen sc1 lds
s_add_u32 m0, s39, 107520
s_add_u32 s37, s37, s38
buffer_load_dwordx4 v23, s[8:11], s37 offen sc1 lds
s_add_u32 m0, s39, 108544
s_add_u32 s37, s37, s38
buffer_load_dwordx4 v22, s[8:11], s37 offen sc1 lds
s_add_u32 m0, s39, 109568
s_add_u32 s37, s37, s38
buffer_load_dwordx4 v23, s[8:11], s37 offen sc1 lds
s_add_u32 m0, s39, 110592
s_add_u32 s37, s37, s38
buffer_load_dwordx4 v22, s[8:11], s37 offen sc1 lds
s_add_u32 m0, s39, 111616
s_add_u32 s37, s37, s38
buffer_load_dwordx4 v23, s[8:11], s37 offen sc1 lds
s_add_u32 m0, s39, 112640
s_add_u32 s37, s37, s38
buffer_load_dwordx4 v22, s[8:11], s37 offen sc1 lds
s_add_u32 m0, s39, 113664
s_add_u32 s37, s37, s38
buffer_load_dwordx4 v23, s[8:11], s37 offen sc1 lds
s_load_dword s64, s[80:81], 0
s_load_dword s65, s[80:81], 64
s_load_dword s66, s[80:81], 128
s_load_dword s67, s[80:81], 192
s_load_dword s68, s[80:81], 256
s_load_dword s69, s[80:81], 320
s_load_dword s70, s[80:81], 384
s_load_dword s71, s[80:81], 448
s_load_dword s72, s[80:81], 512
s_add_u32 s80, s80, 576
s_addc_u32 s81, s81, 0
s_waitcnt vmcnt(16)
s_barrier
s_sub_u32 s41, s41, 1
s_cmp_lg_u32 s41, 0
s_cbranch_scc1 Lp3_139
s_add_u32 s42, s42, 1
s_and_b32 s42, s42, 15
s_add_u32 m0, s39, 0
s_mul_i32 s37, s42, s40
buffer_load_dwordx4 v22, s[8:11], s37 offen sc1 lds
s_add_u32 m0, s39, 1024
s_add_u32 s37, s37, s38
buffer_load_dwordx4 v23, s[8:11], s37 offen sc1 lds
s_add_u32 m0, s39, 2048
s_add_u32 s37, s37, s38
buffer_load_dwordx4 v22, s[8:11], s37 offen sc1 lds
s_add_u32 m0, s39, 3072
s_add_u32 s37, s37, s38
buffer_load_dwordx4 v23, s[8:11], s37 offen sc1 lds
s_add_u32 m0, s39, 4096
s_add_u32 s37, s37, s38
buffer_load_dwordx4 v22, s[8:11], s37 offen sc1 lds
s_add_u32 m0, s39, 5120
s_add_u32 s37, s37, s38
buffer_load_dwordx4 v23, s[8:11], s37 offen sc1 lds
s_add_u32 m0, s39, 6144
s_add_u32 s37, s37, s38
buffer_load_dwordx4 v22, s[8:11], s37 offen sc1 lds
s_add_u32 m0, s39, 7168
s_add_u32 s37, s37, s38
buffer_load_dwordx4 v23, s[8:11], s37 offen sc1 lds
s_add_u32 m0, s39, 8192
s_add_u32 s37, s37, s38
buffer_load_dwordx4 v22, s[8:11], s37 offen sc1 lds
s_add_u32 m0, s39, 9216
s_add_u32 s37, s37, s38
buffer_load_dwordx4 v23, s[8:11], s37 offen sc1 lds
s_add_u32 m0, s39, 10240
s_add_u32 s37, s37, s38
buffer_load_dwordx4 v22, s[8:11], s37 offen sc1 lds
s_add_u32 m0, s39, 11264
s_add_u32 s37, s37, s38
buffer_load_dwordx4 v23, s[8:11], s37 offen sc1 lds
s_add_u32 m0, s39, 12288
s_add_u32 s37, s37, s38
buffer_load_dwordx4 v22, s[8:11], s37 offen sc1 lds
s_add_u32 m0, s39, 13312
s_add_u32 s37, s37, s38
buffer_load_dwordx4 v23, s[8:11], s37 offen sc1 lds
s_add_u32 m0, s39, 14336
s_add_u32 s37, s37, s38
buffer_load_dwordx4 v22, s[8:11], s37 offen sc1 lds
s_add_u32 m0, s39, 15360
s_add_u32 s37, s37, s38
buffer_load_dwordx4 v23, s[8:11], s37 offen sc1 lds
s_load_dword s64, s[80:81], 0
s_load_dword s65, s[80:81], 64
s_load_dword s66, s[80:81], 128
s_load_dword s67, s[80:81], 192
s_load_dword s68, s[80:81], 256
s_load_dword s69, s[80:81], 320
s_load_dword s70, s[80:81], 384
s_load_dword s71, s[80:81], 448
s_load_dword s72, s[80:81], 512
s_add_u32 s80, s80, 576
s_addc_u32 s81, s81, 0
s_waitcnt vmcnt(16)
s_barrier
s_add_u32 s42, s42, 1
s_and_b32 s42, s42, 15
s_add_u32 m0, s39, 49152
s_mul_i32 s37, s42, s40
buffer_load_dwordx4 v22, s[8:11], s37 offen sc1 lds
s_add_u32 m0, s39, 50176
s_add_u32 s37, s37, s38
buffer_load_dwordx4 v23, s[8:11], s37 offen sc1 lds
s_add_u32 m0, s39, 51200
s_add_u32 s37, s37, s38
buffer_load_dwordx4 v22, s[8:11], s37 offen sc1 lds
s_add_u32 m0, s39, 52224
s_add_u32 s37, s37, s38
buffer_load_dwordx4 v23, s[8:11], s37 offen sc1 lds
s_add_u32 m0, s39, 53248
s_add_u32 s37, s37, s38
buffer_load_dwordx4 v22, s[8:11], s37 offen sc1 lds
s_add_u32 m0, s39, 54272
s_add_u32 s37, s37, s38
buffer_load_dwordx4 v23, s[8:11], s37 offen sc1 lds
s_add_u32 m0, s39, 55296
s_add_u32 s37, s37, s38
buffer_load_dwordx4 v22, s[8:11], s37 offen sc1 lds
s_add_u32 m0, s39, 56320
s_add_u32 s37, s37, s38
buffer_load_dwordx4 v23, s[8:11], s37 offen sc1 lds
s_add_u32 m0, s39, 57344
s_add_u32 s37, s37, s38
buffer_load_dwordx4 v22, s[8:11], s37 offen sc1 lds
s_add_u32 m0, s39, 58368
s_add_u32 s37, s37, s38
buffer_load_dwordx4 v23, s[8:11], s37 offen sc1 lds
s_add_u32 m0, s39, 59392
s_add_u32 s37, s37, s38
buffer_load_dwordx4 v22, s[8:11], s37 offen sc1 lds
s_add_u32 m0, s39, 60416
s_add_u32 s37, s37, s38
buffer_load_dwordx4 v23, s[8:11], s37 offen sc1 lds
s_add_u32 m0, s39, 61440
s_add_u32 s37, s37, s38
buffer_load_dwordx4 v22, s[8:11], s37 offen sc1 lds
s_add_u32 m0, s39, 62464
s_add_u32 s37, s37, s38
buffer_load_dwordx4 v23, s[8:11], s37 offen sc1 lds
s_add_u32 m0, s39, 63488
s_add_u32 s37, s37, s38
buffer_load_dwordx4 v22, s[8:11], s37 offen sc1 lds
s_add_u32 m0, s39, 64512
s_add_u32 s37, s37, s38
buffer_load_dwordx4 v23, s[8:11], s37 offen sc1 lds
s_load_dword s64, s[80:81], 0
s_load_dword s65, s[80:81], 64
s_load_dword s66, s[80:81], 128
s_load_dword s67, s[80:81], 192
s_load_dword s68, s[80:81], 256
s_load_dword s69, s[80:81], 320
s_load_dword s70, s[80:81], 384
s_load_dword s71, s[80:81], 448
s_load_dword s72, s[80:81], 512
s_add_u32 s80, s80, 576
s_addc_u32 s81, s81, 0
s_waitcnt vmcnt(16)
s_barrier
s_add_u32 s42, s42, 1
s_and_b32 s42, s42, 15
s_add_u32 m0, s39, 98304
s_mul_i32 s37, s42, s40
buffer_load_dwordx4 v22, s[8:11], s37 offen sc1 lds
s_and_b32 s53, s35, 1
s_lshl_b32 s53, s53, 1
s_mul_i32 s43, s47, 3
s_add_u32 m0, s39, 99328
s_add_u32 s37, s37, s38
buffer_load_dwordx4 v23, s[8:11], s37 offen sc1 lds
s_add_u32 s53, s53, s43
v_lshlrev_b32 v19, 11, v18
v_lshl_add_u32 v19, v17, 4, v19
s_add_u32 m0, s39, 100352
s_add_u32 s37, s37, s38
buffer_load_dwordx4 v22, s[8:11], s37 offen sc1 lds
s_lshl_b32 s43, s46, 10
v_add_u32 v2, s43, v19
v_add_u32 v3, 49152, v2
s_add_u32 m0, s39, 101376
s_add_u32 s37, s37, s38
buffer_load_dwordx4 v23, s[8:11], s37 offen sc1 lds
v_add_u32 v4, 98304, v2
v_lshrrev_b32 v19, 2, v17
v_lshl_add_u32 v20, v18, 2, v19
s_add_u32 m0, s39, 102400
s_add_u32 s37, s37, s38
buffer_load_dwordx4 v22, s[8:11], s37 offen sc1 lds
v_and_b32 v21, 7, v20
v_lshlrev_b32 v20, 8, v20
v_and_b32 v19, 3, v1
s_add_u32 m0, s39, 103424
s_add_u32 s37, s37, s38
buffer_load_dwordx4 v23, s[8:11], s37 offen sc1 lds
v_lshl_add_u32 v20, v19, 3, v20
s_add_u32 s43, s53, 0
v_xor_b32 v19, s43, v21
s_add_u32 m0, s39, 104448
s_add_u32 s37, s37, s38
buffer_load_dwordx4 v22, s[8:11], s37 offen sc1 lds
v_lshl_add_u32 v5, v19, 5, v20
s_add_u32 s43, s53, 1
v_xor_b32 v19, s43, v21
s_add_u32 m0, s39, 105472
s_add_u32 s37, s37, s38
buffer_load_dwordx4 v23, s[8:11], s37 offen sc1 lds
v_lshl_add_u32 v6, v19, 5, v20
s_add_u32 s43, s53, 2
v_xor_b32 v19, s43, v21
s_add_u32 m0, s39, 106496
s_add_u32 s37, s37, s38
buffer_load_dwordx4 v22, s[8:11], s37 offen sc1 lds
v_lshl_add_u32 v7, v19, 5, v20
v_add_u32 v9, 49152, v5
v_add_u32 v10, 49152, v6
s_add_u32 m0, s39, 107520
s_add_u32 s37, s37, s38
buffer_load_dwordx4 v23, s[8:11], s37 offen sc1 lds
v_add_u32 v11, 49152, v7
v_add_u32 v13, 98304, v5
v_add_u32 v14, 98304, v6
s_add_u32 m0, s39, 108544
s_add_u32 s37, s37, s38
buffer_load_dwordx4 v22, s[8:11], s37 offen sc1 lds
v_add_u32 v15, 98304, v7
s_lshl_b32 s43, s46, 9
s_add_u32 s43, s43, 147456
s_add_u32 m0, s39, 109568
s_add_u32 s37, s37, s38
buffer_load_dwordx4 v23, s[8:11], s37 offen sc1 lds
v_lshl_add_u32 v19, v17, 3, s43
ds_read_b64 v[80:81], v19 offset:0
ds_read_b64 v[82:83], v19 offset:128
s_add_u32 m0, s39, 110592
s_add_u32 s37, s37, s38
buffer_load_dwordx4 v22, s[8:11], s37 offen sc1 lds
ds_read_b64 v[84:85], v19 offset:256
ds_read_b64 v[86:87], v19 offset:384
s_mul_i32 s43, s47, 192
s_add_u32 m0, s39, 111616
s_add_u32 s37, s37, s38
buffer_load_dwordx4 v23, s[8:11], s37 offen sc1 lds
s_add_u32 s43, s43, 148992
v_lshl_add_u32 v19, v18, 4, s43
ds_read_b128 v[48:51], v19 offset:0
s_add_u32 m0, s39, 112640
s_add_u32 s37, s37, s38
buffer_load_dwordx4 v22, s[8:11], s37 offen sc1 lds
ds_read_b128 v[52:55], v19 offset:64
ds_read_b128 v[56:59], v19 offset:128
ds_read_b128 v[60:63], v19 offset:896
s_add_u32 m0, s39, 113664
s_add_u32 s37, s37, s38
buffer_load_dwordx4 v23, s[8:11], s37 offen sc1 lds
ds_read_b128 v[64:67], v19 offset:960
ds_read_b128 v[68:71], v19 offset:1024
s_waitcnt vmcnt(16)
s_barrier
s_add_u32 s42, s42, 1
s_and_b32 s42, s42, 15
s_add_u32 m0, s39, 0
s_mul_i32 s37, s42, s40
buffer_load_dwordx4 v22, s[8:11], s37 offen sc1 lds
s_waitcnt lgkmcnt(0)
v_mul_f32 v88, v81, v81
s_add_u32 m0, s39, 1024
s_add_u32 s37, s37, s38
buffer_load_dwordx4 v23, s[8:11], s37 offen sc1 lds
v_mul_f32 v228, 0xc0135761, v81
s_add_u32 m0, s39, 2048
s_add_u32 s37, s37, s38
buffer_load_dwordx4 v22, s[8:11], s37 offen sc1 lds
v_mul_f32 v89, 0xbdd2d3e8, v81
s_add_u32 m0, s39, 3072
s_add_u32 s37, s37, s38
buffer_load_dwordx4 v23, s[8:11], s37 offen sc1 lds
v_rcp_f32 v236, v88
v_mul_f32 v232, v89, v88
s_add_u32 m0, s39, 4096
s_add_u32 s37, s37, s38
buffer_load_dwordx4 v22, s[8:11], s37 offen sc1 lds
v_mul_f32 v88, v83, v83
s_add_u32 m0, s39, 5120
s_add_u32 s37, s37, s38
buffer_load_dwordx4 v23, s[8:11], s37 offen sc1 lds
v_mul_f32 v229, 0xc0135761, v83
s_add_u32 m0, s39, 6144
s_add_u32 s37, s37, s38
buffer_load_dwordx4 v22, s[8:11], s37 offen sc1 lds
v_mul_f32 v89, 0xbdd2d3e8, v83
v_rcp_f32 v237, v88
s_add_u32 m0, s39, 7168
s_add_u32 s37, s37, s38
buffer_load_dwordx4 v23, s[8:11], s37 offen sc1 lds
v_mul_f32 v233, v89, v88
s_add_u32 m0, s39, 8192
s_add_u32 s37, s37, s38
buffer_load_dwordx4 v22, s[8:11], s37 offen sc1 lds
v_mul_f32 v88, v85, v85
s_add_u32 m0, s39, 9216
s_add_u32 s37, s37, s38
buffer_load_dwordx4 v23, s[8:11], s37 offen sc1 lds
v_mul_f32 v230, 0xc0135761, v85
v_mul_f32 v89, 0xbdd2d3e8, v85
s_add_u32 m0, s39, 10240
s_add_u32 s37, s37, s38
buffer_load_dwordx4 v22, s[8:11], s37 offen sc1 lds
v_rcp_f32 v238, v88
s_add_u32 m0, s39, 11264
s_add_u32 s37, s37, s38
buffer_load_dwordx4 v23, s[8:11], s37 offen sc1 lds
v_mul_f32 v234, v89, v88
s_add_u32 m0, s39, 12288
s_add_u32 s37, s37, s38
buffer_load_dwordx4 v22, s[8:11], s37 offen sc1 lds
v_mul_f32 v88, v87, v87
v_mul_f32 v231, 0xc0135761, v87
s_add_u32 m0, s39, 13312
s_add_u32 s37, s37, s38
buffer_load_dwordx4 v23, s[8:11], s37 offen sc1 lds
v_mul_f32 v89, 0xbdd2d3e8, v87
s_add_u32 m0, s39, 14336
s_add_u32 s37, s37, s38
buffer_load_dwordx4 v22, s[8:11], s37 offen sc1 lds
v_rcp_f32 v239, v88
s_add_u32 m0, s39, 15360
s_add_u32 s37, s37, s38
buffer_load_dwordx4 v23, s[8:11], s37 offen sc1 lds
v_mul_f32 v235, v89, v88
s_mul_i32 s43, s34, 917504
s_mov_b32 s44, 3577949200
s_mov_b32 s45, 3137247350
s_lshl_b32 s50, s49, 2
s_lshr_b64 s[44:45], s[44:45], s50
s_and_b32 s50, s44, 15
s_mul_i32 s44, s50, 24576
s_add_u32 s43, s43, s44
s_add_u32 s43, s43, 8912896
s_add_u32 s24, s32, s43
s_addc_u32 s25, s33, 0
s_mov_b32 s26, 24576
s_mov_b32 s27, 0x20000
s_mov_b32 s53, 262144
s_lshl_b32 s43, s47, 13
s_lshl_b32 s44, s46, 10
s_add_u32 s43, s43, s44
v_lshlrev_b32 v19, 11, v18
v_lshl_add_u32 v19, v17, 4, v19
v_add_u32 v27, s43, v19
s_lshl_b32 s43, s47, 12
s_add_u32 s43, s43, s44
s_add_u32 s43, s43, 16384
v_and_b32 v19, 1, v18
v_lshlrev_b32 v19, 11, v19
v_lshrrev_b32 v20, 1, v18
v_lshl_add_u32 v19, v20, 8, v19
v_lshl_add_u32 v19, v17, 4, v19
v_add_u32 v28, s43, v19
s_load_dword s64, s[80:81], 0
s_load_dword s65, s[80:81], 64
s_load_dword s66, s[80:81], 128
s_load_dword s67, s[80:81], 192
s_load_dword s68, s[80:81], 256
s_load_dword s69, s[80:81], 320
s_load_dword s70, s[80:81], 384
s_load_dword s71, s[80:81], 448
s_add_u32 s80, s80, 512
s_addc_u32 s81, s81, 0
s_waitcnt vmcnt(16)
s_barrier
s_add_u32 s42, s42, 1
s_and_b32 s42, s42, 15
s_add_u32 m0, s39, 49152
s_mul_i32 s37, s42, s40
buffer_load_dwordx4 v22, s[8:11], s37 offen sc1 lds
v_mul_f32 v128, -v80, v48
v_mul_f32 v129, -v80, v49
s_add_u32 m0, s39, 50176
s_add_u32 s37, s37, s38
buffer_load_dwordx4 v23, s[8:11], s37 offen sc1 lds
v_mul_f32 v130, -v80, v50
v_mul_f32 v131, -v80, v51
s_add_u32 m0, s39, 51200
s_add_u32 s37, s37, s38
buffer_load_dwordx4 v22, s[8:11], s37 offen sc1 lds
v_mul_f32 v132, -v82, v48
v_mul_f32 v133, -v82, v49
s_add_u32 m0, s39, 52224
s_add_u32 s37, s37, s38
buffer_load_dwordx4 v23, s[8:11], s37 offen sc1 lds
v_mul_f32 v134, -v82, v50
v_mul_f32 v135, -v82, v51
s_add_u32 m0, s39, 53248
s_add_u32 s37, s37, s38
buffer_load_dwordx4 v22, s[8:11], s37 offen sc1 lds
v_mul_f32 v136, -v84, v48
v_mul_f32 v137, -v84, v49
s_add_u32 m0, s39, 54272
s_add_u32 s37, s37, s38
buffer_load_dwordx4 v23, s[8:11], s37 offen sc1 lds
v_mul_f32 v138, -v84, v50
v_mul_f32 v139, -v84, v51
s_add_u32 m0, s39, 55296
s_add_u32 s37, s37, s38
buffer_load_dwordx4 v22, s[8:11], s37 offen sc1 lds
v_mul_f32 v140, -v86, v48
v_mul_f32 v141, -v86, v49
s_add_u32 m0, s39, 56320
s_add_u32 s37, s37, s38
buffer_load_dwordx4 v23, s[8:11], s37 offen sc1 lds
v_mul_f32 v142, -v86, v50
v_mul_f32 v143, -v86, v51
s_add_u32 m0, s39, 57344
s_add_u32 s37, s37, s38
buffer_load_dwordx4 v22, s[8:11], s37 offen sc1 lds
v_mul_f32 v144, -v80, v52
v_mul_f32 v145, -v80, v53
s_add_u32 m0, s39, 58368
s_add_u32 s37, s37, s38
buffer_load_dwordx4 v23, s[8:11], s37 offen sc1 lds
v_mul_f32 v146, -v80, v54
v_mul_f32 v147, -v80, v55
s_add_u32 m0, s39, 59392
s_add_u32 s37, s37, s38
buffer_load_dwordx4 v22, s[8:11], s37 offen sc1 lds
v_mul_f32 v148, -v82, v52
v_mul_f32 v149, -v82, v53
s_add_u32 m0, s39, 60416
s_add_u32 s37, s37, s38
buffer_load_dwordx4 v23, s[8:11], s37 offen sc1 lds
v_mul_f32 v150, -v82, v54
v_mul_f32 v151, -v82, v55
s_add_u32 m0, s39, 61440
s_add_u32 s37, s37, s38
buffer_load_dwordx4 v22, s[8:11], s37 offen sc1 lds
v_mul_f32 v152, -v84, v52
v_mul_f32 v153, -v84, v53
s_add_u32 m0, s39, 62464
s_add_u32 s37, s37, s38
buffer_load_dwordx4 v23, s[8:11], s37 offen sc1 lds
v_mul_f32 v154, -v84, v54
v_mul_f32 v155, -v84, v55
s_add_u32 m0, s39, 63488
s_add_u32 s37, s37, s38
buffer_load_dwordx4 v22, s[8:11], s37 offen sc1 lds
v_mul_f32 v156, -v86, v52
v_mul_f32 v157, -v86, v53
s_add_u32 m0, s39, 64512
s_add_u32 s37, s37, s38
buffer_load_dwordx4 v23, s[8:11], s37 offen sc1 lds
v_mul_f32 v158, -v86, v54
v_mul_f32 v159, -v86, v55
s_load_dword s64, s[80:81], 0
s_load_dword s65, s[80:81], 64
s_load_dword s66, s[80:81], 128
s_load_dword s67, s[80:81], 192
s_load_dword s68, s[80:81], 256
s_load_dword s69, s[80:81], 320
s_load_dword s70, s[80:81], 384
s_load_dword s71, s[80:81], 448
s_add_u32 s80, s80, 512
s_addc_u32 s81, s81, 0
s_waitcnt vmcnt(16)
s_barrier
s_add_u32 s42, s42, 1
s_and_b32 s42, s42, 15
s_add_u32 m0, s39, 98304
s_mul_i32 s37, s42, s40
buffer_load_dwordx4 v22, s[8:11], s37 offen sc1 lds
v_mul_f32 v160, -v80, v56
v_mul_f32 v161, -v80, v57
s_add_u32 m0, s39, 99328
s_add_u32 s37, s37, s38
buffer_load_dwordx4 v23, s[8:11], s37 offen sc1 lds
v_mul_f32 v162, -v80, v58
v_mul_f32 v163, -v80, v59
s_add_u32 m0, s39, 100352
s_add_u32 s37, s37, s38
buffer_load_dwordx4 v22, s[8:11], s37 offen sc1 lds
v_mul_f32 v164, -v82, v56
v_mul_f32 v165, -v82, v57
s_add_u32 m0, s39, 101376
s_add_u32 s37, s37, s38
buffer_load_dwordx4 v23, s[8:11], s37 offen sc1 lds
v_mul_f32 v166, -v82, v58
v_mul_f32 v167, -v82, v59
s_add_u32 m0, s39, 102400
s_add_u32 s37, s37, s38
buffer_load_dwordx4 v22, s[8:11], s37 offen sc1 lds
v_mul_f32 v168, -v84, v56
v_mul_f32 v169, -v84, v57
s_add_u32 m0, s39, 103424
s_add_u32 s37, s37, s38
buffer_load_dwordx4 v23, s[8:11], s37 offen sc1 lds
v_mul_f32 v170, -v84, v58
v_mul_f32 v171, -v84, v59
s_add_u32 m0, s39, 104448
s_add_u32 s37, s37, s38
buffer_load_dwordx4 v22, s[8:11], s37 offen sc1 lds
v_mul_f32 v172, -v86, v56
v_mul_f32 v173, -v86, v57
s_add_u32 m0, s39, 105472
s_add_u32 s37, s37, s38
buffer_load_dwordx4 v23, s[8:11], s37 offen sc1 lds
v_mul_f32 v174, -v86, v58
v_mul_f32 v175, -v86, v59
s_add_u32 m0, s39, 106496
s_add_u32 s37, s37, s38
buffer_load_dwordx4 v22, s[8:11], s37 offen sc1 lds
v_mul_f32 v176, -v80, v60
v_mul_f32 v177, -v80, v61
s_add_u32 m0, s39, 107520
s_add_u32 s37, s37, s38
buffer_load_dwordx4 v23, s[8:11], s37 offen sc1 lds
v_mul_f32 v178, -v80, v62
v_mul_f32 v179, -v80, v63
s_add_u32 m0, s39, 108544
s_add_u32 s37, s37, s38
buffer_load_dwordx4 v22, s[8:11], s37 offen sc1 lds
v_mul_f32 v180, -v82, v60
v_mul_f32 v181, -v82, v61
s_add_u32 m0, s39, 109568
s_add_u32 s37, s37, s38
buffer_load_dwordx4 v23, s[8:11], s37 offen sc1 lds
v_mul_f32 v182, -v82, v62
v_mul_f32 v183, -v82, v63
s_add_u32 m0, s39, 110592
s_add_u32 s37, s37, s38
buffer_load_dwordx4 v22, s[8:11], s37 offen sc1 lds
v_mul_f32 v184, -v84, v60
v_mul_f32 v185, -v84, v61
s_add_u32 m0, s39, 111616
s_add_u32 s37, s37, s38
buffer_load_dwordx4 v23, s[8:11], s37 offen sc1 lds
v_mul_f32 v186, -v84, v62
v_mul_f32 v187, -v84, v63
s_add_u32 m0, s39, 112640
s_add_u32 s37, s37, s38
buffer_load_dwordx4 v22, s[8:11], s37 offen sc1 lds
v_mul_f32 v188, -v86, v60
v_mul_f32 v189, -v86, v61
s_add_u32 m0, s39, 113664
s_add_u32 s37, s37, s38
buffer_load_dwordx4 v23, s[8:11], s37 offen sc1 lds
v_mul_f32 v190, -v86, v62
v_mul_f32 v191, -v86, v63
s_load_dword s64, s[80:81], 0
s_load_dword s65, s[80:81], 64
s_load_dword s66, s[80:81], 128
s_load_dword s67, s[80:81], 192
s_load_dword s68, s[80:81], 256
s_load_dword s69, s[80:81], 320
s_load_dword s70, s[80:81], 384
s_load_dword s71, s[80:81], 448
s_add_u32 s80, s80, 512
s_addc_u32 s81, s81, 0
s_waitcnt vmcnt(16)
s_barrier
s_mul_i32 s43, s49, 192
s_and_b32 s43, s43, 0xffffff80
s_add_u32 s43, s43, 4096
s_cmp_eq_u32 s51, 1
s_cselect_b32 s8, s4, s6
s_cselect_b32 s9, s5, s7
s_sub_u32 s10, 7340032, s43
s_lshl_b32 s44, s34, 18
s_add_u32 s44, s44, 4194304
s_movk_i32 s38, 28672
s_cmp_eq_u32 s51, 0
s_cselect_b32 s8, s32, s8
s_cselect_b32 s9, s33, s9
s_cselect_b32 s10, 262144, s10
s_cselect_b32 s43, s44, s43
s_cselect_b32 s38, 1024, s38
s_cselect_b32 s45, 0, -1
s_add_u32 s8, s8, s43
s_addc_u32 s9, s9, 0
s_mov_b32 s11, 0x20000
s_lshl_b32 s40, s38, 4
s_add_u32 s42, s35, 15
s_lshl_b32 s39, s51, 14
v_lshrrev_b32 v19, 4, v1
v_lshlrev_b32 v20, 5, v19
v_mul_u32_u24 v19, 6912, v19
v_and_b32 v19, s45, v19
v_and_b32 v20, s45, v20
v_lshlrev_b32 v21, 4, v1
v_xor_b32 v21, v21, v20
v_add_u32 v22, v21, v19
s_and_b32 s45, s45, 128
v_xor_b32 v23, s45, v22
s_add_u32 s42, s42, 1
s_and_b32 s42, s42, 15
s_add_u32 m0, s39, 0
s_mul_i32 s37, s42, s40
buffer_load_dwordx4 v22, s[8:11], s37 offen sc1 lds
v_mul_f32 v192, -v80, v64
v_mul_f32 v193, -v80, v65
s_add_u32 m0, s39, 1024
s_add_u32 s37, s37, s38
buffer_load_dwordx4 v23, s[8:11], s37 offen sc1 lds
v_mul_f32 v194, -v80, v66
v_mul_f32 v195, -v80, v67
s_add_u32 m0, s39, 2048
s_add_u32 s37, s37, s38
buffer_load_dwordx4 v22, s[8:11], s37 offen sc1 lds
v_mul_f32 v196, -v82, v64
v_mul_f32 v197, -v82, v65
s_add_u32 m0, s39, 3072
s_add_u32 s37, s37, s38
buffer_load_dwordx4 v23, s[8:11], s37 offen sc1 lds
v_mul_f32 v198, -v82, v66
v_mul_f32 v199, -v82, v67
s_add_u32 m0, s39, 4096
s_add_u32 s37, s37, s38
buffer_load_dwordx4 v22, s[8:11], s37 offen sc1 lds
v_mul_f32 v200, -v84, v64
v_mul_f32 v201, -v84, v65
s_add_u32 m0, s39, 5120
s_add_u32 s37, s37, s38
buffer_load_dwordx4 v23, s[8:11], s37 offen sc1 lds
v_mul_f32 v202, -v84, v66
v_mul_f32 v203, -v84, v67
s_add_u32 m0, s39, 6144
s_add_u32 s37, s37, s38
buffer_load_dwordx4 v22, s[8:11], s37 offen sc1 lds
v_mul_f32 v204, -v86, v64
v_mul_f32 v205, -v86, v65
s_add_u32 m0, s39, 7168
s_add_u32 s37, s37, s38
buffer_load_dwordx4 v23, s[8:11], s37 offen sc1 lds
v_mul_f32 v206, -v86, v66
v_mul_f32 v207, -v86, v67
s_add_u32 m0, s39, 8192
s_add_u32 s37, s37, s38
buffer_load_dwordx4 v22, s[8:11], s37 offen sc1 lds
v_mul_f32 v208, -v80, v68
v_mul_f32 v209, -v80, v69
s_add_u32 m0, s39, 9216
s_add_u32 s37, s37, s38
buffer_load_dwordx4 v23, s[8:11], s37 offen sc1 lds
v_mul_f32 v210, -v80, v70
v_mul_f32 v211, -v80, v71
s_add_u32 m0, s39, 10240
s_add_u32 s37, s37, s38
buffer_load_dwordx4 v22, s[8:11], s37 offen sc1 lds
v_mul_f32 v212, -v82, v68
v_mul_f32 v213, -v82, v69
s_add_u32 m0, s39, 11264
s_add_u32 s37, s37, s38
buffer_load_dwordx4 v23, s[8:11], s37 offen sc1 lds
v_mul_f32 v214, -v82, v70
v_mul_f32 v215, -v82, v71
s_add_u32 m0, s39, 12288
s_add_u32 s37, s37, s38
buffer_load_dwordx4 v22, s[8:11], s37 offen sc1 lds
v_mul_f32 v216, -v84, v68
v_mul_f32 v217, -v84, v69
s_add_u32 m0, s39, 13312
s_add_u32 s37, s37, s38
buffer_load_dwordx4 v23, s[8:11], s37 offen sc1 lds
v_mul_f32 v218, -v84, v70
v_mul_f32 v219, -v84, v71
s_add_u32 m0, s39, 14336
s_add_u32 s37, s37, s38
buffer_load_dwordx4 v22, s[8:11], s37 offen sc1 lds
v_mul_f32 v220, -v86, v68
v_mul_f32 v221, -v86, v69
s_add_u32 m0, s39, 15360
s_add_u32 s37, s37, s38
buffer_load_dwordx4 v23, s[8:11], s37 offen sc1 lds
v_mul_f32 v222, -v86, v70
v_mul_f32 v223, -v86, v71
s_load_dword s64, s[80:81], 0
s_load_dword s65, s[80:81], 64
s_load_dword s66, s[80:81], 128
s_load_dword s67, s[80:81], 192
s_load_dword s68, s[80:81], 256
s_load_dword s69, s[80:81], 320
s_load_dword s70, s[80:81], 384
s_add_u32 s80, s80, 448
s_addc_u32 s81, s81, 0
s_waitcnt vmcnt(16)
s_barrier
s_add_u32 s42, s42, 1
s_and_b32 s42, s42, 15
s_add_u32 m0, s39, 49152
s_mul_i32 s37, s42, s40
buffer_load_dwordx4 v22, s[8:11], s37 offen sc1 lds
s_add_u32 m0, s39, 50176
s_add_u32 s37, s37, s38
buffer_load_dwordx4 v23, s[8:11], s37 offen sc1 lds
s_add_u32 m0, s39, 51200
s_add_u32 s37, s37, s38
buffer_load_dwordx4 v22, s[8:11], s37 offen sc1 lds
s_add_u32 m0, s39, 52224
s_add_u32 s37, s37, s38
buffer_load_dwordx4 v23, s[8:11], s37 offen sc1 lds
s_add_u32 m0, s39, 53248
s_add_u32 s37, s37, s38
buffer_load_dwordx4 v22, s[8:11], s37 offen sc1 lds
s_add_u32 m0, s39, 54272
s_add_u32 s37, s37, s38
buffer_load_dwordx4 v23, s[8:11], s37 offen sc1 lds
s_add_u32 m0, s39, 55296
s_add_u32 s37, s37, s38
buffer_load_dwordx4 v22, s[8:11], s37 offen sc1 lds
s_add_u32 m0, s39, 56320
s_add_u32 s37, s37, s38
buffer_load_dwordx4 v23, s[8:11], s37 offen sc1 lds
s_add_u32 m0, s39, 57344
s_add_u32 s37, s37, s38
buffer_load_dwordx4 v22, s[8:11], s37 offen sc1 lds
s_add_u32 m0, s39, 58368
s_add_u32 s37, s37, s38
buffer_load_dwordx4 v23, s[8:11], s37 offen sc1 lds
s_add_u32 m0, s39, 59392
s_add_u32 s37, s37, s38
buffer_load_dwordx4 v22, s[8:11], s37 offen sc1 lds
s_add_u32 m0, s39, 60416
s_add_u32 s37, s37, s38
buffer_load_dwordx4 v23, s[8:11], s37 offen sc1 lds
s_add_u32 m0, s39, 61440
s_add_u32 s37, s37, s38
buffer_load_dwordx4 v22, s[8:11], s37 offen sc1 lds
s_add_u32 m0, s39, 62464
s_add_u32 s37, s37, s38
buffer_load_dwordx4 v23, s[8:11], s37 offen sc1 lds
s_add_u32 m0, s39, 63488
s_add_u32 s37, s37, s38
buffer_load_dwordx4 v22, s[8:11], s37 offen sc1 lds
s_add_u32 m0, s39, 64512
s_add_u32 s37, s37, s38
buffer_load_dwordx4 v23, s[8:11], s37 offen sc1 lds
s_mul_i32 s44, s34, 917504
s_lshl_b32 s39, s51, 13
s_add_u32 s44, s44, s39
s_add_u32 s44, s44, 8388608
s_and_b32 s43, s51, 1
s_xor_b32 s43, s43, s35
s_lshl_b32 s43, s43, 7
s_mov_b32 s10, 909312
s_movk_i32 s38, 1024
s_movk_i32 s40, 9216
s_movk_i32 s37, 0x4000
s_cmp_ge_u32 s51, 2
s_cselect_b32 s8, s60, s32
s_cselect_b32 s9, s61, s33
s_cselect_b32 s10, 7338112, s10
s_cselect_b32 s43, s43, s44
s_cselect_b32 s38, 16384, s38
s_cselect_b32 s40, 81920, s40
s_cselect_b32 s55, 81920, s38
s_cselect_b32 s37, 262144, s37
s_cselect_b32 s45, -1, 0
s_add_u32 s8, s8, s43
s_addc_u32 s9, s9, 0
s_mov_b32 s11, 0x20000
s_and_b32 s53, s35, 1
s_mul_i32 s54, s53, 6
s_mul_i32 s54, s54, s37
s_mul_i32 s29, s53, 2
s_add_u32 s29, s29, 6
s_mul_i32 s29, s29, s37
s_and_b32 s43, s45, 4290838528
s_add_u32 s29, s29, s43
s_mul_i32 s37, s37, 2
s_sub_u32 s37, s37, s40
v_lshrrev_b32 v19, 3, v1
v_mul_u32_u24 v19, 1920, v19
v_lshrrev_b32 v20, 4, v1
v_lshlrev_b32 v20, 5, v20
v_and_b32 v19, s45, v19
v_and_b32 v20, s45, v20
v_lshlrev_b32 v21, 4, v1
v_xor_b32 v21, v21, v20
v_add_u32 v21, v21, v19
s_waitcnt vmcnt(16)
s_barrier
s_branch LK3b_134
.p2align 6
Lw_43:
s_branch Lr_44
s_nop 0
.p2align 3
L7_133:
s_lshr_b32 s43, s2, 5
s_cmp_eq_u32 s43, 3
s_cbranch_scc1 Lnojob_140
s_cmp_gt_u32 s43, 3
s_cselect_b32 s43, 32, 0
s_sub_u32 s43, s2, s43
s_lshr_b32 s43, s43, 1
s_and_b32 s44, s2, 1
s_cmp_eq_u32 s44, 0
s_cselect_b32 s68, s4, s6
s_cselect_b32 s69, s5, s7
s_mul_i32 s45, s43, 2341
s_lshr_b32 s45, s45, 16
s_mul_i32 s46, s45, 28
s_sub_u32 s46, s43, s46
v_lshrrev_b32 v4, 4, v1
s_lshl_b32 s43, s45, 8
v_add_u32 v4, s43, v4
v_mul_u32_u24 v4, 7168, v4
v_and_b32 v5, 15, v1
v_lshl_add_u32 v4, v5, 4, v4
s_lshl_b32 s43, s46, 8
v_add_u32 v4, s43, v4
s_mov_b32 s64, s68
s_mov_b32 s65, s69
s_mov_b32 s66, 7340032
s_mov_b32 s67, 0x20000
s_lshl_b32 s55, s45, 1
s_add_u32 s55, s55, s44
s_mul_i32 s55, s55, 14336
s_lshl_b32 s45, s46, 9
s_mov_b32 s50, s46
s_add_u32 s55, s55, s45
v_lshl_add_u32 v5, v5, 5, s55
s_add_u32 s72, s32, 27262976
s_addc_u32 s73, s33, 0
s_mov_b32 s74, 114688
s_mov_b32 s75, 0x20000
v_mov_b32 v32, 0
v_mov_b32 v33, 0
v_mov_b32 v34, 0
v_mov_b32 v35, 0
v_mov_b32 v36, 0
v_mov_b32 v37, 0
v_mov_b32 v38, 0
v_mov_b32 v39, 0
s_lshl_b32 s43, s34, 18
s_add_u32 s12, s32, s43
s_addc_u32 s13, s33, 0
s_mov_b32 s14, 262144
s_mov_b32 s15, 0x20000
v_lshlrev_b32 v21, 4, v1
s_lshl_b32 s54, s36, 11
s_add_u32 s43, s35, 1
s_and_b32 s43, s43, 15
s_lshl_b32 s43, s43, 14
s_add_u32 s30, s43, s54
s_add_u32 s43, s35, 2
s_and_b32 s43, s43, 15
s_lshl_b32 s43, s43, 14
s_add_u32 s31, s43, s54
s_waitcnt vmcnt(0)
s_barrier
ds_write_b128 v27, v[68:71] offset:0
ds_write_b128 v27, v[116:119] offset:512
s_mov_b32 s43, 917504
buffer_load_dwordx4 v[56:59], v4, s[64:67], s43 offen
s_mov_b32 s43, 946176
buffer_load_dwordx4 v[60:63], v4, s[64:67], s43 offen
s_mov_b32 s43, 974848
buffer_load_dwordx4 v[64:67], v4, s[64:67], s43 offen
s_mov_b32 s43, 1003520
buffer_load_dwordx4 v[72:75], v4, s[64:67], s43 offen
s_mov_b32 s43, 1032192
buffer_load_dwordx4 v[76:79], v4, s[64:67], s43 offen
s_mov_b32 s43, 1060864
buffer_load_dwordx4 v[80:83], v4, s[64:67], s43 offen
s_mov_b32 s43, 1089536
buffer_load_dwordx4 v[84:87], v4, s[64:67], s43 offen
s_mov_b32 s43, 1118208
buffer_load_dwordx4 v[88:91], v4, s[64:67], s43 offen
s_mov_b32 s43, 1146880
buffer_load_dwordx4 v[92:95], v4, s[64:67], s43 offen
s_mov_b32 s43, 1175552
buffer_load_dwordx4 v[96:99], v4, s[64:67], s43 offen
s_mov_b32 s43, 1204224
buffer_load_dwordx4 v[100:103], v4, s[64:67], s43 offen
s_mov_b32 s43, 1232896
buffer_load_dwordx4 v[104:107], v4, s[64:67], s43 offen
s_mov_b32 s43, 1261568
buffer_load_dwordx4 v[108:111], v4, s[64:67], s43 offen
s_mov_b32 s43, 1290240
buffer_load_dwordx4 v[112:115], v4, s[64:67], s43 offen
s_mov_b32 s43, 1318912
buffer_load_dwordx4 v[120:123], v4, s[64:67], s43 offen
s_mov_b32 s43, 1347584
buffer_load_dwordx4 v[124:127], v4, s[64:67], s43 offen
v_lshlrev_b32 v40, 16, v128
v_and_b32 v41, 0xffff0000, v128
v_lshlrev_b32 v42, 16, v129
v_and_b32 v43, 0xffff0000, v129
v_lshlrev_b32 v44, 16, v130
v_and_b32 v45, 0xffff0000, v130
v_lshlrev_b32 v46, 16, v131
v_and_b32 v47, 0xffff0000, v131
v_pk_add_f32 v[32:33], v[32:33], v[40:41]
v_pk_add_f32 v[34:35], v[34:35], v[42:43]
v_pk_add_f32 v[36:37], v[36:37], v[44:45]
v_pk_add_f32 v[38:39], v[38:39], v[46:47]
v_lshlrev_b32 v48, 16, v132
v_and_b32 v49, 0xffff0000, v132
v_lshlrev_b32 v50, 16, v133
v_and_b32 v51, 0xffff0000, v133
v_lshlrev_b32 v52, 16, v134
v_and_b32 v53, 0xffff0000, v134
v_lshlrev_b32 v54, 16, v135
v_and_b32 v55, 0xffff0000, v135
v_pk_add_f32 v[32:33], v[32:33], v[48:49]
v_pk_add_f32 v[34:35], v[34:35], v[50:51]
v_pk_add_f32 v[36:37], v[36:37], v[52:53]
v_pk_add_f32 v[38:39], v[38:39], v[54:55]
v_lshlrev_b32 v40, 16, v136
v_and_b32 v41, 0xffff0000, v136
v_lshlrev_b32 v42, 16, v137
v_and_b32 v43, 0xffff0000, v137
v_lshlrev_b32 v44, 16, v138
v_and_b32 v45, 0xffff0000, v138
v_lshlrev_b32 v46, 16, v139
v_and_b32 v47, 0xffff0000, v139
v_pk_add_f32 v[32:33], v[32:33], v[40:41]
v_pk_add_f32 v[34:35], v[34:35], v[42:43]
v_pk_add_f32 v[36:37], v[36:37], v[44:45]
v_pk_add_f32 v[38:39], v[38:39], v[46:47]
v_lshlrev_b32 v48, 16, v140
v_and_b32 v49, 0xffff0000, v140
v_lshlrev_b32 v50, 16, v141
v_and_b32 v51, 0xffff0000, v141
v_lshlrev_b32 v52, 16, v142
v_and_b32 v53, 0xffff0000, v142
v_lshlrev_b32 v54, 16, v143
v_and_b32 v55, 0xffff0000, v143
v_pk_add_f32 v[32:33], v[32:33], v[48:49]
v_pk_add_f32 v[34:35], v[34:35], v[50:51]
v_pk_add_f32 v[36:37], v[36:37], v[52:53]
v_pk_add_f32 v[38:39], v[38:39], v[54:55]
v_lshlrev_b32 v40, 16, v144
v_and_b32 v41, 0xffff0000, v144
v_lshlrev_b32 v42, 16, v145
v_and_b32 v43, 0xffff0000, v145
v_lshlrev_b32 v44, 16, v146
v_and_b32 v45, 0xffff0000, v146
v_lshlrev_b32 v46, 16, v147
v_and_b32 v47, 0xffff0000, v147
v_pk_add_f32 v[32:33], v[32:33], v[40:41]
v_pk_add_f32 v[34:35], v[34:35], v[42:43]
v_pk_add_f32 v[36:37], v[36:37], v[44:45]
v_pk_add_f32 v[38:39], v[38:39], v[46:47]
v_lshlrev_b32 v48, 16, v148
v_and_b32 v49, 0xffff0000, v148
v_lshlrev_b32 v50, 16, v149
v_and_b32 v51, 0xffff0000, v149
v_lshlrev_b32 v52, 16, v150
v_and_b32 v53, 0xffff0000, v150
v_lshlrev_b32 v54, 16, v151
v_and_b32 v55, 0xffff0000, v151
v_pk_add_f32 v[32:33], v[32:33], v[48:49]
v_pk_add_f32 v[34:35], v[34:35], v[50:51]
v_pk_add_f32 v[36:37], v[36:37], v[52:53]
v_pk_add_f32 v[38:39], v[38:39], v[54:55]
v_lshlrev_b32 v40, 16, v152
v_and_b32 v41, 0xffff0000, v152
v_lshlrev_b32 v42, 16, v153
v_and_b32 v43, 0xffff0000, v153
v_lshlrev_b32 v44, 16, v154
v_and_b32 v45, 0xffff0000, v154
v_lshlrev_b32 v46, 16, v155
v_and_b32 v47, 0xffff0000, v155
v_pk_add_f32 v[32:33], v[32:33], v[40:41]
v_pk_add_f32 v[34:35], v[34:35], v[42:43]
v_pk_add_f32 v[36:37], v[36:37], v[44:45]
v_pk_add_f32 v[38:39], v[38:39], v[46:47]
v_lshlrev_b32 v48, 16, v156
v_and_b32 v49, 0xffff0000, v156
v_lshlrev_b32 v50, 16, v157
v_and_b32 v51, 0xffff0000, v157
v_lshlrev_b32 v52, 16, v158
v_and_b32 v53, 0xffff0000, v158
v_lshlrev_b32 v54, 16, v159
v_and_b32 v55, 0xffff0000, v159
v_pk_add_f32 v[32:33], v[32:33], v[48:49]
v_pk_add_f32 v[34:35], v[34:35], v[50:51]
v_pk_add_f32 v[36:37], v[36:37], v[52:53]
v_pk_add_f32 v[38:39], v[38:39], v[54:55]
s_waitcnt lgkmcnt(0)
s_barrier
s_add_u32 m0, s54, 16384
s_add_u32 s43, s30, 0
buffer_load_dwordx4 v21, s[12:15], s43 offen sc1 lds
s_add_u32 m0, s54, 17408
s_add_u32 s43, s30, 1024
buffer_load_dwordx4 v21, s[12:15], s43 offen sc1 lds
s_add_u32 m0, s54, 32768
s_add_u32 s43, s31, 0
buffer_load_dwordx4 v21, s[12:15], s43 offen sc1 lds
s_add_u32 m0, s54, 33792
s_add_u32 s43, s31, 1024
buffer_load_dwordx4 v21, s[12:15], s43 offen sc1 lds
s_waitcnt vmcnt(2)
s_barrier
s_waitcnt vmcnt(0)
s_barrier
v_lshlrev_b32 v40, 16, v160
v_and_b32 v41, 0xffff0000, v160
v_lshlrev_b32 v42, 16, v161
v_and_b32 v43, 0xffff0000, v161
v_lshlrev_b32 v44, 16, v162
v_and_b32 v45, 0xffff0000, v162
v_lshlrev_b32 v46, 16, v163
v_and_b32 v47, 0xffff0000, v163
v_pk_add_f32 v[32:33], v[32:33], v[40:41]
v_pk_add_f32 v[34:35], v[34:35], v[42:43]
v_pk_add_f32 v[36:37], v[36:37], v[44:45]
v_pk_add_f32 v[38:39], v[38:39], v[46:47]
v_lshlrev_b32 v48, 16, v164
v_and_b32 v49, 0xffff0000, v164
v_lshlrev_b32 v50, 16, v165
v_and_b32 v51, 0xffff0000, v165
v_lshlrev_b32 v52, 16, v166
v_and_b32 v53, 0xffff0000, v166
v_lshlrev_b32 v54, 16, v167
v_and_b32 v55, 0xffff0000, v167
v_pk_add_f32 v[32:33], v[32:33], v[48:49]
v_pk_add_f32 v[34:35], v[34:35], v[50:51]
v_pk_add_f32 v[36:37], v[36:37], v[52:53]
v_pk_add_f32 v[38:39], v[38:39], v[54:55]
v_lshlrev_b32 v40, 16, v168
v_and_b32 v41, 0xffff0000, v168
v_lshlrev_b32 v42, 16, v169
v_and_b32 v43, 0xffff0000, v169
v_lshlrev_b32 v44, 16, v170
v_and_b32 v45, 0xffff0000, v170
v_lshlrev_b32 v46, 16, v171
v_and_b32 v47, 0xffff0000, v171
v_pk_add_f32 v[32:33], v[32:33], v[40:41]
v_pk_add_f32 v[34:35], v[34:35], v[42:43]
v_pk_add_f32 v[36:37], v[36:37], v[44:45]
v_pk_add_f32 v[38:39], v[38:39], v[46:47]
v_lshlrev_b32 v48, 16, v172
v_and_b32 v49, 0xffff0000, v172
v_lshlrev_b32 v50, 16, v173
v_and_b32 v51, 0xffff0000, v173
v_lshlrev_b32 v52, 16, v174
v_and_b32 v53, 0xffff0000, v174
v_lshlrev_b32 v54, 16, v175
v_and_b32 v55, 0xffff0000, v175
v_pk_add_f32 v[32:33], v[32:33], v[48:49]
v_pk_add_f32 v[34:35], v[34:35], v[50:51]
v_pk_add_f32 v[36:37], v[36:37], v[52:53]
v_pk_add_f32 v[38:39], v[38:39], v[54:55]
s_barrier
v_lshlrev_b32 v40, 16, v176
v_and_b32 v41, 0xffff0000, v176
v_lshlrev_b32 v42, 16, v177
v_and_b32 v43, 0xffff0000, v177
v_lshlrev_b32 v44, 16, v178
v_and_b32 v45, 0xffff0000, v178
v_lshlrev_b32 v46, 16, v179
v_and_b32 v47, 0xffff0000, v179
v_pk_add_f32 v[32:33], v[32:33], v[40:41]
v_pk_add_f32 v[34:35], v[34:35], v[42:43]
v_pk_add_f32 v[36:37], v[36:37], v[44:45]
v_pk_add_f32 v[38:39], v[38:39], v[46:47]
v_lshlrev_b32 v48, 16, v180
v_and_b32 v49, 0xffff0000, v180
v_lshlrev_b32 v50, 16, v181
v_and_b32 v51, 0xffff0000, v181
v_lshlrev_b32 v52, 16, v182
v_and_b32 v53, 0xffff0000, v182
v_lshlrev_b32 v54, 16, v183
v_and_b32 v55, 0xffff0000, v183
v_pk_add_f32 v[32:33], v[32:33], v[48:49]
v_pk_add_f32 v[34:35], v[34:35], v[50:51]
v_pk_add_f32 v[36:37], v[36:37], v[52:53]
v_pk_add_f32 v[38:39], v[38:39], v[54:55]
v_lshlrev_b32 v40, 16, v184
v_and_b32 v41, 0xffff0000, v184
v_lshlrev_b32 v42, 16, v185
v_and_b32 v43, 0xffff0000, v185
v_lshlrev_b32 v44, 16, v186
v_and_b32 v45, 0xffff0000, v186
v_lshlrev_b32 v46, 16, v187
v_and_b32 v47, 0xffff0000, v187
v_pk_add_f32 v[32:33], v[32:33], v[40:41]
v_pk_add_f32 v[34:35], v[34:35], v[42:43]
v_pk_add_f32 v[36:37], v[36:37], v[44:45]
v_pk_add_f32 v[38:39], v[38:39], v[46:47]
v_lshlrev_b32 v48, 16, v188
v_and_b32 v49, 0xffff0000, v188
v_lshlrev_b32 v50, 16, v189
v_and_b32 v51, 0xffff0000, v189
v_lshlrev_b32 v52, 16, v190
v_and_b32 v53, 0xffff0000, v190
v_lshlrev_b32 v54, 16, v191
v_and_b32 v55, 0xffff0000, v191
v_pk_add_f32 v[32:33], v[32:33], v[48:49]
v_pk_add_f32 v[34:35], v[34:35], v[50:51]
v_pk_add_f32 v[36:37], v[36:37], v[52:53]
v_pk_add_f32 v[38:39], v[38:39], v[54:55]
s_barrier
s_add_u32 s43, s34, 0
s_lshl_b32 s43, s43, 7
v_mov_b32 v8, s43
v_mov_b32 v10, 16
buffer_load_dword v9, v8, s[56:59], 0 offen sc1
v_lshlrev_b32 v40, 16, v192
v_and_b32 v41, 0xffff0000, v192
v_lshlrev_b32 v42, 16, v193
v_and_b32 v43, 0xffff0000, v193
v_lshlrev_b32 v44, 16, v194
v_and_b32 v45, 0xffff0000, v194
v_lshlrev_b32 v46, 16, v195
v_and_b32 v47, 0xffff0000, v195
v_pk_add_f32 v[32:33], v[32:33], v[40:41]
v_pk_add_f32 v[34:35], v[34:35], v[42:43]
v_pk_add_f32 v[36:37], v[36:37], v[44:45]
v_pk_add_f32 v[38:39], v[38:39], v[46:47]
v_lshlrev_b32 v48, 16, v196
v_and_b32 v49, 0xffff0000, v196
v_lshlrev_b32 v50, 16, v197
v_and_b32 v51, 0xffff0000, v197
v_lshlrev_b32 v52, 16, v198
v_and_b32 v53, 0xffff0000, v198
v_lshlrev_b32 v54, 16, v199
v_and_b32 v55, 0xffff0000, v199
v_pk_add_f32 v[32:33], v[32:33], v[48:49]
v_pk_add_f32 v[34:35], v[34:35], v[50:51]
v_pk_add_f32 v[36:37], v[36:37], v[52:53]
v_pk_add_f32 v[38:39], v[38:39], v[54:55]
v_lshlrev_b32 v40, 16, v200
v_and_b32 v41, 0xffff0000, v200
v_lshlrev_b32 v42, 16, v201
v_and_b32 v43, 0xffff0000, v201
v_lshlrev_b32 v44, 16, v202
v_and_b32 v45, 0xffff0000, v202
v_lshlrev_b32 v46, 16, v203
v_and_b32 v47, 0xffff0000, v203
v_pk_add_f32 v[32:33], v[32:33], v[40:41]
v_pk_add_f32 v[34:35], v[34:35], v[42:43]
v_pk_add_f32 v[36:37], v[36:37], v[44:45]
v_pk_add_f32 v[38:39], v[38:39], v[46:47]
v_lshlrev_b32 v48, 16, v204
v_and_b32 v49, 0xffff0000, v204
v_lshlrev_b32 v50, 16, v205
v_and_b32 v51, 0xffff0000, v205
v_lshlrev_b32 v52, 16, v206
v_and_b32 v53, 0xffff0000, v206
v_lshlrev_b32 v54, 16, v207
v_and_b32 v55, 0xffff0000, v207
v_pk_add_f32 v[32:33], v[32:33], v[48:49]
v_pk_add_f32 v[34:35], v[34:35], v[50:51]
v_pk_add_f32 v[36:37], v[36:37], v[52:53]
v_pk_add_f32 v[38:39], v[38:39], v[54:55]
s_barrier
v_lshlrev_b32 v40, 16, v208
v_and_b32 v41, 0xffff0000, v208
v_lshlrev_b32 v42, 16, v209
v_and_b32 v43, 0xffff0000, v209
v_lshlrev_b32 v44, 16, v210
v_and_b32 v45, 0xffff0000, v210
v_lshlrev_b32 v46, 16, v211
v_and_b32 v47, 0xffff0000, v211
v_pk_add_f32 v[32:33], v[32:33], v[40:41]
v_pk_add_f32 v[34:35], v[34:35], v[42:43]
v_pk_add_f32 v[36:37], v[36:37], v[44:45]
v_pk_add_f32 v[38:39], v[38:39], v[46:47]
v_lshlrev_b32 v48, 16, v212
v_and_b32 v49, 0xffff0000, v212
v_lshlrev_b32 v50, 16, v213
v_and_b32 v51, 0xffff0000, v213
v_lshlrev_b32 v52, 16, v214
v_and_b32 v53, 0xffff0000, v214
v_lshlrev_b32 v54, 16, v215
v_and_b32 v55, 0xffff0000, v215
v_pk_add_f32 v[32:33], v[32:33], v[48:49]
v_pk_add_f32 v[34:35], v[34:35], v[50:51]
v_pk_add_f32 v[36:37], v[36:37], v[52:53]
v_pk_add_f32 v[38:39], v[38:39], v[54:55]
v_lshlrev_b32 v40, 16, v216
v_and_b32 v41, 0xffff0000, v216
v_lshlrev_b32 v42, 16, v217
v_and_b32 v43, 0xffff0000, v217
v_lshlrev_b32 v44, 16, v218
v_and_b32 v45, 0xffff0000, v218
v_lshlrev_b32 v46, 16, v219
v_and_b32 v47, 0xffff0000, v219
v_pk_add_f32 v[32:33], v[32:33], v[40:41]
v_pk_add_f32 v[34:35], v[34:35], v[42:43]
v_pk_add_f32 v[36:37], v[36:37], v[44:45]
v_pk_add_f32 v[38:39], v[38:39], v[46:47]
v_lshlrev_b32 v48, 16, v220
v_and_b32 v49, 0xffff0000, v220
v_lshlrev_b32 v50, 16, v221
v_and_b32 v51, 0xffff0000, v221
v_lshlrev_b32 v52, 16, v222
v_and_b32 v53, 0xffff0000, v222
v_lshlrev_b32 v54, 16, v223
v_and_b32 v55, 0xffff0000, v223
v_pk_add_f32 v[32:33], v[32:33], v[48:49]
v_pk_add_f32 v[34:35], v[34:35], v[50:51]
v_pk_add_f32 v[36:37], v[36:37], v[52:53]
v_pk_add_f32 v[38:39], v[38:39], v[54:55]
s_barrier
v_lshlrev_b32 v40, 16, v224
v_and_b32 v41, 0xffff0000, v224
v_lshlrev_b32 v42, 16, v225
v_and_b32 v43, 0xffff0000, v225
v_lshlrev_b32 v44, 16, v226
v_and_b32 v45, 0xffff0000, v226
v_lshlrev_b32 v46, 16, v227
v_and_b32 v47, 0xffff0000, v227
v_pk_add_f32 v[32:33], v[32:33], v[40:41]
v_pk_add_f32 v[34:35], v[34:35], v[42:43]
v_pk_add_f32 v[36:37], v[36:37], v[44:45]
v_pk_add_f32 v[38:39], v[38:39], v[46:47]
v_lshlrev_b32 v48, 16, v228
v_and_b32 v49, 0xffff0000, v228
v_lshlrev_b32 v50, 16, v229
v_and_b32 v51, 0xffff0000, v229
v_lshlrev_b32 v52, 16, v230
v_and_b32 v53, 0xffff0000, v230
v_lshlrev_b32 v54, 16, v231
v_and_b32 v55, 0xffff0000, v231
v_pk_add_f32 v[32:33], v[32:33], v[48:49]
v_pk_add_f32 v[34:35], v[34:35], v[50:51]
v_pk_add_f32 v[36:37], v[36:37], v[52:53]
v_pk_add_f32 v[38:39], v[38:39], v[54:55]
v_lshlrev_b32 v40, 16, v232
v_and_b32 v41, 0xffff0000, v232
v_lshlrev_b32 v42, 16, v233
v_and_b32 v43, 0xffff0000, v233
v_lshlrev_b32 v44, 16, v234
v_and_b32 v45, 0xffff0000, v234
v_lshlrev_b32 v46, 16, v235
v_and_b32 v47, 0xffff0000, v235
v_pk_add_f32 v[32:33], v[32:33], v[40:41]
v_pk_add_f32 v[34:35], v[34:35], v[42:43]
v_pk_add_f32 v[36:37], v[36:37], v[44:45]
v_pk_add_f32 v[38:39], v[38:39], v[46:47]
v_lshlrev_b32 v48, 16, v236
v_and_b32 v49, 0xffff0000, v236
v_lshlrev_b32 v50, 16, v237
v_and_b32 v51, 0xffff0000, v237
v_lshlrev_b32 v52, 16, v238
v_and_b32 v53, 0xffff0000, v238
v_lshlrev_b32 v54, 16, v239
v_and_b32 v55, 0xffff0000, v239
v_pk_add_f32 v[32:33], v[32:33], v[48:49]
v_pk_add_f32 v[34:35], v[34:35], v[50:51]
v_pk_add_f32 v[36:37], v[36:37], v[52:53]
v_pk_add_f32 v[38:39], v[38:39], v[54:55]
s_barrier
s_mov_b32 s41, 0x10000
Lpoll_142:
s_waitcnt vmcnt(0)
Lpf_144:
v_cmp_ne_u32 vcc, v10, v9
s_nop 4
s_cbranch_vccz Lpok_143
buffer_load_dword v9, v8, s[56:59], 0 offen sc1
s_sub_u32 s41, s41, 1
s_cmp_lg_u32 s41, 0
s_cbranch_scc1 Lpoll_142
s_waitcnt vmcnt(0)
Lpok_143:
v_lshlrev_b32 v40, 16, v240
v_and_b32 v41, 0xffff0000, v240
v_lshlrev_b32 v42, 16, v241
v_and_b32 v43, 0xffff0000, v241
v_lshlrev_b32 v44, 16, v242
v_and_b32 v45, 0xffff0000, v242
v_lshlrev_b32 v46, 16, v243
v_and_b32 v47, 0xffff0000, v243
v_pk_add_f32 v[32:33], v[32:33], v[40:41]
v_pk_add_f32 v[34:35], v[34:35], v[42:43]
v_pk_add_f32 v[36:37], v[36:37], v[44:45]
v_pk_add_f32 v[38:39], v[38:39], v[46:47]
v_lshlrev_b32 v48, 16, v244
v_and_b32 v49, 0xffff0000, v244
v_lshlrev_b32 v50, 16, v245
v_and_b32 v51, 0xffff0000, v245
v_lshlrev_b32 v52, 16, v246
v_and_b32 v53, 0xffff0000, v246
v_lshlrev_b32 v54, 16, v247
v_and_b32 v55, 0xffff0000, v247
v_pk_add_f32 v[32:33], v[32:33], v[48:49]
v_pk_add_f32 v[34:35], v[34:35], v[50:51]
v_pk_add_f32 v[36:37], v[36:37], v[52:53]
v_pk_add_f32 v[38:39], v[38:39], v[54:55]
v_lshlrev_b32 v40, 16, v248
v_and_b32 v41, 0xffff0000, v248
v_lshlrev_b32 v42, 16, v249
v_and_b32 v43, 0xffff0000, v249
v_lshlrev_b32 v44, 16, v250
v_and_b32 v45, 0xffff0000, v250
v_lshlrev_b32 v46, 16, v251
v_and_b32 v47, 0xffff0000, v251
v_pk_add_f32 v[32:33], v[32:33], v[40:41]
v_pk_add_f32 v[34:35], v[34:35], v[42:43]
v_pk_add_f32 v[36:37], v[36:37], v[44:45]
v_pk_add_f32 v[38:39], v[38:39], v[46:47]
v_lshlrev_b32 v48, 16, v252
v_and_b32 v49, 0xffff0000, v252
v_lshlrev_b32 v50, 16, v253
v_and_b32 v51, 0xffff0000, v253
v_lshlrev_b32 v52, 16, v254
v_and_b32 v53, 0xffff0000, v254
v_lshlrev_b32 v54, 16, v255
v_and_b32 v55, 0xffff0000, v255
v_pk_add_f32 v[32:33], v[32:33], v[48:49]
v_pk_add_f32 v[34:35], v[34:35], v[50:51]
v_pk_add_f32 v[36:37], v[36:37], v[52:53]
v_pk_add_f32 v[38:39], v[38:39], v[54:55]
s_barrier
s_mov_b32 s43, 1376256
buffer_load_dwordx4 v[128:131], v4, s[64:67], s43 offen
s_mov_b32 s43, 1404928
buffer_load_dwordx4 v[132:135], v4, s[64:67], s43 offen
s_mov_b32 s43, 1433600
buffer_load_dwordx4 v[136:139], v4, s[64:67], s43 offen
s_mov_b32 s43, 1462272
buffer_load_dwordx4 v[140:143], v4, s[64:67], s43 offen
s_mov_b32 s43, 1490944
buffer_load_dwordx4 v[144:147], v4, s[64:67], s43 offen
s_mov_b32 s43, 1519616
buffer_load_dwordx4 v[148:151], v4, s[64:67], s43 offen
s_mov_b32 s43, 1548288
buffer_load_dwordx4 v[152:155], v4, s[64:67], s43 offen
s_mov_b32 s43, 1576960
buffer_load_dwordx4 v[156:159], v4, s[64:67], s43 offen
s_mov_b32 s43, 1605632
buffer_load_dwordx4 v[160:163], v4, s[64:67], s43 offen
s_mov_b32 s43, 1634304
buffer_load_dwordx4 v[164:167], v4, s[64:67], s43 offen
s_mov_b32 s43, 1662976
buffer_load_dwordx4 v[168:171], v4, s[64:67], s43 offen
s_mov_b32 s43, 1691648
buffer_load_dwordx4 v[172:175], v4, s[64:67], s43 offen
s_mov_b32 s43, 1720320
buffer_load_dwordx4 v[176:179], v4, s[64:67], s43 offen
s_mov_b32 s43, 1748992
buffer_load_dwordx4 v[180:183], v4, s[64:67], s43 offen
s_mov_b32 s43, 1777664
buffer_load_dwordx4 v[184:187], v4, s[64:67], s43 offen
s_mov_b32 s43, 1806336
buffer_load_dwordx4 v[188:191], v4, s[64:67], s43 offen
s_barrier
v_lshlrev_b32 v40, 16, v56
v_and_b32 v41, 0xffff0000, v56
v_lshlrev_b32 v42, 16, v57
v_and_b32 v43, 0xffff0000, v57
v_lshlrev_b32 v44, 16, v58
v_and_b32 v45, 0xffff0000, v58
v_lshlrev_b32 v46, 16, v59
v_and_b32 v47, 0xffff0000, v59
v_pk_add_f32 v[32:33], v[32:33], v[40:41]
v_pk_add_f32 v[34:35], v[34:35], v[42:43]
v_pk_add_f32 v[36:37], v[36:37], v[44:45]
v_pk_add_f32 v[38:39], v[38:39], v[46:47]
v_lshlrev_b32 v48, 16, v60
v_and_b32 v49, 0xffff0000, v60
v_lshlrev_b32 v50, 16, v61
v_and_b32 v51, 0xffff0000, v61
v_lshlrev_b32 v52, 16, v62
v_and_b32 v53, 0xffff0000, v62
v_lshlrev_b32 v54, 16, v63
v_and_b32 v55, 0xffff0000, v63
v_pk_add_f32 v[32:33], v[32:33], v[48:49]
v_pk_add_f32 v[34:35], v[34:35], v[50:51]
v_pk_add_f32 v[36:37], v[36:37], v[52:53]
v_pk_add_f32 v[38:39], v[38:39], v[54:55]
v_lshlrev_b32 v40, 16, v64
v_and_b32 v41, 0xffff0000, v64
v_lshlrev_b32 v42, 16, v65
v_and_b32 v43, 0xffff0000, v65
v_lshlrev_b32 v44, 16, v66
v_and_b32 v45, 0xffff0000, v66
v_lshlrev_b32 v46, 16, v67
v_and_b32 v47, 0xffff0000, v67
v_pk_add_f32 v[32:33], v[32:33], v[40:41]
v_pk_add_f32 v[34:35], v[34:35], v[42:43]
v_pk_add_f32 v[36:37], v[36:37], v[44:45]
v_pk_add_f32 v[38:39], v[38:39], v[46:47]
v_lshlrev_b32 v48, 16, v72
v_and_b32 v49, 0xffff0000, v72
v_lshlrev_b32 v50, 16, v73
v_and_b32 v51, 0xffff0000, v73
v_lshlrev_b32 v52, 16, v74
v_and_b32 v53, 0xffff0000, v74
v_lshlrev_b32 v54, 16, v75
v_and_b32 v55, 0xffff0000, v75
v_pk_add_f32 v[32:33], v[32:33], v[48:49]
v_pk_add_f32 v[34:35], v[34:35], v[50:51]
v_pk_add_f32 v[36:37], v[36:37], v[52:53]
v_pk_add_f32 v[38:39], v[38:39], v[54:55]
s_barrier
v_lshlrev_b32 v40, 16, v76
v_and_b32 v41, 0xffff0000, v76
v_lshlrev_b32 v42, 16, v77
v_and_b32 v43, 0xffff0000, v77
v_lshlrev_b32 v44, 16, v78
v_and_b32 v45, 0xffff0000, v78
v_lshlrev_b32 v46, 16, v79
v_and_b32 v47, 0xffff0000, v79
v_pk_add_f32 v[32:33], v[32:33], v[40:41]
v_pk_add_f32 v[34:35], v[34:35], v[42:43]
v_pk_add_f32 v[36:37], v[36:37], v[44:45]
v_pk_add_f32 v[38:39], v[38:39], v[46:47]
v_lshlrev_b32 v48, 16, v80
v_and_b32 v49, 0xffff0000, v80
v_lshlrev_b32 v50, 16, v81
v_and_b32 v51, 0xffff0000, v81
v_lshlrev_b32 v52, 16, v82
v_and_b32 v53, 0xffff0000, v82
v_lshlrev_b32 v54, 16, v83
v_and_b32 v55, 0xffff0000, v83
v_pk_add_f32 v[32:33], v[32:33], v[48:49]
v_pk_add_f32 v[34:35], v[34:35], v[50:51]
v_pk_add_f32 v[36:37], v[36:37], v[52:53]
v_pk_add_f32 v[38:39], v[38:39], v[54:55]
v_lshlrev_b32 v40, 16, v84
v_and_b32 v41, 0xffff0000, v84
v_lshlrev_b32 v42, 16, v85
v_and_b32 v43, 0xffff0000, v85
v_lshlrev_b32 v44, 16, v86
v_and_b32 v45, 0xffff0000, v86
v_lshlrev_b32 v46, 16, v87
v_and_b32 v47, 0xffff0000, v87
v_pk_add_f32 v[32:33], v[32:33], v[40:41]
v_pk_add_f32 v[34:35], v[34:35], v[42:43]
v_pk_add_f32 v[36:37], v[36:37], v[44:45]
v_pk_add_f32 v[38:39], v[38:39], v[46:47]
v_lshlrev_b32 v48, 16, v88
v_and_b32 v49, 0xffff0000, v88
v_lshlrev_b32 v50, 16, v89
v_and_b32 v51, 0xffff0000, v89
v_lshlrev_b32 v52, 16, v90
v_and_b32 v53, 0xffff0000, v90
v_lshlrev_b32 v54, 16, v91
v_and_b32 v55, 0xffff0000, v91
v_pk_add_f32 v[32:33], v[32:33], v[48:49]
v_pk_add_f32 v[34:35], v[34:35], v[50:51]
v_pk_add_f32 v[36:37], v[36:37], v[52:53]
v_pk_add_f32 v[38:39], v[38:39], v[54:55]
s_barrier
v_lshlrev_b32 v40, 16, v92
v_and_b32 v41, 0xffff0000, v92
v_lshlrev_b32 v42, 16, v93
v_and_b32 v43, 0xffff0000, v93
v_lshlrev_b32 v44, 16, v94
v_and_b32 v45, 0xffff0000, v94
v_lshlrev_b32 v46, 16, v95
v_and_b32 v47, 0xffff0000, v95
v_pk_add_f32 v[32:33], v[32:33], v[40:41]
v_pk_add_f32 v[34:35], v[34:35], v[42:43]
v_pk_add_f32 v[36:37], v[36:37], v[44:45]
v_pk_add_f32 v[38:39], v[38:39], v[46:47]
v_lshlrev_b32 v48, 16, v96
v_and_b32 v49, 0xffff0000, v96
v_lshlrev_b32 v50, 16, v97
v_and_b32 v51, 0xffff0000, v97
v_lshlrev_b32 v52, 16, v98
v_and_b32 v53, 0xffff0000, v98
v_lshlrev_b32 v54, 16, v99
v_and_b32 v55, 0xffff0000, v99
v_pk_add_f32 v[32:33], v[32:33], v[48:49]
v_pk_add_f32 v[34:35], v[34:35], v[50:51]
v_pk_add_f32 v[36:37], v[36:37], v[52:53]
v_pk_add_f32 v[38:39], v[38:39], v[54:55]
v_lshlrev_b32 v40, 16, v100
v_and_b32 v41, 0xffff0000, v100
v_lshlrev_b32 v42, 16, v101
v_and_b32 v43, 0xffff0000, v101
v_lshlrev_b32 v44, 16, v102
v_and_b32 v45, 0xffff0000, v102
v_lshlrev_b32 v46, 16, v103
v_and_b32 v47, 0xffff0000, v103
v_pk_add_f32 v[32:33], v[32:33], v[40:41]
v_pk_add_f32 v[34:35], v[34:35], v[42:43]
v_pk_add_f32 v[36:37], v[36:37], v[44:45]
v_pk_add_f32 v[38:39], v[38:39], v[46:47]
v_lshlrev_b32 v48, 16, v104
v_and_b32 v49, 0xffff0000, v104
v_lshlrev_b32 v50, 16, v105
v_and_b32 v51, 0xffff0000, v105
v_lshlrev_b32 v52, 16, v106
v_and_b32 v53, 0xffff0000, v106
v_lshlrev_b32 v54, 16, v107
v_and_b32 v55, 0xffff0000, v107
v_pk_add_f32 v[32:33], v[32:33], v[48:49]
v_pk_add_f32 v[34:35], v[34:35], v[50:51]
v_pk_add_f32 v[36:37], v[36:37], v[52:53]
v_pk_add_f32 v[38:39], v[38:39], v[54:55]
s_barrier
v_lshlrev_b32 v40, 16, v108
v_and_b32 v41, 0xffff0000, v108
v_lshlrev_b32 v42, 16, v109
v_and_b32 v43, 0xffff0000, v109
v_lshlrev_b32 v44, 16, v110
v_and_b32 v45, 0xffff0000, v110
v_lshlrev_b32 v46, 16, v111
v_and_b32 v47, 0xffff0000, v111
v_pk_add_f32 v[32:33], v[32:33], v[40:41]
v_pk_add_f32 v[34:35], v[34:35], v[42:43]
v_pk_add_f32 v[36:37], v[36:37], v[44:45]
v_pk_add_f32 v[38:39], v[38:39], v[46:47]
v_lshlrev_b32 v48, 16, v112
v_and_b32 v49, 0xffff0000, v112
v_lshlrev_b32 v50, 16, v113
v_and_b32 v51, 0xffff0000, v113
v_lshlrev_b32 v52, 16, v114
v_and_b32 v53, 0xffff0000, v114
v_lshlrev_b32 v54, 16, v115
v_and_b32 v55, 0xffff0000, v115
v_pk_add_f32 v[32:33], v[32:33], v[48:49]
v_pk_add_f32 v[34:35], v[34:35], v[50:51]
v_pk_add_f32 v[36:37], v[36:37], v[52:53]
v_pk_add_f32 v[38:39], v[38:39], v[54:55]
v_lshlrev_b32 v40, 16, v120
v_and_b32 v41, 0xffff0000, v120
v_lshlrev_b32 v42, 16, v121
v_and_b32 v43, 0xffff0000, v121
v_lshlrev_b32 v44, 16, v122
v_and_b32 v45, 0xffff0000, v122
v_lshlrev_b32 v46, 16, v123
v_and_b32 v47, 0xffff0000, v123
v_pk_add_f32 v[32:33], v[32:33], v[40:41]
v_pk_add_f32 v[34:35], v[34:35], v[42:43]
v_pk_add_f32 v[36:37], v[36:37], v[44:45]
v_pk_add_f32 v[38:39], v[38:39], v[46:47]
v_lshlrev_b32 v48, 16, v124
v_and_b32 v49, 0xffff0000, v124
v_lshlrev_b32 v50, 16, v125
v_and_b32 v51, 0xffff0000, v125
v_lshlrev_b32 v52, 16, v126
v_and_b32 v53, 0xffff0000, v126
v_lshlrev_b32 v54, 16, v127
v_and_b32 v55, 0xffff0000, v127
v_pk_add_f32 v[32:33], v[32:33], v[48:49]
v_pk_add_f32 v[34:35], v[34:35], v[50:51]
v_pk_add_f32 v[36:37], v[36:37], v[52:53]
v_pk_add_f32 v[38:39], v[38:39], v[54:55]
s_barrier
s_waitcnt vmcnt(0)
v_lshlrev_b32 v40, 16, v128
v_and_b32 v41, 0xffff0000, v128
v_lshlrev_b32 v42, 16, v129
v_and_b32 v43, 0xffff0000, v129
v_lshlrev_b32 v44, 16, v130
v_and_b32 v45, 0xffff0000, v130
v_lshlrev_b32 v46, 16, v131
v_and_b32 v47, 0xffff0000, v131
v_pk_add_f32 v[32:33], v[32:33], v[40:41]
v_pk_add_f32 v[34:35], v[34:35], v[42:43]
v_pk_add_f32 v[36:37], v[36:37], v[44:45]
v_pk_add_f32 v[38:39], v[38:39], v[46:47]
v_lshlrev_b32 v48, 16, v132
v_and_b32 v49, 0xffff0000, v132
v_lshlrev_b32 v50, 16, v133
v_and_b32 v51, 0xffff0000, v133
v_lshlrev_b32 v52, 16, v134
v_and_b32 v53, 0xffff0000, v134
v_lshlrev_b32 v54, 16, v135
v_and_b32 v55, 0xffff0000, v135
v_pk_add_f32 v[32:33], v[32:33], v[48:49]
v_pk_add_f32 v[34:35], v[34:35], v[50:51]
v_pk_add_f32 v[36:37], v[36:37], v[52:53]
v_pk_add_f32 v[38:39], v[38:39], v[54:55]
v_lshlrev_b32 v40, 16, v136
v_and_b32 v41, 0xffff0000, v136
v_lshlrev_b32 v42, 16, v137
v_and_b32 v43, 0xffff0000, v137
v_lshlrev_b32 v44, 16, v138
v_and_b32 v45, 0xffff0000, v138
v_lshlrev_b32 v46, 16, v139
v_and_b32 v47, 0xffff0000, v139
v_pk_add_f32 v[32:33], v[32:33], v[40:41]
v_pk_add_f32 v[34:35], v[34:35], v[42:43]
v_pk_add_f32 v[36:37], v[36:37], v[44:45]
v_pk_add_f32 v[38:39], v[38:39], v[46:47]
v_lshlrev_b32 v48, 16, v140
v_and_b32 v49, 0xffff0000, v140
v_lshlrev_b32 v50, 16, v141
v_and_b32 v51, 0xffff0000, v141
v_lshlrev_b32 v52, 16, v142
v_and_b32 v53, 0xffff0000, v142
v_lshlrev_b32 v54, 16, v143
v_and_b32 v55, 0xffff0000, v143
v_pk_add_f32 v[32:33], v[32:33], v[48:49]
v_pk_add_f32 v[34:35], v[34:35], v[50:51]
v_pk_add_f32 v[36:37], v[36:37], v[52:53]
v_pk_add_f32 v[38:39], v[38:39], v[54:55]
s_barrier
v_lshlrev_b32 v40, 16, v144
v_and_b32 v41, 0xffff0000, v144
v_lshlrev_b32 v42, 16, v145
v_and_b32 v43, 0xffff0000, v145
v_lshlrev_b32 v44, 16, v146
v_and_b32 v45, 0xffff0000, v146
v_lshlrev_b32 v46, 16, v147
v_and_b32 v47, 0xffff0000, v147
v_pk_add_f32 v[32:33], v[32:33], v[40:41]
v_pk_add_f32 v[34:35], v[34:35], v[42:43]
v_pk_add_f32 v[36:37], v[36:37], v[44:45]
v_pk_add_f32 v[38:39], v[38:39], v[46:47]
v_lshlrev_b32 v48, 16, v148
v_and_b32 v49, 0xffff0000, v148
v_lshlrev_b32 v50, 16, v149
v_and_b32 v51, 0xffff0000, v149
v_lshlrev_b32 v52, 16, v150
v_and_b32 v53, 0xffff0000, v150
v_lshlrev_b32 v54, 16, v151
v_and_b32 v55, 0xffff0000, v151
v_pk_add_f32 v[32:33], v[32:33], v[48:49]
v_pk_add_f32 v[34:35], v[34:35], v[50:51]
v_pk_add_f32 v[36:37], v[36:37], v[52:53]
v_pk_add_f32 v[38:39], v[38:39], v[54:55]
v_lshlrev_b32 v40, 16, v152
v_and_b32 v41, 0xffff0000, v152
v_lshlrev_b32 v42, 16, v153
v_and_b32 v43, 0xffff0000, v153
v_lshlrev_b32 v44, 16, v154
v_and_b32 v45, 0xffff0000, v154
v_lshlrev_b32 v46, 16, v155
v_and_b32 v47, 0xffff0000, v155
v_pk_add_f32 v[32:33], v[32:33], v[40:41]
v_pk_add_f32 v[34:35], v[34:35], v[42:43]
v_pk_add_f32 v[36:37], v[36:37], v[44:45]
v_pk_add_f32 v[38:39], v[38:39], v[46:47]
v_lshlrev_b32 v48, 16, v156
v_and_b32 v49, 0xffff0000, v156
v_lshlrev_b32 v50, 16, v157
v_and_b32 v51, 0xffff0000, v157
v_lshlrev_b32 v52, 16, v158
v_and_b32 v53, 0xffff0000, v158
v_lshlrev_b32 v54, 16, v159
v_and_b32 v55, 0xffff0000, v159
v_pk_add_f32 v[32:33], v[32:33], v[48:49]
v_pk_add_f32 v[34:35], v[34:35], v[50:51]
v_pk_add_f32 v[36:37], v[36:37], v[52:53]
v_pk_add_f32 v[38:39], v[38:39], v[54:55]
s_barrier
v_lshlrev_b32 v40, 16, v160
v_and_b32 v41, 0xffff0000, v160
v_lshlrev_b32 v42, 16, v161
v_and_b32 v43, 0xffff0000, v161
v_lshlrev_b32 v44, 16, v162
v_and_b32 v45, 0xffff0000, v162
v_lshlrev_b32 v46, 16, v163
v_and_b32 v47, 0xffff0000, v163
v_pk_add_f32 v[32:33], v[32:33], v[40:41]
v_pk_add_f32 v[34:35], v[34:35], v[42:43]
v_pk_add_f32 v[36:37], v[36:37], v[44:45]
v_pk_add_f32 v[38:39], v[38:39], v[46:47]
v_lshlrev_b32 v48, 16, v164
v_and_b32 v49, 0xffff0000, v164
v_lshlrev_b32 v50, 16, v165
v_and_b32 v51, 0xffff0000, v165
v_lshlrev_b32 v52, 16, v166
v_and_b32 v53, 0xffff0000, v166
v_lshlrev_b32 v54, 16, v167
v_and_b32 v55, 0xffff0000, v167
v_pk_add_f32 v[32:33], v[32:33], v[48:49]
v_pk_add_f32 v[34:35], v[34:35], v[50:51]
v_pk_add_f32 v[36:37], v[36:37], v[52:53]
v_pk_add_f32 v[38:39], v[38:39], v[54:55]
v_lshlrev_b32 v40, 16, v168
v_and_b32 v41, 0xffff0000, v168
v_lshlrev_b32 v42, 16, v169
v_and_b32 v43, 0xffff0000, v169
v_lshlrev_b32 v44, 16, v170
v_and_b32 v45, 0xffff0000, v170
v_lshlrev_b32 v46, 16, v171
v_and_b32 v47, 0xffff0000, v171
v_pk_add_f32 v[32:33], v[32:33], v[40:41]
v_pk_add_f32 v[34:35], v[34:35], v[42:43]
v_pk_add_f32 v[36:37], v[36:37], v[44:45]
v_pk_add_f32 v[38:39], v[38:39], v[46:47]
v_lshlrev_b32 v48, 16, v172
v_and_b32 v49, 0xffff0000, v172
v_lshlrev_b32 v50, 16, v173
v_and_b32 v51, 0xffff0000, v173
v_lshlrev_b32 v52, 16, v174
v_and_b32 v53, 0xffff0000, v174
v_lshlrev_b32 v54, 16, v175
v_and_b32 v55, 0xffff0000, v175
v_pk_add_f32 v[32:33], v[32:33], v[48:49]
v_pk_add_f32 v[34:35], v[34:35], v[50:51]
v_pk_add_f32 v[36:37], v[36:37], v[52:53]
v_pk_add_f32 v[38:39], v[38:39], v[54:55]
s_barrier
v_lshlrev_b32 v40, 16, v176
v_and_b32 v41, 0xffff0000, v176
v_lshlrev_b32 v42, 16, v177
v_and_b32 v43, 0xffff0000, v177
v_lshlrev_b32 v44, 16, v178
v_and_b32 v45, 0xffff0000, v178
v_lshlrev_b32 v46, 16, v179
v_and_b32 v47, 0xffff0000, v179
v_pk_add_f32 v[32:33], v[32:33], v[40:41]
v_pk_add_f32 v[34:35], v[34:35], v[42:43]
v_pk_add_f32 v[36:37], v[36:37], v[44:45]
v_pk_add_f32 v[38:39], v[38:39], v[46:47]
v_lshlrev_b32 v48, 16, v180
v_and_b32 v49, 0xffff0000, v180
v_lshlrev_b32 v50, 16, v181
v_and_b32 v51, 0xffff0000, v181
v_lshlrev_b32 v52, 16, v182
v_and_b32 v53, 0xffff0000, v182
v_lshlrev_b32 v54, 16, v183
v_and_b32 v55, 0xffff0000, v183
v_pk_add_f32 v[32:33], v[32:33], v[48:49]
v_pk_add_f32 v[34:35], v[34:35], v[50:51]
v_pk_add_f32 v[36:37], v[36:37], v[52:53]
v_pk_add_f32 v[38:39], v[38:39], v[54:55]
v_lshlrev_b32 v40, 16, v184
v_and_b32 v41, 0xffff0000, v184
v_lshlrev_b32 v42, 16, v185
v_and_b32 v43, 0xffff0000, v185
v_lshlrev_b32 v44, 16, v186
v_and_b32 v45, 0xffff0000, v186
v_lshlrev_b32 v46, 16, v187
v_and_b32 v47, 0xffff0000, v187
v_pk_add_f32 v[32:33], v[32:33], v[40:41]
v_pk_add_f32 v[34:35], v[34:35], v[42:43]
v_pk_add_f32 v[36:37], v[36:37], v[44:45]
v_pk_add_f32 v[38:39], v[38:39], v[46:47]
v_lshlrev_b32 v48, 16, v188
v_and_b32 v49, 0xffff0000, v188
v_lshlrev_b32 v50, 16, v189
v_and_b32 v51, 0xffff0000, v189
v_lshlrev_b32 v52, 16, v190
v_and_b32 v53, 0xffff0000, v190
v_lshlrev_b32 v54, 16, v191
v_and_b32 v55, 0xffff0000, v191
v_pk_add_f32 v[32:33], v[32:33], v[48:49]
v_pk_add_f32 v[34:35], v[34:35], v[50:51]
v_pk_add_f32 v[36:37], v[36:37], v[52:53]
v_pk_add_f32 v[38:39], v[38:39], v[54:55]
s_barrier
s_nop 2
v_mov_b32 v40, v32
v_mov_b32 v41, v33
v_mov_b32 v42, v34
v_mov_b32 v43, v35
v_mov_b32 v44, v36
v_mov_b32 v45, v37
v_mov_b32 v46, v38
v_mov_b32 v47, v39
s_nop 0
v_permlane16_swap_b32 v32, v40
v_permlane16_swap_b32 v33, v41
v_permlane16_swap_b32 v34, v42
v_permlane16_swap_b32 v35, v43
v_permlane16_swap_b32 v36, v44
v_permlane16_swap_b32 v37, v45
v_permlane16_swap_b32 v38, v46
v_permlane16_swap_b32 v39, v47
v_add_f32 v32, v32, v40
v_add_f32 v33, v33, v41
v_add_f32 v34, v34, v42
v_add_f32 v35, v35, v43
v_add_f32 v36, v36, v44
v_add_f32 v37, v37, v45
v_add_f32 v38, v38, v46
v_add_f32 v39, v39, v47
v_mov_b32 v40, v32
v_mov_b32 v41, v33
v_mov_b32 v42, v34
v_mov_b32 v43, v35
v_mov_b32 v44, v36
v_mov_b32 v45, v37
v_mov_b32 v46, v38
v_mov_b32 v47, v39
s_nop 0
v_permlane32_swap_b32 v32, v40
v_permlane32_swap_b32 v33, v41
v_permlane32_swap_b32 v34, v42
v_permlane32_swap_b32 v35, v43
v_permlane32_swap_b32 v36, v44
v_permlane32_swap_b32 v37, v45
v_permlane32_swap_b32 v38, v46
v_permlane32_swap_b32 v39, v47
v_add_f32 v32, v32, v40
v_add_f32 v33, v33, v41
v_add_f32 v34, v34, v42
v_add_f32 v35, v35, v43
v_add_f32 v36, v36, v44
v_add_f32 v37, v37, v45
v_add_f32 v38, v38, v46
v_add_f32 v39, v39, v47
s_mov_b64 exec, 0xffff
buffer_store_dwordx4 v[32:35], v5, s[72:75], 0 offen sc1
buffer_store_dwordx4 v[36:39], v5, s[72:75], 0 offen offset:16 sc1
s_mov_b64 exec, -1
s_waitcnt vmcnt(0)
s_add_u32 s43, s50, 96
s_lshl_b32 s43, s43, 7
v_mov_b32 v12, s43
v_mov_b32 v13, 1
s_mov_b64 exec, 1
buffer_atomic_add v13, v12, s[56:59], 0 offen sc1
s_mov_b64 exec, -1
s_branch Lcsd_141
.p2align 6
Lw_45:
s_branch Lr_46
s_nop 0
Lnojob_140:
s_lshl_b32 s43, s34, 18
s_add_u32 s12, s32, s43
s_addc_u32 s13, s33, 0
s_mov_b32 s14, 262144
s_mov_b32 s15, 0x20000
v_lshlrev_b32 v21, 4, v1
s_lshl_b32 s54, s36, 11
s_add_u32 s43, s35, 1
s_and_b32 s43, s43, 15
s_lshl_b32 s43, s43, 14
s_add_u32 s30, s43, s54
s_add_u32 s43, s35, 2
s_and_b32 s43, s43, 15
s_lshl_b32 s43, s43, 14
s_add_u32 s31, s43, s54
s_waitcnt vmcnt(0)
s_barrier
ds_write_b128 v27, v[68:71] offset:0
ds_write_b128 v27, v[116:119] offset:512
s_waitcnt lgkmcnt(0)
s_barrier
s_add_u32 m0, s54, 16384
s_add_u32 s43, s30, 0
buffer_load_dwordx4 v21, s[12:15], s43 offen sc1 lds
s_add_u32 m0, s54, 17408
s_add_u32 s43, s30, 1024
buffer_load_dwordx4 v21, s[12:15], s43 offen sc1 lds
s_add_u32 m0, s54, 32768
s_add_u32 s43, s31, 0
buffer_load_dwordx4 v21, s[12:15], s43 offen sc1 lds
s_add_u32 m0, s54, 33792
s_add_u32 s43, s31, 1024
buffer_load_dwordx4 v21, s[12:15], s43 offen sc1 lds
s_waitcnt vmcnt(2)
s_barrier
s_waitcnt vmcnt(0)
s_barrier
s_barrier
s_barrier
s_add_u32 s43, s34, 0
s_lshl_b32 s43, s43, 7
v_mov_b32 v8, s43
v_mov_b32 v10, 16
buffer_load_dword v9, v8, s[56:59], 0 offen sc1
s_barrier
s_barrier
s_barrier
s_mov_b32 s41, 0x10000
Lpoll_145:
s_waitcnt vmcnt(0)
Lpf_147:
v_cmp_ne_u32 vcc, v10, v9
s_nop 4
s_cbranch_vccz Lpok_146
buffer_load_dword v9, v8, s[56:59], 0 offen sc1
s_sub_u32 s41, s41, 1
s_cmp_lg_u32 s41, 0
s_cbranch_scc1 Lpoll_145
s_waitcnt vmcnt(0)
Lpok_146:
s_barrier
s_barrier
s_barrier
s_barrier
s_barrier
s_barrier
s_barrier
s_barrier
s_barrier
s_barrier
s_mov_b32 s55, 0
.p2align 3
Lcsd_141:
s_mov_b32 s46, 1
s_lshl_b32 s43, s34, 18
s_add_u32 s12, s32, s43
s_addc_u32 s13, s33, 0
s_add_u32 s12, s12, 4194304
s_addc_u32 s13, s13, 0
s_mov_b32 s14, 262144
s_mov_b32 s15, 0x20000
v_lshlrev_b32 v21, 4, v1
s_lshl_b32 s54, s36, 11
s_add_u32 s43, s35, 1
s_and_b32 s43, s43, 15
s_lshl_b32 s43, s43, 14
s_add_u32 s30, s43, s54
s_add_u32 s43, s35, 2
s_and_b32 s43, s43, 15
s_lshl_b32 s43, s43, 14
s_add_u32 s31, s43, s54
s_mov_b32 s88, s4
s_mov_b32 s89, s5
s_mov_b32 s90, 7340032
s_mov_b32 s91, 0x20000
s_mov_b32 s92, s6
s_mov_b32 s93, s7
s_mov_b32 s94, 7340032
s_mov_b32 s95, 0x20000
s_lshr_b32 s43, s35, 3
v_and_b32 v19, 1, v1
v_bfe_u32 v23, v1, 2, 2
s_lshl_b32 s44, s43, 3
s_add_u32 s44, s44, 1
v_lshl_add_u32 v23, v19, 2, v23
v_add_u32 v23, s44, v23
s_lshl_b32 s43, s43, 11
s_add_u32 s43, s43, 384
s_movk_i32 s44, 1024
s_lshr_b32 s45, s2, 3
s_mul_i32 s45, s45, 14336
s_add_u32 s43, s43, s45
v_mul_lo_u32 v31, v19, s44
v_bfe_u32 v19, v1, 1, 1
v_mul_u32_u24 v19, 7168, v19
v_add3_u32 v31, v31, v19, s43
v_add_u32 v19, 3, v23
v_and_b32 v19, 15, v19
v_mul_u32_u24 v19, 458752, v19
v_add_u32 v19, v19, v31
buffer_load_dword v30, v19, s[88:91], 0 offen
buffer_load_dword v30, v19, s[92:95], 0 offen
s_lshl_b32 s43, s34, 14
s_add_u32 s64, s32, s43
s_addc_u32 s65, s33, 0
s_add_u32 s64, s64, 25165824
s_addc_u32 s65, s65, 0
s_mov_b32 s66, 16384
s_mov_b32 s67, 0x20000
s_add_u32 s72, s32, 27262976
s_addc_u32 s73, s33, 0
s_mov_b32 s74, 114688
s_mov_b32 s75, 0x20000
s_barrier
s_add_u32 s43, s34, 16
s_lshl_b32 s43, s43, 7
v_mov_b32 v8, s43
v_mov_b32 v9, 1
s_mov_b64 exec, 1
buffer_atomic_add v9, v8, s[56:59], 0 offen sc1
s_mov_b64 exec, -1
s_waitcnt vmcnt(0)
s_mul_i32 s43, s2, 28672
s_mul_i32 s44, s51, 7168
s_add_u32 s43, s43, s44
s_add_u32 s80, s60, s43
s_addc_u32 s81, s61, 0
s_load_dword s82, s[80:81], 0
s_load_dword s83, s[80:81], 64
s_load_dword s84, s[80:81], 128
s_load_dword s85, s[80:81], 192
s_load_dword s86, s[80:81], 256
s_load_dword s87, s[80:81], 320
s_load_dword s82, s[80:81], 384
s_load_dword s83, s[80:81], 448
s_load_dword s84, s[80:81], 512
s_load_dword s85, s[80:81], 576
s_load_dword s86, s[80:81], 640
s_add_u32 s80, s80, 704
s_addc_u32 s81, s81, 0
s_barrier
s_load_dword s82, s[80:81], 0
s_load_dword s83, s[80:81], 64
s_load_dword s84, s[80:81], 128
s_load_dword s85, s[80:81], 192
s_load_dword s86, s[80:81], 256
s_load_dword s87, s[80:81], 320
s_load_dword s82, s[80:81], 384
s_load_dword s83, s[80:81], 448
s_load_dword s84, s[80:81], 512
s_load_dword s85, s[80:81], 576
s_load_dword s86, s[80:81], 640
s_add_u32 s80, s80, 704
s_addc_u32 s81, s81, 0
s_barrier
v_add_u32 v19, 7, v23
v_and_b32 v19, 15, v19
v_mul_u32_u24 v19, 458752, v19
v_add_u32 v19, v19, v31
buffer_load_dword v30, v19, s[88:91], 0 offen
buffer_load_dword v30, v19, s[92:95], 0 offen
s_mul_i32 s43, s49, 96
s_add_u32 s44, s43, 95
s_lshr_b32 s43, s43, 7
s_lshr_b32 s44, s44, 7
s_add_u32 s43, s43, 16
s_add_u32 s44, s44, 16
v_mov_b32 v12, s44
v_writelane_b32 v12, s35, 0
v_writelane_b32 v12, s43, 1
v_add_u32 v12, 96, v12
v_lshlrev_b32 v12, 7, v12
v_mov_b32 v14, 8
buffer_load_dword v13, v12, s[56:59], 0 offen sc1
s_load_dword s82, s[80:81], 0
s_load_dword s83, s[80:81], 64
s_load_dword s84, s[80:81], 128
s_load_dword s85, s[80:81], 192
s_load_dword s86, s[80:81], 256
s_load_dword s87, s[80:81], 320
s_load_dword s82, s[80:81], 384
s_load_dword s83, s[80:81], 448
s_load_dword s84, s[80:81], 512
s_load_dword s85, s[80:81], 576
s_load_dword s86, s[80:81], 640
s_add_u32 s80, s80, 704
s_addc_u32 s81, s81, 0
s_barrier
s_add_u32 s43, s34, 16
s_lshl_b32 s43, s43, 7
v_mov_b32 v8, s43
v_mov_b32 v10, 16
buffer_load_dword v9, v8, s[56:59], 0 offen sc1
s_load_dword s82, s[80:81], 0
s_load_dword s83, s[80:81], 64
s_load_dword s84, s[80:81], 128
s_load_dword s85, s[80:81], 192
s_load_dword s86, s[80:81], 256
s_load_dword s87, s[80:81], 320
s_load_dword s82, s[80:81], 384
s_load_dword s83, s[80:81], 448
s_load_dword s84, s[80:81], 512
s_load_dword s85, s[80:81], 576
s_load_dword s86, s[80:81], 640
s_add_u32 s80, s80, 704
s_addc_u32 s81, s81, 0
s_barrier
s_mov_b32 s41, 0x10000
Lpoll_148:
s_waitcnt vmcnt(0)
Lpf_150:
v_cmp_ne_u32 vcc, v10, v9
s_nop 4
s_cbranch_vccz Lpok_149
buffer_load_dword v9, v8, s[56:59], 0 offen sc1
s_sub_u32 s41, s41, 1
s_cmp_lg_u32 s41, 0
s_cbranch_scc1 Lpoll_148
s_waitcnt vmcnt(0)
Lpok_149:
s_mov_b32 s41, 0x10000
Lpoll_151:
s_waitcnt vmcnt(0)
Lpf_153:
v_cmp_ne_u32 vcc, v14, v13
s_nop 4
s_cbranch_vccz Lpok_152
buffer_load_dword v13, v12, s[56:59], 0 offen sc1
s_sub_u32 s41, s41, 1
s_cmp_lg_u32 s41, 0
s_cbranch_scc1 Lpoll_151
s_waitcnt vmcnt(0)
Lpok_152:
v_min_u32 v12, 55, v1
v_lshlrev_b32 v13, 4, v12
s_lshl_b32 s43, s35, 9
s_mul_i32 s44, s49, 384
s_add_u32 s44, s44, 7680
v_mov_b32 v14, s44
v_mov_b32 v15, s43
v_cmp_gt_u32 vcc, 32, v12
s_nop 1
v_cndmask_b32 v14, v14, v15, vcc
v_add_u32 v14, v14, v13
v_add_u32 v13, 148480, v13
s_mov_b32 s43, 0
buffer_load_dwordx4 v[192:195], v14, s[72:75], s43 offen sc1
s_mov_b32 s43, 28672
buffer_load_dwordx4 v[196:199], v14, s[72:75], s43 offen sc1
s_mov_b32 s43, 57344
buffer_load_dwordx4 v[200:203], v14, s[72:75], s43 offen sc1
s_mov_b32 s43, 86016
buffer_load_dwordx4 v[204:207], v14, s[72:75], s43 offen sc1
s_mov_b32 s43, 14336
buffer_load_dwordx4 v[208:211], v14, s[72:75], s43 offen sc1
s_mov_b32 s43, 43008
buffer_load_dwordx4 v[212:215], v14, s[72:75], s43 offen sc1
s_mov_b32 s43, 71680
buffer_load_dwordx4 v[216:219], v14, s[72:75], s43 offen sc1
s_mov_b32 s43, 100352
buffer_load_dwordx4 v[220:223], v14, s[72:75], s43 offen sc1
s_load_dword s82, s[80:81], 0
s_load_dword s83, s[80:81], 64
s_load_dword s84, s[80:81], 128
s_load_dword s85, s[80:81], 192
s_load_dword s86, s[80:81], 256
s_load_dword s87, s[80:81], 320
s_load_dword s82, s[80:81], 384
s_load_dword s83, s[80:81], 448
s_load_dword s84, s[80:81], 512
s_load_dword s85, s[80:81], 576
s_load_dword s86, s[80:81], 640
s_add_u32 s80, s80, 704
s_addc_u32 s81, s81, 0
s_barrier
s_getpc_b64 s[78:79]
Lpc_154:
s_sub_u32 s78, s78, Lpc_154-sequential_preLN__sliding_local_dilated__glu_gated_geglu__prompt_kernel
s_subb_u32 s79, s79, 0
s_lshr_b32 s43, s2, 3
s_mul_i32 s43, s43, 3840
v_min_u32 v19, 29, v1
v_lshl_add_u32 v19, v19, 7, s43
v_min_u32 v19, Ldone_1-sequential_preLN__sliding_local_dilated__glu_gated_geglu__prompt_kernel, v19
global_load_dword v30, v19, s[78:79]
s_mov_b32 s43, 0
buffer_load_dwordx4 v[128:131], v21, s[64:67], s43 offen sc1
s_mov_b32 s43, 1024
buffer_load_dwordx4 v[132:135], v21, s[64:67], s43 offen sc1
s_mov_b32 s43, 2048
buffer_load_dwordx4 v[136:139], v21, s[64:67], s43 offen sc1
s_mov_b32 s43, 3072
buffer_load_dwordx4 v[140:143], v21, s[64:67], s43 offen sc1
s_mov_b32 s43, 4096
buffer_load_dwordx4 v[144:147], v21, s[64:67], s43 offen sc1
s_mov_b32 s43, 5120
buffer_load_dwordx4 v[148:151], v21, s[64:67], s43 offen sc1
s_mov_b32 s43, 6144
buffer_load_dwordx4 v[152:155], v21, s[64:67], s43 offen sc1
s_mov_b32 s43, 7168
buffer_load_dwordx4 v[156:159], v21, s[64:67], s43 offen sc1
s_mov_b32 s43, 8192
buffer_load_dwordx4 v[160:163], v21, s[64:67], s43 offen sc1
s_mov_b32 s43, 9216
buffer_load_dwordx4 v[164:167], v21, s[64:67], s43 offen sc1
s_mov_b32 s43, 10240
buffer_load_dwordx4 v[168:171], v21, s[64:67], s43 offen sc1
s_mov_b32 s43, 11264
buffer_load_dwordx4 v[172:175], v21, s[64:67], s43 offen sc1
s_mov_b32 s43, 12288
buffer_load_dwordx4 v[176:179], v21, s[64:67], s43 offen sc1
s_mov_b32 s43, 13312
buffer_load_dwordx4 v[180:183], v21, s[64:67], s43 offen sc1
s_mov_b32 s43, 14336
buffer_load_dwordx4 v[184:187], v21, s[64:67], s43 offen sc1
s_mov_b32 s43, 15360
buffer_load_dwordx4 v[188:191], v21, s[64:67], s43 offen sc1
s_load_dword s82, s[80:81], 0
s_load_dword s83, s[80:81], 64
s_load_dword s84, s[80:81], 128
s_load_dword s85, s[80:81], 192
s_load_dword s86, s[80:81], 256
s_load_dword s87, s[80:81], 320
s_load_dword s82, s[80:81], 384
s_load_dword s83, s[80:81], 448
s_load_dword s84, s[80:81], 512
s_load_dword s85, s[80:81], 576
s_load_dword s86, s[80:81], 640
s_add_u32 s80, s80, 704
s_addc_u32 s81, s81, 0
s_barrier
v_add_u32 v19, 11, v23
v_and_b32 v19, 15, v19
v_mul_u32_u24 v19, 458752, v19
v_add_u32 v19, v19, v31
buffer_load_dword v30, v19, s[88:91], 0 offen
buffer_load_dword v30, v19, s[92:95], 0 offen
s_waitcnt vmcnt(16)
v_add_f32 v192, v192, v196
v_add_f32 v200, v200, v204
v_add_f32 v193, v193, v197
v_add_f32 v201, v201, v205
v_add_f32 v194, v194, v198
v_add_f32 v202, v202, v206
v_add_f32 v195, v195, v199
v_add_f32 v203, v203, v207
v_add_f32 v192, v192, v200
v_add_f32 v193, v193, v201
v_add_f32 v194, v194, v202
v_add_f32 v195, v195, v203
ds_write_b128 v13, v[192:195] offset:0
v_add_f32 v208, v208, v212
v_add_f32 v216, v216, v220
v_add_f32 v209, v209, v213
v_add_f32 v217, v217, v221
v_add_f32 v210, v210, v214
v_add_f32 v218, v218, v222
v_add_f32 v211, v211, v215
v_add_f32 v219, v219, v223
v_add_f32 v208, v208, v216
v_add_f32 v209, v209, v217
v_add_f32 v210, v210, v218
v_add_f32 v211, v211, v219
ds_write_b128 v13, v[208:211] offset:896
s_barrier
s_waitcnt vmcnt(0)
v_add_f32 v128, v128, v132
v_add_f32 v129, v129, v133
v_add_f32 v130, v130, v134
v_add_f32 v131, v131, v135
v_add_f32 v128, v128, v136
v_add_f32 v129, v129, v137
v_add_f32 v130, v130, v138
v_add_f32 v131, v131, v139
v_add_f32 v128, v128, v140
v_add_f32 v129, v129, v141
v_add_f32 v130, v130, v142
v_add_f32 v131, v131, v143
v_add_f32 v128, v128, v144
v_add_f32 v129, v129, v145
v_add_f32 v130, v130, v146
v_add_f32 v131, v131, v147
v_add_f32 v128, v128, v148
v_add_f32 v129, v129, v149
v_add_f32 v130, v130, v150
v_add_f32 v131, v131, v151
v_add_f32 v128, v128, v152
v_add_f32 v129, v129, v153
v_add_f32 v130, v130, v154
v_add_f32 v131, v131, v155
v_add_f32 v128, v128, v156
v_add_f32 v129, v129, v157
v_add_f32 v130, v130, v158
v_add_f32 v131, v131, v159
v_add_f32 v128, v128, v160
v_add_f32 v129, v129, v161
v_add_f32 v130, v130, v162
v_add_f32 v131, v131, v163
v_add_f32 v128, v128, v164
v_add_f32 v129, v129, v165
v_add_f32 v130, v130, v166
v_add_f32 v131, v131, v167
v_add_f32 v128, v128, v168
v_add_f32 v129, v129, v169
v_add_f32 v130, v130, v170
v_add_f32 v131, v131, v171
v_add_f32 v128, v128, v172
v_add_f32 v129, v129, v173
v_add_f32 v130, v130, v174
v_add_f32 v131, v131, v175
v_add_f32 v128, v128, v176
v_add_f32 v129, v129, v177
v_add_f32 v130, v130, v178
v_add_f32 v131, v131, v179
v_add_f32 v128, v128, v180
v_add_f32 v129, v129, v181
v_add_f32 v130, v130, v182
v_add_f32 v131, v131, v183
v_add_f32 v128, v128, v184
v_add_f32 v129, v129, v185
v_add_f32 v130, v130, v186
v_add_f32 v131, v131, v187
v_add_f32 v128, v128, v188
v_add_f32 v129, v129, v189
v_add_f32 v130, v130, v190
v_add_f32 v131, v131, v191
v_mul_f32 v128, 0x3a800000, v128
v_mul_f32 v129, 0x3a800000, v129
v_fma_f32 v129, -v128, v128, v129
v_max_f32 v129, 0, v129
v_add_f32 v129, 0x3727c5ac, v129
v_rsq_f32 v129, v129
v_mul_f32 v130, 0x3a800000, v130
v_mul_f32 v131, 0x3a800000, v131
v_fma_f32 v131, -v130, v130, v131
v_max_f32 v131, 0, v131
v_add_f32 v131, 0x3727c5ac, v131
v_rsq_f32 v131, v131
v_add_u32 v19, 147456, v21
ds_write_b128 v19, v[128:131]
s_waitcnt lgkmcnt(0)
s_load_dword s82, s[80:81], 0
s_load_dword s83, s[80:81], 64
s_load_dword s84, s[80:81], 128
s_load_dword s85, s[80:81], 192
s_load_dword s86, s[80:81], 256
s_load_dword s87, s[80:81], 320
s_load_dword s82, s[80:81], 384
s_load_dword s83, s[80:81], 448
s_load_dword s84, s[80:81], 512
s_load_dword s85, s[80:81], 576
s_load_dword s86, s[80:81], 640
s_add_u32 s80, s80, 704
s_addc_u32 s81, s81, 0
s_barrier
s_load_dword s82, s[80:81], 0
s_load_dword s83, s[80:81], 64
s_load_dword s84, s[80:81], 128
s_load_dword s85, s[80:81], 192
s_load_dword s86, s[80:81], 256
s_load_dword s87, s[80:81], 320
s_load_dword s82, s[80:81], 384
s_load_dword s83, s[80:81], 448
s_load_dword s84, s[80:81], 512
s_load_dword s85, s[80:81], 576
s_load_dword s86, s[80:81], 640
s_add_u32 s80, s80, 704
s_addc_u32 s81, s81, 0
s_barrier
v_add_u32 v19, 15, v23
v_and_b32 v19, 15, v19
v_mul_u32_u24 v19, 458752, v19
v_add_u32 v19, v19, v31
buffer_load_dword v30, v19, s[88:91], 0 offen
buffer_load_dword v30, v19, s[92:95], 0 offen
s_and_b32 s53, s35, 1
s_lshl_b32 s53, s53, 1
s_mul_i32 s43, s47, 3
s_add_u32 s53, s53, s43
v_lshlrev_b32 v19, 11, v18
v_lshl_add_u32 v19, v17, 4, v19
s_lshl_b32 s43, s46, 10
v_add_u32 v2, s43, v19
v_add_u32 v3, 49152, v2
v_add_u32 v4, 98304, v2
v_lshrrev_b32 v19, 2, v17
v_lshl_add_u32 v20, v18, 2, v19
v_and_b32 v21, 7, v20
v_lshlrev_b32 v20, 8, v20
v_and_b32 v19, 3, v1
v_lshl_add_u32 v20, v19, 3, v20
s_add_u32 s43, s53, 0
v_xor_b32 v19, s43, v21
v_lshl_add_u32 v5, v19, 5, v20
s_add_u32 s43, s53, 1
v_xor_b32 v19, s43, v21
v_lshl_add_u32 v6, v19, 5, v20
s_add_u32 s43, s53, 2
v_xor_b32 v19, s43, v21
v_lshl_add_u32 v7, v19, 5, v20
v_add_u32 v9, 49152, v5
v_add_u32 v10, 49152, v6
v_add_u32 v11, 49152, v7
v_add_u32 v13, 98304, v5
v_add_u32 v14, 98304, v6
v_add_u32 v15, 98304, v7
s_lshl_b32 s43, s46, 9
s_add_u32 s43, s43, 147456
v_lshl_add_u32 v19, v17, 3, s43
ds_read_b64 v[80:81], v19 offset:0
ds_read_b64 v[82:83], v19 offset:128
ds_read_b64 v[84:85], v19 offset:256
ds_read_b64 v[86:87], v19 offset:384
s_mul_i32 s43, s47, 192
s_add_u32 s43, s43, 148992
v_lshl_add_u32 v19, v18, 4, s43
ds_read_b128 v[48:51], v19 offset:0
ds_read_b128 v[52:55], v19 offset:64
ds_read_b128 v[56:59], v19 offset:128
ds_read_b128 v[60:63], v19 offset:896
ds_read_b128 v[64:67], v19 offset:960
ds_read_b128 v[68:71], v19 offset:1024
s_barrier
s_mov_b32 s88, s4
s_mov_b32 s89, s5
s_mov_b32 s90, 7340032
s_mov_b32 s91, 0x20000
s_mov_b32 s92, s6
s_mov_b32 s93, s7
s_mov_b32 s94, 7340032
s_mov_b32 s95, 0x20000
s_lshr_b32 s43, s35, 3
v_and_b32 v19, 1, v1
v_bfe_u32 v23, v1, 2, 2
s_lshl_b32 s44, s43, 1
s_add_u32 s44, s44, 6
v_add_u32 v23, s44, v23
s_mul_i32 s44, s43, 6
s_add_u32 s44, s44, 1
v_mad_u32_u24 v23, v19, s44, v23
s_lshl_b32 s44, s43, 10
s_lshl_b32 s43, s43, 11
s_sub_u32 s43, 6528, s43
s_lshr_b32 s45, s2, 3
s_mul_i32 s45, s45, 14336
s_add_u32 s43, s43, s45
v_mul_lo_u32 v31, v19, s44
v_bfe_u32 v19, v1, 1, 1
v_mul_u32_u24 v19, 7168, v19
v_add3_u32 v31, v31, v19, s43
v_add_u32 v19, 0, v23
v_and_b32 v19, 15, v19
v_mul_u32_u24 v19, 458752, v19
v_add_u32 v19, v19, v31
buffer_load_dword v30, v19, s[88:91], 0 offen
buffer_load_dword v30, v19, s[92:95], 0 offen
s_waitcnt lgkmcnt(0)
v_mul_f32 v88, v81, v81
v_mul_f32 v228, 0xc0135761, v81
v_mul_f32 v89, 0xbdd2d3e8, v81
v_rcp_f32 v236, v88
v_mul_f32 v232, v89, v88
v_mul_f32 v88, v83, v83
v_mul_f32 v229, 0xc0135761, v83
v_mul_f32 v89, 0xbdd2d3e8, v83
v_rcp_f32 v237, v88
v_mul_f32 v233, v89, v88
v_mul_f32 v88, v85, v85
v_mul_f32 v230, 0xc0135761, v85
v_mul_f32 v89, 0xbdd2d3e8, v85
v_rcp_f32 v238, v88
v_mul_f32 v234, v89, v88
v_mul_f32 v88, v87, v87
v_mul_f32 v231, 0xc0135761, v87
v_mul_f32 v89, 0xbdd2d3e8, v87
v_rcp_f32 v239, v88
v_mul_f32 v235, v89, v88
s_mul_i32 s43, s34, 917504
s_mov_b32 s44, 3577949200
s_mov_b32 s45, 3137247350
s_lshl_b32 s50, s49, 2
s_lshr_b64 s[44:45], s[44:45], s50
s_and_b32 s50, s44, 15
s_mul_i32 s44, s50, 24576
s_add_u32 s43, s43, s44
s_add_u32 s43, s43, 8912896
s_add_u32 s24, s32, s43
s_addc_u32 s25, s33, 0
s_mov_b32 s26, 24576
s_mov_b32 s27, 0x20000
s_mov_b32 s53, 262144
s_lshl_b32 s43, s47, 13
s_lshl_b32 s44, s46, 10
s_add_u32 s43, s43, s44
v_lshlrev_b32 v19, 11, v18
v_lshl_add_u32 v19, v17, 4, v19
v_add_u32 v27, s43, v19
s_lshl_b32 s43, s47, 12
s_add_u32 s43, s43, s44
s_add_u32 s43, s43, 16384
v_and_b32 v19, 1, v18
v_lshlrev_b32 v19, 11, v19
v_lshrrev_b32 v20, 1, v18
v_lshl_add_u32 v19, v20, 8, v19
v_lshl_add_u32 v19, v17, 4, v19
v_add_u32 v28, s43, v19
s_load_dword s82, s[80:81], 0
s_load_dword s83, s[80:81], 64
s_load_dword s84, s[80:81], 128
s_load_dword s85, s[80:81], 192
s_load_dword s86, s[80:81], 256
s_load_dword s87, s[80:81], 320
s_load_dword s82, s[80:81], 384
s_load_dword s83, s[80:81], 448
s_add_u32 s80, s80, 512
s_addc_u32 s81, s81, 0
s_barrier
v_mul_f32 v128, -v80, v48
v_mul_f32 v129, -v80, v49
v_mul_f32 v130, -v80, v50
v_mul_f32 v131, -v80, v51
v_mul_f32 v132, -v82, v48
v_mul_f32 v133, -v82, v49
v_mul_f32 v134, -v82, v50
v_mul_f32 v135, -v82, v51
v_mul_f32 v136, -v84, v48
v_mul_f32 v137, -v84, v49
v_mul_f32 v138, -v84, v50
v_mul_f32 v139, -v84, v51
v_mul_f32 v140, -v86, v48
v_mul_f32 v141, -v86, v49
v_mul_f32 v142, -v86, v50
v_mul_f32 v143, -v86, v51
v_mul_f32 v144, -v80, v52
v_mul_f32 v145, -v80, v53
v_mul_f32 v146, -v80, v54
v_mul_f32 v147, -v80, v55
v_mul_f32 v148, -v82, v52
v_mul_f32 v149, -v82, v53
v_mul_f32 v150, -v82, v54
v_mul_f32 v151, -v82, v55
v_mul_f32 v152, -v84, v52
v_mul_f32 v153, -v84, v53
v_mul_f32 v154, -v84, v54
v_mul_f32 v155, -v84, v55
v_mul_f32 v156, -v86, v52
v_mul_f32 v157, -v86, v53
v_mul_f32 v158, -v86, v54
v_mul_f32 v159, -v86, v55
s_load_dword s82, s[80:81], 0
s_load_dword s83, s[80:81], 64
s_load_dword s84, s[80:81], 128
s_load_dword s85, s[80:81], 192
s_load_dword s86, s[80:81], 256
s_load_dword s87, s[80:81], 320
s_load_dword s82, s[80:81], 384
s_load_dword s83, s[80:81], 448
s_add_u32 s80, s80, 512
s_addc_u32 s81, s81, 0
s_barrier
v_mul_f32 v160, -v80, v56
v_mul_f32 v161, -v80, v57
v_mul_f32 v162, -v80, v58
v_mul_f32 v163, -v80, v59
v_mul_f32 v164, -v82, v56
v_mul_f32 v165, -v82, v57
v_mul_f32 v166, -v82, v58
v_mul_f32 v167, -v82, v59
v_mul_f32 v168, -v84, v56
v_mul_f32 v169, -v84, v57
v_mul_f32 v170, -v84, v58
v_mul_f32 v171, -v84, v59
v_mul_f32 v172, -v86, v56
v_mul_f32 v173, -v86, v57
v_mul_f32 v174, -v86, v58
v_mul_f32 v175, -v86, v59
v_mul_f32 v176, -v80, v60
v_mul_f32 v177, -v80, v61
v_mul_f32 v178, -v80, v62
v_mul_f32 v179, -v80, v63
v_mul_f32 v180, -v82, v60
v_mul_f32 v181, -v82, v61
v_mul_f32 v182, -v82, v62
v_mul_f32 v183, -v82, v63
v_mul_f32 v184, -v84, v60
v_mul_f32 v185, -v84, v61
v_mul_f32 v186, -v84, v62
v_mul_f32 v187, -v84, v63
v_mul_f32 v188, -v86, v60
v_mul_f32 v189, -v86, v61
v_mul_f32 v190, -v86, v62
v_mul_f32 v191, -v86, v63
s_load_dword s82, s[80:81], 0
s_load_dword s83, s[80:81], 64
s_load_dword s84, s[80:81], 128
s_load_dword s85, s[80:81], 192
s_load_dword s86, s[80:81], 256
s_load_dword s87, s[80:81], 320
s_load_dword s82, s[80:81], 384
s_load_dword s83, s[80:81], 448
s_add_u32 s80, s80, 512
s_addc_u32 s81, s81, 0
s_barrier
v_mul_f32 v192, -v80, v64
v_mul_f32 v193, -v80, v65
v_mul_f32 v194, -v80, v66
v_mul_f32 v195, -v80, v67
v_mul_f32 v196, -v82, v64
v_mul_f32 v197, -v82, v65
v_mul_f32 v198, -v82, v66
v_mul_f32 v199, -v82, v67
v_mul_f32 v200, -v84, v64
v_mul_f32 v201, -v84, v65
v_mul_f32 v202, -v84, v66
v_mul_f32 v203, -v84, v67
v_mul_f32 v204, -v86, v64
v_mul_f32 v205, -v86, v65
v_mul_f32 v206, -v86, v66
v_mul_f32 v207, -v86, v67
v_mul_f32 v208, -v80, v68
v_mul_f32 v209, -v80, v69
v_mul_f32 v210, -v80, v70
v_mul_f32 v211, -v80, v71
v_mul_f32 v212, -v82, v68
v_mul_f32 v213, -v82, v69
v_mul_f32 v214, -v82, v70
v_mul_f32 v215, -v82, v71
v_mul_f32 v216, -v84, v68
v_mul_f32 v217, -v84, v69
v_mul_f32 v218, -v84, v70
v_mul_f32 v219, -v84, v71
v_mul_f32 v220, -v86, v68
v_mul_f32 v221, -v86, v69
v_mul_f32 v222, -v86, v70
v_mul_f32 v223, -v86, v71
s_barrier
s_branch Lw_155
Lr_156:
v_add_u32 v19, 4, v23
v_and_b32 v19, 15, v19
v_mul_u32_u24 v19, 458752, v19
v_add_u32 v19, v19, v31
buffer_load_dword v30, v19, s[88:91], 0 offen
buffer_load_dword v30, v19, s[92:95], 0 offen
s_mul_i32 s44, s34, 917504
s_lshl_b32 s39, s51, 13
s_add_u32 s44, s44, s39
s_add_u32 s44, s44, 8388608
s_and_b32 s43, s51, 1
s_xor_b32 s43, s43, s35
s_lshl_b32 s43, s43, 7
s_mov_b32 s10, 909312
s_movk_i32 s38, 1024
s_movk_i32 s40, 9216
s_movk_i32 s37, 0x4000
s_cmp_ge_u32 s51, 2
s_cselect_b32 s8, s60, s32
s_cselect_b32 s9, s61, s33
s_cselect_b32 s10, 7338112, s10
s_cselect_b32 s43, s43, s44
s_cselect_b32 s38, 16384, s38
s_cselect_b32 s40, 81920, s40
s_cselect_b32 s55, 81920, s38
s_cselect_b32 s37, 262144, s37
s_cselect_b32 s45, -1, 0
s_add_u32 s8, s8, s43
s_addc_u32 s9, s9, 0
s_mov_b32 s11, 0x20000
s_and_b32 s53, s35, 1
s_mul_i32 s54, s53, 6
s_mul_i32 s54, s54, s37
s_mul_i32 s29, s53, 2
s_add_u32 s29, s29, 6
s_mul_i32 s29, s29, s37
s_and_b32 s43, s45, 4290838528
s_add_u32 s29, s29, s43
s_mul_i32 s37, s37, 2
s_sub_u32 s37, s37, s40
v_lshrrev_b32 v19, 3, v1
v_mul_u32_u24 v19, 1920, v19
v_lshrrev_b32 v20, 4, v1
v_lshlrev_b32 v20, 5, v20
v_and_b32 v19, s45, v19
v_and_b32 v20, s45, v20
v_lshlrev_b32 v21, 4, v1
v_xor_b32 v21, v21, v20
v_add_u32 v21, v21, v19
s_barrier
.p2align 3
LK3b_134:
s_setprio 1
ds_read_b128 v[32:35], v2 offset:0
ds_read_b64_tr_b16 v[48:49], v5 offset:16384
ds_read_b64_tr_b16 v[50:51], v5 offset:20480
ds_read_b128 v[36:39], v2 offset:256
ds_read_b128 v[40:43], v2 offset:512
ds_read_b128 v[44:47], v2 offset:768
ds_read_b64_tr_b16 v[60:61], v5 offset:32768
ds_read_b64_tr_b16 v[62:63], v5 offset:36864
ds_read_b64_tr_b16 v[52:53], v6 offset:16384
ds_read_b64_tr_b16 v[54:55], v6 offset:20480
ds_read_b64_tr_b16 v[64:65], v6 offset:32768
ds_read_b64_tr_b16 v[66:67], v6 offset:36864
ds_read_b64_tr_b16 v[56:57], v7 offset:16384
ds_read_b64_tr_b16 v[58:59], v7 offset:20480
ds_read_b64_tr_b16 v[68:69], v7 offset:32768
ds_read_b64_tr_b16 v[70:71], v7 offset:36864
s_mov_b32 s41, 5
.p2align 3
Lk3_157:
s_waitcnt lgkmcnt(0)
v_mfma_f32_16x16x32_bf16 v[128:131], v[48:51], v[32:35], v[128:131]
ds_read_b128 v[80:83], v2 offset:8192
v_mfma_f32_16x16x32_bf16 v[132:135], v[48:51], v[36:39], v[132:135]
ds_read_b64_tr_b16 v[96:97], v5 offset:24576
v_mfma_f32_16x16x32_bf16 v[136:139], v[48:51], v[40:43], v[136:139]
ds_read_b64_tr_b16 v[98:99], v5 offset:28672
v_mfma_f32_16x16x32_bf16 v[140:143], v[48:51], v[44:47], v[140:143]
ds_read_b128 v[84:87], v2 offset:8448
v_mfma_f32_16x16x32_bf16 v[188:191], v[60:63], v[44:47], v[188:191]
ds_read_b128 v[88:91], v2 offset:8704
v_mfma_f32_16x16x32_bf16 v[184:187], v[60:63], v[40:43], v[184:187]
ds_read_b128 v[92:95], v2 offset:8960
v_mfma_f32_16x16x32_bf16 v[180:183], v[60:63], v[36:39], v[180:183]
ds_read_b64_tr_b16 v[108:109], v5 offset:40960
v_mfma_f32_16x16x32_bf16 v[176:179], v[60:63], v[32:35], v[176:179]
ds_read_b64_tr_b16 v[110:111], v5 offset:45056
v_mfma_f32_16x16x32_bf16 v[144:147], v[52:55], v[32:35], v[144:147]
ds_read_b64_tr_b16 v[100:101], v6 offset:24576
v_mfma_f32_16x16x32_bf16 v[148:151], v[52:55], v[36:39], v[148:151]
ds_read_b64_tr_b16 v[102:103], v6 offset:28672
v_mfma_f32_16x16x32_bf16 v[152:155], v[52:55], v[40:43], v[152:155]
ds_read_b64_tr_b16 v[112:113], v6 offset:40960
v_mfma_f32_16x16x32_bf16 v[156:159], v[52:55], v[44:47], v[156:159]
ds_read_b64_tr_b16 v[114:115], v6 offset:45056
v_mfma_f32_16x16x32_bf16 v[204:207], v[64:67], v[44:47], v[204:207]
ds_read_b64_tr_b16 v[104:105], v7 offset:24576
v_mfma_f32_16x16x32_bf16 v[200:203], v[64:67], v[40:43], v[200:203]
ds_read_b64_tr_b16 v[106:107], v7 offset:28672
v_mfma_f32_16x16x32_bf16 v[196:199], v[64:67], v[36:39], v[196:199]
ds_read_b64_tr_b16 v[116:117], v7 offset:40960
v_mfma_f32_16x16x32_bf16 v[192:195], v[64:67], v[32:35], v[192:195]
ds_read_b64_tr_b16 v[118:119], v7 offset:45056
v_mfma_f32_16x16x32_bf16 v[160:163], v[56:59], v[32:35], v[160:163]
v_mfma_f32_16x16x32_bf16 v[164:167], v[56:59], v[36:39], v[164:167]
v_mfma_f32_16x16x32_bf16 v[168:171], v[56:59], v[40:43], v[168:171]
v_mfma_f32_16x16x32_bf16 v[172:175], v[56:59], v[44:47], v[172:175]
v_mfma_f32_16x16x32_bf16 v[220:223], v[68:71], v[44:47], v[220:223]
v_mfma_f32_16x16x32_bf16 v[216:219], v[68:71], v[40:43], v[216:219]
v_mfma_f32_16x16x32_bf16 v[212:215], v[68:71], v[36:39], v[212:215]
v_mfma_f32_16x16x32_bf16 v[208:211], v[68:71], v[32:35], v[208:211]
s_waitcnt vmcnt(0) lgkmcnt(0)
s_barrier
v_mfma_f32_16x16x32_bf16 v[128:131], v[96:99], v[80:83], v[128:131]
ds_read_b128 v[32:35], v3 offset:0
v_mfma_f32_16x16x32_bf16 v[132:135], v[96:99], v[84:87], v[132:135]
ds_read_b64_tr_b16 v[48:49], v9 offset:16384
v_mfma_f32_16x16x32_bf16 v[136:139], v[96:99], v[88:91], v[136:139]
ds_read_b64_tr_b16 v[50:51], v9 offset:20480
v_mfma_f32_16x16x32_bf16 v[140:143], v[96:99], v[92:95], v[140:143]
ds_read_b128 v[36:39], v3 offset:256
v_mfma_f32_16x16x32_bf16 v[188:191], v[108:111], v[92:95], v[188:191]
ds_read_b128 v[40:43], v3 offset:512
v_mfma_f32_16x16x32_bf16 v[184:187], v[108:111], v[88:91], v[184:187]
ds_read_b128 v[44:47], v3 offset:768
v_mfma_f32_16x16x32_bf16 v[180:183], v[108:111], v[84:87], v[180:183]
ds_read_b64_tr_b16 v[60:61], v9 offset:32768
v_mfma_f32_16x16x32_bf16 v[176:179], v[108:111], v[80:83], v[176:179]
ds_read_b64_tr_b16 v[62:63], v9 offset:36864
v_mfma_f32_16x16x32_bf16 v[144:147], v[100:103], v[80:83], v[144:147]
ds_read_b64_tr_b16 v[52:53], v10 offset:16384
v_mfma_f32_16x16x32_bf16 v[148:151], v[100:103], v[84:87], v[148:151]
ds_read_b64_tr_b16 v[54:55], v10 offset:20480
v_mfma_f32_16x16x32_bf16 v[152:155], v[100:103], v[88:91], v[152:155]
ds_read_b64_tr_b16 v[64:65], v10 offset:32768
v_mfma_f32_16x16x32_bf16 v[156:159], v[100:103], v[92:95], v[156:159]
ds_read_b64_tr_b16 v[66:67], v10 offset:36864
v_mfma_f32_16x16x32_bf16 v[204:207], v[112:115], v[92:95], v[204:207]
ds_read_b64_tr_b16 v[56:57], v11 offset:16384
v_mfma_f32_16x16x32_bf16 v[200:203], v[112:115], v[88:91], v[200:203]
ds_read_b64_tr_b16 v[58:59], v11 offset:20480
v_mfma_f32_16x16x32_bf16 v[196:199], v[112:115], v[84:87], v[196:199]
ds_read_b64_tr_b16 v[68:69], v11 offset:32768
v_mfma_f32_16x16x32_bf16 v[192:195], v[112:115], v[80:83], v[192:195]
ds_read_b64_tr_b16 v[70:71], v11 offset:36864
v_mfma_f32_16x16x32_bf16 v[160:163], v[104:107], v[80:83], v[160:163]
v_mfma_f32_16x16x32_bf16 v[164:167], v[104:107], v[84:87], v[164:167]
v_mfma_f32_16x16x32_bf16 v[168:171], v[104:107], v[88:91], v[168:171]
v_mfma_f32_16x16x32_bf16 v[172:175], v[104:107], v[92:95], v[172:175]
v_mfma_f32_16x16x32_bf16 v[220:223], v[116:119], v[92:95], v[220:223]
v_mfma_f32_16x16x32_bf16 v[216:219], v[116:119], v[88:91], v[216:219]
v_mfma_f32_16x16x32_bf16 v[212:215], v[116:119], v[84:87], v[212:215]
v_mfma_f32_16x16x32_bf16 v[208:211], v[116:119], v[80:83], v[208:211]
s_waitcnt lgkmcnt(0)
v_mfma_f32_16x16x32_bf16 v[128:131], v[48:51], v[32:35], v[128:131]
ds_read_b128 v[80:83], v3 offset:8192
v_mfma_f32_16x16x32_bf16 v[132:135], v[48:51], v[36:39], v[132:135]
ds_read_b64_tr_b16 v[96:97], v9 offset:24576
v_mfma_f32_16x16x32_bf16 v[136:139], v[48:51], v[40:43], v[136:139]
ds_read_b64_tr_b16 v[98:99], v9 offset:28672
v_mfma_f32_16x16x32_bf16 v[140:143], v[48:51], v[44:47], v[140:143]
ds_read_b128 v[84:87], v3 offset:8448
v_mfma_f32_16x16x32_bf16 v[188:191], v[60:63], v[44:47], v[188:191]
ds_read_b128 v[88:91], v3 offset:8704
v_mfma_f32_16x16x32_bf16 v[184:187], v[60:63], v[40:43], v[184:187]
ds_read_b128 v[92:95], v3 offset:8960
v_mfma_f32_16x16x32_bf16 v[180:183], v[60:63], v[36:39], v[180:183]
ds_read_b64_tr_b16 v[108:109], v9 offset:40960
v_mfma_f32_16x16x32_bf16 v[176:179], v[60:63], v[32:35], v[176:179]
ds_read_b64_tr_b16 v[110:111], v9 offset:45056
v_mfma_f32_16x16x32_bf16 v[144:147], v[52:55], v[32:35], v[144:147]
ds_read_b64_tr_b16 v[100:101], v10 offset:24576
v_mfma_f32_16x16x32_bf16 v[148:151], v[52:55], v[36:39], v[148:151]
ds_read_b64_tr_b16 v[102:103], v10 offset:28672
v_mfma_f32_16x16x32_bf16 v[152:155], v[52:55], v[40:43], v[152:155]
ds_read_b64_tr_b16 v[112:113], v10 offset:40960
v_mfma_f32_16x16x32_bf16 v[156:159], v[52:55], v[44:47], v[156:159]
ds_read_b64_tr_b16 v[114:115], v10 offset:45056
v_mfma_f32_16x16x32_bf16 v[204:207], v[64:67], v[44:47], v[204:207]
ds_read_b64_tr_b16 v[104:105], v11 offset:24576
v_mfma_f32_16x16x32_bf16 v[200:203], v[64:67], v[40:43], v[200:203]
ds_read_b64_tr_b16 v[106:107], v11 offset:28672
v_mfma_f32_16x16x32_bf16 v[196:199], v[64:67], v[36:39], v[196:199]
ds_read_b64_tr_b16 v[116:117], v11 offset:40960
v_mfma_f32_16x16x32_bf16 v[192:195], v[64:67], v[32:35], v[192:195]
ds_read_b64_tr_b16 v[118:119], v11 offset:45056
v_mfma_f32_16x16x32_bf16 v[160:163], v[56:59], v[32:35], v[160:163]
v_mfma_f32_16x16x32_bf16 v[164:167], v[56:59], v[36:39], v[164:167]
v_mfma_f32_16x16x32_bf16 v[168:171], v[56:59], v[40:43], v[168:171]
v_mfma_f32_16x16x32_bf16 v[172:175], v[56:59], v[44:47], v[172:175]
v_mfma_f32_16x16x32_bf16 v[220:223], v[68:71], v[44:47], v[220:223]
v_mfma_f32_16x16x32_bf16 v[216:219], v[68:71], v[40:43], v[216:219]
v_mfma_f32_16x16x32_bf16 v[212:215], v[68:71], v[36:39], v[212:215]
v_mfma_f32_16x16x32_bf16 v[208:211], v[68:71], v[32:35], v[208:211]
s_waitcnt lgkmcnt(0)
s_barrier
v_mfma_f32_16x16x32_bf16 v[128:131], v[96:99], v[80:83], v[128:131]
ds_read_b128 v[32:35], v4 offset:0
v_mfma_f32_16x16x32_bf16 v[132:135], v[96:99], v[84:87], v[132:135]
ds_read_b64_tr_b16 v[48:49], v13 offset:16384
v_mfma_f32_16x16x32_bf16 v[136:139], v[96:99], v[88:91], v[136:139]
ds_read_b64_tr_b16 v[50:51], v13 offset:20480
v_mfma_f32_16x16x32_bf16 v[140:143], v[96:99], v[92:95], v[140:143]
ds_read_b128 v[36:39], v4 offset:256
v_mfma_f32_16x16x32_bf16 v[188:191], v[108:111], v[92:95], v[188:191]
ds_read_b128 v[40:43], v4 offset:512
v_mfma_f32_16x16x32_bf16 v[184:187], v[108:111], v[88:91], v[184:187]
ds_read_b128 v[44:47], v4 offset:768
v_mfma_f32_16x16x32_bf16 v[180:183], v[108:111], v[84:87], v[180:183]
ds_read_b64_tr_b16 v[60:61], v13 offset:32768
v_mfma_f32_16x16x32_bf16 v[176:179], v[108:111], v[80:83], v[176:179]
ds_read_b64_tr_b16 v[62:63], v13 offset:36864
v_mfma_f32_16x16x32_bf16 v[144:147], v[100:103], v[80:83], v[144:147]
ds_read_b64_tr_b16 v[52:53], v14 offset:16384
v_mfma_f32_16x16x32_bf16 v[148:151], v[100:103], v[84:87], v[148:151]
ds_read_b64_tr_b16 v[54:55], v14 offset:20480
v_mfma_f32_16x16x32_bf16 v[152:155], v[100:103], v[88:91], v[152:155]
ds_read_b64_tr_b16 v[64:65], v14 offset:32768
v_mfma_f32_16x16x32_bf16 v[156:159], v[100:103], v[92:95], v[156:159]
ds_read_b64_tr_b16 v[66:67], v14 offset:36864
v_mfma_f32_16x16x32_bf16 v[204:207], v[112:115], v[92:95], v[204:207]
ds_read_b64_tr_b16 v[56:57], v15 offset:16384
v_mfma_f32_16x16x32_bf16 v[200:203], v[112:115], v[88:91], v[200:203]
ds_read_b64_tr_b16 v[58:59], v15 offset:20480
v_mfma_f32_16x16x32_bf16 v[196:199], v[112:115], v[84:87], v[196:199]
ds_read_b64_tr_b16 v[68:69], v15 offset:32768
v_mfma_f32_16x16x32_bf16 v[192:195], v[112:115], v[80:83], v[192:195]
ds_read_b64_tr_b16 v[70:71], v15 offset:36864
v_mfma_f32_16x16x32_bf16 v[160:163], v[104:107], v[80:83], v[160:163]
v_mfma_f32_16x16x32_bf16 v[164:167], v[104:107], v[84:87], v[164:167]
v_mfma_f32_16x16x32_bf16 v[168:171], v[104:107], v[88:91], v[168:171]
v_mfma_f32_16x16x32_bf16 v[172:175], v[104:107], v[92:95], v[172:175]
v_mfma_f32_16x16x32_bf16 v[220:223], v[116:119], v[92:95], v[220:223]
v_mfma_f32_16x16x32_bf16 v[216:219], v[116:119], v[88:91], v[216:219]
v_mfma_f32_16x16x32_bf16 v[212:215], v[116:119], v[84:87], v[212:215]
v_mfma_f32_16x16x32_bf16 v[208:211], v[116:119], v[80:83], v[208:211]
s_waitcnt lgkmcnt(0)
v_mfma_f32_16x16x32_bf16 v[128:131], v[48:51], v[32:35], v[128:131]
ds_read_b128 v[80:83], v4 offset:8192
v_mfma_f32_16x16x32_bf16 v[132:135], v[48:51], v[36:39], v[132:135]
ds_read_b64_tr_b16 v[96:97], v13 offset:24576
v_mfma_f32_16x16x32_bf16 v[136:139], v[48:51], v[40:43], v[136:139]
ds_read_b64_tr_b16 v[98:99], v13 offset:28672
v_mfma_f32_16x16x32_bf16 v[140:143], v[48:51], v[44:47], v[140:143]
ds_read_b128 v[84:87], v4 offset:8448
v_mfma_f32_16x16x32_bf16 v[188:191], v[60:63], v[44:47], v[188:191]
ds_read_b128 v[88:91], v4 offset:8704
v_mfma_f32_16x16x32_bf16 v[184:187], v[60:63], v[40:43], v[184:187]
ds_read_b128 v[92:95], v4 offset:8960
v_mfma_f32_16x16x32_bf16 v[180:183], v[60:63], v[36:39], v[180:183]
ds_read_b64_tr_b16 v[108:109], v13 offset:40960
v_mfma_f32_16x16x32_bf16 v[176:179], v[60:63], v[32:35], v[176:179]
ds_read_b64_tr_b16 v[110:111], v13 offset:45056
v_mfma_f32_16x16x32_bf16 v[144:147], v[52:55], v[32:35], v[144:147]
ds_read_b64_tr_b16 v[100:101], v14 offset:24576
v_mfma_f32_16x16x32_bf16 v[148:151], v[52:55], v[36:39], v[148:151]
ds_read_b64_tr_b16 v[102:103], v14 offset:28672
v_mfma_f32_16x16x32_bf16 v[152:155], v[52:55], v[40:43], v[152:155]
ds_read_b64_tr_b16 v[112:113], v14 offset:40960
v_mfma_f32_16x16x32_bf16 v[156:159], v[52:55], v[44:47], v[156:159]
ds_read_b64_tr_b16 v[114:115], v14 offset:45056
v_mfma_f32_16x16x32_bf16 v[204:207], v[64:67], v[44:47], v[204:207]
ds_read_b64_tr_b16 v[104:105], v15 offset:24576
v_mfma_f32_16x16x32_bf16 v[200:203], v[64:67], v[40:43], v[200:203]
ds_read_b64_tr_b16 v[106:107], v15 offset:28672
v_mfma_f32_16x16x32_bf16 v[196:199], v[64:67], v[36:39], v[196:199]
ds_read_b64_tr_b16 v[116:117], v15 offset:40960
v_mfma_f32_16x16x32_bf16 v[192:195], v[64:67], v[32:35], v[192:195]
ds_read_b64_tr_b16 v[118:119], v15 offset:45056
v_mfma_f32_16x16x32_bf16 v[160:163], v[56:59], v[32:35], v[160:163]
v_mfma_f32_16x16x32_bf16 v[164:167], v[56:59], v[36:39], v[164:167]
v_mfma_f32_16x16x32_bf16 v[168:171], v[56:59], v[40:43], v[168:171]
v_mfma_f32_16x16x32_bf16 v[172:175], v[56:59], v[44:47], v[172:175]
v_mfma_f32_16x16x32_bf16 v[220:223], v[68:71], v[44:47], v[220:223]
v_mfma_f32_16x16x32_bf16 v[216:219], v[68:71], v[40:43], v[216:219]
v_mfma_f32_16x16x32_bf16 v[212:215], v[68:71], v[36:39], v[212:215]
v_mfma_f32_16x16x32_bf16 v[208:211], v[68:71], v[32:35], v[208:211]
s_waitcnt lgkmcnt(0)
s_barrier
v_mfma_f32_16x16x32_bf16 v[128:131], v[96:99], v[80:83], v[128:131]
ds_read_b128 v[32:35], v2 offset:0
v_mfma_f32_16x16x32_bf16 v[132:135], v[96:99], v[84:87], v[132:135]
ds_read_b64_tr_b16 v[48:49], v5 offset:16384
v_mfma_f32_16x16x32_bf16 v[136:139], v[96:99], v[88:91], v[136:139]
ds_read_b64_tr_b16 v[50:51], v5 offset:20480
v_mfma_f32_16x16x32_bf16 v[140:143], v[96:99], v[92:95], v[140:143]
ds_read_b128 v[36:39], v2 offset:256
v_mfma_f32_16x16x32_bf16 v[188:191], v[108:111], v[92:95], v[188:191]
ds_read_b128 v[40:43], v2 offset:512
v_mfma_f32_16x16x32_bf16 v[184:187], v[108:111], v[88:91], v[184:187]
ds_read_b128 v[44:47], v2 offset:768
v_mfma_f32_16x16x32_bf16 v[180:183], v[108:111], v[84:87], v[180:183]
ds_read_b64_tr_b16 v[60:61], v5 offset:32768
v_mfma_f32_16x16x32_bf16 v[176:179], v[108:111], v[80:83], v[176:179]
ds_read_b64_tr_b16 v[62:63], v5 offset:36864
v_mfma_f32_16x16x32_bf16 v[144:147], v[100:103], v[80:83], v[144:147]
ds_read_b64_tr_b16 v[52:53], v6 offset:16384
v_mfma_f32_16x16x32_bf16 v[148:151], v[100:103], v[84:87], v[148:151]
ds_read_b64_tr_b16 v[54:55], v6 offset:20480
v_mfma_f32_16x16x32_bf16 v[152:155], v[100:103], v[88:91], v[152:155]
ds_read_b64_tr_b16 v[64:65], v6 offset:32768
v_mfma_f32_16x16x32_bf16 v[156:159], v[100:103], v[92:95], v[156:159]
ds_read_b64_tr_b16 v[66:67], v6 offset:36864
v_mfma_f32_16x16x32_bf16 v[204:207], v[112:115], v[92:95], v[204:207]
ds_read_b64_tr_b16 v[56:57], v7 offset:16384
v_mfma_f32_16x16x32_bf16 v[200:203], v[112:115], v[88:91], v[200:203]
ds_read_b64_tr_b16 v[58:59], v7 offset:20480
v_mfma_f32_16x16x32_bf16 v[196:199], v[112:115], v[84:87], v[196:199]
ds_read_b64_tr_b16 v[68:69], v7 offset:32768
v_mfma_f32_16x16x32_bf16 v[192:195], v[112:115], v[80:83], v[192:195]
ds_read_b64_tr_b16 v[70:71], v7 offset:36864
v_mfma_f32_16x16x32_bf16 v[160:163], v[104:107], v[80:83], v[160:163]
v_mfma_f32_16x16x32_bf16 v[164:167], v[104:107], v[84:87], v[164:167]
v_mfma_f32_16x16x32_bf16 v[168:171], v[104:107], v[88:91], v[168:171]
v_mfma_f32_16x16x32_bf16 v[172:175], v[104:107], v[92:95], v[172:175]
v_mfma_f32_16x16x32_bf16 v[220:223], v[116:119], v[92:95], v[220:223]
v_mfma_f32_16x16x32_bf16 v[216:219], v[116:119], v[88:91], v[216:219]
v_mfma_f32_16x16x32_bf16 v[212:215], v[116:119], v[84:87], v[212:215]
v_mfma_f32_16x16x32_bf16 v[208:211], v[116:119], v[80:83], v[208:211]
s_sub_u32 s41, s41, 1
s_cmp_lg_u32 s41, 0
s_cbranch_scc1 Lk3_157
s_waitcnt lgkmcnt(0)
v_mfma_f32_16x16x32_bf16 v[128:131], v[48:51], v[32:35], v[128:131]
ds_read_b128 v[80:83], v2 offset:8192
v_mfma_f32_16x16x32_bf16 v[132:135], v[48:51], v[36:39], v[132:135]
ds_read_b64_tr_b16 v[96:97], v5 offset:24576
v_mfma_f32_16x16x32_bf16 v[136:139], v[48:51], v[40:43], v[136:139]
ds_read_b64_tr_b16 v[98:99], v5 offset:28672
v_mfma_f32_16x16x32_bf16 v[140:143], v[48:51], v[44:47], v[140:143]
ds_read_b128 v[84:87], v2 offset:8448
v_mfma_f32_16x16x32_bf16 v[188:191], v[60:63], v[44:47], v[188:191]
ds_read_b128 v[88:91], v2 offset:8704
v_mfma_f32_16x16x32_bf16 v[184:187], v[60:63], v[40:43], v[184:187]
ds_read_b128 v[92:95], v2 offset:8960
v_mfma_f32_16x16x32_bf16 v[180:183], v[60:63], v[36:39], v[180:183]
ds_read_b64_tr_b16 v[108:109], v5 offset:40960
v_mfma_f32_16x16x32_bf16 v[176:179], v[60:63], v[32:35], v[176:179]
ds_read_b64_tr_b16 v[110:111], v5 offset:45056
v_mfma_f32_16x16x32_bf16 v[144:147], v[52:55], v[32:35], v[144:147]
ds_read_b64_tr_b16 v[100:101], v6 offset:24576
v_mfma_f32_16x16x32_bf16 v[148:151], v[52:55], v[36:39], v[148:151]
ds_read_b64_tr_b16 v[102:103], v6 offset:28672
v_mfma_f32_16x16x32_bf16 v[152:155], v[52:55], v[40:43], v[152:155]
ds_read_b64_tr_b16 v[112:113], v6 offset:40960
v_mfma_f32_16x16x32_bf16 v[156:159], v[52:55], v[44:47], v[156:159]
ds_read_b64_tr_b16 v[114:115], v6 offset:45056
v_mfma_f32_16x16x32_bf16 v[204:207], v[64:67], v[44:47], v[204:207]
ds_read_b64_tr_b16 v[104:105], v7 offset:24576
v_mfma_f32_16x16x32_bf16 v[200:203], v[64:67], v[40:43], v[200:203]
ds_read_b64_tr_b16 v[106:107], v7 offset:28672
v_mfma_f32_16x16x32_bf16 v[196:199], v[64:67], v[36:39], v[196:199]
ds_read_b64_tr_b16 v[116:117], v7 offset:40960
v_mfma_f32_16x16x32_bf16 v[192:195], v[64:67], v[32:35], v[192:195]
ds_read_b64_tr_b16 v[118:119], v7 offset:45056
v_mfma_f32_16x16x32_bf16 v[160:163], v[56:59], v[32:35], v[160:163]
v_mfma_f32_16x16x32_bf16 v[164:167], v[56:59], v[36:39], v[164:167]
v_mfma_f32_16x16x32_bf16 v[168:171], v[56:59], v[40:43], v[168:171]
v_mfma_f32_16x16x32_bf16 v[172:175], v[56:59], v[44:47], v[172:175]
v_mfma_f32_16x16x32_bf16 v[220:223], v[68:71], v[44:47], v[220:223]
v_mfma_f32_16x16x32_bf16 v[216:219], v[68:71], v[40:43], v[216:219]
v_mfma_f32_16x16x32_bf16 v[212:215], v[68:71], v[36:39], v[212:215]
v_mfma_f32_16x16x32_bf16 v[208:211], v[68:71], v[32:35], v[208:211]
s_waitcnt lgkmcnt(0)
s_barrier
s_cmp_eq_u32 s36, 7
s_cbranch_scc1 L7b_158
s_add_u32 m0, s39, 0
s_add_u32 s37, s37, s40
buffer_load_dwordx4 v21, s[8:11], s37 offen sc1 lds
v_mfma_f32_16x16x32_bf16 v[128:131], v[96:99], v[80:83], v[128:131]
v_mfma_f32_16x16x32_bf16 v[132:135], v[96:99], v[84:87], v[132:135]
s_add_u32 m0, s39, 1024
s_add_u32 s37, s37, s38
buffer_load_dwordx4 v21, s[8:11], s37 offen sc1 lds
v_mfma_f32_16x16x32_bf16 v[136:139], v[96:99], v[88:91], v[136:139]
s_add_u32 m0, s39, 2048
s_add_u32 s37, s37, s38
buffer_load_dwordx4 v21, s[8:11], s37 offen sc1 lds
v_mfma_f32_16x16x32_bf16 v[140:143], v[96:99], v[92:95], v[140:143]
v_mfma_f32_16x16x32_bf16 v[188:191], v[108:111], v[92:95], v[188:191]
s_add_u32 m0, s39, 3072
s_add_u32 s37, s37, s38
buffer_load_dwordx4 v21, s[8:11], s37 offen sc1 lds
v_mfma_f32_16x16x32_bf16 v[184:187], v[108:111], v[88:91], v[184:187]
s_add_u32 m0, s39, 4096
s_add_u32 s37, s37, s55
buffer_load_dwordx4 v21, s[8:11], s37 offen sc1 lds
v_mfma_f32_16x16x32_bf16 v[180:183], v[108:111], v[84:87], v[180:183]
v_mfma_f32_16x16x32_bf16 v[176:179], v[108:111], v[80:83], v[176:179]
s_add_u32 m0, s39, 5120
s_add_u32 s37, s37, s38
buffer_load_dwordx4 v21, s[8:11], s37 offen sc1 lds
v_mfma_f32_16x16x32_bf16 v[144:147], v[100:103], v[80:83], v[144:147]
s_add_u32 m0, s39, 6144
s_add_u32 s37, s37, s38
buffer_load_dwordx4 v21, s[8:11], s37 offen sc1 lds
v_mfma_f32_16x16x32_bf16 v[148:151], v[100:103], v[84:87], v[148:151]
v_mfma_f32_16x16x32_bf16 v[152:155], v[100:103], v[88:91], v[152:155]
s_add_u32 m0, s39, 7168
s_add_u32 s37, s37, s38
buffer_load_dwordx4 v21, s[8:11], s37 offen sc1 lds
v_mfma_f32_16x16x32_bf16 v[156:159], v[100:103], v[92:95], v[156:159]
s_add_u32 m0, s39, 32768
s_add_u32 s37, s37, s40
buffer_load_dwordx4 v21, s[8:11], s37 offen sc1 lds
v_mfma_f32_16x16x32_bf16 v[204:207], v[112:115], v[92:95], v[204:207]
v_mfma_f32_16x16x32_bf16 v[200:203], v[112:115], v[88:91], v[200:203]
s_add_u32 m0, s39, 33792
s_add_u32 s37, s37, s38
buffer_load_dwordx4 v21, s[8:11], s37 offen sc1 lds
v_mfma_f32_16x16x32_bf16 v[196:199], v[112:115], v[84:87], v[196:199]
s_add_u32 m0, s39, 34816
s_add_u32 s37, s37, s38
buffer_load_dwordx4 v21, s[8:11], s37 offen sc1 lds
v_mfma_f32_16x16x32_bf16 v[192:195], v[112:115], v[80:83], v[192:195]
v_mfma_f32_16x16x32_bf16 v[160:163], v[104:107], v[80:83], v[160:163]
s_add_u32 m0, s39, 35840
s_add_u32 s37, s37, s38
buffer_load_dwordx4 v21, s[8:11], s37 offen sc1 lds
v_mfma_f32_16x16x32_bf16 v[164:167], v[104:107], v[84:87], v[164:167]
s_add_u32 m0, s39, 36864
s_add_u32 s37, s37, s55
buffer_load_dwordx4 v21, s[8:11], s37 offen sc1 lds
v_mfma_f32_16x16x32_bf16 v[168:171], v[104:107], v[88:91], v[168:171]
v_mfma_f32_16x16x32_bf16 v[172:175], v[104:107], v[92:95], v[172:175]
s_add_u32 m0, s39, 37888
s_add_u32 s37, s37, s38
buffer_load_dwordx4 v21, s[8:11], s37 offen sc1 lds
v_mfma_f32_16x16x32_bf16 v[220:223], v[116:119], v[92:95], v[220:223]
s_add_u32 m0, s39, 38912
s_add_u32 s37, s37, s38
buffer_load_dwordx4 v21, s[8:11], s37 offen sc1 lds
v_mfma_f32_16x16x32_bf16 v[216:219], v[116:119], v[88:91], v[216:219]
v_mfma_f32_16x16x32_bf16 v[212:215], v[116:119], v[84:87], v[212:215]
s_add_u32 m0, s39, 39936
s_add_u32 s37, s37, s38
buffer_load_dwordx4 v21, s[8:11], s37 offen sc1 lds
v_mfma_f32_16x16x32_bf16 v[208:211], v[116:119], v[80:83], v[208:211]
s_setprio 0
s_barrier
s_add_u32 s37, s37, s54
s_add_u32 m0, s39, 65536
s_add_u32 s37, s37, s40
buffer_load_dwordx4 v21, s[8:11], s37 offen sc1 lds
v_mul_f32 v80, v128, v128
v_mul_f32 v81, v129, v129
v_mul_f32 v82, v130, v130
v_mul_f32 v83, v131, v131
v_fma_f32 v80, v80, v232, v228
v_fma_f32 v81, v81, v232, v228
v_fma_f32 v82, v82, v232, v228
s_add_u32 m0, s39, 66560
s_add_u32 s37, s37, s38
buffer_load_dwordx4 v21, s[8:11], s37 offen sc1 lds
v_fma_f32 v83, v83, v232, v228
v_mul_f32 v80, v80, v128
v_mul_f32 v81, v81, v129
v_mul_f32 v82, v82, v130
v_mul_f32 v83, v83, v131
v_exp_f32 v80, v80
s_add_u32 m0, s39, 67584
s_add_u32 s37, s37, s38
buffer_load_dwordx4 v21, s[8:11], s37 offen sc1 lds
v_exp_f32 v81, v81
v_exp_f32 v82, v82
v_exp_f32 v83, v83
v_mul_f32 v176, v128, v176
v_mul_f32 v177, v129, v177
v_mul_f32 v178, v130, v178
v_mul_f32 v179, v131, v179
s_add_u32 m0, s39, 68608
s_add_u32 s37, s37, s38
buffer_load_dwordx4 v21, s[8:11], s37 offen sc1 lds
v_fma_f32 v80, v80, v236, v236
v_fma_f32 v81, v81, v236, v236
v_fma_f32 v82, v82, v236, v236
v_fma_f32 v83, v83, v236, v236
v_rcp_f32 v80, v80
v_rcp_f32 v81, v81
s_add_u32 m0, s39, 69632
s_add_u32 s37, s37, s55
buffer_load_dwordx4 v21, s[8:11], s37 offen sc1 lds
v_rcp_f32 v82, v82
v_rcp_f32 v83, v83
v_mul_f32 v176, v176, v80
v_mul_f32 v177, v177, v81
v_mul_f32 v178, v178, v82
v_mul_f32 v179, v179, v83
v_cvt_pk_bf16_f32 v96, v176, v177
s_add_u32 m0, s39, 70656
s_add_u32 s37, s37, s38
buffer_load_dwordx4 v21, s[8:11], s37 offen sc1 lds
v_cvt_pk_bf16_f32 v97, v178, v179
v_mul_f32 v84, v144, v144
v_mul_f32 v85, v145, v145
v_mul_f32 v86, v146, v146
v_mul_f32 v87, v147, v147
v_fma_f32 v84, v84, v232, v228
s_add_u32 m0, s39, 71680
s_add_u32 s37, s37, s38
buffer_load_dwordx4 v21, s[8:11], s37 offen sc1 lds
v_fma_f32 v85, v85, v232, v228
v_fma_f32 v86, v86, v232, v228
v_fma_f32 v87, v87, v232, v228
v_mul_f32 v84, v84, v144
v_mul_f32 v85, v85, v145
v_mul_f32 v86, v86, v146
v_mul_f32 v87, v87, v147
s_add_u32 m0, s39, 72704
s_add_u32 s37, s37, s38
buffer_load_dwordx4 v21, s[8:11], s37 offen sc1 lds
v_exp_f32 v84, v84
v_exp_f32 v85, v85
v_exp_f32 v86, v86
v_exp_f32 v87, v87
v_mul_f32 v192, v144, v192
v_mul_f32 v193, v145, v193
s_waitcnt vmcnt(16)
s_barrier
s_add_u32 m0, s39, 98304
s_add_u32 s37, s37, s40
buffer_load_dwordx4 v21, s[8:11], s37 offen sc1 lds
v_mul_f32 v194, v146, v194
v_mul_f32 v195, v147, v195
v_fma_f32 v84, v84, v236, v236
v_fma_f32 v85, v85, v236, v236
v_fma_f32 v86, v86, v236, v236
v_fma_f32 v87, v87, v236, v236
v_rcp_f32 v84, v84
s_add_u32 m0, s39, 99328
s_add_u32 s37, s37, s38
buffer_load_dwordx4 v21, s[8:11], s37 offen sc1 lds
v_rcp_f32 v85, v85
v_rcp_f32 v86, v86
v_rcp_f32 v87, v87
v_mul_f32 v192, v192, v84
v_mul_f32 v193, v193, v85
v_mul_f32 v194, v194, v86
v_mul_f32 v195, v195, v87
s_add_u32 m0, s39, 100352
s_add_u32 s37, s37, s38
buffer_load_dwordx4 v21, s[8:11], s37 offen sc1 lds
v_cvt_pk_bf16_f32 v98, v192, v193
v_cvt_pk_bf16_f32 v99, v194, v195
v_mul_f32 v80, v160, v160
v_mul_f32 v81, v161, v161
v_mul_f32 v82, v162, v162
s_add_u32 m0, s39, 101376
s_add_u32 s37, s37, s38
buffer_load_dwordx4 v21, s[8:11], s37 offen sc1 lds
v_mul_f32 v83, v163, v163
v_fma_f32 v80, v80, v232, v228
v_fma_f32 v81, v81, v232, v228
v_fma_f32 v82, v82, v232, v228
v_fma_f32 v83, v83, v232, v228
v_mul_f32 v80, v80, v160
v_mul_f32 v81, v81, v161
s_add_u32 m0, s39, 102400
s_add_u32 s37, s37, s55
buffer_load_dwordx4 v21, s[8:11], s37 offen sc1 lds
v_mul_f32 v82, v82, v162
v_mul_f32 v83, v83, v163
v_exp_f32 v80, v80
v_exp_f32 v81, v81
v_exp_f32 v82, v82
v_exp_f32 v83, v83
v_mul_f32 v208, v160, v208
s_add_u32 m0, s39, 103424
s_add_u32 s37, s37, s38
buffer_load_dwordx4 v21, s[8:11], s37 offen sc1 lds
v_mul_f32 v209, v161, v209
v_mul_f32 v210, v162, v210
v_mul_f32 v211, v163, v211
v_fma_f32 v80, v80, v236, v236
v_fma_f32 v81, v81, v236, v236
v_fma_f32 v82, v82, v236, v236
s_add_u32 m0, s39, 104448
s_add_u32 s37, s37, s38
buffer_load_dwordx4 v21, s[8:11], s37 offen sc1 lds
v_fma_f32 v83, v83, v236, v236
v_rcp_f32 v80, v80
v_rcp_f32 v81, v81
v_rcp_f32 v82, v82
v_rcp_f32 v83, v83
v_mul_f32 v208, v208, v80
v_mul_f32 v209, v209, v81
s_add_u32 m0, s39, 105472
s_add_u32 s37, s37, s38
buffer_load_dwordx4 v21, s[8:11], s37 offen sc1 lds
v_mul_f32 v210, v210, v82
v_mul_f32 v211, v211, v83
v_cvt_pk_bf16_f32 v112, v208, v209
v_cvt_pk_bf16_f32 v113, v210, v211
v_mul_f32 v80, v132, v132
v_mul_f32 v81, v133, v133
buffer_store_dwordx4 v[96:99], v27, s[24:27], 0 offen offset:0 sc1
s_waitcnt vmcnt(17)
s_barrier
s_add_u32 m0, s39, 0
s_add_u32 s37, s37, s40
buffer_load_dwordx4 v21, s[8:11], s37 offen sc1 lds
v_mul_f32 v82, v134, v134
v_mul_f32 v83, v135, v135
v_fma_f32 v80, v80, v233, v229
v_fma_f32 v81, v81, v233, v229
v_fma_f32 v82, v82, v233, v229
v_fma_f32 v83, v83, v233, v229
v_mul_f32 v80, v80, v132
s_add_u32 m0, s39, 1024
s_add_u32 s37, s37, s38
buffer_load_dwordx4 v21, s[8:11], s37 offen sc1 lds
v_mul_f32 v81, v81, v133
v_mul_f32 v82, v82, v134
v_mul_f32 v83, v83, v135
v_exp_f32 v80, v80
v_exp_f32 v81, v81
v_exp_f32 v82, v82
s_add_u32 m0, s39, 2048
s_add_u32 s37, s37, s38
buffer_load_dwordx4 v21, s[8:11], s37 offen sc1 lds
v_exp_f32 v83, v83
v_mul_f32 v180, v132, v180
v_mul_f32 v181, v133, v181
v_mul_f32 v182, v134, v182
v_mul_f32 v183, v135, v183
v_fma_f32 v80, v80, v237, v237
v_fma_f32 v81, v81, v237, v237
s_add_u32 m0, s39, 3072
s_add_u32 s37, s37, s38
buffer_load_dwordx4 v21, s[8:11], s37 offen sc1 lds
v_fma_f32 v82, v82, v237, v237
v_fma_f32 v83, v83, v237, v237
v_rcp_f32 v80, v80
v_rcp_f32 v81, v81
v_rcp_f32 v82, v82
v_rcp_f32 v83, v83
s_add_u32 m0, s39, 4096
s_add_u32 s37, s37, s55
buffer_load_dwordx4 v21, s[8:11], s37 offen sc1 lds
v_mul_f32 v180, v180, v80
v_mul_f32 v181, v181, v81
v_mul_f32 v182, v182, v82
v_mul_f32 v183, v183, v83
v_cvt_pk_bf16_f32 v100, v180, v181
v_cvt_pk_bf16_f32 v101, v182, v183
v_mul_f32 v84, v148, v148
s_add_u32 m0, s39, 5120
s_add_u32 s37, s37, s38
buffer_load_dwordx4 v21, s[8:11], s37 offen sc1 lds
v_mul_f32 v85, v149, v149
v_mul_f32 v86, v150, v150
v_mul_f32 v87, v151, v151
v_fma_f32 v84, v84, v233, v229
v_fma_f32 v85, v85, v233, v229
v_fma_f32 v86, v86, v233, v229
s_add_u32 m0, s39, 6144
s_add_u32 s37, s37, s38
buffer_load_dwordx4 v21, s[8:11], s37 offen sc1 lds
v_fma_f32 v87, v87, v233, v229
v_mul_f32 v84, v84, v148
v_mul_f32 v85, v85, v149
v_mul_f32 v86, v86, v150
v_mul_f32 v87, v87, v151
v_exp_f32 v84, v84
v_exp_f32 v85, v85
s_add_u32 m0, s39, 7168
s_add_u32 s37, s37, s38
buffer_load_dwordx4 v21, s[8:11], s37 offen sc1 lds
v_exp_f32 v86, v86
v_exp_f32 v87, v87
v_mul_f32 v196, v148, v196
v_mul_f32 v197, v149, v197
v_mul_f32 v198, v150, v198
v_mul_f32 v199, v151, v199
s_waitcnt vmcnt(17)
s_barrier
s_add_u32 m0, s39, 32768
s_add_u32 s37, s37, s40
buffer_load_dwordx4 v21, s[8:11], s37 offen sc1 lds
v_fma_f32 v84, v84, v237, v237
v_fma_f32 v85, v85, v237, v237
v_fma_f32 v86, v86, v237, v237
v_fma_f32 v87, v87, v237, v237
v_rcp_f32 v84, v84
v_rcp_f32 v85, v85
v_rcp_f32 v86, v86
s_add_u32 m0, s39, 33792
s_add_u32 s37, s37, s38
buffer_load_dwordx4 v21, s[8:11], s37 offen sc1 lds
v_rcp_f32 v87, v87
v_mul_f32 v196, v196, v84
v_mul_f32 v197, v197, v85
v_mul_f32 v198, v198, v86
v_mul_f32 v199, v199, v87
v_cvt_pk_bf16_f32 v102, v196, v197
v_cvt_pk_bf16_f32 v103, v198, v199
s_add_u32 m0, s39, 34816
s_add_u32 s37, s37, s38
buffer_load_dwordx4 v21, s[8:11], s37 offen sc1 lds
v_mul_f32 v80, v164, v164
v_mul_f32 v81, v165, v165
v_mul_f32 v82, v166, v166
v_mul_f32 v83, v167, v167
v_fma_f32 v80, v80, v233, v229
s_add_u32 m0, s39, 35840
s_add_u32 s37, s37, s38
buffer_load_dwordx4 v21, s[8:11], s37 offen sc1 lds
v_fma_f32 v81, v81, v233, v229
v_fma_f32 v82, v82, v233, v229
v_fma_f32 v83, v83, v233, v229
v_mul_f32 v80, v80, v164
v_mul_f32 v81, v81, v165
v_mul_f32 v82, v82, v166
v_mul_f32 v83, v83, v167
s_add_u32 m0, s39, 36864
s_add_u32 s37, s37, s55
buffer_load_dwordx4 v21, s[8:11], s37 offen sc1 lds
v_exp_f32 v80, v80
v_exp_f32 v81, v81
v_exp_f32 v82, v82
v_exp_f32 v83, v83
v_mul_f32 v212, v164, v212
v_mul_f32 v213, v165, v213
v_mul_f32 v214, v166, v214
s_add_u32 m0, s39, 37888
s_add_u32 s37, s37, s38
buffer_load_dwordx4 v21, s[8:11], s37 offen sc1 lds
v_mul_f32 v215, v167, v215
v_fma_f32 v80, v80, v237, v237
v_fma_f32 v81, v81, v237, v237
v_fma_f32 v82, v82, v237, v237
v_fma_f32 v83, v83, v237, v237
v_rcp_f32 v80, v80
s_add_u32 m0, s39, 38912
s_add_u32 s37, s37, s38
buffer_load_dwordx4 v21, s[8:11], s37 offen sc1 lds
v_rcp_f32 v81, v81
v_rcp_f32 v82, v82
v_rcp_f32 v83, v83
v_mul_f32 v212, v212, v80
v_mul_f32 v213, v213, v81
v_mul_f32 v214, v214, v82
v_mul_f32 v215, v215, v83
s_add_u32 m0, s39, 39936
s_add_u32 s37, s37, s38
buffer_load_dwordx4 v21, s[8:11], s37 offen sc1 lds
v_cvt_pk_bf16_f32 v114, v212, v213
v_cvt_pk_bf16_f32 v115, v214, v215
s_nop 1
v_permlane32_swap_b32 v112, v114
v_permlane32_swap_b32 v113, v115
buffer_store_dwordx4 v[100:103], v27, s[24:27], 0 offen offset:256 sc1
buffer_store_dwordx4 v[112:115], v28, s[24:27], 0 offen offset:0 sc1
s_waitcnt vmcnt(19)
s_barrier
s_add_u32 m0, s39, 65536
s_add_u32 s37, s37, s40
buffer_load_dwordx4 v21, s[8:11], s37 offen sc1 lds
v_mul_f32 v80, v136, v136
v_mul_f32 v81, v137, v137
v_mul_f32 v82, v138, v138
v_mul_f32 v83, v139, v139
v_fma_f32 v80, v80, v234, v230
v_fma_f32 v81, v81, v234, v230
v_fma_f32 v82, v82, v234, v230
s_add_u32 m0, s39, 66560
s_add_u32 s37, s37, s38
buffer_load_dwordx4 v21, s[8:11], s37 offen sc1 lds
v_fma_f32 v83, v83, v234, v230
v_mul_f32 v80, v80, v136
v_mul_f32 v81, v81, v137
v_mul_f32 v82, v82, v138
v_mul_f32 v83, v83, v139
v_exp_f32 v80, v80
s_add_u32 m0, s39, 67584
s_add_u32 s37, s37, s38
buffer_load_dwordx4 v21, s[8:11], s37 offen sc1 lds
v_exp_f32 v81, v81
v_exp_f32 v82, v82
v_exp_f32 v83, v83
v_mul_f32 v184, v136, v184
v_mul_f32 v185, v137, v185
v_mul_f32 v186, v138, v186
v_mul_f32 v187, v139, v187
s_add_u32 m0, s39, 68608
s_add_u32 s37, s37, s38
buffer_load_dwordx4 v21, s[8:11], s37 offen sc1 lds
v_fma_f32 v80, v80, v238, v238
v_fma_f32 v81, v81, v238, v238
v_fma_f32 v82, v82, v238, v238
v_fma_f32 v83, v83, v238, v238
v_rcp_f32 v80, v80
v_rcp_f32 v81, v81
s_add_u32 m0, s39, 69632
s_add_u32 s37, s37, s55
buffer_load_dwordx4 v21, s[8:11], s37 offen sc1 lds
v_rcp_f32 v82, v82
v_rcp_f32 v83, v83
v_mul_f32 v184, v184, v80
v_mul_f32 v185, v185, v81
v_mul_f32 v186, v186, v82
v_mul_f32 v187, v187, v83
v_cvt_pk_bf16_f32 v104, v184, v185
s_add_u32 m0, s39, 70656
s_add_u32 s37, s37, s38
buffer_load_dwordx4 v21, s[8:11], s37 offen sc1 lds
v_cvt_pk_bf16_f32 v105, v186, v187
v_mul_f32 v84, v152, v152
v_mul_f32 v85, v153, v153
v_mul_f32 v86, v154, v154
v_mul_f32 v87, v155, v155
v_fma_f32 v84, v84, v234, v230
s_add_u32 m0, s39, 71680
s_add_u32 s37, s37, s38
buffer_load_dwordx4 v21, s[8:11], s37 offen sc1 lds
v_fma_f32 v85, v85, v234, v230
v_fma_f32 v86, v86, v234, v230
v_fma_f32 v87, v87, v234, v230
v_mul_f32 v84, v84, v152
v_mul_f32 v85, v85, v153
v_mul_f32 v86, v86, v154
v_mul_f32 v87, v87, v155
s_add_u32 m0, s39, 72704
s_add_u32 s37, s37, s38
buffer_load_dwordx4 v21, s[8:11], s37 offen sc1 lds
v_exp_f32 v84, v84
v_exp_f32 v85, v85
v_exp_f32 v86, v86
v_exp_f32 v87, v87
v_mul_f32 v200, v152, v200
v_mul_f32 v201, v153, v201
s_waitcnt vmcnt(18)
s_barrier
s_add_u32 m0, s39, 98304
s_add_u32 s37, s37, s40
buffer_load_dwordx4 v21, s[8:11], s37 offen sc1 lds
v_mul_f32 v202, v154, v202
v_mul_f32 v203, v155, v203
v_fma_f32 v84, v84, v238, v238
v_fma_f32 v85, v85, v238, v238
v_fma_f32 v86, v86, v238, v238
v_fma_f32 v87, v87, v238, v238
v_rcp_f32 v84, v84
s_add_u32 m0, s39, 99328
s_add_u32 s37, s37, s38
buffer_load_dwordx4 v21, s[8:11], s37 offen sc1 lds
v_rcp_f32 v85, v85
v_rcp_f32 v86, v86
v_rcp_f32 v87, v87
v_mul_f32 v200, v200, v84
v_mul_f32 v201, v201, v85
v_mul_f32 v202, v202, v86
v_mul_f32 v203, v203, v87
s_add_u32 m0, s39, 100352
s_add_u32 s37, s37, s38
buffer_load_dwordx4 v21, s[8:11], s37 offen sc1 lds
v_cvt_pk_bf16_f32 v106, v200, v201
v_cvt_pk_bf16_f32 v107, v202, v203
v_mul_f32 v80, v168, v168
v_mul_f32 v81, v169, v169
v_mul_f32 v82, v170, v170
s_add_u32 m0, s39, 101376
s_add_u32 s37, s37, s38
buffer_load_dwordx4 v21, s[8:11], s37 offen sc1 lds
v_mul_f32 v83, v171, v171
v_fma_f32 v80, v80, v234, v230
v_fma_f32 v81, v81, v234, v230
v_fma_f32 v82, v82, v234, v230
v_fma_f32 v83, v83, v234, v230
v_mul_f32 v80, v80, v168
v_mul_f32 v81, v81, v169
s_add_u32 m0, s39, 102400
s_add_u32 s37, s37, s55
buffer_load_dwordx4 v21, s[8:11], s37 offen sc1 lds
v_mul_f32 v82, v82, v170
v_mul_f32 v83, v83, v171
v_exp_f32 v80, v80
v_exp_f32 v81, v81
v_exp_f32 v82, v82
v_exp_f32 v83, v83
v_mul_f32 v216, v168, v216
s_add_u32 m0, s39, 103424
s_add_u32 s37, s37, s38
buffer_load_dwordx4 v21, s[8:11], s37 offen sc1 lds
v_mul_f32 v217, v169, v217
v_mul_f32 v218, v170, v218
v_mul_f32 v219, v171, v219
v_fma_f32 v80, v80, v238, v238
v_fma_f32 v81, v81, v238, v238
v_fma_f32 v82, v82, v238, v238
s_add_u32 m0, s39, 104448
s_add_u32 s37, s37, s38
buffer_load_dwordx4 v21, s[8:11], s37 offen sc1 lds
v_fma_f32 v83, v83, v238, v238
v_rcp_f32 v80, v80
v_rcp_f32 v81, v81
v_rcp_f32 v82, v82
v_rcp_f32 v83, v83
v_mul_f32 v216, v216, v80
v_mul_f32 v217, v217, v81
s_add_u32 m0, s39, 105472
s_add_u32 s37, s37, s38
buffer_load_dwordx4 v21, s[8:11], s37 offen sc1 lds
v_mul_f32 v218, v218, v82
v_mul_f32 v219, v219, v83
v_cvt_pk_bf16_f32 v116, v216, v217
v_cvt_pk_bf16_f32 v117, v218, v219
v_mul_f32 v80, v140, v140
v_mul_f32 v81, v141, v141
buffer_store_dwordx4 v[104:107], v27, s[24:27], 0 offen offset:512 sc1
s_waitcnt vmcnt(19)
s_barrier
s_add_u32 s37, s37, s29
s_add_u32 m0, s39, 0
s_add_u32 s37, s37, s40
buffer_load_dwordx4 v21, s[8:11], s37 offen sc1 lds
v_mul_f32 v82, v142, v142
v_mul_f32 v83, v143, v143
v_fma_f32 v80, v80, v235, v231
v_fma_f32 v81, v81, v235, v231
v_fma_f32 v82, v82, v235, v231
v_fma_f32 v83, v83, v235, v231
v_mul_f32 v80, v80, v140
s_add_u32 m0, s39, 1024
s_add_u32 s37, s37, s38
buffer_load_dwordx4 v21, s[8:11], s37 offen sc1 lds
v_mul_f32 v81, v81, v141
v_mul_f32 v82, v82, v142
v_mul_f32 v83, v83, v143
v_exp_f32 v80, v80
v_exp_f32 v81, v81
v_exp_f32 v82, v82
s_add_u32 m0, s39, 2048
s_add_u32 s37, s37, s38
buffer_load_dwordx4 v21, s[8:11], s37 offen sc1 lds
v_exp_f32 v83, v83
v_mul_f32 v188, v140, v188
v_mul_f32 v189, v141, v189
v_mul_f32 v190, v142, v190
v_mul_f32 v191, v143, v191
v_fma_f32 v80, v80, v239, v239
v_fma_f32 v81, v81, v239, v239
s_add_u32 m0, s39, 3072
s_add_u32 s37, s37, s38
buffer_load_dwordx4 v21, s[8:11], s37 offen sc1 lds
v_fma_f32 v82, v82, v239, v239
v_fma_f32 v83, v83, v239, v239
v_rcp_f32 v80, v80
v_rcp_f32 v81, v81
v_rcp_f32 v82, v82
v_rcp_f32 v83, v83
s_add_u32 m0, s39, 4096
s_add_u32 s37, s37, s55
buffer_load_dwordx4 v21, s[8:11], s37 offen sc1 lds
v_mul_f32 v188, v188, v80
v_mul_f32 v189, v189, v81
v_mul_f32 v190, v190, v82
v_mul_f32 v191, v191, v83
v_cvt_pk_bf16_f32 v108, v188, v189
v_cvt_pk_bf16_f32 v109, v190, v191
v_mul_f32 v84, v156, v156
s_add_u32 m0, s39, 5120
s_add_u32 s37, s37, s38
buffer_load_dwordx4 v21, s[8:11], s37 offen sc1 lds
v_mul_f32 v85, v157, v157
v_mul_f32 v86, v158, v158
v_mul_f32 v87, v159, v159
v_fma_f32 v84, v84, v235, v231
v_fma_f32 v85, v85, v235, v231
v_fma_f32 v86, v86, v235, v231
s_add_u32 m0, s39, 6144
s_add_u32 s37, s37, s38
buffer_load_dwordx4 v21, s[8:11], s37 offen sc1 lds
v_fma_f32 v87, v87, v235, v231
v_mul_f32 v84, v84, v156
v_mul_f32 v85, v85, v157
v_mul_f32 v86, v86, v158
v_mul_f32 v87, v87, v159
v_exp_f32 v84, v84
v_exp_f32 v85, v85
s_add_u32 m0, s39, 7168
s_add_u32 s37, s37, s38
buffer_load_dwordx4 v21, s[8:11], s37 offen sc1 lds
v_exp_f32 v86, v86
v_exp_f32 v87, v87
v_mul_f32 v204, v156, v204
v_mul_f32 v205, v157, v205
v_mul_f32 v206, v158, v206
v_mul_f32 v207, v159, v207
s_waitcnt vmcnt(17)
s_barrier
s_add_u32 m0, s39, 32768
s_add_u32 s37, s37, s40
buffer_load_dwordx4 v21, s[8:11], s37 offen sc1 lds
v_fma_f32 v84, v84, v239, v239
v_fma_f32 v85, v85, v239, v239
v_fma_f32 v86, v86, v239, v239
v_fma_f32 v87, v87, v239, v239
v_rcp_f32 v84, v84
v_rcp_f32 v85, v85
v_rcp_f32 v86, v86
s_add_u32 m0, s39, 33792
s_add_u32 s37, s37, s38
buffer_load_dwordx4 v21, s[8:11], s37 offen sc1 lds
v_rcp_f32 v87, v87
v_mul_f32 v204, v204, v84
v_mul_f32 v205, v205, v85
v_mul_f32 v206, v206, v86
v_mul_f32 v207, v207, v87
v_cvt_pk_bf16_f32 v110, v204, v205
v_cvt_pk_bf16_f32 v111, v206, v207
s_add_u32 m0, s39, 34816
s_add_u32 s37, s37, s38
buffer_load_dwordx4 v21, s[8:11], s37 offen sc1 lds
v_mul_f32 v80, v172, v172
v_mul_f32 v81, v173, v173
v_mul_f32 v82, v174, v174
v_mul_f32 v83, v175, v175
v_fma_f32 v80, v80, v235, v231
s_add_u32 m0, s39, 35840
s_add_u32 s37, s37, s38
buffer_load_dwordx4 v21, s[8:11], s37 offen sc1 lds
v_fma_f32 v81, v81, v235, v231
v_fma_f32 v82, v82, v235, v231
v_fma_f32 v83, v83, v235, v231
v_mul_f32 v80, v80, v172
v_mul_f32 v81, v81, v173
v_mul_f32 v82, v82, v174
v_mul_f32 v83, v83, v175
s_add_u32 m0, s39, 36864
s_add_u32 s37, s37, s55
buffer_load_dwordx4 v21, s[8:11], s37 offen sc1 lds
v_exp_f32 v80, v80
v_exp_f32 v81, v81
v_exp_f32 v82, v82
v_exp_f32 v83, v83
v_mul_f32 v220, v172, v220
v_mul_f32 v221, v173, v221
v_mul_f32 v222, v174, v222
s_add_u32 m0, s39, 37888
s_add_u32 s37, s37, s38
buffer_load_dwordx4 v21, s[8:11], s37 offen sc1 lds
v_mul_f32 v223, v175, v223
v_fma_f32 v80, v80, v239, v239
v_fma_f32 v81, v81, v239, v239
v_fma_f32 v82, v82, v239, v239
v_fma_f32 v83, v83, v239, v239
v_rcp_f32 v80, v80
s_add_u32 m0, s39, 38912
s_add_u32 s37, s37, s38
buffer_load_dwordx4 v21, s[8:11], s37 offen sc1 lds
v_rcp_f32 v81, v81
v_rcp_f32 v82, v82
v_rcp_f32 v83, v83
v_mul_f32 v220, v220, v80
v_mul_f32 v221, v221, v81
v_mul_f32 v222, v222, v82
v_mul_f32 v223, v223, v83
s_add_u32 m0, s39, 39936
s_add_u32 s37, s37, s38
buffer_load_dwordx4 v21, s[8:11], s37 offen sc1 lds
v_cvt_pk_bf16_f32 v118, v220, v221
v_cvt_pk_bf16_f32 v119, v222, v223
s_nop 1
v_permlane32_swap_b32 v116, v118
v_permlane32_swap_b32 v117, v119
buffer_store_dwordx4 v[108:111], v27, s[24:27], 0 offen offset:768 sc1
buffer_store_dwordx4 v[116:119], v28, s[24:27], 0 offen offset:512 sc1
s_waitcnt vmcnt(19)
s_barrier
s_add_u32 m0, s39, 65536
s_add_u32 s37, s37, s40
buffer_load_dwordx4 v21, s[8:11], s37 offen sc1 lds
s_add_u32 m0, s39, 66560
s_add_u32 s37, s37, s38
buffer_load_dwordx4 v21, s[8:11], s37 offen sc1 lds
s_add_u32 m0, s39, 67584
s_add_u32 s37, s37, s38
buffer_load_dwordx4 v21, s[8:11], s37 offen sc1 lds
s_add_u32 m0, s39, 68608
s_add_u32 s37, s37, s38
buffer_load_dwordx4 v21, s[8:11], s37 offen sc1 lds
s_add_u32 m0, s39, 69632
s_add_u32 s37, s37, s55
buffer_load_dwordx4 v21, s[8:11], s37 offen sc1 lds
s_add_u32 m0, s39, 70656
s_add_u32 s37, s37, s38
buffer_load_dwordx4 v21, s[8:11], s37 offen sc1 lds
s_add_u32 m0, s39, 71680
s_add_u32 s37, s37, s38
buffer_load_dwordx4 v21, s[8:11], s37 offen sc1 lds
s_add_u32 m0, s39, 72704
s_add_u32 s37, s37, s38
buffer_load_dwordx4 v21, s[8:11], s37 offen sc1 lds
s_waitcnt vmcnt(8)
s_barrier
s_add_u32 m0, s39, 98304
s_add_u32 s37, s37, s40
buffer_load_dwordx4 v21, s[8:11], s37 offen sc1 lds
s_add_u32 m0, s39, 99328
s_add_u32 s37, s37, s38
buffer_load_dwordx4 v21, s[8:11], s37 offen sc1 lds
s_add_u32 m0, s39, 100352
s_add_u32 s37, s37, s38
buffer_load_dwordx4 v21, s[8:11], s37 offen sc1 lds
s_add_u32 m0, s39, 101376
s_add_u32 s37, s37, s38
buffer_load_dwordx4 v21, s[8:11], s37 offen sc1 lds
s_add_u32 m0, s39, 102400
s_add_u32 s37, s37, s55
buffer_load_dwordx4 v21, s[8:11], s37 offen sc1 lds
s_add_u32 m0, s39, 103424
s_add_u32 s37, s37, s38
buffer_load_dwordx4 v21, s[8:11], s37 offen sc1 lds
s_add_u32 m0, s39, 104448
s_add_u32 s37, s37, s38
buffer_load_dwordx4 v21, s[8:11], s37 offen sc1 lds
s_add_u32 m0, s39, 105472
s_add_u32 s37, s37, s38
buffer_load_dwordx4 v21, s[8:11], s37 offen sc1 lds
s_waitcnt vmcnt(18)
s_barrier
s_add_u32 m0, s39, 0
s_add_u32 s37, s37, s40
buffer_load_dwordx4 v21, s[8:11], s37 offen sc1 lds
s_add_u32 m0, s39, 1024
s_add_u32 s37, s37, s38
buffer_load_dwordx4 v21, s[8:11], s37 offen sc1 lds
s_add_u32 m0, s39, 2048
s_add_u32 s37, s37, s38
buffer_load_dwordx4 v21, s[8:11], s37 offen sc1 lds
s_add_u32 m0, s39, 3072
s_add_u32 s37, s37, s38
buffer_load_dwordx4 v21, s[8:11], s37 offen sc1 lds
s_add_u32 m0, s39, 4096
s_add_u32 s37, s37, s55
buffer_load_dwordx4 v21, s[8:11], s37 offen sc1 lds
s_add_u32 m0, s39, 5120
s_add_u32 s37, s37, s38
buffer_load_dwordx4 v21, s[8:11], s37 offen sc1 lds
s_add_u32 m0, s39, 6144
s_add_u32 s37, s37, s38
buffer_load_dwordx4 v21, s[8:11], s37 offen sc1 lds
s_add_u32 m0, s39, 7168
s_add_u32 s37, s37, s38
buffer_load_dwordx4 v21, s[8:11], s37 offen sc1 lds
s_waitcnt vmcnt(16)
s_barrier
s_add_u32 m0, s39, 32768
s_add_u32 s37, s37, s40
buffer_load_dwordx4 v21, s[8:11], s37 offen sc1 lds
s_add_u32 m0, s39, 33792
s_add_u32 s37, s37, s38
buffer_load_dwordx4 v21, s[8:11], s37 offen sc1 lds
s_add_u32 m0, s39, 34816
s_add_u32 s37, s37, s38
buffer_load_dwordx4 v21, s[8:11], s37 offen sc1 lds
s_add_u32 m0, s39, 35840
s_add_u32 s37, s37, s38
buffer_load_dwordx4 v21, s[8:11], s37 offen sc1 lds
s_add_u32 m0, s39, 36864
s_add_u32 s37, s37, s55
buffer_load_dwordx4 v21, s[8:11], s37 offen sc1 lds
s_add_u32 m0, s39, 37888
s_add_u32 s37, s37, s38
buffer_load_dwordx4 v21, s[8:11], s37 offen sc1 lds
s_add_u32 m0, s39, 38912
s_add_u32 s37, s37, s38
buffer_load_dwordx4 v21, s[8:11], s37 offen sc1 lds
s_add_u32 m0, s39, 39936
s_add_u32 s37, s37, s38
buffer_load_dwordx4 v21, s[8:11], s37 offen sc1 lds
s_waitcnt vmcnt(16)
s_barrier
s_add_u32 m0, s39, 65536
s_add_u32 s37, s37, s40
buffer_load_dwordx4 v21, s[8:11], s37 offen sc1 lds
s_add_u32 m0, s39, 66560
s_add_u32 s37, s37, s38
buffer_load_dwordx4 v21, s[8:11], s37 offen sc1 lds
s_add_u32 m0, s39, 67584
s_add_u32 s37, s37, s38
buffer_load_dwordx4 v21, s[8:11], s37 offen sc1 lds
s_add_u32 m0, s39, 68608
s_add_u32 s37, s37, s38
buffer_load_dwordx4 v21, s[8:11], s37 offen sc1 lds
s_add_u32 m0, s39, 69632
s_add_u32 s37, s37, s55
buffer_load_dwordx4 v21, s[8:11], s37 offen sc1 lds
s_add_u32 m0, s39, 70656
s_add_u32 s37, s37, s38
buffer_load_dwordx4 v21, s[8:11], s37 offen sc1 lds
s_add_u32 m0, s39, 71680
s_add_u32 s37, s37, s38
buffer_load_dwordx4 v21, s[8:11], s37 offen sc1 lds
s_add_u32 m0, s39, 72704
s_add_u32 s37, s37, s38
buffer_load_dwordx4 v21, s[8:11], s37 offen sc1 lds
s_waitcnt vmcnt(16)
s_barrier
s_add_u32 m0, s39, 98304
s_add_u32 s37, s37, s40
buffer_load_dwordx4 v21, s[8:11], s37 offen sc1 lds
s_add_u32 m0, s39, 99328
s_add_u32 s37, s37, s38
buffer_load_dwordx4 v21, s[8:11], s37 offen sc1 lds
s_add_u32 m0, s39, 100352
s_add_u32 s37, s37, s38
buffer_load_dwordx4 v21, s[8:11], s37 offen sc1 lds
s_add_u32 m0, s39, 101376
s_add_u32 s37, s37, s38
buffer_load_dwordx4 v21, s[8:11], s37 offen sc1 lds
s_add_u32 m0, s39, 102400
s_add_u32 s37, s37, s55
buffer_load_dwordx4 v21, s[8:11], s37 offen sc1 lds
s_add_u32 m0, s39, 103424
s_add_u32 s37, s37, s38
buffer_load_dwordx4 v21, s[8:11], s37 offen sc1 lds
s_add_u32 m0, s39, 104448
s_add_u32 s37, s37, s38
buffer_load_dwordx4 v21, s[8:11], s37 offen sc1 lds
s_add_u32 m0, s39, 105472
s_add_u32 s37, s37, s38
buffer_load_dwordx4 v21, s[8:11], s37 offen sc1 lds
s_waitcnt vmcnt(16)
s_barrier
s_cmp_eq_u32 s51, 2
s_cbranch_scc1 LW4_159
s_mul_i32 s40, s53, 98304
s_add_u32 m0, s39, 0
s_add_u32 s37, s40, 524288
buffer_load_dwordx4 v21, s[8:11], s37 offen sc1 lds
s_add_u32 m0, s39, 1024
s_add_u32 s37, s40, 525312
buffer_load_dwordx4 v21, s[8:11], s37 offen sc1 lds
s_add_u32 m0, s39, 2048
s_add_u32 s37, s40, 526336
buffer_load_dwordx4 v21, s[8:11], s37 offen sc1 lds
s_add_u32 m0, s39, 3072
s_add_u32 s37, s40, 527360
buffer_load_dwordx4 v21, s[8:11], s37 offen sc1 lds
s_add_u32 m0, s39, 4096
s_add_u32 s37, s40, 528384
buffer_load_dwordx4 v21, s[8:11], s37 offen sc1 lds
s_add_u32 m0, s39, 5120
s_add_u32 s37, s40, 529408
buffer_load_dwordx4 v21, s[8:11], s37 offen sc1 lds
s_add_u32 m0, s39, 6144
s_add_u32 s37, s40, 530432
buffer_load_dwordx4 v21, s[8:11], s37 offen sc1 lds
s_add_u32 m0, s39, 7168
s_add_u32 s37, s40, 531456
buffer_load_dwordx4 v21, s[8:11], s37 offen sc1 lds
s_waitcnt vmcnt(16)
s_barrier
s_add_u32 m0, s39, 32768
s_add_u32 s37, s40, 540672
buffer_load_dwordx4 v21, s[8:11], s37 offen sc1 lds
s_add_u32 m0, s39, 33792
s_add_u32 s37, s40, 541696
buffer_load_dwordx4 v21, s[8:11], s37 offen sc1 lds
s_add_u32 m0, s39, 34816
s_add_u32 s37, s40, 542720
buffer_load_dwordx4 v21, s[8:11], s37 offen sc1 lds
s_add_u32 m0, s39, 35840
s_add_u32 s37, s40, 543744
buffer_load_dwordx4 v21, s[8:11], s37 offen sc1 lds
s_add_u32 m0, s39, 36864
s_add_u32 s37, s40, 544768
buffer_load_dwordx4 v21, s[8:11], s37 offen sc1 lds
s_add_u32 m0, s39, 37888
s_add_u32 s37, s40, 545792
buffer_load_dwordx4 v21, s[8:11], s37 offen sc1 lds
s_add_u32 m0, s39, 38912
s_add_u32 s37, s40, 546816
buffer_load_dwordx4 v21, s[8:11], s37 offen sc1 lds
s_add_u32 m0, s39, 39936
s_add_u32 s37, s40, 547840
buffer_load_dwordx4 v21, s[8:11], s37 offen sc1 lds
s_waitcnt vmcnt(16)
s_barrier
s_add_u32 m0, s39, 65536
s_add_u32 s37, s40, 557056
buffer_load_dwordx4 v21, s[8:11], s37 offen sc1 lds
s_add_u32 m0, s39, 66560
s_add_u32 s37, s40, 558080
buffer_load_dwordx4 v21, s[8:11], s37 offen sc1 lds
s_add_u32 m0, s39, 67584
s_add_u32 s37, s40, 559104
buffer_load_dwordx4 v21, s[8:11], s37 offen sc1 lds
s_add_u32 m0, s39, 68608
s_add_u32 s37, s40, 560128
buffer_load_dwordx4 v21, s[8:11], s37 offen sc1 lds
s_add_u32 m0, s39, 69632
s_add_u32 s37, s40, 561152
buffer_load_dwordx4 v21, s[8:11], s37 offen sc1 lds
s_add_u32 m0, s39, 70656
s_add_u32 s37, s40, 562176
buffer_load_dwordx4 v21, s[8:11], s37 offen sc1 lds
s_add_u32 m0, s39, 71680
s_add_u32 s37, s40, 563200
buffer_load_dwordx4 v21, s[8:11], s37 offen sc1 lds
s_add_u32 m0, s39, 72704
s_add_u32 s37, s40, 564224
buffer_load_dwordx4 v21, s[8:11], s37 offen sc1 lds
s_waitcnt vmcnt(16)
s_barrier
s_add_u32 m0, s39, 98304
s_add_u32 s37, s40, 573440
buffer_load_dwordx4 v21, s[8:11], s37 offen sc1 lds
s_add_u32 m0, s39, 99328
s_add_u32 s37, s40, 574464
buffer_load_dwordx4 v21, s[8:11], s37 offen sc1 lds
s_add_u32 m0, s39, 100352
s_add_u32 s37, s40, 575488
buffer_load_dwordx4 v21, s[8:11], s37 offen sc1 lds
s_add_u32 m0, s39, 101376
s_add_u32 s37, s40, 576512
buffer_load_dwordx4 v21, s[8:11], s37 offen sc1 lds
s_add_u32 m0, s39, 102400
s_add_u32 s37, s40, 577536
buffer_load_dwordx4 v21, s[8:11], s37 offen sc1 lds
s_add_u32 m0, s39, 103424
s_add_u32 s37, s40, 578560
buffer_load_dwordx4 v21, s[8:11], s37 offen sc1 lds
s_add_u32 m0, s39, 104448
s_add_u32 s37, s40, 579584
buffer_load_dwordx4 v21, s[8:11], s37 offen sc1 lds
s_add_u32 m0, s39, 105472
s_add_u32 s37, s40, 580608
buffer_load_dwordx4 v21, s[8:11], s37 offen sc1 lds
s_waitcnt vmcnt(16)
s_barrier
s_add_u32 m0, s39, 0
s_add_u32 s37, s40, 589824
buffer_load_dwordx4 v21, s[8:11], s37 offen sc1 lds
s_add_u32 m0, s39, 1024
s_add_u32 s37, s40, 590848
buffer_load_dwordx4 v21, s[8:11], s37 offen sc1 lds
s_add_u32 m0, s39, 2048
s_add_u32 s37, s40, 591872
buffer_load_dwordx4 v21, s[8:11], s37 offen sc1 lds
s_add_u32 m0, s39, 3072
s_add_u32 s37, s40, 592896
buffer_load_dwordx4 v21, s[8:11], s37 offen sc1 lds
s_add_u32 m0, s39, 4096
s_add_u32 s37, s40, 593920
buffer_load_dwordx4 v21, s[8:11], s37 offen sc1 lds
s_add_u32 m0, s39, 5120
s_add_u32 s37, s40, 594944
buffer_load_dwordx4 v21, s[8:11], s37 offen sc1 lds
s_add_u32 m0, s39, 6144
s_add_u32 s37, s40, 595968
buffer_load_dwordx4 v21, s[8:11], s37 offen sc1 lds
s_add_u32 m0, s39, 7168
s_add_u32 s37, s40, 596992
buffer_load_dwordx4 v21, s[8:11], s37 offen sc1 lds
s_waitcnt vmcnt(16)
s_barrier
s_add_u32 m0, s39, 32768
s_add_u32 s37, s40, 606208
buffer_load_dwordx4 v21, s[8:11], s37 offen sc1 lds
s_add_u32 m0, s39, 33792
s_add_u32 s37, s40, 607232
buffer_load_dwordx4 v21, s[8:11], s37 offen sc1 lds
s_add_u32 m0, s39, 34816
s_add_u32 s37, s40, 608256
buffer_load_dwordx4 v21, s[8:11], s37 offen sc1 lds
s_add_u32 m0, s39, 35840
s_add_u32 s37, s40, 609280
buffer_load_dwordx4 v21, s[8:11], s37 offen sc1 lds
s_add_u32 m0, s39, 36864
s_add_u32 s37, s40, 610304
buffer_load_dwordx4 v21, s[8:11], s37 offen sc1 lds
s_add_u32 m0, s39, 37888
s_add_u32 s37, s40, 611328
buffer_load_dwordx4 v21, s[8:11], s37 offen sc1 lds
s_add_u32 m0, s39, 38912
s_add_u32 s37, s40, 612352
buffer_load_dwordx4 v21, s[8:11], s37 offen sc1 lds
s_add_u32 m0, s39, 39936
s_add_u32 s37, s40, 613376
buffer_load_dwordx4 v21, s[8:11], s37 offen sc1 lds
s_waitcnt vmcnt(16)
s_barrier
s_add_u32 m0, s39, 65536
s_mov_b32 s37, 720896
buffer_load_dwordx4 v21, s[8:11], s37 offen sc1 lds
s_add_u32 m0, s39, 66560
s_mov_b32 s37, 721920
buffer_load_dwordx4 v21, s[8:11], s37 offen sc1 lds
s_add_u32 m0, s39, 67584
s_mov_b32 s37, 722944
buffer_load_dwordx4 v21, s[8:11], s37 offen sc1 lds
s_add_u32 m0, s39, 68608
s_mov_b32 s37, 723968
buffer_load_dwordx4 v21, s[8:11], s37 offen sc1 lds
s_add_u32 m0, s39, 69632
s_mov_b32 s37, 724992
buffer_load_dwordx4 v21, s[8:11], s37 offen sc1 lds
s_add_u32 m0, s39, 70656
s_mov_b32 s37, 726016
buffer_load_dwordx4 v21, s[8:11], s37 offen sc1 lds
s_add_u32 m0, s39, 71680
s_mov_b32 s37, 727040
buffer_load_dwordx4 v21, s[8:11], s37 offen sc1 lds
s_add_u32 m0, s39, 72704
s_mov_b32 s37, 728064
buffer_load_dwordx4 v21, s[8:11], s37 offen sc1 lds
s_waitcnt vmcnt(16)
s_barrier
s_add_u32 m0, s39, 98304
s_mov_b32 s37, 737280
buffer_load_dwordx4 v21, s[8:11], s37 offen sc1 lds
s_add_u32 m0, s39, 99328
s_mov_b32 s37, 738304
buffer_load_dwordx4 v21, s[8:11], s37 offen sc1 lds
s_add_u32 m0, s39, 100352
s_mov_b32 s37, 739328
buffer_load_dwordx4 v21, s[8:11], s37 offen sc1 lds
s_add_u32 m0, s39, 101376
s_mov_b32 s37, 740352
buffer_load_dwordx4 v21, s[8:11], s37 offen sc1 lds
s_add_u32 m0, s39, 102400
s_mov_b32 s37, 741376
buffer_load_dwordx4 v21, s[8:11], s37 offen sc1 lds
s_add_u32 m0, s39, 103424
s_mov_b32 s37, 742400
buffer_load_dwordx4 v21, s[8:11], s37 offen sc1 lds
s_add_u32 m0, s39, 104448
s_mov_b32 s37, 743424
buffer_load_dwordx4 v21, s[8:11], s37 offen sc1 lds
s_add_u32 m0, s39, 105472
s_mov_b32 s37, 744448
buffer_load_dwordx4 v21, s[8:11], s37 offen sc1 lds
s_waitcnt vmcnt(16)
s_barrier
s_add_u32 m0, s39, 0
s_mov_b32 s37, 753664
buffer_load_dwordx4 v21, s[8:11], s37 offen sc1 lds
s_add_u32 m0, s39, 1024
s_mov_b32 s37, 754688
buffer_load_dwordx4 v21, s[8:11], s37 offen sc1 lds
s_add_u32 m0, s39, 2048
s_mov_b32 s37, 755712
buffer_load_dwordx4 v21, s[8:11], s37 offen sc1 lds
s_add_u32 m0, s39, 3072
s_mov_b32 s37, 756736
buffer_load_dwordx4 v21, s[8:11], s37 offen sc1 lds
s_add_u32 m0, s39, 4096
s_mov_b32 s37, 757760
buffer_load_dwordx4 v21, s[8:11], s37 offen sc1 lds
s_add_u32 m0, s39, 5120
s_mov_b32 s37, 758784
buffer_load_dwordx4 v21, s[8:11], s37 offen sc1 lds
s_add_u32 m0, s39, 6144
s_mov_b32 s37, 759808
buffer_load_dwordx4 v21, s[8:11], s37 offen sc1 lds
s_add_u32 m0, s39, 7168
s_mov_b32 s37, 760832
buffer_load_dwordx4 v21, s[8:11], s37 offen sc1 lds
s_waitcnt vmcnt(16)
s_barrier
s_add_u32 m0, s39, 32768
s_mov_b32 s37, 770048
buffer_load_dwordx4 v21, s[8:11], s37 offen sc1 lds
s_add_u32 m0, s39, 33792
s_mov_b32 s37, 771072
buffer_load_dwordx4 v21, s[8:11], s37 offen sc1 lds
s_add_u32 m0, s39, 34816
s_mov_b32 s37, 772096
buffer_load_dwordx4 v21, s[8:11], s37 offen sc1 lds
s_add_u32 m0, s39, 35840
s_mov_b32 s37, 773120
buffer_load_dwordx4 v21, s[8:11], s37 offen sc1 lds
s_add_u32 m0, s39, 36864
s_mov_b32 s37, 774144
buffer_load_dwordx4 v21, s[8:11], s37 offen sc1 lds
s_add_u32 m0, s39, 37888
s_mov_b32 s37, 775168
buffer_load_dwordx4 v21, s[8:11], s37 offen sc1 lds
s_add_u32 m0, s39, 38912
s_mov_b32 s37, 776192
buffer_load_dwordx4 v21, s[8:11], s37 offen sc1 lds
s_add_u32 m0, s39, 39936
s_mov_b32 s37, 777216
buffer_load_dwordx4 v21, s[8:11], s37 offen sc1 lds
s_waitcnt vmcnt(16)
s_barrier
s_add_u32 m0, s39, 65536
s_mov_b32 s37, 786432
buffer_load_dwordx4 v21, s[8:11], s37 offen sc1 lds
s_add_u32 m0, s39, 66560
s_mov_b32 s37, 787456
buffer_load_dwordx4 v21, s[8:11], s37 offen sc1 lds
s_add_u32 m0, s39, 67584
s_mov_b32 s37, 788480
buffer_load_dwordx4 v21, s[8:11], s37 offen sc1 lds
s_add_u32 m0, s39, 68608
s_mov_b32 s37, 789504
buffer_load_dwordx4 v21, s[8:11], s37 offen sc1 lds
s_add_u32 m0, s39, 69632
s_mov_b32 s37, 790528
buffer_load_dwordx4 v21, s[8:11], s37 offen sc1 lds
s_add_u32 m0, s39, 70656
s_mov_b32 s37, 791552
buffer_load_dwordx4 v21, s[8:11], s37 offen sc1 lds
s_add_u32 m0, s39, 71680
s_mov_b32 s37, 792576
buffer_load_dwordx4 v21, s[8:11], s37 offen sc1 lds
s_add_u32 m0, s39, 72704
s_mov_b32 s37, 793600
buffer_load_dwordx4 v21, s[8:11], s37 offen sc1 lds
s_waitcnt vmcnt(16)
s_barrier
s_add_u32 m0, s39, 98304
s_mov_b32 s37, 802816
buffer_load_dwordx4 v21, s[8:11], s37 offen sc1 lds
s_add_u32 m0, s39, 99328
s_mov_b32 s37, 803840
buffer_load_dwordx4 v21, s[8:11], s37 offen sc1 lds
s_add_u32 m0, s39, 100352
s_mov_b32 s37, 804864
buffer_load_dwordx4 v21, s[8:11], s37 offen sc1 lds
s_add_u32 m0, s39, 101376
s_mov_b32 s37, 805888
buffer_load_dwordx4 v21, s[8:11], s37 offen sc1 lds
s_add_u32 m0, s39, 102400
s_mov_b32 s37, 806912
buffer_load_dwordx4 v21, s[8:11], s37 offen sc1 lds
s_add_u32 m0, s39, 103424
s_mov_b32 s37, 807936
buffer_load_dwordx4 v21, s[8:11], s37 offen sc1 lds
s_add_u32 m0, s39, 104448
s_mov_b32 s37, 808960
buffer_load_dwordx4 v21, s[8:11], s37 offen sc1 lds
s_add_u32 m0, s39, 105472
s_mov_b32 s37, 809984
buffer_load_dwordx4 v21, s[8:11], s37 offen sc1 lds
s_waitcnt vmcnt(16)
s_barrier
s_add_u32 m0, s39, 0
s_mov_b32 s37, 819200
buffer_load_dwordx4 v21, s[8:11], s37 offen sc1 lds
s_add_u32 m0, s39, 1024
s_mov_b32 s37, 820224
buffer_load_dwordx4 v21, s[8:11], s37 offen sc1 lds
s_add_u32 m0, s39, 2048
s_mov_b32 s37, 821248
buffer_load_dwordx4 v21, s[8:11], s37 offen sc1 lds
s_add_u32 m0, s39, 3072
s_mov_b32 s37, 822272
buffer_load_dwordx4 v21, s[8:11], s37 offen sc1 lds
s_add_u32 m0, s39, 4096
s_mov_b32 s37, 823296
buffer_load_dwordx4 v21, s[8:11], s37 offen sc1 lds
s_add_u32 m0, s39, 5120
s_mov_b32 s37, 824320
buffer_load_dwordx4 v21, s[8:11], s37 offen sc1 lds
s_add_u32 m0, s39, 6144
s_mov_b32 s37, 825344
buffer_load_dwordx4 v21, s[8:11], s37 offen sc1 lds
s_add_u32 m0, s39, 7168
s_mov_b32 s37, 826368
buffer_load_dwordx4 v21, s[8:11], s37 offen sc1 lds
s_waitcnt vmcnt(16)
s_barrier
s_add_u32 m0, s39, 32768
s_mov_b32 s37, 835584
buffer_load_dwordx4 v21, s[8:11], s37 offen sc1 lds
s_add_u32 m0, s39, 33792
s_mov_b32 s37, 836608
buffer_load_dwordx4 v21, s[8:11], s37 offen sc1 lds
s_add_u32 m0, s39, 34816
s_mov_b32 s37, 837632
buffer_load_dwordx4 v21, s[8:11], s37 offen sc1 lds
s_add_u32 m0, s39, 35840
s_mov_b32 s37, 838656
buffer_load_dwordx4 v21, s[8:11], s37 offen sc1 lds
s_add_u32 m0, s39, 36864
s_mov_b32 s37, 839680
buffer_load_dwordx4 v21, s[8:11], s37 offen sc1 lds
s_add_u32 m0, s39, 37888
s_mov_b32 s37, 840704
buffer_load_dwordx4 v21, s[8:11], s37 offen sc1 lds
s_add_u32 m0, s39, 38912
s_mov_b32 s37, 841728
buffer_load_dwordx4 v21, s[8:11], s37 offen sc1 lds
s_add_u32 m0, s39, 39936
s_mov_b32 s37, 842752
buffer_load_dwordx4 v21, s[8:11], s37 offen sc1 lds
s_waitcnt vmcnt(16)
s_barrier
s_add_u32 m0, s39, 65536
s_mov_b32 s37, 851968
buffer_load_dwordx4 v21, s[8:11], s37 offen sc1 lds
s_add_u32 m0, s39, 66560
s_mov_b32 s37, 852992
buffer_load_dwordx4 v21, s[8:11], s37 offen sc1 lds
s_add_u32 m0, s39, 67584
s_mov_b32 s37, 854016
buffer_load_dwordx4 v21, s[8:11], s37 offen sc1 lds
s_add_u32 m0, s39, 68608
s_mov_b32 s37, 855040
buffer_load_dwordx4 v21, s[8:11], s37 offen sc1 lds
s_add_u32 m0, s39, 69632
s_mov_b32 s37, 856064
buffer_load_dwordx4 v21, s[8:11], s37 offen sc1 lds
s_add_u32 m0, s39, 70656
s_mov_b32 s37, 857088
buffer_load_dwordx4 v21, s[8:11], s37 offen sc1 lds
s_add_u32 m0, s39, 71680
s_mov_b32 s37, 858112
buffer_load_dwordx4 v21, s[8:11], s37 offen sc1 lds
s_add_u32 m0, s39, 72704
s_mov_b32 s37, 859136
buffer_load_dwordx4 v21, s[8:11], s37 offen sc1 lds
s_waitcnt vmcnt(16)
s_barrier
s_add_u32 m0, s39, 98304
s_mov_b32 s37, 868352
buffer_load_dwordx4 v21, s[8:11], s37 offen sc1 lds
s_add_u32 m0, s39, 99328
s_mov_b32 s37, 869376
buffer_load_dwordx4 v21, s[8:11], s37 offen sc1 lds
s_add_u32 m0, s39, 100352
s_mov_b32 s37, 870400
buffer_load_dwordx4 v21, s[8:11], s37 offen sc1 lds
s_add_u32 m0, s39, 101376
s_mov_b32 s37, 871424
buffer_load_dwordx4 v21, s[8:11], s37 offen sc1 lds
s_add_u32 m0, s39, 102400
s_mov_b32 s37, 872448
buffer_load_dwordx4 v21, s[8:11], s37 offen sc1 lds
s_add_u32 m0, s39, 103424
s_mov_b32 s37, 873472
buffer_load_dwordx4 v21, s[8:11], s37 offen sc1 lds
s_add_u32 m0, s39, 104448
s_mov_b32 s37, 874496
buffer_load_dwordx4 v21, s[8:11], s37 offen sc1 lds
s_add_u32 m0, s39, 105472
s_mov_b32 s37, 875520
buffer_load_dwordx4 v21, s[8:11], s37 offen sc1 lds
s_waitcnt vmcnt(16)
s_barrier
s_add_u32 m0, s39, 0
s_mov_b32 s37, 884736
buffer_load_dwordx4 v21, s[8:11], s37 offen sc1 lds
s_add_u32 m0, s39, 1024
s_mov_b32 s37, 885760
buffer_load_dwordx4 v21, s[8:11], s37 offen sc1 lds
s_add_u32 m0, s39, 2048
s_mov_b32 s37, 886784
buffer_load_dwordx4 v21, s[8:11], s37 offen sc1 lds
s_add_u32 m0, s39, 3072
s_mov_b32 s37, 887808
buffer_load_dwordx4 v21, s[8:11], s37 offen sc1 lds
s_add_u32 m0, s39, 4096
s_mov_b32 s37, 888832
buffer_load_dwordx4 v21, s[8:11], s37 offen sc1 lds
s_add_u32 m0, s39, 5120
s_mov_b32 s37, 889856
buffer_load_dwordx4 v21, s[8:11], s37 offen sc1 lds
s_add_u32 m0, s39, 6144
s_mov_b32 s37, 890880
buffer_load_dwordx4 v21, s[8:11], s37 offen sc1 lds
s_add_u32 m0, s39, 7168
s_mov_b32 s37, 891904
buffer_load_dwordx4 v21, s[8:11], s37 offen sc1 lds
s_waitcnt vmcnt(16)
s_barrier
s_add_u32 m0, s39, 32768
s_mov_b32 s37, 901120
buffer_load_dwordx4 v21, s[8:11], s37 offen sc1 lds
s_add_u32 m0, s39, 33792
s_mov_b32 s37, 902144
buffer_load_dwordx4 v21, s[8:11], s37 offen sc1 lds
s_add_u32 m0, s39, 34816
s_mov_b32 s37, 903168
buffer_load_dwordx4 v21, s[8:11], s37 offen sc1 lds
s_add_u32 m0, s39, 35840
s_mov_b32 s37, 904192
buffer_load_dwordx4 v21, s[8:11], s37 offen sc1 lds
s_add_u32 m0, s39, 36864
s_mov_b32 s37, 905216
buffer_load_dwordx4 v21, s[8:11], s37 offen sc1 lds
s_add_u32 m0, s39, 37888
s_mov_b32 s37, 906240
buffer_load_dwordx4 v21, s[8:11], s37 offen sc1 lds
s_add_u32 m0, s39, 38912
s_mov_b32 s37, 907264
buffer_load_dwordx4 v21, s[8:11], s37 offen sc1 lds
s_add_u32 m0, s39, 39936
s_mov_b32 s37, 908288
buffer_load_dwordx4 v21, s[8:11], s37 offen sc1 lds
s_waitcnt vmcnt(16)
s_barrier
s_waitcnt vmcnt(8)
s_barrier
s_waitcnt vmcnt(0)
s_barrier
s_branch Ldone_1
.p2align 6
Lw_163:
s_branch Lr_164
s_nop 0
.p2align 3
LW4_159:
s_mul_i32 s40, s53, 983040
s_add_u32 m0, s39, 0
s_add_u32 s37, s40, 4194304
buffer_load_dwordx4 v21, s[8:11], s37 offen sc1 lds
s_add_u32 m0, s39, 1024
s_add_u32 s37, s40, 4210688
buffer_load_dwordx4 v21, s[8:11], s37 offen sc1 lds
s_add_u32 m0, s39, 2048
s_add_u32 s37, s40, 4227072
buffer_load_dwordx4 v21, s[8:11], s37 offen sc1 lds
s_add_u32 m0, s39, 3072
s_add_u32 s37, s40, 4243456
buffer_load_dwordx4 v21, s[8:11], s37 offen sc1 lds
s_add_u32 m0, s39, 4096
s_add_u32 s37, s40, 4292608
buffer_load_dwordx4 v21, s[8:11], s37 offen sc1 lds
s_add_u32 m0, s39, 5120
s_add_u32 s37, s40, 4308992
buffer_load_dwordx4 v21, s[8:11], s37 offen sc1 lds
s_add_u32 m0, s39, 6144
s_add_u32 s37, s40, 4325376
buffer_load_dwordx4 v21, s[8:11], s37 offen sc1 lds
s_add_u32 m0, s39, 7168
s_add_u32 s37, s40, 4341760
buffer_load_dwordx4 v21, s[8:11], s37 offen sc1 lds
s_waitcnt vmcnt(16)
s_barrier
s_add_u32 m0, s39, 32768
s_add_u32 s37, s40, 4259840
buffer_load_dwordx4 v21, s[8:11], s37 offen sc1 lds
s_add_u32 m0, s39, 33792
s_add_u32 s37, s40, 4358144
buffer_load_dwordx4 v21, s[8:11], s37 offen sc1 lds
s_add_u32 m0, s39, 34816
s_add_u32 s37, s40, 4276224
buffer_load_dwordx4 v21, s[8:11], s37 offen sc1 lds
s_add_u32 m0, s39, 35840
s_add_u32 s37, s40, 4374528
buffer_load_dwordx4 v21, s[8:11], s37 offen sc1 lds
s_add_u32 m0, s39, 36864
s_add_u32 s37, s40, 4390912
buffer_load_dwordx4 v21, s[8:11], s37 offen sc1 lds
s_add_u32 m0, s39, 37888
s_add_u32 s37, s40, 4407296
buffer_load_dwordx4 v21, s[8:11], s37 offen sc1 lds
s_add_u32 m0, s39, 38912
s_add_u32 s37, s40, 4423680
buffer_load_dwordx4 v21, s[8:11], s37 offen sc1 lds
s_add_u32 m0, s39, 39936
s_add_u32 s37, s40, 4440064
buffer_load_dwordx4 v21, s[8:11], s37 offen sc1 lds
s_waitcnt vmcnt(16)
s_barrier
s_add_u32 m0, s39, 65536
s_add_u32 s37, s40, 4489216
buffer_load_dwordx4 v21, s[8:11], s37 offen sc1 lds
s_add_u32 m0, s39, 66560
s_add_u32 s37, s40, 4505600
buffer_load_dwordx4 v21, s[8:11], s37 offen sc1 lds
s_add_u32 m0, s39, 67584
s_add_u32 s37, s40, 4521984
buffer_load_dwordx4 v21, s[8:11], s37 offen sc1 lds
s_add_u32 m0, s39, 68608
s_add_u32 s37, s40, 4538368
buffer_load_dwordx4 v21, s[8:11], s37 offen sc1 lds
s_add_u32 m0, s39, 69632
s_add_u32 s37, s40, 4456448
buffer_load_dwordx4 v21, s[8:11], s37 offen sc1 lds
s_add_u32 m0, s39, 70656
s_add_u32 s37, s40, 4554752
buffer_load_dwordx4 v21, s[8:11], s37 offen sc1 lds
s_add_u32 m0, s39, 71680
s_add_u32 s37, s40, 4472832
buffer_load_dwordx4 v21, s[8:11], s37 offen sc1 lds
s_add_u32 m0, s39, 72704
s_add_u32 s37, s40, 4571136
buffer_load_dwordx4 v21, s[8:11], s37 offen sc1 lds
s_waitcnt vmcnt(16)
s_barrier
s_add_u32 m0, s39, 98304
s_add_u32 s37, s40, 4784128
buffer_load_dwordx4 v21, s[8:11], s37 offen sc1 lds
s_add_u32 m0, s39, 99328
s_add_u32 s37, s40, 4800512
buffer_load_dwordx4 v21, s[8:11], s37 offen sc1 lds
s_add_u32 m0, s39, 100352
s_add_u32 s37, s40, 4816896
buffer_load_dwordx4 v21, s[8:11], s37 offen sc1 lds
s_add_u32 m0, s39, 101376
s_add_u32 s37, s40, 4833280
buffer_load_dwordx4 v21, s[8:11], s37 offen sc1 lds
s_add_u32 m0, s39, 102400
s_add_u32 s37, s40, 4882432
buffer_load_dwordx4 v21, s[8:11], s37 offen sc1 lds
s_add_u32 m0, s39, 103424
s_add_u32 s37, s40, 4898816
buffer_load_dwordx4 v21, s[8:11], s37 offen sc1 lds
s_add_u32 m0, s39, 104448
s_add_u32 s37, s40, 4915200
buffer_load_dwordx4 v21, s[8:11], s37 offen sc1 lds
s_add_u32 m0, s39, 105472
s_add_u32 s37, s40, 4931584
buffer_load_dwordx4 v21, s[8:11], s37 offen sc1 lds
s_waitcnt vmcnt(16)
s_barrier
s_add_u32 m0, s39, 0
s_add_u32 s37, s40, 4849664
buffer_load_dwordx4 v21, s[8:11], s37 offen sc1 lds
s_add_u32 m0, s39, 1024
s_add_u32 s37, s40, 4947968
buffer_load_dwordx4 v21, s[8:11], s37 offen sc1 lds
s_add_u32 m0, s39, 2048
s_add_u32 s37, s40, 4866048
buffer_load_dwordx4 v21, s[8:11], s37 offen sc1 lds
s_add_u32 m0, s39, 3072
s_add_u32 s37, s40, 4964352
buffer_load_dwordx4 v21, s[8:11], s37 offen sc1 lds
s_add_u32 m0, s39, 4096
s_add_u32 s37, s40, 4980736
buffer_load_dwordx4 v21, s[8:11], s37 offen sc1 lds
s_add_u32 m0, s39, 5120
s_add_u32 s37, s40, 4997120
buffer_load_dwordx4 v21, s[8:11], s37 offen sc1 lds
s_add_u32 m0, s39, 6144
s_add_u32 s37, s40, 5013504
buffer_load_dwordx4 v21, s[8:11], s37 offen sc1 lds
s_add_u32 m0, s39, 7168
s_add_u32 s37, s40, 5029888
buffer_load_dwordx4 v21, s[8:11], s37 offen sc1 lds
s_waitcnt vmcnt(16)
s_barrier
s_add_u32 m0, s39, 32768
s_add_u32 s37, s40, 5079040
buffer_load_dwordx4 v21, s[8:11], s37 offen sc1 lds
s_add_u32 m0, s39, 33792
s_add_u32 s37, s40, 5095424
buffer_load_dwordx4 v21, s[8:11], s37 offen sc1 lds
s_add_u32 m0, s39, 34816
s_add_u32 s37, s40, 5111808
buffer_load_dwordx4 v21, s[8:11], s37 offen sc1 lds
s_add_u32 m0, s39, 35840
s_add_u32 s37, s40, 5128192
buffer_load_dwordx4 v21, s[8:11], s37 offen sc1 lds
s_add_u32 m0, s39, 36864
s_add_u32 s37, s40, 5046272
buffer_load_dwordx4 v21, s[8:11], s37 offen sc1 lds
s_add_u32 m0, s39, 37888
s_add_u32 s37, s40, 5144576
buffer_load_dwordx4 v21, s[8:11], s37 offen sc1 lds
s_add_u32 m0, s39, 38912
s_add_u32 s37, s40, 5062656
buffer_load_dwordx4 v21, s[8:11], s37 offen sc1 lds
s_add_u32 m0, s39, 39936
s_add_u32 s37, s40, 5160960
buffer_load_dwordx4 v21, s[8:11], s37 offen sc1 lds
s_waitcnt vmcnt(16)
s_barrier
s_add_u32 m0, s39, 65536
s_mov_b32 s37, 6160384
buffer_load_dwordx4 v21, s[8:11], s37 offen sc1 lds
s_add_u32 m0, s39, 66560
s_mov_b32 s37, 6176768
buffer_load_dwordx4 v21, s[8:11], s37 offen sc1 lds
s_add_u32 m0, s39, 67584
s_mov_b32 s37, 6193152
buffer_load_dwordx4 v21, s[8:11], s37 offen sc1 lds
s_add_u32 m0, s39, 68608
s_mov_b32 s37, 6209536
buffer_load_dwordx4 v21, s[8:11], s37 offen sc1 lds
s_add_u32 m0, s39, 69632
s_mov_b32 s37, 6258688
buffer_load_dwordx4 v21, s[8:11], s37 offen sc1 lds
s_add_u32 m0, s39, 70656
s_mov_b32 s37, 6275072
buffer_load_dwordx4 v21, s[8:11], s37 offen sc1 lds
s_add_u32 m0, s39, 71680
s_mov_b32 s37, 6291456
buffer_load_dwordx4 v21, s[8:11], s37 offen sc1 lds
s_add_u32 m0, s39, 72704
s_mov_b32 s37, 6307840
buffer_load_dwordx4 v21, s[8:11], s37 offen sc1 lds
s_waitcnt vmcnt(16)
s_barrier
s_add_u32 m0, s39, 98304
s_mov_b32 s37, 6225920
buffer_load_dwordx4 v21, s[8:11], s37 offen sc1 lds
s_add_u32 m0, s39, 99328
s_mov_b32 s37, 6324224
buffer_load_dwordx4 v21, s[8:11], s37 offen sc1 lds
s_add_u32 m0, s39, 100352
s_mov_b32 s37, 6242304
buffer_load_dwordx4 v21, s[8:11], s37 offen sc1 lds
s_add_u32 m0, s39, 101376
s_mov_b32 s37, 6340608
buffer_load_dwordx4 v21, s[8:11], s37 offen sc1 lds
s_add_u32 m0, s39, 102400
s_mov_b32 s37, 6356992
buffer_load_dwordx4 v21, s[8:11], s37 offen sc1 lds
s_add_u32 m0, s39, 103424
s_mov_b32 s37, 6373376
buffer_load_dwordx4 v21, s[8:11], s37 offen sc1 lds
s_add_u32 m0, s39, 104448
s_mov_b32 s37, 6389760
buffer_load_dwordx4 v21, s[8:11], s37 offen sc1 lds
s_add_u32 m0, s39, 105472
s_mov_b32 s37, 6406144
buffer_load_dwordx4 v21, s[8:11], s37 offen sc1 lds
s_waitcnt vmcnt(16)
s_barrier
s_add_u32 m0, s39, 0
s_mov_b32 s37, 6455296
buffer_load_dwordx4 v21, s[8:11], s37 offen sc1 lds
s_add_u32 m0, s39, 1024
s_mov_b32 s37, 6471680
buffer_load_dwordx4 v21, s[8:11], s37 offen sc1 lds
s_add_u32 m0, s39, 2048
s_mov_b32 s37, 6488064
buffer_load_dwordx4 v21, s[8:11], s37 offen sc1 lds
s_add_u32 m0, s39, 3072
s_mov_b32 s37, 6504448
buffer_load_dwordx4 v21, s[8:11], s37 offen sc1 lds
s_add_u32 m0, s39, 4096
s_mov_b32 s37, 6422528
buffer_load_dwordx4 v21, s[8:11], s37 offen sc1 lds
s_add_u32 m0, s39, 5120
s_mov_b32 s37, 6520832
buffer_load_dwordx4 v21, s[8:11], s37 offen sc1 lds
s_add_u32 m0, s39, 6144
s_mov_b32 s37, 6438912
buffer_load_dwordx4 v21, s[8:11], s37 offen sc1 lds
s_add_u32 m0, s39, 7168
s_mov_b32 s37, 6537216
buffer_load_dwordx4 v21, s[8:11], s37 offen sc1 lds
s_waitcnt vmcnt(16)
s_barrier
s_add_u32 m0, s39, 32768
s_mov_b32 s37, 6946816
buffer_load_dwordx4 v21, s[8:11], s37 offen sc1 lds
s_add_u32 m0, s39, 33792
s_mov_b32 s37, 6963200
buffer_load_dwordx4 v21, s[8:11], s37 offen sc1 lds
s_add_u32 m0, s39, 34816
s_mov_b32 s37, 6979584
buffer_load_dwordx4 v21, s[8:11], s37 offen sc1 lds
s_add_u32 m0, s39, 35840
s_mov_b32 s37, 6995968
buffer_load_dwordx4 v21, s[8:11], s37 offen sc1 lds
s_add_u32 m0, s39, 36864
s_mov_b32 s37, 7045120
buffer_load_dwordx4 v21, s[8:11], s37 offen sc1 lds
s_add_u32 m0, s39, 37888
s_mov_b32 s37, 7061504
buffer_load_dwordx4 v21, s[8:11], s37 offen sc1 lds
s_add_u32 m0, s39, 38912
s_mov_b32 s37, 7077888
buffer_load_dwordx4 v21, s[8:11], s37 offen sc1 lds
s_add_u32 m0, s39, 39936
s_mov_b32 s37, 7094272
buffer_load_dwordx4 v21, s[8:11], s37 offen sc1 lds
s_waitcnt vmcnt(16)
s_barrier
s_add_u32 m0, s39, 65536
s_mov_b32 s37, 7012352
buffer_load_dwordx4 v21, s[8:11], s37 offen sc1 lds
s_add_u32 m0, s39, 66560
s_mov_b32 s37, 7110656
buffer_load_dwordx4 v21, s[8:11], s37 offen sc1 lds
s_add_u32 m0, s39, 67584
s_mov_b32 s37, 7028736
buffer_load_dwordx4 v21, s[8:11], s37 offen sc1 lds
s_add_u32 m0, s39, 68608
s_mov_b32 s37, 7127040
buffer_load_dwordx4 v21, s[8:11], s37 offen sc1 lds
s_add_u32 m0, s39, 69632
s_mov_b32 s37, 7143424
buffer_load_dwordx4 v21, s[8:11], s37 offen sc1 lds
s_add_u32 m0, s39, 70656
s_mov_b32 s37, 7159808
buffer_load_dwordx4 v21, s[8:11], s37 offen sc1 lds
s_add_u32 m0, s39, 71680
s_mov_b32 s37, 7176192
buffer_load_dwordx4 v21, s[8:11], s37 offen sc1 lds
s_add_u32 m0, s39, 72704
s_mov_b32 s37, 7192576
buffer_load_dwordx4 v21, s[8:11], s37 offen sc1 lds
s_waitcnt vmcnt(16)
s_barrier
s_add_u32 m0, s39, 98304
s_mov_b32 s37, 7241728
buffer_load_dwordx4 v21, s[8:11], s37 offen sc1 lds
s_add_u32 m0, s39, 99328
s_mov_b32 s37, 7258112
buffer_load_dwordx4 v21, s[8:11], s37 offen sc1 lds
s_add_u32 m0, s39, 100352
s_mov_b32 s37, 7274496
buffer_load_dwordx4 v21, s[8:11], s37 offen sc1 lds
s_add_u32 m0, s39, 101376
s_mov_b32 s37, 7290880
buffer_load_dwordx4 v21, s[8:11], s37 offen sc1 lds
s_add_u32 m0, s39, 102400
s_mov_b32 s37, 7208960
buffer_load_dwordx4 v21, s[8:11], s37 offen sc1 lds
s_add_u32 m0, s39, 103424
s_mov_b32 s37, 7307264
buffer_load_dwordx4 v21, s[8:11], s37 offen sc1 lds
s_add_u32 m0, s39, 104448
s_mov_b32 s37, 7225344
buffer_load_dwordx4 v21, s[8:11], s37 offen sc1 lds
s_add_u32 m0, s39, 105472
s_mov_b32 s37, 7323648
buffer_load_dwordx4 v21, s[8:11], s37 offen sc1 lds
s_waitcnt vmcnt(16)
s_barrier
s_add_u32 m0, s39, 0
s_mov_b32 s37, 4587520
buffer_load_dwordx4 v21, s[8:11], s37 offen sc1 lds
s_add_u32 m0, s39, 1024
s_mov_b32 s37, 4603904
buffer_load_dwordx4 v21, s[8:11], s37 offen sc1 lds
s_add_u32 m0, s39, 2048
s_mov_b32 s37, 4620288
buffer_load_dwordx4 v21, s[8:11], s37 offen sc1 lds
s_add_u32 m0, s39, 3072
s_mov_b32 s37, 4636672
buffer_load_dwordx4 v21, s[8:11], s37 offen sc1 lds
s_add_u32 m0, s39, 4096
s_mov_b32 s37, 4685824
buffer_load_dwordx4 v21, s[8:11], s37 offen sc1 lds
s_add_u32 m0, s39, 5120
s_mov_b32 s37, 4702208
buffer_load_dwordx4 v21, s[8:11], s37 offen sc1 lds
s_add_u32 m0, s39, 6144
s_mov_b32 s37, 4718592
buffer_load_dwordx4 v21, s[8:11], s37 offen sc1 lds
s_add_u32 m0, s39, 7168
s_mov_b32 s37, 4734976
buffer_load_dwordx4 v21, s[8:11], s37 offen sc1 lds
s_waitcnt vmcnt(16)
s_barrier
s_add_u32 m0, s39, 32768
s_mov_b32 s37, 4653056
buffer_load_dwordx4 v21, s[8:11], s37 offen sc1 lds
s_add_u32 m0, s39, 33792
s_mov_b32 s37, 4751360
buffer_load_dwordx4 v21, s[8:11], s37 offen sc1 lds
s_add_u32 m0, s39, 34816
s_mov_b32 s37, 4669440
buffer_load_dwordx4 v21, s[8:11], s37 offen sc1 lds
s_add_u32 m0, s39, 35840
s_mov_b32 s37, 4767744
buffer_load_dwordx4 v21, s[8:11], s37 offen sc1 lds
s_add_u32 m0, s39, 36864
s_mov_b32 s37, 5570560
buffer_load_dwordx4 v21, s[8:11], s37 offen sc1 lds
s_add_u32 m0, s39, 37888
s_mov_b32 s37, 5586944
buffer_load_dwordx4 v21, s[8:11], s37 offen sc1 lds
s_add_u32 m0, s39, 38912
s_mov_b32 s37, 5603328
buffer_load_dwordx4 v21, s[8:11], s37 offen sc1 lds
s_add_u32 m0, s39, 39936
s_mov_b32 s37, 5619712
buffer_load_dwordx4 v21, s[8:11], s37 offen sc1 lds
s_waitcnt vmcnt(16)
s_barrier
s_add_u32 m0, s39, 65536
s_mov_b32 s37, 5668864
buffer_load_dwordx4 v21, s[8:11], s37 offen sc1 lds
s_add_u32 m0, s39, 66560
s_mov_b32 s37, 5685248
buffer_load_dwordx4 v21, s[8:11], s37 offen sc1 lds
s_add_u32 m0, s39, 67584
s_mov_b32 s37, 5701632
buffer_load_dwordx4 v21, s[8:11], s37 offen sc1 lds
s_add_u32 m0, s39, 68608
s_mov_b32 s37, 5718016
buffer_load_dwordx4 v21, s[8:11], s37 offen sc1 lds
s_add_u32 m0, s39, 69632
s_mov_b32 s37, 5636096
buffer_load_dwordx4 v21, s[8:11], s37 offen sc1 lds
s_add_u32 m0, s39, 70656
s_mov_b32 s37, 5734400
buffer_load_dwordx4 v21, s[8:11], s37 offen sc1 lds
s_add_u32 m0, s39, 71680
s_mov_b32 s37, 5652480
buffer_load_dwordx4 v21, s[8:11], s37 offen sc1 lds
s_add_u32 m0, s39, 72704
s_mov_b32 s37, 5750784
buffer_load_dwordx4 v21, s[8:11], s37 offen sc1 lds
s_waitcnt vmcnt(16)
s_barrier
s_add_u32 m0, s39, 98304
s_mov_b32 s37, 6553600
buffer_load_dwordx4 v21, s[8:11], s37 offen sc1 lds
s_add_u32 m0, s39, 99328
s_mov_b32 s37, 6569984
buffer_load_dwordx4 v21, s[8:11], s37 offen sc1 lds
s_add_u32 m0, s39, 100352
s_mov_b32 s37, 6586368
buffer_load_dwordx4 v21, s[8:11], s37 offen sc1 lds
s_add_u32 m0, s39, 101376
s_mov_b32 s37, 6602752
buffer_load_dwordx4 v21, s[8:11], s37 offen sc1 lds
s_add_u32 m0, s39, 102400
s_mov_b32 s37, 6651904
buffer_load_dwordx4 v21, s[8:11], s37 offen sc1 lds
s_add_u32 m0, s39, 103424
s_mov_b32 s37, 6668288
buffer_load_dwordx4 v21, s[8:11], s37 offen sc1 lds
s_add_u32 m0, s39, 104448
s_mov_b32 s37, 6684672
buffer_load_dwordx4 v21, s[8:11], s37 offen sc1 lds
s_add_u32 m0, s39, 105472
s_mov_b32 s37, 6701056
buffer_load_dwordx4 v21, s[8:11], s37 offen sc1 lds
s_waitcnt vmcnt(16)
s_barrier
s_add_u32 m0, s39, 0
s_mov_b32 s37, 6619136
buffer_load_dwordx4 v21, s[8:11], s37 offen sc1 lds
s_add_u32 m0, s39, 1024
s_mov_b32 s37, 6717440
buffer_load_dwordx4 v21, s[8:11], s37 offen sc1 lds
s_add_u32 m0, s39, 2048
s_mov_b32 s37, 6635520
buffer_load_dwordx4 v21, s[8:11], s37 offen sc1 lds
s_add_u32 m0, s39, 3072
s_mov_b32 s37, 6733824
buffer_load_dwordx4 v21, s[8:11], s37 offen sc1 lds
s_add_u32 m0, s39, 4096
s_mov_b32 s37, 6750208
buffer_load_dwordx4 v21, s[8:11], s37 offen sc1 lds
s_add_u32 m0, s39, 5120
s_mov_b32 s37, 6766592
buffer_load_dwordx4 v21, s[8:11], s37 offen sc1 lds
s_add_u32 m0, s39, 6144
s_mov_b32 s37, 6782976
buffer_load_dwordx4 v21, s[8:11], s37 offen sc1 lds
s_add_u32 m0, s39, 7168
s_mov_b32 s37, 6799360
buffer_load_dwordx4 v21, s[8:11], s37 offen sc1 lds
s_waitcnt vmcnt(16)
s_barrier
s_add_u32 m0, s39, 32768
s_mov_b32 s37, 6848512
buffer_load_dwordx4 v21, s[8:11], s37 offen sc1 lds
s_add_u32 m0, s39, 33792
s_mov_b32 s37, 6864896
buffer_load_dwordx4 v21, s[8:11], s37 offen sc1 lds
s_add_u32 m0, s39, 34816
s_mov_b32 s37, 6881280
buffer_load_dwordx4 v21, s[8:11], s37 offen sc1 lds
s_add_u32 m0, s39, 35840
s_mov_b32 s37, 6897664
buffer_load_dwordx4 v21, s[8:11], s37 offen sc1 lds
s_add_u32 m0, s39, 36864
s_mov_b32 s37, 6815744
buffer_load_dwordx4 v21, s[8:11], s37 offen sc1 lds
s_add_u32 m0, s39, 37888
s_mov_b32 s37, 6914048
buffer_load_dwordx4 v21, s[8:11], s37 offen sc1 lds
s_add_u32 m0, s39, 38912
s_mov_b32 s37, 6832128
buffer_load_dwordx4 v21, s[8:11], s37 offen sc1 lds
s_add_u32 m0, s39, 39936
s_mov_b32 s37, 6930432
buffer_load_dwordx4 v21, s[8:11], s37 offen sc1 lds
s_waitcnt vmcnt(16)
s_barrier
s_waitcnt vmcnt(8)
s_barrier
s_waitcnt vmcnt(0)
s_barrier
s_branch Ldone_1
.p2align 6
Lw_130:
s_branch Lr_131
s_nop 0
.p2align 3
L7b_158:
v_mfma_f32_16x16x32_bf16 v[128:131], v[96:99], v[80:83], v[128:131]
v_mfma_f32_16x16x32_bf16 v[132:135], v[96:99], v[84:87], v[132:135]
v_mfma_f32_16x16x32_bf16 v[136:139], v[96:99], v[88:91], v[136:139]
v_mfma_f32_16x16x32_bf16 v[140:143], v[96:99], v[92:95], v[140:143]
v_mfma_f32_16x16x32_bf16 v[188:191], v[108:111], v[92:95], v[188:191]
v_mfma_f32_16x16x32_bf16 v[184:187], v[108:111], v[88:91], v[184:187]
v_mfma_f32_16x16x32_bf16 v[180:183], v[108:111], v[84:87], v[180:183]
v_mfma_f32_16x16x32_bf16 v[176:179], v[108:111], v[80:83], v[176:179]
v_mfma_f32_16x16x32_bf16 v[144:147], v[100:103], v[80:83], v[144:147]
v_mfma_f32_16x16x32_bf16 v[148:151], v[100:103], v[84:87], v[148:151]
v_mfma_f32_16x16x32_bf16 v[152:155], v[100:103], v[88:91], v[152:155]
v_mfma_f32_16x16x32_bf16 v[156:159], v[100:103], v[92:95], v[156:159]
v_mfma_f32_16x16x32_bf16 v[204:207], v[112:115], v[92:95], v[204:207]
v_mfma_f32_16x16x32_bf16 v[200:203], v[112:115], v[88:91], v[200:203]
v_mfma_f32_16x16x32_bf16 v[196:199], v[112:115], v[84:87], v[196:199]
v_mfma_f32_16x16x32_bf16 v[192:195], v[112:115], v[80:83], v[192:195]
v_mfma_f32_16x16x32_bf16 v[160:163], v[104:107], v[80:83], v[160:163]
v_mfma_f32_16x16x32_bf16 v[164:167], v[104:107], v[84:87], v[164:167]
v_mfma_f32_16x16x32_bf16 v[168:171], v[104:107], v[88:91], v[168:171]
v_mfma_f32_16x16x32_bf16 v[172:175], v[104:107], v[92:95], v[172:175]
v_mfma_f32_16x16x32_bf16 v[220:223], v[116:119], v[92:95], v[220:223]
v_mfma_f32_16x16x32_bf16 v[216:219], v[116:119], v[88:91], v[216:219]
v_mfma_f32_16x16x32_bf16 v[212:215], v[116:119], v[84:87], v[212:215]
v_mfma_f32_16x16x32_bf16 v[208:211], v[116:119], v[80:83], v[208:211]
s_mul_i32 s43, s38, 32
s_add_u32 s37, s37, s43
s_setprio 0
s_barrier
s_mov_b32 s80, s60
s_mov_b32 s81, s61
s_mov_b32 s82, 7340032
s_mov_b32 s83, 0x20000
v_and_b32 v29, 31, v1
v_lshlrev_b32 v29, 11, v29
s_and_b32 s43, s35, 8
s_or_b32 s43, s43, 3
s_lshl_b32 s43, s43, 7
v_add_u32 v29, s43, v29
s_add_u32 s37, s37, s54
s_add_u32 m0, s39, 65536
s_add_u32 s37, s37, s40
buffer_load_dwordx4 v21, s[8:11], s37 offen sc1 lds
v_mul_f32 v80, v128, v128
v_mul_f32 v81, v129, v129
v_mul_f32 v82, v130, v130
v_mul_f32 v83, v131, v131
v_fma_f32 v80, v80, v232, v228
v_fma_f32 v81, v81, v232, v228
v_fma_f32 v82, v82, v232, v228
s_add_u32 m0, s39, 66560
s_add_u32 s37, s37, s38
buffer_load_dwordx4 v21, s[8:11], s37 offen sc1 lds
v_fma_f32 v83, v83, v232, v228
v_mul_f32 v80, v80, v128
v_mul_f32 v81, v81, v129
v_mul_f32 v82, v82, v130
v_mul_f32 v83, v83, v131
v_exp_f32 v80, v80
s_add_u32 m0, s39, 67584
s_add_u32 s37, s37, s38
buffer_load_dwordx4 v21, s[8:11], s37 offen sc1 lds
v_exp_f32 v81, v81
v_exp_f32 v82, v82
v_exp_f32 v83, v83
v_mul_f32 v176, v128, v176
v_mul_f32 v177, v129, v177
v_mul_f32 v178, v130, v178
v_mul_f32 v179, v131, v179
s_add_u32 m0, s39, 68608
s_add_u32 s37, s37, s38
buffer_load_dwordx4 v21, s[8:11], s37 offen sc1 lds
v_fma_f32 v80, v80, v236, v236
v_fma_f32 v81, v81, v236, v236
v_fma_f32 v82, v82, v236, v236
v_fma_f32 v83, v83, v236, v236
v_rcp_f32 v80, v80
v_rcp_f32 v81, v81
s_add_u32 m0, s39, 69632
s_add_u32 s37, s37, s55
buffer_load_dwordx4 v21, s[8:11], s37 offen sc1 lds
v_rcp_f32 v82, v82
v_rcp_f32 v83, v83
v_mul_f32 v176, v176, v80
v_mul_f32 v177, v177, v81
v_mul_f32 v178, v178, v82
v_mul_f32 v179, v179, v83
v_cvt_pk_bf16_f32 v96, v176, v177
s_add_u32 m0, s39, 70656
s_add_u32 s37, s37, s38
buffer_load_dwordx4 v21, s[8:11], s37 offen sc1 lds
v_cvt_pk_bf16_f32 v97, v178, v179
v_mul_f32 v84, v144, v144
v_mul_f32 v85, v145, v145
v_mul_f32 v86, v146, v146
v_mul_f32 v87, v147, v147
v_fma_f32 v84, v84, v232, v228
s_add_u32 m0, s39, 71680
s_add_u32 s37, s37, s38
buffer_load_dwordx4 v21, s[8:11], s37 offen sc1 lds
v_fma_f32 v85, v85, v232, v228
v_fma_f32 v86, v86, v232, v228
v_fma_f32 v87, v87, v232, v228
v_mul_f32 v84, v84, v144
v_mul_f32 v85, v85, v145
v_mul_f32 v86, v86, v146
v_mul_f32 v87, v87, v147
s_add_u32 m0, s39, 72704
s_add_u32 s37, s37, s38
buffer_load_dwordx4 v21, s[8:11], s37 offen sc1 lds
v_exp_f32 v84, v84
v_exp_f32 v85, v85
v_exp_f32 v86, v86
v_exp_f32 v87, v87
v_mul_f32 v192, v144, v192
v_mul_f32 v193, v145, v193
s_barrier
s_lshr_b32 s44, s2, 3
s_lshl_b32 s44, s44, 17
s_add_u32 s43, s44, 65536
buffer_load_dword v30, v29, s[80:83], s43 offen
s_add_u32 m0, s39, 98304
s_add_u32 s37, s37, s40
buffer_load_dwordx4 v21, s[8:11], s37 offen sc1 lds
v_mul_f32 v194, v146, v194
v_mul_f32 v195, v147, v195
v_fma_f32 v84, v84, v236, v236
v_fma_f32 v85, v85, v236, v236
v_fma_f32 v86, v86, v236, v236
v_fma_f32 v87, v87, v236, v236
v_rcp_f32 v84, v84
s_add_u32 m0, s39, 99328
s_add_u32 s37, s37, s38
buffer_load_dwordx4 v21, s[8:11], s37 offen sc1 lds
v_rcp_f32 v85, v85
v_rcp_f32 v86, v86
v_rcp_f32 v87, v87
v_mul_f32 v192, v192, v84
v_mul_f32 v193, v193, v85
v_mul_f32 v194, v194, v86
v_mul_f32 v195, v195, v87
s_add_u32 m0, s39, 100352
s_add_u32 s37, s37, s38
buffer_load_dwordx4 v21, s[8:11], s37 offen sc1 lds
v_cvt_pk_bf16_f32 v98, v192, v193
v_cvt_pk_bf16_f32 v99, v194, v195
v_mul_f32 v80, v160, v160
v_mul_f32 v81, v161, v161
v_mul_f32 v82, v162, v162
s_add_u32 m0, s39, 101376
s_add_u32 s37, s37, s38
buffer_load_dwordx4 v21, s[8:11], s37 offen sc1 lds
v_mul_f32 v83, v163, v163
v_fma_f32 v80, v80, v232, v228
v_fma_f32 v81, v81, v232, v228
v_fma_f32 v82, v82, v232, v228
v_fma_f32 v83, v83, v232, v228
v_mul_f32 v80, v80, v160
v_mul_f32 v81, v81, v161
s_add_u32 m0, s39, 102400
s_add_u32 s37, s37, s55
buffer_load_dwordx4 v21, s[8:11], s37 offen sc1 lds
v_mul_f32 v82, v82, v162
v_mul_f32 v83, v83, v163
v_exp_f32 v80, v80
v_exp_f32 v81, v81
v_exp_f32 v82, v82
v_exp_f32 v83, v83
v_mul_f32 v208, v160, v208
s_add_u32 m0, s39, 103424
s_add_u32 s37, s37, s38
buffer_load_dwordx4 v21, s[8:11], s37 offen sc1 lds
v_mul_f32 v209, v161, v209
v_mul_f32 v210, v162, v210
v_mul_f32 v211, v163, v211
v_fma_f32 v80, v80, v236, v236
v_fma_f32 v81, v81, v236, v236
v_fma_f32 v82, v82, v236, v236
s_add_u32 m0, s39, 104448
s_add_u32 s37, s37, s38
buffer_load_dwordx4 v21, s[8:11], s37 offen sc1 lds
v_fma_f32 v83, v83, v236, v236
v_rcp_f32 v80, v80
v_rcp_f32 v81, v81
v_rcp_f32 v82, v82
v_rcp_f32 v83, v83
v_mul_f32 v208, v208, v80
v_mul_f32 v209, v209, v81
s_add_u32 m0, s39, 105472
s_add_u32 s37, s37, s38
buffer_load_dwordx4 v21, s[8:11], s37 offen sc1 lds
v_mul_f32 v210, v210, v82
v_mul_f32 v211, v211, v83
v_cvt_pk_bf16_f32 v112, v208, v209
v_cvt_pk_bf16_f32 v113, v210, v211
v_mul_f32 v80, v132, v132
v_mul_f32 v81, v133, v133
buffer_store_dwordx4 v[96:99], v27, s[24:27], 0 offen offset:0 sc1
s_barrier
s_add_u32 m0, s39, 0
s_add_u32 s37, s37, s40
buffer_load_dwordx4 v21, s[8:11], s37 offen sc1 lds
v_mul_f32 v82, v134, v134
v_mul_f32 v83, v135, v135
v_fma_f32 v80, v80, v233, v229
v_fma_f32 v81, v81, v233, v229
v_fma_f32 v82, v82, v233, v229
v_fma_f32 v83, v83, v233, v229
v_mul_f32 v80, v80, v132
s_add_u32 m0, s39, 1024
s_add_u32 s37, s37, s38
buffer_load_dwordx4 v21, s[8:11], s37 offen sc1 lds
v_mul_f32 v81, v81, v133
v_mul_f32 v82, v82, v134
v_mul_f32 v83, v83, v135
v_exp_f32 v80, v80
v_exp_f32 v81, v81
v_exp_f32 v82, v82
s_add_u32 m0, s39, 2048
s_add_u32 s37, s37, s38
buffer_load_dwordx4 v21, s[8:11], s37 offen sc1 lds
v_exp_f32 v83, v83
v_mul_f32 v180, v132, v180
v_mul_f32 v181, v133, v181
v_mul_f32 v182, v134, v182
v_mul_f32 v183, v135, v183
v_fma_f32 v80, v80, v237, v237
v_fma_f32 v81, v81, v237, v237
s_add_u32 m0, s39, 3072
s_add_u32 s37, s37, s38
buffer_load_dwordx4 v21, s[8:11], s37 offen sc1 lds
v_fma_f32 v82, v82, v237, v237
v_fma_f32 v83, v83, v237, v237
v_rcp_f32 v80, v80
v_rcp_f32 v81, v81
v_rcp_f32 v82, v82
v_rcp_f32 v83, v83
s_add_u32 m0, s39, 4096
s_add_u32 s37, s37, s55
buffer_load_dwordx4 v21, s[8:11], s37 offen sc1 lds
v_mul_f32 v180, v180, v80
v_mul_f32 v181, v181, v81
v_mul_f32 v182, v182, v82
v_mul_f32 v183, v183, v83
v_cvt_pk_bf16_f32 v100, v180, v181
v_cvt_pk_bf16_f32 v101, v182, v183
v_mul_f32 v84, v148, v148
s_add_u32 m0, s39, 5120
s_add_u32 s37, s37, s38
buffer_load_dwordx4 v21, s[8:11], s37 offen sc1 lds
v_mul_f32 v85, v149, v149
v_mul_f32 v86, v150, v150
v_mul_f32 v87, v151, v151
v_fma_f32 v84, v84, v233, v229
v_fma_f32 v85, v85, v233, v229
v_fma_f32 v86, v86, v233, v229
s_add_u32 m0, s39, 6144
s_add_u32 s37, s37, s38
buffer_load_dwordx4 v21, s[8:11], s37 offen sc1 lds
v_fma_f32 v87, v87, v233, v229
v_mul_f32 v84, v84, v148
v_mul_f32 v85, v85, v149
v_mul_f32 v86, v86, v150
v_mul_f32 v87, v87, v151
v_exp_f32 v84, v84
v_exp_f32 v85, v85
s_add_u32 m0, s39, 7168
s_add_u32 s37, s37, s38
buffer_load_dwordx4 v21, s[8:11], s37 offen sc1 lds
v_exp_f32 v86, v86
v_exp_f32 v87, v87
v_mul_f32 v196, v148, v196
v_mul_f32 v197, v149, v197
v_mul_f32 v198, v150, v198
v_mul_f32 v199, v151, v199
s_waitcnt vmcnt(18)
s_barrier
s_add_u32 s43, s34, 48
s_lshl_b32 s43, s43, 7
v_mov_b32 v10, s43
v_mov_b32 v12, 16
buffer_load_dword v11, v10, s[56:59], 0 offen sc1
s_add_u32 m0, s39, 32768
s_add_u32 s37, s37, s40
buffer_load_dwordx4 v21, s[8:11], s37 offen sc1 lds
v_fma_f32 v84, v84, v237, v237
v_fma_f32 v85, v85, v237, v237
v_fma_f32 v86, v86, v237, v237
v_fma_f32 v87, v87, v237, v237
v_rcp_f32 v84, v84
v_rcp_f32 v85, v85
v_rcp_f32 v86, v86
s_add_u32 m0, s39, 33792
s_add_u32 s37, s37, s38
buffer_load_dwordx4 v21, s[8:11], s37 offen sc1 lds
v_rcp_f32 v87, v87
v_mul_f32 v196, v196, v84
v_mul_f32 v197, v197, v85
v_mul_f32 v198, v198, v86
v_mul_f32 v199, v199, v87
v_cvt_pk_bf16_f32 v102, v196, v197
v_cvt_pk_bf16_f32 v103, v198, v199
s_add_u32 m0, s39, 34816
s_add_u32 s37, s37, s38
buffer_load_dwordx4 v21, s[8:11], s37 offen sc1 lds
v_mul_f32 v80, v164, v164
v_mul_f32 v81, v165, v165
v_mul_f32 v82, v166, v166
v_mul_f32 v83, v167, v167
v_fma_f32 v80, v80, v233, v229
s_add_u32 m0, s39, 35840
s_add_u32 s37, s37, s38
buffer_load_dwordx4 v21, s[8:11], s37 offen sc1 lds
v_fma_f32 v81, v81, v233, v229
v_fma_f32 v82, v82, v233, v229
v_fma_f32 v83, v83, v233, v229
v_mul_f32 v80, v80, v164
v_mul_f32 v81, v81, v165
v_mul_f32 v82, v82, v166
v_mul_f32 v83, v83, v167
s_add_u32 m0, s39, 36864
s_add_u32 s37, s37, s55
buffer_load_dwordx4 v21, s[8:11], s37 offen sc1 lds
v_exp_f32 v80, v80
v_exp_f32 v81, v81
v_exp_f32 v82, v82
v_exp_f32 v83, v83
v_mul_f32 v212, v164, v212
v_mul_f32 v213, v165, v213
v_mul_f32 v214, v166, v214
s_add_u32 m0, s39, 37888
s_add_u32 s37, s37, s38
buffer_load_dwordx4 v21, s[8:11], s37 offen sc1 lds
v_mul_f32 v215, v167, v215
v_fma_f32 v80, v80, v237, v237
v_fma_f32 v81, v81, v237, v237
v_fma_f32 v82, v82, v237, v237
v_fma_f32 v83, v83, v237, v237
v_rcp_f32 v80, v80
s_add_u32 m0, s39, 38912
s_add_u32 s37, s37, s38
buffer_load_dwordx4 v21, s[8:11], s37 offen sc1 lds
v_rcp_f32 v81, v81
v_rcp_f32 v82, v82
v_rcp_f32 v83, v83
v_mul_f32 v212, v212, v80
v_mul_f32 v213, v213, v81
v_mul_f32 v214, v214, v82
v_mul_f32 v215, v215, v83
s_add_u32 m0, s39, 39936
s_add_u32 s37, s37, s38
buffer_load_dwordx4 v21, s[8:11], s37 offen sc1 lds
v_cvt_pk_bf16_f32 v114, v212, v213
v_cvt_pk_bf16_f32 v115, v214, v215
s_nop 1
v_permlane32_swap_b32 v112, v114
v_permlane32_swap_b32 v113, v115
buffer_store_dwordx4 v[100:103], v27, s[24:27], 0 offen offset:256 sc1
buffer_store_dwordx4 v[112:115], v28, s[24:27], 0 offen offset:0 sc1
s_waitcnt vmcnt(20)
s_barrier
s_add_u32 m0, s39, 65536
s_add_u32 s37, s37, s40
buffer_load_dwordx4 v21, s[8:11], s37 offen sc1 lds
v_mul_f32 v80, v136, v136
v_mul_f32 v81, v137, v137
v_mul_f32 v82, v138, v138
v_mul_f32 v83, v139, v139
v_fma_f32 v80, v80, v234, v230
v_fma_f32 v81, v81, v234, v230
v_fma_f32 v82, v82, v234, v230
s_add_u32 m0, s39, 66560
s_add_u32 s37, s37, s38
buffer_load_dwordx4 v21, s[8:11], s37 offen sc1 lds
v_fma_f32 v83, v83, v234, v230
v_mul_f32 v80, v80, v136
v_mul_f32 v81, v81, v137
v_mul_f32 v82, v82, v138
v_mul_f32 v83, v83, v139
v_exp_f32 v80, v80
s_add_u32 m0, s39, 67584
s_add_u32 s37, s37, s38
buffer_load_dwordx4 v21, s[8:11], s37 offen sc1 lds
v_exp_f32 v81, v81
v_exp_f32 v82, v82
v_exp_f32 v83, v83
v_mul_f32 v184, v136, v184
v_mul_f32 v185, v137, v185
v_mul_f32 v186, v138, v186
v_mul_f32 v187, v139, v187
s_add_u32 m0, s39, 68608
s_add_u32 s37, s37, s38
buffer_load_dwordx4 v21, s[8:11], s37 offen sc1 lds
v_fma_f32 v80, v80, v238, v238
v_fma_f32 v81, v81, v238, v238
v_fma_f32 v82, v82, v238, v238
v_fma_f32 v83, v83, v238, v238
v_rcp_f32 v80, v80
v_rcp_f32 v81, v81
s_add_u32 m0, s39, 69632
s_add_u32 s37, s37, s55
buffer_load_dwordx4 v21, s[8:11], s37 offen sc1 lds
v_rcp_f32 v82, v82
v_rcp_f32 v83, v83
v_mul_f32 v184, v184, v80
v_mul_f32 v185, v185, v81
v_mul_f32 v186, v186, v82
v_mul_f32 v187, v187, v83
v_cvt_pk_bf16_f32 v104, v184, v185
s_add_u32 m0, s39, 70656
s_add_u32 s37, s37, s38
buffer_load_dwordx4 v21, s[8:11], s37 offen sc1 lds
v_cvt_pk_bf16_f32 v105, v186, v187
v_mul_f32 v84, v152, v152
v_mul_f32 v85, v153, v153
v_mul_f32 v86, v154, v154
v_mul_f32 v87, v155, v155
v_fma_f32 v84, v84, v234, v230
s_add_u32 m0, s39, 71680
s_add_u32 s37, s37, s38
buffer_load_dwordx4 v21, s[8:11], s37 offen sc1 lds
v_fma_f32 v85, v85, v234, v230
v_fma_f32 v86, v86, v234, v230
v_fma_f32 v87, v87, v234, v230
v_mul_f32 v84, v84, v152
v_mul_f32 v85, v85, v153
v_mul_f32 v86, v86, v154
v_mul_f32 v87, v87, v155
s_add_u32 m0, s39, 72704
s_add_u32 s37, s37, s38
buffer_load_dwordx4 v21, s[8:11], s37 offen sc1 lds
v_exp_f32 v84, v84
v_exp_f32 v85, v85
v_exp_f32 v86, v86
v_exp_f32 v87, v87
v_mul_f32 v200, v152, v200
v_mul_f32 v201, v153, v201
s_waitcnt vmcnt(19)
s_barrier
s_add_u32 m0, s39, 98304
s_add_u32 s37, s37, s40
buffer_load_dwordx4 v21, s[8:11], s37 offen sc1 lds
v_mul_f32 v202, v154, v202
v_mul_f32 v203, v155, v203
v_fma_f32 v84, v84, v238, v238
v_fma_f32 v85, v85, v238, v238
v_fma_f32 v86, v86, v238, v238
v_fma_f32 v87, v87, v238, v238
v_rcp_f32 v84, v84
s_add_u32 m0, s39, 99328
s_add_u32 s37, s37, s38
buffer_load_dwordx4 v21, s[8:11], s37 offen sc1 lds
v_rcp_f32 v85, v85
v_rcp_f32 v86, v86
v_rcp_f32 v87, v87
v_mul_f32 v200, v200, v84
v_mul_f32 v201, v201, v85
v_mul_f32 v202, v202, v86
v_mul_f32 v203, v203, v87
s_add_u32 m0, s39, 100352
s_add_u32 s37, s37, s38
buffer_load_dwordx4 v21, s[8:11], s37 offen sc1 lds
v_cvt_pk_bf16_f32 v106, v200, v201
v_cvt_pk_bf16_f32 v107, v202, v203
v_mul_f32 v80, v168, v168
v_mul_f32 v81, v169, v169
v_mul_f32 v82, v170, v170
s_add_u32 m0, s39, 101376
s_add_u32 s37, s37, s38
buffer_load_dwordx4 v21, s[8:11], s37 offen sc1 lds
v_mul_f32 v83, v171, v171
v_fma_f32 v80, v80, v234, v230
v_fma_f32 v81, v81, v234, v230
v_fma_f32 v82, v82, v234, v230
v_fma_f32 v83, v83, v234, v230
v_mul_f32 v80, v80, v168
v_mul_f32 v81, v81, v169
s_add_u32 m0, s39, 102400
s_add_u32 s37, s37, s55
buffer_load_dwordx4 v21, s[8:11], s37 offen sc1 lds
v_mul_f32 v82, v82, v170
v_mul_f32 v83, v83, v171
v_exp_f32 v80, v80
v_exp_f32 v81, v81
v_exp_f32 v82, v82
v_exp_f32 v83, v83
v_mul_f32 v216, v168, v216
s_add_u32 m0, s39, 103424
s_add_u32 s37, s37, s38
buffer_load_dwordx4 v21, s[8:11], s37 offen sc1 lds
v_mul_f32 v217, v169, v217
v_mul_f32 v218, v170, v218
v_mul_f32 v219, v171, v219
v_fma_f32 v80, v80, v238, v238
v_fma_f32 v81, v81, v238, v238
v_fma_f32 v82, v82, v238, v238
s_add_u32 m0, s39, 104448
s_add_u32 s37, s37, s38
buffer_load_dwordx4 v21, s[8:11], s37 offen sc1 lds
v_fma_f32 v83, v83, v238, v238
v_rcp_f32 v80, v80
v_rcp_f32 v81, v81
v_rcp_f32 v82, v82
v_rcp_f32 v83, v83
v_mul_f32 v216, v216, v80
v_mul_f32 v217, v217, v81
s_add_u32 m0, s39, 105472
s_add_u32 s37, s37, s38
buffer_load_dwordx4 v21, s[8:11], s37 offen sc1 lds
v_mul_f32 v218, v218, v82
v_mul_f32 v219, v219, v83
v_cvt_pk_bf16_f32 v116, v216, v217
v_cvt_pk_bf16_f32 v117, v218, v219
v_mul_f32 v80, v140, v140
v_mul_f32 v81, v141, v141
buffer_store_dwordx4 v[104:107], v27, s[24:27], 0 offen offset:512 sc1
s_waitcnt vmcnt(19)
s_mov_b32 s41, 0x10000
s_waitcnt vmcnt(27)
s_branch Lpf_162
Lpoll_160:
s_waitcnt vmcnt(0)
Lpf_162:
v_cmp_ne_u32 vcc, v12, v11
s_nop 4
s_cbranch_vccz Lpok_161
buffer_load_dword v11, v10, s[56:59], 0 offen sc1
s_sub_u32 s41, s41, 1
s_cmp_lg_u32 s41, 0
s_cbranch_scc1 Lpoll_160
s_waitcnt vmcnt(0)
Lpok_161:
s_barrier
s_add_u32 s37, s37, s29
s_add_u32 m0, s39, 0
s_add_u32 s37, s37, s40
buffer_load_dwordx4 v21, s[8:11], s37 offen sc1 lds
v_mul_f32 v82, v142, v142
v_mul_f32 v83, v143, v143
v_fma_f32 v80, v80, v235, v231
v_fma_f32 v81, v81, v235, v231
v_fma_f32 v82, v82, v235, v231
v_fma_f32 v83, v83, v235, v231
v_mul_f32 v80, v80, v140
s_add_u32 m0, s39, 1024
s_add_u32 s37, s37, s38
buffer_load_dwordx4 v21, s[8:11], s37 offen sc1 lds
v_mul_f32 v81, v81, v141
v_mul_f32 v82, v82, v142
v_mul_f32 v83, v83, v143
v_exp_f32 v80, v80
v_exp_f32 v81, v81
v_exp_f32 v82, v82
s_add_u32 m0, s39, 2048
s_add_u32 s37, s37, s38
buffer_load_dwordx4 v21, s[8:11], s37 offen sc1 lds
v_exp_f32 v83, v83
v_mul_f32 v188, v140, v188
v_mul_f32 v189, v141, v189
v_mul_f32 v190, v142, v190
v_mul_f32 v191, v143, v191
v_fma_f32 v80, v80, v239, v239
v_fma_f32 v81, v81, v239, v239
s_add_u32 m0, s39, 3072
s_add_u32 s37, s37, s38
buffer_load_dwordx4 v21, s[8:11], s37 offen sc1 lds
v_fma_f32 v82, v82, v239, v239
v_fma_f32 v83, v83, v239, v239
v_rcp_f32 v80, v80
v_rcp_f32 v81, v81
v_rcp_f32 v82, v82
v_rcp_f32 v83, v83
s_add_u32 m0, s39, 4096
s_add_u32 s37, s37, s55
buffer_load_dwordx4 v21, s[8:11], s37 offen sc1 lds
v_mul_f32 v188, v188, v80
v_mul_f32 v189, v189, v81
v_mul_f32 v190, v190, v82
v_mul_f32 v191, v191, v83
v_cvt_pk_bf16_f32 v108, v188, v189
v_cvt_pk_bf16_f32 v109, v190, v191
v_mul_f32 v84, v156, v156
s_add_u32 m0, s39, 5120
s_add_u32 s37, s37, s38
buffer_load_dwordx4 v21, s[8:11], s37 offen sc1 lds
v_mul_f32 v85, v157, v157
v_mul_f32 v86, v158, v158
v_mul_f32 v87, v159, v159
v_fma_f32 v84, v84, v235, v231
v_fma_f32 v85, v85, v235, v231
v_fma_f32 v86, v86, v235, v231
s_add_u32 m0, s39, 6144
s_add_u32 s37, s37, s38
buffer_load_dwordx4 v21, s[8:11], s37 offen sc1 lds
v_fma_f32 v87, v87, v235, v231
v_mul_f32 v84, v84, v156
v_mul_f32 v85, v85, v157
v_mul_f32 v86, v86, v158
v_mul_f32 v87, v87, v159
v_exp_f32 v84, v84
v_exp_f32 v85, v85
s_add_u32 m0, s39, 7168
s_add_u32 s37, s37, s38
buffer_load_dwordx4 v21, s[8:11], s37 offen sc1 lds
v_exp_f32 v86, v86
v_exp_f32 v87, v87
v_mul_f32 v204, v156, v204
v_mul_f32 v205, v157, v205
v_mul_f32 v206, v158, v206
v_mul_f32 v207, v159, v207
s_waitcnt vmcnt(17)
s_barrier
s_add_u32 m0, s39, 32768
s_add_u32 s37, s37, s40
buffer_load_dwordx4 v21, s[8:11], s37 offen sc1 lds
v_fma_f32 v84, v84, v239, v239
v_fma_f32 v85, v85, v239, v239
v_fma_f32 v86, v86, v239, v239
v_fma_f32 v87, v87, v239, v239
v_rcp_f32 v84, v84
v_rcp_f32 v85, v85
v_rcp_f32 v86, v86
s_add_u32 m0, s39, 33792
s_add_u32 s37, s37, s38
buffer_load_dwordx4 v21, s[8:11], s37 offen sc1 lds
v_rcp_f32 v87, v87
v_mul_f32 v204, v204, v84
v_mul_f32 v205, v205, v85
v_mul_f32 v206, v206, v86
v_mul_f32 v207, v207, v87
v_cvt_pk_bf16_f32 v110, v204, v205
v_cvt_pk_bf16_f32 v111, v206, v207
s_add_u32 m0, s39, 34816
s_add_u32 s37, s37, s38
buffer_load_dwordx4 v21, s[8:11], s37 offen sc1 lds
v_mul_f32 v80, v172, v172
v_mul_f32 v81, v173, v173
v_mul_f32 v82, v174, v174
v_mul_f32 v83, v175, v175
v_fma_f32 v80, v80, v235, v231
s_add_u32 m0, s39, 35840
s_add_u32 s37, s37, s38
buffer_load_dwordx4 v21, s[8:11], s37 offen sc1 lds
v_fma_f32 v81, v81, v235, v231
v_fma_f32 v82, v82, v235, v231
v_fma_f32 v83, v83, v235, v231
v_mul_f32 v80, v80, v172
v_mul_f32 v81, v81, v173
v_mul_f32 v82, v82, v174
v_mul_f32 v83, v83, v175
s_add_u32 m0, s39, 36864
s_add_u32 s37, s37, s55
buffer_load_dwordx4 v21, s[8:11], s37 offen sc1 lds
v_exp_f32 v80, v80
v_exp_f32 v81, v81
v_exp_f32 v82, v82
v_exp_f32 v83, v83
v_mul_f32 v220, v172, v220
v_mul_f32 v221, v173, v221
v_mul_f32 v222, v174, v222
s_add_u32 m0, s39, 37888
s_add_u32 s37, s37, s38
buffer_load_dwordx4 v21, s[8:11], s37 offen sc1 lds
v_mul_f32 v223, v175, v223
v_fma_f32 v80, v80, v239, v239
v_fma_f32 v81, v81, v239, v239
v_fma_f32 v82, v82, v239, v239
v_fma_f32 v83, v83, v239, v239
v_rcp_f32 v80, v80
s_add_u32 m0, s39, 38912
s_add_u32 s37, s37, s38
buffer_load_dwordx4 v21, s[8:11], s37 offen sc1 lds
v_rcp_f32 v81, v81
v_rcp_f32 v82, v82
v_rcp_f32 v83, v83
v_mul_f32 v220, v220, v80
v_mul_f32 v221, v221, v81
v_mul_f32 v222, v222, v82
v_mul_f32 v223, v223, v83
s_add_u32 m0, s39, 39936
s_add_u32 s37, s37, s38
buffer_load_dwordx4 v21, s[8:11], s37 offen sc1 lds
v_cvt_pk_bf16_f32 v118, v220, v221
v_cvt_pk_bf16_f32 v119, v222, v223
s_nop 1
v_permlane32_swap_b32 v116, v118
v_permlane32_swap_b32 v117, v119
buffer_store_dwordx4 v[108:111], v27, s[24:27], 0 offen offset:768 sc1
buffer_store_dwordx4 v[116:119], v28, s[24:27], 0 offen offset:512 sc1
s_waitcnt vmcnt(19)
s_barrier
s_add_u32 m0, s39, 65536
s_add_u32 s37, s37, s40
buffer_load_dwordx4 v21, s[8:11], s37 offen sc1 lds
s_add_u32 m0, s39, 66560
s_add_u32 s37, s37, s38
buffer_load_dwordx4 v21, s[8:11], s37 offen sc1 lds
s_add_u32 m0, s39, 67584
s_add_u32 s37, s37, s38
buffer_load_dwordx4 v21, s[8:11], s37 offen sc1 lds
s_add_u32 m0, s39, 68608
s_add_u32 s37, s37, s38
buffer_load_dwordx4 v21, s[8:11], s37 offen sc1 lds
s_add_u32 m0, s39, 69632
s_add_u32 s37, s37, s55
buffer_load_dwordx4 v21, s[8:11], s37 offen sc1 lds
s_add_u32 m0, s39, 70656
s_add_u32 s37, s37, s38
buffer_load_dwordx4 v21, s[8:11], s37 offen sc1 lds
s_add_u32 m0, s39, 71680
s_add_u32 s37, s37, s38
buffer_load_dwordx4 v21, s[8:11], s37 offen sc1 lds
s_add_u32 m0, s39, 72704
s_add_u32 s37, s37, s38
buffer_load_dwordx4 v21, s[8:11], s37 offen sc1 lds
s_waitcnt vmcnt(8)
s_barrier
s_cmp_ge_u32 s50, 12
s_cselect_b32 s44, 64, 0
s_add_u32 s44, s44, s34
s_add_u32 s43, s44, 64
s_lshl_b32 s43, s43, 7
v_mov_b32 v10, s43
v_mov_b32 v11, 1
s_mov_b64 exec, 1
buffer_atomic_add v11, v10, s[56:59], 0 offen sc1
s_mov_b64 exec, -1
s_add_u32 m0, s39, 98304
s_add_u32 s37, s37, s40
buffer_load_dwordx4 v21, s[8:11], s37 offen sc1 lds
s_add_u32 m0, s39, 99328
s_add_u32 s37, s37, s38
buffer_load_dwordx4 v21, s[8:11], s37 offen sc1 lds
s_add_u32 m0, s39, 100352
s_add_u32 s37, s37, s38
buffer_load_dwordx4 v21, s[8:11], s37 offen sc1 lds
s_add_u32 m0, s39, 101376
s_add_u32 s37, s37, s38
buffer_load_dwordx4 v21, s[8:11], s37 offen sc1 lds
s_add_u32 m0, s39, 102400
s_add_u32 s37, s37, s55
buffer_load_dwordx4 v21, s[8:11], s37 offen sc1 lds
s_add_u32 m0, s39, 103424
s_add_u32 s37, s37, s38
buffer_load_dwordx4 v21, s[8:11], s37 offen sc1 lds
s_add_u32 m0, s39, 104448
s_add_u32 s37, s37, s38
buffer_load_dwordx4 v21, s[8:11], s37 offen sc1 lds
s_add_u32 m0, s39, 105472
s_add_u32 s37, s37, s38
buffer_load_dwordx4 v21, s[8:11], s37 offen sc1 lds
s_waitcnt vmcnt(19)
s_barrier
s_lshr_b32 s44, s2, 3
s_lshl_b32 s44, s44, 16
s_add_u32 s43, s44, 4194304
buffer_load_dword v30, v29, s[80:83], s43 offen
s_add_u32 m0, s39, 0
s_add_u32 s37, s37, s40
buffer_load_dwordx4 v21, s[8:11], s37 offen sc1 lds
s_add_u32 m0, s39, 1024
s_add_u32 s37, s37, s38
buffer_load_dwordx4 v21, s[8:11], s37 offen sc1 lds
s_add_u32 m0, s39, 2048
s_add_u32 s37, s37, s38
buffer_load_dwordx4 v21, s[8:11], s37 offen sc1 lds
s_add_u32 m0, s39, 3072
s_add_u32 s37, s37, s38
buffer_load_dwordx4 v21, s[8:11], s37 offen sc1 lds
s_add_u32 m0, s39, 4096
s_add_u32 s37, s37, s55
buffer_load_dwordx4 v21, s[8:11], s37 offen sc1 lds
s_add_u32 m0, s39, 5120
s_add_u32 s37, s37, s38
buffer_load_dwordx4 v21, s[8:11], s37 offen sc1 lds
s_add_u32 m0, s39, 6144
s_add_u32 s37, s37, s38
buffer_load_dwordx4 v21, s[8:11], s37 offen sc1 lds
s_add_u32 m0, s39, 7168
s_add_u32 s37, s37, s38
buffer_load_dwordx4 v21, s[8:11], s37 offen sc1 lds
s_waitcnt vmcnt(18)
s_barrier
s_add_u32 s43, s34, 64
s_lshl_b32 s43, s43, 7
v_mov_b32 v10, s43
v_mov_b32 v12, 12
buffer_load_dword v11, v10, s[56:59], 0 offen sc1
s_add_u32 m0, s39, 32768
s_add_u32 s37, s37, s40
buffer_load_dwordx4 v21, s[8:11], s37 offen sc1 lds
s_add_u32 m0, s39, 33792
s_add_u32 s37, s37, s38
buffer_load_dwordx4 v21, s[8:11], s37 offen sc1 lds
s_add_u32 m0, s39, 34816
s_add_u32 s37, s37, s38
buffer_load_dwordx4 v21, s[8:11], s37 offen sc1 lds
s_add_u32 m0, s39, 35840
s_add_u32 s37, s37, s38
buffer_load_dwordx4 v21, s[8:11], s37 offen sc1 lds
s_add_u32 m0, s39, 36864
s_add_u32 s37, s37, s55
buffer_load_dwordx4 v21, s[8:11], s37 offen sc1 lds
s_add_u32 m0, s39, 37888
s_add_u32 s37, s37, s38
buffer_load_dwordx4 v21, s[8:11], s37 offen sc1 lds
s_add_u32 m0, s39, 38912
s_add_u32 s37, s37, s38
buffer_load_dwordx4 v21, s[8:11], s37 offen sc1 lds
s_add_u32 m0, s39, 39936
s_add_u32 s37, s37, s38
buffer_load_dwordx4 v21, s[8:11], s37 offen sc1 lds
s_waitcnt vmcnt(18)
s_barrier
s_add_u32 m0, s39, 65536
s_add_u32 s37, s37, s40
buffer_load_dwordx4 v21, s[8:11], s37 offen sc1 lds
s_add_u32 m0, s39, 66560
s_add_u32 s37, s37, s38
buffer_load_dwordx4 v21, s[8:11], s37 offen sc1 lds
s_add_u32 m0, s39, 67584
s_add_u32 s37, s37, s38
buffer_load_dwordx4 v21, s[8:11], s37 offen sc1 lds
s_add_u32 m0, s39, 68608
s_add_u32 s37, s37, s38
buffer_load_dwordx4 v21, s[8:11], s37 offen sc1 lds
s_add_u32 m0, s39, 69632
s_add_u32 s37, s37, s55
buffer_load_dwordx4 v21, s[8:11], s37 offen sc1 lds
s_add_u32 m0, s39, 70656
s_add_u32 s37, s37, s38
buffer_load_dwordx4 v21, s[8:11], s37 offen sc1 lds
s_add_u32 m0, s39, 71680
s_add_u32 s37, s37, s38
buffer_load_dwordx4 v21, s[8:11], s37 offen sc1 lds
s_add_u32 m0, s39, 72704
s_add_u32 s37, s37, s38
buffer_load_dwordx4 v21, s[8:11], s37 offen sc1 lds
s_waitcnt vmcnt(17)
s_barrier
s_branch Lw_163
Lr_164:
s_add_u32 m0, s39, 98304
s_add_u32 s37, s37, s40
buffer_load_dwordx4 v21, s[8:11], s37 offen sc1 lds
s_add_u32 m0, s39, 99328
s_add_u32 s37, s37, s38
buffer_load_dwordx4 v21, s[8:11], s37 offen sc1 lds
s_add_u32 m0, s39, 100352
s_add_u32 s37, s37, s38
buffer_load_dwordx4 v21, s[8:11], s37 offen sc1 lds
s_add_u32 m0, s39, 101376
s_add_u32 s37, s37, s38
buffer_load_dwordx4 v21, s[8:11], s37 offen sc1 lds
s_add_u32 m0, s39, 102400
s_add_u32 s37, s37, s55
buffer_load_dwordx4 v21, s[8:11], s37 offen sc1 lds
s_add_u32 m0, s39, 103424
s_add_u32 s37, s37, s38
buffer_load_dwordx4 v21, s[8:11], s37 offen sc1 lds
s_add_u32 m0, s39, 104448
s_add_u32 s37, s37, s38
buffer_load_dwordx4 v21, s[8:11], s37 offen sc1 lds
s_add_u32 m0, s39, 105472
s_add_u32 s37, s37, s38
buffer_load_dwordx4 v21, s[8:11], s37 offen sc1 lds
s_waitcnt vmcnt(16)
s_mov_b32 s41, 0x10000
s_waitcnt vmcnt(24)
s_branch Lpf_167
Lpoll_165:
s_waitcnt vmcnt(0)
Lpf_167:
v_cmp_ne_u32 vcc, v12, v11
s_nop 4
s_cbranch_vccz Lpok_166
buffer_load_dword v11, v10, s[56:59], 0 offen sc1
s_sub_u32 s41, s41, 1
s_cmp_lg_u32 s41, 0
s_cbranch_scc1 Lpoll_165
s_waitcnt vmcnt(0)
Lpok_166:
s_barrier
s_mul_i32 s40, s53, 983040
s_add_u32 m0, s39, 0
s_add_u32 s37, s40, 4194304
buffer_load_dwordx4 v21, s[8:11], s37 offen sc1 lds
s_add_u32 m0, s39, 1024
s_add_u32 s37, s40, 4210688
buffer_load_dwordx4 v21, s[8:11], s37 offen sc1 lds
s_add_u32 m0, s39, 2048
s_add_u32 s37, s40, 4227072
buffer_load_dwordx4 v21, s[8:11], s37 offen sc1 lds
s_add_u32 m0, s39, 3072
s_add_u32 s37, s40, 4243456
buffer_load_dwordx4 v21, s[8:11], s37 offen sc1 lds
s_add_u32 m0, s39, 4096
s_add_u32 s37, s40, 4292608
buffer_load_dwordx4 v21, s[8:11], s37 offen sc1 lds
s_add_u32 m0, s39, 5120
s_add_u32 s37, s40, 4308992
buffer_load_dwordx4 v21, s[8:11], s37 offen sc1 lds
s_add_u32 m0, s39, 6144
s_add_u32 s37, s40, 4325376
buffer_load_dwordx4 v21, s[8:11], s37 offen sc1 lds
s_add_u32 m0, s39, 7168
s_add_u32 s37, s40, 4341760
buffer_load_dwordx4 v21, s[8:11], s37 offen sc1 lds
s_waitcnt vmcnt(16)
s_barrier
s_add_u32 m0, s39, 32768
s_add_u32 s37, s40, 4259840
buffer_load_dwordx4 v21, s[8:11], s37 offen sc1 lds
s_add_u32 m0, s39, 33792
s_add_u32 s37, s40, 4358144
buffer_load_dwordx4 v21, s[8:11], s37 offen sc1 lds
s_add_u32 m0, s39, 34816
s_add_u32 s37, s40, 4276224
buffer_load_dwordx4 v21, s[8:11], s37 offen sc1 lds
s_add_u32 m0, s39, 35840
s_add_u32 s37, s40, 4374528
buffer_load_dwordx4 v21, s[8:11], s37 offen sc1 lds
s_add_u32 m0, s39, 36864
s_add_u32 s37, s40, 4390912
buffer_load_dwordx4 v21, s[8:11], s37 offen sc1 lds
s_add_u32 m0, s39, 37888
s_add_u32 s37, s40, 4407296
buffer_load_dwordx4 v21, s[8:11], s37 offen sc1 lds
s_add_u32 m0, s39, 38912
s_add_u32 s37, s40, 4423680
buffer_load_dwordx4 v21, s[8:11], s37 offen sc1 lds
s_add_u32 m0, s39, 39936
s_add_u32 s37, s40, 4440064
buffer_load_dwordx4 v21, s[8:11], s37 offen sc1 lds
s_waitcnt vmcnt(16)
s_barrier
s_add_u32 m0, s39, 65536
s_add_u32 s37, s40, 4489216
buffer_load_dwordx4 v21, s[8:11], s37 offen sc1 lds
s_add_u32 m0, s39, 66560
s_add_u32 s37, s40, 4505600
buffer_load_dwordx4 v21, s[8:11], s37 offen sc1 lds
s_add_u32 m0, s39, 67584
s_add_u32 s37, s40, 4521984
buffer_load_dwordx4 v21, s[8:11], s37 offen sc1 lds
s_add_u32 m0, s39, 68608
s_add_u32 s37, s40, 4538368
buffer_load_dwordx4 v21, s[8:11], s37 offen sc1 lds
s_add_u32 m0, s39, 69632
s_add_u32 s37, s40, 4456448
buffer_load_dwordx4 v21, s[8:11], s37 offen sc1 lds
s_add_u32 m0, s39, 70656
s_add_u32 s37, s40, 4554752
buffer_load_dwordx4 v21, s[8:11], s37 offen sc1 lds
s_add_u32 m0, s39, 71680
s_add_u32 s37, s40, 4472832
buffer_load_dwordx4 v21, s[8:11], s37 offen sc1 lds
s_add_u32 m0, s39, 72704
s_add_u32 s37, s40, 4571136
buffer_load_dwordx4 v21, s[8:11], s37 offen sc1 lds
s_waitcnt vmcnt(16)
s_barrier
s_add_u32 m0, s39, 98304
s_add_u32 s37, s40, 4784128
buffer_load_dwordx4 v21, s[8:11], s37 offen sc1 lds
s_add_u32 m0, s39, 99328
s_add_u32 s37, s40, 4800512
buffer_load_dwordx4 v21, s[8:11], s37 offen sc1 lds
s_add_u32 m0, s39, 100352
s_add_u32 s37, s40, 4816896
buffer_load_dwordx4 v21, s[8:11], s37 offen sc1 lds
s_add_u32 m0, s39, 101376
s_add_u32 s37, s40, 4833280
buffer_load_dwordx4 v21, s[8:11], s37 offen sc1 lds
s_add_u32 m0, s39, 102400
s_add_u32 s37, s40, 4882432
buffer_load_dwordx4 v21, s[8:11], s37 offen sc1 lds
s_add_u32 m0, s39, 103424
s_add_u32 s37, s40, 4898816
buffer_load_dwordx4 v21, s[8:11], s37 offen sc1 lds
s_add_u32 m0, s39, 104448
s_add_u32 s37, s40, 4915200
buffer_load_dwordx4 v21, s[8:11], s37 offen sc1 lds
s_add_u32 m0, s39, 105472
s_add_u32 s37, s40, 4931584
buffer_load_dwordx4 v21, s[8:11], s37 offen sc1 lds
s_waitcnt vmcnt(16)
s_barrier
s_lshr_b32 s44, s2, 3
s_and_b32 s44, s44, 15
s_lshl_b32 s44, s44, 16
s_add_u32 s43, s44, 6291456
buffer_load_dword v30, v29, s[80:83], s43 offen
s_add_u32 m0, s39, 0
s_add_u32 s37, s40, 4849664
buffer_load_dwordx4 v21, s[8:11], s37 offen sc1 lds
s_add_u32 m0, s39, 1024
s_add_u32 s37, s40, 4947968
buffer_load_dwordx4 v21, s[8:11], s37 offen sc1 lds
s_add_u32 m0, s39, 2048
s_add_u32 s37, s40, 4866048
buffer_load_dwordx4 v21, s[8:11], s37 offen sc1 lds
s_add_u32 m0, s39, 3072
s_add_u32 s37, s40, 4964352
buffer_load_dwordx4 v21, s[8:11], s37 offen sc1 lds
s_add_u32 m0, s39, 4096
s_add_u32 s37, s40, 4980736
buffer_load_dwordx4 v21, s[8:11], s37 offen sc1 lds
s_add_u32 m0, s39, 5120
s_add_u32 s37, s40, 4997120
buffer_load_dwordx4 v21, s[8:11], s37 offen sc1 lds
s_add_u32 m0, s39, 6144
s_add_u32 s37, s40, 5013504
buffer_load_dwordx4 v21, s[8:11], s37 offen sc1 lds
s_add_u32 m0, s39, 7168
s_add_u32 s37, s40, 5029888
buffer_load_dwordx4 v21, s[8:11], s37 offen sc1 lds
s_waitcnt vmcnt(17)
s_barrier
s_add_u32 m0, s39, 32768
s_add_u32 s37, s40, 5079040
buffer_load_dwordx4 v21, s[8:11], s37 offen sc1 lds
s_add_u32 m0, s39, 33792
s_add_u32 s37, s40, 5095424
buffer_load_dwordx4 v21, s[8:11], s37 offen sc1 lds
s_add_u32 m0, s39, 34816
s_add_u32 s37, s40, 5111808
buffer_load_dwordx4 v21, s[8:11], s37 offen sc1 lds
s_add_u32 m0, s39, 35840
s_add_u32 s37, s40, 5128192
buffer_load_dwordx4 v21, s[8:11], s37 offen sc1 lds
s_add_u32 m0, s39, 36864
s_add_u32 s37, s40, 5046272
buffer_load_dwordx4 v21, s[8:11], s37 offen sc1 lds
s_add_u32 m0, s39, 37888
s_add_u32 s37, s40, 5144576
buffer_load_dwordx4 v21, s[8:11], s37 offen sc1 lds
s_add_u32 m0, s39, 38912
s_add_u32 s37, s40, 5062656
buffer_load_dwordx4 v21, s[8:11], s37 offen sc1 lds
s_add_u32 m0, s39, 39936
s_add_u32 s37, s40, 5160960
buffer_load_dwordx4 v21, s[8:11], s37 offen sc1 lds
s_waitcnt vmcnt(17)
s_barrier
s_waitcnt vmcnt(8)
s_barrier
s_waitcnt vmcnt(0)
s_barrier
s_barrier
s_add_u32 s43, s34, 128
s_lshl_b32 s43, s43, 7
v_mov_b32 v13, s43
v_mov_b32 v15, 4
buffer_load_dword v14, v13, s[56:59], 0 offen sc1
s_barrier
s_barrier
s_mov_b32 s41, 0x10000
Lpoll_168:
s_waitcnt vmcnt(0)
Lpf_170:
v_cmp_ne_u32 vcc, v15, v14
s_nop 4
s_cbranch_vccz Lpok_169
buffer_load_dword v14, v13, s[56:59], 0 offen sc1
s_sub_u32 s41, s41, 1
s_cmp_lg_u32 s41, 0
s_cbranch_scc1 Lpoll_168
s_waitcnt vmcnt(0)
Lpok_169:
s_barrier
s_barrier
s_lshl_b32 s43, s34, 4
s_add_u32 s43, s43, s35
s_and_b32 s44, s43, 1
s_lshl_b32 s44, s44, 2
s_lshr_b32 s43, s43, 1
s_add_u32 s43, s43, 144
s_lshl_b32 s43, s43, 7
s_add_u32 s43, s43, s44
v_mov_b32 v10, s43
v_mov_b32 v11, 1
s_mov_b64 exec, 1
buffer_store_dword v11, v10, s[56:59], 0 offen sc1
s_mov_b64 exec, -1
s_barrier
s_barrier
s_barrier
s_lshl_b32 s43, s34, 4
s_add_u32 s43, s43, s35
s_xor_b32 s43, s43, 1
s_and_b32 s44, s43, 1
s_lshl_b32 s44, s44, 2
s_lshr_b32 s43, s43, 1
s_add_u32 s43, s43, 144
s_lshl_b32 s43, s43, 7
s_add_u32 s43, s43, s44
v_mov_b32 v10, s43
v_mov_b32 v12, 1
buffer_load_dword v11, v10, s[56:59], 0 offen sc1
s_barrier
s_barrier
s_mov_b32 s41, 0x10000
Lpoll_171:
s_waitcnt vmcnt(0)
Lpf_173:
v_cmp_ne_u32 vcc, v12, v11
s_nop 4
s_cbranch_vccz Lpok_172
buffer_load_dword v11, v10, s[56:59], 0 offen sc1
s_sub_u32 s41, s41, 1
s_cmp_lg_u32 s41, 0
s_cbranch_scc1 Lpoll_171
s_waitcnt vmcnt(0)
Lpok_172:
s_barrier
s_branch Ldone_1
Lxr_8:
v_add_u32 v15, 0, v10
v_xor_b32 v16, 64, v15
ds_read_b128 v[240:243], v15 offset:0
ds_read_b128 v[244:247], v16 offset:0
ds_read_b128 v[248:251], v15 offset:128
ds_read_b128 v[252:255], v16 offset:128
s_branch Lxb_9
Lxr_10:
v_add_u32 v15, 43008, v10
v_xor_b32 v16, 64, v15
ds_read_b128 v[240:243], v15 offset:0
ds_read_b128 v[244:247], v16 offset:0
ds_read_b128 v[248:251], v15 offset:128
ds_read_b128 v[252:255], v16 offset:128
s_branch Lxb_11
Lxr_12:
v_add_u32 v15, 86016, v10
v_xor_b32 v16, 64, v15
ds_read_b128 v[240:243], v15 offset:0
ds_read_b128 v[244:247], v16 offset:0
ds_read_b128 v[248:251], v15 offset:128
ds_read_b128 v[252:255], v16 offset:128
s_branch Lxb_13
Lxr_14:
v_add_u32 v15, 0, v10
v_xor_b32 v16, 64, v15
ds_read_b128 v[240:243], v15 offset:0
ds_read_b128 v[244:247], v16 offset:0
ds_read_b128 v[248:251], v15 offset:128
ds_read_b128 v[252:255], v16 offset:128
s_branch Lxb_15
Lfx_53:
s_add_u32 s44, s35, 1
s_and_b32 s44, s44, 15
s_lshl_b32 s44, s44, 14
s_add_u32 s43, s44, 0x2000
s_mov_b32 s45, 0x20000
Lre_52:
buffer_load_dwordx4 v[80:83], v2, s[12:15], s44 offen offset:0 sc1
buffer_load_dwordx4 v[84:87], v2, s[12:15], s44 offen offset:256 sc1
buffer_load_dwordx4 v[88:91], v2, s[12:15], s43 offen offset:0 sc1
buffer_load_dwordx4 v[92:95], v2, s[12:15], s43 offen offset:256 sc1
s_waitcnt vmcnt(0)
v_max3_u32 v19, v80, v81, v82
v_max3_u32 v19, v19, v83, v84
v_max3_u32 v19, v19, v85, v86
v_max3_u32 v19, v19, v87, v88
v_max3_u32 v19, v19, v89, v90
v_max3_u32 v19, v19, v91, v92
v_max3_u32 v19, v19, v93, v94
v_max_u32 v19, v19, v95
v_cmp_eq_u32 vcc, -1, v19
s_sub_u32 s45, s45, 1
s_cmp_eq_u32 s45, 0
s_cbranch_scc1 Lok_51
s_nop 2
s_cbranch_vccnz Lre_52
s_branch Lok_51
Lfx_56:
s_add_u32 s44, s35, 2
s_and_b32 s44, s44, 15
s_lshl_b32 s44, s44, 14
s_add_u32 s43, s44, 0x2000
s_mov_b32 s45, 0x20000
Lre_55:
buffer_load_dwordx4 v[32:35], v2, s[12:15], s44 offen offset:0 sc1
buffer_load_dwordx4 v[36:39], v2, s[12:15], s44 offen offset:256 sc1
buffer_load_dwordx4 v[40:43], v2, s[12:15], s43 offen offset:0 sc1
buffer_load_dwordx4 v[44:47], v2, s[12:15], s43 offen offset:256 sc1
s_waitcnt vmcnt(0)
v_max3_u32 v19, v32, v33, v34
v_max3_u32 v19, v19, v35, v36
v_max3_u32 v19, v19, v37, v38
v_max3_u32 v19, v19, v39, v40
v_max3_u32 v19, v19, v41, v42
v_max3_u32 v19, v19, v43, v44
v_max3_u32 v19, v19, v45, v46
v_max_u32 v19, v19, v47
v_cmp_eq_u32 vcc, -1, v19
s_sub_u32 s45, s45, 1
s_cmp_eq_u32 s45, 0
s_cbranch_scc1 Lok_54
s_nop 2
s_cbranch_vccnz Lre_55
s_branch Lok_54
Lfx_59:
s_add_u32 s44, s35, 3
s_and_b32 s44, s44, 15
s_lshl_b32 s44, s44, 14
s_add_u32 s43, s44, 0x2000
s_mov_b32 s45, 0x20000
Lre_58:
buffer_load_dwordx4 v[80:83], v2, s[12:15], s44 offen offset:0 sc1
buffer_load_dwordx4 v[84:87], v2, s[12:15], s44 offen offset:256 sc1
buffer_load_dwordx4 v[88:91], v2, s[12:15], s43 offen offset:0 sc1
buffer_load_dwordx4 v[92:95], v2, s[12:15], s43 offen offset:256 sc1
s_waitcnt vmcnt(0)
v_max3_u32 v19, v80, v81, v82
v_max3_u32 v19, v19, v83, v84
v_max3_u32 v19, v19, v85, v86
v_max3_u32 v19, v19, v87, v88
v_max3_u32 v19, v19, v89, v90
v_max3_u32 v19, v19, v91, v92
v_max3_u32 v19, v19, v93, v94
v_max_u32 v19, v19, v95
v_cmp_eq_u32 vcc, -1, v19
s_sub_u32 s45, s45, 1
s_cmp_eq_u32 s45, 0
s_cbranch_scc1 Lok_57
s_nop 2
s_cbranch_vccnz Lre_58
s_branch Lok_57
Lfx_62:
s_add_u32 s44, s35, 4
s_and_b32 s44, s44, 15
s_lshl_b32 s44, s44, 14
s_add_u32 s43, s44, 0x2000
s_mov_b32 s45, 0x20000
Lre_61:
buffer_load_dwordx4 v[32:35], v2, s[12:15], s44 offen offset:0 sc1
buffer_load_dwordx4 v[36:39], v2, s[12:15], s44 offen offset:256 sc1
buffer_load_dwordx4 v[40:43], v2, s[12:15], s43 offen offset:0 sc1
buffer_load_dwordx4 v[44:47], v2, s[12:15], s43 offen offset:256 sc1
s_waitcnt vmcnt(0)
v_max3_u32 v19, v32, v33, v34
v_max3_u32 v19, v19, v35, v36
v_max3_u32 v19, v19, v37, v38
v_max3_u32 v19, v19, v39, v40
v_max3_u32 v19, v19, v41, v42
v_max3_u32 v19, v19, v43, v44
v_max3_u32 v19, v19, v45, v46
v_max_u32 v19, v19, v47
v_cmp_eq_u32 vcc, -1, v19
s_sub_u32 s45, s45, 1
s_cmp_eq_u32 s45, 0
s_cbranch_scc1 Lok_60
s_nop 2
s_cbranch_vccnz Lre_61
s_branch Lok_60
Lfx_65:
s_add_u32 s44, s35, 5
s_and_b32 s44, s44, 15
s_lshl_b32 s44, s44, 14
s_add_u32 s43, s44, 0x2000
s_mov_b32 s45, 0x20000
Lre_64:
buffer_load_dwordx4 v[80:83], v2, s[12:15], s44 offen offset:0 sc1
buffer_load_dwordx4 v[84:87], v2, s[12:15], s44 offen offset:256 sc1
buffer_load_dwordx4 v[88:91], v2, s[12:15], s43 offen offset:0 sc1
buffer_load_dwordx4 v[92:95], v2, s[12:15], s43 offen offset:256 sc1
s_waitcnt vmcnt(0)
v_max3_u32 v19, v80, v81, v82
v_max3_u32 v19, v19, v83, v84
v_max3_u32 v19, v19, v85, v86
v_max3_u32 v19, v19, v87, v88
v_max3_u32 v19, v19, v89, v90
v_max3_u32 v19, v19, v91, v92
v_max3_u32 v19, v19, v93, v94
v_max_u32 v19, v19, v95
v_cmp_eq_u32 vcc, -1, v19
s_sub_u32 s45, s45, 1
s_cmp_eq_u32 s45, 0
s_cbranch_scc1 Lok_63
s_nop 2
s_cbranch_vccnz Lre_64
s_branch Lok_63
Lfx_68:
s_add_u32 s44, s35, 6
s_and_b32 s44, s44, 15
s_lshl_b32 s44, s44, 14
s_add_u32 s43, s44, 0x2000
s_mov_b32 s45, 0x20000
Lre_67:
buffer_load_dwordx4 v[32:35], v2, s[12:15], s44 offen offset:0 sc1
buffer_load_dwordx4 v[36:39], v2, s[12:15], s44 offen offset:256 sc1
buffer_load_dwordx4 v[40:43], v2, s[12:15], s43 offen offset:0 sc1
buffer_load_dwordx4 v[44:47], v2, s[12:15], s43 offen offset:256 sc1
s_waitcnt vmcnt(0)
v_max3_u32 v19, v32, v33, v34
v_max3_u32 v19, v19, v35, v36
v_max3_u32 v19, v19, v37, v38
v_max3_u32 v19, v19, v39, v40
v_max3_u32 v19, v19, v41, v42
v_max3_u32 v19, v19, v43, v44
v_max3_u32 v19, v19, v45, v46
v_max_u32 v19, v19, v47
v_cmp_eq_u32 vcc, -1, v19
s_sub_u32 s45, s45, 1
s_cmp_eq_u32 s45, 0
s_cbranch_scc1 Lok_66
s_nop 2
s_cbranch_vccnz Lre_67
s_branch Lok_66
Lfx_71:
s_add_u32 s44, s35, 7
s_and_b32 s44, s44, 15
s_lshl_b32 s44, s44, 14
s_add_u32 s43, s44, 0x2000
s_mov_b32 s45, 0x20000
Lre_70:
buffer_load_dwordx4 v[80:83], v2, s[12:15], s44 offen offset:0 sc1
buffer_load_dwordx4 v[84:87], v2, s[12:15], s44 offen offset:256 sc1
buffer_load_dwordx4 v[88:91], v2, s[12:15], s43 offen offset:0 sc1
buffer_load_dwordx4 v[92:95], v2, s[12:15], s43 offen offset:256 sc1
s_waitcnt vmcnt(0)
v_max3_u32 v19, v80, v81, v82
v_max3_u32 v19, v19, v83, v84
v_max3_u32 v19, v19, v85, v86
v_max3_u32 v19, v19, v87, v88
v_max3_u32 v19, v19, v89, v90
v_max3_u32 v19, v19, v91, v92
v_max3_u32 v19, v19, v93, v94
v_max_u32 v19, v19, v95
v_cmp_eq_u32 vcc, -1, v19
s_sub_u32 s45, s45, 1
s_cmp_eq_u32 s45, 0
s_cbranch_scc1 Lok_69
s_nop 2
s_cbranch_vccnz Lre_70
s_branch Lok_69
Lfx_74:
s_add_u32 s44, s35, 8
s_and_b32 s44, s44, 15
s_lshl_b32 s44, s44, 14
s_add_u32 s43, s44, 0x2000
s_mov_b32 s45, 0x20000
Lre_73:
buffer_load_dwordx4 v[32:35], v2, s[12:15], s44 offen offset:0 sc1
buffer_load_dwordx4 v[36:39], v2, s[12:15], s44 offen offset:256 sc1
buffer_load_dwordx4 v[40:43], v2, s[12:15], s43 offen offset:0 sc1
buffer_load_dwordx4 v[44:47], v2, s[12:15], s43 offen offset:256 sc1
s_waitcnt vmcnt(0)
v_max3_u32 v19, v32, v33, v34
v_max3_u32 v19, v19, v35, v36
v_max3_u32 v19, v19, v37, v38
v_max3_u32 v19, v19, v39, v40
v_max3_u32 v19, v19, v41, v42
v_max3_u32 v19, v19, v43, v44
v_max3_u32 v19, v19, v45, v46
v_max_u32 v19, v19, v47
v_cmp_eq_u32 vcc, -1, v19
s_sub_u32 s45, s45, 1
s_cmp_eq_u32 s45, 0
s_cbranch_scc1 Lok_72
s_nop 2
s_cbranch_vccnz Lre_73
s_branch Lok_72
Lfx_77:
s_add_u32 s44, s35, 9
s_and_b32 s44, s44, 15
s_lshl_b32 s44, s44, 14
s_add_u32 s43, s44, 0x2000
s_mov_b32 s45, 0x20000
Lre_76:
buffer_load_dwordx4 v[80:83], v2, s[12:15], s44 offen offset:0 sc1
buffer_load_dwordx4 v[84:87], v2, s[12:15], s44 offen offset:256 sc1
buffer_load_dwordx4 v[88:91], v2, s[12:15], s43 offen offset:0 sc1
buffer_load_dwordx4 v[92:95], v2, s[12:15], s43 offen offset:256 sc1
s_waitcnt vmcnt(0)
v_max3_u32 v19, v80, v81, v82
v_max3_u32 v19, v19, v83, v84
v_max3_u32 v19, v19, v85, v86
v_max3_u32 v19, v19, v87, v88
v_max3_u32 v19, v19, v89, v90
v_max3_u32 v19, v19, v91, v92
v_max3_u32 v19, v19, v93, v94
v_max_u32 v19, v19, v95
v_cmp_eq_u32 vcc, -1, v19
s_sub_u32 s45, s45, 1
s_cmp_eq_u32 s45, 0
s_cbranch_scc1 Lok_75
s_nop 2
s_cbranch_vccnz Lre_76
s_branch Lok_75
Lfx_80:
s_add_u32 s44, s35, 10
s_and_b32 s44, s44, 15
s_lshl_b32 s44, s44, 14
s_add_u32 s43, s44, 0x2000
s_mov_b32 s45, 0x20000
Lre_79:
buffer_load_dwordx4 v[32:35], v2, s[12:15], s44 offen offset:0 sc1
buffer_load_dwordx4 v[36:39], v2, s[12:15], s44 offen offset:256 sc1
buffer_load_dwordx4 v[40:43], v2, s[12:15], s43 offen offset:0 sc1
buffer_load_dwordx4 v[44:47], v2, s[12:15], s43 offen offset:256 sc1
s_waitcnt vmcnt(0)
v_max3_u32 v19, v32, v33, v34
v_max3_u32 v19, v19, v35, v36
v_max3_u32 v19, v19, v37, v38
v_max3_u32 v19, v19, v39, v40
v_max3_u32 v19, v19, v41, v42
v_max3_u32 v19, v19, v43, v44
v_max3_u32 v19, v19, v45, v46
v_max_u32 v19, v19, v47
v_cmp_eq_u32 vcc, -1, v19
s_sub_u32 s45, s45, 1
s_cmp_eq_u32 s45, 0
s_cbranch_scc1 Lok_78
s_nop 2
s_cbranch_vccnz Lre_79
s_branch Lok_78
Lfx_83:
s_add_u32 s44, s35, 1
s_and_b32 s44, s44, 15
s_lshl_b32 s44, s44, 14
s_add_u32 s44, s44, 0
s_mov_b32 s45, 0x20000
Lre_82:
buffer_load_dwordx4 v[32:35], v2, s[12:15], s44 offen offset:0 sc1
buffer_load_dwordx4 v[36:39], v2, s[12:15], s44 offen offset:256 sc1
buffer_load_dwordx4 v[40:43], v2, s[12:15], s44 offen offset:512 sc1
buffer_load_dwordx4 v[44:47], v2, s[12:15], s44 offen offset:768 sc1
s_waitcnt vmcnt(0)
v_max3_u32 v19, v32, v33, v34
v_max3_u32 v19, v19, v35, v36
v_max3_u32 v19, v19, v37, v38
v_max3_u32 v19, v19, v39, v40
v_max3_u32 v19, v19, v41, v42
v_max3_u32 v19, v19, v43, v44
v_max3_u32 v19, v19, v45, v46
v_max_u32 v19, v19, v47
v_cmp_eq_u32 vcc, -1, v19
s_sub_u32 s45, s45, 1
s_cmp_eq_u32 s45, 0
s_cbranch_scc1 Lok_81
s_nop 2
s_cbranch_vccnz Lre_82
s_branch Lok_81
Lfx_86:
s_add_u32 s44, s35, 1
s_and_b32 s44, s44, 15
s_lshl_b32 s44, s44, 14
s_add_u32 s44, s44, 8192
s_mov_b32 s45, 0x20000
Lre_85:
buffer_load_dwordx4 v[80:83], v2, s[12:15], s44 offen offset:0 sc1
buffer_load_dwordx4 v[84:87], v2, s[12:15], s44 offen offset:256 sc1
buffer_load_dwordx4 v[88:91], v2, s[12:15], s44 offen offset:512 sc1
buffer_load_dwordx4 v[92:95], v2, s[12:15], s44 offen offset:768 sc1
s_waitcnt vmcnt(0)
v_max3_u32 v19, v80, v81, v82
v_max3_u32 v19, v19, v83, v84
v_max3_u32 v19, v19, v85, v86
v_max3_u32 v19, v19, v87, v88
v_max3_u32 v19, v19, v89, v90
v_max3_u32 v19, v19, v91, v92
v_max3_u32 v19, v19, v93, v94
v_max_u32 v19, v19, v95
v_cmp_eq_u32 vcc, -1, v19
s_sub_u32 s45, s45, 1
s_cmp_eq_u32 s45, 0
s_cbranch_scc1 Lok_84
s_nop 2
s_cbranch_vccnz Lre_85
s_branch Lok_84
Lfx_89:
s_add_u32 s44, s35, 2
s_and_b32 s44, s44, 15
s_lshl_b32 s44, s44, 14
s_add_u32 s44, s44, 0
s_mov_b32 s45, 0x20000
Lre_88:
buffer_load_dwordx4 v[32:35], v2, s[12:15], s44 offen offset:0 sc1
buffer_load_dwordx4 v[36:39], v2, s[12:15], s44 offen offset:256 sc1
buffer_load_dwordx4 v[40:43], v2, s[12:15], s44 offen offset:512 sc1
buffer_load_dwordx4 v[44:47], v2, s[12:15], s44 offen offset:768 sc1
s_waitcnt vmcnt(0)
v_max3_u32 v19, v32, v33, v34
v_max3_u32 v19, v19, v35, v36
v_max3_u32 v19, v19, v37, v38
v_max3_u32 v19, v19, v39, v40
v_max3_u32 v19, v19, v41, v42
v_max3_u32 v19, v19, v43, v44
v_max3_u32 v19, v19, v45, v46
v_max_u32 v19, v19, v47
v_cmp_eq_u32 vcc, -1, v19
s_sub_u32 s45, s45, 1
s_cmp_eq_u32 s45, 0
s_cbranch_scc1 Lok_87
s_nop 2
s_cbranch_vccnz Lre_88
s_branch Lok_87
Lfx_92:
s_add_u32 s44, s35, 2
s_and_b32 s44, s44, 15
s_lshl_b32 s44, s44, 14
s_add_u32 s44, s44, 8192
s_mov_b32 s45, 0x20000
Lre_91:
buffer_load_dwordx4 v[80:83], v2, s[12:15], s44 offen offset:0 sc1
buffer_load_dwordx4 v[84:87], v2, s[12:15], s44 offen offset:256 sc1
buffer_load_dwordx4 v[88:91], v2, s[12:15], s44 offen offset:512 sc1
buffer_load_dwordx4 v[92:95], v2, s[12:15], s44 offen offset:768 sc1
s_waitcnt vmcnt(0)
v_max3_u32 v19, v80, v81, v82
v_max3_u32 v19, v19, v83, v84
v_max3_u32 v19, v19, v85, v86
v_max3_u32 v19, v19, v87, v88
v_max3_u32 v19, v19, v89, v90
v_max3_u32 v19, v19, v91, v92
v_max3_u32 v19, v19, v93, v94
v_max_u32 v19, v19, v95
v_cmp_eq_u32 vcc, -1, v19
s_sub_u32 s45, s45, 1
s_cmp_eq_u32 s45, 0
s_cbranch_scc1 Lok_90
s_nop 2
s_cbranch_vccnz Lre_91
s_branch Lok_90
Lfx_95:
s_add_u32 s44, s35, 3
s_and_b32 s44, s44, 15
s_lshl_b32 s44, s44, 14
s_add_u32 s44, s44, 0
s_mov_b32 s45, 0x20000
Lre_94:
buffer_load_dwordx4 v[32:35], v2, s[12:15], s44 offen offset:0 sc1
buffer_load_dwordx4 v[36:39], v2, s[12:15], s44 offen offset:256 sc1
buffer_load_dwordx4 v[40:43], v2, s[12:15], s44 offen offset:512 sc1
buffer_load_dwordx4 v[44:47], v2, s[12:15], s44 offen offset:768 sc1
s_waitcnt vmcnt(0)
v_max3_u32 v19, v32, v33, v34
v_max3_u32 v19, v19, v35, v36
v_max3_u32 v19, v19, v37, v38
v_max3_u32 v19, v19, v39, v40
v_max3_u32 v19, v19, v41, v42
v_max3_u32 v19, v19, v43, v44
v_max3_u32 v19, v19, v45, v46
v_max_u32 v19, v19, v47
v_cmp_eq_u32 vcc, -1, v19
s_sub_u32 s45, s45, 1
s_cmp_eq_u32 s45, 0
s_cbranch_scc1 Lok_93
s_nop 2
s_cbranch_vccnz Lre_94
s_branch Lok_93
Lfx_98:
s_add_u32 s44, s35, 3
s_and_b32 s44, s44, 15
s_lshl_b32 s44, s44, 14
s_add_u32 s44, s44, 8192
s_mov_b32 s45, 0x20000
Lre_97:
buffer_load_dwordx4 v[80:83], v2, s[12:15], s44 offen offset:0 sc1
buffer_load_dwordx4 v[84:87], v2, s[12:15], s44 offen offset:256 sc1
buffer_load_dwordx4 v[88:91], v2, s[12:15], s44 offen offset:512 sc1
buffer_load_dwordx4 v[92:95], v2, s[12:15], s44 offen offset:768 sc1
s_waitcnt vmcnt(0)
v_max3_u32 v19, v80, v81, v82
v_max3_u32 v19, v19, v83, v84
v_max3_u32 v19, v19, v85, v86
v_max3_u32 v19, v19, v87, v88
v_max3_u32 v19, v19, v89, v90
v_max3_u32 v19, v19, v91, v92
v_max3_u32 v19, v19, v93, v94
v_max_u32 v19, v19, v95
v_cmp_eq_u32 vcc, -1, v19
s_sub_u32 s45, s45, 1
s_cmp_eq_u32 s45, 0
s_cbranch_scc1 Lok_96
s_nop 2
s_cbranch_vccnz Lre_97
s_branch Lok_96
Lfx_101:
s_add_u32 s44, s35, 4
s_and_b32 s44, s44, 15
s_lshl_b32 s44, s44, 14
s_add_u32 s44, s44, 0
s_mov_b32 s45, 0x20000
Lre_100:
buffer_load_dwordx4 v[32:35], v2, s[12:15], s44 offen offset:0 sc1
buffer_load_dwordx4 v[36:39], v2, s[12:15], s44 offen offset:256 sc1
buffer_load_dwordx4 v[40:43], v2, s[12:15], s44 offen offset:512 sc1
buffer_load_dwordx4 v[44:47], v2, s[12:15], s44 offen offset:768 sc1
s_waitcnt vmcnt(0)
v_max3_u32 v19, v32, v33, v34
v_max3_u32 v19, v19, v35, v36
v_max3_u32 v19, v19, v37, v38
v_max3_u32 v19, v19, v39, v40
v_max3_u32 v19, v19, v41, v42
v_max3_u32 v19, v19, v43, v44
v_max3_u32 v19, v19, v45, v46
v_max_u32 v19, v19, v47
v_cmp_eq_u32 vcc, -1, v19
s_sub_u32 s45, s45, 1
s_cmp_eq_u32 s45, 0
s_cbranch_scc1 Lok_99
s_nop 2
s_cbranch_vccnz Lre_100
s_branch Lok_99
Lfx_104:
s_add_u32 s44, s35, 4
s_and_b32 s44, s44, 15
s_lshl_b32 s44, s44, 14
s_add_u32 s44, s44, 8192
s_mov_b32 s45, 0x20000
Lre_103:
buffer_load_dwordx4 v[80:83], v2, s[12:15], s44 offen offset:0 sc1
buffer_load_dwordx4 v[84:87], v2, s[12:15], s44 offen offset:256 sc1
buffer_load_dwordx4 v[88:91], v2, s[12:15], s44 offen offset:512 sc1
buffer_load_dwordx4 v[92:95], v2, s[12:15], s44 offen offset:768 sc1
s_waitcnt vmcnt(0)
v_max3_u32 v19, v80, v81, v82
v_max3_u32 v19, v19, v83, v84
v_max3_u32 v19, v19, v85, v86
v_max3_u32 v19, v19, v87, v88
v_max3_u32 v19, v19, v89, v90
v_max3_u32 v19, v19, v91, v92
v_max3_u32 v19, v19, v93, v94
v_max_u32 v19, v19, v95
v_cmp_eq_u32 vcc, -1, v19
s_sub_u32 s45, s45, 1
s_cmp_eq_u32 s45, 0
s_cbranch_scc1 Lok_102
s_nop 2
s_cbranch_vccnz Lre_103
s_branch Lok_102
Lfx_107:
s_add_u32 s44, s35, 5
s_and_b32 s44, s44, 15
s_lshl_b32 s44, s44, 14
s_add_u32 s44, s44, 0
s_mov_b32 s45, 0x20000
Lre_106:
buffer_load_dwordx4 v[32:35], v2, s[12:15], s44 offen offset:0 sc1
buffer_load_dwordx4 v[36:39], v2, s[12:15], s44 offen offset:256 sc1
buffer_load_dwordx4 v[40:43], v2, s[12:15], s44 offen offset:512 sc1
buffer_load_dwordx4 v[44:47], v2, s[12:15], s44 offen offset:768 sc1
s_waitcnt vmcnt(0)
v_max3_u32 v19, v32, v33, v34
v_max3_u32 v19, v19, v35, v36
v_max3_u32 v19, v19, v37, v38
v_max3_u32 v19, v19, v39, v40
v_max3_u32 v19, v19, v41, v42
v_max3_u32 v19, v19, v43, v44
v_max3_u32 v19, v19, v45, v46
v_max_u32 v19, v19, v47
v_cmp_eq_u32 vcc, -1, v19
s_sub_u32 s45, s45, 1
s_cmp_eq_u32 s45, 0
s_cbranch_scc1 Lok_105
s_nop 2
s_cbranch_vccnz Lre_106
s_branch Lok_105
Lfx_110:
s_add_u32 s44, s35, 5
s_and_b32 s44, s44, 15
s_lshl_b32 s44, s44, 14
s_add_u32 s44, s44, 8192
s_mov_b32 s45, 0x20000
Lre_109:
buffer_load_dwordx4 v[80:83], v2, s[12:15], s44 offen offset:0 sc1
buffer_load_dwordx4 v[84:87], v2, s[12:15], s44 offen offset:256 sc1
buffer_load_dwordx4 v[88:91], v2, s[12:15], s44 offen offset:512 sc1
buffer_load_dwordx4 v[92:95], v2, s[12:15], s44 offen offset:768 sc1
s_waitcnt vmcnt(0)
v_max3_u32 v19, v80, v81, v82
v_max3_u32 v19, v19, v83, v84
v_max3_u32 v19, v19, v85, v86
v_max3_u32 v19, v19, v87, v88
v_max3_u32 v19, v19, v89, v90
v_max3_u32 v19, v19, v91, v92
v_max3_u32 v19, v19, v93, v94
v_max_u32 v19, v19, v95
v_cmp_eq_u32 vcc, -1, v19
s_sub_u32 s45, s45, 1
s_cmp_eq_u32 s45, 0
s_cbranch_scc1 Lok_108
s_nop 2
s_cbranch_vccnz Lre_109
s_branch Lok_108
Lfx_113:
s_add_u32 s44, s35, 6
s_and_b32 s44, s44, 15
s_lshl_b32 s44, s44, 14
s_add_u32 s44, s44, 0
s_mov_b32 s45, 0x20000
Lre_112:
buffer_load_dwordx4 v[32:35], v2, s[12:15], s44 offen offset:0 sc1
buffer_load_dwordx4 v[36:39], v2, s[12:15], s44 offen offset:256 sc1
buffer_load_dwordx4 v[40:43], v2, s[12:15], s44 offen offset:512 sc1
buffer_load_dwordx4 v[44:47], v2, s[12:15], s44 offen offset:768 sc1
s_waitcnt vmcnt(0)
v_max3_u32 v19, v32, v33, v34
v_max3_u32 v19, v19, v35, v36
v_max3_u32 v19, v19, v37, v38
v_max3_u32 v19, v19, v39, v40
v_max3_u32 v19, v19, v41, v42
v_max3_u32 v19, v19, v43, v44
v_max3_u32 v19, v19, v45, v46
v_max_u32 v19, v19, v47
v_cmp_eq_u32 vcc, -1, v19
s_sub_u32 s45, s45, 1
s_cmp_eq_u32 s45, 0
s_cbranch_scc1 Lok_111
s_nop 2
s_cbranch_vccnz Lre_112
s_branch Lok_111
Lfx_116:
s_add_u32 s44, s35, 6
s_and_b32 s44, s44, 15
s_lshl_b32 s44, s44, 14
s_add_u32 s44, s44, 8192
s_mov_b32 s45, 0x20000
Lre_115:
buffer_load_dwordx4 v[80:83], v2, s[12:15], s44 offen offset:0 sc1
buffer_load_dwordx4 v[84:87], v2, s[12:15], s44 offen offset:256 sc1
buffer_load_dwordx4 v[88:91], v2, s[12:15], s44 offen offset:512 sc1
buffer_load_dwordx4 v[92:95], v2, s[12:15], s44 offen offset:768 sc1
s_waitcnt vmcnt(0)
v_max3_u32 v19, v80, v81, v82
v_max3_u32 v19, v19, v83, v84
v_max3_u32 v19, v19, v85, v86
v_max3_u32 v19, v19, v87, v88
v_max3_u32 v19, v19, v89, v90
v_max3_u32 v19, v19, v91, v92
v_max3_u32 v19, v19, v93, v94
v_max_u32 v19, v19, v95
v_cmp_eq_u32 vcc, -1, v19
s_sub_u32 s45, s45, 1
s_cmp_eq_u32 s45, 0
s_cbranch_scc1 Lok_114
s_nop 2
s_cbranch_vccnz Lre_115
s_branch Lok_114
Lfx_119:
s_add_u32 s44, s35, 7
s_and_b32 s44, s44, 15
s_lshl_b32 s44, s44, 14
s_add_u32 s44, s44, 0
s_mov_b32 s45, 0x20000
Lre_118:
buffer_load_dwordx4 v[32:35], v2, s[12:15], s44 offen offset:0 sc1
buffer_load_dwordx4 v[36:39], v2, s[12:15], s44 offen offset:256 sc1
buffer_load_dwordx4 v[40:43], v2, s[12:15], s44 offen offset:512 sc1
buffer_load_dwordx4 v[44:47], v2, s[12:15], s44 offen offset:768 sc1
s_waitcnt vmcnt(0)
v_max3_u32 v19, v32, v33, v34
v_max3_u32 v19, v19, v35, v36
v_max3_u32 v19, v19, v37, v38
v_max3_u32 v19, v19, v39, v40
v_max3_u32 v19, v19, v41, v42
v_max3_u32 v19, v19, v43, v44
v_max3_u32 v19, v19, v45, v46
v_max_u32 v19, v19, v47
v_cmp_eq_u32 vcc, -1, v19
s_sub_u32 s45, s45, 1
s_cmp_eq_u32 s45, 0
s_cbranch_scc1 Lok_117
s_nop 2
s_cbranch_vccnz Lre_118
s_branch Lok_117
Lfx_122:
s_add_u32 s44, s35, 7
s_and_b32 s44, s44, 15
s_lshl_b32 s44, s44, 14
s_add_u32 s44, s44, 8192
s_mov_b32 s45, 0x20000
Lre_121:
buffer_load_dwordx4 v[80:83], v2, s[12:15], s44 offen offset:0 sc1
buffer_load_dwordx4 v[84:87], v2, s[12:15], s44 offen offset:256 sc1
buffer_load_dwordx4 v[88:91], v2, s[12:15], s44 offen offset:512 sc1
buffer_load_dwordx4 v[92:95], v2, s[12:15], s44 offen offset:768 sc1
s_waitcnt vmcnt(0)
v_max3_u32 v19, v80, v81, v82
v_max3_u32 v19, v19, v83, v84
v_max3_u32 v19, v19, v85, v86
v_max3_u32 v19, v19, v87, v88
v_max3_u32 v19, v19, v89, v90
v_max3_u32 v19, v19, v91, v92
v_max3_u32 v19, v19, v93, v94
v_max_u32 v19, v19, v95
v_cmp_eq_u32 vcc, -1, v19
s_sub_u32 s45, s45, 1
s_cmp_eq_u32 s45, 0
s_cbranch_scc1 Lok_120
s_nop 2
s_cbranch_vccnz Lre_121
s_branch Lok_120
Ldone_1:
s_endpgm
.section .rodata,"a"
.p2align 6
.amdhsa_kernel sequential_preLN__sliding_local_dilated__glu_gated_geglu__prompt_kernel
  .amdhsa_next_free_vgpr 256
  .amdhsa_next_free_sgpr 100
  .amdhsa_accum_offset 256
  .amdhsa_group_segment_fixed_size 0
  .amdhsa_kernarg_size 80
  .amdhsa_user_sgpr_count 2
  .amdhsa_user_sgpr_kernarg_segment_ptr 1
  .amdhsa_system_sgpr_workgroup_id_x 1
  .amdhsa_float_denorm_mode_32 3
  .amdhsa_float_denorm_mode_16_64 3
.end_amdhsa_kernel
```

```asm
; @launch grid=(256,1,1) block=(512,1,1) lds=151552
.amdgcn_target "amdgcn-amd-amdhsa--gfx950"
.text
.globl sequential_preLN__sliding_local_dilated__glu_gated_geglu__prompt_kernel
.p2align 8
.type sequential_preLN__sliding_local_dilated__glu_gated_geglu__prompt_kernel,@function
sequential_preLN__sliding_local_dilated__glu_gated_geglu__prompt_kernel:
s_cmp_ge_u32 s2, 256
s_cbranch_scc1 Ldone_1
s_load_dwordx4 s[4:7], s[0:1], 0
s_load_dwordx2 s[32:33], s[0:1], 72
s_load_dwordx2 s[80:81], s[0:1], 32
s_and_b32 s3, s2, 7
s_lshr_b32 s42, s2, 3
s_and_b32 s48, s42, 3
s_lshr_b32 s49, s42, 2
s_and_b32 s34, s3, 3
s_lshl_b32 s34, s34, 2
s_add_u32 s34, s34, s48
s_lshr_b32 s35, s3, 2
s_lshl_b32 s35, s35, 3
s_add_u32 s35, s35, s49
v_lshrrev_b32 v12, 6, v0
v_and_b32 v1, 63, v0
v_readfirstlane_b32 s36, v12
s_nop 3
s_lshl_b32 s44, s34, 18
s_lshl_b32 s45, s35, 14
s_add_u32 s45, s45, s44
s_lshl_b32 s50, s34, 7
s_sub_u32 s50, s50, 16
s_and_b32 s47, s36, 3
s_lshl_b32 s43, s34, 7
s_lshl_b32 s44, s35, 3
s_add_u32 s43, s43, s44
s_mov_b32 s63, s43
s_lshl_b32 s44, s47, 1
s_add_u32 s51, s43, s44
v_lshlrev_b32 v10, 4, v1
v_lshrrev_b32 v14, 3, v1
v_and_b32 v15, 7, v1
v_and_b32 v16, 2, v14
v_xor_b32 v16, v15, v16
v_lshlrev_b32 v16, 4, v16
v_mul_u32_u24 v17, 6144, v14
s_lshl_b32 s43, s47, 11
v_add3_u32 v2, v17, v16, s43
v_xor_b32 v3, 64, v2
v_lshrrev_b32 v16, 1, v14
v_xor_b32 v16, v15, v16
v_lshlrev_b32 v16, 4, v16
s_lshl_b32 s43, s47, 3
s_add_u32 s43, s43, s50
v_add_u32 v17, s43, v14
s_and_b32 s44, s47, 1
s_lshl_b32 s44, s44, 6
v_add_u32 v18, 0, v17
v_max_i32 v18, 0, v18
v_lshl_add_u32 v18, v18, 11, v16
v_xor_b32 v18, s44, v18
v_mov_b32 v4, v18
v_add_u32 v18, 24, v17
v_max_i32 v18, 0, v18
v_lshl_add_u32 v18, v18, 11, v16
v_xor_b32 v18, s44, v18
v_xor_b32 v5, 64, v18
v_add_u32 v18, 48, v17
v_max_i32 v18, 0, v18
v_lshl_add_u32 v18, v18, 11, v16
v_xor_b32 v18, s44, v18
v_mov_b32 v6, v18
v_add_u32 v18, 72, v17
v_max_i32 v18, 0, v18
v_lshl_add_u32 v18, v18, 11, v16
v_xor_b32 v18, s44, v18
v_xor_b32 v7, 64, v18
v_add_u32 v18, 96, v17
v_max_i32 v18, 0, v18
v_lshl_add_u32 v18, v18, 11, v16
v_xor_b32 v18, s44, v18
v_mov_b32 v8, v18
v_add_u32 v18, 120, v17
v_max_i32 v18, 0, v18
v_lshl_add_u32 v18, v18, 11, v16
v_xor_b32 v18, s44, v18
v_xor_b32 v9, 64, v18
s_lshl_b32 s39, s47, 10
s_lshl_b32 s40, s47, 13
s_add_u32 s40, s40, 18432
s_mov_b32 s37, 0
s_mov_b32 s38, 0
s_bfm_b64 s[60:61], 56, 8
s_cmp_eq_u32 s47, 0
s_cselect_b64 s[60:61], s[60:61], -1
s_mov_b32 s53, 0x3f803f80
v_and_b32 v12, 15, v1
v_lshrrev_b32 v13, 4, v1
s_lshl_b32 s43, s35, 7
s_waitcnt lgkmcnt(0)
s_mov_b32 s8, s4
s_mov_b32 s9, s5
s_mov_b32 s10, 4194304
s_mov_b32 s11, 0x20000
s_add_u32 s12, s6, s43
s_addc_u32 s13, s7, 0
s_mov_b32 s14, 6289536
s_mov_b32 s15, 0x20000
s_add_u32 s16, s32, s45
s_addc_u32 s17, s33, 0
s_mov_b32 s18, 16384
s_mov_b32 s19, 0x20000
s_add_u32 s20, s32, 26214400
s_addc_u32 s21, s33, 0
s_mov_b32 s22, 16384
s_mov_b32 s23, 0x20000
s_cmp_lt_u32 s36, 4
s_cbranch_scc1 Lcons_2
s_cmp_eq_u32 s36, 7
s_cbranch_scc1 Lpf_3
s_add_u32 m0, s39, 0
s_mov_b64 exec, s[60:61]
buffer_load_dwordx4 v4, s[8:11], s37 offen lds
s_mov_b64 exec, -1
s_add_u32 m0, s39, 3072
s_nop 0
buffer_load_dwordx4 v5, s[8:11], s37 offen lds
s_add_u32 m0, s39, 6144
s_nop 0
buffer_load_dwordx4 v6, s[8:11], s37 offen lds
s_add_u32 m0, s39, 9216
s_nop 0
buffer_load_dwordx4 v7, s[8:11], s37 offen lds
s_add_u32 m0, s39, 12288
s_nop 0
buffer_load_dwordx4 v8, s[8:11], s37 offen lds
s_add_u32 m0, s39, 15360
s_nop 0
buffer_load_dwordx4 v9, s[8:11], s37 offen lds
s_add_u32 m0, s40, 0
s_add_u32 s43, s38, 0
buffer_load_dwordx4 v2, s[12:15], s43 offen lds
s_add_u32 m0, s40, 1024
s_add_u32 s43, s38, 49152
buffer_load_dwordx4 v3, s[12:15], s43 offen lds
s_add_u32 m0, s40, 2048
s_add_u32 s43, s38, 98304
buffer_load_dwordx4 v2, s[12:15], s43 offen lds
s_add_u32 m0, s40, 3072
s_add_u32 s43, s38, 147456
buffer_load_dwordx4 v3, s[12:15], s43 offen lds
s_add_u32 m0, s40, 4096
s_add_u32 s43, s38, 196608
buffer_load_dwordx4 v2, s[12:15], s43 offen lds
s_add_u32 m0, s40, 5120
s_add_u32 s43, s38, 245760
buffer_load_dwordx4 v3, s[12:15], s43 offen lds
s_add_u32 m0, s40, 6144
s_add_u32 s43, s38, 294912
buffer_load_dwordx4 v2, s[12:15], s43 offen lds
s_add_u32 m0, s40, 7168
s_add_u32 s43, s38, 344064
buffer_load_dwordx4 v3, s[12:15], s43 offen lds
s_add_u32 s37, s37, 128
s_add_u32 s38, s38, 393216
s_add_u32 m0, s39, 43008
s_mov_b64 exec, s[60:61]
buffer_load_dwordx4 v4, s[8:11], s37 offen lds
s_mov_b64 exec, -1
s_add_u32 m0, s39, 46080
s_nop 0
buffer_load_dwordx4 v5, s[8:11], s37 offen lds
s_add_u32 m0, s39, 49152
s_nop 0
buffer_load_dwordx4 v6, s[8:11], s37 offen lds
s_add_u32 m0, s39, 52224
s_nop 0
buffer_load_dwordx4 v7, s[8:11], s37 offen lds
s_add_u32 m0, s39, 55296
s_nop 0
buffer_load_dwordx4 v8, s[8:11], s37 offen lds
s_add_u32 m0, s39, 58368
s_nop 0
buffer_load_dwordx4 v9, s[8:11], s37 offen lds
s_add_u32 m0, s40, 43008
s_add_u32 s43, s38, 0
buffer_load_dwordx4 v2, s[12:15], s43 offen lds
s_add_u32 m0, s40, 44032
s_add_u32 s43, s38, 49152
buffer_load_dwordx4 v3, s[12:15], s43 offen lds
s_add_u32 m0, s40, 45056
s_add_u32 s43, s38, 98304
buffer_load_dwordx4 v2, s[12:15], s43 offen lds
s_add_u32 m0, s40, 46080
s_add_u32 s43, s38, 147456
buffer_load_dwordx4 v3, s[12:15], s43 offen lds
s_add_u32 m0, s40, 47104
s_add_u32 s43, s38, 196608
buffer_load_dwordx4 v2, s[12:15], s43 offen lds
s_add_u32 m0, s40, 48128
s_add_u32 s43, s38, 245760
buffer_load_dwordx4 v3, s[12:15], s43 offen lds
s_add_u32 m0, s40, 49152
s_add_u32 s43, s38, 294912
buffer_load_dwordx4 v2, s[12:15], s43 offen lds
s_add_u32 m0, s40, 50176
s_add_u32 s43, s38, 344064
buffer_load_dwordx4 v3, s[12:15], s43 offen lds
s_add_u32 s37, s37, 128
s_add_u32 s38, s38, 393216
s_waitcnt vmcnt(14)
s_barrier
s_add_u32 m0, s39, 86016
s_mov_b64 exec, s[60:61]
buffer_load_dwordx4 v4, s[8:11], s37 offen lds
s_mov_b64 exec, -1
s_add_u32 m0, s39, 89088
s_nop 0
buffer_load_dwordx4 v5, s[8:11], s37 offen lds
s_add_u32 m0, s39, 92160
s_nop 0
buffer_load_dwordx4 v6, s[8:11], s37 offen lds
s_add_u32 m0, s39, 95232
s_nop 0
buffer_load_dwordx4 v7, s[8:11], s37 offen lds
s_add_u32 m0, s39, 98304
s_nop 0
buffer_load_dwordx4 v8, s[8:11], s37 offen lds
s_add_u32 m0, s39, 101376
s_nop 0
buffer_load_dwordx4 v9, s[8:11], s37 offen lds
s_add_u32 m0, s40, 86016
s_add_u32 s43, s38, 0
buffer_load_dwordx4 v2, s[12:15], s43 offen lds
s_add_u32 m0, s40, 87040
s_add_u32 s43, s38, 49152
buffer_load_dwordx4 v3, s[12:15], s43 offen lds
s_add_u32 m0, s40, 88064
s_add_u32 s43, s38, 98304
buffer_load_dwordx4 v2, s[12:15], s43 offen lds
s_add_u32 m0, s40, 89088
s_add_u32 s43, s38, 147456
buffer_load_dwordx4 v3, s[12:15], s43 offen lds
s_add_u32 m0, s40, 90112
s_add_u32 s43, s38, 196608
buffer_load_dwordx4 v2, s[12:15], s43 offen lds
s_add_u32 m0, s40, 91136
s_add_u32 s43, s38, 245760
buffer_load_dwordx4 v3, s[12:15], s43 offen lds
s_add_u32 m0, s40, 92160
s_add_u32 s43, s38, 294912
buffer_load_dwordx4 v2, s[12:15], s43 offen lds
s_add_u32 m0, s40, 93184
s_add_u32 s43, s38, 344064
buffer_load_dwordx4 v3, s[12:15], s43 offen lds
s_add_u32 s37, s37, 128
s_add_u32 s38, s38, 393216
s_lshl_b32 s43, s51, 11
buffer_load_dwordx4 v[96:99], v10, s[8:11], s43 offen offset:0
buffer_load_dwordx4 v[100:103], v10, s[8:11], s43 offen offset:1024
buffer_load_dwordx4 v[104:107], v10, s[8:11], s43 offen offset:2048
buffer_load_dwordx4 v[108:111], v10, s[8:11], s43 offen offset:3072
s_lshr_b32 s43, s2, 5
s_cmp_eq_u32 s43, 3
s_cbranch_scc1 Lsj_16
s_cmp_gt_u32 s43, 3
s_cselect_b32 s43, 32, 0
s_sub_u32 s43, s2, s43
s_lshr_b32 s43, s43, 1
s_and_b32 s44, s2, 1
s_lshl_b32 s44, s44, 3
s_add_u32 s44, s44, 32
s_load_dwordx2 s[80:81], s[0:1], s44
s_mul_i32 s45, s43, 2341
s_lshr_b32 s45, s45, 16
s_mul_i32 s46, s45, 28
s_sub_u32 s46, s43, s46
s_lshl_b32 s45, s45, 8
s_mul_i32 s44, s47, 18
s_add_u32 s45, s45, s44
s_add_u32 s45, s45, 184
s_mul_i32 s45, s45, 7168
s_lshl_b32 s46, s46, 8
s_add_u32 s45, s45, s46
s_waitcnt lgkmcnt(0)
s_add_u32 s80, s80, s45
s_addc_u32 s81, s81, 0
Lsj_16:
s_waitcnt vmcnt(18)
s_barrier
s_add_u32 m0, s39, 0
s_mov_b64 exec, s[60:61]
buffer_load_dwordx4 v4, s[8:11], s37 offen lds
s_mov_b64 exec, -1
s_add_u32 m0, s39, 3072
s_nop 0
buffer_load_dwordx4 v5, s[8:11], s37 offen lds
s_add_u32 m0, s39, 6144
s_nop 0
buffer_load_dwordx4 v6, s[8:11], s37 offen lds
s_add_u32 m0, s39, 9216
s_nop 0
buffer_load_dwordx4 v7, s[8:11], s37 offen lds
s_add_u32 m0, s39, 12288
s_nop 0
buffer_load_dwordx4 v8, s[8:11], s37 offen lds
s_add_u32 m0, s39, 15360
s_nop 0
buffer_load_dwordx4 v9, s[8:11], s37 offen lds
s_add_u32 m0, s40, 0
s_add_u32 s43, s38, 0
buffer_load_dwordx4 v2, s[12:15], s43 offen lds
s_add_u32 m0, s40, 1024
s_add_u32 s43, s38, 49152
buffer_load_dwordx4 v3, s[12:15], s43 offen lds
s_add_u32 m0, s40, 2048
s_add_u32 s43, s38, 98304
buffer_load_dwordx4 v2, s[12:15], s43 offen lds
s_add_u32 m0, s40, 3072
s_add_u32 s43, s38, 147456
buffer_load_dwordx4 v3, s[12:15], s43 offen lds
s_add_u32 m0, s40, 4096
s_add_u32 s43, s38, 196608
buffer_load_dwordx4 v2, s[12:15], s43 offen lds
s_add_u32 m0, s40, 5120
s_add_u32 s43, s38, 245760
buffer_load_dwordx4 v3, s[12:15], s43 offen lds
s_add_u32 m0, s40, 6144
s_add_u32 s43, s38, 294912
buffer_load_dwordx4 v2, s[12:15], s43 offen lds
s_add_u32 m0, s40, 7168
s_add_u32 s43, s38, 344064
buffer_load_dwordx4 v3, s[12:15], s43 offen lds
s_add_u32 s37, s37, 128
s_add_u32 s38, s38, 393216
s_waitcnt vmcnt(14)
s_barrier
s_add_u32 m0, s39, 43008
s_mov_b64 exec, s[60:61]
buffer_load_dwordx4 v4, s[8:11], s37 offen lds
s_mov_b64 exec, -1
s_add_u32 m0, s39, 46080
s_nop 0
buffer_load_dwordx4 v5, s[8:11], s37 offen lds
s_add_u32 m0, s39, 49152
s_nop 0
buffer_load_dwordx4 v6, s[8:11], s37 offen lds
s_add_u32 m0, s39, 52224
s_nop 0
buffer_load_dwordx4 v7, s[8:11], s37 offen lds
s_add_u32 m0, s39, 55296
s_nop 0
buffer_load_dwordx4 v8, s[8:11], s37 offen lds
s_add_u32 m0, s39, 58368
s_nop 0
buffer_load_dwordx4 v9, s[8:11], s37 offen lds
s_add_u32 m0, s40, 43008
s_add_u32 s43, s38, 0
buffer_load_dwordx4 v2, s[12:15], s43 offen lds
s_add_u32 m0, s40, 44032
s_add_u32 s43, s38, 49152
buffer_load_dwordx4 v3, s[12:15], s43 offen lds
s_add_u32 m0, s40, 45056
s_add_u32 s43, s38, 98304
buffer_load_dwordx4 v2, s[12:15], s43 offen lds
s_add_u32 m0, s40, 46080
s_add_u32 s43, s38, 147456
buffer_load_dwordx4 v3, s[12:15], s43 offen lds
s_add_u32 m0, s40, 47104
s_add_u32 s43, s38, 196608
buffer_load_dwordx4 v2, s[12:15], s43 offen lds
s_add_u32 m0, s40, 48128
s_add_u32 s43, s38, 245760
buffer_load_dwordx4 v3, s[12:15], s43 offen lds
s_add_u32 m0, s40, 49152
s_add_u32 s43, s38, 294912
buffer_load_dwordx4 v2, s[12:15], s43 offen lds
s_add_u32 m0, s40, 50176
s_add_u32 s43, s38, 344064
buffer_load_dwordx4 v3, s[12:15], s43 offen lds
s_add_u32 s37, s37, 128
s_add_u32 s38, s38, 393216
v_lshlrev_b32 v116, 16, v96
v_and_b32 v117, 0xffff0000, v96
v_mul_f32 v118, v116, v116
v_mul_f32 v119, v117, v117
v_lshlrev_b32 v126, 16, v97
v_and_b32 v127, 0xffff0000, v97
v_add_f32 v116, v116, v126
v_add_f32 v117, v117, v127
v_fmac_f32 v118, v126, v126
v_fmac_f32 v119, v127, v127
v_lshlrev_b32 v124, 16, v98
v_and_b32 v125, 0xffff0000, v98
v_add_f32 v116, v116, v124
v_add_f32 v117, v117, v125
v_fmac_f32 v118, v124, v124
v_fmac_f32 v119, v125, v125
v_lshlrev_b32 v126, 16, v99
v_and_b32 v127, 0xffff0000, v99
v_add_f32 v116, v116, v126
v_add_f32 v117, v117, v127
v_fmac_f32 v118, v126, v126
v_fmac_f32 v119, v127, v127
v_lshlrev_b32 v124, 16, v100
v_and_b32 v125, 0xffff0000, v100
v_add_f32 v116, v116, v124
v_add_f32 v117, v117, v125
v_fmac_f32 v118, v124, v124
v_fmac_f32 v119, v125, v125
v_lshlrev_b32 v126, 16, v101
v_and_b32 v127, 0xffff0000, v101
v_add_f32 v116, v116, v126
v_add_f32 v117, v117, v127
v_fmac_f32 v118, v126, v126
v_fmac_f32 v119, v127, v127
v_lshlrev_b32 v124, 16, v102
v_and_b32 v125, 0xffff0000, v102
v_add_f32 v116, v116, v124
v_add_f32 v117, v117, v125
v_fmac_f32 v118, v124, v124
v_fmac_f32 v119, v125, v125
v_lshlrev_b32 v126, 16, v103
v_and_b32 v127, 0xffff0000, v103
v_add_f32 v116, v116, v126
v_add_f32 v117, v117, v127
v_fmac_f32 v118, v126, v126
v_fmac_f32 v119, v127, v127
v_lshlrev_b32 v120, 16, v104
v_and_b32 v121, 0xffff0000, v104
v_mul_f32 v122, v120, v120
v_mul_f32 v123, v121, v121
s_waitcnt vmcnt(14)
s_barrier
s_add_u32 m0, s39, 86016
s_mov_b64 exec, s[60:61]
buffer_load_dwordx4 v4, s[8:11], s37 offen lds
s_mov_b64 exec, -1
s_add_u32 m0, s39, 89088
s_nop 0
buffer_load_dwordx4 v5, s[8:11], s37 offen lds
s_add_u32 m0, s39, 92160
s_nop 0
buffer_load_dwordx4 v6, s[8:11], s37 offen lds
s_add_u32 m0, s39, 95232
s_nop 0
buffer_load_dwordx4 v7, s[8:11], s37 offen lds
s_add_u32 m0, s39, 98304
s_nop 0
buffer_load_dwordx4 v8, s[8:11], s37 offen lds
s_add_u32 m0, s39, 101376
s_nop 0
buffer_load_dwordx4 v9, s[8:11], s37 offen lds
s_add_u32 m0, s40, 86016
s_add_u32 s43, s38, 0
buffer_load_dwordx4 v2, s[12:15], s43 offen lds
s_add_u32 m0, s40, 87040
s_add_u32 s43, s38, 49152
buffer_load_dwordx4 v3, s[12:15], s43 offen lds
s_add_u32 m0, s40, 88064
s_add_u32 s43, s38, 98304
buffer_load_dwordx4 v2, s[12:15], s43 offen lds
s_add_u32 m0, s40, 89088
s_add_u32 s43, s38, 147456
buffer_load_dwordx4 v3, s[12:15], s43 offen lds
s_add_u32 m0, s40, 90112
s_add_u32 s43, s38, 196608
buffer_load_dwordx4 v2, s[12:15], s43 offen lds
s_add_u32 m0, s40, 91136
s_add_u32 s43, s38, 245760
buffer_load_dwordx4 v3, s[12:15], s43 offen lds
s_add_u32 m0, s40, 92160
s_add_u32 s43, s38, 294912
buffer_load_dwordx4 v2, s[12:15], s43 offen lds
s_add_u32 m0, s40, 93184
s_add_u32 s43, s38, 344064
buffer_load_dwordx4 v3, s[12:15], s43 offen lds
s_add_u32 s37, s37, 128
s_add_u32 s38, s38, 393216
v_lshlrev_b32 v126, 16, v105
v_and_b32 v127, 0xffff0000, v105
v_add_f32 v120, v120, v126
v_add_f32 v121, v121, v127
v_fmac_f32 v122, v126, v126
v_fmac_f32 v123, v127, v127
v_lshlrev_b32 v124, 16, v106
v_and_b32 v125, 0xffff0000, v106
v_add_f32 v120, v120, v124
v_add_f32 v121, v121, v125
v_fmac_f32 v122, v124, v124
v_fmac_f32 v123, v125, v125
v_lshlrev_b32 v126, 16, v107
v_and_b32 v127, 0xffff0000, v107
v_add_f32 v120, v120, v126
v_add_f32 v121, v121, v127
v_fmac_f32 v122, v126, v126
v_fmac_f32 v123, v127, v127
v_lshlrev_b32 v124, 16, v108
v_and_b32 v125, 0xffff0000, v108
v_add_f32 v120, v120, v124
v_add_f32 v121, v121, v125
v_fmac_f32 v122, v124, v124
v_fmac_f32 v123, v125, v125
v_lshlrev_b32 v126, 16, v109
v_and_b32 v127, 0xffff0000, v109
v_add_f32 v120, v120, v126
v_add_f32 v121, v121, v127
v_fmac_f32 v122, v126, v126
v_fmac_f32 v123, v127, v127
v_lshlrev_b32 v124, 16, v110
v_and_b32 v125, 0xffff0000, v110
v_add_f32 v120, v120, v124
v_add_f32 v121, v121, v125
v_fmac_f32 v122, v124, v124
v_fmac_f32 v123, v125, v125
v_lshlrev_b32 v126, 16, v111
v_and_b32 v127, 0xffff0000, v111
v_add_f32 v120, v120, v126
v_add_f32 v121, v121, v127
v_fmac_f32 v122, v126, v126
v_fmac_f32 v123, v127, v127
v_add_f32 v116, v116, v117
v_add_f32 v118, v118, v119
v_add_f32 v120, v120, v121
v_add_f32 v122, v122, v123
v_add_f32_dpp v116, v116, v116 row_ror:8 row_mask:0xf bank_mask:0xf
v_add_f32_dpp v118, v118, v118 row_ror:8 row_mask:0xf bank_mask:0xf
v_add_f32_dpp v120, v120, v120 row_ror:8 row_mask:0xf bank_mask:0xf
v_add_f32_dpp v122, v122, v122 row_ror:8 row_mask:0xf bank_mask:0xf
v_mov_b32 v128, -1
v_mov_b32 v129, -1
v_mov_b32 v130, -1
v_mov_b32 v131, -1
s_mul_i32 s28, s47, 5120
buffer_store_dwordx4 v[128:131], v10, s[16:19], s28 offen sc1
s_add_u32 s28, s28, 1024
buffer_store_dwordx4 v[128:131], v10, s[16:19], s28 offen sc1
s_add_u32 s28, s28, 1024
s_waitcnt vmcnt(16)
s_barrier
s_add_u32 m0, s39, 0
s_mov_b64 exec, s[60:61]
buffer_load_dwordx4 v4, s[8:11], s37 offen lds
s_mov_b64 exec, -1
s_add_u32 m0, s39, 3072
s_nop 0
buffer_load_dwordx4 v5, s[8:11], s37 offen lds
s_add_u32 m0, s39, 6144
s_nop 0
buffer_load_dwordx4 v6, s[8:11], s37 offen lds
s_add_u32 m0, s39, 9216
s_nop 0
buffer_load_dwordx4 v7, s[8:11], s37 offen lds
s_add_u32 m0, s39, 12288
s_nop 0
buffer_load_dwordx4 v8, s[8:11], s37 offen lds
s_add_u32 m0, s39, 15360
s_nop 0
buffer_load_dwordx4 v9, s[8:11], s37 offen lds
s_add_u32 m0, s40, 0
s_add_u32 s43, s38, 0
buffer_load_dwordx4 v2, s[12:15], s43 offen lds
s_add_u32 m0, s40, 1024
s_add_u32 s43, s38, 49152
buffer_load_dwordx4 v3, s[12:15], s43 offen lds
s_add_u32 m0, s40, 2048
s_add_u32 s43, s38, 98304
buffer_load_dwordx4 v2, s[12:15], s43 offen lds
s_add_u32 m0, s40, 3072
s_add_u32 s43, s38, 147456
buffer_load_dwordx4 v3, s[12:15], s43 offen lds
s_add_u32 m0, s40, 4096
s_add_u32 s43, s38, 196608
buffer_load_dwordx4 v2, s[12:15], s43 offen lds
s_add_u32 m0, s40, 5120
s_add_u32 s43, s38, 245760
buffer_load_dwordx4 v3, s[12:15], s43 offen lds
s_add_u32 m0, s40, 6144
s_add_u32 s43, s38, 294912
buffer_load_dwordx4 v2, s[12:15], s43 offen lds
s_add_u32 m0, s40, 7168
s_add_u32 s43, s38, 344064
buffer_load_dwordx4 v3, s[12:15], s43 offen lds
s_add_u32 s37, s37, 128
s_add_u32 s38, s38, 393216
v_add_f32_dpp v116, v116, v116 row_ror:4 row_mask:0xf bank_mask:0xf
v_add_f32_dpp v118, v118, v118 row_ror:4 row_mask:0xf bank_mask:0xf
v_add_f32_dpp v120, v120, v120 row_ror:4 row_mask:0xf bank_mask:0xf
v_add_f32_dpp v122, v122, v122 row_ror:4 row_mask:0xf bank_mask:0xf
v_add_f32_dpp v116, v116, v116 row_ror:2 row_mask:0xf bank_mask:0xf
v_add_f32_dpp v118, v118, v118 row_ror:2 row_mask:0xf bank_mask:0xf
v_add_f32_dpp v120, v120, v120 row_ror:2 row_mask:0xf bank_mask:0xf
v_add_f32_dpp v122, v122, v122 row_ror:2 row_mask:0xf bank_mask:0xf
v_add_f32_dpp v116, v116, v116 row_ror:1 row_mask:0xf bank_mask:0xf
v_add_f32_dpp v118, v118, v118 row_ror:1 row_mask:0xf bank_mask:0xf
v_add_f32_dpp v120, v120, v120 row_ror:1 row_mask:0xf bank_mask:0xf
v_add_f32_dpp v122, v122, v122 row_ror:1 row_mask:0xf bank_mask:0xf
v_mov_b32 v117, v116
v_mov_b32 v119, v118
v_mov_b32 v121, v120
v_mov_b32 v123, v122
s_nop 0
v_permlane16_swap_b32 v116, v117
v_permlane16_swap_b32 v118, v119
v_permlane16_swap_b32 v120, v121
v_permlane16_swap_b32 v122, v123
v_add_f32 v116, v116, v117
v_add_f32 v118, v118, v119
v_add_f32 v120, v120, v121
v_add_f32 v122, v122, v123
v_mov_b32 v117, v116
v_mov_b32 v119, v118
v_mov_b32 v121, v120
v_mov_b32 v123, v122
s_nop 0
v_permlane32_swap_b32 v116, v117
v_permlane32_swap_b32 v118, v119
v_permlane32_swap_b32 v120, v121
v_permlane32_swap_b32 v122, v123
v_add_f32 v116, v116, v117
v_add_f32 v118, v118, v119
v_add_f32 v120, v120, v121
v_add_f32 v122, v122, v123
v_mul_f32 v112, 0x3a800000, v116
v_mul_f32 v113, 0x3a800000, v118
v_fma_f32 v113, -v112, v112, v113
v_max_f32 v113, 0, v113
v_add_f32 v113, 0x3727c5ac, v113
v_rsq_f32 v113, v113
v_mul_f32 v114, 0x3a800000, v120
v_mul_f32 v115, 0x3a800000, v122
v_fma_f32 v115, -v114, v114, v115
v_max_f32 v115, 0, v115
v_add_f32 v115, 0x3727c5ac, v115
v_rsq_f32 v115, v115
s_nop 0
s_lshl_b32 s43, s47, 4
s_add_u32 s43, s43, 130176
v_mov_b32 v11, s43
ds_write_b128 v11, v[112:115]
s_waitcnt lgkmcnt(0)
buffer_store_dwordx4 v[128:131], v10, s[16:19], s28 offen sc1
s_add_u32 s28, s28, 1024
buffer_store_dwordx4 v[128:131], v10, s[16:19], s28 offen sc1
s_add_u32 s28, s28, 1024
s_load_dword s64, s[80:81], 0
s_load_dword s65, s[80:81], 64
s_load_dword s66, s[80:81], 128
s_load_dword s67, s[80:81], 192
s_load_dword s68, s[80:81], 7168
s_load_dword s69, s[80:81], 7232
s_load_dword s70, s[80:81], 7296
s_load_dword s71, s[80:81], 7360
s_add_u32 s80, s80, 14336
s_addc_u32 s81, s81, 0
s_waitcnt vmcnt(18)
s_barrier
s_add_u32 m0, s39, 43008
s_mov_b64 exec, s[60:61]
buffer_load_dwordx4 v4, s[8:11], s37 offen lds
s_mov_b64 exec, -1
s_add_u32 m0, s39, 46080
s_nop 0
buffer_load_dwordx4 v5, s[8:11], s37 offen lds
s_add_u32 m0, s39, 49152
s_nop 0
buffer_load_dwordx4 v6, s[8:11], s37 offen lds
s_add_u32 m0, s39, 52224
s_nop 0
buffer_load_dwordx4 v7, s[8:11], s37 offen lds
s_add_u32 m0, s39, 55296
s_nop 0
buffer_load_dwordx4 v8, s[8:11], s37 offen lds
s_add_u32 m0, s39, 58368
s_nop 0
buffer_load_dwordx4 v9, s[8:11], s37 offen lds
s_add_u32 m0, s40, 43008
s_add_u32 s43, s38, 0
buffer_load_dwordx4 v2, s[12:15], s43 offen lds
s_add_u32 m0, s40, 44032
s_add_u32 s43, s38, 49152
buffer_load_dwordx4 v3, s[12:15], s43 offen lds
s_add_u32 m0, s40, 45056
s_add_u32 s43, s38, 98304
buffer_load_dwordx4 v2, s[12:15], s43 offen lds
s_add_u32 m0, s40, 46080
s_add_u32 s43, s38, 147456
buffer_load_dwordx4 v3, s[12:15], s43 offen lds
s_add_u32 m0, s40, 47104
s_add_u32 s43, s38, 196608
buffer_load_dwordx4 v2, s[12:15], s43 offen lds
s_add_u32 m0, s40, 48128
s_add_u32 s43, s38, 245760
buffer_load_dwordx4 v3, s[12:15], s43 offen lds
s_add_u32 m0, s40, 49152
s_add_u32 s43, s38, 294912
buffer_load_dwordx4 v2, s[12:15], s43 offen lds
s_add_u32 m0, s40, 50176
s_add_u32 s43, s38, 344064
buffer_load_dwordx4 v3, s[12:15], s43 offen lds
s_add_u32 s37, s37, 128
s_add_u32 s38, s38, 393216
buffer_store_dwordx4 v[128:131], v10, s[16:19], s28 offen sc1
s_add_u32 s28, s28, 1024
buffer_store_dwordx4 v[128:131], v10, s[16:19], s28 offen sc1
s_add_u32 s28, s28, 1024
s_load_dword s64, s[80:81], 0
s_load_dword s65, s[80:81], 64
s_load_dword s66, s[80:81], 128
s_load_dword s67, s[80:81], 192
s_load_dword s68, s[80:81], 7168
s_load_dword s69, s[80:81], 7232
s_load_dword s70, s[80:81], 7296
s_load_dword s71, s[80:81], 7360
s_add_u32 s80, s80, 14336
s_addc_u32 s81, s81, 0
s_waitcnt vmcnt(18)
s_barrier
s_add_u32 m0, s39, 86016
s_mov_b64 exec, s[60:61]
buffer_load_dwordx4 v4, s[8:11], s37 offen lds
s_mov_b64 exec, -1
s_add_u32 m0, s39, 89088
s_nop 0
buffer_load_dwordx4 v5, s[8:11], s37 offen lds
s_add_u32 m0, s39, 92160
s_nop 0
buffer_load_dwordx4 v6, s[8:11], s37 offen lds
s_add_u32 m0, s39, 95232
s_nop 0
buffer_load_dwordx4 v7, s[8:11], s37 offen lds
s_add_u32 m0, s39, 98304
s_nop 0
buffer_load_dwordx4 v8, s[8:11], s37 offen lds
s_add_u32 m0, s39, 101376
s_nop 0
buffer_load_dwordx4 v9, s[8:11], s37 offen lds
s_add_u32 m0, s40, 86016
s_add_u32 s43, s38, 0
buffer_load_dwordx4 v2, s[12:15], s43 offen lds
s_add_u32 m0, s40, 87040
s_add_u32 s43, s38, 49152
buffer_load_dwordx4 v3, s[12:15], s43 offen lds
s_add_u32 m0, s40, 88064
s_add_u32 s43, s38, 98304
buffer_load_dwordx4 v2, s[12:15], s43 offen lds
s_add_u32 m0, s40, 89088
s_add_u32 s43, s38, 147456
buffer_load_dwordx4 v3, s[12:15], s43 offen lds
s_add_u32 m0, s40, 90112
s_add_u32 s43, s38, 196608
buffer_load_dwordx4 v2, s[12:15], s43 offen lds
s_add_u32 m0, s40, 91136
s_add_u32 s43, s38, 245760
buffer_load_dwordx4 v3, s[12:15], s43 offen lds
s_add_u32 m0, s40, 92160
s_add_u32 s43, s38, 294912
buffer_load_dwordx4 v2, s[12:15], s43 offen lds
s_add_u32 m0, s40, 93184
s_add_u32 s43, s38, 344064
buffer_load_dwordx4 v3, s[12:15], s43 offen lds
s_add_u32 s37, s37, 128
s_add_u32 s38, s38, 393216
s_add_u32 s24, s16, 4194304
s_addc_u32 s25, s17, 0
s_mov_b32 s26, 16384
s_mov_b32 s27, 0x20000
s_mul_i32 s28, s47, 5120
buffer_store_dwordx4 v[128:131], v10, s[24:27], s28 offen sc1
s_add_u32 s28, s28, 1024
s_load_dword s64, s[80:81], 0
s_load_dword s65, s[80:81], 64
s_load_dword s66, s[80:81], 128
s_load_dword s67, s[80:81], 192
s_load_dword s68, s[80:81], 7168
s_load_dword s69, s[80:81], 7232
s_load_dword s70, s[80:81], 7296
s_load_dword s71, s[80:81], 7360
s_add_u32 s80, s80, 14336
s_addc_u32 s81, s81, 0
s_waitcnt vmcnt(17)
s_barrier
s_add_u32 m0, s39, 0
s_mov_b64 exec, s[60:61]
buffer_load_dwordx4 v4, s[8:11], s37 offen lds
s_mov_b64 exec, -1
s_add_u32 m0, s39, 3072
s_nop 0
buffer_load_dwordx4 v5, s[8:11], s37 offen lds
s_add_u32 m0, s39, 6144
s_nop 0
buffer_load_dwordx4 v6, s[8:11], s37 offen lds
s_add_u32 m0, s39, 9216
s_nop 0
buffer_load_dwordx4 v7, s[8:11], s37 offen lds
s_add_u32 m0, s39, 12288
s_nop 0
buffer_load_dwordx4 v8, s[8:11], s37 offen lds
s_add_u32 m0, s39, 15360
s_nop 0
buffer_load_dwordx4 v9, s[8:11], s37 offen lds
s_add_u32 m0, s40, 0
s_add_u32 s43, s38, 0
buffer_load_dwordx4 v2, s[12:15], s43 offen lds
s_add_u32 m0, s40, 1024
s_add_u32 s43, s38, 49152
buffer_load_dwordx4 v3, s[12:15], s43 offen lds
s_add_u32 m0, s40, 2048
s_add_u32 s43, s38, 98304
buffer_load_dwordx4 v2, s[12:15], s43 offen lds
s_add_u32 m0, s40, 3072
s_add_u32 s43, s38, 147456
buffer_load_dwordx4 v3, s[12:15], s43 offen lds
s_add_u32 m0, s40, 4096
s_add_u32 s43, s38, 196608
buffer_load_dwordx4 v2, s[12:15], s43 offen lds
s_add_u32 m0, s40, 5120
s_add_u32 s43, s38, 245760
buffer_load_dwordx4 v3, s[12:15], s43 offen lds
s_add_u32 m0, s40, 6144
s_add_u32 s43, s38, 294912
buffer_load_dwordx4 v2, s[12:15], s43 offen lds
s_add_u32 m0, s40, 7168
s_add_u32 s43, s38, 344064
buffer_load_dwordx4 v3, s[12:15], s43 offen lds
s_add_u32 s37, s37, 128
s_add_u32 s38, s38, 393216
buffer_store_dwordx4 v[128:131], v10, s[24:27], s28 offen sc1
s_add_u32 s28, s28, 1024
s_load_dword s64, s[80:81], 0
s_load_dword s65, s[80:81], 64
s_load_dword s66, s[80:81], 128
s_load_dword s67, s[80:81], 192
s_load_dword s68, s[80:81], 7168
s_load_dword s69, s[80:81], 7232
s_load_dword s70, s[80:81], 7296
s_load_dword s71, s[80:81], 7360
s_add_u32 s80, s80, 14336
s_addc_u32 s81, s81, 0
s_waitcnt vmcnt(16)
s_barrier
s_add_u32 m0, s39, 43008
s_mov_b64 exec, s[60:61]
buffer_load_dwordx4 v4, s[8:11], s37 offen lds
s_mov_b64 exec, -1
s_add_u32 m0, s39, 46080
s_nop 0
buffer_load_dwordx4 v5, s[8:11], s37 offen lds
s_add_u32 m0, s39, 49152
s_nop 0
buffer_load_dwordx4 v6, s[8:11], s37 offen lds
s_add_u32 m0, s39, 52224
s_nop 0
buffer_load_dwordx4 v7, s[8:11], s37 offen lds
s_add_u32 m0, s39, 55296
s_nop 0
buffer_load_dwordx4 v8, s[8:11], s37 offen lds
s_add_u32 m0, s39, 58368
s_nop 0
buffer_load_dwordx4 v9, s[8:11], s37 offen lds
s_add_u32 m0, s40, 43008
s_add_u32 s43, s38, 0
buffer_load_dwordx4 v2, s[12:15], s43 offen lds
s_add_u32 m0, s40, 44032
s_add_u32 s43, s38, 49152
buffer_load_dwordx4 v3, s[12:15], s43 offen lds
s_add_u32 m0, s40, 45056
s_add_u32 s43, s38, 98304
buffer_load_dwordx4 v2, s[12:15], s43 offen lds
s_add_u32 m0, s40, 46080
s_add_u32 s43, s38, 147456
buffer_load_dwordx4 v3, s[12:15], s43 offen lds
s_add_u32 m0, s40, 47104
s_add_u32 s43, s38, 196608
buffer_load_dwordx4 v2, s[12:15], s43 offen lds
s_add_u32 m0, s40, 48128
s_add_u32 s43, s38, 245760
buffer_load_dwordx4 v3, s[12:15], s43 offen lds
s_add_u32 m0, s40, 49152
s_add_u32 s43, s38, 294912
buffer_load_dwordx4 v2, s[12:15], s43 offen lds
s_add_u32 m0, s40, 50176
s_add_u32 s43, s38, 344064
buffer_load_dwordx4 v3, s[12:15], s43 offen lds
s_add_u32 s37, s37, 128
s_add_u32 s38, s38, 393216
buffer_store_dwordx4 v[128:131], v10, s[24:27], s28 offen sc1
s_add_u32 s28, s28, 1024
s_load_dword s64, s[80:81], 0
s_load_dword s65, s[80:81], 64
s_load_dword s66, s[80:81], 128
s_load_dword s67, s[80:81], 192
s_load_dword s68, s[80:81], 7168
s_load_dword s69, s[80:81], 7232
s_load_dword s70, s[80:81], 7296
s_load_dword s71, s[80:81], 7360
s_add_u32 s80, s80, 14336
s_addc_u32 s81, s81, 0
s_waitcnt vmcnt(16)
s_barrier
s_add_u32 m0, s39, 86016
s_mov_b64 exec, s[60:61]
buffer_load_dwordx4 v4, s[8:11], s37 offen lds
s_mov_b64 exec, -1
s_add_u32 m0, s39, 89088
s_nop 0
buffer_load_dwordx4 v5, s[8:11], s37 offen lds
s_add_u32 m0, s39, 92160
s_nop 0
buffer_load_dwordx4 v6, s[8:11], s37 offen lds
s_add_u32 m0, s39, 95232
s_nop 0
buffer_load_dwordx4 v7, s[8:11], s37 offen lds
s_add_u32 m0, s39, 98304
s_nop 0
buffer_load_dwordx4 v8, s[8:11], s37 offen lds
s_add_u32 m0, s39, 101376
s_nop 0
buffer_load_dwordx4 v9, s[8:11], s37 offen lds
s_add_u32 m0, s40, 86016
s_add_u32 s43, s38, 0
buffer_load_dwordx4 v2, s[12:15], s43 offen lds
s_add_u32 m0, s40, 87040
s_add_u32 s43, s38, 49152
buffer_load_dwordx4 v3, s[12:15], s43 offen lds
s_add_u32 m0, s40, 88064
s_add_u32 s43, s38, 98304
buffer_load_dwordx4 v2, s[12:15], s43 offen lds
s_add_u32 m0, s40, 89088
s_add_u32 s43, s38, 147456
buffer_load_dwordx4 v3, s[12:15], s43 offen lds
s_add_u32 m0, s40, 90112
s_add_u32 s43, s38, 196608
buffer_load_dwordx4 v2, s[12:15], s43 offen lds
s_add_u32 m0, s40, 91136
s_add_u32 s43, s38, 245760
buffer_load_dwordx4 v3, s[12:15], s43 offen lds
s_add_u32 m0, s40, 92160
s_add_u32 s43, s38, 294912
buffer_load_dwordx4 v2, s[12:15], s43 offen lds
s_add_u32 m0, s40, 93184
s_add_u32 s43, s38, 344064
buffer_load_dwordx4 v3, s[12:15], s43 offen lds
s_add_u32 s37, s37, 128
s_add_u32 s38, s38, 393216
buffer_store_dwordx4 v[128:131], v10, s[24:27], s28 offen sc1
s_add_u32 s28, s28, 1024
s_load_dword s64, s[80:81], 0
s_load_dword s65, s[80:81], 64
s_load_dword s66, s[80:81], 128
s_load_dword s67, s[80:81], 192
s_load_dword s68, s[80:81], 7168
s_load_dword s69, s[80:81], 7232
s_load_dword s70, s[80:81], 7296
s_load_dword s71, s[80:81], 7360
s_add_u32 s80, s80, 14336
s_addc_u32 s81, s81, 0
s_waitcnt vmcnt(16)
s_barrier
s_add_u32 m0, s39, 0
s_mov_b64 exec, s[60:61]
buffer_load_dwordx4 v4, s[8:11], s37 offen lds
s_mov_b64 exec, -1
s_add_u32 m0, s39, 3072
s_nop 0
buffer_load_dwordx4 v5, s[8:11], s37 offen lds
s_add_u32 m0, s39, 6144
s_nop 0
buffer_load_dwordx4 v6, s[8:11], s37 offen lds
s_add_u32 m0, s39, 9216
s_nop 0
buffer_load_dwordx4 v7, s[8:11], s37 offen lds
s_add_u32 m0, s39, 12288
s_nop 0
buffer_load_dwordx4 v8, s[8:11], s37 offen lds
s_add_u32 m0, s39, 15360
s_nop 0
buffer_load_dwordx4 v9, s[8:11], s37 offen lds
s_add_u32 m0, s40, 0
s_add_u32 s43, s38, 0
buffer_load_dwordx4 v2, s[12:15], s43 offen lds
s_add_u32 m0, s40, 1024
s_add_u32 s43, s38, 49152
buffer_load_dwordx4 v3, s[12:15], s43 offen lds
s_add_u32 m0, s40, 2048
s_add_u32 s43, s38, 98304
buffer_load_dwordx4 v2, s[12:15], s43 offen lds
s_add_u32 m0, s40, 3072
s_add_u32 s43, s38, 147456
buffer_load_dwordx4 v3, s[12:15], s43 offen lds
s_add_u32 m0, s40, 4096
s_add_u32 s43, s38, 196608
buffer_load_dwordx4 v2, s[12:15], s43 offen lds
s_add_u32 m0, s40, 5120
s_add_u32 s43, s38, 245760
buffer_load_dwordx4 v3, s[12:15], s43 offen lds
s_add_u32 m0, s40, 6144
s_add_u32 s43, s38, 294912
buffer_load_dwordx4 v2, s[12:15], s43 offen lds
s_add_u32 m0, s40, 7168
s_add_u32 s43, s38, 344064
buffer_load_dwordx4 v3, s[12:15], s43 offen lds
s_add_u32 s37, s37, 128
s_add_u32 s38, s38, 393216
buffer_store_dwordx4 v[128:131], v10, s[24:27], s28 offen sc1
s_add_u32 s28, s28, 1024
s_load_dword s64, s[80:81], 0
s_load_dword s65, s[80:81], 64
s_load_dword s66, s[80:81], 128
s_load_dword s67, s[80:81], 192
s_load_dword s68, s[80:81], 7168
s_load_dword s69, s[80:81], 7232
s_load_dword s70, s[80:81], 7296
s_load_dword s71, s[80:81], 7360
s_add_u32 s80, s80, 14336
s_addc_u32 s81, s81, 0
s_waitcnt vmcnt(16)
s_barrier
s_add_u32 m0, s39, 43008
s_mov_b64 exec, s[60:61]
buffer_load_dwordx4 v4, s[8:11], s37 offen lds
s_mov_b64 exec, -1
s_add_u32 m0, s39, 46080
s_nop 0
buffer_load_dwordx4 v5, s[8:11], s37 offen lds
s_add_u32 m0, s39, 49152
s_nop 0
buffer_load_dwordx4 v6, s[8:11], s37 offen lds
s_add_u32 m0, s39, 52224
s_nop 0
buffer_load_dwordx4 v7, s[8:11], s37 offen lds
s_add_u32 m0, s39, 55296
s_nop 0
buffer_load_dwordx4 v8, s[8:11], s37 offen lds
s_add_u32 m0, s39, 58368
s_nop 0
buffer_load_dwordx4 v9, s[8:11], s37 offen lds
s_add_u32 m0, s40, 43008
s_add_u32 s43, s38, 0
buffer_load_dwordx4 v2, s[12:15], s43 offen lds
s_add_u32 m0, s40, 44032
s_add_u32 s43, s38, 49152
buffer_load_dwordx4 v3, s[12:15], s43 offen lds
s_add_u32 m0, s40, 45056
s_add_u32 s43, s38, 98304
buffer_load_dwordx4 v2, s[12:15], s43 offen lds
s_add_u32 m0, s40, 46080
s_add_u32 s43, s38, 147456
buffer_load_dwordx4 v3, s[12:15], s43 offen lds
s_add_u32 m0, s40, 47104
s_add_u32 s43, s38, 196608
buffer_load_dwordx4 v2, s[12:15], s43 offen lds
s_add_u32 m0, s40, 48128
s_add_u32 s43, s38, 245760
buffer_load_dwordx4 v3, s[12:15], s43 offen lds
s_add_u32 m0, s40, 49152
s_add_u32 s43, s38, 294912
buffer_load_dwordx4 v2, s[12:15], s43 offen lds
s_add_u32 m0, s40, 50176
s_add_u32 s43, s38, 344064
buffer_load_dwordx4 v3, s[12:15], s43 offen lds
s_add_u32 s37, s37, 128
s_add_u32 s38, s38, 393216
buffer_store_dwordx4 v[128:131], v10, s[24:27], s28 offen sc1
s_add_u32 s28, s28, 1024
s_load_dword s64, s[80:81], 0
s_load_dword s65, s[80:81], 64
s_load_dword s66, s[80:81], 128
s_load_dword s67, s[80:81], 192
s_load_dword s68, s[80:81], 7168
s_load_dword s69, s[80:81], 7232
s_load_dword s70, s[80:81], 7296
s_load_dword s71, s[80:81], 7360
s_add_u32 s80, s80, 14336
s_addc_u32 s81, s81, 0
s_waitcnt vmcnt(16)
s_barrier
s_add_u32 m0, s39, 86016
s_mov_b64 exec, s[60:61]
buffer_load_dwordx4 v4, s[8:11], s37 offen lds
s_mov_b64 exec, -1
s_add_u32 m0, s39, 89088
s_nop 0
buffer_load_dwordx4 v5, s[8:11], s37 offen lds
s_add_u32 m0, s39, 92160
s_nop 0
buffer_load_dwordx4 v6, s[8:11], s37 offen lds
s_add_u32 m0, s39, 95232
s_nop 0
buffer_load_dwordx4 v7, s[8:11], s37 offen lds
s_add_u32 m0, s39, 98304
s_nop 0
buffer_load_dwordx4 v8, s[8:11], s37 offen lds
s_add_u32 m0, s39, 101376
s_nop 0
buffer_load_dwordx4 v9, s[8:11], s37 offen lds
s_add_u32 m0, s40, 86016
s_add_u32 s43, s38, 0
buffer_load_dwordx4 v2, s[12:15], s43 offen lds
s_add_u32 m0, s40, 87040
s_add_u32 s43, s38, 49152
buffer_load_dwordx4 v3, s[12:15], s43 offen lds
s_add_u32 m0, s40, 88064
s_add_u32 s43, s38, 98304
buffer_load_dwordx4 v2, s[12:15], s43 offen lds
s_add_u32 m0, s40, 89088
s_add_u32 s43, s38, 147456
buffer_load_dwordx4 v3, s[12:15], s43 offen lds
s_add_u32 m0, s40, 90112
s_add_u32 s43, s38, 196608
buffer_load_dwordx4 v2, s[12:15], s43 offen lds
s_add_u32 m0, s40, 91136
s_add_u32 s43, s38, 245760
buffer_load_dwordx4 v3, s[12:15], s43 offen lds
s_add_u32 m0, s40, 92160
s_add_u32 s43, s38, 294912
buffer_load_dwordx4 v2, s[12:15], s43 offen lds
s_add_u32 m0, s40, 93184
s_add_u32 s43, s38, 344064
buffer_load_dwordx4 v3, s[12:15], s43 offen lds
s_add_u32 s37, s37, 128
s_add_u32 s38, s38, 393216
s_load_dword s64, s[80:81], 0
s_load_dword s65, s[80:81], 64
s_load_dword s66, s[80:81], 128
s_load_dword s67, s[80:81], 192
s_load_dword s68, s[80:81], 7168
s_load_dword s69, s[80:81], 7232
s_load_dword s70, s[80:81], 7296
s_load_dword s71, s[80:81], 7360
s_add_u32 s80, s80, 14336
s_addc_u32 s81, s81, 0
s_waitcnt vmcnt(15)
s_barrier
s_add_u32 m0, s39, 0
s_mov_b64 exec, s[60:61]
buffer_load_dwordx4 v4, s[8:11], s37 offen lds
s_mov_b64 exec, -1
s_add_u32 m0, s39, 3072
s_nop 0
buffer_load_dwordx4 v5, s[8:11], s37 offen lds
s_add_u32 m0, s39, 6144
s_nop 0
buffer_load_dwordx4 v6, s[8:11], s37 offen lds
s_add_u32 m0, s39, 9216
s_nop 0
buffer_load_dwordx4 v7, s[8:11], s37 offen lds
s_add_u32 m0, s39, 12288
s_nop 0
buffer_load_dwordx4 v8, s[8:11], s37 offen lds
s_add_u32 m0, s39, 15360
s_nop 0
buffer_load_dwordx4 v9, s[8:11], s37 offen lds
s_add_u32 m0, s40, 0
s_add_u32 s43, s38, 0
buffer_load_dwordx4 v2, s[12:15], s43 offen lds
s_add_u32 m0, s40, 1024
s_add_u32 s43, s38, 49152
buffer_load_dwordx4 v3, s[12:15], s43 offen lds
s_add_u32 m0, s40, 2048
s_add_u32 s43, s38, 98304
buffer_load_dwordx4 v2, s[12:15], s43 offen lds
s_add_u32 m0, s40, 3072
s_add_u32 s43, s38, 147456
buffer_load_dwordx4 v3, s[12:15], s43 offen lds
s_add_u32 m0, s40, 4096
s_add_u32 s43, s38, 196608
buffer_load_dwordx4 v2, s[12:15], s43 offen lds
s_add_u32 m0, s40, 5120
s_add_u32 s43, s38, 245760
buffer_load_dwordx4 v3, s[12:15], s43 offen lds
s_add_u32 m0, s40, 6144
s_add_u32 s43, s38, 294912
buffer_load_dwordx4 v2, s[12:15], s43 offen lds
s_add_u32 m0, s40, 7168
s_add_u32 s43, s38, 344064
buffer_load_dwordx4 v3, s[12:15], s43 offen lds
s_add_u32 s37, s37, 128
s_add_u32 s38, s38, 393216
s_waitcnt vmcnt(14)
s_barrier
s_waitcnt vmcnt(0)
s_barrier
s_barrier
s_cmp_eq_u32 s47, 0
s_cbranch_scc1 Lx_17
s_cmp_eq_u32 s47, 1
s_cbranch_scc1 Lx_18
s_branch Lw_20
Lr_21:
s_branch Lx_19
Lx_18:
s_branch Lw_22
Lr_23:
s_branch Lx_19
Lx_17:
s_branch Lw_24
Lr_25:
Lx_19:
s_waitcnt lgkmcnt(0)
s_and_b32 s43, s36, 1
s_lshr_b32 s44, s36, 1
s_and_b32 s44, s44, 1
s_lshr_b32 s45, s36, 2
s_xor_b32 s45, s45, 1
v_lshlrev_b32 v14, 2, v13
v_sub_u32 v14, v12, v14
v_subrev_u32 v15, 0, v14
v_cmp_ge_u32 s[52:53], 7, v15
v_add_u32 v15, 16, v15
v_cmp_ge_u32 s[84:85], 7, v15
v_subrev_u32 v15, 1, v14
v_cmp_ge_u32 s[54:55], 7, v15
v_add_u32 v15, 16, v15
v_cmp_ge_u32 s[86:87], 7, v15
v_subrev_u32 v15, 2, v14
v_cmp_ge_u32 s[56:57], 7, v15
v_add_u32 v15, 16, v15
v_cmp_ge_u32 s[88:89], 7, v15
v_subrev_u32 v15, 3, v14
v_cmp_ge_u32 s[58:59], 7, v15
v_add_u32 v15, 16, v15
v_cmp_ge_u32 s[90:91], 7, v15
s_lshl_b32 s46, s45, 6
s_add_u32 s46, s46, s44
s_add_u32 s46, s46, 16
v_lshl_add_u32 v14, v12, 1, s46
s_lshl_b32 s47, s43, 6
v_lshl_add_u32 v15, v13, 4, s47
v_mul_u32_u24 v20, 400, v14
v_add_u32 v20, v20, v15
v_subrev_u32 v16, 32, v14
v_max_i32 v16, 0, v16
v_mul_u32_u24 v21, 400, v16
v_add_u32 v21, v21, v15
v_lshrrev_b32 v16, 2, v12
v_lshl_add_u32 v16, v13, 2, v16
v_lshl_add_u32 v16, v16, 1, s46
v_and_b32 v17, 3, v1
v_lshl_add_u32 v17, v17, 3, s47
v_mul_u32_u24 v22, 400, v16
v_add_u32 v22, v22, v17
v_subrev_u32 v16, 32, v16
v_max_i32 v16, 0, v16
v_mul_u32_u24 v23, 400, v16
v_add_u32 v23, v23, v17
s_lshl_b32 s60, s43, 13
s_lshl_b32 s61, s45, 10
s_add_u32 s60, s60, s61
s_lshl_b32 s61, s44, 8
s_add_u32 s60, s60, s61
v_lshlrev_b32 v27, 11, v13
v_lshl_add_u32 v27, v12, 4, v27
v_add_u32 v27, s60, v27
v_mov_b32 v28, 0xff800000
s_mov_b32 s61, 0x3e8293ee
s_nop 2
s_or_b32 s62, s34, s45
s_cmp_lg_u32 s62, 0
s_cselect_b64 s[64:65], s[84:85], 0
s_cselect_b64 s[66:67], s[86:87], 0
s_cselect_b64 s[68:69], s[88:89], 0
s_cselect_b64 s[70:71], s[90:91], 0
s_branch Latt_5
.p2align 3
Lcons_2:
s_lshr_b32 s44, s2, 3
s_lshr_b32 s43, s36, 1
s_lshl_b32 s43, s43, 2
s_add_u32 s43, s43, s44
s_lshr_b32 s46, s43, 2
s_cmp_eq_u32 s46, 3
s_cselect_b32 s46, 1, 0
s_lshr_b32 s44, s36, 1
s_cmp_lg_u32 s46, s44
s_cbranch_scc1 Lsp_6
s_mov_b32 s44, s43
s_cmp_ge_u32 s2, 128
s_cbranch_scc1 Lsp_6
s_mov_b32 s84, s6
s_mov_b32 s85, s7
s_mov_b32 s86, 6291456
s_mov_b32 s87, 0x20000
s_and_b32 s43, s35, 8
s_or_b32 s43, s43, 3
s_lshl_b32 s43, s43, 7
s_mul_i32 s44, s44, 196608
s_add_u32 s43, s43, s44
s_and_b32 s44, s36, 1
s_lshl_b32 s44, s44, 6
v_add_u32 v15, s44, v1
v_min_u32 v15, 95, v15
v_mul_u32_u24 v16, 21846, v15
v_lshrrev_b32 v16, 16, v16
v_mul_u32_u24 v17, 3, v16
v_sub_u32 v15, v15, v17
v_mul_u32_u24 v16, 6144, v16
v_lshl_add_u32 v15, v15, 11, v16
buffer_load_dword v31, v15, s[84:87], s43 offen
Lsp_6:
v_lshrrev_b32 v16, 1, v12
v_xor_b32 v15, v13, v16
v_lshlrev_b32 v15, 4, v15
v_lshl_add_u32 v2, v12, 7, v15
v_xor_b32 v3, 64, v2
v_add_u32 v4, 86016, v2
v_add_u32 v5, 86016, v3
v_lshrrev_b32 v15, 2, v12
v_and_b32 v16, 3, v1
v_lshl_add_u32 v19, v13, 3, v15
v_lshlrev_b32 v19, 7, v19
v_and_b32 v15, 2, v15
v_and_b32 v17, 1, v13
v_lshl_add_u32 v15, v17, 2, v15
v_lshrrev_b32 v17, 1, v16
s_lshl_b32 s43, s36, 1
v_add_u32 v17, s43, v17
v_xor_b32 v15, v15, v17
v_lshl_add_u32 v19, v15, 4, v19
v_and_b32 v16, 1, v16
v_lshl_add_u32 v19, v16, 3, v19
v_add_u32 v6, 18432, v19
v_add_u32 v7, 61440, v19
v_add_u32 v8, 104448, v19
v_mov_b32 v128, 0
v_mov_b32 v129, 0
v_mov_b32 v130, 0
v_mov_b32 v131, 0
v_mov_b32 v132, 0
v_mov_b32 v133, 0
v_mov_b32 v134, 0
v_mov_b32 v135, 0
v_mov_b32 v136, 0
v_mov_b32 v137, 0
v_mov_b32 v138, 0
v_mov_b32 v139, 0
v_mov_b32 v140, 0
v_mov_b32 v141, 0
v_mov_b32 v142, 0
v_mov_b32 v143, 0
v_mov_b32 v144, 0
v_mov_b32 v145, 0
v_mov_b32 v146, 0
v_mov_b32 v147, 0
v_mov_b32 v148, 0
v_mov_b32 v149, 0
v_mov_b32 v150, 0
v_mov_b32 v151, 0
v_mov_b32 v152, 0
v_mov_b32 v153, 0
v_mov_b32 v154, 0
v_mov_b32 v155, 0
v_mov_b32 v156, 0
v_mov_b32 v157, 0
v_mov_b32 v158, 0
v_mov_b32 v159, 0
v_mov_b32 v160, 0
v_mov_b32 v161, 0
v_mov_b32 v162, 0
v_mov_b32 v163, 0
v_mov_b32 v164, 0
v_mov_b32 v165, 0
v_mov_b32 v166, 0
v_mov_b32 v167, 0
v_mov_b32 v168, 0
v_mov_b32 v169, 0
v_mov_b32 v170, 0
v_mov_b32 v171, 0
v_mov_b32 v172, 0
v_mov_b32 v173, 0
v_mov_b32 v174, 0
v_mov_b32 v175, 0
v_mov_b32 v176, 0
v_mov_b32 v177, 0
v_mov_b32 v178, 0
v_mov_b32 v179, 0
v_mov_b32 v180, 0
v_mov_b32 v181, 0
v_mov_b32 v182, 0
v_mov_b32 v183, 0
v_mov_b32 v184, 0
v_mov_b32 v185, 0
v_mov_b32 v186, 0
v_mov_b32 v187, 0
v_mov_b32 v188, 0
v_mov_b32 v189, 0
v_mov_b32 v190, 0
v_mov_b32 v191, 0
v_mov_b32 v192, 0
v_mov_b32 v193, 0
v_mov_b32 v194, 0
v_mov_b32 v195, 0
v_mov_b32 v196, 0
v_mov_b32 v197, 0
v_mov_b32 v198, 0
v_mov_b32 v199, 0
v_mov_b32 v200, 0
v_mov_b32 v201, 0
v_mov_b32 v202, 0
v_mov_b32 v203, 0
v_mov_b32 v204, 0
v_mov_b32 v205, 0
v_mov_b32 v206, 0
v_mov_b32 v207, 0
v_mov_b32 v208, 0
v_mov_b32 v209, 0
v_mov_b32 v210, 0
v_mov_b32 v211, 0
v_mov_b32 v212, 0
v_mov_b32 v213, 0
v_mov_b32 v214, 0
v_mov_b32 v215, 0
v_mov_b32 v216, 0
v_mov_b32 v217, 0
v_mov_b32 v218, 0
v_mov_b32 v219, 0
v_mov_b32 v220, 0
v_mov_b32 v221, 0
v_mov_b32 v222, 0
v_mov_b32 v223, 0
v_mov_b32 v224, 0
v_mov_b32 v225, 0
v_mov_b32 v226, 0
v_mov_b32 v227, 0
v_mov_b32 v228, 0
v_mov_b32 v229, 0
v_mov_b32 v230, 0
v_mov_b32 v231, 0
v_mov_b32 v232, 0
v_mov_b32 v233, 0
v_mov_b32 v234, 0
v_mov_b32 v235, 0
s_and_b32 s43, s36, 1
s_lshr_b32 s44, s36, 1
s_and_b32 s44, s44, 1
s_lshr_b32 s45, s36, 2
s_xor_b32 s45, s45, 1
v_lshlrev_b32 v14, 2, v13
v_sub_u32 v14, v12, v14
v_subrev_u32 v15, 0, v14
v_cmp_ge_u32 s[52:53], 7, v15
v_add_u32 v15, 16, v15
v_cmp_ge_u32 s[84:85], 7, v15
v_subrev_u32 v15, 1, v14
v_cmp_ge_u32 s[54:55], 7, v15
v_add_u32 v15, 16, v15
v_cmp_ge_u32 s[86:87], 7, v15
v_subrev_u32 v15, 2, v14
v_cmp_ge_u32 s[56:57], 7, v15
v_add_u32 v15, 16, v15
v_cmp_ge_u32 s[88:89], 7, v15
v_subrev_u32 v15, 3, v14
v_cmp_ge_u32 s[58:59], 7, v15
v_add_u32 v15, 16, v15
v_cmp_ge_u32 s[90:91], 7, v15
s_lshl_b32 s46, s45, 6
s_add_u32 s46, s46, s44
s_add_u32 s46, s46, 16
v_lshl_add_u32 v14, v12, 1, s46
s_lshl_b32 s47, s43, 6
v_lshl_add_u32 v15, v13, 4, s47
v_mul_u32_u24 v20, 400, v14
v_add_u32 v20, v20, v15
v_subrev_u32 v16, 32, v14
v_max_i32 v16, 0, v16
v_mul_u32_u24 v21, 400, v16
v_add_u32 v21, v21, v15
v_lshrrev_b32 v16, 2, v12
v_lshl_add_u32 v16, v13, 2, v16
v_lshl_add_u32 v16, v16, 1, s46
v_and_b32 v17, 3, v1
v_lshl_add_u32 v17, v17, 3, s47
v_mul_u32_u24 v22, 400, v16
v_add_u32 v22, v22, v17
v_subrev_u32 v16, 32, v16
v_max_i32 v16, 0, v16
v_mul_u32_u24 v23, 400, v16
v_add_u32 v23, v23, v17
s_lshl_b32 s60, s43, 13
s_lshl_b32 s61, s45, 10
s_add_u32 s60, s60, s61
s_lshl_b32 s61, s44, 8
s_add_u32 s60, s60, s61
v_lshlrev_b32 v27, 11, v13
v_lshl_add_u32 v27, v12, 4, v27
v_add_u32 v27, s60, v27
v_mov_b32 v28, 0xff800000
s_mov_b32 s61, 0x3e8293ee
s_nop 2
s_or_b32 s62, s34, s45
s_cmp_lg_u32 s62, 0
s_cselect_b64 s[64:65], s[84:85], 0
s_cselect_b64 s[66:67], s[86:87], 0
s_cselect_b64 s[68:69], s[88:89], 0
s_cselect_b64 s[70:71], s[90:91], 0
s_lshl_b32 s43, s36, 5
s_add_u32 s43, s43, 16
v_lshl_add_u32 v10, v12, 1, s43
v_lshlrev_b32 v10, 7, v10
v_and_b32 v16, 1, v13
v_lshlrev_b32 v16, 1, v16
v_lshrrev_b32 v17, 1, v13
v_add_u32 v16, v16, v17
v_and_b32 v17, 7, v12
v_xor_b32 v16, v16, v17
v_lshl_add_u32 v10, v16, 4, v10
s_mov_b32 s42, s35
v_lshlrev_b32 v9, 3, v12
v_add_u32 v9, 129024, v9
v_mul_u32_u24 v14, 400, v12
v_lshl_add_u32 v14, v13, 3, v14
s_lshl_b32 s43, s36, 5
v_add_u32 v14, s43, v14
s_barrier
ds_read_b128 v[32:35], v2 offset:0
ds_read_b64_tr_b16 v[72:73], v6 offset:8192
ds_read_b64_tr_b16 v[74:75], v6 offset:8704
ds_read_b64_tr_b16 v[76:77], v6 offset:16384
ds_read_b64_tr_b16 v[78:79], v6 offset:16896
ds_read_b64_tr_b16 v[68:69], v6 offset:0
ds_read_b64_tr_b16 v[70:71], v6 offset:512
ds_read_b128 v[36:39], v2 offset:2048
ds_read_b128 v[40:43], v2 offset:4096
ds_read_b128 v[44:47], v2 offset:6144
ds_read_b128 v[48:51], v2 offset:8192
ds_read_b128 v[52:55], v2 offset:10240
ds_read_b128 v[56:59], v2 offset:12288
ds_read_b128 v[60:63], v2 offset:14336
ds_read_b128 v[64:67], v2 offset:16384
s_mov_b32 s41, 5
.p2align 3
Lcl_7:
s_waitcnt lgkmcnt(0)
v_mfma_f32_16x16x32_bf16 v[164:167], v[72:75], v[32:35], v[164:167]
ds_read_b128 v[80:83], v3 offset:0
v_mfma_f32_16x16x32_bf16 v[200:203], v[76:79], v[32:35], v[200:203]
ds_read_b64_tr_b16 v[120:121], v6 offset:12288
v_mfma_f32_16x16x32_bf16 v[128:131], v[68:71], v[32:35], v[128:131]
ds_read_b64_tr_b16 v[122:123], v6 offset:12800
v_mfma_f32_16x16x32_bf16 v[168:171], v[72:75], v[36:39], v[168:171]
ds_read_b64_tr_b16 v[124:125], v6 offset:20480
v_mfma_f32_16x16x32_bf16 v[204:207], v[76:79], v[36:39], v[204:207]
ds_read_b64_tr_b16 v[126:127], v6 offset:20992
v_mfma_f32_16x16x32_bf16 v[132:135], v[68:71], v[36:39], v[132:135]
ds_read_b64_tr_b16 v[116:117], v6 offset:4096
v_mfma_f32_16x16x32_bf16 v[172:175], v[72:75], v[40:43], v[172:175]
ds_read_b64_tr_b16 v[118:119], v6 offset:4608
v_mfma_f32_16x16x32_bf16 v[208:211], v[76:79], v[40:43], v[208:211]
ds_read_b128 v[84:87], v3 offset:2048
v_mfma_f32_16x16x32_bf16 v[136:139], v[68:71], v[40:43], v[136:139]
ds_read_b128 v[88:91], v3 offset:4096
v_mfma_f32_16x16x32_bf16 v[176:179], v[72:75], v[44:47], v[176:179]
ds_read_b128 v[92:95], v3 offset:6144
v_mfma_f32_16x16x32_bf16 v[212:215], v[76:79], v[44:47], v[212:215]
ds_read_b128 v[96:99], v3 offset:8192
v_mfma_f32_16x16x32_bf16 v[140:143], v[68:71], v[44:47], v[140:143]
ds_read_b128 v[100:103], v3 offset:10240
v_mfma_f32_16x16x32_bf16 v[180:183], v[72:75], v[48:51], v[180:183]
ds_read_b128 v[104:107], v3 offset:12288
v_mfma_f32_16x16x32_bf16 v[216:219], v[76:79], v[48:51], v[216:219]
ds_read_b128 v[108:111], v3 offset:14336
v_mfma_f32_16x16x32_bf16 v[144:147], v[68:71], v[48:51], v[144:147]
ds_read_b128 v[112:115], v3 offset:16384
v_mfma_f32_16x16x32_bf16 v[184:187], v[72:75], v[52:55], v[184:187]
v_mfma_f32_16x16x32_bf16 v[220:223], v[76:79], v[52:55], v[220:223]
v_mfma_f32_16x16x32_bf16 v[148:151], v[68:71], v[52:55], v[148:151]
v_mfma_f32_16x16x32_bf16 v[188:191], v[72:75], v[56:59], v[188:191]
v_mfma_f32_16x16x32_bf16 v[224:227], v[76:79], v[56:59], v[224:227]
v_mfma_f32_16x16x32_bf16 v[152:155], v[68:71], v[56:59], v[152:155]
v_mfma_f32_16x16x32_bf16 v[192:195], v[72:75], v[60:63], v[192:195]
v_mfma_f32_16x16x32_bf16 v[228:231], v[76:79], v[60:63], v[228:231]
s_sub_u32 s42, s42, 1
s_cbranch_scc1 Lxr_8
Lxb_9:
v_mfma_f32_16x16x32_bf16 v[156:159], v[68:71], v[60:63], v[156:159]
v_mfma_f32_16x16x32_bf16 v[196:199], v[72:75], v[64:67], v[196:199]
v_mfma_f32_16x16x32_bf16 v[232:235], v[76:79], v[64:67], v[232:235]
v_mfma_f32_16x16x32_bf16 v[160:163], v[68:71], v[64:67], v[160:163]
s_waitcnt lgkmcnt(0)
s_barrier
v_mfma_f32_16x16x32_bf16 v[164:167], v[120:123], v[80:83], v[164:167]
ds_read_b128 v[32:35], v2 offset:43008
v_mfma_f32_16x16x32_bf16 v[200:203], v[124:127], v[80:83], v[200:203]
ds_read_b64_tr_b16 v[72:73], v7 offset:8192
v_mfma_f32_16x16x32_bf16 v[128:131], v[116:119], v[80:83], v[128:131]
ds_read_b64_tr_b16 v[74:75], v7 offset:8704
v_mfma_f32_16x16x32_bf16 v[168:171], v[120:123], v[84:87], v[168:171]
ds_read_b64_tr_b16 v[76:77], v7 offset:16384
v_mfma_f32_16x16x32_bf16 v[204:207], v[124:127], v[84:87], v[204:207]
ds_read_b64_tr_b16 v[78:79], v7 offset:16896
v_mfma_f32_16x16x32_bf16 v[132:135], v[116:119], v[84:87], v[132:135]
ds_read_b64_tr_b16 v[68:69], v7 offset:0
v_mfma_f32_16x16x32_bf16 v[172:175], v[120:123], v[88:91], v[172:175]
ds_read_b64_tr_b16 v[70:71], v7 offset:512
v_mfma_f32_16x16x32_bf16 v[208:211], v[124:127], v[88:91], v[208:211]
ds_read_b128 v[36:39], v2 offset:45056
v_mfma_f32_16x16x32_bf16 v[136:139], v[116:119], v[88:91], v[136:139]
ds_read_b128 v[40:43], v2 offset:47104
v_mfma_f32_16x16x32_bf16 v[176:179], v[120:123], v[92:95], v[176:179]
ds_read_b128 v[44:47], v2 offset:49152
v_mfma_f32_16x16x32_bf16 v[212:215], v[124:127], v[92:95], v[212:215]
ds_read_b128 v[48:51], v2 offset:51200
v_mfma_f32_16x16x32_bf16 v[140:143], v[116:119], v[92:95], v[140:143]
ds_read_b128 v[52:55], v2 offset:53248
v_mfma_f32_16x16x32_bf16 v[180:183], v[120:123], v[96:99], v[180:183]
ds_read_b128 v[56:59], v2 offset:55296
v_mfma_f32_16x16x32_bf16 v[216:219], v[124:127], v[96:99], v[216:219]
ds_read_b128 v[60:63], v2 offset:57344
v_mfma_f32_16x16x32_bf16 v[144:147], v[116:119], v[96:99], v[144:147]
ds_read_b128 v[64:67], v2 offset:59392
v_mfma_f32_16x16x32_bf16 v[184:187], v[120:123], v[100:103], v[184:187]
v_mfma_f32_16x16x32_bf16 v[220:223], v[124:127], v[100:103], v[220:223]
v_mfma_f32_16x16x32_bf16 v[148:151], v[116:119], v[100:103], v[148:151]
v_mfma_f32_16x16x32_bf16 v[188:191], v[120:123], v[104:107], v[188:191]
v_mfma_f32_16x16x32_bf16 v[224:227], v[124:127], v[104:107], v[224:227]
v_mfma_f32_16x16x32_bf16 v[152:155], v[116:119], v[104:107], v[152:155]
v_mfma_f32_16x16x32_bf16 v[192:195], v[120:123], v[108:111], v[192:195]
v_mfma_f32_16x16x32_bf16 v[228:231], v[124:127], v[108:111], v[228:231]
v_mfma_f32_16x16x32_bf16 v[156:159], v[116:119], v[108:111], v[156:159]
v_mfma_f32_16x16x32_bf16 v[196:199], v[120:123], v[112:115], v[196:199]
v_mfma_f32_16x16x32_bf16 v[232:235], v[124:127], v[112:115], v[232:235]
v_mfma_f32_16x16x32_bf16 v[160:163], v[116:119], v[112:115], v[160:163]
s_waitcnt lgkmcnt(0)
v_mfma_f32_16x16x32_bf16 v[164:167], v[72:75], v[32:35], v[164:167]
ds_read_b128 v[80:83], v3 offset:43008
v_mfma_f32_16x16x32_bf16 v[200:203], v[76:79], v[32:35], v[200:203]
ds_read_b64_tr_b16 v[120:121], v7 offset:12288
v_mfma_f32_16x16x32_bf16 v[128:131], v[68:71], v[32:35], v[128:131]
ds_read_b64_tr_b16 v[122:123], v7 offset:12800
v_mfma_f32_16x16x32_bf16 v[168:171], v[72:75], v[36:39], v[168:171]
ds_read_b64_tr_b16 v[124:125], v7 offset:20480
v_mfma_f32_16x16x32_bf16 v[204:207], v[76:79], v[36:39], v[204:207]
ds_read_b64_tr_b16 v[126:127], v7 offset:20992
v_mfma_f32_16x16x32_bf16 v[132:135], v[68:71], v[36:39], v[132:135]
ds_read_b64_tr_b16 v[116:117], v7 offset:4096
v_mfma_f32_16x16x32_bf16 v[172:175], v[72:75], v[40:43], v[172:175]
ds_read_b64_tr_b16 v[118:119], v7 offset:4608
v_mfma_f32_16x16x32_bf16 v[208:211], v[76:79], v[40:43], v[208:211]
ds_read_b128 v[84:87], v3 offset:45056
v_mfma_f32_16x16x32_bf16 v[136:139], v[68:71], v[40:43], v[136:139]
ds_read_b128 v[88:91], v3 offset:47104
v_mfma_f32_16x16x32_bf16 v[176:179], v[72:75], v[44:47], v[176:179]
ds_read_b128 v[92:95], v3 offset:49152
v_mfma_f32_16x16x32_bf16 v[212:215], v[76:79], v[44:47], v[212:215]
ds_read_b128 v[96:99], v3 offset:51200
v_mfma_f32_16x16x32_bf16 v[140:143], v[68:71], v[44:47], v[140:143]
ds_read_b128 v[100:103], v3 offset:53248
v_mfma_f32_16x16x32_bf16 v[180:183], v[72:75], v[48:51], v[180:183]
ds_read_b128 v[104:107], v3 offset:55296
v_mfma_f32_16x16x32_bf16 v[216:219], v[76:79], v[48:51], v[216:219]
ds_read_b128 v[108:111], v3 offset:57344
v_mfma_f32_16x16x32_bf16 v[144:147], v[68:71], v[48:51], v[144:147]
ds_read_b128 v[112:115], v3 offset:59392
v_mfma_f32_16x16x32_bf16 v[184:187], v[72:75], v[52:55], v[184:187]
v_mfma_f32_16x16x32_bf16 v[220:223], v[76:79], v[52:55], v[220:223]
v_mfma_f32_16x16x32_bf16 v[148:151], v[68:71], v[52:55], v[148:151]
v_mfma_f32_16x16x32_bf16 v[188:191], v[72:75], v[56:59], v[188:191]
v_mfma_f32_16x16x32_bf16 v[224:227], v[76:79], v[56:59], v[224:227]
v_mfma_f32_16x16x32_bf16 v[152:155], v[68:71], v[56:59], v[152:155]
v_mfma_f32_16x16x32_bf16 v[192:195], v[72:75], v[60:63], v[192:195]
v_mfma_f32_16x16x32_bf16 v[228:231], v[76:79], v[60:63], v[228:231]
s_sub_u32 s42, s42, 1
s_cbranch_scc1 Lxr_10
Lxb_11:
v_mfma_f32_16x16x32_bf16 v[156:159], v[68:71], v[60:63], v[156:159]
v_mfma_f32_16x16x32_bf16 v[196:199], v[72:75], v[64:67], v[196:199]
v_mfma_f32_16x16x32_bf16 v[232:235], v[76:79], v[64:67], v[232:235]
v_mfma_f32_16x16x32_bf16 v[160:163], v[68:71], v[64:67], v[160:163]
s_waitcnt lgkmcnt(0)
s_barrier
v_mfma_f32_16x16x32_bf16 v[164:167], v[120:123], v[80:83], v[164:167]
ds_read_b128 v[32:35], v4 offset:0
v_mfma_f32_16x16x32_bf16 v[200:203], v[124:127], v[80:83], v[200:203]
ds_read_b64_tr_b16 v[72:73], v8 offset:8192
v_mfma_f32_16x16x32_bf16 v[128:131], v[116:119], v[80:83], v[128:131]
ds_read_b64_tr_b16 v[74:75], v8 offset:8704
v_mfma_f32_16x16x32_bf16 v[168:171], v[120:123], v[84:87], v[168:171]
ds_read_b64_tr_b16 v[76:77], v8 offset:16384
v_mfma_f32_16x16x32_bf16 v[204:207], v[124:127], v[84:87], v[204:207]
ds_read_b64_tr_b16 v[78:79], v8 offset:16896
v_mfma_f32_16x16x32_bf16 v[132:135], v[116:119], v[84:87], v[132:135]
ds_read_b64_tr_b16 v[68:69], v8 offset:0
v_mfma_f32_16x16x32_bf16 v[172:175], v[120:123], v[88:91], v[172:175]
ds_read_b64_tr_b16 v[70:71], v8 offset:512
v_mfma_f32_16x16x32_bf16 v[208:211], v[124:127], v[88:91], v[208:211]
ds_read_b128 v[36:39], v4 offset:2048
v_mfma_f32_16x16x32_bf16 v[136:139], v[116:119], v[88:91], v[136:139]
ds_read_b128 v[40:43], v4 offset:4096
v_mfma_f32_16x16x32_bf16 v[176:179], v[120:123], v[92:95], v[176:179]
ds_read_b128 v[44:47], v4 offset:6144
v_mfma_f32_16x16x32_bf16 v[212:215], v[124:127], v[92:95], v[212:215]
ds_read_b128 v[48:51], v4 offset:8192
v_mfma_f32_16x16x32_bf16 v[140:143], v[116:119], v[92:95], v[140:143]
ds_read_b128 v[52:55], v4 offset:10240
v_mfma_f32_16x16x32_bf16 v[180:183], v[120:123], v[96:99], v[180:183]
ds_read_b128 v[56:59], v4 offset:12288
v_mfma_f32_16x16x32_bf16 v[216:219], v[124:127], v[96:99], v[216:219]
ds_read_b128 v[60:63], v4 offset:14336
v_mfma_f32_16x16x32_bf16 v[144:147], v[116:119], v[96:99], v[144:147]
ds_read_b128 v[64:67], v4 offset:16384
v_mfma_f32_16x16x32_bf16 v[184:187], v[120:123], v[100:103], v[184:187]
v_mfma_f32_16x16x32_bf16 v[220:223], v[124:127], v[100:103], v[220:223]
v_mfma_f32_16x16x32_bf16 v[148:151], v[116:119], v[100:103], v[148:151]
v_mfma_f32_16x16x32_bf16 v[188:191], v[120:123], v[104:107], v[188:191]
v_mfma_f32_16x16x32_bf16 v[224:227], v[124:127], v[104:107], v[224:227]
v_mfma_f32_16x16x32_bf16 v[152:155], v[116:119], v[104:107], v[152:155]
v_mfma_f32_16x16x32_bf16 v[192:195], v[120:123], v[108:111], v[192:195]
v_mfma_f32_16x16x32_bf16 v[228:231], v[124:127], v[108:111], v[228:231]
v_mfma_f32_16x16x32_bf16 v[156:159], v[116:119], v[108:111], v[156:159]
v_mfma_f32_16x16x32_bf16 v[196:199], v[120:123], v[112:115], v[196:199]
v_mfma_f32_16x16x32_bf16 v[232:235], v[124:127], v[112:115], v[232:235]
v_mfma_f32_16x16x32_bf16 v[160:163], v[116:119], v[112:115], v[160:163]
s_waitcnt lgkmcnt(0)
v_mfma_f32_16x16x32_bf16 v[164:167], v[72:75], v[32:35], v[164:167]
ds_read_b128 v[80:83], v5 offset:0
v_mfma_f32_16x16x32_bf16 v[200:203], v[76:79], v[32:35], v[200:203]
ds_read_b64_tr_b16 v[120:121], v8 offset:12288
v_mfma_f32_16x16x32_bf16 v[128:131], v[68:71], v[32:35], v[128:131]
ds_read_b64_tr_b16 v[122:123], v8 offset:12800
v_mfma_f32_16x16x32_bf16 v[168:171], v[72:75], v[36:39], v[168:171]
ds_read_b64_tr_b16 v[124:125], v8 offset:20480
v_mfma_f32_16x16x32_bf16 v[204:207], v[76:79], v[36:39], v[204:207]
ds_read_b64_tr_b16 v[126:127], v8 offset:20992
v_mfma_f32_16x16x32_bf16 v[132:135], v[68:71], v[36:39], v[132:135]
ds_read_b64_tr_b16 v[116:117], v8 offset:4096
v_mfma_f32_16x16x32_bf16 v[172:175], v[72:75], v[40:43], v[172:175]
ds_read_b64_tr_b16 v[118:119], v8 offset:4608
v_mfma_f32_16x16x32_bf16 v[208:211], v[76:79], v[40:43], v[208:211]
ds_read_b128 v[84:87], v5 offset:2048
v_mfma_f32_16x16x32_bf16 v[136:139], v[68:71], v[40:43], v[136:139]
ds_read_b128 v[88:91], v5 offset:4096
v_mfma_f32_16x16x32_bf16 v[176:179], v[72:75], v[44:47], v[176:179]
ds_read_b128 v[92:95], v5 offset:6144
v_mfma_f32_16x16x32_bf16 v[212:215], v[76:79], v[44:47], v[212:215]
ds_read_b128 v[96:99], v5 offset:8192
v_mfma_f32_16x16x32_bf16 v[140:143], v[68:71], v[44:47], v[140:143]
ds_read_b128 v[100:103], v5 offset:10240
v_mfma_f32_16x16x32_bf16 v[180:183], v[72:75], v[48:51], v[180:183]
ds_read_b128 v[104:107], v5 offset:12288
v_mfma_f32_16x16x32_bf16 v[216:219], v[76:79], v[48:51], v[216:219]
ds_read_b128 v[108:111], v5 offset:14336
v_mfma_f32_16x16x32_bf16 v[144:147], v[68:71], v[48:51], v[144:147]
ds_read_b128 v[112:115], v5 offset:16384
v_mfma_f32_16x16x32_bf16 v[184:187], v[72:75], v[52:55], v[184:187]
v_mfma_f32_16x16x32_bf16 v[220:223], v[76:79], v[52:55], v[220:223]
v_mfma_f32_16x16x32_bf16 v[148:151], v[68:71], v[52:55], v[148:151]
v_mfma_f32_16x16x32_bf16 v[188:191], v[72:75], v[56:59], v[188:191]
v_mfma_f32_16x16x32_bf16 v[224:227], v[76:79], v[56:59], v[224:227]
v_mfma_f32_16x16x32_bf16 v[152:155], v[68:71], v[56:59], v[152:155]
v_mfma_f32_16x16x32_bf16 v[192:195], v[72:75], v[60:63], v[192:195]
v_mfma_f32_16x16x32_bf16 v[228:231], v[76:79], v[60:63], v[228:231]
s_sub_u32 s42, s42, 1
s_cbranch_scc1 Lxr_12
Lxb_13:
v_mfma_f32_16x16x32_bf16 v[156:159], v[68:71], v[60:63], v[156:159]
v_mfma_f32_16x16x32_bf16 v[196:199], v[72:75], v[64:67], v[196:199]
v_mfma_f32_16x16x32_bf16 v[232:235], v[76:79], v[64:67], v[232:235]
v_mfma_f32_16x16x32_bf16 v[160:163], v[68:71], v[64:67], v[160:163]
s_waitcnt lgkmcnt(0)
s_barrier
v_mfma_f32_16x16x32_bf16 v[164:167], v[120:123], v[80:83], v[164:167]
ds_read_b128 v[32:35], v2 offset:0
v_mfma_f32_16x16x32_bf16 v[200:203], v[124:127], v[80:83], v[200:203]
ds_read_b64_tr_b16 v[72:73], v6 offset:8192
v_mfma_f32_16x16x32_bf16 v[128:131], v[116:119], v[80:83], v[128:131]
ds_read_b64_tr_b16 v[74:75], v6 offset:8704
v_mfma_f32_16x16x32_bf16 v[168:171], v[120:123], v[84:87], v[168:171]
ds_read_b64_tr_b16 v[76:77], v6 offset:16384
v_mfma_f32_16x16x32_bf16 v[204:207], v[124:127], v[84:87], v[204:207]
ds_read_b64_tr_b16 v[78:79], v6 offset:16896
v_mfma_f32_16x16x32_bf16 v[132:135], v[116:119], v[84:87], v[132:135]
ds_read_b64_tr_b16 v[68:69], v6 offset:0
v_mfma_f32_16x16x32_bf16 v[172:175], v[120:123], v[88:91], v[172:175]
ds_read_b64_tr_b16 v[70:71], v6 offset:512
v_mfma_f32_16x16x32_bf16 v[208:211], v[124:127], v[88:91], v[208:211]
ds_read_b128 v[36:39], v2 offset:2048
v_mfma_f32_16x16x32_bf16 v[136:139], v[116:119], v[88:91], v[136:139]
ds_read_b128 v[40:43], v2 offset:4096
v_mfma_f32_16x16x32_bf16 v[176:179], v[120:123], v[92:95], v[176:179]
ds_read_b128 v[44:47], v2 offset:6144
v_mfma_f32_16x16x32_bf16 v[212:215], v[124:127], v[92:95], v[212:215]
ds_read_b128 v[48:51], v2 offset:8192
v_mfma_f32_16x16x32_bf16 v[140:143], v[116:119], v[92:95], v[140:143]
ds_read_b128 v[52:55], v2 offset:10240
v_mfma_f32_16x16x32_bf16 v[180:183], v[120:123], v[96:99], v[180:183]
ds_read_b128 v[56:59], v2 offset:12288
v_mfma_f32_16x16x32_bf16 v[216:219], v[124:127], v[96:99], v[216:219]
ds_read_b128 v[60:63], v2 offset:14336
v_mfma_f32_16x16x32_bf16 v[144:147], v[116:119], v[96:99], v[144:147]
ds_read_b128 v[64:67], v2 offset:16384
v_mfma_f32_16x16x32_bf16 v[184:187], v[120:123], v[100:103], v[184:187]
v_mfma_f32_16x16x32_bf16 v[220:223], v[124:127], v[100:103], v[220:223]
v_mfma_f32_16x16x32_bf16 v[148:151], v[116:119], v[100:103], v[148:151]
v_mfma_f32_16x16x32_bf16 v[188:191], v[120:123], v[104:107], v[188:191]
v_mfma_f32_16x16x32_bf16 v[224:227], v[124:127], v[104:107], v[224:227]
v_mfma_f32_16x16x32_bf16 v[152:155], v[116:119], v[104:107], v[152:155]
v_mfma_f32_16x16x32_bf16 v[192:195], v[120:123], v[108:111], v[192:195]
v_mfma_f32_16x16x32_bf16 v[228:231], v[124:127], v[108:111], v[228:231]
v_mfma_f32_16x16x32_bf16 v[156:159], v[116:119], v[108:111], v[156:159]
v_mfma_f32_16x16x32_bf16 v[196:199], v[120:123], v[112:115], v[196:199]
v_mfma_f32_16x16x32_bf16 v[232:235], v[124:127], v[112:115], v[232:235]
v_mfma_f32_16x16x32_bf16 v[160:163], v[116:119], v[112:115], v[160:163]
s_sub_u32 s41, s41, 1
s_cmp_lg_u32 s41, 0
s_cbranch_scc1 Lcl_7
s_waitcnt lgkmcnt(0)
v_mfma_f32_16x16x32_bf16 v[164:167], v[72:75], v[32:35], v[164:167]
ds_read_b128 v[80:83], v3 offset:0
v_mfma_f32_16x16x32_bf16 v[200:203], v[76:79], v[32:35], v[200:203]
ds_read_b64_tr_b16 v[120:121], v6 offset:12288
v_mfma_f32_16x16x32_bf16 v[128:131], v[68:71], v[32:35], v[128:131]
ds_read_b64_tr_b16 v[122:123], v6 offset:12800
v_mfma_f32_16x16x32_bf16 v[168:171], v[72:75], v[36:39], v[168:171]
ds_read_b64_tr_b16 v[124:125], v6 offset:20480
v_mfma_f32_16x16x32_bf16 v[204:207], v[76:79], v[36:39], v[204:207]
ds_read_b64_tr_b16 v[126:127], v6 offset:20992
v_mfma_f32_16x16x32_bf16 v[132:135], v[68:71], v[36:39], v[132:135]
ds_read_b64_tr_b16 v[116:117], v6 offset:4096
v_mfma_f32_16x16x32_bf16 v[172:175], v[72:75], v[40:43], v[172:175]
ds_read_b64_tr_b16 v[118:119], v6 offset:4608
v_mfma_f32_16x16x32_bf16 v[208:211], v[76:79], v[40:43], v[208:211]
ds_read_b128 v[84:87], v3 offset:2048
v_mfma_f32_16x16x32_bf16 v[136:139], v[68:71], v[40:43], v[136:139]
ds_read_b128 v[88:91], v3 offset:4096
v_mfma_f32_16x16x32_bf16 v[176:179], v[72:75], v[44:47], v[176:179]
ds_read_b128 v[92:95], v3 offset:6144
v_mfma_f32_16x16x32_bf16 v[212:215], v[76:79], v[44:47], v[212:215]
ds_read_b128 v[96:99], v3 offset:8192
v_mfma_f32_16x16x32_bf16 v[140:143], v[68:71], v[44:47], v[140:143]
ds_read_b128 v[100:103], v3 offset:10240
v_mfma_f32_16x16x32_bf16 v[180:183], v[72:75], v[48:51], v[180:183]
ds_read_b128 v[104:107], v3 offset:12288
v_mfma_f32_16x16x32_bf16 v[216:219], v[76:79], v[48:51], v[216:219]
ds_read_b128 v[108:111], v3 offset:14336
v_mfma_f32_16x16x32_bf16 v[144:147], v[68:71], v[48:51], v[144:147]
ds_read_b128 v[112:115], v3 offset:16384
v_mfma_f32_16x16x32_bf16 v[184:187], v[72:75], v[52:55], v[184:187]
v_mfma_f32_16x16x32_bf16 v[220:223], v[76:79], v[52:55], v[220:223]
v_mfma_f32_16x16x32_bf16 v[148:151], v[68:71], v[52:55], v[148:151]
v_mfma_f32_16x16x32_bf16 v[188:191], v[72:75], v[56:59], v[188:191]
v_mfma_f32_16x16x32_bf16 v[224:227], v[76:79], v[56:59], v[224:227]
v_mfma_f32_16x16x32_bf16 v[152:155], v[68:71], v[56:59], v[152:155]
v_mfma_f32_16x16x32_bf16 v[192:195], v[72:75], v[60:63], v[192:195]
v_mfma_f32_16x16x32_bf16 v[228:231], v[76:79], v[60:63], v[228:231]
s_sub_u32 s42, s42, 1
s_cbranch_scc1 Lxr_14
Lxb_15:
v_mfma_f32_16x16x32_bf16 v[156:159], v[68:71], v[60:63], v[156:159]
v_mfma_f32_16x16x32_bf16 v[196:199], v[72:75], v[64:67], v[196:199]
v_mfma_f32_16x16x32_bf16 v[232:235], v[76:79], v[64:67], v[232:235]
v_mfma_f32_16x16x32_bf16 v[160:163], v[68:71], v[64:67], v[160:163]
s_waitcnt lgkmcnt(0)
s_barrier
v_mfma_f32_16x16x32_bf16 v[164:167], v[120:123], v[80:83], v[164:167]
ds_read_b64 v[32:33], v9 offset:0
v_mfma_f32_16x16x32_bf16 v[200:203], v[124:127], v[80:83], v[200:203]
ds_read_b64 v[34:35], v9 offset:128
v_mfma_f32_16x16x32_bf16 v[128:131], v[116:119], v[80:83], v[128:131]
ds_read_b64 v[36:37], v9 offset:256
v_mfma_f32_16x16x32_bf16 v[168:171], v[120:123], v[84:87], v[168:171]
ds_read_b64 v[38:39], v9 offset:384
v_mfma_f32_16x16x32_bf16 v[204:207], v[124:127], v[84:87], v[204:207]
ds_read_b64 v[40:41], v9 offset:512
v_mfma_f32_16x16x32_bf16 v[132:135], v[116:119], v[84:87], v[132:135]
ds_read_b64 v[42:43], v9 offset:640
v_mfma_f32_16x16x32_bf16 v[172:175], v[120:123], v[88:91], v[172:175]
ds_read_b64 v[44:45], v9 offset:768
v_mfma_f32_16x16x32_bf16 v[208:211], v[124:127], v[88:91], v[208:211]
ds_read_b64 v[46:47], v9 offset:896
v_mfma_f32_16x16x32_bf16 v[136:139], v[116:119], v[88:91], v[136:139]
ds_read_b64 v[48:49], v9 offset:1024
v_mfma_f32_16x16x32_bf16 v[176:179], v[120:123], v[92:95], v[176:179]
v_mov_b32_dpp v52, v128 row_newbcast:0 row_mask:0xf bank_mask:0xf
v_mov_b32_dpp v53, v129 row_newbcast:0 row_mask:0xf bank_mask:0xf
v_mfma_f32_16x16x32_bf16 v[212:215], v[124:127], v[92:95], v[212:215]
v_mov_b32_dpp v54, v130 row_newbcast:0 row_mask:0xf bank_mask:0xf
v_mov_b32_dpp v55, v131 row_newbcast:0 row_mask:0xf bank_mask:0xf
v_mfma_f32_16x16x32_bf16 v[140:143], v[116:119], v[92:95], v[140:143]
v_mov_b32_dpp v56, v164 row_newbcast:0 row_mask:0xf bank_mask:0xf
v_mov_b32_dpp v57, v165 row_newbcast:0 row_mask:0xf bank_mask:0xf
v_mfma_f32_16x16x32_bf16 v[180:183], v[120:123], v[96:99], v[180:183]
v_mov_b32_dpp v58, v166 row_newbcast:0 row_mask:0xf bank_mask:0xf
v_mov_b32_dpp v59, v167 row_newbcast:0 row_mask:0xf bank_mask:0xf
v_mfma_f32_16x16x32_bf16 v[216:219], v[124:127], v[96:99], v[216:219]
v_mov_b32_dpp v60, v200 row_newbcast:0 row_mask:0xf bank_mask:0xf
v_mov_b32_dpp v61, v201 row_newbcast:0 row_mask:0xf bank_mask:0xf
v_mfma_f32_16x16x32_bf16 v[144:147], v[116:119], v[96:99], v[144:147]
v_mov_b32_dpp v62, v202 row_newbcast:0 row_mask:0xf bank_mask:0xf
v_mov_b32_dpp v63, v203 row_newbcast:0 row_mask:0xf bank_mask:0xf
v_mfma_f32_16x16x32_bf16 v[184:187], v[120:123], v[100:103], v[184:187]
s_waitcnt lgkmcnt(0)
v_fma_f32 v164, -v32, v56, v164
v_mfma_f32_16x16x32_bf16 v[220:223], v[124:127], v[100:103], v[220:223]
v_fma_f32 v165, -v32, v57, v165
v_fma_f32 v166, -v32, v58, v166
v_mfma_f32_16x16x32_bf16 v[148:151], v[116:119], v[100:103], v[148:151]
v_fma_f32 v167, -v32, v59, v167
v_mul_f32 v164, v33, v164
v_mfma_f32_16x16x32_bf16 v[188:191], v[120:123], v[104:107], v[188:191]
v_mul_f32 v165, v33, v165
v_mul_f32 v166, v33, v166
v_mfma_f32_16x16x32_bf16 v[224:227], v[124:127], v[104:107], v[224:227]
v_mul_f32 v167, v33, v167
v_cvt_pk_bf16_f32 v164, v164, v165
v_mfma_f32_16x16x32_bf16 v[152:155], v[116:119], v[104:107], v[152:155]
v_cvt_pk_bf16_f32 v165, v166, v167
ds_write_b64 v14, v[164:165] offset:128
v_mfma_f32_16x16x32_bf16 v[192:195], v[120:123], v[108:111], v[192:195]
v_fma_f32 v200, -v32, v60, v200
v_fma_f32 v201, -v32, v61, v201
v_mfma_f32_16x16x32_bf16 v[228:231], v[124:127], v[108:111], v[228:231]
v_fma_f32 v202, -v32, v62, v202
v_fma_f32 v203, -v32, v63, v203
v_mfma_f32_16x16x32_bf16 v[156:159], v[116:119], v[108:111], v[156:159]
v_mul_f32 v200, v33, v200
v_mul_f32 v201, v33, v201
v_mfma_f32_16x16x32_bf16 v[196:199], v[120:123], v[112:115], v[196:199]
v_mul_f32 v202, v33, v202
v_mul_f32 v203, v33, v203
v_mfma_f32_16x16x32_bf16 v[232:235], v[124:127], v[112:115], v[232:235]
v_cvt_pk_bf16_f32 v200, v200, v201
v_cvt_pk_bf16_f32 v201, v202, v203
v_mfma_f32_16x16x32_bf16 v[160:163], v[116:119], v[112:115], v[160:163]
ds_write_b64 v14, v[200:201] offset:256
v_fma_f32 v132, -v34, v52, v132
v_fma_f32 v133, -v34, v53, v133
v_fma_f32 v134, -v34, v54, v134
v_fma_f32 v135, -v34, v55, v135
v_mul_f32 v132, v35, v132
v_mul_f32 v133, v35, v133
v_mul_f32 v134, v35, v134
v_mul_f32 v135, v35, v135
v_cvt_pk_bf16_f32 v132, v132, v133
v_cvt_pk_bf16_f32 v133, v134, v135
ds_write_b64 v14, v[132:133] offset:6400
v_pk_fma_f32 v[168:169], v[34:35], v[56:57], v[168:169] op_sel_hi:[0,1,1] neg_lo:[1,0,0] neg_hi:[1,0,0]
v_pk_fma_f32 v[170:171], v[34:35], v[58:59], v[170:171] op_sel_hi:[0,1,1] neg_lo:[1,0,0] neg_hi:[1,0,0]
v_pk_mul_f32 v[168:169], v[34:35], v[168:169] op_sel:[1,0] op_sel_hi:[1,1]
v_pk_mul_f32 v[170:171], v[34:35], v[170:171] op_sel:[1,0] op_sel_hi:[1,1]
v_cvt_pk_bf16_f32 v168, v168, v169
v_cvt_pk_bf16_f32 v169, v170, v171
ds_write_b64 v14, v[168:169] offset:6528
v_pk_fma_f32 v[204:205], v[34:35], v[60:61], v[204:205] op_sel_hi:[0,1,1] neg_lo:[1,0,0] neg_hi:[1,0,0]
v_pk_fma_f32 v[206:207], v[34:35], v[62:63], v[206:207] op_sel_hi:[0,1,1] neg_lo:[1,0,0] neg_hi:[1,0,0]
v_pk_mul_f32 v[204:205], v[34:35], v[204:205] op_sel:[1,0] op_sel_hi:[1,1]
v_pk_mul_f32 v[206:207], v[34:35], v[206:207] op_sel:[1,0] op_sel_hi:[1,1]
v_cvt_pk_bf16_f32 v204, v204, v205
v_cvt_pk_bf16_f32 v205, v206, v207
ds_write_b64 v14, v[204:205] offset:6656
v_pk_fma_f32 v[136:137], v[36:37], v[52:53], v[136:137] op_sel_hi:[0,1,1] neg_lo:[1,0,0] neg_hi:[1,0,0]
v_pk_fma_f32 v[138:139], v[36:37], v[54:55], v[138:139] op_sel_hi:[0,1,1] neg_lo:[1,0,0] neg_hi:[1,0,0]
v_pk_mul_f32 v[136:137], v[36:37], v[136:137] op_sel:[1,0] op_sel_hi:[1,1]
v_pk_mul_f32 v[138:139], v[36:37], v[138:139] op_sel:[1,0] op_sel_hi:[1,1]
v_cvt_pk_bf16_f32 v136, v136, v137
v_cvt_pk_bf16_f32 v137, v138, v139
ds_write_b64 v14, v[136:137] offset:12800
v_pk_fma_f32 v[172:173], v[36:37], v[56:57], v[172:173] op_sel_hi:[0,1,1] neg_lo:[1,0,0] neg_hi:[1,0,0]
v_pk_fma_f32 v[174:175], v[36:37], v[58:59], v[174:175] op_sel_hi:[0,1,1] neg_lo:[1,0,0] neg_hi:[1,0,0]
v_pk_mul_f32 v[172:173], v[36:37], v[172:173] op_sel:[1,0] op_sel_hi:[1,1]
v_pk_mul_f32 v[174:175], v[36:37], v[174:175] op_sel:[1,0] op_sel_hi:[1,1]
v_cvt_pk_bf16_f32 v172, v172, v173
v_cvt_pk_bf16_f32 v173, v174, v175
ds_write_b64 v14, v[172:173] offset:12928
v_pk_fma_f32 v[208:209], v[36:37], v[60:61], v[208:209] op_sel_hi:[0,1,1] neg_lo:[1,0,0] neg_hi:[1,0,0]
v_pk_fma_f32 v[210:211], v[36:37], v[62:63], v[210:211] op_sel_hi:[0,1,1] neg_lo:[1,0,0] neg_hi:[1,0,0]
v_pk_mul_f32 v[208:209], v[36:37], v[208:209] op_sel:[1,0] op_sel_hi:[1,1]
v_pk_mul_f32 v[210:211], v[36:37], v[210:211] op_sel:[1,0] op_sel_hi:[1,1]
v_cvt_pk_bf16_f32 v208, v208, v209
v_cvt_pk_bf16_f32 v209, v210, v211
ds_write_b64 v14, v[208:209] offset:13056
v_pk_fma_f32 v[140:141], v[38:39], v[52:53], v[140:141] op_sel_hi:[0,1,1] neg_lo:[1,0,0] neg_hi:[1,0,0]
v_pk_fma_f32 v[142:143], v[38:39], v[54:55], v[142:143] op_sel_hi:[0,1,1] neg_lo:[1,0,0] neg_hi:[1,0,0]
v_pk_mul_f32 v[140:141], v[38:39], v[140:141] op_sel:[1,0] op_sel_hi:[1,1]
v_pk_mul_f32 v[142:143], v[38:39], v[142:143] op_sel:[1,0] op_sel_hi:[1,1]
v_cvt_pk_bf16_f32 v140, v140, v141
v_cvt_pk_bf16_f32 v141, v142, v143
ds_write_b64 v14, v[140:141] offset:19200
v_pk_fma_f32 v[176:177], v[38:39], v[56:57], v[176:177] op_sel_hi:[0,1,1] neg_lo:[1,0,0] neg_hi:[1,0,0]
v_pk_fma_f32 v[178:179], v[38:39], v[58:59], v[178:179] op_sel_hi:[0,1,1] neg_lo:[1,0,0] neg_hi:[1,0,0]
v_pk_mul_f32 v[176:177], v[38:39], v[176:177] op_sel:[1,0] op_sel_hi:[1,1]
v_pk_mul_f32 v[178:179], v[38:39], v[178:179] op_sel:[1,0] op_sel_hi:[1,1]
v_cvt_pk_bf16_f32 v176, v176, v177
v_cvt_pk_bf16_f32 v177, v178, v179
ds_write_b64 v14, v[176:177] offset:19328
v_pk_fma_f32 v[212:213], v[38:39], v[60:61], v[212:213] op_sel_hi:[0,1,1] neg_lo:[1,0,0] neg_hi:[1,0,0]
v_pk_fma_f32 v[214:215], v[38:39], v[62:63], v[214:215] op_sel_hi:[0,1,1] neg_lo:[1,0,0] neg_hi:[1,0,0]
v_pk_mul_f32 v[212:213], v[38:39], v[212:213] op_sel:[1,0] op_sel_hi:[1,1]
v_pk_mul_f32 v[214:215], v[38:39], v[214:215] op_sel:[1,0] op_sel_hi:[1,1]
v_cvt_pk_bf16_f32 v212, v212, v213
v_cvt_pk_bf16_f32 v213, v214, v215
ds_write_b64 v14, v[212:213] offset:19456
v_pk_fma_f32 v[144:145], v[40:41], v[52:53], v[144:145] op_sel_hi:[0,1,1] neg_lo:[1,0,0] neg_hi:[1,0,0]
v_pk_fma_f32 v[146:147], v[40:41], v[54:55], v[146:147] op_sel_hi:[0,1,1] neg_lo:[1,0,0] neg_hi:[1,0,0]
v_pk_mul_f32 v[144:145], v[40:41], v[144:145] op_sel:[1,0] op_sel_hi:[1,1]
v_pk_mul_f32 v[146:147], v[40:41], v[146:147] op_sel:[1,0] op_sel_hi:[1,1]
v_cvt_pk_bf16_f32 v144, v144, v145
v_cvt_pk_bf16_f32 v145, v146, v147
ds_write_b64 v14, v[144:145] offset:25600
v_pk_fma_f32 v[180:181], v[40:41], v[56:57], v[180:181] op_sel_hi:[0,1,1] neg_lo:[1,0,0] neg_hi:[1,0,0]
v_pk_fma_f32 v[182:183], v[40:41], v[58:59], v[182:183] op_sel_hi:[0,1,1] neg_lo:[1,0,0] neg_hi:[1,0,0]
v_pk_mul_f32 v[180:181], v[40:41], v[180:181] op_sel:[1,0] op_sel_hi:[1,1]
v_pk_mul_f32 v[182:183], v[40:41], v[182:183] op_sel:[1,0] op_sel_hi:[1,1]
v_cvt_pk_bf16_f32 v180, v180, v181
v_cvt_pk_bf16_f32 v181, v182, v183
ds_write_b64 v14, v[180:181] offset:25728
v_pk_fma_f32 v[216:217], v[40:41], v[60:61], v[216:217] op_sel_hi:[0,1,1] neg_lo:[1,0,0] neg_hi:[1,0,0]
v_pk_fma_f32 v[218:219], v[40:41], v[62:63], v[218:219] op_sel_hi:[0,1,1] neg_lo:[1,0,0] neg_hi:[1,0,0]
v_pk_mul_f32 v[216:217], v[40:41], v[216:217] op_sel:[1,0] op_sel_hi:[1,1]
v_pk_mul_f32 v[218:219], v[40:41], v[218:219] op_sel:[1,0] op_sel_hi:[1,1]
v_cvt_pk_bf16_f32 v216, v216, v217
v_cvt_pk_bf16_f32 v217, v218, v219
ds_write_b64 v14, v[216:217] offset:25856
s_waitcnt lgkmcnt(0)
s_barrier
v_pk_fma_f32 v[148:149], v[42:43], v[52:53], v[148:149] op_sel_hi:[0,1,1] neg_lo:[1,0,0] neg_hi:[1,0,0]
v_pk_fma_f32 v[150:151], v[42:43], v[54:55], v[150:151] op_sel_hi:[0,1,1] neg_lo:[1,0,0] neg_hi:[1,0,0]
v_pk_mul_f32 v[148:149], v[42:43], v[148:149] op_sel:[1,0] op_sel_hi:[1,1]
v_pk_mul_f32 v[150:151], v[42:43], v[150:151] op_sel:[1,0] op_sel_hi:[1,1]
v_cvt_pk_bf16_f32 v148, v148, v149
v_cvt_pk_bf16_f32 v149, v150, v151
ds_write_b64 v14, v[148:149] offset:32000
v_pk_fma_f32 v[184:185], v[42:43], v[56:57], v[184:185] op_sel_hi:[0,1,1] neg_lo:[1,0,0] neg_hi:[1,0,0]
v_pk_fma_f32 v[186:187], v[42:43], v[58:59], v[186:187] op_sel_hi:[0,1,1] neg_lo:[1,0,0] neg_hi:[1,0,0]
v_pk_mul_f32 v[184:185], v[42:43], v[184:185] op_sel:[1,0] op_sel_hi:[1,1]
v_pk_mul_f32 v[186:187], v[42:43], v[186:187] op_sel:[1,0] op_sel_hi:[1,1]
v_cvt_pk_bf16_f32 v184, v184, v185
v_cvt_pk_bf16_f32 v185, v186, v187
ds_write_b64 v14, v[184:185] offset:32128
v_pk_fma_f32 v[220:221], v[42:43], v[60:61], v[220:221] op_sel_hi:[0,1,1] neg_lo:[1,0,0] neg_hi:[1,0,0]
v_pk_fma_f32 v[222:223], v[42:43], v[62:63], v[222:223] op_sel_hi:[0,1,1] neg_lo:[1,0,0] neg_hi:[1,0,0]
v_pk_mul_f32 v[220:221], v[42:43], v[220:221] op_sel:[1,0] op_sel_hi:[1,1]
v_pk_mul_f32 v[222:223], v[42:43], v[222:223] op_sel:[1,0] op_sel_hi:[1,1]
v_cvt_pk_bf16_f32 v220, v220, v221
v_cvt_pk_bf16_f32 v221, v222, v223
ds_write_b64 v14, v[220:221] offset:32256
v_pk_fma_f32 v[152:153], v[44:45], v[52:53], v[152:153] op_sel_hi:[0,1,1] neg_lo:[1,0,0] neg_hi:[1,0,0]
v_pk_fma_f32 v[154:155], v[44:45], v[54:55], v[154:155] op_sel_hi:[0,1,1] neg_lo:[1,0,0] neg_hi:[1,0,0]
v_pk_mul_f32 v[152:153], v[44:45], v[152:153] op_sel:[1,0] op_sel_hi:[1,1]
v_pk_mul_f32 v[154:155], v[44:45], v[154:155] op_sel:[1,0] op_sel_hi:[1,1]
v_cvt_pk_bf16_f32 v152, v152, v153
v_cvt_pk_bf16_f32 v153, v154, v155
ds_write_b64 v14, v[152:153] offset:38400
v_pk_fma_f32 v[188:189], v[44:45], v[56:57], v[188:189] op_sel_hi:[0,1,1] neg_lo:[1,0,0] neg_hi:[1,0,0]
v_pk_fma_f32 v[190:191], v[44:45], v[58:59], v[190:191] op_sel_hi:[0,1,1] neg_lo:[1,0,0] neg_hi:[1,0,0]
v_pk_mul_f32 v[188:189], v[44:45], v[188:189] op_sel:[1,0] op_sel_hi:[1,1]
v_pk_mul_f32 v[190:191], v[44:45], v[190:191] op_sel:[1,0] op_sel_hi:[1,1]
v_cvt_pk_bf16_f32 v188, v188, v189
v_cvt_pk_bf16_f32 v189, v190, v191
ds_write_b64 v14, v[188:189] offset:38528
v_pk_fma_f32 v[224:225], v[44:45], v[60:61], v[224:225] op_sel_hi:[0,1,1] neg_lo:[1,0,0] neg_hi:[1,0,0]
v_pk_fma_f32 v[226:227], v[44:45], v[62:63], v[226:227] op_sel_hi:[0,1,1] neg_lo:[1,0,0] neg_hi:[1,0,0]
v_pk_mul_f32 v[224:225], v[44:45], v[224:225] op_sel:[1,0] op_sel_hi:[1,1]
v_pk_mul_f32 v[226:227], v[44:45], v[226:227] op_sel:[1,0] op_sel_hi:[1,1]
v_cvt_pk_bf16_f32 v224, v224, v225
v_cvt_pk_bf16_f32 v225, v226, v227
ds_write_b64 v14, v[224:225] offset:38656
v_pk_fma_f32 v[156:157], v[46:47], v[52:53], v[156:157] op_sel_hi:[0,1,1] neg_lo:[1,0,0] neg_hi:[1,0,0]
v_pk_fma_f32 v[158:159], v[46:47], v[54:55], v[158:159] op_sel_hi:[0,1,1] neg_lo:[1,0,0] neg_hi:[1,0,0]
v_pk_mul_f32 v[156:157], v[46:47], v[156:157] op_sel:[1,0] op_sel_hi:[1,1]
v_pk_mul_f32 v[158:159], v[46:47], v[158:159] op_sel:[1,0] op_sel_hi:[1,1]
v_cvt_pk_bf16_f32 v156, v156, v157
v_cvt_pk_bf16_f32 v157, v158, v159
ds_write_b64 v14, v[156:157] offset:44800
v_pk_fma_f32 v[192:193], v[46:47], v[56:57], v[192:193] op_sel_hi:[0,1,1] neg_lo:[1,0,0] neg_hi:[1,0,0]
v_pk_fma_f32 v[194:195], v[46:47], v[58:59], v[194:195] op_sel_hi:[0,1,1] neg_lo:[1,0,0] neg_hi:[1,0,0]
v_pk_mul_f32 v[192:193], v[46:47], v[192:193] op_sel:[1,0] op_sel_hi:[1,1]
v_pk_mul_f32 v[194:195], v[46:47], v[194:195] op_sel:[1,0] op_sel_hi:[1,1]
v_cvt_pk_bf16_f32 v192, v192, v193
v_cvt_pk_bf16_f32 v193, v194, v195
ds_write_b64 v14, v[192:193] offset:44928
v_pk_fma_f32 v[228:229], v[46:47], v[60:61], v[228:229] op_sel_hi:[0,1,1] neg_lo:[1,0,0] neg_hi:[1,0,0]
v_pk_fma_f32 v[230:231], v[46:47], v[62:63], v[230:231] op_sel_hi:[0,1,1] neg_lo:[1,0,0] neg_hi:[1,0,0]
v_pk_mul_f32 v[228:229], v[46:47], v[228:229] op_sel:[1,0] op_sel_hi:[1,1]
v_pk_mul_f32 v[230:231], v[46:47], v[230:231] op_sel:[1,0] op_sel_hi:[1,1]
v_cvt_pk_bf16_f32 v228, v228, v229
v_cvt_pk_bf16_f32 v229, v230, v231
ds_write_b64 v14, v[228:229] offset:45056
v_pk_fma_f32 v[160:161], v[48:49], v[52:53], v[160:161] op_sel_hi:[0,1,1] neg_lo:[1,0,0] neg_hi:[1,0,0]
v_pk_fma_f32 v[162:163], v[48:49], v[54:55], v[162:163] op_sel_hi:[0,1,1] neg_lo:[1,0,0] neg_hi:[1,0,0]
v_pk_mul_f32 v[160:161], v[48:49], v[160:161] op_sel:[1,0] op_sel_hi:[1,1]
v_pk_mul_f32 v[162:163], v[48:49], v[162:163] op_sel:[1,0] op_sel_hi:[1,1]
v_cvt_pk_bf16_f32 v160, v160, v161
v_cvt_pk_bf16_f32 v161, v162, v163
ds_write_b64 v14, v[160:161] offset:51200
v_pk_fma_f32 v[196:197], v[48:49], v[56:57], v[196:197] op_sel_hi:[0,1,1] neg_lo:[1,0,0] neg_hi:[1,0,0]
v_pk_fma_f32 v[198:199], v[48:49], v[58:59], v[198:199] op_sel_hi:[0,1,1] neg_lo:[1,0,0] neg_hi:[1,0,0]
v_pk_mul_f32 v[196:197], v[48:49], v[196:197] op_sel:[1,0] op_sel_hi:[1,1]
v_pk_mul_f32 v[198:199], v[48:49], v[198:199] op_sel:[1,0] op_sel_hi:[1,1]
v_cvt_pk_bf16_f32 v196, v196, v197
v_cvt_pk_bf16_f32 v197, v198, v199
ds_write_b64 v14, v[196:197] offset:51328
v_pk_fma_f32 v[232:233], v[48:49], v[60:61], v[232:233] op_sel_hi:[0,1,1] neg_lo:[1,0,0] neg_hi:[1,0,0]
v_pk_fma_f32 v[234:235], v[48:49], v[62:63], v[234:235] op_sel_hi:[0,1,1] neg_lo:[1,0,0] neg_hi:[1,0,0]
v_pk_mul_f32 v[232:233], v[48:49], v[232:233] op_sel:[1,0] op_sel_hi:[1,1]
v_pk_mul_f32 v[234:235], v[48:49], v[234:235] op_sel:[1,0] op_sel_hi:[1,1]
v_cvt_pk_bf16_f32 v232, v232, v233
v_cvt_pk_bf16_f32 v233, v234, v235
ds_write_b64 v14, v[232:233] offset:51456
s_waitcnt lgkmcnt(0)
s_branch Latt_4
Lpf_3:
s_load_dwordx2 s[26:27], s[0:1], 64
s_or_b32 s43, s34, s35
s_cmp_lg_u32 s43, 0
s_cbranch_scc1 Lz_26
s_add_u32 s84, s32, 28311552
s_addc_u32 s85, s33, 0
s_mov_b32 s86, 40960
s_mov_b32 s87, 0x20000
v_lshlrev_b32 v14, 7, v1
v_mov_b32 v36, 0
v_mov_b32 v37, 0
s_mov_b32 s43, 0
buffer_store_dwordx2 v[36:37], v14, s[84:87], s43 offen sc1
s_mov_b32 s43, 8192
buffer_store_dwordx2 v[36:37], v14, s[84:87], s43 offen sc1
s_mov_b32 s43, 16384
buffer_store_dwordx2 v[36:37], v14, s[84:87], s43 offen sc1
s_mov_b32 s43, 24576
buffer_store_dwordx2 v[36:37], v14, s[84:87], s43 offen sc1
s_mov_b32 s43, 32768
buffer_store_dwordx2 v[36:37], v14, s[84:87], s43 offen sc1
Lz_26:
s_lshl_b32 s43, s51, 11
buffer_load_dwordx4 v[96:99], v10, s[8:11], s43 offen offset:0
buffer_load_dwordx4 v[100:103], v10, s[8:11], s43 offen offset:1024
buffer_load_dwordx4 v[104:107], v10, s[8:11], s43 offen offset:2048
buffer_load_dwordx4 v[108:111], v10, s[8:11], s43 offen offset:3072
v_min_u32 v14, 23, v1
v_lshrrev_b32 v15, 3, v14
v_mul_u32_u24 v15, 43008, v15
v_and_b32 v14, 7, v14
v_lshl_add_u32 v15, v14, 4, v15
v_mov_b32 v32, 0x3f803f80
v_mov_b32 v33, 0x3f803f80
v_mov_b32 v34, 0x3f803f80
v_mov_b32 v35, 0x3f803f80
ds_write_b128 v15, v[32:35]
v_add_u32 v14, 0, v1
v_min_u32 v14, 47, v14
v_mul_u32_u24 v15, 21846, v14
v_lshrrev_b32 v15, 16, v15
v_mul_u32_u24 v16, 3, v15
v_sub_u32 v16, v14, v16
s_mul_i32 s43, s48, 16
v_add_u32 v15, s43, v15
v_mul_u32_u24 v15, 6144, v15
v_lshl_add_u32 v2, v16, 11, v15
s_waitcnt lgkmcnt(0)
s_mov_b32 s56, s26
s_mov_b32 s57, s27
s_mov_b32 s58, 256
s_mov_b32 s59, 0x20000
v_lshlrev_b32 v14, 7, v1
s_barrier
s_cmp_ge_u32 s2, 128
s_cbranch_scc1 Lm_28
s_lshr_b32 s44, s2, 4
s_cmp_eq_u32 s44, 2
s_cbranch_scc1 Lm_28
s_lshr_b32 s44, s2, 5
s_cmp_eq_u32 s44, 3
s_cbranch_scc1 Lm_28
s_mov_b32 s84, s6
s_mov_b32 s85, s7
s_mov_b32 s86, 6291456
s_mov_b32 s87, 0x20000
s_cmp_lt_u32 s2, 32
s_cselect_b32 s43, 96, 0
s_add_u32 s43, s43, s2
s_mul_i32 s43, s43, 24576
buffer_load_dword v31, v14, s[84:87], s43 offen
s_add_u32 s43, s43, 8192
buffer_load_dword v31, v14, s[84:87], s43 offen
s_add_u32 s43, s43, 8192
buffer_load_dword v31, v14, s[84:87], s43 offen
Lm_28:
s_mov_b32 s84, s6
s_mov_b32 s85, s7
s_mov_b32 s86, 6291456
s_mov_b32 s87, 0x20000
s_lshr_b32 s44, s2, 3
s_lshr_b32 s43, s2, 5
s_cmp_eq_u32 s43, 3
s_cbranch_scc1 Lsj_29
s_cmp_gt_u32 s43, 3
s_cselect_b32 s43, 32, 0
s_sub_u32 s43, s2, s43
s_lshr_b32 s43, s43, 1
s_and_b32 s44, s2, 1
s_lshl_b32 s44, s44, 3
s_add_u32 s44, s44, 32
s_load_dwordx2 s[80:81], s[0:1], s44
s_mul_i32 s45, s43, 2341
s_lshr_b32 s45, s45, 16
s_mul_i32 s46, s45, 28
s_sub_u32 s46, s43, s46
s_lshl_b32 s45, s45, 8
s_mul_i32 s44, s47, 18
s_add_u32 s45, s45, s44
s_add_u32 s45, s45, 184
s_mul_i32 s45, s45, 7168
s_lshl_b32 s46, s46, 8
s_add_u32 s45, s45, s46
s_waitcnt lgkmcnt(0)
s_add_u32 s80, s80, s45
s_addc_u32 s81, s81, 0
Lsj_29:
s_barrier
s_cmp_ge_u32 s2, 128
s_cbranch_scc0 Lm_30
s_mov_b32 s84, s6
s_mov_b32 s85, s7
s_mov_b32 s86, 6291456
s_mov_b32 s87, 0x20000
s_cmp_lt_u32 s2, 32
s_cselect_b32 s43, 96, 0
s_add_u32 s43, s43, s2
s_mul_i32 s43, s43, 24576
buffer_load_dword v31, v14, s[84:87], s43 offen
s_add_u32 s43, s43, 8192
buffer_load_dword v31, v14, s[84:87], s43 offen
s_add_u32 s43, s43, 8192
buffer_load_dword v31, v14, s[84:87], s43 offen
Lm_30:
s_barrier
s_getpc_b64 s[88:89]
Lpc_31:
s_sub_u32 s88, s88, Lpc_31-sequential_preLN__sliding_local_dilated__glu_gated_geglu__prompt_kernel
s_subb_u32 s89, s89, 0
s_lshr_b32 s43, s2, 3
s_mul_i32 s43, s43, 3840
v_min_u32 v15, 29, v1
v_lshl_add_u32 v15, v15, 7, s43
v_min_u32 v15, Ldone_1-sequential_preLN__sliding_local_dilated__glu_gated_geglu__prompt_kernel, v15
global_load_dword v31, v15, s[88:89]
s_or_b32 s43, s34, s35
s_cmp_lg_u32 s43, 0
s_cbranch_scc1 Lz_32
s_waitcnt vmcnt(0)
v_mov_b32 v5, 1
v_mov_b32 v6, 0
s_mov_b64 exec, 1
buffer_store_dword v5, v6, s[56:59], 0 offen sc1
s_mov_b64 exec, -1
Lz_32:
s_waitcnt vmcnt(1)
v_lshlrev_b32 v116, 16, v96
v_and_b32 v117, 0xffff0000, v96
v_mul_f32 v118, v116, v116
v_mul_f32 v119, v117, v117
v_lshlrev_b32 v126, 16, v97
v_and_b32 v127, 0xffff0000, v97
v_add_f32 v116, v116, v126
v_add_f32 v117, v117, v127
v_fmac_f32 v118, v126, v126
v_fmac_f32 v119, v127, v127
v_lshlrev_b32 v124, 16, v98
v_and_b32 v125, 0xffff0000, v98
v_add_f32 v116, v116, v124
v_add_f32 v117, v117, v125
v_fmac_f32 v118, v124, v124
v_fmac_f32 v119, v125, v125
v_lshlrev_b32 v126, 16, v99
v_and_b32 v127, 0xffff0000, v99
v_add_f32 v116, v116, v126
v_add_f32 v117, v117, v127
v_fmac_f32 v118, v126, v126
v_fmac_f32 v119, v127, v127
v_lshlrev_b32 v124, 16, v100
v_and_b32 v125, 0xffff0000, v100
v_add_f32 v116, v116, v124
v_add_f32 v117, v117, v125
v_fmac_f32 v118, v124, v124
v_fmac_f32 v119, v125, v125
v_lshlrev_b32 v126, 16, v101
v_and_b32 v127, 0xffff0000, v101
v_add_f32 v116, v116, v126
v_add_f32 v117, v117, v127
v_fmac_f32 v118, v126, v126
v_fmac_f32 v119, v127, v127
v_lshlrev_b32 v124, 16, v102
v_and_b32 v125, 0xffff0000, v102
v_add_f32 v116, v116, v124
v_add_f32 v117, v117, v125
v_fmac_f32 v118, v124, v124
v_fmac_f32 v119, v125, v125
v_lshlrev_b32 v126, 16, v103
v_and_b32 v127, 0xffff0000, v103
v_add_f32 v116, v116, v126
v_add_f32 v117, v117, v127
v_fmac_f32 v118, v126, v126
v_fmac_f32 v119, v127, v127
v_lshlrev_b32 v120, 16, v104
v_and_b32 v121, 0xffff0000, v104
v_mul_f32 v122, v120, v120
v_mul_f32 v123, v121, v121
s_barrier
s_cmp_lt_u32 s2, 128
s_cbranch_scc1 Lm_33
s_mov_b32 s84, s6
s_mov_b32 s85, s7
s_mov_b32 s86, 6291456
s_mov_b32 s87, 0x20000
s_lshr_b32 s44, s2, 3
s_and_b32 s43, s35, 8
s_or_b32 s43, s43, 3
s_lshl_b32 s43, s43, 7
s_mul_i32 s45, s44, 196608
s_add_u32 s43, s43, s45
v_add_u32 v15, 0, v1
v_min_u32 v15, 95, v15
v_mul_u32_u24 v16, 21846, v15
v_lshrrev_b32 v16, 16, v16
v_mul_u32_u24 v17, 3, v16
v_sub_u32 v15, v15, v17
v_mul_u32_u24 v16, 6144, v16
v_lshl_add_u32 v15, v15, 11, v16
buffer_load_dword v31, v15, s[84:87], s43 offen
v_add_u32 v15, 64, v1
v_min_u32 v15, 95, v15
v_mul_u32_u24 v16, 21846, v15
v_lshrrev_b32 v16, 16, v16
v_mul_u32_u24 v17, 3, v16
v_sub_u32 v15, v15, v17
v_mul_u32_u24 v16, 6144, v16
v_lshl_add_u32 v15, v15, 11, v16
buffer_load_dword v31, v15, s[84:87], s43 offen
Lm_33:
v_lshlrev_b32 v126, 16, v105
v_and_b32 v127, 0xffff0000, v105
v_add_f32 v120, v120, v126
v_add_f32 v121, v121, v127
v_fmac_f32 v122, v126, v126
v_fmac_f32 v123, v127, v127
v_lshlrev_b32 v124, 16, v106
v_and_b32 v125, 0xffff0000, v106
v_add_f32 v120, v120, v124
v_add_f32 v121, v121, v125
v_fmac_f32 v122, v124, v124
v_fmac_f32 v123, v125, v125
v_lshlrev_b32 v126, 16, v107
v_and_b32 v127, 0xffff0000, v107
v_add_f32 v120, v120, v126
v_add_f32 v121, v121, v127
v_fmac_f32 v122, v126, v126
v_fmac_f32 v123, v127, v127
v_lshlrev_b32 v124, 16, v108
v_and_b32 v125, 0xffff0000, v108
v_add_f32 v120, v120, v124
v_add_f32 v121, v121, v125
v_fmac_f32 v122, v124, v124
v_fmac_f32 v123, v125, v125
v_lshlrev_b32 v126, 16, v109
v_and_b32 v127, 0xffff0000, v109
v_add_f32 v120, v120, v126
v_add_f32 v121, v121, v127
v_fmac_f32 v122, v126, v126
v_fmac_f32 v123, v127, v127
v_lshlrev_b32 v124, 16, v110
v_and_b32 v125, 0xffff0000, v110
v_add_f32 v120, v120, v124
v_add_f32 v121, v121, v125
v_fmac_f32 v122, v124, v124
v_fmac_f32 v123, v125, v125
v_lshlrev_b32 v126, 16, v111
v_and_b32 v127, 0xffff0000, v111
v_add_f32 v120, v120, v126
v_add_f32 v121, v121, v127
v_fmac_f32 v122, v126, v126
v_fmac_f32 v123, v127, v127
v_add_f32 v116, v116, v117
v_add_f32 v118, v118, v119
v_add_f32 v120, v120, v121
v_add_f32 v122, v122, v123
v_add_f32_dpp v116, v116, v116 row_ror:8 row_mask:0xf bank_mask:0xf
v_add_f32_dpp v118, v118, v118 row_ror:8 row_mask:0xf bank_mask:0xf
v_add_f32_dpp v120, v120, v120 row_ror:8 row_mask:0xf bank_mask:0xf
v_add_f32_dpp v122, v122, v122 row_ror:8 row_mask:0xf bank_mask:0xf
s_barrier
v_add_f32_dpp v116, v116, v116 row_ror:4 row_mask:0xf bank_mask:0xf
v_add_f32_dpp v118, v118, v118 row_ror:4 row_mask:0xf bank_mask:0xf
v_add_f32_dpp v120, v120, v120 row_ror:4 row_mask:0xf bank_mask:0xf
v_add_f32_dpp v122, v122, v122 row_ror:4 row_mask:0xf bank_mask:0xf
v_add_f32_dpp v116, v116, v116 row_ror:2 row_mask:0xf bank_mask:0xf
v_add_f32_dpp v118, v118, v118 row_ror:2 row_mask:0xf bank_mask:0xf
v_add_f32_dpp v120, v120, v120 row_ror:2 row_mask:0xf bank_mask:0xf
v_add_f32_dpp v122, v122, v122 row_ror:2 row_mask:0xf bank_mask:0xf
v_add_f32_dpp v116, v116, v116 row_ror:1 row_mask:0xf bank_mask:0xf
v_add_f32_dpp v118, v118, v118 row_ror:1 row_mask:0xf bank_mask:0xf
v_add_f32_dpp v120, v120, v120 row_ror:1 row_mask:0xf bank_mask:0xf
v_add_f32_dpp v122, v122, v122 row_ror:1 row_mask:0xf bank_mask:0xf
v_mov_b32 v117, v116
v_mov_b32 v119, v118
v_mov_b32 v121, v120
v_mov_b32 v123, v122
s_nop 0
v_permlane16_swap_b32 v116, v117
v_permlane16_swap_b32 v118, v119
v_permlane16_swap_b32 v120, v121
v_permlane16_swap_b32 v122, v123
v_add_f32 v116, v116, v117
v_add_f32 v118, v118, v119
v_add_f32 v120, v120, v121
v_add_f32 v122, v122, v123
v_mov_b32 v117, v116
v_mov_b32 v119, v118
v_mov_b32 v121, v120
v_mov_b32 v123, v122
s_nop 0
v_permlane32_swap_b32 v116, v117
v_permlane32_swap_b32 v118, v119
v_permlane32_swap_b32 v120, v121
v_permlane32_swap_b32 v122, v123
v_add_f32 v116, v116, v117
v_add_f32 v118, v118, v119
v_add_f32 v120, v120, v121
v_add_f32 v122, v122, v123
v_mul_f32 v112, 0x3a800000, v116
v_mul_f32 v113, 0x3a800000, v118
v_fma_f32 v113, -v112, v112, v113
v_max_f32 v113, 0, v113
v_add_f32 v113, 0x3727c5ac, v113
v_rsq_f32 v113, v113
v_mul_f32 v114, 0x3a800000, v120
v_mul_f32 v115, 0x3a800000, v122
v_fma_f32 v115, -v114, v114, v115
v_max_f32 v115, 0, v115
v_add_f32 v115, 0x3727c5ac, v115
v_rsq_f32 v115, v115
s_nop 0
s_lshl_b32 s43, s47, 4
s_add_u32 s43, s43, 130176
v_mov_b32 v11, s43
ds_write_b128 v11, v[112:115]
s_waitcnt lgkmcnt(0)
s_barrier
v_lshlrev_b32 v5, 4, v1
v_and_b32 v5, 63, v5
v_add_u32 v6, 130176, v5
ds_read_b128 v[112:115], v6
s_lshl_b32 s43, s63, 3
v_add_u32 v5, s43, v5
s_waitcnt lgkmcnt(0)
s_mov_b64 exec, 15
buffer_store_dwordx4 v[112:115], v5, s[20:23], 0 offen sc1
s_mov_b64 exec, -1
s_load_dword s64, s[80:81], 0
s_load_dword s65, s[80:81], 64
s_load_dword s66, s[80:81], 128
s_load_dword s67, s[80:81], 192
s_load_dword s68, s[80:81], 7168
s_load_dword s69, s[80:81], 7232
s_load_dword s70, s[80:81], 7296
s_load_dword s71, s[80:81], 7360
s_add_u32 s80, s80, 14336
s_addc_u32 s81, s81, 0
s_barrier
v_mov_b32 v7, 0
v_mov_b32 v9, 1
buffer_load_dword v8, v7, s[56:59], 0 offen sc1
s_load_dword s64, s[80:81], 0
s_load_dword s65, s[80:81], 64
s_load_dword s66, s[80:81], 128
s_load_dword s67, s[80:81], 192
s_load_dword s68, s[80:81], 7168
s_load_dword s69, s[80:81], 7232
s_load_dword s70, s[80:81], 7296
s_load_dword s71, s[80:81], 7360
s_add_u32 s80, s80, 14336
s_addc_u32 s81, s81, 0
s_barrier
s_load_dword s64, s[80:81], 0
s_load_dword s65, s[80:81], 64
s_load_dword s66, s[80:81], 128
s_load_dword s67, s[80:81], 192
s_load_dword s68, s[80:81], 7168
s_load_dword s69, s[80:81], 7232
s_load_dword s70, s[80:81], 7296
s_load_dword s71, s[80:81], 7360
s_add_u32 s80, s80, 14336
s_addc_u32 s81, s81, 0
s_barrier
s_mov_b32 s41, 0x10000
Lpoll_34:
s_waitcnt vmcnt(0)
Lpf_36:
v_cmp_ne_u32 vcc, v9, v8
s_nop 4
s_cbranch_vccz Lpok_35
buffer_load_dword v8, v7, s[56:59], 0 offen sc1
s_sub_u32 s41, s41, 1
s_cmp_lg_u32 s41, 0
s_cbranch_scc1 Lpoll_34
s_waitcnt vmcnt(0)
Lpok_35:
s_add_u32 s56, s32, 28311552
s_addc_u32 s57, s33, 0
s_mov_b32 s58, 40960
s_mov_b32 s59, 0x20000
s_add_u32 s43, s34, 80
s_lshl_b32 s43, s43, 7
v_mov_b32 v5, s43
v_mov_b32 v6, 1
s_mov_b64 exec, 1
buffer_atomic_add v6, v5, s[56:59], 0 offen sc1
s_mov_b64 exec, -1
s_load_dword s64, s[80:81], 0
s_load_dword s65, s[80:81], 64
s_load_dword s66, s[80:81], 128
s_load_dword s67, s[80:81], 192
s_load_dword s68, s[80:81], 7168
s_load_dword s69, s[80:81], 7232
s_load_dword s70, s[80:81], 7296
s_load_dword s71, s[80:81], 7360
s_add_u32 s80, s80, 14336
s_addc_u32 s81, s81, 0
s_barrier
s_load_dword s64, s[80:81], 0
s_load_dword s65, s[80:81], 64
s_load_dword s66, s[80:81], 128
s_load_dword s67, s[80:81], 192
s_load_dword s68, s[80:81], 7168
s_load_dword s69, s[80:81], 7232
s_load_dword s70, s[80:81], 7296
s_load_dword s71, s[80:81], 7360
s_add_u32 s80, s80, 14336
s_addc_u32 s81, s81, 0
s_barrier
s_getpc_b64 s[88:89]
Lpc_37:
s_sub_u32 s88, s88, Lpc_37-sequential_preLN__sliding_local_dilated__glu_gated_geglu__prompt_kernel
s_subb_u32 s89, s89, 0
s_lshr_b32 s43, s2, 3
s_mul_i32 s43, s43, 3840
v_min_u32 v15, 29, v1
v_lshl_add_u32 v15, v15, 7, s43
v_min_u32 v15, Ldone_1-sequential_preLN__sliding_local_dilated__glu_gated_geglu__prompt_kernel, v15
global_load_dword v31, v15, s[88:89]
s_sub_u32 s44, s34, 1
s_max_i32 s44, s44, 0
v_mov_b32 v5, s44
v_mov_b32 v6, s34
v_cmp_eq_u32 vcc, 0, v1
s_nop 1
v_cndmask_b32 v5, v5, v6, vcc
v_add_u32 v5, 80, v5
v_lshlrev_b32 v5, 7, v5
buffer_load_dword v6, v5, s[56:59], 0 offen sc1
s_load_dword s64, s[80:81], 0
s_load_dword s65, s[80:81], 64
s_load_dword s66, s[80:81], 128
s_load_dword s67, s[80:81], 192
s_load_dword s68, s[80:81], 7168
s_load_dword s69, s[80:81], 7232
s_load_dword s70, s[80:81], 7296
s_load_dword s71, s[80:81], 7360
s_add_u32 s80, s80, 14336
s_addc_u32 s81, s81, 0
s_barrier
s_load_dword s64, s[80:81], 0
s_load_dword s65, s[80:81], 64
s_load_dword s66, s[80:81], 128
s_load_dword s67, s[80:81], 192
s_load_dword s68, s[80:81], 7168
s_load_dword s69, s[80:81], 7232
s_load_dword s70, s[80:81], 7296
s_load_dword s71, s[80:81], 7360
s_add_u32 s80, s80, 14336
s_addc_u32 s81, s81, 0
s_barrier
v_mov_b32 v7, 16
s_mov_b32 s41, 0x10000
Lpoll_38:
s_waitcnt vmcnt(0)
Lpf_40:
v_cmp_ne_u32 vcc, v7, v6
s_nop 4
s_cbranch_vccz Lpok_39
buffer_load_dword v6, v5, s[56:59], 0 offen sc1
s_sub_u32 s41, s41, 1
s_cmp_lg_u32 s41, 0
s_cbranch_scc1 Lpoll_38
s_waitcnt vmcnt(0)
Lpok_39:
v_add_u32 v5, 0, v1
v_min_u32 v5, 143, v5
v_lshlrev_b32 v20, 3, v5
v_add_u32 v5, s50, v5
v_max_i32 v5, 0, v5
v_lshlrev_b32 v5, 3, v5
buffer_load_dwordx2 v[32:33], v5, s[20:23], 0 offen sc1
v_add_u32 v5, 64, v1
v_min_u32 v5, 143, v5
v_lshlrev_b32 v21, 3, v5
v_add_u32 v5, s50, v5
v_max_i32 v5, 0, v5
v_lshlrev_b32 v5, 3, v5
buffer_load_dwordx2 v[34:35], v5, s[20:23], 0 offen sc1
v_add_u32 v5, 128, v1
v_min_u32 v5, 143, v5
v_lshlrev_b32 v22, 3, v5
v_add_u32 v5, s50, v5
v_max_i32 v5, 0, v5
v_lshlrev_b32 v5, 3, v5
buffer_load_dwordx2 v[36:37], v5, s[20:23], 0 offen sc1
s_load_dword s64, s[80:81], 0
s_load_dword s65, s[80:81], 64
s_load_dword s66, s[80:81], 128
s_load_dword s67, s[80:81], 192
s_load_dword s68, s[80:81], 7168
s_load_dword s69, s[80:81], 7232
s_load_dword s70, s[80:81], 7296
s_load_dword s71, s[80:81], 7360
s_add_u32 s80, s80, 14336
s_addc_u32 s81, s81, 0
s_barrier
s_load_dwordx2 s[88:89], s[0:1], 16
v_lshlrev_b32 v29, 7, v1
s_lshl_b32 s43, s2, 13
s_waitcnt lgkmcnt(0)
s_mov_b32 s84, s88
s_mov_b32 s85, s89
s_mov_b32 s86, 2097152
s_mov_b32 s87, 0x20000
buffer_load_dword v30, v29, s[84:87], s43 offen
v_and_b32 v29, 31, v1
v_lshlrev_b32 v29, 11, v29
s_and_b32 s43, s35, 8
s_or_b32 s43, s43, 3
s_lshl_b32 s43, s43, 7
s_lshr_b32 s44, s2, 3
s_lshl_b32 s44, s44, 16
s_add_u32 s43, s43, s44
buffer_load_dword v30, v29, s[84:87], s43 offen
s_barrier
s_waitcnt vmcnt(2)
v_add_u32 v20, 129024, v20
ds_write_b64 v20, v[32:33]
v_add_u32 v21, 129024, v21
ds_write_b64 v21, v[34:35]
v_add_u32 v22, 129024, v22
ds_write_b64 v22, v[36:37]
s_waitcnt lgkmcnt(0)
s_lshr_b32 s43, s2, 5
s_cmp_eq_u32 s43, 3
s_cbranch_scc1 Lnj_41
s_cmp_gt_u32 s43, 3
s_cselect_b32 s43, 32, 0
s_sub_u32 s43, s2, s43
s_lshr_b32 s43, s43, 1
s_and_b32 s44, s2, 1
s_lshl_b32 s45, s44, 3
s_add_u32 s45, s45, 32
s_load_dwordx2 s[88:89], s[0:1], s45
s_mul_i32 s45, s43, 2341
s_lshr_b32 s45, s45, 16
s_mul_i32 s46, s45, 28
s_sub_u32 s46, s43, s46
v_lshrrev_b32 v28, 4, v1
s_lshl_b32 s43, s45, 8
v_add_u32 v28, s43, v28
v_mul_u32_u24 v28, 7168, v28
v_and_b32 v29, 15, v1
v_lshl_add_u32 v28, v29, 4, v28
s_lshl_b32 s43, s46, 8
v_add_u32 v28, s43, v28
s_waitcnt lgkmcnt(0)
s_mov_b32 s84, s88
s_mov_b32 s85, s89
s_mov_b32 s86, 7340032
s_mov_b32 s87, 0x20000
s_mov_b32 s43, 0
buffer_load_dwordx4 v[128:131], v28, s[84:87], s43 offen
s_mov_b32 s43, 28672
buffer_load_dwordx4 v[132:135], v28, s[84:87], s43 offen
s_mov_b32 s43, 57344
buffer_load_dwordx4 v[136:139], v28, s[84:87], s43 offen
s_mov_b32 s43, 86016
buffer_load_dwordx4 v[140:143], v28, s[84:87], s43 offen
s_mov_b32 s43, 114688
buffer_load_dwordx4 v[144:147], v28, s[84:87], s43 offen
s_mov_b32 s43, 143360
buffer_load_dwordx4 v[148:151], v28, s[84:87], s43 offen
s_mov_b32 s43, 172032
buffer_load_dwordx4 v[152:155], v28, s[84:87], s43 offen
s_mov_b32 s43, 200704
buffer_load_dwordx4 v[156:159], v28, s[84:87], s43 offen
s_mov_b32 s43, 229376
buffer_load_dwordx4 v[160:163], v28, s[84:87], s43 offen
s_mov_b32 s43, 258048
buffer_load_dwordx4 v[164:167], v28, s[84:87], s43 offen
s_mov_b32 s43, 286720
buffer_load_dwordx4 v[168:171], v28, s[84:87], s43 offen
s_mov_b32 s43, 315392
buffer_load_dwordx4 v[172:175], v28, s[84:87], s43 offen
s_mov_b32 s43, 344064
buffer_load_dwordx4 v[176:179], v28, s[84:87], s43 offen
s_mov_b32 s43, 372736
buffer_load_dwordx4 v[180:183], v28, s[84:87], s43 offen
s_mov_b32 s43, 401408
buffer_load_dwordx4 v[184:187], v28, s[84:87], s43 offen
s_mov_b32 s43, 430080
buffer_load_dwordx4 v[188:191], v28, s[84:87], s43 offen
Lnj_41:
s_barrier
s_lshr_b32 s43, s2, 5
s_cmp_eq_u32 s43, 3
s_cbranch_scc1 Lnj_42
s_cmp_gt_u32 s43, 3
s_cselect_b32 s43, 32, 0
s_sub_u32 s43, s2, s43
s_lshr_b32 s43, s43, 1
s_and_b32 s44, s2, 1
s_lshl_b32 s45, s44, 3
s_add_u32 s45, s45, 32
s_load_dwordx2 s[88:89], s[0:1], s45
s_mul_i32 s45, s43, 2341
s_lshr_b32 s45, s45, 16
s_mul_i32 s46, s45, 28
s_sub_u32 s46, s43, s46
v_lshrrev_b32 v28, 4, v1
s_lshl_b32 s43, s45, 8
v_add_u32 v28, s43, v28
v_mul_u32_u24 v28, 7168, v28
v_and_b32 v29, 15, v1
v_lshl_add_u32 v28, v29, 4, v28
s_lshl_b32 s43, s46, 8
v_add_u32 v28, s43, v28
s_waitcnt lgkmcnt(0)
s_mov_b32 s84, s88
s_mov_b32 s85, s89
s_mov_b32 s86, 7340032
s_mov_b32 s87, 0x20000
s_mov_b32 s43, 458752
buffer_load_dwordx4 v[192:195], v28, s[84:87], s43 offen
s_mov_b32 s43, 487424
buffer_load_dwordx4 v[196:199], v28, s[84:87], s43 offen
s_mov_b32 s43, 516096
buffer_load_dwordx4 v[200:203], v28, s[84:87], s43 offen
s_mov_b32 s43, 544768
buffer_load_dwordx4 v[204:207], v28, s[84:87], s43 offen
s_mov_b32 s43, 573440
buffer_load_dwordx4 v[208:211], v28, s[84:87], s43 offen
s_mov_b32 s43, 602112
buffer_load_dwordx4 v[212:215], v28, s[84:87], s43 offen
s_mov_b32 s43, 630784
buffer_load_dwordx4 v[216:219], v28, s[84:87], s43 offen
s_mov_b32 s43, 659456
buffer_load_dwordx4 v[220:223], v28, s[84:87], s43 offen
s_mov_b32 s43, 688128
buffer_load_dwordx4 v[224:227], v28, s[84:87], s43 offen
s_mov_b32 s43, 716800
buffer_load_dwordx4 v[228:231], v28, s[84:87], s43 offen
s_mov_b32 s43, 745472
buffer_load_dwordx4 v[232:235], v28, s[84:87], s43 offen
s_mov_b32 s43, 774144
buffer_load_dwordx4 v[236:239], v28, s[84:87], s43 offen
s_mov_b32 s43, 802816
buffer_load_dwordx4 v[240:243], v28, s[84:87], s43 offen
s_mov_b32 s43, 831488
buffer_load_dwordx4 v[244:247], v28, s[84:87], s43 offen
s_mov_b32 s43, 860160
buffer_load_dwordx4 v[248:251], v28, s[84:87], s43 offen
s_mov_b32 s43, 888832
buffer_load_dwordx4 v[252:255], v28, s[84:87], s43 offen
Lnj_42:
s_barrier
s_branch Lw_43
Lr_44:
s_branch Lw_45
Lr_46:
s_branch Lw_47
Lr_48:
s_waitcnt lgkmcnt(0)
s_and_b32 s43, s36, 1
s_lshr_b32 s44, s36, 1
s_and_b32 s44, s44, 1
s_lshr_b32 s45, s36, 2
s_xor_b32 s45, s45, 1
v_lshlrev_b32 v14, 2, v13
v_sub_u32 v14, v12, v14
v_subrev_u32 v15, 0, v14
v_cmp_ge_u32 s[52:53], 7, v15
v_add_u32 v15, 16, v15
v_cmp_ge_u32 s[84:85], 7, v15
v_subrev_u32 v15, 1, v14
v_cmp_ge_u32 s[54:55], 7, v15
v_add_u32 v15, 16, v15
v_cmp_ge_u32 s[86:87], 7, v15
v_subrev_u32 v15, 2, v14
v_cmp_ge_u32 s[56:57], 7, v15
v_add_u32 v15, 16, v15
v_cmp_ge_u32 s[88:89], 7, v15
v_subrev_u32 v15, 3, v14
v_cmp_ge_u32 s[58:59], 7, v15
v_add_u32 v15, 16, v15
v_cmp_ge_u32 s[90:91], 7, v15
s_lshl_b32 s46, s45, 6
s_add_u32 s46, s46, s44
s_add_u32 s46, s46, 16
v_lshl_add_u32 v14, v12, 1, s46
s_lshl_b32 s47, s43, 6
v_lshl_add_u32 v15, v13, 4, s47
v_mul_u32_u24 v20, 400, v14
v_add_u32 v20, v20, v15
v_subrev_u32 v16, 32, v14
v_max_i32 v16, 0, v16
v_mul_u32_u24 v21, 400, v16
v_add_u32 v21, v21, v15
v_lshrrev_b32 v16, 2, v12
v_lshl_add_u32 v16, v13, 2, v16
v_lshl_add_u32 v16, v16, 1, s46
v_and_b32 v17, 3, v1
v_lshl_add_u32 v17, v17, 3, s47
v_mul_u32_u24 v22, 400, v16
v_add_u32 v22, v22, v17
v_subrev_u32 v16, 32, v16
v_max_i32 v16, 0, v16
v_mul_u32_u24 v23, 400, v16
v_add_u32 v23, v23, v17
s_lshl_b32 s60, s43, 13
s_lshl_b32 s61, s45, 10
s_add_u32 s60, s60, s61
s_lshl_b32 s61, s44, 8
s_add_u32 s60, s60, s61
v_lshlrev_b32 v27, 11, v13
v_lshl_add_u32 v27, v12, 4, v27
v_add_u32 v27, s60, v27
v_mov_b32 v28, 0xff800000
s_mov_b32 s61, 0x3e8293ee
s_nop 2
s_or_b32 s62, s34, s45
s_cmp_lg_u32 s62, 0
s_cselect_b64 s[64:65], s[84:85], 0
s_cselect_b64 s[66:67], s[86:87], 0
s_cselect_b64 s[68:69], s[88:89], 0
s_cselect_b64 s[70:71], s[90:91], 0
.p2align 3
Latt_5:
s_barrier
ds_read_b128 v[32:35], v20 offset:0
ds_read_b128 v[36:39], v20 offset:128
ds_read_b128 v[40:43], v21 offset:128
ds_read_b128 v[80:83], v20 offset:12800
ds_read_b128 v[84:87], v20 offset:12928
ds_read_b128 v[88:91], v20 offset:128
ds_read_b64_tr_b16 v[44:45], v23 offset:256
ds_read_b64_tr_b16 v[46:47], v22 offset:256
ds_read_b64_tr_b16 v[48:49], v23 offset:288
ds_read_b64_tr_b16 v[50:51], v22 offset:288
ds_read_b64_tr_b16 v[92:93], v22 offset:256
ds_read_b64_tr_b16 v[94:95], v22 offset:13056
ds_read_b64_tr_b16 v[96:97], v22 offset:288
ds_read_b64_tr_b16 v[98:99], v22 offset:13088
s_waitcnt lgkmcnt(11)
v_mfma_f32_16x16x32_bf16 v[52:55], v[40:43], v[32:35], 0
v_mfma_f32_16x16x32_bf16 v[56:59], v[36:39], v[32:35], 0
s_waitcnt lgkmcnt(8)
v_mfma_f32_16x16x32_bf16 v[100:103], v[88:91], v[80:83], 0
v_mfma_f32_16x16x32_bf16 v[104:107], v[84:87], v[80:83], 0
s_nop 7
v_cndmask_b32 v52, v28, v52, s[64:65]
v_cndmask_b32 v100, v28, v100, s[84:85]
v_cndmask_b32 v53, v28, v53, s[66:67]
v_cndmask_b32 v101, v28, v101, s[86:87]
v_cndmask_b32 v54, v28, v54, s[68:69]
v_cndmask_b32 v102, v28, v102, s[88:89]
v_cndmask_b32 v55, v28, v55, s[70:71]
v_cndmask_b32 v103, v28, v103, s[90:91]
v_cndmask_b32 v56, v28, v56, s[52:53]
v_cndmask_b32 v104, v28, v104, s[52:53]
v_cndmask_b32 v57, v28, v57, s[54:55]
v_cndmask_b32 v105, v28, v105, s[54:55]
v_cndmask_b32 v58, v28, v58, s[56:57]
v_cndmask_b32 v106, v28, v106, s[56:57]
v_cndmask_b32 v59, v28, v59, s[58:59]
v_cndmask_b32 v107, v28, v107, s[58:59]
v_max3_f32 v60, v52, v53, v54
v_max3_f32 v108, v100, v101, v102
v_max3_f32 v61, v55, v56, v57
v_max3_f32 v109, v103, v104, v105
v_max3_f32 v60, v60, v58, v59
v_max3_f32 v108, v108, v106, v107
v_max_f32 v60, v60, v61
v_max_f32 v108, v108, v109
v_mov_b32 v61, v60
v_mov_b32 v109, v108
s_nop 0
v_permlane32_swap_b32 v60, v61
v_permlane32_swap_b32 v108, v109
v_max_f32 v60, v60, v61
v_max_f32 v108, v108, v109
v_mov_b32 v61, v60
v_mov_b32 v109, v108
s_nop 0
v_permlane16_swap_b32 v60, v61
v_permlane16_swap_b32 v108, v109
v_max_f32 v60, v60, v61
v_max_f32 v108, v108, v109
v_mul_f32 v60, s61, v60
v_mul_f32 v108, s61, v108
v_fma_f32 v52, v52, s61, -v60
v_fma_f32 v100, v100, s61, -v108
v_fma_f32 v53, v53, s61, -v60
v_fma_f32 v101, v101, s61, -v108
v_fma_f32 v54, v54, s61, -v60
v_fma_f32 v102, v102, s61, -v108
v_fma_f32 v55, v55, s61, -v60
v_fma_f32 v103, v103, s61, -v108
v_fma_f32 v56, v56, s61, -v60
v_fma_f32 v104, v104, s61, -v108
v_fma_f32 v57, v57, s61, -v60
v_fma_f32 v105, v105, s61, -v108
v_fma_f32 v58, v58, s61, -v60
v_fma_f32 v106, v106, s61, -v108
v_fma_f32 v59, v59, s61, -v60
v_fma_f32 v107, v107, s61, -v108
v_exp_f32 v52, v52
v_exp_f32 v100, v100
s_barrier
v_exp_f32 v53, v53
v_exp_f32 v101, v101
v_exp_f32 v54, v54
v_exp_f32 v102, v102
v_exp_f32 v55, v55
v_exp_f32 v103, v103
v_exp_f32 v56, v56
v_exp_f32 v104, v104
v_exp_f32 v57, v57
v_exp_f32 v105, v105
v_exp_f32 v58, v58
v_exp_f32 v106, v106
v_exp_f32 v59, v59
v_exp_f32 v107, v107
v_cvt_pk_bf16_f32 v64, v52, v53
v_cvt_pk_bf16_f32 v112, v100, v101
v_cvt_pk_bf16_f32 v65, v54, v55
v_cvt_pk_bf16_f32 v113, v102, v103
v_cvt_pk_bf16_f32 v66, v56, v57
v_cvt_pk_bf16_f32 v114, v104, v105
v_cvt_pk_bf16_f32 v67, v58, v59
v_cvt_pk_bf16_f32 v115, v106, v107
s_waitcnt lgkmcnt(0)
v_mfma_f32_16x16x32_bf16 v[68:71], v[44:47], v[64:67], 0
v_mfma_f32_16x16x32_bf16 v[72:75], v[48:51], v[64:67], 0
v_mfma_f32_16x16x32_bf16 v[116:119], v[92:95], v[112:115], 0
v_mfma_f32_16x16x32_bf16 v[120:123], v[96:99], v[112:115], 0
s_load_dwordx4 s[4:7], s[0:1], 32
s_load_dwordx2 s[28:29], s[0:1], 16
s_load_dwordx4 s[60:63], s[0:1], 48
v_add_f32 v60, v52, v53
v_add_f32 v108, v100, v101
v_add_f32 v61, v54, v55
v_add_f32 v109, v102, v103
v_add_f32 v56, v56, v57
v_add_f32 v104, v104, v105
v_add_f32 v58, v58, v59
v_add_f32 v106, v106, v107
v_add_f32 v60, v60, v61
v_add_f32 v108, v108, v109
v_add_f32 v56, v56, v58
v_add_f32 v104, v104, v106
v_add_f32 v60, v60, v56
v_add_f32 v108, v108, v104
v_mov_b32 v61, v60
v_mov_b32 v109, v108
s_nop 0
v_permlane32_swap_b32 v60, v61
v_permlane32_swap_b32 v108, v109
v_add_f32 v60, v60, v61
v_add_f32 v108, v108, v109
v_mov_b32 v61, v60
v_mov_b32 v109, v108
s_nop 0
v_permlane16_swap_b32 v60, v61
v_permlane16_swap_b32 v108, v109
v_add_f32 v60, v60, v61
v_add_f32 v108, v108, v109
v_rcp_f32 v60, v60
v_rcp_f32 v108, v108
s_nop 0
v_pk_mul_f32 v[68:69], v[60:61], v[68:69] op_sel_hi:[0,1]
v_pk_mul_f32 v[70:71], v[60:61], v[70:71] op_sel_hi:[0,1]
v_pk_mul_f32 v[72:73], v[60:61], v[72:73] op_sel_hi:[0,1]
v_pk_mul_f32 v[74:75], v[60:61], v[74:75] op_sel_hi:[0,1]
v_cvt_pk_bf16_f32 v68, v68, v69
v_cvt_pk_bf16_f32 v69, v70, v71
v_cvt_pk_bf16_f32 v70, v72, v73
v_cvt_pk_bf16_f32 v71, v74, v75
buffer_store_dwordx4 v[68:71], v27, s[16:19], 0 offen offset:0 sc1
v_pk_mul_f32 v[116:117], v[108:109], v[116:117] op_sel_hi:[0,1]
v_pk_mul_f32 v[118:119], v[108:109], v[118:119] op_sel_hi:[0,1]
v_pk_mul_f32 v[120:121], v[108:109], v[120:121] op_sel_hi:[0,1]
v_pk_mul_f32 v[122:123], v[108:109], v[122:123] op_sel_hi:[0,1]
v_cvt_pk_bf16_f32 v116, v116, v117
v_cvt_pk_bf16_f32 v117, v118, v119
v_cvt_pk_bf16_f32 v118, v120, v121
v_cvt_pk_bf16_f32 v119, v122, v123
buffer_store_dwordx4 v[116:119], v27, s[16:19], 0 offen offset:512 sc1
s_branch Lk1e_49
.p2align 6
Lw_47:
s_branch Lr_48
s_nop 0
.p2align 3
Latt_4:
s_barrier
ds_read_b128 v[32:35], v20 offset:0
ds_read_b128 v[36:39], v20 offset:128
ds_read_b128 v[40:43], v21 offset:128
ds_read_b128 v[80:83], v20 offset:12800
ds_read_b128 v[84:87], v20 offset:12928
ds_read_b128 v[88:91], v20 offset:128
ds_read_b64_tr_b16 v[44:45], v23 offset:256
ds_read_b64_tr_b16 v[46:47], v22 offset:256
ds_read_b64_tr_b16 v[48:49], v23 offset:288
ds_read_b64_tr_b16 v[50:51], v22 offset:288
ds_read_b64_tr_b16 v[92:93], v22 offset:256
ds_read_b64_tr_b16 v[94:95], v22 offset:13056
ds_read_b64_tr_b16 v[96:97], v22 offset:288
ds_read_b64_tr_b16 v[98:99], v22 offset:13088
s_waitcnt lgkmcnt(11)
v_mfma_f32_16x16x32_bf16 v[52:55], v[40:43], v[32:35], 0
v_mfma_f32_16x16x32_bf16 v[56:59], v[36:39], v[32:35], 0
s_waitcnt lgkmcnt(8)
v_mfma_f32_16x16x32_bf16 v[100:103], v[88:91], v[80:83], 0
v_mfma_f32_16x16x32_bf16 v[104:107], v[84:87], v[80:83], 0
s_nop 7
v_cndmask_b32 v52, v28, v52, s[64:65]
v_cndmask_b32 v100, v28, v100, s[84:85]
v_cndmask_b32 v53, v28, v53, s[66:67]
v_cndmask_b32 v101, v28, v101, s[86:87]
v_cndmask_b32 v54, v28, v54, s[68:69]
v_cndmask_b32 v102, v28, v102, s[88:89]
v_cndmask_b32 v55, v28, v55, s[70:71]
v_cndmask_b32 v103, v28, v103, s[90:91]
v_cndmask_b32 v56, v28, v56, s[52:53]
v_cndmask_b32 v104, v28, v104, s[52:53]
v_cndmask_b32 v57, v28, v57, s[54:55]
v_cndmask_b32 v105, v28, v105, s[54:55]
v_cndmask_b32 v58, v28, v58, s[56:57]
v_cndmask_b32 v106, v28, v106, s[56:57]
v_cndmask_b32 v59, v28, v59, s[58:59]
v_cndmask_b32 v107, v28, v107, s[58:59]
v_max3_f32 v60, v52, v53, v54
v_max3_f32 v108, v100, v101, v102
v_max3_f32 v61, v55, v56, v57
v_max3_f32 v109, v103, v104, v105
v_max3_f32 v60, v60, v58, v59
v_max3_f32 v108, v108, v106, v107
v_max_f32 v60, v60, v61
v_max_f32 v108, v108, v109
v_mov_b32 v61, v60
v_mov_b32 v109, v108
s_nop 0
v_permlane32_swap_b32 v60, v61
v_permlane32_swap_b32 v108, v109
v_max_f32 v60, v60, v61
v_max_f32 v108, v108, v109
v_mov_b32 v61, v60
v_mov_b32 v109, v108
s_nop 0
v_permlane16_swap_b32 v60, v61
v_permlane16_swap_b32 v108, v109
v_max_f32 v60, v60, v61
v_max_f32 v108, v108, v109
v_mul_f32 v60, s61, v60
v_mul_f32 v108, s61, v108
v_fma_f32 v52, v52, s61, -v60
v_fma_f32 v100, v100, s61, -v108
v_fma_f32 v53, v53, s61, -v60
v_fma_f32 v101, v101, s61, -v108
v_fma_f32 v54, v54, s61, -v60
v_fma_f32 v102, v102, s61, -v108
v_fma_f32 v55, v55, s61, -v60
v_fma_f32 v103, v103, s61, -v108
v_fma_f32 v56, v56, s61, -v60
v_fma_f32 v104, v104, s61, -v108
v_fma_f32 v57, v57, s61, -v60
v_fma_f32 v105, v105, s61, -v108
v_fma_f32 v58, v58, s61, -v60
v_fma_f32 v106, v106, s61, -v108
v_fma_f32 v59, v59, s61, -v60
v_fma_f32 v107, v107, s61, -v108
v_exp_f32 v52, v52
v_exp_f32 v100, v100
v_exp_f32 v53, v53
v_exp_f32 v101, v101
v_exp_f32 v54, v54
v_exp_f32 v102, v102
v_exp_f32 v55, v55
v_exp_f32 v103, v103
v_exp_f32 v56, v56
v_exp_f32 v104, v104
v_exp_f32 v57, v57
v_exp_f32 v105, v105
v_exp_f32 v58, v58
v_exp_f32 v106, v106
v_exp_f32 v59, v59
v_exp_f32 v107, v107
v_cvt_pk_bf16_f32 v64, v52, v53
v_cvt_pk_bf16_f32 v112, v100, v101
v_cvt_pk_bf16_f32 v65, v54, v55
v_cvt_pk_bf16_f32 v113, v102, v103
v_cvt_pk_bf16_f32 v66, v56, v57
v_cvt_pk_bf16_f32 v114, v104, v105
v_cvt_pk_bf16_f32 v67, v58, v59
v_cvt_pk_bf16_f32 v115, v106, v107
s_waitcnt lgkmcnt(0)
v_mfma_f32_16x16x32_bf16 v[68:71], v[44:47], v[64:67], 0
v_mfma_f32_16x16x32_bf16 v[72:75], v[48:51], v[64:67], 0
v_mfma_f32_16x16x32_bf16 v[116:119], v[92:95], v[112:115], 0
v_mfma_f32_16x16x32_bf16 v[120:123], v[96:99], v[112:115], 0
s_load_dwordx4 s[4:7], s[0:1], 32
s_load_dwordx2 s[28:29], s[0:1], 16
s_load_dwordx4 s[60:63], s[0:1], 48
v_add_f32 v60, v52, v53
v_add_f32 v108, v100, v101
v_add_f32 v61, v54, v55
v_add_f32 v109, v102, v103
v_add_f32 v56, v56, v57
v_add_f32 v104, v104, v105
v_add_f32 v58, v58, v59
v_add_f32 v106, v106, v107
v_add_f32 v60, v60, v61
v_add_f32 v108, v108, v109
v_add_f32 v56, v56, v58
v_add_f32 v104, v104, v106
v_add_f32 v60, v60, v56
v_add_f32 v108, v108, v104
v_mov_b32 v61, v60
v_mov_b32 v109, v108
s_nop 0
v_permlane32_swap_b32 v60, v61
v_permlane32_swap_b32 v108, v109
v_add_f32 v60, v60, v61
v_add_f32 v108, v108, v109
v_mov_b32 v61, v60
v_mov_b32 v109, v108
s_nop 0
v_permlane16_swap_b32 v60, v61
v_permlane16_swap_b32 v108, v109
v_add_f32 v60, v60, v61
v_add_f32 v108, v108, v109
v_rcp_f32 v60, v60
v_rcp_f32 v108, v108
s_nop 0
v_pk_mul_f32 v[68:69], v[60:61], v[68:69] op_sel_hi:[0,1]
v_pk_mul_f32 v[70:71], v[60:61], v[70:71] op_sel_hi:[0,1]
v_pk_mul_f32 v[72:73], v[60:61], v[72:73] op_sel_hi:[0,1]
v_pk_mul_f32 v[74:75], v[60:61], v[74:75] op_sel_hi:[0,1]
v_cvt_pk_bf16_f32 v68, v68, v69
v_cvt_pk_bf16_f32 v69, v70, v71
v_cvt_pk_bf16_f32 v70, v72, v73
v_cvt_pk_bf16_f32 v71, v74, v75
buffer_store_dwordx4 v[68:71], v27, s[16:19], 0 offen offset:0 sc1
v_pk_mul_f32 v[116:117], v[108:109], v[116:117] op_sel_hi:[0,1]
v_pk_mul_f32 v[118:119], v[108:109], v[118:119] op_sel_hi:[0,1]
v_pk_mul_f32 v[120:121], v[108:109], v[120:121] op_sel_hi:[0,1]
v_pk_mul_f32 v[122:123], v[108:109], v[122:123] op_sel_hi:[0,1]
v_cvt_pk_bf16_f32 v116, v116, v117
v_cvt_pk_bf16_f32 v117, v118, v119
v_cvt_pk_bf16_f32 v118, v120, v121
v_cvt_pk_bf16_f32 v119, v122, v123
buffer_store_dwordx4 v[116:119], v27, s[16:19], 0 offen offset:512 sc1
Lk1e_49:
s_add_u32 s56, s32, 28311552
s_addc_u32 s57, s33, 0
s_mov_b32 s58, 40960
s_mov_b32 s59, 0x20000
v_and_b32 v17, 15, v1
v_lshrrev_b32 v18, 4, v1
s_lshr_b32 s46, s36, 1
s_and_b32 s46, s46, 1
s_and_b32 s47, s36, 1
s_and_b32 s51, s36, 3
s_bfe_u32 s49, s35, 0x20001
s_sub_u32 s43, 0, s49
s_and_b32 s43, s43, 3
s_cmp_ge_u32 s35, 8
s_cselect_b32 s49, s43, s49
s_lshl_b32 s49, s49, 2
s_lshr_b32 s43, s35, 3
s_lshl_b32 s43, s43, 1
s_add_u32 s49, s49, s43
s_and_b32 s43, s35, 1
s_add_u32 s49, s49, s43
s_waitcnt lgkmcnt(0)
s_cmp_ge_u32 s36, 4
s_cbranch_scc1 LG1_50
v_lshlrev_b32 v19, 11, v18
v_lshl_add_u32 v19, v17, 4, v19
s_lshl_b32 s43, s36, 9
v_add_u32 v2, s43, v19
v_add_u32 v4, 98304, v2
v_lshrrev_b32 v19, 2, v17
v_lshl_add_u32 v20, v18, 2, v19
v_bfe_u32 v21, v20, 1, 2
v_lshlrev_b32 v20, 7, v20
v_lshl_add_u32 v20, v21, 5, v20
v_and_b32 v19, 3, v1
v_lshl_add_u32 v20, v19, 3, v20
v_add_u32 v5, 0x10000, v20
v_xor_b32 v6, 32, v5
v_xor_b32 v7, 64, v5
v_xor_b32 v8, 96, v5
v_add_u32 v9, 0x10000, v5
v_add_u32 v10, 0x10000, v6
v_add_u32 v11, 0x10000, v7
v_add_u32 v12, 0x10000, v8
s_lshl_b32 s43, s34, 18
s_lshl_b32 s44, s35, 14
s_add_u32 s43, s43, s44
s_add_u32 s20, s32, s43
s_addc_u32 s21, s33, 0
s_add_u32 s20, s20, 4194304
s_addc_u32 s21, s21, 0
s_mov_b32 s22, 16384
s_mov_b32 s23, 0x20000
s_lshl_b32 s43, s34, 14
s_lshl_b32 s44, s35, 10
s_add_u32 s43, s43, s44
s_add_u32 s24, s32, s43
s_addc_u32 s25, s33, 0
s_add_u32 s24, s24, 25165824
s_addc_u32 s25, s25, 0
s_mov_b32 s26, 1024
s_mov_b32 s27, 0x20000
s_movk_i32 s50, 0x2000
v_lshrrev_b32 v19, 1, v18
v_lshl_add_u32 v19, v19, 4, v17
s_lshl_b32 s43, s36, 5
v_add_u32 v19, s43, v19
v_and_b32 v20, 1, v18
v_lshlrev_b32 v20, 2, v20
v_lshl_add_u32 v22, v19, 3, v20
s_lshl_b32 s43, s34, 18
s_add_u32 s12, s32, s43
s_addc_u32 s13, s33, 0
s_mov_b32 s14, 262144
s_mov_b32 s15, 0x20000
v_lshlrev_b32 v21, 4, v1
s_lshl_b32 s54, s36, 11
s_xor_b32 s43, s35, 1
s_and_b32 s43, s43, 15
s_lshl_b32 s43, s43, 14
s_add_u32 s30, s43, s54
s_xor_b32 s43, s35, 2
s_and_b32 s43, s43, 15
s_lshl_b32 s43, s43, 14
s_add_u32 s31, s43, s54
s_waitcnt vmcnt(0)
s_barrier
ds_write_b128 v27, v[68:71] offset:0
ds_write_b128 v27, v[116:119] offset:512
v_permlane16_swap_b32 v240, v242
v_permlane16_swap_b32 v241, v243
v_permlane16_swap_b32 v244, v246
v_permlane16_swap_b32 v245, v247
v_permlane16_swap_b32 v248, v250
v_permlane16_swap_b32 v249, v251
v_permlane16_swap_b32 v252, v254
v_permlane16_swap_b32 v253, v255
v_lshlrev_b32 v128, 16, v240
v_and_b32 v129, 0xffff0000, v240
v_lshlrev_b32 v130, 16, v241
v_and_b32 v131, 0xffff0000, v241
v_lshlrev_b32 v132, 16, v242
v_and_b32 v133, 0xffff0000, v242
v_lshlrev_b32 v134, 16, v243
v_and_b32 v135, 0xffff0000, v243
v_lshlrev_b32 v136, 16, v244
v_and_b32 v137, 0xffff0000, v244
v_lshlrev_b32 v138, 16, v245
v_and_b32 v139, 0xffff0000, v245
v_lshlrev_b32 v140, 16, v246
v_and_b32 v141, 0xffff0000, v246
v_lshlrev_b32 v142, 16, v247
v_and_b32 v143, 0xffff0000, v247
v_lshlrev_b32 v144, 16, v248
v_and_b32 v145, 0xffff0000, v248
v_lshlrev_b32 v146, 16, v249
v_and_b32 v147, 0xffff0000, v249
v_lshlrev_b32 v148, 16, v250
v_and_b32 v149, 0xffff0000, v250
v_lshlrev_b32 v150, 16, v251
v_and_b32 v151, 0xffff0000, v251
v_lshlrev_b32 v152, 16, v252
v_and_b32 v153, 0xffff0000, v252
v_lshlrev_b32 v154, 16, v253
v_and_b32 v155, 0xffff0000, v253
v_lshlrev_b32 v156, 16, v254
v_and_b32 v157, 0xffff0000, v254
v_lshlrev_b32 v158, 16, v255
v_and_b32 v159, 0xffff0000, v255
s_waitcnt lgkmcnt(0)
s_barrier
s_add_u32 m0, s54, 16384
s_add_u32 s43, s30, 0
buffer_load_dwordx4 v21, s[12:15], s43 offen sc1 lds
s_add_u32 m0, s54, 17408
s_add_u32 s43, s30, 1024
buffer_load_dwordx4 v21, s[12:15], s43 offen sc1 lds
s_add_u32 m0, s54, 32768
s_add_u32 s43, s31, 0
buffer_load_dwordx4 v21, s[12:15], s43 offen sc1 lds
s_add_u32 m0, s54, 33792
s_add_u32 s43, s31, 1024
buffer_load_dwordx4 v21, s[12:15], s43 offen sc1 lds
ds_read_b128 v[32:35], v2 offset:0
ds_read_b64_tr_b16 v[48:49], v5 offset:0
ds_read_b64_tr_b16 v[50:51], v5 offset:2048
ds_read_b64_tr_b16 v[52:53], v6 offset:0
ds_read_b64_tr_b16 v[54:55], v6 offset:2048
ds_read_b128 v[36:39], v2 offset:256
ds_read_b64_tr_b16 v[56:57], v7 offset:0
ds_read_b64_tr_b16 v[58:59], v7 offset:2048
ds_read_b64_tr_b16 v[60:61], v8 offset:0
ds_read_b64_tr_b16 v[62:63], v8 offset:2048
ds_read_b128 v[40:43], v2 offset:8192
ds_read_b64_tr_b16 v[64:65], v5 offset:4096
ds_read_b64_tr_b16 v[66:67], v5 offset:6144
ds_read_b64_tr_b16 v[68:69], v6 offset:4096
ds_read_b64_tr_b16 v[70:71], v6 offset:6144
ds_read_b128 v[44:47], v2 offset:8448
ds_read_b64_tr_b16 v[72:73], v7 offset:4096
ds_read_b64_tr_b16 v[74:75], v7 offset:6144
ds_read_b64_tr_b16 v[76:77], v8 offset:4096
ds_read_b64_tr_b16 v[78:79], v8 offset:6144
s_waitcnt lgkmcnt(0)
v_mfma_f32_16x16x32_bf16 v[128:131], v[48:51], v[32:35], v[128:131]
v_mfma_f32_16x16x32_bf16 v[132:135], v[52:55], v[32:35], v[132:135]
v_mfma_f32_16x16x32_bf16 v[136:139], v[56:59], v[32:35], v[136:139]
v_mfma_f32_16x16x32_bf16 v[140:143], v[60:63], v[32:35], v[140:143]
v_mfma_f32_16x16x32_bf16 v[144:147], v[48:51], v[36:39], v[144:147]
v_mfma_f32_16x16x32_bf16 v[148:151], v[52:55], v[36:39], v[148:151]
v_mfma_f32_16x16x32_bf16 v[152:155], v[56:59], v[36:39], v[152:155]
v_mfma_f32_16x16x32_bf16 v[156:159], v[60:63], v[36:39], v[156:159]
v_mfma_f32_16x16x32_bf16 v[128:131], v[64:67], v[40:43], v[128:131]
v_mfma_f32_16x16x32_bf16 v[132:135], v[68:71], v[40:43], v[132:135]
v_mfma_f32_16x16x32_bf16 v[136:139], v[72:75], v[40:43], v[136:139]
v_mfma_f32_16x16x32_bf16 v[140:143], v[76:79], v[40:43], v[140:143]
v_mfma_f32_16x16x32_bf16 v[144:147], v[64:67], v[44:47], v[144:147]
v_mfma_f32_16x16x32_bf16 v[148:151], v[68:71], v[44:47], v[148:151]
v_mfma_f32_16x16x32_bf16 v[152:155], v[72:75], v[44:47], v[152:155]
v_mfma_f32_16x16x32_bf16 v[156:159], v[76:79], v[44:47], v[156:159]
s_waitcnt vmcnt(2)
s_barrier
ds_read_b128 v[80:83], v2 offset:16384
ds_read_b64_tr_b16 v[96:97], v5 offset:8192
ds_read_b64_tr_b16 v[98:99], v5 offset:10240
ds_read_b64_tr_b16 v[100:101], v6 offset:8192
ds_read_b64_tr_b16 v[102:103], v6 offset:10240
ds_read_b128 v[84:87], v2 offset:16640
ds_read_b64_tr_b16 v[104:105], v7 offset:8192
ds_read_b64_tr_b16 v[106:107], v7 offset:10240
ds_read_b64_tr_b16 v[108:109], v8 offset:8192
ds_read_b64_tr_b16 v[110:111], v8 offset:10240
ds_read_b128 v[88:91], v2 offset:24576
ds_read_b64_tr_b16 v[112:113], v5 offset:12288
ds_read_b64_tr_b16 v[114:115], v5 offset:14336
ds_read_b64_tr_b16 v[116:117], v6 offset:12288
ds_read_b64_tr_b16 v[118:119], v6 offset:14336
ds_read_b128 v[92:95], v2 offset:24832
ds_read_b64_tr_b16 v[120:121], v7 offset:12288
ds_read_b64_tr_b16 v[122:123], v7 offset:14336
ds_read_b64_tr_b16 v[124:125], v8 offset:12288
ds_read_b64_tr_b16 v[126:127], v8 offset:14336
s_waitcnt vmcnt(0) lgkmcnt(0)
v_max3_u32 v19, v80, v81, v82
v_max3_u32 v19, v19, v83, v84
v_max3_u32 v19, v19, v85, v86
v_max3_u32 v19, v19, v87, v88
v_max3_u32 v19, v19, v89, v90
v_max3_u32 v19, v19, v91, v92
v_max3_u32 v19, v19, v93, v94
v_max_u32 v19, v19, v95
v_cmp_eq_u32 vcc, -1, v19
s_nop 4
s_cbranch_vccnz Lfx_53
Lok_51:
s_barrier
v_mfma_f32_16x16x32_bf16 v[128:131], v[96:99], v[80:83], v[128:131]
ds_read_b128 v[32:35], v2 offset:32768
ds_read_b64_tr_b16 v[48:49], v5 offset:16384
v_mfma_f32_16x16x32_bf16 v[132:135], v[100:103], v[80:83], v[132:135]
ds_read_b64_tr_b16 v[50:51], v5 offset:18432
v_mfma_f32_16x16x32_bf16 v[136:139], v[104:107], v[80:83], v[136:139]
ds_read_b64_tr_b16 v[52:53], v6 offset:16384
v_mfma_f32_16x16x32_bf16 v[140:143], v[108:111], v[80:83], v[140:143]
ds_read_b64_tr_b16 v[54:55], v6 offset:18432
v_mfma_f32_16x16x32_bf16 v[144:147], v[96:99], v[84:87], v[144:147]
ds_read_b128 v[36:39], v2 offset:33024
ds_read_b64_tr_b16 v[56:57], v7 offset:16384
v_mfma_f32_16x16x32_bf16 v[148:151], v[100:103], v[84:87], v[148:151]
ds_read_b64_tr_b16 v[58:59], v7 offset:18432
v_mfma_f32_16x16x32_bf16 v[152:155], v[104:107], v[84:87], v[152:155]
ds_read_b64_tr_b16 v[60:61], v8 offset:16384
v_mfma_f32_16x16x32_bf16 v[156:159], v[108:111], v[84:87], v[156:159]
ds_read_b64_tr_b16 v[62:63], v8 offset:18432
v_mfma_f32_16x16x32_bf16 v[128:131], v[112:115], v[88:91], v[128:131]
ds_read_b128 v[40:43], v2 offset:40960
ds_read_b64_tr_b16 v[64:65], v5 offset:20480
v_mfma_f32_16x16x32_bf16 v[132:135], v[116:119], v[88:91], v[132:135]
ds_read_b64_tr_b16 v[66:67], v5 offset:22528
v_mfma_f32_16x16x32_bf16 v[136:139], v[120:123], v[88:91], v[136:139]
ds_read_b64_tr_b16 v[68:69], v6 offset:20480
v_mfma_f32_16x16x32_bf16 v[140:143], v[124:127], v[88:91], v[140:143]
ds_read_b64_tr_b16 v[70:71], v6 offset:22528
v_mfma_f32_16x16x32_bf16 v[144:147], v[112:115], v[92:95], v[144:147]
ds_read_b128 v[44:47], v2 offset:41216
ds_read_b64_tr_b16 v[72:73], v7 offset:20480
v_mfma_f32_16x16x32_bf16 v[148:151], v[116:119], v[92:95], v[148:151]
ds_read_b64_tr_b16 v[74:75], v7 offset:22528
v_mfma_f32_16x16x32_bf16 v[152:155], v[120:123], v[92:95], v[152:155]
ds_read_b64_tr_b16 v[76:77], v8 offset:20480
v_mfma_f32_16x16x32_bf16 v[156:159], v[124:127], v[92:95], v[156:159]
ds_read_b64_tr_b16 v[78:79], v8 offset:22528
s_waitcnt lgkmcnt(0)
v_max3_u32 v19, v32, v33, v34
v_max3_u32 v19, v19, v35, v36
v_max3_u32 v19, v19, v37, v38
v_max3_u32 v19, v19, v39, v40
v_max3_u32 v19, v19, v41, v42
v_max3_u32 v19, v19, v43, v44
v_max3_u32 v19, v19, v45, v46
v_max_u32 v19, v19, v47
v_cmp_eq_u32 vcc, -1, v19
s_nop 4
s_cbranch_vccnz Lfx_56
Lok_54:
s_barrier
v_mfma_f32_16x16x32_bf16 v[128:131], v[48:51], v[32:35], v[128:131]
ds_read_b128 v[80:83], v2 offset:49152
ds_read_b64_tr_b16 v[96:97], v5 offset:24576
v_mfma_f32_16x16x32_bf16 v[132:135], v[52:55], v[32:35], v[132:135]
ds_read_b64_tr_b16 v[98:99], v5 offset:26624
v_mfma_f32_16x16x32_bf16 v[136:139], v[56:59], v[32:35], v[136:139]
ds_read_b64_tr_b16 v[100:101], v6 offset:24576
v_mfma_f32_16x16x32_bf16 v[140:143], v[60:63], v[32:35], v[140:143]
ds_read_b64_tr_b16 v[102:103], v6 offset:26624
v_mfma_f32_16x16x32_bf16 v[144:147], v[48:51], v[36:39], v[144:147]
ds_read_b128 v[84:87], v2 offset:49408
ds_read_b64_tr_b16 v[104:105], v7 offset:24576
v_mfma_f32_16x16x32_bf16 v[148:151], v[52:55], v[36:39], v[148:151]
ds_read_b64_tr_b16 v[106:107], v7 offset:26624
v_mfma_f32_16x16x32_bf16 v[152:155], v[56:59], v[36:39], v[152:155]
ds_read_b64_tr_b16 v[108:109], v8 offset:24576
v_mfma_f32_16x16x32_bf16 v[156:159], v[60:63], v[36:39], v[156:159]
ds_read_b64_tr_b16 v[110:111], v8 offset:26624
v_mfma_f32_16x16x32_bf16 v[128:131], v[64:67], v[40:43], v[128:131]
ds_read_b128 v[88:91], v2 offset:57344
ds_read_b64_tr_b16 v[112:113], v5 offset:28672
v_mfma_f32_16x16x32_bf16 v[132:135], v[68:71], v[40:43], v[132:135]
ds_read_b64_tr_b16 v[114:115], v5 offset:30720
v_mfma_f32_16x16x32_bf16 v[136:139], v[72:75], v[40:43], v[136:139]
ds_read_b64_tr_b16 v[116:117], v6 offset:28672
v_mfma_f32_16x16x32_bf16 v[140:143], v[76:79], v[40:43], v[140:143]
ds_read_b64_tr_b16 v[118:119], v6 offset:30720
v_mfma_f32_16x16x32_bf16 v[144:147], v[64:67], v[44:47], v[144:147]
ds_read_b128 v[92:95], v2 offset:57600
ds_read_b64_tr_b16 v[120:121], v7 offset:28672
v_mfma_f32_16x16x32_bf16 v[148:151], v[68:71], v[44:47], v[148:151]
ds_read_b64_tr_b16 v[122:123], v7 offset:30720
v_mfma_f32_16x16x32_bf16 v[152:155], v[72:75], v[44:47], v[152:155]
ds_read_b64_tr_b16 v[124:125], v8 offset:28672
v_mfma_f32_16x16x32_bf16 v[156:159], v[76:79], v[44:47], v[156:159]
ds_read_b64_tr_b16 v[126:127], v8 offset:30720
s_waitcnt lgkmcnt(0)
v_max3_u32 v19, v80, v81, v82
v_max3_u32 v19, v19, v83, v84
v_max3_u32 v19, v19, v85, v86
v_max3_u32 v19, v19, v87, v88
v_max3_u32 v19, v19, v89, v90
v_max3_u32 v19, v19, v91, v92
v_max3_u32 v19, v19, v93, v94
v_max_u32 v19, v19, v95
v_cmp_eq_u32 vcc, -1, v19
s_nop 4
s_cbranch_vccnz Lfx_59
Lok_57:
s_barrier
v_mfma_f32_16x16x32_bf16 v[128:131], v[96:99], v[80:83], v[128:131]
ds_read_b128 v[32:35], v2 offset:0
ds_read_b64_tr_b16 v[48:49], v5 offset:32768
v_mfma_f32_16x16x32_bf16 v[132:135], v[100:103], v[80:83], v[132:135]
ds_read_b64_tr_b16 v[50:51], v5 offset:34816
v_mfma_f32_16x16x32_bf16 v[136:139], v[104:107], v[80:83], v[136:139]
ds_read_b64_tr_b16 v[52:53], v6 offset:32768
v_mfma_f32_16x16x32_bf16 v[140:143], v[108:111], v[80:83], v[140:143]
ds_read_b64_tr_b16 v[54:55], v6 offset:34816
v_mfma_f32_16x16x32_bf16 v[144:147], v[96:99], v[84:87], v[144:147]
ds_read_b128 v[36:39], v2 offset:256
ds_read_b64_tr_b16 v[56:57], v7 offset:32768
v_mfma_f32_16x16x32_bf16 v[148:151], v[100:103], v[84:87], v[148:151]
ds_read_b64_tr_b16 v[58:59], v7 offset:34816
v_mfma_f32_16x16x32_bf16 v[152:155], v[104:107], v[84:87], v[152:155]
ds_read_b64_tr_b16 v[60:61], v8 offset:32768
v_mfma_f32_16x16x32_bf16 v[156:159], v[108:111], v[84:87], v[156:159]
ds_read_b64_tr_b16 v[62:63], v8 offset:34816
v_mfma_f32_16x16x32_bf16 v[128:131], v[112:115], v[88:91], v[128:131]
ds_read_b128 v[40:43], v2 offset:8192
ds_read_b64_tr_b16 v[64:65], v5 offset:36864
v_mfma_f32_16x16x32_bf16 v[132:135], v[116:119], v[88:91], v[132:135]
ds_read_b64_tr_b16 v[66:67], v5 offset:38912
v_mfma_f32_16x16x32_bf16 v[136:139], v[120:123], v[88:91], v[136:139]
ds_read_b64_tr_b16 v[68:69], v6 offset:36864
v_mfma_f32_16x16x32_bf16 v[140:143], v[124:127], v[88:91], v[140:143]
ds_read_b64_tr_b16 v[70:71], v6 offset:38912
v_mfma_f32_16x16x32_bf16 v[144:147], v[112:115], v[92:95], v[144:147]
ds_read_b128 v[44:47], v2 offset:8448
ds_read_b64_tr_b16 v[72:73], v7 offset:36864
v_mfma_f32_16x16x32_bf16 v[148:151], v[116:119], v[92:95], v[148:151]
ds_read_b64_tr_b16 v[74:75], v7 offset:38912
v_mfma_f32_16x16x32_bf16 v[152:155], v[120:123], v[92:95], v[152:155]
ds_read_b64_tr_b16 v[76:77], v8 offset:36864
v_mfma_f32_16x16x32_bf16 v[156:159], v[124:127], v[92:95], v[156:159]
ds_read_b64_tr_b16 v[78:79], v8 offset:38912
s_waitcnt lgkmcnt(0)
v_max3_u32 v19, v32, v33, v34
v_max3_u32 v19, v19, v35, v36
v_max3_u32 v19, v19, v37, v38
v_max3_u32 v19, v19, v39, v40
v_max3_u32 v19, v19, v41, v42
v_max3_u32 v19, v19, v43, v44
v_max3_u32 v19, v19, v45, v46
v_max_u32 v19, v19, v47
v_cmp_eq_u32 vcc, -1, v19
s_nop 4
s_cbranch_vccnz Lfx_62
Lok_60:
s_barrier
v_mfma_f32_16x16x32_bf16 v[128:131], v[48:51], v[32:35], v[128:131]
ds_read_b128 v[80:83], v2 offset:16384
ds_read_b64_tr_b16 v[96:97], v5 offset:40960
v_mfma_f32_16x16x32_bf16 v[132:135], v[52:55], v[32:35], v[132:135]
ds_read_b64_tr_b16 v[98:99], v5 offset:43008
v_mfma_f32_16x16x32_bf16 v[136:139], v[56:59], v[32:35], v[136:139]
ds_read_b64_tr_b16 v[100:101], v6 offset:40960
v_mfma_f32_16x16x32_bf16 v[140:143], v[60:63], v[32:35], v[140:143]
ds_read_b64_tr_b16 v[102:103], v6 offset:43008
v_mfma_f32_16x16x32_bf16 v[144:147], v[48:51], v[36:39], v[144:147]
ds_read_b128 v[84:87], v2 offset:16640
ds_read_b64_tr_b16 v[104:105], v7 offset:40960
v_mfma_f32_16x16x32_bf16 v[148:151], v[52:55], v[36:39], v[148:151]
ds_read_b64_tr_b16 v[106:107], v7 offset:43008
v_mfma_f32_16x16x32_bf16 v[152:155], v[56:59], v[36:39], v[152:155]
ds_read_b64_tr_b16 v[108:109], v8 offset:40960
v_mfma_f32_16x16x32_bf16 v[156:159], v[60:63], v[36:39], v[156:159]
ds_read_b64_tr_b16 v[110:111], v8 offset:43008
v_mfma_f32_16x16x32_bf16 v[128:131], v[64:67], v[40:43], v[128:131]
ds_read_b128 v[88:91], v2 offset:24576
ds_read_b64_tr_b16 v[112:113], v5 offset:45056
v_mfma_f32_16x16x32_bf16 v[132:135], v[68:71], v[40:43], v[132:135]
ds_read_b64_tr_b16 v[114:115], v5 offset:47104
v_mfma_f32_16x16x32_bf16 v[136:139], v[72:75], v[40:43], v[136:139]
ds_read_b64_tr_b16 v[116:117], v6 offset:45056
v_mfma_f32_16x16x32_bf16 v[140:143], v[76:79], v[40:43], v[140:143]
ds_read_b64_tr_b16 v[118:119], v6 offset:47104
v_mfma_f32_16x16x32_bf16 v[144:147], v[64:67], v[44:47], v[144:147]
ds_read_b128 v[92:95], v2 offset:24832
ds_read_b64_tr_b16 v[120:121], v7 offset:45056
v_mfma_f32_16x16x32_bf16 v[148:151], v[68:71], v[44:47], v[148:151]
ds_read_b64_tr_b16 v[122:123], v7 offset:47104
v_mfma_f32_16x16x32_bf16 v[152:155], v[72:75], v[44:47], v[152:155]
ds_read_b64_tr_b16 v[124:125], v8 offset:45056
v_mfma_f32_16x16x32_bf16 v[156:159], v[76:79], v[44:47], v[156:159]
ds_read_b64_tr_b16 v[126:127], v8 offset:47104
s_waitcnt lgkmcnt(0)
v_max3_u32 v19, v80, v81, v82
v_max3_u32 v19, v19, v83, v84
v_max3_u32 v19, v19, v85, v86
v_max3_u32 v19, v19, v87, v88
v_max3_u32 v19, v19, v89, v90
v_max3_u32 v19, v19, v91, v92
v_max3_u32 v19, v19, v93, v94
v_max_u32 v19, v19, v95
v_cmp_eq_u32 vcc, -1, v19
s_nop 4
s_cbranch_vccnz Lfx_65
Lok_63:
s_barrier
v_mfma_f32_16x16x32_bf16 v[128:131], v[96:99], v[80:83], v[128:131]
ds_read_b128 v[32:35], v2 offset:32768
ds_read_b64_tr_b16 v[48:49], v5 offset:49152
v_mfma_f32_16x16x32_bf16 v[132:135], v[100:103], v[80:83], v[132:135]
ds_read_b64_tr_b16 v[50:51], v5 offset:51200
v_mfma_f32_16x16x32_bf16 v[136:139], v[104:107], v[80:83], v[136:139]
ds_read_b64_tr_b16 v[52:53], v6 offset:49152
v_mfma_f32_16x16x32_bf16 v[140:143], v[108:111], v[80:83], v[140:143]
ds_read_b64_tr_b16 v[54:55], v6 offset:51200
v_mfma_f32_16x16x32_bf16 v[144:147], v[96:99], v[84:87], v[144:147]
ds_read_b128 v[36:39], v2 offset:33024
ds_read_b64_tr_b16 v[56:57], v7 offset:49152
v_mfma_f32_16x16x32_bf16 v[148:151], v[100:103], v[84:87], v[148:151]
ds_read_b64_tr_b16 v[58:59], v7 offset:51200
v_mfma_f32_16x16x32_bf16 v[152:155], v[104:107], v[84:87], v[152:155]
ds_read_b64_tr_b16 v[60:61], v8 offset:49152
v_mfma_f32_16x16x32_bf16 v[156:159], v[108:111], v[84:87], v[156:159]
ds_read_b64_tr_b16 v[62:63], v8 offset:51200
v_mfma_f32_16x16x32_bf16 v[128:131], v[112:115], v[88:91], v[128:131]
ds_read_b128 v[40:43], v2 offset:40960
ds_read_b64_tr_b16 v[64:65], v5 offset:53248
v_mfma_f32_16x16x32_bf16 v[132:135], v[116:119], v[88:91], v[132:135]
ds_read_b64_tr_b16 v[66:67], v5 offset:55296
v_mfma_f32_16x16x32_bf16 v[136:139], v[120:123], v[88:91], v[136:139]
ds_read_b64_tr_b16 v[68:69], v6 offset:53248
v_mfma_f32_16x16x32_bf16 v[140:143], v[124:127], v[88:91], v[140:143]
ds_read_b64_tr_b16 v[70:71], v6 offset:55296
v_mfma_f32_16x16x32_bf16 v[144:147], v[112:115], v[92:95], v[144:147]
ds_read_b128 v[44:47], v2 offset:41216
ds_read_b64_tr_b16 v[72:73], v7 offset:53248
v_mfma_f32_16x16x32_bf16 v[148:151], v[116:119], v[92:95], v[148:151]
ds_read_b64_tr_b16 v[74:75], v7 offset:55296
v_mfma_f32_16x16x32_bf16 v[152:155], v[120:123], v[92:95], v[152:155]
ds_read_b64_tr_b16 v[76:77], v8 offset:53248
v_mfma_f32_16x16x32_bf16 v[156:159], v[124:127], v[92:95], v[156:159]
ds_read_b64_tr_b16 v[78:79], v8 offset:55296
s_waitcnt lgkmcnt(0)
v_max3_u32 v19, v32, v33, v34
v_max3_u32 v19, v19, v35, v36
v_max3_u32 v19, v19, v37, v38
v_max3_u32 v19, v19, v39, v40
v_max3_u32 v19, v19, v41, v42
v_max3_u32 v19, v19, v43, v44
v_max3_u32 v19, v19, v45, v46
v_max_u32 v19, v19, v47
v_cmp_eq_u32 vcc, -1, v19
s_nop 4
s_cbranch_vccnz Lfx_68
Lok_66:
s_barrier
v_mfma_f32_16x16x32_bf16 v[128:131], v[48:51], v[32:35], v[128:131]
ds_read_b128 v[80:83], v2 offset:49152
ds_read_b64_tr_b16 v[96:97], v5 offset:57344
v_mfma_f32_16x16x32_bf16 v[132:135], v[52:55], v[32:35], v[132:135]
ds_read_b64_tr_b16 v[98:99], v5 offset:59392
v_mfma_f32_16x16x32_bf16 v[136:139], v[56:59], v[32:35], v[136:139]
ds_read_b64_tr_b16 v[100:101], v6 offset:57344
v_mfma_f32_16x16x32_bf16 v[140:143], v[60:63], v[32:35], v[140:143]
ds_read_b64_tr_b16 v[102:103], v6 offset:59392
v_mfma_f32_16x16x32_bf16 v[144:147], v[48:51], v[36:39], v[144:147]
ds_read_b128 v[84:87], v2 offset:49408
ds_read_b64_tr_b16 v[104:105], v7 offset:57344
v_mfma_f32_16x16x32_bf16 v[148:151], v[52:55], v[36:39], v[148:151]
ds_read_b64_tr_b16 v[106:107], v7 offset:59392
v_mfma_f32_16x16x32_bf16 v[152:155], v[56:59], v[36:39], v[152:155]
ds_read_b64_tr_b16 v[108:109], v8 offset:57344
v_mfma_f32_16x16x32_bf16 v[156:159], v[60:63], v[36:39], v[156:159]
ds_read_b64_tr_b16 v[110:111], v8 offset:59392
v_mfma_f32_16x16x32_bf16 v[128:131], v[64:67], v[40:43], v[128:131]
ds_read_b128 v[88:91], v2 offset:57344
ds_read_b64_tr_b16 v[112:113], v5 offset:61440
v_mfma_f32_16x16x32_bf16 v[132:135], v[68:71], v[40:43], v[132:135]
ds_read_b64_tr_b16 v[114:115], v5 offset:63488
v_mfma_f32_16x16x32_bf16 v[136:139], v[72:75], v[40:43], v[136:139]
ds_read_b64_tr_b16 v[116:117], v6 offset:61440
v_mfma_f32_16x16x32_bf16 v[140:143], v[76:79], v[40:43], v[140:143]
ds_read_b64_tr_b16 v[118:119], v6 offset:63488
v_mfma_f32_16x16x32_bf16 v[144:147], v[64:67], v[44:47], v[144:147]
ds_read_b128 v[92:95], v2 offset:57600
ds_read_b64_tr_b16 v[120:121], v7 offset:61440
v_mfma_f32_16x16x32_bf16 v[148:151], v[68:71], v[44:47], v[148:151]
ds_read_b64_tr_b16 v[122:123], v7 offset:63488
v_mfma_f32_16x16x32_bf16 v[152:155], v[72:75], v[44:47], v[152:155]
ds_read_b64_tr_b16 v[124:125], v8 offset:61440
v_mfma_f32_16x16x32_bf16 v[156:159], v[76:79], v[44:47], v[156:159]
ds_read_b64_tr_b16 v[126:127], v8 offset:63488
s_waitcnt lgkmcnt(0)
v_max3_u32 v19, v80, v81, v82
v_max3_u32 v19, v19, v83, v84
v_max3_u32 v19, v19, v85, v86
v_max3_u32 v19, v19, v87, v88
v_max3_u32 v19, v19, v89, v90
v_max3_u32 v19, v19, v91, v92
v_max3_u32 v19, v19, v93, v94
v_max_u32 v19, v19, v95
v_cmp_eq_u32 vcc, -1, v19
s_nop 4
s_cbranch_vccnz Lfx_71
Lok_69:
s_barrier
v_mfma_f32_16x16x32_bf16 v[128:131], v[96:99], v[80:83], v[128:131]
ds_read_b128 v[32:35], v2 offset:0
ds_read_b64_tr_b16 v[48:49], v9 offset:0
v_mfma_f32_16x16x32_bf16 v[132:135], v[100:103], v[80:83], v[132:135]
ds_read_b64_tr_b16 v[50:51], v9 offset:2048
v_mfma_f32_16x16x32_bf16 v[136:139], v[104:107], v[80:83], v[136:139]
ds_read_b64_tr_b16 v[52:53], v10 offset:0
v_mfma_f32_16x16x32_bf16 v[140:143], v[108:111], v[80:83], v[140:143]
ds_read_b64_tr_b16 v[54:55], v10 offset:2048
v_mfma_f32_16x16x32_bf16 v[144:147], v[96:99], v[84:87], v[144:147]
ds_read_b128 v[36:39], v2 offset:256
ds_read_b64_tr_b16 v[56:57], v11 offset:0
v_mfma_f32_16x16x32_bf16 v[148:151], v[100:103], v[84:87], v[148:151]
ds_read_b64_tr_b16 v[58:59], v11 offset:2048
v_mfma_f32_16x16x32_bf16 v[152:155], v[104:107], v[84:87], v[152:155]
ds_read_b64_tr_b16 v[60:61], v12 offset:0
v_mfma_f32_16x16x32_bf16 v[156:159], v[108:111], v[84:87], v[156:159]
ds_read_b64_tr_b16 v[62:63], v12 offset:2048
v_mfma_f32_16x16x32_bf16 v[128:131], v[112:115], v[88:91], v[128:131]
ds_read_b128 v[40:43], v2 offset:8192
ds_read_b64_tr_b16 v[64:65], v9 offset:4096
v_mfma_f32_16x16x32_bf16 v[132:135], v[116:119], v[88:91], v[132:135]
ds_read_b64_tr_b16 v[66:67], v9 offset:6144
v_mfma_f32_16x16x32_bf16 v[136:139], v[120:123], v[88:91], v[136:139]
ds_read_b64_tr_b16 v[68:69], v10 offset:4096
v_mfma_f32_16x16x32_bf16 v[140:143], v[124:127], v[88:91], v[140:143]
ds_read_b64_tr_b16 v[70:71], v10 offset:6144
v_mfma_f32_16x16x32_bf16 v[144:147], v[112:115], v[92:95], v[144:147]
ds_read_b128 v[44:47], v2 offset:8448
ds_read_b64_tr_b16 v[72:73], v11 offset:4096
v_mfma_f32_16x16x32_bf16 v[148:151], v[116:119], v[92:95], v[148:151]
ds_read_b64_tr_b16 v[74:75], v11 offset:6144
v_mfma_f32_16x16x32_bf16 v[152:155], v[120:123], v[92:95], v[152:155]
ds_read_b64_tr_b16 v[76:77], v12 offset:4096
v_mfma_f32_16x16x32_bf16 v[156:159], v[124:127], v[92:95], v[156:159]
ds_read_b64_tr_b16 v[78:79], v12 offset:6144
s_waitcnt lgkmcnt(0)
v_max3_u32 v19, v32, v33, v34
v_max3_u32 v19, v19, v35, v36
v_max3_u32 v19, v19, v37, v38
v_max3_u32 v19, v19, v39, v40
v_max3_u32 v19, v19, v41, v42
v_max3_u32 v19, v19, v43, v44
v_max3_u32 v19, v19, v45, v46
v_max_u32 v19, v19, v47
v_cmp_eq_u32 vcc, -1, v19
s_nop 4
s_cbranch_vccnz Lfx_74
Lok_72:
s_barrier
v_mfma_f32_16x16x32_bf16 v[128:131], v[48:51], v[32:35], v[128:131]
ds_read_b128 v[80:83], v2 offset:16384
ds_read_b64_tr_b16 v[96:97], v9 offset:8192
v_mfma_f32_16x16x32_bf16 v[132:135], v[52:55], v[32:35], v[132:135]
ds_read_b64_tr_b16 v[98:99], v9 offset:10240
v_mfma_f32_16x16x32_bf16 v[136:139], v[56:59], v[32:35], v[136:139]
ds_read_b64_tr_b16 v[100:101], v10 offset:8192
v_mfma_f32_16x16x32_bf16 v[140:143], v[60:63], v[32:35], v[140:143]
ds_read_b64_tr_b16 v[102:103], v10 offset:10240
v_mfma_f32_16x16x32_bf16 v[144:147], v[48:51], v[36:39], v[144:147]
ds_read_b128 v[84:87], v2 offset:16640
ds_read_b64_tr_b16 v[104:105], v11 offset:8192
v_mfma_f32_16x16x32_bf16 v[148:151], v[52:55], v[36:39], v[148:151]
ds_read_b64_tr_b16 v[106:107], v11 offset:10240
v_mfma_f32_16x16x32_bf16 v[152:155], v[56:59], v[36:39], v[152:155]
ds_read_b64_tr_b16 v[108:109], v12 offset:8192
v_mfma_f32_16x16x32_bf16 v[156:159], v[60:63], v[36:39], v[156:159]
ds_read_b64_tr_b16 v[110:111], v12 offset:10240
v_mfma_f32_16x16x32_bf16 v[128:131], v[64:67], v[40:43], v[128:131]
ds_read_b128 v[88:91], v2 offset:24576
ds_read_b64_tr_b16 v[112:113], v9 offset:12288
v_mfma_f32_16x16x32_bf16 v[132:135], v[68:71], v[40:43], v[132:135]
ds_read_b64_tr_b16 v[114:115], v9 offset:14336
v_mfma_f32_16x16x32_bf16 v[136:139], v[72:75], v[40:43], v[136:139]
ds_read_b64_tr_b16 v[116:117], v10 offset:12288
v_mfma_f32_16x16x32_bf16 v[140:143], v[76:79], v[40:43], v[140:143]
ds_read_b64_tr_b16 v[118:119], v10 offset:14336
v_mfma_f32_16x16x32_bf16 v[144:147], v[64:67], v[44:47], v[144:147]
ds_read_b128 v[92:95], v2 offset:24832
ds_read_b64_tr_b16 v[120:121], v11 offset:12288
v_mfma_f32_16x16x32_bf16 v[148:151], v[68:71], v[44:47], v[148:151]
ds_read_b64_tr_b16 v[122:123], v11 offset:14336
v_mfma_f32_16x16x32_bf16 v[152:155], v[72:75], v[44:47], v[152:155]
ds_read_b64_tr_b16 v[124:125], v12 offset:12288
v_mfma_f32_16x16x32_bf16 v[156:159], v[76:79], v[44:47], v[156:159]
ds_read_b64_tr_b16 v[126:127], v12 offset:14336
s_waitcnt lgkmcnt(0)
v_max3_u32 v19, v80, v81, v82
v_max3_u32 v19, v19, v83, v84
v_max3_u32 v19, v19, v85, v86
v_max3_u32 v19, v19, v87, v88
v_max3_u32 v19, v19, v89, v90
v_max3_u32 v19, v19, v91, v92
v_max3_u32 v19, v19, v93, v94
v_max_u32 v19, v19, v95
v_cmp_eq_u32 vcc, -1, v19
s_nop 4
s_cbranch_vccnz Lfx_77
Lok_75:
s_barrier
v_mfma_f32_16x16x32_bf16 v[128:131], v[96:99], v[80:83], v[128:131]
ds_read_b128 v[32:35], v2 offset:32768
ds_read_b64_tr_b16 v[48:49], v5 offset:0
v_mfma_f32_16x16x32_bf16 v[132:135], v[100:103], v[80:83], v[132:135]
ds_read_b64_tr_b16 v[50:51], v5 offset:2048
v_mfma_f32_16x16x32_bf16 v[136:139], v[104:107], v[80:83], v[136:139]
ds_read_b64_tr_b16 v[52:53], v6 offset:0
v_mfma_f32_16x16x32_bf16 v[140:143], v[108:111], v[80:83], v[140:143]
ds_read_b64_tr_b16 v[54:55], v6 offset:2048
v_mfma_f32_16x16x32_bf16 v[144:147], v[96:99], v[84:87], v[144:147]
ds_read_b128 v[36:39], v2 offset:33024
ds_read_b64_tr_b16 v[56:57], v7 offset:0
v_mfma_f32_16x16x32_bf16 v[148:151], v[100:103], v[84:87], v[148:151]
ds_read_b64_tr_b16 v[58:59], v7 offset:2048
v_mfma_f32_16x16x32_bf16 v[152:155], v[104:107], v[84:87], v[152:155]
ds_read_b64_tr_b16 v[60:61], v8 offset:0
v_mfma_f32_16x16x32_bf16 v[156:159], v[108:111], v[84:87], v[156:159]
ds_read_b64_tr_b16 v[62:63], v8 offset:2048
v_mfma_f32_16x16x32_bf16 v[128:131], v[112:115], v[88:91], v[128:131]
ds_read_b128 v[40:43], v2 offset:40960
ds_read_b64_tr_b16 v[64:65], v5 offset:4096
v_mfma_f32_16x16x32_bf16 v[132:135], v[116:119], v[88:91], v[132:135]
ds_read_b64_tr_b16 v[66:67], v5 offset:6144
v_mfma_f32_16x16x32_bf16 v[136:139], v[120:123], v[88:91], v[136:139]
ds_read_b64_tr_b16 v[68:69], v6 offset:4096
v_mfma_f32_16x16x32_bf16 v[140:143], v[124:127], v[88:91], v[140:143]
ds_read_b64_tr_b16 v[70:71], v6 offset:6144
v_mfma_f32_16x16x32_bf16 v[144:147], v[112:115], v[92:95], v[144:147]
ds_read_b128 v[44:47], v2 offset:41216
ds_read_b64_tr_b16 v[72:73], v7 offset:4096
v_mfma_f32_16x16x32_bf16 v[148:151], v[116:119], v[92:95], v[148:151]
ds_read_b64_tr_b16 v[74:75], v7 offset:6144
v_mfma_f32_16x16x32_bf16 v[152:155], v[120:123], v[92:95], v[152:155]
ds_read_b64_tr_b16 v[76:77], v8 offset:4096
v_mfma_f32_16x16x32_bf16 v[156:159], v[124:127], v[92:95], v[156:159]
ds_read_b64_tr_b16 v[78:79], v8 offset:6144
s_waitcnt lgkmcnt(0)
v_max3_u32 v19, v32, v33, v34
v_max3_u32 v19, v19, v35, v36
v_max3_u32 v19, v19, v37, v38
v_max3_u32 v19, v19, v39, v40
v_max3_u32 v19, v19, v41, v42
v_max3_u32 v19, v19, v43, v44
v_max3_u32 v19, v19, v45, v46
v_max_u32 v19, v19, v47
v_cmp_eq_u32 vcc, -1, v19
s_nop 4
s_cbranch_vccnz Lfx_80
Lok_78:
s_barrier
v_mfma_f32_16x16x32_bf16 v[128:131], v[48:51], v[32:35], v[128:131]
ds_read_b128 v[80:83], v2 offset:49152
ds_read_b64_tr_b16 v[96:97], v5 offset:8192
v_mfma_f32_16x16x32_bf16 v[132:135], v[52:55], v[32:35], v[132:135]
ds_read_b64_tr_b16 v[98:99], v5 offset:10240
v_mfma_f32_16x16x32_bf16 v[136:139], v[56:59], v[32:35], v[136:139]
ds_read_b64_tr_b16 v[100:101], v6 offset:8192
v_mfma_f32_16x16x32_bf16 v[140:143], v[60:63], v[32:35], v[140:143]
ds_read_b64_tr_b16 v[102:103], v6 offset:10240
v_mfma_f32_16x16x32_bf16 v[144:147], v[48:51], v[36:39], v[144:147]
ds_read_b128 v[84:87], v2 offset:49408
ds_read_b64_tr_b16 v[104:105], v7 offset:8192
v_mfma_f32_16x16x32_bf16 v[148:151], v[52:55], v[36:39], v[148:151]
ds_read_b64_tr_b16 v[106:107], v7 offset:10240
v_mfma_f32_16x16x32_bf16 v[152:155], v[56:59], v[36:39], v[152:155]
ds_read_b64_tr_b16 v[108:109], v8 offset:8192
v_mfma_f32_16x16x32_bf16 v[156:159], v[60:63], v[36:39], v[156:159]
ds_read_b64_tr_b16 v[110:111], v8 offset:10240
v_mfma_f32_16x16x32_bf16 v[128:131], v[64:67], v[40:43], v[128:131]
ds_read_b128 v[88:91], v2 offset:57344
ds_read_b64_tr_b16 v[112:113], v5 offset:12288
v_mfma_f32_16x16x32_bf16 v[132:135], v[68:71], v[40:43], v[132:135]
ds_read_b64_tr_b16 v[114:115], v5 offset:14336
v_mfma_f32_16x16x32_bf16 v[136:139], v[72:75], v[40:43], v[136:139]
ds_read_b64_tr_b16 v[116:117], v6 offset:12288
v_mfma_f32_16x16x32_bf16 v[140:143], v[76:79], v[40:43], v[140:143]
ds_read_b64_tr_b16 v[118:119], v6 offset:14336
v_mfma_f32_16x16x32_bf16 v[144:147], v[64:67], v[44:47], v[144:147]
ds_read_b128 v[92:95], v2 offset:57600
ds_read_b64_tr_b16 v[120:121], v7 offset:12288
v_mfma_f32_16x16x32_bf16 v[148:151], v[68:71], v[44:47], v[148:151]
ds_read_b64_tr_b16 v[122:123], v7 offset:14336
v_mfma_f32_16x16x32_bf16 v[152:155], v[72:75], v[44:47], v[152:155]
ds_read_b64_tr_b16 v[124:125], v8 offset:12288
v_mfma_f32_16x16x32_bf16 v[156:159], v[76:79], v[44:47], v[156:159]
ds_read_b64_tr_b16 v[126:127], v8 offset:14336
s_waitcnt lgkmcnt(0)
s_barrier
v_mfma_f32_16x16x32_bf16 v[128:131], v[96:99], v[80:83], v[128:131]
ds_read_b128 v[32:35], v2 offset:0
ds_read_b64_tr_b16 v[48:49], v5 offset:16384
v_mfma_f32_16x16x32_bf16 v[132:135], v[100:103], v[80:83], v[132:135]
ds_read_b64_tr_b16 v[50:51], v5 offset:18432
v_mfma_f32_16x16x32_bf16 v[136:139], v[104:107], v[80:83], v[136:139]
ds_read_b64_tr_b16 v[52:53], v6 offset:16384
v_mfma_f32_16x16x32_bf16 v[140:143], v[108:111], v[80:83], v[140:143]
ds_read_b64_tr_b16 v[54:55], v6 offset:18432
v_mfma_f32_16x16x32_bf16 v[144:147], v[96:99], v[84:87], v[144:147]
ds_read_b128 v[36:39], v2 offset:256
ds_read_b64_tr_b16 v[56:57], v7 offset:16384
v_mfma_f32_16x16x32_bf16 v[148:151], v[100:103], v[84:87], v[148:151]
ds_read_b64_tr_b16 v[58:59], v7 offset:18432
v_mfma_f32_16x16x32_bf16 v[152:155], v[104:107], v[84:87], v[152:155]
ds_read_b64_tr_b16 v[60:61], v8 offset:16384
v_mfma_f32_16x16x32_bf16 v[156:159], v[108:111], v[84:87], v[156:159]
ds_read_b64_tr_b16 v[62:63], v8 offset:18432
v_mfma_f32_16x16x32_bf16 v[128:131], v[112:115], v[88:91], v[128:131]
ds_read_b128 v[40:43], v2 offset:8192
ds_read_b64_tr_b16 v[64:65], v5 offset:20480
v_mfma_f32_16x16x32_bf16 v[132:135], v[116:119], v[88:91], v[132:135]
ds_read_b64_tr_b16 v[66:67], v5 offset:22528
v_mfma_f32_16x16x32_bf16 v[136:139], v[120:123], v[88:91], v[136:139]
ds_read_b64_tr_b16 v[68:69], v6 offset:20480
v_mfma_f32_16x16x32_bf16 v[140:143], v[124:127], v[88:91], v[140:143]
ds_read_b64_tr_b16 v[70:71], v6 offset:22528
v_mfma_f32_16x16x32_bf16 v[144:147], v[112:115], v[92:95], v[144:147]
ds_read_b128 v[44:47], v2 offset:8448
ds_read_b64_tr_b16 v[72:73], v7 offset:20480
v_mfma_f32_16x16x32_bf16 v[148:151], v[116:119], v[92:95], v[148:151]
ds_read_b64_tr_b16 v[74:75], v7 offset:22528
v_mfma_f32_16x16x32_bf16 v[152:155], v[120:123], v[92:95], v[152:155]
ds_read_b64_tr_b16 v[76:77], v8 offset:20480
v_mfma_f32_16x16x32_bf16 v[156:159], v[124:127], v[92:95], v[156:159]
ds_read_b64_tr_b16 v[78:79], v8 offset:22528
s_waitcnt lgkmcnt(0)
s_barrier
v_mfma_f32_16x16x32_bf16 v[128:131], v[48:51], v[32:35], v[128:131]
ds_read_b128 v[80:83], v2 offset:16384
ds_read_b64_tr_b16 v[96:97], v5 offset:24576
v_mfma_f32_16x16x32_bf16 v[132:135], v[52:55], v[32:35], v[132:135]
ds_read_b64_tr_b16 v[98:99], v5 offset:26624
v_mfma_f32_16x16x32_bf16 v[136:139], v[56:59], v[32:35], v[136:139]
ds_read_b64_tr_b16 v[100:101], v6 offset:24576
v_mfma_f32_16x16x32_bf16 v[140:143], v[60:63], v[32:35], v[140:143]
ds_read_b64_tr_b16 v[102:103], v6 offset:26624
v_mfma_f32_16x16x32_bf16 v[144:147], v[48:51], v[36:39], v[144:147]
ds_read_b128 v[84:87], v2 offset:16640
ds_read_b64_tr_b16 v[104:105], v7 offset:24576
v_mfma_f32_16x16x32_bf16 v[148:151], v[52:55], v[36:39], v[148:151]
ds_read_b64_tr_b16 v[106:107], v7 offset:26624
v_mfma_f32_16x16x32_bf16 v[152:155], v[56:59], v[36:39], v[152:155]
ds_read_b64_tr_b16 v[108:109], v8 offset:24576
v_mfma_f32_16x16x32_bf16 v[156:159], v[60:63], v[36:39], v[156:159]
ds_read_b64_tr_b16 v[110:111], v8 offset:26624
v_mfma_f32_16x16x32_bf16 v[128:131], v[64:67], v[40:43], v[128:131]
ds_read_b128 v[88:91], v2 offset:24576
ds_read_b64_tr_b16 v[112:113], v5 offset:28672
v_mfma_f32_16x16x32_bf16 v[132:135], v[68:71], v[40:43], v[132:135]
ds_read_b64_tr_b16 v[114:115], v5 offset:30720
v_mfma_f32_16x16x32_bf16 v[136:139], v[72:75], v[40:43], v[136:139]
ds_read_b64_tr_b16 v[116:117], v6 offset:28672
v_mfma_f32_16x16x32_bf16 v[140:143], v[76:79], v[40:43], v[140:143]
ds_read_b64_tr_b16 v[118:119], v6 offset:30720
v_mfma_f32_16x16x32_bf16 v[144:147], v[64:67], v[44:47], v[144:147]
ds_read_b128 v[92:95], v2 offset:24832
ds_read_b64_tr_b16 v[120:121], v7 offset:28672
v_mfma_f32_16x16x32_bf16 v[148:151], v[68:71], v[44:47], v[148:151]
ds_read_b64_tr_b16 v[122:123], v7 offset:30720
v_mfma_f32_16x16x32_bf16 v[152:155], v[72:75], v[44:47], v[152:155]
ds_read_b64_tr_b16 v[124:125], v8 offset:28672
v_mfma_f32_16x16x32_bf16 v[156:159], v[76:79], v[44:47], v[156:159]
ds_read_b64_tr_b16 v[126:127], v8 offset:30720
s_waitcnt lgkmcnt(0)
s_barrier
v_mfma_f32_16x16x32_bf16 v[128:131], v[96:99], v[80:83], v[128:131]
ds_read_b128 v[32:35], v2 offset:32768
ds_read_b64_tr_b16 v[48:49], v5 offset:32768
v_mfma_f32_16x16x32_bf16 v[132:135], v[100:103], v[80:83], v[132:135]
ds_read_b64_tr_b16 v[50:51], v5 offset:34816
v_mfma_f32_16x16x32_bf16 v[136:139], v[104:107], v[80:83], v[136:139]
ds_read_b64_tr_b16 v[52:53], v6 offset:32768
v_mfma_f32_16x16x32_bf16 v[140:143], v[108:111], v[80:83], v[140:143]
ds_read_b64_tr_b16 v[54:55], v6 offset:34816
v_mfma_f32_16x16x32_bf16 v[144:147], v[96:99], v[84:87], v[144:147]
ds_read_b128 v[36:39], v2 offset:33024
ds_read_b64_tr_b16 v[56:57], v7 offset:32768
v_mfma_f32_16x16x32_bf16 v[148:151], v[100:103], v[84:87], v[148:151]
ds_read_b64_tr_b16 v[58:59], v7 offset:34816
v_mfma_f32_16x16x32_bf16 v[152:155], v[104:107], v[84:87], v[152:155]
ds_read_b64_tr_b16 v[60:61], v8 offset:32768
v_mfma_f32_16x16x32_bf16 v[156:159], v[108:111], v[84:87], v[156:159]
ds_read_b64_tr_b16 v[62:63], v8 offset:34816
v_mfma_f32_16x16x32_bf16 v[128:131], v[112:115], v[88:91], v[128:131]
ds_read_b128 v[40:43], v2 offset:40960
ds_read_b64_tr_b16 v[64:65], v5 offset:36864
v_mfma_f32_16x16x32_bf16 v[132:135], v[116:119], v[88:91], v[132:135]
ds_read_b64_tr_b16 v[66:67], v5 offset:38912
v_mfma_f32_16x16x32_bf16 v[136:139], v[120:123], v[88:91], v[136:139]
ds_read_b64_tr_b16 v[68:69], v6 offset:36864
v_mfma_f32_16x16x32_bf16 v[140:143], v[124:127], v[88:91], v[140:143]
ds_read_b64_tr_b16 v[70:71], v6 offset:38912
v_mfma_f32_16x16x32_bf16 v[144:147], v[112:115], v[92:95], v[144:147]
ds_read_b128 v[44:47], v2 offset:41216
ds_read_b64_tr_b16 v[72:73], v7 offset:36864
v_mfma_f32_16x16x32_bf16 v[148:151], v[116:119], v[92:95], v[148:151]
ds_read_b64_tr_b16 v[74:75], v7 offset:38912
v_mfma_f32_16x16x32_bf16 v[152:155], v[120:123], v[92:95], v[152:155]
ds_read_b64_tr_b16 v[76:77], v8 offset:36864
v_mfma_f32_16x16x32_bf16 v[156:159], v[124:127], v[92:95], v[156:159]
ds_read_b64_tr_b16 v[78:79], v8 offset:38912
s_waitcnt lgkmcnt(0)
s_barrier
v_mfma_f32_16x16x32_bf16 v[128:131], v[48:51], v[32:35], v[128:131]
ds_read_b128 v[80:83], v2 offset:49152
ds_read_b64_tr_b16 v[96:97], v5 offset:40960
v_mfma_f32_16x16x32_bf16 v[132:135], v[52:55], v[32:35], v[132:135]
ds_read_b64_tr_b16 v[98:99], v5 offset:43008
v_mfma_f32_16x16x32_bf16 v[136:139], v[56:59], v[32:35], v[136:139]
ds_read_b64_tr_b16 v[100:101], v6 offset:40960
v_mfma_f32_16x16x32_bf16 v[140:143], v[60:63], v[32:35], v[140:143]
ds_read_b64_tr_b16 v[102:103], v6 offset:43008
v_mfma_f32_16x16x32_bf16 v[144:147], v[48:51], v[36:39], v[144:147]
ds_read_b128 v[84:87], v2 offset:49408
ds_read_b64_tr_b16 v[104:105], v7 offset:40960
v_mfma_f32_16x16x32_bf16 v[148:151], v[52:55], v[36:39], v[148:151]
ds_read_b64_tr_b16 v[106:107], v7 offset:43008
v_mfma_f32_16x16x32_bf16 v[152:155], v[56:59], v[36:39], v[152:155]
ds_read_b64_tr_b16 v[108:109], v8 offset:40960
v_mfma_f32_16x16x32_bf16 v[156:159], v[60:63], v[36:39], v[156:159]
ds_read_b64_tr_b16 v[110:111], v8 offset:43008
v_mfma_f32_16x16x32_bf16 v[128:131], v[64:67], v[40:43], v[128:131]
ds_read_b128 v[88:91], v2 offset:57344
ds_read_b64_tr_b16 v[112:113], v5 offset:45056
v_mfma_f32_16x16x32_bf16 v[132:135], v[68:71], v[40:43], v[132:135]
ds_read_b64_tr_b16 v[114:115], v5 offset:47104
v_mfma_f32_16x16x32_bf16 v[136:139], v[72:75], v[40:43], v[136:139]
ds_read_b64_tr_b16 v[116:117], v6 offset:45056
v_mfma_f32_16x16x32_bf16 v[140:143], v[76:79], v[40:43], v[140:143]
ds_read_b64_tr_b16 v[118:119], v6 offset:47104
v_mfma_f32_16x16x32_bf16 v[144:147], v[64:67], v[44:47], v[144:147]
ds_read_b128 v[92:95], v2 offset:57600
ds_read_b64_tr_b16 v[120:121], v7 offset:45056
v_mfma_f32_16x16x32_bf16 v[148:151], v[68:71], v[44:47], v[148:151]
ds_read_b64_tr_b16 v[122:123], v7 offset:47104
v_mfma_f32_16x16x32_bf16 v[152:155], v[72:75], v[44:47], v[152:155]
ds_read_b64_tr_b16 v[124:125], v8 offset:45056
v_mfma_f32_16x16x32_bf16 v[156:159], v[76:79], v[44:47], v[156:159]
ds_read_b64_tr_b16 v[126:127], v8 offset:47104
s_waitcnt lgkmcnt(0)
s_barrier
v_mfma_f32_16x16x32_bf16 v[128:131], v[96:99], v[80:83], v[128:131]
v_mfma_f32_16x16x32_bf16 v[132:135], v[100:103], v[80:83], v[132:135]
v_mfma_f32_16x16x32_bf16 v[136:139], v[104:107], v[80:83], v[136:139]
v_mfma_f32_16x16x32_bf16 v[140:143], v[108:111], v[80:83], v[140:143]
v_mfma_f32_16x16x32_bf16 v[144:147], v[96:99], v[84:87], v[144:147]
v_mfma_f32_16x16x32_bf16 v[148:151], v[100:103], v[84:87], v[148:151]
v_mfma_f32_16x16x32_bf16 v[152:155], v[104:107], v[84:87], v[152:155]
v_mfma_f32_16x16x32_bf16 v[156:159], v[108:111], v[84:87], v[156:159]
v_mfma_f32_16x16x32_bf16 v[128:131], v[112:115], v[88:91], v[128:131]
v_mfma_f32_16x16x32_bf16 v[132:135], v[116:119], v[88:91], v[132:135]
v_mfma_f32_16x16x32_bf16 v[136:139], v[120:123], v[88:91], v[136:139]
v_mfma_f32_16x16x32_bf16 v[140:143], v[124:127], v[88:91], v[140:143]
v_mfma_f32_16x16x32_bf16 v[144:147], v[112:115], v[92:95], v[144:147]
v_mfma_f32_16x16x32_bf16 v[148:151], v[116:119], v[92:95], v[148:151]
v_mfma_f32_16x16x32_bf16 v[152:155], v[120:123], v[92:95], v[152:155]
v_mfma_f32_16x16x32_bf16 v[156:159], v[124:127], v[92:95], v[156:159]
s_nop 4
v_cvt_pk_bf16_f32 v96, v128, v129
v_cvt_pk_bf16_f32 v97, v130, v131
v_cvt_pk_bf16_f32 v98, v132, v133
v_cvt_pk_bf16_f32 v99, v134, v135
buffer_store_dwordx4 v[96:99], v2, s[20:23], 0 offen offset:0 sc1
ds_write_b128 v4, v[96:99] offset:0
v_cvt_pk_bf16_f32 v100, v136, v137
v_cvt_pk_bf16_f32 v101, v138, v139
v_cvt_pk_bf16_f32 v102, v140, v141
v_cvt_pk_bf16_f32 v103, v142, v143
buffer_store_dwordx4 v[100:103], v2, s[20:23], s50 offen offset:0 sc1
ds_write_b128 v4, v[100:103] offset:8192
v_cvt_pk_bf16_f32 v104, v144, v145
v_cvt_pk_bf16_f32 v105, v146, v147
v_cvt_pk_bf16_f32 v106, v148, v149
v_cvt_pk_bf16_f32 v107, v150, v151
buffer_store_dwordx4 v[104:107], v2, s[20:23], 0 offen offset:256 sc1
ds_write_b128 v4, v[104:107] offset:256
v_cvt_pk_bf16_f32 v108, v152, v153
v_cvt_pk_bf16_f32 v109, v154, v155
v_cvt_pk_bf16_f32 v110, v156, v157
v_cvt_pk_bf16_f32 v111, v158, v159
buffer_store_dwordx4 v[108:111], v2, s[20:23], s50 offen offset:256 sc1
ds_write_b128 v4, v[108:111] offset:8448
v_pk_mul_f32 v[118:119], v[128:129], v[128:129]
v_pk_mul_f32 v[122:123], v[144:145], v[144:145]
v_pk_fma_f32 v[118:119], v[130:131], v[130:131], v[118:119]
v_pk_add_f32 v[116:117], v[130:131], v[128:129]
v_pk_fma_f32 v[122:123], v[146:147], v[146:147], v[122:123]
v_pk_add_f32 v[120:121], v[146:147], v[144:145]
v_pk_fma_f32 v[118:119], v[132:133], v[132:133], v[118:119]
v_pk_add_f32 v[116:117], v[132:133], v[116:117]
v_pk_fma_f32 v[122:123], v[148:149], v[148:149], v[122:123]
v_pk_add_f32 v[120:121], v[148:149], v[120:121]
v_pk_fma_f32 v[118:119], v[134:135], v[134:135], v[118:119]
v_pk_add_f32 v[116:117], v[134:135], v[116:117]
v_pk_fma_f32 v[122:123], v[150:151], v[150:151], v[122:123]
v_pk_add_f32 v[120:121], v[150:151], v[120:121]
v_pk_fma_f32 v[118:119], v[136:137], v[136:137], v[118:119]
v_pk_add_f32 v[116:117], v[136:137], v[116:117]
v_pk_fma_f32 v[122:123], v[152:153], v[152:153], v[122:123]
v_pk_add_f32 v[120:121], v[152:153], v[120:121]
v_pk_fma_f32 v[118:119], v[138:139], v[138:139], v[118:119]
v_pk_add_f32 v[116:117], v[138:139], v[116:117]
v_pk_fma_f32 v[122:123], v[154:155], v[154:155], v[122:123]
v_pk_add_f32 v[120:121], v[154:155], v[120:121]
v_pk_fma_f32 v[118:119], v[140:141], v[140:141], v[118:119]
v_pk_add_f32 v[116:117], v[140:141], v[116:117]
v_pk_fma_f32 v[122:123], v[156:157], v[156:157], v[122:123]
v_pk_add_f32 v[120:121], v[156:157], v[120:121]
v_pk_fma_f32 v[118:119], v[142:143], v[142:143], v[118:119]
v_pk_add_f32 v[116:117], v[142:143], v[116:117]
v_pk_fma_f32 v[122:123], v[158:159], v[158:159], v[122:123]
v_pk_add_f32 v[120:121], v[158:159], v[120:121]
v_add_f32 v112, v116, v117
v_add_f32 v113, v118, v119
v_add_f32 v114, v120, v121
v_add_f32 v115, v122, v123
s_nop 1
v_permlane32_swap_b32 v112, v114
v_permlane32_swap_b32 v113, v115
v_add_f32 v112, v112, v114
v_add_f32 v113, v113, v115
s_nop 1
v_permlane16_swap_b32 v112, v113
v_add_f32 v112, v112, v113
buffer_store_dword v112, v22, s[24:27], 0 offen sc1
s_waitcnt lgkmcnt(0)
s_barrier
s_lshl_b32 s53, s47, 2
v_lshlrev_b32 v19, 11, v18
v_lshl_add_u32 v19, v17, 4, v19
s_lshl_b32 s43, s46, 10
v_add_u32 v2, s43, v19
v_add_u32 v3, 49152, v2
v_add_u32 v4, 98304, v2
v_lshrrev_b32 v19, 2, v17
v_lshl_add_u32 v20, v18, 2, v19
v_and_b32 v21, 7, v20
v_lshlrev_b32 v20, 8, v20
v_and_b32 v19, 3, v1
v_lshl_add_u32 v20, v19, 3, v20
s_add_u32 s43, s53, 0
v_xor_b32 v19, s43, v21
v_lshl_add_u32 v5, v19, 5, v20
s_add_u32 s43, s53, 1
v_xor_b32 v19, s43, v21
v_lshl_add_u32 v6, v19, 5, v20
s_add_u32 s43, s53, 2
v_xor_b32 v19, s43, v21
v_lshl_add_u32 v7, v19, 5, v20
s_add_u32 s43, s53, 3
v_xor_b32 v19, s43, v21
v_lshl_add_u32 v8, v19, 5, v20
v_add_u32 v9, 49152, v5
v_add_u32 v10, 49152, v6
v_add_u32 v11, 49152, v7
v_add_u32 v12, 49152, v8
v_add_u32 v13, 98304, v5
v_add_u32 v14, 98304, v6
v_add_u32 v15, 98304, v7
v_add_u32 v16, 98304, v8
ds_read_b128 v[32:35], v4 offset:0
ds_read_b64_tr_b16 v[48:49], v13 offset:16384
ds_read_b64_tr_b16 v[50:51], v13 offset:20480
ds_read_b128 v[36:39], v4 offset:256
ds_read_b128 v[40:43], v4 offset:512
ds_read_b128 v[44:47], v4 offset:768
ds_read_b64_tr_b16 v[64:65], v13 offset:32768
ds_read_b64_tr_b16 v[66:67], v13 offset:36864
ds_read_b64_tr_b16 v[52:53], v14 offset:16384
ds_read_b64_tr_b16 v[54:55], v14 offset:20480
ds_read_b64_tr_b16 v[68:69], v14 offset:32768
ds_read_b64_tr_b16 v[70:71], v14 offset:36864
ds_read_b64_tr_b16 v[56:57], v15 offset:16384
ds_read_b64_tr_b16 v[58:59], v15 offset:20480
ds_read_b64_tr_b16 v[72:73], v15 offset:32768
ds_read_b64_tr_b16 v[74:75], v15 offset:36864
ds_read_b64_tr_b16 v[60:61], v16 offset:16384
ds_read_b64_tr_b16 v[62:63], v16 offset:20480
ds_read_b64_tr_b16 v[76:77], v16 offset:32768
ds_read_b64_tr_b16 v[78:79], v16 offset:36864
s_waitcnt lgkmcnt(0)
v_mfma_f32_16x16x32_bf16 v[128:131], v[48:51], v[32:35], 0
ds_read_b128 v[80:83], v4 offset:8192
v_mfma_f32_16x16x32_bf16 v[132:135], v[48:51], v[36:39], 0
ds_read_b64_tr_b16 v[96:97], v13 offset:24576
v_mfma_f32_16x16x32_bf16 v[136:139], v[48:51], v[40:43], 0
ds_read_b64_tr_b16 v[98:99], v13 offset:28672
v_mfma_f32_16x16x32_bf16 v[140:143], v[48:51], v[44:47], 0
ds_read_b128 v[84:87], v4 offset:8448
v_mfma_f32_16x16x32_bf16 v[204:207], v[64:67], v[44:47], 0
ds_read_b128 v[88:91], v4 offset:8704
v_mfma_f32_16x16x32_bf16 v[200:203], v[64:67], v[40:43], 0
ds_read_b128 v[92:95], v4 offset:8960
v_mfma_f32_16x16x32_bf16 v[196:199], v[64:67], v[36:39], 0
ds_read_b64_tr_b16 v[112:113], v13 offset:40960
v_mfma_f32_16x16x32_bf16 v[192:195], v[64:67], v[32:35], 0
ds_read_b64_tr_b16 v[114:115], v13 offset:45056
v_mfma_f32_16x16x32_bf16 v[144:147], v[52:55], v[32:35], 0
ds_read_b64_tr_b16 v[100:101], v14 offset:24576
v_mfma_f32_16x16x32_bf16 v[148:151], v[52:55], v[36:39], 0
ds_read_b64_tr_b16 v[102:103], v14 offset:28672
v_mfma_f32_16x16x32_bf16 v[152:155], v[52:55], v[40:43], 0
ds_read_b64_tr_b16 v[116:117], v14 offset:40960
v_mfma_f32_16x16x32_bf16 v[156:159], v[52:55], v[44:47], 0
ds_read_b64_tr_b16 v[118:119], v14 offset:45056
v_mfma_f32_16x16x32_bf16 v[220:223], v[68:71], v[44:47], 0
ds_read_b64_tr_b16 v[104:105], v15 offset:24576
v_mfma_f32_16x16x32_bf16 v[216:219], v[68:71], v[40:43], 0
ds_read_b64_tr_b16 v[106:107], v15 offset:28672
v_mfma_f32_16x16x32_bf16 v[212:215], v[68:71], v[36:39], 0
ds_read_b64_tr_b16 v[120:121], v15 offset:40960
v_mfma_f32_16x16x32_bf16 v[208:211], v[68:71], v[32:35], 0
ds_read_b64_tr_b16 v[122:123], v15 offset:45056
v_mfma_f32_16x16x32_bf16 v[160:163], v[56:59], v[32:35], 0
ds_read_b64_tr_b16 v[108:109], v16 offset:24576
v_mfma_f32_16x16x32_bf16 v[164:167], v[56:59], v[36:39], 0
ds_read_b64_tr_b16 v[110:111], v16 offset:28672
v_mfma_f32_16x16x32_bf16 v[168:171], v[56:59], v[40:43], 0
ds_read_b64_tr_b16 v[124:125], v16 offset:40960
v_mfma_f32_16x16x32_bf16 v[172:175], v[56:59], v[44:47], 0
ds_read_b64_tr_b16 v[126:127], v16 offset:45056
v_mfma_f32_16x16x32_bf16 v[236:239], v[72:75], v[44:47], 0
v_mfma_f32_16x16x32_bf16 v[232:235], v[72:75], v[40:43], 0
v_mfma_f32_16x16x32_bf16 v[228:231], v[72:75], v[36:39], 0
v_mfma_f32_16x16x32_bf16 v[224:227], v[72:75], v[32:35], 0
v_mfma_f32_16x16x32_bf16 v[176:179], v[60:63], v[32:35], 0
v_mfma_f32_16x16x32_bf16 v[180:183], v[60:63], v[36:39], 0
v_mfma_f32_16x16x32_bf16 v[184:187], v[60:63], v[40:43], 0
v_mfma_f32_16x16x32_bf16 v[188:191], v[60:63], v[44:47], 0
v_mfma_f32_16x16x32_bf16 v[252:255], v[76:79], v[44:47], 0
v_mfma_f32_16x16x32_bf16 v[248:251], v[76:79], v[40:43], 0
v_mfma_f32_16x16x32_bf16 v[244:247], v[76:79], v[36:39], 0
v_mfma_f32_16x16x32_bf16 v[240:243], v[76:79], v[32:35], 0
s_waitcnt lgkmcnt(0)
v_mfma_f32_16x16x32_bf16 v[128:131], v[96:99], v[80:83], v[128:131]
v_mfma_f32_16x16x32_bf16 v[132:135], v[96:99], v[84:87], v[132:135]
v_mfma_f32_16x16x32_bf16 v[136:139], v[96:99], v[88:91], v[136:139]
v_mfma_f32_16x16x32_bf16 v[140:143], v[96:99], v[92:95], v[140:143]
v_mfma_f32_16x16x32_bf16 v[204:207], v[112:115], v[92:95], v[204:207]
v_mfma_f32_16x16x32_bf16 v[200:203], v[112:115], v[88:91], v[200:203]
v_mfma_f32_16x16x32_bf16 v[196:199], v[112:115], v[84:87], v[196:199]
v_mfma_f32_16x16x32_bf16 v[192:195], v[112:115], v[80:83], v[192:195]
v_mfma_f32_16x16x32_bf16 v[144:147], v[100:103], v[80:83], v[144:147]
v_mfma_f32_16x16x32_bf16 v[148:151], v[100:103], v[84:87], v[148:151]
v_mfma_f32_16x16x32_bf16 v[152:155], v[100:103], v[88:91], v[152:155]
v_mfma_f32_16x16x32_bf16 v[156:159], v[100:103], v[92:95], v[156:159]
v_mfma_f32_16x16x32_bf16 v[220:223], v[116:119], v[92:95], v[220:223]
v_mfma_f32_16x16x32_bf16 v[216:219], v[116:119], v[88:91], v[216:219]
v_mfma_f32_16x16x32_bf16 v[212:215], v[116:119], v[84:87], v[212:215]
v_mfma_f32_16x16x32_bf16 v[208:211], v[116:119], v[80:83], v[208:211]
v_mfma_f32_16x16x32_bf16 v[160:163], v[104:107], v[80:83], v[160:163]
v_mfma_f32_16x16x32_bf16 v[164:167], v[104:107], v[84:87], v[164:167]
v_mfma_f32_16x16x32_bf16 v[168:171], v[104:107], v[88:91], v[168:171]
v_mfma_f32_16x16x32_bf16 v[172:175], v[104:107], v[92:95], v[172:175]
v_mfma_f32_16x16x32_bf16 v[236:239], v[120:123], v[92:95], v[236:239]
v_mfma_f32_16x16x32_bf16 v[232:235], v[120:123], v[88:91], v[232:235]
v_mfma_f32_16x16x32_bf16 v[228:231], v[120:123], v[84:87], v[228:231]
v_mfma_f32_16x16x32_bf16 v[224:227], v[120:123], v[80:83], v[224:227]
v_mfma_f32_16x16x32_bf16 v[176:179], v[108:111], v[80:83], v[176:179]
v_mfma_f32_16x16x32_bf16 v[180:183], v[108:111], v[84:87], v[180:183]
v_mfma_f32_16x16x32_bf16 v[184:187], v[108:111], v[88:91], v[184:187]
v_mfma_f32_16x16x32_bf16 v[188:191], v[108:111], v[92:95], v[188:191]
v_mfma_f32_16x16x32_bf16 v[252:255], v[124:127], v[92:95], v[252:255]
v_mfma_f32_16x16x32_bf16 v[248:251], v[124:127], v[88:91], v[248:251]
v_mfma_f32_16x16x32_bf16 v[244:247], v[124:127], v[84:87], v[244:247]
v_mfma_f32_16x16x32_bf16 v[240:243], v[124:127], v[80:83], v[240:243]
s_mul_i32 s43, s49, 192
s_and_b32 s43, s43, 0xffffff80
s_add_u32 s43, s43, 4096
s_cmp_eq_u32 s51, 1
s_cselect_b32 s8, s4, s6
s_cselect_b32 s9, s5, s7
s_sub_u32 s10, 7340032, s43
s_lshl_b32 s44, s34, 18
s_add_u32 s44, s44, 4194304
s_movk_i32 s38, 28672
s_cmp_eq_u32 s51, 0
s_cselect_b32 s8, s32, s8
s_cselect_b32 s9, s33, s9
s_cselect_b32 s10, 262144, s10
s_cselect_b32 s43, s44, s43
s_cselect_b32 s38, 1024, s38
s_cselect_b32 s45, 0, -1
s_add_u32 s8, s8, s43
s_addc_u32 s9, s9, 0
s_mov_b32 s11, 0x20000
s_lshl_b32 s40, s38, 4
s_mov_b32 s42, 1
s_lshl_b32 s39, s51, 14
v_lshrrev_b32 v19, 4, v1
v_lshlrev_b32 v20, 5, v19
v_mul_u32_u24 v19, 6912, v19
v_and_b32 v19, s45, v19
v_and_b32 v20, s45, v20
v_lshlrev_b32 v21, 4, v1
v_xor_b32 v21, v21, v20
v_add_u32 v22, v21, v19
s_and_b32 s45, s45, 128
v_xor_b32 v23, s45, v22
s_mul_i32 s43, s34, 917504
s_mul_i32 s44, s35, 16384
s_add_u32 s43, s43, s44
s_add_u32 s43, s43, 8388608
s_add_u32 s24, s32, s43
s_addc_u32 s25, s33, 0
s_mov_b32 s26, 278528
s_mov_b32 s27, 0x20000
s_mov_b32 s53, 262144
s_lshl_b32 s43, s47, 13
s_lshl_b32 s44, s46, 10
s_add_u32 s43, s43, s44
v_lshlrev_b32 v19, 11, v18
v_lshl_add_u32 v19, v17, 4, v19
v_add_u32 v27, s43, v19
s_lshl_b32 s43, s34, 18
s_lshl_b32 s44, s35, 7
s_add_u32 s43, s43, s44
s_add_u32 s16, s62, s43
s_addc_u32 s17, s63, 0
s_mov_b32 s18, 260224
s_mov_b32 s19, 0x20000
s_lshl_b32 s43, s46, 6
v_lshl_add_u32 v19, v17, 1, s43
v_lshlrev_b32 v19, 11, v19
v_and_b32 v20, 1, v18
v_lshl_add_u32 v19, v20, 5, v19
v_lshrrev_b32 v20, 1, v18
v_lshl_add_u32 v19, v20, 4, v19
s_lshl_b32 s43, s47, 6
v_add_u32 v28, s43, v19
s_lshl_b32 s43, s34, 4
s_add_u32 s43, s43, s35
s_xor_b32 s43, s43, 0
s_lshl_b32 s43, s43, 15
s_add_u32 s43, s43, 33554432
s_add_u32 s64, s32, s43
s_addc_u32 s65, s33, 0
s_mov_b32 s66, 32768
s_mov_b32 s67, 0x20000
s_lshl_b32 s43, s34, 4
s_add_u32 s43, s43, s35
s_xor_b32 s43, s43, 1
s_lshl_b32 s43, s43, 15
s_add_u32 s43, s43, 33554432
s_add_u32 s68, s32, s43
s_addc_u32 s69, s33, 0
s_mov_b32 s70, 32768
s_mov_b32 s71, 0x20000
s_lshl_b32 s43, s34, 18
s_add_u32 s12, s32, s43
s_addc_u32 s13, s33, 0
s_add_u32 s12, s12, 4194304
s_addc_u32 s13, s13, 0
s_mov_b32 s14, 262144
s_mov_b32 s15, 0x20000
v_lshlrev_b32 v21, 4, v1
s_lshl_b32 s54, s36, 11
s_xor_b32 s43, s35, 1
s_and_b32 s43, s43, 15
s_lshl_b32 s43, s43, 14
s_add_u32 s30, s43, s54
s_xor_b32 s43, s35, 2
s_and_b32 s43, s43, 15
s_lshl_b32 s43, s43, 14
s_add_u32 s31, s43, s54
s_waitcnt vmcnt(0)
s_barrier
s_setprio 1
ds_read_b128 v[32:35], v2 offset:0
ds_read_b64_tr_b16 v[48:49], v5 offset:16384
ds_read_b64_tr_b16 v[50:51], v5 offset:20480
ds_read_b128 v[36:39], v2 offset:256
ds_read_b128 v[40:43], v2 offset:512
ds_read_b128 v[44:47], v2 offset:768
ds_read_b64_tr_b16 v[64:65], v5 offset:32768
ds_read_b64_tr_b16 v[66:67], v5 offset:36864
ds_read_b64_tr_b16 v[52:53], v6 offset:16384
ds_read_b64_tr_b16 v[54:55], v6 offset:20480
ds_read_b64_tr_b16 v[68:69], v6 offset:32768
ds_read_b64_tr_b16 v[70:71], v6 offset:36864
ds_read_b64_tr_b16 v[56:57], v7 offset:16384
ds_read_b64_tr_b16 v[58:59], v7 offset:20480
ds_read_b64_tr_b16 v[72:73], v7 offset:32768
ds_read_b64_tr_b16 v[74:75], v7 offset:36864
ds_read_b64_tr_b16 v[60:61], v8 offset:16384
ds_read_b64_tr_b16 v[62:63], v8 offset:20480
ds_read_b64_tr_b16 v[76:77], v8 offset:32768
ds_read_b64_tr_b16 v[78:79], v8 offset:36864
s_waitcnt lgkmcnt(14)
v_max3_u32 v19, v32, v33, v34
v_max3_u32 v19, v19, v35, v36
v_max3_u32 v19, v19, v37, v38
v_max3_u32 v19, v19, v39, v40
v_max3_u32 v19, v19, v41, v42
v_max3_u32 v19, v19, v43, v44
v_max3_u32 v19, v19, v45, v46
v_max_u32 v19, v19, v47
v_cmp_eq_u32 vcc, -1, v19
s_nop 4
s_cbranch_vccnz Lfx_83
Lok_81:
s_waitcnt lgkmcnt(0)
v_mfma_f32_16x16x32_bf16 v[128:131], v[48:51], v[32:35], v[128:131]
ds_read_b128 v[80:83], v2 offset:8192
v_mfma_f32_16x16x32_bf16 v[132:135], v[48:51], v[36:39], v[132:135]
ds_read_b64_tr_b16 v[96:97], v5 offset:24576
v_mfma_f32_16x16x32_bf16 v[136:139], v[48:51], v[40:43], v[136:139]
ds_read_b64_tr_b16 v[98:99], v5 offset:28672
v_mfma_f32_16x16x32_bf16 v[140:143], v[48:51], v[44:47], v[140:143]
ds_read_b128 v[84:87], v2 offset:8448
v_mfma_f32_16x16x32_bf16 v[204:207], v[64:67], v[44:47], v[204:207]
ds_read_b128 v[88:91], v2 offset:8704
v_mfma_f32_16x16x32_bf16 v[200:203], v[64:67], v[40:43], v[200:203]
ds_read_b128 v[92:95], v2 offset:8960
v_mfma_f32_16x16x32_bf16 v[196:199], v[64:67], v[36:39], v[196:199]
ds_read_b64_tr_b16 v[112:113], v5 offset:40960
v_mfma_f32_16x16x32_bf16 v[192:195], v[64:67], v[32:35], v[192:195]
ds_read_b64_tr_b16 v[114:115], v5 offset:45056
v_mfma_f32_16x16x32_bf16 v[144:147], v[52:55], v[32:35], v[144:147]
ds_read_b64_tr_b16 v[100:101], v6 offset:24576
v_mfma_f32_16x16x32_bf16 v[148:151], v[52:55], v[36:39], v[148:151]
ds_read_b64_tr_b16 v[102:103], v6 offset:28672
v_mfma_f32_16x16x32_bf16 v[152:155], v[52:55], v[40:43], v[152:155]
ds_read_b64_tr_b16 v[116:117], v6 offset:40960
v_mfma_f32_16x16x32_bf16 v[156:159], v[52:55], v[44:47], v[156:159]
ds_read_b64_tr_b16 v[118:119], v6 offset:45056
v_mfma_f32_16x16x32_bf16 v[220:223], v[68:71], v[44:47], v[220:223]
ds_read_b64_tr_b16 v[104:105], v7 offset:24576
v_mfma_f32_16x16x32_bf16 v[216:219], v[68:71], v[40:43], v[216:219]
ds_read_b64_tr_b16 v[106:107], v7 offset:28672
v_mfma_f32_16x16x32_bf16 v[212:215], v[68:71], v[36:39], v[212:215]
ds_read_b64_tr_b16 v[120:121], v7 offset:40960
v_mfma_f32_16x16x32_bf16 v[208:211], v[68:71], v[32:35], v[208:211]
ds_read_b64_tr_b16 v[122:123], v7 offset:45056
v_mfma_f32_16x16x32_bf16 v[160:163], v[56:59], v[32:35], v[160:163]
ds_read_b64_tr_b16 v[108:109], v8 offset:24576
v_mfma_f32_16x16x32_bf16 v[164:167], v[56:59], v[36:39], v[164:167]
ds_read_b64_tr_b16 v[110:111], v8 offset:28672
v_mfma_f32_16x16x32_bf16 v[168:171], v[56:59], v[40:43], v[168:171]
ds_read_b64_tr_b16 v[124:125], v8 offset:40960
v_mfma_f32_16x16x32_bf16 v[172:175], v[56:59], v[44:47], v[172:175]
ds_read_b64_tr_b16 v[126:127], v8 offset:45056
s_waitcnt lgkmcnt(14)
v_mfma_f32_16x16x32_bf16 v[236:239], v[72:75], v[44:47], v[236:239]
v_max3_u32 v19, v80, v81, v82
v_mfma_f32_16x16x32_bf16 v[232:235], v[72:75], v[40:43], v[232:235]
v_max3_u32 v19, v19, v83, v84
v_mfma_f32_16x16x32_bf16 v[228:231], v[72:75], v[36:39], v[228:231]
v_max3_u32 v19, v19, v85, v86
v_mfma_f32_16x16x32_bf16 v[224:227], v[72:75], v[32:35], v[224:227]
v_max3_u32 v19, v19, v87, v88
v_mfma_f32_16x16x32_bf16 v[176:179], v[60:63], v[32:35], v[176:179]
v_max3_u32 v19, v19, v89, v90
v_mfma_f32_16x16x32_bf16 v[180:183], v[60:63], v[36:39], v[180:183]
v_max3_u32 v19, v19, v91, v92
v_mfma_f32_16x16x32_bf16 v[184:187], v[60:63], v[40:43], v[184:187]
v_max3_u32 v19, v19, v93, v94
v_mfma_f32_16x16x32_bf16 v[188:191], v[60:63], v[44:47], v[188:191]
v_max_u32 v19, v19, v95
v_mfma_f32_16x16x32_bf16 v[252:255], v[76:79], v[44:47], v[252:255]
v_cmp_eq_u32 vcc, -1, v19
v_mfma_f32_16x16x32_bf16 v[248:251], v[76:79], v[40:43], v[248:251]
v_mfma_f32_16x16x32_bf16 v[244:247], v[76:79], v[36:39], v[244:247]
v_mfma_f32_16x16x32_bf16 v[240:243], v[76:79], v[32:35], v[240:243]
s_nop 1
s_cbranch_vccnz Lfx_86
Lok_84:
s_waitcnt lgkmcnt(0)
s_barrier
v_mfma_f32_16x16x32_bf16 v[128:131], v[96:99], v[80:83], v[128:131]
ds_read_b128 v[32:35], v3 offset:0
v_mfma_f32_16x16x32_bf16 v[132:135], v[96:99], v[84:87], v[132:135]
ds_read_b64_tr_b16 v[48:49], v9 offset:16384
v_mfma_f32_16x16x32_bf16 v[136:139], v[96:99], v[88:91], v[136:139]
ds_read_b64_tr_b16 v[50:51], v9 offset:20480
v_mfma_f32_16x16x32_bf16 v[140:143], v[96:99], v[92:95], v[140:143]
ds_read_b128 v[36:39], v3 offset:256
v_mfma_f32_16x16x32_bf16 v[204:207], v[112:115], v[92:95], v[204:207]
ds_read_b128 v[40:43], v3 offset:512
v_mfma_f32_16x16x32_bf16 v[200:203], v[112:115], v[88:91], v[200:203]
ds_read_b128 v[44:47], v3 offset:768
v_mfma_f32_16x16x32_bf16 v[196:199], v[112:115], v[84:87], v[196:199]
ds_read_b64_tr_b16 v[64:65], v9 offset:32768
v_mfma_f32_16x16x32_bf16 v[192:195], v[112:115], v[80:83], v[192:195]
ds_read_b64_tr_b16 v[66:67], v9 offset:36864
v_mfma_f32_16x16x32_bf16 v[144:147], v[100:103], v[80:83], v[144:147]
ds_read_b64_tr_b16 v[52:53], v10 offset:16384
v_mfma_f32_16x16x32_bf16 v[148:151], v[100:103], v[84:87], v[148:151]
ds_read_b64_tr_b16 v[54:55], v10 offset:20480
v_mfma_f32_16x16x32_bf16 v[152:155], v[100:103], v[88:91], v[152:155]
ds_read_b64_tr_b16 v[68:69], v10 offset:32768
v_mfma_f32_16x16x32_bf16 v[156:159], v[100:103], v[92:95], v[156:159]
ds_read_b64_tr_b16 v[70:71], v10 offset:36864
v_mfma_f32_16x16x32_bf16 v[220:223], v[116:119], v[92:95], v[220:223]
ds_read_b64_tr_b16 v[56:57], v11 offset:16384
v_mfma_f32_16x16x32_bf16 v[216:219], v[116:119], v[88:91], v[216:219]
ds_read_b64_tr_b16 v[58:59], v11 offset:20480
v_mfma_f32_16x16x32_bf16 v[212:215], v[116:119], v[84:87], v[212:215]
ds_read_b64_tr_b16 v[72:73], v11 offset:32768
v_mfma_f32_16x16x32_bf16 v[208:211], v[116:119], v[80:83], v[208:211]
ds_read_b64_tr_b16 v[74:75], v11 offset:36864
v_mfma_f32_16x16x32_bf16 v[160:163], v[104:107], v[80:83], v[160:163]
ds_read_b64_tr_b16 v[60:61], v12 offset:16384
v_mfma_f32_16x16x32_bf16 v[164:167], v[104:107], v[84:87], v[164:167]
ds_read_b64_tr_b16 v[62:63], v12 offset:20480
v_mfma_f32_16x16x32_bf16 v[168:171], v[104:107], v[88:91], v[168:171]
ds_read_b64_tr_b16 v[76:77], v12 offset:32768
v_mfma_f32_16x16x32_bf16 v[172:175], v[104:107], v[92:95], v[172:175]
ds_read_b64_tr_b16 v[78:79], v12 offset:36864
s_waitcnt lgkmcnt(14)
v_mfma_f32_16x16x32_bf16 v[236:239], v[120:123], v[92:95], v[236:239]
v_max3_u32 v19, v32, v33, v34
v_mfma_f32_16x16x32_bf16 v[232:235], v[120:123], v[88:91], v[232:235]
v_max3_u32 v19, v19, v35, v36
v_mfma_f32_16x16x32_bf16 v[228:231], v[120:123], v[84:87], v[228:231]
v_max3_u32 v19, v19, v37, v38
v_mfma_f32_16x16x32_bf16 v[224:227], v[120:123], v[80:83], v[224:227]
v_max3_u32 v19, v19, v39, v40
v_mfma_f32_16x16x32_bf16 v[176:179], v[108:111], v[80:83], v[176:179]
v_max3_u32 v19, v19, v41, v42
v_mfma_f32_16x16x32_bf16 v[180:183], v[108:111], v[84:87], v[180:183]
v_max3_u32 v19, v19, v43, v44
v_mfma_f32_16x16x32_bf16 v[184:187], v[108:111], v[88:91], v[184:187]
v_max3_u32 v19, v19, v45, v46
v_mfma_f32_16x16x32_bf16 v[188:191], v[108:111], v[92:95], v[188:191]
v_max_u32 v19, v19, v47
v_mfma_f32_16x16x32_bf16 v[252:255], v[124:127], v[92:95], v[252:255]
v_cmp_eq_u32 vcc, -1, v19
v_mfma_f32_16x16x32_bf16 v[248:251], v[124:127], v[88:91], v[248:251]
v_mfma_f32_16x16x32_bf16 v[244:247], v[124:127], v[84:87], v[244:247]
v_mfma_f32_16x16x32_bf16 v[240:243], v[124:127], v[80:83], v[240:243]
s_nop 1
s_cbranch_vccnz Lfx_89
Lok_87:
s_waitcnt lgkmcnt(0)
v_mfma_f32_16x16x32_bf16 v[128:131], v[48:51], v[32:35], v[128:131]
ds_read_b128 v[80:83], v3 offset:8192
v_mfma_f32_16x16x32_bf16 v[132:135], v[48:51], v[36:39], v[132:135]
ds_read_b64_tr_b16 v[96:97], v9 offset:24576
v_mfma_f32_16x16x32_bf16 v[136:139], v[48:51], v[40:43], v[136:139]
ds_read_b64_tr_b16 v[98:99], v9 offset:28672
v_mfma_f32_16x16x32_bf16 v[140:143], v[48:51], v[44:47], v[140:143]
ds_read_b128 v[84:87], v3 offset:8448
v_mfma_f32_16x16x32_bf16 v[204:207], v[64:67], v[44:47], v[204:207]
ds_read_b128 v[88:91], v3 offset:8704
v_mfma_f32_16x16x32_bf16 v[200:203], v[64:67], v[40:43], v[200:203]
ds_read_b128 v[92:95], v3 offset:8960
v_mfma_f32_16x16x32_bf16 v[196:199], v[64:67], v[36:39], v[196:199]
ds_read_b64_tr_b16 v[112:113], v9 offset:40960
v_mfma_f32_16x16x32_bf16 v[192:195], v[64:67], v[32:35], v[192:195]
ds_read_b64_tr_b16 v[114:115], v9 offset:45056
v_mfma_f32_16x16x32_bf16 v[144:147], v[52:55], v[32:35], v[144:147]
ds_read_b64_tr_b16 v[100:101], v10 offset:24576
v_mfma_f32_16x16x32_bf16 v[148:151], v[52:55], v[36:39], v[148:151]
ds_read_b64_tr_b16 v[102:103], v10 offset:28672
v_mfma_f32_16x16x32_bf16 v[152:155], v[52:55], v[40:43], v[152:155]
ds_read_b64_tr_b16 v[116:117], v10 offset:40960
v_mfma_f32_16x16x32_bf16 v[156:159], v[52:55], v[44:47], v[156:159]
ds_read_b64_tr_b16 v[118:119], v10 offset:45056
v_mfma_f32_16x16x32_bf16 v[220:223], v[68:71], v[44:47], v[220:223]
ds_read_b64_tr_b16 v[104:105], v11 offset:24576
v_mfma_f32_16x16x32_bf16 v[216:219], v[68:71], v[40:43], v[216:219]
ds_read_b64_tr_b16 v[106:107], v11 offset:28672
v_mfma_f32_16x16x32_bf16 v[212:215], v[68:71], v[36:39], v[212:215]
ds_read_b64_tr_b16 v[120:121], v11 offset:40960
v_mfma_f32_16x16x32_bf16 v[208:211], v[68:71], v[32:35], v[208:211]
ds_read_b64_tr_b16 v[122:123], v11 offset:45056
v_mfma_f32_16x16x32_bf16 v[160:163], v[56:59], v[32:35], v[160:163]
ds_read_b64_tr_b16 v[108:109], v12 offset:24576
v_mfma_f32_16x16x32_bf16 v[164:167], v[56:59], v[36:39], v[164:167]
ds_read_b64_tr_b16 v[110:111], v12 offset:28672
v_mfma_f32_16x16x32_bf16 v[168:171], v[56:59], v[40:43], v[168:171]
ds_read_b64_tr_b16 v[124:125], v12 offset:40960
v_mfma_f32_16x16x32_bf16 v[172:175], v[56:59], v[44:47], v[172:175]
ds_read_b64_tr_b16 v[126:127], v12 offset:45056
s_waitcnt lgkmcnt(14)
v_mfma_f32_16x16x32_bf16 v[236:239], v[72:75], v[44:47], v[236:239]
v_max3_u32 v19, v80, v81, v82
v_mfma_f32_16x16x32_bf16 v[232:235], v[72:75], v[40:43], v[232:235]
v_max3_u32 v19, v19, v83, v84
v_mfma_f32_16x16x32_bf16 v[228:231], v[72:75], v[36:39], v[228:231]
v_max3_u32 v19, v19, v85, v86
v_mfma_f32_16x16x32_bf16 v[224:227], v[72:75], v[32:35], v[224:227]
v_max3_u32 v19, v19, v87, v88
v_mfma_f32_16x16x32_bf16 v[176:179], v[60:63], v[32:35], v[176:179]
v_max3_u32 v19, v19, v89, v90
v_mfma_f32_16x16x32_bf16 v[180:183], v[60:63], v[36:39], v[180:183]
v_max3_u32 v19, v19, v91, v92
v_mfma_f32_16x16x32_bf16 v[184:187], v[60:63], v[40:43], v[184:187]
v_max3_u32 v19, v19, v93, v94
v_mfma_f32_16x16x32_bf16 v[188:191], v[60:63], v[44:47], v[188:191]
v_max_u32 v19, v19, v95
v_mfma_f32_16x16x32_bf16 v[252:255], v[76:79], v[44:47], v[252:255]
v_cmp_eq_u32 vcc, -1, v19
v_mfma_f32_16x16x32_bf16 v[248:251], v[76:79], v[40:43], v[248:251]
v_mfma_f32_16x16x32_bf16 v[244:247], v[76:79], v[36:39], v[244:247]
v_mfma_f32_16x16x32_bf16 v[240:243], v[76:79], v[32:35], v[240:243]
s_nop 1
s_cbranch_vccnz Lfx_92
Lok_90:
s_waitcnt lgkmcnt(0)
s_barrier
v_mfma_f32_16x16x32_bf16 v[128:131], v[96:99], v[80:83], v[128:131]
ds_read_b128 v[32:35], v4 offset:0
v_mfma_f32_16x16x32_bf16 v[132:135], v[96:99], v[84:87], v[132:135]
ds_read_b64_tr_b16 v[48:49], v13 offset:16384
v_mfma_f32_16x16x32_bf16 v[136:139], v[96:99], v[88:91], v[136:139]
ds_read_b64_tr_b16 v[50:51], v13 offset:20480
v_mfma_f32_16x16x32_bf16 v[140:143], v[96:99], v[92:95], v[140:143]
ds_read_b128 v[36:39], v4 offset:256
v_mfma_f32_16x16x32_bf16 v[204:207], v[112:115], v[92:95], v[204:207]
ds_read_b128 v[40:43], v4 offset:512
v_mfma_f32_16x16x32_bf16 v[200:203], v[112:115], v[88:91], v[200:203]
ds_read_b128 v[44:47], v4 offset:768
v_mfma_f32_16x16x32_bf16 v[196:199], v[112:115], v[84:87], v[196:199]
ds_read_b64_tr_b16 v[64:65], v13 offset:32768
v_mfma_f32_16x16x32_bf16 v[192:195], v[112:115], v[80:83], v[192:195]
ds_read_b64_tr_b16 v[66:67], v13 offset:36864
v_mfma_f32_16x16x32_bf16 v[144:147], v[100:103], v[80:83], v[144:147]
ds_read_b64_tr_b16 v[52:53], v14 offset:16384
v_mfma_f32_16x16x32_bf16 v[148:151], v[100:103], v[84:87], v[148:151]
ds_read_b64_tr_b16 v[54:55], v14 offset:20480
v_mfma_f32_16x16x32_bf16 v[152:155], v[100:103], v[88:91], v[152:155]
ds_read_b64_tr_b16 v[68:69], v14 offset:32768
v_mfma_f32_16x16x32_bf16 v[156:159], v[100:103], v[92:95], v[156:159]
ds_read_b64_tr_b16 v[70:71], v14 offset:36864
v_mfma_f32_16x16x32_bf16 v[220:223], v[116:119], v[92:95], v[220:223]
ds_read_b64_tr_b16 v[56:57], v15 offset:16384
v_mfma_f32_16x16x32_bf16 v[216:219], v[116:119], v[88:91], v[216:219]
ds_read_b64_tr_b16 v[58:59], v15 offset:20480
v_mfma_f32_16x16x32_bf16 v[212:215], v[116:119], v[84:87], v[212:215]
ds_read_b64_tr_b16 v[72:73], v15 offset:32768
v_mfma_f32_16x16x32_bf16 v[208:211], v[116:119], v[80:83], v[208:211]
ds_read_b64_tr_b16 v[74:75], v15 offset:36864
v_mfma_f32_16x16x32_bf16 v[160:163], v[104:107], v[80:83], v[160:163]
ds_read_b64_tr_b16 v[60:61], v16 offset:16384
v_mfma_f32_16x16x32_bf16 v[164:167], v[104:107], v[84:87], v[164:167]
ds_read_b64_tr_b16 v[62:63], v16 offset:20480
v_mfma_f32_16x16x32_bf16 v[168:171], v[104:107], v[88:91], v[168:171]
ds_read_b64_tr_b16 v[76:77], v16 offset:32768
v_mfma_f32_16x16x32_bf16 v[172:175], v[104:107], v[92:95], v[172:175]
ds_read_b64_tr_b16 v[78:79], v16 offset:36864
s_waitcnt lgkmcnt(14)
v_mfma_f32_16x16x32_bf16 v[236:239], v[120:123], v[92:95], v[236:239]
v_max3_u32 v19, v32, v33, v34
v_mfma_f32_16x16x32_bf16 v[232:235], v[120:123], v[88:91], v[232:235]
v_max3_u32 v19, v19, v35, v36
v_mfma_f32_16x16x32_bf16 v[228:231], v[120:123], v[84:87], v[228:231]
v_max3_u32 v19, v19, v37, v38
v_mfma_f32_16x16x32_bf16 v[224:227], v[120:123], v[80:83], v[224:227]
v_max3_u32 v19, v19, v39, v40
v_mfma_f32_16x16x32_bf16 v[176:179], v[108:111], v[80:83], v[176:179]
v_max3_u32 v19, v19, v41, v42
v_mfma_f32_16x16x32_bf16 v[180:183], v[108:111], v[84:87], v[180:183]
v_max3_u32 v19, v19, v43, v44
v_mfma_f32_16x16x32_bf16 v[184:187], v[108:111], v[88:91], v[184:187]
v_max3_u32 v19, v19, v45, v46
v_mfma_f32_16x16x32_bf16 v[188:191], v[108:111], v[92:95], v[188:191]
v_max_u32 v19, v19, v47
v_mfma_f32_16x16x32_bf16 v[252:255], v[124:127], v[92:95], v[252:255]
v_cmp_eq_u32 vcc, -1, v19
v_mfma_f32_16x16x32_bf16 v[248:251], v[124:127], v[88:91], v[248:251]
v_mfma_f32_16x16x32_bf16 v[244:247], v[124:127], v[84:87], v[244:247]
v_mfma_f32_16x16x32_bf16 v[240:243], v[124:127], v[80:83], v[240:243]
s_nop 1
s_cbranch_vccnz Lfx_95
Lok_93:
s_waitcnt lgkmcnt(0)
v_mfma_f32_16x16x32_bf16 v[128:131], v[48:51], v[32:35], v[128:131]
ds_read_b128 v[80:83], v4 offset:8192
v_mfma_f32_16x16x32_bf16 v[132:135], v[48:51], v[36:39], v[132:135]
ds_read_b64_tr_b16 v[96:97], v13 offset:24576
v_mfma_f32_16x16x32_bf16 v[136:139], v[48:51], v[40:43], v[136:139]
ds_read_b64_tr_b16 v[98:99], v13 offset:28672
v_mfma_f32_16x16x32_bf16 v[140:143], v[48:51], v[44:47], v[140:143]
ds_read_b128 v[84:87], v4 offset:8448
v_mfma_f32_16x16x32_bf16 v[204:207], v[64:67], v[44:47], v[204:207]
ds_read_b128 v[88:91], v4 offset:8704
v_mfma_f32_16x16x32_bf16 v[200:203], v[64:67], v[40:43], v[200:203]
ds_read_b128 v[92:95], v4 offset:8960
v_mfma_f32_16x16x32_bf16 v[196:199], v[64:67], v[36:39], v[196:199]
ds_read_b64_tr_b16 v[112:113], v13 offset:40960
v_mfma_f32_16x16x32_bf16 v[192:195], v[64:67], v[32:35], v[192:195]
ds_read_b64_tr_b16 v[114:115], v13 offset:45056
v_mfma_f32_16x16x32_bf16 v[144:147], v[52:55], v[32:35], v[144:147]
ds_read_b64_tr_b16 v[100:101], v14 offset:24576
v_mfma_f32_16x16x32_bf16 v[148:151], v[52:55], v[36:39], v[148:151]
ds_read_b64_tr_b16 v[102:103], v14 offset:28672
v_mfma_f32_16x16x32_bf16 v[152:155], v[52:55], v[40:43], v[152:155]
ds_read_b64_tr_b16 v[116:117], v14 offset:40960
v_mfma_f32_16x16x32_bf16 v[156:159], v[52:55], v[44:47], v[156:159]
ds_read_b64_tr_b16 v[118:119], v14 offset:45056
v_mfma_f32_16x16x32_bf16 v[220:223], v[68:71], v[44:47], v[220:223]
ds_read_b64_tr_b16 v[104:105], v15 offset:24576
v_mfma_f32_16x16x32_bf16 v[216:219], v[68:71], v[40:43], v[216:219]
ds_read_b64_tr_b16 v[106:107], v15 offset:28672
v_mfma_f32_16x16x32_bf16 v[212:215], v[68:71], v[36:39], v[212:215]
ds_read_b64_tr_b16 v[120:121], v15 offset:40960
v_mfma_f32_16x16x32_bf16 v[208:211], v[68:71], v[32:35], v[208:211]
ds_read_b64_tr_b16 v[122:123], v15 offset:45056
v_mfma_f32_16x16x32_bf16 v[160:163], v[56:59], v[32:35], v[160:163]
ds_read_b64_tr_b16 v[108:109], v16 offset:24576
v_mfma_f32_16x16x32_bf16 v[164:167], v[56:59], v[36:39], v[164:167]
ds_read_b64_tr_b16 v[110:111], v16 offset:28672
v_mfma_f32_16x16x32_bf16 v[168:171], v[56:59], v[40:43], v[168:171]
ds_read_b64_tr_b16 v[124:125], v16 offset:40960
v_mfma_f32_16x16x32_bf16 v[172:175], v[56:59], v[44:47], v[172:175]
ds_read_b64_tr_b16 v[126:127], v16 offset:45056
s_waitcnt lgkmcnt(14)
v_mfma_f32_16x16x32_bf16 v[236:239], v[72:75], v[44:47], v[236:239]
v_max3_u32 v19, v80, v81, v82
v_mfma_f32_16x16x32_bf16 v[232:235], v[72:75], v[40:43], v[232:235]
v_max3_u32 v19, v19, v83, v84
v_mfma_f32_16x16x32_bf16 v[228:231], v[72:75], v[36:39], v[228:231]
v_max3_u32 v19, v19, v85, v86
v_mfma_f32_16x16x32_bf16 v[224:227], v[72:75], v[32:35], v[224:227]
v_max3_u32 v19, v19, v87, v88
v_mfma_f32_16x16x32_bf16 v[176:179], v[60:63], v[32:35], v[176:179]
v_max3_u32 v19, v19, v89, v90
v_mfma_f32_16x16x32_bf16 v[180:183], v[60:63], v[36:39], v[180:183]
v_max3_u32 v19, v19, v91, v92
v_mfma_f32_16x16x32_bf16 v[184:187], v[60:63], v[40:43], v[184:187]
v_max3_u32 v19, v19, v93, v94
v_mfma_f32_16x16x32_bf16 v[188:191], v[60:63], v[44:47], v[188:191]
v_max_u32 v19, v19, v95
v_mfma_f32_16x16x32_bf16 v[252:255], v[76:79], v[44:47], v[252:255]
v_cmp_eq_u32 vcc, -1, v19
v_mfma_f32_16x16x32_bf16 v[248:251], v[76:79], v[40:43], v[248:251]
v_mfma_f32_16x16x32_bf16 v[244:247], v[76:79], v[36:39], v[244:247]
v_mfma_f32_16x16x32_bf16 v[240:243], v[76:79], v[32:35], v[240:243]
s_nop 1
s_cbranch_vccnz Lfx_98
Lok_96:
s_waitcnt lgkmcnt(0)
s_barrier
v_mfma_f32_16x16x32_bf16 v[128:131], v[96:99], v[80:83], v[128:131]
ds_read_b128 v[32:35], v2 offset:0
v_mfma_f32_16x16x32_bf16 v[132:135], v[96:99], v[84:87], v[132:135]
ds_read_b64_tr_b16 v[48:49], v5 offset:16384
v_mfma_f32_16x16x32_bf16 v[136:139], v[96:99], v[88:91], v[136:139]
ds_read_b64_tr_b16 v[50:51], v5 offset:20480
v_mfma_f32_16x16x32_bf16 v[140:143], v[96:99], v[92:95], v[140:143]
ds_read_b128 v[36:39], v2 offset:256
v_mfma_f32_16x16x32_bf16 v[204:207], v[112:115], v[92:95], v[204:207]
ds_read_b128 v[40:43], v2 offset:512
v_mfma_f32_16x16x32_bf16 v[200:203], v[112:115], v[88:91], v[200:203]
ds_read_b128 v[44:47], v2 offset:768
v_mfma_f32_16x16x32_bf16 v[196:199], v[112:115], v[84:87], v[196:199]
ds_read_b64_tr_b16 v[64:65], v5 offset:32768
v_mfma_f32_16x16x32_bf16 v[192:195], v[112:115], v[80:83], v[192:195]
ds_read_b64_tr_b16 v[66:67], v5 offset:36864
v_mfma_f32_16x16x32_bf16 v[144:147], v[100:103], v[80:83], v[144:147]
ds_read_b64_tr_b16 v[52:53], v6 offset:16384
v_mfma_f32_16x16x32_bf16 v[148:151], v[100:103], v[84:87], v[148:151]
ds_read_b64_tr_b16 v[54:55], v6 offset:20480
v_mfma_f32_16x16x32_bf16 v[152:155], v[100:103], v[88:91], v[152:155]
ds_read_b64_tr_b16 v[68:69], v6 offset:32768
v_mfma_f32_16x16x32_bf16 v[156:159], v[100:103], v[92:95], v[156:159]
ds_read_b64_tr_b16 v[70:71], v6 offset:36864
v_mfma_f32_16x16x32_bf16 v[220:223], v[116:119], v[92:95], v[220:223]
ds_read_b64_tr_b16 v[56:57], v7 offset:16384
v_mfma_f32_16x16x32_bf16 v[216:219], v[116:119], v[88:91], v[216:219]
ds_read_b64_tr_b16 v[58:59], v7 offset:20480
v_mfma_f32_16x16x32_bf16 v[212:215], v[116:119], v[84:87], v[212:215]
ds_read_b64_tr_b16 v[72:73], v7 offset:32768
v_mfma_f32_16x16x32_bf16 v[208:211], v[116:119], v[80:83], v[208:211]
ds_read_b64_tr_b16 v[74:75], v7 offset:36864
v_mfma_f32_16x16x32_bf16 v[160:163], v[104:107], v[80:83], v[160:163]
ds_read_b64_tr_b16 v[60:61], v8 offset:16384
v_mfma_f32_16x16x32_bf16 v[164:167], v[104:107], v[84:87], v[164:167]
ds_read_b64_tr_b16 v[62:63], v8 offset:20480
v_mfma_f32_16x16x32_bf16 v[168:171], v[104:107], v[88:91], v[168:171]
ds_read_b64_tr_b16 v[76:77], v8 offset:32768
v_mfma_f32_16x16x32_bf16 v[172:175], v[104:107], v[92:95], v[172:175]
ds_read_b64_tr_b16 v[78:79], v8 offset:36864
s_waitcnt lgkmcnt(14)
v_mfma_f32_16x16x32_bf16 v[236:239], v[120:123], v[92:95], v[236:239]
v_max3_u32 v19, v32, v33, v34
v_mfma_f32_16x16x32_bf16 v[232:235], v[120:123], v[88:91], v[232:235]
v_max3_u32 v19, v19, v35, v36
v_mfma_f32_16x16x32_bf16 v[228:231], v[120:123], v[84:87], v[228:231]
v_max3_u32 v19, v19, v37, v38
v_mfma_f32_16x16x32_bf16 v[224:227], v[120:123], v[80:83], v[224:227]
v_max3_u32 v19, v19, v39, v40
v_mfma_f32_16x16x32_bf16 v[176:179], v[108:111], v[80:83], v[176:179]
v_max3_u32 v19, v19, v41, v42
v_mfma_f32_16x16x32_bf16 v[180:183], v[108:111], v[84:87], v[180:183]
v_max3_u32 v19, v19, v43, v44
v_mfma_f32_16x16x32_bf16 v[184:187], v[108:111], v[88:91], v[184:187]
v_max3_u32 v19, v19, v45, v46
v_mfma_f32_16x16x32_bf16 v[188:191], v[108:111], v[92:95], v[188:191]
v_max_u32 v19, v19, v47
v_mfma_f32_16x16x32_bf16 v[252:255], v[124:127], v[92:95], v[252:255]
v_cmp_eq_u32 vcc, -1, v19
v_mfma_f32_16x16x32_bf16 v[248:251], v[124:127], v[88:91], v[248:251]
v_mfma_f32_16x16x32_bf16 v[244:247], v[124:127], v[84:87], v[244:247]
v_mfma_f32_16x16x32_bf16 v[240:243], v[124:127], v[80:83], v[240:243]
s_nop 1
s_cbranch_vccnz Lfx_101
Lok_99:
s_waitcnt lgkmcnt(0)
v_mfma_f32_16x16x32_bf16 v[128:131], v[48:51], v[32:35], v[128:131]
ds_read_b128 v[80:83], v2 offset:8192
v_mfma_f32_16x16x32_bf16 v[132:135], v[48:51], v[36:39], v[132:135]
ds_read_b64_tr_b16 v[96:97], v5 offset:24576
v_mfma_f32_16x16x32_bf16 v[136:139], v[48:51], v[40:43], v[136:139]
ds_read_b64_tr_b16 v[98:99], v5 offset:28672
v_mfma_f32_16x16x32_bf16 v[140:143], v[48:51], v[44:47], v[140:143]
ds_read_b128 v[84:87], v2 offset:8448
v_mfma_f32_16x16x32_bf16 v[204:207], v[64:67], v[44:47], v[204:207]
ds_read_b128 v[88:91], v2 offset:8704
v_mfma_f32_16x16x32_bf16 v[200:203], v[64:67], v[40:43], v[200:203]
ds_read_b128 v[92:95], v2 offset:8960
v_mfma_f32_16x16x32_bf16 v[196:199], v[64:67], v[36:39], v[196:199]
ds_read_b64_tr_b16 v[112:113], v5 offset:40960
v_mfma_f32_16x16x32_bf16 v[192:195], v[64:67], v[32:35], v[192:195]
ds_read_b64_tr_b16 v[114:115], v5 offset:45056
v_mfma_f32_16x16x32_bf16 v[144:147], v[52:55], v[32:35], v[144:147]
ds_read_b64_tr_b16 v[100:101], v6 offset:24576
v_mfma_f32_16x16x32_bf16 v[148:151], v[52:55], v[36:39], v[148:151]
ds_read_b64_tr_b16 v[102:103], v6 offset:28672
v_mfma_f32_16x16x32_bf16 v[152:155], v[52:55], v[40:43], v[152:155]
ds_read_b64_tr_b16 v[116:117], v6 offset:40960
v_mfma_f32_16x16x32_bf16 v[156:159], v[52:55], v[44:47], v[156:159]
ds_read_b64_tr_b16 v[118:119], v6 offset:45056
v_mfma_f32_16x16x32_bf16 v[220:223], v[68:71], v[44:47], v[220:223]
ds_read_b64_tr_b16 v[104:105], v7 offset:24576
v_mfma_f32_16x16x32_bf16 v[216:219], v[68:71], v[40:43], v[216:219]
ds_read_b64_tr_b16 v[106:107], v7 offset:28672
v_mfma_f32_16x16x32_bf16 v[212:215], v[68:71], v[36:39], v[212:215]
ds_read_b64_tr_b16 v[120:121], v7 offset:40960
v_mfma_f32_16x16x32_bf16 v[208:211], v[68:71], v[32:35], v[208:211]
ds_read_b64_tr_b16 v[122:123], v7 offset:45056
v_mfma_f32_16x16x32_bf16 v[160:163], v[56:59], v[32:35], v[160:163]
ds_read_b64_tr_b16 v[108:109], v8 offset:24576
v_mfma_f32_16x16x32_bf16 v[164:167], v[56:59], v[36:39], v[164:167]
ds_read_b64_tr_b16 v[110:111], v8 offset:28672
v_mfma_f32_16x16x32_bf16 v[168:171], v[56:59], v[40:43], v[168:171]
ds_read_b64_tr_b16 v[124:125], v8 offset:40960
v_mfma_f32_16x16x32_bf16 v[172:175], v[56:59], v[44:47], v[172:175]
ds_read_b64_tr_b16 v[126:127], v8 offset:45056
s_waitcnt lgkmcnt(14)
v_mfma_f32_16x16x32_bf16 v[236:239], v[72:75], v[44:47], v[236:239]
v_max3_u32 v19, v80, v81, v82
v_mfma_f32_16x16x32_bf16 v[232:235], v[72:75], v[40:43], v[232:235]
v_max3_u32 v19, v19, v83, v84
v_mfma_f32_16x16x32_bf16 v[228:231], v[72:75], v[36:39], v[228:231]
v_max3_u32 v19, v19, v85, v86
v_mfma_f32_16x16x32_bf16 v[224:227], v[72:75], v[32:35], v[224:227]
v_max3_u32 v19, v19, v87, v88
v_mfma_f32_16x16x32_bf16 v[176:179], v[60:63], v[32:35], v[176:179]
v_max3_u32 v19, v19, v89, v90
v_mfma_f32_16x16x32_bf16 v[180:183], v[60:63], v[36:39], v[180:183]
v_max3_u32 v19, v19, v91, v92
v_mfma_f32_16x16x32_bf16 v[184:187], v[60:63], v[40:43], v[184:187]
v_max3_u32 v19, v19, v93, v94
v_mfma_f32_16x16x32_bf16 v[188:191], v[60:63], v[44:47], v[188:191]
v_max_u32 v19, v19, v95
v_mfma_f32_16x16x32_bf16 v[252:255], v[76:79], v[44:47], v[252:255]
v_cmp_eq_u32 vcc, -1, v19
v_mfma_f32_16x16x32_bf16 v[248:251], v[76:79], v[40:43], v[248:251]
v_mfma_f32_16x16x32_bf16 v[244:247], v[76:79], v[36:39], v[244:247]
v_mfma_f32_16x16x32_bf16 v[240:243], v[76:79], v[32:35], v[240:243]
s_nop 1
s_cbranch_vccnz Lfx_104
Lok_102:
s_waitcnt lgkmcnt(0)
s_barrier
v_mfma_f32_16x16x32_bf16 v[128:131], v[96:99], v[80:83], v[128:131]
ds_read_b128 v[32:35], v3 offset:0
v_mfma_f32_16x16x32_bf16 v[132:135], v[96:99], v[84:87], v[132:135]
ds_read_b64_tr_b16 v[48:49], v9 offset:16384
v_mfma_f32_16x16x32_bf16 v[136:139], v[96:99], v[88:91], v[136:139]
ds_read_b64_tr_b16 v[50:51], v9 offset:20480
v_mfma_f32_16x16x32_bf16 v[140:143], v[96:99], v[92:95], v[140:143]
ds_read_b128 v[36:39], v3 offset:256
v_mfma_f32_16x16x32_bf16 v[204:207], v[112:115], v[92:95], v[204:207]
ds_read_b128 v[40:43], v3 offset:512
v_mfma_f32_16x16x32_bf16 v[200:203], v[112:115], v[88:91], v[200:203]
ds_read_b128 v[44:47], v3 offset:768
v_mfma_f32_16x16x32_bf16 v[196:199], v[112:115], v[84:87], v[196:199]
ds_read_b64_tr_b16 v[64:65], v9 offset:32768
v_mfma_f32_16x16x32_bf16 v[192:195], v[112:115], v[80:83], v[192:195]
ds_read_b64_tr_b16 v[66:67], v9 offset:36864
v_mfma_f32_16x16x32_bf16 v[144:147], v[100:103], v[80:83], v[144:147]
ds_read_b64_tr_b16 v[52:53], v10 offset:16384
v_mfma_f32_16x16x32_bf16 v[148:151], v[100:103], v[84:87], v[148:151]
ds_read_b64_tr_b16 v[54:55], v10 offset:20480
v_mfma_f32_16x16x32_bf16 v[152:155], v[100:103], v[88:91], v[152:155]
ds_read_b64_tr_b16 v[68:69], v10 offset:32768
v_mfma_f32_16x16x32_bf16 v[156:159], v[100:103], v[92:95], v[156:159]
ds_read_b64_tr_b16 v[70:71], v10 offset:36864
v_mfma_f32_16x16x32_bf16 v[220:223], v[116:119], v[92:95], v[220:223]
ds_read_b64_tr_b16 v[56:57], v11 offset:16384
v_mfma_f32_16x16x32_bf16 v[216:219], v[116:119], v[88:91], v[216:219]
ds_read_b64_tr_b16 v[58:59], v11 offset:20480
v_mfma_f32_16x16x32_bf16 v[212:215], v[116:119], v[84:87], v[212:215]
ds_read_b64_tr_b16 v[72:73], v11 offset:32768
v_mfma_f32_16x16x32_bf16 v[208:211], v[116:119], v[80:83], v[208:211]
ds_read_b64_tr_b16 v[74:75], v11 offset:36864
v_mfma_f32_16x16x32_bf16 v[160:163], v[104:107], v[80:83], v[160:163]
ds_read_b64_tr_b16 v[60:61], v12 offset:16384
v_mfma_f32_16x16x32_bf16 v[164:167], v[104:107], v[84:87], v[164:167]
ds_read_b64_tr_b16 v[62:63], v12 offset:20480
v_mfma_f32_16x16x32_bf16 v[168:171], v[104:107], v[88:91], v[168:171]
ds_read_b64_tr_b16 v[76:77], v12 offset:32768
v_mfma_f32_16x16x32_bf16 v[172:175], v[104:107], v[92:95], v[172:175]
ds_read_b64_tr_b16 v[78:79], v12 offset:36864
s_waitcnt lgkmcnt(14)
v_mfma_f32_16x16x32_bf16 v[236:239], v[120:123], v[92:95], v[236:239]
v_max3_u32 v19, v32, v33, v34
v_mfma_f32_16x16x32_bf16 v[232:235], v[120:123], v[88:91], v[232:235]
v_max3_u32 v19, v19, v35, v36
v_mfma_f32_16x16x32_bf16 v[228:231], v[120:123], v[84:87], v[228:231]
v_max3_u32 v19, v19, v37, v38
v_mfma_f32_16x16x32_bf16 v[224:227], v[120:123], v[80:83], v[224:227]
v_max3_u32 v19, v19, v39, v40
v_mfma_f32_16x16x32_bf16 v[176:179], v[108:111], v[80:83], v[176:179]
v_max3_u32 v19, v19, v41, v42
v_mfma_f32_16x16x32_bf16 v[180:183], v[108:111], v[84:87], v[180:183]
v_max3_u32 v19, v19, v43, v44
v_mfma_f32_16x16x32_bf16 v[184:187], v[108:111], v[88:91], v[184:187]
v_max3_u32 v19, v19, v45, v46
v_mfma_f32_16x16x32_bf16 v[188:191], v[108:111], v[92:95], v[188:191]
v_max_u32 v19, v19, v47
v_mfma_f32_16x16x32_bf16 v[252:255], v[124:127], v[92:95], v[252:255]
v_cmp_eq_u32 vcc, -1, v19
v_mfma_f32_16x16x32_bf16 v[248:251], v[124:127], v[88:91], v[248:251]
v_mfma_f32_16x16x32_bf16 v[244:247], v[124:127], v[84:87], v[244:247]
v_mfma_f32_16x16x32_bf16 v[240:243], v[124:127], v[80:83], v[240:243]
s_nop 1
s_cbranch_vccnz Lfx_107
Lok_105:
s_waitcnt lgkmcnt(0)
v_mfma_f32_16x16x32_bf16 v[128:131], v[48:51], v[32:35], v[128:131]
ds_read_b128 v[80:83], v3 offset:8192
v_mfma_f32_16x16x32_bf16 v[132:135], v[48:51], v[36:39], v[132:135]
ds_read_b64_tr_b16 v[96:97], v9 offset:24576
v_mfma_f32_16x16x32_bf16 v[136:139], v[48:51], v[40:43], v[136:139]
ds_read_b64_tr_b16 v[98:99], v9 offset:28672
v_mfma_f32_16x16x32_bf16 v[140:143], v[48:51], v[44:47], v[140:143]
ds_read_b128 v[84:87], v3 offset:8448
v_mfma_f32_16x16x32_bf16 v[204:207], v[64:67], v[44:47], v[204:207]
ds_read_b128 v[88:91], v3 offset:8704
v_mfma_f32_16x16x32_bf16 v[200:203], v[64:67], v[40:43], v[200:203]
ds_read_b128 v[92:95], v3 offset:8960
v_mfma_f32_16x16x32_bf16 v[196:199], v[64:67], v[36:39], v[196:199]
ds_read_b64_tr_b16 v[112:113], v9 offset:40960
v_mfma_f32_16x16x32_bf16 v[192:195], v[64:67], v[32:35], v[192:195]
ds_read_b64_tr_b16 v[114:115], v9 offset:45056
v_mfma_f32_16x16x32_bf16 v[144:147], v[52:55], v[32:35], v[144:147]
ds_read_b64_tr_b16 v[100:101], v10 offset:24576
v_mfma_f32_16x16x32_bf16 v[148:151], v[52:55], v[36:39], v[148:151]
ds_read_b64_tr_b16 v[102:103], v10 offset:28672
v_mfma_f32_16x16x32_bf16 v[152:155], v[52:55], v[40:43], v[152:155]
ds_read_b64_tr_b16 v[116:117], v10 offset:40960
v_mfma_f32_16x16x32_bf16 v[156:159], v[52:55], v[44:47], v[156:159]
ds_read_b64_tr_b16 v[118:119], v10 offset:45056
v_mfma_f32_16x16x32_bf16 v[220:223], v[68:71], v[44:47], v[220:223]
ds_read_b64_tr_b16 v[104:105], v11 offset:24576
v_mfma_f32_16x16x32_bf16 v[216:219], v[68:71], v[40:43], v[216:219]
ds_read_b64_tr_b16 v[106:107], v11 offset:28672
v_mfma_f32_16x16x32_bf16 v[212:215], v[68:71], v[36:39], v[212:215]
ds_read_b64_tr_b16 v[120:121], v11 offset:40960
v_mfma_f32_16x16x32_bf16 v[208:211], v[68:71], v[32:35], v[208:211]
ds_read_b64_tr_b16 v[122:123], v11 offset:45056
v_mfma_f32_16x16x32_bf16 v[160:163], v[56:59], v[32:35], v[160:163]
ds_read_b64_tr_b16 v[108:109], v12 offset:24576
v_mfma_f32_16x16x32_bf16 v[164:167], v[56:59], v[36:39], v[164:167]
ds_read_b64_tr_b16 v[110:111], v12 offset:28672
v_mfma_f32_16x16x32_bf16 v[168:171], v[56:59], v[40:43], v[168:171]
ds_read_b64_tr_b16 v[124:125], v12 offset:40960
v_mfma_f32_16x16x32_bf16 v[172:175], v[56:59], v[44:47], v[172:175]
ds_read_b64_tr_b16 v[126:127], v12 offset:45056
s_waitcnt lgkmcnt(14)
v_mfma_f32_16x16x32_bf16 v[236:239], v[72:75], v[44:47], v[236:239]
v_max3_u32 v19, v80, v81, v82
v_mfma_f32_16x16x32_bf16 v[232:235], v[72:75], v[40:43], v[232:235]
v_max3_u32 v19, v19, v83, v84
v_mfma_f32_16x16x32_bf16 v[228:231], v[72:75], v[36:39], v[228:231]
v_max3_u32 v19, v19, v85, v86
v_mfma_f32_16x16x32_bf16 v[224:227], v[72:75], v[32:35], v[224:227]
v_max3_u32 v19, v19, v87, v88
v_mfma_f32_16x16x32_bf16 v[176:179], v[60:63], v[32:35], v[176:179]
v_max3_u32 v19, v19, v89, v90
v_mfma_f32_16x16x32_bf16 v[180:183], v[60:63], v[36:39], v[180:183]
v_max3_u32 v19, v19, v91, v92
v_mfma_f32_16x16x32_bf16 v[184:187], v[60:63], v[40:43], v[184:187]
v_max3_u32 v19, v19, v93, v94
v_mfma_f32_16x16x32_bf16 v[188:191], v[60:63], v[44:47], v[188:191]
v_max_u32 v19, v19, v95
v_mfma_f32_16x16x32_bf16 v[252:255], v[76:79], v[44:47], v[252:255]
v_cmp_eq_u32 vcc, -1, v19
v_mfma_f32_16x16x32_bf16 v[248:251], v[76:79], v[40:43], v[248:251]
v_mfma_f32_16x16x32_bf16 v[244:247], v[76:79], v[36:39], v[244:247]
v_mfma_f32_16x16x32_bf16 v[240:243], v[76:79], v[32:35], v[240:243]
s_nop 1
s_cbranch_vccnz Lfx_110
Lok_108:
s_waitcnt lgkmcnt(0)
s_barrier
v_mfma_f32_16x16x32_bf16 v[128:131], v[96:99], v[80:83], v[128:131]
ds_read_b128 v[32:35], v4 offset:0
v_mfma_f32_16x16x32_bf16 v[132:135], v[96:99], v[84:87], v[132:135]
ds_read_b64_tr_b16 v[48:49], v13 offset:16384
v_mfma_f32_16x16x32_bf16 v[136:139], v[96:99], v[88:91], v[136:139]
ds_read_b64_tr_b16 v[50:51], v13 offset:20480
v_mfma_f32_16x16x32_bf16 v[140:143], v[96:99], v[92:95], v[140:143]
ds_read_b128 v[36:39], v4 offset:256
v_mfma_f32_16x16x32_bf16 v[204:207], v[112:115], v[92:95], v[204:207]
ds_read_b128 v[40:43], v4 offset:512
v_mfma_f32_16x16x32_bf16 v[200:203], v[112:115], v[88:91], v[200:203]
ds_read_b128 v[44:47], v4 offset:768
v_mfma_f32_16x16x32_bf16 v[196:199], v[112:115], v[84:87], v[196:199]
ds_read_b64_tr_b16 v[64:65], v13 offset:32768
v_mfma_f32_16x16x32_bf16 v[192:195], v[112:115], v[80:83], v[192:195]
ds_read_b64_tr_b16 v[66:67], v13 offset:36864
v_mfma_f32_16x16x32_bf16 v[144:147], v[100:103], v[80:83], v[144:147]
ds_read_b64_tr_b16 v[52:53], v14 offset:16384
v_mfma_f32_16x16x32_bf16 v[148:151], v[100:103], v[84:87], v[148:151]
ds_read_b64_tr_b16 v[54:55], v14 offset:20480
v_mfma_f32_16x16x32_bf16 v[152:155], v[100:103], v[88:91], v[152:155]
ds_read_b64_tr_b16 v[68:69], v14 offset:32768
v_mfma_f32_16x16x32_bf16 v[156:159], v[100:103], v[92:95], v[156:159]
ds_read_b64_tr_b16 v[70:71], v14 offset:36864
v_mfma_f32_16x16x32_bf16 v[220:223], v[116:119], v[92:95], v[220:223]
ds_read_b64_tr_b16 v[56:57], v15 offset:16384
v_mfma_f32_16x16x32_bf16 v[216:219], v[116:119], v[88:91], v[216:219]
ds_read_b64_tr_b16 v[58:59], v15 offset:20480
v_mfma_f32_16x16x32_bf16 v[212:215], v[116:119], v[84:87], v[212:215]
ds_read_b64_tr_b16 v[72:73], v15 offset:32768
v_mfma_f32_16x16x32_bf16 v[208:211], v[116:119], v[80:83], v[208:211]
ds_read_b64_tr_b16 v[74:75], v15 offset:36864
v_mfma_f32_16x16x32_bf16 v[160:163], v[104:107], v[80:83], v[160:163]
ds_read_b64_tr_b16 v[60:61], v16 offset:16384
v_mfma_f32_16x16x32_bf16 v[164:167], v[104:107], v[84:87], v[164:167]
ds_read_b64_tr_b16 v[62:63], v16 offset:20480
v_mfma_f32_16x16x32_bf16 v[168:171], v[104:107], v[88:91], v[168:171]
ds_read_b64_tr_b16 v[76:77], v16 offset:32768
v_mfma_f32_16x16x32_bf16 v[172:175], v[104:107], v[92:95], v[172:175]
ds_read_b64_tr_b16 v[78:79], v16 offset:36864
s_waitcnt lgkmcnt(14)
v_mfma_f32_16x16x32_bf16 v[236:239], v[120:123], v[92:95], v[236:239]
v_max3_u32 v19, v32, v33, v34
v_mfma_f32_16x16x32_bf16 v[232:235], v[120:123], v[88:91], v[232:235]
v_max3_u32 v19, v19, v35, v36
v_mfma_f32_16x16x32_bf16 v[228:231], v[120:123], v[84:87], v[228:231]
v_max3_u32 v19, v19, v37, v38
v_mfma_f32_16x16x32_bf16 v[224:227], v[120:123], v[80:83], v[224:227]
v_max3_u32 v19, v19, v39, v40
v_mfma_f32_16x16x32_bf16 v[176:179], v[108:111], v[80:83], v[176:179]
v_max3_u32 v19, v19, v41, v42
v_mfma_f32_16x16x32_bf16 v[180:183], v[108:111], v[84:87], v[180:183]
v_max3_u32 v19, v19, v43, v44
v_mfma_f32_16x16x32_bf16 v[184:187], v[108:111], v[88:91], v[184:187]
v_max3_u32 v19, v19, v45, v46
v_mfma_f32_16x16x32_bf16 v[188:191], v[108:111], v[92:95], v[188:191]
v_max_u32 v19, v19, v47
v_mfma_f32_16x16x32_bf16 v[252:255], v[124:127], v[92:95], v[252:255]
v_cmp_eq_u32 vcc, -1, v19
v_mfma_f32_16x16x32_bf16 v[248:251], v[124:127], v[88:91], v[248:251]
v_mfma_f32_16x16x32_bf16 v[244:247], v[124:127], v[84:87], v[244:247]
v_mfma_f32_16x16x32_bf16 v[240:243], v[124:127], v[80:83], v[240:243]
s_nop 1
s_cbranch_vccnz Lfx_113
Lok_111:
s_waitcnt lgkmcnt(0)
v_mfma_f32_16x16x32_bf16 v[128:131], v[48:51], v[32:35], v[128:131]
ds_read_b128 v[80:83], v4 offset:8192
v_mfma_f32_16x16x32_bf16 v[132:135], v[48:51], v[36:39], v[132:135]
ds_read_b64_tr_b16 v[96:97], v13 offset:24576
v_mfma_f32_16x16x32_bf16 v[136:139], v[48:51], v[40:43], v[136:139]
ds_read_b64_tr_b16 v[98:99], v13 offset:28672
v_mfma_f32_16x16x32_bf16 v[140:143], v[48:51], v[44:47], v[140:143]
ds_read_b128 v[84:87], v4 offset:8448
v_mfma_f32_16x16x32_bf16 v[204:207], v[64:67], v[44:47], v[204:207]
ds_read_b128 v[88:91], v4 offset:8704
v_mfma_f32_16x16x32_bf16 v[200:203], v[64:67], v[40:43], v[200:203]
ds_read_b128 v[92:95], v4 offset:8960
v_mfma_f32_16x16x32_bf16 v[196:199], v[64:67], v[36:39], v[196:199]
ds_read_b64_tr_b16 v[112:113], v13 offset:40960
v_mfma_f32_16x16x32_bf16 v[192:195], v[64:67], v[32:35], v[192:195]
ds_read_b64_tr_b16 v[114:115], v13 offset:45056
v_mfma_f32_16x16x32_bf16 v[144:147], v[52:55], v[32:35], v[144:147]
ds_read_b64_tr_b16 v[100:101], v14 offset:24576
v_mfma_f32_16x16x32_bf16 v[148:151], v[52:55], v[36:39], v[148:151]
ds_read_b64_tr_b16 v[102:103], v14 offset:28672
v_mfma_f32_16x16x32_bf16 v[152:155], v[52:55], v[40:43], v[152:155]
ds_read_b64_tr_b16 v[116:117], v14 offset:40960
v_mfma_f32_16x16x32_bf16 v[156:159], v[52:55], v[44:47], v[156:159]
ds_read_b64_tr_b16 v[118:119], v14 offset:45056
v_mfma_f32_16x16x32_bf16 v[220:223], v[68:71], v[44:47], v[220:223]
ds_read_b64_tr_b16 v[104:105], v15 offset:24576
v_mfma_f32_16x16x32_bf16 v[216:219], v[68:71], v[40:43], v[216:219]
ds_read_b64_tr_b16 v[106:107], v15 offset:28672
v_mfma_f32_16x16x32_bf16 v[212:215], v[68:71], v[36:39], v[212:215]
ds_read_b64_tr_b16 v[120:121], v15 offset:40960
v_mfma_f32_16x16x32_bf16 v[208:211], v[68:71], v[32:35], v[208:211]
ds_read_b64_tr_b16 v[122:123], v15 offset:45056
v_mfma_f32_16x16x32_bf16 v[160:163], v[56:59], v[32:35], v[160:163]
ds_read_b64_tr_b16 v[108:109], v16 offset:24576
v_mfma_f32_16x16x32_bf16 v[164:167], v[56:59], v[36:39], v[164:167]
ds_read_b64_tr_b16 v[110:111], v16 offset:28672
v_mfma_f32_16x16x32_bf16 v[168:171], v[56:59], v[40:43], v[168:171]
ds_read_b64_tr_b16 v[124:125], v16 offset:40960
v_mfma_f32_16x16x32_bf16 v[172:175], v[56:59], v[44:47], v[172:175]
ds_read_b64_tr_b16 v[126:127], v16 offset:45056
s_waitcnt lgkmcnt(14)
v_mfma_f32_16x16x32_bf16 v[236:239], v[72:75], v[44:47], v[236:239]
v_max3_u32 v19, v80, v81, v82
v_mfma_f32_16x16x32_bf16 v[232:235], v[72:75], v[40:43], v[232:235]
v_max3_u32 v19, v19, v83, v84
v_mfma_f32_16x16x32_bf16 v[228:231], v[72:75], v[36:39], v[228:231]
v_max3_u32 v19, v19, v85, v86
v_mfma_f32_16x16x32_bf16 v[224:227], v[72:75], v[32:35], v[224:227]
v_max3_u32 v19, v19, v87, v88
v_mfma_f32_16x16x32_bf16 v[176:179], v[60:63], v[32:35], v[176:179]
v_max3_u32 v19, v19, v89, v90
v_mfma_f32_16x16x32_bf16 v[180:183], v[60:63], v[36:39], v[180:183]
v_max3_u32 v19, v19, v91, v92
v_mfma_f32_16x16x32_bf16 v[184:187], v[60:63], v[40:43], v[184:187]
v_max3_u32 v19, v19, v93, v94
v_mfma_f32_16x16x32_bf16 v[188:191], v[60:63], v[44:47], v[188:191]
v_max_u32 v19, v19, v95
v_mfma_f32_16x16x32_bf16 v[252:255], v[76:79], v[44:47], v[252:255]
v_cmp_eq_u32 vcc, -1, v19
v_mfma_f32_16x16x32_bf16 v[248:251], v[76:79], v[40:43], v[248:251]
v_mfma_f32_16x16x32_bf16 v[244:247], v[76:79], v[36:39], v[244:247]
v_mfma_f32_16x16x32_bf16 v[240:243], v[76:79], v[32:35], v[240:243]
s_nop 1
s_cbranch_vccnz Lfx_116
Lok_114:
s_waitcnt lgkmcnt(0)
s_barrier
v_mfma_f32_16x16x32_bf16 v[128:131], v[96:99], v[80:83], v[128:131]
ds_read_b128 v[32:35], v2 offset:0
v_mfma_f32_16x16x32_bf16 v[132:135], v[96:99], v[84:87], v[132:135]
ds_read_b64_tr_b16 v[48:49], v5 offset:16384
v_mfma_f32_16x16x32_bf16 v[136:139], v[96:99], v[88:91], v[136:139]
ds_read_b64_tr_b16 v[50:51], v5 offset:20480
v_mfma_f32_16x16x32_bf16 v[140:143], v[96:99], v[92:95], v[140:143]
ds_read_b128 v[36:39], v2 offset:256
v_mfma_f32_16x16x32_bf16 v[204:207], v[112:115], v[92:95], v[204:207]
ds_read_b128 v[40:43], v2 offset:512
v_mfma_f32_16x16x32_bf16 v[200:203], v[112:115], v[88:91], v[200:203]
ds_read_b128 v[44:47], v2 offset:768
v_mfma_f32_16x16x32_bf16 v[196:199], v[112:115], v[84:87], v[196:199]
ds_read_b64_tr_b16 v[64:65], v5 offset:32768
v_mfma_f32_16x16x32_bf16 v[192:195], v[112:115], v[80:83], v[192:195]
ds_read_b64_tr_b16 v[66:67], v5 offset:36864
v_mfma_f32_16x16x32_bf16 v[144:147], v[100:103], v[80:83], v[144:147]
ds_read_b64_tr_b16 v[52:53], v6 offset:16384
v_mfma_f32_16x16x32_bf16 v[148:151], v[100:103], v[84:87], v[148:151]
ds_read_b64_tr_b16 v[54:55], v6 offset:20480
v_mfma_f32_16x16x32_bf16 v[152:155], v[100:103], v[88:91], v[152:155]
ds_read_b64_tr_b16 v[68:69], v6 offset:32768
v_mfma_f32_16x16x32_bf16 v[156:159], v[100:103], v[92:95], v[156:159]
ds_read_b64_tr_b16 v[70:71], v6 offset:36864
v_mfma_f32_16x16x32_bf16 v[220:223], v[116:119], v[92:95], v[220:223]
ds_read_b64_tr_b16 v[56:57], v7 offset:16384
v_mfma_f32_16x16x32_bf16 v[216:219], v[116:119], v[88:91], v[216:219]
ds_read_b64_tr_b16 v[58:59], v7 offset:20480
v_mfma_f32_16x16x32_bf16 v[212:215], v[116:119], v[84:87], v[212:215]
ds_read_b64_tr_b16 v[72:73], v7 offset:32768
v_mfma_f32_16x16x32_bf16 v[208:211], v[116:119], v[80:83], v[208:211]
ds_read_b64_tr_b16 v[74:75], v7 offset:36864
v_mfma_f32_16x16x32_bf16 v[160:163], v[104:107], v[80:83], v[160:163]
ds_read_b64_tr_b16 v[60:61], v8 offset:16384
v_mfma_f32_16x16x32_bf16 v[164:167], v[104:107], v[84:87], v[164:167]
ds_read_b64_tr_b16 v[62:63], v8 offset:20480
v_mfma_f32_16x16x32_bf16 v[168:171], v[104:107], v[88:91], v[168:171]
ds_read_b64_tr_b16 v[76:77], v8 offset:32768
v_mfma_f32_16x16x32_bf16 v[172:175], v[104:107], v[92:95], v[172:175]
ds_read_b64_tr_b16 v[78:79], v8 offset:36864
s_waitcnt lgkmcnt(14)
v_mfma_f32_16x16x32_bf16 v[236:239], v[120:123], v[92:95], v[236:239]
v_max3_u32 v19, v32, v33, v34
v_mfma_f32_16x16x32_bf16 v[232:235], v[120:123], v[88:91], v[232:235]
v_max3_u32 v19, v19, v35, v36
v_mfma_f32_16x16x32_bf16 v[228:231], v[120:123], v[84:87], v[228:231]
v_max3_u32 v19, v19, v37, v38
v_mfma_f32_16x16x32_bf16 v[224:227], v[120:123], v[80:83], v[224:227]
v_max3_u32 v19, v19, v39, v40
v_mfma_f32_16x16x32_bf16 v[176:179], v[108:111], v[80:83], v[176:179]
v_max3_u32 v19, v19, v41, v42
v_mfma_f32_16x16x32_bf16 v[180:183], v[108:111], v[84:87], v[180:183]
v_max3_u32 v19, v19, v43, v44
v_mfma_f32_16x16x32_bf16 v[184:187], v[108:111], v[88:91], v[184:187]
v_max3_u32 v19, v19, v45, v46
v_mfma_f32_16x16x32_bf16 v[188:191], v[108:111], v[92:95], v[188:191]
v_max_u32 v19, v19, v47
v_mfma_f32_16x16x32_bf16 v[252:255], v[124:127], v[92:95], v[252:255]
v_cmp_eq_u32 vcc, -1, v19
v_mfma_f32_16x16x32_bf16 v[248:251], v[124:127], v[88:91], v[248:251]
v_mfma_f32_16x16x32_bf16 v[244:247], v[124:127], v[84:87], v[244:247]
v_mfma_f32_16x16x32_bf16 v[240:243], v[124:127], v[80:83], v[240:243]
s_nop 1
s_cbranch_vccnz Lfx_119
Lok_117:
s_waitcnt lgkmcnt(0)
v_mfma_f32_16x16x32_bf16 v[128:131], v[48:51], v[32:35], v[128:131]
ds_read_b128 v[80:83], v2 offset:8192
v_mfma_f32_16x16x32_bf16 v[132:135], v[48:51], v[36:39], v[132:135]
ds_read_b64_tr_b16 v[96:97], v5 offset:24576
v_mfma_f32_16x16x32_bf16 v[136:139], v[48:51], v[40:43], v[136:139]
ds_read_b64_tr_b16 v[98:99], v5 offset:28672
v_mfma_f32_16x16x32_bf16 v[140:143], v[48:51], v[44:47], v[140:143]
ds_read_b128 v[84:87], v2 offset:8448
v_mfma_f32_16x16x32_bf16 v[204:207], v[64:67], v[44:47], v[204:207]
ds_read_b128 v[88:91], v2 offset:8704
v_mfma_f32_16x16x32_bf16 v[200:203], v[64:67], v[40:43], v[200:203]
ds_read_b128 v[92:95], v2 offset:8960
v_mfma_f32_16x16x32_bf16 v[196:199], v[64:67], v[36:39], v[196:199]
ds_read_b64_tr_b16 v[112:113], v5 offset:40960
v_mfma_f32_16x16x32_bf16 v[192:195], v[64:67], v[32:35], v[192:195]
ds_read_b64_tr_b16 v[114:115], v5 offset:45056
v_mfma_f32_16x16x32_bf16 v[144:147], v[52:55], v[32:35], v[144:147]
ds_read_b64_tr_b16 v[100:101], v6 offset:24576
v_mfma_f32_16x16x32_bf16 v[148:151], v[52:55], v[36:39], v[148:151]
ds_read_b64_tr_b16 v[102:103], v6 offset:28672
v_mfma_f32_16x16x32_bf16 v[152:155], v[52:55], v[40:43], v[152:155]
ds_read_b64_tr_b16 v[116:117], v6 offset:40960
v_mfma_f32_16x16x32_bf16 v[156:159], v[52:55], v[44:47], v[156:159]
ds_read_b64_tr_b16 v[118:119], v6 offset:45056
v_mfma_f32_16x16x32_bf16 v[220:223], v[68:71], v[44:47], v[220:223]
ds_read_b64_tr_b16 v[104:105], v7 offset:24576
v_mfma_f32_16x16x32_bf16 v[216:219], v[68:71], v[40:43], v[216:219]
ds_read_b64_tr_b16 v[106:107], v7 offset:28672
v_mfma_f32_16x16x32_bf16 v[212:215], v[68:71], v[36:39], v[212:215]
ds_read_b64_tr_b16 v[120:121], v7 offset:40960
v_mfma_f32_16x16x32_bf16 v[208:211], v[68:71], v[32:35], v[208:211]
ds_read_b64_tr_b16 v[122:123], v7 offset:45056
v_mfma_f32_16x16x32_bf16 v[160:163], v[56:59], v[32:35], v[160:163]
ds_read_b64_tr_b16 v[108:109], v8 offset:24576
v_mfma_f32_16x16x32_bf16 v[164:167], v[56:59], v[36:39], v[164:167]
ds_read_b64_tr_b16 v[110:111], v8 offset:28672
v_mfma_f32_16x16x32_bf16 v[168:171], v[56:59], v[40:43], v[168:171]
ds_read_b64_tr_b16 v[124:125], v8 offset:40960
v_mfma_f32_16x16x32_bf16 v[172:175], v[56:59], v[44:47], v[172:175]
ds_read_b64_tr_b16 v[126:127], v8 offset:45056
s_waitcnt lgkmcnt(14)
v_mfma_f32_16x16x32_bf16 v[236:239], v[72:75], v[44:47], v[236:239]
v_max3_u32 v19, v80, v81, v82
v_mfma_f32_16x16x32_bf16 v[232:235], v[72:75], v[40:43], v[232:235]
v_max3_u32 v19, v19, v83, v84
v_mfma_f32_16x16x32_bf16 v[228:231], v[72:75], v[36:39], v[228:231]
v_max3_u32 v19, v19, v85, v86
v_mfma_f32_16x16x32_bf16 v[224:227], v[72:75], v[32:35], v[224:227]
v_max3_u32 v19, v19, v87, v88
v_mfma_f32_16x16x32_bf16 v[176:179], v[60:63], v[32:35], v[176:179]
v_max3_u32 v19, v19, v89, v90
v_mfma_f32_16x16x32_bf16 v[180:183], v[60:63], v[36:39], v[180:183]
v_max3_u32 v19, v19, v91, v92
v_mfma_f32_16x16x32_bf16 v[184:187], v[60:63], v[40:43], v[184:187]
v_max3_u32 v19, v19, v93, v94
v_mfma_f32_16x16x32_bf16 v[188:191], v[60:63], v[44:47], v[188:191]
v_max_u32 v19, v19, v95
v_mfma_f32_16x16x32_bf16 v[252:255], v[76:79], v[44:47], v[252:255]
v_cmp_eq_u32 vcc, -1, v19
v_mfma_f32_16x16x32_bf16 v[248:251], v[76:79], v[40:43], v[248:251]
v_mfma_f32_16x16x32_bf16 v[244:247], v[76:79], v[36:39], v[244:247]
v_mfma_f32_16x16x32_bf16 v[240:243], v[76:79], v[32:35], v[240:243]
s_nop 1
s_cbranch_vccnz Lfx_122
Lok_120:
s_waitcnt lgkmcnt(0)
s_barrier
v_mfma_f32_16x16x32_bf16 v[128:131], v[96:99], v[80:83], v[128:131]
ds_read_b128 v[32:35], v3 offset:0
v_mfma_f32_16x16x32_bf16 v[132:135], v[96:99], v[84:87], v[132:135]
ds_read_b64_tr_b16 v[48:49], v9 offset:16384
v_mfma_f32_16x16x32_bf16 v[136:139], v[96:99], v[88:91], v[136:139]
ds_read_b64_tr_b16 v[50:51], v9 offset:20480
v_mfma_f32_16x16x32_bf16 v[140:143], v[96:99], v[92:95], v[140:143]
ds_read_b128 v[36:39], v3 offset:256
v_mfma_f32_16x16x32_bf16 v[204:207], v[112:115], v[92:95], v[204:207]
ds_read_b128 v[40:43], v3 offset:512
v_mfma_f32_16x16x32_bf16 v[200:203], v[112:115], v[88:91], v[200:203]
ds_read_b128 v[44:47], v3 offset:768
v_mfma_f32_16x16x32_bf16 v[196:199], v[112:115], v[84:87], v[196:199]
ds_read_b64_tr_b16 v[64:65], v9 offset:32768
v_mfma_f32_16x16x32_bf16 v[192:195], v[112:115], v[80:83], v[192:195]
ds_read_b64_tr_b16 v[66:67], v9 offset:36864
v_mfma_f32_16x16x32_bf16 v[144:147], v[100:103], v[80:83], v[144:147]
ds_read_b64_tr_b16 v[52:53], v10 offset:16384
v_mfma_f32_16x16x32_bf16 v[148:151], v[100:103], v[84:87], v[148:151]
ds_read_b64_tr_b16 v[54:55], v10 offset:20480
v_mfma_f32_16x16x32_bf16 v[152:155], v[100:103], v[88:91], v[152:155]
ds_read_b64_tr_b16 v[68:69], v10 offset:32768
v_mfma_f32_16x16x32_bf16 v[156:159], v[100:103], v[92:95], v[156:159]
ds_read_b64_tr_b16 v[70:71], v10 offset:36864
v_mfma_f32_16x16x32_bf16 v[220:223], v[116:119], v[92:95], v[220:223]
ds_read_b64_tr_b16 v[56:57], v11 offset:16384
v_mfma_f32_16x16x32_bf16 v[216:219], v[116:119], v[88:91], v[216:219]
ds_read_b64_tr_b16 v[58:59], v11 offset:20480
v_mfma_f32_16x16x32_bf16 v[212:215], v[116:119], v[84:87], v[212:215]
ds_read_b64_tr_b16 v[72:73], v11 offset:32768
v_mfma_f32_16x16x32_bf16 v[208:211], v[116:119], v[80:83], v[208:211]
ds_read_b64_tr_b16 v[74:75], v11 offset:36864
v_mfma_f32_16x16x32_bf16 v[160:163], v[104:107], v[80:83], v[160:163]
ds_read_b64_tr_b16 v[60:61], v12 offset:16384
v_mfma_f32_16x16x32_bf16 v[164:167], v[104:107], v[84:87], v[164:167]
ds_read_b64_tr_b16 v[62:63], v12 offset:20480
v_mfma_f32_16x16x32_bf16 v[168:171], v[104:107], v[88:91], v[168:171]
ds_read_b64_tr_b16 v[76:77], v12 offset:32768
v_mfma_f32_16x16x32_bf16 v[172:175], v[104:107], v[92:95], v[172:175]
ds_read_b64_tr_b16 v[78:79], v12 offset:36864
v_mfma_f32_16x16x32_bf16 v[236:239], v[120:123], v[92:95], v[236:239]
v_mfma_f32_16x16x32_bf16 v[232:235], v[120:123], v[88:91], v[232:235]
v_mfma_f32_16x16x32_bf16 v[228:231], v[120:123], v[84:87], v[228:231]
v_mfma_f32_16x16x32_bf16 v[224:227], v[120:123], v[80:83], v[224:227]
v_mfma_f32_16x16x32_bf16 v[176:179], v[108:111], v[80:83], v[176:179]
v_mfma_f32_16x16x32_bf16 v[180:183], v[108:111], v[84:87], v[180:183]
v_mfma_f32_16x16x32_bf16 v[184:187], v[108:111], v[88:91], v[184:187]
v_mfma_f32_16x16x32_bf16 v[188:191], v[108:111], v[92:95], v[188:191]
v_mfma_f32_16x16x32_bf16 v[252:255], v[124:127], v[92:95], v[252:255]
v_mfma_f32_16x16x32_bf16 v[248:251], v[124:127], v[88:91], v[248:251]
v_mfma_f32_16x16x32_bf16 v[244:247], v[124:127], v[84:87], v[244:247]
v_mfma_f32_16x16x32_bf16 v[240:243], v[124:127], v[80:83], v[240:243]
s_mov_b32 s41, 2
.p2align 3
Lk3_123:
s_waitcnt lgkmcnt(0)
v_mfma_f32_16x16x32_bf16 v[128:131], v[48:51], v[32:35], v[128:131]
ds_read_b128 v[80:83], v3 offset:8192
v_mfma_f32_16x16x32_bf16 v[132:135], v[48:51], v[36:39], v[132:135]
ds_read_b64_tr_b16 v[96:97], v9 offset:24576
v_mfma_f32_16x16x32_bf16 v[136:139], v[48:51], v[40:43], v[136:139]
ds_read_b64_tr_b16 v[98:99], v9 offset:28672
v_mfma_f32_16x16x32_bf16 v[140:143], v[48:51], v[44:47], v[140:143]
ds_read_b128 v[84:87], v3 offset:8448
v_mfma_f32_16x16x32_bf16 v[204:207], v[64:67], v[44:47], v[204:207]
ds_read_b128 v[88:91], v3 offset:8704
v_mfma_f32_16x16x32_bf16 v[200:203], v[64:67], v[40:43], v[200:203]
ds_read_b128 v[92:95], v3 offset:8960
v_mfma_f32_16x16x32_bf16 v[196:199], v[64:67], v[36:39], v[196:199]
ds_read_b64_tr_b16 v[112:113], v9 offset:40960
v_mfma_f32_16x16x32_bf16 v[192:195], v[64:67], v[32:35], v[192:195]
ds_read_b64_tr_b16 v[114:115], v9 offset:45056
v_mfma_f32_16x16x32_bf16 v[144:147], v[52:55], v[32:35], v[144:147]
ds_read_b64_tr_b16 v[100:101], v10 offset:24576
v_mfma_f32_16x16x32_bf16 v[148:151], v[52:55], v[36:39], v[148:151]
ds_read_b64_tr_b16 v[102:103], v10 offset:28672
v_mfma_f32_16x16x32_bf16 v[152:155], v[52:55], v[40:43], v[152:155]
ds_read_b64_tr_b16 v[116:117], v10 offset:40960
v_mfma_f32_16x16x32_bf16 v[156:159], v[52:55], v[44:47], v[156:159]
ds_read_b64_tr_b16 v[118:119], v10 offset:45056
v_mfma_f32_16x16x32_bf16 v[220:223], v[68:71], v[44:47], v[220:223]
ds_read_b64_tr_b16 v[104:105], v11 offset:24576
v_mfma_f32_16x16x32_bf16 v[216:219], v[68:71], v[40:43], v[216:219]
ds_read_b64_tr_b16 v[106:107], v11 offset:28672
v_mfma_f32_16x16x32_bf16 v[212:215], v[68:71], v[36:39], v[212:215]
ds_read_b64_tr_b16 v[120:121], v11 offset:40960
v_mfma_f32_16x16x32_bf16 v[208:211], v[68:71], v[32:35], v[208:211]
ds_read_b64_tr_b16 v[122:123], v11 offset:45056
v_mfma_f32_16x16x32_bf16 v[160:163], v[56:59], v[32:35], v[160:163]
ds_read_b64_tr_b16 v[108:109], v12 offset:24576
v_mfma_f32_16x16x32_bf16 v[164:167], v[56:59], v[36:39], v[164:167]
ds_read_b64_tr_b16 v[110:111], v12 offset:28672
v_mfma_f32_16x16x32_bf16 v[168:171], v[56:59], v[40:43], v[168:171]
ds_read_b64_tr_b16 v[124:125], v12 offset:40960
v_mfma_f32_16x16x32_bf16 v[172:175], v[56:59], v[44:47], v[172:175]
ds_read_b64_tr_b16 v[126:127], v12 offset:45056
v_mfma_f32_16x16x32_bf16 v[236:239], v[72:75], v[44:47], v[236:239]
v_mfma_f32_16x16x32_bf16 v[232:235], v[72:75], v[40:43], v[232:235]
v_mfma_f32_16x16x32_bf16 v[228:231], v[72:75], v[36:39], v[228:231]
v_mfma_f32_16x16x32_bf16 v[224:227], v[72:75], v[32:35], v[224:227]
v_mfma_f32_16x16x32_bf16 v[176:179], v[60:63], v[32:35], v[176:179]
v_mfma_f32_16x16x32_bf16 v[180:183], v[60:63], v[36:39], v[180:183]
v_mfma_f32_16x16x32_bf16 v[184:187], v[60:63], v[40:43], v[184:187]
v_mfma_f32_16x16x32_bf16 v[188:191], v[60:63], v[44:47], v[188:191]
v_mfma_f32_16x16x32_bf16 v[252:255], v[76:79], v[44:47], v[252:255]
v_mfma_f32_16x16x32_bf16 v[248:251], v[76:79], v[40:43], v[248:251]
v_mfma_f32_16x16x32_bf16 v[244:247], v[76:79], v[36:39], v[244:247]
v_mfma_f32_16x16x32_bf16 v[240:243], v[76:79], v[32:35], v[240:243]
s_waitcnt lgkmcnt(0)
s_barrier
v_mfma_f32_16x16x32_bf16 v[128:131], v[96:99], v[80:83], v[128:131]
ds_read_b128 v[32:35], v4 offset:0
v_mfma_f32_16x16x32_bf16 v[132:135], v[96:99], v[84:87], v[132:135]
ds_read_b64_tr_b16 v[48:49], v13 offset:16384
v_mfma_f32_16x16x32_bf16 v[136:139], v[96:99], v[88:91], v[136:139]
ds_read_b64_tr_b16 v[50:51], v13 offset:20480
v_mfma_f32_16x16x32_bf16 v[140:143], v[96:99], v[92:95], v[140:143]
ds_read_b128 v[36:39], v4 offset:256
v_mfma_f32_16x16x32_bf16 v[204:207], v[112:115], v[92:95], v[204:207]
ds_read_b128 v[40:43], v4 offset:512
v_mfma_f32_16x16x32_bf16 v[200:203], v[112:115], v[88:91], v[200:203]
ds_read_b128 v[44:47], v4 offset:768
v_mfma_f32_16x16x32_bf16 v[196:199], v[112:115], v[84:87], v[196:199]
ds_read_b64_tr_b16 v[64:65], v13 offset:32768
v_mfma_f32_16x16x32_bf16 v[192:195], v[112:115], v[80:83], v[192:195]
ds_read_b64_tr_b16 v[66:67], v13 offset:36864
v_mfma_f32_16x16x32_bf16 v[144:147], v[100:103], v[80:83], v[144:147]
ds_read_b64_tr_b16 v[52:53], v14 offset:16384
v_mfma_f32_16x16x32_bf16 v[148:151], v[100:103], v[84:87], v[148:151]
ds_read_b64_tr_b16 v[54:55], v14 offset:20480
v_mfma_f32_16x16x32_bf16 v[152:155], v[100:103], v[88:91], v[152:155]
ds_read_b64_tr_b16 v[68:69], v14 offset:32768
v_mfma_f32_16x16x32_bf16 v[156:159], v[100:103], v[92:95], v[156:159]
ds_read_b64_tr_b16 v[70:71], v14 offset:36864
v_mfma_f32_16x16x32_bf16 v[220:223], v[116:119], v[92:95], v[220:223]
ds_read_b64_tr_b16 v[56:57], v15 offset:16384
v_mfma_f32_16x16x32_bf16 v[216:219], v[116:119], v[88:91], v[216:219]
ds_read_b64_tr_b16 v[58:59], v15 offset:20480
v_mfma_f32_16x16x32_bf16 v[212:215], v[116:119], v[84:87], v[212:215]
ds_read_b64_tr_b16 v[72:73], v15 offset:32768
v_mfma_f32_16x16x32_bf16 v[208:211], v[116:119], v[80:83], v[208:211]
ds_read_b64_tr_b16 v[74:75], v15 offset:36864
v_mfma_f32_16x16x32_bf16 v[160:163], v[104:107], v[80:83], v[160:163]
ds_read_b64_tr_b16 v[60:61], v16 offset:16384
v_mfma_f32_16x16x32_bf16 v[164:167], v[104:107], v[84:87], v[164:167]
ds_read_b64_tr_b16 v[62:63], v16 offset:20480
v_mfma_f32_16x16x32_bf16 v[168:171], v[104:107], v[88:91], v[168:171]
ds_read_b64_tr_b16 v[76:77], v16 offset:32768
v_mfma_f32_16x16x32_bf16 v[172:175], v[104:107], v[92:95], v[172:175]
ds_read_b64_tr_b16 v[78:79], v16 offset:36864
v_mfma_f32_16x16x32_bf16 v[236:239], v[120:123], v[92:95], v[236:239]
v_mfma_f32_16x16x32_bf16 v[232:235], v[120:123], v[88:91], v[232:235]
v_mfma_f32_16x16x32_bf16 v[228:231], v[120:123], v[84:87], v[228:231]
v_mfma_f32_16x16x32_bf16 v[224:227], v[120:123], v[80:83], v[224:227]
v_mfma_f32_16x16x32_bf16 v[176:179], v[108:111], v[80:83], v[176:179]
v_mfma_f32_16x16x32_bf16 v[180:183], v[108:111], v[84:87], v[180:183]
v_mfma_f32_16x16x32_bf16 v[184:187], v[108:111], v[88:91], v[184:187]
v_mfma_f32_16x16x32_bf16 v[188:191], v[108:111], v[92:95], v[188:191]
v_mfma_f32_16x16x32_bf16 v[252:255], v[124:127], v[92:95], v[252:255]
v_mfma_f32_16x16x32_bf16 v[248:251], v[124:127], v[88:91], v[248:251]
v_mfma_f32_16x16x32_bf16 v[244:247], v[124:127], v[84:87], v[244:247]
v_mfma_f32_16x16x32_bf16 v[240:243], v[124:127], v[80:83], v[240:243]
s_waitcnt lgkmcnt(0)
v_mfma_f32_16x16x32_bf16 v[128:131], v[48:51], v[32:35], v[128:131]
ds_read_b128 v[80:83], v4 offset:8192
v_mfma_f32_16x16x32_bf16 v[132:135], v[48:51], v[36:39], v[132:135]
ds_read_b64_tr_b16 v[96:97], v13 offset:24576
v_mfma_f32_16x16x32_bf16 v[136:139], v[48:51], v[40:43], v[136:139]
ds_read_b64_tr_b16 v[98:99], v13 offset:28672
v_mfma_f32_16x16x32_bf16 v[140:143], v[48:51], v[44:47], v[140:143]
ds_read_b128 v[84:87], v4 offset:8448
v_mfma_f32_16x16x32_bf16 v[204:207], v[64:67], v[44:47], v[204:207]
ds_read_b128 v[88:91], v4 offset:8704
v_mfma_f32_16x16x32_bf16 v[200:203], v[64:67], v[40:43], v[200:203]
ds_read_b128 v[92:95], v4 offset:8960
v_mfma_f32_16x16x32_bf16 v[196:199], v[64:67], v[36:39], v[196:199]
ds_read_b64_tr_b16 v[112:113], v13 offset:40960
v_mfma_f32_16x16x32_bf16 v[192:195], v[64:67], v[32:35], v[192:195]
ds_read_b64_tr_b16 v[114:115], v13 offset:45056
v_mfma_f32_16x16x32_bf16 v[144:147], v[52:55], v[32:35], v[144:147]
ds_read_b64_tr_b16 v[100:101], v14 offset:24576
v_mfma_f32_16x16x32_bf16 v[148:151], v[52:55], v[36:39], v[148:151]
ds_read_b64_tr_b16 v[102:103], v14 offset:28672
v_mfma_f32_16x16x32_bf16 v[152:155], v[52:55], v[40:43], v[152:155]
ds_read_b64_tr_b16 v[116:117], v14 offset:40960
v_mfma_f32_16x16x32_bf16 v[156:159], v[52:55], v[44:47], v[156:159]
ds_read_b64_tr_b16 v[118:119], v14 offset:45056
v_mfma_f32_16x16x32_bf16 v[220:223], v[68:71], v[44:47], v[220:223]
ds_read_b64_tr_b16 v[104:105], v15 offset:24576
v_mfma_f32_16x16x32_bf16 v[216:219], v[68:71], v[40:43], v[216:219]
ds_read_b64_tr_b16 v[106:107], v15 offset:28672
v_mfma_f32_16x16x32_bf16 v[212:215], v[68:71], v[36:39], v[212:215]
ds_read_b64_tr_b16 v[120:121], v15 offset:40960
v_mfma_f32_16x16x32_bf16 v[208:211], v[68:71], v[32:35], v[208:211]
ds_read_b64_tr_b16 v[122:123], v15 offset:45056
v_mfma_f32_16x16x32_bf16 v[160:163], v[56:59], v[32:35], v[160:163]
ds_read_b64_tr_b16 v[108:109], v16 offset:24576
v_mfma_f32_16x16x32_bf16 v[164:167], v[56:59], v[36:39], v[164:167]
ds_read_b64_tr_b16 v[110:111], v16 offset:28672
v_mfma_f32_16x16x32_bf16 v[168:171], v[56:59], v[40:43], v[168:171]
ds_read_b64_tr_b16 v[124:125], v16 offset:40960
v_mfma_f32_16x16x32_bf16 v[172:175], v[56:59], v[44:47], v[172:175]
ds_read_b64_tr_b16 v[126:127], v16 offset:45056
v_mfma_f32_16x16x32_bf16 v[236:239], v[72:75], v[44:47], v[236:239]
v_mfma_f32_16x16x32_bf16 v[232:235], v[72:75], v[40:43], v[232:235]
v_mfma_f32_16x16x32_bf16 v[228:231], v[72:75], v[36:39], v[228:231]
v_mfma_f32_16x16x32_bf16 v[224:227], v[72:75], v[32:35], v[224:227]
v_mfma_f32_16x16x32_bf16 v[176:179], v[60:63], v[32:35], v[176:179]
v_mfma_f32_16x16x32_bf16 v[180:183], v[60:63], v[36:39], v[180:183]
v_mfma_f32_16x16x32_bf16 v[184:187], v[60:63], v[40:43], v[184:187]
v_mfma_f32_16x16x32_bf16 v[188:191], v[60:63], v[44:47], v[188:191]
v_mfma_f32_16x16x32_bf16 v[252:255], v[76:79], v[44:47], v[252:255]
v_mfma_f32_16x16x32_bf16 v[248:251], v[76:79], v[40:43], v[248:251]
v_mfma_f32_16x16x32_bf16 v[244:247], v[76:79], v[36:39], v[244:247]
v_mfma_f32_16x16x32_bf16 v[240:243], v[76:79], v[32:35], v[240:243]
s_waitcnt lgkmcnt(0)
s_barrier
v_mfma_f32_16x16x32_bf16 v[128:131], v[96:99], v[80:83], v[128:131]
ds_read_b128 v[32:35], v2 offset:0
v_mfma_f32_16x16x32_bf16 v[132:135], v[96:99], v[84:87], v[132:135]
ds_read_b64_tr_b16 v[48:49], v5 offset:16384
v_mfma_f32_16x16x32_bf16 v[136:139], v[96:99], v[88:91], v[136:139]
ds_read_b64_tr_b16 v[50:51], v5 offset:20480
v_mfma_f32_16x16x32_bf16 v[140:143], v[96:99], v[92:95], v[140:143]
ds_read_b128 v[36:39], v2 offset:256
v_mfma_f32_16x16x32_bf16 v[204:207], v[112:115], v[92:95], v[204:207]
ds_read_b128 v[40:43], v2 offset:512
v_mfma_f32_16x16x32_bf16 v[200:203], v[112:115], v[88:91], v[200:203]
ds_read_b128 v[44:47], v2 offset:768
v_mfma_f32_16x16x32_bf16 v[196:199], v[112:115], v[84:87], v[196:199]
ds_read_b64_tr_b16 v[64:65], v5 offset:32768
v_mfma_f32_16x16x32_bf16 v[192:195], v[112:115], v[80:83], v[192:195]
ds_read_b64_tr_b16 v[66:67], v5 offset:36864
v_mfma_f32_16x16x32_bf16 v[144:147], v[100:103], v[80:83], v[144:147]
ds_read_b64_tr_b16 v[52:53], v6 offset:16384
v_mfma_f32_16x16x32_bf16 v[148:151], v[100:103], v[84:87], v[148:151]
ds_read_b64_tr_b16 v[54:55], v6 offset:20480
v_mfma_f32_16x16x32_bf16 v[152:155], v[100:103], v[88:91], v[152:155]
ds_read_b64_tr_b16 v[68:69], v6 offset:32768
v_mfma_f32_16x16x32_bf16 v[156:159], v[100:103], v[92:95], v[156:159]
ds_read_b64_tr_b16 v[70:71], v6 offset:36864
v_mfma_f32_16x16x32_bf16 v[220:223], v[116:119], v[92:95], v[220:223]
ds_read_b64_tr_b16 v[56:57], v7 offset:16384
v_mfma_f32_16x16x32_bf16 v[216:219], v[116:119], v[88:91], v[216:219]
ds_read_b64_tr_b16 v[58:59], v7 offset:20480
v_mfma_f32_16x16x32_bf16 v[212:215], v[116:119], v[84:87], v[212:215]
ds_read_b64_tr_b16 v[72:73], v7 offset:32768
v_mfma_f32_16x16x32_bf16 v[208:211], v[116:119], v[80:83], v[208:211]
ds_read_b64_tr_b16 v[74:75], v7 offset:36864
v_mfma_f32_16x16x32_bf16 v[160:163], v[104:107], v[80:83], v[160:163]
ds_read_b64_tr_b16 v[60:61], v8 offset:16384
v_mfma_f32_16x16x32_bf16 v[164:167], v[104:107], v[84:87], v[164:167]
ds_read_b64_tr_b16 v[62:63], v8 offset:20480
v_mfma_f32_16x16x32_bf16 v[168:171], v[104:107], v[88:91], v[168:171]
ds_read_b64_tr_b16 v[76:77], v8 offset:32768
v_mfma_f32_16x16x32_bf16 v[172:175], v[104:107], v[92:95], v[172:175]
ds_read_b64_tr_b16 v[78:79], v8 offset:36864
v_mfma_f32_16x16x32_bf16 v[236:239], v[120:123], v[92:95], v[236:239]
v_mfma_f32_16x16x32_bf16 v[232:235], v[120:123], v[88:91], v[232:235]
v_mfma_f32_16x16x32_bf16 v[228:231], v[120:123], v[84:87], v[228:231]
v_mfma_f32_16x16x32_bf16 v[224:227], v[120:123], v[80:83], v[224:227]
v_mfma_f32_16x16x32_bf16 v[176:179], v[108:111], v[80:83], v[176:179]
v_mfma_f32_16x16x32_bf16 v[180:183], v[108:111], v[84:87], v[180:183]
v_mfma_f32_16x16x32_bf16 v[184:187], v[108:111], v[88:91], v[184:187]
v_mfma_f32_16x16x32_bf16 v[188:191], v[108:111], v[92:95], v[188:191]
v_mfma_f32_16x16x32_bf16 v[252:255], v[124:127], v[92:95], v[252:255]
v_mfma_f32_16x16x32_bf16 v[248:251], v[124:127], v[88:91], v[248:251]
v_mfma_f32_16x16x32_bf16 v[244:247], v[124:127], v[84:87], v[244:247]
v_mfma_f32_16x16x32_bf16 v[240:243], v[124:127], v[80:83], v[240:243]
s_waitcnt lgkmcnt(0)
v_mfma_f32_16x16x32_bf16 v[128:131], v[48:51], v[32:35], v[128:131]
ds_read_b128 v[80:83], v2 offset:8192
v_mfma_f32_16x16x32_bf16 v[132:135], v[48:51], v[36:39], v[132:135]
ds_read_b64_tr_b16 v[96:97], v5 offset:24576
v_mfma_f32_16x16x32_bf16 v[136:139], v[48:51], v[40:43], v[136:139]
ds_read_b64_tr_b16 v[98:99], v5 offset:28672
v_mfma_f32_16x16x32_bf16 v[140:143], v[48:51], v[44:47], v[140:143]
ds_read_b128 v[84:87], v2 offset:8448
v_mfma_f32_16x16x32_bf16 v[204:207], v[64:67], v[44:47], v[204:207]
ds_read_b128 v[88:91], v2 offset:8704
v_mfma_f32_16x16x32_bf16 v[200:203], v[64:67], v[40:43], v[200:203]
ds_read_b128 v[92:95], v2 offset:8960
v_mfma_f32_16x16x32_bf16 v[196:199], v[64:67], v[36:39], v[196:199]
ds_read_b64_tr_b16 v[112:113], v5 offset:40960
v_mfma_f32_16x16x32_bf16 v[192:195], v[64:67], v[32:35], v[192:195]
ds_read_b64_tr_b16 v[114:115], v5 offset:45056
v_mfma_f32_16x16x32_bf16 v[144:147], v[52:55], v[32:35], v[144:147]
ds_read_b64_tr_b16 v[100:101], v6 offset:24576
v_mfma_f32_16x16x32_bf16 v[148:151], v[52:55], v[36:39], v[148:151]
ds_read_b64_tr_b16 v[102:103], v6 offset:28672
v_mfma_f32_16x16x32_bf16 v[152:155], v[52:55], v[40:43], v[152:155]
ds_read_b64_tr_b16 v[116:117], v6 offset:40960
v_mfma_f32_16x16x32_bf16 v[156:159], v[52:55], v[44:47], v[156:159]
ds_read_b64_tr_b16 v[118:119], v6 offset:45056
v_mfma_f32_16x16x32_bf16 v[220:223], v[68:71], v[44:47], v[220:223]
ds_read_b64_tr_b16 v[104:105], v7 offset:24576
v_mfma_f32_16x16x32_bf16 v[216:219], v[68:71], v[40:43], v[216:219]
ds_read_b64_tr_b16 v[106:107], v7 offset:28672
v_mfma_f32_16x16x32_bf16 v[212:215], v[68:71], v[36:39], v[212:215]
ds_read_b64_tr_b16 v[120:121], v7 offset:40960
v_mfma_f32_16x16x32_bf16 v[208:211], v[68:71], v[32:35], v[208:211]
ds_read_b64_tr_b16 v[122:123], v7 offset:45056
v_mfma_f32_16x16x32_bf16 v[160:163], v[56:59], v[32:35], v[160:163]
ds_read_b64_tr_b16 v[108:109], v8 offset:24576
v_mfma_f32_16x16x32_bf16 v[164:167], v[56:59], v[36:39], v[164:167]
ds_read_b64_tr_b16 v[110:111], v8 offset:28672
v_mfma_f32_16x16x32_bf16 v[168:171], v[56:59], v[40:43], v[168:171]
ds_read_b64_tr_b16 v[124:125], v8 offset:40960
v_mfma_f32_16x16x32_bf16 v[172:175], v[56:59], v[44:47], v[172:175]
ds_read_b64_tr_b16 v[126:127], v8 offset:45056
v_mfma_f32_16x16x32_bf16 v[236:239], v[72:75], v[44:47], v[236:239]
v_mfma_f32_16x16x32_bf16 v[232:235], v[72:75], v[40:43], v[232:235]
v_mfma_f32_16x16x32_bf16 v[228:231], v[72:75], v[36:39], v[228:231]
v_mfma_f32_16x16x32_bf16 v[224:227], v[72:75], v[32:35], v[224:227]
v_mfma_f32_16x16x32_bf16 v[176:179], v[60:63], v[32:35], v[176:179]
v_mfma_f32_16x16x32_bf16 v[180:183], v[60:63], v[36:39], v[180:183]
v_mfma_f32_16x16x32_bf16 v[184:187], v[60:63], v[40:43], v[184:187]
v_mfma_f32_16x16x32_bf16 v[188:191], v[60:63], v[44:47], v[188:191]
v_mfma_f32_16x16x32_bf16 v[252:255], v[76:79], v[44:47], v[252:255]
v_mfma_f32_16x16x32_bf16 v[248:251], v[76:79], v[40:43], v[248:251]
v_mfma_f32_16x16x32_bf16 v[244:247], v[76:79], v[36:39], v[244:247]
v_mfma_f32_16x16x32_bf16 v[240:243], v[76:79], v[32:35], v[240:243]
s_waitcnt lgkmcnt(0)
s_barrier
v_mfma_f32_16x16x32_bf16 v[128:131], v[96:99], v[80:83], v[128:131]
ds_read_b128 v[32:35], v3 offset:0
v_mfma_f32_16x16x32_bf16 v[132:135], v[96:99], v[84:87], v[132:135]
ds_read_b64_tr_b16 v[48:49], v9 offset:16384
v_mfma_f32_16x16x32_bf16 v[136:139], v[96:99], v[88:91], v[136:139]
ds_read_b64_tr_b16 v[50:51], v9 offset:20480
v_mfma_f32_16x16x32_bf16 v[140:143], v[96:99], v[92:95], v[140:143]
ds_read_b128 v[36:39], v3 offset:256
v_mfma_f32_16x16x32_bf16 v[204:207], v[112:115], v[92:95], v[204:207]
ds_read_b128 v[40:43], v3 offset:512
v_mfma_f32_16x16x32_bf16 v[200:203], v[112:115], v[88:91], v[200:203]
ds_read_b128 v[44:47], v3 offset:768
v_mfma_f32_16x16x32_bf16 v[196:199], v[112:115], v[84:87], v[196:199]
ds_read_b64_tr_b16 v[64:65], v9 offset:32768
v_mfma_f32_16x16x32_bf16 v[192:195], v[112:115], v[80:83], v[192:195]
ds_read_b64_tr_b16 v[66:67], v9 offset:36864
v_mfma_f32_16x16x32_bf16 v[144:147], v[100:103], v[80:83], v[144:147]
ds_read_b64_tr_b16 v[52:53], v10 offset:16384
v_mfma_f32_16x16x32_bf16 v[148:151], v[100:103], v[84:87], v[148:151]
ds_read_b64_tr_b16 v[54:55], v10 offset:20480
v_mfma_f32_16x16x32_bf16 v[152:155], v[100:103], v[88:91], v[152:155]
ds_read_b64_tr_b16 v[68:69], v10 offset:32768
v_mfma_f32_16x16x32_bf16 v[156:159], v[100:103], v[92:95], v[156:159]
ds_read_b64_tr_b16 v[70:71], v10 offset:36864
v_mfma_f32_16x16x32_bf16 v[220:223], v[116:119], v[92:95], v[220:223]
ds_read_b64_tr_b16 v[56:57], v11 offset:16384
v_mfma_f32_16x16x32_bf16 v[216:219], v[116:119], v[88:91], v[216:219]
ds_read_b64_tr_b16 v[58:59], v11 offset:20480
v_mfma_f32_16x16x32_bf16 v[212:215], v[116:119], v[84:87], v[212:215]
ds_read_b64_tr_b16 v[72:73], v11 offset:32768
v_mfma_f32_16x16x32_bf16 v[208:211], v[116:119], v[80:83], v[208:211]
ds_read_b64_tr_b16 v[74:75], v11 offset:36864
v_mfma_f32_16x16x32_bf16 v[160:163], v[104:107], v[80:83], v[160:163]
ds_read_b64_tr_b16 v[60:61], v12 offset:16384
v_mfma_f32_16x16x32_bf16 v[164:167], v[104:107], v[84:87], v[164:167]
ds_read_b64_tr_b16 v[62:63], v12 offset:20480
v_mfma_f32_16x16x32_bf16 v[168:171], v[104:107], v[88:91], v[168:171]
ds_read_b64_tr_b16 v[76:77], v12 offset:32768
v_mfma_f32_16x16x32_bf16 v[172:175], v[104:107], v[92:95], v[172:175]
ds_read_b64_tr_b16 v[78:79], v12 offset:36864
v_mfma_f32_16x16x32_bf16 v[236:239], v[120:123], v[92:95], v[236:239]
v_mfma_f32_16x16x32_bf16 v[232:235], v[120:123], v[88:91], v[232:235]
v_mfma_f32_16x16x32_bf16 v[228:231], v[120:123], v[84:87], v[228:231]
v_mfma_f32_16x16x32_bf16 v[224:227], v[120:123], v[80:83], v[224:227]
v_mfma_f32_16x16x32_bf16 v[176:179], v[108:111], v[80:83], v[176:179]
v_mfma_f32_16x16x32_bf16 v[180:183], v[108:111], v[84:87], v[180:183]
v_mfma_f32_16x16x32_bf16 v[184:187], v[108:111], v[88:91], v[184:187]
v_mfma_f32_16x16x32_bf16 v[188:191], v[108:111], v[92:95], v[188:191]
v_mfma_f32_16x16x32_bf16 v[252:255], v[124:127], v[92:95], v[252:255]
v_mfma_f32_16x16x32_bf16 v[248:251], v[124:127], v[88:91], v[248:251]
v_mfma_f32_16x16x32_bf16 v[244:247], v[124:127], v[84:87], v[244:247]
v_mfma_f32_16x16x32_bf16 v[240:243], v[124:127], v[80:83], v[240:243]
s_sub_u32 s41, s41, 1
s_cmp_lg_u32 s41, 0
s_cbranch_scc1 Lk3_123
s_waitcnt lgkmcnt(0)
v_mfma_f32_16x16x32_bf16 v[128:131], v[48:51], v[32:35], v[128:131]
ds_read_b128 v[80:83], v3 offset:8192
v_mfma_f32_16x16x32_bf16 v[132:135], v[48:51], v[36:39], v[132:135]
ds_read_b64_tr_b16 v[96:97], v9 offset:24576
v_mfma_f32_16x16x32_bf16 v[136:139], v[48:51], v[40:43], v[136:139]
ds_read_b64_tr_b16 v[98:99], v9 offset:28672
v_mfma_f32_16x16x32_bf16 v[140:143], v[48:51], v[44:47], v[140:143]
ds_read_b128 v[84:87], v3 offset:8448
v_mfma_f32_16x16x32_bf16 v[204:207], v[64:67], v[44:47], v[204:207]
ds_read_b128 v[88:91], v3 offset:8704
v_mfma_f32_16x16x32_bf16 v[200:203], v[64:67], v[40:43], v[200:203]
ds_read_b128 v[92:95], v3 offset:8960
v_mfma_f32_16x16x32_bf16 v[196:199], v[64:67], v[36:39], v[196:199]
ds_read_b64_tr_b16 v[112:113], v9 offset:40960
v_mfma_f32_16x16x32_bf16 v[192:195], v[64:67], v[32:35], v[192:195]
ds_read_b64_tr_b16 v[114:115], v9 offset:45056
v_mfma_f32_16x16x32_bf16 v[144:147], v[52:55], v[32:35], v[144:147]
ds_read_b64_tr_b16 v[100:101], v10 offset:24576
v_mfma_f32_16x16x32_bf16 v[148:151], v[52:55], v[36:39], v[148:151]
ds_read_b64_tr_b16 v[102:103], v10 offset:28672
v_mfma_f32_16x16x32_bf16 v[152:155], v[52:55], v[40:43], v[152:155]
ds_read_b64_tr_b16 v[116:117], v10 offset:40960
v_mfma_f32_16x16x32_bf16 v[156:159], v[52:55], v[44:47], v[156:159]
ds_read_b64_tr_b16 v[118:119], v10 offset:45056
v_mfma_f32_16x16x32_bf16 v[220:223], v[68:71], v[44:47], v[220:223]
ds_read_b64_tr_b16 v[104:105], v11 offset:24576
v_mfma_f32_16x16x32_bf16 v[216:219], v[68:71], v[40:43], v[216:219]
ds_read_b64_tr_b16 v[106:107], v11 offset:28672
v_mfma_f32_16x16x32_bf16 v[212:215], v[68:71], v[36:39], v[212:215]
ds_read_b64_tr_b16 v[120:121], v11 offset:40960
v_mfma_f32_16x16x32_bf16 v[208:211], v[68:71], v[32:35], v[208:211]
ds_read_b64_tr_b16 v[122:123], v11 offset:45056
v_mfma_f32_16x16x32_bf16 v[160:163], v[56:59], v[32:35], v[160:163]
ds_read_b64_tr_b16 v[108:109], v12 offset:24576
v_mfma_f32_16x16x32_bf16 v[164:167], v[56:59], v[36:39], v[164:167]
ds_read_b64_tr_b16 v[110:111], v12 offset:28672
v_mfma_f32_16x16x32_bf16 v[168:171], v[56:59], v[40:43], v[168:171]
ds_read_b64_tr_b16 v[124:125], v12 offset:40960
v_mfma_f32_16x16x32_bf16 v[172:175], v[56:59], v[44:47], v[172:175]
ds_read_b64_tr_b16 v[126:127], v12 offset:45056
v_mfma_f32_16x16x32_bf16 v[236:239], v[72:75], v[44:47], v[236:239]
v_mfma_f32_16x16x32_bf16 v[232:235], v[72:75], v[40:43], v[232:235]
v_mfma_f32_16x16x32_bf16 v[228:231], v[72:75], v[36:39], v[228:231]
v_mfma_f32_16x16x32_bf16 v[224:227], v[72:75], v[32:35], v[224:227]
v_mfma_f32_16x16x32_bf16 v[176:179], v[60:63], v[32:35], v[176:179]
v_mfma_f32_16x16x32_bf16 v[180:183], v[60:63], v[36:39], v[180:183]
v_mfma_f32_16x16x32_bf16 v[184:187], v[60:63], v[40:43], v[184:187]
v_mfma_f32_16x16x32_bf16 v[188:191], v[60:63], v[44:47], v[188:191]
v_mfma_f32_16x16x32_bf16 v[252:255], v[76:79], v[44:47], v[252:255]
v_mfma_f32_16x16x32_bf16 v[248:251], v[76:79], v[40:43], v[248:251]
v_mfma_f32_16x16x32_bf16 v[244:247], v[76:79], v[36:39], v[244:247]
v_mfma_f32_16x16x32_bf16 v[240:243], v[76:79], v[32:35], v[240:243]
s_waitcnt lgkmcnt(0)
s_barrier
v_mfma_f32_16x16x32_bf16 v[128:131], v[96:99], v[80:83], v[128:131]
ds_read_b128 v[32:35], v4 offset:0
v_mfma_f32_16x16x32_bf16 v[132:135], v[96:99], v[84:87], v[132:135]
ds_read_b64_tr_b16 v[48:49], v13 offset:16384
v_mfma_f32_16x16x32_bf16 v[136:139], v[96:99], v[88:91], v[136:139]
ds_read_b64_tr_b16 v[50:51], v13 offset:20480
v_mfma_f32_16x16x32_bf16 v[140:143], v[96:99], v[92:95], v[140:143]
ds_read_b128 v[36:39], v4 offset:256
v_mfma_f32_16x16x32_bf16 v[204:207], v[112:115], v[92:95], v[204:207]
ds_read_b128 v[40:43], v4 offset:512
v_mfma_f32_16x16x32_bf16 v[200:203], v[112:115], v[88:91], v[200:203]
ds_read_b128 v[44:47], v4 offset:768
v_mfma_f32_16x16x32_bf16 v[196:199], v[112:115], v[84:87], v[196:199]
ds_read_b64_tr_b16 v[64:65], v13 offset:32768
v_mfma_f32_16x16x32_bf16 v[192:195], v[112:115], v[80:83], v[192:195]
ds_read_b64_tr_b16 v[66:67], v13 offset:36864
v_mfma_f32_16x16x32_bf16 v[144:147], v[100:103], v[80:83], v[144:147]
ds_read_b64_tr_b16 v[52:53], v14 offset:16384
v_mfma_f32_16x16x32_bf16 v[148:151], v[100:103], v[84:87], v[148:151]
ds_read_b64_tr_b16 v[54:55], v14 offset:20480
v_mfma_f32_16x16x32_bf16 v[152:155], v[100:103], v[88:91], v[152:155]
ds_read_b64_tr_b16 v[68:69], v14 offset:32768
v_mfma_f32_16x16x32_bf16 v[156:159], v[100:103], v[92:95], v[156:159]
ds_read_b64_tr_b16 v[70:71], v14 offset:36864
v_mfma_f32_16x16x32_bf16 v[220:223], v[116:119], v[92:95], v[220:223]
ds_read_b64_tr_b16 v[56:57], v15 offset:16384
v_mfma_f32_16x16x32_bf16 v[216:219], v[116:119], v[88:91], v[216:219]
ds_read_b64_tr_b16 v[58:59], v15 offset:20480
v_mfma_f32_16x16x32_bf16 v[212:215], v[116:119], v[84:87], v[212:215]
ds_read_b64_tr_b16 v[72:73], v15 offset:32768
v_mfma_f32_16x16x32_bf16 v[208:211], v[116:119], v[80:83], v[208:211]
ds_read_b64_tr_b16 v[74:75], v15 offset:36864
v_mfma_f32_16x16x32_bf16 v[160:163], v[104:107], v[80:83], v[160:163]
ds_read_b64_tr_b16 v[60:61], v16 offset:16384
v_mfma_f32_16x16x32_bf16 v[164:167], v[104:107], v[84:87], v[164:167]
ds_read_b64_tr_b16 v[62:63], v16 offset:20480
v_mfma_f32_16x16x32_bf16 v[168:171], v[104:107], v[88:91], v[168:171]
ds_read_b64_tr_b16 v[76:77], v16 offset:32768
v_mfma_f32_16x16x32_bf16 v[172:175], v[104:107], v[92:95], v[172:175]
ds_read_b64_tr_b16 v[78:79], v16 offset:36864
v_mfma_f32_16x16x32_bf16 v[236:239], v[120:123], v[92:95], v[236:239]
v_mfma_f32_16x16x32_bf16 v[232:235], v[120:123], v[88:91], v[232:235]
v_mfma_f32_16x16x32_bf16 v[228:231], v[120:123], v[84:87], v[228:231]
v_mfma_f32_16x16x32_bf16 v[224:227], v[120:123], v[80:83], v[224:227]
v_mfma_f32_16x16x32_bf16 v[176:179], v[108:111], v[80:83], v[176:179]
v_mfma_f32_16x16x32_bf16 v[180:183], v[108:111], v[84:87], v[180:183]
v_mfma_f32_16x16x32_bf16 v[184:187], v[108:111], v[88:91], v[184:187]
v_mfma_f32_16x16x32_bf16 v[188:191], v[108:111], v[92:95], v[188:191]
v_mfma_f32_16x16x32_bf16 v[252:255], v[124:127], v[92:95], v[252:255]
v_mfma_f32_16x16x32_bf16 v[248:251], v[124:127], v[88:91], v[248:251]
v_mfma_f32_16x16x32_bf16 v[244:247], v[124:127], v[84:87], v[244:247]
v_mfma_f32_16x16x32_bf16 v[240:243], v[124:127], v[80:83], v[240:243]
s_waitcnt lgkmcnt(0)
v_mfma_f32_16x16x32_bf16 v[128:131], v[48:51], v[32:35], v[128:131]
ds_read_b128 v[80:83], v4 offset:8192
v_mfma_f32_16x16x32_bf16 v[132:135], v[48:51], v[36:39], v[132:135]
ds_read_b64_tr_b16 v[96:97], v13 offset:24576
v_mfma_f32_16x16x32_bf16 v[136:139], v[48:51], v[40:43], v[136:139]
ds_read_b64_tr_b16 v[98:99], v13 offset:28672
v_mfma_f32_16x16x32_bf16 v[140:143], v[48:51], v[44:47], v[140:143]
ds_read_b128 v[84:87], v4 offset:8448
v_mfma_f32_16x16x32_bf16 v[204:207], v[64:67], v[44:47], v[204:207]
ds_read_b128 v[88:91], v4 offset:8704
v_mfma_f32_16x16x32_bf16 v[200:203], v[64:67], v[40:43], v[200:203]
ds_read_b128 v[92:95], v4 offset:8960
v_mfma_f32_16x16x32_bf16 v[196:199], v[64:67], v[36:39], v[196:199]
ds_read_b64_tr_b16 v[112:113], v13 offset:40960
v_mfma_f32_16x16x32_bf16 v[192:195], v[64:67], v[32:35], v[192:195]
ds_read_b64_tr_b16 v[114:115], v13 offset:45056
v_mfma_f32_16x16x32_bf16 v[144:147], v[52:55], v[32:35], v[144:147]
ds_read_b64_tr_b16 v[100:101], v14 offset:24576
v_mfma_f32_16x16x32_bf16 v[148:151], v[52:55], v[36:39], v[148:151]
ds_read_b64_tr_b16 v[102:103], v14 offset:28672
v_mfma_f32_16x16x32_bf16 v[152:155], v[52:55], v[40:43], v[152:155]
ds_read_b64_tr_b16 v[116:117], v14 offset:40960
v_mfma_f32_16x16x32_bf16 v[156:159], v[52:55], v[44:47], v[156:159]
ds_read_b64_tr_b16 v[118:119], v14 offset:45056
v_mfma_f32_16x16x32_bf16 v[220:223], v[68:71], v[44:47], v[220:223]
ds_read_b64_tr_b16 v[104:105], v15 offset:24576
v_mfma_f32_16x16x32_bf16 v[216:219], v[68:71], v[40:43], v[216:219]
ds_read_b64_tr_b16 v[106:107], v15 offset:28672
v_mfma_f32_16x16x32_bf16 v[212:215], v[68:71], v[36:39], v[212:215]
ds_read_b64_tr_b16 v[120:121], v15 offset:40960
v_mfma_f32_16x16x32_bf16 v[208:211], v[68:71], v[32:35], v[208:211]
ds_read_b64_tr_b16 v[122:123], v15 offset:45056
v_mfma_f32_16x16x32_bf16 v[160:163], v[56:59], v[32:35], v[160:163]
ds_read_b64_tr_b16 v[108:109], v16 offset:24576
v_mfma_f32_16x16x32_bf16 v[164:167], v[56:59], v[36:39], v[164:167]
ds_read_b64_tr_b16 v[110:111], v16 offset:28672
v_mfma_f32_16x16x32_bf16 v[168:171], v[56:59], v[40:43], v[168:171]
ds_read_b64_tr_b16 v[124:125], v16 offset:40960
v_mfma_f32_16x16x32_bf16 v[172:175], v[56:59], v[44:47], v[172:175]
ds_read_b64_tr_b16 v[126:127], v16 offset:45056
v_mfma_f32_16x16x32_bf16 v[236:239], v[72:75], v[44:47], v[236:239]
v_mfma_f32_16x16x32_bf16 v[232:235], v[72:75], v[40:43], v[232:235]
v_mfma_f32_16x16x32_bf16 v[228:231], v[72:75], v[36:39], v[228:231]
v_mfma_f32_16x16x32_bf16 v[224:227], v[72:75], v[32:35], v[224:227]
v_mfma_f32_16x16x32_bf16 v[176:179], v[60:63], v[32:35], v[176:179]
v_mfma_f32_16x16x32_bf16 v[180:183], v[60:63], v[36:39], v[180:183]
v_mfma_f32_16x16x32_bf16 v[184:187], v[60:63], v[40:43], v[184:187]
v_mfma_f32_16x16x32_bf16 v[188:191], v[60:63], v[44:47], v[188:191]
v_mfma_f32_16x16x32_bf16 v[252:255], v[76:79], v[44:47], v[252:255]
v_mfma_f32_16x16x32_bf16 v[248:251], v[76:79], v[40:43], v[248:251]
v_mfma_f32_16x16x32_bf16 v[244:247], v[76:79], v[36:39], v[244:247]
v_mfma_f32_16x16x32_bf16 v[240:243], v[76:79], v[32:35], v[240:243]
s_waitcnt lgkmcnt(0)
s_barrier
s_cmp_eq_u32 s36, 3
s_cbranch_scc1 L3h_124
s_add_u32 s42, s42, 1
s_xor_b32 s37, s42, s35
s_add_u32 m0, s39, 98304
s_mul_i32 s37, s37, s40
buffer_load_dwordx4 v22, s[8:11], s37 offen sc1 lds
v_mfma_f32_16x16x32_bf16 v[128:131], v[96:99], v[80:83], v[128:131]
s_lshl_b32 s43, s46, 9
v_mfma_f32_16x16x32_bf16 v[132:135], v[96:99], v[84:87], v[132:135]
s_add_u32 s43, s43, 147456
s_add_u32 m0, s39, 99328
s_add_u32 s37, s37, s38
buffer_load_dwordx4 v23, s[8:11], s37 offen sc1 lds
v_mfma_f32_16x16x32_bf16 v[136:139], v[96:99], v[88:91], v[136:139]
v_lshl_add_u32 v19, v17, 3, s43
v_mfma_f32_16x16x32_bf16 v[140:143], v[96:99], v[92:95], v[140:143]
s_add_u32 m0, s39, 100352
s_add_u32 s37, s37, s38
buffer_load_dwordx4 v22, s[8:11], s37 offen sc1 lds
ds_read_b64 v[2:3], v19 offset:0
v_mfma_f32_16x16x32_bf16 v[204:207], v[112:115], v[92:95], v[204:207]
ds_read_b64 v[4:5], v19 offset:128
s_add_u32 m0, s39, 101376
s_add_u32 s37, s37, s38
buffer_load_dwordx4 v23, s[8:11], s37 offen sc1 lds
v_mfma_f32_16x16x32_bf16 v[200:203], v[112:115], v[88:91], v[200:203]
ds_read_b64 v[6:7], v19 offset:256
v_mfma_f32_16x16x32_bf16 v[196:199], v[112:115], v[84:87], v[196:199]
s_add_u32 m0, s39, 102400
s_add_u32 s37, s37, s38
buffer_load_dwordx4 v22, s[8:11], s37 offen sc1 lds
ds_read_b64 v[8:9], v19 offset:384
v_mfma_f32_16x16x32_bf16 v[192:195], v[112:115], v[80:83], v[192:195]
s_mul_i32 s43, s47, 256
s_add_u32 m0, s39, 103424
s_add_u32 s37, s37, s38
buffer_load_dwordx4 v23, s[8:11], s37 offen sc1 lds
v_mfma_f32_16x16x32_bf16 v[144:147], v[100:103], v[80:83], v[144:147]
s_add_u32 s43, s43, 148480
v_mfma_f32_16x16x32_bf16 v[148:151], v[100:103], v[84:87], v[148:151]
s_add_u32 m0, s39, 104448
s_add_u32 s37, s37, s38
buffer_load_dwordx4 v22, s[8:11], s37 offen sc1 lds
v_lshl_add_u32 v19, v18, 4, s43
v_mfma_f32_16x16x32_bf16 v[152:155], v[100:103], v[88:91], v[152:155]
ds_read_b128 v[48:51], v19 offset:0
s_add_u32 m0, s39, 105472
s_add_u32 s37, s37, s38
buffer_load_dwordx4 v23, s[8:11], s37 offen sc1 lds
v_mfma_f32_16x16x32_bf16 v[156:159], v[100:103], v[92:95], v[156:159]
ds_read_b128 v[52:55], v19 offset:64
v_mfma_f32_16x16x32_bf16 v[220:223], v[116:119], v[92:95], v[220:223]
s_add_u32 m0, s39, 106496
s_add_u32 s37, s37, s38
buffer_load_dwordx4 v22, s[8:11], s37 offen sc1 lds
ds_read_b128 v[56:59], v19 offset:128
v_mfma_f32_16x16x32_bf16 v[216:219], v[116:119], v[88:91], v[216:219]
ds_read_b128 v[60:63], v19 offset:192
v_mfma_f32_16x16x32_bf16 v[212:215], v[116:119], v[84:87], v[212:215]
s_add_u32 m0, s39, 107520
s_add_u32 s37, s37, s38
buffer_load_dwordx4 v23, s[8:11], s37 offen sc1 lds
ds_read_b128 v[64:67], v19 offset:896
v_mfma_f32_16x16x32_bf16 v[208:211], v[116:119], v[80:83], v[208:211]
ds_read_b128 v[68:71], v19 offset:960
s_add_u32 m0, s39, 108544
s_add_u32 s37, s37, s38
buffer_load_dwordx4 v22, s[8:11], s37 offen sc1 lds
v_mfma_f32_16x16x32_bf16 v[160:163], v[104:107], v[80:83], v[160:163]
ds_read_b128 v[72:75], v19 offset:1024
v_mfma_f32_16x16x32_bf16 v[164:167], v[104:107], v[84:87], v[164:167]
s_add_u32 m0, s39, 109568
s_add_u32 s37, s37, s38
buffer_load_dwordx4 v23, s[8:11], s37 offen sc1 lds
ds_read_b128 v[76:79], v19 offset:1088
v_mfma_f32_16x16x32_bf16 v[168:171], v[104:107], v[88:91], v[168:171]
v_mfma_f32_16x16x32_bf16 v[172:175], v[104:107], v[92:95], v[172:175]
s_add_u32 m0, s39, 110592
s_add_u32 s37, s37, s38
buffer_load_dwordx4 v22, s[8:11], s37 offen sc1 lds
v_mfma_f32_16x16x32_bf16 v[236:239], v[120:123], v[92:95], v[236:239]
v_mfma_f32_16x16x32_bf16 v[232:235], v[120:123], v[88:91], v[232:235]
v_mfma_f32_16x16x32_bf16 v[228:231], v[120:123], v[84:87], v[228:231]
s_add_u32 m0, s39, 111616
s_add_u32 s37, s37, s38
buffer_load_dwordx4 v23, s[8:11], s37 offen sc1 lds
v_mfma_f32_16x16x32_bf16 v[224:227], v[120:123], v[80:83], v[224:227]
v_mfma_f32_16x16x32_bf16 v[176:179], v[108:111], v[80:83], v[176:179]
v_mfma_f32_16x16x32_bf16 v[180:183], v[108:111], v[84:87], v[180:183]
s_add_u32 m0, s39, 112640
s_add_u32 s37, s37, s38
buffer_load_dwordx4 v22, s[8:11], s37 offen sc1 lds
v_mfma_f32_16x16x32_bf16 v[184:187], v[108:111], v[88:91], v[184:187]
v_mfma_f32_16x16x32_bf16 v[188:191], v[108:111], v[92:95], v[188:191]
v_mfma_f32_16x16x32_bf16 v[252:255], v[124:127], v[92:95], v[252:255]
s_add_u32 m0, s39, 113664
s_add_u32 s37, s37, s38
buffer_load_dwordx4 v23, s[8:11], s37 offen sc1 lds
v_mfma_f32_16x16x32_bf16 v[248:251], v[124:127], v[88:91], v[248:251]
v_mfma_f32_16x16x32_bf16 v[244:247], v[124:127], v[84:87], v[244:247]
v_mfma_f32_16x16x32_bf16 v[240:243], v[124:127], v[80:83], v[240:243]
s_setprio 0
s_waitcnt lgkmcnt(0)
v_mov_b32 v32, v2
v_mul_f32 v88, v3, v3
v_mul_f32 v36, 0xc0135761, v3
v_mul_f32 v89, 0xbdd2d3e8, v3
v_rcp_f32 v44, v88
v_mul_f32 v40, v89, v88
v_mov_b32 v33, v4
v_mul_f32 v88, v5, v5
v_mul_f32 v37, 0xc0135761, v5
v_mul_f32 v89, 0xbdd2d3e8, v5
v_rcp_f32 v45, v88
v_mul_f32 v41, v89, v88
v_mov_b32 v34, v6
v_mul_f32 v88, v7, v7
v_mul_f32 v38, 0xc0135761, v7
v_mul_f32 v89, 0xbdd2d3e8, v7
v_rcp_f32 v46, v88
v_mul_f32 v42, v89, v88
v_mov_b32 v35, v8
v_mul_f32 v88, v9, v9
v_mul_f32 v39, 0xc0135761, v9
v_mul_f32 v89, 0xbdd2d3e8, v9
v_rcp_f32 v47, v88
v_mul_f32 v43, v89, v88
s_barrier
s_add_u32 s42, s42, 1
s_xor_b32 s37, s42, s35
s_add_u32 m0, s39, 0
s_mul_i32 s37, s37, s40
buffer_load_dwordx4 v22, s[8:11], s37 offen sc1 lds
v_fma_f32 v128, -v32, v48, v128
v_fma_f32 v129, -v32, v49, v129
v_fma_f32 v130, -v32, v50, v130
v_fma_f32 v131, -v32, v51, v131
s_add_u32 m0, s39, 1024
s_add_u32 s37, s37, s38
buffer_load_dwordx4 v23, s[8:11], s37 offen sc1 lds
v_fma_f32 v192, -v32, v64, v192
v_fma_f32 v193, -v32, v65, v193
v_fma_f32 v194, -v32, v66, v194
s_add_u32 m0, s39, 2048
s_add_u32 s37, s37, s38
buffer_load_dwordx4 v22, s[8:11], s37 offen sc1 lds
v_fma_f32 v195, -v32, v67, v195
v_mul_f32 v80, v128, v128
v_mul_f32 v81, v129, v129
s_add_u32 m0, s39, 3072
s_add_u32 s37, s37, s38
buffer_load_dwordx4 v23, s[8:11], s37 offen sc1 lds
v_mul_f32 v82, v130, v130
v_mul_f32 v83, v131, v131
v_fma_f32 v80, v80, v40, v36
s_add_u32 m0, s39, 4096
s_add_u32 s37, s37, s38
buffer_load_dwordx4 v22, s[8:11], s37 offen sc1 lds
v_fma_f32 v81, v81, v40, v36
v_fma_f32 v82, v82, v40, v36
v_fma_f32 v83, v83, v40, v36
v_mul_f32 v80, v80, v128
s_add_u32 m0, s39, 5120
s_add_u32 s37, s37, s38
buffer_load_dwordx4 v23, s[8:11], s37 offen sc1 lds
v_mul_f32 v81, v81, v129
v_mul_f32 v82, v82, v130
v_mul_f32 v83, v83, v131
s_add_u32 m0, s39, 6144
s_add_u32 s37, s37, s38
buffer_load_dwordx4 v22, s[8:11], s37 offen sc1 lds
v_exp_f32 v80, v80
v_exp_f32 v81, v81
v_exp_f32 v82, v82
s_add_u32 m0, s39, 7168
s_add_u32 s37, s37, s38
buffer_load_dwordx4 v23, s[8:11], s37 offen sc1 lds
v_exp_f32 v83, v83
v_mul_f32 v192, v128, v192
v_mul_f32 v193, v129, v193
s_add_u32 m0, s39, 8192
s_add_u32 s37, s37, s38
buffer_load_dwordx4 v22, s[8:11], s37 offen sc1 lds
v_mul_f32 v194, v130, v194
v_mul_f32 v195, v131, v195
v_fma_f32 v80, v80, v44, v44
v_fma_f32 v81, v81, v44, v44
s_add_u32 m0, s39, 9216
s_add_u32 s37, s37, s38
buffer_load_dwordx4 v23, s[8:11], s37 offen sc1 lds
v_fma_f32 v82, v82, v44, v44
v_fma_f32 v83, v83, v44, v44
v_rcp_f32 v80, v80
s_add_u32 m0, s39, 10240
s_add_u32 s37, s37, s38
buffer_load_dwordx4 v22, s[8:11], s37 offen sc1 lds
v_rcp_f32 v81, v81
v_rcp_f32 v82, v82
v_rcp_f32 v83, v83
s_add_u32 m0, s39, 11264
s_add_u32 s37, s37, s38
buffer_load_dwordx4 v23, s[8:11], s37 offen sc1 lds
v_mul_f32 v192, v192, v80
v_mul_f32 v193, v193, v81
v_mul_f32 v194, v194, v82
s_add_u32 m0, s39, 12288
s_add_u32 s37, s37, s38
buffer_load_dwordx4 v22, s[8:11], s37 offen sc1 lds
v_mul_f32 v195, v195, v83
v_cvt_pk_bf16_f32 v96, v192, v193
v_cvt_pk_bf16_f32 v97, v194, v195
v_fma_f32 v144, -v32, v52, v144
s_add_u32 m0, s39, 13312
s_add_u32 s37, s37, s38
buffer_load_dwordx4 v23, s[8:11], s37 offen sc1 lds
v_fma_f32 v145, -v32, v53, v145
v_fma_f32 v146, -v32, v54, v146
v_fma_f32 v147, -v32, v55, v147
s_add_u32 m0, s39, 14336
s_add_u32 s37, s37, s38
buffer_load_dwordx4 v22, s[8:11], s37 offen sc1 lds
v_fma_f32 v208, -v32, v68, v208
v_fma_f32 v209, -v32, v69, v209
v_fma_f32 v210, -v32, v70, v210
s_add_u32 m0, s39, 15360
s_add_u32 s37, s37, s38
buffer_load_dwordx4 v23, s[8:11], s37 offen sc1 lds
v_fma_f32 v211, -v32, v71, v211
v_mul_f32 v84, v144, v144
v_mul_f32 v85, v145, v145
s_waitcnt vmcnt(16)
s_barrier
s_add_u32 s42, s42, 1
s_xor_b32 s37, s42, s35
s_add_u32 m0, s39, 49152
s_mul_i32 s37, s37, s40
buffer_load_dwordx4 v22, s[8:11], s37 offen sc1 lds
v_mul_f32 v86, v146, v146
v_mul_f32 v87, v147, v147
v_fma_f32 v84, v84, v40, v36
v_fma_f32 v85, v85, v40, v36
v_fma_f32 v86, v86, v40, v36
s_add_u32 m0, s39, 50176
s_add_u32 s37, s37, s38
buffer_load_dwordx4 v23, s[8:11], s37 offen sc1 lds
v_fma_f32 v87, v87, v40, v36
v_mul_f32 v84, v84, v144
v_mul_f32 v85, v85, v145
v_mul_f32 v86, v86, v146
v_mul_f32 v87, v87, v147
s_add_u32 m0, s39, 51200
s_add_u32 s37, s37, s38
buffer_load_dwordx4 v22, s[8:11], s37 offen sc1 lds
v_exp_f32 v84, v84
v_exp_f32 v85, v85
v_exp_f32 v86, v86
v_exp_f32 v87, v87
s_add_u32 m0, s39, 52224
s_add_u32 s37, s37, s38
buffer_load_dwordx4 v23, s[8:11], s37 offen sc1 lds
v_mul_f32 v208, v144, v208
v_mul_f32 v209, v145, v209
v_mul_f32 v210, v146, v210
v_mul_f32 v211, v147, v211
v_fma_f32 v84, v84, v44, v44
s_add_u32 m0, s39, 53248
s_add_u32 s37, s37, s38
buffer_load_dwordx4 v22, s[8:11], s37 offen sc1 lds
v_fma_f32 v85, v85, v44, v44
v_fma_f32 v86, v86, v44, v44
v_fma_f32 v87, v87, v44, v44
v_rcp_f32 v84, v84
v_rcp_f32 v85, v85
s_add_u32 m0, s39, 54272
s_add_u32 s37, s37, s38
buffer_load_dwordx4 v23, s[8:11], s37 offen sc1 lds
v_rcp_f32 v86, v86
v_rcp_f32 v87, v87
v_mul_f32 v208, v208, v84
v_mul_f32 v209, v209, v85
s_add_u32 m0, s39, 55296
s_add_u32 s37, s37, s38
buffer_load_dwordx4 v22, s[8:11], s37 offen sc1 lds
v_mul_f32 v210, v210, v86
v_mul_f32 v211, v211, v87
v_cvt_pk_bf16_f32 v98, v208, v209
v_cvt_pk_bf16_f32 v99, v210, v211
s_add_u32 m0, s39, 56320
s_add_u32 s37, s37, s38
buffer_load_dwordx4 v23, s[8:11], s37 offen sc1 lds
v_fma_f32 v132, -v33, v48, v132
v_fma_f32 v133, -v33, v49, v133
v_fma_f32 v134, -v33, v50, v134
v_fma_f32 v135, -v33, v51, v135
s_add_u32 m0, s39, 57344
s_add_u32 s37, s37, s38
buffer_load_dwordx4 v22, s[8:11], s37 offen sc1 lds
v_fma_f32 v196, -v33, v64, v196
v_fma_f32 v197, -v33, v65, v197
v_fma_f32 v198, -v33, v66, v198
v_fma_f32 v199, -v33, v67, v199
v_mul_f32 v80, v132, v132
s_add_u32 m0, s39, 58368
s_add_u32 s37, s37, s38
buffer_load_dwordx4 v23, s[8:11], s37 offen sc1 lds
v_mul_f32 v81, v133, v133
v_mul_f32 v82, v134, v134
v_mul_f32 v83, v135, v135
v_fma_f32 v80, v80, v41, v37
v_fma_f32 v81, v81, v41, v37
s_add_u32 m0, s39, 59392
s_add_u32 s37, s37, s38
buffer_load_dwordx4 v22, s[8:11], s37 offen sc1 lds
v_fma_f32 v82, v82, v41, v37
v_fma_f32 v83, v83, v41, v37
v_mul_f32 v80, v80, v132
v_mul_f32 v81, v81, v133
s_add_u32 m0, s39, 60416
s_add_u32 s37, s37, s38
buffer_load_dwordx4 v23, s[8:11], s37 offen sc1 lds
v_mul_f32 v82, v82, v134
v_lshlrev_b32 v19, 11, v18
v_lshl_add_u32 v19, v17, 4, v19
s_lshl_b32 s43, s46, 10
v_add_u32 v2, s43, v19
s_add_u32 m0, s39, 61440
s_add_u32 s37, s37, s38
buffer_load_dwordx4 v22, s[8:11], s37 offen sc1 lds
v_add_u32 v3, 0x10000, v2
v_lshrrev_b32 v19, 2, v17
v_lshl_add_u32 v20, v18, 2, v19
v_bfe_u32 v21, v20, 1, 2
s_lshl_b32 s43, s47, 1
s_add_u32 m0, s39, 62464
s_add_u32 s37, s37, s38
buffer_load_dwordx4 v23, s[8:11], s37 offen sc1 lds
v_xor_b32 v21, s43, v21
v_lshlrev_b32 v20, 7, v20
v_lshl_add_u32 v20, v21, 5, v20
v_and_b32 v19, 3, v1
s_add_u32 m0, s39, 63488
s_add_u32 s37, s37, s38
buffer_load_dwordx4 v22, s[8:11], s37 offen sc1 lds
v_lshl_add_u32 v20, v19, 3, v20
v_add_u32 v5, 16384, v20
v_xor_b32 v6, 32, v5
v_add_u32 v7, 0x10000, v5
v_add_u32 v8, 0x10000, v6
s_add_u32 m0, s39, 64512
s_add_u32 s37, s37, s38
buffer_load_dwordx4 v23, s[8:11], s37 offen sc1 lds
s_lshl_b32 s43, s36, 12
v_lshl_add_u32 v9, v1, 4, s43
s_mov_b32 s54, 0x10000
s_movk_i32 s52, 0x1000
buffer_store_dwordx4 v[96:99], v27, s[24:27], 0 offen offset:0 sc1
s_waitcnt vmcnt(17)
s_barrier
s_add_u32 s42, s42, 1
s_xor_b32 s37, s42, s35
s_add_u32 m0, s39, 98304
s_mul_i32 s37, s37, s40
buffer_load_dwordx4 v22, s[8:11], s37 offen sc1 lds
v_mul_f32 v83, v83, v135
v_exp_f32 v80, v80
v_exp_f32 v81, v81
v_exp_f32 v82, v82
s_add_u32 m0, s39, 99328
s_add_u32 s37, s37, s38
buffer_load_dwordx4 v23, s[8:11], s37 offen sc1 lds
v_exp_f32 v83, v83
v_mul_f32 v196, v132, v196
v_mul_f32 v197, v133, v197
s_add_u32 m0, s39, 100352
s_add_u32 s37, s37, s38
buffer_load_dwordx4 v22, s[8:11], s37 offen sc1 lds
v_mul_f32 v198, v134, v198
v_mul_f32 v199, v135, v199
v_fma_f32 v80, v80, v45, v45
s_add_u32 m0, s39, 101376
s_add_u32 s37, s37, s38
buffer_load_dwordx4 v23, s[8:11], s37 offen sc1 lds
v_fma_f32 v81, v81, v45, v45
v_fma_f32 v82, v82, v45, v45
v_fma_f32 v83, v83, v45, v45
s_add_u32 m0, s39, 102400
s_add_u32 s37, s37, s38
buffer_load_dwordx4 v22, s[8:11], s37 offen sc1 lds
v_rcp_f32 v80, v80
v_rcp_f32 v81, v81
v_rcp_f32 v82, v82
v_rcp_f32 v83, v83
s_add_u32 m0, s39, 103424
s_add_u32 s37, s37, s38
buffer_load_dwordx4 v23, s[8:11], s37 offen sc1 lds
v_mul_f32 v196, v196, v80
v_mul_f32 v197, v197, v81
v_mul_f32 v198, v198, v82
s_add_u32 m0, s39, 104448
s_add_u32 s37, s37, s38
buffer_load_dwordx4 v22, s[8:11], s37 offen sc1 lds
v_mul_f32 v199, v199, v83
v_cvt_pk_bf16_f32 v100, v196, v197
v_cvt_pk_bf16_f32 v101, v198, v199
s_add_u32 m0, s39, 105472
s_add_u32 s37, s37, s38
buffer_load_dwordx4 v23, s[8:11], s37 offen sc1 lds
v_fma_f32 v148, -v33, v52, v148
v_fma_f32 v149, -v33, v53, v149
v_fma_f32 v150, -v33, v54, v150
s_add_u32 m0, s39, 106496
s_add_u32 s37, s37, s38
buffer_load_dwordx4 v22, s[8:11], s37 offen sc1 lds
v_fma_f32 v151, -v33, v55, v151
v_fma_f32 v212, -v33, v68, v212
v_fma_f32 v213, -v33, v69, v213
v_fma_f32 v214, -v33, v70, v214
s_add_u32 m0, s39, 107520
s_add_u32 s37, s37, s38
buffer_load_dwordx4 v23, s[8:11], s37 offen sc1 lds
v_fma_f32 v215, -v33, v71, v215
v_mul_f32 v84, v148, v148
v_mul_f32 v85, v149, v149
s_add_u32 m0, s39, 108544
s_add_u32 s37, s37, s38
buffer_load_dwordx4 v22, s[8:11], s37 offen sc1 lds
v_mul_f32 v86, v150, v150
v_mul_f32 v87, v151, v151
v_fma_f32 v84, v84, v41, v37
s_add_u32 m0, s39, 109568
s_add_u32 s37, s37, s38
buffer_load_dwordx4 v23, s[8:11], s37 offen sc1 lds
v_fma_f32 v85, v85, v41, v37
v_fma_f32 v86, v86, v41, v37
v_fma_f32 v87, v87, v41, v37
s_add_u32 m0, s39, 110592
s_add_u32 s37, s37, s38
buffer_load_dwordx4 v22, s[8:11], s37 offen sc1 lds
v_mul_f32 v84, v84, v148
v_mul_f32 v85, v85, v149
v_mul_f32 v86, v86, v150
v_mul_f32 v87, v87, v151
s_add_u32 m0, s39, 111616
s_add_u32 s37, s37, s38
buffer_load_dwordx4 v23, s[8:11], s37 offen sc1 lds
v_exp_f32 v84, v84
v_exp_f32 v85, v85
v_exp_f32 v86, v86
s_add_u32 m0, s39, 112640
s_add_u32 s37, s37, s38
buffer_load_dwordx4 v22, s[8:11], s37 offen sc1 lds
v_exp_f32 v87, v87
v_mul_f32 v212, v148, v212
v_mul_f32 v213, v149, v213
s_add_u32 m0, s39, 113664
s_add_u32 s37, s37, s38
buffer_load_dwordx4 v23, s[8:11], s37 offen sc1 lds
v_mul_f32 v214, v150, v214
v_mul_f32 v215, v151, v215
v_fma_f32 v84, v84, v45, v45
s_waitcnt vmcnt(17)
s_barrier
s_add_u32 s42, s42, 1
s_xor_b32 s37, s42, s35
s_add_u32 m0, s39, 0
s_mul_i32 s37, s37, s40
buffer_load_dwordx4 v22, s[8:11], s37 offen sc1 lds
v_fma_f32 v85, v85, v45, v45
v_fma_f32 v86, v86, v45, v45
v_fma_f32 v87, v87, v45, v45
v_rcp_f32 v84, v84
s_add_u32 m0, s39, 1024
s_add_u32 s37, s37, s38
buffer_load_dwordx4 v23, s[8:11], s37 offen sc1 lds
v_rcp_f32 v85, v85
v_rcp_f32 v86, v86
v_rcp_f32 v87, v87
s_add_u32 m0, s39, 2048
s_add_u32 s37, s37, s38
buffer_load_dwordx4 v22, s[8:11], s37 offen sc1 lds
v_mul_f32 v212, v212, v84
v_mul_f32 v213, v213, v85
v_mul_f32 v214, v214, v86
s_add_u32 m0, s39, 3072
s_add_u32 s37, s37, s38
buffer_load_dwordx4 v23, s[8:11], s37 offen sc1 lds
v_mul_f32 v215, v215, v87
v_cvt_pk_bf16_f32 v102, v212, v213
v_cvt_pk_bf16_f32 v103, v214, v215
s_add_u32 m0, s39, 4096
s_add_u32 s37, s37, s38
buffer_load_dwordx4 v22, s[8:11], s37 offen sc1 lds
v_fma_f32 v136, -v34, v48, v136
v_fma_f32 v137, -v34, v49, v137
v_fma_f32 v138, -v34, v50, v138
s_add_u32 m0, s39, 5120
s_add_u32 s37, s37, s38
buffer_load_dwordx4 v23, s[8:11], s37 offen sc1 lds
v_fma_f32 v139, -v34, v51, v139
v_fma_f32 v200, -v34, v64, v200
v_fma_f32 v201, -v34, v65, v201
s_add_u32 m0, s39, 6144
s_add_u32 s37, s37, s38
buffer_load_dwordx4 v22, s[8:11], s37 offen sc1 lds
v_fma_f32 v202, -v34, v66, v202
v_fma_f32 v203, -v34, v67, v203
v_mul_f32 v80, v136, v136
v_mul_f32 v81, v137, v137
s_add_u32 m0, s39, 7168
s_add_u32 s37, s37, s38
buffer_load_dwordx4 v23, s[8:11], s37 offen sc1 lds
v_mul_f32 v82, v138, v138
v_mul_f32 v83, v139, v139
v_fma_f32 v80, v80, v42, v38
s_add_u32 m0, s39, 8192
s_add_u32 s37, s37, s38
buffer_load_dwordx4 v22, s[8:11], s37 offen sc1 lds
v_fma_f32 v81, v81, v42, v38
v_fma_f32 v82, v82, v42, v38
v_fma_f32 v83, v83, v42, v38
s_add_u32 m0, s39, 9216
s_add_u32 s37, s37, s38
buffer_load_dwordx4 v23, s[8:11], s37 offen sc1 lds
v_mul_f32 v80, v80, v136
v_mul_f32 v81, v81, v137
v_mul_f32 v82, v82, v138
v_mul_f32 v83, v83, v139
s_add_u32 m0, s39, 10240
s_add_u32 s37, s37, s38
buffer_load_dwordx4 v22, s[8:11], s37 offen sc1 lds
v_exp_f32 v80, v80
v_exp_f32 v81, v81
v_exp_f32 v82, v82
s_add_u32 m0, s39, 11264
s_add_u32 s37, s37, s38
buffer_load_dwordx4 v23, s[8:11], s37 offen sc1 lds
v_exp_f32 v83, v83
v_mul_f32 v200, v136, v200
v_mul_f32 v201, v137, v201
s_add_u32 m0, s39, 12288
s_add_u32 s37, s37, s38
buffer_load_dwordx4 v22, s[8:11], s37 offen sc1 lds
v_mul_f32 v202, v138, v202
v_mul_f32 v203, v139, v203
v_fma_f32 v80, v80, v46, v46
v_fma_f32 v81, v81, v46, v46
s_add_u32 m0, s39, 13312
s_add_u32 s37, s37, s38
buffer_load_dwordx4 v23, s[8:11], s37 offen sc1 lds
v_fma_f32 v82, v82, v46, v46
v_fma_f32 v83, v83, v46, v46
v_rcp_f32 v80, v80
s_add_u32 m0, s39, 14336
s_add_u32 s37, s37, s38
buffer_load_dwordx4 v22, s[8:11], s37 offen sc1 lds
v_rcp_f32 v81, v81
v_rcp_f32 v82, v82
v_rcp_f32 v83, v83
s_add_u32 m0, s39, 15360
s_add_u32 s37, s37, s38
buffer_load_dwordx4 v23, s[8:11], s37 offen sc1 lds
v_mul_f32 v200, v200, v80
v_mul_f32 v201, v201, v81
v_mul_f32 v202, v202, v82
buffer_store_dwordx4 v[100:103], v27, s[24:27], 0 offen offset:256 sc1
s_waitcnt vmcnt(17)
s_barrier
s_add_u32 s42, s42, 1
s_xor_b32 s37, s42, s35
s_add_u32 m0, s39, 49152
s_mul_i32 s37, s37, s40
buffer_load_dwordx4 v22, s[8:11], s37 offen sc1 lds
v_mul_f32 v203, v203, v83
v_cvt_pk_bf16_f32 v104, v200, v201
v_cvt_pk_bf16_f32 v105, v202, v203
v_fma_f32 v152, -v34, v52, v152
s_add_u32 m0, s39, 50176
s_add_u32 s37, s37, s38
buffer_load_dwordx4 v23, s[8:11], s37 offen sc1 lds
v_fma_f32 v153, -v34, v53, v153
v_fma_f32 v154, -v34, v54, v154
v_fma_f32 v155, -v34, v55, v155
s_add_u32 m0, s39, 51200
s_add_u32 s37, s37, s38
buffer_load_dwordx4 v22, s[8:11], s37 offen sc1 lds
v_fma_f32 v216, -v34, v68, v216
v_fma_f32 v217, -v34, v69, v217
v_fma_f32 v218, -v34, v70, v218
s_add_u32 m0, s39, 52224
s_add_u32 s37, s37, s38
buffer_load_dwordx4 v23, s[8:11], s37 offen sc1 lds
v_fma_f32 v219, -v34, v71, v219
v_mul_f32 v84, v152, v152
v_mul_f32 v85, v153, v153
s_add_u32 m0, s39, 53248
s_add_u32 s37, s37, s38
buffer_load_dwordx4 v22, s[8:11], s37 offen sc1 lds
v_mul_f32 v86, v154, v154
v_mul_f32 v87, v155, v155
v_fma_f32 v84, v84, v42, v38
v_fma_f32 v85, v85, v42, v38
s_add_u32 m0, s39, 54272
s_add_u32 s37, s37, s38
buffer_load_dwordx4 v23, s[8:11], s37 offen sc1 lds
v_fma_f32 v86, v86, v42, v38
v_fma_f32 v87, v87, v42, v38
v_mul_f32 v84, v84, v152
s_add_u32 m0, s39, 55296
s_add_u32 s37, s37, s38
buffer_load_dwordx4 v22, s[8:11], s37 offen sc1 lds
v_mul_f32 v85, v85, v153
v_mul_f32 v86, v86, v154
v_mul_f32 v87, v87, v155
s_add_u32 m0, s39, 56320
s_add_u32 s37, s37, s38
buffer_load_dwordx4 v23, s[8:11], s37 offen sc1 lds
v_exp_f32 v84, v84
v_exp_f32 v85, v85
v_exp_f32 v86, v86
s_add_u32 m0, s39, 57344
s_add_u32 s37, s37, s38
buffer_load_dwordx4 v22, s[8:11], s37 offen sc1 lds
v_exp_f32 v87, v87
v_mul_f32 v216, v152, v216
v_mul_f32 v217, v153, v217
v_mul_f32 v218, v154, v218
s_add_u32 m0, s39, 58368
s_add_u32 s37, s37, s38
buffer_load_dwordx4 v23, s[8:11], s37 offen sc1 lds
v_mul_f32 v219, v155, v219
v_fma_f32 v84, v84, v46, v46
v_fma_f32 v85, v85, v46, v46
s_add_u32 m0, s39, 59392
s_add_u32 s37, s37, s38
buffer_load_dwordx4 v22, s[8:11], s37 offen sc1 lds
v_fma_f32 v86, v86, v46, v46
v_fma_f32 v87, v87, v46, v46
v_rcp_f32 v84, v84
s_add_u32 m0, s39, 60416
s_add_u32 s37, s37, s38
buffer_load_dwordx4 v23, s[8:11], s37 offen sc1 lds
v_rcp_f32 v85, v85
v_rcp_f32 v86, v86
v_rcp_f32 v87, v87
s_add_u32 m0, s39, 61440
s_add_u32 s37, s37, s38
buffer_load_dwordx4 v22, s[8:11], s37 offen sc1 lds
v_mul_f32 v216, v216, v84
v_mul_f32 v217, v217, v85
v_mul_f32 v218, v218, v86
v_mul_f32 v219, v219, v87
s_add_u32 m0, s39, 62464
s_add_u32 s37, s37, s38
buffer_load_dwordx4 v23, s[8:11], s37 offen sc1 lds
v_cvt_pk_bf16_f32 v106, v216, v217
v_cvt_pk_bf16_f32 v107, v218, v219
s_add_u32 m0, s39, 63488
s_add_u32 s37, s37, s38
buffer_load_dwordx4 v22, s[8:11], s37 offen sc1 lds
v_fma_f32 v140, -v35, v48, v140
v_fma_f32 v141, -v35, v49, v141
v_fma_f32 v142, -v35, v50, v142
s_add_u32 m0, s39, 64512
s_add_u32 s37, s37, s38
buffer_load_dwordx4 v23, s[8:11], s37 offen sc1 lds
v_fma_f32 v143, -v35, v51, v143
v_fma_f32 v204, -v35, v64, v204
v_fma_f32 v205, -v35, v65, v205
buffer_store_dwordx4 v[104:107], v27, s[24:27], 0 offen offset:512 sc1
s_waitcnt vmcnt(18)
s_barrier
s_add_u32 s42, s42, 1
s_xor_b32 s37, s42, s35
s_add_u32 m0, s39, 98304
s_mul_i32 s37, s37, s40
buffer_load_dwordx4 v22, s[8:11], s37 offen sc1 lds
v_fma_f32 v206, -v35, v66, v206
v_fma_f32 v207, -v35, v67, v207
v_mul_f32 v80, v140, v140
v_mul_f32 v81, v141, v141
s_add_u32 m0, s39, 99328
s_add_u32 s37, s37, s38
buffer_load_dwordx4 v23, s[8:11], s37 offen sc1 lds
v_mul_f32 v82, v142, v142
v_mul_f32 v83, v143, v143
v_fma_f32 v80, v80, v43, v39
s_add_u32 m0, s39, 100352
s_add_u32 s37, s37, s38
buffer_load_dwordx4 v22, s[8:11], s37 offen sc1 lds
v_fma_f32 v81, v81, v43, v39
v_fma_f32 v82, v82, v43, v39
v_fma_f32 v83, v83, v43, v39
s_add_u32 m0, s39, 101376
s_add_u32 s37, s37, s38
buffer_load_dwordx4 v23, s[8:11], s37 offen sc1 lds
v_mul_f32 v80, v80, v140
v_mul_f32 v81, v81, v141
v_mul_f32 v82, v82, v142
s_add_u32 m0, s39, 102400
s_add_u32 s37, s37, s38
buffer_load_dwordx4 v22, s[8:11], s37 offen sc1 lds
v_mul_f32 v83, v83, v143
v_exp_f32 v80, v80
v_exp_f32 v81, v81
v_exp_f32 v82, v82
s_add_u32 m0, s39, 103424
s_add_u32 s37, s37, s38
buffer_load_dwordx4 v23, s[8:11], s37 offen sc1 lds
v_exp_f32 v83, v83
v_mul_f32 v204, v140, v204
v_mul_f32 v205, v141, v205
s_add_u32 m0, s39, 104448
s_add_u32 s37, s37, s38
buffer_load_dwordx4 v22, s[8:11], s37 offen sc1 lds
v_mul_f32 v206, v142, v206
v_mul_f32 v207, v143, v207
v_fma_f32 v80, v80, v47, v47
s_add_u32 m0, s39, 105472
s_add_u32 s37, s37, s38
buffer_load_dwordx4 v23, s[8:11], s37 offen sc1 lds
v_fma_f32 v81, v81, v47, v47
v_fma_f32 v82, v82, v47, v47
v_fma_f32 v83, v83, v47, v47
s_add_u32 m0, s39, 106496
s_add_u32 s37, s37, s38
buffer_load_dwordx4 v22, s[8:11], s37 offen sc1 lds
v_rcp_f32 v80, v80
v_rcp_f32 v81, v81
v_rcp_f32 v82, v82
v_rcp_f32 v83, v83
s_add_u32 m0, s39, 107520
s_add_u32 s37, s37, s38
buffer_load_dwordx4 v23, s[8:11], s37 offen sc1 lds
v_mul_f32 v204, v204, v80
v_mul_f32 v205, v205, v81
v_mul_f32 v206, v206, v82
s_add_u32 m0, s39, 108544
s_add_u32 s37, s37, s38
buffer_load_dwordx4 v22, s[8:11], s37 offen sc1 lds
v_mul_f32 v207, v207, v83
v_cvt_pk_bf16_f32 v108, v204, v205
v_cvt_pk_bf16_f32 v109, v206, v207
s_add_u32 m0, s39, 109568
s_add_u32 s37, s37, s38
buffer_load_dwordx4 v23, s[8:11], s37 offen sc1 lds
v_fma_f32 v156, -v35, v52, v156
v_fma_f32 v157, -v35, v53, v157
v_fma_f32 v158, -v35, v54, v158
s_add_u32 m0, s39, 110592
s_add_u32 s37, s37, s38
buffer_load_dwordx4 v22, s[8:11], s37 offen sc1 lds
v_fma_f32 v159, -v35, v55, v159
v_fma_f32 v220, -v35, v68, v220
v_fma_f32 v221, -v35, v69, v221
v_fma_f32 v222, -v35, v70, v222
s_add_u32 m0, s39, 111616
s_add_u32 s37, s37, s38
buffer_load_dwordx4 v23, s[8:11], s37 offen sc1 lds
v_fma_f32 v223, -v35, v71, v223
v_mul_f32 v84, v156, v156
v_mul_f32 v85, v157, v157
s_add_u32 m0, s39, 112640
s_add_u32 s37, s37, s38
buffer_load_dwordx4 v22, s[8:11], s37 offen sc1 lds
v_mul_f32 v86, v158, v158
v_mul_f32 v87, v159, v159
v_fma_f32 v84, v84, v43, v39
s_add_u32 m0, s39, 113664
s_add_u32 s37, s37, s38
buffer_load_dwordx4 v23, s[8:11], s37 offen sc1 lds
v_fma_f32 v85, v85, v43, v39
v_fma_f32 v86, v86, v43, v39
v_fma_f32 v87, v87, v43, v39
s_waitcnt vmcnt(17)
s_barrier
s_add_u32 s42, s42, 1
s_xor_b32 s37, s42, s35
s_add_u32 m0, s39, 0
s_mul_i32 s37, s37, s40
buffer_load_dwordx4 v22, s[8:11], s37 offen sc1 lds
v_mul_f32 v84, v84, v156
v_mul_f32 v85, v85, v157
v_mul_f32 v86, v86, v158
v_mul_f32 v87, v87, v159
s_add_u32 m0, s39, 1024
s_add_u32 s37, s37, s38
buffer_load_dwordx4 v23, s[8:11], s37 offen sc1 lds
v_exp_f32 v84, v84
v_exp_f32 v85, v85
v_exp_f32 v86, v86
s_add_u32 m0, s39, 2048
s_add_u32 s37, s37, s38
buffer_load_dwordx4 v22, s[8:11], s37 offen sc1 lds
v_exp_f32 v87, v87
v_mul_f32 v220, v156, v220
v_mul_f32 v221, v157, v221
s_add_u32 m0, s39, 3072
s_add_u32 s37, s37, s38
buffer_load_dwordx4 v23, s[8:11], s37 offen sc1 lds
v_mul_f32 v222, v158, v222
v_mul_f32 v223, v159, v223
v_fma_f32 v84, v84, v47, v47
v_fma_f32 v85, v85, v47, v47
s_add_u32 m0, s39, 4096
s_add_u32 s37, s37, s38
buffer_load_dwordx4 v22, s[8:11], s37 offen sc1 lds
v_fma_f32 v86, v86, v47, v47
v_fma_f32 v87, v87, v47, v47
v_rcp_f32 v84, v84
s_add_u32 m0, s39, 5120
s_add_u32 s37, s37, s38
buffer_load_dwordx4 v23, s[8:11], s37 offen sc1 lds
v_rcp_f32 v85, v85
v_rcp_f32 v86, v86
v_rcp_f32 v87, v87
s_add_u32 m0, s39, 6144
s_add_u32 s37, s37, s38
buffer_load_dwordx4 v22, s[8:11], s37 offen sc1 lds
v_mul_f32 v220, v220, v84
v_mul_f32 v221, v221, v85
v_mul_f32 v222, v222, v86
v_mul_f32 v223, v223, v87
s_add_u32 m0, s39, 7168
s_add_u32 s37, s37, s38
buffer_load_dwordx4 v23, s[8:11], s37 offen sc1 lds
v_cvt_pk_bf16_f32 v110, v220, v221
v_cvt_pk_bf16_f32 v111, v222, v223
s_add_u32 m0, s39, 8192
s_add_u32 s37, s37, s38
buffer_load_dwordx4 v22, s[8:11], s37 offen sc1 lds
v_fma_f32 v160, -v32, v56, v160
v_fma_f32 v161, -v32, v57, v161
v_fma_f32 v162, -v32, v58, v162
s_add_u32 m0, s39, 9216
s_add_u32 s37, s37, s38
buffer_load_dwordx4 v23, s[8:11], s37 offen sc1 lds
v_fma_f32 v163, -v32, v59, v163
v_fma_f32 v224, -v32, v72, v224
v_fma_f32 v225, -v32, v73, v225
v_fma_f32 v226, -v32, v74, v226
s_add_u32 m0, s39, 10240
s_add_u32 s37, s37, s38
buffer_load_dwordx4 v22, s[8:11], s37 offen sc1 lds
v_fma_f32 v227, -v32, v75, v227
v_mul_f32 v80, v160, v160
v_mul_f32 v81, v161, v161
s_add_u32 m0, s39, 11264
s_add_u32 s37, s37, s38
buffer_load_dwordx4 v23, s[8:11], s37 offen sc1 lds
v_mul_f32 v82, v162, v162
v_mul_f32 v83, v163, v163
v_fma_f32 v80, v80, v40, v36
s_add_u32 m0, s39, 12288
s_add_u32 s37, s37, s38
buffer_load_dwordx4 v22, s[8:11], s37 offen sc1 lds
v_fma_f32 v81, v81, v40, v36
v_fma_f32 v82, v82, v40, v36
v_fma_f32 v83, v83, v40, v36
v_mul_f32 v80, v80, v160
s_add_u32 m0, s39, 13312
s_add_u32 s37, s37, s38
buffer_load_dwordx4 v23, s[8:11], s37 offen sc1 lds
v_mul_f32 v81, v81, v161
v_mul_f32 v82, v82, v162
v_mul_f32 v83, v83, v163
s_add_u32 m0, s39, 14336
s_add_u32 s37, s37, s38
buffer_load_dwordx4 v22, s[8:11], s37 offen sc1 lds
v_exp_f32 v80, v80
v_exp_f32 v81, v81
v_exp_f32 v82, v82
s_add_u32 m0, s39, 15360
s_add_u32 s37, s37, s38
buffer_load_dwordx4 v23, s[8:11], s37 offen sc1 lds
v_exp_f32 v83, v83
v_mul_f32 v224, v160, v224
v_mul_f32 v225, v161, v225
buffer_store_dwordx4 v[108:111], v27, s[24:27], 0 offen offset:768 sc1
s_waitcnt vmcnt(17)
s_barrier
s_add_u32 s42, s42, 1
s_xor_b32 s37, s42, s35
s_add_u32 m0, s39, 49152
s_mul_i32 s37, s37, s40
buffer_load_dwordx4 v22, s[8:11], s37 offen sc1 lds
v_mul_f32 v226, v162, v226
v_mul_f32 v227, v163, v227
v_fma_f32 v80, v80, v44, v44
v_fma_f32 v81, v81, v44, v44
s_add_u32 m0, s39, 50176
s_add_u32 s37, s37, s38
buffer_load_dwordx4 v23, s[8:11], s37 offen sc1 lds
v_fma_f32 v82, v82, v44, v44
v_fma_f32 v83, v83, v44, v44
v_rcp_f32 v80, v80
v_rcp_f32 v81, v81
s_add_u32 m0, s39, 51200
s_add_u32 s37, s37, s38
buffer_load_dwordx4 v22, s[8:11], s37 offen sc1 lds
v_rcp_f32 v82, v82
v_rcp_f32 v83, v83
v_mul_f32 v224, v224, v80
v_mul_f32 v225, v225, v81
s_add_u32 m0, s39, 52224
s_add_u32 s37, s37, s38
buffer_load_dwordx4 v23, s[8:11], s37 offen sc1 lds
v_mul_f32 v226, v226, v82
v_mul_f32 v227, v227, v83
v_cvt_pk_bf16_f32 v96, v224, v225
v_cvt_pk_bf16_f32 v97, v226, v227
s_add_u32 m0, s39, 53248
s_add_u32 s37, s37, s38
buffer_load_dwordx4 v22, s[8:11], s37 offen sc1 lds
v_fma_f32 v176, -v32, v60, v176
v_fma_f32 v177, -v32, v61, v177
v_fma_f32 v178, -v32, v62, v178
v_fma_f32 v179, -v32, v63, v179
s_add_u32 m0, s39, 54272
s_add_u32 s37, s37, s38
buffer_load_dwordx4 v23, s[8:11], s37 offen sc1 lds
v_fma_f32 v240, -v32, v76, v240
v_fma_f32 v241, -v32, v77, v241
v_fma_f32 v242, -v32, v78, v242
v_fma_f32 v243, -v32, v79, v243
s_add_u32 m0, s39, 55296
s_add_u32 s37, s37, s38
buffer_load_dwordx4 v22, s[8:11], s37 offen sc1 lds
v_mul_f32 v84, v176, v176
v_mul_f32 v85, v177, v177
v_mul_f32 v86, v178, v178
v_mul_f32 v87, v179, v179
s_add_u32 m0, s39, 56320
s_add_u32 s37, s37, s38
buffer_load_dwordx4 v23, s[8:11], s37 offen sc1 lds
v_fma_f32 v84, v84, v40, v36
v_fma_f32 v85, v85, v40, v36
v_fma_f32 v86, v86, v40, v36
s_add_u32 m0, s39, 57344
s_add_u32 s37, s37, s38
buffer_load_dwordx4 v22, s[8:11], s37 offen sc1 lds
v_fma_f32 v87, v87, v40, v36
v_mul_f32 v84, v84, v176
v_mul_f32 v85, v85, v177
v_mul_f32 v86, v86, v178
s_add_u32 m0, s39, 58368
s_add_u32 s37, s37, s38
buffer_load_dwordx4 v23, s[8:11], s37 offen sc1 lds
v_mul_f32 v87, v87, v179
v_exp_f32 v84, v84
v_exp_f32 v85, v85
v_exp_f32 v86, v86
s_add_u32 m0, s39, 59392
s_add_u32 s37, s37, s38
buffer_load_dwordx4 v22, s[8:11], s37 offen sc1 lds
v_exp_f32 v87, v87
v_mul_f32 v240, v176, v240
v_mul_f32 v241, v177, v241
v_mul_f32 v242, v178, v242
s_add_u32 m0, s39, 60416
s_add_u32 s37, s37, s38
buffer_load_dwordx4 v23, s[8:11], s37 offen sc1 lds
v_mul_f32 v243, v179, v243
v_fma_f32 v84, v84, v44, v44
v_fma_f32 v85, v85, v44, v44
v_fma_f32 v86, v86, v44, v44
s_add_u32 m0, s39, 61440
s_add_u32 s37, s37, s38
buffer_load_dwordx4 v22, s[8:11], s37 offen sc1 lds
v_fma_f32 v87, v87, v44, v44
v_rcp_f32 v84, v84
v_rcp_f32 v85, v85
v_rcp_f32 v86, v86
s_add_u32 m0, s39, 62464
s_add_u32 s37, s37, s38
buffer_load_dwordx4 v23, s[8:11], s37 offen sc1 lds
v_rcp_f32 v87, v87
v_lshlrev_b32 v19, 11, v18
v_lshl_add_u32 v19, v17, 4, v19
s_lshl_b32 s43, s46, 10
s_add_u32 m0, s39, 63488
s_add_u32 s37, s37, s38
buffer_load_dwordx4 v22, s[8:11], s37 offen sc1 lds
s_lshl_b32 s44, s47, 13
v_add3_u32 v208, v19, s43, 0
v_add_u32 v208, s44, v208
buffer_load_dwordx4 v[192:195], v208, s[20:23], 0 offen offset:0 sc1
s_add_u32 m0, s39, 64512
s_add_u32 s37, s37, s38
buffer_load_dwordx4 v23, s[8:11], s37 offen sc1 lds
buffer_load_dwordx4 v[196:199], v208, s[20:23], 0 offen offset:256 sc1
buffer_load_dwordx4 v[200:203], v208, s[20:23], 0 offen offset:512 sc1
buffer_load_dwordx4 v[204:207], v208, s[20:23], 0 offen offset:768 sc1
s_waitcnt vmcnt(20)
s_barrier
s_add_u32 s42, s42, 1
s_xor_b32 s37, s42, s35
s_add_u32 m0, s39, 98304
s_mul_i32 s37, s37, s40
buffer_load_dwordx4 v22, s[8:11], s37 offen sc1 lds
v_mul_f32 v240, v240, v84
v_mul_f32 v241, v241, v85
v_mul_f32 v242, v242, v86
v_mul_f32 v243, v243, v87
s_add_u32 m0, s39, 99328
s_add_u32 s37, s37, s38
buffer_load_dwordx4 v23, s[8:11], s37 offen sc1 lds
v_cvt_pk_bf16_f32 v98, v240, v241
v_cvt_pk_bf16_f32 v99, v242, v243
s_add_u32 m0, s39, 100352
s_add_u32 s37, s37, s38
buffer_load_dwordx4 v22, s[8:11], s37 offen sc1 lds
v_fma_f32 v164, -v33, v56, v164
v_fma_f32 v165, -v33, v57, v165
v_fma_f32 v166, -v33, v58, v166
s_add_u32 m0, s39, 101376
s_add_u32 s37, s37, s38
buffer_load_dwordx4 v23, s[8:11], s37 offen sc1 lds
v_fma_f32 v167, -v33, v59, v167
v_fma_f32 v228, -v33, v72, v228
v_fma_f32 v229, -v33, v73, v229
s_add_u32 m0, s39, 102400
s_add_u32 s37, s37, s38
buffer_load_dwordx4 v22, s[8:11], s37 offen sc1 lds
v_fma_f32 v230, -v33, v74, v230
v_fma_f32 v231, -v33, v75, v231
v_mul_f32 v80, v164, v164
v_mul_f32 v81, v165, v165
s_add_u32 m0, s39, 103424
s_add_u32 s37, s37, s38
buffer_load_dwordx4 v23, s[8:11], s37 offen sc1 lds
v_mul_f32 v82, v166, v166
v_mul_f32 v83, v167, v167
v_fma_f32 v80, v80, v41, v37
s_add_u32 m0, s39, 104448
s_add_u32 s37, s37, s38
buffer_load_dwordx4 v22, s[8:11], s37 offen sc1 lds
v_fma_f32 v81, v81, v41, v37
v_fma_f32 v82, v82, v41, v37
v_fma_f32 v83, v83, v41, v37
s_add_u32 m0, s39, 105472
s_add_u32 s37, s37, s38
buffer_load_dwordx4 v23, s[8:11], s37 offen sc1 lds
v_mul_f32 v80, v80, v164
v_mul_f32 v81, v81, v165
v_mul_f32 v82, v82, v166
s_add_u32 m0, s39, 106496
s_add_u32 s37, s37, s38
buffer_load_dwordx4 v22, s[8:11], s37 offen sc1 lds
v_mul_f32 v83, v83, v167
v_exp_f32 v80, v80
v_exp_f32 v81, v81
v_exp_f32 v82, v82
s_add_u32 m0, s39, 107520
s_add_u32 s37, s37, s38
buffer_load_dwordx4 v23, s[8:11], s37 offen sc1 lds
v_exp_f32 v83, v83
v_mul_f32 v228, v164, v228
v_mul_f32 v229, v165, v229
s_add_u32 m0, s39, 108544
s_add_u32 s37, s37, s38
buffer_load_dwordx4 v22, s[8:11], s37 offen sc1 lds
v_mul_f32 v230, v166, v230
v_mul_f32 v231, v167, v231
v_fma_f32 v80, v80, v45, v45
s_add_u32 m0, s39, 109568
s_add_u32 s37, s37, s38
buffer_load_dwordx4 v23, s[8:11], s37 offen sc1 lds
v_fma_f32 v81, v81, v45, v45
v_fma_f32 v82, v82, v45, v45
v_fma_f32 v83, v83, v45, v45
s_add_u32 m0, s39, 110592
s_add_u32 s37, s37, s38
buffer_load_dwordx4 v22, s[8:11], s37 offen sc1 lds
v_rcp_f32 v80, v80
v_rcp_f32 v81, v81
v_rcp_f32 v82, v82
v_rcp_f32 v83, v83
s_add_u32 m0, s39, 111616
s_add_u32 s37, s37, s38
buffer_load_dwordx4 v23, s[8:11], s37 offen sc1 lds
v_mul_f32 v228, v228, v80
v_mul_f32 v229, v229, v81
v_mul_f32 v230, v230, v82
s_add_u32 m0, s39, 112640
s_add_u32 s37, s37, s38
buffer_load_dwordx4 v22, s[8:11], s37 offen sc1 lds
v_mul_f32 v231, v231, v83
v_cvt_pk_bf16_f32 v100, v228, v229
v_cvt_pk_bf16_f32 v101, v230, v231
s_add_u32 m0, s39, 113664
s_add_u32 s37, s37, s38
buffer_load_dwordx4 v23, s[8:11], s37 offen sc1 lds
v_fma_f32 v180, -v33, v60, v180
v_fma_f32 v181, -v33, v61, v181
v_fma_f32 v182, -v33, v62, v182
buffer_store_dwordx4 v[96:99], v27, s[24:27], s53 offen offset:0 sc1
s_waitcnt vmcnt(20)
s_barrier
s_add_u32 s42, s42, 1
s_xor_b32 s37, s42, s35
s_add_u32 m0, s39, 0
s_mul_i32 s37, s37, s40
buffer_load_dwordx4 v22, s[8:11], s37 offen sc1 lds
v_fma_f32 v183, -v33, v63, v183
v_fma_f32 v244, -v33, v76, v244
v_fma_f32 v245, -v33, v77, v245
v_fma_f32 v246, -v33, v78, v246
s_add_u32 m0, s39, 1024
s_add_u32 s37, s37, s38
buffer_load_dwordx4 v23, s[8:11], s37 offen sc1 lds
v_fma_f32 v247, -v33, v79, v247
v_mul_f32 v84, v180, v180
v_mul_f32 v85, v181, v181
s_add_u32 m0, s39, 2048
s_add_u32 s37, s37, s38
buffer_load_dwordx4 v22, s[8:11], s37 offen sc1 lds
v_mul_f32 v86, v182, v182
v_mul_f32 v87, v183, v183
v_fma_f32 v84, v84, v41, v37
s_add_u32 m0, s39, 3072
s_add_u32 s37, s37, s38
buffer_load_dwordx4 v23, s[8:11], s37 offen sc1 lds
v_fma_f32 v85, v85, v41, v37
v_fma_f32 v86, v86, v41, v37
v_fma_f32 v87, v87, v41, v37
v_mul_f32 v84, v84, v180
s_add_u32 m0, s39, 4096
s_add_u32 s37, s37, s38
buffer_load_dwordx4 v22, s[8:11], s37 offen sc1 lds
v_mul_f32 v85, v85, v181
v_mul_f32 v86, v86, v182
v_mul_f32 v87, v87, v183
s_add_u32 m0, s39, 5120
s_add_u32 s37, s37, s38
buffer_load_dwordx4 v23, s[8:11], s37 offen sc1 lds
v_exp_f32 v84, v84
v_exp_f32 v85, v85
v_exp_f32 v86, v86
s_add_u32 m0, s39, 6144
s_add_u32 s37, s37, s38
buffer_load_dwordx4 v22, s[8:11], s37 offen sc1 lds
v_exp_f32 v87, v87
v_mul_f32 v244, v180, v244
v_mul_f32 v245, v181, v245
v_mul_f32 v246, v182, v246
s_add_u32 m0, s39, 7168
s_add_u32 s37, s37, s38
buffer_load_dwordx4 v23, s[8:11], s37 offen sc1 lds
v_mul_f32 v247, v183, v247
v_fma_f32 v84, v84, v45, v45
v_fma_f32 v85, v85, v45, v45
s_add_u32 m0, s39, 8192
s_add_u32 s37, s37, s38
buffer_load_dwordx4 v22, s[8:11], s37 offen sc1 lds
v_fma_f32 v86, v86, v45, v45
v_fma_f32 v87, v87, v45, v45
v_rcp_f32 v84, v84
s_add_u32 m0, s39, 9216
s_add_u32 s37, s37, s38
buffer_load_dwordx4 v23, s[8:11], s37 offen sc1 lds
v_rcp_f32 v85, v85
v_rcp_f32 v86, v86
v_rcp_f32 v87, v87
v_mul_f32 v244, v244, v84
s_add_u32 m0, s39, 10240
s_add_u32 s37, s37, s38
buffer_load_dwordx4 v22, s[8:11], s37 offen sc1 lds
v_mul_f32 v245, v245, v85
v_mul_f32 v246, v246, v86
v_mul_f32 v247, v247, v87
s_add_u32 m0, s39, 11264
s_add_u32 s37, s37, s38
buffer_load_dwordx4 v23, s[8:11], s37 offen sc1 lds
v_cvt_pk_bf16_f32 v102, v244, v245
v_cvt_pk_bf16_f32 v103, v246, v247
s_add_u32 m0, s39, 12288
s_add_u32 s37, s37, s38
buffer_load_dwordx4 v22, s[8:11], s37 offen sc1 lds
v_fma_f32 v168, -v34, v56, v168
v_fma_f32 v169, -v34, v57, v169
v_fma_f32 v170, -v34, v58, v170
v_fma_f32 v171, -v34, v59, v171
s_add_u32 m0, s39, 13312
s_add_u32 s37, s37, s38
buffer_load_dwordx4 v23, s[8:11], s37 offen sc1 lds
v_fma_f32 v232, -v34, v72, v232
v_fma_f32 v233, -v34, v73, v233
v_fma_f32 v234, -v34, v74, v234
s_add_u32 m0, s39, 14336
s_add_u32 s37, s37, s38
buffer_load_dwordx4 v22, s[8:11], s37 offen sc1 lds
v_fma_f32 v235, -v34, v75, v235
v_mul_f32 v80, v168, v168
v_mul_f32 v81, v169, v169
s_add_u32 m0, s39, 15360
s_add_u32 s37, s37, s38
buffer_load_dwordx4 v23, s[8:11], s37 offen sc1 lds
v_mul_f32 v82, v170, v170
v_mul_f32 v83, v171, v171
v_fma_f32 v80, v80, v42, v38
buffer_store_dwordx4 v[100:103], v27, s[24:27], s53 offen offset:256 sc1
s_waitcnt vmcnt(18)
s_barrier
s_add_u32 s42, s42, 1
s_xor_b32 s37, s42, s35
s_add_u32 m0, s39, 49152
s_mul_i32 s37, s37, s40
buffer_load_dwordx4 v22, s[8:11], s37 offen sc1 lds
v_fma_f32 v81, v81, v42, v38
v_fma_f32 v82, v82, v42, v38
v_fma_f32 v83, v83, v42, v38
v_mul_f32 v80, v80, v168
s_add_u32 m0, s39, 50176
s_add_u32 s37, s37, s38
buffer_load_dwordx4 v23, s[8:11], s37 offen sc1 lds
v_mul_f32 v81, v81, v169
v_mul_f32 v82, v82, v170
v_mul_f32 v83, v83, v171
s_add_u32 m0, s39, 51200
s_add_u32 s37, s37, s38
buffer_load_dwordx4 v22, s[8:11], s37 offen sc1 lds
v_exp_f32 v80, v80
v_exp_f32 v81, v81
v_exp_f32 v82, v82
s_add_u32 m0, s39, 52224
s_add_u32 s37, s37, s38
buffer_load_dwordx4 v23, s[8:11], s37 offen sc1 lds
v_exp_f32 v83, v83
v_mul_f32 v232, v168, v232
v_mul_f32 v233, v169, v233
s_add_u32 m0, s39, 53248
s_add_u32 s37, s37, s38
buffer_load_dwordx4 v22, s[8:11], s37 offen sc1 lds
v_mul_f32 v234, v170, v234
v_mul_f32 v235, v171, v235
v_fma_f32 v80, v80, v46, v46
v_fma_f32 v81, v81, v46, v46
s_add_u32 m0, s39, 54272
s_add_u32 s37, s37, s38
buffer_load_dwordx4 v23, s[8:11], s37 offen sc1 lds
v_fma_f32 v82, v82, v46, v46
v_fma_f32 v83, v83, v46, v46
v_rcp_f32 v80, v80
s_add_u32 m0, s39, 55296
s_add_u32 s37, s37, s38
buffer_load_dwordx4 v22, s[8:11], s37 offen sc1 lds
v_rcp_f32 v81, v81
v_rcp_f32 v82, v82
v_rcp_f32 v83, v83
s_add_u32 m0, s39, 56320
s_add_u32 s37, s37, s38
buffer_load_dwordx4 v23, s[8:11], s37 offen sc1 lds
v_mul_f32 v232, v232, v80
v_mul_f32 v233, v233, v81
v_mul_f32 v234, v234, v82
s_add_u32 m0, s39, 57344
s_add_u32 s37, s37, s38
buffer_load_dwordx4 v22, s[8:11], s37 offen sc1 lds
v_mul_f32 v235, v235, v83
v_cvt_pk_bf16_f32 v104, v232, v233
v_cvt_pk_bf16_f32 v105, v234, v235
v_fma_f32 v184, -v34, v60, v184
s_add_u32 m0, s39, 58368
s_add_u32 s37, s37, s38
buffer_load_dwordx4 v23, s[8:11], s37 offen sc1 lds
v_fma_f32 v185, -v34, v61, v185
v_fma_f32 v186, -v34, v62, v186
v_fma_f32 v187, -v34, v63, v187
s_add_u32 m0, s39, 59392
s_add_u32 s37, s37, s38
buffer_load_dwordx4 v22, s[8:11], s37 offen sc1 lds
v_fma_f32 v248, -v34, v76, v248
v_fma_f32 v249, -v34, v77, v249
v_fma_f32 v250, -v34, v78, v250
s_add_u32 m0, s39, 60416
s_add_u32 s37, s37, s38
buffer_load_dwordx4 v23, s[8:11], s37 offen sc1 lds
v_fma_f32 v251, -v34, v79, v251
v_mul_f32 v84, v184, v184
v_mul_f32 v85, v185, v185
s_add_u32 m0, s39, 61440
s_add_u32 s37, s37, s38
buffer_load_dwordx4 v22, s[8:11], s37 offen sc1 lds
v_mul_f32 v86, v186, v186
v_mul_f32 v87, v187, v187
v_fma_f32 v84, v84, v42, v38
v_fma_f32 v85, v85, v42, v38
s_add_u32 m0, s39, 62464
s_add_u32 s37, s37, s38
buffer_load_dwordx4 v23, s[8:11], s37 offen sc1 lds
v_fma_f32 v86, v86, v42, v38
v_fma_f32 v87, v87, v42, v38
v_mul_f32 v84, v84, v184
s_add_u32 m0, s39, 63488
s_add_u32 s37, s37, s38
buffer_load_dwordx4 v22, s[8:11], s37 offen sc1 lds
v_mul_f32 v85, v85, v185
v_mul_f32 v86, v86, v186
v_mul_f32 v87, v87, v187
s_add_u32 m0, s39, 64512
s_add_u32 s37, s37, s38
buffer_load_dwordx4 v23, s[8:11], s37 offen sc1 lds
v_exp_f32 v84, v84
v_exp_f32 v85, v85
v_exp_f32 v86, v86
s_waitcnt vmcnt(17)
s_barrier
s_add_u32 s42, s42, 1
s_xor_b32 s37, s42, s35
s_add_u32 m0, s39, 98304
s_mul_i32 s37, s37, s40
buffer_load_dwordx4 v22, s[8:11], s37 offen sc1 lds
v_exp_f32 v87, v87
v_mul_f32 v248, v184, v248
v_mul_f32 v249, v185, v249
v_mul_f32 v250, v186, v250
s_add_u32 m0, s39, 99328
s_add_u32 s37, s37, s38
buffer_load_dwordx4 v23, s[8:11], s37 offen sc1 lds
v_mul_f32 v251, v187, v251
v_fma_f32 v84, v84, v46, v46
v_fma_f32 v85, v85, v46, v46
s_add_u32 m0, s39, 100352
s_add_u32 s37, s37, s38
buffer_load_dwordx4 v22, s[8:11], s37 offen sc1 lds
v_fma_f32 v86, v86, v46, v46
v_fma_f32 v87, v87, v46, v46
v_rcp_f32 v84, v84
s_add_u32 m0, s39, 101376
s_add_u32 s37, s37, s38
buffer_load_dwordx4 v23, s[8:11], s37 offen sc1 lds
v_rcp_f32 v85, v85
v_rcp_f32 v86, v86
v_rcp_f32 v87, v87
s_add_u32 m0, s39, 102400
s_add_u32 s37, s37, s38
buffer_load_dwordx4 v22, s[8:11], s37 offen sc1 lds
v_mul_f32 v248, v248, v84
v_mul_f32 v249, v249, v85
v_mul_f32 v250, v250, v86
v_mul_f32 v251, v251, v87
s_add_u32 m0, s39, 103424
s_add_u32 s37, s37, s38
buffer_load_dwordx4 v23, s[8:11], s37 offen sc1 lds
v_cvt_pk_bf16_f32 v106, v248, v249
v_cvt_pk_bf16_f32 v107, v250, v251
s_add_u32 m0, s39, 104448
s_add_u32 s37, s37, s38
buffer_load_dwordx4 v22, s[8:11], s37 offen sc1 lds
v_fma_f32 v172, -v35, v56, v172
v_fma_f32 v173, -v35, v57, v173
v_fma_f32 v174, -v35, v58, v174
s_add_u32 m0, s39, 105472
s_add_u32 s37, s37, s38
buffer_load_dwordx4 v23, s[8:11], s37 offen sc1 lds
v_fma_f32 v175, -v35, v59, v175
v_fma_f32 v236, -v35, v72, v236
v_fma_f32 v237, -v35, v73, v237
s_add_u32 m0, s39, 106496
s_add_u32 s37, s37, s38
buffer_load_dwordx4 v22, s[8:11], s37 offen sc1 lds
v_fma_f32 v238, -v35, v74, v238
v_fma_f32 v239, -v35, v75, v239
v_mul_f32 v80, v172, v172
v_mul_f32 v81, v173, v173
s_add_u32 m0, s39, 107520
s_add_u32 s37, s37, s38
buffer_load_dwordx4 v23, s[8:11], s37 offen sc1 lds
v_mul_f32 v82, v174, v174
v_mul_f32 v83, v175, v175
v_fma_f32 v80, v80, v43, v39
s_add_u32 m0, s39, 108544
s_add_u32 s37, s37, s38
buffer_load_dwordx4 v22, s[8:11], s37 offen sc1 lds
v_fma_f32 v81, v81, v43, v39
v_fma_f32 v82, v82, v43, v39
v_fma_f32 v83, v83, v43, v39
s_add_u32 m0, s39, 109568
s_add_u32 s37, s37, s38
buffer_load_dwordx4 v23, s[8:11], s37 offen sc1 lds
v_mul_f32 v80, v80, v172
v_mul_f32 v81, v81, v173
v_mul_f32 v82, v82, v174
s_add_u32 m0, s39, 110592
s_add_u32 s37, s37, s38
buffer_load_dwordx4 v22, s[8:11], s37 offen sc1 lds
v_mul_f32 v83, v83, v175
v_exp_f32 v80, v80
v_exp_f32 v81, v81
v_exp_f32 v82, v82
s_add_u32 m0, s39, 111616
s_add_u32 s37, s37, s38
buffer_load_dwordx4 v23, s[8:11], s37 offen sc1 lds
v_exp_f32 v83, v83
v_mul_f32 v236, v172, v236
v_mul_f32 v237, v173, v237
s_add_u32 m0, s39, 112640
s_add_u32 s37, s37, s38
buffer_load_dwordx4 v22, s[8:11], s37 offen sc1 lds
v_mul_f32 v238, v174, v238
v_mul_f32 v239, v175, v239
v_fma_f32 v80, v80, v47, v47
s_add_u32 m0, s39, 113664
s_add_u32 s37, s37, s38
buffer_load_dwordx4 v23, s[8:11], s37 offen sc1 lds
v_fma_f32 v81, v81, v47, v47
v_fma_f32 v82, v82, v47, v47
v_fma_f32 v83, v83, v47, v47
buffer_store_dwordx4 v[104:107], v27, s[24:27], s53 offen offset:512 sc1
s_waitcnt vmcnt(17)
s_barrier
s_add_u32 s42, s42, 1
s_xor_b32 s37, s42, s35
s_add_u32 m0, s39, 0
s_mul_i32 s37, s37, s40
buffer_load_dwordx4 v22, s[8:11], s37 offen sc1 lds
v_rcp_f32 v80, v80
v_rcp_f32 v81, v81
v_rcp_f32 v82, v82
v_rcp_f32 v83, v83
s_add_u32 m0, s39, 1024
s_add_u32 s37, s37, s38
buffer_load_dwordx4 v23, s[8:11], s37 offen sc1 lds
v_mul_f32 v236, v236, v80
v_mul_f32 v237, v237, v81
v_mul_f32 v238, v238, v82
s_add_u32 m0, s39, 2048
s_add_u32 s37, s37, s38
buffer_load_dwordx4 v22, s[8:11], s37 offen sc1 lds
v_mul_f32 v239, v239, v83
v_cvt_pk_bf16_f32 v108, v236, v237
v_cvt_pk_bf16_f32 v109, v238, v239
s_add_u32 m0, s39, 3072
s_add_u32 s37, s37, s38
buffer_load_dwordx4 v23, s[8:11], s37 offen sc1 lds
v_fma_f32 v188, -v35, v60, v188
v_fma_f32 v189, -v35, v61, v189
v_fma_f32 v190, -v35, v62, v190
v_fma_f32 v191, -v35, v63, v191
s_add_u32 m0, s39, 4096
s_add_u32 s37, s37, s38
buffer_load_dwordx4 v22, s[8:11], s37 offen sc1 lds
v_fma_f32 v252, -v35, v76, v252
v_fma_f32 v253, -v35, v77, v253
v_fma_f32 v254, -v35, v78, v254
s_add_u32 m0, s39, 5120
s_add_u32 s37, s37, s38
buffer_load_dwordx4 v23, s[8:11], s37 offen sc1 lds
v_fma_f32 v255, -v35, v79, v255
v_mul_f32 v84, v188, v188
v_mul_f32 v85, v189, v189
s_add_u32 m0, s39, 6144
s_add_u32 s37, s37, s38
buffer_load_dwordx4 v22, s[8:11], s37 offen sc1 lds
v_mul_f32 v86, v190, v190
v_mul_f32 v87, v191, v191
v_fma_f32 v84, v84, v43, v39
v_fma_f32 v85, v85, v43, v39
s_add_u32 m0, s39, 7168
s_add_u32 s37, s37, s38
buffer_load_dwordx4 v23, s[8:11], s37 offen sc1 lds
v_fma_f32 v86, v86, v43, v39
v_fma_f32 v87, v87, v43, v39
v_mul_f32 v84, v84, v188
s_add_u32 m0, s39, 8192
s_add_u32 s37, s37, s38
buffer_load_dwordx4 v22, s[8:11], s37 offen sc1 lds
v_mul_f32 v85, v85, v189
v_mul_f32 v86, v86, v190
v_mul_f32 v87, v87, v191
s_add_u32 m0, s39, 9216
s_add_u32 s37, s37, s38
buffer_load_dwordx4 v23, s[8:11], s37 offen sc1 lds
v_exp_f32 v84, v84
v_exp_f32 v85, v85
v_exp_f32 v86, v86
v_exp_f32 v87, v87
s_add_u32 m0, s39, 10240
s_add_u32 s37, s37, s38
buffer_load_dwordx4 v22, s[8:11], s37 offen sc1 lds
v_mul_f32 v252, v188, v252
v_mul_f32 v253, v189, v253
v_mul_f32 v254, v190, v254
s_add_u32 m0, s39, 11264
s_add_u32 s37, s37, s38
buffer_load_dwordx4 v23, s[8:11], s37 offen sc1 lds
v_mul_f32 v255, v191, v255
v_fma_f32 v84, v84, v47, v47
v_fma_f32 v85, v85, v47, v47
s_add_u32 m0, s39, 12288
s_add_u32 s37, s37, s38
buffer_load_dwordx4 v22, s[8:11], s37 offen sc1 lds
v_fma_f32 v86, v86, v47, v47
v_fma_f32 v87, v87, v47, v47
v_rcp_f32 v84, v84
v_rcp_f32 v85, v85
s_add_u32 m0, s39, 13312
s_add_u32 s37, s37, s38
buffer_load_dwordx4 v23, s[8:11], s37 offen sc1 lds
v_rcp_f32 v86, v86
v_rcp_f32 v87, v87
v_mul_f32 v252, v252, v84
s_add_u32 m0, s39, 14336
s_add_u32 s37, s37, s38
buffer_load_dwordx4 v22, s[8:11], s37 offen sc1 lds
v_mul_f32 v253, v253, v85
v_mul_f32 v254, v254, v86
v_mul_f32 v255, v255, v87
s_add_u32 m0, s39, 15360
s_add_u32 s37, s37, s38
buffer_load_dwordx4 v23, s[8:11], s37 offen sc1 lds
v_cvt_pk_bf16_f32 v110, v252, v253
v_cvt_pk_bf16_f32 v111, v254, v255
buffer_store_dwordx4 v[108:111], v27, s[24:27], s53 offen offset:768 sc1
s_waitcnt vmcnt(18)
s_barrier
s_mul_i32 s44, s34, 917504
s_lshl_b32 s39, s51, 13
s_add_u32 s44, s44, s39
s_add_u32 s44, s44, 8388608
s_and_b32 s43, s51, 1
s_xor_b32 s43, s43, s35
s_lshl_b32 s43, s43, 7
s_mov_b32 s10, 909312
s_movk_i32 s38, 1024
s_movk_i32 s40, 9216
s_movk_i32 s37, 0x4000
s_cmp_ge_u32 s51, 2
s_cselect_b32 s8, s60, s32
s_cselect_b32 s9, s61, s33
s_cselect_b32 s10, 7338112, s10
s_cselect_b32 s43, s43, s44
s_cselect_b32 s38, 16384, s38
s_cselect_b32 s40, 81920, s40
s_cselect_b32 s55, 81920, s38
s_cselect_b32 s37, 262144, s37
s_cselect_b32 s45, -1, 0
s_add_u32 s8, s8, s43
s_addc_u32 s9, s9, 0
s_mov_b32 s11, 0x20000
s_and_b32 s53, s35, 1
s_mul_i32 s54, s53, 6
s_mul_i32 s54, s54, s37
s_mul_i32 s29, s53, 2
s_add_u32 s29, s29, 6
s_mul_i32 s29, s29, s37
s_and_b32 s43, s45, 4290838528
s_add_u32 s29, s29, s43
s_mul_i32 s37, s37, 0
s_sub_u32 s37, s37, s40
v_lshrrev_b32 v19, 3, v1
v_mul_u32_u24 v19, 1920, v19
v_lshrrev_b32 v20, 4, v1
v_lshlrev_b32 v20, 5, v20
v_and_b32 v19, s45, v19
v_and_b32 v20, s45, v20
v_lshlrev_b32 v21, 4, v1
v_xor_b32 v21, v21, v20
v_add_u32 v21, v21, v19
s_mov_b64 s[72:73], -1
s_add_u32 m0, s39, 65536
s_add_u32 s37, s37, s40
buffer_load_dwordx4 v21, s[8:11], s37 offen sc1 lds
v_lshlrev_b32 v128, 16, v192
v_and_b32 v129, 0xffff0000, v192
v_lshlrev_b32 v130, 16, v193
v_and_b32 v131, 0xffff0000, v193
s_add_u32 m0, s39, 66560
s_add_u32 s37, s37, s38
buffer_load_dwordx4 v21, s[8:11], s37 offen sc1 lds
v_lshlrev_b32 v132, 16, v194
v_and_b32 v133, 0xffff0000, v194
v_lshlrev_b32 v134, 16, v195
v_and_b32 v135, 0xffff0000, v195
s_add_u32 m0, s39, 67584
s_add_u32 s37, s37, s38
buffer_load_dwordx4 v21, s[8:11], s37 offen sc1 lds
v_lshlrev_b32 v136, 16, v196
v_and_b32 v137, 0xffff0000, v196
v_lshlrev_b32 v138, 16, v197
v_and_b32 v139, 0xffff0000, v197
s_add_u32 m0, s39, 68608
s_add_u32 s37, s37, s38
buffer_load_dwordx4 v21, s[8:11], s37 offen sc1 lds
v_lshlrev_b32 v140, 16, v198
v_and_b32 v141, 0xffff0000, v198
v_lshlrev_b32 v142, 16, v199
v_and_b32 v143, 0xffff0000, v199
s_add_u32 m0, s39, 69632
s_add_u32 s37, s37, s55
buffer_load_dwordx4 v21, s[8:11], s37 offen sc1 lds
v_lshlrev_b32 v144, 16, v200
v_and_b32 v145, 0xffff0000, v200
v_lshlrev_b32 v146, 16, v201
v_and_b32 v147, 0xffff0000, v201
s_add_u32 m0, s39, 70656
s_add_u32 s37, s37, s38
buffer_load_dwordx4 v21, s[8:11], s37 offen sc1 lds
v_lshlrev_b32 v148, 16, v202
v_and_b32 v149, 0xffff0000, v202
v_lshlrev_b32 v150, 16, v203
v_and_b32 v151, 0xffff0000, v203
s_add_u32 m0, s39, 71680
s_add_u32 s37, s37, s38
buffer_load_dwordx4 v21, s[8:11], s37 offen sc1 lds
v_lshlrev_b32 v152, 16, v204
v_and_b32 v153, 0xffff0000, v204
v_lshlrev_b32 v154, 16, v205
v_and_b32 v155, 0xffff0000, v205
s_add_u32 m0, s39, 72704
s_add_u32 s37, s37, s38
buffer_load_dwordx4 v21, s[8:11], s37 offen sc1 lds
v_lshlrev_b32 v156, 16, v206
v_and_b32 v157, 0xffff0000, v206
v_lshlrev_b32 v158, 16, v207
v_and_b32 v159, 0xffff0000, v207
s_waitcnt vmcnt(8)
s_barrier
s_add_u32 m0, s39, 98304
s_add_u32 s37, s37, s40
buffer_load_dwordx4 v21, s[8:11], s37 offen sc1 lds
v_mov_b32 v192, 0
v_mov_b32 v193, 0
v_mov_b32 v194, 0
v_mov_b32 v195, 0
s_add_u32 m0, s39, 99328
s_add_u32 s37, s37, s38
buffer_load_dwordx4 v21, s[8:11], s37 offen sc1 lds
v_mov_b32 v196, 0
v_mov_b32 v197, 0
v_mov_b32 v198, 0
v_mov_b32 v199, 0
s_add_u32 m0, s39, 100352
s_add_u32 s37, s37, s38
buffer_load_dwordx4 v21, s[8:11], s37 offen sc1 lds
v_mov_b32 v200, 0
v_mov_b32 v201, 0
v_mov_b32 v202, 0
v_mov_b32 v203, 0
s_add_u32 m0, s39, 101376
s_add_u32 s37, s37, s38
buffer_load_dwordx4 v21, s[8:11], s37 offen sc1 lds
v_mov_b32 v204, 0
v_mov_b32 v205, 0
v_mov_b32 v206, 0
v_mov_b32 v207, 0
s_add_u32 m0, s39, 102400
s_add_u32 s37, s37, s55
buffer_load_dwordx4 v21, s[8:11], s37 offen sc1 lds
v_mov_b32 v208, 0
v_mov_b32 v209, 0
v_mov_b32 v210, 0
v_mov_b32 v211, 0
s_add_u32 m0, s39, 103424
s_add_u32 s37, s37, s38
buffer_load_dwordx4 v21, s[8:11], s37 offen sc1 lds
v_mov_b32 v212, 0
v_mov_b32 v213, 0
v_mov_b32 v214, 0
v_mov_b32 v215, 0
s_add_u32 m0, s39, 104448
s_add_u32 s37, s37, s38
buffer_load_dwordx4 v21, s[8:11], s37 offen sc1 lds
v_mov_b32 v216, 0
v_mov_b32 v217, 0
v_mov_b32 v218, 0
v_mov_b32 v219, 0
s_add_u32 m0, s39, 105472
s_add_u32 s37, s37, s38
buffer_load_dwordx4 v21, s[8:11], s37 offen sc1 lds
v_mov_b32 v220, 0
v_mov_b32 v221, 0
v_mov_b32 v222, 0
v_mov_b32 v223, 0
s_waitcnt vmcnt(8)
s_barrier
s_branch LK4_125
.p2align 6
Lw_155:
s_branch Lr_156
s_nop 0
.p2align 3
L3h_124:
v_mfma_f32_16x16x32_bf16 v[128:131], v[96:99], v[80:83], v[128:131]
s_lshl_b32 s43, s46, 9
v_mfma_f32_16x16x32_bf16 v[132:135], v[96:99], v[84:87], v[132:135]
s_add_u32 s43, s43, 147456
v_mfma_f32_16x16x32_bf16 v[136:139], v[96:99], v[88:91], v[136:139]
v_lshl_add_u32 v19, v17, 3, s43
v_mfma_f32_16x16x32_bf16 v[140:143], v[96:99], v[92:95], v[140:143]
ds_read_b64 v[2:3], v19 offset:0
v_mfma_f32_16x16x32_bf16 v[204:207], v[112:115], v[92:95], v[204:207]
ds_read_b64 v[4:5], v19 offset:128
v_mfma_f32_16x16x32_bf16 v[200:203], v[112:115], v[88:91], v[200:203]
ds_read_b64 v[6:7], v19 offset:256
v_mfma_f32_16x16x32_bf16 v[196:199], v[112:115], v[84:87], v[196:199]
ds_read_b64 v[8:9], v19 offset:384
v_mfma_f32_16x16x32_bf16 v[192:195], v[112:115], v[80:83], v[192:195]
s_mul_i32 s43, s47, 256
v_mfma_f32_16x16x32_bf16 v[144:147], v[100:103], v[80:83], v[144:147]
s_add_u32 s43, s43, 148480
v_mfma_f32_16x16x32_bf16 v[148:151], v[100:103], v[84:87], v[148:151]
v_lshl_add_u32 v19, v18, 4, s43
v_mfma_f32_16x16x32_bf16 v[152:155], v[100:103], v[88:91], v[152:155]
ds_read_b128 v[48:51], v19 offset:0
v_mfma_f32_16x16x32_bf16 v[156:159], v[100:103], v[92:95], v[156:159]
ds_read_b128 v[52:55], v19 offset:64
v_mfma_f32_16x16x32_bf16 v[220:223], v[116:119], v[92:95], v[220:223]
ds_read_b128 v[56:59], v19 offset:128
v_mfma_f32_16x16x32_bf16 v[216:219], v[116:119], v[88:91], v[216:219]
ds_read_b128 v[60:63], v19 offset:192
v_mfma_f32_16x16x32_bf16 v[212:215], v[116:119], v[84:87], v[212:215]
ds_read_b128 v[64:67], v19 offset:896
v_mfma_f32_16x16x32_bf16 v[208:211], v[116:119], v[80:83], v[208:211]
ds_read_b128 v[68:71], v19 offset:960
v_mfma_f32_16x16x32_bf16 v[160:163], v[104:107], v[80:83], v[160:163]
ds_read_b128 v[72:75], v19 offset:1024
v_mfma_f32_16x16x32_bf16 v[164:167], v[104:107], v[84:87], v[164:167]
ds_read_b128 v[76:79], v19 offset:1088
v_mfma_f32_16x16x32_bf16 v[168:171], v[104:107], v[88:91], v[168:171]
v_mfma_f32_16x16x32_bf16 v[172:175], v[104:107], v[92:95], v[172:175]
v_mfma_f32_16x16x32_bf16 v[236:239], v[120:123], v[92:95], v[236:239]
v_mfma_f32_16x16x32_bf16 v[232:235], v[120:123], v[88:91], v[232:235]
v_mfma_f32_16x16x32_bf16 v[228:231], v[120:123], v[84:87], v[228:231]
v_mfma_f32_16x16x32_bf16 v[224:227], v[120:123], v[80:83], v[224:227]
v_mfma_f32_16x16x32_bf16 v[176:179], v[108:111], v[80:83], v[176:179]
v_mfma_f32_16x16x32_bf16 v[180:183], v[108:111], v[84:87], v[180:183]
v_mfma_f32_16x16x32_bf16 v[184:187], v[108:111], v[88:91], v[184:187]
v_mfma_f32_16x16x32_bf16 v[188:191], v[108:111], v[92:95], v[188:191]
v_mfma_f32_16x16x32_bf16 v[252:255], v[124:127], v[92:95], v[252:255]
v_mfma_f32_16x16x32_bf16 v[248:251], v[124:127], v[88:91], v[248:251]
v_mfma_f32_16x16x32_bf16 v[244:247], v[124:127], v[84:87], v[244:247]
v_mfma_f32_16x16x32_bf16 v[240:243], v[124:127], v[80:83], v[240:243]
s_setprio 0
s_waitcnt lgkmcnt(0)
v_mov_b32 v32, v2
v_mul_f32 v88, v3, v3
v_mul_f32 v36, 0xc0135761, v3
v_mul_f32 v89, 0xbdd2d3e8, v3
v_rcp_f32 v44, v88
v_mul_f32 v40, v89, v88
v_mov_b32 v33, v4
v_mul_f32 v88, v5, v5
v_mul_f32 v37, 0xc0135761, v5
v_mul_f32 v89, 0xbdd2d3e8, v5
v_rcp_f32 v45, v88
v_mul_f32 v41, v89, v88
v_mov_b32 v34, v6
v_mul_f32 v88, v7, v7
v_mul_f32 v38, 0xc0135761, v7
v_mul_f32 v89, 0xbdd2d3e8, v7
v_rcp_f32 v46, v88
v_mul_f32 v42, v89, v88
v_mov_b32 v35, v8
v_mul_f32 v88, v9, v9
v_mul_f32 v39, 0xc0135761, v9
v_mul_f32 v89, 0xbdd2d3e8, v9
v_rcp_f32 v47, v88
v_mul_f32 v43, v89, v88
s_barrier
v_fma_f32 v128, -v32, v48, v128
v_fma_f32 v129, -v32, v49, v129
v_fma_f32 v130, -v32, v50, v130
v_fma_f32 v131, -v32, v51, v131
v_fma_f32 v192, -v32, v64, v192
v_fma_f32 v193, -v32, v65, v193
v_fma_f32 v194, -v32, v66, v194
v_fma_f32 v195, -v32, v67, v195
v_mul_f32 v80, v128, v128
v_mul_f32 v81, v129, v129
v_mul_f32 v82, v130, v130
v_mul_f32 v83, v131, v131
v_fma_f32 v80, v80, v40, v36
v_fma_f32 v81, v81, v40, v36
v_fma_f32 v82, v82, v40, v36
v_fma_f32 v83, v83, v40, v36
v_mul_f32 v80, v80, v128
v_mul_f32 v81, v81, v129
v_mul_f32 v82, v82, v130
v_mul_f32 v83, v83, v131
v_exp_f32 v80, v80
v_exp_f32 v81, v81
v_exp_f32 v82, v82
v_exp_f32 v83, v83
v_mul_f32 v192, v128, v192
v_mul_f32 v193, v129, v193
v_mul_f32 v194, v130, v194
v_mul_f32 v195, v131, v195
v_fma_f32 v80, v80, v44, v44
v_fma_f32 v81, v81, v44, v44
v_fma_f32 v82, v82, v44, v44
v_fma_f32 v83, v83, v44, v44
v_rcp_f32 v80, v80
v_rcp_f32 v81, v81
v_rcp_f32 v82, v82
v_rcp_f32 v83, v83
v_mul_f32 v192, v192, v80
v_mul_f32 v193, v193, v81
v_mul_f32 v194, v194, v82
v_mul_f32 v195, v195, v83
v_cvt_pk_bf16_f32 v96, v192, v193
v_cvt_pk_bf16_f32 v97, v194, v195
v_fma_f32 v144, -v32, v52, v144
v_fma_f32 v145, -v32, v53, v145
v_fma_f32 v146, -v32, v54, v146
v_fma_f32 v147, -v32, v55, v147
v_fma_f32 v208, -v32, v68, v208
v_fma_f32 v209, -v32, v69, v209
v_fma_f32 v210, -v32, v70, v210
v_fma_f32 v211, -v32, v71, v211
v_mul_f32 v84, v144, v144
v_mul_f32 v85, v145, v145
s_barrier
v_mul_f32 v86, v146, v146
v_mul_f32 v87, v147, v147
v_fma_f32 v84, v84, v40, v36
v_fma_f32 v85, v85, v40, v36
v_fma_f32 v86, v86, v40, v36
v_fma_f32 v87, v87, v40, v36
v_mul_f32 v84, v84, v144
v_mul_f32 v85, v85, v145
v_mul_f32 v86, v86, v146
v_mul_f32 v87, v87, v147
v_exp_f32 v84, v84
v_exp_f32 v85, v85
v_exp_f32 v86, v86
v_exp_f32 v87, v87
v_mul_f32 v208, v144, v208
v_mul_f32 v209, v145, v209
v_mul_f32 v210, v146, v210
v_mul_f32 v211, v147, v211
v_fma_f32 v84, v84, v44, v44
v_fma_f32 v85, v85, v44, v44
v_fma_f32 v86, v86, v44, v44
v_fma_f32 v87, v87, v44, v44
v_rcp_f32 v84, v84
v_rcp_f32 v85, v85
v_rcp_f32 v86, v86
v_rcp_f32 v87, v87
v_mul_f32 v208, v208, v84
v_mul_f32 v209, v209, v85
v_mul_f32 v210, v210, v86
v_mul_f32 v211, v211, v87
v_cvt_pk_bf16_f32 v98, v208, v209
v_cvt_pk_bf16_f32 v99, v210, v211
buffer_store_dwordx4 v[96:99], v27, s[24:27], 0 offen offset:0 sc1
v_fma_f32 v132, -v33, v48, v132
v_fma_f32 v133, -v33, v49, v133
v_fma_f32 v134, -v33, v50, v134
v_fma_f32 v135, -v33, v51, v135
v_fma_f32 v196, -v33, v64, v196
v_fma_f32 v197, -v33, v65, v197
v_fma_f32 v198, -v33, v66, v198
v_fma_f32 v199, -v33, v67, v199
v_mul_f32 v80, v132, v132
v_mul_f32 v81, v133, v133
v_mul_f32 v82, v134, v134
v_mul_f32 v83, v135, v135
v_fma_f32 v80, v80, v41, v37
v_fma_f32 v81, v81, v41, v37
v_fma_f32 v82, v82, v41, v37
v_fma_f32 v83, v83, v41, v37
v_mul_f32 v80, v80, v132
v_mul_f32 v81, v81, v133
v_mul_f32 v82, v82, v134
v_lshlrev_b32 v19, 11, v18
v_lshl_add_u32 v19, v17, 4, v19
s_lshl_b32 s43, s46, 10
v_add_u32 v2, s43, v19
v_add_u32 v3, 0x10000, v2
v_lshrrev_b32 v19, 2, v17
v_lshl_add_u32 v20, v18, 2, v19
v_bfe_u32 v21, v20, 1, 2
s_lshl_b32 s43, s47, 1
v_xor_b32 v21, s43, v21
v_lshlrev_b32 v20, 7, v20
v_lshl_add_u32 v20, v21, 5, v20
v_and_b32 v19, 3, v1
v_lshl_add_u32 v20, v19, 3, v20
v_add_u32 v5, 16384, v20
v_xor_b32 v6, 32, v5
v_add_u32 v7, 0x10000, v5
v_add_u32 v8, 0x10000, v6
s_lshl_b32 s43, s36, 12
v_lshl_add_u32 v9, v1, 4, s43
s_mov_b32 s54, 0x10000
s_movk_i32 s52, 0x1000
s_barrier
v_mul_f32 v83, v83, v135
v_exp_f32 v80, v80
v_exp_f32 v81, v81
v_exp_f32 v82, v82
v_exp_f32 v83, v83
v_mul_f32 v196, v132, v196
v_mul_f32 v197, v133, v197
v_mul_f32 v198, v134, v198
v_mul_f32 v199, v135, v199
v_fma_f32 v80, v80, v45, v45
v_fma_f32 v81, v81, v45, v45
v_fma_f32 v82, v82, v45, v45
v_fma_f32 v83, v83, v45, v45
v_rcp_f32 v80, v80
v_rcp_f32 v81, v81
v_rcp_f32 v82, v82
v_rcp_f32 v83, v83
v_mul_f32 v196, v196, v80
v_mul_f32 v197, v197, v81
v_mul_f32 v198, v198, v82
v_mul_f32 v199, v199, v83
v_cvt_pk_bf16_f32 v100, v196, v197
v_cvt_pk_bf16_f32 v101, v198, v199
v_fma_f32 v148, -v33, v52, v148
v_fma_f32 v149, -v33, v53, v149
v_fma_f32 v150, -v33, v54, v150
v_fma_f32 v151, -v33, v55, v151
v_fma_f32 v212, -v33, v68, v212
v_fma_f32 v213, -v33, v69, v213
v_fma_f32 v214, -v33, v70, v214
v_fma_f32 v215, -v33, v71, v215
v_mul_f32 v84, v148, v148
v_mul_f32 v85, v149, v149
v_mul_f32 v86, v150, v150
v_mul_f32 v87, v151, v151
v_fma_f32 v84, v84, v41, v37
v_fma_f32 v85, v85, v41, v37
v_fma_f32 v86, v86, v41, v37
v_fma_f32 v87, v87, v41, v37
v_mul_f32 v84, v84, v148
v_mul_f32 v85, v85, v149
v_mul_f32 v86, v86, v150
v_mul_f32 v87, v87, v151
v_exp_f32 v84, v84
v_exp_f32 v85, v85
v_exp_f32 v86, v86
v_exp_f32 v87, v87
v_mul_f32 v212, v148, v212
v_mul_f32 v213, v149, v213
v_mul_f32 v214, v150, v214
v_mul_f32 v215, v151, v215
v_fma_f32 v84, v84, v45, v45
s_barrier
v_fma_f32 v85, v85, v45, v45
v_fma_f32 v86, v86, v45, v45
v_fma_f32 v87, v87, v45, v45
v_rcp_f32 v84, v84
v_rcp_f32 v85, v85
v_rcp_f32 v86, v86
v_rcp_f32 v87, v87
v_mul_f32 v212, v212, v84
v_mul_f32 v213, v213, v85
v_mul_f32 v214, v214, v86
v_mul_f32 v215, v215, v87
v_cvt_pk_bf16_f32 v102, v212, v213
v_cvt_pk_bf16_f32 v103, v214, v215
buffer_store_dwordx4 v[100:103], v27, s[24:27], 0 offen offset:256 sc1
v_fma_f32 v136, -v34, v48, v136
v_fma_f32 v137, -v34, v49, v137
v_fma_f32 v138, -v34, v50, v138
v_fma_f32 v139, -v34, v51, v139
v_fma_f32 v200, -v34, v64, v200
v_fma_f32 v201, -v34, v65, v201
v_fma_f32 v202, -v34, v66, v202
v_fma_f32 v203, -v34, v67, v203
v_mul_f32 v80, v136, v136
v_mul_f32 v81, v137, v137
v_mul_f32 v82, v138, v138
v_mul_f32 v83, v139, v139
v_fma_f32 v80, v80, v42, v38
v_fma_f32 v81, v81, v42, v38
v_fma_f32 v82, v82, v42, v38
v_fma_f32 v83, v83, v42, v38
v_mul_f32 v80, v80, v136
v_mul_f32 v81, v81, v137
v_mul_f32 v82, v82, v138
v_mul_f32 v83, v83, v139
v_exp_f32 v80, v80
v_exp_f32 v81, v81
v_exp_f32 v82, v82
v_exp_f32 v83, v83
v_mul_f32 v200, v136, v200
v_mul_f32 v201, v137, v201
v_mul_f32 v202, v138, v202
v_mul_f32 v203, v139, v203
v_fma_f32 v80, v80, v46, v46
v_fma_f32 v81, v81, v46, v46
v_fma_f32 v82, v82, v46, v46
v_fma_f32 v83, v83, v46, v46
v_rcp_f32 v80, v80
v_rcp_f32 v81, v81
v_rcp_f32 v82, v82
v_rcp_f32 v83, v83
v_mul_f32 v200, v200, v80
v_mul_f32 v201, v201, v81
v_mul_f32 v202, v202, v82
s_barrier
v_mul_f32 v203, v203, v83
v_cvt_pk_bf16_f32 v104, v200, v201
v_cvt_pk_bf16_f32 v105, v202, v203
v_fma_f32 v152, -v34, v52, v152
v_fma_f32 v153, -v34, v53, v153
v_fma_f32 v154, -v34, v54, v154
v_fma_f32 v155, -v34, v55, v155
v_fma_f32 v216, -v34, v68, v216
v_fma_f32 v217, -v34, v69, v217
v_fma_f32 v218, -v34, v70, v218
v_fma_f32 v219, -v34, v71, v219
v_mul_f32 v84, v152, v152
v_mul_f32 v85, v153, v153
v_mul_f32 v86, v154, v154
v_mul_f32 v87, v155, v155
v_fma_f32 v84, v84, v42, v38
v_fma_f32 v85, v85, v42, v38
v_fma_f32 v86, v86, v42, v38
v_fma_f32 v87, v87, v42, v38
v_mul_f32 v84, v84, v152
v_mul_f32 v85, v85, v153
v_mul_f32 v86, v86, v154
v_mul_f32 v87, v87, v155
v_exp_f32 v84, v84
v_exp_f32 v85, v85
v_exp_f32 v86, v86
v_exp_f32 v87, v87
v_mul_f32 v216, v152, v216
v_mul_f32 v217, v153, v217
v_mul_f32 v218, v154, v218
v_mul_f32 v219, v155, v219
v_fma_f32 v84, v84, v46, v46
v_fma_f32 v85, v85, v46, v46
v_fma_f32 v86, v86, v46, v46
v_fma_f32 v87, v87, v46, v46
v_rcp_f32 v84, v84
v_rcp_f32 v85, v85
v_rcp_f32 v86, v86
v_rcp_f32 v87, v87
v_mul_f32 v216, v216, v84
v_mul_f32 v217, v217, v85
v_mul_f32 v218, v218, v86
v_mul_f32 v219, v219, v87
v_cvt_pk_bf16_f32 v106, v216, v217
v_cvt_pk_bf16_f32 v107, v218, v219
buffer_store_dwordx4 v[104:107], v27, s[24:27], 0 offen offset:512 sc1
v_fma_f32 v140, -v35, v48, v140
v_fma_f32 v141, -v35, v49, v141
v_fma_f32 v142, -v35, v50, v142
v_fma_f32 v143, -v35, v51, v143
v_fma_f32 v204, -v35, v64, v204
v_fma_f32 v205, -v35, v65, v205
s_barrier
v_fma_f32 v206, -v35, v66, v206
v_fma_f32 v207, -v35, v67, v207
v_mul_f32 v80, v140, v140
v_mul_f32 v81, v141, v141
v_mul_f32 v82, v142, v142
v_mul_f32 v83, v143, v143
v_fma_f32 v80, v80, v43, v39
v_fma_f32 v81, v81, v43, v39
v_fma_f32 v82, v82, v43, v39
v_fma_f32 v83, v83, v43, v39
v_mul_f32 v80, v80, v140
v_mul_f32 v81, v81, v141
v_mul_f32 v82, v82, v142
v_mul_f32 v83, v83, v143
v_exp_f32 v80, v80
v_exp_f32 v81, v81
v_exp_f32 v82, v82
v_exp_f32 v83, v83
v_mul_f32 v204, v140, v204
v_mul_f32 v205, v141, v205
v_mul_f32 v206, v142, v206
v_mul_f32 v207, v143, v207
v_fma_f32 v80, v80, v47, v47
v_fma_f32 v81, v81, v47, v47
v_fma_f32 v82, v82, v47, v47
v_fma_f32 v83, v83, v47, v47
v_rcp_f32 v80, v80
v_rcp_f32 v81, v81
v_rcp_f32 v82, v82
v_rcp_f32 v83, v83
v_mul_f32 v204, v204, v80
v_mul_f32 v205, v205, v81
v_mul_f32 v206, v206, v82
v_mul_f32 v207, v207, v83
v_cvt_pk_bf16_f32 v108, v204, v205
v_cvt_pk_bf16_f32 v109, v206, v207
v_fma_f32 v156, -v35, v52, v156
v_fma_f32 v157, -v35, v53, v157
v_fma_f32 v158, -v35, v54, v158
v_fma_f32 v159, -v35, v55, v159
v_fma_f32 v220, -v35, v68, v220
v_fma_f32 v221, -v35, v69, v221
v_fma_f32 v222, -v35, v70, v222
v_fma_f32 v223, -v35, v71, v223
v_mul_f32 v84, v156, v156
v_mul_f32 v85, v157, v157
v_mul_f32 v86, v158, v158
v_mul_f32 v87, v159, v159
v_fma_f32 v84, v84, v43, v39
v_fma_f32 v85, v85, v43, v39
v_fma_f32 v86, v86, v43, v39
v_fma_f32 v87, v87, v43, v39
s_barrier
s_getpc_b64 s[78:79]
Lpc_126:
s_sub_u32 s78, s78, Lpc_126-sequential_preLN__sliding_local_dilated__glu_gated_geglu__prompt_kernel
s_subb_u32 s79, s79, 0
s_lshr_b32 s43, s2, 3
s_mul_i32 s43, s43, 3840
v_min_u32 v19, 29, v1
v_lshl_add_u32 v19, v19, 7, s43
v_min_u32 v19, Ldone_1-sequential_preLN__sliding_local_dilated__glu_gated_geglu__prompt_kernel, v19
global_load_dword v30, v19, s[78:79]
v_mul_f32 v84, v84, v156
v_mul_f32 v85, v85, v157
v_mul_f32 v86, v86, v158
v_mul_f32 v87, v87, v159
v_exp_f32 v84, v84
v_exp_f32 v85, v85
v_exp_f32 v86, v86
v_exp_f32 v87, v87
v_mul_f32 v220, v156, v220
v_mul_f32 v221, v157, v221
v_mul_f32 v222, v158, v222
v_mul_f32 v223, v159, v223
v_fma_f32 v84, v84, v47, v47
v_fma_f32 v85, v85, v47, v47
v_fma_f32 v86, v86, v47, v47
v_fma_f32 v87, v87, v47, v47
v_rcp_f32 v84, v84
v_rcp_f32 v85, v85
v_rcp_f32 v86, v86
v_rcp_f32 v87, v87
v_mul_f32 v220, v220, v84
v_mul_f32 v221, v221, v85
v_mul_f32 v222, v222, v86
v_mul_f32 v223, v223, v87
v_cvt_pk_bf16_f32 v110, v220, v221
v_cvt_pk_bf16_f32 v111, v222, v223
buffer_store_dwordx4 v[108:111], v27, s[24:27], 0 offen offset:768 sc1
v_fma_f32 v160, -v32, v56, v160
v_fma_f32 v161, -v32, v57, v161
v_fma_f32 v162, -v32, v58, v162
v_fma_f32 v163, -v32, v59, v163
v_fma_f32 v224, -v32, v72, v224
v_fma_f32 v225, -v32, v73, v225
v_fma_f32 v226, -v32, v74, v226
v_fma_f32 v227, -v32, v75, v227
v_mul_f32 v80, v160, v160
v_mul_f32 v81, v161, v161
v_mul_f32 v82, v162, v162
v_mul_f32 v83, v163, v163
v_fma_f32 v80, v80, v40, v36
v_fma_f32 v81, v81, v40, v36
v_fma_f32 v82, v82, v40, v36
v_fma_f32 v83, v83, v40, v36
v_mul_f32 v80, v80, v160
v_mul_f32 v81, v81, v161
v_mul_f32 v82, v82, v162
v_mul_f32 v83, v83, v163
v_exp_f32 v80, v80
v_exp_f32 v81, v81
v_exp_f32 v82, v82
v_exp_f32 v83, v83
v_mul_f32 v224, v160, v224
v_mul_f32 v225, v161, v225
s_barrier
v_mul_f32 v226, v162, v226
v_mul_f32 v227, v163, v227
v_fma_f32 v80, v80, v44, v44
v_fma_f32 v81, v81, v44, v44
v_fma_f32 v82, v82, v44, v44
v_fma_f32 v83, v83, v44, v44
v_rcp_f32 v80, v80
v_rcp_f32 v81, v81
v_rcp_f32 v82, v82
v_rcp_f32 v83, v83
v_mul_f32 v224, v224, v80
v_mul_f32 v225, v225, v81
v_mul_f32 v226, v226, v82
v_mul_f32 v227, v227, v83
v_cvt_pk_bf16_f32 v96, v224, v225
v_cvt_pk_bf16_f32 v97, v226, v227
v_fma_f32 v176, -v32, v60, v176
v_fma_f32 v177, -v32, v61, v177
v_fma_f32 v178, -v32, v62, v178
v_fma_f32 v179, -v32, v63, v179
v_fma_f32 v240, -v32, v76, v240
v_fma_f32 v241, -v32, v77, v241
v_fma_f32 v242, -v32, v78, v242
v_fma_f32 v243, -v32, v79, v243
v_mul_f32 v84, v176, v176
v_mul_f32 v85, v177, v177
v_mul_f32 v86, v178, v178
v_mul_f32 v87, v179, v179
v_fma_f32 v84, v84, v40, v36
v_fma_f32 v85, v85, v40, v36
v_fma_f32 v86, v86, v40, v36
v_fma_f32 v87, v87, v40, v36
v_mul_f32 v84, v84, v176
v_mul_f32 v85, v85, v177
v_mul_f32 v86, v86, v178
v_mul_f32 v87, v87, v179
v_exp_f32 v84, v84
v_exp_f32 v85, v85
v_exp_f32 v86, v86
v_exp_f32 v87, v87
v_mul_f32 v240, v176, v240
v_mul_f32 v241, v177, v241
v_mul_f32 v242, v178, v242
v_mul_f32 v243, v179, v243
v_fma_f32 v84, v84, v44, v44
v_fma_f32 v85, v85, v44, v44
v_fma_f32 v86, v86, v44, v44
v_fma_f32 v87, v87, v44, v44
v_rcp_f32 v84, v84
v_rcp_f32 v85, v85
v_rcp_f32 v86, v86
v_rcp_f32 v87, v87
v_lshlrev_b32 v19, 11, v18
v_lshl_add_u32 v19, v17, 4, v19
s_lshl_b32 s43, s46, 10
s_lshl_b32 s44, s47, 13
v_add3_u32 v208, v19, s43, 0
v_add_u32 v208, s44, v208
buffer_load_dwordx4 v[192:195], v208, s[20:23], 0 offen offset:0 sc1
buffer_load_dwordx4 v[196:199], v208, s[20:23], 0 offen offset:256 sc1
buffer_load_dwordx4 v[200:203], v208, s[20:23], 0 offen offset:512 sc1
buffer_load_dwordx4 v[204:207], v208, s[20:23], 0 offen offset:768 sc1
s_waitcnt vmcnt(4)
s_barrier
s_add_u32 s43, s34, 32
s_lshl_b32 s43, s43, 7
v_mov_b32 v21, s43
v_mov_b32 v22, 1
s_mov_b64 exec, 1
buffer_atomic_add v22, v21, s[56:59], 0 offen sc1
s_mov_b64 exec, -1
v_mul_f32 v240, v240, v84
v_mul_f32 v241, v241, v85
v_mul_f32 v242, v242, v86
v_mul_f32 v243, v243, v87
v_cvt_pk_bf16_f32 v98, v240, v241
v_cvt_pk_bf16_f32 v99, v242, v243
buffer_store_dwordx4 v[96:99], v27, s[24:27], s53 offen offset:0 sc1
v_fma_f32 v164, -v33, v56, v164
v_fma_f32 v165, -v33, v57, v165
v_fma_f32 v166, -v33, v58, v166
v_fma_f32 v167, -v33, v59, v167
v_fma_f32 v228, -v33, v72, v228
v_fma_f32 v229, -v33, v73, v229
v_fma_f32 v230, -v33, v74, v230
v_fma_f32 v231, -v33, v75, v231
v_mul_f32 v80, v164, v164
v_mul_f32 v81, v165, v165
v_mul_f32 v82, v166, v166
v_mul_f32 v83, v167, v167
v_fma_f32 v80, v80, v41, v37
v_fma_f32 v81, v81, v41, v37
v_fma_f32 v82, v82, v41, v37
v_fma_f32 v83, v83, v41, v37
v_mul_f32 v80, v80, v164
v_mul_f32 v81, v81, v165
v_mul_f32 v82, v82, v166
v_mul_f32 v83, v83, v167
v_exp_f32 v80, v80
v_exp_f32 v81, v81
v_exp_f32 v82, v82
v_exp_f32 v83, v83
v_mul_f32 v228, v164, v228
v_mul_f32 v229, v165, v229
v_mul_f32 v230, v166, v230
v_mul_f32 v231, v167, v231
v_fma_f32 v80, v80, v45, v45
v_fma_f32 v81, v81, v45, v45
v_fma_f32 v82, v82, v45, v45
v_fma_f32 v83, v83, v45, v45
v_rcp_f32 v80, v80
v_rcp_f32 v81, v81
v_rcp_f32 v82, v82
v_rcp_f32 v83, v83
v_mul_f32 v228, v228, v80
v_mul_f32 v229, v229, v81
v_mul_f32 v230, v230, v82
v_mul_f32 v231, v231, v83
v_cvt_pk_bf16_f32 v100, v228, v229
v_cvt_pk_bf16_f32 v101, v230, v231
v_fma_f32 v180, -v33, v60, v180
v_fma_f32 v181, -v33, v61, v181
v_fma_f32 v182, -v33, v62, v182
s_barrier
s_mov_b32 s80, s60
s_mov_b32 s81, s61
s_mov_b32 s82, 7340032
s_mov_b32 s83, 0x20000
v_and_b32 v29, 31, v1
v_lshlrev_b32 v29, 11, v29
s_and_b32 s43, s35, 8
s_or_b32 s43, s43, 3
s_lshl_b32 s43, s43, 7
v_add_u32 v29, s43, v29
s_lshr_b32 s44, s2, 3
s_lshl_b32 s44, s44, 17
s_add_u32 s43, s44, 0
buffer_load_dword v30, v29, s[80:83], s43 offen
v_fma_f32 v183, -v33, v63, v183
v_fma_f32 v244, -v33, v76, v244
v_fma_f32 v245, -v33, v77, v245
v_fma_f32 v246, -v33, v78, v246
v_fma_f32 v247, -v33, v79, v247
v_mul_f32 v84, v180, v180
v_mul_f32 v85, v181, v181
v_mul_f32 v86, v182, v182
v_mul_f32 v87, v183, v183
v_fma_f32 v84, v84, v41, v37
v_fma_f32 v85, v85, v41, v37
v_fma_f32 v86, v86, v41, v37
v_fma_f32 v87, v87, v41, v37
v_mul_f32 v84, v84, v180
v_mul_f32 v85, v85, v181
v_mul_f32 v86, v86, v182
v_mul_f32 v87, v87, v183
v_exp_f32 v84, v84
v_exp_f32 v85, v85
v_exp_f32 v86, v86
v_exp_f32 v87, v87
v_mul_f32 v244, v180, v244
v_mul_f32 v245, v181, v245
v_mul_f32 v246, v182, v246
v_mul_f32 v247, v183, v247
v_fma_f32 v84, v84, v45, v45
v_fma_f32 v85, v85, v45, v45
v_fma_f32 v86, v86, v45, v45
v_fma_f32 v87, v87, v45, v45
v_rcp_f32 v84, v84
v_rcp_f32 v85, v85
v_rcp_f32 v86, v86
v_rcp_f32 v87, v87
v_mul_f32 v244, v244, v84
v_mul_f32 v245, v245, v85
v_mul_f32 v246, v246, v86
v_mul_f32 v247, v247, v87
v_cvt_pk_bf16_f32 v102, v244, v245
v_cvt_pk_bf16_f32 v103, v246, v247
buffer_store_dwordx4 v[100:103], v27, s[24:27], s53 offen offset:256 sc1
v_fma_f32 v168, -v34, v56, v168
v_fma_f32 v169, -v34, v57, v169
v_fma_f32 v170, -v34, v58, v170
v_fma_f32 v171, -v34, v59, v171
v_fma_f32 v232, -v34, v72, v232
v_fma_f32 v233, -v34, v73, v233
v_fma_f32 v234, -v34, v74, v234
v_fma_f32 v235, -v34, v75, v235
v_mul_f32 v80, v168, v168
v_mul_f32 v81, v169, v169
v_mul_f32 v82, v170, v170
v_mul_f32 v83, v171, v171
v_fma_f32 v80, v80, v42, v38
s_waitcnt vmcnt(2)
s_barrier
v_fma_f32 v81, v81, v42, v38
v_fma_f32 v82, v82, v42, v38
v_fma_f32 v83, v83, v42, v38
v_mul_f32 v80, v80, v168
v_mul_f32 v81, v81, v169
v_mul_f32 v82, v82, v170
v_mul_f32 v83, v83, v171
v_exp_f32 v80, v80
v_exp_f32 v81, v81
v_exp_f32 v82, v82
v_exp_f32 v83, v83
v_mul_f32 v232, v168, v232
v_mul_f32 v233, v169, v233
v_mul_f32 v234, v170, v234
v_mul_f32 v235, v171, v235
v_fma_f32 v80, v80, v46, v46
v_fma_f32 v81, v81, v46, v46
v_fma_f32 v82, v82, v46, v46
v_fma_f32 v83, v83, v46, v46
v_rcp_f32 v80, v80
v_rcp_f32 v81, v81
v_rcp_f32 v82, v82
v_rcp_f32 v83, v83
v_mul_f32 v232, v232, v80
v_mul_f32 v233, v233, v81
v_mul_f32 v234, v234, v82
v_mul_f32 v235, v235, v83
v_cvt_pk_bf16_f32 v104, v232, v233
v_cvt_pk_bf16_f32 v105, v234, v235
v_fma_f32 v184, -v34, v60, v184
v_fma_f32 v185, -v34, v61, v185
v_fma_f32 v186, -v34, v62, v186
v_fma_f32 v187, -v34, v63, v187
v_fma_f32 v248, -v34, v76, v248
v_fma_f32 v249, -v34, v77, v249
v_fma_f32 v250, -v34, v78, v250
v_fma_f32 v251, -v34, v79, v251
v_mul_f32 v84, v184, v184
v_mul_f32 v85, v185, v185
v_mul_f32 v86, v186, v186
v_mul_f32 v87, v187, v187
v_fma_f32 v84, v84, v42, v38
v_fma_f32 v85, v85, v42, v38
v_fma_f32 v86, v86, v42, v38
v_fma_f32 v87, v87, v42, v38
v_mul_f32 v84, v84, v184
v_mul_f32 v85, v85, v185
v_mul_f32 v86, v86, v186
v_mul_f32 v87, v87, v187
v_exp_f32 v84, v84
v_exp_f32 v85, v85
v_exp_f32 v86, v86
s_barrier
s_add_u32 s43, s34, 32
s_lshl_b32 s43, s43, 7
v_mov_b32 v21, s43
v_mov_b32 v23, 16
buffer_load_dword v22, v21, s[56:59], 0 offen sc1
v_exp_f32 v87, v87
v_mul_f32 v248, v184, v248
v_mul_f32 v249, v185, v249
v_mul_f32 v250, v186, v250
v_mul_f32 v251, v187, v251
v_fma_f32 v84, v84, v46, v46
v_fma_f32 v85, v85, v46, v46
v_fma_f32 v86, v86, v46, v46
v_fma_f32 v87, v87, v46, v46
v_rcp_f32 v84, v84
v_rcp_f32 v85, v85
v_rcp_f32 v86, v86
v_rcp_f32 v87, v87
v_mul_f32 v248, v248, v84
v_mul_f32 v249, v249, v85
v_mul_f32 v250, v250, v86
v_mul_f32 v251, v251, v87
v_cvt_pk_bf16_f32 v106, v248, v249
v_cvt_pk_bf16_f32 v107, v250, v251
buffer_store_dwordx4 v[104:107], v27, s[24:27], s53 offen offset:512 sc1
v_fma_f32 v172, -v35, v56, v172
v_fma_f32 v173, -v35, v57, v173
v_fma_f32 v174, -v35, v58, v174
v_fma_f32 v175, -v35, v59, v175
v_fma_f32 v236, -v35, v72, v236
v_fma_f32 v237, -v35, v73, v237
v_fma_f32 v238, -v35, v74, v238
v_fma_f32 v239, -v35, v75, v239
v_mul_f32 v80, v172, v172
v_mul_f32 v81, v173, v173
v_mul_f32 v82, v174, v174
v_mul_f32 v83, v175, v175
v_fma_f32 v80, v80, v43, v39
v_fma_f32 v81, v81, v43, v39
v_fma_f32 v82, v82, v43, v39
v_fma_f32 v83, v83, v43, v39
v_mul_f32 v80, v80, v172
v_mul_f32 v81, v81, v173
v_mul_f32 v82, v82, v174
v_mul_f32 v83, v83, v175
v_exp_f32 v80, v80
v_exp_f32 v81, v81
v_exp_f32 v82, v82
v_exp_f32 v83, v83
v_mul_f32 v236, v172, v236
v_mul_f32 v237, v173, v237
v_mul_f32 v238, v174, v238
v_mul_f32 v239, v175, v239
v_fma_f32 v80, v80, v47, v47
v_fma_f32 v81, v81, v47, v47
v_fma_f32 v82, v82, v47, v47
v_fma_f32 v83, v83, v47, v47
s_barrier
v_rcp_f32 v80, v80
v_rcp_f32 v81, v81
v_rcp_f32 v82, v82
v_rcp_f32 v83, v83
v_mul_f32 v236, v236, v80
v_mul_f32 v237, v237, v81
v_mul_f32 v238, v238, v82
v_mul_f32 v239, v239, v83
v_cvt_pk_bf16_f32 v108, v236, v237
v_cvt_pk_bf16_f32 v109, v238, v239
v_fma_f32 v188, -v35, v60, v188
v_fma_f32 v189, -v35, v61, v189
v_fma_f32 v190, -v35, v62, v190
v_fma_f32 v191, -v35, v63, v191
v_fma_f32 v252, -v35, v76, v252
v_fma_f32 v253, -v35, v77, v253
v_fma_f32 v254, -v35, v78, v254
v_fma_f32 v255, -v35, v79, v255
v_mul_f32 v84, v188, v188
v_mul_f32 v85, v189, v189
v_mul_f32 v86, v190, v190
v_mul_f32 v87, v191, v191
v_fma_f32 v84, v84, v43, v39
v_fma_f32 v85, v85, v43, v39
v_fma_f32 v86, v86, v43, v39
v_fma_f32 v87, v87, v43, v39
v_mul_f32 v84, v84, v188
v_mul_f32 v85, v85, v189
v_mul_f32 v86, v86, v190
v_mul_f32 v87, v87, v191
v_exp_f32 v84, v84
v_exp_f32 v85, v85
v_exp_f32 v86, v86
v_exp_f32 v87, v87
v_mul_f32 v252, v188, v252
v_mul_f32 v253, v189, v253
v_mul_f32 v254, v190, v254
v_mul_f32 v255, v191, v255
v_fma_f32 v84, v84, v47, v47
v_fma_f32 v85, v85, v47, v47
v_fma_f32 v86, v86, v47, v47
v_fma_f32 v87, v87, v47, v47
v_rcp_f32 v84, v84
v_rcp_f32 v85, v85
v_rcp_f32 v86, v86
v_rcp_f32 v87, v87
v_mul_f32 v252, v252, v84
v_mul_f32 v253, v253, v85
v_mul_f32 v254, v254, v86
v_mul_f32 v255, v255, v87
v_cvt_pk_bf16_f32 v110, v252, v253
v_cvt_pk_bf16_f32 v111, v254, v255
buffer_store_dwordx4 v[108:111], v27, s[24:27], s53 offen offset:768 sc1
s_mov_b32 s41, 0x10000
s_waitcnt vmcnt(2)
s_branch Lpf_129
Lpoll_127:
s_waitcnt vmcnt(0)
Lpf_129:
v_cmp_ne_u32 vcc, v23, v22
s_nop 4
s_cbranch_vccz Lpok_128
buffer_load_dword v22, v21, s[56:59], 0 offen sc1
s_sub_u32 s41, s41, 1
s_cmp_lg_u32 s41, 0
s_cbranch_scc1 Lpoll_127
s_waitcnt vmcnt(0)
Lpok_128:
s_barrier
v_lshlrev_b32 v128, 16, v192
v_and_b32 v129, 0xffff0000, v192
v_lshlrev_b32 v130, 16, v193
v_and_b32 v131, 0xffff0000, v193
v_lshlrev_b32 v132, 16, v194
v_and_b32 v133, 0xffff0000, v194
v_lshlrev_b32 v134, 16, v195
v_and_b32 v135, 0xffff0000, v195
v_lshlrev_b32 v136, 16, v196
v_and_b32 v137, 0xffff0000, v196
v_lshlrev_b32 v138, 16, v197
v_and_b32 v139, 0xffff0000, v197
v_lshlrev_b32 v140, 16, v198
v_and_b32 v141, 0xffff0000, v198
v_lshlrev_b32 v142, 16, v199
v_and_b32 v143, 0xffff0000, v199
v_lshlrev_b32 v144, 16, v200
v_and_b32 v145, 0xffff0000, v200
v_lshlrev_b32 v146, 16, v201
v_and_b32 v147, 0xffff0000, v201
v_lshlrev_b32 v148, 16, v202
v_and_b32 v149, 0xffff0000, v202
v_lshlrev_b32 v150, 16, v203
v_and_b32 v151, 0xffff0000, v203
v_lshlrev_b32 v152, 16, v204
v_and_b32 v153, 0xffff0000, v204
v_lshlrev_b32 v154, 16, v205
v_and_b32 v155, 0xffff0000, v205
v_lshlrev_b32 v156, 16, v206
v_and_b32 v157, 0xffff0000, v206
v_lshlrev_b32 v158, 16, v207
v_and_b32 v159, 0xffff0000, v207
s_waitcnt vmcnt(0)
s_barrier
s_add_u32 s43, s34, 48
s_lshl_b32 s43, s43, 7
v_mov_b32 v22, s43
v_mov_b32 v23, 1
s_mov_b64 exec, 1
buffer_atomic_add v23, v22, s[56:59], 0 offen sc1
s_mov_b64 exec, -1
s_branch Lw_130
Lr_131:
v_mov_b32 v192, 0
v_mov_b32 v193, 0
v_mov_b32 v194, 0
v_mov_b32 v195, 0
v_mov_b32 v196, 0
v_mov_b32 v197, 0
v_mov_b32 v198, 0
v_mov_b32 v199, 0
v_mov_b32 v200, 0
v_mov_b32 v201, 0
v_mov_b32 v202, 0
v_mov_b32 v203, 0
v_mov_b32 v204, 0
v_mov_b32 v205, 0
v_mov_b32 v206, 0
v_mov_b32 v207, 0
v_mov_b32 v208, 0
v_mov_b32 v209, 0
v_mov_b32 v210, 0
v_mov_b32 v211, 0
v_mov_b32 v212, 0
v_mov_b32 v213, 0
v_mov_b32 v214, 0
v_mov_b32 v215, 0
v_mov_b32 v216, 0
v_mov_b32 v217, 0
v_mov_b32 v218, 0
v_mov_b32 v219, 0
v_mov_b32 v220, 0
v_mov_b32 v221, 0
v_mov_b32 v222, 0
v_mov_b32 v223, 0
s_barrier
.p2align 3
LK4_125:
s_setprio 1
ds_read_b64_tr_b16 v[64:65], v7 offset:0
ds_read_b128 v[32:35], v3 offset:0
ds_read_b64_tr_b16 v[66:67], v7 offset:2048
ds_read_b128 v[36:39], v3 offset:256
ds_read_b64_tr_b16 v[68:69], v8 offset:0
ds_read_b128 v[40:43], v3 offset:512
ds_read_b64_tr_b16 v[70:71], v8 offset:2048
ds_read_b128 v[44:47], v3 offset:768
ds_read_b64_tr_b16 v[72:73], v7 offset:4096
ds_read_b128 v[48:51], v3 offset:8192
ds_read_b64_tr_b16 v[74:75], v7 offset:6144
ds_read_b128 v[52:55], v3 offset:8448
ds_read_b64_tr_b16 v[76:77], v8 offset:4096
ds_read_b128 v[56:59], v3 offset:8704
ds_read_b64_tr_b16 v[78:79], v8 offset:6144
ds_read_b128 v[60:63], v3 offset:8960
s_waitcnt vmcnt(0) lgkmcnt(0)
s_barrier
v_mfma_f32_16x16x32_bf16 v[128:131], v[64:67], v[32:35], v[128:131]
ds_read_b64_tr_b16 v[160:161], v7 offset:32768
v_mfma_f32_16x16x32_bf16 v[132:135], v[68:71], v[32:35], v[132:135]
ds_read_b128 v[96:99], v3 offset:32768
v_mfma_f32_16x16x32_bf16 v[136:139], v[64:67], v[36:39], v[136:139]
ds_read_b64_tr_b16 v[162:163], v7 offset:34816
v_mfma_f32_16x16x32_bf16 v[140:143], v[68:71], v[36:39], v[140:143]
ds_read_b128 v[100:103], v3 offset:33024
v_mfma_f32_16x16x32_bf16 v[144:147], v[64:67], v[40:43], v[144:147]
ds_read_b64_tr_b16 v[164:165], v8 offset:32768
v_mfma_f32_16x16x32_bf16 v[148:151], v[68:71], v[40:43], v[148:151]
ds_read_b128 v[104:107], v3 offset:33280
v_mfma_f32_16x16x32_bf16 v[152:155], v[64:67], v[44:47], v[152:155]
ds_read_b64_tr_b16 v[166:167], v8 offset:34816
v_mfma_f32_16x16x32_bf16 v[156:159], v[68:71], v[44:47], v[156:159]
ds_read_b128 v[108:111], v3 offset:33536
v_mfma_f32_16x16x32_bf16 v[128:131], v[72:75], v[48:51], v[128:131]
ds_read_b64_tr_b16 v[168:169], v7 offset:36864
v_mfma_f32_16x16x32_bf16 v[132:135], v[76:79], v[48:51], v[132:135]
ds_read_b128 v[112:115], v3 offset:40960
v_mfma_f32_16x16x32_bf16 v[136:139], v[72:75], v[52:55], v[136:139]
ds_read_b64_tr_b16 v[170:171], v7 offset:38912
v_mfma_f32_16x16x32_bf16 v[140:143], v[76:79], v[52:55], v[140:143]
ds_read_b128 v[116:119], v3 offset:41216
v_mfma_f32_16x16x32_bf16 v[144:147], v[72:75], v[56:59], v[144:147]
ds_read_b64_tr_b16 v[172:173], v8 offset:36864
v_mfma_f32_16x16x32_bf16 v[148:151], v[76:79], v[56:59], v[148:151]
ds_read_b128 v[120:123], v3 offset:41472
v_mfma_f32_16x16x32_bf16 v[152:155], v[72:75], v[60:63], v[152:155]
ds_read_b64_tr_b16 v[174:175], v8 offset:38912
v_mfma_f32_16x16x32_bf16 v[156:159], v[76:79], v[60:63], v[156:159]
ds_read_b128 v[124:127], v3 offset:41728
s_waitcnt lgkmcnt(0)
s_barrier
v_mfma_f32_16x16x32_bf16 v[128:131], v[160:163], v[96:99], v[128:131]
ds_read_b64_tr_b16 v[64:65], v5 offset:0
v_mfma_f32_16x16x32_bf16 v[132:135], v[164:167], v[96:99], v[132:135]
ds_read_b128 v[32:35], v2 offset:0
v_mfma_f32_16x16x32_bf16 v[136:139], v[160:163], v[100:103], v[136:139]
ds_read_b64_tr_b16 v[66:67], v5 offset:2048
v_mfma_f32_16x16x32_bf16 v[140:143], v[164:167], v[100:103], v[140:143]
ds_read_b128 v[36:39], v2 offset:256
v_mfma_f32_16x16x32_bf16 v[144:147], v[160:163], v[104:107], v[144:147]
ds_read_b64_tr_b16 v[68:69], v6 offset:0
v_mfma_f32_16x16x32_bf16 v[148:151], v[164:167], v[104:107], v[148:151]
ds_read_b128 v[40:43], v2 offset:512
v_mfma_f32_16x16x32_bf16 v[152:155], v[160:163], v[108:111], v[152:155]
ds_read_b64_tr_b16 v[70:71], v6 offset:2048
v_mfma_f32_16x16x32_bf16 v[156:159], v[164:167], v[108:111], v[156:159]
ds_read_b128 v[44:47], v2 offset:768
v_mfma_f32_16x16x32_bf16 v[128:131], v[168:171], v[112:115], v[128:131]
ds_read_b64_tr_b16 v[72:73], v5 offset:4096
v_mfma_f32_16x16x32_bf16 v[132:135], v[172:175], v[112:115], v[132:135]
ds_read_b128 v[48:51], v2 offset:8192
v_mfma_f32_16x16x32_bf16 v[136:139], v[168:171], v[116:119], v[136:139]
ds_read_b64_tr_b16 v[74:75], v5 offset:6144
v_mfma_f32_16x16x32_bf16 v[140:143], v[172:175], v[116:119], v[140:143]
ds_read_b128 v[52:55], v2 offset:8448
v_mfma_f32_16x16x32_bf16 v[144:147], v[168:171], v[120:123], v[144:147]
ds_read_b64_tr_b16 v[76:77], v6 offset:4096
v_mfma_f32_16x16x32_bf16 v[148:151], v[172:175], v[120:123], v[148:151]
ds_read_b128 v[56:59], v2 offset:8704
v_mfma_f32_16x16x32_bf16 v[152:155], v[168:171], v[124:127], v[152:155]
ds_read_b64_tr_b16 v[78:79], v6 offset:6144
v_mfma_f32_16x16x32_bf16 v[156:159], v[172:175], v[124:127], v[156:159]
ds_read_b128 v[60:63], v2 offset:8960
s_waitcnt lgkmcnt(0)
s_barrier
v_mfma_f32_16x16x32_bf16 v[128:131], v[64:67], v[32:35], v[128:131]
ds_read_b64_tr_b16 v[160:161], v5 offset:32768
v_mfma_f32_16x16x32_bf16 v[132:135], v[68:71], v[32:35], v[132:135]
ds_read_b128 v[96:99], v2 offset:32768
v_mfma_f32_16x16x32_bf16 v[136:139], v[64:67], v[36:39], v[136:139]
ds_read_b64_tr_b16 v[162:163], v5 offset:34816
v_mfma_f32_16x16x32_bf16 v[140:143], v[68:71], v[36:39], v[140:143]
ds_read_b128 v[100:103], v2 offset:33024
v_mfma_f32_16x16x32_bf16 v[144:147], v[64:67], v[40:43], v[144:147]
ds_read_b64_tr_b16 v[164:165], v6 offset:32768
v_mfma_f32_16x16x32_bf16 v[148:151], v[68:71], v[40:43], v[148:151]
ds_read_b128 v[104:107], v2 offset:33280
v_mfma_f32_16x16x32_bf16 v[152:155], v[64:67], v[44:47], v[152:155]
ds_read_b64_tr_b16 v[166:167], v6 offset:34816
v_mfma_f32_16x16x32_bf16 v[156:159], v[68:71], v[44:47], v[156:159]
ds_read_b128 v[108:111], v2 offset:33536
v_mfma_f32_16x16x32_bf16 v[128:131], v[72:75], v[48:51], v[128:131]
ds_read_b64_tr_b16 v[168:169], v5 offset:36864
v_mfma_f32_16x16x32_bf16 v[132:135], v[76:79], v[48:51], v[132:135]
ds_read_b128 v[112:115], v2 offset:40960
v_mfma_f32_16x16x32_bf16 v[136:139], v[72:75], v[52:55], v[136:139]
ds_read_b64_tr_b16 v[170:171], v5 offset:38912
v_mfma_f32_16x16x32_bf16 v[140:143], v[76:79], v[52:55], v[140:143]
ds_read_b128 v[116:119], v2 offset:41216
v_mfma_f32_16x16x32_bf16 v[144:147], v[72:75], v[56:59], v[144:147]
ds_read_b64_tr_b16 v[172:173], v6 offset:36864
v_mfma_f32_16x16x32_bf16 v[148:151], v[76:79], v[56:59], v[148:151]
ds_read_b128 v[120:123], v2 offset:41472
v_mfma_f32_16x16x32_bf16 v[152:155], v[72:75], v[60:63], v[152:155]
ds_read_b64_tr_b16 v[174:175], v6 offset:38912
v_mfma_f32_16x16x32_bf16 v[156:159], v[76:79], v[60:63], v[156:159]
ds_read_b128 v[124:127], v2 offset:41728
s_waitcnt lgkmcnt(0)
s_barrier
v_mfma_f32_16x16x32_bf16 v[128:131], v[160:163], v[96:99], v[128:131]
ds_read_b64_tr_b16 v[64:65], v7 offset:0
v_mfma_f32_16x16x32_bf16 v[132:135], v[164:167], v[96:99], v[132:135]
ds_read_b128 v[32:35], v3 offset:0
v_mfma_f32_16x16x32_bf16 v[136:139], v[160:163], v[100:103], v[136:139]
ds_read_b64_tr_b16 v[66:67], v7 offset:2048
v_mfma_f32_16x16x32_bf16 v[140:143], v[164:167], v[100:103], v[140:143]
ds_read_b128 v[36:39], v3 offset:256
v_mfma_f32_16x16x32_bf16 v[144:147], v[160:163], v[104:107], v[144:147]
ds_read_b64_tr_b16 v[68:69], v8 offset:0
v_mfma_f32_16x16x32_bf16 v[148:151], v[164:167], v[104:107], v[148:151]
ds_read_b128 v[40:43], v3 offset:512
v_mfma_f32_16x16x32_bf16 v[152:155], v[160:163], v[108:111], v[152:155]
ds_read_b64_tr_b16 v[70:71], v8 offset:2048
v_mfma_f32_16x16x32_bf16 v[156:159], v[164:167], v[108:111], v[156:159]
ds_read_b128 v[44:47], v3 offset:768
v_mfma_f32_16x16x32_bf16 v[128:131], v[168:171], v[112:115], v[128:131]
ds_read_b64_tr_b16 v[80:81], v7 offset:8192
v_mfma_f32_16x16x32_bf16 v[132:135], v[172:175], v[112:115], v[132:135]
ds_read_b64_tr_b16 v[82:83], v7 offset:10240
v_mfma_f32_16x16x32_bf16 v[136:139], v[168:171], v[116:119], v[136:139]
ds_read_b64_tr_b16 v[84:85], v8 offset:8192
v_mfma_f32_16x16x32_bf16 v[140:143], v[172:175], v[116:119], v[140:143]
ds_read_b64_tr_b16 v[86:87], v8 offset:10240
v_mfma_f32_16x16x32_bf16 v[144:147], v[168:171], v[120:123], v[144:147]
ds_read_b64_tr_b16 v[72:73], v7 offset:4096
v_mfma_f32_16x16x32_bf16 v[148:151], v[172:175], v[120:123], v[148:151]
ds_read_b128 v[48:51], v3 offset:8192
v_mfma_f32_16x16x32_bf16 v[152:155], v[168:171], v[124:127], v[152:155]
ds_read_b64_tr_b16 v[74:75], v7 offset:6144
v_mfma_f32_16x16x32_bf16 v[156:159], v[172:175], v[124:127], v[156:159]
ds_read_b128 v[52:55], v3 offset:8448
ds_read_b64_tr_b16 v[76:77], v8 offset:4096
ds_read_b128 v[56:59], v3 offset:8704
ds_read_b64_tr_b16 v[78:79], v8 offset:6144
ds_read_b128 v[60:63], v3 offset:8960
ds_read_b64_tr_b16 v[88:89], v7 offset:12288
ds_read_b64_tr_b16 v[90:91], v7 offset:14336
ds_read_b64_tr_b16 v[92:93], v8 offset:12288
ds_read_b64_tr_b16 v[94:95], v8 offset:14336
s_mov_b32 s41, 4
.p2align 3
Lk4_132:
s_waitcnt lgkmcnt(0)
s_barrier
v_mfma_f32_16x16x32_bf16 v[128:131], v[64:67], v[32:35], v[128:131]
ds_read_b64_tr_b16 v[160:161], v7 offset:32768
v_mfma_f32_16x16x32_bf16 v[132:135], v[68:71], v[32:35], v[132:135]
ds_read_b128 v[96:99], v3 offset:32768
v_mfma_f32_16x16x32_bf16 v[192:195], v[80:83], v[32:35], v[192:195]
ds_read_b64_tr_b16 v[162:163], v7 offset:34816
v_mfma_f32_16x16x32_bf16 v[196:199], v[84:87], v[32:35], v[196:199]
ds_read_b128 v[100:103], v3 offset:33024
v_mfma_f32_16x16x32_bf16 v[136:139], v[64:67], v[36:39], v[136:139]
ds_read_b64_tr_b16 v[164:165], v8 offset:32768
v_mfma_f32_16x16x32_bf16 v[140:143], v[68:71], v[36:39], v[140:143]
ds_read_b128 v[104:107], v3 offset:33280
v_mfma_f32_16x16x32_bf16 v[200:203], v[80:83], v[36:39], v[200:203]
ds_read_b64_tr_b16 v[166:167], v8 offset:34816
v_mfma_f32_16x16x32_bf16 v[204:207], v[84:87], v[36:39], v[204:207]
ds_read_b128 v[108:111], v3 offset:33536
v_mfma_f32_16x16x32_bf16 v[144:147], v[64:67], v[40:43], v[144:147]
ds_read_b64_tr_b16 v[176:177], v7 offset:40960
v_mfma_f32_16x16x32_bf16 v[148:151], v[68:71], v[40:43], v[148:151]
ds_read_b64_tr_b16 v[178:179], v7 offset:43008
v_mfma_f32_16x16x32_bf16 v[208:211], v[80:83], v[40:43], v[208:211]
ds_read_b64_tr_b16 v[180:181], v8 offset:40960
v_mfma_f32_16x16x32_bf16 v[212:215], v[84:87], v[40:43], v[212:215]
ds_read_b64_tr_b16 v[182:183], v8 offset:43008
v_mfma_f32_16x16x32_bf16 v[152:155], v[64:67], v[44:47], v[152:155]
ds_read_b64_tr_b16 v[168:169], v7 offset:36864
v_mfma_f32_16x16x32_bf16 v[156:159], v[68:71], v[44:47], v[156:159]
ds_read_b128 v[112:115], v3 offset:40960
v_mfma_f32_16x16x32_bf16 v[216:219], v[80:83], v[44:47], v[216:219]
ds_read_b64_tr_b16 v[170:171], v7 offset:38912
v_mfma_f32_16x16x32_bf16 v[220:223], v[84:87], v[44:47], v[220:223]
ds_read_b128 v[116:119], v3 offset:41216
v_mfma_f32_16x16x32_bf16 v[128:131], v[72:75], v[48:51], v[128:131]
ds_read_b64_tr_b16 v[172:173], v8 offset:36864
v_mfma_f32_16x16x32_bf16 v[132:135], v[76:79], v[48:51], v[132:135]
ds_read_b128 v[120:123], v3 offset:41472
v_mfma_f32_16x16x32_bf16 v[192:195], v[88:91], v[48:51], v[192:195]
ds_read_b64_tr_b16 v[174:175], v8 offset:38912
v_mfma_f32_16x16x32_bf16 v[196:199], v[92:95], v[48:51], v[196:199]
ds_read_b128 v[124:127], v3 offset:41728
v_mfma_f32_16x16x32_bf16 v[136:139], v[72:75], v[52:55], v[136:139]
ds_read_b64_tr_b16 v[184:185], v7 offset:45056
v_mfma_f32_16x16x32_bf16 v[140:143], v[76:79], v[52:55], v[140:143]
ds_read_b64_tr_b16 v[186:187], v7 offset:47104
v_mfma_f32_16x16x32_bf16 v[200:203], v[88:91], v[52:55], v[200:203]
ds_read_b64_tr_b16 v[188:189], v8 offset:45056
v_mfma_f32_16x16x32_bf16 v[204:207], v[92:95], v[52:55], v[204:207]
ds_read_b64_tr_b16 v[190:191], v8 offset:47104
v_mfma_f32_16x16x32_bf16 v[144:147], v[72:75], v[56:59], v[144:147]
v_mfma_f32_16x16x32_bf16 v[148:151], v[76:79], v[56:59], v[148:151]
v_mfma_f32_16x16x32_bf16 v[208:211], v[88:91], v[56:59], v[208:211]
v_mfma_f32_16x16x32_bf16 v[212:215], v[92:95], v[56:59], v[212:215]
v_mfma_f32_16x16x32_bf16 v[152:155], v[72:75], v[60:63], v[152:155]
v_mfma_f32_16x16x32_bf16 v[156:159], v[76:79], v[60:63], v[156:159]
v_mfma_f32_16x16x32_bf16 v[216:219], v[88:91], v[60:63], v[216:219]
v_mfma_f32_16x16x32_bf16 v[220:223], v[92:95], v[60:63], v[220:223]
s_waitcnt lgkmcnt(0)
s_barrier
v_mfma_f32_16x16x32_bf16 v[128:131], v[160:163], v[96:99], v[128:131]
ds_read_b64_tr_b16 v[64:65], v5 offset:0
v_mfma_f32_16x16x32_bf16 v[132:135], v[164:167], v[96:99], v[132:135]
ds_read_b128 v[32:35], v2 offset:0
v_mfma_f32_16x16x32_bf16 v[192:195], v[176:179], v[96:99], v[192:195]
ds_read_b64_tr_b16 v[66:67], v5 offset:2048
v_mfma_f32_16x16x32_bf16 v[196:199], v[180:183], v[96:99], v[196:199]
ds_read_b128 v[36:39], v2 offset:256
v_mfma_f32_16x16x32_bf16 v[136:139], v[160:163], v[100:103], v[136:139]
ds_read_b64_tr_b16 v[68:69], v6 offset:0
v_mfma_f32_16x16x32_bf16 v[140:143], v[164:167], v[100:103], v[140:143]
ds_read_b128 v[40:43], v2 offset:512
v_mfma_f32_16x16x32_bf16 v[200:203], v[176:179], v[100:103], v[200:203]
ds_read_b64_tr_b16 v[70:71], v6 offset:2048
v_mfma_f32_16x16x32_bf16 v[204:207], v[180:183], v[100:103], v[204:207]
ds_read_b128 v[44:47], v2 offset:768
v_mfma_f32_16x16x32_bf16 v[144:147], v[160:163], v[104:107], v[144:147]
ds_read_b64_tr_b16 v[80:81], v5 offset:8192
v_mfma_f32_16x16x32_bf16 v[148:151], v[164:167], v[104:107], v[148:151]
ds_read_b64_tr_b16 v[82:83], v5 offset:10240
v_mfma_f32_16x16x32_bf16 v[208:211], v[176:179], v[104:107], v[208:211]
ds_read_b64_tr_b16 v[84:85], v6 offset:8192
v_mfma_f32_16x16x32_bf16 v[212:215], v[180:183], v[104:107], v[212:215]
ds_read_b64_tr_b16 v[86:87], v6 offset:10240
v_mfma_f32_16x16x32_bf16 v[152:155], v[160:163], v[108:111], v[152:155]
ds_read_b64_tr_b16 v[72:73], v5 offset:4096
v_mfma_f32_16x16x32_bf16 v[156:159], v[164:167], v[108:111], v[156:159]
ds_read_b128 v[48:51], v2 offset:8192
v_mfma_f32_16x16x32_bf16 v[216:219], v[176:179], v[108:111], v[216:219]
ds_read_b64_tr_b16 v[74:75], v5 offset:6144
v_mfma_f32_16x16x32_bf16 v[220:223], v[180:183], v[108:111], v[220:223]
ds_read_b128 v[52:55], v2 offset:8448
v_mfma_f32_16x16x32_bf16 v[128:131], v[168:171], v[112:115], v[128:131]
ds_read_b64_tr_b16 v[76:77], v6 offset:4096
v_mfma_f32_16x16x32_bf16 v[132:135], v[172:175], v[112:115], v[132:135]
ds_read_b128 v[56:59], v2 offset:8704
v_mfma_f32_16x16x32_bf16 v[192:195], v[184:187], v[112:115], v[192:195]
ds_read_b64_tr_b16 v[78:79], v6 offset:6144
v_mfma_f32_16x16x32_bf16 v[196:199], v[188:191], v[112:115], v[196:199]
ds_read_b128 v[60:63], v2 offset:8960
v_mfma_f32_16x16x32_bf16 v[136:139], v[168:171], v[116:119], v[136:139]
ds_read_b64_tr_b16 v[88:89], v5 offset:12288
v_mfma_f32_16x16x32_bf16 v[140:143], v[172:175], v[116:119], v[140:143]
ds_read_b64_tr_b16 v[90:91], v5 offset:14336
v_mfma_f32_16x16x32_bf16 v[200:203], v[184:187], v[116:119], v[200:203]
ds_read_b64_tr_b16 v[92:93], v6 offset:12288
v_mfma_f32_16x16x32_bf16 v[204:207], v[188:191], v[116:119], v[204:207]
ds_read_b64_tr_b16 v[94:95], v6 offset:14336
v_mfma_f32_16x16x32_bf16 v[144:147], v[168:171], v[120:123], v[144:147]
v_mfma_f32_16x16x32_bf16 v[148:151], v[172:175], v[120:123], v[148:151]
v_mfma_f32_16x16x32_bf16 v[208:211], v[184:187], v[120:123], v[208:211]
v_mfma_f32_16x16x32_bf16 v[212:215], v[188:191], v[120:123], v[212:215]
v_mfma_f32_16x16x32_bf16 v[152:155], v[168:171], v[124:127], v[152:155]
v_mfma_f32_16x16x32_bf16 v[156:159], v[172:175], v[124:127], v[156:159]
v_mfma_f32_16x16x32_bf16 v[216:219], v[184:187], v[124:127], v[216:219]
v_mfma_f32_16x16x32_bf16 v[220:223], v[188:191], v[124:127], v[220:223]
s_waitcnt lgkmcnt(0)
s_barrier
v_mfma_f32_16x16x32_bf16 v[128:131], v[64:67], v[32:35], v[128:131]
ds_read_b64_tr_b16 v[160:161], v5 offset:32768
v_mfma_f32_16x16x32_bf16 v[132:135], v[68:71], v[32:35], v[132:135]
ds_read_b128 v[96:99], v2 offset:32768
v_mfma_f32_16x16x32_bf16 v[192:195], v[80:83], v[32:35], v[192:195]
ds_read_b64_tr_b16 v[162:163], v5 offset:34816
v_mfma_f32_16x16x32_bf16 v[196:199], v[84:87], v[32:35], v[196:199]
ds_read_b128 v[100:103], v2 offset:33024
v_mfma_f32_16x16x32_bf16 v[136:139], v[64:67], v[36:39], v[136:139]
ds_read_b64_tr_b16 v[164:165], v6 offset:32768
v_mfma_f32_16x16x32_bf16 v[140:143], v[68:71], v[36:39], v[140:143]
ds_read_b128 v[104:107], v2 offset:33280
v_mfma_f32_16x16x32_bf16 v[200:203], v[80:83], v[36:39], v[200:203]
ds_read_b64_tr_b16 v[166:167], v6 offset:34816
v_mfma_f32_16x16x32_bf16 v[204:207], v[84:87], v[36:39], v[204:207]
ds_read_b128 v[108:111], v2 offset:33536
v_mfma_f32_16x16x32_bf16 v[144:147], v[64:67], v[40:43], v[144:147]
ds_read_b64_tr_b16 v[176:177], v5 offset:40960
v_mfma_f32_16x16x32_bf16 v[148:151], v[68:71], v[40:43], v[148:151]
ds_read_b64_tr_b16 v[178:179], v5 offset:43008
v_mfma_f32_16x16x32_bf16 v[208:211], v[80:83], v[40:43], v[208:211]
ds_read_b64_tr_b16 v[180:181], v6 offset:40960
v_mfma_f32_16x16x32_bf16 v[212:215], v[84:87], v[40:43], v[212:215]
ds_read_b64_tr_b16 v[182:183], v6 offset:43008
v_mfma_f32_16x16x32_bf16 v[152:155], v[64:67], v[44:47], v[152:155]
ds_read_b64_tr_b16 v[168:169], v5 offset:36864
v_mfma_f32_16x16x32_bf16 v[156:159], v[68:71], v[44:47], v[156:159]
ds_read_b128 v[112:115], v2 offset:40960
v_mfma_f32_16x16x32_bf16 v[216:219], v[80:83], v[44:47], v[216:219]
ds_read_b64_tr_b16 v[170:171], v5 offset:38912
v_mfma_f32_16x16x32_bf16 v[220:223], v[84:87], v[44:47], v[220:223]
ds_read_b128 v[116:119], v2 offset:41216
v_mfma_f32_16x16x32_bf16 v[128:131], v[72:75], v[48:51], v[128:131]
ds_read_b64_tr_b16 v[172:173], v6 offset:36864
v_mfma_f32_16x16x32_bf16 v[132:135], v[76:79], v[48:51], v[132:135]
ds_read_b128 v[120:123], v2 offset:41472
v_mfma_f32_16x16x32_bf16 v[192:195], v[88:91], v[48:51], v[192:195]
ds_read_b64_tr_b16 v[174:175], v6 offset:38912
v_mfma_f32_16x16x32_bf16 v[196:199], v[92:95], v[48:51], v[196:199]
ds_read_b128 v[124:127], v2 offset:41728
v_mfma_f32_16x16x32_bf16 v[136:139], v[72:75], v[52:55], v[136:139]
ds_read_b64_tr_b16 v[184:185], v5 offset:45056
v_mfma_f32_16x16x32_bf16 v[140:143], v[76:79], v[52:55], v[140:143]
ds_read_b64_tr_b16 v[186:187], v5 offset:47104
v_mfma_f32_16x16x32_bf16 v[200:203], v[88:91], v[52:55], v[200:203]
ds_read_b64_tr_b16 v[188:189], v6 offset:45056
v_mfma_f32_16x16x32_bf16 v[204:207], v[92:95], v[52:55], v[204:207]
ds_read_b64_tr_b16 v[190:191], v6 offset:47104
v_mfma_f32_16x16x32_bf16 v[144:147], v[72:75], v[56:59], v[144:147]
v_mfma_f32_16x16x32_bf16 v[148:151], v[76:79], v[56:59], v[148:151]
v_mfma_f32_16x16x32_bf16 v[208:211], v[88:91], v[56:59], v[208:211]
v_mfma_f32_16x16x32_bf16 v[212:215], v[92:95], v[56:59], v[212:215]
v_mfma_f32_16x16x32_bf16 v[152:155], v[72:75], v[60:63], v[152:155]
v_mfma_f32_16x16x32_bf16 v[156:159], v[76:79], v[60:63], v[156:159]
v_mfma_f32_16x16x32_bf16 v[216:219], v[88:91], v[60:63], v[216:219]
v_mfma_f32_16x16x32_bf16 v[220:223], v[92:95], v[60:63], v[220:223]
s_waitcnt lgkmcnt(0)
s_barrier
v_mfma_f32_16x16x32_bf16 v[128:131], v[160:163], v[96:99], v[128:131]
ds_read_b64_tr_b16 v[64:65], v7 offset:0
v_mfma_f32_16x16x32_bf16 v[132:135], v[164:167], v[96:99], v[132:135]
ds_read_b128 v[32:35], v3 offset:0
v_mfma_f32_16x16x32_bf16 v[192:195], v[176:179], v[96:99], v[192:195]
ds_read_b64_tr_b16 v[66:67], v7 offset:2048
v_mfma_f32_16x16x32_bf16 v[196:199], v[180:183], v[96:99], v[196:199]
ds_read_b128 v[36:39], v3 offset:256
v_mfma_f32_16x16x32_bf16 v[136:139], v[160:163], v[100:103], v[136:139]
ds_read_b64_tr_b16 v[68:69], v8 offset:0
v_mfma_f32_16x16x32_bf16 v[140:143], v[164:167], v[100:103], v[140:143]
ds_read_b128 v[40:43], v3 offset:512
v_mfma_f32_16x16x32_bf16 v[200:203], v[176:179], v[100:103], v[200:203]
ds_read_b64_tr_b16 v[70:71], v8 offset:2048
v_mfma_f32_16x16x32_bf16 v[204:207], v[180:183], v[100:103], v[204:207]
ds_read_b128 v[44:47], v3 offset:768
v_mfma_f32_16x16x32_bf16 v[144:147], v[160:163], v[104:107], v[144:147]
ds_read_b64_tr_b16 v[80:81], v7 offset:8192
v_mfma_f32_16x16x32_bf16 v[148:151], v[164:167], v[104:107], v[148:151]
ds_read_b64_tr_b16 v[82:83], v7 offset:10240
v_mfma_f32_16x16x32_bf16 v[208:211], v[176:179], v[104:107], v[208:211]
ds_read_b64_tr_b16 v[84:85], v8 offset:8192
v_mfma_f32_16x16x32_bf16 v[212:215], v[180:183], v[104:107], v[212:215]
ds_read_b64_tr_b16 v[86:87], v8 offset:10240
v_mfma_f32_16x16x32_bf16 v[152:155], v[160:163], v[108:111], v[152:155]
ds_read_b64_tr_b16 v[72:73], v7 offset:4096
v_mfma_f32_16x16x32_bf16 v[156:159], v[164:167], v[108:111], v[156:159]
ds_read_b128 v[48:51], v3 offset:8192
v_mfma_f32_16x16x32_bf16 v[216:219], v[176:179], v[108:111], v[216:219]
ds_read_b64_tr_b16 v[74:75], v7 offset:6144
v_mfma_f32_16x16x32_bf16 v[220:223], v[180:183], v[108:111], v[220:223]
ds_read_b128 v[52:55], v3 offset:8448
v_mfma_f32_16x16x32_bf16 v[128:131], v[168:171], v[112:115], v[128:131]
ds_read_b64_tr_b16 v[76:77], v8 offset:4096
v_mfma_f32_16x16x32_bf16 v[132:135], v[172:175], v[112:115], v[132:135]
ds_read_b128 v[56:59], v3 offset:8704
v_mfma_f32_16x16x32_bf16 v[192:195], v[184:187], v[112:115], v[192:195]
ds_read_b64_tr_b16 v[78:79], v8 offset:6144
v_mfma_f32_16x16x32_bf16 v[196:199], v[188:191], v[112:115], v[196:199]
ds_read_b128 v[60:63], v3 offset:8960
v_mfma_f32_16x16x32_bf16 v[136:139], v[168:171], v[116:119], v[136:139]
ds_read_b64_tr_b16 v[88:89], v7 offset:12288
v_mfma_f32_16x16x32_bf16 v[140:143], v[172:175], v[116:119], v[140:143]
ds_read_b64_tr_b16 v[90:91], v7 offset:14336
v_mfma_f32_16x16x32_bf16 v[200:203], v[184:187], v[116:119], v[200:203]
ds_read_b64_tr_b16 v[92:93], v8 offset:12288
v_mfma_f32_16x16x32_bf16 v[204:207], v[188:191], v[116:119], v[204:207]
ds_read_b64_tr_b16 v[94:95], v8 offset:14336
v_mfma_f32_16x16x32_bf16 v[144:147], v[168:171], v[120:123], v[144:147]
v_mfma_f32_16x16x32_bf16 v[148:151], v[172:175], v[120:123], v[148:151]
v_mfma_f32_16x16x32_bf16 v[208:211], v[184:187], v[120:123], v[208:211]
v_mfma_f32_16x16x32_bf16 v[212:215], v[188:191], v[120:123], v[212:215]
v_mfma_f32_16x16x32_bf16 v[152:155], v[168:171], v[124:127], v[152:155]
v_mfma_f32_16x16x32_bf16 v[156:159], v[172:175], v[124:127], v[156:159]
v_mfma_f32_16x16x32_bf16 v[216:219], v[184:187], v[124:127], v[216:219]
v_mfma_f32_16x16x32_bf16 v[220:223], v[188:191], v[124:127], v[220:223]
s_sub_u32 s41, s41, 1
s_cmp_lg_u32 s41, 0
s_cbranch_scc1 Lk4_132
s_waitcnt lgkmcnt(0)
s_barrier
v_mfma_f32_16x16x32_bf16 v[128:131], v[64:67], v[32:35], v[128:131]
ds_read_b64_tr_b16 v[160:161], v7 offset:32768
v_mfma_f32_16x16x32_bf16 v[132:135], v[68:71], v[32:35], v[132:135]
ds_read_b128 v[96:99], v3 offset:32768
v_mfma_f32_16x16x32_bf16 v[192:195], v[80:83], v[32:35], v[192:195]
ds_read_b64_tr_b16 v[162:163], v7 offset:34816
v_mfma_f32_16x16x32_bf16 v[196:199], v[84:87], v[32:35], v[196:199]
ds_read_b128 v[100:103], v3 offset:33024
v_mfma_f32_16x16x32_bf16 v[136:139], v[64:67], v[36:39], v[136:139]
ds_read_b64_tr_b16 v[164:165], v8 offset:32768
v_mfma_f32_16x16x32_bf16 v[140:143], v[68:71], v[36:39], v[140:143]
ds_read_b128 v[104:107], v3 offset:33280
v_mfma_f32_16x16x32_bf16 v[200:203], v[80:83], v[36:39], v[200:203]
ds_read_b64_tr_b16 v[166:167], v8 offset:34816
v_mfma_f32_16x16x32_bf16 v[204:207], v[84:87], v[36:39], v[204:207]
ds_read_b128 v[108:111], v3 offset:33536
v_mfma_f32_16x16x32_bf16 v[144:147], v[64:67], v[40:43], v[144:147]
ds_read_b64_tr_b16 v[176:177], v7 offset:40960
v_mfma_f32_16x16x32_bf16 v[148:151], v[68:71], v[40:43], v[148:151]
ds_read_b64_tr_b16 v[178:179], v7 offset:43008
v_mfma_f32_16x16x32_bf16 v[208:211], v[80:83], v[40:43], v[208:211]
ds_read_b64_tr_b16 v[180:181], v8 offset:40960
v_mfma_f32_16x16x32_bf16 v[212:215], v[84:87], v[40:43], v[212:215]
ds_read_b64_tr_b16 v[182:183], v8 offset:43008
v_mfma_f32_16x16x32_bf16 v[152:155], v[64:67], v[44:47], v[152:155]
ds_read_b64_tr_b16 v[168:169], v7 offset:36864
v_mfma_f32_16x16x32_bf16 v[156:159], v[68:71], v[44:47], v[156:159]
ds_read_b128 v[112:115], v3 offset:40960
v_mfma_f32_16x16x32_bf16 v[216:219], v[80:83], v[44:47], v[216:219]
ds_read_b64_tr_b16 v[170:171], v7 offset:38912
v_mfma_f32_16x16x32_bf16 v[220:223], v[84:87], v[44:47], v[220:223]
ds_read_b128 v[116:119], v3 offset:41216
v_mfma_f32_16x16x32_bf16 v[128:131], v[72:75], v[48:51], v[128:131]
ds_read_b64_tr_b16 v[172:173], v8 offset:36864
v_mfma_f32_16x16x32_bf16 v[132:135], v[76:79], v[48:51], v[132:135]
ds_read_b128 v[120:123], v3 offset:41472
v_mfma_f32_16x16x32_bf16 v[192:195], v[88:91], v[48:51], v[192:195]
ds_read_b64_tr_b16 v[174:175], v8 offset:38912
v_mfma_f32_16x16x32_bf16 v[196:199], v[92:95], v[48:51], v[196:199]
ds_read_b128 v[124:127], v3 offset:41728
v_mfma_f32_16x16x32_bf16 v[136:139], v[72:75], v[52:55], v[136:139]
ds_read_b64_tr_b16 v[184:185], v7 offset:45056
v_mfma_f32_16x16x32_bf16 v[140:143], v[76:79], v[52:55], v[140:143]
ds_read_b64_tr_b16 v[186:187], v7 offset:47104
v_mfma_f32_16x16x32_bf16 v[200:203], v[88:91], v[52:55], v[200:203]
ds_read_b64_tr_b16 v[188:189], v8 offset:45056
v_mfma_f32_16x16x32_bf16 v[204:207], v[92:95], v[52:55], v[204:207]
ds_read_b64_tr_b16 v[190:191], v8 offset:47104
v_mfma_f32_16x16x32_bf16 v[144:147], v[72:75], v[56:59], v[144:147]
v_mfma_f32_16x16x32_bf16 v[148:151], v[76:79], v[56:59], v[148:151]
v_mfma_f32_16x16x32_bf16 v[208:211], v[88:91], v[56:59], v[208:211]
v_mfma_f32_16x16x32_bf16 v[212:215], v[92:95], v[56:59], v[212:215]
v_mfma_f32_16x16x32_bf16 v[152:155], v[72:75], v[60:63], v[152:155]
v_mfma_f32_16x16x32_bf16 v[156:159], v[76:79], v[60:63], v[156:159]
v_mfma_f32_16x16x32_bf16 v[216:219], v[88:91], v[60:63], v[216:219]
v_mfma_f32_16x16x32_bf16 v[220:223], v[92:95], v[60:63], v[220:223]
s_waitcnt lgkmcnt(0)
s_barrier
v_mfma_f32_16x16x32_bf16 v[128:131], v[160:163], v[96:99], v[128:131]
ds_read_b64_tr_b16 v[64:65], v5 offset:0
v_mfma_f32_16x16x32_bf16 v[132:135], v[164:167], v[96:99], v[132:135]
ds_read_b128 v[32:35], v2 offset:0
v_mfma_f32_16x16x32_bf16 v[192:195], v[176:179], v[96:99], v[192:195]
ds_read_b64_tr_b16 v[66:67], v5 offset:2048
v_mfma_f32_16x16x32_bf16 v[196:199], v[180:183], v[96:99], v[196:199]
ds_read_b128 v[36:39], v2 offset:256
v_mfma_f32_16x16x32_bf16 v[136:139], v[160:163], v[100:103], v[136:139]
ds_read_b64_tr_b16 v[68:69], v6 offset:0
v_mfma_f32_16x16x32_bf16 v[140:143], v[164:167], v[100:103], v[140:143]
ds_read_b128 v[40:43], v2 offset:512
v_mfma_f32_16x16x32_bf16 v[200:203], v[176:179], v[100:103], v[200:203]
ds_read_b64_tr_b16 v[70:71], v6 offset:2048
v_mfma_f32_16x16x32_bf16 v[204:207], v[180:183], v[100:103], v[204:207]
ds_read_b128 v[44:47], v2 offset:768
v_mfma_f32_16x16x32_bf16 v[144:147], v[160:163], v[104:107], v[144:147]
ds_read_b64_tr_b16 v[80:81], v5 offset:8192
v_mfma_f32_16x16x32_bf16 v[148:151], v[164:167], v[104:107], v[148:151]
ds_read_b64_tr_b16 v[82:83], v5 offset:10240
v_mfma_f32_16x16x32_bf16 v[208:211], v[176:179], v[104:107], v[208:211]
ds_read_b64_tr_b16 v[84:85], v6 offset:8192
v_mfma_f32_16x16x32_bf16 v[212:215], v[180:183], v[104:107], v[212:215]
ds_read_b64_tr_b16 v[86:87], v6 offset:10240
v_mfma_f32_16x16x32_bf16 v[152:155], v[160:163], v[108:111], v[152:155]
ds_read_b64_tr_b16 v[72:73], v5 offset:4096
v_mfma_f32_16x16x32_bf16 v[156:159], v[164:167], v[108:111], v[156:159]
ds_read_b128 v[48:51], v2 offset:8192
v_mfma_f32_16x16x32_bf16 v[216:219], v[176:179], v[108:111], v[216:219]
ds_read_b64_tr_b16 v[74:75], v5 offset:6144
v_mfma_f32_16x16x32_bf16 v[220:223], v[180:183], v[108:111], v[220:223]
ds_read_b128 v[52:55], v2 offset:8448
v_mfma_f32_16x16x32_bf16 v[128:131], v[168:171], v[112:115], v[128:131]
ds_read_b64_tr_b16 v[76:77], v6 offset:4096
v_mfma_f32_16x16x32_bf16 v[132:135], v[172:175], v[112:115], v[132:135]
ds_read_b128 v[56:59], v2 offset:8704
v_mfma_f32_16x16x32_bf16 v[192:195], v[184:187], v[112:115], v[192:195]
ds_read_b64_tr_b16 v[78:79], v6 offset:6144
v_mfma_f32_16x16x32_bf16 v[196:199], v[188:191], v[112:115], v[196:199]
ds_read_b128 v[60:63], v2 offset:8960
v_mfma_f32_16x16x32_bf16 v[136:139], v[168:171], v[116:119], v[136:139]
ds_read_b64_tr_b16 v[88:89], v5 offset:12288
v_mfma_f32_16x16x32_bf16 v[140:143], v[172:175], v[116:119], v[140:143]
ds_read_b64_tr_b16 v[90:91], v5 offset:14336
v_mfma_f32_16x16x32_bf16 v[200:203], v[184:187], v[116:119], v[200:203]
ds_read_b64_tr_b16 v[92:93], v6 offset:12288
v_mfma_f32_16x16x32_bf16 v[204:207], v[188:191], v[116:119], v[204:207]
ds_read_b64_tr_b16 v[94:95], v6 offset:14336
v_mfma_f32_16x16x32_bf16 v[144:147], v[168:171], v[120:123], v[144:147]
v_mfma_f32_16x16x32_bf16 v[148:151], v[172:175], v[120:123], v[148:151]
v_mfma_f32_16x16x32_bf16 v[208:211], v[184:187], v[120:123], v[208:211]
v_mfma_f32_16x16x32_bf16 v[212:215], v[188:191], v[120:123], v[212:215]
v_mfma_f32_16x16x32_bf16 v[152:155], v[168:171], v[124:127], v[152:155]
v_mfma_f32_16x16x32_bf16 v[156:159], v[172:175], v[124:127], v[156:159]
v_mfma_f32_16x16x32_bf16 v[216:219], v[184:187], v[124:127], v[216:219]
v_mfma_f32_16x16x32_bf16 v[220:223], v[188:191], v[124:127], v[220:223]
s_waitcnt lgkmcnt(0)
s_barrier
v_mfma_f32_16x16x32_bf16 v[128:131], v[64:67], v[32:35], v[128:131]
ds_read_b64_tr_b16 v[160:161], v5 offset:32768
v_mfma_f32_16x16x32_bf16 v[132:135], v[68:71], v[32:35], v[132:135]
ds_read_b128 v[96:99], v2 offset:32768
v_mfma_f32_16x16x32_bf16 v[192:195], v[80:83], v[32:35], v[192:195]
ds_read_b64_tr_b16 v[162:163], v5 offset:34816
v_mfma_f32_16x16x32_bf16 v[196:199], v[84:87], v[32:35], v[196:199]
ds_read_b128 v[100:103], v2 offset:33024
v_mfma_f32_16x16x32_bf16 v[136:139], v[64:67], v[36:39], v[136:139]
ds_read_b64_tr_b16 v[164:165], v6 offset:32768
v_mfma_f32_16x16x32_bf16 v[140:143], v[68:71], v[36:39], v[140:143]
ds_read_b128 v[104:107], v2 offset:33280
v_mfma_f32_16x16x32_bf16 v[200:203], v[80:83], v[36:39], v[200:203]
ds_read_b64_tr_b16 v[166:167], v6 offset:34816
v_mfma_f32_16x16x32_bf16 v[204:207], v[84:87], v[36:39], v[204:207]
ds_read_b128 v[108:111], v2 offset:33536
v_mfma_f32_16x16x32_bf16 v[144:147], v[64:67], v[40:43], v[144:147]
ds_read_b64_tr_b16 v[176:177], v5 offset:40960
v_mfma_f32_16x16x32_bf16 v[148:151], v[68:71], v[40:43], v[148:151]
ds_read_b64_tr_b16 v[178:179], v5 offset:43008
v_mfma_f32_16x16x32_bf16 v[208:211], v[80:83], v[40:43], v[208:211]
ds_read_b64_tr_b16 v[180:181], v6 offset:40960
v_mfma_f32_16x16x32_bf16 v[212:215], v[84:87], v[40:43], v[212:215]
ds_read_b64_tr_b16 v[182:183], v6 offset:43008
v_mfma_f32_16x16x32_bf16 v[152:155], v[64:67], v[44:47], v[152:155]
ds_read_b64_tr_b16 v[168:169], v5 offset:36864
v_mfma_f32_16x16x32_bf16 v[156:159], v[68:71], v[44:47], v[156:159]
ds_read_b128 v[112:115], v2 offset:40960
v_mfma_f32_16x16x32_bf16 v[216:219], v[80:83], v[44:47], v[216:219]
ds_read_b64_tr_b16 v[170:171], v5 offset:38912
v_mfma_f32_16x16x32_bf16 v[220:223], v[84:87], v[44:47], v[220:223]
ds_read_b128 v[116:119], v2 offset:41216
v_mfma_f32_16x16x32_bf16 v[128:131], v[72:75], v[48:51], v[128:131]
ds_read_b64_tr_b16 v[172:173], v6 offset:36864
v_mfma_f32_16x16x32_bf16 v[132:135], v[76:79], v[48:51], v[132:135]
ds_read_b128 v[120:123], v2 offset:41472
v_mfma_f32_16x16x32_bf16 v[192:195], v[88:91], v[48:51], v[192:195]
ds_read_b64_tr_b16 v[174:175], v6 offset:38912
v_mfma_f32_16x16x32_bf16 v[196:199], v[92:95], v[48:51], v[196:199]
ds_read_b128 v[124:127], v2 offset:41728
v_mfma_f32_16x16x32_bf16 v[136:139], v[72:75], v[52:55], v[136:139]
ds_read_b64_tr_b16 v[184:185], v5 offset:45056
v_mfma_f32_16x16x32_bf16 v[140:143], v[76:79], v[52:55], v[140:143]
ds_read_b64_tr_b16 v[186:187], v5 offset:47104
v_mfma_f32_16x16x32_bf16 v[200:203], v[88:91], v[52:55], v[200:203]
ds_read_b64_tr_b16 v[188:189], v6 offset:45056
v_mfma_f32_16x16x32_bf16 v[204:207], v[92:95], v[52:55], v[204:207]
ds_read_b64_tr_b16 v[190:191], v6 offset:47104
v_mfma_f32_16x16x32_bf16 v[144:147], v[72:75], v[56:59], v[144:147]
v_mfma_f32_16x16x32_bf16 v[148:151], v[76:79], v[56:59], v[148:151]
v_mfma_f32_16x16x32_bf16 v[208:211], v[88:91], v[56:59], v[208:211]
v_mfma_f32_16x16x32_bf16 v[212:215], v[92:95], v[56:59], v[212:215]
v_mfma_f32_16x16x32_bf16 v[152:155], v[72:75], v[60:63], v[152:155]
v_mfma_f32_16x16x32_bf16 v[156:159], v[76:79], v[60:63], v[156:159]
v_mfma_f32_16x16x32_bf16 v[216:219], v[88:91], v[60:63], v[216:219]
v_mfma_f32_16x16x32_bf16 v[220:223], v[92:95], v[60:63], v[220:223]
s_waitcnt lgkmcnt(0)
s_barrier
v_mfma_f32_16x16x32_bf16 v[128:131], v[160:163], v[96:99], v[128:131]
ds_read_b64_tr_b16 v[64:65], v7 offset:0
v_mfma_f32_16x16x32_bf16 v[132:135], v[164:167], v[96:99], v[132:135]
ds_read_b128 v[32:35], v3 offset:0
v_mfma_f32_16x16x32_bf16 v[192:195], v[176:179], v[96:99], v[192:195]
ds_read_b64_tr_b16 v[66:67], v7 offset:2048
v_mfma_f32_16x16x32_bf16 v[196:199], v[180:183], v[96:99], v[196:199]
ds_read_b128 v[36:39], v3 offset:256
v_mfma_f32_16x16x32_bf16 v[136:139], v[160:163], v[100:103], v[136:139]
ds_read_b64_tr_b16 v[68:69], v8 offset:0
v_mfma_f32_16x16x32_bf16 v[140:143], v[164:167], v[100:103], v[140:143]
ds_read_b128 v[40:43], v3 offset:512
v_mfma_f32_16x16x32_bf16 v[200:203], v[176:179], v[100:103], v[200:203]
ds_read_b64_tr_b16 v[70:71], v8 offset:2048
v_mfma_f32_16x16x32_bf16 v[204:207], v[180:183], v[100:103], v[204:207]
ds_read_b128 v[44:47], v3 offset:768
v_mfma_f32_16x16x32_bf16 v[144:147], v[160:163], v[104:107], v[144:147]
ds_read_b64_tr_b16 v[72:73], v7 offset:4096
v_mfma_f32_16x16x32_bf16 v[148:151], v[164:167], v[104:107], v[148:151]
ds_read_b128 v[48:51], v3 offset:8192
v_mfma_f32_16x16x32_bf16 v[208:211], v[176:179], v[104:107], v[208:211]
ds_read_b64_tr_b16 v[74:75], v7 offset:6144
v_mfma_f32_16x16x32_bf16 v[212:215], v[180:183], v[104:107], v[212:215]
ds_read_b128 v[52:55], v3 offset:8448
v_mfma_f32_16x16x32_bf16 v[152:155], v[160:163], v[108:111], v[152:155]
ds_read_b64_tr_b16 v[76:77], v8 offset:4096
v_mfma_f32_16x16x32_bf16 v[156:159], v[164:167], v[108:111], v[156:159]
ds_read_b128 v[56:59], v3 offset:8704
v_mfma_f32_16x16x32_bf16 v[216:219], v[176:179], v[108:111], v[216:219]
ds_read_b64_tr_b16 v[78:79], v8 offset:6144
v_mfma_f32_16x16x32_bf16 v[220:223], v[180:183], v[108:111], v[220:223]
ds_read_b128 v[60:63], v3 offset:8960
v_mfma_f32_16x16x32_bf16 v[128:131], v[168:171], v[112:115], v[128:131]
v_mfma_f32_16x16x32_bf16 v[132:135], v[172:175], v[112:115], v[132:135]
v_mfma_f32_16x16x32_bf16 v[192:195], v[184:187], v[112:115], v[192:195]
v_mfma_f32_16x16x32_bf16 v[196:199], v[188:191], v[112:115], v[196:199]
v_mfma_f32_16x16x32_bf16 v[136:139], v[168:171], v[116:119], v[136:139]
v_mfma_f32_16x16x32_bf16 v[140:143], v[172:175], v[116:119], v[140:143]
v_mfma_f32_16x16x32_bf16 v[200:203], v[184:187], v[116:119], v[200:203]
v_mfma_f32_16x16x32_bf16 v[204:207], v[188:191], v[116:119], v[204:207]
v_mfma_f32_16x16x32_bf16 v[144:147], v[168:171], v[120:123], v[144:147]
v_mfma_f32_16x16x32_bf16 v[148:151], v[172:175], v[120:123], v[148:151]
v_mfma_f32_16x16x32_bf16 v[208:211], v[184:187], v[120:123], v[208:211]
v_mfma_f32_16x16x32_bf16 v[212:215], v[188:191], v[120:123], v[212:215]
v_mfma_f32_16x16x32_bf16 v[152:155], v[168:171], v[124:127], v[152:155]
v_mfma_f32_16x16x32_bf16 v[156:159], v[172:175], v[124:127], v[156:159]
v_mfma_f32_16x16x32_bf16 v[216:219], v[184:187], v[124:127], v[216:219]
v_mfma_f32_16x16x32_bf16 v[220:223], v[188:191], v[124:127], v[220:223]
s_mov_b32 s54, 0x10000
s_waitcnt lgkmcnt(0)
s_barrier
v_mfma_f32_16x16x32_bf16 v[128:131], v[64:67], v[32:35], v[128:131]
ds_read_b64_tr_b16 v[160:161], v7 offset:32768
v_mfma_f32_16x16x32_bf16 v[132:135], v[68:71], v[32:35], v[132:135]
ds_read_b128 v[96:99], v3 offset:32768
v_mfma_f32_16x16x32_bf16 v[136:139], v[64:67], v[36:39], v[136:139]
ds_read_b64_tr_b16 v[162:163], v7 offset:34816
v_mfma_f32_16x16x32_bf16 v[140:143], v[68:71], v[36:39], v[140:143]
ds_read_b128 v[100:103], v3 offset:33024
v_cvt_pk_bf16_f32 v224, v192, v193
v_mfma_f32_16x16x32_bf16 v[144:147], v[64:67], v[40:43], v[144:147]
ds_read_b64_tr_b16 v[164:165], v8 offset:32768
v_cvt_pk_bf16_f32 v225, v194, v195
v_mfma_f32_16x16x32_bf16 v[148:151], v[68:71], v[40:43], v[148:151]
v_cvt_pk_bf16_f32 v226, v196, v197
ds_read_b128 v[104:107], v3 offset:33280
v_cvt_pk_bf16_f32 v227, v198, v199
v_mfma_f32_16x16x32_bf16 v[152:155], v[64:67], v[44:47], v[152:155]
buffer_store_dwordx4 v[224:227], v9, s[64:67], 0 offen offset:0 sc1
ds_read_b64_tr_b16 v[166:167], v8 offset:34816
v_cvt_pk_bf16_f32 v228, v200, v201
v_mfma_f32_16x16x32_bf16 v[156:159], v[68:71], v[44:47], v[156:159]
ds_read_b128 v[108:111], v3 offset:33536
v_cvt_pk_bf16_f32 v229, v202, v203
v_mfma_f32_16x16x32_bf16 v[128:131], v[72:75], v[48:51], v[128:131]
v_cvt_pk_bf16_f32 v230, v204, v205
ds_read_b64_tr_b16 v[168:169], v7 offset:36864
v_cvt_pk_bf16_f32 v231, v206, v207
v_mfma_f32_16x16x32_bf16 v[132:135], v[76:79], v[48:51], v[132:135]
buffer_store_dwordx4 v[228:231], v9, s[64:67], 0 offen offset:1024 sc1
ds_read_b128 v[112:115], v3 offset:40960
v_cvt_pk_bf16_f32 v232, v208, v209
v_mfma_f32_16x16x32_bf16 v[136:139], v[72:75], v[52:55], v[136:139]
ds_read_b64_tr_b16 v[170:171], v7 offset:38912
v_cvt_pk_bf16_f32 v233, v210, v211
v_mfma_f32_16x16x32_bf16 v[140:143], v[76:79], v[52:55], v[140:143]
v_cvt_pk_bf16_f32 v234, v212, v213
ds_read_b128 v[116:119], v3 offset:41216
v_cvt_pk_bf16_f32 v235, v214, v215
v_mfma_f32_16x16x32_bf16 v[144:147], v[72:75], v[56:59], v[144:147]
buffer_store_dwordx4 v[232:235], v9, s[64:67], 0 offen offset:2048 sc1
ds_read_b64_tr_b16 v[172:173], v8 offset:36864
v_cvt_pk_bf16_f32 v236, v216, v217
v_mfma_f32_16x16x32_bf16 v[148:151], v[76:79], v[56:59], v[148:151]
ds_read_b128 v[120:123], v3 offset:41472
v_cvt_pk_bf16_f32 v237, v218, v219
v_mfma_f32_16x16x32_bf16 v[152:155], v[72:75], v[60:63], v[152:155]
v_cvt_pk_bf16_f32 v238, v220, v221
ds_read_b64_tr_b16 v[174:175], v8 offset:38912
v_cvt_pk_bf16_f32 v239, v222, v223
v_mfma_f32_16x16x32_bf16 v[156:159], v[76:79], v[60:63], v[156:159]
buffer_store_dwordx4 v[236:239], v9, s[64:67], 0 offen offset:3072 sc1
ds_read_b128 v[124:127], v3 offset:41728
s_waitcnt lgkmcnt(0)
s_barrier
v_mfma_f32_16x16x32_bf16 v[128:131], v[160:163], v[96:99], v[128:131]
ds_read_b64_tr_b16 v[64:65], v5 offset:0
v_mfma_f32_16x16x32_bf16 v[132:135], v[164:167], v[96:99], v[132:135]
ds_read_b128 v[32:35], v2 offset:0
v_mfma_f32_16x16x32_bf16 v[136:139], v[160:163], v[100:103], v[136:139]
ds_read_b64_tr_b16 v[66:67], v5 offset:2048
v_mfma_f32_16x16x32_bf16 v[140:143], v[164:167], v[100:103], v[140:143]
ds_read_b128 v[36:39], v2 offset:256
v_mfma_f32_16x16x32_bf16 v[144:147], v[160:163], v[104:107], v[144:147]
ds_read_b64_tr_b16 v[68:69], v6 offset:0
v_mfma_f32_16x16x32_bf16 v[148:151], v[164:167], v[104:107], v[148:151]
ds_read_b128 v[40:43], v2 offset:512
v_mfma_f32_16x16x32_bf16 v[152:155], v[160:163], v[108:111], v[152:155]
ds_read_b64_tr_b16 v[70:71], v6 offset:2048
v_mfma_f32_16x16x32_bf16 v[156:159], v[164:167], v[108:111], v[156:159]
ds_read_b128 v[44:47], v2 offset:768
v_mfma_f32_16x16x32_bf16 v[128:131], v[168:171], v[112:115], v[128:131]
ds_read_b64_tr_b16 v[72:73], v5 offset:4096
v_mfma_f32_16x16x32_bf16 v[132:135], v[172:175], v[112:115], v[132:135]
ds_read_b128 v[48:51], v2 offset:8192
v_mfma_f32_16x16x32_bf16 v[136:139], v[168:171], v[116:119], v[136:139]
ds_read_b64_tr_b16 v[74:75], v5 offset:6144
v_mfma_f32_16x16x32_bf16 v[140:143], v[172:175], v[116:119], v[140:143]
ds_read_b128 v[52:55], v2 offset:8448
v_mfma_f32_16x16x32_bf16 v[144:147], v[168:171], v[120:123], v[144:147]
ds_read_b64_tr_b16 v[76:77], v6 offset:4096
v_mfma_f32_16x16x32_bf16 v[148:151], v[172:175], v[120:123], v[148:151]
ds_read_b128 v[56:59], v2 offset:8704
v_mfma_f32_16x16x32_bf16 v[152:155], v[168:171], v[124:127], v[152:155]
ds_read_b64_tr_b16 v[78:79], v6 offset:6144
v_mfma_f32_16x16x32_bf16 v[156:159], v[172:175], v[124:127], v[156:159]
ds_read_b128 v[60:63], v2 offset:8960
s_waitcnt lgkmcnt(0)
s_barrier
v_mfma_f32_16x16x32_bf16 v[128:131], v[64:67], v[32:35], v[128:131]
ds_read_b64_tr_b16 v[160:161], v5 offset:32768
v_mfma_f32_16x16x32_bf16 v[132:135], v[68:71], v[32:35], v[132:135]
ds_read_b128 v[96:99], v2 offset:32768
v_mfma_f32_16x16x32_bf16 v[136:139], v[64:67], v[36:39], v[136:139]
ds_read_b64_tr_b16 v[162:163], v5 offset:34816
v_mfma_f32_16x16x32_bf16 v[140:143], v[68:71], v[36:39], v[140:143]
ds_read_b128 v[100:103], v2 offset:33024
v_mfma_f32_16x16x32_bf16 v[144:147], v[64:67], v[40:43], v[144:147]
ds_read_b64_tr_b16 v[164:165], v6 offset:32768
v_mfma_f32_16x16x32_bf16 v[148:151], v[68:71], v[40:43], v[148:151]
ds_read_b128 v[104:107], v2 offset:33280
v_mfma_f32_16x16x32_bf16 v[152:155], v[64:67], v[44:47], v[152:155]
ds_read_b64_tr_b16 v[166:167], v6 offset:34816
v_mfma_f32_16x16x32_bf16 v[156:159], v[68:71], v[44:47], v[156:159]
ds_read_b128 v[108:111], v2 offset:33536
v_mfma_f32_16x16x32_bf16 v[128:131], v[72:75], v[48:51], v[128:131]
ds_read_b64_tr_b16 v[168:169], v5 offset:36864
v_mfma_f32_16x16x32_bf16 v[132:135], v[76:79], v[48:51], v[132:135]
ds_read_b128 v[112:115], v2 offset:40960
v_mfma_f32_16x16x32_bf16 v[136:139], v[72:75], v[52:55], v[136:139]
ds_read_b64_tr_b16 v[170:171], v5 offset:38912
v_mfma_f32_16x16x32_bf16 v[140:143], v[76:79], v[52:55], v[140:143]
ds_read_b128 v[116:119], v2 offset:41216
v_mfma_f32_16x16x32_bf16 v[144:147], v[72:75], v[56:59], v[144:147]
ds_read_b64_tr_b16 v[172:173], v6 offset:36864
v_mfma_f32_16x16x32_bf16 v[148:151], v[76:79], v[56:59], v[148:151]
ds_read_b128 v[120:123], v2 offset:41472
v_mfma_f32_16x16x32_bf16 v[152:155], v[72:75], v[60:63], v[152:155]
ds_read_b64_tr_b16 v[174:175], v6 offset:38912
v_mfma_f32_16x16x32_bf16 v[156:159], v[76:79], v[60:63], v[156:159]
ds_read_b128 v[124:127], v2 offset:41728
s_waitcnt vmcnt(0) lgkmcnt(0)
s_barrier
v_mfma_f32_16x16x32_bf16 v[128:131], v[160:163], v[96:99], v[128:131]
ds_read_b64_tr_b16 v[64:65], v7 offset:0
v_mfma_f32_16x16x32_bf16 v[132:135], v[164:167], v[96:99], v[132:135]
ds_read_b128 v[32:35], v3 offset:0
v_mfma_f32_16x16x32_bf16 v[136:139], v[160:163], v[100:103], v[136:139]
ds_read_b64_tr_b16 v[66:67], v7 offset:2048
v_mfma_f32_16x16x32_bf16 v[140:143], v[164:167], v[100:103], v[140:143]
ds_read_b128 v[36:39], v3 offset:256
v_mfma_f32_16x16x32_bf16 v[144:147], v[160:163], v[104:107], v[144:147]
ds_read_b64_tr_b16 v[68:69], v8 offset:0
v_mfma_f32_16x16x32_bf16 v[148:151], v[164:167], v[104:107], v[148:151]
ds_read_b128 v[40:43], v3 offset:512
v_mfma_f32_16x16x32_bf16 v[152:155], v[160:163], v[108:111], v[152:155]
ds_read_b64_tr_b16 v[70:71], v8 offset:2048
v_mfma_f32_16x16x32_bf16 v[156:159], v[164:167], v[108:111], v[156:159]
ds_read_b128 v[44:47], v3 offset:768
v_mfma_f32_16x16x32_bf16 v[128:131], v[168:171], v[112:115], v[128:131]
ds_read_b64_tr_b16 v[72:73], v7 offset:4096
v_mfma_f32_16x16x32_bf16 v[132:135], v[172:175], v[112:115], v[132:135]
ds_read_b128 v[48:51], v3 offset:8192
v_mfma_f32_16x16x32_bf16 v[136:139], v[168:171], v[116:119], v[136:139]
ds_read_b64_tr_b16 v[74:75], v7 offset:6144
v_mfma_f32_16x16x32_bf16 v[140:143], v[172:175], v[116:119], v[140:143]
ds_read_b128 v[52:55], v3 offset:8448
v_mfma_f32_16x16x32_bf16 v[144:147], v[168:171], v[120:123], v[144:147]
ds_read_b64_tr_b16 v[76:77], v8 offset:4096
v_mfma_f32_16x16x32_bf16 v[148:151], v[172:175], v[120:123], v[148:151]
ds_read_b128 v[56:59], v3 offset:8704
v_mfma_f32_16x16x32_bf16 v[152:155], v[168:171], v[124:127], v[152:155]
ds_read_b64_tr_b16 v[78:79], v8 offset:6144
v_mfma_f32_16x16x32_bf16 v[156:159], v[172:175], v[124:127], v[156:159]
ds_read_b128 v[60:63], v3 offset:8960
s_waitcnt lgkmcnt(0)
s_barrier
v_mfma_f32_16x16x32_bf16 v[128:131], v[64:67], v[32:35], v[128:131]
ds_read_b64_tr_b16 v[160:161], v7 offset:32768
v_mfma_f32_16x16x32_bf16 v[132:135], v[68:71], v[32:35], v[132:135]
ds_read_b128 v[96:99], v3 offset:32768
v_mfma_f32_16x16x32_bf16 v[136:139], v[64:67], v[36:39], v[136:139]
ds_read_b64_tr_b16 v[162:163], v7 offset:34816
v_mfma_f32_16x16x32_bf16 v[140:143], v[68:71], v[36:39], v[140:143]
ds_read_b128 v[100:103], v3 offset:33024
v_mfma_f32_16x16x32_bf16 v[144:147], v[64:67], v[40:43], v[144:147]
ds_read_b64_tr_b16 v[164:165], v8 offset:32768
v_mfma_f32_16x16x32_bf16 v[148:151], v[68:71], v[40:43], v[148:151]
ds_read_b128 v[104:107], v3 offset:33280
v_mfma_f32_16x16x32_bf16 v[152:155], v[64:67], v[44:47], v[152:155]
ds_read_b64_tr_b16 v[166:167], v8 offset:34816
v_mfma_f32_16x16x32_bf16 v[156:159], v[68:71], v[44:47], v[156:159]
ds_read_b128 v[108:111], v3 offset:33536
v_mfma_f32_16x16x32_bf16 v[128:131], v[72:75], v[48:51], v[128:131]
ds_read_b64_tr_b16 v[168:169], v7 offset:36864
v_mfma_f32_16x16x32_bf16 v[132:135], v[76:79], v[48:51], v[132:135]
ds_read_b128 v[112:115], v3 offset:40960
v_mfma_f32_16x16x32_bf16 v[136:139], v[72:75], v[52:55], v[136:139]
ds_read_b64_tr_b16 v[170:171], v7 offset:38912
v_mfma_f32_16x16x32_bf16 v[140:143], v[76:79], v[52:55], v[140:143]
ds_read_b128 v[116:119], v3 offset:41216
v_mfma_f32_16x16x32_bf16 v[144:147], v[72:75], v[56:59], v[144:147]
ds_read_b64_tr_b16 v[172:173], v8 offset:36864
v_mfma_f32_16x16x32_bf16 v[148:151], v[76:79], v[56:59], v[148:151]
ds_read_b128 v[120:123], v3 offset:41472
v_mfma_f32_16x16x32_bf16 v[152:155], v[72:75], v[60:63], v[152:155]
ds_read_b64_tr_b16 v[174:175], v8 offset:38912
v_mfma_f32_16x16x32_bf16 v[156:159], v[76:79], v[60:63], v[156:159]
ds_read_b128 v[124:127], v3 offset:41728
s_waitcnt lgkmcnt(0)
s_barrier
v_mfma_f32_16x16x32_bf16 v[128:131], v[160:163], v[96:99], v[128:131]
ds_read_b64_tr_b16 v[64:65], v5 offset:0
v_mfma_f32_16x16x32_bf16 v[132:135], v[164:167], v[96:99], v[132:135]
ds_read_b128 v[32:35], v2 offset:0
v_mfma_f32_16x16x32_bf16 v[136:139], v[160:163], v[100:103], v[136:139]
ds_read_b64_tr_b16 v[66:67], v5 offset:2048
v_mfma_f32_16x16x32_bf16 v[140:143], v[164:167], v[100:103], v[140:143]
ds_read_b128 v[36:39], v2 offset:256
v_mfma_f32_16x16x32_bf16 v[144:147], v[160:163], v[104:107], v[144:147]
ds_read_b64_tr_b16 v[68:69], v6 offset:0
v_mfma_f32_16x16x32_bf16 v[148:151], v[164:167], v[104:107], v[148:151]
ds_read_b128 v[40:43], v2 offset:512
v_mfma_f32_16x16x32_bf16 v[152:155], v[160:163], v[108:111], v[152:155]
ds_read_b64_tr_b16 v[70:71], v6 offset:2048
v_mfma_f32_16x16x32_bf16 v[156:159], v[164:167], v[108:111], v[156:159]
ds_read_b128 v[44:47], v2 offset:768
v_mfma_f32_16x16x32_bf16 v[128:131], v[168:171], v[112:115], v[128:131]
ds_read_b64_tr_b16 v[72:73], v5 offset:4096
v_mfma_f32_16x16x32_bf16 v[132:135], v[172:175], v[112:115], v[132:135]
ds_read_b128 v[48:51], v2 offset:8192
v_mfma_f32_16x16x32_bf16 v[136:139], v[168:171], v[116:119], v[136:139]
ds_read_b64_tr_b16 v[74:75], v5 offset:6144
v_mfma_f32_16x16x32_bf16 v[140:143], v[172:175], v[116:119], v[140:143]
ds_read_b128 v[52:55], v2 offset:8448
v_mfma_f32_16x16x32_bf16 v[144:147], v[168:171], v[120:123], v[144:147]
ds_read_b64_tr_b16 v[76:77], v6 offset:4096
v_mfma_f32_16x16x32_bf16 v[148:151], v[172:175], v[120:123], v[148:151]
ds_read_b128 v[56:59], v2 offset:8704
v_mfma_f32_16x16x32_bf16 v[152:155], v[168:171], v[124:127], v[152:155]
ds_read_b64_tr_b16 v[78:79], v6 offset:6144
v_mfma_f32_16x16x32_bf16 v[156:159], v[172:175], v[124:127], v[156:159]
ds_read_b128 v[60:63], v2 offset:8960
s_waitcnt lgkmcnt(0)
s_barrier
v_mfma_f32_16x16x32_bf16 v[128:131], v[64:67], v[32:35], v[128:131]
ds_read_b64_tr_b16 v[160:161], v5 offset:32768
v_mfma_f32_16x16x32_bf16 v[132:135], v[68:71], v[32:35], v[132:135]
ds_read_b128 v[96:99], v2 offset:32768
v_mfma_f32_16x16x32_bf16 v[136:139], v[64:67], v[36:39], v[136:139]
ds_read_b64_tr_b16 v[162:163], v5 offset:34816
v_mfma_f32_16x16x32_bf16 v[140:143], v[68:71], v[36:39], v[140:143]
ds_read_b128 v[100:103], v2 offset:33024
v_mfma_f32_16x16x32_bf16 v[144:147], v[64:67], v[40:43], v[144:147]
ds_read_b64_tr_b16 v[164:165], v6 offset:32768
v_mfma_f32_16x16x32_bf16 v[148:151], v[68:71], v[40:43], v[148:151]
ds_read_b128 v[104:107], v2 offset:33280
v_mfma_f32_16x16x32_bf16 v[152:155], v[64:67], v[44:47], v[152:155]
ds_read_b64_tr_b16 v[166:167], v6 offset:34816
v_mfma_f32_16x16x32_bf16 v[156:159], v[68:71], v[44:47], v[156:159]
ds_read_b128 v[108:111], v2 offset:33536
v_mfma_f32_16x16x32_bf16 v[128:131], v[72:75], v[48:51], v[128:131]
ds_read_b64_tr_b16 v[168:169], v5 offset:36864
v_mfma_f32_16x16x32_bf16 v[132:135], v[76:79], v[48:51], v[132:135]
ds_read_b128 v[112:115], v2 offset:40960
v_mfma_f32_16x16x32_bf16 v[136:139], v[72:75], v[52:55], v[136:139]
ds_read_b64_tr_b16 v[170:171], v5 offset:38912
v_mfma_f32_16x16x32_bf16 v[140:143], v[76:79], v[52:55], v[140:143]
ds_read_b128 v[116:119], v2 offset:41216
v_mfma_f32_16x16x32_bf16 v[144:147], v[72:75], v[56:59], v[144:147]
ds_read_b64_tr_b16 v[172:173], v6 offset:36864
v_mfma_f32_16x16x32_bf16 v[148:151], v[76:79], v[56:59], v[148:151]
ds_read_b128 v[120:123], v2 offset:41472
v_mfma_f32_16x16x32_bf16 v[152:155], v[72:75], v[60:63], v[152:155]
ds_read_b64_tr_b16 v[174:175], v6 offset:38912
v_mfma_f32_16x16x32_bf16 v[156:159], v[76:79], v[60:63], v[156:159]
ds_read_b128 v[124:127], v2 offset:41728
s_waitcnt lgkmcnt(0)
s_barrier
v_mfma_f32_16x16x32_bf16 v[128:131], v[160:163], v[96:99], v[128:131]
ds_read_b64_tr_b16 v[64:65], v7 offset:0
v_mfma_f32_16x16x32_bf16 v[132:135], v[164:167], v[96:99], v[132:135]
ds_read_b128 v[32:35], v3 offset:0
v_mfma_f32_16x16x32_bf16 v[136:139], v[160:163], v[100:103], v[136:139]
ds_read_b64_tr_b16 v[66:67], v7 offset:2048
v_mfma_f32_16x16x32_bf16 v[140:143], v[164:167], v[100:103], v[140:143]
ds_read_b128 v[36:39], v3 offset:256
v_mfma_f32_16x16x32_bf16 v[144:147], v[160:163], v[104:107], v[144:147]
ds_read_b64_tr_b16 v[68:69], v8 offset:0
v_mfma_f32_16x16x32_bf16 v[148:151], v[164:167], v[104:107], v[148:151]
ds_read_b128 v[40:43], v3 offset:512
v_mfma_f32_16x16x32_bf16 v[152:155], v[160:163], v[108:111], v[152:155]
ds_read_b64_tr_b16 v[70:71], v8 offset:2048
v_mfma_f32_16x16x32_bf16 v[156:159], v[164:167], v[108:111], v[156:159]
ds_read_b128 v[44:47], v3 offset:768
v_mfma_f32_16x16x32_bf16 v[128:131], v[168:171], v[112:115], v[128:131]
ds_read_b64_tr_b16 v[72:73], v7 offset:4096
v_mfma_f32_16x16x32_bf16 v[132:135], v[172:175], v[112:115], v[132:135]
ds_read_b128 v[48:51], v3 offset:8192
v_mfma_f32_16x16x32_bf16 v[136:139], v[168:171], v[116:119], v[136:139]
ds_read_b64_tr_b16 v[74:75], v7 offset:6144
v_mfma_f32_16x16x32_bf16 v[140:143], v[172:175], v[116:119], v[140:143]
ds_read_b128 v[52:55], v3 offset:8448
v_mfma_f32_16x16x32_bf16 v[144:147], v[168:171], v[120:123], v[144:147]
ds_read_b64_tr_b16 v[76:77], v8 offset:4096
v_mfma_f32_16x16x32_bf16 v[148:151], v[172:175], v[120:123], v[148:151]
ds_read_b128 v[56:59], v3 offset:8704
v_mfma_f32_16x16x32_bf16 v[152:155], v[168:171], v[124:127], v[152:155]
ds_read_b64_tr_b16 v[78:79], v8 offset:6144
v_mfma_f32_16x16x32_bf16 v[156:159], v[172:175], v[124:127], v[156:159]
ds_read_b128 v[60:63], v3 offset:8960
s_waitcnt lgkmcnt(0)
s_barrier
v_mfma_f32_16x16x32_bf16 v[128:131], v[64:67], v[32:35], v[128:131]
ds_read_b64_tr_b16 v[160:161], v7 offset:32768
v_mfma_f32_16x16x32_bf16 v[132:135], v[68:71], v[32:35], v[132:135]
ds_read_b128 v[96:99], v3 offset:32768
v_mfma_f32_16x16x32_bf16 v[136:139], v[64:67], v[36:39], v[136:139]
ds_read_b64_tr_b16 v[162:163], v7 offset:34816
v_mfma_f32_16x16x32_bf16 v[140:143], v[68:71], v[36:39], v[140:143]
ds_read_b128 v[100:103], v3 offset:33024
v_mfma_f32_16x16x32_bf16 v[144:147], v[64:67], v[40:43], v[144:147]
ds_read_b64_tr_b16 v[164:165], v8 offset:32768
v_mfma_f32_16x16x32_bf16 v[148:151], v[68:71], v[40:43], v[148:151]
ds_read_b128 v[104:107], v3 offset:33280
v_mfma_f32_16x16x32_bf16 v[152:155], v[64:67], v[44:47], v[152:155]
ds_read_b64_tr_b16 v[166:167], v8 offset:34816
v_mfma_f32_16x16x32_bf16 v[156:159], v[68:71], v[44:47], v[156:159]
ds_read_b128 v[108:111], v3 offset:33536
v_mfma_f32_16x16x32_bf16 v[128:131], v[72:75], v[48:51], v[128:131]
ds_read_b64_tr_b16 v[168:169], v7 offset:36864
v_mfma_f32_16x16x32_bf16 v[132:135], v[76:79], v[48:51], v[132:135]
ds_read_b128 v[112:115], v3 offset:40960
v_mfma_f32_16x16x32_bf16 v[136:139], v[72:75], v[52:55], v[136:139]
ds_read_b64_tr_b16 v[170:171], v7 offset:38912
v_mfma_f32_16x16x32_bf16 v[140:143], v[76:79], v[52:55], v[140:143]
ds_read_b128 v[116:119], v3 offset:41216
v_mfma_f32_16x16x32_bf16 v[144:147], v[72:75], v[56:59], v[144:147]
ds_read_b64_tr_b16 v[172:173], v8 offset:36864
v_mfma_f32_16x16x32_bf16 v[148:151], v[76:79], v[56:59], v[148:151]
ds_read_b128 v[120:123], v3 offset:41472
v_mfma_f32_16x16x32_bf16 v[152:155], v[72:75], v[60:63], v[152:155]
ds_read_b64_tr_b16 v[174:175], v8 offset:38912
v_mfma_f32_16x16x32_bf16 v[156:159], v[76:79], v[60:63], v[156:159]
ds_read_b128 v[124:127], v3 offset:41728
s_waitcnt lgkmcnt(0)
s_barrier
v_mfma_f32_16x16x32_bf16 v[128:131], v[160:163], v[96:99], v[128:131]
ds_read_b64_tr_b16 v[64:65], v5 offset:0
v_mfma_f32_16x16x32_bf16 v[132:135], v[164:167], v[96:99], v[132:135]
ds_read_b128 v[32:35], v2 offset:0
v_mfma_f32_16x16x32_bf16 v[136:139], v[160:163], v[100:103], v[136:139]
ds_read_b64_tr_b16 v[66:67], v5 offset:2048
v_mfma_f32_16x16x32_bf16 v[140:143], v[164:167], v[100:103], v[140:143]
ds_read_b128 v[36:39], v2 offset:256
buffer_load_dwordx4 v[192:195], v9, s[68:71], 0 offen offset:0 sc1
v_mfma_f32_16x16x32_bf16 v[144:147], v[160:163], v[104:107], v[144:147]
ds_read_b64_tr_b16 v[68:69], v6 offset:0
v_mfma_f32_16x16x32_bf16 v[148:151], v[164:167], v[104:107], v[148:151]
ds_read_b128 v[40:43], v2 offset:512
v_mfma_f32_16x16x32_bf16 v[152:155], v[160:163], v[108:111], v[152:155]
ds_read_b64_tr_b16 v[70:71], v6 offset:2048
buffer_load_dwordx4 v[196:199], v9, s[68:71], 0 offen offset:1024 sc1
v_mfma_f32_16x16x32_bf16 v[156:159], v[164:167], v[108:111], v[156:159]
ds_read_b128 v[44:47], v2 offset:768
v_mfma_f32_16x16x32_bf16 v[128:131], v[168:171], v[112:115], v[128:131]
ds_read_b64_tr_b16 v[72:73], v5 offset:4096
v_mfma_f32_16x16x32_bf16 v[132:135], v[172:175], v[112:115], v[132:135]
ds_read_b128 v[48:51], v2 offset:8192
buffer_load_dwordx4 v[200:203], v9, s[68:71], 0 offen offset:2048 sc1
v_mfma_f32_16x16x32_bf16 v[136:139], v[168:171], v[116:119], v[136:139]
ds_read_b64_tr_b16 v[74:75], v5 offset:6144
v_mfma_f32_16x16x32_bf16 v[140:143], v[172:175], v[116:119], v[140:143]
ds_read_b128 v[52:55], v2 offset:8448
v_mfma_f32_16x16x32_bf16 v[144:147], v[168:171], v[120:123], v[144:147]
ds_read_b64_tr_b16 v[76:77], v6 offset:4096
buffer_load_dwordx4 v[204:207], v9, s[68:71], 0 offen offset:3072 sc1
v_mfma_f32_16x16x32_bf16 v[148:151], v[172:175], v[120:123], v[148:151]
ds_read_b128 v[56:59], v2 offset:8704
v_mfma_f32_16x16x32_bf16 v[152:155], v[168:171], v[124:127], v[152:155]
ds_read_b64_tr_b16 v[78:79], v6 offset:6144
v_mfma_f32_16x16x32_bf16 v[156:159], v[172:175], v[124:127], v[156:159]
ds_read_b128 v[60:63], v2 offset:8960
s_waitcnt lgkmcnt(0)
s_barrier
v_mfma_f32_16x16x32_bf16 v[128:131], v[64:67], v[32:35], v[128:131]
ds_read_b64_tr_b16 v[160:161], v5 offset:32768
v_mfma_f32_16x16x32_bf16 v[132:135], v[68:71], v[32:35], v[132:135]
ds_read_b128 v[96:99], v2 offset:32768
v_mfma_f32_16x16x32_bf16 v[136:139], v[64:67], v[36:39], v[136:139]
ds_read_b64_tr_b16 v[162:163], v5 offset:34816
v_mfma_f32_16x16x32_bf16 v[140:143], v[68:71], v[36:39], v[140:143]
ds_read_b128 v[100:103], v2 offset:33024
v_mfma_f32_16x16x32_bf16 v[144:147], v[64:67], v[40:43], v[144:147]
ds_read_b64_tr_b16 v[164:165], v6 offset:32768
v_mfma_f32_16x16x32_bf16 v[148:151], v[68:71], v[40:43], v[148:151]
ds_read_b128 v[104:107], v2 offset:33280
v_mfma_f32_16x16x32_bf16 v[152:155], v[64:67], v[44:47], v[152:155]
ds_read_b64_tr_b16 v[166:167], v6 offset:34816
v_mfma_f32_16x16x32_bf16 v[156:159], v[68:71], v[44:47], v[156:159]
ds_read_b128 v[108:111], v2 offset:33536
v_mfma_f32_16x16x32_bf16 v[128:131], v[72:75], v[48:51], v[128:131]
ds_read_b64_tr_b16 v[168:169], v5 offset:36864
v_mfma_f32_16x16x32_bf16 v[132:135], v[76:79], v[48:51], v[132:135]
ds_read_b128 v[112:115], v2 offset:40960
v_mfma_f32_16x16x32_bf16 v[136:139], v[72:75], v[52:55], v[136:139]
ds_read_b64_tr_b16 v[170:171], v5 offset:38912
v_mfma_f32_16x16x32_bf16 v[140:143], v[76:79], v[52:55], v[140:143]
ds_read_b128 v[116:119], v2 offset:41216
v_mfma_f32_16x16x32_bf16 v[144:147], v[72:75], v[56:59], v[144:147]
ds_read_b64_tr_b16 v[172:173], v6 offset:36864
v_mfma_f32_16x16x32_bf16 v[148:151], v[76:79], v[56:59], v[148:151]
ds_read_b128 v[120:123], v2 offset:41472
v_mfma_f32_16x16x32_bf16 v[152:155], v[72:75], v[60:63], v[152:155]
ds_read_b64_tr_b16 v[174:175], v6 offset:38912
v_mfma_f32_16x16x32_bf16 v[156:159], v[76:79], v[60:63], v[156:159]
ds_read_b128 v[124:127], v2 offset:41728
s_waitcnt lgkmcnt(0)
s_barrier
v_mfma_f32_16x16x32_bf16 v[128:131], v[160:163], v[96:99], v[128:131]
v_mfma_f32_16x16x32_bf16 v[132:135], v[164:167], v[96:99], v[132:135]
v_mfma_f32_16x16x32_bf16 v[136:139], v[160:163], v[100:103], v[136:139]
v_mfma_f32_16x16x32_bf16 v[140:143], v[164:167], v[100:103], v[140:143]
v_mfma_f32_16x16x32_bf16 v[144:147], v[160:163], v[104:107], v[144:147]
v_mfma_f32_16x16x32_bf16 v[148:151], v[164:167], v[104:107], v[148:151]
v_mfma_f32_16x16x32_bf16 v[152:155], v[160:163], v[108:111], v[152:155]
v_mfma_f32_16x16x32_bf16 v[156:159], v[164:167], v[108:111], v[156:159]
s_waitcnt vmcnt(0)
v_mfma_f32_16x16x32_bf16 v[128:131], v[168:171], v[112:115], v[128:131]
v_lshlrev_b32 v224, 16, v192
v_and_b32 v225, 0xffff0000, v192
v_lshlrev_b32 v226, 16, v193
v_and_b32 v227, 0xffff0000, v193
v_mfma_f32_16x16x32_bf16 v[132:135], v[172:175], v[112:115], v[132:135]
v_lshlrev_b32 v228, 16, v194
v_and_b32 v229, 0xffff0000, v194
v_lshlrev_b32 v230, 16, v195
v_and_b32 v231, 0xffff0000, v195
v_mfma_f32_16x16x32_bf16 v[136:139], v[168:171], v[116:119], v[136:139]
v_lshlrev_b32 v232, 16, v196
v_and_b32 v233, 0xffff0000, v196
v_lshlrev_b32 v234, 16, v197
v_and_b32 v235, 0xffff0000, v197
v_mfma_f32_16x16x32_bf16 v[140:143], v[172:175], v[116:119], v[140:143]
v_lshlrev_b32 v236, 16, v198
v_and_b32 v237, 0xffff0000, v198
v_lshlrev_b32 v238, 16, v199
v_and_b32 v239, 0xffff0000, v199
v_mfma_f32_16x16x32_bf16 v[144:147], v[168:171], v[120:123], v[144:147]
v_lshlrev_b32 v240, 16, v200
v_and_b32 v241, 0xffff0000, v200
v_lshlrev_b32 v242, 16, v201
v_and_b32 v243, 0xffff0000, v201
v_mfma_f32_16x16x32_bf16 v[148:151], v[172:175], v[120:123], v[148:151]
v_lshlrev_b32 v244, 16, v202
v_and_b32 v245, 0xffff0000, v202
v_lshlrev_b32 v246, 16, v203
v_and_b32 v247, 0xffff0000, v203
v_mfma_f32_16x16x32_bf16 v[152:155], v[168:171], v[124:127], v[152:155]
v_lshlrev_b32 v248, 16, v204
v_and_b32 v249, 0xffff0000, v204
v_lshlrev_b32 v250, 16, v205
v_and_b32 v251, 0xffff0000, v205
v_mfma_f32_16x16x32_bf16 v[156:159], v[172:175], v[124:127], v[156:159]
v_lshlrev_b32 v252, 16, v206
v_and_b32 v253, 0xffff0000, v206
v_lshlrev_b32 v254, 16, v207
v_and_b32 v255, 0xffff0000, v207
s_waitcnt vmcnt(0)
s_nop 4
v_pk_add_f32 v[128:129], v[128:129], v[224:225]
v_pk_add_f32 v[130:131], v[130:131], v[226:227]
v_pk_add_f32 v[132:133], v[132:133], v[228:229]
v_pk_add_f32 v[134:135], v[134:135], v[230:231]
v_cvt_pk_bf16_f32 v32, v128, v129
v_cvt_pk_bf16_f32 v33, v130, v131
v_cvt_pk_bf16_f32 v34, v132, v133
v_cvt_pk_bf16_f32 v35, v134, v135
v_pk_add_f32 v[136:137], v[136:137], v[232:233]
v_pk_add_f32 v[138:139], v[138:139], v[234:235]
v_pk_add_f32 v[140:141], v[140:141], v[236:237]
v_pk_add_f32 v[142:143], v[142:143], v[238:239]
v_cvt_pk_bf16_f32 v36, v136, v137
v_cvt_pk_bf16_f32 v37, v138, v139
v_cvt_pk_bf16_f32 v38, v140, v141
v_cvt_pk_bf16_f32 v39, v142, v143
v_pk_add_f32 v[144:145], v[144:145], v[240:241]
v_pk_add_f32 v[146:147], v[146:147], v[242:243]
v_pk_add_f32 v[148:149], v[148:149], v[244:245]
v_pk_add_f32 v[150:151], v[150:151], v[246:247]
v_cvt_pk_bf16_f32 v40, v144, v145
v_cvt_pk_bf16_f32 v41, v146, v147
v_cvt_pk_bf16_f32 v42, v148, v149
v_cvt_pk_bf16_f32 v43, v150, v151
v_pk_add_f32 v[152:153], v[152:153], v[248:249]
v_pk_add_f32 v[154:155], v[154:155], v[250:251]
v_pk_add_f32 v[156:157], v[156:157], v[252:253]
v_pk_add_f32 v[158:159], v[158:159], v[254:255]
v_cvt_pk_bf16_f32 v44, v152, v153
v_cvt_pk_bf16_f32 v45, v154, v155
v_cvt_pk_bf16_f32 v46, v156, v157
v_cvt_pk_bf16_f32 v47, v158, v159
v_permlane16_swap_b32 v32, v34
v_permlane16_swap_b32 v33, v35
buffer_store_dwordx4 v[32:35], v28, s[16:19], 0 offen offset:0
v_permlane16_swap_b32 v36, v38
v_permlane16_swap_b32 v37, v39
buffer_store_dwordx4 v[36:39], v28, s[16:19], 0 offen offset:2048
v_permlane16_swap_b32 v40, v42
v_permlane16_swap_b32 v41, v43
buffer_store_dwordx4 v[40:43], v28, s[16:19], s54 offen offset:0
v_permlane16_swap_b32 v44, v46
v_permlane16_swap_b32 v45, v47
buffer_store_dwordx4 v[44:47], v28, s[16:19], s54 offen offset:2048
s_branch Ldone_1
.p2align 6
Lw_24:
s_branch Lr_25
s_nop 0
.p2align 3
LG1_50:
s_cmp_eq_u32 s36, 7
s_cbranch_scc1 L7_133
s_mul_i32 s44, s34, 262144
s_lshl_b32 s39, s51, 13
s_add_u32 s44, s44, s39
s_add_u32 s44, s44, 0
s_lshl_b32 s43, s35, 7
s_mov_b32 s10, 253952
s_movk_i32 s38, 1024
s_movk_i32 s40, 9216
s_cmp_eq_u32 s51, 2
s_cselect_b32 s8, s28, s32
s_cselect_b32 s9, s29, s33
s_cselect_b32 s10, 2095232, s10
s_cselect_b32 s43, s43, s44
s_cselect_b32 s38, 16384, s38
s_cselect_b32 s40, 16384, s40
s_cselect_b32 s55, 16384, s38
s_cselect_b32 s45, -1, 0
s_add_u32 s8, s8, s43
s_addc_u32 s9, s9, 0
s_mov_b32 s11, 0x20000
s_sub_u32 s37, 0, s40
v_lshrrev_b32 v19, 3, v1
v_mul_u32_u24 v19, 1920, v19
v_lshrrev_b32 v20, 4, v1
v_lshlrev_b32 v20, 5, v20
v_and_b32 v19, s45, v19
v_and_b32 v20, s45, v20
v_lshlrev_b32 v23, 4, v1
v_xor_b32 v23, v23, v20
v_add_u32 v23, v23, v19
s_lshl_b32 s43, s34, 18
s_add_u32 s12, s32, s43
s_addc_u32 s13, s33, 0
s_mov_b32 s14, 262144
s_mov_b32 s15, 0x20000
v_lshlrev_b32 v21, 4, v1
s_lshl_b32 s54, s36, 11
s_xor_b32 s43, s35, 1
s_and_b32 s43, s43, 15
s_lshl_b32 s43, s43, 14
s_add_u32 s30, s43, s54
s_xor_b32 s43, s35, 2
s_and_b32 s43, s43, 15
s_lshl_b32 s43, s43, 14
s_add_u32 s31, s43, s54
s_cmp_eq_u32 s51, 1
s_cbranch_scc1 Lp_137
s_cmp_eq_u32 s51, 2
s_cbranch_scc1 Lp_138
.p2align 3
Lp_136:
s_mov_b32 s42, 2
s_waitcnt vmcnt(0)
s_barrier
ds_write_b128 v27, v[68:71] offset:0
ds_write_b128 v27, v[116:119] offset:512
s_waitcnt lgkmcnt(0)
s_barrier
s_add_u32 m0, s54, 16384
s_add_u32 s43, s30, 0
buffer_load_dwordx4 v21, s[12:15], s43 offen sc1 lds
s_add_u32 m0, s54, 17408
s_add_u32 s43, s30, 1024
buffer_load_dwordx4 v21, s[12:15], s43 offen sc1 lds
s_add_u32 m0, s54, 32768
s_add_u32 s43, s31, 0
buffer_load_dwordx4 v21, s[12:15], s43 offen sc1 lds
s_add_u32 m0, s54, 33792
s_add_u32 s43, s31, 1024
buffer_load_dwordx4 v21, s[12:15], s43 offen sc1 lds
s_add_u32 s42, s42, 1
s_xor_b32 s37, s42, s35
s_add_u32 m0, s39, 49152
s_lshl_b32 s37, s37, 14
buffer_load_dwordx4 v23, s[8:11], s37 offen sc1 lds
s_add_u32 m0, s39, 50176
s_add_u32 s37, s37, s38
buffer_load_dwordx4 v23, s[8:11], s37 offen sc1 lds
s_add_u32 m0, s39, 51200
s_add_u32 s37, s37, s38
buffer_load_dwordx4 v23, s[8:11], s37 offen sc1 lds
s_add_u32 m0, s39, 52224
s_add_u32 s37, s37, s38
buffer_load_dwordx4 v23, s[8:11], s37 offen sc1 lds
s_add_u32 m0, s39, 53248
s_add_u32 s37, s37, s38
buffer_load_dwordx4 v23, s[8:11], s37 offen sc1 lds
s_add_u32 m0, s39, 54272
s_add_u32 s37, s37, s38
buffer_load_dwordx4 v23, s[8:11], s37 offen sc1 lds
s_add_u32 m0, s39, 55296
s_add_u32 s37, s37, s38
buffer_load_dwordx4 v23, s[8:11], s37 offen sc1 lds
s_add_u32 m0, s39, 56320
s_add_u32 s37, s37, s38
buffer_load_dwordx4 v23, s[8:11], s37 offen sc1 lds
s_waitcnt vmcnt(10)
s_barrier
s_add_u32 s42, s42, 1
s_xor_b32 s37, s42, s35
s_add_u32 m0, s39, 0
s_lshl_b32 s37, s37, 14
buffer_load_dwordx4 v23, s[8:11], s37 offen sc1 lds
s_add_u32 m0, s39, 1024
s_add_u32 s37, s37, s38
buffer_load_dwordx4 v23, s[8:11], s37 offen sc1 lds
s_add_u32 m0, s39, 2048
s_add_u32 s37, s37, s38
buffer_load_dwordx4 v23, s[8:11], s37 offen sc1 lds
s_add_u32 m0, s39, 3072
s_add_u32 s37, s37, s38
buffer_load_dwordx4 v23, s[8:11], s37 offen sc1 lds
s_add_u32 m0, s39, 4096
s_add_u32 s37, s37, s38
buffer_load_dwordx4 v23, s[8:11], s37 offen sc1 lds
s_add_u32 m0, s39, 5120
s_add_u32 s37, s37, s38
buffer_load_dwordx4 v23, s[8:11], s37 offen sc1 lds
s_add_u32 m0, s39, 6144
s_add_u32 s37, s37, s38
buffer_load_dwordx4 v23, s[8:11], s37 offen sc1 lds
s_add_u32 m0, s39, 7168
s_add_u32 s37, s37, s38
buffer_load_dwordx4 v23, s[8:11], s37 offen sc1 lds
s_waitcnt vmcnt(16)
s_barrier
s_add_u32 s42, s42, 1
s_xor_b32 s37, s42, s35
s_add_u32 m0, s39, 16384
s_lshl_b32 s37, s37, 14
buffer_load_dwordx4 v23, s[8:11], s37 offen sc1 lds
s_add_u32 m0, s39, 17408
s_add_u32 s37, s37, s38
buffer_load_dwordx4 v23, s[8:11], s37 offen sc1 lds
s_add_u32 m0, s39, 18432
s_add_u32 s37, s37, s38
buffer_load_dwordx4 v23, s[8:11], s37 offen sc1 lds
s_add_u32 m0, s39, 19456
s_add_u32 s37, s37, s38
buffer_load_dwordx4 v23, s[8:11], s37 offen sc1 lds
s_add_u32 m0, s39, 20480
s_add_u32 s37, s37, s38
buffer_load_dwordx4 v23, s[8:11], s37 offen sc1 lds
s_add_u32 m0, s39, 21504
s_add_u32 s37, s37, s38
buffer_load_dwordx4 v23, s[8:11], s37 offen sc1 lds
s_add_u32 m0, s39, 22528
s_add_u32 s37, s37, s38
buffer_load_dwordx4 v23, s[8:11], s37 offen sc1 lds
s_add_u32 m0, s39, 23552
s_add_u32 s37, s37, s38
buffer_load_dwordx4 v23, s[8:11], s37 offen sc1 lds
s_waitcnt vmcnt(16)
s_barrier
s_add_u32 s42, s42, 1
s_xor_b32 s37, s42, s35
s_add_u32 m0, s39, 32768
s_lshl_b32 s37, s37, 14
buffer_load_dwordx4 v23, s[8:11], s37 offen sc1 lds
s_add_u32 m0, s39, 33792
s_add_u32 s37, s37, s38
buffer_load_dwordx4 v23, s[8:11], s37 offen sc1 lds
s_add_u32 m0, s39, 34816
s_add_u32 s37, s37, s38
buffer_load_dwordx4 v23, s[8:11], s37 offen sc1 lds
s_add_u32 m0, s39, 35840
s_add_u32 s37, s37, s38
buffer_load_dwordx4 v23, s[8:11], s37 offen sc1 lds
s_add_u32 m0, s39, 36864
s_add_u32 s37, s37, s38
buffer_load_dwordx4 v23, s[8:11], s37 offen sc1 lds
s_add_u32 m0, s39, 37888
s_add_u32 s37, s37, s38
buffer_load_dwordx4 v23, s[8:11], s37 offen sc1 lds
s_add_u32 m0, s39, 38912
s_add_u32 s37, s37, s38
buffer_load_dwordx4 v23, s[8:11], s37 offen sc1 lds
s_add_u32 m0, s39, 39936
s_add_u32 s37, s37, s38
buffer_load_dwordx4 v23, s[8:11], s37 offen sc1 lds
s_waitcnt vmcnt(16)
s_barrier
s_add_u32 s42, s42, 1
s_xor_b32 s37, s42, s35
s_add_u32 m0, s39, 49152
s_lshl_b32 s37, s37, 14
buffer_load_dwordx4 v23, s[8:11], s37 offen sc1 lds
s_add_u32 m0, s39, 50176
s_add_u32 s37, s37, s38
buffer_load_dwordx4 v23, s[8:11], s37 offen sc1 lds
s_add_u32 m0, s39, 51200
s_add_u32 s37, s37, s38
buffer_load_dwordx4 v23, s[8:11], s37 offen sc1 lds
s_add_u32 m0, s39, 52224
s_add_u32 s37, s37, s38
buffer_load_dwordx4 v23, s[8:11], s37 offen sc1 lds
s_add_u32 m0, s39, 53248
s_add_u32 s37, s37, s38
buffer_load_dwordx4 v23, s[8:11], s37 offen sc1 lds
s_add_u32 m0, s39, 54272
s_add_u32 s37, s37, s38
buffer_load_dwordx4 v23, s[8:11], s37 offen sc1 lds
s_add_u32 m0, s39, 55296
s_add_u32 s37, s37, s38
buffer_load_dwordx4 v23, s[8:11], s37 offen sc1 lds
s_add_u32 m0, s39, 56320
s_add_u32 s37, s37, s38
buffer_load_dwordx4 v23, s[8:11], s37 offen sc1 lds
s_waitcnt vmcnt(16)
s_barrier
s_add_u32 s42, s42, 1
s_xor_b32 s37, s42, s35
s_add_u32 m0, s39, 0
s_lshl_b32 s37, s37, 14
buffer_load_dwordx4 v23, s[8:11], s37 offen sc1 lds
s_add_u32 m0, s39, 1024
s_add_u32 s37, s37, s38
buffer_load_dwordx4 v23, s[8:11], s37 offen sc1 lds
s_add_u32 m0, s39, 2048
s_add_u32 s37, s37, s38
buffer_load_dwordx4 v23, s[8:11], s37 offen sc1 lds
s_add_u32 m0, s39, 3072
s_add_u32 s37, s37, s38
buffer_load_dwordx4 v23, s[8:11], s37 offen sc1 lds
s_add_u32 m0, s39, 4096
s_add_u32 s37, s37, s38
buffer_load_dwordx4 v23, s[8:11], s37 offen sc1 lds
s_add_u32 m0, s39, 5120
s_add_u32 s37, s37, s38
buffer_load_dwordx4 v23, s[8:11], s37 offen sc1 lds
s_add_u32 m0, s39, 6144
s_add_u32 s37, s37, s38
buffer_load_dwordx4 v23, s[8:11], s37 offen sc1 lds
s_add_u32 m0, s39, 7168
s_add_u32 s37, s37, s38
buffer_load_dwordx4 v23, s[8:11], s37 offen sc1 lds
s_waitcnt vmcnt(16)
s_barrier
s_add_u32 s42, s42, 1
s_xor_b32 s37, s42, s35
s_add_u32 m0, s39, 16384
s_lshl_b32 s37, s37, 14
buffer_load_dwordx4 v23, s[8:11], s37 offen sc1 lds
s_add_u32 m0, s39, 17408
s_add_u32 s37, s37, s38
buffer_load_dwordx4 v23, s[8:11], s37 offen sc1 lds
s_add_u32 m0, s39, 18432
s_add_u32 s37, s37, s38
buffer_load_dwordx4 v23, s[8:11], s37 offen sc1 lds
s_add_u32 m0, s39, 19456
s_add_u32 s37, s37, s38
buffer_load_dwordx4 v23, s[8:11], s37 offen sc1 lds
s_add_u32 m0, s39, 20480
s_add_u32 s37, s37, s38
buffer_load_dwordx4 v23, s[8:11], s37 offen sc1 lds
s_add_u32 m0, s39, 21504
s_add_u32 s37, s37, s38
buffer_load_dwordx4 v23, s[8:11], s37 offen sc1 lds
s_add_u32 m0, s39, 22528
s_add_u32 s37, s37, s38
buffer_load_dwordx4 v23, s[8:11], s37 offen sc1 lds
s_add_u32 m0, s39, 23552
s_add_u32 s37, s37, s38
buffer_load_dwordx4 v23, s[8:11], s37 offen sc1 lds
s_waitcnt vmcnt(16)
s_barrier
s_add_u32 s42, s42, 1
s_xor_b32 s37, s42, s35
s_add_u32 m0, s39, 32768
s_lshl_b32 s37, s37, 14
buffer_load_dwordx4 v23, s[8:11], s37 offen sc1 lds
s_add_u32 m0, s39, 33792
s_add_u32 s37, s37, s38
buffer_load_dwordx4 v23, s[8:11], s37 offen sc1 lds
s_add_u32 m0, s39, 34816
s_add_u32 s37, s37, s38
buffer_load_dwordx4 v23, s[8:11], s37 offen sc1 lds
s_add_u32 m0, s39, 35840
s_add_u32 s37, s37, s38
buffer_load_dwordx4 v23, s[8:11], s37 offen sc1 lds
s_add_u32 m0, s39, 36864
s_add_u32 s37, s37, s38
buffer_load_dwordx4 v23, s[8:11], s37 offen sc1 lds
s_add_u32 m0, s39, 37888
s_add_u32 s37, s37, s38
buffer_load_dwordx4 v23, s[8:11], s37 offen sc1 lds
s_add_u32 m0, s39, 38912
s_add_u32 s37, s37, s38
buffer_load_dwordx4 v23, s[8:11], s37 offen sc1 lds
s_add_u32 m0, s39, 39936
s_add_u32 s37, s37, s38
buffer_load_dwordx4 v23, s[8:11], s37 offen sc1 lds
s_waitcnt vmcnt(16)
s_barrier
s_add_u32 s42, s42, 1
s_xor_b32 s37, s42, s35
s_add_u32 m0, s39, 49152
s_lshl_b32 s37, s37, 14
buffer_load_dwordx4 v23, s[8:11], s37 offen sc1 lds
s_add_u32 m0, s39, 50176
s_add_u32 s37, s37, s38
buffer_load_dwordx4 v23, s[8:11], s37 offen sc1 lds
s_add_u32 m0, s39, 51200
s_add_u32 s37, s37, s38
buffer_load_dwordx4 v23, s[8:11], s37 offen sc1 lds
s_add_u32 m0, s39, 52224
s_add_u32 s37, s37, s38
buffer_load_dwordx4 v23, s[8:11], s37 offen sc1 lds
s_add_u32 m0, s39, 53248
s_add_u32 s37, s37, s38
buffer_load_dwordx4 v23, s[8:11], s37 offen sc1 lds
s_add_u32 m0, s39, 54272
s_add_u32 s37, s37, s38
buffer_load_dwordx4 v23, s[8:11], s37 offen sc1 lds
s_add_u32 m0, s39, 55296
s_add_u32 s37, s37, s38
buffer_load_dwordx4 v23, s[8:11], s37 offen sc1 lds
s_add_u32 m0, s39, 56320
s_add_u32 s37, s37, s38
buffer_load_dwordx4 v23, s[8:11], s37 offen sc1 lds
s_waitcnt vmcnt(16)
s_barrier
s_add_u32 s42, s42, 1
s_xor_b32 s37, s42, s35
s_add_u32 m0, s39, 0
s_lshl_b32 s37, s37, 14
buffer_load_dwordx4 v23, s[8:11], s37 offen sc1 lds
s_add_u32 m0, s39, 1024
s_add_u32 s37, s37, s38
buffer_load_dwordx4 v23, s[8:11], s37 offen sc1 lds
s_add_u32 m0, s39, 2048
s_add_u32 s37, s37, s38
buffer_load_dwordx4 v23, s[8:11], s37 offen sc1 lds
s_add_u32 m0, s39, 3072
s_add_u32 s37, s37, s38
buffer_load_dwordx4 v23, s[8:11], s37 offen sc1 lds
s_add_u32 m0, s39, 4096
s_add_u32 s37, s37, s38
buffer_load_dwordx4 v23, s[8:11], s37 offen sc1 lds
s_add_u32 m0, s39, 5120
s_add_u32 s37, s37, s38
buffer_load_dwordx4 v23, s[8:11], s37 offen sc1 lds
s_add_u32 m0, s39, 6144
s_add_u32 s37, s37, s38
buffer_load_dwordx4 v23, s[8:11], s37 offen sc1 lds
s_add_u32 m0, s39, 7168
s_add_u32 s37, s37, s38
buffer_load_dwordx4 v23, s[8:11], s37 offen sc1 lds
s_waitcnt vmcnt(16)
s_barrier
s_add_u32 s42, s42, 1
s_xor_b32 s37, s42, s35
s_add_u32 m0, s39, 16384
s_lshl_b32 s37, s37, 14
buffer_load_dwordx4 v23, s[8:11], s37 offen sc1 lds
s_add_u32 m0, s39, 17408
s_add_u32 s37, s37, s38
buffer_load_dwordx4 v23, s[8:11], s37 offen sc1 lds
s_add_u32 m0, s39, 18432
s_add_u32 s37, s37, s38
buffer_load_dwordx4 v23, s[8:11], s37 offen sc1 lds
s_add_u32 m0, s39, 19456
s_add_u32 s37, s37, s38
buffer_load_dwordx4 v23, s[8:11], s37 offen sc1 lds
s_add_u32 m0, s39, 20480
s_add_u32 s37, s37, s38
buffer_load_dwordx4 v23, s[8:11], s37 offen sc1 lds
s_add_u32 m0, s39, 21504
s_add_u32 s37, s37, s38
buffer_load_dwordx4 v23, s[8:11], s37 offen sc1 lds
s_add_u32 m0, s39, 22528
s_add_u32 s37, s37, s38
buffer_load_dwordx4 v23, s[8:11], s37 offen sc1 lds
s_add_u32 m0, s39, 23552
s_add_u32 s37, s37, s38
buffer_load_dwordx4 v23, s[8:11], s37 offen sc1 lds
s_waitcnt vmcnt(16)
s_barrier
s_add_u32 s42, s42, 1
s_xor_b32 s37, s42, s35
s_add_u32 m0, s39, 32768
s_lshl_b32 s37, s37, 14
buffer_load_dwordx4 v23, s[8:11], s37 offen sc1 lds
s_add_u32 m0, s39, 33792
s_add_u32 s37, s37, s38
buffer_load_dwordx4 v23, s[8:11], s37 offen sc1 lds
s_add_u32 m0, s39, 34816
s_add_u32 s37, s37, s38
buffer_load_dwordx4 v23, s[8:11], s37 offen sc1 lds
s_add_u32 m0, s39, 35840
s_add_u32 s37, s37, s38
buffer_load_dwordx4 v23, s[8:11], s37 offen sc1 lds
s_add_u32 m0, s39, 36864
s_add_u32 s37, s37, s38
buffer_load_dwordx4 v23, s[8:11], s37 offen sc1 lds
s_add_u32 m0, s39, 37888
s_add_u32 s37, s37, s38
buffer_load_dwordx4 v23, s[8:11], s37 offen sc1 lds
s_add_u32 m0, s39, 38912
s_add_u32 s37, s37, s38
buffer_load_dwordx4 v23, s[8:11], s37 offen sc1 lds
s_add_u32 m0, s39, 39936
s_add_u32 s37, s37, s38
buffer_load_dwordx4 v23, s[8:11], s37 offen sc1 lds
s_waitcnt vmcnt(16)
s_barrier
s_add_u32 s42, s42, 1
s_xor_b32 s37, s42, s35
s_add_u32 m0, s39, 49152
s_lshl_b32 s37, s37, 14
buffer_load_dwordx4 v23, s[8:11], s37 offen sc1 lds
s_add_u32 m0, s39, 50176
s_add_u32 s37, s37, s38
buffer_load_dwordx4 v23, s[8:11], s37 offen sc1 lds
s_add_u32 m0, s39, 51200
s_add_u32 s37, s37, s38
buffer_load_dwordx4 v23, s[8:11], s37 offen sc1 lds
s_add_u32 m0, s39, 52224
s_add_u32 s37, s37, s38
buffer_load_dwordx4 v23, s[8:11], s37 offen sc1 lds
s_add_u32 m0, s39, 53248
s_add_u32 s37, s37, s38
buffer_load_dwordx4 v23, s[8:11], s37 offen sc1 lds
s_add_u32 m0, s39, 54272
s_add_u32 s37, s37, s38
buffer_load_dwordx4 v23, s[8:11], s37 offen sc1 lds
s_add_u32 m0, s39, 55296
s_add_u32 s37, s37, s38
buffer_load_dwordx4 v23, s[8:11], s37 offen sc1 lds
s_add_u32 m0, s39, 56320
s_add_u32 s37, s37, s38
buffer_load_dwordx4 v23, s[8:11], s37 offen sc1 lds
s_lshl_b32 s43, s35, 8
s_cmp_eq_u32 s51, 1
s_cselect_b32 s8, s4, s6
s_cselect_b32 s9, s5, s7
s_sub_u32 s10, 7340032, s43
s_lshl_b32 s44, s34, 18
s_add_u32 s44, s44, 4194304
s_movk_i32 s38, 28672
s_cmp_eq_u32 s51, 0
s_cselect_b32 s8, s32, s8
s_cselect_b32 s9, s33, s9
s_cselect_b32 s10, 262144, s10
s_cselect_b32 s43, s44, s43
s_cselect_b32 s38, 1024, s38
s_cselect_b32 s45, 0, -1
s_add_u32 s8, s8, s43
s_addc_u32 s9, s9, 0
s_mov_b32 s11, 0x20000
s_lshl_b32 s40, s38, 4
s_mov_b32 s42, -1
s_lshl_b32 s39, s51, 14
v_lshrrev_b32 v19, 4, v1
v_lshlrev_b32 v20, 5, v19
v_mul_u32_u24 v19, 6912, v19
v_and_b32 v19, s45, v19
v_and_b32 v20, s45, v20
v_lshlrev_b32 v21, 4, v1
v_xor_b32 v21, v21, v20
v_add_u32 v22, v21, v19
s_and_b32 s45, s45, 128
v_xor_b32 v23, s45, v22
s_waitcnt vmcnt(16)
s_barrier
s_waitcnt vmcnt(8)
s_barrier
s_waitcnt vmcnt(0)
s_barrier
s_barrier
s_barrier
s_add_u32 s43, s34, 16
s_lshl_b32 s43, s43, 7
v_mov_b32 v8, s43
v_mov_b32 v10, 16
buffer_load_dword v9, v8, s[56:59], 0 offen sc1
s_waitcnt vmcnt(0)
s_add_u32 s43, s34, 16
s_lshl_b32 s43, s43, 7
v_mov_b32 v8, s43
v_mov_b32 v10, 16
buffer_load_dword v9, v8, s[56:59], 0 offen sc1
s_waitcnt vmcnt(0)
s_add_u32 s42, s42, 1
s_add_u32 s42, s42, 1
s_xor_b32 s37, s42, s35
s_add_u32 m0, s39, 0
s_mul_i32 s37, s37, s40
buffer_load_dwordx4 v22, s[8:11], s37 offen sc1 lds
s_add_u32 m0, s39, 1024
s_add_u32 s37, s37, s38
buffer_load_dwordx4 v23, s[8:11], s37 offen sc1 lds
s_add_u32 m0, s39, 2048
s_add_u32 s37, s37, s38
buffer_load_dwordx4 v22, s[8:11], s37 offen sc1 lds
s_add_u32 m0, s39, 3072
s_add_u32 s37, s37, s38
buffer_load_dwordx4 v23, s[8:11], s37 offen sc1 lds
s_add_u32 m0, s39, 4096
s_add_u32 s37, s37, s38
buffer_load_dwordx4 v22, s[8:11], s37 offen sc1 lds
s_add_u32 m0, s39, 5120
s_add_u32 s37, s37, s38
buffer_load_dwordx4 v23, s[8:11], s37 offen sc1 lds
s_add_u32 m0, s39, 6144
s_add_u32 s37, s37, s38
buffer_load_dwordx4 v22, s[8:11], s37 offen sc1 lds
s_add_u32 m0, s39, 7168
s_add_u32 s37, s37, s38
buffer_load_dwordx4 v23, s[8:11], s37 offen sc1 lds
s_add_u32 m0, s39, 8192
s_add_u32 s37, s37, s38
buffer_load_dwordx4 v22, s[8:11], s37 offen sc1 lds
s_add_u32 m0, s39, 9216
s_add_u32 s37, s37, s38
buffer_load_dwordx4 v23, s[8:11], s37 offen sc1 lds
s_add_u32 m0, s39, 10240
s_add_u32 s37, s37, s38
buffer_load_dwordx4 v22, s[8:11], s37 offen sc1 lds
s_add_u32 m0, s39, 11264
s_add_u32 s37, s37, s38
buffer_load_dwordx4 v23, s[8:11], s37 offen sc1 lds
s_add_u32 m0, s39, 12288
s_add_u32 s37, s37, s38
buffer_load_dwordx4 v22, s[8:11], s37 offen sc1 lds
s_add_u32 m0, s39, 13312
s_add_u32 s37, s37, s38
buffer_load_dwordx4 v23, s[8:11], s37 offen sc1 lds
s_add_u32 m0, s39, 14336
s_add_u32 s37, s37, s38
buffer_load_dwordx4 v22, s[8:11], s37 offen sc1 lds
s_add_u32 m0, s39, 15360
s_add_u32 s37, s37, s38
buffer_load_dwordx4 v23, s[8:11], s37 offen sc1 lds
s_add_u32 s42, s42, 1
s_xor_b32 s37, s42, s35
s_add_u32 m0, s39, 49152
s_mul_i32 s37, s37, s40
buffer_load_dwordx4 v22, s[8:11], s37 offen sc1 lds
s_add_u32 m0, s39, 50176
s_add_u32 s37, s37, s38
buffer_load_dwordx4 v23, s[8:11], s37 offen sc1 lds
s_add_u32 m0, s39, 51200
s_add_u32 s37, s37, s38
buffer_load_dwordx4 v22, s[8:11], s37 offen sc1 lds
s_add_u32 m0, s39, 52224
s_add_u32 s37, s37, s38
buffer_load_dwordx4 v23, s[8:11], s37 offen sc1 lds
s_add_u32 m0, s39, 53248
s_add_u32 s37, s37, s38
buffer_load_dwordx4 v22, s[8:11], s37 offen sc1 lds
s_add_u32 m0, s39, 54272
s_add_u32 s37, s37, s38
buffer_load_dwordx4 v23, s[8:11], s37 offen sc1 lds
s_add_u32 m0, s39, 55296
s_add_u32 s37, s37, s38
buffer_load_dwordx4 v22, s[8:11], s37 offen sc1 lds
s_add_u32 m0, s39, 56320
s_add_u32 s37, s37, s38
buffer_load_dwordx4 v23, s[8:11], s37 offen sc1 lds
s_add_u32 m0, s39, 57344
s_add_u32 s37, s37, s38
buffer_load_dwordx4 v22, s[8:11], s37 offen sc1 lds
s_add_u32 m0, s39, 58368
s_add_u32 s37, s37, s38
buffer_load_dwordx4 v23, s[8:11], s37 offen sc1 lds
s_add_u32 m0, s39, 59392
s_add_u32 s37, s37, s38
buffer_load_dwordx4 v22, s[8:11], s37 offen sc1 lds
s_add_u32 m0, s39, 60416
s_add_u32 s37, s37, s38
buffer_load_dwordx4 v23, s[8:11], s37 offen sc1 lds
s_add_u32 m0, s39, 61440
s_add_u32 s37, s37, s38
buffer_load_dwordx4 v22, s[8:11], s37 offen sc1 lds
s_add_u32 m0, s39, 62464
s_add_u32 s37, s37, s38
buffer_load_dwordx4 v23, s[8:11], s37 offen sc1 lds
s_add_u32 m0, s39, 63488
s_add_u32 s37, s37, s38
buffer_load_dwordx4 v22, s[8:11], s37 offen sc1 lds
s_add_u32 m0, s39, 64512
s_add_u32 s37, s37, s38
buffer_load_dwordx4 v23, s[8:11], s37 offen sc1 lds
s_branch LP3_135
.p2align 6
Lw_22:
s_branch Lr_23
s_nop 0
.p2align 3
Lp_137:
s_mov_b32 s42, 2
s_waitcnt vmcnt(0)
s_barrier
s_add_u32 s43, s34, 0
s_lshl_b32 s43, s43, 7
v_mov_b32 v13, s43
v_mov_b32 v14, 1
s_mov_b64 exec, 1
buffer_atomic_add v14, v13, s[56:59], 0 offen sc1
s_mov_b64 exec, -1
ds_write_b128 v27, v[68:71] offset:0
ds_write_b128 v27, v[116:119] offset:512
s_waitcnt lgkmcnt(0)
s_barrier
s_add_u32 m0, s54, 16384
s_add_u32 s43, s30, 0
buffer_load_dwordx4 v21, s[12:15], s43 offen sc1 lds
s_add_u32 m0, s54, 17408
s_add_u32 s43, s30, 1024
buffer_load_dwordx4 v21, s[12:15], s43 offen sc1 lds
s_add_u32 m0, s54, 32768
s_add_u32 s43, s31, 0
buffer_load_dwordx4 v21, s[12:15], s43 offen sc1 lds
s_add_u32 m0, s54, 33792
s_add_u32 s43, s31, 1024
buffer_load_dwordx4 v21, s[12:15], s43 offen sc1 lds
s_add_u32 s42, s42, 1
s_xor_b32 s37, s42, s35
s_add_u32 m0, s39, 49152
s_lshl_b32 s37, s37, 14
buffer_load_dwordx4 v23, s[8:11], s37 offen sc1 lds
s_add_u32 m0, s39, 50176
s_add_u32 s37, s37, s38
buffer_load_dwordx4 v23, s[8:11], s37 offen sc1 lds
s_add_u32 m0, s39, 51200
s_add_u32 s37, s37, s38
buffer_load_dwordx4 v23, s[8:11], s37 offen sc1 lds
s_add_u32 m0, s39, 52224
s_add_u32 s37, s37, s38
buffer_load_dwordx4 v23, s[8:11], s37 offen sc1 lds
s_add_u32 m0, s39, 53248
s_add_u32 s37, s37, s38
buffer_load_dwordx4 v23, s[8:11], s37 offen sc1 lds
s_add_u32 m0, s39, 54272
s_add_u32 s37, s37, s38
buffer_load_dwordx4 v23, s[8:11], s37 offen sc1 lds
s_add_u32 m0, s39, 55296
s_add_u32 s37, s37, s38
buffer_load_dwordx4 v23, s[8:11], s37 offen sc1 lds
s_add_u32 m0, s39, 56320
s_add_u32 s37, s37, s38
buffer_load_dwordx4 v23, s[8:11], s37 offen sc1 lds
s_waitcnt vmcnt(10)
s_barrier
s_add_u32 s42, s42, 1
s_xor_b32 s37, s42, s35
s_add_u32 m0, s39, 0
s_lshl_b32 s37, s37, 14
buffer_load_dwordx4 v23, s[8:11], s37 offen sc1 lds
s_add_u32 m0, s39, 1024
s_add_u32 s37, s37, s38
buffer_load_dwordx4 v23, s[8:11], s37 offen sc1 lds
s_add_u32 m0, s39, 2048
s_add_u32 s37, s37, s38
buffer_load_dwordx4 v23, s[8:11], s37 offen sc1 lds
s_add_u32 m0, s39, 3072
s_add_u32 s37, s37, s38
buffer_load_dwordx4 v23, s[8:11], s37 offen sc1 lds
s_add_u32 m0, s39, 4096
s_add_u32 s37, s37, s38
buffer_load_dwordx4 v23, s[8:11], s37 offen sc1 lds
s_add_u32 m0, s39, 5120
s_add_u32 s37, s37, s38
buffer_load_dwordx4 v23, s[8:11], s37 offen sc1 lds
s_add_u32 m0, s39, 6144
s_add_u32 s37, s37, s38
buffer_load_dwordx4 v23, s[8:11], s37 offen sc1 lds
s_add_u32 m0, s39, 7168
s_add_u32 s37, s37, s38
buffer_load_dwordx4 v23, s[8:11], s37 offen sc1 lds
s_waitcnt vmcnt(16)
s_barrier
s_add_u32 s42, s42, 1
s_xor_b32 s37, s42, s35
s_add_u32 m0, s39, 16384
s_lshl_b32 s37, s37, 14
buffer_load_dwordx4 v23, s[8:11], s37 offen sc1 lds
s_add_u32 m0, s39, 17408
s_add_u32 s37, s37, s38
buffer_load_dwordx4 v23, s[8:11], s37 offen sc1 lds
s_add_u32 m0, s39, 18432
s_add_u32 s37, s37, s38
buffer_load_dwordx4 v23, s[8:11], s37 offen sc1 lds
s_add_u32 m0, s39, 19456
s_add_u32 s37, s37, s38
buffer_load_dwordx4 v23, s[8:11], s37 offen sc1 lds
s_add_u32 m0, s39, 20480
s_add_u32 s37, s37, s38
buffer_load_dwordx4 v23, s[8:11], s37 offen sc1 lds
s_add_u32 m0, s39, 21504
s_add_u32 s37, s37, s38
buffer_load_dwordx4 v23, s[8:11], s37 offen sc1 lds
s_add_u32 m0, s39, 22528
s_add_u32 s37, s37, s38
buffer_load_dwordx4 v23, s[8:11], s37 offen sc1 lds
s_add_u32 m0, s39, 23552
s_add_u32 s37, s37, s38
buffer_load_dwordx4 v23, s[8:11], s37 offen sc1 lds
s_waitcnt vmcnt(16)
s_barrier
s_add_u32 s42, s42, 1
s_xor_b32 s37, s42, s35
s_add_u32 m0, s39, 32768
s_lshl_b32 s37, s37, 14
buffer_load_dwordx4 v23, s[8:11], s37 offen sc1 lds
s_add_u32 m0, s39, 33792
s_add_u32 s37, s37, s38
buffer_load_dwordx4 v23, s[8:11], s37 offen sc1 lds
s_add_u32 m0, s39, 34816
s_add_u32 s37, s37, s38
buffer_load_dwordx4 v23, s[8:11], s37 offen sc1 lds
s_add_u32 m0, s39, 35840
s_add_u32 s37, s37, s38
buffer_load_dwordx4 v23, s[8:11], s37 offen sc1 lds
s_add_u32 m0, s39, 36864
s_add_u32 s37, s37, s38
buffer_load_dwordx4 v23, s[8:11], s37 offen sc1 lds
s_add_u32 m0, s39, 37888
s_add_u32 s37, s37, s38
buffer_load_dwordx4 v23, s[8:11], s37 offen sc1 lds
s_add_u32 m0, s39, 38912
s_add_u32 s37, s37, s38
buffer_load_dwordx4 v23, s[8:11], s37 offen sc1 lds
s_add_u32 m0, s39, 39936
s_add_u32 s37, s37, s38
buffer_load_dwordx4 v23, s[8:11], s37 offen sc1 lds
s_waitcnt vmcnt(16)
s_barrier
s_add_u32 s42, s42, 1
s_xor_b32 s37, s42, s35
s_add_u32 m0, s39, 49152
s_lshl_b32 s37, s37, 14
buffer_load_dwordx4 v23, s[8:11], s37 offen sc1 lds
s_add_u32 m0, s39, 50176
s_add_u32 s37, s37, s38
buffer_load_dwordx4 v23, s[8:11], s37 offen sc1 lds
s_add_u32 m0, s39, 51200
s_add_u32 s37, s37, s38
buffer_load_dwordx4 v23, s[8:11], s37 offen sc1 lds
s_add_u32 m0, s39, 52224
s_add_u32 s37, s37, s38
buffer_load_dwordx4 v23, s[8:11], s37 offen sc1 lds
s_add_u32 m0, s39, 53248
s_add_u32 s37, s37, s38
buffer_load_dwordx4 v23, s[8:11], s37 offen sc1 lds
s_add_u32 m0, s39, 54272
s_add_u32 s37, s37, s38
buffer_load_dwordx4 v23, s[8:11], s37 offen sc1 lds
s_add_u32 m0, s39, 55296
s_add_u32 s37, s37, s38
buffer_load_dwordx4 v23, s[8:11], s37 offen sc1 lds
s_add_u32 m0, s39, 56320
s_add_u32 s37, s37, s38
buffer_load_dwordx4 v23, s[8:11], s37 offen sc1 lds
s_waitcnt vmcnt(16)
s_barrier
s_add_u32 s42, s42, 1
s_xor_b32 s37, s42, s35
s_add_u32 m0, s39, 0
s_lshl_b32 s37, s37, 14
buffer_load_dwordx4 v23, s[8:11], s37 offen sc1 lds
s_add_u32 m0, s39, 1024
s_add_u32 s37, s37, s38
buffer_load_dwordx4 v23, s[8:11], s37 offen sc1 lds
s_add_u32 m0, s39, 2048
s_add_u32 s37, s37, s38
buffer_load_dwordx4 v23, s[8:11], s37 offen sc1 lds
s_add_u32 m0, s39, 3072
s_add_u32 s37, s37, s38
buffer_load_dwordx4 v23, s[8:11], s37 offen sc1 lds
s_add_u32 m0, s39, 4096
s_add_u32 s37, s37, s38
buffer_load_dwordx4 v23, s[8:11], s37 offen sc1 lds
s_add_u32 m0, s39, 5120
s_add_u32 s37, s37, s38
buffer_load_dwordx4 v23, s[8:11], s37 offen sc1 lds
s_add_u32 m0, s39, 6144
s_add_u32 s37, s37, s38
buffer_load_dwordx4 v23, s[8:11], s37 offen sc1 lds
s_add_u32 m0, s39, 7168
s_add_u32 s37, s37, s38
buffer_load_dwordx4 v23, s[8:11], s37 offen sc1 lds
s_waitcnt vmcnt(16)
s_barrier
s_add_u32 s42, s42, 1
s_xor_b32 s37, s42, s35
s_add_u32 m0, s39, 16384
s_lshl_b32 s37, s37, 14
buffer_load_dwordx4 v23, s[8:11], s37 offen sc1 lds
s_add_u32 m0, s39, 17408
s_add_u32 s37, s37, s38
buffer_load_dwordx4 v23, s[8:11], s37 offen sc1 lds
s_add_u32 m0, s39, 18432
s_add_u32 s37, s37, s38
buffer_load_dwordx4 v23, s[8:11], s37 offen sc1 lds
s_add_u32 m0, s39, 19456
s_add_u32 s37, s37, s38
buffer_load_dwordx4 v23, s[8:11], s37 offen sc1 lds
s_add_u32 m0, s39, 20480
s_add_u32 s37, s37, s38
buffer_load_dwordx4 v23, s[8:11], s37 offen sc1 lds
s_add_u32 m0, s39, 21504
s_add_u32 s37, s37, s38
buffer_load_dwordx4 v23, s[8:11], s37 offen sc1 lds
s_add_u32 m0, s39, 22528
s_add_u32 s37, s37, s38
buffer_load_dwordx4 v23, s[8:11], s37 offen sc1 lds
s_add_u32 m0, s39, 23552
s_add_u32 s37, s37, s38
buffer_load_dwordx4 v23, s[8:11], s37 offen sc1 lds
s_waitcnt vmcnt(16)
s_barrier
s_add_u32 s42, s42, 1
s_xor_b32 s37, s42, s35
s_add_u32 m0, s39, 32768
s_lshl_b32 s37, s37, 14
buffer_load_dwordx4 v23, s[8:11], s37 offen sc1 lds
s_add_u32 m0, s39, 33792
s_add_u32 s37, s37, s38
buffer_load_dwordx4 v23, s[8:11], s37 offen sc1 lds
s_add_u32 m0, s39, 34816
s_add_u32 s37, s37, s38
buffer_load_dwordx4 v23, s[8:11], s37 offen sc1 lds
s_add_u32 m0, s39, 35840
s_add_u32 s37, s37, s38
buffer_load_dwordx4 v23, s[8:11], s37 offen sc1 lds
s_add_u32 m0, s39, 36864
s_add_u32 s37, s37, s38
buffer_load_dwordx4 v23, s[8:11], s37 offen sc1 lds
s_add_u32 m0, s39, 37888
s_add_u32 s37, s37, s38
buffer_load_dwordx4 v23, s[8:11], s37 offen sc1 lds
s_add_u32 m0, s39, 38912
s_add_u32 s37, s37, s38
buffer_load_dwordx4 v23, s[8:11], s37 offen sc1 lds
s_add_u32 m0, s39, 39936
s_add_u32 s37, s37, s38
buffer_load_dwordx4 v23, s[8:11], s37 offen sc1 lds
s_waitcnt vmcnt(16)
s_barrier
s_add_u32 s42, s42, 1
s_xor_b32 s37, s42, s35
s_add_u32 m0, s39, 49152
s_lshl_b32 s37, s37, 14
buffer_load_dwordx4 v23, s[8:11], s37 offen sc1 lds
s_add_u32 m0, s39, 50176
s_add_u32 s37, s37, s38
buffer_load_dwordx4 v23, s[8:11], s37 offen sc1 lds
s_add_u32 m0, s39, 51200
s_add_u32 s37, s37, s38
buffer_load_dwordx4 v23, s[8:11], s37 offen sc1 lds
s_add_u32 m0, s39, 52224
s_add_u32 s37, s37, s38
buffer_load_dwordx4 v23, s[8:11], s37 offen sc1 lds
s_add_u32 m0, s39, 53248
s_add_u32 s37, s37, s38
buffer_load_dwordx4 v23, s[8:11], s37 offen sc1 lds
s_add_u32 m0, s39, 54272
s_add_u32 s37, s37, s38
buffer_load_dwordx4 v23, s[8:11], s37 offen sc1 lds
s_add_u32 m0, s39, 55296
s_add_u32 s37, s37, s38
buffer_load_dwordx4 v23, s[8:11], s37 offen sc1 lds
s_add_u32 m0, s39, 56320
s_add_u32 s37, s37, s38
buffer_load_dwordx4 v23, s[8:11], s37 offen sc1 lds
s_waitcnt vmcnt(16)
s_barrier
s_add_u32 s42, s42, 1
s_xor_b32 s37, s42, s35
s_add_u32 m0, s39, 0
s_lshl_b32 s37, s37, 14
buffer_load_dwordx4 v23, s[8:11], s37 offen sc1 lds
s_add_u32 m0, s39, 1024
s_add_u32 s37, s37, s38
buffer_load_dwordx4 v23, s[8:11], s37 offen sc1 lds
s_add_u32 m0, s39, 2048
s_add_u32 s37, s37, s38
buffer_load_dwordx4 v23, s[8:11], s37 offen sc1 lds
s_add_u32 m0, s39, 3072
s_add_u32 s37, s37, s38
buffer_load_dwordx4 v23, s[8:11], s37 offen sc1 lds
s_add_u32 m0, s39, 4096
s_add_u32 s37, s37, s38
buffer_load_dwordx4 v23, s[8:11], s37 offen sc1 lds
s_add_u32 m0, s39, 5120
s_add_u32 s37, s37, s38
buffer_load_dwordx4 v23, s[8:11], s37 offen sc1 lds
s_add_u32 m0, s39, 6144
s_add_u32 s37, s37, s38
buffer_load_dwordx4 v23, s[8:11], s37 offen sc1 lds
s_add_u32 m0, s39, 7168
s_add_u32 s37, s37, s38
buffer_load_dwordx4 v23, s[8:11], s37 offen sc1 lds
s_waitcnt vmcnt(16)
s_barrier
s_add_u32 s42, s42, 1
s_xor_b32 s37, s42, s35
s_add_u32 m0, s39, 16384
s_lshl_b32 s37, s37, 14
buffer_load_dwordx4 v23, s[8:11], s37 offen sc1 lds
s_add_u32 m0, s39, 17408
s_add_u32 s37, s37, s38
buffer_load_dwordx4 v23, s[8:11], s37 offen sc1 lds
s_add_u32 m0, s39, 18432
s_add_u32 s37, s37, s38
buffer_load_dwordx4 v23, s[8:11], s37 offen sc1 lds
s_add_u32 m0, s39, 19456
s_add_u32 s37, s37, s38
buffer_load_dwordx4 v23, s[8:11], s37 offen sc1 lds
s_add_u32 m0, s39, 20480
s_add_u32 s37, s37, s38
buffer_load_dwordx4 v23, s[8:11], s37 offen sc1 lds
s_add_u32 m0, s39, 21504
s_add_u32 s37, s37, s38
buffer_load_dwordx4 v23, s[8:11], s37 offen sc1 lds
s_add_u32 m0, s39, 22528
s_add_u32 s37, s37, s38
buffer_load_dwordx4 v23, s[8:11], s37 offen sc1 lds
s_add_u32 m0, s39, 23552
s_add_u32 s37, s37, s38
buffer_load_dwordx4 v23, s[8:11], s37 offen sc1 lds
s_waitcnt vmcnt(16)
s_barrier
s_add_u32 s42, s42, 1
s_xor_b32 s37, s42, s35
s_add_u32 m0, s39, 32768
s_lshl_b32 s37, s37, 14
buffer_load_dwordx4 v23, s[8:11], s37 offen sc1 lds
s_add_u32 m0, s39, 33792
s_add_u32 s37, s37, s38
buffer_load_dwordx4 v23, s[8:11], s37 offen sc1 lds
s_add_u32 m0, s39, 34816
s_add_u32 s37, s37, s38
buffer_load_dwordx4 v23, s[8:11], s37 offen sc1 lds
s_add_u32 m0, s39, 35840
s_add_u32 s37, s37, s38
buffer_load_dwordx4 v23, s[8:11], s37 offen sc1 lds
s_add_u32 m0, s39, 36864
s_add_u32 s37, s37, s38
buffer_load_dwordx4 v23, s[8:11], s37 offen sc1 lds
s_add_u32 m0, s39, 37888
s_add_u32 s37, s37, s38
buffer_load_dwordx4 v23, s[8:11], s37 offen sc1 lds
s_add_u32 m0, s39, 38912
s_add_u32 s37, s37, s38
buffer_load_dwordx4 v23, s[8:11], s37 offen sc1 lds
s_add_u32 m0, s39, 39936
s_add_u32 s37, s37, s38
buffer_load_dwordx4 v23, s[8:11], s37 offen sc1 lds
s_waitcnt vmcnt(16)
s_barrier
s_add_u32 s42, s42, 1
s_xor_b32 s37, s42, s35
s_add_u32 m0, s39, 49152
s_lshl_b32 s37, s37, 14
buffer_load_dwordx4 v23, s[8:11], s37 offen sc1 lds
s_add_u32 m0, s39, 50176
s_add_u32 s37, s37, s38
buffer_load_dwordx4 v23, s[8:11], s37 offen sc1 lds
s_add_u32 m0, s39, 51200
s_add_u32 s37, s37, s38
buffer_load_dwordx4 v23, s[8:11], s37 offen sc1 lds
s_add_u32 m0, s39, 52224
s_add_u32 s37, s37, s38
buffer_load_dwordx4 v23, s[8:11], s37 offen sc1 lds
s_add_u32 m0, s39, 53248
s_add_u32 s37, s37, s38
buffer_load_dwordx4 v23, s[8:11], s37 offen sc1 lds
s_add_u32 m0, s39, 54272
s_add_u32 s37, s37, s38
buffer_load_dwordx4 v23, s[8:11], s37 offen sc1 lds
s_add_u32 m0, s39, 55296
s_add_u32 s37, s37, s38
buffer_load_dwordx4 v23, s[8:11], s37 offen sc1 lds
s_add_u32 m0, s39, 56320
s_add_u32 s37, s37, s38
buffer_load_dwordx4 v23, s[8:11], s37 offen sc1 lds
s_lshl_b32 s43, s35, 8
s_cmp_eq_u32 s51, 1
s_cselect_b32 s8, s4, s6
s_cselect_b32 s9, s5, s7
s_sub_u32 s10, 7340032, s43
s_lshl_b32 s44, s34, 18
s_add_u32 s44, s44, 4194304
s_movk_i32 s38, 28672
s_cmp_eq_u32 s51, 0
s_cselect_b32 s8, s32, s8
s_cselect_b32 s9, s33, s9
s_cselect_b32 s10, 262144, s10
s_cselect_b32 s43, s44, s43
s_cselect_b32 s38, 1024, s38
s_cselect_b32 s45, 0, -1
s_add_u32 s8, s8, s43
s_addc_u32 s9, s9, 0
s_mov_b32 s11, 0x20000
s_lshl_b32 s40, s38, 4
s_mov_b32 s42, -1
s_lshl_b32 s39, s51, 14
v_lshrrev_b32 v19, 4, v1
v_lshlrev_b32 v20, 5, v19
v_mul_u32_u24 v19, 6912, v19
v_and_b32 v19, s45, v19
v_and_b32 v20, s45, v20
v_lshlrev_b32 v21, 4, v1
v_xor_b32 v21, v21, v20
v_add_u32 v22, v21, v19
s_and_b32 s45, s45, 128
v_xor_b32 v23, s45, v22
s_waitcnt vmcnt(16)
s_barrier
s_add_u32 s42, s42, 1
s_xor_b32 s37, s42, s35
s_add_u32 m0, s39, 98304
s_mul_i32 s37, s37, s40
buffer_load_dwordx4 v22, s[8:11], s37 offen sc1 lds
s_add_u32 m0, s39, 99328
s_add_u32 s37, s37, s38
buffer_load_dwordx4 v23, s[8:11], s37 offen sc1 lds
s_add_u32 m0, s39, 100352
s_add_u32 s37, s37, s38
buffer_load_dwordx4 v22, s[8:11], s37 offen sc1 lds
s_add_u32 m0, s39, 101376
s_add_u32 s37, s37, s38
buffer_load_dwordx4 v23, s[8:11], s37 offen sc1 lds
s_add_u32 m0, s39, 102400
s_add_u32 s37, s37, s38
buffer_load_dwordx4 v22, s[8:11], s37 offen sc1 lds
s_add_u32 m0, s39, 103424
s_add_u32 s37, s37, s38
buffer_load_dwordx4 v23, s[8:11], s37 offen sc1 lds
s_add_u32 m0, s39, 104448
s_add_u32 s37, s37, s38
buffer_load_dwordx4 v22, s[8:11], s37 offen sc1 lds
s_add_u32 m0, s39, 105472
s_add_u32 s37, s37, s38
buffer_load_dwordx4 v23, s[8:11], s37 offen sc1 lds
s_add_u32 m0, s39, 106496
s_add_u32 s37, s37, s38
buffer_load_dwordx4 v22, s[8:11], s37 offen sc1 lds
s_add_u32 m0, s39, 107520
s_add_u32 s37, s37, s38
buffer_load_dwordx4 v23, s[8:11], s37 offen sc1 lds
s_add_u32 m0, s39, 108544
s_add_u32 s37, s37, s38
buffer_load_dwordx4 v22, s[8:11], s37 offen sc1 lds
s_add_u32 m0, s39, 109568
s_add_u32 s37, s37, s38
buffer_load_dwordx4 v23, s[8:11], s37 offen sc1 lds
s_add_u32 m0, s39, 110592
s_add_u32 s37, s37, s38
buffer_load_dwordx4 v22, s[8:11], s37 offen sc1 lds
s_add_u32 m0, s39, 111616
s_add_u32 s37, s37, s38
buffer_load_dwordx4 v23, s[8:11], s37 offen sc1 lds
s_add_u32 m0, s39, 112640
s_add_u32 s37, s37, s38
buffer_load_dwordx4 v22, s[8:11], s37 offen sc1 lds
s_add_u32 m0, s39, 113664
s_add_u32 s37, s37, s38
buffer_load_dwordx4 v23, s[8:11], s37 offen sc1 lds
s_waitcnt vmcnt(24)
s_barrier
s_waitcnt vmcnt(16)
s_barrier
s_add_u32 s42, s42, 1
s_xor_b32 s37, s42, s35
s_add_u32 m0, s39, 0
s_mul_i32 s37, s37, s40
buffer_load_dwordx4 v22, s[8:11], s37 offen sc1 lds
s_add_u32 m0, s39, 1024
s_add_u32 s37, s37, s38
buffer_load_dwordx4 v23, s[8:11], s37 offen sc1 lds
s_add_u32 m0, s39, 2048
s_add_u32 s37, s37, s38
buffer_load_dwordx4 v22, s[8:11], s37 offen sc1 lds
s_add_u32 m0, s39, 3072
s_add_u32 s37, s37, s38
buffer_load_dwordx4 v23, s[8:11], s37 offen sc1 lds
s_add_u32 m0, s39, 4096
s_add_u32 s37, s37, s38
buffer_load_dwordx4 v22, s[8:11], s37 offen sc1 lds
s_add_u32 m0, s39, 5120
s_add_u32 s37, s37, s38
buffer_load_dwordx4 v23, s[8:11], s37 offen sc1 lds
s_add_u32 m0, s39, 6144
s_add_u32 s37, s37, s38
buffer_load_dwordx4 v22, s[8:11], s37 offen sc1 lds
s_add_u32 m0, s39, 7168
s_add_u32 s37, s37, s38
buffer_load_dwordx4 v23, s[8:11], s37 offen sc1 lds
s_add_u32 m0, s39, 8192
s_add_u32 s37, s37, s38
buffer_load_dwordx4 v22, s[8:11], s37 offen sc1 lds
s_add_u32 m0, s39, 9216
s_add_u32 s37, s37, s38
buffer_load_dwordx4 v23, s[8:11], s37 offen sc1 lds
s_add_u32 m0, s39, 10240
s_add_u32 s37, s37, s38
buffer_load_dwordx4 v22, s[8:11], s37 offen sc1 lds
s_add_u32 m0, s39, 11264
s_add_u32 s37, s37, s38
buffer_load_dwordx4 v23, s[8:11], s37 offen sc1 lds
s_add_u32 m0, s39, 12288
s_add_u32 s37, s37, s38
buffer_load_dwordx4 v22, s[8:11], s37 offen sc1 lds
s_add_u32 m0, s39, 13312
s_add_u32 s37, s37, s38
buffer_load_dwordx4 v23, s[8:11], s37 offen sc1 lds
s_add_u32 m0, s39, 14336
s_add_u32 s37, s37, s38
buffer_load_dwordx4 v22, s[8:11], s37 offen sc1 lds
s_add_u32 m0, s39, 15360
s_add_u32 s37, s37, s38
buffer_load_dwordx4 v23, s[8:11], s37 offen sc1 lds
s_barrier
s_waitcnt vmcnt(16)
s_barrier
s_add_u32 s42, s42, 1
s_xor_b32 s37, s42, s35
s_add_u32 m0, s39, 49152
s_mul_i32 s37, s37, s40
buffer_load_dwordx4 v22, s[8:11], s37 offen sc1 lds
s_add_u32 m0, s39, 50176
s_add_u32 s37, s37, s38
buffer_load_dwordx4 v23, s[8:11], s37 offen sc1 lds
s_add_u32 m0, s39, 51200
s_add_u32 s37, s37, s38
buffer_load_dwordx4 v22, s[8:11], s37 offen sc1 lds
s_add_u32 m0, s39, 52224
s_add_u32 s37, s37, s38
buffer_load_dwordx4 v23, s[8:11], s37 offen sc1 lds
s_add_u32 m0, s39, 53248
s_add_u32 s37, s37, s38
buffer_load_dwordx4 v22, s[8:11], s37 offen sc1 lds
s_add_u32 m0, s39, 54272
s_add_u32 s37, s37, s38
buffer_load_dwordx4 v23, s[8:11], s37 offen sc1 lds
s_add_u32 m0, s39, 55296
s_add_u32 s37, s37, s38
buffer_load_dwordx4 v22, s[8:11], s37 offen sc1 lds
s_add_u32 m0, s39, 56320
s_add_u32 s37, s37, s38
buffer_load_dwordx4 v23, s[8:11], s37 offen sc1 lds
s_add_u32 m0, s39, 57344
s_add_u32 s37, s37, s38
buffer_load_dwordx4 v22, s[8:11], s37 offen sc1 lds
s_add_u32 m0, s39, 58368
s_add_u32 s37, s37, s38
buffer_load_dwordx4 v23, s[8:11], s37 offen sc1 lds
s_add_u32 m0, s39, 59392
s_add_u32 s37, s37, s38
buffer_load_dwordx4 v22, s[8:11], s37 offen sc1 lds
s_add_u32 m0, s39, 60416
s_add_u32 s37, s37, s38
buffer_load_dwordx4 v23, s[8:11], s37 offen sc1 lds
s_add_u32 m0, s39, 61440
s_add_u32 s37, s37, s38
buffer_load_dwordx4 v22, s[8:11], s37 offen sc1 lds
s_add_u32 m0, s39, 62464
s_add_u32 s37, s37, s38
buffer_load_dwordx4 v23, s[8:11], s37 offen sc1 lds
s_add_u32 m0, s39, 63488
s_add_u32 s37, s37, s38
buffer_load_dwordx4 v22, s[8:11], s37 offen sc1 lds
s_add_u32 m0, s39, 64512
s_add_u32 s37, s37, s38
buffer_load_dwordx4 v23, s[8:11], s37 offen sc1 lds
s_branch LP3_135
.p2align 6
Lw_20:
s_branch Lr_21
s_nop 0
.p2align 3
Lp_138:
s_mov_b32 s42, -1
s_waitcnt vmcnt(0)
s_barrier
ds_write_b128 v27, v[68:71] offset:0
ds_write_b128 v27, v[116:119] offset:512
s_add_u32 s42, s42, 1
s_xor_b32 s37, s42, s35
s_add_u32 m0, s39, 49152
s_lshl_b32 s37, s37, 17
buffer_load_dwordx4 v23, s[8:11], s37 offen sc1 lds
s_add_u32 m0, s39, 50176
s_add_u32 s37, s37, s38
buffer_load_dwordx4 v23, s[8:11], s37 offen sc1 lds
s_add_u32 m0, s39, 51200
s_add_u32 s37, s37, s38
buffer_load_dwordx4 v23, s[8:11], s37 offen sc1 lds
s_add_u32 m0, s39, 52224
s_add_u32 s37, s37, s38
buffer_load_dwordx4 v23, s[8:11], s37 offen sc1 lds
s_add_u32 m0, s39, 53248
s_add_u32 s37, s37, s38
buffer_load_dwordx4 v23, s[8:11], s37 offen sc1 lds
s_add_u32 m0, s39, 54272
s_add_u32 s37, s37, s38
buffer_load_dwordx4 v23, s[8:11], s37 offen sc1 lds
s_add_u32 m0, s39, 55296
s_add_u32 s37, s37, s38
buffer_load_dwordx4 v23, s[8:11], s37 offen sc1 lds
s_add_u32 m0, s39, 56320
s_add_u32 s37, s37, s38
buffer_load_dwordx4 v23, s[8:11], s37 offen sc1 lds
s_add_u32 s42, s42, 1
s_xor_b32 s37, s42, s35
s_add_u32 m0, s39, 57344
s_lshl_b32 s37, s37, 17
buffer_load_dwordx4 v23, s[8:11], s37 offen sc1 lds
s_add_u32 m0, s39, 58368
s_add_u32 s37, s37, s38
buffer_load_dwordx4 v23, s[8:11], s37 offen sc1 lds
s_add_u32 m0, s39, 59392
s_add_u32 s37, s37, s38
buffer_load_dwordx4 v23, s[8:11], s37 offen sc1 lds
s_add_u32 m0, s39, 60416
s_add_u32 s37, s37, s38
buffer_load_dwordx4 v23, s[8:11], s37 offen sc1 lds
s_add_u32 m0, s39, 61440
s_add_u32 s37, s37, s38
buffer_load_dwordx4 v23, s[8:11], s37 offen sc1 lds
s_add_u32 m0, s39, 62464
s_add_u32 s37, s37, s38
buffer_load_dwordx4 v23, s[8:11], s37 offen sc1 lds
s_add_u32 m0, s39, 63488
s_add_u32 s37, s37, s38
buffer_load_dwordx4 v23, s[8:11], s37 offen sc1 lds
s_add_u32 m0, s39, 64512
s_add_u32 s37, s37, s38
buffer_load_dwordx4 v23, s[8:11], s37 offen sc1 lds
s_waitcnt vmcnt(8)
s_waitcnt lgkmcnt(0)
s_barrier
s_add_u32 m0, s54, 16384
s_add_u32 s43, s30, 0
buffer_load_dwordx4 v21, s[12:15], s43 offen sc1 lds
s_add_u32 m0, s54, 17408
s_add_u32 s43, s30, 1024
buffer_load_dwordx4 v21, s[12:15], s43 offen sc1 lds
s_add_u32 m0, s54, 32768
s_add_u32 s43, s31, 0
buffer_load_dwordx4 v21, s[12:15], s43 offen sc1 lds
s_add_u32 m0, s54, 33792
s_add_u32 s43, s31, 1024
buffer_load_dwordx4 v21, s[12:15], s43 offen sc1 lds
s_add_u32 s42, s42, 1
s_xor_b32 s37, s42, s35
s_add_u32 m0, s39, 65536
s_lshl_b32 s37, s37, 17
buffer_load_dwordx4 v23, s[8:11], s37 offen sc1 lds
s_add_u32 m0, s39, 66560
s_add_u32 s37, s37, s38
buffer_load_dwordx4 v23, s[8:11], s37 offen sc1 lds
s_add_u32 m0, s39, 67584
s_add_u32 s37, s37, s38
buffer_load_dwordx4 v23, s[8:11], s37 offen sc1 lds
s_add_u32 m0, s39, 68608
s_add_u32 s37, s37, s38
buffer_load_dwordx4 v23, s[8:11], s37 offen sc1 lds
s_add_u32 m0, s39, 69632
s_add_u32 s37, s37, s38
buffer_load_dwordx4 v23, s[8:11], s37 offen sc1 lds
s_add_u32 m0, s39, 70656
s_add_u32 s37, s37, s38
buffer_load_dwordx4 v23, s[8:11], s37 offen sc1 lds
s_add_u32 m0, s39, 71680
s_add_u32 s37, s37, s38
buffer_load_dwordx4 v23, s[8:11], s37 offen sc1 lds
s_add_u32 m0, s39, 72704
s_add_u32 s37, s37, s38
buffer_load_dwordx4 v23, s[8:11], s37 offen sc1 lds
s_waitcnt vmcnt(10)
s_barrier
s_add_u32 s42, s42, 1
s_xor_b32 s37, s42, s35
s_add_u32 m0, s39, 73728
s_lshl_b32 s37, s37, 17
buffer_load_dwordx4 v23, s[8:11], s37 offen sc1 lds
s_add_u32 m0, s39, 74752
s_add_u32 s37, s37, s38
buffer_load_dwordx4 v23, s[8:11], s37 offen sc1 lds
s_add_u32 m0, s39, 75776
s_add_u32 s37, s37, s38
buffer_load_dwordx4 v23, s[8:11], s37 offen sc1 lds
s_add_u32 m0, s39, 76800
s_add_u32 s37, s37, s38
buffer_load_dwordx4 v23, s[8:11], s37 offen sc1 lds
s_add_u32 m0, s39, 77824
s_add_u32 s37, s37, s38
buffer_load_dwordx4 v23, s[8:11], s37 offen sc1 lds
s_add_u32 m0, s39, 78848
s_add_u32 s37, s37, s38
buffer_load_dwordx4 v23, s[8:11], s37 offen sc1 lds
s_add_u32 m0, s39, 79872
s_add_u32 s37, s37, s38
buffer_load_dwordx4 v23, s[8:11], s37 offen sc1 lds
s_add_u32 m0, s39, 80896
s_add_u32 s37, s37, s38
buffer_load_dwordx4 v23, s[8:11], s37 offen sc1 lds
s_waitcnt vmcnt(8)
s_barrier
s_add_u32 s42, s42, 1
s_xor_b32 s37, s42, s35
s_add_u32 m0, s39, 81920
s_lshl_b32 s37, s37, 17
buffer_load_dwordx4 v23, s[8:11], s37 offen sc1 lds
s_add_u32 m0, s39, 82944
s_add_u32 s37, s37, s38
buffer_load_dwordx4 v23, s[8:11], s37 offen sc1 lds
s_add_u32 m0, s39, 83968
s_add_u32 s37, s37, s38
buffer_load_dwordx4 v23, s[8:11], s37 offen sc1 lds
s_add_u32 m0, s39, 84992
s_add_u32 s37, s37, s38
buffer_load_dwordx4 v23, s[8:11], s37 offen sc1 lds
s_add_u32 m0, s39, 86016
s_add_u32 s37, s37, s38
buffer_load_dwordx4 v23, s[8:11], s37 offen sc1 lds
s_add_u32 m0, s39, 87040
s_add_u32 s37, s37, s38
buffer_load_dwordx4 v23, s[8:11], s37 offen sc1 lds
s_add_u32 m0, s39, 88064
s_add_u32 s37, s37, s38
buffer_load_dwordx4 v23, s[8:11], s37 offen sc1 lds
s_add_u32 m0, s39, 89088
s_add_u32 s37, s37, s38
buffer_load_dwordx4 v23, s[8:11], s37 offen sc1 lds
s_add_u32 s42, s42, 1
s_xor_b32 s37, s42, s35
s_add_u32 m0, s39, 90112
s_lshl_b32 s37, s37, 17
buffer_load_dwordx4 v23, s[8:11], s37 offen sc1 lds
s_add_u32 m0, s39, 91136
s_add_u32 s37, s37, s38
buffer_load_dwordx4 v23, s[8:11], s37 offen sc1 lds
s_add_u32 m0, s39, 92160
s_add_u32 s37, s37, s38
buffer_load_dwordx4 v23, s[8:11], s37 offen sc1 lds
s_add_u32 m0, s39, 93184
s_add_u32 s37, s37, s38
buffer_load_dwordx4 v23, s[8:11], s37 offen sc1 lds
s_add_u32 m0, s39, 94208
s_add_u32 s37, s37, s38
buffer_load_dwordx4 v23, s[8:11], s37 offen sc1 lds
s_add_u32 m0, s39, 95232
s_add_u32 s37, s37, s38
buffer_load_dwordx4 v23, s[8:11], s37 offen sc1 lds
s_add_u32 m0, s39, 96256
s_add_u32 s37, s37, s38
buffer_load_dwordx4 v23, s[8:11], s37 offen sc1 lds
s_add_u32 m0, s39, 97280
s_add_u32 s37, s37, s38
buffer_load_dwordx4 v23, s[8:11], s37 offen sc1 lds
s_waitcnt vmcnt(16)
s_barrier
s_add_u32 s42, s42, 1
s_xor_b32 s37, s42, s35
s_add_u32 m0, s39, 98304
s_lshl_b32 s37, s37, 17
buffer_load_dwordx4 v23, s[8:11], s37 offen sc1 lds
s_add_u32 m0, s39, 99328
s_add_u32 s37, s37, s38
buffer_load_dwordx4 v23, s[8:11], s37 offen sc1 lds
s_add_u32 m0, s39, 100352
s_add_u32 s37, s37, s38
buffer_load_dwordx4 v23, s[8:11], s37 offen sc1 lds
s_add_u32 m0, s39, 101376
s_add_u32 s37, s37, s38
buffer_load_dwordx4 v23, s[8:11], s37 offen sc1 lds
s_add_u32 m0, s39, 102400
s_add_u32 s37, s37, s38
buffer_load_dwordx4 v23, s[8:11], s37 offen sc1 lds
s_add_u32 m0, s39, 103424
s_add_u32 s37, s37, s38
buffer_load_dwordx4 v23, s[8:11], s37 offen sc1 lds
s_add_u32 m0, s39, 104448
s_add_u32 s37, s37, s38
buffer_load_dwordx4 v23, s[8:11], s37 offen sc1 lds
s_add_u32 m0, s39, 105472
s_add_u32 s37, s37, s38
buffer_load_dwordx4 v23, s[8:11], s37 offen sc1 lds
s_add_u32 s42, s42, 1
s_xor_b32 s37, s42, s35
s_add_u32 m0, s39, 106496
s_lshl_b32 s37, s37, 17
buffer_load_dwordx4 v23, s[8:11], s37 offen sc1 lds
s_add_u32 m0, s39, 107520
s_add_u32 s37, s37, s38
buffer_load_dwordx4 v23, s[8:11], s37 offen sc1 lds
s_add_u32 m0, s39, 108544
s_add_u32 s37, s37, s38
buffer_load_dwordx4 v23, s[8:11], s37 offen sc1 lds
s_add_u32 m0, s39, 109568
s_add_u32 s37, s37, s38
buffer_load_dwordx4 v23, s[8:11], s37 offen sc1 lds
s_add_u32 m0, s39, 110592
s_add_u32 s37, s37, s38
buffer_load_dwordx4 v23, s[8:11], s37 offen sc1 lds
s_add_u32 m0, s39, 111616
s_add_u32 s37, s37, s38
buffer_load_dwordx4 v23, s[8:11], s37 offen sc1 lds
s_add_u32 m0, s39, 112640
s_add_u32 s37, s37, s38
buffer_load_dwordx4 v23, s[8:11], s37 offen sc1 lds
s_add_u32 m0, s39, 113664
s_add_u32 s37, s37, s38
buffer_load_dwordx4 v23, s[8:11], s37 offen sc1 lds
s_waitcnt vmcnt(24)
s_barrier
s_add_u32 s42, s42, 1
s_xor_b32 s37, s42, s35
s_add_u32 m0, s39, 114688
s_lshl_b32 s37, s37, 17
buffer_load_dwordx4 v23, s[8:11], s37 offen sc1 lds
s_add_u32 m0, s39, 115712
s_add_u32 s37, s37, s38
buffer_load_dwordx4 v23, s[8:11], s37 offen sc1 lds
s_add_u32 m0, s39, 116736
s_add_u32 s37, s37, s38
buffer_load_dwordx4 v23, s[8:11], s37 offen sc1 lds
s_add_u32 m0, s39, 117760
s_add_u32 s37, s37, s38
buffer_load_dwordx4 v23, s[8:11], s37 offen sc1 lds
s_add_u32 m0, s39, 118784
s_add_u32 s37, s37, s38
buffer_load_dwordx4 v23, s[8:11], s37 offen sc1 lds
s_add_u32 m0, s39, 119808
s_add_u32 s37, s37, s38
buffer_load_dwordx4 v23, s[8:11], s37 offen sc1 lds
s_add_u32 m0, s39, 120832
s_add_u32 s37, s37, s38
buffer_load_dwordx4 v23, s[8:11], s37 offen sc1 lds
s_add_u32 m0, s39, 121856
s_add_u32 s37, s37, s38
buffer_load_dwordx4 v23, s[8:11], s37 offen sc1 lds
s_add_u32 s42, s42, 1
s_xor_b32 s37, s42, s35
s_add_u32 m0, s39, 122880
s_lshl_b32 s37, s37, 17
buffer_load_dwordx4 v23, s[8:11], s37 offen sc1 lds
s_add_u32 m0, s39, 123904
s_add_u32 s37, s37, s38
buffer_load_dwordx4 v23, s[8:11], s37 offen sc1 lds
s_add_u32 m0, s39, 124928
s_add_u32 s37, s37, s38
buffer_load_dwordx4 v23, s[8:11], s37 offen sc1 lds
s_add_u32 m0, s39, 125952
s_add_u32 s37, s37, s38
buffer_load_dwordx4 v23, s[8:11], s37 offen sc1 lds
s_add_u32 m0, s39, 126976
s_add_u32 s37, s37, s38
buffer_load_dwordx4 v23, s[8:11], s37 offen sc1 lds
s_add_u32 m0, s39, 128000
s_add_u32 s37, s37, s38
buffer_load_dwordx4 v23, s[8:11], s37 offen sc1 lds
s_add_u32 m0, s39, 129024
s_add_u32 s37, s37, s38
buffer_load_dwordx4 v23, s[8:11], s37 offen sc1 lds
s_add_u32 m0, s39, 130048
s_add_u32 s37, s37, s38
buffer_load_dwordx4 v23, s[8:11], s37 offen sc1 lds
s_waitcnt vmcnt(32)
s_barrier
s_add_u32 s42, s42, 1
s_xor_b32 s37, s42, s35
s_add_u32 m0, s39, 49152
s_lshl_b32 s37, s37, 17
buffer_load_dwordx4 v23, s[8:11], s37 offen sc1 lds
s_add_u32 m0, s39, 50176
s_add_u32 s37, s37, s38
buffer_load_dwordx4 v23, s[8:11], s37 offen sc1 lds
s_add_u32 m0, s39, 51200
s_add_u32 s37, s37, s38
buffer_load_dwordx4 v23, s[8:11], s37 offen sc1 lds
s_add_u32 m0, s39, 52224
s_add_u32 s37, s37, s38
buffer_load_dwordx4 v23, s[8:11], s37 offen sc1 lds
s_add_u32 m0, s39, 53248
s_add_u32 s37, s37, s38
buffer_load_dwordx4 v23, s[8:11], s37 offen sc1 lds
s_add_u32 m0, s39, 54272
s_add_u32 s37, s37, s38
buffer_load_dwordx4 v23, s[8:11], s37 offen sc1 lds
s_add_u32 m0, s39, 55296
s_add_u32 s37, s37, s38
buffer_load_dwordx4 v23, s[8:11], s37 offen sc1 lds
s_add_u32 m0, s39, 56320
s_add_u32 s37, s37, s38
buffer_load_dwordx4 v23, s[8:11], s37 offen sc1 lds
s_add_u32 s42, s42, 1
s_xor_b32 s37, s42, s35
s_add_u32 m0, s39, 57344
s_lshl_b32 s37, s37, 17
buffer_load_dwordx4 v23, s[8:11], s37 offen sc1 lds
s_add_u32 m0, s39, 58368
s_add_u32 s37, s37, s38
buffer_load_dwordx4 v23, s[8:11], s37 offen sc1 lds
s_add_u32 m0, s39, 59392
s_add_u32 s37, s37, s38
buffer_load_dwordx4 v23, s[8:11], s37 offen sc1 lds
s_add_u32 m0, s39, 60416
s_add_u32 s37, s37, s38
buffer_load_dwordx4 v23, s[8:11], s37 offen sc1 lds
s_add_u32 m0, s39, 61440
s_add_u32 s37, s37, s38
buffer_load_dwordx4 v23, s[8:11], s37 offen sc1 lds
s_add_u32 m0, s39, 62464
s_add_u32 s37, s37, s38
buffer_load_dwordx4 v23, s[8:11], s37 offen sc1 lds
s_add_u32 m0, s39, 63488
s_add_u32 s37, s37, s38
buffer_load_dwordx4 v23, s[8:11], s37 offen sc1 lds
s_add_u32 m0, s39, 64512
s_add_u32 s37, s37, s38
buffer_load_dwordx4 v23, s[8:11], s37 offen sc1 lds
s_waitcnt vmcnt(40)
s_barrier
s_add_u32 s42, s42, 1
s_xor_b32 s37, s42, s35
s_add_u32 m0, s39, 65536
s_lshl_b32 s37, s37, 17
buffer_load_dwordx4 v23, s[8:11], s37 offen sc1 lds
s_add_u32 m0, s39, 66560
s_add_u32 s37, s37, s38
buffer_load_dwordx4 v23, s[8:11], s37 offen sc1 lds
s_add_u32 m0, s39, 67584
s_add_u32 s37, s37, s38
buffer_load_dwordx4 v23, s[8:11], s37 offen sc1 lds
s_add_u32 m0, s39, 68608
s_add_u32 s37, s37, s38
buffer_load_dwordx4 v23, s[8:11], s37 offen sc1 lds
s_add_u32 m0, s39, 69632
s_add_u32 s37, s37, s38
buffer_load_dwordx4 v23, s[8:11], s37 offen sc1 lds
s_add_u32 m0, s39, 70656
s_add_u32 s37, s37, s38
buffer_load_dwordx4 v23, s[8:11], s37 offen sc1 lds
s_add_u32 m0, s39, 71680
s_add_u32 s37, s37, s38
buffer_load_dwordx4 v23, s[8:11], s37 offen sc1 lds
s_add_u32 m0, s39, 72704
s_add_u32 s37, s37, s38
buffer_load_dwordx4 v23, s[8:11], s37 offen sc1 lds
s_add_u32 s42, s42, 1
s_xor_b32 s37, s42, s35
s_add_u32 m0, s39, 73728
s_lshl_b32 s37, s37, 17
buffer_load_dwordx4 v23, s[8:11], s37 offen sc1 lds
s_add_u32 m0, s39, 74752
s_add_u32 s37, s37, s38
buffer_load_dwordx4 v23, s[8:11], s37 offen sc1 lds
s_add_u32 m0, s39, 75776
s_add_u32 s37, s37, s38
buffer_load_dwordx4 v23, s[8:11], s37 offen sc1 lds
s_add_u32 m0, s39, 76800
s_add_u32 s37, s37, s38
buffer_load_dwordx4 v23, s[8:11], s37 offen sc1 lds
s_add_u32 m0, s39, 77824
s_add_u32 s37, s37, s38
buffer_load_dwordx4 v23, s[8:11], s37 offen sc1 lds
s_add_u32 m0, s39, 78848
s_add_u32 s37, s37, s38
buffer_load_dwordx4 v23, s[8:11], s37 offen sc1 lds
s_add_u32 m0, s39, 79872
s_add_u32 s37, s37, s38
buffer_load_dwordx4 v23, s[8:11], s37 offen sc1 lds
s_add_u32 m0, s39, 80896
s_add_u32 s37, s37, s38
buffer_load_dwordx4 v23, s[8:11], s37 offen sc1 lds
s_waitcnt vmcnt(48)
s_barrier
s_add_u32 s42, s42, 1
s_xor_b32 s37, s42, s35
s_add_u32 m0, s39, 81920
s_lshl_b32 s37, s37, 17
buffer_load_dwordx4 v23, s[8:11], s37 offen sc1 lds
s_add_u32 m0, s39, 82944
s_add_u32 s37, s37, s38
buffer_load_dwordx4 v23, s[8:11], s37 offen sc1 lds
s_add_u32 m0, s39, 83968
s_add_u32 s37, s37, s38
buffer_load_dwordx4 v23, s[8:11], s37 offen sc1 lds
s_add_u32 m0, s39, 84992
s_add_u32 s37, s37, s38
buffer_load_dwordx4 v23, s[8:11], s37 offen sc1 lds
s_add_u32 m0, s39, 86016
s_add_u32 s37, s37, s38
buffer_load_dwordx4 v23, s[8:11], s37 offen sc1 lds
s_add_u32 m0, s39, 87040
s_add_u32 s37, s37, s38
buffer_load_dwordx4 v23, s[8:11], s37 offen sc1 lds
s_add_u32 m0, s39, 88064
s_add_u32 s37, s37, s38
buffer_load_dwordx4 v23, s[8:11], s37 offen sc1 lds
s_add_u32 m0, s39, 89088
s_add_u32 s37, s37, s38
buffer_load_dwordx4 v23, s[8:11], s37 offen sc1 lds
s_add_u32 s42, s42, 1
s_xor_b32 s37, s42, s35
s_add_u32 m0, s39, 90112
s_lshl_b32 s37, s37, 17
buffer_load_dwordx4 v23, s[8:11], s37 offen sc1 lds
s_add_u32 m0, s39, 91136
s_add_u32 s37, s37, s38
buffer_load_dwordx4 v23, s[8:11], s37 offen sc1 lds
s_add_u32 m0, s39, 92160
s_add_u32 s37, s37, s38
buffer_load_dwordx4 v23, s[8:11], s37 offen sc1 lds
s_add_u32 m0, s39, 93184
s_add_u32 s37, s37, s38
buffer_load_dwordx4 v23, s[8:11], s37 offen sc1 lds
s_add_u32 m0, s39, 94208
s_add_u32 s37, s37, s38
buffer_load_dwordx4 v23, s[8:11], s37 offen sc1 lds
s_add_u32 m0, s39, 95232
s_add_u32 s37, s37, s38
buffer_load_dwordx4 v23, s[8:11], s37 offen sc1 lds
s_add_u32 m0, s39, 96256
s_add_u32 s37, s37, s38
buffer_load_dwordx4 v23, s[8:11], s37 offen sc1 lds
s_add_u32 m0, s39, 97280
s_add_u32 s37, s37, s38
buffer_load_dwordx4 v23, s[8:11], s37 offen sc1 lds
s_waitcnt vmcnt(56)
s_barrier
s_waitcnt vmcnt(48)
s_barrier
s_waitcnt vmcnt(40)
s_barrier
s_waitcnt vmcnt(32)
s_barrier
s_waitcnt vmcnt(24)
s_barrier
s_lshl_b32 s43, s35, 8
s_cmp_eq_u32 s51, 1
s_cselect_b32 s8, s4, s6
s_cselect_b32 s9, s5, s7
s_sub_u32 s10, 7340032, s43
s_lshl_b32 s44, s34, 18
s_add_u32 s44, s44, 4194304
s_movk_i32 s38, 28672
s_cmp_eq_u32 s51, 0
s_cselect_b32 s8, s32, s8
s_cselect_b32 s9, s33, s9
s_cselect_b32 s10, 262144, s10
s_cselect_b32 s43, s44, s43
s_cselect_b32 s38, 1024, s38
s_cselect_b32 s45, 0, -1
s_add_u32 s8, s8, s43
s_addc_u32 s9, s9, 0
s_mov_b32 s11, 0x20000
s_lshl_b32 s40, s38, 4
s_mov_b32 s42, -1
s_lshl_b32 s39, s51, 14
v_lshrrev_b32 v19, 4, v1
v_lshlrev_b32 v20, 5, v19
v_mul_u32_u24 v19, 6912, v19
v_and_b32 v19, s45, v19
v_and_b32 v20, s45, v20
v_lshlrev_b32 v21, 4, v1
v_xor_b32 v21, v21, v20
v_add_u32 v22, v21, v19
s_and_b32 s45, s45, 128
v_xor_b32 v23, s45, v22
s_waitcnt vmcnt(16)
s_barrier
s_add_u32 s42, s42, 1
s_xor_b32 s37, s42, s35
s_add_u32 m0, s39, 98304
s_mul_i32 s37, s37, s40
buffer_load_dwordx4 v22, s[8:11], s37 offen sc1 lds
s_add_u32 m0, s39, 99328
s_add_u32 s37, s37, s38
buffer_load_dwordx4 v23, s[8:11], s37 offen sc1 lds
s_add_u32 m0, s39, 100352
s_add_u32 s37, s37, s38
buffer_load_dwordx4 v22, s[8:11], s37 offen sc1 lds
s_add_u32 m0, s39, 101376
s_add_u32 s37, s37, s38
buffer_load_dwordx4 v23, s[8:11], s37 offen sc1 lds
s_add_u32 m0, s39, 102400
s_add_u32 s37, s37, s38
buffer_load_dwordx4 v22, s[8:11], s37 offen sc1 lds
s_add_u32 m0, s39, 103424
s_add_u32 s37, s37, s38
buffer_load_dwordx4 v23, s[8:11], s37 offen sc1 lds
s_add_u32 m0, s39, 104448
s_add_u32 s37, s37, s38
buffer_load_dwordx4 v22, s[8:11], s37 offen sc1 lds
s_add_u32 m0, s39, 105472
s_add_u32 s37, s37, s38
buffer_load_dwordx4 v23, s[8:11], s37 offen sc1 lds
s_add_u32 m0, s39, 106496
s_add_u32 s37, s37, s38
buffer_load_dwordx4 v22, s[8:11], s37 offen sc1 lds
s_add_u32 m0, s39, 107520
s_add_u32 s37, s37, s38
buffer_load_dwordx4 v23, s[8:11], s37 offen sc1 lds
s_add_u32 m0, s39, 108544
s_add_u32 s37, s37, s38
buffer_load_dwordx4 v22, s[8:11], s37 offen sc1 lds
s_add_u32 m0, s39, 109568
s_add_u32 s37, s37, s38
buffer_load_dwordx4 v23, s[8:11], s37 offen sc1 lds
s_add_u32 m0, s39, 110592
s_add_u32 s37, s37, s38
buffer_load_dwordx4 v22, s[8:11], s37 offen sc1 lds
s_add_u32 m0, s39, 111616
s_add_u32 s37, s37, s38
buffer_load_dwordx4 v23, s[8:11], s37 offen sc1 lds
s_add_u32 m0, s39, 112640
s_add_u32 s37, s37, s38
buffer_load_dwordx4 v22, s[8:11], s37 offen sc1 lds
s_add_u32 m0, s39, 113664
s_add_u32 s37, s37, s38
buffer_load_dwordx4 v23, s[8:11], s37 offen sc1 lds
s_waitcnt vmcnt(24)
s_barrier
s_waitcnt vmcnt(16)
s_barrier
s_add_u32 s42, s42, 1
s_xor_b32 s37, s42, s35
s_add_u32 m0, s39, 0
s_mul_i32 s37, s37, s40
buffer_load_dwordx4 v22, s[8:11], s37 offen sc1 lds
s_add_u32 m0, s39, 1024
s_add_u32 s37, s37, s38
buffer_load_dwordx4 v23, s[8:11], s37 offen sc1 lds
s_add_u32 m0, s39, 2048
s_add_u32 s37, s37, s38
buffer_load_dwordx4 v22, s[8:11], s37 offen sc1 lds
s_add_u32 m0, s39, 3072
s_add_u32 s37, s37, s38
buffer_load_dwordx4 v23, s[8:11], s37 offen sc1 lds
s_add_u32 m0, s39, 4096
s_add_u32 s37, s37, s38
buffer_load_dwordx4 v22, s[8:11], s37 offen sc1 lds
s_add_u32 m0, s39, 5120
s_add_u32 s37, s37, s38
buffer_load_dwordx4 v23, s[8:11], s37 offen sc1 lds
s_add_u32 m0, s39, 6144
s_add_u32 s37, s37, s38
buffer_load_dwordx4 v22, s[8:11], s37 offen sc1 lds
s_add_u32 m0, s39, 7168
s_add_u32 s37, s37, s38
buffer_load_dwordx4 v23, s[8:11], s37 offen sc1 lds
s_add_u32 m0, s39, 8192
s_add_u32 s37, s37, s38
buffer_load_dwordx4 v22, s[8:11], s37 offen sc1 lds
s_add_u32 m0, s39, 9216
s_add_u32 s37, s37, s38
buffer_load_dwordx4 v23, s[8:11], s37 offen sc1 lds
s_add_u32 m0, s39, 10240
s_add_u32 s37, s37, s38
buffer_load_dwordx4 v22, s[8:11], s37 offen sc1 lds
s_add_u32 m0, s39, 11264
s_add_u32 s37, s37, s38
buffer_load_dwordx4 v23, s[8:11], s37 offen sc1 lds
s_add_u32 m0, s39, 12288
s_add_u32 s37, s37, s38
buffer_load_dwordx4 v22, s[8:11], s37 offen sc1 lds
s_add_u32 m0, s39, 13312
s_add_u32 s37, s37, s38
buffer_load_dwordx4 v23, s[8:11], s37 offen sc1 lds
s_add_u32 m0, s39, 14336
s_add_u32 s37, s37, s38
buffer_load_dwordx4 v22, s[8:11], s37 offen sc1 lds
s_add_u32 m0, s39, 15360
s_add_u32 s37, s37, s38
buffer_load_dwordx4 v23, s[8:11], s37 offen sc1 lds
s_barrier
s_waitcnt vmcnt(16)
s_barrier
s_add_u32 s42, s42, 1
s_xor_b32 s37, s42, s35
s_add_u32 m0, s39, 49152
s_mul_i32 s37, s37, s40
buffer_load_dwordx4 v22, s[8:11], s37 offen sc1 lds
s_add_u32 m0, s39, 50176
s_add_u32 s37, s37, s38
buffer_load_dwordx4 v23, s[8:11], s37 offen sc1 lds
s_add_u32 m0, s39, 51200
s_add_u32 s37, s37, s38
buffer_load_dwordx4 v22, s[8:11], s37 offen sc1 lds
s_add_u32 m0, s39, 52224
s_add_u32 s37, s37, s38
buffer_load_dwordx4 v23, s[8:11], s37 offen sc1 lds
s_add_u32 m0, s39, 53248
s_add_u32 s37, s37, s38
buffer_load_dwordx4 v22, s[8:11], s37 offen sc1 lds
s_add_u32 m0, s39, 54272
s_add_u32 s37, s37, s38
buffer_load_dwordx4 v23, s[8:11], s37 offen sc1 lds
s_add_u32 m0, s39, 55296
s_add_u32 s37, s37, s38
buffer_load_dwordx4 v22, s[8:11], s37 offen sc1 lds
s_add_u32 m0, s39, 56320
s_add_u32 s37, s37, s38
buffer_load_dwordx4 v23, s[8:11], s37 offen sc1 lds
s_add_u32 m0, s39, 57344
s_add_u32 s37, s37, s38
buffer_load_dwordx4 v22, s[8:11], s37 offen sc1 lds
s_add_u32 m0, s39, 58368
s_add_u32 s37, s37, s38
buffer_load_dwordx4 v23, s[8:11], s37 offen sc1 lds
s_add_u32 m0, s39, 59392
s_add_u32 s37, s37, s38
buffer_load_dwordx4 v22, s[8:11], s37 offen sc1 lds
s_add_u32 m0, s39, 60416
s_add_u32 s37, s37, s38
buffer_load_dwordx4 v23, s[8:11], s37 offen sc1 lds
s_add_u32 m0, s39, 61440
s_add_u32 s37, s37, s38
buffer_load_dwordx4 v22, s[8:11], s37 offen sc1 lds
s_add_u32 m0, s39, 62464
s_add_u32 s37, s37, s38
buffer_load_dwordx4 v23, s[8:11], s37 offen sc1 lds
s_add_u32 m0, s39, 63488
s_add_u32 s37, s37, s38
buffer_load_dwordx4 v22, s[8:11], s37 offen sc1 lds
s_add_u32 m0, s39, 64512
s_add_u32 s37, s37, s38
buffer_load_dwordx4 v23, s[8:11], s37 offen sc1 lds
.p2align 3
LP3_135:
s_mul_i32 s43, s2, 28672
s_mul_i32 s44, s51, 7168
s_add_u32 s43, s43, s44
s_add_u32 s80, s60, s43
s_addc_u32 s81, s61, 0
s_waitcnt vmcnt(16)
s_barrier
s_add_u32 s42, s42, 1
s_xor_b32 s37, s42, s35
s_add_u32 m0, s39, 98304
s_mul_i32 s37, s37, s40
buffer_load_dwordx4 v22, s[8:11], s37 offen sc1 lds
s_add_u32 m0, s39, 99328
s_add_u32 s37, s37, s38
buffer_load_dwordx4 v23, s[8:11], s37 offen sc1 lds
s_add_u32 m0, s39, 100352
s_add_u32 s37, s37, s38
buffer_load_dwordx4 v22, s[8:11], s37 offen sc1 lds
s_add_u32 m0, s39, 101376
s_add_u32 s37, s37, s38
buffer_load_dwordx4 v23, s[8:11], s37 offen sc1 lds
s_add_u32 m0, s39, 102400
s_add_u32 s37, s37, s38
buffer_load_dwordx4 v22, s[8:11], s37 offen sc1 lds
s_add_u32 m0, s39, 103424
s_add_u32 s37, s37, s38
buffer_load_dwordx4 v23, s[8:11], s37 offen sc1 lds
s_add_u32 m0, s39, 104448
s_add_u32 s37, s37, s38
buffer_load_dwordx4 v22, s[8:11], s37 offen sc1 lds
s_add_u32 m0, s39, 105472
s_add_u32 s37, s37, s38
buffer_load_dwordx4 v23, s[8:11], s37 offen sc1 lds
s_add_u32 m0, s39, 106496
s_add_u32 s37, s37, s38
buffer_load_dwordx4 v22, s[8:11], s37 offen sc1 lds
s_add_u32 m0, s39, 107520
s_add_u32 s37, s37, s38
buffer_load_dwordx4 v23, s[8:11], s37 offen sc1 lds
s_add_u32 m0, s39, 108544
s_add_u32 s37, s37, s38
buffer_load_dwordx4 v22, s[8:11], s37 offen sc1 lds
s_add_u32 m0, s39, 109568
s_add_u32 s37, s37, s38
buffer_load_dwordx4 v23, s[8:11], s37 offen sc1 lds
s_add_u32 m0, s39, 110592
s_add_u32 s37, s37, s38
buffer_load_dwordx4 v22, s[8:11], s37 offen sc1 lds
s_add_u32 m0, s39, 111616
s_add_u32 s37, s37, s38
buffer_load_dwordx4 v23, s[8:11], s37 offen sc1 lds
s_add_u32 m0, s39, 112640
s_add_u32 s37, s37, s38
buffer_load_dwordx4 v22, s[8:11], s37 offen sc1 lds
s_add_u32 m0, s39, 113664
s_add_u32 s37, s37, s38
buffer_load_dwordx4 v23, s[8:11], s37 offen sc1 lds
s_load_dword s64, s[80:81], 0
s_load_dword s65, s[80:81], 64
s_load_dword s66, s[80:81], 128
s_load_dword s67, s[80:81], 192
s_load_dword s68, s[80:81], 256
s_load_dword s69, s[80:81], 320
s_load_dword s70, s[80:81], 384
s_load_dword s71, s[80:81], 448
s_load_dword s72, s[80:81], 512
s_add_u32 s80, s80, 576
s_addc_u32 s81, s81, 0
s_waitcnt vmcnt(16)
s_barrier
s_mov_b32 s41, 2
.p2align 3
Lp3_139:
s_add_u32 s42, s42, 1
s_xor_b32 s37, s42, s35
s_add_u32 m0, s39, 0
s_mul_i32 s37, s37, s40
buffer_load_dwordx4 v22, s[8:11], s37 offen sc1 lds
s_add_u32 m0, s39, 1024
s_add_u32 s37, s37, s38
buffer_load_dwordx4 v23, s[8:11], s37 offen sc1 lds
s_add_u32 m0, s39, 2048
s_add_u32 s37, s37, s38
buffer_load_dwordx4 v22, s[8:11], s37 offen sc1 lds
s_add_u32 m0, s39, 3072
s_add_u32 s37, s37, s38
buffer_load_dwordx4 v23, s[8:11], s37 offen sc1 lds
s_add_u32 m0, s39, 4096
s_add_u32 s37, s37, s38
buffer_load_dwordx4 v22, s[8:11], s37 offen sc1 lds
s_add_u32 m0, s39, 5120
s_add_u32 s37, s37, s38
buffer_load_dwordx4 v23, s[8:11], s37 offen sc1 lds
s_add_u32 m0, s39, 6144
s_add_u32 s37, s37, s38
buffer_load_dwordx4 v22, s[8:11], s37 offen sc1 lds
s_add_u32 m0, s39, 7168
s_add_u32 s37, s37, s38
buffer_load_dwordx4 v23, s[8:11], s37 offen sc1 lds
s_add_u32 m0, s39, 8192
s_add_u32 s37, s37, s38
buffer_load_dwordx4 v22, s[8:11], s37 offen sc1 lds
s_add_u32 m0, s39, 9216
s_add_u32 s37, s37, s38
buffer_load_dwordx4 v23, s[8:11], s37 offen sc1 lds
s_add_u32 m0, s39, 10240
s_add_u32 s37, s37, s38
buffer_load_dwordx4 v22, s[8:11], s37 offen sc1 lds
s_add_u32 m0, s39, 11264
s_add_u32 s37, s37, s38
buffer_load_dwordx4 v23, s[8:11], s37 offen sc1 lds
s_add_u32 m0, s39, 12288
s_add_u32 s37, s37, s38
buffer_load_dwordx4 v22, s[8:11], s37 offen sc1 lds
s_add_u32 m0, s39, 13312
s_add_u32 s37, s37, s38
buffer_load_dwordx4 v23, s[8:11], s37 offen sc1 lds
s_add_u32 m0, s39, 14336
s_add_u32 s37, s37, s38
buffer_load_dwordx4 v22, s[8:11], s37 offen sc1 lds
s_add_u32 m0, s39, 15360
s_add_u32 s37, s37, s38
buffer_load_dwordx4 v23, s[8:11], s37 offen sc1 lds
s_load_dword s64, s[80:81], 0
s_load_dword s65, s[80:81], 64
s_load_dword s66, s[80:81], 128
s_load_dword s67, s[80:81], 192
s_load_dword s68, s[80:81], 256
s_load_dword s69, s[80:81], 320
s_load_dword s70, s[80:81], 384
s_load_dword s71, s[80:81], 448
s_load_dword s72, s[80:81], 512
s_add_u32 s80, s80, 576
s_addc_u32 s81, s81, 0
s_waitcnt vmcnt(16)
s_barrier
s_add_u32 s42, s42, 1
s_xor_b32 s37, s42, s35
s_add_u32 m0, s39, 49152
s_mul_i32 s37, s37, s40
buffer_load_dwordx4 v22, s[8:11], s37 offen sc1 lds
s_add_u32 m0, s39, 50176
s_add_u32 s37, s37, s38
buffer_load_dwordx4 v23, s[8:11], s37 offen sc1 lds
s_add_u32 m0, s39, 51200
s_add_u32 s37, s37, s38
buffer_load_dwordx4 v22, s[8:11], s37 offen sc1 lds
s_add_u32 m0, s39, 52224
s_add_u32 s37, s37, s38
buffer_load_dwordx4 v23, s[8:11], s37 offen sc1 lds
s_add_u32 m0, s39, 53248
s_add_u32 s37, s37, s38
buffer_load_dwordx4 v22, s[8:11], s37 offen sc1 lds
s_add_u32 m0, s39, 54272
s_add_u32 s37, s37, s38
buffer_load_dwordx4 v23, s[8:11], s37 offen sc1 lds
s_add_u32 m0, s39, 55296
s_add_u32 s37, s37, s38
buffer_load_dwordx4 v22, s[8:11], s37 offen sc1 lds
s_add_u32 m0, s39, 56320
s_add_u32 s37, s37, s38
buffer_load_dwordx4 v23, s[8:11], s37 offen sc1 lds
s_add_u32 m0, s39, 57344
s_add_u32 s37, s37, s38
buffer_load_dwordx4 v22, s[8:11], s37 offen sc1 lds
s_add_u32 m0, s39, 58368
s_add_u32 s37, s37, s38
buffer_load_dwordx4 v23, s[8:11], s37 offen sc1 lds
s_add_u32 m0, s39, 59392
s_add_u32 s37, s37, s38
buffer_load_dwordx4 v22, s[8:11], s37 offen sc1 lds
s_add_u32 m0, s39, 60416
s_add_u32 s37, s37, s38
buffer_load_dwordx4 v23, s[8:11], s37 offen sc1 lds
s_add_u32 m0, s39, 61440
s_add_u32 s37, s37, s38
buffer_load_dwordx4 v22, s[8:11], s37 offen sc1 lds
s_add_u32 m0, s39, 62464
s_add_u32 s37, s37, s38
buffer_load_dwordx4 v23, s[8:11], s37 offen sc1 lds
s_add_u32 m0, s39, 63488
s_add_u32 s37, s37, s38
buffer_load_dwordx4 v22, s[8:11], s37 offen sc1 lds
s_add_u32 m0, s39, 64512
s_add_u32 s37, s37, s38
buffer_load_dwordx4 v23, s[8:11], s37 offen sc1 lds
s_load_dword s64, s[80:81], 0
s_load_dword s65, s[80:81], 64
s_load_dword s66, s[80:81], 128
s_load_dword s67, s[80:81], 192
s_load_dword s68, s[80:81], 256
s_load_dword s69, s[80:81], 320
s_load_dword s70, s[80:81], 384
s_load_dword s71, s[80:81], 448
s_load_dword s72, s[80:81], 512
s_add_u32 s80, s80, 576
s_addc_u32 s81, s81, 0
s_waitcnt vmcnt(16)
s_barrier
s_add_u32 s42, s42, 1
s_xor_b32 s37, s42, s35
s_add_u32 m0, s39, 98304
s_mul_i32 s37, s37, s40
buffer_load_dwordx4 v22, s[8:11], s37 offen sc1 lds
s_add_u32 m0, s39, 99328
s_add_u32 s37, s37, s38
buffer_load_dwordx4 v23, s[8:11], s37 offen sc1 lds
s_add_u32 m0, s39, 100352
s_add_u32 s37, s37, s38
buffer_load_dwordx4 v22, s[8:11], s37 offen sc1 lds
s_add_u32 m0, s39, 101376
s_add_u32 s37, s37, s38
buffer_load_dwordx4 v23, s[8:11], s37 offen sc1 lds
s_add_u32 m0, s39, 102400
s_add_u32 s37, s37, s38
buffer_load_dwordx4 v22, s[8:11], s37 offen sc1 lds
s_add_u32 m0, s39, 103424
s_add_u32 s37, s37, s38
buffer_load_dwordx4 v23, s[8:11], s37 offen sc1 lds
s_add_u32 m0, s39, 104448
s_add_u32 s37, s37, s38
buffer_load_dwordx4 v22, s[8:11], s37 offen sc1 lds
s_add_u32 m0, s39, 105472
s_add_u32 s37, s37, s38
buffer_load_dwordx4 v23, s[8:11], s37 offen sc1 lds
s_add_u32 m0, s39, 106496
s_add_u32 s37, s37, s38
buffer_load_dwordx4 v22, s[8:11], s37 offen sc1 lds
s_add_u32 m0, s39, 107520
s_add_u32 s37, s37, s38
buffer_load_dwordx4 v23, s[8:11], s37 offen sc1 lds
s_add_u32 m0, s39, 108544
s_add_u32 s37, s37, s38
buffer_load_dwordx4 v22, s[8:11], s37 offen sc1 lds
s_add_u32 m0, s39, 109568
s_add_u32 s37, s37, s38
buffer_load_dwordx4 v23, s[8:11], s37 offen sc1 lds
s_add_u32 m0, s39, 110592
s_add_u32 s37, s37, s38
buffer_load_dwordx4 v22, s[8:11], s37 offen sc1 lds
s_add_u32 m0, s39, 111616
s_add_u32 s37, s37, s38
buffer_load_dwordx4 v23, s[8:11], s37 offen sc1 lds
s_add_u32 m0, s39, 112640
s_add_u32 s37, s37, s38
buffer_load_dwordx4 v22, s[8:11], s37 offen sc1 lds
s_add_u32 m0, s39, 113664
s_add_u32 s37, s37, s38
buffer_load_dwordx4 v23, s[8:11], s37 offen sc1 lds
s_load_dword s64, s[80:81], 0
s_load_dword s65, s[80:81], 64
s_load_dword s66, s[80:81], 128
s_load_dword s67, s[80:81], 192
s_load_dword s68, s[80:81], 256
s_load_dword s69, s[80:81], 320
s_load_dword s70, s[80:81], 384
s_load_dword s71, s[80:81], 448
s_load_dword s72, s[80:81], 512
s_add_u32 s80, s80, 576
s_addc_u32 s81, s81, 0
s_waitcnt vmcnt(16)
s_barrier
s_sub_u32 s41, s41, 1
s_cmp_lg_u32 s41, 0
s_cbranch_scc1 Lp3_139
s_add_u32 s42, s42, 1
s_xor_b32 s37, s42, s35
s_add_u32 m0, s39, 0
s_mul_i32 s37, s37, s40
buffer_load_dwordx4 v22, s[8:11], s37 offen sc1 lds
s_add_u32 m0, s39, 1024
s_add_u32 s37, s37, s38
buffer_load_dwordx4 v23, s[8:11], s37 offen sc1 lds
s_add_u32 m0, s39, 2048
s_add_u32 s37, s37, s38
buffer_load_dwordx4 v22, s[8:11], s37 offen sc1 lds
s_add_u32 m0, s39, 3072
s_add_u32 s37, s37, s38
buffer_load_dwordx4 v23, s[8:11], s37 offen sc1 lds
s_add_u32 m0, s39, 4096
s_add_u32 s37, s37, s38
buffer_load_dwordx4 v22, s[8:11], s37 offen sc1 lds
s_add_u32 m0, s39, 5120
s_add_u32 s37, s37, s38
buffer_load_dwordx4 v23, s[8:11], s37 offen sc1 lds
s_add_u32 m0, s39, 6144
s_add_u32 s37, s37, s38
buffer_load_dwordx4 v22, s[8:11], s37 offen sc1 lds
s_add_u32 m0, s39, 7168
s_add_u32 s37, s37, s38
buffer_load_dwordx4 v23, s[8:11], s37 offen sc1 lds
s_add_u32 m0, s39, 8192
s_add_u32 s37, s37, s38
buffer_load_dwordx4 v22, s[8:11], s37 offen sc1 lds
s_add_u32 m0, s39, 9216
s_add_u32 s37, s37, s38
buffer_load_dwordx4 v23, s[8:11], s37 offen sc1 lds
s_add_u32 m0, s39, 10240
s_add_u32 s37, s37, s38
buffer_load_dwordx4 v22, s[8:11], s37 offen sc1 lds
s_add_u32 m0, s39, 11264
s_add_u32 s37, s37, s38
buffer_load_dwordx4 v23, s[8:11], s37 offen sc1 lds
s_add_u32 m0, s39, 12288
s_add_u32 s37, s37, s38
buffer_load_dwordx4 v22, s[8:11], s37 offen sc1 lds
s_add_u32 m0, s39, 13312
s_add_u32 s37, s37, s38
buffer_load_dwordx4 v23, s[8:11], s37 offen sc1 lds
s_add_u32 m0, s39, 14336
s_add_u32 s37, s37, s38
buffer_load_dwordx4 v22, s[8:11], s37 offen sc1 lds
s_add_u32 m0, s39, 15360
s_add_u32 s37, s37, s38
buffer_load_dwordx4 v23, s[8:11], s37 offen sc1 lds
s_load_dword s64, s[80:81], 0
s_load_dword s65, s[80:81], 64
s_load_dword s66, s[80:81], 128
s_load_dword s67, s[80:81], 192
s_load_dword s68, s[80:81], 256
s_load_dword s69, s[80:81], 320
s_load_dword s70, s[80:81], 384
s_load_dword s71, s[80:81], 448
s_load_dword s72, s[80:81], 512
s_add_u32 s80, s80, 576
s_addc_u32 s81, s81, 0
s_waitcnt vmcnt(16)
s_barrier
s_add_u32 s42, s42, 1
s_xor_b32 s37, s42, s35
s_add_u32 m0, s39, 49152
s_mul_i32 s37, s37, s40
buffer_load_dwordx4 v22, s[8:11], s37 offen sc1 lds
s_add_u32 m0, s39, 50176
s_add_u32 s37, s37, s38
buffer_load_dwordx4 v23, s[8:11], s37 offen sc1 lds
s_add_u32 m0, s39, 51200
s_add_u32 s37, s37, s38
buffer_load_dwordx4 v22, s[8:11], s37 offen sc1 lds
s_add_u32 m0, s39, 52224
s_add_u32 s37, s37, s38
buffer_load_dwordx4 v23, s[8:11], s37 offen sc1 lds
s_add_u32 m0, s39, 53248
s_add_u32 s37, s37, s38
buffer_load_dwordx4 v22, s[8:11], s37 offen sc1 lds
s_add_u32 m0, s39, 54272
s_add_u32 s37, s37, s38
buffer_load_dwordx4 v23, s[8:11], s37 offen sc1 lds
s_add_u32 m0, s39, 55296
s_add_u32 s37, s37, s38
buffer_load_dwordx4 v22, s[8:11], s37 offen sc1 lds
s_add_u32 m0, s39, 56320
s_add_u32 s37, s37, s38
buffer_load_dwordx4 v23, s[8:11], s37 offen sc1 lds
s_add_u32 m0, s39, 57344
s_add_u32 s37, s37, s38
buffer_load_dwordx4 v22, s[8:11], s37 offen sc1 lds
s_add_u32 m0, s39, 58368
s_add_u32 s37, s37, s38
buffer_load_dwordx4 v23, s[8:11], s37 offen sc1 lds
s_add_u32 m0, s39, 59392
s_add_u32 s37, s37, s38
buffer_load_dwordx4 v22, s[8:11], s37 offen sc1 lds
s_add_u32 m0, s39, 60416
s_add_u32 s37, s37, s38
buffer_load_dwordx4 v23, s[8:11], s37 offen sc1 lds
s_add_u32 m0, s39, 61440
s_add_u32 s37, s37, s38
buffer_load_dwordx4 v22, s[8:11], s37 offen sc1 lds
s_add_u32 m0, s39, 62464
s_add_u32 s37, s37, s38
buffer_load_dwordx4 v23, s[8:11], s37 offen sc1 lds
s_add_u32 m0, s39, 63488
s_add_u32 s37, s37, s38
buffer_load_dwordx4 v22, s[8:11], s37 offen sc1 lds
s_add_u32 m0, s39, 64512
s_add_u32 s37, s37, s38
buffer_load_dwordx4 v23, s[8:11], s37 offen sc1 lds
s_load_dword s64, s[80:81], 0
s_load_dword s65, s[80:81], 64
s_load_dword s66, s[80:81], 128
s_load_dword s67, s[80:81], 192
s_load_dword s68, s[80:81], 256
s_load_dword s69, s[80:81], 320
s_load_dword s70, s[80:81], 384
s_load_dword s71, s[80:81], 448
s_load_dword s72, s[80:81], 512
s_add_u32 s80, s80, 576
s_addc_u32 s81, s81, 0
s_waitcnt vmcnt(16)
s_barrier
s_add_u32 s42, s42, 1
s_xor_b32 s37, s42, s35
s_add_u32 m0, s39, 98304
s_mul_i32 s37, s37, s40
buffer_load_dwordx4 v22, s[8:11], s37 offen sc1 lds
s_and_b32 s53, s35, 1
s_lshl_b32 s53, s53, 1
s_mul_i32 s43, s47, 3
s_add_u32 m0, s39, 99328
s_add_u32 s37, s37, s38
buffer_load_dwordx4 v23, s[8:11], s37 offen sc1 lds
s_add_u32 s53, s53, s43
v_lshlrev_b32 v19, 11, v18
v_lshl_add_u32 v19, v17, 4, v19
s_add_u32 m0, s39, 100352
s_add_u32 s37, s37, s38
buffer_load_dwordx4 v22, s[8:11], s37 offen sc1 lds
s_lshl_b32 s43, s46, 10
v_add_u32 v2, s43, v19
v_add_u32 v3, 49152, v2
s_add_u32 m0, s39, 101376
s_add_u32 s37, s37, s38
buffer_load_dwordx4 v23, s[8:11], s37 offen sc1 lds
v_add_u32 v4, 98304, v2
v_lshrrev_b32 v19, 2, v17
v_lshl_add_u32 v20, v18, 2, v19
s_add_u32 m0, s39, 102400
s_add_u32 s37, s37, s38
buffer_load_dwordx4 v22, s[8:11], s37 offen sc1 lds
v_and_b32 v21, 7, v20
v_lshlrev_b32 v20, 8, v20
v_and_b32 v19, 3, v1
s_add_u32 m0, s39, 103424
s_add_u32 s37, s37, s38
buffer_load_dwordx4 v23, s[8:11], s37 offen sc1 lds
v_lshl_add_u32 v20, v19, 3, v20
s_add_u32 s43, s53, 0
v_xor_b32 v19, s43, v21
s_add_u32 m0, s39, 104448
s_add_u32 s37, s37, s38
buffer_load_dwordx4 v22, s[8:11], s37 offen sc1 lds
v_lshl_add_u32 v5, v19, 5, v20
s_add_u32 s43, s53, 1
v_xor_b32 v19, s43, v21
s_add_u32 m0, s39, 105472
s_add_u32 s37, s37, s38
buffer_load_dwordx4 v23, s[8:11], s37 offen sc1 lds
v_lshl_add_u32 v6, v19, 5, v20
s_add_u32 s43, s53, 2
v_xor_b32 v19, s43, v21
s_add_u32 m0, s39, 106496
s_add_u32 s37, s37, s38
buffer_load_dwordx4 v22, s[8:11], s37 offen sc1 lds
v_lshl_add_u32 v7, v19, 5, v20
v_add_u32 v9, 49152, v5
v_add_u32 v10, 49152, v6
s_add_u32 m0, s39, 107520
s_add_u32 s37, s37, s38
buffer_load_dwordx4 v23, s[8:11], s37 offen sc1 lds
v_add_u32 v11, 49152, v7
v_add_u32 v13, 98304, v5
v_add_u32 v14, 98304, v6
s_add_u32 m0, s39, 108544
s_add_u32 s37, s37, s38
buffer_load_dwordx4 v22, s[8:11], s37 offen sc1 lds
v_add_u32 v15, 98304, v7
s_lshl_b32 s43, s46, 9
s_add_u32 s43, s43, 147456
s_add_u32 m0, s39, 109568
s_add_u32 s37, s37, s38
buffer_load_dwordx4 v23, s[8:11], s37 offen sc1 lds
v_lshl_add_u32 v19, v17, 3, s43
ds_read_b64 v[80:81], v19 offset:0
ds_read_b64 v[82:83], v19 offset:128
s_add_u32 m0, s39, 110592
s_add_u32 s37, s37, s38
buffer_load_dwordx4 v22, s[8:11], s37 offen sc1 lds
ds_read_b64 v[84:85], v19 offset:256
ds_read_b64 v[86:87], v19 offset:384
s_mul_i32 s43, s47, 192
s_add_u32 m0, s39, 111616
s_add_u32 s37, s37, s38
buffer_load_dwordx4 v23, s[8:11], s37 offen sc1 lds
s_add_u32 s43, s43, 148992
v_lshl_add_u32 v19, v18, 4, s43
ds_read_b128 v[48:51], v19 offset:0
s_add_u32 m0, s39, 112640
s_add_u32 s37, s37, s38
buffer_load_dwordx4 v22, s[8:11], s37 offen sc1 lds
ds_read_b128 v[52:55], v19 offset:64
ds_read_b128 v[56:59], v19 offset:128
ds_read_b128 v[60:63], v19 offset:896
s_add_u32 m0, s39, 113664
s_add_u32 s37, s37, s38
buffer_load_dwordx4 v23, s[8:11], s37 offen sc1 lds
ds_read_b128 v[64:67], v19 offset:960
ds_read_b128 v[68:71], v19 offset:1024
s_waitcnt vmcnt(16)
s_barrier
s_add_u32 s42, s42, 1
s_xor_b32 s37, s42, s35
s_add_u32 m0, s39, 0
s_mul_i32 s37, s37, s40
buffer_load_dwordx4 v22, s[8:11], s37 offen sc1 lds
s_waitcnt lgkmcnt(0)
v_mul_f32 v88, v81, v81
s_add_u32 m0, s39, 1024
s_add_u32 s37, s37, s38
buffer_load_dwordx4 v23, s[8:11], s37 offen sc1 lds
v_mul_f32 v228, 0xc0135761, v81
s_add_u32 m0, s39, 2048
s_add_u32 s37, s37, s38
buffer_load_dwordx4 v22, s[8:11], s37 offen sc1 lds
v_mul_f32 v89, 0xbdd2d3e8, v81
s_add_u32 m0, s39, 3072
s_add_u32 s37, s37, s38
buffer_load_dwordx4 v23, s[8:11], s37 offen sc1 lds
v_rcp_f32 v236, v88
v_mul_f32 v232, v89, v88
s_add_u32 m0, s39, 4096
s_add_u32 s37, s37, s38
buffer_load_dwordx4 v22, s[8:11], s37 offen sc1 lds
v_mul_f32 v88, v83, v83
s_add_u32 m0, s39, 5120
s_add_u32 s37, s37, s38
buffer_load_dwordx4 v23, s[8:11], s37 offen sc1 lds
v_mul_f32 v229, 0xc0135761, v83
s_add_u32 m0, s39, 6144
s_add_u32 s37, s37, s38
buffer_load_dwordx4 v22, s[8:11], s37 offen sc1 lds
v_mul_f32 v89, 0xbdd2d3e8, v83
v_rcp_f32 v237, v88
s_add_u32 m0, s39, 7168
s_add_u32 s37, s37, s38
buffer_load_dwordx4 v23, s[8:11], s37 offen sc1 lds
v_mul_f32 v233, v89, v88
s_add_u32 m0, s39, 8192
s_add_u32 s37, s37, s38
buffer_load_dwordx4 v22, s[8:11], s37 offen sc1 lds
v_mul_f32 v88, v85, v85
s_add_u32 m0, s39, 9216
s_add_u32 s37, s37, s38
buffer_load_dwordx4 v23, s[8:11], s37 offen sc1 lds
v_mul_f32 v230, 0xc0135761, v85
v_mul_f32 v89, 0xbdd2d3e8, v85
s_add_u32 m0, s39, 10240
s_add_u32 s37, s37, s38
buffer_load_dwordx4 v22, s[8:11], s37 offen sc1 lds
v_rcp_f32 v238, v88
s_add_u32 m0, s39, 11264
s_add_u32 s37, s37, s38
buffer_load_dwordx4 v23, s[8:11], s37 offen sc1 lds
v_mul_f32 v234, v89, v88
s_add_u32 m0, s39, 12288
s_add_u32 s37, s37, s38
buffer_load_dwordx4 v22, s[8:11], s37 offen sc1 lds
v_mul_f32 v88, v87, v87
v_mul_f32 v231, 0xc0135761, v87
s_add_u32 m0, s39, 13312
s_add_u32 s37, s37, s38
buffer_load_dwordx4 v23, s[8:11], s37 offen sc1 lds
v_mul_f32 v89, 0xbdd2d3e8, v87
s_add_u32 m0, s39, 14336
s_add_u32 s37, s37, s38
buffer_load_dwordx4 v22, s[8:11], s37 offen sc1 lds
v_rcp_f32 v239, v88
s_add_u32 m0, s39, 15360
s_add_u32 s37, s37, s38
buffer_load_dwordx4 v23, s[8:11], s37 offen sc1 lds
v_mul_f32 v235, v89, v88
s_mul_i32 s43, s34, 917504
s_mov_b32 s44, 3577949200
s_mov_b32 s45, 3137247350
s_lshl_b32 s50, s49, 2
s_lshr_b64 s[44:45], s[44:45], s50
s_and_b32 s50, s44, 15
s_mul_i32 s44, s50, 24576
s_add_u32 s43, s43, s44
s_add_u32 s43, s43, 8912896
s_add_u32 s24, s32, s43
s_addc_u32 s25, s33, 0
s_mov_b32 s26, 24576
s_mov_b32 s27, 0x20000
s_mov_b32 s53, 262144
s_lshl_b32 s43, s47, 13
s_lshl_b32 s44, s46, 10
s_add_u32 s43, s43, s44
v_lshlrev_b32 v19, 11, v18
v_lshl_add_u32 v19, v17, 4, v19
v_add_u32 v27, s43, v19
s_lshl_b32 s43, s47, 12
s_add_u32 s43, s43, s44
s_add_u32 s43, s43, 16384
v_and_b32 v19, 1, v18
v_lshlrev_b32 v19, 11, v19
v_lshrrev_b32 v20, 1, v18
v_lshl_add_u32 v19, v20, 8, v19
v_lshl_add_u32 v19, v17, 4, v19
v_add_u32 v28, s43, v19
s_load_dword s64, s[80:81], 0
s_load_dword s65, s[80:81], 64
s_load_dword s66, s[80:81], 128
s_load_dword s67, s[80:81], 192
s_load_dword s68, s[80:81], 256
s_load_dword s69, s[80:81], 320
s_load_dword s70, s[80:81], 384
s_load_dword s71, s[80:81], 448
s_add_u32 s80, s80, 512
s_addc_u32 s81, s81, 0
s_waitcnt vmcnt(16)
s_barrier
s_add_u32 s42, s42, 1
s_xor_b32 s37, s42, s35
s_add_u32 m0, s39, 49152
s_mul_i32 s37, s37, s40
buffer_load_dwordx4 v22, s[8:11], s37 offen sc1 lds
v_mul_f32 v128, -v80, v48
v_mul_f32 v129, -v80, v49
s_add_u32 m0, s39, 50176
s_add_u32 s37, s37, s38
buffer_load_dwordx4 v23, s[8:11], s37 offen sc1 lds
v_mul_f32 v130, -v80, v50
v_mul_f32 v131, -v80, v51
s_add_u32 m0, s39, 51200
s_add_u32 s37, s37, s38
buffer_load_dwordx4 v22, s[8:11], s37 offen sc1 lds
v_mul_f32 v132, -v82, v48
v_mul_f32 v133, -v82, v49
s_add_u32 m0, s39, 52224
s_add_u32 s37, s37, s38
buffer_load_dwordx4 v23, s[8:11], s37 offen sc1 lds
v_mul_f32 v134, -v82, v50
v_mul_f32 v135, -v82, v51
s_add_u32 m0, s39, 53248
s_add_u32 s37, s37, s38
buffer_load_dwordx4 v22, s[8:11], s37 offen sc1 lds
v_mul_f32 v136, -v84, v48
v_mul_f32 v137, -v84, v49
s_add_u32 m0, s39, 54272
s_add_u32 s37, s37, s38
buffer_load_dwordx4 v23, s[8:11], s37 offen sc1 lds
v_mul_f32 v138, -v84, v50
v_mul_f32 v139, -v84, v51
s_add_u32 m0, s39, 55296
s_add_u32 s37, s37, s38
buffer_load_dwordx4 v22, s[8:11], s37 offen sc1 lds
v_mul_f32 v140, -v86, v48
v_mul_f32 v141, -v86, v49
s_add_u32 m0, s39, 56320
s_add_u32 s37, s37, s38
buffer_load_dwordx4 v23, s[8:11], s37 offen sc1 lds
v_mul_f32 v142, -v86, v50
v_mul_f32 v143, -v86, v51
s_add_u32 m0, s39, 57344
s_add_u32 s37, s37, s38
buffer_load_dwordx4 v22, s[8:11], s37 offen sc1 lds
v_mul_f32 v144, -v80, v52
v_mul_f32 v145, -v80, v53
s_add_u32 m0, s39, 58368
s_add_u32 s37, s37, s38
buffer_load_dwordx4 v23, s[8:11], s37 offen sc1 lds
v_mul_f32 v146, -v80, v54
v_mul_f32 v147, -v80, v55
s_add_u32 m0, s39, 59392
s_add_u32 s37, s37, s38
buffer_load_dwordx4 v22, s[8:11], s37 offen sc1 lds
v_mul_f32 v148, -v82, v52
v_mul_f32 v149, -v82, v53
s_add_u32 m0, s39, 60416
s_add_u32 s37, s37, s38
buffer_load_dwordx4 v23, s[8:11], s37 offen sc1 lds
v_mul_f32 v150, -v82, v54
v_mul_f32 v151, -v82, v55
s_add_u32 m0, s39, 61440
s_add_u32 s37, s37, s38
buffer_load_dwordx4 v22, s[8:11], s37 offen sc1 lds
v_mul_f32 v152, -v84, v52
v_mul_f32 v153, -v84, v53
s_add_u32 m0, s39, 62464
s_add_u32 s37, s37, s38
buffer_load_dwordx4 v23, s[8:11], s37 offen sc1 lds
v_mul_f32 v154, -v84, v54
v_mul_f32 v155, -v84, v55
s_add_u32 m0, s39, 63488
s_add_u32 s37, s37, s38
buffer_load_dwordx4 v22, s[8:11], s37 offen sc1 lds
v_mul_f32 v156, -v86, v52
v_mul_f32 v157, -v86, v53
s_add_u32 m0, s39, 64512
s_add_u32 s37, s37, s38
buffer_load_dwordx4 v23, s[8:11], s37 offen sc1 lds
v_mul_f32 v158, -v86, v54
v_mul_f32 v159, -v86, v55
s_load_dword s64, s[80:81], 0
s_load_dword s65, s[80:81], 64
s_load_dword s66, s[80:81], 128
s_load_dword s67, s[80:81], 192
s_load_dword s68, s[80:81], 256
s_load_dword s69, s[80:81], 320
s_load_dword s70, s[80:81], 384
s_load_dword s71, s[80:81], 448
s_add_u32 s80, s80, 512
s_addc_u32 s81, s81, 0
s_waitcnt vmcnt(16)
s_barrier
s_add_u32 s42, s42, 1
s_xor_b32 s37, s42, s35
s_add_u32 m0, s39, 98304
s_mul_i32 s37, s37, s40
buffer_load_dwordx4 v22, s[8:11], s37 offen sc1 lds
v_mul_f32 v160, -v80, v56
v_mul_f32 v161, -v80, v57
s_add_u32 m0, s39, 99328
s_add_u32 s37, s37, s38
buffer_load_dwordx4 v23, s[8:11], s37 offen sc1 lds
v_mul_f32 v162, -v80, v58
v_mul_f32 v163, -v80, v59
s_add_u32 m0, s39, 100352
s_add_u32 s37, s37, s38
buffer_load_dwordx4 v22, s[8:11], s37 offen sc1 lds
v_mul_f32 v164, -v82, v56
v_mul_f32 v165, -v82, v57
s_add_u32 m0, s39, 101376
s_add_u32 s37, s37, s38
buffer_load_dwordx4 v23, s[8:11], s37 offen sc1 lds
v_mul_f32 v166, -v82, v58
v_mul_f32 v167, -v82, v59
s_add_u32 m0, s39, 102400
s_add_u32 s37, s37, s38
buffer_load_dwordx4 v22, s[8:11], s37 offen sc1 lds
v_mul_f32 v168, -v84, v56
v_mul_f32 v169, -v84, v57
s_add_u32 m0, s39, 103424
s_add_u32 s37, s37, s38
buffer_load_dwordx4 v23, s[8:11], s37 offen sc1 lds
v_mul_f32 v170, -v84, v58
v_mul_f32 v171, -v84, v59
s_add_u32 m0, s39, 104448
s_add_u32 s37, s37, s38
buffer_load_dwordx4 v22, s[8:11], s37 offen sc1 lds
v_mul_f32 v172, -v86, v56
v_mul_f32 v173, -v86, v57
s_add_u32 m0, s39, 105472
s_add_u32 s37, s37, s38
buffer_load_dwordx4 v23, s[8:11], s37 offen sc1 lds
v_mul_f32 v174, -v86, v58
v_mul_f32 v175, -v86, v59
s_add_u32 m0, s39, 106496
s_add_u32 s37, s37, s38
buffer_load_dwordx4 v22, s[8:11], s37 offen sc1 lds
v_mul_f32 v176, -v80, v60
v_mul_f32 v177, -v80, v61
s_add_u32 m0, s39, 107520
s_add_u32 s37, s37, s38
buffer_load_dwordx4 v23, s[8:11], s37 offen sc1 lds
v_mul_f32 v178, -v80, v62
v_mul_f32 v179, -v80, v63
s_add_u32 m0, s39, 108544
s_add_u32 s37, s37, s38
buffer_load_dwordx4 v22, s[8:11], s37 offen sc1 lds
v_mul_f32 v180, -v82, v60
v_mul_f32 v181, -v82, v61
s_add_u32 m0, s39, 109568
s_add_u32 s37, s37, s38
buffer_load_dwordx4 v23, s[8:11], s37 offen sc1 lds
v_mul_f32 v182, -v82, v62
v_mul_f32 v183, -v82, v63
s_add_u32 m0, s39, 110592
s_add_u32 s37, s37, s38
buffer_load_dwordx4 v22, s[8:11], s37 offen sc1 lds
v_mul_f32 v184, -v84, v60
v_mul_f32 v185, -v84, v61
s_add_u32 m0, s39, 111616
s_add_u32 s37, s37, s38
buffer_load_dwordx4 v23, s[8:11], s37 offen sc1 lds
v_mul_f32 v186, -v84, v62
v_mul_f32 v187, -v84, v63
s_add_u32 m0, s39, 112640
s_add_u32 s37, s37, s38
buffer_load_dwordx4 v22, s[8:11], s37 offen sc1 lds
v_mul_f32 v188, -v86, v60
v_mul_f32 v189, -v86, v61
s_add_u32 m0, s39, 113664
s_add_u32 s37, s37, s38
buffer_load_dwordx4 v23, s[8:11], s37 offen sc1 lds
v_mul_f32 v190, -v86, v62
v_mul_f32 v191, -v86, v63
s_load_dword s64, s[80:81], 0
s_load_dword s65, s[80:81], 64
s_load_dword s66, s[80:81], 128
s_load_dword s67, s[80:81], 192
s_load_dword s68, s[80:81], 256
s_load_dword s69, s[80:81], 320
s_load_dword s70, s[80:81], 384
s_load_dword s71, s[80:81], 448
s_add_u32 s80, s80, 512
s_addc_u32 s81, s81, 0
s_waitcnt vmcnt(16)
s_barrier
s_mul_i32 s43, s49, 192
s_and_b32 s43, s43, 0xffffff80
s_add_u32 s43, s43, 4096
s_cmp_eq_u32 s51, 1
s_cselect_b32 s8, s4, s6
s_cselect_b32 s9, s5, s7
s_sub_u32 s10, 7340032, s43
s_lshl_b32 s44, s34, 18
s_add_u32 s44, s44, 4194304
s_movk_i32 s38, 28672
s_cmp_eq_u32 s51, 0
s_cselect_b32 s8, s32, s8
s_cselect_b32 s9, s33, s9
s_cselect_b32 s10, 262144, s10
s_cselect_b32 s43, s44, s43
s_cselect_b32 s38, 1024, s38
s_cselect_b32 s45, 0, -1
s_add_u32 s8, s8, s43
s_addc_u32 s9, s9, 0
s_mov_b32 s11, 0x20000
s_lshl_b32 s40, s38, 4
s_mov_b32 s42, -1
s_lshl_b32 s39, s51, 14
v_lshrrev_b32 v19, 4, v1
v_lshlrev_b32 v20, 5, v19
v_mul_u32_u24 v19, 6912, v19
v_and_b32 v19, s45, v19
v_and_b32 v20, s45, v20
v_lshlrev_b32 v21, 4, v1
v_xor_b32 v21, v21, v20
v_add_u32 v22, v21, v19
s_and_b32 s45, s45, 128
v_xor_b32 v23, s45, v22
s_add_u32 s42, s42, 1
s_xor_b32 s37, s42, s35
s_add_u32 m0, s39, 0
s_mul_i32 s37, s37, s40
buffer_load_dwordx4 v22, s[8:11], s37 offen sc1 lds
v_mul_f32 v192, -v80, v64
v_mul_f32 v193, -v80, v65
s_add_u32 m0, s39, 1024
s_add_u32 s37, s37, s38
buffer_load_dwordx4 v23, s[8:11], s37 offen sc1 lds
v_mul_f32 v194, -v80, v66
v_mul_f32 v195, -v80, v67
s_add_u32 m0, s39, 2048
s_add_u32 s37, s37, s38
buffer_load_dwordx4 v22, s[8:11], s37 offen sc1 lds
v_mul_f32 v196, -v82, v64
v_mul_f32 v197, -v82, v65
s_add_u32 m0, s39, 3072
s_add_u32 s37, s37, s38
buffer_load_dwordx4 v23, s[8:11], s37 offen sc1 lds
v_mul_f32 v198, -v82, v66
v_mul_f32 v199, -v82, v67
s_add_u32 m0, s39, 4096
s_add_u32 s37, s37, s38
buffer_load_dwordx4 v22, s[8:11], s37 offen sc1 lds
v_mul_f32 v200, -v84, v64
v_mul_f32 v201, -v84, v65
s_add_u32 m0, s39, 5120
s_add_u32 s37, s37, s38
buffer_load_dwordx4 v23, s[8:11], s37 offen sc1 lds
v_mul_f32 v202, -v84, v66
v_mul_f32 v203, -v84, v67
s_add_u32 m0, s39, 6144
s_add_u32 s37, s37, s38
buffer_load_dwordx4 v22, s[8:11], s37 offen sc1 lds
v_mul_f32 v204, -v86, v64
v_mul_f32 v205, -v86, v65
s_add_u32 m0, s39, 7168
s_add_u32 s37, s37, s38
buffer_load_dwordx4 v23, s[8:11], s37 offen sc1 lds
v_mul_f32 v206, -v86, v66
v_mul_f32 v207, -v86, v67
s_add_u32 m0, s39, 8192
s_add_u32 s37, s37, s38
buffer_load_dwordx4 v22, s[8:11], s37 offen sc1 lds
v_mul_f32 v208, -v80, v68
v_mul_f32 v209, -v80, v69
s_add_u32 m0, s39, 9216
s_add_u32 s37, s37, s38
buffer_load_dwordx4 v23, s[8:11], s37 offen sc1 lds
v_mul_f32 v210, -v80, v70
v_mul_f32 v211, -v80, v71
s_add_u32 m0, s39, 10240
s_add_u32 s37, s37, s38
buffer_load_dwordx4 v22, s[8:11], s37 offen sc1 lds
v_mul_f32 v212, -v82, v68
v_mul_f32 v213, -v82, v69
s_add_u32 m0, s39, 11264
s_add_u32 s37, s37, s38
buffer_load_dwordx4 v23, s[8:11], s37 offen sc1 lds
v_mul_f32 v214, -v82, v70
v_mul_f32 v215, -v82, v71
s_add_u32 m0, s39, 12288
s_add_u32 s37, s37, s38
buffer_load_dwordx4 v22, s[8:11], s37 offen sc1 lds
v_mul_f32 v216, -v84, v68
v_mul_f32 v217, -v84, v69
s_add_u32 m0, s39, 13312
s_add_u32 s37, s37, s38
buffer_load_dwordx4 v23, s[8:11], s37 offen sc1 lds
v_mul_f32 v218, -v84, v70
v_mul_f32 v219, -v84, v71
s_add_u32 m0, s39, 14336
s_add_u32 s37, s37, s38
buffer_load_dwordx4 v22, s[8:11], s37 offen sc1 lds
v_mul_f32 v220, -v86, v68
v_mul_f32 v221, -v86, v69
s_add_u32 m0, s39, 15360
s_add_u32 s37, s37, s38
buffer_load_dwordx4 v23, s[8:11], s37 offen sc1 lds
v_mul_f32 v222, -v86, v70
v_mul_f32 v223, -v86, v71
s_load_dword s64, s[80:81], 0
s_load_dword s65, s[80:81], 64
s_load_dword s66, s[80:81], 128
s_load_dword s67, s[80:81], 192
s_load_dword s68, s[80:81], 256
s_load_dword s69, s[80:81], 320
s_load_dword s70, s[80:81], 384
s_add_u32 s80, s80, 448
s_addc_u32 s81, s81, 0
s_waitcnt vmcnt(16)
s_barrier
s_add_u32 s42, s42, 1
s_xor_b32 s37, s42, s35
s_add_u32 m0, s39, 49152
s_mul_i32 s37, s37, s40
buffer_load_dwordx4 v22, s[8:11], s37 offen sc1 lds
s_add_u32 m0, s39, 50176
s_add_u32 s37, s37, s38
buffer_load_dwordx4 v23, s[8:11], s37 offen sc1 lds
s_add_u32 m0, s39, 51200
s_add_u32 s37, s37, s38
buffer_load_dwordx4 v22, s[8:11], s37 offen sc1 lds
s_add_u32 m0, s39, 52224
s_add_u32 s37, s37, s38
buffer_load_dwordx4 v23, s[8:11], s37 offen sc1 lds
s_add_u32 m0, s39, 53248
s_add_u32 s37, s37, s38
buffer_load_dwordx4 v22, s[8:11], s37 offen sc1 lds
s_add_u32 m0, s39, 54272
s_add_u32 s37, s37, s38
buffer_load_dwordx4 v23, s[8:11], s37 offen sc1 lds
s_add_u32 m0, s39, 55296
s_add_u32 s37, s37, s38
buffer_load_dwordx4 v22, s[8:11], s37 offen sc1 lds
s_add_u32 m0, s39, 56320
s_add_u32 s37, s37, s38
buffer_load_dwordx4 v23, s[8:11], s37 offen sc1 lds
s_add_u32 m0, s39, 57344
s_add_u32 s37, s37, s38
buffer_load_dwordx4 v22, s[8:11], s37 offen sc1 lds
s_add_u32 m0, s39, 58368
s_add_u32 s37, s37, s38
buffer_load_dwordx4 v23, s[8:11], s37 offen sc1 lds
s_add_u32 m0, s39, 59392
s_add_u32 s37, s37, s38
buffer_load_dwordx4 v22, s[8:11], s37 offen sc1 lds
s_add_u32 m0, s39, 60416
s_add_u32 s37, s37, s38
buffer_load_dwordx4 v23, s[8:11], s37 offen sc1 lds
s_add_u32 m0, s39, 61440
s_add_u32 s37, s37, s38
buffer_load_dwordx4 v22, s[8:11], s37 offen sc1 lds
s_add_u32 m0, s39, 62464
s_add_u32 s37, s37, s38
buffer_load_dwordx4 v23, s[8:11], s37 offen sc1 lds
s_add_u32 m0, s39, 63488
s_add_u32 s37, s37, s38
buffer_load_dwordx4 v22, s[8:11], s37 offen sc1 lds
s_add_u32 m0, s39, 64512
s_add_u32 s37, s37, s38
buffer_load_dwordx4 v23, s[8:11], s37 offen sc1 lds
s_mul_i32 s44, s34, 917504
s_lshl_b32 s39, s51, 13
s_add_u32 s44, s44, s39
s_add_u32 s44, s44, 8388608
s_and_b32 s43, s51, 1
s_xor_b32 s43, s43, s35
s_lshl_b32 s43, s43, 7
s_mov_b32 s10, 909312
s_movk_i32 s38, 1024
s_movk_i32 s40, 9216
s_movk_i32 s37, 0x4000
s_cmp_ge_u32 s51, 2
s_cselect_b32 s8, s60, s32
s_cselect_b32 s9, s61, s33
s_cselect_b32 s10, 7338112, s10
s_cselect_b32 s43, s43, s44
s_cselect_b32 s38, 16384, s38
s_cselect_b32 s40, 81920, s40
s_cselect_b32 s55, 81920, s38
s_cselect_b32 s37, 262144, s37
s_cselect_b32 s45, -1, 0
s_add_u32 s8, s8, s43
s_addc_u32 s9, s9, 0
s_mov_b32 s11, 0x20000
s_and_b32 s53, s35, 1
s_mul_i32 s54, s53, 6
s_mul_i32 s54, s54, s37
s_mul_i32 s29, s53, 2
s_add_u32 s29, s29, 6
s_mul_i32 s29, s29, s37
s_and_b32 s43, s45, 4290838528
s_add_u32 s29, s29, s43
s_mul_i32 s37, s37, 2
s_sub_u32 s37, s37, s40
v_lshrrev_b32 v19, 3, v1
v_mul_u32_u24 v19, 1920, v19
v_lshrrev_b32 v20, 4, v1
v_lshlrev_b32 v20, 5, v20
v_and_b32 v19, s45, v19
v_and_b32 v20, s45, v20
v_lshlrev_b32 v21, 4, v1
v_xor_b32 v21, v21, v20
v_add_u32 v21, v21, v19
s_waitcnt vmcnt(16)
s_barrier
s_branch LK3b_134
.p2align 6
Lw_43:
s_branch Lr_44
s_nop 0
.p2align 3
L7_133:
s_lshr_b32 s43, s2, 5
s_cmp_eq_u32 s43, 3
s_cbranch_scc1 Lnojob_140
s_cmp_gt_u32 s43, 3
s_cselect_b32 s43, 32, 0
s_sub_u32 s43, s2, s43
s_lshr_b32 s43, s43, 1
s_and_b32 s44, s2, 1
s_cmp_eq_u32 s44, 0
s_cselect_b32 s68, s4, s6
s_cselect_b32 s69, s5, s7
s_mul_i32 s45, s43, 2341
s_lshr_b32 s45, s45, 16
s_mul_i32 s46, s45, 28
s_sub_u32 s46, s43, s46
v_lshrrev_b32 v4, 4, v1
s_lshl_b32 s43, s45, 8
v_add_u32 v4, s43, v4
v_mul_u32_u24 v4, 7168, v4
v_and_b32 v5, 15, v1
v_lshl_add_u32 v4, v5, 4, v4
s_lshl_b32 s43, s46, 8
v_add_u32 v4, s43, v4
s_mov_b32 s64, s68
s_mov_b32 s65, s69
s_mov_b32 s66, 7340032
s_mov_b32 s67, 0x20000
s_lshl_b32 s55, s45, 1
s_add_u32 s55, s55, s44
s_mul_i32 s55, s55, 14336
s_lshl_b32 s45, s46, 9
s_mov_b32 s50, s46
s_add_u32 s55, s55, s45
v_lshl_add_u32 v5, v5, 5, s55
s_add_u32 s72, s32, 27262976
s_addc_u32 s73, s33, 0
s_mov_b32 s74, 114688
s_mov_b32 s75, 0x20000
v_mov_b32 v32, 0
v_mov_b32 v33, 0
v_mov_b32 v34, 0
v_mov_b32 v35, 0
v_mov_b32 v36, 0
v_mov_b32 v37, 0
v_mov_b32 v38, 0
v_mov_b32 v39, 0
s_lshl_b32 s43, s34, 18
s_add_u32 s12, s32, s43
s_addc_u32 s13, s33, 0
s_mov_b32 s14, 262144
s_mov_b32 s15, 0x20000
v_lshlrev_b32 v21, 4, v1
s_lshl_b32 s54, s36, 11
s_xor_b32 s43, s35, 1
s_and_b32 s43, s43, 15
s_lshl_b32 s43, s43, 14
s_add_u32 s30, s43, s54
s_xor_b32 s43, s35, 2
s_and_b32 s43, s43, 15
s_lshl_b32 s43, s43, 14
s_add_u32 s31, s43, s54
s_waitcnt vmcnt(0)
s_barrier
ds_write_b128 v27, v[68:71] offset:0
ds_write_b128 v27, v[116:119] offset:512
s_mov_b32 s43, 917504
buffer_load_dwordx4 v[56:59], v4, s[64:67], s43 offen
s_mov_b32 s43, 946176
buffer_load_dwordx4 v[60:63], v4, s[64:67], s43 offen
s_mov_b32 s43, 974848
buffer_load_dwordx4 v[64:67], v4, s[64:67], s43 offen
s_mov_b32 s43, 1003520
buffer_load_dwordx4 v[72:75], v4, s[64:67], s43 offen
s_mov_b32 s43, 1032192
buffer_load_dwordx4 v[76:79], v4, s[64:67], s43 offen
s_mov_b32 s43, 1060864
buffer_load_dwordx4 v[80:83], v4, s[64:67], s43 offen
s_mov_b32 s43, 1089536
buffer_load_dwordx4 v[84:87], v4, s[64:67], s43 offen
s_mov_b32 s43, 1118208
buffer_load_dwordx4 v[88:91], v4, s[64:67], s43 offen
s_mov_b32 s43, 1146880
buffer_load_dwordx4 v[92:95], v4, s[64:67], s43 offen
s_mov_b32 s43, 1175552
buffer_load_dwordx4 v[96:99], v4, s[64:67], s43 offen
s_mov_b32 s43, 1204224
buffer_load_dwordx4 v[100:103], v4, s[64:67], s43 offen
s_mov_b32 s43, 1232896
buffer_load_dwordx4 v[104:107], v4, s[64:67], s43 offen
s_mov_b32 s43, 1261568
buffer_load_dwordx4 v[108:111], v4, s[64:67], s43 offen
s_mov_b32 s43, 1290240
buffer_load_dwordx4 v[112:115], v4, s[64:67], s43 offen
s_mov_b32 s43, 1318912
buffer_load_dwordx4 v[120:123], v4, s[64:67], s43 offen
s_mov_b32 s43, 1347584
buffer_load_dwordx4 v[124:127], v4, s[64:67], s43 offen
v_lshlrev_b32 v40, 16, v128
v_and_b32 v41, 0xffff0000, v128
v_lshlrev_b32 v42, 16, v129
v_and_b32 v43, 0xffff0000, v129
v_lshlrev_b32 v44, 16, v130
v_and_b32 v45, 0xffff0000, v130
v_lshlrev_b32 v46, 16, v131
v_and_b32 v47, 0xffff0000, v131
v_pk_add_f32 v[32:33], v[32:33], v[40:41]
v_pk_add_f32 v[34:35], v[34:35], v[42:43]
v_pk_add_f32 v[36:37], v[36:37], v[44:45]
v_pk_add_f32 v[38:39], v[38:39], v[46:47]
v_lshlrev_b32 v48, 16, v132
v_and_b32 v49, 0xffff0000, v132
v_lshlrev_b32 v50, 16, v133
v_and_b32 v51, 0xffff0000, v133
v_lshlrev_b32 v52, 16, v134
v_and_b32 v53, 0xffff0000, v134
v_lshlrev_b32 v54, 16, v135
v_and_b32 v55, 0xffff0000, v135
v_pk_add_f32 v[32:33], v[32:33], v[48:49]
v_pk_add_f32 v[34:35], v[34:35], v[50:51]
v_pk_add_f32 v[36:37], v[36:37], v[52:53]
v_pk_add_f32 v[38:39], v[38:39], v[54:55]
v_lshlrev_b32 v40, 16, v136
v_and_b32 v41, 0xffff0000, v136
v_lshlrev_b32 v42, 16, v137
v_and_b32 v43, 0xffff0000, v137
v_lshlrev_b32 v44, 16, v138
v_and_b32 v45, 0xffff0000, v138
v_lshlrev_b32 v46, 16, v139
v_and_b32 v47, 0xffff0000, v139
v_pk_add_f32 v[32:33], v[32:33], v[40:41]
v_pk_add_f32 v[34:35], v[34:35], v[42:43]
v_pk_add_f32 v[36:37], v[36:37], v[44:45]
v_pk_add_f32 v[38:39], v[38:39], v[46:47]
v_lshlrev_b32 v48, 16, v140
v_and_b32 v49, 0xffff0000, v140
v_lshlrev_b32 v50, 16, v141
v_and_b32 v51, 0xffff0000, v141
v_lshlrev_b32 v52, 16, v142
v_and_b32 v53, 0xffff0000, v142
v_lshlrev_b32 v54, 16, v143
v_and_b32 v55, 0xffff0000, v143
v_pk_add_f32 v[32:33], v[32:33], v[48:49]
v_pk_add_f32 v[34:35], v[34:35], v[50:51]
v_pk_add_f32 v[36:37], v[36:37], v[52:53]
v_pk_add_f32 v[38:39], v[38:39], v[54:55]
v_lshlrev_b32 v40, 16, v144
v_and_b32 v41, 0xffff0000, v144
v_lshlrev_b32 v42, 16, v145
v_and_b32 v43, 0xffff0000, v145
v_lshlrev_b32 v44, 16, v146
v_and_b32 v45, 0xffff0000, v146
v_lshlrev_b32 v46, 16, v147
v_and_b32 v47, 0xffff0000, v147
v_pk_add_f32 v[32:33], v[32:33], v[40:41]
v_pk_add_f32 v[34:35], v[34:35], v[42:43]
v_pk_add_f32 v[36:37], v[36:37], v[44:45]
v_pk_add_f32 v[38:39], v[38:39], v[46:47]
v_lshlrev_b32 v48, 16, v148
v_and_b32 v49, 0xffff0000, v148
v_lshlrev_b32 v50, 16, v149
v_and_b32 v51, 0xffff0000, v149
v_lshlrev_b32 v52, 16, v150
v_and_b32 v53, 0xffff0000, v150
v_lshlrev_b32 v54, 16, v151
v_and_b32 v55, 0xffff0000, v151
v_pk_add_f32 v[32:33], v[32:33], v[48:49]
v_pk_add_f32 v[34:35], v[34:35], v[50:51]
v_pk_add_f32 v[36:37], v[36:37], v[52:53]
v_pk_add_f32 v[38:39], v[38:39], v[54:55]
v_lshlrev_b32 v40, 16, v152
v_and_b32 v41, 0xffff0000, v152
v_lshlrev_b32 v42, 16, v153
v_and_b32 v43, 0xffff0000, v153
v_lshlrev_b32 v44, 16, v154
v_and_b32 v45, 0xffff0000, v154
v_lshlrev_b32 v46, 16, v155
v_and_b32 v47, 0xffff0000, v155
v_pk_add_f32 v[32:33], v[32:33], v[40:41]
v_pk_add_f32 v[34:35], v[34:35], v[42:43]
v_pk_add_f32 v[36:37], v[36:37], v[44:45]
v_pk_add_f32 v[38:39], v[38:39], v[46:47]
v_lshlrev_b32 v48, 16, v156
v_and_b32 v49, 0xffff0000, v156
v_lshlrev_b32 v50, 16, v157
v_and_b32 v51, 0xffff0000, v157
v_lshlrev_b32 v52, 16, v158
v_and_b32 v53, 0xffff0000, v158
v_lshlrev_b32 v54, 16, v159
v_and_b32 v55, 0xffff0000, v159
v_pk_add_f32 v[32:33], v[32:33], v[48:49]
v_pk_add_f32 v[34:35], v[34:35], v[50:51]
v_pk_add_f32 v[36:37], v[36:37], v[52:53]
v_pk_add_f32 v[38:39], v[38:39], v[54:55]
s_waitcnt lgkmcnt(0)
s_barrier
s_add_u32 m0, s54, 16384
s_add_u32 s43, s30, 0
buffer_load_dwordx4 v21, s[12:15], s43 offen sc1 lds
s_add_u32 m0, s54, 17408
s_add_u32 s43, s30, 1024
buffer_load_dwordx4 v21, s[12:15], s43 offen sc1 lds
s_add_u32 m0, s54, 32768
s_add_u32 s43, s31, 0
buffer_load_dwordx4 v21, s[12:15], s43 offen sc1 lds
s_add_u32 m0, s54, 33792
s_add_u32 s43, s31, 1024
buffer_load_dwordx4 v21, s[12:15], s43 offen sc1 lds
s_waitcnt vmcnt(2)
s_barrier
s_waitcnt vmcnt(0)
s_barrier
v_lshlrev_b32 v40, 16, v160
v_and_b32 v41, 0xffff0000, v160
v_lshlrev_b32 v42, 16, v161
v_and_b32 v43, 0xffff0000, v161
v_lshlrev_b32 v44, 16, v162
v_and_b32 v45, 0xffff0000, v162
v_lshlrev_b32 v46, 16, v163
v_and_b32 v47, 0xffff0000, v163
v_pk_add_f32 v[32:33], v[32:33], v[40:41]
v_pk_add_f32 v[34:35], v[34:35], v[42:43]
v_pk_add_f32 v[36:37], v[36:37], v[44:45]
v_pk_add_f32 v[38:39], v[38:39], v[46:47]
v_lshlrev_b32 v48, 16, v164
v_and_b32 v49, 0xffff0000, v164
v_lshlrev_b32 v50, 16, v165
v_and_b32 v51, 0xffff0000, v165
v_lshlrev_b32 v52, 16, v166
v_and_b32 v53, 0xffff0000, v166
v_lshlrev_b32 v54, 16, v167
v_and_b32 v55, 0xffff0000, v167
v_pk_add_f32 v[32:33], v[32:33], v[48:49]
v_pk_add_f32 v[34:35], v[34:35], v[50:51]
v_pk_add_f32 v[36:37], v[36:37], v[52:53]
v_pk_add_f32 v[38:39], v[38:39], v[54:55]
v_lshlrev_b32 v40, 16, v168
v_and_b32 v41, 0xffff0000, v168
v_lshlrev_b32 v42, 16, v169
v_and_b32 v43, 0xffff0000, v169
v_lshlrev_b32 v44, 16, v170
v_and_b32 v45, 0xffff0000, v170
v_lshlrev_b32 v46, 16, v171
v_and_b32 v47, 0xffff0000, v171
v_pk_add_f32 v[32:33], v[32:33], v[40:41]
v_pk_add_f32 v[34:35], v[34:35], v[42:43]
v_pk_add_f32 v[36:37], v[36:37], v[44:45]
v_pk_add_f32 v[38:39], v[38:39], v[46:47]
v_lshlrev_b32 v48, 16, v172
v_and_b32 v49, 0xffff0000, v172
v_lshlrev_b32 v50, 16, v173
v_and_b32 v51, 0xffff0000, v173
v_lshlrev_b32 v52, 16, v174
v_and_b32 v53, 0xffff0000, v174
v_lshlrev_b32 v54, 16, v175
v_and_b32 v55, 0xffff0000, v175
v_pk_add_f32 v[32:33], v[32:33], v[48:49]
v_pk_add_f32 v[34:35], v[34:35], v[50:51]
v_pk_add_f32 v[36:37], v[36:37], v[52:53]
v_pk_add_f32 v[38:39], v[38:39], v[54:55]
s_barrier
v_lshlrev_b32 v40, 16, v176
v_and_b32 v41, 0xffff0000, v176
v_lshlrev_b32 v42, 16, v177
v_and_b32 v43, 0xffff0000, v177
v_lshlrev_b32 v44, 16, v178
v_and_b32 v45, 0xffff0000, v178
v_lshlrev_b32 v46, 16, v179
v_and_b32 v47, 0xffff0000, v179
v_pk_add_f32 v[32:33], v[32:33], v[40:41]
v_pk_add_f32 v[34:35], v[34:35], v[42:43]
v_pk_add_f32 v[36:37], v[36:37], v[44:45]
v_pk_add_f32 v[38:39], v[38:39], v[46:47]
v_lshlrev_b32 v48, 16, v180
v_and_b32 v49, 0xffff0000, v180
v_lshlrev_b32 v50, 16, v181
v_and_b32 v51, 0xffff0000, v181
v_lshlrev_b32 v52, 16, v182
v_and_b32 v53, 0xffff0000, v182
v_lshlrev_b32 v54, 16, v183
v_and_b32 v55, 0xffff0000, v183
v_pk_add_f32 v[32:33], v[32:33], v[48:49]
v_pk_add_f32 v[34:35], v[34:35], v[50:51]
v_pk_add_f32 v[36:37], v[36:37], v[52:53]
v_pk_add_f32 v[38:39], v[38:39], v[54:55]
v_lshlrev_b32 v40, 16, v184
v_and_b32 v41, 0xffff0000, v184
v_lshlrev_b32 v42, 16, v185
v_and_b32 v43, 0xffff0000, v185
v_lshlrev_b32 v44, 16, v186
v_and_b32 v45, 0xffff0000, v186
v_lshlrev_b32 v46, 16, v187
v_and_b32 v47, 0xffff0000, v187
v_pk_add_f32 v[32:33], v[32:33], v[40:41]
v_pk_add_f32 v[34:35], v[34:35], v[42:43]
v_pk_add_f32 v[36:37], v[36:37], v[44:45]
v_pk_add_f32 v[38:39], v[38:39], v[46:47]
v_lshlrev_b32 v48, 16, v188
v_and_b32 v49, 0xffff0000, v188
v_lshlrev_b32 v50, 16, v189
v_and_b32 v51, 0xffff0000, v189
v_lshlrev_b32 v52, 16, v190
v_and_b32 v53, 0xffff0000, v190
v_lshlrev_b32 v54, 16, v191
v_and_b32 v55, 0xffff0000, v191
v_pk_add_f32 v[32:33], v[32:33], v[48:49]
v_pk_add_f32 v[34:35], v[34:35], v[50:51]
v_pk_add_f32 v[36:37], v[36:37], v[52:53]
v_pk_add_f32 v[38:39], v[38:39], v[54:55]
s_barrier
s_add_u32 s43, s34, 0
s_lshl_b32 s43, s43, 7
v_mov_b32 v8, s43
v_mov_b32 v10, 16
buffer_load_dword v9, v8, s[56:59], 0 offen sc1
v_lshlrev_b32 v40, 16, v192
v_and_b32 v41, 0xffff0000, v192
v_lshlrev_b32 v42, 16, v193
v_and_b32 v43, 0xffff0000, v193
v_lshlrev_b32 v44, 16, v194
v_and_b32 v45, 0xffff0000, v194
v_lshlrev_b32 v46, 16, v195
v_and_b32 v47, 0xffff0000, v195
v_pk_add_f32 v[32:33], v[32:33], v[40:41]
v_pk_add_f32 v[34:35], v[34:35], v[42:43]
v_pk_add_f32 v[36:37], v[36:37], v[44:45]
v_pk_add_f32 v[38:39], v[38:39], v[46:47]
v_lshlrev_b32 v48, 16, v196
v_and_b32 v49, 0xffff0000, v196
v_lshlrev_b32 v50, 16, v197
v_and_b32 v51, 0xffff0000, v197
v_lshlrev_b32 v52, 16, v198
v_and_b32 v53, 0xffff0000, v198
v_lshlrev_b32 v54, 16, v199
v_and_b32 v55, 0xffff0000, v199
v_pk_add_f32 v[32:33], v[32:33], v[48:49]
v_pk_add_f32 v[34:35], v[34:35], v[50:51]
v_pk_add_f32 v[36:37], v[36:37], v[52:53]
v_pk_add_f32 v[38:39], v[38:39], v[54:55]
v_lshlrev_b32 v40, 16, v200
v_and_b32 v41, 0xffff0000, v200
v_lshlrev_b32 v42, 16, v201
v_and_b32 v43, 0xffff0000, v201
v_lshlrev_b32 v44, 16, v202
v_and_b32 v45, 0xffff0000, v202
v_lshlrev_b32 v46, 16, v203
v_and_b32 v47, 0xffff0000, v203
v_pk_add_f32 v[32:33], v[32:33], v[40:41]
v_pk_add_f32 v[34:35], v[34:35], v[42:43]
v_pk_add_f32 v[36:37], v[36:37], v[44:45]
v_pk_add_f32 v[38:39], v[38:39], v[46:47]
v_lshlrev_b32 v48, 16, v204
v_and_b32 v49, 0xffff0000, v204
v_lshlrev_b32 v50, 16, v205
v_and_b32 v51, 0xffff0000, v205
v_lshlrev_b32 v52, 16, v206
v_and_b32 v53, 0xffff0000, v206
v_lshlrev_b32 v54, 16, v207
v_and_b32 v55, 0xffff0000, v207
v_pk_add_f32 v[32:33], v[32:33], v[48:49]
v_pk_add_f32 v[34:35], v[34:35], v[50:51]
v_pk_add_f32 v[36:37], v[36:37], v[52:53]
v_pk_add_f32 v[38:39], v[38:39], v[54:55]
s_barrier
v_lshlrev_b32 v40, 16, v208
v_and_b32 v41, 0xffff0000, v208
v_lshlrev_b32 v42, 16, v209
v_and_b32 v43, 0xffff0000, v209
v_lshlrev_b32 v44, 16, v210
v_and_b32 v45, 0xffff0000, v210
v_lshlrev_b32 v46, 16, v211
v_and_b32 v47, 0xffff0000, v211
v_pk_add_f32 v[32:33], v[32:33], v[40:41]
v_pk_add_f32 v[34:35], v[34:35], v[42:43]
v_pk_add_f32 v[36:37], v[36:37], v[44:45]
v_pk_add_f32 v[38:39], v[38:39], v[46:47]
v_lshlrev_b32 v48, 16, v212
v_and_b32 v49, 0xffff0000, v212
v_lshlrev_b32 v50, 16, v213
v_and_b32 v51, 0xffff0000, v213
v_lshlrev_b32 v52, 16, v214
v_and_b32 v53, 0xffff0000, v214
v_lshlrev_b32 v54, 16, v215
v_and_b32 v55, 0xffff0000, v215
v_pk_add_f32 v[32:33], v[32:33], v[48:49]
v_pk_add_f32 v[34:35], v[34:35], v[50:51]
v_pk_add_f32 v[36:37], v[36:37], v[52:53]
v_pk_add_f32 v[38:39], v[38:39], v[54:55]
v_lshlrev_b32 v40, 16, v216
v_and_b32 v41, 0xffff0000, v216
v_lshlrev_b32 v42, 16, v217
v_and_b32 v43, 0xffff0000, v217
v_lshlrev_b32 v44, 16, v218
v_and_b32 v45, 0xffff0000, v218
v_lshlrev_b32 v46, 16, v219
v_and_b32 v47, 0xffff0000, v219
v_pk_add_f32 v[32:33], v[32:33], v[40:41]
v_pk_add_f32 v[34:35], v[34:35], v[42:43]
v_pk_add_f32 v[36:37], v[36:37], v[44:45]
v_pk_add_f32 v[38:39], v[38:39], v[46:47]
v_lshlrev_b32 v48, 16, v220
v_and_b32 v49, 0xffff0000, v220
v_lshlrev_b32 v50, 16, v221
v_and_b32 v51, 0xffff0000, v221
v_lshlrev_b32 v52, 16, v222
v_and_b32 v53, 0xffff0000, v222
v_lshlrev_b32 v54, 16, v223
v_and_b32 v55, 0xffff0000, v223
v_pk_add_f32 v[32:33], v[32:33], v[48:49]
v_pk_add_f32 v[34:35], v[34:35], v[50:51]
v_pk_add_f32 v[36:37], v[36:37], v[52:53]
v_pk_add_f32 v[38:39], v[38:39], v[54:55]
s_barrier
v_lshlrev_b32 v40, 16, v224
v_and_b32 v41, 0xffff0000, v224
v_lshlrev_b32 v42, 16, v225
v_and_b32 v43, 0xffff0000, v225
v_lshlrev_b32 v44, 16, v226
v_and_b32 v45, 0xffff0000, v226
v_lshlrev_b32 v46, 16, v227
v_and_b32 v47, 0xffff0000, v227
v_pk_add_f32 v[32:33], v[32:33], v[40:41]
v_pk_add_f32 v[34:35], v[34:35], v[42:43]
v_pk_add_f32 v[36:37], v[36:37], v[44:45]
v_pk_add_f32 v[38:39], v[38:39], v[46:47]
v_lshlrev_b32 v48, 16, v228
v_and_b32 v49, 0xffff0000, v228
v_lshlrev_b32 v50, 16, v229
v_and_b32 v51, 0xffff0000, v229
v_lshlrev_b32 v52, 16, v230
v_and_b32 v53, 0xffff0000, v230
v_lshlrev_b32 v54, 16, v231
v_and_b32 v55, 0xffff0000, v231
v_pk_add_f32 v[32:33], v[32:33], v[48:49]
v_pk_add_f32 v[34:35], v[34:35], v[50:51]
v_pk_add_f32 v[36:37], v[36:37], v[52:53]
v_pk_add_f32 v[38:39], v[38:39], v[54:55]
v_lshlrev_b32 v40, 16, v232
v_and_b32 v41, 0xffff0000, v232
v_lshlrev_b32 v42, 16, v233
v_and_b32 v43, 0xffff0000, v233
v_lshlrev_b32 v44, 16, v234
v_and_b32 v45, 0xffff0000, v234
v_lshlrev_b32 v46, 16, v235
v_and_b32 v47, 0xffff0000, v235
v_pk_add_f32 v[32:33], v[32:33], v[40:41]
v_pk_add_f32 v[34:35], v[34:35], v[42:43]
v_pk_add_f32 v[36:37], v[36:37], v[44:45]
v_pk_add_f32 v[38:39], v[38:39], v[46:47]
v_lshlrev_b32 v48, 16, v236
v_and_b32 v49, 0xffff0000, v236
v_lshlrev_b32 v50, 16, v237
v_and_b32 v51, 0xffff0000, v237
v_lshlrev_b32 v52, 16, v238
v_and_b32 v53, 0xffff0000, v238
v_lshlrev_b32 v54, 16, v239
v_and_b32 v55, 0xffff0000, v239
v_pk_add_f32 v[32:33], v[32:33], v[48:49]
v_pk_add_f32 v[34:35], v[34:35], v[50:51]
v_pk_add_f32 v[36:37], v[36:37], v[52:53]
v_pk_add_f32 v[38:39], v[38:39], v[54:55]
s_barrier
s_mov_b32 s41, 0x10000
Lpoll_142:
s_waitcnt vmcnt(0)
Lpf_144:
v_cmp_ne_u32 vcc, v10, v9
s_nop 4
s_cbranch_vccz Lpok_143
buffer_load_dword v9, v8, s[56:59], 0 offen sc1
s_sub_u32 s41, s41, 1
s_cmp_lg_u32 s41, 0
s_cbranch_scc1 Lpoll_142
s_waitcnt vmcnt(0)
Lpok_143:
v_lshlrev_b32 v40, 16, v240
v_and_b32 v41, 0xffff0000, v240
v_lshlrev_b32 v42, 16, v241
v_and_b32 v43, 0xffff0000, v241
v_lshlrev_b32 v44, 16, v242
v_and_b32 v45, 0xffff0000, v242
v_lshlrev_b32 v46, 16, v243
v_and_b32 v47, 0xffff0000, v243
v_pk_add_f32 v[32:33], v[32:33], v[40:41]
v_pk_add_f32 v[34:35], v[34:35], v[42:43]
v_pk_add_f32 v[36:37], v[36:37], v[44:45]
v_pk_add_f32 v[38:39], v[38:39], v[46:47]
v_lshlrev_b32 v48, 16, v244
v_and_b32 v49, 0xffff0000, v244
v_lshlrev_b32 v50, 16, v245
v_and_b32 v51, 0xffff0000, v245
v_lshlrev_b32 v52, 16, v246
v_and_b32 v53, 0xffff0000, v246
v_lshlrev_b32 v54, 16, v247
v_and_b32 v55, 0xffff0000, v247
v_pk_add_f32 v[32:33], v[32:33], v[48:49]
v_pk_add_f32 v[34:35], v[34:35], v[50:51]
v_pk_add_f32 v[36:37], v[36:37], v[52:53]
v_pk_add_f32 v[38:39], v[38:39], v[54:55]
v_lshlrev_b32 v40, 16, v248
v_and_b32 v41, 0xffff0000, v248
v_lshlrev_b32 v42, 16, v249
v_and_b32 v43, 0xffff0000, v249
v_lshlrev_b32 v44, 16, v250
v_and_b32 v45, 0xffff0000, v250
v_lshlrev_b32 v46, 16, v251
v_and_b32 v47, 0xffff0000, v251
v_pk_add_f32 v[32:33], v[32:33], v[40:41]
v_pk_add_f32 v[34:35], v[34:35], v[42:43]
v_pk_add_f32 v[36:37], v[36:37], v[44:45]
v_pk_add_f32 v[38:39], v[38:39], v[46:47]
v_lshlrev_b32 v48, 16, v252
v_and_b32 v49, 0xffff0000, v252
v_lshlrev_b32 v50, 16, v253
v_and_b32 v51, 0xffff0000, v253
v_lshlrev_b32 v52, 16, v254
v_and_b32 v53, 0xffff0000, v254
v_lshlrev_b32 v54, 16, v255
v_and_b32 v55, 0xffff0000, v255
v_pk_add_f32 v[32:33], v[32:33], v[48:49]
v_pk_add_f32 v[34:35], v[34:35], v[50:51]
v_pk_add_f32 v[36:37], v[36:37], v[52:53]
v_pk_add_f32 v[38:39], v[38:39], v[54:55]
s_barrier
s_mov_b32 s43, 1376256
buffer_load_dwordx4 v[128:131], v4, s[64:67], s43 offen
s_mov_b32 s43, 1404928
buffer_load_dwordx4 v[132:135], v4, s[64:67], s43 offen
s_mov_b32 s43, 1433600
buffer_load_dwordx4 v[136:139], v4, s[64:67], s43 offen
s_mov_b32 s43, 1462272
buffer_load_dwordx4 v[140:143], v4, s[64:67], s43 offen
s_mov_b32 s43, 1490944
buffer_load_dwordx4 v[144:147], v4, s[64:67], s43 offen
s_mov_b32 s43, 1519616
buffer_load_dwordx4 v[148:151], v4, s[64:67], s43 offen
s_mov_b32 s43, 1548288
buffer_load_dwordx4 v[152:155], v4, s[64:67], s43 offen
s_mov_b32 s43, 1576960
buffer_load_dwordx4 v[156:159], v4, s[64:67], s43 offen
s_mov_b32 s43, 1605632
buffer_load_dwordx4 v[160:163], v4, s[64:67], s43 offen
s_mov_b32 s43, 1634304
buffer_load_dwordx4 v[164:167], v4, s[64:67], s43 offen
s_mov_b32 s43, 1662976
buffer_load_dwordx4 v[168:171], v4, s[64:67], s43 offen
s_mov_b32 s43, 1691648
buffer_load_dwordx4 v[172:175], v4, s[64:67], s43 offen
s_mov_b32 s43, 1720320
buffer_load_dwordx4 v[176:179], v4, s[64:67], s43 offen
s_mov_b32 s43, 1748992
buffer_load_dwordx4 v[180:183], v4, s[64:67], s43 offen
s_mov_b32 s43, 1777664
buffer_load_dwordx4 v[184:187], v4, s[64:67], s43 offen
s_mov_b32 s43, 1806336
buffer_load_dwordx4 v[188:191], v4, s[64:67], s43 offen
s_barrier
v_lshlrev_b32 v40, 16, v56
v_and_b32 v41, 0xffff0000, v56
v_lshlrev_b32 v42, 16, v57
v_and_b32 v43, 0xffff0000, v57
v_lshlrev_b32 v44, 16, v58
v_and_b32 v45, 0xffff0000, v58
v_lshlrev_b32 v46, 16, v59
v_and_b32 v47, 0xffff0000, v59
v_pk_add_f32 v[32:33], v[32:33], v[40:41]
v_pk_add_f32 v[34:35], v[34:35], v[42:43]
v_pk_add_f32 v[36:37], v[36:37], v[44:45]
v_pk_add_f32 v[38:39], v[38:39], v[46:47]
v_lshlrev_b32 v48, 16, v60
v_and_b32 v49, 0xffff0000, v60
v_lshlrev_b32 v50, 16, v61
v_and_b32 v51, 0xffff0000, v61
v_lshlrev_b32 v52, 16, v62
v_and_b32 v53, 0xffff0000, v62
v_lshlrev_b32 v54, 16, v63
v_and_b32 v55, 0xffff0000, v63
v_pk_add_f32 v[32:33], v[32:33], v[48:49]
v_pk_add_f32 v[34:35], v[34:35], v[50:51]
v_pk_add_f32 v[36:37], v[36:37], v[52:53]
v_pk_add_f32 v[38:39], v[38:39], v[54:55]
v_lshlrev_b32 v40, 16, v64
v_and_b32 v41, 0xffff0000, v64
v_lshlrev_b32 v42, 16, v65
v_and_b32 v43, 0xffff0000, v65
v_lshlrev_b32 v44, 16, v66
v_and_b32 v45, 0xffff0000, v66
v_lshlrev_b32 v46, 16, v67
v_and_b32 v47, 0xffff0000, v67
v_pk_add_f32 v[32:33], v[32:33], v[40:41]
v_pk_add_f32 v[34:35], v[34:35], v[42:43]
v_pk_add_f32 v[36:37], v[36:37], v[44:45]
v_pk_add_f32 v[38:39], v[38:39], v[46:47]
v_lshlrev_b32 v48, 16, v72
v_and_b32 v49, 0xffff0000, v72
v_lshlrev_b32 v50, 16, v73
v_and_b32 v51, 0xffff0000, v73
v_lshlrev_b32 v52, 16, v74
v_and_b32 v53, 0xffff0000, v74
v_lshlrev_b32 v54, 16, v75
v_and_b32 v55, 0xffff0000, v75
v_pk_add_f32 v[32:33], v[32:33], v[48:49]
v_pk_add_f32 v[34:35], v[34:35], v[50:51]
v_pk_add_f32 v[36:37], v[36:37], v[52:53]
v_pk_add_f32 v[38:39], v[38:39], v[54:55]
s_barrier
v_lshlrev_b32 v40, 16, v76
v_and_b32 v41, 0xffff0000, v76
v_lshlrev_b32 v42, 16, v77
v_and_b32 v43, 0xffff0000, v77
v_lshlrev_b32 v44, 16, v78
v_and_b32 v45, 0xffff0000, v78
v_lshlrev_b32 v46, 16, v79
v_and_b32 v47, 0xffff0000, v79
v_pk_add_f32 v[32:33], v[32:33], v[40:41]
v_pk_add_f32 v[34:35], v[34:35], v[42:43]
v_pk_add_f32 v[36:37], v[36:37], v[44:45]
v_pk_add_f32 v[38:39], v[38:39], v[46:47]
v_lshlrev_b32 v48, 16, v80
v_and_b32 v49, 0xffff0000, v80
v_lshlrev_b32 v50, 16, v81
v_and_b32 v51, 0xffff0000, v81
v_lshlrev_b32 v52, 16, v82
v_and_b32 v53, 0xffff0000, v82
v_lshlrev_b32 v54, 16, v83
v_and_b32 v55, 0xffff0000, v83
v_pk_add_f32 v[32:33], v[32:33], v[48:49]
v_pk_add_f32 v[34:35], v[34:35], v[50:51]
v_pk_add_f32 v[36:37], v[36:37], v[52:53]
v_pk_add_f32 v[38:39], v[38:39], v[54:55]
v_lshlrev_b32 v40, 16, v84
v_and_b32 v41, 0xffff0000, v84
v_lshlrev_b32 v42, 16, v85
v_and_b32 v43, 0xffff0000, v85
v_lshlrev_b32 v44, 16, v86
v_and_b32 v45, 0xffff0000, v86
v_lshlrev_b32 v46, 16, v87
v_and_b32 v47, 0xffff0000, v87
v_pk_add_f32 v[32:33], v[32:33], v[40:41]
v_pk_add_f32 v[34:35], v[34:35], v[42:43]
v_pk_add_f32 v[36:37], v[36:37], v[44:45]
v_pk_add_f32 v[38:39], v[38:39], v[46:47]
v_lshlrev_b32 v48, 16, v88
v_and_b32 v49, 0xffff0000, v88
v_lshlrev_b32 v50, 16, v89
v_and_b32 v51, 0xffff0000, v89
v_lshlrev_b32 v52, 16, v90
v_and_b32 v53, 0xffff0000, v90
v_lshlrev_b32 v54, 16, v91
v_and_b32 v55, 0xffff0000, v91
v_pk_add_f32 v[32:33], v[32:33], v[48:49]
v_pk_add_f32 v[34:35], v[34:35], v[50:51]
v_pk_add_f32 v[36:37], v[36:37], v[52:53]
v_pk_add_f32 v[38:39], v[38:39], v[54:55]
s_barrier
v_lshlrev_b32 v40, 16, v92
v_and_b32 v41, 0xffff0000, v92
v_lshlrev_b32 v42, 16, v93
v_and_b32 v43, 0xffff0000, v93
v_lshlrev_b32 v44, 16, v94
v_and_b32 v45, 0xffff0000, v94
v_lshlrev_b32 v46, 16, v95
v_and_b32 v47, 0xffff0000, v95
v_pk_add_f32 v[32:33], v[32:33], v[40:41]
v_pk_add_f32 v[34:35], v[34:35], v[42:43]
v_pk_add_f32 v[36:37], v[36:37], v[44:45]
v_pk_add_f32 v[38:39], v[38:39], v[46:47]
v_lshlrev_b32 v48, 16, v96
v_and_b32 v49, 0xffff0000, v96
v_lshlrev_b32 v50, 16, v97
v_and_b32 v51, 0xffff0000, v97
v_lshlrev_b32 v52, 16, v98
v_and_b32 v53, 0xffff0000, v98
v_lshlrev_b32 v54, 16, v99
v_and_b32 v55, 0xffff0000, v99
v_pk_add_f32 v[32:33], v[32:33], v[48:49]
v_pk_add_f32 v[34:35], v[34:35], v[50:51]
v_pk_add_f32 v[36:37], v[36:37], v[52:53]
v_pk_add_f32 v[38:39], v[38:39], v[54:55]
v_lshlrev_b32 v40, 16, v100
v_and_b32 v41, 0xffff0000, v100
v_lshlrev_b32 v42, 16, v101
v_and_b32 v43, 0xffff0000, v101
v_lshlrev_b32 v44, 16, v102
v_and_b32 v45, 0xffff0000, v102
v_lshlrev_b32 v46, 16, v103
v_and_b32 v47, 0xffff0000, v103
v_pk_add_f32 v[32:33], v[32:33], v[40:41]
v_pk_add_f32 v[34:35], v[34:35], v[42:43]
v_pk_add_f32 v[36:37], v[36:37], v[44:45]
v_pk_add_f32 v[38:39], v[38:39], v[46:47]
v_lshlrev_b32 v48, 16, v104
v_and_b32 v49, 0xffff0000, v104
v_lshlrev_b32 v50, 16, v105
v_and_b32 v51, 0xffff0000, v105
v_lshlrev_b32 v52, 16, v106
v_and_b32 v53, 0xffff0000, v106
v_lshlrev_b32 v54, 16, v107
v_and_b32 v55, 0xffff0000, v107
v_pk_add_f32 v[32:33], v[32:33], v[48:49]
v_pk_add_f32 v[34:35], v[34:35], v[50:51]
v_pk_add_f32 v[36:37], v[36:37], v[52:53]
v_pk_add_f32 v[38:39], v[38:39], v[54:55]
s_barrier
v_lshlrev_b32 v40, 16, v108
v_and_b32 v41, 0xffff0000, v108
v_lshlrev_b32 v42, 16, v109
v_and_b32 v43, 0xffff0000, v109
v_lshlrev_b32 v44, 16, v110
v_and_b32 v45, 0xffff0000, v110
v_lshlrev_b32 v46, 16, v111
v_and_b32 v47, 0xffff0000, v111
v_pk_add_f32 v[32:33], v[32:33], v[40:41]
v_pk_add_f32 v[34:35], v[34:35], v[42:43]
v_pk_add_f32 v[36:37], v[36:37], v[44:45]
v_pk_add_f32 v[38:39], v[38:39], v[46:47]
v_lshlrev_b32 v48, 16, v112
v_and_b32 v49, 0xffff0000, v112
v_lshlrev_b32 v50, 16, v113
v_and_b32 v51, 0xffff0000, v113
v_lshlrev_b32 v52, 16, v114
v_and_b32 v53, 0xffff0000, v114
v_lshlrev_b32 v54, 16, v115
v_and_b32 v55, 0xffff0000, v115
v_pk_add_f32 v[32:33], v[32:33], v[48:49]
v_pk_add_f32 v[34:35], v[34:35], v[50:51]
v_pk_add_f32 v[36:37], v[36:37], v[52:53]
v_pk_add_f32 v[38:39], v[38:39], v[54:55]
v_lshlrev_b32 v40, 16, v120
v_and_b32 v41, 0xffff0000, v120
v_lshlrev_b32 v42, 16, v121
v_and_b32 v43, 0xffff0000, v121
v_lshlrev_b32 v44, 16, v122
v_and_b32 v45, 0xffff0000, v122
v_lshlrev_b32 v46, 16, v123
v_and_b32 v47, 0xffff0000, v123
v_pk_add_f32 v[32:33], v[32:33], v[40:41]
v_pk_add_f32 v[34:35], v[34:35], v[42:43]
v_pk_add_f32 v[36:37], v[36:37], v[44:45]
v_pk_add_f32 v[38:39], v[38:39], v[46:47]
v_lshlrev_b32 v48, 16, v124
v_and_b32 v49, 0xffff0000, v124
v_lshlrev_b32 v50, 16, v125
v_and_b32 v51, 0xffff0000, v125
v_lshlrev_b32 v52, 16, v126
v_and_b32 v53, 0xffff0000, v126
v_lshlrev_b32 v54, 16, v127
v_and_b32 v55, 0xffff0000, v127
v_pk_add_f32 v[32:33], v[32:33], v[48:49]
v_pk_add_f32 v[34:35], v[34:35], v[50:51]
v_pk_add_f32 v[36:37], v[36:37], v[52:53]
v_pk_add_f32 v[38:39], v[38:39], v[54:55]
s_barrier
s_waitcnt vmcnt(0)
v_lshlrev_b32 v40, 16, v128
v_and_b32 v41, 0xffff0000, v128
v_lshlrev_b32 v42, 16, v129
v_and_b32 v43, 0xffff0000, v129
v_lshlrev_b32 v44, 16, v130
v_and_b32 v45, 0xffff0000, v130
v_lshlrev_b32 v46, 16, v131
v_and_b32 v47, 0xffff0000, v131
v_pk_add_f32 v[32:33], v[32:33], v[40:41]
v_pk_add_f32 v[34:35], v[34:35], v[42:43]
v_pk_add_f32 v[36:37], v[36:37], v[44:45]
v_pk_add_f32 v[38:39], v[38:39], v[46:47]
v_lshlrev_b32 v48, 16, v132
v_and_b32 v49, 0xffff0000, v132
v_lshlrev_b32 v50, 16, v133
v_and_b32 v51, 0xffff0000, v133
v_lshlrev_b32 v52, 16, v134
v_and_b32 v53, 0xffff0000, v134
v_lshlrev_b32 v54, 16, v135
v_and_b32 v55, 0xffff0000, v135
v_pk_add_f32 v[32:33], v[32:33], v[48:49]
v_pk_add_f32 v[34:35], v[34:35], v[50:51]
v_pk_add_f32 v[36:37], v[36:37], v[52:53]
v_pk_add_f32 v[38:39], v[38:39], v[54:55]
v_lshlrev_b32 v40, 16, v136
v_and_b32 v41, 0xffff0000, v136
v_lshlrev_b32 v42, 16, v137
v_and_b32 v43, 0xffff0000, v137
v_lshlrev_b32 v44, 16, v138
v_and_b32 v45, 0xffff0000, v138
v_lshlrev_b32 v46, 16, v139
v_and_b32 v47, 0xffff0000, v139
v_pk_add_f32 v[32:33], v[32:33], v[40:41]
v_pk_add_f32 v[34:35], v[34:35], v[42:43]
v_pk_add_f32 v[36:37], v[36:37], v[44:45]
v_pk_add_f32 v[38:39], v[38:39], v[46:47]
v_lshlrev_b32 v48, 16, v140
v_and_b32 v49, 0xffff0000, v140
v_lshlrev_b32 v50, 16, v141
v_and_b32 v51, 0xffff0000, v141
v_lshlrev_b32 v52, 16, v142
v_and_b32 v53, 0xffff0000, v142
v_lshlrev_b32 v54, 16, v143
v_and_b32 v55, 0xffff0000, v143
v_pk_add_f32 v[32:33], v[32:33], v[48:49]
v_pk_add_f32 v[34:35], v[34:35], v[50:51]
v_pk_add_f32 v[36:37], v[36:37], v[52:53]
v_pk_add_f32 v[38:39], v[38:39], v[54:55]
s_barrier
v_lshlrev_b32 v40, 16, v144
v_and_b32 v41, 0xffff0000, v144
v_lshlrev_b32 v42, 16, v145
v_and_b32 v43, 0xffff0000, v145
v_lshlrev_b32 v44, 16, v146
v_and_b32 v45, 0xffff0000, v146
v_lshlrev_b32 v46, 16, v147
v_and_b32 v47, 0xffff0000, v147
v_pk_add_f32 v[32:33], v[32:33], v[40:41]
v_pk_add_f32 v[34:35], v[34:35], v[42:43]
v_pk_add_f32 v[36:37], v[36:37], v[44:45]
v_pk_add_f32 v[38:39], v[38:39], v[46:47]
v_lshlrev_b32 v48, 16, v148
v_and_b32 v49, 0xffff0000, v148
v_lshlrev_b32 v50, 16, v149
v_and_b32 v51, 0xffff0000, v149
v_lshlrev_b32 v52, 16, v150
v_and_b32 v53, 0xffff0000, v150
v_lshlrev_b32 v54, 16, v151
v_and_b32 v55, 0xffff0000, v151
v_pk_add_f32 v[32:33], v[32:33], v[48:49]
v_pk_add_f32 v[34:35], v[34:35], v[50:51]
v_pk_add_f32 v[36:37], v[36:37], v[52:53]
v_pk_add_f32 v[38:39], v[38:39], v[54:55]
v_lshlrev_b32 v40, 16, v152
v_and_b32 v41, 0xffff0000, v152
v_lshlrev_b32 v42, 16, v153
v_and_b32 v43, 0xffff0000, v153
v_lshlrev_b32 v44, 16, v154
v_and_b32 v45, 0xffff0000, v154
v_lshlrev_b32 v46, 16, v155
v_and_b32 v47, 0xffff0000, v155
v_pk_add_f32 v[32:33], v[32:33], v[40:41]
v_pk_add_f32 v[34:35], v[34:35], v[42:43]
v_pk_add_f32 v[36:37], v[36:37], v[44:45]
v_pk_add_f32 v[38:39], v[38:39], v[46:47]
v_lshlrev_b32 v48, 16, v156
v_and_b32 v49, 0xffff0000, v156
v_lshlrev_b32 v50, 16, v157
v_and_b32 v51, 0xffff0000, v157
v_lshlrev_b32 v52, 16, v158
v_and_b32 v53, 0xffff0000, v158
v_lshlrev_b32 v54, 16, v159
v_and_b32 v55, 0xffff0000, v159
v_pk_add_f32 v[32:33], v[32:33], v[48:49]
v_pk_add_f32 v[34:35], v[34:35], v[50:51]
v_pk_add_f32 v[36:37], v[36:37], v[52:53]
v_pk_add_f32 v[38:39], v[38:39], v[54:55]
s_barrier
v_lshlrev_b32 v40, 16, v160
v_and_b32 v41, 0xffff0000, v160
v_lshlrev_b32 v42, 16, v161
v_and_b32 v43, 0xffff0000, v161
v_lshlrev_b32 v44, 16, v162
v_and_b32 v45, 0xffff0000, v162
v_lshlrev_b32 v46, 16, v163
v_and_b32 v47, 0xffff0000, v163
v_pk_add_f32 v[32:33], v[32:33], v[40:41]
v_pk_add_f32 v[34:35], v[34:35], v[42:43]
v_pk_add_f32 v[36:37], v[36:37], v[44:45]
v_pk_add_f32 v[38:39], v[38:39], v[46:47]
v_lshlrev_b32 v48, 16, v164
v_and_b32 v49, 0xffff0000, v164
v_lshlrev_b32 v50, 16, v165
v_and_b32 v51, 0xffff0000, v165
v_lshlrev_b32 v52, 16, v166
v_and_b32 v53, 0xffff0000, v166
v_lshlrev_b32 v54, 16, v167
v_and_b32 v55, 0xffff0000, v167
v_pk_add_f32 v[32:33], v[32:33], v[48:49]
v_pk_add_f32 v[34:35], v[34:35], v[50:51]
v_pk_add_f32 v[36:37], v[36:37], v[52:53]
v_pk_add_f32 v[38:39], v[38:39], v[54:55]
v_lshlrev_b32 v40, 16, v168
v_and_b32 v41, 0xffff0000, v168
v_lshlrev_b32 v42, 16, v169
v_and_b32 v43, 0xffff0000, v169
v_lshlrev_b32 v44, 16, v170
v_and_b32 v45, 0xffff0000, v170
v_lshlrev_b32 v46, 16, v171
v_and_b32 v47, 0xffff0000, v171
v_pk_add_f32 v[32:33], v[32:33], v[40:41]
v_pk_add_f32 v[34:35], v[34:35], v[42:43]
v_pk_add_f32 v[36:37], v[36:37], v[44:45]
v_pk_add_f32 v[38:39], v[38:39], v[46:47]
v_lshlrev_b32 v48, 16, v172
v_and_b32 v49, 0xffff0000, v172
v_lshlrev_b32 v50, 16, v173
v_and_b32 v51, 0xffff0000, v173
v_lshlrev_b32 v52, 16, v174
v_and_b32 v53, 0xffff0000, v174
v_lshlrev_b32 v54, 16, v175
v_and_b32 v55, 0xffff0000, v175
v_pk_add_f32 v[32:33], v[32:33], v[48:49]
v_pk_add_f32 v[34:35], v[34:35], v[50:51]
v_pk_add_f32 v[36:37], v[36:37], v[52:53]
v_pk_add_f32 v[38:39], v[38:39], v[54:55]
s_barrier
v_lshlrev_b32 v40, 16, v176
v_and_b32 v41, 0xffff0000, v176
v_lshlrev_b32 v42, 16, v177
v_and_b32 v43, 0xffff0000, v177
v_lshlrev_b32 v44, 16, v178
v_and_b32 v45, 0xffff0000, v178
v_lshlrev_b32 v46, 16, v179
v_and_b32 v47, 0xffff0000, v179
v_pk_add_f32 v[32:33], v[32:33], v[40:41]
v_pk_add_f32 v[34:35], v[34:35], v[42:43]
v_pk_add_f32 v[36:37], v[36:37], v[44:45]
v_pk_add_f32 v[38:39], v[38:39], v[46:47]
v_lshlrev_b32 v48, 16, v180
v_and_b32 v49, 0xffff0000, v180
v_lshlrev_b32 v50, 16, v181
v_and_b32 v51, 0xffff0000, v181
v_lshlrev_b32 v52, 16, v182
v_and_b32 v53, 0xffff0000, v182
v_lshlrev_b32 v54, 16, v183
v_and_b32 v55, 0xffff0000, v183
v_pk_add_f32 v[32:33], v[32:33], v[48:49]
v_pk_add_f32 v[34:35], v[34:35], v[50:51]
v_pk_add_f32 v[36:37], v[36:37], v[52:53]
v_pk_add_f32 v[38:39], v[38:39], v[54:55]
v_lshlrev_b32 v40, 16, v184
v_and_b32 v41, 0xffff0000, v184
v_lshlrev_b32 v42, 16, v185
v_and_b32 v43, 0xffff0000, v185
v_lshlrev_b32 v44, 16, v186
v_and_b32 v45, 0xffff0000, v186
v_lshlrev_b32 v46, 16, v187
v_and_b32 v47, 0xffff0000, v187
v_pk_add_f32 v[32:33], v[32:33], v[40:41]
v_pk_add_f32 v[34:35], v[34:35], v[42:43]
v_pk_add_f32 v[36:37], v[36:37], v[44:45]
v_pk_add_f32 v[38:39], v[38:39], v[46:47]
v_lshlrev_b32 v48, 16, v188
v_and_b32 v49, 0xffff0000, v188
v_lshlrev_b32 v50, 16, v189
v_and_b32 v51, 0xffff0000, v189
v_lshlrev_b32 v52, 16, v190
v_and_b32 v53, 0xffff0000, v190
v_lshlrev_b32 v54, 16, v191
v_and_b32 v55, 0xffff0000, v191
v_pk_add_f32 v[32:33], v[32:33], v[48:49]
v_pk_add_f32 v[34:35], v[34:35], v[50:51]
v_pk_add_f32 v[36:37], v[36:37], v[52:53]
v_pk_add_f32 v[38:39], v[38:39], v[54:55]
s_barrier
s_nop 2
v_mov_b32 v40, v32
v_mov_b32 v41, v33
v_mov_b32 v42, v34
v_mov_b32 v43, v35
v_mov_b32 v44, v36
v_mov_b32 v45, v37
v_mov_b32 v46, v38
v_mov_b32 v47, v39
s_nop 0
v_permlane16_swap_b32 v32, v40
v_permlane16_swap_b32 v33, v41
v_permlane16_swap_b32 v34, v42
v_permlane16_swap_b32 v35, v43
v_permlane16_swap_b32 v36, v44
v_permlane16_swap_b32 v37, v45
v_permlane16_swap_b32 v38, v46
v_permlane16_swap_b32 v39, v47
v_add_f32 v32, v32, v40
v_add_f32 v33, v33, v41
v_add_f32 v34, v34, v42
v_add_f32 v35, v35, v43
v_add_f32 v36, v36, v44
v_add_f32 v37, v37, v45
v_add_f32 v38, v38, v46
v_add_f32 v39, v39, v47
v_mov_b32 v40, v32
v_mov_b32 v41, v33
v_mov_b32 v42, v34
v_mov_b32 v43, v35
v_mov_b32 v44, v36
v_mov_b32 v45, v37
v_mov_b32 v46, v38
v_mov_b32 v47, v39
s_nop 0
v_permlane32_swap_b32 v32, v40
v_permlane32_swap_b32 v33, v41
v_permlane32_swap_b32 v34, v42
v_permlane32_swap_b32 v35, v43
v_permlane32_swap_b32 v36, v44
v_permlane32_swap_b32 v37, v45
v_permlane32_swap_b32 v38, v46
v_permlane32_swap_b32 v39, v47
v_add_f32 v32, v32, v40
v_add_f32 v33, v33, v41
v_add_f32 v34, v34, v42
v_add_f32 v35, v35, v43
v_add_f32 v36, v36, v44
v_add_f32 v37, v37, v45
v_add_f32 v38, v38, v46
v_add_f32 v39, v39, v47
s_mov_b64 exec, 0xffff
buffer_store_dwordx4 v[32:35], v5, s[72:75], 0 offen sc1
buffer_store_dwordx4 v[36:39], v5, s[72:75], 0 offen offset:16 sc1
s_mov_b64 exec, -1
s_waitcnt vmcnt(0)
s_add_u32 s43, s50, 96
s_lshl_b32 s43, s43, 7
v_mov_b32 v12, s43
v_mov_b32 v13, 1
s_mov_b64 exec, 1
buffer_atomic_add v13, v12, s[56:59], 0 offen sc1
s_mov_b64 exec, -1
s_branch Lcsd_141
.p2align 6
Lw_45:
s_branch Lr_46
s_nop 0
Lnojob_140:
s_lshl_b32 s43, s34, 18
s_add_u32 s12, s32, s43
s_addc_u32 s13, s33, 0
s_mov_b32 s14, 262144
s_mov_b32 s15, 0x20000
v_lshlrev_b32 v21, 4, v1
s_lshl_b32 s54, s36, 11
s_xor_b32 s43, s35, 1
s_and_b32 s43, s43, 15
s_lshl_b32 s43, s43, 14
s_add_u32 s30, s43, s54
s_xor_b32 s43, s35, 2
s_and_b32 s43, s43, 15
s_lshl_b32 s43, s43, 14
s_add_u32 s31, s43, s54
s_waitcnt vmcnt(0)
s_barrier
ds_write_b128 v27, v[68:71] offset:0
ds_write_b128 v27, v[116:119] offset:512
s_waitcnt lgkmcnt(0)
s_barrier
s_add_u32 m0, s54, 16384
s_add_u32 s43, s30, 0
buffer_load_dwordx4 v21, s[12:15], s43 offen sc1 lds
s_add_u32 m0, s54, 17408
s_add_u32 s43, s30, 1024
buffer_load_dwordx4 v21, s[12:15], s43 offen sc1 lds
s_add_u32 m0, s54, 32768
s_add_u32 s43, s31, 0
buffer_load_dwordx4 v21, s[12:15], s43 offen sc1 lds
s_add_u32 m0, s54, 33792
s_add_u32 s43, s31, 1024
buffer_load_dwordx4 v21, s[12:15], s43 offen sc1 lds
s_waitcnt vmcnt(2)
s_barrier
s_waitcnt vmcnt(0)
s_barrier
s_barrier
s_barrier
s_add_u32 s43, s34, 0
s_lshl_b32 s43, s43, 7
v_mov_b32 v8, s43
v_mov_b32 v10, 16
buffer_load_dword v9, v8, s[56:59], 0 offen sc1
s_barrier
s_barrier
s_barrier
s_mov_b32 s41, 0x10000
Lpoll_145:
s_waitcnt vmcnt(0)
Lpf_147:
v_cmp_ne_u32 vcc, v10, v9
s_nop 4
s_cbranch_vccz Lpok_146
buffer_load_dword v9, v8, s[56:59], 0 offen sc1
s_sub_u32 s41, s41, 1
s_cmp_lg_u32 s41, 0
s_cbranch_scc1 Lpoll_145
s_waitcnt vmcnt(0)
Lpok_146:
s_barrier
s_barrier
s_barrier
s_barrier
s_barrier
s_barrier
s_barrier
s_barrier
s_barrier
s_barrier
s_mov_b32 s55, 0
.p2align 3
Lcsd_141:
s_mov_b32 s46, 1
s_lshl_b32 s43, s34, 18
s_add_u32 s12, s32, s43
s_addc_u32 s13, s33, 0
s_add_u32 s12, s12, 4194304
s_addc_u32 s13, s13, 0
s_mov_b32 s14, 262144
s_mov_b32 s15, 0x20000
v_lshlrev_b32 v21, 4, v1
s_lshl_b32 s54, s36, 11
s_xor_b32 s43, s35, 1
s_and_b32 s43, s43, 15
s_lshl_b32 s43, s43, 14
s_add_u32 s30, s43, s54
s_xor_b32 s43, s35, 2
s_and_b32 s43, s43, 15
s_lshl_b32 s43, s43, 14
s_add_u32 s31, s43, s54
s_lshl_b32 s43, s34, 14
s_add_u32 s64, s32, s43
s_addc_u32 s65, s33, 0
s_add_u32 s64, s64, 25165824
s_addc_u32 s65, s65, 0
s_mov_b32 s66, 16384
s_mov_b32 s67, 0x20000
s_add_u32 s72, s32, 27262976
s_addc_u32 s73, s33, 0
s_mov_b32 s74, 114688
s_mov_b32 s75, 0x20000
s_barrier
s_add_u32 s43, s34, 16
s_lshl_b32 s43, s43, 7
v_mov_b32 v8, s43
v_mov_b32 v9, 1
s_mov_b64 exec, 1
buffer_atomic_add v9, v8, s[56:59], 0 offen sc1
s_mov_b64 exec, -1
s_waitcnt vmcnt(0)
s_mul_i32 s43, s2, 28672
s_mul_i32 s44, s51, 7168
s_add_u32 s43, s43, s44
s_add_u32 s80, s60, s43
s_addc_u32 s81, s61, 0
s_load_dword s82, s[80:81], 0
s_load_dword s83, s[80:81], 64
s_load_dword s84, s[80:81], 128
s_load_dword s85, s[80:81], 192
s_load_dword s86, s[80:81], 256
s_load_dword s87, s[80:81], 320
s_load_dword s82, s[80:81], 384
s_load_dword s83, s[80:81], 448
s_load_dword s84, s[80:81], 512
s_load_dword s85, s[80:81], 576
s_load_dword s86, s[80:81], 640
s_add_u32 s80, s80, 704
s_addc_u32 s81, s81, 0
s_barrier
s_load_dword s82, s[80:81], 0
s_load_dword s83, s[80:81], 64
s_load_dword s84, s[80:81], 128
s_load_dword s85, s[80:81], 192
s_load_dword s86, s[80:81], 256
s_load_dword s87, s[80:81], 320
s_load_dword s82, s[80:81], 384
s_load_dword s83, s[80:81], 448
s_load_dword s84, s[80:81], 512
s_load_dword s85, s[80:81], 576
s_load_dword s86, s[80:81], 640
s_add_u32 s80, s80, 704
s_addc_u32 s81, s81, 0
s_barrier
s_mul_i32 s43, s49, 96
s_add_u32 s44, s43, 95
s_lshr_b32 s43, s43, 7
s_lshr_b32 s44, s44, 7
s_add_u32 s43, s43, 16
s_add_u32 s44, s44, 16
v_mov_b32 v12, s44
v_writelane_b32 v12, s35, 0
v_writelane_b32 v12, s43, 1
v_add_u32 v12, 96, v12
v_lshlrev_b32 v12, 7, v12
v_mov_b32 v14, 8
buffer_load_dword v13, v12, s[56:59], 0 offen sc1
s_load_dword s82, s[80:81], 0
s_load_dword s83, s[80:81], 64
s_load_dword s84, s[80:81], 128
s_load_dword s85, s[80:81], 192
s_load_dword s86, s[80:81], 256
s_load_dword s87, s[80:81], 320
s_load_dword s82, s[80:81], 384
s_load_dword s83, s[80:81], 448
s_load_dword s84, s[80:81], 512
s_load_dword s85, s[80:81], 576
s_load_dword s86, s[80:81], 640
s_add_u32 s80, s80, 704
s_addc_u32 s81, s81, 0
s_barrier
s_add_u32 s43, s34, 16
s_lshl_b32 s43, s43, 7
v_mov_b32 v8, s43
v_mov_b32 v10, 16
buffer_load_dword v9, v8, s[56:59], 0 offen sc1
s_load_dword s82, s[80:81], 0
s_load_dword s83, s[80:81], 64
s_load_dword s84, s[80:81], 128
s_load_dword s85, s[80:81], 192
s_load_dword s86, s[80:81], 256
s_load_dword s87, s[80:81], 320
s_load_dword s82, s[80:81], 384
s_load_dword s83, s[80:81], 448
s_load_dword s84, s[80:81], 512
s_load_dword s85, s[80:81], 576
s_load_dword s86, s[80:81], 640
s_add_u32 s80, s80, 704
s_addc_u32 s81, s81, 0
s_barrier
s_mov_b32 s41, 0x10000
Lpoll_148:
s_waitcnt vmcnt(0)
Lpf_150:
v_cmp_ne_u32 vcc, v10, v9
s_nop 4
s_cbranch_vccz Lpok_149
buffer_load_dword v9, v8, s[56:59], 0 offen sc1
s_sub_u32 s41, s41, 1
s_cmp_lg_u32 s41, 0
s_cbranch_scc1 Lpoll_148
s_waitcnt vmcnt(0)
Lpok_149:
s_mov_b32 s41, 0x10000
Lpoll_151:
s_waitcnt vmcnt(0)
Lpf_153:
v_cmp_ne_u32 vcc, v14, v13
s_nop 4
s_cbranch_vccz Lpok_152
buffer_load_dword v13, v12, s[56:59], 0 offen sc1
s_sub_u32 s41, s41, 1
s_cmp_lg_u32 s41, 0
s_cbranch_scc1 Lpoll_151
s_waitcnt vmcnt(0)
Lpok_152:
v_min_u32 v12, 55, v1
v_lshlrev_b32 v13, 4, v12
s_lshl_b32 s43, s35, 9
s_mul_i32 s44, s49, 384
s_add_u32 s44, s44, 7680
v_mov_b32 v14, s44
v_mov_b32 v15, s43
v_cmp_gt_u32 vcc, 32, v12
s_nop 1
v_cndmask_b32 v14, v14, v15, vcc
v_add_u32 v14, v14, v13
v_add_u32 v13, 148480, v13
s_mov_b32 s43, 0
buffer_load_dwordx4 v[192:195], v14, s[72:75], s43 offen sc1
s_mov_b32 s43, 28672
buffer_load_dwordx4 v[196:199], v14, s[72:75], s43 offen sc1
s_mov_b32 s43, 57344
buffer_load_dwordx4 v[200:203], v14, s[72:75], s43 offen sc1
s_mov_b32 s43, 86016
buffer_load_dwordx4 v[204:207], v14, s[72:75], s43 offen sc1
s_mov_b32 s43, 14336
buffer_load_dwordx4 v[208:211], v14, s[72:75], s43 offen sc1
s_mov_b32 s43, 43008
buffer_load_dwordx4 v[212:215], v14, s[72:75], s43 offen sc1
s_mov_b32 s43, 71680
buffer_load_dwordx4 v[216:219], v14, s[72:75], s43 offen sc1
s_mov_b32 s43, 100352
buffer_load_dwordx4 v[220:223], v14, s[72:75], s43 offen sc1
s_load_dword s82, s[80:81], 0
s_load_dword s83, s[80:81], 64
s_load_dword s84, s[80:81], 128
s_load_dword s85, s[80:81], 192
s_load_dword s86, s[80:81], 256
s_load_dword s87, s[80:81], 320
s_load_dword s82, s[80:81], 384
s_load_dword s83, s[80:81], 448
s_load_dword s84, s[80:81], 512
s_load_dword s85, s[80:81], 576
s_load_dword s86, s[80:81], 640
s_add_u32 s80, s80, 704
s_addc_u32 s81, s81, 0
s_barrier
s_getpc_b64 s[78:79]
Lpc_154:
s_sub_u32 s78, s78, Lpc_154-sequential_preLN__sliding_local_dilated__glu_gated_geglu__prompt_kernel
s_subb_u32 s79, s79, 0
s_lshr_b32 s43, s2, 3
s_mul_i32 s43, s43, 3840
v_min_u32 v19, 29, v1
v_lshl_add_u32 v19, v19, 7, s43
v_min_u32 v19, Ldone_1-sequential_preLN__sliding_local_dilated__glu_gated_geglu__prompt_kernel, v19
global_load_dword v30, v19, s[78:79]
s_mov_b32 s43, 0
buffer_load_dwordx4 v[128:131], v21, s[64:67], s43 offen sc1
s_mov_b32 s43, 1024
buffer_load_dwordx4 v[132:135], v21, s[64:67], s43 offen sc1
s_mov_b32 s43, 2048
buffer_load_dwordx4 v[136:139], v21, s[64:67], s43 offen sc1
s_mov_b32 s43, 3072
buffer_load_dwordx4 v[140:143], v21, s[64:67], s43 offen sc1
s_mov_b32 s43, 4096
buffer_load_dwordx4 v[144:147], v21, s[64:67], s43 offen sc1
s_mov_b32 s43, 5120
buffer_load_dwordx4 v[148:151], v21, s[64:67], s43 offen sc1
s_mov_b32 s43, 6144
buffer_load_dwordx4 v[152:155], v21, s[64:67], s43 offen sc1
s_mov_b32 s43, 7168
buffer_load_dwordx4 v[156:159], v21, s[64:67], s43 offen sc1
s_mov_b32 s43, 8192
buffer_load_dwordx4 v[160:163], v21, s[64:67], s43 offen sc1
s_mov_b32 s43, 9216
buffer_load_dwordx4 v[164:167], v21, s[64:67], s43 offen sc1
s_mov_b32 s43, 10240
buffer_load_dwordx4 v[168:171], v21, s[64:67], s43 offen sc1
s_mov_b32 s43, 11264
buffer_load_dwordx4 v[172:175], v21, s[64:67], s43 offen sc1
s_mov_b32 s43, 12288
buffer_load_dwordx4 v[176:179], v21, s[64:67], s43 offen sc1
s_mov_b32 s43, 13312
buffer_load_dwordx4 v[180:183], v21, s[64:67], s43 offen sc1
s_mov_b32 s43, 14336
buffer_load_dwordx4 v[184:187], v21, s[64:67], s43 offen sc1
s_mov_b32 s43, 15360
buffer_load_dwordx4 v[188:191], v21, s[64:67], s43 offen sc1
s_load_dword s82, s[80:81], 0
s_load_dword s83, s[80:81], 64
s_load_dword s84, s[80:81], 128
s_load_dword s85, s[80:81], 192
s_load_dword s86, s[80:81], 256
s_load_dword s87, s[80:81], 320
s_load_dword s82, s[80:81], 384
s_load_dword s83, s[80:81], 448
s_load_dword s84, s[80:81], 512
s_load_dword s85, s[80:81], 576
s_load_dword s86, s[80:81], 640
s_add_u32 s80, s80, 704
s_addc_u32 s81, s81, 0
s_barrier
s_waitcnt vmcnt(16)
v_add_f32 v192, v192, v196
v_add_f32 v200, v200, v204
v_add_f32 v193, v193, v197
v_add_f32 v201, v201, v205
v_add_f32 v194, v194, v198
v_add_f32 v202, v202, v206
v_add_f32 v195, v195, v199
v_add_f32 v203, v203, v207
v_add_f32 v192, v192, v200
v_add_f32 v193, v193, v201
v_add_f32 v194, v194, v202
v_add_f32 v195, v195, v203
ds_write_b128 v13, v[192:195] offset:0
v_add_f32 v208, v208, v212
v_add_f32 v216, v216, v220
v_add_f32 v209, v209, v213
v_add_f32 v217, v217, v221
v_add_f32 v210, v210, v214
v_add_f32 v218, v218, v222
v_add_f32 v211, v211, v215
v_add_f32 v219, v219, v223
v_add_f32 v208, v208, v216
v_add_f32 v209, v209, v217
v_add_f32 v210, v210, v218
v_add_f32 v211, v211, v219
ds_write_b128 v13, v[208:211] offset:896
s_barrier
s_waitcnt vmcnt(0)
v_add_f32 v128, v128, v132
v_add_f32 v129, v129, v133
v_add_f32 v130, v130, v134
v_add_f32 v131, v131, v135
v_add_f32 v128, v128, v136
v_add_f32 v129, v129, v137
v_add_f32 v130, v130, v138
v_add_f32 v131, v131, v139
v_add_f32 v128, v128, v140
v_add_f32 v129, v129, v141
v_add_f32 v130, v130, v142
v_add_f32 v131, v131, v143
v_add_f32 v128, v128, v144
v_add_f32 v129, v129, v145
v_add_f32 v130, v130, v146
v_add_f32 v131, v131, v147
v_add_f32 v128, v128, v148
v_add_f32 v129, v129, v149
v_add_f32 v130, v130, v150
v_add_f32 v131, v131, v151
v_add_f32 v128, v128, v152
v_add_f32 v129, v129, v153
v_add_f32 v130, v130, v154
v_add_f32 v131, v131, v155
v_add_f32 v128, v128, v156
v_add_f32 v129, v129, v157
v_add_f32 v130, v130, v158
v_add_f32 v131, v131, v159
v_add_f32 v128, v128, v160
v_add_f32 v129, v129, v161
v_add_f32 v130, v130, v162
v_add_f32 v131, v131, v163
v_add_f32 v128, v128, v164
v_add_f32 v129, v129, v165
v_add_f32 v130, v130, v166
v_add_f32 v131, v131, v167
v_add_f32 v128, v128, v168
v_add_f32 v129, v129, v169
v_add_f32 v130, v130, v170
v_add_f32 v131, v131, v171
v_add_f32 v128, v128, v172
v_add_f32 v129, v129, v173
v_add_f32 v130, v130, v174
v_add_f32 v131, v131, v175
v_add_f32 v128, v128, v176
v_add_f32 v129, v129, v177
v_add_f32 v130, v130, v178
v_add_f32 v131, v131, v179
v_add_f32 v128, v128, v180
v_add_f32 v129, v129, v181
v_add_f32 v130, v130, v182
v_add_f32 v131, v131, v183
v_add_f32 v128, v128, v184
v_add_f32 v129, v129, v185
v_add_f32 v130, v130, v186
v_add_f32 v131, v131, v187
v_add_f32 v128, v128, v188
v_add_f32 v129, v129, v189
v_add_f32 v130, v130, v190
v_add_f32 v131, v131, v191
v_mul_f32 v128, 0x3a800000, v128
v_mul_f32 v129, 0x3a800000, v129
v_fma_f32 v129, -v128, v128, v129
v_max_f32 v129, 0, v129
v_add_f32 v129, 0x3727c5ac, v129
v_rsq_f32 v129, v129
v_mul_f32 v130, 0x3a800000, v130
v_mul_f32 v131, 0x3a800000, v131
v_fma_f32 v131, -v130, v130, v131
v_max_f32 v131, 0, v131
v_add_f32 v131, 0x3727c5ac, v131
v_rsq_f32 v131, v131
v_add_u32 v19, 147456, v21
ds_write_b128 v19, v[128:131]
s_waitcnt lgkmcnt(0)
s_load_dword s82, s[80:81], 0
s_load_dword s83, s[80:81], 64
s_load_dword s84, s[80:81], 128
s_load_dword s85, s[80:81], 192
s_load_dword s86, s[80:81], 256
s_load_dword s87, s[80:81], 320
s_load_dword s82, s[80:81], 384
s_load_dword s83, s[80:81], 448
s_load_dword s84, s[80:81], 512
s_load_dword s85, s[80:81], 576
s_load_dword s86, s[80:81], 640
s_add_u32 s80, s80, 704
s_addc_u32 s81, s81, 0
s_barrier
s_load_dword s82, s[80:81], 0
s_load_dword s83, s[80:81], 64
s_load_dword s84, s[80:81], 128
s_load_dword s85, s[80:81], 192
s_load_dword s86, s[80:81], 256
s_load_dword s87, s[80:81], 320
s_load_dword s82, s[80:81], 384
s_load_dword s83, s[80:81], 448
s_load_dword s84, s[80:81], 512
s_load_dword s85, s[80:81], 576
s_load_dword s86, s[80:81], 640
s_add_u32 s80, s80, 704
s_addc_u32 s81, s81, 0
s_barrier
s_and_b32 s53, s35, 1
s_lshl_b32 s53, s53, 1
s_mul_i32 s43, s47, 3
s_add_u32 s53, s53, s43
v_lshlrev_b32 v19, 11, v18
v_lshl_add_u32 v19, v17, 4, v19
s_lshl_b32 s43, s46, 10
v_add_u32 v2, s43, v19
v_add_u32 v3, 49152, v2
v_add_u32 v4, 98304, v2
v_lshrrev_b32 v19, 2, v17
v_lshl_add_u32 v20, v18, 2, v19
v_and_b32 v21, 7, v20
v_lshlrev_b32 v20, 8, v20
v_and_b32 v19, 3, v1
v_lshl_add_u32 v20, v19, 3, v20
s_add_u32 s43, s53, 0
v_xor_b32 v19, s43, v21
v_lshl_add_u32 v5, v19, 5, v20
s_add_u32 s43, s53, 1
v_xor_b32 v19, s43, v21
v_lshl_add_u32 v6, v19, 5, v20
s_add_u32 s43, s53, 2
v_xor_b32 v19, s43, v21
v_lshl_add_u32 v7, v19, 5, v20
v_add_u32 v9, 49152, v5
v_add_u32 v10, 49152, v6
v_add_u32 v11, 49152, v7
v_add_u32 v13, 98304, v5
v_add_u32 v14, 98304, v6
v_add_u32 v15, 98304, v7
s_lshl_b32 s43, s46, 9
s_add_u32 s43, s43, 147456
v_lshl_add_u32 v19, v17, 3, s43
ds_read_b64 v[80:81], v19 offset:0
ds_read_b64 v[82:83], v19 offset:128
ds_read_b64 v[84:85], v19 offset:256
ds_read_b64 v[86:87], v19 offset:384
s_mul_i32 s43, s47, 192
s_add_u32 s43, s43, 148992
v_lshl_add_u32 v19, v18, 4, s43
ds_read_b128 v[48:51], v19 offset:0
ds_read_b128 v[52:55], v19 offset:64
ds_read_b128 v[56:59], v19 offset:128
ds_read_b128 v[60:63], v19 offset:896
ds_read_b128 v[64:67], v19 offset:960
ds_read_b128 v[68:71], v19 offset:1024
s_barrier
s_waitcnt lgkmcnt(0)
v_mul_f32 v88, v81, v81
v_mul_f32 v228, 0xc0135761, v81
v_mul_f32 v89, 0xbdd2d3e8, v81
v_rcp_f32 v236, v88
v_mul_f32 v232, v89, v88
v_mul_f32 v88, v83, v83
v_mul_f32 v229, 0xc0135761, v83
v_mul_f32 v89, 0xbdd2d3e8, v83
v_rcp_f32 v237, v88
v_mul_f32 v233, v89, v88
v_mul_f32 v88, v85, v85
v_mul_f32 v230, 0xc0135761, v85
v_mul_f32 v89, 0xbdd2d3e8, v85
v_rcp_f32 v238, v88
v_mul_f32 v234, v89, v88
v_mul_f32 v88, v87, v87
v_mul_f32 v231, 0xc0135761, v87
v_mul_f32 v89, 0xbdd2d3e8, v87
v_rcp_f32 v239, v88
v_mul_f32 v235, v89, v88
s_mul_i32 s43, s34, 917504
s_mov_b32 s44, 3577949200
s_mov_b32 s45, 3137247350
s_lshl_b32 s50, s49, 2
s_lshr_b64 s[44:45], s[44:45], s50
s_and_b32 s50, s44, 15
s_mul_i32 s44, s50, 24576
s_add_u32 s43, s43, s44
s_add_u32 s43, s43, 8912896
s_add_u32 s24, s32, s43
s_addc_u32 s25, s33, 0
s_mov_b32 s26, 24576
s_mov_b32 s27, 0x20000
s_mov_b32 s53, 262144
s_lshl_b32 s43, s47, 13
s_lshl_b32 s44, s46, 10
s_add_u32 s43, s43, s44
v_lshlrev_b32 v19, 11, v18
v_lshl_add_u32 v19, v17, 4, v19
v_add_u32 v27, s43, v19
s_lshl_b32 s43, s47, 12
s_add_u32 s43, s43, s44
s_add_u32 s43, s43, 16384
v_and_b32 v19, 1, v18
v_lshlrev_b32 v19, 11, v19
v_lshrrev_b32 v20, 1, v18
v_lshl_add_u32 v19, v20, 8, v19
v_lshl_add_u32 v19, v17, 4, v19
v_add_u32 v28, s43, v19
s_load_dword s82, s[80:81], 0
s_load_dword s83, s[80:81], 64
s_load_dword s84, s[80:81], 128
s_load_dword s85, s[80:81], 192
s_load_dword s86, s[80:81], 256
s_load_dword s87, s[80:81], 320
s_load_dword s82, s[80:81], 384
s_load_dword s83, s[80:81], 448
s_add_u32 s80, s80, 512
s_addc_u32 s81, s81, 0
s_barrier
v_mul_f32 v128, -v80, v48
v_mul_f32 v129, -v80, v49
v_mul_f32 v130, -v80, v50
v_mul_f32 v131, -v80, v51
v_mul_f32 v132, -v82, v48
v_mul_f32 v133, -v82, v49
v_mul_f32 v134, -v82, v50
v_mul_f32 v135, -v82, v51
v_mul_f32 v136, -v84, v48
v_mul_f32 v137, -v84, v49
v_mul_f32 v138, -v84, v50
v_mul_f32 v139, -v84, v51
v_mul_f32 v140, -v86, v48
v_mul_f32 v141, -v86, v49
v_mul_f32 v142, -v86, v50
v_mul_f32 v143, -v86, v51
v_mul_f32 v144, -v80, v52
v_mul_f32 v145, -v80, v53
v_mul_f32 v146, -v80, v54
v_mul_f32 v147, -v80, v55
v_mul_f32 v148, -v82, v52
v_mul_f32 v149, -v82, v53
v_mul_f32 v150, -v82, v54
v_mul_f32 v151, -v82, v55
v_mul_f32 v152, -v84, v52
v_mul_f32 v153, -v84, v53
v_mul_f32 v154, -v84, v54
v_mul_f32 v155, -v84, v55
v_mul_f32 v156, -v86, v52
v_mul_f32 v157, -v86, v53
v_mul_f32 v158, -v86, v54
v_mul_f32 v159, -v86, v55
s_load_dword s82, s[80:81], 0
s_load_dword s83, s[80:81], 64
s_load_dword s84, s[80:81], 128
s_load_dword s85, s[80:81], 192
s_load_dword s86, s[80:81], 256
s_load_dword s87, s[80:81], 320
s_load_dword s82, s[80:81], 384
s_load_dword s83, s[80:81], 448
s_add_u32 s80, s80, 512
s_addc_u32 s81, s81, 0
s_barrier
v_mul_f32 v160, -v80, v56
v_mul_f32 v161, -v80, v57
v_mul_f32 v162, -v80, v58
v_mul_f32 v163, -v80, v59
v_mul_f32 v164, -v82, v56
v_mul_f32 v165, -v82, v57
v_mul_f32 v166, -v82, v58
v_mul_f32 v167, -v82, v59
v_mul_f32 v168, -v84, v56
v_mul_f32 v169, -v84, v57
v_mul_f32 v170, -v84, v58
v_mul_f32 v171, -v84, v59
v_mul_f32 v172, -v86, v56
v_mul_f32 v173, -v86, v57
v_mul_f32 v174, -v86, v58
v_mul_f32 v175, -v86, v59
v_mul_f32 v176, -v80, v60
v_mul_f32 v177, -v80, v61
v_mul_f32 v178, -v80, v62
v_mul_f32 v179, -v80, v63
v_mul_f32 v180, -v82, v60
v_mul_f32 v181, -v82, v61
v_mul_f32 v182, -v82, v62
v_mul_f32 v183, -v82, v63
v_mul_f32 v184, -v84, v60
v_mul_f32 v185, -v84, v61
v_mul_f32 v186, -v84, v62
v_mul_f32 v187, -v84, v63
v_mul_f32 v188, -v86, v60
v_mul_f32 v189, -v86, v61
v_mul_f32 v190, -v86, v62
v_mul_f32 v191, -v86, v63
s_load_dword s82, s[80:81], 0
s_load_dword s83, s[80:81], 64
s_load_dword s84, s[80:81], 128
s_load_dword s85, s[80:81], 192
s_load_dword s86, s[80:81], 256
s_load_dword s87, s[80:81], 320
s_load_dword s82, s[80:81], 384
s_load_dword s83, s[80:81], 448
s_add_u32 s80, s80, 512
s_addc_u32 s81, s81, 0
s_barrier
v_mul_f32 v192, -v80, v64
v_mul_f32 v193, -v80, v65
v_mul_f32 v194, -v80, v66
v_mul_f32 v195, -v80, v67
v_mul_f32 v196, -v82, v64
v_mul_f32 v197, -v82, v65
v_mul_f32 v198, -v82, v66
v_mul_f32 v199, -v82, v67
v_mul_f32 v200, -v84, v64
v_mul_f32 v201, -v84, v65
v_mul_f32 v202, -v84, v66
v_mul_f32 v203, -v84, v67
v_mul_f32 v204, -v86, v64
v_mul_f32 v205, -v86, v65
v_mul_f32 v206, -v86, v66
v_mul_f32 v207, -v86, v67
v_mul_f32 v208, -v80, v68
v_mul_f32 v209, -v80, v69
v_mul_f32 v210, -v80, v70
v_mul_f32 v211, -v80, v71
v_mul_f32 v212, -v82, v68
v_mul_f32 v213, -v82, v69
v_mul_f32 v214, -v82, v70
v_mul_f32 v215, -v82, v71
v_mul_f32 v216, -v84, v68
v_mul_f32 v217, -v84, v69
v_mul_f32 v218, -v84, v70
v_mul_f32 v219, -v84, v71
v_mul_f32 v220, -v86, v68
v_mul_f32 v221, -v86, v69
v_mul_f32 v222, -v86, v70
v_mul_f32 v223, -v86, v71
s_barrier
s_branch Lw_155
Lr_156:
s_mul_i32 s44, s34, 917504
s_lshl_b32 s39, s51, 13
s_add_u32 s44, s44, s39
s_add_u32 s44, s44, 8388608
s_and_b32 s43, s51, 1
s_xor_b32 s43, s43, s35
s_lshl_b32 s43, s43, 7
s_mov_b32 s10, 909312
s_movk_i32 s38, 1024
s_movk_i32 s40, 9216
s_movk_i32 s37, 0x4000
s_cmp_ge_u32 s51, 2
s_cselect_b32 s8, s60, s32
s_cselect_b32 s9, s61, s33
s_cselect_b32 s10, 7338112, s10
s_cselect_b32 s43, s43, s44
s_cselect_b32 s38, 16384, s38
s_cselect_b32 s40, 81920, s40
s_cselect_b32 s55, 81920, s38
s_cselect_b32 s37, 262144, s37
s_cselect_b32 s45, -1, 0
s_add_u32 s8, s8, s43
s_addc_u32 s9, s9, 0
s_mov_b32 s11, 0x20000
s_and_b32 s53, s35, 1
s_mul_i32 s54, s53, 6
s_mul_i32 s54, s54, s37
s_mul_i32 s29, s53, 2
s_add_u32 s29, s29, 6
s_mul_i32 s29, s29, s37
s_and_b32 s43, s45, 4290838528
s_add_u32 s29, s29, s43
s_mul_i32 s37, s37, 2
s_sub_u32 s37, s37, s40
v_lshrrev_b32 v19, 3, v1
v_mul_u32_u24 v19, 1920, v19
v_lshrrev_b32 v20, 4, v1
v_lshlrev_b32 v20, 5, v20
v_and_b32 v19, s45, v19
v_and_b32 v20, s45, v20
v_lshlrev_b32 v21, 4, v1
v_xor_b32 v21, v21, v20
v_add_u32 v21, v21, v19
s_barrier
.p2align 3
LK3b_134:
s_setprio 1
ds_read_b128 v[32:35], v2 offset:0
ds_read_b64_tr_b16 v[48:49], v5 offset:16384
ds_read_b64_tr_b16 v[50:51], v5 offset:20480
ds_read_b128 v[36:39], v2 offset:256
ds_read_b128 v[40:43], v2 offset:512
ds_read_b128 v[44:47], v2 offset:768
ds_read_b64_tr_b16 v[60:61], v5 offset:32768
ds_read_b64_tr_b16 v[62:63], v5 offset:36864
ds_read_b64_tr_b16 v[52:53], v6 offset:16384
ds_read_b64_tr_b16 v[54:55], v6 offset:20480
ds_read_b64_tr_b16 v[64:65], v6 offset:32768
ds_read_b64_tr_b16 v[66:67], v6 offset:36864
ds_read_b64_tr_b16 v[56:57], v7 offset:16384
ds_read_b64_tr_b16 v[58:59], v7 offset:20480
ds_read_b64_tr_b16 v[68:69], v7 offset:32768
ds_read_b64_tr_b16 v[70:71], v7 offset:36864
s_mov_b32 s41, 5
.p2align 3
Lk3_157:
s_waitcnt lgkmcnt(0)
v_mfma_f32_16x16x32_bf16 v[128:131], v[48:51], v[32:35], v[128:131]
ds_read_b128 v[80:83], v2 offset:8192
v_mfma_f32_16x16x32_bf16 v[132:135], v[48:51], v[36:39], v[132:135]
ds_read_b64_tr_b16 v[96:97], v5 offset:24576
v_mfma_f32_16x16x32_bf16 v[136:139], v[48:51], v[40:43], v[136:139]
ds_read_b64_tr_b16 v[98:99], v5 offset:28672
v_mfma_f32_16x16x32_bf16 v[140:143], v[48:51], v[44:47], v[140:143]
ds_read_b128 v[84:87], v2 offset:8448
v_mfma_f32_16x16x32_bf16 v[188:191], v[60:63], v[44:47], v[188:191]
ds_read_b128 v[88:91], v2 offset:8704
v_mfma_f32_16x16x32_bf16 v[184:187], v[60:63], v[40:43], v[184:187]
ds_read_b128 v[92:95], v2 offset:8960
v_mfma_f32_16x16x32_bf16 v[180:183], v[60:63], v[36:39], v[180:183]
ds_read_b64_tr_b16 v[108:109], v5 offset:40960
v_mfma_f32_16x16x32_bf16 v[176:179], v[60:63], v[32:35], v[176:179]
ds_read_b64_tr_b16 v[110:111], v5 offset:45056
v_mfma_f32_16x16x32_bf16 v[144:147], v[52:55], v[32:35], v[144:147]
ds_read_b64_tr_b16 v[100:101], v6 offset:24576
v_mfma_f32_16x16x32_bf16 v[148:151], v[52:55], v[36:39], v[148:151]
ds_read_b64_tr_b16 v[102:103], v6 offset:28672
v_mfma_f32_16x16x32_bf16 v[152:155], v[52:55], v[40:43], v[152:155]
ds_read_b64_tr_b16 v[112:113], v6 offset:40960
v_mfma_f32_16x16x32_bf16 v[156:159], v[52:55], v[44:47], v[156:159]
ds_read_b64_tr_b16 v[114:115], v6 offset:45056
v_mfma_f32_16x16x32_bf16 v[204:207], v[64:67], v[44:47], v[204:207]
ds_read_b64_tr_b16 v[104:105], v7 offset:24576
v_mfma_f32_16x16x32_bf16 v[200:203], v[64:67], v[40:43], v[200:203]
ds_read_b64_tr_b16 v[106:107], v7 offset:28672
v_mfma_f32_16x16x32_bf16 v[196:199], v[64:67], v[36:39], v[196:199]
ds_read_b64_tr_b16 v[116:117], v7 offset:40960
v_mfma_f32_16x16x32_bf16 v[192:195], v[64:67], v[32:35], v[192:195]
ds_read_b64_tr_b16 v[118:119], v7 offset:45056
v_mfma_f32_16x16x32_bf16 v[160:163], v[56:59], v[32:35], v[160:163]
v_mfma_f32_16x16x32_bf16 v[164:167], v[56:59], v[36:39], v[164:167]
v_mfma_f32_16x16x32_bf16 v[168:171], v[56:59], v[40:43], v[168:171]
v_mfma_f32_16x16x32_bf16 v[172:175], v[56:59], v[44:47], v[172:175]
v_mfma_f32_16x16x32_bf16 v[220:223], v[68:71], v[44:47], v[220:223]
v_mfma_f32_16x16x32_bf16 v[216:219], v[68:71], v[40:43], v[216:219]
v_mfma_f32_16x16x32_bf16 v[212:215], v[68:71], v[36:39], v[212:215]
v_mfma_f32_16x16x32_bf16 v[208:211], v[68:71], v[32:35], v[208:211]
s_waitcnt vmcnt(0) lgkmcnt(0)
s_barrier
v_mfma_f32_16x16x32_bf16 v[128:131], v[96:99], v[80:83], v[128:131]
ds_read_b128 v[32:35], v3 offset:0
v_mfma_f32_16x16x32_bf16 v[132:135], v[96:99], v[84:87], v[132:135]
ds_read_b64_tr_b16 v[48:49], v9 offset:16384
v_mfma_f32_16x16x32_bf16 v[136:139], v[96:99], v[88:91], v[136:139]
ds_read_b64_tr_b16 v[50:51], v9 offset:20480
v_mfma_f32_16x16x32_bf16 v[140:143], v[96:99], v[92:95], v[140:143]
ds_read_b128 v[36:39], v3 offset:256
v_mfma_f32_16x16x32_bf16 v[188:191], v[108:111], v[92:95], v[188:191]
ds_read_b128 v[40:43], v3 offset:512
v_mfma_f32_16x16x32_bf16 v[184:187], v[108:111], v[88:91], v[184:187]
ds_read_b128 v[44:47], v3 offset:768
v_mfma_f32_16x16x32_bf16 v[180:183], v[108:111], v[84:87], v[180:183]
ds_read_b64_tr_b16 v[60:61], v9 offset:32768
v_mfma_f32_16x16x32_bf16 v[176:179], v[108:111], v[80:83], v[176:179]
ds_read_b64_tr_b16 v[62:63], v9 offset:36864
v_mfma_f32_16x16x32_bf16 v[144:147], v[100:103], v[80:83], v[144:147]
ds_read_b64_tr_b16 v[52:53], v10 offset:16384
v_mfma_f32_16x16x32_bf16 v[148:151], v[100:103], v[84:87], v[148:151]
ds_read_b64_tr_b16 v[54:55], v10 offset:20480
v_mfma_f32_16x16x32_bf16 v[152:155], v[100:103], v[88:91], v[152:155]
ds_read_b64_tr_b16 v[64:65], v10 offset:32768
v_mfma_f32_16x16x32_bf16 v[156:159], v[100:103], v[92:95], v[156:159]
ds_read_b64_tr_b16 v[66:67], v10 offset:36864
v_mfma_f32_16x16x32_bf16 v[204:207], v[112:115], v[92:95], v[204:207]
ds_read_b64_tr_b16 v[56:57], v11 offset:16384
v_mfma_f32_16x16x32_bf16 v[200:203], v[112:115], v[88:91], v[200:203]
ds_read_b64_tr_b16 v[58:59], v11 offset:20480
v_mfma_f32_16x16x32_bf16 v[196:199], v[112:115], v[84:87], v[196:199]
ds_read_b64_tr_b16 v[68:69], v11 offset:32768
v_mfma_f32_16x16x32_bf16 v[192:195], v[112:115], v[80:83], v[192:195]
ds_read_b64_tr_b16 v[70:71], v11 offset:36864
v_mfma_f32_16x16x32_bf16 v[160:163], v[104:107], v[80:83], v[160:163]
v_mfma_f32_16x16x32_bf16 v[164:167], v[104:107], v[84:87], v[164:167]
v_mfma_f32_16x16x32_bf16 v[168:171], v[104:107], v[88:91], v[168:171]
v_mfma_f32_16x16x32_bf16 v[172:175], v[104:107], v[92:95], v[172:175]
v_mfma_f32_16x16x32_bf16 v[220:223], v[116:119], v[92:95], v[220:223]
v_mfma_f32_16x16x32_bf16 v[216:219], v[116:119], v[88:91], v[216:219]
v_mfma_f32_16x16x32_bf16 v[212:215], v[116:119], v[84:87], v[212:215]
v_mfma_f32_16x16x32_bf16 v[208:211], v[116:119], v[80:83], v[208:211]
s_waitcnt lgkmcnt(0)
v_mfma_f32_16x16x32_bf16 v[128:131], v[48:51], v[32:35], v[128:131]
ds_read_b128 v[80:83], v3 offset:8192
v_mfma_f32_16x16x32_bf16 v[132:135], v[48:51], v[36:39], v[132:135]
ds_read_b64_tr_b16 v[96:97], v9 offset:24576
v_mfma_f32_16x16x32_bf16 v[136:139], v[48:51], v[40:43], v[136:139]
ds_read_b64_tr_b16 v[98:99], v9 offset:28672
v_mfma_f32_16x16x32_bf16 v[140:143], v[48:51], v[44:47], v[140:143]
ds_read_b128 v[84:87], v3 offset:8448
v_mfma_f32_16x16x32_bf16 v[188:191], v[60:63], v[44:47], v[188:191]
ds_read_b128 v[88:91], v3 offset:8704
v_mfma_f32_16x16x32_bf16 v[184:187], v[60:63], v[40:43], v[184:187]
ds_read_b128 v[92:95], v3 offset:8960
v_mfma_f32_16x16x32_bf16 v[180:183], v[60:63], v[36:39], v[180:183]
ds_read_b64_tr_b16 v[108:109], v9 offset:40960
v_mfma_f32_16x16x32_bf16 v[176:179], v[60:63], v[32:35], v[176:179]
ds_read_b64_tr_b16 v[110:111], v9 offset:45056
v_mfma_f32_16x16x32_bf16 v[144:147], v[52:55], v[32:35], v[144:147]
ds_read_b64_tr_b16 v[100:101], v10 offset:24576
v_mfma_f32_16x16x32_bf16 v[148:151], v[52:55], v[36:39], v[148:151]
ds_read_b64_tr_b16 v[102:103], v10 offset:28672
v_mfma_f32_16x16x32_bf16 v[152:155], v[52:55], v[40:43], v[152:155]
ds_read_b64_tr_b16 v[112:113], v10 offset:40960
v_mfma_f32_16x16x32_bf16 v[156:159], v[52:55], v[44:47], v[156:159]
ds_read_b64_tr_b16 v[114:115], v10 offset:45056
v_mfma_f32_16x16x32_bf16 v[204:207], v[64:67], v[44:47], v[204:207]
ds_read_b64_tr_b16 v[104:105], v11 offset:24576
v_mfma_f32_16x16x32_bf16 v[200:203], v[64:67], v[40:43], v[200:203]
ds_read_b64_tr_b16 v[106:107], v11 offset:28672
v_mfma_f32_16x16x32_bf16 v[196:199], v[64:67], v[36:39], v[196:199]
ds_read_b64_tr_b16 v[116:117], v11 offset:40960
v_mfma_f32_16x16x32_bf16 v[192:195], v[64:67], v[32:35], v[192:195]
ds_read_b64_tr_b16 v[118:119], v11 offset:45056
v_mfma_f32_16x16x32_bf16 v[160:163], v[56:59], v[32:35], v[160:163]
v_mfma_f32_16x16x32_bf16 v[164:167], v[56:59], v[36:39], v[164:167]
v_mfma_f32_16x16x32_bf16 v[168:171], v[56:59], v[40:43], v[168:171]
v_mfma_f32_16x16x32_bf16 v[172:175], v[56:59], v[44:47], v[172:175]
v_mfma_f32_16x16x32_bf16 v[220:223], v[68:71], v[44:47], v[220:223]
v_mfma_f32_16x16x32_bf16 v[216:219], v[68:71], v[40:43], v[216:219]
v_mfma_f32_16x16x32_bf16 v[212:215], v[68:71], v[36:39], v[212:215]
v_mfma_f32_16x16x32_bf16 v[208:211], v[68:71], v[32:35], v[208:211]
s_waitcnt lgkmcnt(0)
s_barrier
v_mfma_f32_16x16x32_bf16 v[128:131], v[96:99], v[80:83], v[128:131]
ds_read_b128 v[32:35], v4 offset:0
v_mfma_f32_16x16x32_bf16 v[132:135], v[96:99], v[84:87], v[132:135]
ds_read_b64_tr_b16 v[48:49], v13 offset:16384
v_mfma_f32_16x16x32_bf16 v[136:139], v[96:99], v[88:91], v[136:139]
ds_read_b64_tr_b16 v[50:51], v13 offset:20480
v_mfma_f32_16x16x32_bf16 v[140:143], v[96:99], v[92:95], v[140:143]
ds_read_b128 v[36:39], v4 offset:256
v_mfma_f32_16x16x32_bf16 v[188:191], v[108:111], v[92:95], v[188:191]
ds_read_b128 v[40:43], v4 offset:512
v_mfma_f32_16x16x32_bf16 v[184:187], v[108:111], v[88:91], v[184:187]
ds_read_b128 v[44:47], v4 offset:768
v_mfma_f32_16x16x32_bf16 v[180:183], v[108:111], v[84:87], v[180:183]
ds_read_b64_tr_b16 v[60:61], v13 offset:32768
v_mfma_f32_16x16x32_bf16 v[176:179], v[108:111], v[80:83], v[176:179]
ds_read_b64_tr_b16 v[62:63], v13 offset:36864
v_mfma_f32_16x16x32_bf16 v[144:147], v[100:103], v[80:83], v[144:147]
ds_read_b64_tr_b16 v[52:53], v14 offset:16384
v_mfma_f32_16x16x32_bf16 v[148:151], v[100:103], v[84:87], v[148:151]
ds_read_b64_tr_b16 v[54:55], v14 offset:20480
v_mfma_f32_16x16x32_bf16 v[152:155], v[100:103], v[88:91], v[152:155]
ds_read_b64_tr_b16 v[64:65], v14 offset:32768
v_mfma_f32_16x16x32_bf16 v[156:159], v[100:103], v[92:95], v[156:159]
ds_read_b64_tr_b16 v[66:67], v14 offset:36864
v_mfma_f32_16x16x32_bf16 v[204:207], v[112:115], v[92:95], v[204:207]
ds_read_b64_tr_b16 v[56:57], v15 offset:16384
v_mfma_f32_16x16x32_bf16 v[200:203], v[112:115], v[88:91], v[200:203]
ds_read_b64_tr_b16 v[58:59], v15 offset:20480
v_mfma_f32_16x16x32_bf16 v[196:199], v[112:115], v[84:87], v[196:199]
ds_read_b64_tr_b16 v[68:69], v15 offset:32768
v_mfma_f32_16x16x32_bf16 v[192:195], v[112:115], v[80:83], v[192:195]
ds_read_b64_tr_b16 v[70:71], v15 offset:36864
v_mfma_f32_16x16x32_bf16 v[160:163], v[104:107], v[80:83], v[160:163]
v_mfma_f32_16x16x32_bf16 v[164:167], v[104:107], v[84:87], v[164:167]
v_mfma_f32_16x16x32_bf16 v[168:171], v[104:107], v[88:91], v[168:171]
v_mfma_f32_16x16x32_bf16 v[172:175], v[104:107], v[92:95], v[172:175]
v_mfma_f32_16x16x32_bf16 v[220:223], v[116:119], v[92:95], v[220:223]
v_mfma_f32_16x16x32_bf16 v[216:219], v[116:119], v[88:91], v[216:219]
v_mfma_f32_16x16x32_bf16 v[212:215], v[116:119], v[84:87], v[212:215]
v_mfma_f32_16x16x32_bf16 v[208:211], v[116:119], v[80:83], v[208:211]
s_waitcnt lgkmcnt(0)
v_mfma_f32_16x16x32_bf16 v[128:131], v[48:51], v[32:35], v[128:131]
ds_read_b128 v[80:83], v4 offset:8192
v_mfma_f32_16x16x32_bf16 v[132:135], v[48:51], v[36:39], v[132:135]
ds_read_b64_tr_b16 v[96:97], v13 offset:24576
v_mfma_f32_16x16x32_bf16 v[136:139], v[48:51], v[40:43], v[136:139]
ds_read_b64_tr_b16 v[98:99], v13 offset:28672
v_mfma_f32_16x16x32_bf16 v[140:143], v[48:51], v[44:47], v[140:143]
ds_read_b128 v[84:87], v4 offset:8448
v_mfma_f32_16x16x32_bf16 v[188:191], v[60:63], v[44:47], v[188:191]
ds_read_b128 v[88:91], v4 offset:8704
v_mfma_f32_16x16x32_bf16 v[184:187], v[60:63], v[40:43], v[184:187]
ds_read_b128 v[92:95], v4 offset:8960
v_mfma_f32_16x16x32_bf16 v[180:183], v[60:63], v[36:39], v[180:183]
ds_read_b64_tr_b16 v[108:109], v13 offset:40960
v_mfma_f32_16x16x32_bf16 v[176:179], v[60:63], v[32:35], v[176:179]
ds_read_b64_tr_b16 v[110:111], v13 offset:45056
v_mfma_f32_16x16x32_bf16 v[144:147], v[52:55], v[32:35], v[144:147]
ds_read_b64_tr_b16 v[100:101], v14 offset:24576
v_mfma_f32_16x16x32_bf16 v[148:151], v[52:55], v[36:39], v[148:151]
ds_read_b64_tr_b16 v[102:103], v14 offset:28672
v_mfma_f32_16x16x32_bf16 v[152:155], v[52:55], v[40:43], v[152:155]
ds_read_b64_tr_b16 v[112:113], v14 offset:40960
v_mfma_f32_16x16x32_bf16 v[156:159], v[52:55], v[44:47], v[156:159]
ds_read_b64_tr_b16 v[114:115], v14 offset:45056
v_mfma_f32_16x16x32_bf16 v[204:207], v[64:67], v[44:47], v[204:207]
ds_read_b64_tr_b16 v[104:105], v15 offset:24576
v_mfma_f32_16x16x32_bf16 v[200:203], v[64:67], v[40:43], v[200:203]
ds_read_b64_tr_b16 v[106:107], v15 offset:28672
v_mfma_f32_16x16x32_bf16 v[196:199], v[64:67], v[36:39], v[196:199]
ds_read_b64_tr_b16 v[116:117], v15 offset:40960
v_mfma_f32_16x16x32_bf16 v[192:195], v[64:67], v[32:35], v[192:195]
ds_read_b64_tr_b16 v[118:119], v15 offset:45056
v_mfma_f32_16x16x32_bf16 v[160:163], v[56:59], v[32:35], v[160:163]
v_mfma_f32_16x16x32_bf16 v[164:167], v[56:59], v[36:39], v[164:167]
v_mfma_f32_16x16x32_bf16 v[168:171], v[56:59], v[40:43], v[168:171]
v_mfma_f32_16x16x32_bf16 v[172:175], v[56:59], v[44:47], v[172:175]
v_mfma_f32_16x16x32_bf16 v[220:223], v[68:71], v[44:47], v[220:223]
v_mfma_f32_16x16x32_bf16 v[216:219], v[68:71], v[40:43], v[216:219]
v_mfma_f32_16x16x32_bf16 v[212:215], v[68:71], v[36:39], v[212:215]
v_mfma_f32_16x16x32_bf16 v[208:211], v[68:71], v[32:35], v[208:211]
s_waitcnt lgkmcnt(0)
s_barrier
v_mfma_f32_16x16x32_bf16 v[128:131], v[96:99], v[80:83], v[128:131]
ds_read_b128 v[32:35], v2 offset:0
v_mfma_f32_16x16x32_bf16 v[132:135], v[96:99], v[84:87], v[132:135]
ds_read_b64_tr_b16 v[48:49], v5 offset:16384
v_mfma_f32_16x16x32_bf16 v[136:139], v[96:99], v[88:91], v[136:139]
ds_read_b64_tr_b16 v[50:51], v5 offset:20480
v_mfma_f32_16x16x32_bf16 v[140:143], v[96:99], v[92:95], v[140:143]
ds_read_b128 v[36:39], v2 offset:256
v_mfma_f32_16x16x32_bf16 v[188:191], v[108:111], v[92:95], v[188:191]
ds_read_b128 v[40:43], v2 offset:512
v_mfma_f32_16x16x32_bf16 v[184:187], v[108:111], v[88:91], v[184:187]
ds_read_b128 v[44:47], v2 offset:768
v_mfma_f32_16x16x32_bf16 v[180:183], v[108:111], v[84:87], v[180:183]
ds_read_b64_tr_b16 v[60:61], v5 offset:32768
v_mfma_f32_16x16x32_bf16 v[176:179], v[108:111], v[80:83], v[176:179]
ds_read_b64_tr_b16 v[62:63], v5 offset:36864
v_mfma_f32_16x16x32_bf16 v[144:147], v[100:103], v[80:83], v[144:147]
ds_read_b64_tr_b16 v[52:53], v6 offset:16384
v_mfma_f32_16x16x32_bf16 v[148:151], v[100:103], v[84:87], v[148:151]
ds_read_b64_tr_b16 v[54:55], v6 offset:20480
v_mfma_f32_16x16x32_bf16 v[152:155], v[100:103], v[88:91], v[152:155]
ds_read_b64_tr_b16 v[64:65], v6 offset:32768
v_mfma_f32_16x16x32_bf16 v[156:159], v[100:103], v[92:95], v[156:159]
ds_read_b64_tr_b16 v[66:67], v6 offset:36864
v_mfma_f32_16x16x32_bf16 v[204:207], v[112:115], v[92:95], v[204:207]
ds_read_b64_tr_b16 v[56:57], v7 offset:16384
v_mfma_f32_16x16x32_bf16 v[200:203], v[112:115], v[88:91], v[200:203]
ds_read_b64_tr_b16 v[58:59], v7 offset:20480
v_mfma_f32_16x16x32_bf16 v[196:199], v[112:115], v[84:87], v[196:199]
ds_read_b64_tr_b16 v[68:69], v7 offset:32768
v_mfma_f32_16x16x32_bf16 v[192:195], v[112:115], v[80:83], v[192:195]
ds_read_b64_tr_b16 v[70:71], v7 offset:36864
v_mfma_f32_16x16x32_bf16 v[160:163], v[104:107], v[80:83], v[160:163]
v_mfma_f32_16x16x32_bf16 v[164:167], v[104:107], v[84:87], v[164:167]
v_mfma_f32_16x16x32_bf16 v[168:171], v[104:107], v[88:91], v[168:171]
v_mfma_f32_16x16x32_bf16 v[172:175], v[104:107], v[92:95], v[172:175]
v_mfma_f32_16x16x32_bf16 v[220:223], v[116:119], v[92:95], v[220:223]
v_mfma_f32_16x16x32_bf16 v[216:219], v[116:119], v[88:91], v[216:219]
v_mfma_f32_16x16x32_bf16 v[212:215], v[116:119], v[84:87], v[212:215]
v_mfma_f32_16x16x32_bf16 v[208:211], v[116:119], v[80:83], v[208:211]
s_sub_u32 s41, s41, 1
s_cmp_lg_u32 s41, 0
s_cbranch_scc1 Lk3_157
s_waitcnt lgkmcnt(0)
v_mfma_f32_16x16x32_bf16 v[128:131], v[48:51], v[32:35], v[128:131]
ds_read_b128 v[80:83], v2 offset:8192
v_mfma_f32_16x16x32_bf16 v[132:135], v[48:51], v[36:39], v[132:135]
ds_read_b64_tr_b16 v[96:97], v5 offset:24576
v_mfma_f32_16x16x32_bf16 v[136:139], v[48:51], v[40:43], v[136:139]
ds_read_b64_tr_b16 v[98:99], v5 offset:28672
v_mfma_f32_16x16x32_bf16 v[140:143], v[48:51], v[44:47], v[140:143]
ds_read_b128 v[84:87], v2 offset:8448
v_mfma_f32_16x16x32_bf16 v[188:191], v[60:63], v[44:47], v[188:191]
ds_read_b128 v[88:91], v2 offset:8704
v_mfma_f32_16x16x32_bf16 v[184:187], v[60:63], v[40:43], v[184:187]
ds_read_b128 v[92:95], v2 offset:8960
v_mfma_f32_16x16x32_bf16 v[180:183], v[60:63], v[36:39], v[180:183]
ds_read_b64_tr_b16 v[108:109], v5 offset:40960
v_mfma_f32_16x16x32_bf16 v[176:179], v[60:63], v[32:35], v[176:179]
ds_read_b64_tr_b16 v[110:111], v5 offset:45056
v_mfma_f32_16x16x32_bf16 v[144:147], v[52:55], v[32:35], v[144:147]
ds_read_b64_tr_b16 v[100:101], v6 offset:24576
v_mfma_f32_16x16x32_bf16 v[148:151], v[52:55], v[36:39], v[148:151]
ds_read_b64_tr_b16 v[102:103], v6 offset:28672
v_mfma_f32_16x16x32_bf16 v[152:155], v[52:55], v[40:43], v[152:155]
ds_read_b64_tr_b16 v[112:113], v6 offset:40960
v_mfma_f32_16x16x32_bf16 v[156:159], v[52:55], v[44:47], v[156:159]
ds_read_b64_tr_b16 v[114:115], v6 offset:45056
v_mfma_f32_16x16x32_bf16 v[204:207], v[64:67], v[44:47], v[204:207]
ds_read_b64_tr_b16 v[104:105], v7 offset:24576
v_mfma_f32_16x16x32_bf16 v[200:203], v[64:67], v[40:43], v[200:203]
ds_read_b64_tr_b16 v[106:107], v7 offset:28672
v_mfma_f32_16x16x32_bf16 v[196:199], v[64:67], v[36:39], v[196:199]
ds_read_b64_tr_b16 v[116:117], v7 offset:40960
v_mfma_f32_16x16x32_bf16 v[192:195], v[64:67], v[32:35], v[192:195]
ds_read_b64_tr_b16 v[118:119], v7 offset:45056
v_mfma_f32_16x16x32_bf16 v[160:163], v[56:59], v[32:35], v[160:163]
v_mfma_f32_16x16x32_bf16 v[164:167], v[56:59], v[36:39], v[164:167]
v_mfma_f32_16x16x32_bf16 v[168:171], v[56:59], v[40:43], v[168:171]
v_mfma_f32_16x16x32_bf16 v[172:175], v[56:59], v[44:47], v[172:175]
v_mfma_f32_16x16x32_bf16 v[220:223], v[68:71], v[44:47], v[220:223]
v_mfma_f32_16x16x32_bf16 v[216:219], v[68:71], v[40:43], v[216:219]
v_mfma_f32_16x16x32_bf16 v[212:215], v[68:71], v[36:39], v[212:215]
v_mfma_f32_16x16x32_bf16 v[208:211], v[68:71], v[32:35], v[208:211]
s_waitcnt lgkmcnt(0)
s_barrier
s_cmp_eq_u32 s36, 7
s_cbranch_scc1 L7b_158
s_add_u32 m0, s39, 0
s_add_u32 s37, s37, s40
buffer_load_dwordx4 v21, s[8:11], s37 offen sc1 lds
v_mfma_f32_16x16x32_bf16 v[128:131], v[96:99], v[80:83], v[128:131]
v_mfma_f32_16x16x32_bf16 v[132:135], v[96:99], v[84:87], v[132:135]
s_add_u32 m0, s39, 1024
s_add_u32 s37, s37, s38
buffer_load_dwordx4 v21, s[8:11], s37 offen sc1 lds
v_mfma_f32_16x16x32_bf16 v[136:139], v[96:99], v[88:91], v[136:139]
s_add_u32 m0, s39, 2048
s_add_u32 s37, s37, s38
buffer_load_dwordx4 v21, s[8:11], s37 offen sc1 lds
v_mfma_f32_16x16x32_bf16 v[140:143], v[96:99], v[92:95], v[140:143]
v_mfma_f32_16x16x32_bf16 v[188:191], v[108:111], v[92:95], v[188:191]
s_add_u32 m0, s39, 3072
s_add_u32 s37, s37, s38
buffer_load_dwordx4 v21, s[8:11], s37 offen sc1 lds
v_mfma_f32_16x16x32_bf16 v[184:187], v[108:111], v[88:91], v[184:187]
s_add_u32 m0, s39, 4096
s_add_u32 s37, s37, s55
buffer_load_dwordx4 v21, s[8:11], s37 offen sc1 lds
v_mfma_f32_16x16x32_bf16 v[180:183], v[108:111], v[84:87], v[180:183]
v_mfma_f32_16x16x32_bf16 v[176:179], v[108:111], v[80:83], v[176:179]
s_add_u32 m0, s39, 5120
s_add_u32 s37, s37, s38
buffer_load_dwordx4 v21, s[8:11], s37 offen sc1 lds
v_mfma_f32_16x16x32_bf16 v[144:147], v[100:103], v[80:83], v[144:147]
s_add_u32 m0, s39, 6144
s_add_u32 s37, s37, s38
buffer_load_dwordx4 v21, s[8:11], s37 offen sc1 lds
v_mfma_f32_16x16x32_bf16 v[148:151], v[100:103], v[84:87], v[148:151]
v_mfma_f32_16x16x32_bf16 v[152:155], v[100:103], v[88:91], v[152:155]
s_add_u32 m0, s39, 7168
s_add_u32 s37, s37, s38
buffer_load_dwordx4 v21, s[8:11], s37 offen sc1 lds
v_mfma_f32_16x16x32_bf16 v[156:159], v[100:103], v[92:95], v[156:159]
s_add_u32 m0, s39, 32768
s_add_u32 s37, s37, s40
buffer_load_dwordx4 v21, s[8:11], s37 offen sc1 lds
v_mfma_f32_16x16x32_bf16 v[204:207], v[112:115], v[92:95], v[204:207]
v_mfma_f32_16x16x32_bf16 v[200:203], v[112:115], v[88:91], v[200:203]
s_add_u32 m0, s39, 33792
s_add_u32 s37, s37, s38
buffer_load_dwordx4 v21, s[8:11], s37 offen sc1 lds
v_mfma_f32_16x16x32_bf16 v[196:199], v[112:115], v[84:87], v[196:199]
s_add_u32 m0, s39, 34816
s_add_u32 s37, s37, s38
buffer_load_dwordx4 v21, s[8:11], s37 offen sc1 lds
v_mfma_f32_16x16x32_bf16 v[192:195], v[112:115], v[80:83], v[192:195]
v_mfma_f32_16x16x32_bf16 v[160:163], v[104:107], v[80:83], v[160:163]
s_add_u32 m0, s39, 35840
s_add_u32 s37, s37, s38
buffer_load_dwordx4 v21, s[8:11], s37 offen sc1 lds
v_mfma_f32_16x16x32_bf16 v[164:167], v[104:107], v[84:87], v[164:167]
s_add_u32 m0, s39, 36864
s_add_u32 s37, s37, s55
buffer_load_dwordx4 v21, s[8:11], s37 offen sc1 lds
v_mfma_f32_16x16x32_bf16 v[168:171], v[104:107], v[88:91], v[168:171]
v_mfma_f32_16x16x32_bf16 v[172:175], v[104:107], v[92:95], v[172:175]
s_add_u32 m0, s39, 37888
s_add_u32 s37, s37, s38
buffer_load_dwordx4 v21, s[8:11], s37 offen sc1 lds
v_mfma_f32_16x16x32_bf16 v[220:223], v[116:119], v[92:95], v[220:223]
s_add_u32 m0, s39, 38912
s_add_u32 s37, s37, s38
buffer_load_dwordx4 v21, s[8:11], s37 offen sc1 lds
v_mfma_f32_16x16x32_bf16 v[216:219], v[116:119], v[88:91], v[216:219]
v_mfma_f32_16x16x32_bf16 v[212:215], v[116:119], v[84:87], v[212:215]
s_add_u32 m0, s39, 39936
s_add_u32 s37, s37, s38
buffer_load_dwordx4 v21, s[8:11], s37 offen sc1 lds
v_mfma_f32_16x16x32_bf16 v[208:211], v[116:119], v[80:83], v[208:211]
s_setprio 0
s_barrier
s_add_u32 s37, s37, s54
s_add_u32 m0, s39, 65536
s_add_u32 s37, s37, s40
buffer_load_dwordx4 v21, s[8:11], s37 offen sc1 lds
v_mul_f32 v80, v128, v128
v_mul_f32 v81, v129, v129
v_mul_f32 v82, v130, v130
v_mul_f32 v83, v131, v131
v_fma_f32 v80, v80, v232, v228
v_fma_f32 v81, v81, v232, v228
v_fma_f32 v82, v82, v232, v228
s_add_u32 m0, s39, 66560
s_add_u32 s37, s37, s38
buffer_load_dwordx4 v21, s[8:11], s37 offen sc1 lds
v_fma_f32 v83, v83, v232, v228
v_mul_f32 v80, v80, v128
v_mul_f32 v81, v81, v129
v_mul_f32 v82, v82, v130
v_mul_f32 v83, v83, v131
v_exp_f32 v80, v80
s_add_u32 m0, s39, 67584
s_add_u32 s37, s37, s38
buffer_load_dwordx4 v21, s[8:11], s37 offen sc1 lds
v_exp_f32 v81, v81
v_exp_f32 v82, v82
v_exp_f32 v83, v83
v_mul_f32 v176, v128, v176
v_mul_f32 v177, v129, v177
v_mul_f32 v178, v130, v178
v_mul_f32 v179, v131, v179
s_add_u32 m0, s39, 68608
s_add_u32 s37, s37, s38
buffer_load_dwordx4 v21, s[8:11], s37 offen sc1 lds
v_fma_f32 v80, v80, v236, v236
v_fma_f32 v81, v81, v236, v236
v_fma_f32 v82, v82, v236, v236
v_fma_f32 v83, v83, v236, v236
v_rcp_f32 v80, v80
v_rcp_f32 v81, v81
s_add_u32 m0, s39, 69632
s_add_u32 s37, s37, s55
buffer_load_dwordx4 v21, s[8:11], s37 offen sc1 lds
v_rcp_f32 v82, v82
v_rcp_f32 v83, v83
v_mul_f32 v176, v176, v80
v_mul_f32 v177, v177, v81
v_mul_f32 v178, v178, v82
v_mul_f32 v179, v179, v83
v_cvt_pk_bf16_f32 v96, v176, v177
s_add_u32 m0, s39, 70656
s_add_u32 s37, s37, s38
buffer_load_dwordx4 v21, s[8:11], s37 offen sc1 lds
v_cvt_pk_bf16_f32 v97, v178, v179
v_mul_f32 v84, v144, v144
v_mul_f32 v85, v145, v145
v_mul_f32 v86, v146, v146
v_mul_f32 v87, v147, v147
v_fma_f32 v84, v84, v232, v228
s_add_u32 m0, s39, 71680
s_add_u32 s37, s37, s38
buffer_load_dwordx4 v21, s[8:11], s37 offen sc1 lds
v_fma_f32 v85, v85, v232, v228
v_fma_f32 v86, v86, v232, v228
v_fma_f32 v87, v87, v232, v228
v_mul_f32 v84, v84, v144
v_mul_f32 v85, v85, v145
v_mul_f32 v86, v86, v146
v_mul_f32 v87, v87, v147
s_add_u32 m0, s39, 72704
s_add_u32 s37, s37, s38
buffer_load_dwordx4 v21, s[8:11], s37 offen sc1 lds
v_exp_f32 v84, v84
v_exp_f32 v85, v85
v_exp_f32 v86, v86
v_exp_f32 v87, v87
v_mul_f32 v192, v144, v192
v_mul_f32 v193, v145, v193
s_waitcnt vmcnt(16)
s_barrier
s_add_u32 m0, s39, 98304
s_add_u32 s37, s37, s40
buffer_load_dwordx4 v21, s[8:11], s37 offen sc1 lds
v_mul_f32 v194, v146, v194
v_mul_f32 v195, v147, v195
v_fma_f32 v84, v84, v236, v236
v_fma_f32 v85, v85, v236, v236
v_fma_f32 v86, v86, v236, v236
v_fma_f32 v87, v87, v236, v236
v_rcp_f32 v84, v84
s_add_u32 m0, s39, 99328
s_add_u32 s37, s37, s38
buffer_load_dwordx4 v21, s[8:11], s37 offen sc1 lds
v_rcp_f32 v85, v85
v_rcp_f32 v86, v86
v_rcp_f32 v87, v87
v_mul_f32 v192, v192, v84
v_mul_f32 v193, v193, v85
v_mul_f32 v194, v194, v86
v_mul_f32 v195, v195, v87
s_add_u32 m0, s39, 100352
s_add_u32 s37, s37, s38
buffer_load_dwordx4 v21, s[8:11], s37 offen sc1 lds
v_cvt_pk_bf16_f32 v98, v192, v193
v_cvt_pk_bf16_f32 v99, v194, v195
v_mul_f32 v80, v160, v160
v_mul_f32 v81, v161, v161
v_mul_f32 v82, v162, v162
s_add_u32 m0, s39, 101376
s_add_u32 s37, s37, s38
buffer_load_dwordx4 v21, s[8:11], s37 offen sc1 lds
v_mul_f32 v83, v163, v163
v_fma_f32 v80, v80, v232, v228
v_fma_f32 v81, v81, v232, v228
v_fma_f32 v82, v82, v232, v228
v_fma_f32 v83, v83, v232, v228
v_mul_f32 v80, v80, v160
v_mul_f32 v81, v81, v161
s_add_u32 m0, s39, 102400
s_add_u32 s37, s37, s55
buffer_load_dwordx4 v21, s[8:11], s37 offen sc1 lds
v_mul_f32 v82, v82, v162
v_mul_f32 v83, v83, v163
v_exp_f32 v80, v80
v_exp_f32 v81, v81
v_exp_f32 v82, v82
v_exp_f32 v83, v83
v_mul_f32 v208, v160, v208
s_add_u32 m0, s39, 103424
s_add_u32 s37, s37, s38
buffer_load_dwordx4 v21, s[8:11], s37 offen sc1 lds
v_mul_f32 v209, v161, v209
v_mul_f32 v210, v162, v210
v_mul_f32 v211, v163, v211
v_fma_f32 v80, v80, v236, v236
v_fma_f32 v81, v81, v236, v236
v_fma_f32 v82, v82, v236, v236
s_add_u32 m0, s39, 104448
s_add_u32 s37, s37, s38
buffer_load_dwordx4 v21, s[8:11], s37 offen sc1 lds
v_fma_f32 v83, v83, v236, v236
v_rcp_f32 v80, v80
v_rcp_f32 v81, v81
v_rcp_f32 v82, v82
v_rcp_f32 v83, v83
v_mul_f32 v208, v208, v80
v_mul_f32 v209, v209, v81
s_add_u32 m0, s39, 105472
s_add_u32 s37, s37, s38
buffer_load_dwordx4 v21, s[8:11], s37 offen sc1 lds
v_mul_f32 v210, v210, v82
v_mul_f32 v211, v211, v83
v_cvt_pk_bf16_f32 v112, v208, v209
v_cvt_pk_bf16_f32 v113, v210, v211
v_mul_f32 v80, v132, v132
v_mul_f32 v81, v133, v133
buffer_store_dwordx4 v[96:99], v27, s[24:27], 0 offen offset:0 sc1
s_waitcnt vmcnt(17)
s_barrier
s_add_u32 m0, s39, 0
s_add_u32 s37, s37, s40
buffer_load_dwordx4 v21, s[8:11], s37 offen sc1 lds
v_mul_f32 v82, v134, v134
v_mul_f32 v83, v135, v135
v_fma_f32 v80, v80, v233, v229
v_fma_f32 v81, v81, v233, v229
v_fma_f32 v82, v82, v233, v229
v_fma_f32 v83, v83, v233, v229
v_mul_f32 v80, v80, v132
s_add_u32 m0, s39, 1024
s_add_u32 s37, s37, s38
buffer_load_dwordx4 v21, s[8:11], s37 offen sc1 lds
v_mul_f32 v81, v81, v133
v_mul_f32 v82, v82, v134
v_mul_f32 v83, v83, v135
v_exp_f32 v80, v80
v_exp_f32 v81, v81
v_exp_f32 v82, v82
s_add_u32 m0, s39, 2048
s_add_u32 s37, s37, s38
buffer_load_dwordx4 v21, s[8:11], s37 offen sc1 lds
v_exp_f32 v83, v83
v_mul_f32 v180, v132, v180
v_mul_f32 v181, v133, v181
v_mul_f32 v182, v134, v182
v_mul_f32 v183, v135, v183
v_fma_f32 v80, v80, v237, v237
v_fma_f32 v81, v81, v237, v237
s_add_u32 m0, s39, 3072
s_add_u32 s37, s37, s38
buffer_load_dwordx4 v21, s[8:11], s37 offen sc1 lds
v_fma_f32 v82, v82, v237, v237
v_fma_f32 v83, v83, v237, v237
v_rcp_f32 v80, v80
v_rcp_f32 v81, v81
v_rcp_f32 v82, v82
v_rcp_f32 v83, v83
s_add_u32 m0, s39, 4096
s_add_u32 s37, s37, s55
buffer_load_dwordx4 v21, s[8:11], s37 offen sc1 lds
v_mul_f32 v180, v180, v80
v_mul_f32 v181, v181, v81
v_mul_f32 v182, v182, v82
v_mul_f32 v183, v183, v83
v_cvt_pk_bf16_f32 v100, v180, v181
v_cvt_pk_bf16_f32 v101, v182, v183
v_mul_f32 v84, v148, v148
s_add_u32 m0, s39, 5120
s_add_u32 s37, s37, s38
buffer_load_dwordx4 v21, s[8:11], s37 offen sc1 lds
v_mul_f32 v85, v149, v149
v_mul_f32 v86, v150, v150
v_mul_f32 v87, v151, v151
v_fma_f32 v84, v84, v233, v229
v_fma_f32 v85, v85, v233, v229
v_fma_f32 v86, v86, v233, v229
s_add_u32 m0, s39, 6144
s_add_u32 s37, s37, s38
buffer_load_dwordx4 v21, s[8:11], s37 offen sc1 lds
v_fma_f32 v87, v87, v233, v229
v_mul_f32 v84, v84, v148
v_mul_f32 v85, v85, v149
v_mul_f32 v86, v86, v150
v_mul_f32 v87, v87, v151
v_exp_f32 v84, v84
v_exp_f32 v85, v85
s_add_u32 m0, s39, 7168
s_add_u32 s37, s37, s38
buffer_load_dwordx4 v21, s[8:11], s37 offen sc1 lds
v_exp_f32 v86, v86
v_exp_f32 v87, v87
v_mul_f32 v196, v148, v196
v_mul_f32 v197, v149, v197
v_mul_f32 v198, v150, v198
v_mul_f32 v199, v151, v199
s_waitcnt vmcnt(17)
s_barrier
s_add_u32 m0, s39, 32768
s_add_u32 s37, s37, s40
buffer_load_dwordx4 v21, s[8:11], s37 offen sc1 lds
v_fma_f32 v84, v84, v237, v237
v_fma_f32 v85, v85, v237, v237
v_fma_f32 v86, v86, v237, v237
v_fma_f32 v87, v87, v237, v237
v_rcp_f32 v84, v84
v_rcp_f32 v85, v85
v_rcp_f32 v86, v86
s_add_u32 m0, s39, 33792
s_add_u32 s37, s37, s38
buffer_load_dwordx4 v21, s[8:11], s37 offen sc1 lds
v_rcp_f32 v87, v87
v_mul_f32 v196, v196, v84
v_mul_f32 v197, v197, v85
v_mul_f32 v198, v198, v86
v_mul_f32 v199, v199, v87
v_cvt_pk_bf16_f32 v102, v196, v197
v_cvt_pk_bf16_f32 v103, v198, v199
s_add_u32 m0, s39, 34816
s_add_u32 s37, s37, s38
buffer_load_dwordx4 v21, s[8:11], s37 offen sc1 lds
v_mul_f32 v80, v164, v164
v_mul_f32 v81, v165, v165
v_mul_f32 v82, v166, v166
v_mul_f32 v83, v167, v167
v_fma_f32 v80, v80, v233, v229
s_add_u32 m0, s39, 35840
s_add_u32 s37, s37, s38
buffer_load_dwordx4 v21, s[8:11], s37 offen sc1 lds
v_fma_f32 v81, v81, v233, v229
v_fma_f32 v82, v82, v233, v229
v_fma_f32 v83, v83, v233, v229
v_mul_f32 v80, v80, v164
v_mul_f32 v81, v81, v165
v_mul_f32 v82, v82, v166
v_mul_f32 v83, v83, v167
s_add_u32 m0, s39, 36864
s_add_u32 s37, s37, s55
buffer_load_dwordx4 v21, s[8:11], s37 offen sc1 lds
v_exp_f32 v80, v80
v_exp_f32 v81, v81
v_exp_f32 v82, v82
v_exp_f32 v83, v83
v_mul_f32 v212, v164, v212
v_mul_f32 v213, v165, v213
v_mul_f32 v214, v166, v214
s_add_u32 m0, s39, 37888
s_add_u32 s37, s37, s38
buffer_load_dwordx4 v21, s[8:11], s37 offen sc1 lds
v_mul_f32 v215, v167, v215
v_fma_f32 v80, v80, v237, v237
v_fma_f32 v81, v81, v237, v237
v_fma_f32 v82, v82, v237, v237
v_fma_f32 v83, v83, v237, v237
v_rcp_f32 v80, v80
s_add_u32 m0, s39, 38912
s_add_u32 s37, s37, s38
buffer_load_dwordx4 v21, s[8:11], s37 offen sc1 lds
v_rcp_f32 v81, v81
v_rcp_f32 v82, v82
v_rcp_f32 v83, v83
v_mul_f32 v212, v212, v80
v_mul_f32 v213, v213, v81
v_mul_f32 v214, v214, v82
v_mul_f32 v215, v215, v83
s_add_u32 m0, s39, 39936
s_add_u32 s37, s37, s38
buffer_load_dwordx4 v21, s[8:11], s37 offen sc1 lds
v_cvt_pk_bf16_f32 v114, v212, v213
v_cvt_pk_bf16_f32 v115, v214, v215
s_nop 1
v_permlane32_swap_b32 v112, v114
v_permlane32_swap_b32 v113, v115
buffer_store_dwordx4 v[100:103], v27, s[24:27], 0 offen offset:256 sc1
buffer_store_dwordx4 v[112:115], v28, s[24:27], 0 offen offset:0 sc1
s_waitcnt vmcnt(19)
s_barrier
s_add_u32 m0, s39, 65536
s_add_u32 s37, s37, s40
buffer_load_dwordx4 v21, s[8:11], s37 offen sc1 lds
v_mul_f32 v80, v136, v136
v_mul_f32 v81, v137, v137
v_mul_f32 v82, v138, v138
v_mul_f32 v83, v139, v139
v_fma_f32 v80, v80, v234, v230
v_fma_f32 v81, v81, v234, v230
v_fma_f32 v82, v82, v234, v230
s_add_u32 m0, s39, 66560
s_add_u32 s37, s37, s38
buffer_load_dwordx4 v21, s[8:11], s37 offen sc1 lds
v_fma_f32 v83, v83, v234, v230
v_mul_f32 v80, v80, v136
v_mul_f32 v81, v81, v137
v_mul_f32 v82, v82, v138
v_mul_f32 v83, v83, v139
v_exp_f32 v80, v80
s_add_u32 m0, s39, 67584
s_add_u32 s37, s37, s38
buffer_load_dwordx4 v21, s[8:11], s37 offen sc1 lds
v_exp_f32 v81, v81
v_exp_f32 v82, v82
v_exp_f32 v83, v83
v_mul_f32 v184, v136, v184
v_mul_f32 v185, v137, v185
v_mul_f32 v186, v138, v186
v_mul_f32 v187, v139, v187
s_add_u32 m0, s39, 68608
s_add_u32 s37, s37, s38
buffer_load_dwordx4 v21, s[8:11], s37 offen sc1 lds
v_fma_f32 v80, v80, v238, v238
v_fma_f32 v81, v81, v238, v238
v_fma_f32 v82, v82, v238, v238
v_fma_f32 v83, v83, v238, v238
v_rcp_f32 v80, v80
v_rcp_f32 v81, v81
s_add_u32 m0, s39, 69632
s_add_u32 s37, s37, s55
buffer_load_dwordx4 v21, s[8:11], s37 offen sc1 lds
v_rcp_f32 v82, v82
v_rcp_f32 v83, v83
v_mul_f32 v184, v184, v80
v_mul_f32 v185, v185, v81
v_mul_f32 v186, v186, v82
v_mul_f32 v187, v187, v83
v_cvt_pk_bf16_f32 v104, v184, v185
s_add_u32 m0, s39, 70656
s_add_u32 s37, s37, s38
buffer_load_dwordx4 v21, s[8:11], s37 offen sc1 lds
v_cvt_pk_bf16_f32 v105, v186, v187
v_mul_f32 v84, v152, v152
v_mul_f32 v85, v153, v153
v_mul_f32 v86, v154, v154
v_mul_f32 v87, v155, v155
v_fma_f32 v84, v84, v234, v230
s_add_u32 m0, s39, 71680
s_add_u32 s37, s37, s38
buffer_load_dwordx4 v21, s[8:11], s37 offen sc1 lds
v_fma_f32 v85, v85, v234, v230
v_fma_f32 v86, v86, v234, v230
v_fma_f32 v87, v87, v234, v230
v_mul_f32 v84, v84, v152
v_mul_f32 v85, v85, v153
v_mul_f32 v86, v86, v154
v_mul_f32 v87, v87, v155
s_add_u32 m0, s39, 72704
s_add_u32 s37, s37, s38
buffer_load_dwordx4 v21, s[8:11], s37 offen sc1 lds
v_exp_f32 v84, v84
v_exp_f32 v85, v85
v_exp_f32 v86, v86
v_exp_f32 v87, v87
v_mul_f32 v200, v152, v200
v_mul_f32 v201, v153, v201
s_waitcnt vmcnt(18)
s_barrier
s_add_u32 m0, s39, 98304
s_add_u32 s37, s37, s40
buffer_load_dwordx4 v21, s[8:11], s37 offen sc1 lds
v_mul_f32 v202, v154, v202
v_mul_f32 v203, v155, v203
v_fma_f32 v84, v84, v238, v238
v_fma_f32 v85, v85, v238, v238
v_fma_f32 v86, v86, v238, v238
v_fma_f32 v87, v87, v238, v238
v_rcp_f32 v84, v84
s_add_u32 m0, s39, 99328
s_add_u32 s37, s37, s38
buffer_load_dwordx4 v21, s[8:11], s37 offen sc1 lds
v_rcp_f32 v85, v85
v_rcp_f32 v86, v86
v_rcp_f32 v87, v87
v_mul_f32 v200, v200, v84
v_mul_f32 v201, v201, v85
v_mul_f32 v202, v202, v86
v_mul_f32 v203, v203, v87
s_add_u32 m0, s39, 100352
s_add_u32 s37, s37, s38
buffer_load_dwordx4 v21, s[8:11], s37 offen sc1 lds
v_cvt_pk_bf16_f32 v106, v200, v201
v_cvt_pk_bf16_f32 v107, v202, v203
v_mul_f32 v80, v168, v168
v_mul_f32 v81, v169, v169
v_mul_f32 v82, v170, v170
s_add_u32 m0, s39, 101376
s_add_u32 s37, s37, s38
buffer_load_dwordx4 v21, s[8:11], s37 offen sc1 lds
v_mul_f32 v83, v171, v171
v_fma_f32 v80, v80, v234, v230
v_fma_f32 v81, v81, v234, v230
v_fma_f32 v82, v82, v234, v230
v_fma_f32 v83, v83, v234, v230
v_mul_f32 v80, v80, v168
v_mul_f32 v81, v81, v169
s_add_u32 m0, s39, 102400
s_add_u32 s37, s37, s55
buffer_load_dwordx4 v21, s[8:11], s37 offen sc1 lds
v_mul_f32 v82, v82, v170
v_mul_f32 v83, v83, v171
v_exp_f32 v80, v80
v_exp_f32 v81, v81
v_exp_f32 v82, v82
v_exp_f32 v83, v83
v_mul_f32 v216, v168, v216
s_add_u32 m0, s39, 103424
s_add_u32 s37, s37, s38
buffer_load_dwordx4 v21, s[8:11], s37 offen sc1 lds
v_mul_f32 v217, v169, v217
v_mul_f32 v218, v170, v218
v_mul_f32 v219, v171, v219
v_fma_f32 v80, v80, v238, v238
v_fma_f32 v81, v81, v238, v238
v_fma_f32 v82, v82, v238, v238
s_add_u32 m0, s39, 104448
s_add_u32 s37, s37, s38
buffer_load_dwordx4 v21, s[8:11], s37 offen sc1 lds
v_fma_f32 v83, v83, v238, v238
v_rcp_f32 v80, v80
v_rcp_f32 v81, v81
v_rcp_f32 v82, v82
v_rcp_f32 v83, v83
v_mul_f32 v216, v216, v80
v_mul_f32 v217, v217, v81
s_add_u32 m0, s39, 105472
s_add_u32 s37, s37, s38
buffer_load_dwordx4 v21, s[8:11], s37 offen sc1 lds
v_mul_f32 v218, v218, v82
v_mul_f32 v219, v219, v83
v_cvt_pk_bf16_f32 v116, v216, v217
v_cvt_pk_bf16_f32 v117, v218, v219
v_mul_f32 v80, v140, v140
v_mul_f32 v81, v141, v141
buffer_store_dwordx4 v[104:107], v27, s[24:27], 0 offen offset:512 sc1
s_waitcnt vmcnt(19)
s_barrier
s_add_u32 s37, s37, s29
s_add_u32 m0, s39, 0
s_add_u32 s37, s37, s40
buffer_load_dwordx4 v21, s[8:11], s37 offen sc1 lds
v_mul_f32 v82, v142, v142
v_mul_f32 v83, v143, v143
v_fma_f32 v80, v80, v235, v231
v_fma_f32 v81, v81, v235, v231
v_fma_f32 v82, v82, v235, v231
v_fma_f32 v83, v83, v235, v231
v_mul_f32 v80, v80, v140
s_add_u32 m0, s39, 1024
s_add_u32 s37, s37, s38
buffer_load_dwordx4 v21, s[8:11], s37 offen sc1 lds
v_mul_f32 v81, v81, v141
v_mul_f32 v82, v82, v142
v_mul_f32 v83, v83, v143
v_exp_f32 v80, v80
v_exp_f32 v81, v81
v_exp_f32 v82, v82
s_add_u32 m0, s39, 2048
s_add_u32 s37, s37, s38
buffer_load_dwordx4 v21, s[8:11], s37 offen sc1 lds
v_exp_f32 v83, v83
v_mul_f32 v188, v140, v188
v_mul_f32 v189, v141, v189
v_mul_f32 v190, v142, v190
v_mul_f32 v191, v143, v191
v_fma_f32 v80, v80, v239, v239
v_fma_f32 v81, v81, v239, v239
s_add_u32 m0, s39, 3072
s_add_u32 s37, s37, s38
buffer_load_dwordx4 v21, s[8:11], s37 offen sc1 lds
v_fma_f32 v82, v82, v239, v239
v_fma_f32 v83, v83, v239, v239
v_rcp_f32 v80, v80
v_rcp_f32 v81, v81
v_rcp_f32 v82, v82
v_rcp_f32 v83, v83
s_add_u32 m0, s39, 4096
s_add_u32 s37, s37, s55
buffer_load_dwordx4 v21, s[8:11], s37 offen sc1 lds
v_mul_f32 v188, v188, v80
v_mul_f32 v189, v189, v81
v_mul_f32 v190, v190, v82
v_mul_f32 v191, v191, v83
v_cvt_pk_bf16_f32 v108, v188, v189
v_cvt_pk_bf16_f32 v109, v190, v191
v_mul_f32 v84, v156, v156
s_add_u32 m0, s39, 5120
s_add_u32 s37, s37, s38
buffer_load_dwordx4 v21, s[8:11], s37 offen sc1 lds
v_mul_f32 v85, v157, v157
v_mul_f32 v86, v158, v158
v_mul_f32 v87, v159, v159
v_fma_f32 v84, v84, v235, v231
v_fma_f32 v85, v85, v235, v231
v_fma_f32 v86, v86, v235, v231
s_add_u32 m0, s39, 6144
s_add_u32 s37, s37, s38
buffer_load_dwordx4 v21, s[8:11], s37 offen sc1 lds
v_fma_f32 v87, v87, v235, v231
v_mul_f32 v84, v84, v156
v_mul_f32 v85, v85, v157
v_mul_f32 v86, v86, v158
v_mul_f32 v87, v87, v159
v_exp_f32 v84, v84
v_exp_f32 v85, v85
s_add_u32 m0, s39, 7168
s_add_u32 s37, s37, s38
buffer_load_dwordx4 v21, s[8:11], s37 offen sc1 lds
v_exp_f32 v86, v86
v_exp_f32 v87, v87
v_mul_f32 v204, v156, v204
v_mul_f32 v205, v157, v205
v_mul_f32 v206, v158, v206
v_mul_f32 v207, v159, v207
s_waitcnt vmcnt(17)
s_barrier
s_add_u32 m0, s39, 32768
s_add_u32 s37, s37, s40
buffer_load_dwordx4 v21, s[8:11], s37 offen sc1 lds
v_fma_f32 v84, v84, v239, v239
v_fma_f32 v85, v85, v239, v239
v_fma_f32 v86, v86, v239, v239
v_fma_f32 v87, v87, v239, v239
v_rcp_f32 v84, v84
v_rcp_f32 v85, v85
v_rcp_f32 v86, v86
s_add_u32 m0, s39, 33792
s_add_u32 s37, s37, s38
buffer_load_dwordx4 v21, s[8:11], s37 offen sc1 lds
v_rcp_f32 v87, v87
v_mul_f32 v204, v204, v84
v_mul_f32 v205, v205, v85
v_mul_f32 v206, v206, v86
v_mul_f32 v207, v207, v87
v_cvt_pk_bf16_f32 v110, v204, v205
v_cvt_pk_bf16_f32 v111, v206, v207
s_add_u32 m0, s39, 34816
s_add_u32 s37, s37, s38
buffer_load_dwordx4 v21, s[8:11], s37 offen sc1 lds
v_mul_f32 v80, v172, v172
v_mul_f32 v81, v173, v173
v_mul_f32 v82, v174, v174
v_mul_f32 v83, v175, v175
v_fma_f32 v80, v80, v235, v231
s_add_u32 m0, s39, 35840
s_add_u32 s37, s37, s38
buffer_load_dwordx4 v21, s[8:11], s37 offen sc1 lds
v_fma_f32 v81, v81, v235, v231
v_fma_f32 v82, v82, v235, v231
v_fma_f32 v83, v83, v235, v231
v_mul_f32 v80, v80, v172
v_mul_f32 v81, v81, v173
v_mul_f32 v82, v82, v174
v_mul_f32 v83, v83, v175
s_add_u32 m0, s39, 36864
s_add_u32 s37, s37, s55
buffer_load_dwordx4 v21, s[8:11], s37 offen sc1 lds
v_exp_f32 v80, v80
v_exp_f32 v81, v81
v_exp_f32 v82, v82
v_exp_f32 v83, v83
v_mul_f32 v220, v172, v220
v_mul_f32 v221, v173, v221
v_mul_f32 v222, v174, v222
s_add_u32 m0, s39, 37888
s_add_u32 s37, s37, s38
buffer_load_dwordx4 v21, s[8:11], s37 offen sc1 lds
v_mul_f32 v223, v175, v223
v_fma_f32 v80, v80, v239, v239
v_fma_f32 v81, v81, v239, v239
v_fma_f32 v82, v82, v239, v239
v_fma_f32 v83, v83, v239, v239
v_rcp_f32 v80, v80
s_add_u32 m0, s39, 38912
s_add_u32 s37, s37, s38
buffer_load_dwordx4 v21, s[8:11], s37 offen sc1 lds
v_rcp_f32 v81, v81
v_rcp_f32 v82, v82
v_rcp_f32 v83, v83
v_mul_f32 v220, v220, v80
v_mul_f32 v221, v221, v81
v_mul_f32 v222, v222, v82
v_mul_f32 v223, v223, v83
s_add_u32 m0, s39, 39936
s_add_u32 s37, s37, s38
buffer_load_dwordx4 v21, s[8:11], s37 offen sc1 lds
v_cvt_pk_bf16_f32 v118, v220, v221
v_cvt_pk_bf16_f32 v119, v222, v223
s_nop 1
v_permlane32_swap_b32 v116, v118
v_permlane32_swap_b32 v117, v119
buffer_store_dwordx4 v[108:111], v27, s[24:27], 0 offen offset:768 sc1
buffer_store_dwordx4 v[116:119], v28, s[24:27], 0 offen offset:512 sc1
s_waitcnt vmcnt(19)
s_barrier
s_add_u32 m0, s39, 65536
s_add_u32 s37, s37, s40
buffer_load_dwordx4 v21, s[8:11], s37 offen sc1 lds
s_add_u32 m0, s39, 66560
s_add_u32 s37, s37, s38
buffer_load_dwordx4 v21, s[8:11], s37 offen sc1 lds
s_add_u32 m0, s39, 67584
s_add_u32 s37, s37, s38
buffer_load_dwordx4 v21, s[8:11], s37 offen sc1 lds
s_add_u32 m0, s39, 68608
s_add_u32 s37, s37, s38
buffer_load_dwordx4 v21, s[8:11], s37 offen sc1 lds
s_add_u32 m0, s39, 69632
s_add_u32 s37, s37, s55
buffer_load_dwordx4 v21, s[8:11], s37 offen sc1 lds
s_add_u32 m0, s39, 70656
s_add_u32 s37, s37, s38
buffer_load_dwordx4 v21, s[8:11], s37 offen sc1 lds
s_add_u32 m0, s39, 71680
s_add_u32 s37, s37, s38
buffer_load_dwordx4 v21, s[8:11], s37 offen sc1 lds
s_add_u32 m0, s39, 72704
s_add_u32 s37, s37, s38
buffer_load_dwordx4 v21, s[8:11], s37 offen sc1 lds
s_waitcnt vmcnt(8)
s_barrier
s_add_u32 m0, s39, 98304
s_add_u32 s37, s37, s40
buffer_load_dwordx4 v21, s[8:11], s37 offen sc1 lds
s_add_u32 m0, s39, 99328
s_add_u32 s37, s37, s38
buffer_load_dwordx4 v21, s[8:11], s37 offen sc1 lds
s_add_u32 m0, s39, 100352
s_add_u32 s37, s37, s38
buffer_load_dwordx4 v21, s[8:11], s37 offen sc1 lds
s_add_u32 m0, s39, 101376
s_add_u32 s37, s37, s38
buffer_load_dwordx4 v21, s[8:11], s37 offen sc1 lds
s_add_u32 m0, s39, 102400
s_add_u32 s37, s37, s55
buffer_load_dwordx4 v21, s[8:11], s37 offen sc1 lds
s_add_u32 m0, s39, 103424
s_add_u32 s37, s37, s38
buffer_load_dwordx4 v21, s[8:11], s37 offen sc1 lds
s_add_u32 m0, s39, 104448
s_add_u32 s37, s37, s38
buffer_load_dwordx4 v21, s[8:11], s37 offen sc1 lds
s_add_u32 m0, s39, 105472
s_add_u32 s37, s37, s38
buffer_load_dwordx4 v21, s[8:11], s37 offen sc1 lds
s_waitcnt vmcnt(18)
s_barrier
s_add_u32 m0, s39, 0
s_add_u32 s37, s37, s40
buffer_load_dwordx4 v21, s[8:11], s37 offen sc1 lds
s_add_u32 m0, s39, 1024
s_add_u32 s37, s37, s38
buffer_load_dwordx4 v21, s[8:11], s37 offen sc1 lds
s_add_u32 m0, s39, 2048
s_add_u32 s37, s37, s38
buffer_load_dwordx4 v21, s[8:11], s37 offen sc1 lds
s_add_u32 m0, s39, 3072
s_add_u32 s37, s37, s38
buffer_load_dwordx4 v21, s[8:11], s37 offen sc1 lds
s_add_u32 m0, s39, 4096
s_add_u32 s37, s37, s55
buffer_load_dwordx4 v21, s[8:11], s37 offen sc1 lds
s_add_u32 m0, s39, 5120
s_add_u32 s37, s37, s38
buffer_load_dwordx4 v21, s[8:11], s37 offen sc1 lds
s_add_u32 m0, s39, 6144
s_add_u32 s37, s37, s38
buffer_load_dwordx4 v21, s[8:11], s37 offen sc1 lds
s_add_u32 m0, s39, 7168
s_add_u32 s37, s37, s38
buffer_load_dwordx4 v21, s[8:11], s37 offen sc1 lds
s_waitcnt vmcnt(16)
s_barrier
s_add_u32 m0, s39, 32768
s_add_u32 s37, s37, s40
buffer_load_dwordx4 v21, s[8:11], s37 offen sc1 lds
s_add_u32 m0, s39, 33792
s_add_u32 s37, s37, s38
buffer_load_dwordx4 v21, s[8:11], s37 offen sc1 lds
s_add_u32 m0, s39, 34816
s_add_u32 s37, s37, s38
buffer_load_dwordx4 v21, s[8:11], s37 offen sc1 lds
s_add_u32 m0, s39, 35840
s_add_u32 s37, s37, s38
buffer_load_dwordx4 v21, s[8:11], s37 offen sc1 lds
s_add_u32 m0, s39, 36864
s_add_u32 s37, s37, s55
buffer_load_dwordx4 v21, s[8:11], s37 offen sc1 lds
s_add_u32 m0, s39, 37888
s_add_u32 s37, s37, s38
buffer_load_dwordx4 v21, s[8:11], s37 offen sc1 lds
s_add_u32 m0, s39, 38912
s_add_u32 s37, s37, s38
buffer_load_dwordx4 v21, s[8:11], s37 offen sc1 lds
s_add_u32 m0, s39, 39936
s_add_u32 s37, s37, s38
buffer_load_dwordx4 v21, s[8:11], s37 offen sc1 lds
s_waitcnt vmcnt(16)
s_barrier
s_add_u32 m0, s39, 65536
s_add_u32 s37, s37, s40
buffer_load_dwordx4 v21, s[8:11], s37 offen sc1 lds
s_add_u32 m0, s39, 66560
s_add_u32 s37, s37, s38
buffer_load_dwordx4 v21, s[8:11], s37 offen sc1 lds
s_add_u32 m0, s39, 67584
s_add_u32 s37, s37, s38
buffer_load_dwordx4 v21, s[8:11], s37 offen sc1 lds
s_add_u32 m0, s39, 68608
s_add_u32 s37, s37, s38
buffer_load_dwordx4 v21, s[8:11], s37 offen sc1 lds
s_add_u32 m0, s39, 69632
s_add_u32 s37, s37, s55
buffer_load_dwordx4 v21, s[8:11], s37 offen sc1 lds
s_add_u32 m0, s39, 70656
s_add_u32 s37, s37, s38
buffer_load_dwordx4 v21, s[8:11], s37 offen sc1 lds
s_add_u32 m0, s39, 71680
s_add_u32 s37, s37, s38
buffer_load_dwordx4 v21, s[8:11], s37 offen sc1 lds
s_add_u32 m0, s39, 72704
s_add_u32 s37, s37, s38
buffer_load_dwordx4 v21, s[8:11], s37 offen sc1 lds
s_waitcnt vmcnt(16)
s_barrier
s_add_u32 m0, s39, 98304
s_add_u32 s37, s37, s40
buffer_load_dwordx4 v21, s[8:11], s37 offen sc1 lds
s_add_u32 m0, s39, 99328
s_add_u32 s37, s37, s38
buffer_load_dwordx4 v21, s[8:11], s37 offen sc1 lds
s_add_u32 m0, s39, 100352
s_add_u32 s37, s37, s38
buffer_load_dwordx4 v21, s[8:11], s37 offen sc1 lds
s_add_u32 m0, s39, 101376
s_add_u32 s37, s37, s38
buffer_load_dwordx4 v21, s[8:11], s37 offen sc1 lds
s_add_u32 m0, s39, 102400
s_add_u32 s37, s37, s55
buffer_load_dwordx4 v21, s[8:11], s37 offen sc1 lds
s_add_u32 m0, s39, 103424
s_add_u32 s37, s37, s38
buffer_load_dwordx4 v21, s[8:11], s37 offen sc1 lds
s_add_u32 m0, s39, 104448
s_add_u32 s37, s37, s38
buffer_load_dwordx4 v21, s[8:11], s37 offen sc1 lds
s_add_u32 m0, s39, 105472
s_add_u32 s37, s37, s38
buffer_load_dwordx4 v21, s[8:11], s37 offen sc1 lds
s_waitcnt vmcnt(16)
s_barrier
s_cmp_eq_u32 s51, 2
s_cbranch_scc1 LW4_159
s_mul_i32 s40, s53, 98304
s_add_u32 m0, s39, 0
s_add_u32 s37, s40, 524288
buffer_load_dwordx4 v21, s[8:11], s37 offen sc1 lds
s_add_u32 m0, s39, 1024
s_add_u32 s37, s40, 525312
buffer_load_dwordx4 v21, s[8:11], s37 offen sc1 lds
s_add_u32 m0, s39, 2048
s_add_u32 s37, s40, 526336
buffer_load_dwordx4 v21, s[8:11], s37 offen sc1 lds
s_add_u32 m0, s39, 3072
s_add_u32 s37, s40, 527360
buffer_load_dwordx4 v21, s[8:11], s37 offen sc1 lds
s_add_u32 m0, s39, 4096
s_add_u32 s37, s40, 528384
buffer_load_dwordx4 v21, s[8:11], s37 offen sc1 lds
s_add_u32 m0, s39, 5120
s_add_u32 s37, s40, 529408
buffer_load_dwordx4 v21, s[8:11], s37 offen sc1 lds
s_add_u32 m0, s39, 6144
s_add_u32 s37, s40, 530432
buffer_load_dwordx4 v21, s[8:11], s37 offen sc1 lds
s_add_u32 m0, s39, 7168
s_add_u32 s37, s40, 531456
buffer_load_dwordx4 v21, s[8:11], s37 offen sc1 lds
s_waitcnt vmcnt(16)
s_barrier
s_add_u32 m0, s39, 32768
s_add_u32 s37, s40, 540672
buffer_load_dwordx4 v21, s[8:11], s37 offen sc1 lds
s_add_u32 m0, s39, 33792
s_add_u32 s37, s40, 541696
buffer_load_dwordx4 v21, s[8:11], s37 offen sc1 lds
s_add_u32 m0, s39, 34816
s_add_u32 s37, s40, 542720
buffer_load_dwordx4 v21, s[8:11], s37 offen sc1 lds
s_add_u32 m0, s39, 35840
s_add_u32 s37, s40, 543744
buffer_load_dwordx4 v21, s[8:11], s37 offen sc1 lds
s_add_u32 m0, s39, 36864
s_add_u32 s37, s40, 544768
buffer_load_dwordx4 v21, s[8:11], s37 offen sc1 lds
s_add_u32 m0, s39, 37888
s_add_u32 s37, s40, 545792
buffer_load_dwordx4 v21, s[8:11], s37 offen sc1 lds
s_add_u32 m0, s39, 38912
s_add_u32 s37, s40, 546816
buffer_load_dwordx4 v21, s[8:11], s37 offen sc1 lds
s_add_u32 m0, s39, 39936
s_add_u32 s37, s40, 547840
buffer_load_dwordx4 v21, s[8:11], s37 offen sc1 lds
s_waitcnt vmcnt(16)
s_barrier
s_add_u32 m0, s39, 65536
s_add_u32 s37, s40, 557056
buffer_load_dwordx4 v21, s[8:11], s37 offen sc1 lds
s_add_u32 m0, s39, 66560
s_add_u32 s37, s40, 558080
buffer_load_dwordx4 v21, s[8:11], s37 offen sc1 lds
s_add_u32 m0, s39, 67584
s_add_u32 s37, s40, 559104
buffer_load_dwordx4 v21, s[8:11], s37 offen sc1 lds
s_add_u32 m0, s39, 68608
s_add_u32 s37, s40, 560128
buffer_load_dwordx4 v21, s[8:11], s37 offen sc1 lds
s_add_u32 m0, s39, 69632
s_add_u32 s37, s40, 561152
buffer_load_dwordx4 v21, s[8:11], s37 offen sc1 lds
s_add_u32 m0, s39, 70656
s_add_u32 s37, s40, 562176
buffer_load_dwordx4 v21, s[8:11], s37 offen sc1 lds
s_add_u32 m0, s39, 71680
s_add_u32 s37, s40, 563200
buffer_load_dwordx4 v21, s[8:11], s37 offen sc1 lds
s_add_u32 m0, s39, 72704
s_add_u32 s37, s40, 564224
buffer_load_dwordx4 v21, s[8:11], s37 offen sc1 lds
s_waitcnt vmcnt(16)
s_barrier
s_add_u32 m0, s39, 98304
s_add_u32 s37, s40, 573440
buffer_load_dwordx4 v21, s[8:11], s37 offen sc1 lds
s_add_u32 m0, s39, 99328
s_add_u32 s37, s40, 574464
buffer_load_dwordx4 v21, s[8:11], s37 offen sc1 lds
s_add_u32 m0, s39, 100352
s_add_u32 s37, s40, 575488
buffer_load_dwordx4 v21, s[8:11], s37 offen sc1 lds
s_add_u32 m0, s39, 101376
s_add_u32 s37, s40, 576512
buffer_load_dwordx4 v21, s[8:11], s37 offen sc1 lds
s_add_u32 m0, s39, 102400
s_add_u32 s37, s40, 577536
buffer_load_dwordx4 v21, s[8:11], s37 offen sc1 lds
s_add_u32 m0, s39, 103424
s_add_u32 s37, s40, 578560
buffer_load_dwordx4 v21, s[8:11], s37 offen sc1 lds
s_add_u32 m0, s39, 104448
s_add_u32 s37, s40, 579584
buffer_load_dwordx4 v21, s[8:11], s37 offen sc1 lds
s_add_u32 m0, s39, 105472
s_add_u32 s37, s40, 580608
buffer_load_dwordx4 v21, s[8:11], s37 offen sc1 lds
s_waitcnt vmcnt(16)
s_barrier
s_add_u32 m0, s39, 0
s_add_u32 s37, s40, 589824
buffer_load_dwordx4 v21, s[8:11], s37 offen sc1 lds
s_add_u32 m0, s39, 1024
s_add_u32 s37, s40, 590848
buffer_load_dwordx4 v21, s[8:11], s37 offen sc1 lds
s_add_u32 m0, s39, 2048
s_add_u32 s37, s40, 591872
buffer_load_dwordx4 v21, s[8:11], s37 offen sc1 lds
s_add_u32 m0, s39, 3072
s_add_u32 s37, s40, 592896
buffer_load_dwordx4 v21, s[8:11], s37 offen sc1 lds
s_add_u32 m0, s39, 4096
s_add_u32 s37, s40, 593920
buffer_load_dwordx4 v21, s[8:11], s37 offen sc1 lds
s_add_u32 m0, s39, 5120
s_add_u32 s37, s40, 594944
buffer_load_dwordx4 v21, s[8:11], s37 offen sc1 lds
s_add_u32 m0, s39, 6144
s_add_u32 s37, s40, 595968
buffer_load_dwordx4 v21, s[8:11], s37 offen sc1 lds
s_add_u32 m0, s39, 7168
s_add_u32 s37, s40, 596992
buffer_load_dwordx4 v21, s[8:11], s37 offen sc1 lds
s_waitcnt vmcnt(16)
s_barrier
s_add_u32 m0, s39, 32768
s_add_u32 s37, s40, 606208
buffer_load_dwordx4 v21, s[8:11], s37 offen sc1 lds
s_add_u32 m0, s39, 33792
s_add_u32 s37, s40, 607232
buffer_load_dwordx4 v21, s[8:11], s37 offen sc1 lds
s_add_u32 m0, s39, 34816
s_add_u32 s37, s40, 608256
buffer_load_dwordx4 v21, s[8:11], s37 offen sc1 lds
s_add_u32 m0, s39, 35840
s_add_u32 s37, s40, 609280
buffer_load_dwordx4 v21, s[8:11], s37 offen sc1 lds
s_add_u32 m0, s39, 36864
s_add_u32 s37, s40, 610304
buffer_load_dwordx4 v21, s[8:11], s37 offen sc1 lds
s_add_u32 m0, s39, 37888
s_add_u32 s37, s40, 611328
buffer_load_dwordx4 v21, s[8:11], s37 offen sc1 lds
s_add_u32 m0, s39, 38912
s_add_u32 s37, s40, 612352
buffer_load_dwordx4 v21, s[8:11], s37 offen sc1 lds
s_add_u32 m0, s39, 39936
s_add_u32 s37, s40, 613376
buffer_load_dwordx4 v21, s[8:11], s37 offen sc1 lds
s_waitcnt vmcnt(16)
s_barrier
s_add_u32 m0, s39, 65536
s_mov_b32 s37, 720896
buffer_load_dwordx4 v21, s[8:11], s37 offen sc1 lds
s_add_u32 m0, s39, 66560
s_mov_b32 s37, 721920
buffer_load_dwordx4 v21, s[8:11], s37 offen sc1 lds
s_add_u32 m0, s39, 67584
s_mov_b32 s37, 722944
buffer_load_dwordx4 v21, s[8:11], s37 offen sc1 lds
s_add_u32 m0, s39, 68608
s_mov_b32 s37, 723968
buffer_load_dwordx4 v21, s[8:11], s37 offen sc1 lds
s_add_u32 m0, s39, 69632
s_mov_b32 s37, 724992
buffer_load_dwordx4 v21, s[8:11], s37 offen sc1 lds
s_add_u32 m0, s39, 70656
s_mov_b32 s37, 726016
buffer_load_dwordx4 v21, s[8:11], s37 offen sc1 lds
s_add_u32 m0, s39, 71680
s_mov_b32 s37, 727040
buffer_load_dwordx4 v21, s[8:11], s37 offen sc1 lds
s_add_u32 m0, s39, 72704
s_mov_b32 s37, 728064
buffer_load_dwordx4 v21, s[8:11], s37 offen sc1 lds
s_waitcnt vmcnt(16)
s_barrier
s_add_u32 m0, s39, 98304
s_mov_b32 s37, 737280
buffer_load_dwordx4 v21, s[8:11], s37 offen sc1 lds
s_add_u32 m0, s39, 99328
s_mov_b32 s37, 738304
buffer_load_dwordx4 v21, s[8:11], s37 offen sc1 lds
s_add_u32 m0, s39, 100352
s_mov_b32 s37, 739328
buffer_load_dwordx4 v21, s[8:11], s37 offen sc1 lds
s_add_u32 m0, s39, 101376
s_mov_b32 s37, 740352
buffer_load_dwordx4 v21, s[8:11], s37 offen sc1 lds
s_add_u32 m0, s39, 102400
s_mov_b32 s37, 741376
buffer_load_dwordx4 v21, s[8:11], s37 offen sc1 lds
s_add_u32 m0, s39, 103424
s_mov_b32 s37, 742400
buffer_load_dwordx4 v21, s[8:11], s37 offen sc1 lds
s_add_u32 m0, s39, 104448
s_mov_b32 s37, 743424
buffer_load_dwordx4 v21, s[8:11], s37 offen sc1 lds
s_add_u32 m0, s39, 105472
s_mov_b32 s37, 744448
buffer_load_dwordx4 v21, s[8:11], s37 offen sc1 lds
s_waitcnt vmcnt(16)
s_barrier
s_add_u32 m0, s39, 0
s_mov_b32 s37, 753664
buffer_load_dwordx4 v21, s[8:11], s37 offen sc1 lds
s_add_u32 m0, s39, 1024
s_mov_b32 s37, 754688
buffer_load_dwordx4 v21, s[8:11], s37 offen sc1 lds
s_add_u32 m0, s39, 2048
s_mov_b32 s37, 755712
buffer_load_dwordx4 v21, s[8:11], s37 offen sc1 lds
s_add_u32 m0, s39, 3072
s_mov_b32 s37, 756736
buffer_load_dwordx4 v21, s[8:11], s37 offen sc1 lds
s_add_u32 m0, s39, 4096
s_mov_b32 s37, 757760
buffer_load_dwordx4 v21, s[8:11], s37 offen sc1 lds
s_add_u32 m0, s39, 5120
s_mov_b32 s37, 758784
buffer_load_dwordx4 v21, s[8:11], s37 offen sc1 lds
s_add_u32 m0, s39, 6144
s_mov_b32 s37, 759808
buffer_load_dwordx4 v21, s[8:11], s37 offen sc1 lds
s_add_u32 m0, s39, 7168
s_mov_b32 s37, 760832
buffer_load_dwordx4 v21, s[8:11], s37 offen sc1 lds
s_waitcnt vmcnt(16)
s_barrier
s_add_u32 m0, s39, 32768
s_mov_b32 s37, 770048
buffer_load_dwordx4 v21, s[8:11], s37 offen sc1 lds
s_add_u32 m0, s39, 33792
s_mov_b32 s37, 771072
buffer_load_dwordx4 v21, s[8:11], s37 offen sc1 lds
s_add_u32 m0, s39, 34816
s_mov_b32 s37, 772096
buffer_load_dwordx4 v21, s[8:11], s37 offen sc1 lds
s_add_u32 m0, s39, 35840
s_mov_b32 s37, 773120
buffer_load_dwordx4 v21, s[8:11], s37 offen sc1 lds
s_add_u32 m0, s39, 36864
s_mov_b32 s37, 774144
buffer_load_dwordx4 v21, s[8:11], s37 offen sc1 lds
s_add_u32 m0, s39, 37888
s_mov_b32 s37, 775168
buffer_load_dwordx4 v21, s[8:11], s37 offen sc1 lds
s_add_u32 m0, s39, 38912
s_mov_b32 s37, 776192
buffer_load_dwordx4 v21, s[8:11], s37 offen sc1 lds
s_add_u32 m0, s39, 39936
s_mov_b32 s37, 777216
buffer_load_dwordx4 v21, s[8:11], s37 offen sc1 lds
s_waitcnt vmcnt(16)
s_barrier
s_add_u32 m0, s39, 65536
s_mov_b32 s37, 786432
buffer_load_dwordx4 v21, s[8:11], s37 offen sc1 lds
s_add_u32 m0, s39, 66560
s_mov_b32 s37, 787456
buffer_load_dwordx4 v21, s[8:11], s37 offen sc1 lds
s_add_u32 m0, s39, 67584
s_mov_b32 s37, 788480
buffer_load_dwordx4 v21, s[8:11], s37 offen sc1 lds
s_add_u32 m0, s39, 68608
s_mov_b32 s37, 789504
buffer_load_dwordx4 v21, s[8:11], s37 offen sc1 lds
s_add_u32 m0, s39, 69632
s_mov_b32 s37, 790528
buffer_load_dwordx4 v21, s[8:11], s37 offen sc1 lds
s_add_u32 m0, s39, 70656
s_mov_b32 s37, 791552
buffer_load_dwordx4 v21, s[8:11], s37 offen sc1 lds
s_add_u32 m0, s39, 71680
s_mov_b32 s37, 792576
buffer_load_dwordx4 v21, s[8:11], s37 offen sc1 lds
s_add_u32 m0, s39, 72704
s_mov_b32 s37, 793600
buffer_load_dwordx4 v21, s[8:11], s37 offen sc1 lds
s_waitcnt vmcnt(16)
s_barrier
s_add_u32 m0, s39, 98304
s_mov_b32 s37, 802816
buffer_load_dwordx4 v21, s[8:11], s37 offen sc1 lds
s_add_u32 m0, s39, 99328
s_mov_b32 s37, 803840
buffer_load_dwordx4 v21, s[8:11], s37 offen sc1 lds
s_add_u32 m0, s39, 100352
s_mov_b32 s37, 804864
buffer_load_dwordx4 v21, s[8:11], s37 offen sc1 lds
s_add_u32 m0, s39, 101376
s_mov_b32 s37, 805888
buffer_load_dwordx4 v21, s[8:11], s37 offen sc1 lds
s_add_u32 m0, s39, 102400
s_mov_b32 s37, 806912
buffer_load_dwordx4 v21, s[8:11], s37 offen sc1 lds
s_add_u32 m0, s39, 103424
s_mov_b32 s37, 807936
buffer_load_dwordx4 v21, s[8:11], s37 offen sc1 lds
s_add_u32 m0, s39, 104448
s_mov_b32 s37, 808960
buffer_load_dwordx4 v21, s[8:11], s37 offen sc1 lds
s_add_u32 m0, s39, 105472
s_mov_b32 s37, 809984
buffer_load_dwordx4 v21, s[8:11], s37 offen sc1 lds
s_waitcnt vmcnt(16)
s_barrier
s_add_u32 m0, s39, 0
s_mov_b32 s37, 819200
buffer_load_dwordx4 v21, s[8:11], s37 offen sc1 lds
s_add_u32 m0, s39, 1024
s_mov_b32 s37, 820224
buffer_load_dwordx4 v21, s[8:11], s37 offen sc1 lds
s_add_u32 m0, s39, 2048
s_mov_b32 s37, 821248
buffer_load_dwordx4 v21, s[8:11], s37 offen sc1 lds
s_add_u32 m0, s39, 3072
s_mov_b32 s37, 822272
buffer_load_dwordx4 v21, s[8:11], s37 offen sc1 lds
s_add_u32 m0, s39, 4096
s_mov_b32 s37, 823296
buffer_load_dwordx4 v21, s[8:11], s37 offen sc1 lds
s_add_u32 m0, s39, 5120
s_mov_b32 s37, 824320
buffer_load_dwordx4 v21, s[8:11], s37 offen sc1 lds
s_add_u32 m0, s39, 6144
s_mov_b32 s37, 825344
buffer_load_dwordx4 v21, s[8:11], s37 offen sc1 lds
s_add_u32 m0, s39, 7168
s_mov_b32 s37, 826368
buffer_load_dwordx4 v21, s[8:11], s37 offen sc1 lds
s_waitcnt vmcnt(16)
s_barrier
s_add_u32 m0, s39, 32768
s_mov_b32 s37, 835584
buffer_load_dwordx4 v21, s[8:11], s37 offen sc1 lds
s_add_u32 m0, s39, 33792
s_mov_b32 s37, 836608
buffer_load_dwordx4 v21, s[8:11], s37 offen sc1 lds
s_add_u32 m0, s39, 34816
s_mov_b32 s37, 837632
buffer_load_dwordx4 v21, s[8:11], s37 offen sc1 lds
s_add_u32 m0, s39, 35840
s_mov_b32 s37, 838656
buffer_load_dwordx4 v21, s[8:11], s37 offen sc1 lds
s_add_u32 m0, s39, 36864
s_mov_b32 s37, 839680
buffer_load_dwordx4 v21, s[8:11], s37 offen sc1 lds
s_add_u32 m0, s39, 37888
s_mov_b32 s37, 840704
buffer_load_dwordx4 v21, s[8:11], s37 offen sc1 lds
s_add_u32 m0, s39, 38912
s_mov_b32 s37, 841728
buffer_load_dwordx4 v21, s[8:11], s37 offen sc1 lds
s_add_u32 m0, s39, 39936
s_mov_b32 s37, 842752
buffer_load_dwordx4 v21, s[8:11], s37 offen sc1 lds
s_waitcnt vmcnt(16)
s_barrier
s_add_u32 m0, s39, 65536
s_mov_b32 s37, 851968
buffer_load_dwordx4 v21, s[8:11], s37 offen sc1 lds
s_add_u32 m0, s39, 66560
s_mov_b32 s37, 852992
buffer_load_dwordx4 v21, s[8:11], s37 offen sc1 lds
s_add_u32 m0, s39, 67584
s_mov_b32 s37, 854016
buffer_load_dwordx4 v21, s[8:11], s37 offen sc1 lds
s_add_u32 m0, s39, 68608
s_mov_b32 s37, 855040
buffer_load_dwordx4 v21, s[8:11], s37 offen sc1 lds
s_add_u32 m0, s39, 69632
s_mov_b32 s37, 856064
buffer_load_dwordx4 v21, s[8:11], s37 offen sc1 lds
s_add_u32 m0, s39, 70656
s_mov_b32 s37, 857088
buffer_load_dwordx4 v21, s[8:11], s37 offen sc1 lds
s_add_u32 m0, s39, 71680
s_mov_b32 s37, 858112
buffer_load_dwordx4 v21, s[8:11], s37 offen sc1 lds
s_add_u32 m0, s39, 72704
s_mov_b32 s37, 859136
buffer_load_dwordx4 v21, s[8:11], s37 offen sc1 lds
s_waitcnt vmcnt(16)
s_barrier
s_add_u32 m0, s39, 98304
s_mov_b32 s37, 868352
buffer_load_dwordx4 v21, s[8:11], s37 offen sc1 lds
s_add_u32 m0, s39, 99328
s_mov_b32 s37, 869376
buffer_load_dwordx4 v21, s[8:11], s37 offen sc1 lds
s_add_u32 m0, s39, 100352
s_mov_b32 s37, 870400
buffer_load_dwordx4 v21, s[8:11], s37 offen sc1 lds
s_add_u32 m0, s39, 101376
s_mov_b32 s37, 871424
buffer_load_dwordx4 v21, s[8:11], s37 offen sc1 lds
s_add_u32 m0, s39, 102400
s_mov_b32 s37, 872448
buffer_load_dwordx4 v21, s[8:11], s37 offen sc1 lds
s_add_u32 m0, s39, 103424
s_mov_b32 s37, 873472
buffer_load_dwordx4 v21, s[8:11], s37 offen sc1 lds
s_add_u32 m0, s39, 104448
s_mov_b32 s37, 874496
buffer_load_dwordx4 v21, s[8:11], s37 offen sc1 lds
s_add_u32 m0, s39, 105472
s_mov_b32 s37, 875520
buffer_load_dwordx4 v21, s[8:11], s37 offen sc1 lds
s_waitcnt vmcnt(16)
s_barrier
s_add_u32 m0, s39, 0
s_mov_b32 s37, 884736
buffer_load_dwordx4 v21, s[8:11], s37 offen sc1 lds
s_add_u32 m0, s39, 1024
s_mov_b32 s37, 885760
buffer_load_dwordx4 v21, s[8:11], s37 offen sc1 lds
s_add_u32 m0, s39, 2048
s_mov_b32 s37, 886784
buffer_load_dwordx4 v21, s[8:11], s37 offen sc1 lds
s_add_u32 m0, s39, 3072
s_mov_b32 s37, 887808
buffer_load_dwordx4 v21, s[8:11], s37 offen sc1 lds
s_add_u32 m0, s39, 4096
s_mov_b32 s37, 888832
buffer_load_dwordx4 v21, s[8:11], s37 offen sc1 lds
s_add_u32 m0, s39, 5120
s_mov_b32 s37, 889856
buffer_load_dwordx4 v21, s[8:11], s37 offen sc1 lds
s_add_u32 m0, s39, 6144
s_mov_b32 s37, 890880
buffer_load_dwordx4 v21, s[8:11], s37 offen sc1 lds
s_add_u32 m0, s39, 7168
s_mov_b32 s37, 891904
buffer_load_dwordx4 v21, s[8:11], s37 offen sc1 lds
s_waitcnt vmcnt(16)
s_barrier
s_add_u32 m0, s39, 32768
s_mov_b32 s37, 901120
buffer_load_dwordx4 v21, s[8:11], s37 offen sc1 lds
s_add_u32 m0, s39, 33792
s_mov_b32 s37, 902144
buffer_load_dwordx4 v21, s[8:11], s37 offen sc1 lds
s_add_u32 m0, s39, 34816
s_mov_b32 s37, 903168
buffer_load_dwordx4 v21, s[8:11], s37 offen sc1 lds
s_add_u32 m0, s39, 35840
s_mov_b32 s37, 904192
buffer_load_dwordx4 v21, s[8:11], s37 offen sc1 lds
s_add_u32 m0, s39, 36864
s_mov_b32 s37, 905216
buffer_load_dwordx4 v21, s[8:11], s37 offen sc1 lds
s_add_u32 m0, s39, 37888
s_mov_b32 s37, 906240
buffer_load_dwordx4 v21, s[8:11], s37 offen sc1 lds
s_add_u32 m0, s39, 38912
s_mov_b32 s37, 907264
buffer_load_dwordx4 v21, s[8:11], s37 offen sc1 lds
s_add_u32 m0, s39, 39936
s_mov_b32 s37, 908288
buffer_load_dwordx4 v21, s[8:11], s37 offen sc1 lds
s_waitcnt vmcnt(16)
s_barrier
s_waitcnt vmcnt(8)
s_barrier
s_waitcnt vmcnt(0)
s_barrier
s_branch Ldone_1
.p2align 6
Lw_163:
s_branch Lr_164
s_nop 0
.p2align 3
LW4_159:
s_mul_i32 s40, s53, 983040
s_add_u32 m0, s39, 0
s_add_u32 s37, s40, 4194304
buffer_load_dwordx4 v21, s[8:11], s37 offen sc1 lds
s_add_u32 m0, s39, 1024
s_add_u32 s37, s40, 4210688
buffer_load_dwordx4 v21, s[8:11], s37 offen sc1 lds
s_add_u32 m0, s39, 2048
s_add_u32 s37, s40, 4227072
buffer_load_dwordx4 v21, s[8:11], s37 offen sc1 lds
s_add_u32 m0, s39, 3072
s_add_u32 s37, s40, 4243456
buffer_load_dwordx4 v21, s[8:11], s37 offen sc1 lds
s_add_u32 m0, s39, 4096
s_add_u32 s37, s40, 4292608
buffer_load_dwordx4 v21, s[8:11], s37 offen sc1 lds
s_add_u32 m0, s39, 5120
s_add_u32 s37, s40, 4308992
buffer_load_dwordx4 v21, s[8:11], s37 offen sc1 lds
s_add_u32 m0, s39, 6144
s_add_u32 s37, s40, 4325376
buffer_load_dwordx4 v21, s[8:11], s37 offen sc1 lds
s_add_u32 m0, s39, 7168
s_add_u32 s37, s40, 4341760
buffer_load_dwordx4 v21, s[8:11], s37 offen sc1 lds
s_waitcnt vmcnt(16)
s_barrier
s_add_u32 m0, s39, 32768
s_add_u32 s37, s40, 4259840
buffer_load_dwordx4 v21, s[8:11], s37 offen sc1 lds
s_add_u32 m0, s39, 33792
s_add_u32 s37, s40, 4358144
buffer_load_dwordx4 v21, s[8:11], s37 offen sc1 lds
s_add_u32 m0, s39, 34816
s_add_u32 s37, s40, 4276224
buffer_load_dwordx4 v21, s[8:11], s37 offen sc1 lds
s_add_u32 m0, s39, 35840
s_add_u32 s37, s40, 4374528
buffer_load_dwordx4 v21, s[8:11], s37 offen sc1 lds
s_add_u32 m0, s39, 36864
s_add_u32 s37, s40, 4390912
buffer_load_dwordx4 v21, s[8:11], s37 offen sc1 lds
s_add_u32 m0, s39, 37888
s_add_u32 s37, s40, 4407296
buffer_load_dwordx4 v21, s[8:11], s37 offen sc1 lds
s_add_u32 m0, s39, 38912
s_add_u32 s37, s40, 4423680
buffer_load_dwordx4 v21, s[8:11], s37 offen sc1 lds
s_add_u32 m0, s39, 39936
s_add_u32 s37, s40, 4440064
buffer_load_dwordx4 v21, s[8:11], s37 offen sc1 lds
s_waitcnt vmcnt(16)
s_barrier
s_add_u32 m0, s39, 65536
s_add_u32 s37, s40, 4489216
buffer_load_dwordx4 v21, s[8:11], s37 offen sc1 lds
s_add_u32 m0, s39, 66560
s_add_u32 s37, s40, 4505600
buffer_load_dwordx4 v21, s[8:11], s37 offen sc1 lds
s_add_u32 m0, s39, 67584
s_add_u32 s37, s40, 4521984
buffer_load_dwordx4 v21, s[8:11], s37 offen sc1 lds
s_add_u32 m0, s39, 68608
s_add_u32 s37, s40, 4538368
buffer_load_dwordx4 v21, s[8:11], s37 offen sc1 lds
s_add_u32 m0, s39, 69632
s_add_u32 s37, s40, 4456448
buffer_load_dwordx4 v21, s[8:11], s37 offen sc1 lds
s_add_u32 m0, s39, 70656
s_add_u32 s37, s40, 4554752
buffer_load_dwordx4 v21, s[8:11], s37 offen sc1 lds
s_add_u32 m0, s39, 71680
s_add_u32 s37, s40, 4472832
buffer_load_dwordx4 v21, s[8:11], s37 offen sc1 lds
s_add_u32 m0, s39, 72704
s_add_u32 s37, s40, 4571136
buffer_load_dwordx4 v21, s[8:11], s37 offen sc1 lds
s_waitcnt vmcnt(16)
s_barrier
s_add_u32 m0, s39, 98304
s_add_u32 s37, s40, 4784128
buffer_load_dwordx4 v21, s[8:11], s37 offen sc1 lds
s_add_u32 m0, s39, 99328
s_add_u32 s37, s40, 4800512
buffer_load_dwordx4 v21, s[8:11], s37 offen sc1 lds
s_add_u32 m0, s39, 100352
s_add_u32 s37, s40, 4816896
buffer_load_dwordx4 v21, s[8:11], s37 offen sc1 lds
s_add_u32 m0, s39, 101376
s_add_u32 s37, s40, 4833280
buffer_load_dwordx4 v21, s[8:11], s37 offen sc1 lds
s_add_u32 m0, s39, 102400
s_add_u32 s37, s40, 4882432
buffer_load_dwordx4 v21, s[8:11], s37 offen sc1 lds
s_add_u32 m0, s39, 103424
s_add_u32 s37, s40, 4898816
buffer_load_dwordx4 v21, s[8:11], s37 offen sc1 lds
s_add_u32 m0, s39, 104448
s_add_u32 s37, s40, 4915200
buffer_load_dwordx4 v21, s[8:11], s37 offen sc1 lds
s_add_u32 m0, s39, 105472
s_add_u32 s37, s40, 4931584
buffer_load_dwordx4 v21, s[8:11], s37 offen sc1 lds
s_waitcnt vmcnt(16)
s_barrier
s_add_u32 m0, s39, 0
s_add_u32 s37, s40, 4849664
buffer_load_dwordx4 v21, s[8:11], s37 offen sc1 lds
s_add_u32 m0, s39, 1024
s_add_u32 s37, s40, 4947968
buffer_load_dwordx4 v21, s[8:11], s37 offen sc1 lds
s_add_u32 m0, s39, 2048
s_add_u32 s37, s40, 4866048
buffer_load_dwordx4 v21, s[8:11], s37 offen sc1 lds
s_add_u32 m0, s39, 3072
s_add_u32 s37, s40, 4964352
buffer_load_dwordx4 v21, s[8:11], s37 offen sc1 lds
s_add_u32 m0, s39, 4096
s_add_u32 s37, s40, 4980736
buffer_load_dwordx4 v21, s[8:11], s37 offen sc1 lds
s_add_u32 m0, s39, 5120
s_add_u32 s37, s40, 4997120
buffer_load_dwordx4 v21, s[8:11], s37 offen sc1 lds
s_add_u32 m0, s39, 6144
s_add_u32 s37, s40, 5013504
buffer_load_dwordx4 v21, s[8:11], s37 offen sc1 lds
s_add_u32 m0, s39, 7168
s_add_u32 s37, s40, 5029888
buffer_load_dwordx4 v21, s[8:11], s37 offen sc1 lds
s_waitcnt vmcnt(16)
s_barrier
s_add_u32 m0, s39, 32768
s_add_u32 s37, s40, 5079040
buffer_load_dwordx4 v21, s[8:11], s37 offen sc1 lds
s_add_u32 m0, s39, 33792
s_add_u32 s37, s40, 5095424
buffer_load_dwordx4 v21, s[8:11], s37 offen sc1 lds
s_add_u32 m0, s39, 34816
s_add_u32 s37, s40, 5111808
buffer_load_dwordx4 v21, s[8:11], s37 offen sc1 lds
s_add_u32 m0, s39, 35840
s_add_u32 s37, s40, 5128192
buffer_load_dwordx4 v21, s[8:11], s37 offen sc1 lds
s_add_u32 m0, s39, 36864
s_add_u32 s37, s40, 5046272
buffer_load_dwordx4 v21, s[8:11], s37 offen sc1 lds
s_add_u32 m0, s39, 37888
s_add_u32 s37, s40, 5144576
buffer_load_dwordx4 v21, s[8:11], s37 offen sc1 lds
s_add_u32 m0, s39, 38912
s_add_u32 s37, s40, 5062656
buffer_load_dwordx4 v21, s[8:11], s37 offen sc1 lds
s_add_u32 m0, s39, 39936
s_add_u32 s37, s40, 5160960
buffer_load_dwordx4 v21, s[8:11], s37 offen sc1 lds
s_waitcnt vmcnt(16)
s_barrier
s_add_u32 m0, s39, 65536
s_mov_b32 s37, 6160384
buffer_load_dwordx4 v21, s[8:11], s37 offen sc1 lds
s_add_u32 m0, s39, 66560
s_mov_b32 s37, 6176768
buffer_load_dwordx4 v21, s[8:11], s37 offen sc1 lds
s_add_u32 m0, s39, 67584
s_mov_b32 s37, 6193152
buffer_load_dwordx4 v21, s[8:11], s37 offen sc1 lds
s_add_u32 m0, s39, 68608
s_mov_b32 s37, 6209536
buffer_load_dwordx4 v21, s[8:11], s37 offen sc1 lds
s_add_u32 m0, s39, 69632
s_mov_b32 s37, 6258688
buffer_load_dwordx4 v21, s[8:11], s37 offen sc1 lds
s_add_u32 m0, s39, 70656
s_mov_b32 s37, 6275072
buffer_load_dwordx4 v21, s[8:11], s37 offen sc1 lds
s_add_u32 m0, s39, 71680
s_mov_b32 s37, 6291456
buffer_load_dwordx4 v21, s[8:11], s37 offen sc1 lds
s_add_u32 m0, s39, 72704
s_mov_b32 s37, 6307840
buffer_load_dwordx4 v21, s[8:11], s37 offen sc1 lds
s_waitcnt vmcnt(16)
s_barrier
s_add_u32 m0, s39, 98304
s_mov_b32 s37, 6225920
buffer_load_dwordx4 v21, s[8:11], s37 offen sc1 lds
s_add_u32 m0, s39, 99328
s_mov_b32 s37, 6324224
buffer_load_dwordx4 v21, s[8:11], s37 offen sc1 lds
s_add_u32 m0, s39, 100352
s_mov_b32 s37, 6242304
buffer_load_dwordx4 v21, s[8:11], s37 offen sc1 lds
s_add_u32 m0, s39, 101376
s_mov_b32 s37, 6340608
buffer_load_dwordx4 v21, s[8:11], s37 offen sc1 lds
s_add_u32 m0, s39, 102400
s_mov_b32 s37, 6356992
buffer_load_dwordx4 v21, s[8:11], s37 offen sc1 lds
s_add_u32 m0, s39, 103424
s_mov_b32 s37, 6373376
buffer_load_dwordx4 v21, s[8:11], s37 offen sc1 lds
s_add_u32 m0, s39, 104448
s_mov_b32 s37, 6389760
buffer_load_dwordx4 v21, s[8:11], s37 offen sc1 lds
s_add_u32 m0, s39, 105472
s_mov_b32 s37, 6406144
buffer_load_dwordx4 v21, s[8:11], s37 offen sc1 lds
s_waitcnt vmcnt(16)
s_barrier
s_add_u32 m0, s39, 0
s_mov_b32 s37, 6455296
buffer_load_dwordx4 v21, s[8:11], s37 offen sc1 lds
s_add_u32 m0, s39, 1024
s_mov_b32 s37, 6471680
buffer_load_dwordx4 v21, s[8:11], s37 offen sc1 lds
s_add_u32 m0, s39, 2048
s_mov_b32 s37, 6488064
buffer_load_dwordx4 v21, s[8:11], s37 offen sc1 lds
s_add_u32 m0, s39, 3072
s_mov_b32 s37, 6504448
buffer_load_dwordx4 v21, s[8:11], s37 offen sc1 lds
s_add_u32 m0, s39, 4096
s_mov_b32 s37, 6422528
buffer_load_dwordx4 v21, s[8:11], s37 offen sc1 lds
s_add_u32 m0, s39, 5120
s_mov_b32 s37, 6520832
buffer_load_dwordx4 v21, s[8:11], s37 offen sc1 lds
s_add_u32 m0, s39, 6144
s_mov_b32 s37, 6438912
buffer_load_dwordx4 v21, s[8:11], s37 offen sc1 lds
s_add_u32 m0, s39, 7168
s_mov_b32 s37, 6537216
buffer_load_dwordx4 v21, s[8:11], s37 offen sc1 lds
s_waitcnt vmcnt(16)
s_barrier
s_add_u32 m0, s39, 32768
s_mov_b32 s37, 6946816
buffer_load_dwordx4 v21, s[8:11], s37 offen sc1 lds
s_add_u32 m0, s39, 33792
s_mov_b32 s37, 6963200
buffer_load_dwordx4 v21, s[8:11], s37 offen sc1 lds
s_add_u32 m0, s39, 34816
s_mov_b32 s37, 6979584
buffer_load_dwordx4 v21, s[8:11], s37 offen sc1 lds
s_add_u32 m0, s39, 35840
s_mov_b32 s37, 6995968
buffer_load_dwordx4 v21, s[8:11], s37 offen sc1 lds
s_add_u32 m0, s39, 36864
s_mov_b32 s37, 7045120
buffer_load_dwordx4 v21, s[8:11], s37 offen sc1 lds
s_add_u32 m0, s39, 37888
s_mov_b32 s37, 7061504
buffer_load_dwordx4 v21, s[8:11], s37 offen sc1 lds
s_add_u32 m0, s39, 38912
s_mov_b32 s37, 7077888
buffer_load_dwordx4 v21, s[8:11], s37 offen sc1 lds
s_add_u32 m0, s39, 39936
s_mov_b32 s37, 7094272
buffer_load_dwordx4 v21, s[8:11], s37 offen sc1 lds
s_waitcnt vmcnt(16)
s_barrier
s_add_u32 m0, s39, 65536
s_mov_b32 s37, 7012352
buffer_load_dwordx4 v21, s[8:11], s37 offen sc1 lds
s_add_u32 m0, s39, 66560
s_mov_b32 s37, 7110656
buffer_load_dwordx4 v21, s[8:11], s37 offen sc1 lds
s_add_u32 m0, s39, 67584
s_mov_b32 s37, 7028736
buffer_load_dwordx4 v21, s[8:11], s37 offen sc1 lds
s_add_u32 m0, s39, 68608
s_mov_b32 s37, 7127040
buffer_load_dwordx4 v21, s[8:11], s37 offen sc1 lds
s_add_u32 m0, s39, 69632
s_mov_b32 s37, 7143424
buffer_load_dwordx4 v21, s[8:11], s37 offen sc1 lds
s_add_u32 m0, s39, 70656
s_mov_b32 s37, 7159808
buffer_load_dwordx4 v21, s[8:11], s37 offen sc1 lds
s_add_u32 m0, s39, 71680
s_mov_b32 s37, 7176192
buffer_load_dwordx4 v21, s[8:11], s37 offen sc1 lds
s_add_u32 m0, s39, 72704
s_mov_b32 s37, 7192576
buffer_load_dwordx4 v21, s[8:11], s37 offen sc1 lds
s_waitcnt vmcnt(16)
s_barrier
s_add_u32 m0, s39, 98304
s_mov_b32 s37, 7241728
buffer_load_dwordx4 v21, s[8:11], s37 offen sc1 lds
s_add_u32 m0, s39, 99328
s_mov_b32 s37, 7258112
buffer_load_dwordx4 v21, s[8:11], s37 offen sc1 lds
s_add_u32 m0, s39, 100352
s_mov_b32 s37, 7274496
buffer_load_dwordx4 v21, s[8:11], s37 offen sc1 lds
s_add_u32 m0, s39, 101376
s_mov_b32 s37, 7290880
buffer_load_dwordx4 v21, s[8:11], s37 offen sc1 lds
s_add_u32 m0, s39, 102400
s_mov_b32 s37, 7208960
buffer_load_dwordx4 v21, s[8:11], s37 offen sc1 lds
s_add_u32 m0, s39, 103424
s_mov_b32 s37, 7307264
buffer_load_dwordx4 v21, s[8:11], s37 offen sc1 lds
s_add_u32 m0, s39, 104448
s_mov_b32 s37, 7225344
buffer_load_dwordx4 v21, s[8:11], s37 offen sc1 lds
s_add_u32 m0, s39, 105472
s_mov_b32 s37, 7323648
buffer_load_dwordx4 v21, s[8:11], s37 offen sc1 lds
s_waitcnt vmcnt(16)
s_barrier
s_add_u32 m0, s39, 0
s_mov_b32 s37, 4587520
buffer_load_dwordx4 v21, s[8:11], s37 offen sc1 lds
s_add_u32 m0, s39, 1024
s_mov_b32 s37, 4603904
buffer_load_dwordx4 v21, s[8:11], s37 offen sc1 lds
s_add_u32 m0, s39, 2048
s_mov_b32 s37, 4620288
buffer_load_dwordx4 v21, s[8:11], s37 offen sc1 lds
s_add_u32 m0, s39, 3072
s_mov_b32 s37, 4636672
buffer_load_dwordx4 v21, s[8:11], s37 offen sc1 lds
s_add_u32 m0, s39, 4096
s_mov_b32 s37, 4685824
buffer_load_dwordx4 v21, s[8:11], s37 offen sc1 lds
s_add_u32 m0, s39, 5120
s_mov_b32 s37, 4702208
buffer_load_dwordx4 v21, s[8:11], s37 offen sc1 lds
s_add_u32 m0, s39, 6144
s_mov_b32 s37, 4718592
buffer_load_dwordx4 v21, s[8:11], s37 offen sc1 lds
s_add_u32 m0, s39, 7168
s_mov_b32 s37, 4734976
buffer_load_dwordx4 v21, s[8:11], s37 offen sc1 lds
s_waitcnt vmcnt(16)
s_barrier
s_add_u32 m0, s39, 32768
s_mov_b32 s37, 4653056
buffer_load_dwordx4 v21, s[8:11], s37 offen sc1 lds
s_add_u32 m0, s39, 33792
s_mov_b32 s37, 4751360
buffer_load_dwordx4 v21, s[8:11], s37 offen sc1 lds
s_add_u32 m0, s39, 34816
s_mov_b32 s37, 4669440
buffer_load_dwordx4 v21, s[8:11], s37 offen sc1 lds
s_add_u32 m0, s39, 35840
s_mov_b32 s37, 4767744
buffer_load_dwordx4 v21, s[8:11], s37 offen sc1 lds
s_add_u32 m0, s39, 36864
s_mov_b32 s37, 5570560
buffer_load_dwordx4 v21, s[8:11], s37 offen sc1 lds
s_add_u32 m0, s39, 37888
s_mov_b32 s37, 5586944
buffer_load_dwordx4 v21, s[8:11], s37 offen sc1 lds
s_add_u32 m0, s39, 38912
s_mov_b32 s37, 5603328
buffer_load_dwordx4 v21, s[8:11], s37 offen sc1 lds
s_add_u32 m0, s39, 39936
s_mov_b32 s37, 5619712
buffer_load_dwordx4 v21, s[8:11], s37 offen sc1 lds
s_waitcnt vmcnt(16)
s_barrier
s_add_u32 m0, s39, 65536
s_mov_b32 s37, 5668864
buffer_load_dwordx4 v21, s[8:11], s37 offen sc1 lds
s_add_u32 m0, s39, 66560
s_mov_b32 s37, 5685248
buffer_load_dwordx4 v21, s[8:11], s37 offen sc1 lds
s_add_u32 m0, s39, 67584
s_mov_b32 s37, 5701632
buffer_load_dwordx4 v21, s[8:11], s37 offen sc1 lds
s_add_u32 m0, s39, 68608
s_mov_b32 s37, 5718016
buffer_load_dwordx4 v21, s[8:11], s37 offen sc1 lds
s_add_u32 m0, s39, 69632
s_mov_b32 s37, 5636096
buffer_load_dwordx4 v21, s[8:11], s37 offen sc1 lds
s_add_u32 m0, s39, 70656
s_mov_b32 s37, 5734400
buffer_load_dwordx4 v21, s[8:11], s37 offen sc1 lds
s_add_u32 m0, s39, 71680
s_mov_b32 s37, 5652480
buffer_load_dwordx4 v21, s[8:11], s37 offen sc1 lds
s_add_u32 m0, s39, 72704
s_mov_b32 s37, 5750784
buffer_load_dwordx4 v21, s[8:11], s37 offen sc1 lds
s_waitcnt vmcnt(16)
s_barrier
s_add_u32 m0, s39, 98304
s_mov_b32 s37, 6553600
buffer_load_dwordx4 v21, s[8:11], s37 offen sc1 lds
s_add_u32 m0, s39, 99328
s_mov_b32 s37, 6569984
buffer_load_dwordx4 v21, s[8:11], s37 offen sc1 lds
s_add_u32 m0, s39, 100352
s_mov_b32 s37, 6586368
buffer_load_dwordx4 v21, s[8:11], s37 offen sc1 lds
s_add_u32 m0, s39, 101376
s_mov_b32 s37, 6602752
buffer_load_dwordx4 v21, s[8:11], s37 offen sc1 lds
s_add_u32 m0, s39, 102400
s_mov_b32 s37, 6651904
buffer_load_dwordx4 v21, s[8:11], s37 offen sc1 lds
s_add_u32 m0, s39, 103424
s_mov_b32 s37, 6668288
buffer_load_dwordx4 v21, s[8:11], s37 offen sc1 lds
s_add_u32 m0, s39, 104448
s_mov_b32 s37, 6684672
buffer_load_dwordx4 v21, s[8:11], s37 offen sc1 lds
s_add_u32 m0, s39, 105472
s_mov_b32 s37, 6701056
buffer_load_dwordx4 v21, s[8:11], s37 offen sc1 lds
s_waitcnt vmcnt(16)
s_barrier
s_add_u32 m0, s39, 0
s_mov_b32 s37, 6619136
buffer_load_dwordx4 v21, s[8:11], s37 offen sc1 lds
s_add_u32 m0, s39, 1024
s_mov_b32 s37, 6717440
buffer_load_dwordx4 v21, s[8:11], s37 offen sc1 lds
s_add_u32 m0, s39, 2048
s_mov_b32 s37, 6635520
buffer_load_dwordx4 v21, s[8:11], s37 offen sc1 lds
s_add_u32 m0, s39, 3072
s_mov_b32 s37, 6733824
buffer_load_dwordx4 v21, s[8:11], s37 offen sc1 lds
s_add_u32 m0, s39, 4096
s_mov_b32 s37, 6750208
buffer_load_dwordx4 v21, s[8:11], s37 offen sc1 lds
s_add_u32 m0, s39, 5120
s_mov_b32 s37, 6766592
buffer_load_dwordx4 v21, s[8:11], s37 offen sc1 lds
s_add_u32 m0, s39, 6144
s_mov_b32 s37, 6782976
buffer_load_dwordx4 v21, s[8:11], s37 offen sc1 lds
s_add_u32 m0, s39, 7168
s_mov_b32 s37, 6799360
buffer_load_dwordx4 v21, s[8:11], s37 offen sc1 lds
s_waitcnt vmcnt(16)
s_barrier
s_add_u32 m0, s39, 32768
s_mov_b32 s37, 6848512
buffer_load_dwordx4 v21, s[8:11], s37 offen sc1 lds
s_add_u32 m0, s39, 33792
s_mov_b32 s37, 6864896
buffer_load_dwordx4 v21, s[8:11], s37 offen sc1 lds
s_add_u32 m0, s39, 34816
s_mov_b32 s37, 6881280
buffer_load_dwordx4 v21, s[8:11], s37 offen sc1 lds
s_add_u32 m0, s39, 35840
s_mov_b32 s37, 6897664
buffer_load_dwordx4 v21, s[8:11], s37 offen sc1 lds
s_add_u32 m0, s39, 36864
s_mov_b32 s37, 6815744
buffer_load_dwordx4 v21, s[8:11], s37 offen sc1 lds
s_add_u32 m0, s39, 37888
s_mov_b32 s37, 6914048
buffer_load_dwordx4 v21, s[8:11], s37 offen sc1 lds
s_add_u32 m0, s39, 38912
s_mov_b32 s37, 6832128
buffer_load_dwordx4 v21, s[8:11], s37 offen sc1 lds
s_add_u32 m0, s39, 39936
s_mov_b32 s37, 6930432
buffer_load_dwordx4 v21, s[8:11], s37 offen sc1 lds
s_waitcnt vmcnt(16)
s_barrier
s_waitcnt vmcnt(8)
s_barrier
s_waitcnt vmcnt(0)
s_barrier
s_branch Ldone_1
.p2align 6
Lw_130:
s_branch Lr_131
s_nop 0
.p2align 3
L7b_158:
v_mfma_f32_16x16x32_bf16 v[128:131], v[96:99], v[80:83], v[128:131]
v_mfma_f32_16x16x32_bf16 v[132:135], v[96:99], v[84:87], v[132:135]
v_mfma_f32_16x16x32_bf16 v[136:139], v[96:99], v[88:91], v[136:139]
v_mfma_f32_16x16x32_bf16 v[140:143], v[96:99], v[92:95], v[140:143]
v_mfma_f32_16x16x32_bf16 v[188:191], v[108:111], v[92:95], v[188:191]
v_mfma_f32_16x16x32_bf16 v[184:187], v[108:111], v[88:91], v[184:187]
v_mfma_f32_16x16x32_bf16 v[180:183], v[108:111], v[84:87], v[180:183]
v_mfma_f32_16x16x32_bf16 v[176:179], v[108:111], v[80:83], v[176:179]
v_mfma_f32_16x16x32_bf16 v[144:147], v[100:103], v[80:83], v[144:147]
v_mfma_f32_16x16x32_bf16 v[148:151], v[100:103], v[84:87], v[148:151]
v_mfma_f32_16x16x32_bf16 v[152:155], v[100:103], v[88:91], v[152:155]
v_mfma_f32_16x16x32_bf16 v[156:159], v[100:103], v[92:95], v[156:159]
v_mfma_f32_16x16x32_bf16 v[204:207], v[112:115], v[92:95], v[204:207]
v_mfma_f32_16x16x32_bf16 v[200:203], v[112:115], v[88:91], v[200:203]
v_mfma_f32_16x16x32_bf16 v[196:199], v[112:115], v[84:87], v[196:199]
v_mfma_f32_16x16x32_bf16 v[192:195], v[112:115], v[80:83], v[192:195]
v_mfma_f32_16x16x32_bf16 v[160:163], v[104:107], v[80:83], v[160:163]
v_mfma_f32_16x16x32_bf16 v[164:167], v[104:107], v[84:87], v[164:167]
v_mfma_f32_16x16x32_bf16 v[168:171], v[104:107], v[88:91], v[168:171]
v_mfma_f32_16x16x32_bf16 v[172:175], v[104:107], v[92:95], v[172:175]
v_mfma_f32_16x16x32_bf16 v[220:223], v[116:119], v[92:95], v[220:223]
v_mfma_f32_16x16x32_bf16 v[216:219], v[116:119], v[88:91], v[216:219]
v_mfma_f32_16x16x32_bf16 v[212:215], v[116:119], v[84:87], v[212:215]
v_mfma_f32_16x16x32_bf16 v[208:211], v[116:119], v[80:83], v[208:211]
s_mul_i32 s43, s38, 32
s_add_u32 s37, s37, s43
s_setprio 0
s_barrier
s_mov_b32 s80, s60
s_mov_b32 s81, s61
s_mov_b32 s82, 7340032
s_mov_b32 s83, 0x20000
v_and_b32 v29, 31, v1
v_lshlrev_b32 v29, 11, v29
s_and_b32 s43, s35, 8
s_or_b32 s43, s43, 3
s_lshl_b32 s43, s43, 7
v_add_u32 v29, s43, v29
s_add_u32 s37, s37, s54
s_add_u32 m0, s39, 65536
s_add_u32 s37, s37, s40
buffer_load_dwordx4 v21, s[8:11], s37 offen sc1 lds
v_mul_f32 v80, v128, v128
v_mul_f32 v81, v129, v129
v_mul_f32 v82, v130, v130
v_mul_f32 v83, v131, v131
v_fma_f32 v80, v80, v232, v228
v_fma_f32 v81, v81, v232, v228
v_fma_f32 v82, v82, v232, v228
s_add_u32 m0, s39, 66560
s_add_u32 s37, s37, s38
buffer_load_dwordx4 v21, s[8:11], s37 offen sc1 lds
v_fma_f32 v83, v83, v232, v228
v_mul_f32 v80, v80, v128
v_mul_f32 v81, v81, v129
v_mul_f32 v82, v82, v130
v_mul_f32 v83, v83, v131
v_exp_f32 v80, v80
s_add_u32 m0, s39, 67584
s_add_u32 s37, s37, s38
buffer_load_dwordx4 v21, s[8:11], s37 offen sc1 lds
v_exp_f32 v81, v81
v_exp_f32 v82, v82
v_exp_f32 v83, v83
v_mul_f32 v176, v128, v176
v_mul_f32 v177, v129, v177
v_mul_f32 v178, v130, v178
v_mul_f32 v179, v131, v179
s_add_u32 m0, s39, 68608
s_add_u32 s37, s37, s38
buffer_load_dwordx4 v21, s[8:11], s37 offen sc1 lds
v_fma_f32 v80, v80, v236, v236
v_fma_f32 v81, v81, v236, v236
v_fma_f32 v82, v82, v236, v236
v_fma_f32 v83, v83, v236, v236
v_rcp_f32 v80, v80
v_rcp_f32 v81, v81
s_add_u32 m0, s39, 69632
s_add_u32 s37, s37, s55
buffer_load_dwordx4 v21, s[8:11], s37 offen sc1 lds
v_rcp_f32 v82, v82
v_rcp_f32 v83, v83
v_mul_f32 v176, v176, v80
v_mul_f32 v177, v177, v81
v_mul_f32 v178, v178, v82
v_mul_f32 v179, v179, v83
v_cvt_pk_bf16_f32 v96, v176, v177
s_add_u32 m0, s39, 70656
s_add_u32 s37, s37, s38
buffer_load_dwordx4 v21, s[8:11], s37 offen sc1 lds
v_cvt_pk_bf16_f32 v97, v178, v179
v_mul_f32 v84, v144, v144
v_mul_f32 v85, v145, v145
v_mul_f32 v86, v146, v146
v_mul_f32 v87, v147, v147
v_fma_f32 v84, v84, v232, v228
s_add_u32 m0, s39, 71680
s_add_u32 s37, s37, s38
buffer_load_dwordx4 v21, s[8:11], s37 offen sc1 lds
v_fma_f32 v85, v85, v232, v228
v_fma_f32 v86, v86, v232, v228
v_fma_f32 v87, v87, v232, v228
v_mul_f32 v84, v84, v144
v_mul_f32 v85, v85, v145
v_mul_f32 v86, v86, v146
v_mul_f32 v87, v87, v147
s_add_u32 m0, s39, 72704
s_add_u32 s37, s37, s38
buffer_load_dwordx4 v21, s[8:11], s37 offen sc1 lds
v_exp_f32 v84, v84
v_exp_f32 v85, v85
v_exp_f32 v86, v86
v_exp_f32 v87, v87
v_mul_f32 v192, v144, v192
v_mul_f32 v193, v145, v193
s_barrier
s_lshr_b32 s44, s2, 3
s_lshl_b32 s44, s44, 17
s_add_u32 s43, s44, 65536
buffer_load_dword v30, v29, s[80:83], s43 offen
s_add_u32 m0, s39, 98304
s_add_u32 s37, s37, s40
buffer_load_dwordx4 v21, s[8:11], s37 offen sc1 lds
v_mul_f32 v194, v146, v194
v_mul_f32 v195, v147, v195
v_fma_f32 v84, v84, v236, v236
v_fma_f32 v85, v85, v236, v236
v_fma_f32 v86, v86, v236, v236
v_fma_f32 v87, v87, v236, v236
v_rcp_f32 v84, v84
s_add_u32 m0, s39, 99328
s_add_u32 s37, s37, s38
buffer_load_dwordx4 v21, s[8:11], s37 offen sc1 lds
v_rcp_f32 v85, v85
v_rcp_f32 v86, v86
v_rcp_f32 v87, v87
v_mul_f32 v192, v192, v84
v_mul_f32 v193, v193, v85
v_mul_f32 v194, v194, v86
v_mul_f32 v195, v195, v87
s_add_u32 m0, s39, 100352
s_add_u32 s37, s37, s38
buffer_load_dwordx4 v21, s[8:11], s37 offen sc1 lds
v_cvt_pk_bf16_f32 v98, v192, v193
v_cvt_pk_bf16_f32 v99, v194, v195
v_mul_f32 v80, v160, v160
v_mul_f32 v81, v161, v161
v_mul_f32 v82, v162, v162
s_add_u32 m0, s39, 101376
s_add_u32 s37, s37, s38
buffer_load_dwordx4 v21, s[8:11], s37 offen sc1 lds
v_mul_f32 v83, v163, v163
v_fma_f32 v80, v80, v232, v228
v_fma_f32 v81, v81, v232, v228
v_fma_f32 v82, v82, v232, v228
v_fma_f32 v83, v83, v232, v228
v_mul_f32 v80, v80, v160
v_mul_f32 v81, v81, v161
s_add_u32 m0, s39, 102400
s_add_u32 s37, s37, s55
buffer_load_dwordx4 v21, s[8:11], s37 offen sc1 lds
v_mul_f32 v82, v82, v162
v_mul_f32 v83, v83, v163
v_exp_f32 v80, v80
v_exp_f32 v81, v81
v_exp_f32 v82, v82
v_exp_f32 v83, v83
v_mul_f32 v208, v160, v208
s_add_u32 m0, s39, 103424
s_add_u32 s37, s37, s38
buffer_load_dwordx4 v21, s[8:11], s37 offen sc1 lds
v_mul_f32 v209, v161, v209
v_mul_f32 v210, v162, v210
v_mul_f32 v211, v163, v211
v_fma_f32 v80, v80, v236, v236
v_fma_f32 v81, v81, v236, v236
v_fma_f32 v82, v82, v236, v236
s_add_u32 m0, s39, 104448
s_add_u32 s37, s37, s38
buffer_load_dwordx4 v21, s[8:11], s37 offen sc1 lds
v_fma_f32 v83, v83, v236, v236
v_rcp_f32 v80, v80
v_rcp_f32 v81, v81
v_rcp_f32 v82, v82
v_rcp_f32 v83, v83
v_mul_f32 v208, v208, v80
v_mul_f32 v209, v209, v81
s_add_u32 m0, s39, 105472
s_add_u32 s37, s37, s38
buffer_load_dwordx4 v21, s[8:11], s37 offen sc1 lds
v_mul_f32 v210, v210, v82
v_mul_f32 v211, v211, v83
v_cvt_pk_bf16_f32 v112, v208, v209
v_cvt_pk_bf16_f32 v113, v210, v211
v_mul_f32 v80, v132, v132
v_mul_f32 v81, v133, v133
buffer_store_dwordx4 v[96:99], v27, s[24:27], 0 offen offset:0 sc1
s_barrier
s_add_u32 m0, s39, 0
s_add_u32 s37, s37, s40
buffer_load_dwordx4 v21, s[8:11], s37 offen sc1 lds
v_mul_f32 v82, v134, v134
v_mul_f32 v83, v135, v135
v_fma_f32 v80, v80, v233, v229
v_fma_f32 v81, v81, v233, v229
v_fma_f32 v82, v82, v233, v229
v_fma_f32 v83, v83, v233, v229
v_mul_f32 v80, v80, v132
s_add_u32 m0, s39, 1024
s_add_u32 s37, s37, s38
buffer_load_dwordx4 v21, s[8:11], s37 offen sc1 lds
v_mul_f32 v81, v81, v133
v_mul_f32 v82, v82, v134
v_mul_f32 v83, v83, v135
v_exp_f32 v80, v80
v_exp_f32 v81, v81
v_exp_f32 v82, v82
s_add_u32 m0, s39, 2048
s_add_u32 s37, s37, s38
buffer_load_dwordx4 v21, s[8:11], s37 offen sc1 lds
v_exp_f32 v83, v83
v_mul_f32 v180, v132, v180
v_mul_f32 v181, v133, v181
v_mul_f32 v182, v134, v182
v_mul_f32 v183, v135, v183
v_fma_f32 v80, v80, v237, v237
v_fma_f32 v81, v81, v237, v237
s_add_u32 m0, s39, 3072
s_add_u32 s37, s37, s38
buffer_load_dwordx4 v21, s[8:11], s37 offen sc1 lds
v_fma_f32 v82, v82, v237, v237
v_fma_f32 v83, v83, v237, v237
v_rcp_f32 v80, v80
v_rcp_f32 v81, v81
v_rcp_f32 v82, v82
v_rcp_f32 v83, v83
s_add_u32 m0, s39, 4096
s_add_u32 s37, s37, s55
buffer_load_dwordx4 v21, s[8:11], s37 offen sc1 lds
v_mul_f32 v180, v180, v80
v_mul_f32 v181, v181, v81
v_mul_f32 v182, v182, v82
v_mul_f32 v183, v183, v83
v_cvt_pk_bf16_f32 v100, v180, v181
v_cvt_pk_bf16_f32 v101, v182, v183
v_mul_f32 v84, v148, v148
s_add_u32 m0, s39, 5120
s_add_u32 s37, s37, s38
buffer_load_dwordx4 v21, s[8:11], s37 offen sc1 lds
v_mul_f32 v85, v149, v149
v_mul_f32 v86, v150, v150
v_mul_f32 v87, v151, v151
v_fma_f32 v84, v84, v233, v229
v_fma_f32 v85, v85, v233, v229
v_fma_f32 v86, v86, v233, v229
s_add_u32 m0, s39, 6144
s_add_u32 s37, s37, s38
buffer_load_dwordx4 v21, s[8:11], s37 offen sc1 lds
v_fma_f32 v87, v87, v233, v229
v_mul_f32 v84, v84, v148
v_mul_f32 v85, v85, v149
v_mul_f32 v86, v86, v150
v_mul_f32 v87, v87, v151
v_exp_f32 v84, v84
v_exp_f32 v85, v85
s_add_u32 m0, s39, 7168
s_add_u32 s37, s37, s38
buffer_load_dwordx4 v21, s[8:11], s37 offen sc1 lds
v_exp_f32 v86, v86
v_exp_f32 v87, v87
v_mul_f32 v196, v148, v196
v_mul_f32 v197, v149, v197
v_mul_f32 v198, v150, v198
v_mul_f32 v199, v151, v199
s_waitcnt vmcnt(18)
s_barrier
s_add_u32 s43, s34, 48
s_lshl_b32 s43, s43, 7
v_mov_b32 v10, s43
v_mov_b32 v12, 16
buffer_load_dword v11, v10, s[56:59], 0 offen sc1
s_add_u32 m0, s39, 32768
s_add_u32 s37, s37, s40
buffer_load_dwordx4 v21, s[8:11], s37 offen sc1 lds
v_fma_f32 v84, v84, v237, v237
v_fma_f32 v85, v85, v237, v237
v_fma_f32 v86, v86, v237, v237
v_fma_f32 v87, v87, v237, v237
v_rcp_f32 v84, v84
v_rcp_f32 v85, v85
v_rcp_f32 v86, v86
s_add_u32 m0, s39, 33792
s_add_u32 s37, s37, s38
buffer_load_dwordx4 v21, s[8:11], s37 offen sc1 lds
v_rcp_f32 v87, v87
v_mul_f32 v196, v196, v84
v_mul_f32 v197, v197, v85
v_mul_f32 v198, v198, v86
v_mul_f32 v199, v199, v87
v_cvt_pk_bf16_f32 v102, v196, v197
v_cvt_pk_bf16_f32 v103, v198, v199
s_add_u32 m0, s39, 34816
s_add_u32 s37, s37, s38
buffer_load_dwordx4 v21, s[8:11], s37 offen sc1 lds
v_mul_f32 v80, v164, v164
v_mul_f32 v81, v165, v165
v_mul_f32 v82, v166, v166
v_mul_f32 v83, v167, v167
v_fma_f32 v80, v80, v233, v229
s_add_u32 m0, s39, 35840
s_add_u32 s37, s37, s38
buffer_load_dwordx4 v21, s[8:11], s37 offen sc1 lds
v_fma_f32 v81, v81, v233, v229
v_fma_f32 v82, v82, v233, v229
v_fma_f32 v83, v83, v233, v229
v_mul_f32 v80, v80, v164
v_mul_f32 v81, v81, v165
v_mul_f32 v82, v82, v166
v_mul_f32 v83, v83, v167
s_add_u32 m0, s39, 36864
s_add_u32 s37, s37, s55
buffer_load_dwordx4 v21, s[8:11], s37 offen sc1 lds
v_exp_f32 v80, v80
v_exp_f32 v81, v81
v_exp_f32 v82, v82
v_exp_f32 v83, v83
v_mul_f32 v212, v164, v212
v_mul_f32 v213, v165, v213
v_mul_f32 v214, v166, v214
s_add_u32 m0, s39, 37888
s_add_u32 s37, s37, s38
buffer_load_dwordx4 v21, s[8:11], s37 offen sc1 lds
v_mul_f32 v215, v167, v215
v_fma_f32 v80, v80, v237, v237
v_fma_f32 v81, v81, v237, v237
v_fma_f32 v82, v82, v237, v237
v_fma_f32 v83, v83, v237, v237
v_rcp_f32 v80, v80
s_add_u32 m0, s39, 38912
s_add_u32 s37, s37, s38
buffer_load_dwordx4 v21, s[8:11], s37 offen sc1 lds
v_rcp_f32 v81, v81
v_rcp_f32 v82, v82
v_rcp_f32 v83, v83
v_mul_f32 v212, v212, v80
v_mul_f32 v213, v213, v81
v_mul_f32 v214, v214, v82
v_mul_f32 v215, v215, v83
s_add_u32 m0, s39, 39936
s_add_u32 s37, s37, s38
buffer_load_dwordx4 v21, s[8:11], s37 offen sc1 lds
v_cvt_pk_bf16_f32 v114, v212, v213
v_cvt_pk_bf16_f32 v115, v214, v215
s_nop 1
v_permlane32_swap_b32 v112, v114
v_permlane32_swap_b32 v113, v115
buffer_store_dwordx4 v[100:103], v27, s[24:27], 0 offen offset:256 sc1
buffer_store_dwordx4 v[112:115], v28, s[24:27], 0 offen offset:0 sc1
s_waitcnt vmcnt(20)
s_barrier
s_add_u32 m0, s39, 65536
s_add_u32 s37, s37, s40
buffer_load_dwordx4 v21, s[8:11], s37 offen sc1 lds
v_mul_f32 v80, v136, v136
v_mul_f32 v81, v137, v137
v_mul_f32 v82, v138, v138
v_mul_f32 v83, v139, v139
v_fma_f32 v80, v80, v234, v230
v_fma_f32 v81, v81, v234, v230
v_fma_f32 v82, v82, v234, v230
s_add_u32 m0, s39, 66560
s_add_u32 s37, s37, s38
buffer_load_dwordx4 v21, s[8:11], s37 offen sc1 lds
v_fma_f32 v83, v83, v234, v230
v_mul_f32 v80, v80, v136
v_mul_f32 v81, v81, v137
v_mul_f32 v82, v82, v138
v_mul_f32 v83, v83, v139
v_exp_f32 v80, v80
s_add_u32 m0, s39, 67584
s_add_u32 s37, s37, s38
buffer_load_dwordx4 v21, s[8:11], s37 offen sc1 lds
v_exp_f32 v81, v81
v_exp_f32 v82, v82
v_exp_f32 v83, v83
v_mul_f32 v184, v136, v184
v_mul_f32 v185, v137, v185
v_mul_f32 v186, v138, v186
v_mul_f32 v187, v139, v187
s_add_u32 m0, s39, 68608
s_add_u32 s37, s37, s38
buffer_load_dwordx4 v21, s[8:11], s37 offen sc1 lds
v_fma_f32 v80, v80, v238, v238
v_fma_f32 v81, v81, v238, v238
v_fma_f32 v82, v82, v238, v238
v_fma_f32 v83, v83, v238, v238
v_rcp_f32 v80, v80
v_rcp_f32 v81, v81
s_add_u32 m0, s39, 69632
s_add_u32 s37, s37, s55
buffer_load_dwordx4 v21, s[8:11], s37 offen sc1 lds
v_rcp_f32 v82, v82
v_rcp_f32 v83, v83
v_mul_f32 v184, v184, v80
v_mul_f32 v185, v185, v81
v_mul_f32 v186, v186, v82
v_mul_f32 v187, v187, v83
v_cvt_pk_bf16_f32 v104, v184, v185
s_add_u32 m0, s39, 70656
s_add_u32 s37, s37, s38
buffer_load_dwordx4 v21, s[8:11], s37 offen sc1 lds
v_cvt_pk_bf16_f32 v105, v186, v187
v_mul_f32 v84, v152, v152
v_mul_f32 v85, v153, v153
v_mul_f32 v86, v154, v154
v_mul_f32 v87, v155, v155
v_fma_f32 v84, v84, v234, v230
s_add_u32 m0, s39, 71680
s_add_u32 s37, s37, s38
buffer_load_dwordx4 v21, s[8:11], s37 offen sc1 lds
v_fma_f32 v85, v85, v234, v230
v_fma_f32 v86, v86, v234, v230
v_fma_f32 v87, v87, v234, v230
v_mul_f32 v84, v84, v152
v_mul_f32 v85, v85, v153
v_mul_f32 v86, v86, v154
v_mul_f32 v87, v87, v155
s_add_u32 m0, s39, 72704
s_add_u32 s37, s37, s38
buffer_load_dwordx4 v21, s[8:11], s37 offen sc1 lds
v_exp_f32 v84, v84
v_exp_f32 v85, v85
v_exp_f32 v86, v86
v_exp_f32 v87, v87
v_mul_f32 v200, v152, v200
v_mul_f32 v201, v153, v201
s_waitcnt vmcnt(19)
s_barrier
s_add_u32 m0, s39, 98304
s_add_u32 s37, s37, s40
buffer_load_dwordx4 v21, s[8:11], s37 offen sc1 lds
v_mul_f32 v202, v154, v202
v_mul_f32 v203, v155, v203
v_fma_f32 v84, v84, v238, v238
v_fma_f32 v85, v85, v238, v238
v_fma_f32 v86, v86, v238, v238
v_fma_f32 v87, v87, v238, v238
v_rcp_f32 v84, v84
s_add_u32 m0, s39, 99328
s_add_u32 s37, s37, s38
buffer_load_dwordx4 v21, s[8:11], s37 offen sc1 lds
v_rcp_f32 v85, v85
v_rcp_f32 v86, v86
v_rcp_f32 v87, v87
v_mul_f32 v200, v200, v84
v_mul_f32 v201, v201, v85
v_mul_f32 v202, v202, v86
v_mul_f32 v203, v203, v87
s_add_u32 m0, s39, 100352
s_add_u32 s37, s37, s38
buffer_load_dwordx4 v21, s[8:11], s37 offen sc1 lds
v_cvt_pk_bf16_f32 v106, v200, v201
v_cvt_pk_bf16_f32 v107, v202, v203
v_mul_f32 v80, v168, v168
v_mul_f32 v81, v169, v169
v_mul_f32 v82, v170, v170
s_add_u32 m0, s39, 101376
s_add_u32 s37, s37, s38
buffer_load_dwordx4 v21, s[8:11], s37 offen sc1 lds
v_mul_f32 v83, v171, v171
v_fma_f32 v80, v80, v234, v230
v_fma_f32 v81, v81, v234, v230
v_fma_f32 v82, v82, v234, v230
v_fma_f32 v83, v83, v234, v230
v_mul_f32 v80, v80, v168
v_mul_f32 v81, v81, v169
s_add_u32 m0, s39, 102400
s_add_u32 s37, s37, s55
buffer_load_dwordx4 v21, s[8:11], s37 offen sc1 lds
v_mul_f32 v82, v82, v170
v_mul_f32 v83, v83, v171
v_exp_f32 v80, v80
v_exp_f32 v81, v81
v_exp_f32 v82, v82
v_exp_f32 v83, v83
v_mul_f32 v216, v168, v216
s_add_u32 m0, s39, 103424
s_add_u32 s37, s37, s38
buffer_load_dwordx4 v21, s[8:11], s37 offen sc1 lds
v_mul_f32 v217, v169, v217
v_mul_f32 v218, v170, v218
v_mul_f32 v219, v171, v219
v_fma_f32 v80, v80, v238, v238
v_fma_f32 v81, v81, v238, v238
v_fma_f32 v82, v82, v238, v238
s_add_u32 m0, s39, 104448
s_add_u32 s37, s37, s38
buffer_load_dwordx4 v21, s[8:11], s37 offen sc1 lds
v_fma_f32 v83, v83, v238, v238
v_rcp_f32 v80, v80
v_rcp_f32 v81, v81
v_rcp_f32 v82, v82
v_rcp_f32 v83, v83
v_mul_f32 v216, v216, v80
v_mul_f32 v217, v217, v81
s_add_u32 m0, s39, 105472
s_add_u32 s37, s37, s38
buffer_load_dwordx4 v21, s[8:11], s37 offen sc1 lds
v_mul_f32 v218, v218, v82
v_mul_f32 v219, v219, v83
v_cvt_pk_bf16_f32 v116, v216, v217
v_cvt_pk_bf16_f32 v117, v218, v219
v_mul_f32 v80, v140, v140
v_mul_f32 v81, v141, v141
buffer_store_dwordx4 v[104:107], v27, s[24:27], 0 offen offset:512 sc1
s_waitcnt vmcnt(19)
s_mov_b32 s41, 0x10000
s_waitcnt vmcnt(27)
s_branch Lpf_162
Lpoll_160:
s_waitcnt vmcnt(0)
Lpf_162:
v_cmp_ne_u32 vcc, v12, v11
s_nop 4
s_cbranch_vccz Lpok_161
buffer_load_dword v11, v10, s[56:59], 0 offen sc1
s_sub_u32 s41, s41, 1
s_cmp_lg_u32 s41, 0
s_cbranch_scc1 Lpoll_160
s_waitcnt vmcnt(0)
Lpok_161:
s_barrier
s_add_u32 s37, s37, s29
s_add_u32 m0, s39, 0
s_add_u32 s37, s37, s40
buffer_load_dwordx4 v21, s[8:11], s37 offen sc1 lds
v_mul_f32 v82, v142, v142
v_mul_f32 v83, v143, v143
v_fma_f32 v80, v80, v235, v231
v_fma_f32 v81, v81, v235, v231
v_fma_f32 v82, v82, v235, v231
v_fma_f32 v83, v83, v235, v231
v_mul_f32 v80, v80, v140
s_add_u32 m0, s39, 1024
s_add_u32 s37, s37, s38
buffer_load_dwordx4 v21, s[8:11], s37 offen sc1 lds
v_mul_f32 v81, v81, v141
v_mul_f32 v82, v82, v142
v_mul_f32 v83, v83, v143
v_exp_f32 v80, v80
v_exp_f32 v81, v81
v_exp_f32 v82, v82
s_add_u32 m0, s39, 2048
s_add_u32 s37, s37, s38
buffer_load_dwordx4 v21, s[8:11], s37 offen sc1 lds
v_exp_f32 v83, v83
v_mul_f32 v188, v140, v188
v_mul_f32 v189, v141, v189
v_mul_f32 v190, v142, v190
v_mul_f32 v191, v143, v191
v_fma_f32 v80, v80, v239, v239
v_fma_f32 v81, v81, v239, v239
s_add_u32 m0, s39, 3072
s_add_u32 s37, s37, s38
buffer_load_dwordx4 v21, s[8:11], s37 offen sc1 lds
v_fma_f32 v82, v82, v239, v239
v_fma_f32 v83, v83, v239, v239
v_rcp_f32 v80, v80
v_rcp_f32 v81, v81
v_rcp_f32 v82, v82
v_rcp_f32 v83, v83
s_add_u32 m0, s39, 4096
s_add_u32 s37, s37, s55
buffer_load_dwordx4 v21, s[8:11], s37 offen sc1 lds
v_mul_f32 v188, v188, v80
v_mul_f32 v189, v189, v81
v_mul_f32 v190, v190, v82
v_mul_f32 v191, v191, v83
v_cvt_pk_bf16_f32 v108, v188, v189
v_cvt_pk_bf16_f32 v109, v190, v191
v_mul_f32 v84, v156, v156
s_add_u32 m0, s39, 5120
s_add_u32 s37, s37, s38
buffer_load_dwordx4 v21, s[8:11], s37 offen sc1 lds
v_mul_f32 v85, v157, v157
v_mul_f32 v86, v158, v158
v_mul_f32 v87, v159, v159
v_fma_f32 v84, v84, v235, v231
v_fma_f32 v85, v85, v235, v231
v_fma_f32 v86, v86, v235, v231
s_add_u32 m0, s39, 6144
s_add_u32 s37, s37, s38
buffer_load_dwordx4 v21, s[8:11], s37 offen sc1 lds
v_fma_f32 v87, v87, v235, v231
v_mul_f32 v84, v84, v156
v_mul_f32 v85, v85, v157
v_mul_f32 v86, v86, v158
v_mul_f32 v87, v87, v159
v_exp_f32 v84, v84
v_exp_f32 v85, v85
s_add_u32 m0, s39, 7168
s_add_u32 s37, s37, s38
buffer_load_dwordx4 v21, s[8:11], s37 offen sc1 lds
v_exp_f32 v86, v86
v_exp_f32 v87, v87
v_mul_f32 v204, v156, v204
v_mul_f32 v205, v157, v205
v_mul_f32 v206, v158, v206
v_mul_f32 v207, v159, v207
s_waitcnt vmcnt(17)
s_barrier
s_add_u32 m0, s39, 32768
s_add_u32 s37, s37, s40
buffer_load_dwordx4 v21, s[8:11], s37 offen sc1 lds
v_fma_f32 v84, v84, v239, v239
v_fma_f32 v85, v85, v239, v239
v_fma_f32 v86, v86, v239, v239
v_fma_f32 v87, v87, v239, v239
v_rcp_f32 v84, v84
v_rcp_f32 v85, v85
v_rcp_f32 v86, v86
s_add_u32 m0, s39, 33792
s_add_u32 s37, s37, s38
buffer_load_dwordx4 v21, s[8:11], s37 offen sc1 lds
v_rcp_f32 v87, v87
v_mul_f32 v204, v204, v84
v_mul_f32 v205, v205, v85
v_mul_f32 v206, v206, v86
v_mul_f32 v207, v207, v87
v_cvt_pk_bf16_f32 v110, v204, v205
v_cvt_pk_bf16_f32 v111, v206, v207
s_add_u32 m0, s39, 34816
s_add_u32 s37, s37, s38
buffer_load_dwordx4 v21, s[8:11], s37 offen sc1 lds
v_mul_f32 v80, v172, v172
v_mul_f32 v81, v173, v173
v_mul_f32 v82, v174, v174
v_mul_f32 v83, v175, v175
v_fma_f32 v80, v80, v235, v231
s_add_u32 m0, s39, 35840
s_add_u32 s37, s37, s38
buffer_load_dwordx4 v21, s[8:11], s37 offen sc1 lds
v_fma_f32 v81, v81, v235, v231
v_fma_f32 v82, v82, v235, v231
v_fma_f32 v83, v83, v235, v231
v_mul_f32 v80, v80, v172
v_mul_f32 v81, v81, v173
v_mul_f32 v82, v82, v174
v_mul_f32 v83, v83, v175
s_add_u32 m0, s39, 36864
s_add_u32 s37, s37, s55
buffer_load_dwordx4 v21, s[8:11], s37 offen sc1 lds
v_exp_f32 v80, v80
v_exp_f32 v81, v81
v_exp_f32 v82, v82
v_exp_f32 v83, v83
v_mul_f32 v220, v172, v220
v_mul_f32 v221, v173, v221
v_mul_f32 v222, v174, v222
s_add_u32 m0, s39, 37888
s_add_u32 s37, s37, s38
buffer_load_dwordx4 v21, s[8:11], s37 offen sc1 lds
v_mul_f32 v223, v175, v223
v_fma_f32 v80, v80, v239, v239
v_fma_f32 v81, v81, v239, v239
v_fma_f32 v82, v82, v239, v239
v_fma_f32 v83, v83, v239, v239
v_rcp_f32 v80, v80
s_add_u32 m0, s39, 38912
s_add_u32 s37, s37, s38
buffer_load_dwordx4 v21, s[8:11], s37 offen sc1 lds
v_rcp_f32 v81, v81
v_rcp_f32 v82, v82
v_rcp_f32 v83, v83
v_mul_f32 v220, v220, v80
v_mul_f32 v221, v221, v81
v_mul_f32 v222, v222, v82
v_mul_f32 v223, v223, v83
s_add_u32 m0, s39, 39936
s_add_u32 s37, s37, s38
buffer_load_dwordx4 v21, s[8:11], s37 offen sc1 lds
v_cvt_pk_bf16_f32 v118, v220, v221
v_cvt_pk_bf16_f32 v119, v222, v223
s_nop 1
v_permlane32_swap_b32 v116, v118
v_permlane32_swap_b32 v117, v119
buffer_store_dwordx4 v[108:111], v27, s[24:27], 0 offen offset:768 sc1
buffer_store_dwordx4 v[116:119], v28, s[24:27], 0 offen offset:512 sc1
s_waitcnt vmcnt(19)
s_barrier
s_add_u32 m0, s39, 65536
s_add_u32 s37, s37, s40
buffer_load_dwordx4 v21, s[8:11], s37 offen sc1 lds
s_add_u32 m0, s39, 66560
s_add_u32 s37, s37, s38
buffer_load_dwordx4 v21, s[8:11], s37 offen sc1 lds
s_add_u32 m0, s39, 67584
s_add_u32 s37, s37, s38
buffer_load_dwordx4 v21, s[8:11], s37 offen sc1 lds
s_add_u32 m0, s39, 68608
s_add_u32 s37, s37, s38
buffer_load_dwordx4 v21, s[8:11], s37 offen sc1 lds
s_add_u32 m0, s39, 69632
s_add_u32 s37, s37, s55
buffer_load_dwordx4 v21, s[8:11], s37 offen sc1 lds
s_add_u32 m0, s39, 70656
s_add_u32 s37, s37, s38
buffer_load_dwordx4 v21, s[8:11], s37 offen sc1 lds
s_add_u32 m0, s39, 71680
s_add_u32 s37, s37, s38
buffer_load_dwordx4 v21, s[8:11], s37 offen sc1 lds
s_add_u32 m0, s39, 72704
s_add_u32 s37, s37, s38
buffer_load_dwordx4 v21, s[8:11], s37 offen sc1 lds
s_waitcnt vmcnt(8)
s_barrier
s_cmp_ge_u32 s50, 12
s_cselect_b32 s44, 64, 0
s_add_u32 s44, s44, s34
s_add_u32 s43, s44, 64
s_lshl_b32 s43, s43, 7
v_mov_b32 v10, s43
v_mov_b32 v11, 1
s_mov_b64 exec, 1
buffer_atomic_add v11, v10, s[56:59], 0 offen sc1
s_mov_b64 exec, -1
s_add_u32 m0, s39, 98304
s_add_u32 s37, s37, s40
buffer_load_dwordx4 v21, s[8:11], s37 offen sc1 lds
s_add_u32 m0, s39, 99328
s_add_u32 s37, s37, s38
buffer_load_dwordx4 v21, s[8:11], s37 offen sc1 lds
s_add_u32 m0, s39, 100352
s_add_u32 s37, s37, s38
buffer_load_dwordx4 v21, s[8:11], s37 offen sc1 lds
s_add_u32 m0, s39, 101376
s_add_u32 s37, s37, s38
buffer_load_dwordx4 v21, s[8:11], s37 offen sc1 lds
s_add_u32 m0, s39, 102400
s_add_u32 s37, s37, s55
buffer_load_dwordx4 v21, s[8:11], s37 offen sc1 lds
s_add_u32 m0, s39, 103424
s_add_u32 s37, s37, s38
buffer_load_dwordx4 v21, s[8:11], s37 offen sc1 lds
s_add_u32 m0, s39, 104448
s_add_u32 s37, s37, s38
buffer_load_dwordx4 v21, s[8:11], s37 offen sc1 lds
s_add_u32 m0, s39, 105472
s_add_u32 s37, s37, s38
buffer_load_dwordx4 v21, s[8:11], s37 offen sc1 lds
s_waitcnt vmcnt(19)
s_barrier
s_lshr_b32 s44, s2, 3
s_lshl_b32 s44, s44, 16
s_add_u32 s43, s44, 4194304
buffer_load_dword v30, v29, s[80:83], s43 offen
s_add_u32 m0, s39, 0
s_add_u32 s37, s37, s40
buffer_load_dwordx4 v21, s[8:11], s37 offen sc1 lds
s_add_u32 m0, s39, 1024
s_add_u32 s37, s37, s38
buffer_load_dwordx4 v21, s[8:11], s37 offen sc1 lds
s_add_u32 m0, s39, 2048
s_add_u32 s37, s37, s38
buffer_load_dwordx4 v21, s[8:11], s37 offen sc1 lds
s_add_u32 m0, s39, 3072
s_add_u32 s37, s37, s38
buffer_load_dwordx4 v21, s[8:11], s37 offen sc1 lds
s_add_u32 m0, s39, 4096
s_add_u32 s37, s37, s55
buffer_load_dwordx4 v21, s[8:11], s37 offen sc1 lds
s_add_u32 m0, s39, 5120
s_add_u32 s37, s37, s38
buffer_load_dwordx4 v21, s[8:11], s37 offen sc1 lds
s_add_u32 m0, s39, 6144
s_add_u32 s37, s37, s38
buffer_load_dwordx4 v21, s[8:11], s37 offen sc1 lds
s_add_u32 m0, s39, 7168
s_add_u32 s37, s37, s38
buffer_load_dwordx4 v21, s[8:11], s37 offen sc1 lds
s_waitcnt vmcnt(18)
s_barrier
s_add_u32 s43, s34, 64
s_lshl_b32 s43, s43, 7
v_mov_b32 v10, s43
v_mov_b32 v12, 12
buffer_load_dword v11, v10, s[56:59], 0 offen sc1
s_add_u32 m0, s39, 32768
s_add_u32 s37, s37, s40
buffer_load_dwordx4 v21, s[8:11], s37 offen sc1 lds
s_add_u32 m0, s39, 33792
s_add_u32 s37, s37, s38
buffer_load_dwordx4 v21, s[8:11], s37 offen sc1 lds
s_add_u32 m0, s39, 34816
s_add_u32 s37, s37, s38
buffer_load_dwordx4 v21, s[8:11], s37 offen sc1 lds
s_add_u32 m0, s39, 35840
s_add_u32 s37, s37, s38
buffer_load_dwordx4 v21, s[8:11], s37 offen sc1 lds
s_add_u32 m0, s39, 36864
s_add_u32 s37, s37, s55
buffer_load_dwordx4 v21, s[8:11], s37 offen sc1 lds
s_add_u32 m0, s39, 37888
s_add_u32 s37, s37, s38
buffer_load_dwordx4 v21, s[8:11], s37 offen sc1 lds
s_add_u32 m0, s39, 38912
s_add_u32 s37, s37, s38
buffer_load_dwordx4 v21, s[8:11], s37 offen sc1 lds
s_add_u32 m0, s39, 39936
s_add_u32 s37, s37, s38
buffer_load_dwordx4 v21, s[8:11], s37 offen sc1 lds
s_waitcnt vmcnt(18)
s_barrier
s_add_u32 m0, s39, 65536
s_add_u32 s37, s37, s40
buffer_load_dwordx4 v21, s[8:11], s37 offen sc1 lds
s_add_u32 m0, s39, 66560
s_add_u32 s37, s37, s38
buffer_load_dwordx4 v21, s[8:11], s37 offen sc1 lds
s_add_u32 m0, s39, 67584
s_add_u32 s37, s37, s38
buffer_load_dwordx4 v21, s[8:11], s37 offen sc1 lds
s_add_u32 m0, s39, 68608
s_add_u32 s37, s37, s38
buffer_load_dwordx4 v21, s[8:11], s37 offen sc1 lds
s_add_u32 m0, s39, 69632
s_add_u32 s37, s37, s55
buffer_load_dwordx4 v21, s[8:11], s37 offen sc1 lds
s_add_u32 m0, s39, 70656
s_add_u32 s37, s37, s38
buffer_load_dwordx4 v21, s[8:11], s37 offen sc1 lds
s_add_u32 m0, s39, 71680
s_add_u32 s37, s37, s38
buffer_load_dwordx4 v21, s[8:11], s37 offen sc1 lds
s_add_u32 m0, s39, 72704
s_add_u32 s37, s37, s38
buffer_load_dwordx4 v21, s[8:11], s37 offen sc1 lds
s_waitcnt vmcnt(17)
s_barrier
s_branch Lw_163
Lr_164:
s_add_u32 m0, s39, 98304
s_add_u32 s37, s37, s40
buffer_load_dwordx4 v21, s[8:11], s37 offen sc1 lds
s_add_u32 m0, s39, 99328
s_add_u32 s37, s37, s38
buffer_load_dwordx4 v21, s[8:11], s37 offen sc1 lds
s_add_u32 m0, s39, 100352
s_add_u32 s37, s37, s38
buffer_load_dwordx4 v21, s[8:11], s37 offen sc1 lds
s_add_u32 m0, s39, 101376
s_add_u32 s37, s37, s38
buffer_load_dwordx4 v21, s[8:11], s37 offen sc1 lds
s_add_u32 m0, s39, 102400
s_add_u32 s37, s37, s55
buffer_load_dwordx4 v21, s[8:11], s37 offen sc1 lds
s_add_u32 m0, s39, 103424
s_add_u32 s37, s37, s38
buffer_load_dwordx4 v21, s[8:11], s37 offen sc1 lds
s_add_u32 m0, s39, 104448
s_add_u32 s37, s37, s38
buffer_load_dwordx4 v21, s[8:11], s37 offen sc1 lds
s_add_u32 m0, s39, 105472
s_add_u32 s37, s37, s38
buffer_load_dwordx4 v21, s[8:11], s37 offen sc1 lds
s_waitcnt vmcnt(16)
s_mov_b32 s41, 0x10000
s_waitcnt vmcnt(24)
s_branch Lpf_167
Lpoll_165:
s_waitcnt vmcnt(0)
Lpf_167:
v_cmp_ne_u32 vcc, v12, v11
s_nop 4
s_cbranch_vccz Lpok_166
buffer_load_dword v11, v10, s[56:59], 0 offen sc1
s_sub_u32 s41, s41, 1
s_cmp_lg_u32 s41, 0
s_cbranch_scc1 Lpoll_165
s_waitcnt vmcnt(0)
Lpok_166:
s_barrier
s_mul_i32 s40, s53, 983040
s_add_u32 m0, s39, 0
s_add_u32 s37, s40, 4194304
buffer_load_dwordx4 v21, s[8:11], s37 offen sc1 lds
s_add_u32 m0, s39, 1024
s_add_u32 s37, s40, 4210688
buffer_load_dwordx4 v21, s[8:11], s37 offen sc1 lds
s_add_u32 m0, s39, 2048
s_add_u32 s37, s40, 4227072
buffer_load_dwordx4 v21, s[8:11], s37 offen sc1 lds
s_add_u32 m0, s39, 3072
s_add_u32 s37, s40, 4243456
buffer_load_dwordx4 v21, s[8:11], s37 offen sc1 lds
s_add_u32 m0, s39, 4096
s_add_u32 s37, s40, 4292608
buffer_load_dwordx4 v21, s[8:11], s37 offen sc1 lds
s_add_u32 m0, s39, 5120
s_add_u32 s37, s40, 4308992
buffer_load_dwordx4 v21, s[8:11], s37 offen sc1 lds
s_add_u32 m0, s39, 6144
s_add_u32 s37, s40, 4325376
buffer_load_dwordx4 v21, s[8:11], s37 offen sc1 lds
s_add_u32 m0, s39, 7168
s_add_u32 s37, s40, 4341760
buffer_load_dwordx4 v21, s[8:11], s37 offen sc1 lds
s_waitcnt vmcnt(16)
s_barrier
s_add_u32 m0, s39, 32768
s_add_u32 s37, s40, 4259840
buffer_load_dwordx4 v21, s[8:11], s37 offen sc1 lds
s_add_u32 m0, s39, 33792
s_add_u32 s37, s40, 4358144
buffer_load_dwordx4 v21, s[8:11], s37 offen sc1 lds
s_add_u32 m0, s39, 34816
s_add_u32 s37, s40, 4276224
buffer_load_dwordx4 v21, s[8:11], s37 offen sc1 lds
s_add_u32 m0, s39, 35840
s_add_u32 s37, s40, 4374528
buffer_load_dwordx4 v21, s[8:11], s37 offen sc1 lds
s_add_u32 m0, s39, 36864
s_add_u32 s37, s40, 4390912
buffer_load_dwordx4 v21, s[8:11], s37 offen sc1 lds
s_add_u32 m0, s39, 37888
s_add_u32 s37, s40, 4407296
buffer_load_dwordx4 v21, s[8:11], s37 offen sc1 lds
s_add_u32 m0, s39, 38912
s_add_u32 s37, s40, 4423680
buffer_load_dwordx4 v21, s[8:11], s37 offen sc1 lds
s_add_u32 m0, s39, 39936
s_add_u32 s37, s40, 4440064
buffer_load_dwordx4 v21, s[8:11], s37 offen sc1 lds
s_waitcnt vmcnt(16)
s_barrier
s_add_u32 m0, s39, 65536
s_add_u32 s37, s40, 4489216
buffer_load_dwordx4 v21, s[8:11], s37 offen sc1 lds
s_add_u32 m0, s39, 66560
s_add_u32 s37, s40, 4505600
buffer_load_dwordx4 v21, s[8:11], s37 offen sc1 lds
s_add_u32 m0, s39, 67584
s_add_u32 s37, s40, 4521984
buffer_load_dwordx4 v21, s[8:11], s37 offen sc1 lds
s_add_u32 m0, s39, 68608
s_add_u32 s37, s40, 4538368
buffer_load_dwordx4 v21, s[8:11], s37 offen sc1 lds
s_add_u32 m0, s39, 69632
s_add_u32 s37, s40, 4456448
buffer_load_dwordx4 v21, s[8:11], s37 offen sc1 lds
s_add_u32 m0, s39, 70656
s_add_u32 s37, s40, 4554752
buffer_load_dwordx4 v21, s[8:11], s37 offen sc1 lds
s_add_u32 m0, s39, 71680
s_add_u32 s37, s40, 4472832
buffer_load_dwordx4 v21, s[8:11], s37 offen sc1 lds
s_add_u32 m0, s39, 72704
s_add_u32 s37, s40, 4571136
buffer_load_dwordx4 v21, s[8:11], s37 offen sc1 lds
s_waitcnt vmcnt(16)
s_barrier
s_add_u32 m0, s39, 98304
s_add_u32 s37, s40, 4784128
buffer_load_dwordx4 v21, s[8:11], s37 offen sc1 lds
s_add_u32 m0, s39, 99328
s_add_u32 s37, s40, 4800512
buffer_load_dwordx4 v21, s[8:11], s37 offen sc1 lds
s_add_u32 m0, s39, 100352
s_add_u32 s37, s40, 4816896
buffer_load_dwordx4 v21, s[8:11], s37 offen sc1 lds
s_add_u32 m0, s39, 101376
s_add_u32 s37, s40, 4833280
buffer_load_dwordx4 v21, s[8:11], s37 offen sc1 lds
s_add_u32 m0, s39, 102400
s_add_u32 s37, s40, 4882432
buffer_load_dwordx4 v21, s[8:11], s37 offen sc1 lds
s_add_u32 m0, s39, 103424
s_add_u32 s37, s40, 4898816
buffer_load_dwordx4 v21, s[8:11], s37 offen sc1 lds
s_add_u32 m0, s39, 104448
s_add_u32 s37, s40, 4915200
buffer_load_dwordx4 v21, s[8:11], s37 offen sc1 lds
s_add_u32 m0, s39, 105472
s_add_u32 s37, s40, 4931584
buffer_load_dwordx4 v21, s[8:11], s37 offen sc1 lds
s_waitcnt vmcnt(16)
s_barrier
s_lshr_b32 s44, s2, 3
s_and_b32 s44, s44, 15
s_lshl_b32 s44, s44, 16
s_add_u32 s43, s44, 6291456
buffer_load_dword v30, v29, s[80:83], s43 offen
s_add_u32 m0, s39, 0
s_add_u32 s37, s40, 4849664
buffer_load_dwordx4 v21, s[8:11], s37 offen sc1 lds
s_add_u32 m0, s39, 1024
s_add_u32 s37, s40, 4947968
buffer_load_dwordx4 v21, s[8:11], s37 offen sc1 lds
s_add_u32 m0, s39, 2048
s_add_u32 s37, s40, 4866048
buffer_load_dwordx4 v21, s[8:11], s37 offen sc1 lds
s_add_u32 m0, s39, 3072
s_add_u32 s37, s40, 4964352
buffer_load_dwordx4 v21, s[8:11], s37 offen sc1 lds
s_add_u32 m0, s39, 4096
s_add_u32 s37, s40, 4980736
buffer_load_dwordx4 v21, s[8:11], s37 offen sc1 lds
s_add_u32 m0, s39, 5120
s_add_u32 s37, s40, 4997120
buffer_load_dwordx4 v21, s[8:11], s37 offen sc1 lds
s_add_u32 m0, s39, 6144
s_add_u32 s37, s40, 5013504
buffer_load_dwordx4 v21, s[8:11], s37 offen sc1 lds
s_add_u32 m0, s39, 7168
s_add_u32 s37, s40, 5029888
buffer_load_dwordx4 v21, s[8:11], s37 offen sc1 lds
s_waitcnt vmcnt(17)
s_barrier
s_add_u32 m0, s39, 32768
s_add_u32 s37, s40, 5079040
buffer_load_dwordx4 v21, s[8:11], s37 offen sc1 lds
s_add_u32 m0, s39, 33792
s_add_u32 s37, s40, 5095424
buffer_load_dwordx4 v21, s[8:11], s37 offen sc1 lds
s_add_u32 m0, s39, 34816
s_add_u32 s37, s40, 5111808
buffer_load_dwordx4 v21, s[8:11], s37 offen sc1 lds
s_add_u32 m0, s39, 35840
s_add_u32 s37, s40, 5128192
buffer_load_dwordx4 v21, s[8:11], s37 offen sc1 lds
s_add_u32 m0, s39, 36864
s_add_u32 s37, s40, 5046272
buffer_load_dwordx4 v21, s[8:11], s37 offen sc1 lds
s_add_u32 m0, s39, 37888
s_add_u32 s37, s40, 5144576
buffer_load_dwordx4 v21, s[8:11], s37 offen sc1 lds
s_add_u32 m0, s39, 38912
s_add_u32 s37, s40, 5062656
buffer_load_dwordx4 v21, s[8:11], s37 offen sc1 lds
s_add_u32 m0, s39, 39936
s_add_u32 s37, s40, 5160960
buffer_load_dwordx4 v21, s[8:11], s37 offen sc1 lds
s_waitcnt vmcnt(17)
s_barrier
s_waitcnt vmcnt(8)
s_barrier
s_waitcnt vmcnt(0)
s_barrier
s_barrier
s_add_u32 s43, s34, 128
s_lshl_b32 s43, s43, 7
v_mov_b32 v13, s43
v_mov_b32 v15, 4
buffer_load_dword v14, v13, s[56:59], 0 offen sc1
s_barrier
s_barrier
s_mov_b32 s41, 0x10000
Lpoll_168:
s_waitcnt vmcnt(0)
Lpf_170:
v_cmp_ne_u32 vcc, v15, v14
s_nop 4
s_cbranch_vccz Lpok_169
buffer_load_dword v14, v13, s[56:59], 0 offen sc1
s_sub_u32 s41, s41, 1
s_cmp_lg_u32 s41, 0
s_cbranch_scc1 Lpoll_168
s_waitcnt vmcnt(0)
Lpok_169:
s_barrier
s_barrier
s_lshl_b32 s43, s34, 4
s_add_u32 s43, s43, s35
s_and_b32 s44, s43, 1
s_lshl_b32 s44, s44, 2
s_lshr_b32 s43, s43, 1
s_add_u32 s43, s43, 144
s_lshl_b32 s43, s43, 7
s_add_u32 s43, s43, s44
v_mov_b32 v10, s43
v_mov_b32 v11, 1
s_mov_b64 exec, 1
buffer_store_dword v11, v10, s[56:59], 0 offen sc1
s_mov_b64 exec, -1
s_barrier
s_barrier
s_barrier
s_lshl_b32 s43, s34, 4
s_add_u32 s43, s43, s35
s_xor_b32 s43, s43, 1
s_and_b32 s44, s43, 1
s_lshl_b32 s44, s44, 2
s_lshr_b32 s43, s43, 1
s_add_u32 s43, s43, 144
s_lshl_b32 s43, s43, 7
s_add_u32 s43, s43, s44
v_mov_b32 v10, s43
v_mov_b32 v12, 1
buffer_load_dword v11, v10, s[56:59], 0 offen sc1
s_barrier
s_barrier
s_mov_b32 s41, 0x10000
Lpoll_171:
s_waitcnt vmcnt(0)
Lpf_173:
v_cmp_ne_u32 vcc, v12, v11
s_nop 4
s_cbranch_vccz Lpok_172
buffer_load_dword v11, v10, s[56:59], 0 offen sc1
s_sub_u32 s41, s41, 1
s_cmp_lg_u32 s41, 0
s_cbranch_scc1 Lpoll_171
s_waitcnt vmcnt(0)
Lpok_172:
s_barrier
s_branch Ldone_1
Lxr_8:
v_add_u32 v15, 0, v10
v_xor_b32 v16, 64, v15
ds_read_b128 v[240:243], v15 offset:0
ds_read_b128 v[244:247], v16 offset:0
ds_read_b128 v[248:251], v15 offset:128
ds_read_b128 v[252:255], v16 offset:128
s_branch Lxb_9
Lxr_10:
v_add_u32 v15, 43008, v10
v_xor_b32 v16, 64, v15
ds_read_b128 v[240:243], v15 offset:0
ds_read_b128 v[244:247], v16 offset:0
ds_read_b128 v[248:251], v15 offset:128
ds_read_b128 v[252:255], v16 offset:128
s_branch Lxb_11
Lxr_12:
v_add_u32 v15, 86016, v10
v_xor_b32 v16, 64, v15
ds_read_b128 v[240:243], v15 offset:0
ds_read_b128 v[244:247], v16 offset:0
ds_read_b128 v[248:251], v15 offset:128
ds_read_b128 v[252:255], v16 offset:128
s_branch Lxb_13
Lxr_14:
v_add_u32 v15, 0, v10
v_xor_b32 v16, 64, v15
ds_read_b128 v[240:243], v15 offset:0
ds_read_b128 v[244:247], v16 offset:0
ds_read_b128 v[248:251], v15 offset:128
ds_read_b128 v[252:255], v16 offset:128
s_branch Lxb_15
Lfx_53:
s_xor_b32 s44, s35, 1
s_and_b32 s44, s44, 15
s_lshl_b32 s44, s44, 14
s_add_u32 s43, s44, 0x2000
s_mov_b32 s45, 0x20000
Lre_52:
buffer_load_dwordx4 v[80:83], v2, s[12:15], s44 offen offset:0 sc1
buffer_load_dwordx4 v[84:87], v2, s[12:15], s44 offen offset:256 sc1
buffer_load_dwordx4 v[88:91], v2, s[12:15], s43 offen offset:0 sc1
buffer_load_dwordx4 v[92:95], v2, s[12:15], s43 offen offset:256 sc1
s_waitcnt vmcnt(0)
v_max3_u32 v19, v80, v81, v82
v_max3_u32 v19, v19, v83, v84
v_max3_u32 v19, v19, v85, v86
v_max3_u32 v19, v19, v87, v88
v_max3_u32 v19, v19, v89, v90
v_max3_u32 v19, v19, v91, v92
v_max3_u32 v19, v19, v93, v94
v_max_u32 v19, v19, v95
v_cmp_eq_u32 vcc, -1, v19
s_sub_u32 s45, s45, 1
s_cmp_eq_u32 s45, 0
s_cbranch_scc1 Lok_51
s_nop 2
s_cbranch_vccnz Lre_52
s_branch Lok_51
Lfx_56:
s_xor_b32 s44, s35, 2
s_and_b32 s44, s44, 15
s_lshl_b32 s44, s44, 14
s_add_u32 s43, s44, 0x2000
s_mov_b32 s45, 0x20000
Lre_55:
buffer_load_dwordx4 v[32:35], v2, s[12:15], s44 offen offset:0 sc1
buffer_load_dwordx4 v[36:39], v2, s[12:15], s44 offen offset:256 sc1
buffer_load_dwordx4 v[40:43], v2, s[12:15], s43 offen offset:0 sc1
buffer_load_dwordx4 v[44:47], v2, s[12:15], s43 offen offset:256 sc1
s_waitcnt vmcnt(0)
v_max3_u32 v19, v32, v33, v34
v_max3_u32 v19, v19, v35, v36
v_max3_u32 v19, v19, v37, v38
v_max3_u32 v19, v19, v39, v40
v_max3_u32 v19, v19, v41, v42
v_max3_u32 v19, v19, v43, v44
v_max3_u32 v19, v19, v45, v46
v_max_u32 v19, v19, v47
v_cmp_eq_u32 vcc, -1, v19
s_sub_u32 s45, s45, 1
s_cmp_eq_u32 s45, 0
s_cbranch_scc1 Lok_54
s_nop 2
s_cbranch_vccnz Lre_55
s_branch Lok_54
Lfx_59:
s_xor_b32 s44, s35, 3
s_and_b32 s44, s44, 15
s_lshl_b32 s44, s44, 14
s_add_u32 s43, s44, 0x2000
s_mov_b32 s45, 0x20000
Lre_58:
buffer_load_dwordx4 v[80:83], v2, s[12:15], s44 offen offset:0 sc1
buffer_load_dwordx4 v[84:87], v2, s[12:15], s44 offen offset:256 sc1
buffer_load_dwordx4 v[88:91], v2, s[12:15], s43 offen offset:0 sc1
buffer_load_dwordx4 v[92:95], v2, s[12:15], s43 offen offset:256 sc1
s_waitcnt vmcnt(0)
v_max3_u32 v19, v80, v81, v82
v_max3_u32 v19, v19, v83, v84
v_max3_u32 v19, v19, v85, v86
v_max3_u32 v19, v19, v87, v88
v_max3_u32 v19, v19, v89, v90
v_max3_u32 v19, v19, v91, v92
v_max3_u32 v19, v19, v93, v94
v_max_u32 v19, v19, v95
v_cmp_eq_u32 vcc, -1, v19
s_sub_u32 s45, s45, 1
s_cmp_eq_u32 s45, 0
s_cbranch_scc1 Lok_57
s_nop 2
s_cbranch_vccnz Lre_58
s_branch Lok_57
Lfx_62:
s_xor_b32 s44, s35, 4
s_and_b32 s44, s44, 15
s_lshl_b32 s44, s44, 14
s_add_u32 s43, s44, 0x2000
s_mov_b32 s45, 0x20000
Lre_61:
buffer_load_dwordx4 v[32:35], v2, s[12:15], s44 offen offset:0 sc1
buffer_load_dwordx4 v[36:39], v2, s[12:15], s44 offen offset:256 sc1
buffer_load_dwordx4 v[40:43], v2, s[12:15], s43 offen offset:0 sc1
buffer_load_dwordx4 v[44:47], v2, s[12:15], s43 offen offset:256 sc1
s_waitcnt vmcnt(0)
v_max3_u32 v19, v32, v33, v34
v_max3_u32 v19, v19, v35, v36
v_max3_u32 v19, v19, v37, v38
v_max3_u32 v19, v19, v39, v40
v_max3_u32 v19, v19, v41, v42
v_max3_u32 v19, v19, v43, v44
v_max3_u32 v19, v19, v45, v46
v_max_u32 v19, v19, v47
v_cmp_eq_u32 vcc, -1, v19
s_sub_u32 s45, s45, 1
s_cmp_eq_u32 s45, 0
s_cbranch_scc1 Lok_60
s_nop 2
s_cbranch_vccnz Lre_61
s_branch Lok_60
Lfx_65:
s_xor_b32 s44, s35, 5
s_and_b32 s44, s44, 15
s_lshl_b32 s44, s44, 14
s_add_u32 s43, s44, 0x2000
s_mov_b32 s45, 0x20000
Lre_64:
buffer_load_dwordx4 v[80:83], v2, s[12:15], s44 offen offset:0 sc1
buffer_load_dwordx4 v[84:87], v2, s[12:15], s44 offen offset:256 sc1
buffer_load_dwordx4 v[88:91], v2, s[12:15], s43 offen offset:0 sc1
buffer_load_dwordx4 v[92:95], v2, s[12:15], s43 offen offset:256 sc1
s_waitcnt vmcnt(0)
v_max3_u32 v19, v80, v81, v82
v_max3_u32 v19, v19, v83, v84
v_max3_u32 v19, v19, v85, v86
v_max3_u32 v19, v19, v87, v88
v_max3_u32 v19, v19, v89, v90
v_max3_u32 v19, v19, v91, v92
v_max3_u32 v19, v19, v93, v94
v_max_u32 v19, v19, v95
v_cmp_eq_u32 vcc, -1, v19
s_sub_u32 s45, s45, 1
s_cmp_eq_u32 s45, 0
s_cbranch_scc1 Lok_63
s_nop 2
s_cbranch_vccnz Lre_64
s_branch Lok_63
Lfx_68:
s_xor_b32 s44, s35, 6
s_and_b32 s44, s44, 15
s_lshl_b32 s44, s44, 14
s_add_u32 s43, s44, 0x2000
s_mov_b32 s45, 0x20000
Lre_67:
buffer_load_dwordx4 v[32:35], v2, s[12:15], s44 offen offset:0 sc1
buffer_load_dwordx4 v[36:39], v2, s[12:15], s44 offen offset:256 sc1
buffer_load_dwordx4 v[40:43], v2, s[12:15], s43 offen offset:0 sc1
buffer_load_dwordx4 v[44:47], v2, s[12:15], s43 offen offset:256 sc1
s_waitcnt vmcnt(0)
v_max3_u32 v19, v32, v33, v34
v_max3_u32 v19, v19, v35, v36
v_max3_u32 v19, v19, v37, v38
v_max3_u32 v19, v19, v39, v40
v_max3_u32 v19, v19, v41, v42
v_max3_u32 v19, v19, v43, v44
v_max3_u32 v19, v19, v45, v46
v_max_u32 v19, v19, v47
v_cmp_eq_u32 vcc, -1, v19
s_sub_u32 s45, s45, 1
s_cmp_eq_u32 s45, 0
s_cbranch_scc1 Lok_66
s_nop 2
s_cbranch_vccnz Lre_67
s_branch Lok_66
Lfx_71:
s_xor_b32 s44, s35, 7
s_and_b32 s44, s44, 15
s_lshl_b32 s44, s44, 14
s_add_u32 s43, s44, 0x2000
s_mov_b32 s45, 0x20000
Lre_70:
buffer_load_dwordx4 v[80:83], v2, s[12:15], s44 offen offset:0 sc1
buffer_load_dwordx4 v[84:87], v2, s[12:15], s44 offen offset:256 sc1
buffer_load_dwordx4 v[88:91], v2, s[12:15], s43 offen offset:0 sc1
buffer_load_dwordx4 v[92:95], v2, s[12:15], s43 offen offset:256 sc1
s_waitcnt vmcnt(0)
v_max3_u32 v19, v80, v81, v82
v_max3_u32 v19, v19, v83, v84
v_max3_u32 v19, v19, v85, v86
v_max3_u32 v19, v19, v87, v88
v_max3_u32 v19, v19, v89, v90
v_max3_u32 v19, v19, v91, v92
v_max3_u32 v19, v19, v93, v94
v_max_u32 v19, v19, v95
v_cmp_eq_u32 vcc, -1, v19
s_sub_u32 s45, s45, 1
s_cmp_eq_u32 s45, 0
s_cbranch_scc1 Lok_69
s_nop 2
s_cbranch_vccnz Lre_70
s_branch Lok_69
Lfx_74:
s_xor_b32 s44, s35, 8
s_and_b32 s44, s44, 15
s_lshl_b32 s44, s44, 14
s_add_u32 s43, s44, 0x2000
s_mov_b32 s45, 0x20000
Lre_73:
buffer_load_dwordx4 v[32:35], v2, s[12:15], s44 offen offset:0 sc1
buffer_load_dwordx4 v[36:39], v2, s[12:15], s44 offen offset:256 sc1
buffer_load_dwordx4 v[40:43], v2, s[12:15], s43 offen offset:0 sc1
buffer_load_dwordx4 v[44:47], v2, s[12:15], s43 offen offset:256 sc1
s_waitcnt vmcnt(0)
v_max3_u32 v19, v32, v33, v34
v_max3_u32 v19, v19, v35, v36
v_max3_u32 v19, v19, v37, v38
v_max3_u32 v19, v19, v39, v40
v_max3_u32 v19, v19, v41, v42
v_max3_u32 v19, v19, v43, v44
v_max3_u32 v19, v19, v45, v46
v_max_u32 v19, v19, v47
v_cmp_eq_u32 vcc, -1, v19
s_sub_u32 s45, s45, 1
s_cmp_eq_u32 s45, 0
s_cbranch_scc1 Lok_72
s_nop 2
s_cbranch_vccnz Lre_73
s_branch Lok_72
Lfx_77:
s_xor_b32 s44, s35, 9
s_and_b32 s44, s44, 15
s_lshl_b32 s44, s44, 14
s_add_u32 s43, s44, 0x2000
s_mov_b32 s45, 0x20000
Lre_76:
buffer_load_dwordx4 v[80:83], v2, s[12:15], s44 offen offset:0 sc1
buffer_load_dwordx4 v[84:87], v2, s[12:15], s44 offen offset:256 sc1
buffer_load_dwordx4 v[88:91], v2, s[12:15], s43 offen offset:0 sc1
buffer_load_dwordx4 v[92:95], v2, s[12:15], s43 offen offset:256 sc1
s_waitcnt vmcnt(0)
v_max3_u32 v19, v80, v81, v82
v_max3_u32 v19, v19, v83, v84
v_max3_u32 v19, v19, v85, v86
v_max3_u32 v19, v19, v87, v88
v_max3_u32 v19, v19, v89, v90
v_max3_u32 v19, v19, v91, v92
v_max3_u32 v19, v19, v93, v94
v_max_u32 v19, v19, v95
v_cmp_eq_u32 vcc, -1, v19
s_sub_u32 s45, s45, 1
s_cmp_eq_u32 s45, 0
s_cbranch_scc1 Lok_75
s_nop 2
s_cbranch_vccnz Lre_76
s_branch Lok_75
Lfx_80:
s_xor_b32 s44, s35, 10
s_and_b32 s44, s44, 15
s_lshl_b32 s44, s44, 14
s_add_u32 s43, s44, 0x2000
s_mov_b32 s45, 0x20000
Lre_79:
buffer_load_dwordx4 v[32:35], v2, s[12:15], s44 offen offset:0 sc1
buffer_load_dwordx4 v[36:39], v2, s[12:15], s44 offen offset:256 sc1
buffer_load_dwordx4 v[40:43], v2, s[12:15], s43 offen offset:0 sc1
buffer_load_dwordx4 v[44:47], v2, s[12:15], s43 offen offset:256 sc1
s_waitcnt vmcnt(0)
v_max3_u32 v19, v32, v33, v34
v_max3_u32 v19, v19, v35, v36
v_max3_u32 v19, v19, v37, v38
v_max3_u32 v19, v19, v39, v40
v_max3_u32 v19, v19, v41, v42
v_max3_u32 v19, v19, v43, v44
v_max3_u32 v19, v19, v45, v46
v_max_u32 v19, v19, v47
v_cmp_eq_u32 vcc, -1, v19
s_sub_u32 s45, s45, 1
s_cmp_eq_u32 s45, 0
s_cbranch_scc1 Lok_78
s_nop 2
s_cbranch_vccnz Lre_79
s_branch Lok_78
Lfx_83:
s_xor_b32 s44, s35, 1
s_and_b32 s44, s44, 15
s_lshl_b32 s44, s44, 14
s_add_u32 s44, s44, 0
s_mov_b32 s45, 0x20000
Lre_82:
buffer_load_dwordx4 v[32:35], v2, s[12:15], s44 offen offset:0 sc1
buffer_load_dwordx4 v[36:39], v2, s[12:15], s44 offen offset:256 sc1
buffer_load_dwordx4 v[40:43], v2, s[12:15], s44 offen offset:512 sc1
buffer_load_dwordx4 v[44:47], v2, s[12:15], s44 offen offset:768 sc1
s_waitcnt vmcnt(0)
v_max3_u32 v19, v32, v33, v34
v_max3_u32 v19, v19, v35, v36
v_max3_u32 v19, v19, v37, v38
v_max3_u32 v19, v19, v39, v40
v_max3_u32 v19, v19, v41, v42
v_max3_u32 v19, v19, v43, v44
v_max3_u32 v19, v19, v45, v46
v_max_u32 v19, v19, v47
v_cmp_eq_u32 vcc, -1, v19
s_sub_u32 s45, s45, 1
s_cmp_eq_u32 s45, 0
s_cbranch_scc1 Lok_81
s_nop 2
s_cbranch_vccnz Lre_82
s_branch Lok_81
Lfx_86:
s_xor_b32 s44, s35, 1
s_and_b32 s44, s44, 15
s_lshl_b32 s44, s44, 14
s_add_u32 s44, s44, 8192
s_mov_b32 s45, 0x20000
Lre_85:
buffer_load_dwordx4 v[80:83], v2, s[12:15], s44 offen offset:0 sc1
buffer_load_dwordx4 v[84:87], v2, s[12:15], s44 offen offset:256 sc1
buffer_load_dwordx4 v[88:91], v2, s[12:15], s44 offen offset:512 sc1
buffer_load_dwordx4 v[92:95], v2, s[12:15], s44 offen offset:768 sc1
s_waitcnt vmcnt(0)
v_max3_u32 v19, v80, v81, v82
v_max3_u32 v19, v19, v83, v84
v_max3_u32 v19, v19, v85, v86
v_max3_u32 v19, v19, v87, v88
v_max3_u32 v19, v19, v89, v90
v_max3_u32 v19, v19, v91, v92
v_max3_u32 v19, v19, v93, v94
v_max_u32 v19, v19, v95
v_cmp_eq_u32 vcc, -1, v19
s_sub_u32 s45, s45, 1
s_cmp_eq_u32 s45, 0
s_cbranch_scc1 Lok_84
s_nop 2
s_cbranch_vccnz Lre_85
s_branch Lok_84
Lfx_89:
s_xor_b32 s44, s35, 2
s_and_b32 s44, s44, 15
s_lshl_b32 s44, s44, 14
s_add_u32 s44, s44, 0
s_mov_b32 s45, 0x20000
Lre_88:
buffer_load_dwordx4 v[32:35], v2, s[12:15], s44 offen offset:0 sc1
buffer_load_dwordx4 v[36:39], v2, s[12:15], s44 offen offset:256 sc1
buffer_load_dwordx4 v[40:43], v2, s[12:15], s44 offen offset:512 sc1
buffer_load_dwordx4 v[44:47], v2, s[12:15], s44 offen offset:768 sc1
s_waitcnt vmcnt(0)
v_max3_u32 v19, v32, v33, v34
v_max3_u32 v19, v19, v35, v36
v_max3_u32 v19, v19, v37, v38
v_max3_u32 v19, v19, v39, v40
v_max3_u32 v19, v19, v41, v42
v_max3_u32 v19, v19, v43, v44
v_max3_u32 v19, v19, v45, v46
v_max_u32 v19, v19, v47
v_cmp_eq_u32 vcc, -1, v19
s_sub_u32 s45, s45, 1
s_cmp_eq_u32 s45, 0
s_cbranch_scc1 Lok_87
s_nop 2
s_cbranch_vccnz Lre_88
s_branch Lok_87
Lfx_92:
s_xor_b32 s44, s35, 2
s_and_b32 s44, s44, 15
s_lshl_b32 s44, s44, 14
s_add_u32 s44, s44, 8192
s_mov_b32 s45, 0x20000
Lre_91:
buffer_load_dwordx4 v[80:83], v2, s[12:15], s44 offen offset:0 sc1
buffer_load_dwordx4 v[84:87], v2, s[12:15], s44 offen offset:256 sc1
buffer_load_dwordx4 v[88:91], v2, s[12:15], s44 offen offset:512 sc1
buffer_load_dwordx4 v[92:95], v2, s[12:15], s44 offen offset:768 sc1
s_waitcnt vmcnt(0)
v_max3_u32 v19, v80, v81, v82
v_max3_u32 v19, v19, v83, v84
v_max3_u32 v19, v19, v85, v86
v_max3_u32 v19, v19, v87, v88
v_max3_u32 v19, v19, v89, v90
v_max3_u32 v19, v19, v91, v92
v_max3_u32 v19, v19, v93, v94
v_max_u32 v19, v19, v95
v_cmp_eq_u32 vcc, -1, v19
s_sub_u32 s45, s45, 1
s_cmp_eq_u32 s45, 0
s_cbranch_scc1 Lok_90
s_nop 2
s_cbranch_vccnz Lre_91
s_branch Lok_90
Lfx_95:
s_xor_b32 s44, s35, 3
s_and_b32 s44, s44, 15
s_lshl_b32 s44, s44, 14
s_add_u32 s44, s44, 0
s_mov_b32 s45, 0x20000
Lre_94:
buffer_load_dwordx4 v[32:35], v2, s[12:15], s44 offen offset:0 sc1
buffer_load_dwordx4 v[36:39], v2, s[12:15], s44 offen offset:256 sc1
buffer_load_dwordx4 v[40:43], v2, s[12:15], s44 offen offset:512 sc1
buffer_load_dwordx4 v[44:47], v2, s[12:15], s44 offen offset:768 sc1
s_waitcnt vmcnt(0)
v_max3_u32 v19, v32, v33, v34
v_max3_u32 v19, v19, v35, v36
v_max3_u32 v19, v19, v37, v38
v_max3_u32 v19, v19, v39, v40
v_max3_u32 v19, v19, v41, v42
v_max3_u32 v19, v19, v43, v44
v_max3_u32 v19, v19, v45, v46
v_max_u32 v19, v19, v47
v_cmp_eq_u32 vcc, -1, v19
s_sub_u32 s45, s45, 1
s_cmp_eq_u32 s45, 0
s_cbranch_scc1 Lok_93
s_nop 2
s_cbranch_vccnz Lre_94
s_branch Lok_93
Lfx_98:
s_xor_b32 s44, s35, 3
s_and_b32 s44, s44, 15
s_lshl_b32 s44, s44, 14
s_add_u32 s44, s44, 8192
s_mov_b32 s45, 0x20000
Lre_97:
buffer_load_dwordx4 v[80:83], v2, s[12:15], s44 offen offset:0 sc1
buffer_load_dwordx4 v[84:87], v2, s[12:15], s44 offen offset:256 sc1
buffer_load_dwordx4 v[88:91], v2, s[12:15], s44 offen offset:512 sc1
buffer_load_dwordx4 v[92:95], v2, s[12:15], s44 offen offset:768 sc1
s_waitcnt vmcnt(0)
v_max3_u32 v19, v80, v81, v82
v_max3_u32 v19, v19, v83, v84
v_max3_u32 v19, v19, v85, v86
v_max3_u32 v19, v19, v87, v88
v_max3_u32 v19, v19, v89, v90
v_max3_u32 v19, v19, v91, v92
v_max3_u32 v19, v19, v93, v94
v_max_u32 v19, v19, v95
v_cmp_eq_u32 vcc, -1, v19
s_sub_u32 s45, s45, 1
s_cmp_eq_u32 s45, 0
s_cbranch_scc1 Lok_96
s_nop 2
s_cbranch_vccnz Lre_97
s_branch Lok_96
Lfx_101:
s_xor_b32 s44, s35, 4
s_and_b32 s44, s44, 15
s_lshl_b32 s44, s44, 14
s_add_u32 s44, s44, 0
s_mov_b32 s45, 0x20000
Lre_100:
buffer_load_dwordx4 v[32:35], v2, s[12:15], s44 offen offset:0 sc1
buffer_load_dwordx4 v[36:39], v2, s[12:15], s44 offen offset:256 sc1
buffer_load_dwordx4 v[40:43], v2, s[12:15], s44 offen offset:512 sc1
buffer_load_dwordx4 v[44:47], v2, s[12:15], s44 offen offset:768 sc1
s_waitcnt vmcnt(0)
v_max3_u32 v19, v32, v33, v34
v_max3_u32 v19, v19, v35, v36
v_max3_u32 v19, v19, v37, v38
v_max3_u32 v19, v19, v39, v40
v_max3_u32 v19, v19, v41, v42
v_max3_u32 v19, v19, v43, v44
v_max3_u32 v19, v19, v45, v46
v_max_u32 v19, v19, v47
v_cmp_eq_u32 vcc, -1, v19
s_sub_u32 s45, s45, 1
s_cmp_eq_u32 s45, 0
s_cbranch_scc1 Lok_99
s_nop 2
s_cbranch_vccnz Lre_100
s_branch Lok_99
Lfx_104:
s_xor_b32 s44, s35, 4
s_and_b32 s44, s44, 15
s_lshl_b32 s44, s44, 14
s_add_u32 s44, s44, 8192
s_mov_b32 s45, 0x20000
Lre_103:
buffer_load_dwordx4 v[80:83], v2, s[12:15], s44 offen offset:0 sc1
buffer_load_dwordx4 v[84:87], v2, s[12:15], s44 offen offset:256 sc1
buffer_load_dwordx4 v[88:91], v2, s[12:15], s44 offen offset:512 sc1
buffer_load_dwordx4 v[92:95], v2, s[12:15], s44 offen offset:768 sc1
s_waitcnt vmcnt(0)
v_max3_u32 v19, v80, v81, v82
v_max3_u32 v19, v19, v83, v84
v_max3_u32 v19, v19, v85, v86
v_max3_u32 v19, v19, v87, v88
v_max3_u32 v19, v19, v89, v90
v_max3_u32 v19, v19, v91, v92
v_max3_u32 v19, v19, v93, v94
v_max_u32 v19, v19, v95
v_cmp_eq_u32 vcc, -1, v19
s_sub_u32 s45, s45, 1
s_cmp_eq_u32 s45, 0
s_cbranch_scc1 Lok_102
s_nop 2
s_cbranch_vccnz Lre_103
s_branch Lok_102
Lfx_107:
s_xor_b32 s44, s35, 5
s_and_b32 s44, s44, 15
s_lshl_b32 s44, s44, 14
s_add_u32 s44, s44, 0
s_mov_b32 s45, 0x20000
Lre_106:
buffer_load_dwordx4 v[32:35], v2, s[12:15], s44 offen offset:0 sc1
buffer_load_dwordx4 v[36:39], v2, s[12:15], s44 offen offset:256 sc1
buffer_load_dwordx4 v[40:43], v2, s[12:15], s44 offen offset:512 sc1
buffer_load_dwordx4 v[44:47], v2, s[12:15], s44 offen offset:768 sc1
s_waitcnt vmcnt(0)
v_max3_u32 v19, v32, v33, v34
v_max3_u32 v19, v19, v35, v36
v_max3_u32 v19, v19, v37, v38
v_max3_u32 v19, v19, v39, v40
v_max3_u32 v19, v19, v41, v42
v_max3_u32 v19, v19, v43, v44
v_max3_u32 v19, v19, v45, v46
v_max_u32 v19, v19, v47
v_cmp_eq_u32 vcc, -1, v19
s_sub_u32 s45, s45, 1
s_cmp_eq_u32 s45, 0
s_cbranch_scc1 Lok_105
s_nop 2
s_cbranch_vccnz Lre_106
s_branch Lok_105
Lfx_110:
s_xor_b32 s44, s35, 5
s_and_b32 s44, s44, 15
s_lshl_b32 s44, s44, 14
s_add_u32 s44, s44, 8192
s_mov_b32 s45, 0x20000
Lre_109:
buffer_load_dwordx4 v[80:83], v2, s[12:15], s44 offen offset:0 sc1
buffer_load_dwordx4 v[84:87], v2, s[12:15], s44 offen offset:256 sc1
buffer_load_dwordx4 v[88:91], v2, s[12:15], s44 offen offset:512 sc1
buffer_load_dwordx4 v[92:95], v2, s[12:15], s44 offen offset:768 sc1
s_waitcnt vmcnt(0)
v_max3_u32 v19, v80, v81, v82
v_max3_u32 v19, v19, v83, v84
v_max3_u32 v19, v19, v85, v86
v_max3_u32 v19, v19, v87, v88
v_max3_u32 v19, v19, v89, v90
v_max3_u32 v19, v19, v91, v92
v_max3_u32 v19, v19, v93, v94
v_max_u32 v19, v19, v95
v_cmp_eq_u32 vcc, -1, v19
s_sub_u32 s45, s45, 1
s_cmp_eq_u32 s45, 0
s_cbranch_scc1 Lok_108
s_nop 2
s_cbranch_vccnz Lre_109
s_branch Lok_108
Lfx_113:
s_xor_b32 s44, s35, 6
s_and_b32 s44, s44, 15
s_lshl_b32 s44, s44, 14
s_add_u32 s44, s44, 0
s_mov_b32 s45, 0x20000
Lre_112:
buffer_load_dwordx4 v[32:35], v2, s[12:15], s44 offen offset:0 sc1
buffer_load_dwordx4 v[36:39], v2, s[12:15], s44 offen offset:256 sc1
buffer_load_dwordx4 v[40:43], v2, s[12:15], s44 offen offset:512 sc1
buffer_load_dwordx4 v[44:47], v2, s[12:15], s44 offen offset:768 sc1
s_waitcnt vmcnt(0)
v_max3_u32 v19, v32, v33, v34
v_max3_u32 v19, v19, v35, v36
v_max3_u32 v19, v19, v37, v38
v_max3_u32 v19, v19, v39, v40
v_max3_u32 v19, v19, v41, v42
v_max3_u32 v19, v19, v43, v44
v_max3_u32 v19, v19, v45, v46
v_max_u32 v19, v19, v47
v_cmp_eq_u32 vcc, -1, v19
s_sub_u32 s45, s45, 1
s_cmp_eq_u32 s45, 0
s_cbranch_scc1 Lok_111
s_nop 2
s_cbranch_vccnz Lre_112
s_branch Lok_111
Lfx_116:
s_xor_b32 s44, s35, 6
s_and_b32 s44, s44, 15
s_lshl_b32 s44, s44, 14
s_add_u32 s44, s44, 8192
s_mov_b32 s45, 0x20000
Lre_115:
buffer_load_dwordx4 v[80:83], v2, s[12:15], s44 offen offset:0 sc1
buffer_load_dwordx4 v[84:87], v2, s[12:15], s44 offen offset:256 sc1
buffer_load_dwordx4 v[88:91], v2, s[12:15], s44 offen offset:512 sc1
buffer_load_dwordx4 v[92:95], v2, s[12:15], s44 offen offset:768 sc1
s_waitcnt vmcnt(0)
v_max3_u32 v19, v80, v81, v82
v_max3_u32 v19, v19, v83, v84
v_max3_u32 v19, v19, v85, v86
v_max3_u32 v19, v19, v87, v88
v_max3_u32 v19, v19, v89, v90
v_max3_u32 v19, v19, v91, v92
v_max3_u32 v19, v19, v93, v94
v_max_u32 v19, v19, v95
v_cmp_eq_u32 vcc, -1, v19
s_sub_u32 s45, s45, 1
s_cmp_eq_u32 s45, 0
s_cbranch_scc1 Lok_114
s_nop 2
s_cbranch_vccnz Lre_115
s_branch Lok_114
Lfx_119:
s_xor_b32 s44, s35, 7
s_and_b32 s44, s44, 15
s_lshl_b32 s44, s44, 14
s_add_u32 s44, s44, 0
s_mov_b32 s45, 0x20000
Lre_118:
buffer_load_dwordx4 v[32:35], v2, s[12:15], s44 offen offset:0 sc1
buffer_load_dwordx4 v[36:39], v2, s[12:15], s44 offen offset:256 sc1
buffer_load_dwordx4 v[40:43], v2, s[12:15], s44 offen offset:512 sc1
buffer_load_dwordx4 v[44:47], v2, s[12:15], s44 offen offset:768 sc1
s_waitcnt vmcnt(0)
v_max3_u32 v19, v32, v33, v34
v_max3_u32 v19, v19, v35, v36
v_max3_u32 v19, v19, v37, v38
v_max3_u32 v19, v19, v39, v40
v_max3_u32 v19, v19, v41, v42
v_max3_u32 v19, v19, v43, v44
v_max3_u32 v19, v19, v45, v46
v_max_u32 v19, v19, v47
v_cmp_eq_u32 vcc, -1, v19
s_sub_u32 s45, s45, 1
s_cmp_eq_u32 s45, 0
s_cbranch_scc1 Lok_117
s_nop 2
s_cbranch_vccnz Lre_118
s_branch Lok_117
Lfx_122:
s_xor_b32 s44, s35, 7
s_and_b32 s44, s44, 15
s_lshl_b32 s44, s44, 14
s_add_u32 s44, s44, 8192
s_mov_b32 s45, 0x20000
Lre_121:
buffer_load_dwordx4 v[80:83], v2, s[12:15], s44 offen offset:0 sc1
buffer_load_dwordx4 v[84:87], v2, s[12:15], s44 offen offset:256 sc1
buffer_load_dwordx4 v[88:91], v2, s[12:15], s44 offen offset:512 sc1
buffer_load_dwordx4 v[92:95], v2, s[12:15], s44 offen offset:768 sc1
s_waitcnt vmcnt(0)
v_max3_u32 v19, v80, v81, v82
v_max3_u32 v19, v19, v83, v84
v_max3_u32 v19, v19, v85, v86
v_max3_u32 v19, v19, v87, v88
v_max3_u32 v19, v19, v89, v90
v_max3_u32 v19, v19, v91, v92
v_max3_u32 v19, v19, v93, v94
v_max_u32 v19, v19, v95
v_cmp_eq_u32 vcc, -1, v19
s_sub_u32 s45, s45, 1
s_cmp_eq_u32 s45, 0
s_cbranch_scc1 Lok_120
s_nop 2
s_cbranch_vccnz Lre_121
s_branch Lok_120
Ldone_1:
s_endpgm
.section .rodata,"a"
.p2align 6
.amdhsa_kernel sequential_preLN__sliding_local_dilated__glu_gated_geglu__prompt_kernel
  .amdhsa_next_free_vgpr 256
  .amdhsa_next_free_sgpr 100
  .amdhsa_accum_offset 256
  .amdhsa_group_segment_fixed_size 0
  .amdhsa_kernarg_size 80
  .amdhsa_user_sgpr_count 2
  .amdhsa_user_sgpr_kernarg_segment_ptr 1
  .amdhsa_system_sgpr_workgroup_id_x 1
  .amdhsa_float_denorm_mode_32 3
  .amdhsa_float_denorm_mode_16_64 3
.end_amdhsa_kernel
```

```asm
; @launch grid=(256,1,1) block=(512,1,1) lds=151552
.amdgcn_target "amdgcn-amd-amdhsa--gfx950"
.text
.globl sequential_preLN__sliding_local_dilated__glu_gated_geglu__prompt_kernel
.p2align 8
.type sequential_preLN__sliding_local_dilated__glu_gated_geglu__prompt_kernel,@function
sequential_preLN__sliding_local_dilated__glu_gated_geglu__prompt_kernel:
s_cmp_ge_u32 s2, 256
s_cbranch_scc1 Ldone_1
s_load_dwordx4 s[4:7], s[0:1], 0
s_load_dwordx2 s[32:33], s[0:1], 72
s_load_dwordx2 s[80:81], s[0:1], 32
s_and_b32 s3, s2, 7
s_lshr_b32 s42, s2, 3
s_and_b32 s48, s42, 3
s_lshr_b32 s49, s42, 2
s_and_b32 s34, s3, 3
s_lshl_b32 s34, s34, 2
s_add_u32 s34, s34, s48
s_lshr_b32 s35, s3, 2
s_lshl_b32 s35, s35, 3
s_add_u32 s35, s35, s49
v_lshrrev_b32 v12, 6, v0
v_and_b32 v1, 63, v0
v_readfirstlane_b32 s36, v12
s_nop 3
s_lshl_b32 s44, s34, 18
s_lshl_b32 s45, s35, 14
s_add_u32 s45, s45, s44
s_lshl_b32 s50, s34, 7
s_sub_u32 s50, s50, 16
s_and_b32 s47, s36, 3
s_lshl_b32 s43, s34, 7
s_lshl_b32 s44, s35, 3
s_add_u32 s43, s43, s44
s_mov_b32 s63, s43
s_lshl_b32 s44, s47, 1
s_add_u32 s51, s43, s44
v_lshlrev_b32 v10, 4, v1
v_lshrrev_b32 v14, 3, v1
v_and_b32 v15, 7, v1
v_and_b32 v16, 2, v14
v_xor_b32 v16, v15, v16
v_lshlrev_b32 v16, 4, v16
v_mul_u32_u24 v17, 6144, v14
s_lshl_b32 s43, s47, 11
v_add3_u32 v2, v17, v16, s43
v_xor_b32 v3, 64, v2
v_lshrrev_b32 v16, 1, v14
v_xor_b32 v16, v15, v16
v_lshlrev_b32 v16, 4, v16
s_lshl_b32 s43, s47, 3
s_add_u32 s43, s43, s50
v_add_u32 v17, s43, v14
s_and_b32 s44, s47, 1
s_lshl_b32 s44, s44, 6
v_add_u32 v18, 0, v17
v_max_i32 v18, 0, v18
v_lshl_add_u32 v18, v18, 11, v16
v_xor_b32 v18, s44, v18
v_mov_b32 v4, v18
v_add_u32 v18, 24, v17
v_max_i32 v18, 0, v18
v_lshl_add_u32 v18, v18, 11, v16
v_xor_b32 v18, s44, v18
v_xor_b32 v5, 64, v18
v_add_u32 v18, 48, v17
v_max_i32 v18, 0, v18
v_lshl_add_u32 v18, v18, 11, v16
v_xor_b32 v18, s44, v18
v_mov_b32 v6, v18
v_add_u32 v18, 72, v17
v_max_i32 v18, 0, v18
v_lshl_add_u32 v18, v18, 11, v16
v_xor_b32 v18, s44, v18
v_xor_b32 v7, 64, v18
v_add_u32 v18, 96, v17
v_max_i32 v18, 0, v18
v_lshl_add_u32 v18, v18, 11, v16
v_xor_b32 v18, s44, v18
v_mov_b32 v8, v18
v_add_u32 v18, 120, v17
v_max_i32 v18, 0, v18
v_lshl_add_u32 v18, v18, 11, v16
v_xor_b32 v18, s44, v18
v_xor_b32 v9, 64, v18
s_lshl_b32 s39, s47, 10
s_lshl_b32 s40, s47, 13
s_add_u32 s40, s40, 18432
s_mov_b32 s37, 0
s_mov_b32 s38, 0
s_bfm_b64 s[60:61], 56, 8
s_cmp_eq_u32 s47, 0
s_cselect_b64 s[60:61], s[60:61], -1
s_mov_b32 s53, 0x3f803f80
v_and_b32 v12, 15, v1
v_lshrrev_b32 v13, 4, v1
s_lshl_b32 s43, s35, 7
s_waitcnt lgkmcnt(0)
s_mov_b32 s8, s4
s_mov_b32 s9, s5
s_mov_b32 s10, 4194304
s_mov_b32 s11, 0x20000
s_add_u32 s12, s6, s43
s_addc_u32 s13, s7, 0
s_mov_b32 s14, 6289536
s_mov_b32 s15, 0x20000
s_add_u32 s16, s32, s45
s_addc_u32 s17, s33, 0
s_mov_b32 s18, 16384
s_mov_b32 s19, 0x20000
s_add_u32 s20, s32, 26214400
s_addc_u32 s21, s33, 0
s_mov_b32 s22, 16384
s_mov_b32 s23, 0x20000
s_cmp_lt_u32 s36, 4
s_cbranch_scc1 Lcons_2
s_cmp_eq_u32 s36, 7
s_cbranch_scc1 Lpf_3
s_add_u32 m0, s39, 0
s_mov_b64 exec, s[60:61]
buffer_load_dwordx4 v4, s[8:11], s37 offen lds
s_mov_b64 exec, -1
s_add_u32 m0, s39, 3072
s_nop 0
buffer_load_dwordx4 v5, s[8:11], s37 offen lds
s_add_u32 m0, s39, 6144
s_nop 0
buffer_load_dwordx4 v6, s[8:11], s37 offen lds
s_add_u32 m0, s39, 9216
s_nop 0
buffer_load_dwordx4 v7, s[8:11], s37 offen lds
s_add_u32 m0, s39, 12288
s_nop 0
buffer_load_dwordx4 v8, s[8:11], s37 offen lds
s_add_u32 m0, s39, 15360
s_nop 0
buffer_load_dwordx4 v9, s[8:11], s37 offen lds
s_add_u32 m0, s40, 0
s_add_u32 s43, s38, 0
buffer_load_dwordx4 v2, s[12:15], s43 offen lds
s_add_u32 m0, s40, 1024
s_add_u32 s43, s38, 49152
buffer_load_dwordx4 v3, s[12:15], s43 offen lds
s_add_u32 m0, s40, 2048
s_add_u32 s43, s38, 98304
buffer_load_dwordx4 v2, s[12:15], s43 offen lds
s_add_u32 m0, s40, 3072
s_add_u32 s43, s38, 147456
buffer_load_dwordx4 v3, s[12:15], s43 offen lds
s_add_u32 m0, s40, 4096
s_add_u32 s43, s38, 196608
buffer_load_dwordx4 v2, s[12:15], s43 offen lds
s_add_u32 m0, s40, 5120
s_add_u32 s43, s38, 245760
buffer_load_dwordx4 v3, s[12:15], s43 offen lds
s_add_u32 m0, s40, 6144
s_add_u32 s43, s38, 294912
buffer_load_dwordx4 v2, s[12:15], s43 offen lds
s_add_u32 m0, s40, 7168
s_add_u32 s43, s38, 344064
buffer_load_dwordx4 v3, s[12:15], s43 offen lds
s_add_u32 s37, s37, 128
s_add_u32 s38, s38, 393216
s_add_u32 m0, s39, 43008
s_mov_b64 exec, s[60:61]
buffer_load_dwordx4 v4, s[8:11], s37 offen lds
s_mov_b64 exec, -1
s_add_u32 m0, s39, 46080
s_nop 0
buffer_load_dwordx4 v5, s[8:11], s37 offen lds
s_add_u32 m0, s39, 49152
s_nop 0
buffer_load_dwordx4 v6, s[8:11], s37 offen lds
s_add_u32 m0, s39, 52224
s_nop 0
buffer_load_dwordx4 v7, s[8:11], s37 offen lds
s_add_u32 m0, s39, 55296
s_nop 0
buffer_load_dwordx4 v8, s[8:11], s37 offen lds
s_add_u32 m0, s39, 58368
s_nop 0
buffer_load_dwordx4 v9, s[8:11], s37 offen lds
s_add_u32 m0, s40, 43008
s_add_u32 s43, s38, 0
buffer_load_dwordx4 v2, s[12:15], s43 offen lds
s_add_u32 m0, s40, 44032
s_add_u32 s43, s38, 49152
buffer_load_dwordx4 v3, s[12:15], s43 offen lds
s_add_u32 m0, s40, 45056
s_add_u32 s43, s38, 98304
buffer_load_dwordx4 v2, s[12:15], s43 offen lds
s_add_u32 m0, s40, 46080
s_add_u32 s43, s38, 147456
buffer_load_dwordx4 v3, s[12:15], s43 offen lds
s_add_u32 m0, s40, 47104
s_add_u32 s43, s38, 196608
buffer_load_dwordx4 v2, s[12:15], s43 offen lds
s_add_u32 m0, s40, 48128
s_add_u32 s43, s38, 245760
buffer_load_dwordx4 v3, s[12:15], s43 offen lds
s_add_u32 m0, s40, 49152
s_add_u32 s43, s38, 294912
buffer_load_dwordx4 v2, s[12:15], s43 offen lds
s_add_u32 m0, s40, 50176
s_add_u32 s43, s38, 344064
buffer_load_dwordx4 v3, s[12:15], s43 offen lds
s_add_u32 s37, s37, 128
s_add_u32 s38, s38, 393216
s_waitcnt vmcnt(14)
s_barrier
s_add_u32 m0, s39, 86016
s_mov_b64 exec, s[60:61]
buffer_load_dwordx4 v4, s[8:11], s37 offen lds
s_mov_b64 exec, -1
s_add_u32 m0, s39, 89088
s_nop 0
buffer_load_dwordx4 v5, s[8:11], s37 offen lds
s_add_u32 m0, s39, 92160
s_nop 0
buffer_load_dwordx4 v6, s[8:11], s37 offen lds
s_add_u32 m0, s39, 95232
s_nop 0
buffer_load_dwordx4 v7, s[8:11], s37 offen lds
s_add_u32 m0, s39, 98304
s_nop 0
buffer_load_dwordx4 v8, s[8:11], s37 offen lds
s_add_u32 m0, s39, 101376
s_nop 0
buffer_load_dwordx4 v9, s[8:11], s37 offen lds
s_add_u32 m0, s40, 86016
s_add_u32 s43, s38, 0
buffer_load_dwordx4 v2, s[12:15], s43 offen lds
s_add_u32 m0, s40, 87040
s_add_u32 s43, s38, 49152
buffer_load_dwordx4 v3, s[12:15], s43 offen lds
s_add_u32 m0, s40, 88064
s_add_u32 s43, s38, 98304
buffer_load_dwordx4 v2, s[12:15], s43 offen lds
s_add_u32 m0, s40, 89088
s_add_u32 s43, s38, 147456
buffer_load_dwordx4 v3, s[12:15], s43 offen lds
s_add_u32 m0, s40, 90112
s_add_u32 s43, s38, 196608
buffer_load_dwordx4 v2, s[12:15], s43 offen lds
s_add_u32 m0, s40, 91136
s_add_u32 s43, s38, 245760
buffer_load_dwordx4 v3, s[12:15], s43 offen lds
s_add_u32 m0, s40, 92160
s_add_u32 s43, s38, 294912
buffer_load_dwordx4 v2, s[12:15], s43 offen lds
s_add_u32 m0, s40, 93184
s_add_u32 s43, s38, 344064
buffer_load_dwordx4 v3, s[12:15], s43 offen lds
s_add_u32 s37, s37, 128
s_add_u32 s38, s38, 393216
s_lshl_b32 s43, s51, 11
buffer_load_dwordx4 v[96:99], v10, s[8:11], s43 offen offset:0
buffer_load_dwordx4 v[100:103], v10, s[8:11], s43 offen offset:1024
buffer_load_dwordx4 v[104:107], v10, s[8:11], s43 offen offset:2048
buffer_load_dwordx4 v[108:111], v10, s[8:11], s43 offen offset:3072
s_lshr_b32 s43, s2, 5
s_cmp_eq_u32 s43, 3
s_cbranch_scc1 Lsj_16
s_cmp_gt_u32 s43, 3
s_cselect_b32 s43, 32, 0
s_sub_u32 s43, s2, s43
s_lshr_b32 s43, s43, 1
s_and_b32 s44, s2, 1
s_lshl_b32 s44, s44, 3
s_add_u32 s44, s44, 32
s_load_dwordx2 s[80:81], s[0:1], s44
s_mul_i32 s45, s43, 2341
s_lshr_b32 s45, s45, 16
s_mul_i32 s46, s45, 28
s_sub_u32 s46, s43, s46
s_lshl_b32 s45, s45, 8
s_mul_i32 s44, s47, 18
s_add_u32 s45, s45, s44
s_add_u32 s45, s45, 184
s_mul_i32 s45, s45, 7168
s_lshl_b32 s46, s46, 8
s_add_u32 s45, s45, s46
s_waitcnt lgkmcnt(0)
s_add_u32 s80, s80, s45
s_addc_u32 s81, s81, 0
Lsj_16:
s_waitcnt vmcnt(18)
s_barrier
s_add_u32 m0, s39, 0
s_mov_b64 exec, s[60:61]
buffer_load_dwordx4 v4, s[8:11], s37 offen lds
s_mov_b64 exec, -1
s_add_u32 m0, s39, 3072
s_nop 0
buffer_load_dwordx4 v5, s[8:11], s37 offen lds
s_add_u32 m0, s39, 6144
s_nop 0
buffer_load_dwordx4 v6, s[8:11], s37 offen lds
s_add_u32 m0, s39, 9216
s_nop 0
buffer_load_dwordx4 v7, s[8:11], s37 offen lds
s_add_u32 m0, s39, 12288
s_nop 0
buffer_load_dwordx4 v8, s[8:11], s37 offen lds
s_add_u32 m0, s39, 15360
s_nop 0
buffer_load_dwordx4 v9, s[8:11], s37 offen lds
s_add_u32 m0, s40, 0
s_add_u32 s43, s38, 0
buffer_load_dwordx4 v2, s[12:15], s43 offen lds
s_add_u32 m0, s40, 1024
s_add_u32 s43, s38, 49152
buffer_load_dwordx4 v3, s[12:15], s43 offen lds
s_add_u32 m0, s40, 2048
s_add_u32 s43, s38, 98304
buffer_load_dwordx4 v2, s[12:15], s43 offen lds
s_add_u32 m0, s40, 3072
s_add_u32 s43, s38, 147456
buffer_load_dwordx4 v3, s[12:15], s43 offen lds
s_add_u32 m0, s40, 4096
s_add_u32 s43, s38, 196608
buffer_load_dwordx4 v2, s[12:15], s43 offen lds
s_add_u32 m0, s40, 5120
s_add_u32 s43, s38, 245760
buffer_load_dwordx4 v3, s[12:15], s43 offen lds
s_add_u32 m0, s40, 6144
s_add_u32 s43, s38, 294912
buffer_load_dwordx4 v2, s[12:15], s43 offen lds
s_add_u32 m0, s40, 7168
s_add_u32 s43, s38, 344064
buffer_load_dwordx4 v3, s[12:15], s43 offen lds
s_add_u32 s37, s37, 128
s_add_u32 s38, s38, 393216
s_waitcnt vmcnt(14)
s_barrier
s_add_u32 m0, s39, 43008
s_mov_b64 exec, s[60:61]
buffer_load_dwordx4 v4, s[8:11], s37 offen lds
s_mov_b64 exec, -1
s_add_u32 m0, s39, 46080
s_nop 0
buffer_load_dwordx4 v5, s[8:11], s37 offen lds
s_add_u32 m0, s39, 49152
s_nop 0
buffer_load_dwordx4 v6, s[8:11], s37 offen lds
s_add_u32 m0, s39, 52224
s_nop 0
buffer_load_dwordx4 v7, s[8:11], s37 offen lds
s_add_u32 m0, s39, 55296
s_nop 0
buffer_load_dwordx4 v8, s[8:11], s37 offen lds
s_add_u32 m0, s39, 58368
s_nop 0
buffer_load_dwordx4 v9, s[8:11], s37 offen lds
s_add_u32 m0, s40, 43008
s_add_u32 s43, s38, 0
buffer_load_dwordx4 v2, s[12:15], s43 offen lds
s_add_u32 m0, s40, 44032
s_add_u32 s43, s38, 49152
buffer_load_dwordx4 v3, s[12:15], s43 offen lds
s_add_u32 m0, s40, 45056
s_add_u32 s43, s38, 98304
buffer_load_dwordx4 v2, s[12:15], s43 offen lds
s_add_u32 m0, s40, 46080
s_add_u32 s43, s38, 147456
buffer_load_dwordx4 v3, s[12:15], s43 offen lds
s_add_u32 m0, s40, 47104
s_add_u32 s43, s38, 196608
buffer_load_dwordx4 v2, s[12:15], s43 offen lds
s_add_u32 m0, s40, 48128
s_add_u32 s43, s38, 245760
buffer_load_dwordx4 v3, s[12:15], s43 offen lds
s_add_u32 m0, s40, 49152
s_add_u32 s43, s38, 294912
buffer_load_dwordx4 v2, s[12:15], s43 offen lds
s_add_u32 m0, s40, 50176
s_add_u32 s43, s38, 344064
buffer_load_dwordx4 v3, s[12:15], s43 offen lds
s_add_u32 s37, s37, 128
s_add_u32 s38, s38, 393216
v_lshlrev_b32 v116, 16, v96
v_and_b32 v117, 0xffff0000, v96
v_mul_f32 v118, v116, v116
v_mul_f32 v119, v117, v117
v_lshlrev_b32 v126, 16, v97
v_and_b32 v127, 0xffff0000, v97
v_add_f32 v116, v116, v126
v_add_f32 v117, v117, v127
v_fmac_f32 v118, v126, v126
v_fmac_f32 v119, v127, v127
v_lshlrev_b32 v124, 16, v98
v_and_b32 v125, 0xffff0000, v98
v_add_f32 v116, v116, v124
v_add_f32 v117, v117, v125
v_fmac_f32 v118, v124, v124
v_fmac_f32 v119, v125, v125
v_lshlrev_b32 v126, 16, v99
v_and_b32 v127, 0xffff0000, v99
v_add_f32 v116, v116, v126
v_add_f32 v117, v117, v127
v_fmac_f32 v118, v126, v126
v_fmac_f32 v119, v127, v127
v_lshlrev_b32 v124, 16, v100
v_and_b32 v125, 0xffff0000, v100
v_add_f32 v116, v116, v124
v_add_f32 v117, v117, v125
v_fmac_f32 v118, v124, v124
v_fmac_f32 v119, v125, v125
v_lshlrev_b32 v126, 16, v101
v_and_b32 v127, 0xffff0000, v101
v_add_f32 v116, v116, v126
v_add_f32 v117, v117, v127
v_fmac_f32 v118, v126, v126
v_fmac_f32 v119, v127, v127
v_lshlrev_b32 v124, 16, v102
v_and_b32 v125, 0xffff0000, v102
v_add_f32 v116, v116, v124
v_add_f32 v117, v117, v125
v_fmac_f32 v118, v124, v124
v_fmac_f32 v119, v125, v125
v_lshlrev_b32 v126, 16, v103
v_and_b32 v127, 0xffff0000, v103
v_add_f32 v116, v116, v126
v_add_f32 v117, v117, v127
v_fmac_f32 v118, v126, v126
v_fmac_f32 v119, v127, v127
v_lshlrev_b32 v120, 16, v104
v_and_b32 v121, 0xffff0000, v104
v_mul_f32 v122, v120, v120
v_mul_f32 v123, v121, v121
s_waitcnt vmcnt(14)
s_barrier
s_add_u32 m0, s39, 86016
s_mov_b64 exec, s[60:61]
buffer_load_dwordx4 v4, s[8:11], s37 offen lds
s_mov_b64 exec, -1
s_add_u32 m0, s39, 89088
s_nop 0
buffer_load_dwordx4 v5, s[8:11], s37 offen lds
s_add_u32 m0, s39, 92160
s_nop 0
buffer_load_dwordx4 v6, s[8:11], s37 offen lds
s_add_u32 m0, s39, 95232
s_nop 0
buffer_load_dwordx4 v7, s[8:11], s37 offen lds
s_add_u32 m0, s39, 98304
s_nop 0
buffer_load_dwordx4 v8, s[8:11], s37 offen lds
s_add_u32 m0, s39, 101376
s_nop 0
buffer_load_dwordx4 v9, s[8:11], s37 offen lds
s_add_u32 m0, s40, 86016
s_add_u32 s43, s38, 0
buffer_load_dwordx4 v2, s[12:15], s43 offen lds
s_add_u32 m0, s40, 87040
s_add_u32 s43, s38, 49152
buffer_load_dwordx4 v3, s[12:15], s43 offen lds
s_add_u32 m0, s40, 88064
s_add_u32 s43, s38, 98304
buffer_load_dwordx4 v2, s[12:15], s43 offen lds
s_add_u32 m0, s40, 89088
s_add_u32 s43, s38, 147456
buffer_load_dwordx4 v3, s[12:15], s43 offen lds
s_add_u32 m0, s40, 90112
s_add_u32 s43, s38, 196608
buffer_load_dwordx4 v2, s[12:15], s43 offen lds
s_add_u32 m0, s40, 91136
s_add_u32 s43, s38, 245760
buffer_load_dwordx4 v3, s[12:15], s43 offen lds
s_add_u32 m0, s40, 92160
s_add_u32 s43, s38, 294912
buffer_load_dwordx4 v2, s[12:15], s43 offen lds
s_add_u32 m0, s40, 93184
s_add_u32 s43, s38, 344064
buffer_load_dwordx4 v3, s[12:15], s43 offen lds
s_add_u32 s37, s37, 128
s_add_u32 s38, s38, 393216
v_lshlrev_b32 v126, 16, v105
v_and_b32 v127, 0xffff0000, v105
v_add_f32 v120, v120, v126
v_add_f32 v121, v121, v127
v_fmac_f32 v122, v126, v126
v_fmac_f32 v123, v127, v127
v_lshlrev_b32 v124, 16, v106
v_and_b32 v125, 0xffff0000, v106
v_add_f32 v120, v120, v124
v_add_f32 v121, v121, v125
v_fmac_f32 v122, v124, v124
v_fmac_f32 v123, v125, v125
v_lshlrev_b32 v126, 16, v107
v_and_b32 v127, 0xffff0000, v107
v_add_f32 v120, v120, v126
v_add_f32 v121, v121, v127
v_fmac_f32 v122, v126, v126
v_fmac_f32 v123, v127, v127
v_lshlrev_b32 v124, 16, v108
v_and_b32 v125, 0xffff0000, v108
v_add_f32 v120, v120, v124
v_add_f32 v121, v121, v125
v_fmac_f32 v122, v124, v124
v_fmac_f32 v123, v125, v125
v_lshlrev_b32 v126, 16, v109
v_and_b32 v127, 0xffff0000, v109
v_add_f32 v120, v120, v126
v_add_f32 v121, v121, v127
v_fmac_f32 v122, v126, v126
v_fmac_f32 v123, v127, v127
v_lshlrev_b32 v124, 16, v110
v_and_b32 v125, 0xffff0000, v110
v_add_f32 v120, v120, v124
v_add_f32 v121, v121, v125
v_fmac_f32 v122, v124, v124
v_fmac_f32 v123, v125, v125
v_lshlrev_b32 v126, 16, v111
v_and_b32 v127, 0xffff0000, v111
v_add_f32 v120, v120, v126
v_add_f32 v121, v121, v127
v_fmac_f32 v122, v126, v126
v_fmac_f32 v123, v127, v127
v_add_f32 v116, v116, v117
v_add_f32 v118, v118, v119
v_add_f32 v120, v120, v121
v_add_f32 v122, v122, v123
v_add_f32_dpp v116, v116, v116 row_ror:8 row_mask:0xf bank_mask:0xf
v_add_f32_dpp v118, v118, v118 row_ror:8 row_mask:0xf bank_mask:0xf
v_add_f32_dpp v120, v120, v120 row_ror:8 row_mask:0xf bank_mask:0xf
v_add_f32_dpp v122, v122, v122 row_ror:8 row_mask:0xf bank_mask:0xf
v_mov_b32 v128, -1
v_mov_b32 v129, -1
v_mov_b32 v130, -1
v_mov_b32 v131, -1
s_mul_i32 s28, s47, 5120
buffer_store_dwordx4 v[128:131], v10, s[16:19], s28 offen sc1
s_add_u32 s28, s28, 1024
buffer_store_dwordx4 v[128:131], v10, s[16:19], s28 offen sc1
s_add_u32 s28, s28, 1024
s_waitcnt vmcnt(16)
s_barrier
s_add_u32 m0, s39, 0
s_mov_b64 exec, s[60:61]
buffer_load_dwordx4 v4, s[8:11], s37 offen lds
s_mov_b64 exec, -1
s_add_u32 m0, s39, 3072
s_nop 0
buffer_load_dwordx4 v5, s[8:11], s37 offen lds
s_add_u32 m0, s39, 6144
s_nop 0
buffer_load_dwordx4 v6, s[8:11], s37 offen lds
s_add_u32 m0, s39, 9216
s_nop 0
buffer_load_dwordx4 v7, s[8:11], s37 offen lds
s_add_u32 m0, s39, 12288
s_nop 0
buffer_load_dwordx4 v8, s[8:11], s37 offen lds
s_add_u32 m0, s39, 15360
s_nop 0
buffer_load_dwordx4 v9, s[8:11], s37 offen lds
s_add_u32 m0, s40, 0
s_add_u32 s43, s38, 0
buffer_load_dwordx4 v2, s[12:15], s43 offen lds
s_add_u32 m0, s40, 1024
s_add_u32 s43, s38, 49152
buffer_load_dwordx4 v3, s[12:15], s43 offen lds
s_add_u32 m0, s40, 2048
s_add_u32 s43, s38, 98304
buffer_load_dwordx4 v2, s[12:15], s43 offen lds
s_add_u32 m0, s40, 3072
s_add_u32 s43, s38, 147456
buffer_load_dwordx4 v3, s[12:15], s43 offen lds
s_add_u32 m0, s40, 4096
s_add_u32 s43, s38, 196608
buffer_load_dwordx4 v2, s[12:15], s43 offen lds
s_add_u32 m0, s40, 5120
s_add_u32 s43, s38, 245760
buffer_load_dwordx4 v3, s[12:15], s43 offen lds
s_add_u32 m0, s40, 6144
s_add_u32 s43, s38, 294912
buffer_load_dwordx4 v2, s[12:15], s43 offen lds
s_add_u32 m0, s40, 7168
s_add_u32 s43, s38, 344064
buffer_load_dwordx4 v3, s[12:15], s43 offen lds
s_add_u32 s37, s37, 128
s_add_u32 s38, s38, 393216
v_add_f32_dpp v116, v116, v116 row_ror:4 row_mask:0xf bank_mask:0xf
v_add_f32_dpp v118, v118, v118 row_ror:4 row_mask:0xf bank_mask:0xf
v_add_f32_dpp v120, v120, v120 row_ror:4 row_mask:0xf bank_mask:0xf
v_add_f32_dpp v122, v122, v122 row_ror:4 row_mask:0xf bank_mask:0xf
v_add_f32_dpp v116, v116, v116 row_ror:2 row_mask:0xf bank_mask:0xf
v_add_f32_dpp v118, v118, v118 row_ror:2 row_mask:0xf bank_mask:0xf
v_add_f32_dpp v120, v120, v120 row_ror:2 row_mask:0xf bank_mask:0xf
v_add_f32_dpp v122, v122, v122 row_ror:2 row_mask:0xf bank_mask:0xf
v_add_f32_dpp v116, v116, v116 row_ror:1 row_mask:0xf bank_mask:0xf
v_add_f32_dpp v118, v118, v118 row_ror:1 row_mask:0xf bank_mask:0xf
v_add_f32_dpp v120, v120, v120 row_ror:1 row_mask:0xf bank_mask:0xf
v_add_f32_dpp v122, v122, v122 row_ror:1 row_mask:0xf bank_mask:0xf
v_mov_b32 v117, v116
v_mov_b32 v119, v118
v_mov_b32 v121, v120
v_mov_b32 v123, v122
s_nop 0
v_permlane16_swap_b32 v116, v117
v_permlane16_swap_b32 v118, v119
v_permlane16_swap_b32 v120, v121
v_permlane16_swap_b32 v122, v123
v_add_f32 v116, v116, v117
v_add_f32 v118, v118, v119
v_add_f32 v120, v120, v121
v_add_f32 v122, v122, v123
v_mov_b32 v117, v116
v_mov_b32 v119, v118
v_mov_b32 v121, v120
v_mov_b32 v123, v122
s_nop 0
v_permlane32_swap_b32 v116, v117
v_permlane32_swap_b32 v118, v119
v_permlane32_swap_b32 v120, v121
v_permlane32_swap_b32 v122, v123
v_add_f32 v116, v116, v117
v_add_f32 v118, v118, v119
v_add_f32 v120, v120, v121
v_add_f32 v122, v122, v123
v_mul_f32 v112, 0x3a800000, v116
v_mul_f32 v113, 0x3a800000, v118
v_fma_f32 v113, -v112, v112, v113
v_max_f32 v113, 0, v113
v_add_f32 v113, 0x3727c5ac, v113
v_rsq_f32 v113, v113
v_mul_f32 v114, 0x3a800000, v120
v_mul_f32 v115, 0x3a800000, v122
v_fma_f32 v115, -v114, v114, v115
v_max_f32 v115, 0, v115
v_add_f32 v115, 0x3727c5ac, v115
v_rsq_f32 v115, v115
s_nop 0
s_lshl_b32 s43, s47, 4
s_add_u32 s43, s43, 130176
v_mov_b32 v11, s43
ds_write_b128 v11, v[112:115]
s_waitcnt lgkmcnt(0)
buffer_store_dwordx4 v[128:131], v10, s[16:19], s28 offen sc1
s_add_u32 s28, s28, 1024
buffer_store_dwordx4 v[128:131], v10, s[16:19], s28 offen sc1
s_add_u32 s28, s28, 1024
s_load_dword s64, s[80:81], 0
s_load_dword s65, s[80:81], 64
s_load_dword s66, s[80:81], 128
s_load_dword s67, s[80:81], 192
s_load_dword s68, s[80:81], 7168
s_load_dword s69, s[80:81], 7232
s_load_dword s70, s[80:81], 7296
s_load_dword s71, s[80:81], 7360
s_add_u32 s80, s80, 14336
s_addc_u32 s81, s81, 0
s_waitcnt vmcnt(18)
s_barrier
s_add_u32 m0, s39, 43008
s_mov_b64 exec, s[60:61]
buffer_load_dwordx4 v4, s[8:11], s37 offen lds
s_mov_b64 exec, -1
s_add_u32 m0, s39, 46080
s_nop 0
buffer_load_dwordx4 v5, s[8:11], s37 offen lds
s_add_u32 m0, s39, 49152
s_nop 0
buffer_load_dwordx4 v6, s[8:11], s37 offen lds
s_add_u32 m0, s39, 52224
s_nop 0
buffer_load_dwordx4 v7, s[8:11], s37 offen lds
s_add_u32 m0, s39, 55296
s_nop 0
buffer_load_dwordx4 v8, s[8:11], s37 offen lds
s_add_u32 m0, s39, 58368
s_nop 0
buffer_load_dwordx4 v9, s[8:11], s37 offen lds
s_add_u32 m0, s40, 43008
s_add_u32 s43, s38, 0
buffer_load_dwordx4 v2, s[12:15], s43 offen lds
s_add_u32 m0, s40, 44032
s_add_u32 s43, s38, 49152
buffer_load_dwordx4 v3, s[12:15], s43 offen lds
s_add_u32 m0, s40, 45056
s_add_u32 s43, s38, 98304
buffer_load_dwordx4 v2, s[12:15], s43 offen lds
s_add_u32 m0, s40, 46080
s_add_u32 s43, s38, 147456
buffer_load_dwordx4 v3, s[12:15], s43 offen lds
s_add_u32 m0, s40, 47104
s_add_u32 s43, s38, 196608
buffer_load_dwordx4 v2, s[12:15], s43 offen lds
s_add_u32 m0, s40, 48128
s_add_u32 s43, s38, 245760
buffer_load_dwordx4 v3, s[12:15], s43 offen lds
s_add_u32 m0, s40, 49152
s_add_u32 s43, s38, 294912
buffer_load_dwordx4 v2, s[12:15], s43 offen lds
s_add_u32 m0, s40, 50176
s_add_u32 s43, s38, 344064
buffer_load_dwordx4 v3, s[12:15], s43 offen lds
s_add_u32 s37, s37, 128
s_add_u32 s38, s38, 393216
buffer_store_dwordx4 v[128:131], v10, s[16:19], s28 offen sc1
s_add_u32 s28, s28, 1024
buffer_store_dwordx4 v[128:131], v10, s[16:19], s28 offen sc1
s_add_u32 s28, s28, 1024
s_load_dword s64, s[80:81], 0
s_load_dword s65, s[80:81], 64
s_load_dword s66, s[80:81], 128
s_load_dword s67, s[80:81], 192
s_load_dword s68, s[80:81], 7168
s_load_dword s69, s[80:81], 7232
s_load_dword s70, s[80:81], 7296
s_load_dword s71, s[80:81], 7360
s_add_u32 s80, s80, 14336
s_addc_u32 s81, s81, 0
s_waitcnt vmcnt(18)
s_barrier
s_add_u32 m0, s39, 86016
s_mov_b64 exec, s[60:61]
buffer_load_dwordx4 v4, s[8:11], s37 offen lds
s_mov_b64 exec, -1
s_add_u32 m0, s39, 89088
s_nop 0
buffer_load_dwordx4 v5, s[8:11], s37 offen lds
s_add_u32 m0, s39, 92160
s_nop 0
buffer_load_dwordx4 v6, s[8:11], s37 offen lds
s_add_u32 m0, s39, 95232
s_nop 0
buffer_load_dwordx4 v7, s[8:11], s37 offen lds
s_add_u32 m0, s39, 98304
s_nop 0
buffer_load_dwordx4 v8, s[8:11], s37 offen lds
s_add_u32 m0, s39, 101376
s_nop 0
buffer_load_dwordx4 v9, s[8:11], s37 offen lds
s_add_u32 m0, s40, 86016
s_add_u32 s43, s38, 0
buffer_load_dwordx4 v2, s[12:15], s43 offen lds
s_add_u32 m0, s40, 87040
s_add_u32 s43, s38, 49152
buffer_load_dwordx4 v3, s[12:15], s43 offen lds
s_add_u32 m0, s40, 88064
s_add_u32 s43, s38, 98304
buffer_load_dwordx4 v2, s[12:15], s43 offen lds
s_add_u32 m0, s40, 89088
s_add_u32 s43, s38, 147456
buffer_load_dwordx4 v3, s[12:15], s43 offen lds
s_add_u32 m0, s40, 90112
s_add_u32 s43, s38, 196608
buffer_load_dwordx4 v2, s[12:15], s43 offen lds
s_add_u32 m0, s40, 91136
s_add_u32 s43, s38, 245760
buffer_load_dwordx4 v3, s[12:15], s43 offen lds
s_add_u32 m0, s40, 92160
s_add_u32 s43, s38, 294912
buffer_load_dwordx4 v2, s[12:15], s43 offen lds
s_add_u32 m0, s40, 93184
s_add_u32 s43, s38, 344064
buffer_load_dwordx4 v3, s[12:15], s43 offen lds
s_add_u32 s37, s37, 128
s_add_u32 s38, s38, 393216
s_add_u32 s24, s16, 4194304
s_addc_u32 s25, s17, 0
s_mov_b32 s26, 16384
s_mov_b32 s27, 0x20000
s_mul_i32 s28, s47, 5120
buffer_store_dwordx4 v[128:131], v10, s[24:27], s28 offen sc1
s_add_u32 s28, s28, 1024
s_load_dword s64, s[80:81], 0
s_load_dword s65, s[80:81], 64
s_load_dword s66, s[80:81], 128
s_load_dword s67, s[80:81], 192
s_load_dword s68, s[80:81], 7168
s_load_dword s69, s[80:81], 7232
s_load_dword s70, s[80:81], 7296
s_load_dword s71, s[80:81], 7360
s_add_u32 s80, s80, 14336
s_addc_u32 s81, s81, 0
s_waitcnt vmcnt(17)
s_barrier
s_add_u32 m0, s39, 0
s_mov_b64 exec, s[60:61]
buffer_load_dwordx4 v4, s[8:11], s37 offen lds
s_mov_b64 exec, -1
s_add_u32 m0, s39, 3072
s_nop 0
buffer_load_dwordx4 v5, s[8:11], s37 offen lds
s_add_u32 m0, s39, 6144
s_nop 0
buffer_load_dwordx4 v6, s[8:11], s37 offen lds
s_add_u32 m0, s39, 9216
s_nop 0
buffer_load_dwordx4 v7, s[8:11], s37 offen lds
s_add_u32 m0, s39, 12288
s_nop 0
buffer_load_dwordx4 v8, s[8:11], s37 offen lds
s_add_u32 m0, s39, 15360
s_nop 0
buffer_load_dwordx4 v9, s[8:11], s37 offen lds
s_add_u32 m0, s40, 0
s_add_u32 s43, s38, 0
buffer_load_dwordx4 v2, s[12:15], s43 offen lds
s_add_u32 m0, s40, 1024
s_add_u32 s43, s38, 49152
buffer_load_dwordx4 v3, s[12:15], s43 offen lds
s_add_u32 m0, s40, 2048
s_add_u32 s43, s38, 98304
buffer_load_dwordx4 v2, s[12:15], s43 offen lds
s_add_u32 m0, s40, 3072
s_add_u32 s43, s38, 147456
buffer_load_dwordx4 v3, s[12:15], s43 offen lds
s_add_u32 m0, s40, 4096
s_add_u32 s43, s38, 196608
buffer_load_dwordx4 v2, s[12:15], s43 offen lds
s_add_u32 m0, s40, 5120
s_add_u32 s43, s38, 245760
buffer_load_dwordx4 v3, s[12:15], s43 offen lds
s_add_u32 m0, s40, 6144
s_add_u32 s43, s38, 294912
buffer_load_dwordx4 v2, s[12:15], s43 offen lds
s_add_u32 m0, s40, 7168
s_add_u32 s43, s38, 344064
buffer_load_dwordx4 v3, s[12:15], s43 offen lds
s_add_u32 s37, s37, 128
s_add_u32 s38, s38, 393216
buffer_store_dwordx4 v[128:131], v10, s[24:27], s28 offen sc1
s_add_u32 s28, s28, 1024
s_load_dword s64, s[80:81], 0
s_load_dword s65, s[80:81], 64
s_load_dword s66, s[80:81], 128
s_load_dword s67, s[80:81], 192
s_load_dword s68, s[80:81], 7168
s_load_dword s69, s[80:81], 7232
s_load_dword s70, s[80:81], 7296
s_load_dword s71, s[80:81], 7360
s_add_u32 s80, s80, 14336
s_addc_u32 s81, s81, 0
s_waitcnt vmcnt(16)
s_barrier
s_add_u32 m0, s39, 43008
s_mov_b64 exec, s[60:61]
buffer_load_dwordx4 v4, s[8:11], s37 offen lds
s_mov_b64 exec, -1
s_add_u32 m0, s39, 46080
s_nop 0
buffer_load_dwordx4 v5, s[8:11], s37 offen lds
s_add_u32 m0, s39, 49152
s_nop 0
buffer_load_dwordx4 v6, s[8:11], s37 offen lds
s_add_u32 m0, s39, 52224
s_nop 0
buffer_load_dwordx4 v7, s[8:11], s37 offen lds
s_add_u32 m0, s39, 55296
s_nop 0
buffer_load_dwordx4 v8, s[8:11], s37 offen lds
s_add_u32 m0, s39, 58368
s_nop 0
buffer_load_dwordx4 v9, s[8:11], s37 offen lds
s_add_u32 m0, s40, 43008
s_add_u32 s43, s38, 0
buffer_load_dwordx4 v2, s[12:15], s43 offen lds
s_add_u32 m0, s40, 44032
s_add_u32 s43, s38, 49152
buffer_load_dwordx4 v3, s[12:15], s43 offen lds
s_add_u32 m0, s40, 45056
s_add_u32 s43, s38, 98304
buffer_load_dwordx4 v2, s[12:15], s43 offen lds
s_add_u32 m0, s40, 46080
s_add_u32 s43, s38, 147456
buffer_load_dwordx4 v3, s[12:15], s43 offen lds
s_add_u32 m0, s40, 47104
s_add_u32 s43, s38, 196608
buffer_load_dwordx4 v2, s[12:15], s43 offen lds
s_add_u32 m0, s40, 48128
s_add_u32 s43, s38, 245760
buffer_load_dwordx4 v3, s[12:15], s43 offen lds
s_add_u32 m0, s40, 49152
s_add_u32 s43, s38, 294912
buffer_load_dwordx4 v2, s[12:15], s43 offen lds
s_add_u32 m0, s40, 50176
s_add_u32 s43, s38, 344064
buffer_load_dwordx4 v3, s[12:15], s43 offen lds
s_add_u32 s37, s37, 128
s_add_u32 s38, s38, 393216
buffer_store_dwordx4 v[128:131], v10, s[24:27], s28 offen sc1
s_add_u32 s28, s28, 1024
s_load_dword s64, s[80:81], 0
s_load_dword s65, s[80:81], 64
s_load_dword s66, s[80:81], 128
s_load_dword s67, s[80:81], 192
s_load_dword s68, s[80:81], 7168
s_load_dword s69, s[80:81], 7232
s_load_dword s70, s[80:81], 7296
s_load_dword s71, s[80:81], 7360
s_add_u32 s80, s80, 14336
s_addc_u32 s81, s81, 0
s_waitcnt vmcnt(16)
s_barrier
s_add_u32 m0, s39, 86016
s_mov_b64 exec, s[60:61]
buffer_load_dwordx4 v4, s[8:11], s37 offen lds
s_mov_b64 exec, -1
s_add_u32 m0, s39, 89088
s_nop 0
buffer_load_dwordx4 v5, s[8:11], s37 offen lds
s_add_u32 m0, s39, 92160
s_nop 0
buffer_load_dwordx4 v6, s[8:11], s37 offen lds
s_add_u32 m0, s39, 95232
s_nop 0
buffer_load_dwordx4 v7, s[8:11], s37 offen lds
s_add_u32 m0, s39, 98304
s_nop 0
buffer_load_dwordx4 v8, s[8:11], s37 offen lds
s_add_u32 m0, s39, 101376
s_nop 0
buffer_load_dwordx4 v9, s[8:11], s37 offen lds
s_add_u32 m0, s40, 86016
s_add_u32 s43, s38, 0
buffer_load_dwordx4 v2, s[12:15], s43 offen lds
s_add_u32 m0, s40, 87040
s_add_u32 s43, s38, 49152
buffer_load_dwordx4 v3, s[12:15], s43 offen lds
s_add_u32 m0, s40, 88064
s_add_u32 s43, s38, 98304
buffer_load_dwordx4 v2, s[12:15], s43 offen lds
s_add_u32 m0, s40, 89088
s_add_u32 s43, s38, 147456
buffer_load_dwordx4 v3, s[12:15], s43 offen lds
s_add_u32 m0, s40, 90112
s_add_u32 s43, s38, 196608
buffer_load_dwordx4 v2, s[12:15], s43 offen lds
s_add_u32 m0, s40, 91136
s_add_u32 s43, s38, 245760
buffer_load_dwordx4 v3, s[12:15], s43 offen lds
s_add_u32 m0, s40, 92160
s_add_u32 s43, s38, 294912
buffer_load_dwordx4 v2, s[12:15], s43 offen lds
s_add_u32 m0, s40, 93184
s_add_u32 s43, s38, 344064
buffer_load_dwordx4 v3, s[12:15], s43 offen lds
s_add_u32 s37, s37, 128
s_add_u32 s38, s38, 393216
buffer_store_dwordx4 v[128:131], v10, s[24:27], s28 offen sc1
s_add_u32 s28, s28, 1024
s_load_dword s64, s[80:81], 0
s_load_dword s65, s[80:81], 64
s_load_dword s66, s[80:81], 128
s_load_dword s67, s[80:81], 192
s_load_dword s68, s[80:81], 7168
s_load_dword s69, s[80:81], 7232
s_load_dword s70, s[80:81], 7296
s_load_dword s71, s[80:81], 7360
s_add_u32 s80, s80, 14336
s_addc_u32 s81, s81, 0
s_waitcnt vmcnt(16)
s_barrier
s_add_u32 m0, s39, 0
s_mov_b64 exec, s[60:61]
buffer_load_dwordx4 v4, s[8:11], s37 offen lds
s_mov_b64 exec, -1
s_add_u32 m0, s39, 3072
s_nop 0
buffer_load_dwordx4 v5, s[8:11], s37 offen lds
s_add_u32 m0, s39, 6144
s_nop 0
buffer_load_dwordx4 v6, s[8:11], s37 offen lds
s_add_u32 m0, s39, 9216
s_nop 0
buffer_load_dwordx4 v7, s[8:11], s37 offen lds
s_add_u32 m0, s39, 12288
s_nop 0
buffer_load_dwordx4 v8, s[8:11], s37 offen lds
s_add_u32 m0, s39, 15360
s_nop 0
buffer_load_dwordx4 v9, s[8:11], s37 offen lds
s_add_u32 m0, s40, 0
s_add_u32 s43, s38, 0
buffer_load_dwordx4 v2, s[12:15], s43 offen lds
s_add_u32 m0, s40, 1024
s_add_u32 s43, s38, 49152
buffer_load_dwordx4 v3, s[12:15], s43 offen lds
s_add_u32 m0, s40, 2048
s_add_u32 s43, s38, 98304
buffer_load_dwordx4 v2, s[12:15], s43 offen lds
s_add_u32 m0, s40, 3072
s_add_u32 s43, s38, 147456
buffer_load_dwordx4 v3, s[12:15], s43 offen lds
s_add_u32 m0, s40, 4096
s_add_u32 s43, s38, 196608
buffer_load_dwordx4 v2, s[12:15], s43 offen lds
s_add_u32 m0, s40, 5120
s_add_u32 s43, s38, 245760
buffer_load_dwordx4 v3, s[12:15], s43 offen lds
s_add_u32 m0, s40, 6144
s_add_u32 s43, s38, 294912
buffer_load_dwordx4 v2, s[12:15], s43 offen lds
s_add_u32 m0, s40, 7168
s_add_u32 s43, s38, 344064
buffer_load_dwordx4 v3, s[12:15], s43 offen lds
s_add_u32 s37, s37, 128
s_add_u32 s38, s38, 393216
buffer_store_dwordx4 v[128:131], v10, s[24:27], s28 offen sc1
s_add_u32 s28, s28, 1024
s_load_dword s64, s[80:81], 0
s_load_dword s65, s[80:81], 64
s_load_dword s66, s[80:81], 128
s_load_dword s67, s[80:81], 192
s_load_dword s68, s[80:81], 7168
s_load_dword s69, s[80:81], 7232
s_load_dword s70, s[80:81], 7296
s_load_dword s71, s[80:81], 7360
s_add_u32 s80, s80, 14336
s_addc_u32 s81, s81, 0
s_waitcnt vmcnt(16)
s_barrier
s_add_u32 m0, s39, 43008
s_mov_b64 exec, s[60:61]
buffer_load_dwordx4 v4, s[8:11], s37 offen lds
s_mov_b64 exec, -1
s_add_u32 m0, s39, 46080
s_nop 0
buffer_load_dwordx4 v5, s[8:11], s37 offen lds
s_add_u32 m0, s39, 49152
s_nop 0
buffer_load_dwordx4 v6, s[8:11], s37 offen lds
s_add_u32 m0, s39, 52224
s_nop 0
buffer_load_dwordx4 v7, s[8:11], s37 offen lds
s_add_u32 m0, s39, 55296
s_nop 0
buffer_load_dwordx4 v8, s[8:11], s37 offen lds
s_add_u32 m0, s39, 58368
s_nop 0
buffer_load_dwordx4 v9, s[8:11], s37 offen lds
s_add_u32 m0, s40, 43008
s_add_u32 s43, s38, 0
buffer_load_dwordx4 v2, s[12:15], s43 offen lds
s_add_u32 m0, s40, 44032
s_add_u32 s43, s38, 49152
buffer_load_dwordx4 v3, s[12:15], s43 offen lds
s_add_u32 m0, s40, 45056
s_add_u32 s43, s38, 98304
buffer_load_dwordx4 v2, s[12:15], s43 offen lds
s_add_u32 m0, s40, 46080
s_add_u32 s43, s38, 147456
buffer_load_dwordx4 v3, s[12:15], s43 offen lds
s_add_u32 m0, s40, 47104
s_add_u32 s43, s38, 196608
buffer_load_dwordx4 v2, s[12:15], s43 offen lds
s_add_u32 m0, s40, 48128
s_add_u32 s43, s38, 245760
buffer_load_dwordx4 v3, s[12:15], s43 offen lds
s_add_u32 m0, s40, 49152
s_add_u32 s43, s38, 294912
buffer_load_dwordx4 v2, s[12:15], s43 offen lds
s_add_u32 m0, s40, 50176
s_add_u32 s43, s38, 344064
buffer_load_dwordx4 v3, s[12:15], s43 offen lds
s_add_u32 s37, s37, 128
s_add_u32 s38, s38, 393216
buffer_store_dwordx4 v[128:131], v10, s[24:27], s28 offen sc1
s_add_u32 s28, s28, 1024
s_load_dword s64, s[80:81], 0
s_load_dword s65, s[80:81], 64
s_load_dword s66, s[80:81], 128
s_load_dword s67, s[80:81], 192
s_load_dword s68, s[80:81], 7168
s_load_dword s69, s[80:81], 7232
s_load_dword s70, s[80:81], 7296
s_load_dword s71, s[80:81], 7360
s_add_u32 s80, s80, 14336
s_addc_u32 s81, s81, 0
s_waitcnt vmcnt(16)
s_barrier
s_add_u32 m0, s39, 86016
s_mov_b64 exec, s[60:61]
buffer_load_dwordx4 v4, s[8:11], s37 offen lds
s_mov_b64 exec, -1
s_add_u32 m0, s39, 89088
s_nop 0
buffer_load_dwordx4 v5, s[8:11], s37 offen lds
s_add_u32 m0, s39, 92160
s_nop 0
buffer_load_dwordx4 v6, s[8:11], s37 offen lds
s_add_u32 m0, s39, 95232
s_nop 0
buffer_load_dwordx4 v7, s[8:11], s37 offen lds
s_add_u32 m0, s39, 98304
s_nop 0
buffer_load_dwordx4 v8, s[8:11], s37 offen lds
s_add_u32 m0, s39, 101376
s_nop 0
buffer_load_dwordx4 v9, s[8:11], s37 offen lds
s_add_u32 m0, s40, 86016
s_add_u32 s43, s38, 0
buffer_load_dwordx4 v2, s[12:15], s43 offen lds
s_add_u32 m0, s40, 87040
s_add_u32 s43, s38, 49152
buffer_load_dwordx4 v3, s[12:15], s43 offen lds
s_add_u32 m0, s40, 88064
s_add_u32 s43, s38, 98304
buffer_load_dwordx4 v2, s[12:15], s43 offen lds
s_add_u32 m0, s40, 89088
s_add_u32 s43, s38, 147456
buffer_load_dwordx4 v3, s[12:15], s43 offen lds
s_add_u32 m0, s40, 90112
s_add_u32 s43, s38, 196608
buffer_load_dwordx4 v2, s[12:15], s43 offen lds
s_add_u32 m0, s40, 91136
s_add_u32 s43, s38, 245760
buffer_load_dwordx4 v3, s[12:15], s43 offen lds
s_add_u32 m0, s40, 92160
s_add_u32 s43, s38, 294912
buffer_load_dwordx4 v2, s[12:15], s43 offen lds
s_add_u32 m0, s40, 93184
s_add_u32 s43, s38, 344064
buffer_load_dwordx4 v3, s[12:15], s43 offen lds
s_add_u32 s37, s37, 128
s_add_u32 s38, s38, 393216
s_load_dword s64, s[80:81], 0
s_load_dword s65, s[80:81], 64
s_load_dword s66, s[80:81], 128
s_load_dword s67, s[80:81], 192
s_load_dword s68, s[80:81], 7168
s_load_dword s69, s[80:81], 7232
s_load_dword s70, s[80:81], 7296
s_load_dword s71, s[80:81], 7360
s_add_u32 s80, s80, 14336
s_addc_u32 s81, s81, 0
s_waitcnt vmcnt(15)
s_barrier
s_add_u32 m0, s39, 0
s_mov_b64 exec, s[60:61]
buffer_load_dwordx4 v4, s[8:11], s37 offen lds
s_mov_b64 exec, -1
s_add_u32 m0, s39, 3072
s_nop 0
buffer_load_dwordx4 v5, s[8:11], s37 offen lds
s_add_u32 m0, s39, 6144
s_nop 0
buffer_load_dwordx4 v6, s[8:11], s37 offen lds
s_add_u32 m0, s39, 9216
s_nop 0
buffer_load_dwordx4 v7, s[8:11], s37 offen lds
s_add_u32 m0, s39, 12288
s_nop 0
buffer_load_dwordx4 v8, s[8:11], s37 offen lds
s_add_u32 m0, s39, 15360
s_nop 0
buffer_load_dwordx4 v9, s[8:11], s37 offen lds
s_add_u32 m0, s40, 0
s_add_u32 s43, s38, 0
buffer_load_dwordx4 v2, s[12:15], s43 offen lds
s_add_u32 m0, s40, 1024
s_add_u32 s43, s38, 49152
buffer_load_dwordx4 v3, s[12:15], s43 offen lds
s_add_u32 m0, s40, 2048
s_add_u32 s43, s38, 98304
buffer_load_dwordx4 v2, s[12:15], s43 offen lds
s_add_u32 m0, s40, 3072
s_add_u32 s43, s38, 147456
buffer_load_dwordx4 v3, s[12:15], s43 offen lds
s_add_u32 m0, s40, 4096
s_add_u32 s43, s38, 196608
buffer_load_dwordx4 v2, s[12:15], s43 offen lds
s_add_u32 m0, s40, 5120
s_add_u32 s43, s38, 245760
buffer_load_dwordx4 v3, s[12:15], s43 offen lds
s_add_u32 m0, s40, 6144
s_add_u32 s43, s38, 294912
buffer_load_dwordx4 v2, s[12:15], s43 offen lds
s_add_u32 m0, s40, 7168
s_add_u32 s43, s38, 344064
buffer_load_dwordx4 v3, s[12:15], s43 offen lds
s_add_u32 s37, s37, 128
s_add_u32 s38, s38, 393216
s_waitcnt vmcnt(14)
s_barrier
s_waitcnt vmcnt(0)
s_barrier
s_barrier
s_cmp_eq_u32 s47, 0
s_cbranch_scc1 Lx_17
s_cmp_eq_u32 s47, 1
s_cbranch_scc1 Lx_18
s_branch Lw_20
Lr_21:
s_branch Lx_19
Lx_18:
s_branch Lw_22
Lr_23:
s_branch Lx_19
Lx_17:
s_branch Lw_24
Lr_25:
Lx_19:
s_waitcnt lgkmcnt(0)
s_and_b32 s43, s36, 1
s_lshr_b32 s44, s36, 1
s_and_b32 s44, s44, 1
s_lshr_b32 s45, s36, 2
s_xor_b32 s45, s45, 1
v_lshlrev_b32 v14, 2, v13
v_sub_u32 v14, v12, v14
v_subrev_u32 v15, 0, v14
v_cmp_ge_u32 s[52:53], 7, v15
v_add_u32 v15, 16, v15
v_cmp_ge_u32 s[84:85], 7, v15
v_subrev_u32 v15, 1, v14
v_cmp_ge_u32 s[54:55], 7, v15
v_add_u32 v15, 16, v15
v_cmp_ge_u32 s[86:87], 7, v15
v_subrev_u32 v15, 2, v14
v_cmp_ge_u32 s[56:57], 7, v15
v_add_u32 v15, 16, v15
v_cmp_ge_u32 s[88:89], 7, v15
v_subrev_u32 v15, 3, v14
v_cmp_ge_u32 s[58:59], 7, v15
v_add_u32 v15, 16, v15
v_cmp_ge_u32 s[90:91], 7, v15
s_lshl_b32 s46, s45, 6
s_add_u32 s46, s46, s44
s_add_u32 s46, s46, 16
v_lshl_add_u32 v14, v12, 1, s46
s_lshl_b32 s47, s43, 6
v_lshl_add_u32 v15, v13, 4, s47
v_mul_u32_u24 v20, 400, v14
v_add_u32 v20, v20, v15
v_subrev_u32 v16, 32, v14
v_max_i32 v16, 0, v16
v_mul_u32_u24 v21, 400, v16
v_add_u32 v21, v21, v15
v_lshrrev_b32 v16, 2, v12
v_lshl_add_u32 v16, v13, 2, v16
v_lshl_add_u32 v16, v16, 1, s46
v_and_b32 v17, 3, v1
v_lshl_add_u32 v17, v17, 3, s47
v_mul_u32_u24 v22, 400, v16
v_add_u32 v22, v22, v17
v_subrev_u32 v16, 32, v16
v_max_i32 v16, 0, v16
v_mul_u32_u24 v23, 400, v16
v_add_u32 v23, v23, v17
s_lshl_b32 s60, s43, 13
s_lshl_b32 s61, s45, 10
s_add_u32 s60, s60, s61
s_lshl_b32 s61, s44, 8
s_add_u32 s60, s60, s61
v_lshlrev_b32 v27, 11, v13
v_lshl_add_u32 v27, v12, 4, v27
v_add_u32 v27, s60, v27
v_mov_b32 v28, 0xff800000
s_mov_b32 s61, 0x3e8293ee
s_nop 2
s_or_b32 s62, s34, s45
s_cmp_lg_u32 s62, 0
s_cselect_b64 s[64:65], s[84:85], 0
s_cselect_b64 s[66:67], s[86:87], 0
s_cselect_b64 s[68:69], s[88:89], 0
s_cselect_b64 s[70:71], s[90:91], 0
s_branch Latt_5
.p2align 3
Lcons_2:
s_lshr_b32 s44, s2, 3
s_lshr_b32 s43, s36, 1
s_lshl_b32 s43, s43, 2
s_add_u32 s43, s43, s44
s_lshr_b32 s46, s43, 2
s_cmp_eq_u32 s46, 3
s_cselect_b32 s46, 1, 0
s_lshr_b32 s44, s36, 1
s_cmp_lg_u32 s46, s44
s_cbranch_scc1 Lsp_6
s_mov_b32 s44, s43
s_cmp_ge_u32 s2, 128
s_cbranch_scc1 Lsp_6
s_mov_b32 s84, s6
s_mov_b32 s85, s7
s_mov_b32 s86, 6291456
s_mov_b32 s87, 0x20000
s_and_b32 s43, s35, 8
s_or_b32 s43, s43, 3
s_lshl_b32 s43, s43, 7
s_mul_i32 s44, s44, 196608
s_add_u32 s43, s43, s44
s_and_b32 s44, s36, 1
s_lshl_b32 s44, s44, 6
v_add_u32 v15, s44, v1
v_min_u32 v15, 95, v15
v_mul_u32_u24 v16, 21846, v15
v_lshrrev_b32 v16, 16, v16
v_mul_u32_u24 v17, 3, v16
v_sub_u32 v15, v15, v17
v_mul_u32_u24 v16, 6144, v16
v_lshl_add_u32 v15, v15, 11, v16
buffer_load_dword v31, v15, s[84:87], s43 offen
Lsp_6:
v_lshrrev_b32 v16, 1, v12
v_xor_b32 v15, v13, v16
v_lshlrev_b32 v15, 4, v15
v_lshl_add_u32 v2, v12, 7, v15
v_xor_b32 v3, 64, v2
v_add_u32 v4, 86016, v2
v_add_u32 v5, 86016, v3
v_lshrrev_b32 v15, 2, v12
v_and_b32 v16, 3, v1
v_lshl_add_u32 v19, v13, 3, v15
v_lshlrev_b32 v19, 7, v19
v_and_b32 v15, 2, v15
v_and_b32 v17, 1, v13
v_lshl_add_u32 v15, v17, 2, v15
v_lshrrev_b32 v17, 1, v16
s_lshl_b32 s43, s36, 1
v_add_u32 v17, s43, v17
v_xor_b32 v15, v15, v17
v_lshl_add_u32 v19, v15, 4, v19
v_and_b32 v16, 1, v16
v_lshl_add_u32 v19, v16, 3, v19
v_add_u32 v6, 18432, v19
v_add_u32 v7, 61440, v19
v_add_u32 v8, 104448, v19
v_mov_b32 v128, 0
v_mov_b32 v129, 0
v_mov_b32 v130, 0
v_mov_b32 v131, 0
v_mov_b32 v132, 0
v_mov_b32 v133, 0
v_mov_b32 v134, 0
v_mov_b32 v135, 0
v_mov_b32 v136, 0
v_mov_b32 v137, 0
v_mov_b32 v138, 0
v_mov_b32 v139, 0
v_mov_b32 v140, 0
v_mov_b32 v141, 0
v_mov_b32 v142, 0
v_mov_b32 v143, 0
v_mov_b32 v144, 0
v_mov_b32 v145, 0
v_mov_b32 v146, 0
v_mov_b32 v147, 0
v_mov_b32 v148, 0
v_mov_b32 v149, 0
v_mov_b32 v150, 0
v_mov_b32 v151, 0
v_mov_b32 v152, 0
v_mov_b32 v153, 0
v_mov_b32 v154, 0
v_mov_b32 v155, 0
v_mov_b32 v156, 0
v_mov_b32 v157, 0
v_mov_b32 v158, 0
v_mov_b32 v159, 0
v_mov_b32 v160, 0
v_mov_b32 v161, 0
v_mov_b32 v162, 0
v_mov_b32 v163, 0
v_mov_b32 v164, 0
v_mov_b32 v165, 0
v_mov_b32 v166, 0
v_mov_b32 v167, 0
v_mov_b32 v168, 0
v_mov_b32 v169, 0
v_mov_b32 v170, 0
v_mov_b32 v171, 0
v_mov_b32 v172, 0
v_mov_b32 v173, 0
v_mov_b32 v174, 0
v_mov_b32 v175, 0
v_mov_b32 v176, 0
v_mov_b32 v177, 0
v_mov_b32 v178, 0
v_mov_b32 v179, 0
v_mov_b32 v180, 0
v_mov_b32 v181, 0
v_mov_b32 v182, 0
v_mov_b32 v183, 0
v_mov_b32 v184, 0
v_mov_b32 v185, 0
v_mov_b32 v186, 0
v_mov_b32 v187, 0
v_mov_b32 v188, 0
v_mov_b32 v189, 0
v_mov_b32 v190, 0
v_mov_b32 v191, 0
v_mov_b32 v192, 0
v_mov_b32 v193, 0
v_mov_b32 v194, 0
v_mov_b32 v195, 0
v_mov_b32 v196, 0
v_mov_b32 v197, 0
v_mov_b32 v198, 0
v_mov_b32 v199, 0
v_mov_b32 v200, 0
v_mov_b32 v201, 0
v_mov_b32 v202, 0
v_mov_b32 v203, 0
v_mov_b32 v204, 0
v_mov_b32 v205, 0
v_mov_b32 v206, 0
v_mov_b32 v207, 0
v_mov_b32 v208, 0
v_mov_b32 v209, 0
v_mov_b32 v210, 0
v_mov_b32 v211, 0
v_mov_b32 v212, 0
v_mov_b32 v213, 0
v_mov_b32 v214, 0
v_mov_b32 v215, 0
v_mov_b32 v216, 0
v_mov_b32 v217, 0
v_mov_b32 v218, 0
v_mov_b32 v219, 0
v_mov_b32 v220, 0
v_mov_b32 v221, 0
v_mov_b32 v222, 0
v_mov_b32 v223, 0
v_mov_b32 v224, 0
v_mov_b32 v225, 0
v_mov_b32 v226, 0
v_mov_b32 v227, 0
v_mov_b32 v228, 0
v_mov_b32 v229, 0
v_mov_b32 v230, 0
v_mov_b32 v231, 0
v_mov_b32 v232, 0
v_mov_b32 v233, 0
v_mov_b32 v234, 0
v_mov_b32 v235, 0
s_and_b32 s43, s36, 1
s_lshr_b32 s44, s36, 1
s_and_b32 s44, s44, 1
s_lshr_b32 s45, s36, 2
s_xor_b32 s45, s45, 1
v_lshlrev_b32 v14, 2, v13
v_sub_u32 v14, v12, v14
v_subrev_u32 v15, 0, v14
v_cmp_ge_u32 s[52:53], 7, v15
v_add_u32 v15, 16, v15
v_cmp_ge_u32 s[84:85], 7, v15
v_subrev_u32 v15, 1, v14
v_cmp_ge_u32 s[54:55], 7, v15
v_add_u32 v15, 16, v15
v_cmp_ge_u32 s[86:87], 7, v15
v_subrev_u32 v15, 2, v14
v_cmp_ge_u32 s[56:57], 7, v15
v_add_u32 v15, 16, v15
v_cmp_ge_u32 s[88:89], 7, v15
v_subrev_u32 v15, 3, v14
v_cmp_ge_u32 s[58:59], 7, v15
v_add_u32 v15, 16, v15
v_cmp_ge_u32 s[90:91], 7, v15
s_lshl_b32 s46, s45, 6
s_add_u32 s46, s46, s44
s_add_u32 s46, s46, 16
v_lshl_add_u32 v14, v12, 1, s46
s_lshl_b32 s47, s43, 6
v_lshl_add_u32 v15, v13, 4, s47
v_mul_u32_u24 v20, 400, v14
v_add_u32 v20, v20, v15
v_subrev_u32 v16, 32, v14
v_max_i32 v16, 0, v16
v_mul_u32_u24 v21, 400, v16
v_add_u32 v21, v21, v15
v_lshrrev_b32 v16, 2, v12
v_lshl_add_u32 v16, v13, 2, v16
v_lshl_add_u32 v16, v16, 1, s46
v_and_b32 v17, 3, v1
v_lshl_add_u32 v17, v17, 3, s47
v_mul_u32_u24 v22, 400, v16
v_add_u32 v22, v22, v17
v_subrev_u32 v16, 32, v16
v_max_i32 v16, 0, v16
v_mul_u32_u24 v23, 400, v16
v_add_u32 v23, v23, v17
s_lshl_b32 s60, s43, 13
s_lshl_b32 s61, s45, 10
s_add_u32 s60, s60, s61
s_lshl_b32 s61, s44, 8
s_add_u32 s60, s60, s61
v_lshlrev_b32 v27, 11, v13
v_lshl_add_u32 v27, v12, 4, v27
v_add_u32 v27, s60, v27
v_mov_b32 v28, 0xff800000
s_mov_b32 s61, 0x3e8293ee
s_nop 2
s_or_b32 s62, s34, s45
s_cmp_lg_u32 s62, 0
s_cselect_b64 s[64:65], s[84:85], 0
s_cselect_b64 s[66:67], s[86:87], 0
s_cselect_b64 s[68:69], s[88:89], 0
s_cselect_b64 s[70:71], s[90:91], 0
s_lshl_b32 s43, s36, 5
s_add_u32 s43, s43, 16
v_lshl_add_u32 v10, v12, 1, s43
v_lshlrev_b32 v10, 7, v10
v_and_b32 v16, 1, v13
v_lshlrev_b32 v16, 1, v16
v_lshrrev_b32 v17, 1, v13
v_add_u32 v16, v16, v17
v_and_b32 v17, 7, v12
v_xor_b32 v16, v16, v17
v_lshl_add_u32 v10, v16, 4, v10
s_mov_b32 s42, s35
v_lshlrev_b32 v9, 3, v12
v_add_u32 v9, 129024, v9
v_mul_u32_u24 v14, 400, v12
v_lshl_add_u32 v14, v13, 3, v14
s_lshl_b32 s43, s36, 5
v_add_u32 v14, s43, v14
s_barrier
ds_read_b128 v[32:35], v2 offset:0
ds_read_b64_tr_b16 v[72:73], v6 offset:8192
ds_read_b64_tr_b16 v[74:75], v6 offset:8704
ds_read_b64_tr_b16 v[76:77], v6 offset:16384
ds_read_b64_tr_b16 v[78:79], v6 offset:16896
ds_read_b64_tr_b16 v[68:69], v6 offset:0
ds_read_b64_tr_b16 v[70:71], v6 offset:512
ds_read_b128 v[36:39], v2 offset:2048
ds_read_b128 v[40:43], v2 offset:4096
ds_read_b128 v[44:47], v2 offset:6144
ds_read_b128 v[48:51], v2 offset:8192
ds_read_b128 v[52:55], v2 offset:10240
ds_read_b128 v[56:59], v2 offset:12288
ds_read_b128 v[60:63], v2 offset:14336
ds_read_b128 v[64:67], v2 offset:16384
s_mov_b32 s41, 5
.p2align 3
Lcl_7:
s_waitcnt lgkmcnt(0)
v_mfma_f32_16x16x32_bf16 v[164:167], v[72:75], v[32:35], v[164:167]
ds_read_b128 v[80:83], v3 offset:0
v_mfma_f32_16x16x32_bf16 v[200:203], v[76:79], v[32:35], v[200:203]
ds_read_b64_tr_b16 v[120:121], v6 offset:12288
v_mfma_f32_16x16x32_bf16 v[128:131], v[68:71], v[32:35], v[128:131]
ds_read_b64_tr_b16 v[122:123], v6 offset:12800
v_mfma_f32_16x16x32_bf16 v[168:171], v[72:75], v[36:39], v[168:171]
ds_read_b64_tr_b16 v[124:125], v6 offset:20480
v_mfma_f32_16x16x32_bf16 v[204:207], v[76:79], v[36:39], v[204:207]
ds_read_b64_tr_b16 v[126:127], v6 offset:20992
v_mfma_f32_16x16x32_bf16 v[132:135], v[68:71], v[36:39], v[132:135]
ds_read_b64_tr_b16 v[116:117], v6 offset:4096
v_mfma_f32_16x16x32_bf16 v[172:175], v[72:75], v[40:43], v[172:175]
ds_read_b64_tr_b16 v[118:119], v6 offset:4608
v_mfma_f32_16x16x32_bf16 v[208:211], v[76:79], v[40:43], v[208:211]
ds_read_b128 v[84:87], v3 offset:2048
v_mfma_f32_16x16x32_bf16 v[136:139], v[68:71], v[40:43], v[136:139]
ds_read_b128 v[88:91], v3 offset:4096
v_mfma_f32_16x16x32_bf16 v[176:179], v[72:75], v[44:47], v[176:179]
ds_read_b128 v[92:95], v3 offset:6144
v_mfma_f32_16x16x32_bf16 v[212:215], v[76:79], v[44:47], v[212:215]
ds_read_b128 v[96:99], v3 offset:8192
v_mfma_f32_16x16x32_bf16 v[140:143], v[68:71], v[44:47], v[140:143]
ds_read_b128 v[100:103], v3 offset:10240
v_mfma_f32_16x16x32_bf16 v[180:183], v[72:75], v[48:51], v[180:183]
ds_read_b128 v[104:107], v3 offset:12288
v_mfma_f32_16x16x32_bf16 v[216:219], v[76:79], v[48:51], v[216:219]
ds_read_b128 v[108:111], v3 offset:14336
v_mfma_f32_16x16x32_bf16 v[144:147], v[68:71], v[48:51], v[144:147]
ds_read_b128 v[112:115], v3 offset:16384
v_mfma_f32_16x16x32_bf16 v[184:187], v[72:75], v[52:55], v[184:187]
v_mfma_f32_16x16x32_bf16 v[220:223], v[76:79], v[52:55], v[220:223]
v_mfma_f32_16x16x32_bf16 v[148:151], v[68:71], v[52:55], v[148:151]
v_mfma_f32_16x16x32_bf16 v[188:191], v[72:75], v[56:59], v[188:191]
v_mfma_f32_16x16x32_bf16 v[224:227], v[76:79], v[56:59], v[224:227]
v_mfma_f32_16x16x32_bf16 v[152:155], v[68:71], v[56:59], v[152:155]
v_mfma_f32_16x16x32_bf16 v[192:195], v[72:75], v[60:63], v[192:195]
v_mfma_f32_16x16x32_bf16 v[228:231], v[76:79], v[60:63], v[228:231]
s_sub_u32 s42, s42, 1
s_cbranch_scc1 Lxr_8
Lxb_9:
v_mfma_f32_16x16x32_bf16 v[156:159], v[68:71], v[60:63], v[156:159]
v_mfma_f32_16x16x32_bf16 v[196:199], v[72:75], v[64:67], v[196:199]
v_mfma_f32_16x16x32_bf16 v[232:235], v[76:79], v[64:67], v[232:235]
v_mfma_f32_16x16x32_bf16 v[160:163], v[68:71], v[64:67], v[160:163]
s_waitcnt lgkmcnt(0)
s_barrier
v_mfma_f32_16x16x32_bf16 v[164:167], v[120:123], v[80:83], v[164:167]
ds_read_b128 v[32:35], v2 offset:43008
v_mfma_f32_16x16x32_bf16 v[200:203], v[124:127], v[80:83], v[200:203]
ds_read_b64_tr_b16 v[72:73], v7 offset:8192
v_mfma_f32_16x16x32_bf16 v[128:131], v[116:119], v[80:83], v[128:131]
ds_read_b64_tr_b16 v[74:75], v7 offset:8704
v_mfma_f32_16x16x32_bf16 v[168:171], v[120:123], v[84:87], v[168:171]
ds_read_b64_tr_b16 v[76:77], v7 offset:16384
v_mfma_f32_16x16x32_bf16 v[204:207], v[124:127], v[84:87], v[204:207]
ds_read_b64_tr_b16 v[78:79], v7 offset:16896
v_mfma_f32_16x16x32_bf16 v[132:135], v[116:119], v[84:87], v[132:135]
ds_read_b64_tr_b16 v[68:69], v7 offset:0
v_mfma_f32_16x16x32_bf16 v[172:175], v[120:123], v[88:91], v[172:175]
ds_read_b64_tr_b16 v[70:71], v7 offset:512
v_mfma_f32_16x16x32_bf16 v[208:211], v[124:127], v[88:91], v[208:211]
ds_read_b128 v[36:39], v2 offset:45056
v_mfma_f32_16x16x32_bf16 v[136:139], v[116:119], v[88:91], v[136:139]
ds_read_b128 v[40:43], v2 offset:47104
v_mfma_f32_16x16x32_bf16 v[176:179], v[120:123], v[92:95], v[176:179]
ds_read_b128 v[44:47], v2 offset:49152
v_mfma_f32_16x16x32_bf16 v[212:215], v[124:127], v[92:95], v[212:215]
ds_read_b128 v[48:51], v2 offset:51200
v_mfma_f32_16x16x32_bf16 v[140:143], v[116:119], v[92:95], v[140:143]
ds_read_b128 v[52:55], v2 offset:53248
v_mfma_f32_16x16x32_bf16 v[180:183], v[120:123], v[96:99], v[180:183]
ds_read_b128 v[56:59], v2 offset:55296
v_mfma_f32_16x16x32_bf16 v[216:219], v[124:127], v[96:99], v[216:219]
ds_read_b128 v[60:63], v2 offset:57344
v_mfma_f32_16x16x32_bf16 v[144:147], v[116:119], v[96:99], v[144:147]
ds_read_b128 v[64:67], v2 offset:59392
v_mfma_f32_16x16x32_bf16 v[184:187], v[120:123], v[100:103], v[184:187]
v_mfma_f32_16x16x32_bf16 v[220:223], v[124:127], v[100:103], v[220:223]
v_mfma_f32_16x16x32_bf16 v[148:151], v[116:119], v[100:103], v[148:151]
v_mfma_f32_16x16x32_bf16 v[188:191], v[120:123], v[104:107], v[188:191]
v_mfma_f32_16x16x32_bf16 v[224:227], v[124:127], v[104:107], v[224:227]
v_mfma_f32_16x16x32_bf16 v[152:155], v[116:119], v[104:107], v[152:155]
v_mfma_f32_16x16x32_bf16 v[192:195], v[120:123], v[108:111], v[192:195]
v_mfma_f32_16x16x32_bf16 v[228:231], v[124:127], v[108:111], v[228:231]
v_mfma_f32_16x16x32_bf16 v[156:159], v[116:119], v[108:111], v[156:159]
v_mfma_f32_16x16x32_bf16 v[196:199], v[120:123], v[112:115], v[196:199]
v_mfma_f32_16x16x32_bf16 v[232:235], v[124:127], v[112:115], v[232:235]
v_mfma_f32_16x16x32_bf16 v[160:163], v[116:119], v[112:115], v[160:163]
s_waitcnt lgkmcnt(0)
v_mfma_f32_16x16x32_bf16 v[164:167], v[72:75], v[32:35], v[164:167]
ds_read_b128 v[80:83], v3 offset:43008
v_mfma_f32_16x16x32_bf16 v[200:203], v[76:79], v[32:35], v[200:203]
ds_read_b64_tr_b16 v[120:121], v7 offset:12288
v_mfma_f32_16x16x32_bf16 v[128:131], v[68:71], v[32:35], v[128:131]
ds_read_b64_tr_b16 v[122:123], v7 offset:12800
v_mfma_f32_16x16x32_bf16 v[168:171], v[72:75], v[36:39], v[168:171]
ds_read_b64_tr_b16 v[124:125], v7 offset:20480
v_mfma_f32_16x16x32_bf16 v[204:207], v[76:79], v[36:39], v[204:207]
ds_read_b64_tr_b16 v[126:127], v7 offset:20992
v_mfma_f32_16x16x32_bf16 v[132:135], v[68:71], v[36:39], v[132:135]
ds_read_b64_tr_b16 v[116:117], v7 offset:4096
v_mfma_f32_16x16x32_bf16 v[172:175], v[72:75], v[40:43], v[172:175]
ds_read_b64_tr_b16 v[118:119], v7 offset:4608
v_mfma_f32_16x16x32_bf16 v[208:211], v[76:79], v[40:43], v[208:211]
ds_read_b128 v[84:87], v3 offset:45056
v_mfma_f32_16x16x32_bf16 v[136:139], v[68:71], v[40:43], v[136:139]
ds_read_b128 v[88:91], v3 offset:47104
v_mfma_f32_16x16x32_bf16 v[176:179], v[72:75], v[44:47], v[176:179]
ds_read_b128 v[92:95], v3 offset:49152
v_mfma_f32_16x16x32_bf16 v[212:215], v[76:79], v[44:47], v[212:215]
ds_read_b128 v[96:99], v3 offset:51200
v_mfma_f32_16x16x32_bf16 v[140:143], v[68:71], v[44:47], v[140:143]
ds_read_b128 v[100:103], v3 offset:53248
v_mfma_f32_16x16x32_bf16 v[180:183], v[72:75], v[48:51], v[180:183]
ds_read_b128 v[104:107], v3 offset:55296
v_mfma_f32_16x16x32_bf16 v[216:219], v[76:79], v[48:51], v[216:219]
ds_read_b128 v[108:111], v3 offset:57344
v_mfma_f32_16x16x32_bf16 v[144:147], v[68:71], v[48:51], v[144:147]
ds_read_b128 v[112:115], v3 offset:59392
v_mfma_f32_16x16x32_bf16 v[184:187], v[72:75], v[52:55], v[184:187]
v_mfma_f32_16x16x32_bf16 v[220:223], v[76:79], v[52:55], v[220:223]
v_mfma_f32_16x16x32_bf16 v[148:151], v[68:71], v[52:55], v[148:151]
v_mfma_f32_16x16x32_bf16 v[188:191], v[72:75], v[56:59], v[188:191]
v_mfma_f32_16x16x32_bf16 v[224:227], v[76:79], v[56:59], v[224:227]
v_mfma_f32_16x16x32_bf16 v[152:155], v[68:71], v[56:59], v[152:155]
v_mfma_f32_16x16x32_bf16 v[192:195], v[72:75], v[60:63], v[192:195]
v_mfma_f32_16x16x32_bf16 v[228:231], v[76:79], v[60:63], v[228:231]
s_sub_u32 s42, s42, 1
s_cbranch_scc1 Lxr_10
Lxb_11:
v_mfma_f32_16x16x32_bf16 v[156:159], v[68:71], v[60:63], v[156:159]
v_mfma_f32_16x16x32_bf16 v[196:199], v[72:75], v[64:67], v[196:199]
v_mfma_f32_16x16x32_bf16 v[232:235], v[76:79], v[64:67], v[232:235]
v_mfma_f32_16x16x32_bf16 v[160:163], v[68:71], v[64:67], v[160:163]
s_waitcnt lgkmcnt(0)
s_barrier
v_mfma_f32_16x16x32_bf16 v[164:167], v[120:123], v[80:83], v[164:167]
ds_read_b128 v[32:35], v4 offset:0
v_mfma_f32_16x16x32_bf16 v[200:203], v[124:127], v[80:83], v[200:203]
ds_read_b64_tr_b16 v[72:73], v8 offset:8192
v_mfma_f32_16x16x32_bf16 v[128:131], v[116:119], v[80:83], v[128:131]
ds_read_b64_tr_b16 v[74:75], v8 offset:8704
v_mfma_f32_16x16x32_bf16 v[168:171], v[120:123], v[84:87], v[168:171]
ds_read_b64_tr_b16 v[76:77], v8 offset:16384
v_mfma_f32_16x16x32_bf16 v[204:207], v[124:127], v[84:87], v[204:207]
ds_read_b64_tr_b16 v[78:79], v8 offset:16896
v_mfma_f32_16x16x32_bf16 v[132:135], v[116:119], v[84:87], v[132:135]
ds_read_b64_tr_b16 v[68:69], v8 offset:0
v_mfma_f32_16x16x32_bf16 v[172:175], v[120:123], v[88:91], v[172:175]
ds_read_b64_tr_b16 v[70:71], v8 offset:512
v_mfma_f32_16x16x32_bf16 v[208:211], v[124:127], v[88:91], v[208:211]
ds_read_b128 v[36:39], v4 offset:2048
v_mfma_f32_16x16x32_bf16 v[136:139], v[116:119], v[88:91], v[136:139]
ds_read_b128 v[40:43], v4 offset:4096
v_mfma_f32_16x16x32_bf16 v[176:179], v[120:123], v[92:95], v[176:179]
ds_read_b128 v[44:47], v4 offset:6144
v_mfma_f32_16x16x32_bf16 v[212:215], v[124:127], v[92:95], v[212:215]
ds_read_b128 v[48:51], v4 offset:8192
v_mfma_f32_16x16x32_bf16 v[140:143], v[116:119], v[92:95], v[140:143]
ds_read_b128 v[52:55], v4 offset:10240
v_mfma_f32_16x16x32_bf16 v[180:183], v[120:123], v[96:99], v[180:183]
ds_read_b128 v[56:59], v4 offset:12288
v_mfma_f32_16x16x32_bf16 v[216:219], v[124:127], v[96:99], v[216:219]
ds_read_b128 v[60:63], v4 offset:14336
v_mfma_f32_16x16x32_bf16 v[144:147], v[116:119], v[96:99], v[144:147]
ds_read_b128 v[64:67], v4 offset:16384
v_mfma_f32_16x16x32_bf16 v[184:187], v[120:123], v[100:103], v[184:187]
v_mfma_f32_16x16x32_bf16 v[220:223], v[124:127], v[100:103], v[220:223]
v_mfma_f32_16x16x32_bf16 v[148:151], v[116:119], v[100:103], v[148:151]
v_mfma_f32_16x16x32_bf16 v[188:191], v[120:123], v[104:107], v[188:191]
v_mfma_f32_16x16x32_bf16 v[224:227], v[124:127], v[104:107], v[224:227]
v_mfma_f32_16x16x32_bf16 v[152:155], v[116:119], v[104:107], v[152:155]
v_mfma_f32_16x16x32_bf16 v[192:195], v[120:123], v[108:111], v[192:195]
v_mfma_f32_16x16x32_bf16 v[228:231], v[124:127], v[108:111], v[228:231]
v_mfma_f32_16x16x32_bf16 v[156:159], v[116:119], v[108:111], v[156:159]
v_mfma_f32_16x16x32_bf16 v[196:199], v[120:123], v[112:115], v[196:199]
v_mfma_f32_16x16x32_bf16 v[232:235], v[124:127], v[112:115], v[232:235]
v_mfma_f32_16x16x32_bf16 v[160:163], v[116:119], v[112:115], v[160:163]
s_waitcnt lgkmcnt(0)
v_mfma_f32_16x16x32_bf16 v[164:167], v[72:75], v[32:35], v[164:167]
ds_read_b128 v[80:83], v5 offset:0
v_mfma_f32_16x16x32_bf16 v[200:203], v[76:79], v[32:35], v[200:203]
ds_read_b64_tr_b16 v[120:121], v8 offset:12288
v_mfma_f32_16x16x32_bf16 v[128:131], v[68:71], v[32:35], v[128:131]
ds_read_b64_tr_b16 v[122:123], v8 offset:12800
v_mfma_f32_16x16x32_bf16 v[168:171], v[72:75], v[36:39], v[168:171]
ds_read_b64_tr_b16 v[124:125], v8 offset:20480
v_mfma_f32_16x16x32_bf16 v[204:207], v[76:79], v[36:39], v[204:207]
ds_read_b64_tr_b16 v[126:127], v8 offset:20992
v_mfma_f32_16x16x32_bf16 v[132:135], v[68:71], v[36:39], v[132:135]
ds_read_b64_tr_b16 v[116:117], v8 offset:4096
v_mfma_f32_16x16x32_bf16 v[172:175], v[72:75], v[40:43], v[172:175]
ds_read_b64_tr_b16 v[118:119], v8 offset:4608
v_mfma_f32_16x16x32_bf16 v[208:211], v[76:79], v[40:43], v[208:211]
ds_read_b128 v[84:87], v5 offset:2048
v_mfma_f32_16x16x32_bf16 v[136:139], v[68:71], v[40:43], v[136:139]
ds_read_b128 v[88:91], v5 offset:4096
v_mfma_f32_16x16x32_bf16 v[176:179], v[72:75], v[44:47], v[176:179]
ds_read_b128 v[92:95], v5 offset:6144
v_mfma_f32_16x16x32_bf16 v[212:215], v[76:79], v[44:47], v[212:215]
ds_read_b128 v[96:99], v5 offset:8192
v_mfma_f32_16x16x32_bf16 v[140:143], v[68:71], v[44:47], v[140:143]
ds_read_b128 v[100:103], v5 offset:10240
v_mfma_f32_16x16x32_bf16 v[180:183], v[72:75], v[48:51], v[180:183]
ds_read_b128 v[104:107], v5 offset:12288
v_mfma_f32_16x16x32_bf16 v[216:219], v[76:79], v[48:51], v[216:219]
ds_read_b128 v[108:111], v5 offset:14336
v_mfma_f32_16x16x32_bf16 v[144:147], v[68:71], v[48:51], v[144:147]
ds_read_b128 v[112:115], v5 offset:16384
v_mfma_f32_16x16x32_bf16 v[184:187], v[72:75], v[52:55], v[184:187]
v_mfma_f32_16x16x32_bf16 v[220:223], v[76:79], v[52:55], v[220:223]
v_mfma_f32_16x16x32_bf16 v[148:151], v[68:71], v[52:55], v[148:151]
v_mfma_f32_16x16x32_bf16 v[188:191], v[72:75], v[56:59], v[188:191]
v_mfma_f32_16x16x32_bf16 v[224:227], v[76:79], v[56:59], v[224:227]
v_mfma_f32_16x16x32_bf16 v[152:155], v[68:71], v[56:59], v[152:155]
v_mfma_f32_16x16x32_bf16 v[192:195], v[72:75], v[60:63], v[192:195]
v_mfma_f32_16x16x32_bf16 v[228:231], v[76:79], v[60:63], v[228:231]
s_sub_u32 s42, s42, 1
s_cbranch_scc1 Lxr_12
Lxb_13:
v_mfma_f32_16x16x32_bf16 v[156:159], v[68:71], v[60:63], v[156:159]
v_mfma_f32_16x16x32_bf16 v[196:199], v[72:75], v[64:67], v[196:199]
v_mfma_f32_16x16x32_bf16 v[232:235], v[76:79], v[64:67], v[232:235]
v_mfma_f32_16x16x32_bf16 v[160:163], v[68:71], v[64:67], v[160:163]
s_waitcnt lgkmcnt(0)
s_barrier
v_mfma_f32_16x16x32_bf16 v[164:167], v[120:123], v[80:83], v[164:167]
ds_read_b128 v[32:35], v2 offset:0
v_mfma_f32_16x16x32_bf16 v[200:203], v[124:127], v[80:83], v[200:203]
ds_read_b64_tr_b16 v[72:73], v6 offset:8192
v_mfma_f32_16x16x32_bf16 v[128:131], v[116:119], v[80:83], v[128:131]
ds_read_b64_tr_b16 v[74:75], v6 offset:8704
v_mfma_f32_16x16x32_bf16 v[168:171], v[120:123], v[84:87], v[168:171]
ds_read_b64_tr_b16 v[76:77], v6 offset:16384
v_mfma_f32_16x16x32_bf16 v[204:207], v[124:127], v[84:87], v[204:207]
ds_read_b64_tr_b16 v[78:79], v6 offset:16896
v_mfma_f32_16x16x32_bf16 v[132:135], v[116:119], v[84:87], v[132:135]
ds_read_b64_tr_b16 v[68:69], v6 offset:0
v_mfma_f32_16x16x32_bf16 v[172:175], v[120:123], v[88:91], v[172:175]
ds_read_b64_tr_b16 v[70:71], v6 offset:512
v_mfma_f32_16x16x32_bf16 v[208:211], v[124:127], v[88:91], v[208:211]
ds_read_b128 v[36:39], v2 offset:2048
v_mfma_f32_16x16x32_bf16 v[136:139], v[116:119], v[88:91], v[136:139]
ds_read_b128 v[40:43], v2 offset:4096
v_mfma_f32_16x16x32_bf16 v[176:179], v[120:123], v[92:95], v[176:179]
ds_read_b128 v[44:47], v2 offset:6144
v_mfma_f32_16x16x32_bf16 v[212:215], v[124:127], v[92:95], v[212:215]
ds_read_b128 v[48:51], v2 offset:8192
v_mfma_f32_16x16x32_bf16 v[140:143], v[116:119], v[92:95], v[140:143]
ds_read_b128 v[52:55], v2 offset:10240
v_mfma_f32_16x16x32_bf16 v[180:183], v[120:123], v[96:99], v[180:183]
ds_read_b128 v[56:59], v2 offset:12288
v_mfma_f32_16x16x32_bf16 v[216:219], v[124:127], v[96:99], v[216:219]
ds_read_b128 v[60:63], v2 offset:14336
v_mfma_f32_16x16x32_bf16 v[144:147], v[116:119], v[96:99], v[144:147]
ds_read_b128 v[64:67], v2 offset:16384
v_mfma_f32_16x16x32_bf16 v[184:187], v[120:123], v[100:103], v[184:187]
v_mfma_f32_16x16x32_bf16 v[220:223], v[124:127], v[100:103], v[220:223]
v_mfma_f32_16x16x32_bf16 v[148:151], v[116:119], v[100:103], v[148:151]
v_mfma_f32_16x16x32_bf16 v[188:191], v[120:123], v[104:107], v[188:191]
v_mfma_f32_16x16x32_bf16 v[224:227], v[124:127], v[104:107], v[224:227]
v_mfma_f32_16x16x32_bf16 v[152:155], v[116:119], v[104:107], v[152:155]
v_mfma_f32_16x16x32_bf16 v[192:195], v[120:123], v[108:111], v[192:195]
v_mfma_f32_16x16x32_bf16 v[228:231], v[124:127], v[108:111], v[228:231]
v_mfma_f32_16x16x32_bf16 v[156:159], v[116:119], v[108:111], v[156:159]
v_mfma_f32_16x16x32_bf16 v[196:199], v[120:123], v[112:115], v[196:199]
v_mfma_f32_16x16x32_bf16 v[232:235], v[124:127], v[112:115], v[232:235]
v_mfma_f32_16x16x32_bf16 v[160:163], v[116:119], v[112:115], v[160:163]
s_sub_u32 s41, s41, 1
s_cmp_lg_u32 s41, 0
s_cbranch_scc1 Lcl_7
s_waitcnt lgkmcnt(0)
v_mfma_f32_16x16x32_bf16 v[164:167], v[72:75], v[32:35], v[164:167]
ds_read_b128 v[80:83], v3 offset:0
v_mfma_f32_16x16x32_bf16 v[200:203], v[76:79], v[32:35], v[200:203]
ds_read_b64_tr_b16 v[120:121], v6 offset:12288
v_mfma_f32_16x16x32_bf16 v[128:131], v[68:71], v[32:35], v[128:131]
ds_read_b64_tr_b16 v[122:123], v6 offset:12800
v_mfma_f32_16x16x32_bf16 v[168:171], v[72:75], v[36:39], v[168:171]
ds_read_b64_tr_b16 v[124:125], v6 offset:20480
v_mfma_f32_16x16x32_bf16 v[204:207], v[76:79], v[36:39], v[204:207]
ds_read_b64_tr_b16 v[126:127], v6 offset:20992
v_mfma_f32_16x16x32_bf16 v[132:135], v[68:71], v[36:39], v[132:135]
ds_read_b64_tr_b16 v[116:117], v6 offset:4096
v_mfma_f32_16x16x32_bf16 v[172:175], v[72:75], v[40:43], v[172:175]
ds_read_b64_tr_b16 v[118:119], v6 offset:4608
v_mfma_f32_16x16x32_bf16 v[208:211], v[76:79], v[40:43], v[208:211]
ds_read_b128 v[84:87], v3 offset:2048
v_mfma_f32_16x16x32_bf16 v[136:139], v[68:71], v[40:43], v[136:139]
ds_read_b128 v[88:91], v3 offset:4096
v_mfma_f32_16x16x32_bf16 v[176:179], v[72:75], v[44:47], v[176:179]
ds_read_b128 v[92:95], v3 offset:6144
v_mfma_f32_16x16x32_bf16 v[212:215], v[76:79], v[44:47], v[212:215]
ds_read_b128 v[96:99], v3 offset:8192
v_mfma_f32_16x16x32_bf16 v[140:143], v[68:71], v[44:47], v[140:143]
ds_read_b128 v[100:103], v3 offset:10240
v_mfma_f32_16x16x32_bf16 v[180:183], v[72:75], v[48:51], v[180:183]
ds_read_b128 v[104:107], v3 offset:12288
v_mfma_f32_16x16x32_bf16 v[216:219], v[76:79], v[48:51], v[216:219]
ds_read_b128 v[108:111], v3 offset:14336
v_mfma_f32_16x16x32_bf16 v[144:147], v[68:71], v[48:51], v[144:147]
ds_read_b128 v[112:115], v3 offset:16384
v_mfma_f32_16x16x32_bf16 v[184:187], v[72:75], v[52:55], v[184:187]
v_mfma_f32_16x16x32_bf16 v[220:223], v[76:79], v[52:55], v[220:223]
v_mfma_f32_16x16x32_bf16 v[148:151], v[68:71], v[52:55], v[148:151]
v_mfma_f32_16x16x32_bf16 v[188:191], v[72:75], v[56:59], v[188:191]
v_mfma_f32_16x16x32_bf16 v[224:227], v[76:79], v[56:59], v[224:227]
v_mfma_f32_16x16x32_bf16 v[152:155], v[68:71], v[56:59], v[152:155]
v_mfma_f32_16x16x32_bf16 v[192:195], v[72:75], v[60:63], v[192:195]
v_mfma_f32_16x16x32_bf16 v[228:231], v[76:79], v[60:63], v[228:231]
s_sub_u32 s42, s42, 1
s_cbranch_scc1 Lxr_14
Lxb_15:
v_mfma_f32_16x16x32_bf16 v[156:159], v[68:71], v[60:63], v[156:159]
v_mfma_f32_16x16x32_bf16 v[196:199], v[72:75], v[64:67], v[196:199]
v_mfma_f32_16x16x32_bf16 v[232:235], v[76:79], v[64:67], v[232:235]
v_mfma_f32_16x16x32_bf16 v[160:163], v[68:71], v[64:67], v[160:163]
s_waitcnt lgkmcnt(0)
s_barrier
v_mfma_f32_16x16x32_bf16 v[164:167], v[120:123], v[80:83], v[164:167]
ds_read_b64 v[32:33], v9 offset:0
v_mfma_f32_16x16x32_bf16 v[200:203], v[124:127], v[80:83], v[200:203]
ds_read_b64 v[34:35], v9 offset:128
v_mfma_f32_16x16x32_bf16 v[128:131], v[116:119], v[80:83], v[128:131]
ds_read_b64 v[36:37], v9 offset:256
v_mfma_f32_16x16x32_bf16 v[168:171], v[120:123], v[84:87], v[168:171]
ds_read_b64 v[38:39], v9 offset:384
v_mfma_f32_16x16x32_bf16 v[204:207], v[124:127], v[84:87], v[204:207]
ds_read_b64 v[40:41], v9 offset:512
v_mfma_f32_16x16x32_bf16 v[132:135], v[116:119], v[84:87], v[132:135]
ds_read_b64 v[42:43], v9 offset:640
v_mfma_f32_16x16x32_bf16 v[172:175], v[120:123], v[88:91], v[172:175]
ds_read_b64 v[44:45], v9 offset:768
v_mfma_f32_16x16x32_bf16 v[208:211], v[124:127], v[88:91], v[208:211]
ds_read_b64 v[46:47], v9 offset:896
v_mfma_f32_16x16x32_bf16 v[136:139], v[116:119], v[88:91], v[136:139]
ds_read_b64 v[48:49], v9 offset:1024
v_mfma_f32_16x16x32_bf16 v[176:179], v[120:123], v[92:95], v[176:179]
v_mov_b32_dpp v52, v128 row_newbcast:0 row_mask:0xf bank_mask:0xf
v_mov_b32_dpp v53, v129 row_newbcast:0 row_mask:0xf bank_mask:0xf
v_mfma_f32_16x16x32_bf16 v[212:215], v[124:127], v[92:95], v[212:215]
v_mov_b32_dpp v54, v130 row_newbcast:0 row_mask:0xf bank_mask:0xf
v_mov_b32_dpp v55, v131 row_newbcast:0 row_mask:0xf bank_mask:0xf
v_mfma_f32_16x16x32_bf16 v[140:143], v[116:119], v[92:95], v[140:143]
v_mov_b32_dpp v56, v164 row_newbcast:0 row_mask:0xf bank_mask:0xf
v_mov_b32_dpp v57, v165 row_newbcast:0 row_mask:0xf bank_mask:0xf
v_mfma_f32_16x16x32_bf16 v[180:183], v[120:123], v[96:99], v[180:183]
v_mov_b32_dpp v58, v166 row_newbcast:0 row_mask:0xf bank_mask:0xf
v_mov_b32_dpp v59, v167 row_newbcast:0 row_mask:0xf bank_mask:0xf
v_mfma_f32_16x16x32_bf16 v[216:219], v[124:127], v[96:99], v[216:219]
v_mov_b32_dpp v60, v200 row_newbcast:0 row_mask:0xf bank_mask:0xf
v_mov_b32_dpp v61, v201 row_newbcast:0 row_mask:0xf bank_mask:0xf
v_mfma_f32_16x16x32_bf16 v[144:147], v[116:119], v[96:99], v[144:147]
v_mov_b32_dpp v62, v202 row_newbcast:0 row_mask:0xf bank_mask:0xf
v_mov_b32_dpp v63, v203 row_newbcast:0 row_mask:0xf bank_mask:0xf
v_mfma_f32_16x16x32_bf16 v[184:187], v[120:123], v[100:103], v[184:187]
s_waitcnt lgkmcnt(0)
v_fma_f32 v164, -v32, v56, v164
v_mfma_f32_16x16x32_bf16 v[220:223], v[124:127], v[100:103], v[220:223]
v_fma_f32 v165, -v32, v57, v165
v_fma_f32 v166, -v32, v58, v166
v_mfma_f32_16x16x32_bf16 v[148:151], v[116:119], v[100:103], v[148:151]
v_fma_f32 v167, -v32, v59, v167
v_mul_f32 v164, v33, v164
v_mfma_f32_16x16x32_bf16 v[188:191], v[120:123], v[104:107], v[188:191]
v_mul_f32 v165, v33, v165
v_mul_f32 v166, v33, v166
v_mfma_f32_16x16x32_bf16 v[224:227], v[124:127], v[104:107], v[224:227]
v_mul_f32 v167, v33, v167
v_cvt_pk_bf16_f32 v164, v164, v165
v_mfma_f32_16x16x32_bf16 v[152:155], v[116:119], v[104:107], v[152:155]
v_cvt_pk_bf16_f32 v165, v166, v167
ds_write_b64 v14, v[164:165] offset:128
v_mfma_f32_16x16x32_bf16 v[192:195], v[120:123], v[108:111], v[192:195]
v_fma_f32 v200, -v32, v60, v200
v_fma_f32 v201, -v32, v61, v201
v_mfma_f32_16x16x32_bf16 v[228:231], v[124:127], v[108:111], v[228:231]
v_fma_f32 v202, -v32, v62, v202
v_fma_f32 v203, -v32, v63, v203
v_mfma_f32_16x16x32_bf16 v[156:159], v[116:119], v[108:111], v[156:159]
v_mul_f32 v200, v33, v200
v_mul_f32 v201, v33, v201
v_mfma_f32_16x16x32_bf16 v[196:199], v[120:123], v[112:115], v[196:199]
v_mul_f32 v202, v33, v202
v_mul_f32 v203, v33, v203
v_mfma_f32_16x16x32_bf16 v[232:235], v[124:127], v[112:115], v[232:235]
v_cvt_pk_bf16_f32 v200, v200, v201
v_cvt_pk_bf16_f32 v201, v202, v203
v_mfma_f32_16x16x32_bf16 v[160:163], v[116:119], v[112:115], v[160:163]
ds_write_b64 v14, v[200:201] offset:256
v_fma_f32 v132, -v34, v52, v132
v_fma_f32 v133, -v34, v53, v133
v_fma_f32 v134, -v34, v54, v134
v_fma_f32 v135, -v34, v55, v135
v_mul_f32 v132, v35, v132
v_mul_f32 v133, v35, v133
v_mul_f32 v134, v35, v134
v_mul_f32 v135, v35, v135
v_cvt_pk_bf16_f32 v132, v132, v133
v_cvt_pk_bf16_f32 v133, v134, v135
ds_write_b64 v14, v[132:133] offset:6400
v_pk_fma_f32 v[168:169], v[34:35], v[56:57], v[168:169] op_sel_hi:[0,1,1] neg_lo:[1,0,0] neg_hi:[1,0,0]
v_pk_fma_f32 v[170:171], v[34:35], v[58:59], v[170:171] op_sel_hi:[0,1,1] neg_lo:[1,0,0] neg_hi:[1,0,0]
v_pk_mul_f32 v[168:169], v[34:35], v[168:169] op_sel:[1,0] op_sel_hi:[1,1]
v_pk_mul_f32 v[170:171], v[34:35], v[170:171] op_sel:[1,0] op_sel_hi:[1,1]
v_cvt_pk_bf16_f32 v168, v168, v169
v_cvt_pk_bf16_f32 v169, v170, v171
ds_write_b64 v14, v[168:169] offset:6528
v_pk_fma_f32 v[204:205], v[34:35], v[60:61], v[204:205] op_sel_hi:[0,1,1] neg_lo:[1,0,0] neg_hi:[1,0,0]
v_pk_fma_f32 v[206:207], v[34:35], v[62:63], v[206:207] op_sel_hi:[0,1,1] neg_lo:[1,0,0] neg_hi:[1,0,0]
v_pk_mul_f32 v[204:205], v[34:35], v[204:205] op_sel:[1,0] op_sel_hi:[1,1]
v_pk_mul_f32 v[206:207], v[34:35], v[206:207] op_sel:[1,0] op_sel_hi:[1,1]
v_cvt_pk_bf16_f32 v204, v204, v205
v_cvt_pk_bf16_f32 v205, v206, v207
ds_write_b64 v14, v[204:205] offset:6656
v_pk_fma_f32 v[136:137], v[36:37], v[52:53], v[136:137] op_sel_hi:[0,1,1] neg_lo:[1,0,0] neg_hi:[1,0,0]
v_pk_fma_f32 v[138:139], v[36:37], v[54:55], v[138:139] op_sel_hi:[0,1,1] neg_lo:[1,0,0] neg_hi:[1,0,0]
v_pk_mul_f32 v[136:137], v[36:37], v[136:137] op_sel:[1,0] op_sel_hi:[1,1]
v_pk_mul_f32 v[138:139], v[36:37], v[138:139] op_sel:[1,0] op_sel_hi:[1,1]
v_cvt_pk_bf16_f32 v136, v136, v137
v_cvt_pk_bf16_f32 v137, v138, v139
ds_write_b64 v14, v[136:137] offset:12800
v_pk_fma_f32 v[172:173], v[36:37], v[56:57], v[172:173] op_sel_hi:[0,1,1] neg_lo:[1,0,0] neg_hi:[1,0,0]
v_pk_fma_f32 v[174:175], v[36:37], v[58:59], v[174:175] op_sel_hi:[0,1,1] neg_lo:[1,0,0] neg_hi:[1,0,0]
v_pk_mul_f32 v[172:173], v[36:37], v[172:173] op_sel:[1,0] op_sel_hi:[1,1]
v_pk_mul_f32 v[174:175], v[36:37], v[174:175] op_sel:[1,0] op_sel_hi:[1,1]
v_cvt_pk_bf16_f32 v172, v172, v173
v_cvt_pk_bf16_f32 v173, v174, v175
ds_write_b64 v14, v[172:173] offset:12928
v_pk_fma_f32 v[208:209], v[36:37], v[60:61], v[208:209] op_sel_hi:[0,1,1] neg_lo:[1,0,0] neg_hi:[1,0,0]
v_pk_fma_f32 v[210:211], v[36:37], v[62:63], v[210:211] op_sel_hi:[0,1,1] neg_lo:[1,0,0] neg_hi:[1,0,0]
v_pk_mul_f32 v[208:209], v[36:37], v[208:209] op_sel:[1,0] op_sel_hi:[1,1]
v_pk_mul_f32 v[210:211], v[36:37], v[210:211] op_sel:[1,0] op_sel_hi:[1,1]
v_cvt_pk_bf16_f32 v208, v208, v209
v_cvt_pk_bf16_f32 v209, v210, v211
ds_write_b64 v14, v[208:209] offset:13056
v_pk_fma_f32 v[140:141], v[38:39], v[52:53], v[140:141] op_sel_hi:[0,1,1] neg_lo:[1,0,0] neg_hi:[1,0,0]
v_pk_fma_f32 v[142:143], v[38:39], v[54:55], v[142:143] op_sel_hi:[0,1,1] neg_lo:[1,0,0] neg_hi:[1,0,0]
v_pk_mul_f32 v[140:141], v[38:39], v[140:141] op_sel:[1,0] op_sel_hi:[1,1]
v_pk_mul_f32 v[142:143], v[38:39], v[142:143] op_sel:[1,0] op_sel_hi:[1,1]
v_cvt_pk_bf16_f32 v140, v140, v141
v_cvt_pk_bf16_f32 v141, v142, v143
ds_write_b64 v14, v[140:141] offset:19200
v_pk_fma_f32 v[176:177], v[38:39], v[56:57], v[176:177] op_sel_hi:[0,1,1] neg_lo:[1,0,0] neg_hi:[1,0,0]
v_pk_fma_f32 v[178:179], v[38:39], v[58:59], v[178:179] op_sel_hi:[0,1,1] neg_lo:[1,0,0] neg_hi:[1,0,0]
v_pk_mul_f32 v[176:177], v[38:39], v[176:177] op_sel:[1,0] op_sel_hi:[1,1]
v_pk_mul_f32 v[178:179], v[38:39], v[178:179] op_sel:[1,0] op_sel_hi:[1,1]
v_cvt_pk_bf16_f32 v176, v176, v177
v_cvt_pk_bf16_f32 v177, v178, v179
ds_write_b64 v14, v[176:177] offset:19328
v_pk_fma_f32 v[212:213], v[38:39], v[60:61], v[212:213] op_sel_hi:[0,1,1] neg_lo:[1,0,0] neg_hi:[1,0,0]
v_pk_fma_f32 v[214:215], v[38:39], v[62:63], v[214:215] op_sel_hi:[0,1,1] neg_lo:[1,0,0] neg_hi:[1,0,0]
v_pk_mul_f32 v[212:213], v[38:39], v[212:213] op_sel:[1,0] op_sel_hi:[1,1]
v_pk_mul_f32 v[214:215], v[38:39], v[214:215] op_sel:[1,0] op_sel_hi:[1,1]
v_cvt_pk_bf16_f32 v212, v212, v213
v_cvt_pk_bf16_f32 v213, v214, v215
ds_write_b64 v14, v[212:213] offset:19456
v_pk_fma_f32 v[144:145], v[40:41], v[52:53], v[144:145] op_sel_hi:[0,1,1] neg_lo:[1,0,0] neg_hi:[1,0,0]
v_pk_fma_f32 v[146:147], v[40:41], v[54:55], v[146:147] op_sel_hi:[0,1,1] neg_lo:[1,0,0] neg_hi:[1,0,0]
v_pk_mul_f32 v[144:145], v[40:41], v[144:145] op_sel:[1,0] op_sel_hi:[1,1]
v_pk_mul_f32 v[146:147], v[40:41], v[146:147] op_sel:[1,0] op_sel_hi:[1,1]
v_cvt_pk_bf16_f32 v144, v144, v145
v_cvt_pk_bf16_f32 v145, v146, v147
ds_write_b64 v14, v[144:145] offset:25600
v_pk_fma_f32 v[180:181], v[40:41], v[56:57], v[180:181] op_sel_hi:[0,1,1] neg_lo:[1,0,0] neg_hi:[1,0,0]
v_pk_fma_f32 v[182:183], v[40:41], v[58:59], v[182:183] op_sel_hi:[0,1,1] neg_lo:[1,0,0] neg_hi:[1,0,0]
v_pk_mul_f32 v[180:181], v[40:41], v[180:181] op_sel:[1,0] op_sel_hi:[1,1]
v_pk_mul_f32 v[182:183], v[40:41], v[182:183] op_sel:[1,0] op_sel_hi:[1,1]
v_cvt_pk_bf16_f32 v180, v180, v181
v_cvt_pk_bf16_f32 v181, v182, v183
ds_write_b64 v14, v[180:181] offset:25728
v_pk_fma_f32 v[216:217], v[40:41], v[60:61], v[216:217] op_sel_hi:[0,1,1] neg_lo:[1,0,0] neg_hi:[1,0,0]
v_pk_fma_f32 v[218:219], v[40:41], v[62:63], v[218:219] op_sel_hi:[0,1,1] neg_lo:[1,0,0] neg_hi:[1,0,0]
v_pk_mul_f32 v[216:217], v[40:41], v[216:217] op_sel:[1,0] op_sel_hi:[1,1]
v_pk_mul_f32 v[218:219], v[40:41], v[218:219] op_sel:[1,0] op_sel_hi:[1,1]
v_cvt_pk_bf16_f32 v216, v216, v217
v_cvt_pk_bf16_f32 v217, v218, v219
ds_write_b64 v14, v[216:217] offset:25856
s_waitcnt lgkmcnt(0)
s_barrier
v_pk_fma_f32 v[148:149], v[42:43], v[52:53], v[148:149] op_sel_hi:[0,1,1] neg_lo:[1,0,0] neg_hi:[1,0,0]
v_pk_fma_f32 v[150:151], v[42:43], v[54:55], v[150:151] op_sel_hi:[0,1,1] neg_lo:[1,0,0] neg_hi:[1,0,0]
v_pk_mul_f32 v[148:149], v[42:43], v[148:149] op_sel:[1,0] op_sel_hi:[1,1]
v_pk_mul_f32 v[150:151], v[42:43], v[150:151] op_sel:[1,0] op_sel_hi:[1,1]
v_cvt_pk_bf16_f32 v148, v148, v149
v_cvt_pk_bf16_f32 v149, v150, v151
ds_write_b64 v14, v[148:149] offset:32000
v_pk_fma_f32 v[184:185], v[42:43], v[56:57], v[184:185] op_sel_hi:[0,1,1] neg_lo:[1,0,0] neg_hi:[1,0,0]
v_pk_fma_f32 v[186:187], v[42:43], v[58:59], v[186:187] op_sel_hi:[0,1,1] neg_lo:[1,0,0] neg_hi:[1,0,0]
v_pk_mul_f32 v[184:185], v[42:43], v[184:185] op_sel:[1,0] op_sel_hi:[1,1]
v_pk_mul_f32 v[186:187], v[42:43], v[186:187] op_sel:[1,0] op_sel_hi:[1,1]
v_cvt_pk_bf16_f32 v184, v184, v185
v_cvt_pk_bf16_f32 v185, v186, v187
ds_write_b64 v14, v[184:185] offset:32128
v_pk_fma_f32 v[220:221], v[42:43], v[60:61], v[220:221] op_sel_hi:[0,1,1] neg_lo:[1,0,0] neg_hi:[1,0,0]
v_pk_fma_f32 v[222:223], v[42:43], v[62:63], v[222:223] op_sel_hi:[0,1,1] neg_lo:[1,0,0] neg_hi:[1,0,0]
v_pk_mul_f32 v[220:221], v[42:43], v[220:221] op_sel:[1,0] op_sel_hi:[1,1]
v_pk_mul_f32 v[222:223], v[42:43], v[222:223] op_sel:[1,0] op_sel_hi:[1,1]
v_cvt_pk_bf16_f32 v220, v220, v221
v_cvt_pk_bf16_f32 v221, v222, v223
ds_write_b64 v14, v[220:221] offset:32256
v_pk_fma_f32 v[152:153], v[44:45], v[52:53], v[152:153] op_sel_hi:[0,1,1] neg_lo:[1,0,0] neg_hi:[1,0,0]
v_pk_fma_f32 v[154:155], v[44:45], v[54:55], v[154:155] op_sel_hi:[0,1,1] neg_lo:[1,0,0] neg_hi:[1,0,0]
v_pk_mul_f32 v[152:153], v[44:45], v[152:153] op_sel:[1,0] op_sel_hi:[1,1]
v_pk_mul_f32 v[154:155], v[44:45], v[154:155] op_sel:[1,0] op_sel_hi:[1,1]
v_cvt_pk_bf16_f32 v152, v152, v153
v_cvt_pk_bf16_f32 v153, v154, v155
ds_write_b64 v14, v[152:153] offset:38400
v_pk_fma_f32 v[188:189], v[44:45], v[56:57], v[188:189] op_sel_hi:[0,1,1] neg_lo:[1,0,0] neg_hi:[1,0,0]
v_pk_fma_f32 v[190:191], v[44:45], v[58:59], v[190:191] op_sel_hi:[0,1,1] neg_lo:[1,0,0] neg_hi:[1,0,0]
v_pk_mul_f32 v[188:189], v[44:45], v[188:189] op_sel:[1,0] op_sel_hi:[1,1]
v_pk_mul_f32 v[190:191], v[44:45], v[190:191] op_sel:[1,0] op_sel_hi:[1,1]
v_cvt_pk_bf16_f32 v188, v188, v189
v_cvt_pk_bf16_f32 v189, v190, v191
ds_write_b64 v14, v[188:189] offset:38528
v_pk_fma_f32 v[224:225], v[44:45], v[60:61], v[224:225] op_sel_hi:[0,1,1] neg_lo:[1,0,0] neg_hi:[1,0,0]
v_pk_fma_f32 v[226:227], v[44:45], v[62:63], v[226:227] op_sel_hi:[0,1,1] neg_lo:[1,0,0] neg_hi:[1,0,0]
v_pk_mul_f32 v[224:225], v[44:45], v[224:225] op_sel:[1,0] op_sel_hi:[1,1]
v_pk_mul_f32 v[226:227], v[44:45], v[226:227] op_sel:[1,0] op_sel_hi:[1,1]
v_cvt_pk_bf16_f32 v224, v224, v225
v_cvt_pk_bf16_f32 v225, v226, v227
ds_write_b64 v14, v[224:225] offset:38656
v_pk_fma_f32 v[156:157], v[46:47], v[52:53], v[156:157] op_sel_hi:[0,1,1] neg_lo:[1,0,0] neg_hi:[1,0,0]
v_pk_fma_f32 v[158:159], v[46:47], v[54:55], v[158:159] op_sel_hi:[0,1,1] neg_lo:[1,0,0] neg_hi:[1,0,0]
v_pk_mul_f32 v[156:157], v[46:47], v[156:157] op_sel:[1,0] op_sel_hi:[1,1]
v_pk_mul_f32 v[158:159], v[46:47], v[158:159] op_sel:[1,0] op_sel_hi:[1,1]
v_cvt_pk_bf16_f32 v156, v156, v157
v_cvt_pk_bf16_f32 v157, v158, v159
ds_write_b64 v14, v[156:157] offset:44800
v_pk_fma_f32 v[192:193], v[46:47], v[56:57], v[192:193] op_sel_hi:[0,1,1] neg_lo:[1,0,0] neg_hi:[1,0,0]
v_pk_fma_f32 v[194:195], v[46:47], v[58:59], v[194:195] op_sel_hi:[0,1,1] neg_lo:[1,0,0] neg_hi:[1,0,0]
v_pk_mul_f32 v[192:193], v[46:47], v[192:193] op_sel:[1,0] op_sel_hi:[1,1]
v_pk_mul_f32 v[194:195], v[46:47], v[194:195] op_sel:[1,0] op_sel_hi:[1,1]
v_cvt_pk_bf16_f32 v192, v192, v193
v_cvt_pk_bf16_f32 v193, v194, v195
ds_write_b64 v14, v[192:193] offset:44928
v_pk_fma_f32 v[228:229], v[46:47], v[60:61], v[228:229] op_sel_hi:[0,1,1] neg_lo:[1,0,0] neg_hi:[1,0,0]
v_pk_fma_f32 v[230:231], v[46:47], v[62:63], v[230:231] op_sel_hi:[0,1,1] neg_lo:[1,0,0] neg_hi:[1,0,0]
v_pk_mul_f32 v[228:229], v[46:47], v[228:229] op_sel:[1,0] op_sel_hi:[1,1]
v_pk_mul_f32 v[230:231], v[46:47], v[230:231] op_sel:[1,0] op_sel_hi:[1,1]
v_cvt_pk_bf16_f32 v228, v228, v229
v_cvt_pk_bf16_f32 v229, v230, v231
ds_write_b64 v14, v[228:229] offset:45056
v_pk_fma_f32 v[160:161], v[48:49], v[52:53], v[160:161] op_sel_hi:[0,1,1] neg_lo:[1,0,0] neg_hi:[1,0,0]
v_pk_fma_f32 v[162:163], v[48:49], v[54:55], v[162:163] op_sel_hi:[0,1,1] neg_lo:[1,0,0] neg_hi:[1,0,0]
v_pk_mul_f32 v[160:161], v[48:49], v[160:161] op_sel:[1,0] op_sel_hi:[1,1]
v_pk_mul_f32 v[162:163], v[48:49], v[162:163] op_sel:[1,0] op_sel_hi:[1,1]
v_cvt_pk_bf16_f32 v160, v160, v161
v_cvt_pk_bf16_f32 v161, v162, v163
ds_write_b64 v14, v[160:161] offset:51200
v_pk_fma_f32 v[196:197], v[48:49], v[56:57], v[196:197] op_sel_hi:[0,1,1] neg_lo:[1,0,0] neg_hi:[1,0,0]
v_pk_fma_f32 v[198:199], v[48:49], v[58:59], v[198:199] op_sel_hi:[0,1,1] neg_lo:[1,0,0] neg_hi:[1,0,0]
v_pk_mul_f32 v[196:197], v[48:49], v[196:197] op_sel:[1,0] op_sel_hi:[1,1]
v_pk_mul_f32 v[198:199], v[48:49], v[198:199] op_sel:[1,0] op_sel_hi:[1,1]
v_cvt_pk_bf16_f32 v196, v196, v197
v_cvt_pk_bf16_f32 v197, v198, v199
ds_write_b64 v14, v[196:197] offset:51328
v_pk_fma_f32 v[232:233], v[48:49], v[60:61], v[232:233] op_sel_hi:[0,1,1] neg_lo:[1,0,0] neg_hi:[1,0,0]
v_pk_fma_f32 v[234:235], v[48:49], v[62:63], v[234:235] op_sel_hi:[0,1,1] neg_lo:[1,0,0] neg_hi:[1,0,0]
v_pk_mul_f32 v[232:233], v[48:49], v[232:233] op_sel:[1,0] op_sel_hi:[1,1]
v_pk_mul_f32 v[234:235], v[48:49], v[234:235] op_sel:[1,0] op_sel_hi:[1,1]
v_cvt_pk_bf16_f32 v232, v232, v233
v_cvt_pk_bf16_f32 v233, v234, v235
ds_write_b64 v14, v[232:233] offset:51456
s_waitcnt lgkmcnt(0)
s_branch Latt_4
Lpf_3:
s_load_dwordx2 s[26:27], s[0:1], 64
s_or_b32 s43, s34, s35
s_cmp_lg_u32 s43, 0
s_cbranch_scc1 Lz_26
s_add_u32 s84, s32, 28311552
s_addc_u32 s85, s33, 0
s_mov_b32 s86, 40960
s_mov_b32 s87, 0x20000
v_lshlrev_b32 v14, 7, v1
v_mov_b32 v36, 0
v_mov_b32 v37, 0
s_mov_b32 s43, 0
buffer_store_dwordx2 v[36:37], v14, s[84:87], s43 offen sc1
s_mov_b32 s43, 8192
buffer_store_dwordx2 v[36:37], v14, s[84:87], s43 offen sc1
s_mov_b32 s43, 16384
buffer_store_dwordx2 v[36:37], v14, s[84:87], s43 offen sc1
s_mov_b32 s43, 24576
buffer_store_dwordx2 v[36:37], v14, s[84:87], s43 offen sc1
s_mov_b32 s43, 32768
buffer_store_dwordx2 v[36:37], v14, s[84:87], s43 offen sc1
Lz_26:
s_lshl_b32 s43, s51, 11
buffer_load_dwordx4 v[96:99], v10, s[8:11], s43 offen offset:0
buffer_load_dwordx4 v[100:103], v10, s[8:11], s43 offen offset:1024
buffer_load_dwordx4 v[104:107], v10, s[8:11], s43 offen offset:2048
buffer_load_dwordx4 v[108:111], v10, s[8:11], s43 offen offset:3072
v_min_u32 v14, 23, v1
v_lshrrev_b32 v15, 3, v14
v_mul_u32_u24 v15, 43008, v15
v_and_b32 v14, 7, v14
v_lshl_add_u32 v15, v14, 4, v15
v_mov_b32 v32, 0x3f803f80
v_mov_b32 v33, 0x3f803f80
v_mov_b32 v34, 0x3f803f80
v_mov_b32 v35, 0x3f803f80
ds_write_b128 v15, v[32:35]
v_add_u32 v14, 0, v1
v_min_u32 v14, 47, v14
v_mul_u32_u24 v15, 21846, v14
v_lshrrev_b32 v15, 16, v15
v_mul_u32_u24 v16, 3, v15
v_sub_u32 v16, v14, v16
s_mul_i32 s43, s48, 16
v_add_u32 v15, s43, v15
v_mul_u32_u24 v15, 6144, v15
v_lshl_add_u32 v2, v16, 11, v15
s_waitcnt lgkmcnt(0)
s_mov_b32 s56, s26
s_mov_b32 s57, s27
s_mov_b32 s58, 256
s_mov_b32 s59, 0x20000
v_lshlrev_b32 v14, 7, v1
s_barrier
s_cmp_ge_u32 s2, 128
s_cbranch_scc1 Lm_28
s_lshr_b32 s44, s2, 4
s_cmp_eq_u32 s44, 2
s_cbranch_scc1 Lm_28
s_lshr_b32 s44, s2, 5
s_cmp_eq_u32 s44, 3
s_cbranch_scc1 Lm_28
s_mov_b32 s84, s6
s_mov_b32 s85, s7
s_mov_b32 s86, 6291456
s_mov_b32 s87, 0x20000
s_cmp_lt_u32 s2, 32
s_cselect_b32 s43, 96, 0
s_add_u32 s43, s43, s2
s_mul_i32 s43, s43, 24576
buffer_load_dword v31, v14, s[84:87], s43 offen
s_add_u32 s43, s43, 8192
buffer_load_dword v31, v14, s[84:87], s43 offen
s_add_u32 s43, s43, 8192
buffer_load_dword v31, v14, s[84:87], s43 offen
Lm_28:
s_mov_b32 s84, s6
s_mov_b32 s85, s7
s_mov_b32 s86, 6291456
s_mov_b32 s87, 0x20000
s_lshr_b32 s44, s2, 3
s_lshr_b32 s43, s2, 5
s_cmp_eq_u32 s43, 3
s_cbranch_scc1 Lsj_29
s_cmp_gt_u32 s43, 3
s_cselect_b32 s43, 32, 0
s_sub_u32 s43, s2, s43
s_lshr_b32 s43, s43, 1
s_and_b32 s44, s2, 1
s_lshl_b32 s44, s44, 3
s_add_u32 s44, s44, 32
s_load_dwordx2 s[80:81], s[0:1], s44
s_mul_i32 s45, s43, 2341
s_lshr_b32 s45, s45, 16
s_mul_i32 s46, s45, 28
s_sub_u32 s46, s43, s46
s_lshl_b32 s45, s45, 8
s_mul_i32 s44, s47, 18
s_add_u32 s45, s45, s44
s_add_u32 s45, s45, 184
s_mul_i32 s45, s45, 7168
s_lshl_b32 s46, s46, 8
s_add_u32 s45, s45, s46
s_waitcnt lgkmcnt(0)
s_add_u32 s80, s80, s45
s_addc_u32 s81, s81, 0
Lsj_29:
s_barrier
s_cmp_ge_u32 s2, 128
s_cbranch_scc0 Lm_30
s_mov_b32 s84, s6
s_mov_b32 s85, s7
s_mov_b32 s86, 6291456
s_mov_b32 s87, 0x20000
s_cmp_lt_u32 s2, 32
s_cselect_b32 s43, 96, 0
s_add_u32 s43, s43, s2
s_mul_i32 s43, s43, 24576
buffer_load_dword v31, v14, s[84:87], s43 offen
s_add_u32 s43, s43, 8192
buffer_load_dword v31, v14, s[84:87], s43 offen
s_add_u32 s43, s43, 8192
buffer_load_dword v31, v14, s[84:87], s43 offen
Lm_30:
s_barrier
s_getpc_b64 s[88:89]
Lpc_31:
s_sub_u32 s88, s88, Lpc_31-sequential_preLN__sliding_local_dilated__glu_gated_geglu__prompt_kernel
s_subb_u32 s89, s89, 0
s_lshr_b32 s43, s2, 3
s_mul_i32 s43, s43, 3840
v_min_u32 v15, 29, v1
v_lshl_add_u32 v15, v15, 7, s43
v_min_u32 v15, Ldone_1-sequential_preLN__sliding_local_dilated__glu_gated_geglu__prompt_kernel, v15
global_load_dword v31, v15, s[88:89]
s_or_b32 s43, s34, s35
s_cmp_lg_u32 s43, 0
s_cbranch_scc1 Lz_32
s_waitcnt vmcnt(0)
v_mov_b32 v5, 1
v_mov_b32 v6, 0
s_mov_b64 exec, 1
buffer_store_dword v5, v6, s[56:59], 0 offen sc1
s_mov_b64 exec, -1
Lz_32:
s_waitcnt vmcnt(1)
v_lshlrev_b32 v116, 16, v96
v_and_b32 v117, 0xffff0000, v96
v_mul_f32 v118, v116, v116
v_mul_f32 v119, v117, v117
v_lshlrev_b32 v126, 16, v97
v_and_b32 v127, 0xffff0000, v97
v_add_f32 v116, v116, v126
v_add_f32 v117, v117, v127
v_fmac_f32 v118, v126, v126
v_fmac_f32 v119, v127, v127
v_lshlrev_b32 v124, 16, v98
v_and_b32 v125, 0xffff0000, v98
v_add_f32 v116, v116, v124
v_add_f32 v117, v117, v125
v_fmac_f32 v118, v124, v124
v_fmac_f32 v119, v125, v125
v_lshlrev_b32 v126, 16, v99
v_and_b32 v127, 0xffff0000, v99
v_add_f32 v116, v116, v126
v_add_f32 v117, v117, v127
v_fmac_f32 v118, v126, v126
v_fmac_f32 v119, v127, v127
v_lshlrev_b32 v124, 16, v100
v_and_b32 v125, 0xffff0000, v100
v_add_f32 v116, v116, v124
v_add_f32 v117, v117, v125
v_fmac_f32 v118, v124, v124
v_fmac_f32 v119, v125, v125
v_lshlrev_b32 v126, 16, v101
v_and_b32 v127, 0xffff0000, v101
v_add_f32 v116, v116, v126
v_add_f32 v117, v117, v127
v_fmac_f32 v118, v126, v126
v_fmac_f32 v119, v127, v127
v_lshlrev_b32 v124, 16, v102
v_and_b32 v125, 0xffff0000, v102
v_add_f32 v116, v116, v124
v_add_f32 v117, v117, v125
v_fmac_f32 v118, v124, v124
v_fmac_f32 v119, v125, v125
v_lshlrev_b32 v126, 16, v103
v_and_b32 v127, 0xffff0000, v103
v_add_f32 v116, v116, v126
v_add_f32 v117, v117, v127
v_fmac_f32 v118, v126, v126
v_fmac_f32 v119, v127, v127
v_lshlrev_b32 v120, 16, v104
v_and_b32 v121, 0xffff0000, v104
v_mul_f32 v122, v120, v120
v_mul_f32 v123, v121, v121
s_barrier
s_cmp_lt_u32 s2, 128
s_cbranch_scc1 Lm_33
s_mov_b32 s84, s6
s_mov_b32 s85, s7
s_mov_b32 s86, 6291456
s_mov_b32 s87, 0x20000
s_lshr_b32 s44, s2, 3
s_and_b32 s43, s35, 8
s_or_b32 s43, s43, 3
s_lshl_b32 s43, s43, 7
s_mul_i32 s45, s44, 196608
s_add_u32 s43, s43, s45
v_add_u32 v15, 0, v1
v_min_u32 v15, 95, v15
v_mul_u32_u24 v16, 21846, v15
v_lshrrev_b32 v16, 16, v16
v_mul_u32_u24 v17, 3, v16
v_sub_u32 v15, v15, v17
v_mul_u32_u24 v16, 6144, v16
v_lshl_add_u32 v15, v15, 11, v16
buffer_load_dword v31, v15, s[84:87], s43 offen
v_add_u32 v15, 64, v1
v_min_u32 v15, 95, v15
v_mul_u32_u24 v16, 21846, v15
v_lshrrev_b32 v16, 16, v16
v_mul_u32_u24 v17, 3, v16
v_sub_u32 v15, v15, v17
v_mul_u32_u24 v16, 6144, v16
v_lshl_add_u32 v15, v15, 11, v16
buffer_load_dword v31, v15, s[84:87], s43 offen
Lm_33:
v_lshlrev_b32 v126, 16, v105
v_and_b32 v127, 0xffff0000, v105
v_add_f32 v120, v120, v126
v_add_f32 v121, v121, v127
v_fmac_f32 v122, v126, v126
v_fmac_f32 v123, v127, v127
v_lshlrev_b32 v124, 16, v106
v_and_b32 v125, 0xffff0000, v106
v_add_f32 v120, v120, v124
v_add_f32 v121, v121, v125
v_fmac_f32 v122, v124, v124
v_fmac_f32 v123, v125, v125
v_lshlrev_b32 v126, 16, v107
v_and_b32 v127, 0xffff0000, v107
v_add_f32 v120, v120, v126
v_add_f32 v121, v121, v127
v_fmac_f32 v122, v126, v126
v_fmac_f32 v123, v127, v127
v_lshlrev_b32 v124, 16, v108
v_and_b32 v125, 0xffff0000, v108
v_add_f32 v120, v120, v124
v_add_f32 v121, v121, v125
v_fmac_f32 v122, v124, v124
v_fmac_f32 v123, v125, v125
v_lshlrev_b32 v126, 16, v109
v_and_b32 v127, 0xffff0000, v109
v_add_f32 v120, v120, v126
v_add_f32 v121, v121, v127
v_fmac_f32 v122, v126, v126
v_fmac_f32 v123, v127, v127
v_lshlrev_b32 v124, 16, v110
v_and_b32 v125, 0xffff0000, v110
v_add_f32 v120, v120, v124
v_add_f32 v121, v121, v125
v_fmac_f32 v122, v124, v124
v_fmac_f32 v123, v125, v125
v_lshlrev_b32 v126, 16, v111
v_and_b32 v127, 0xffff0000, v111
v_add_f32 v120, v120, v126
v_add_f32 v121, v121, v127
v_fmac_f32 v122, v126, v126
v_fmac_f32 v123, v127, v127
v_add_f32 v116, v116, v117
v_add_f32 v118, v118, v119
v_add_f32 v120, v120, v121
v_add_f32 v122, v122, v123
v_add_f32_dpp v116, v116, v116 row_ror:8 row_mask:0xf bank_mask:0xf
v_add_f32_dpp v118, v118, v118 row_ror:8 row_mask:0xf bank_mask:0xf
v_add_f32_dpp v120, v120, v120 row_ror:8 row_mask:0xf bank_mask:0xf
v_add_f32_dpp v122, v122, v122 row_ror:8 row_mask:0xf bank_mask:0xf
s_barrier
v_add_f32_dpp v116, v116, v116 row_ror:4 row_mask:0xf bank_mask:0xf
v_add_f32_dpp v118, v118, v118 row_ror:4 row_mask:0xf bank_mask:0xf
v_add_f32_dpp v120, v120, v120 row_ror:4 row_mask:0xf bank_mask:0xf
v_add_f32_dpp v122, v122, v122 row_ror:4 row_mask:0xf bank_mask:0xf
v_add_f32_dpp v116, v116, v116 row_ror:2 row_mask:0xf bank_mask:0xf
v_add_f32_dpp v118, v118, v118 row_ror:2 row_mask:0xf bank_mask:0xf
v_add_f32_dpp v120, v120, v120 row_ror:2 row_mask:0xf bank_mask:0xf
v_add_f32_dpp v122, v122, v122 row_ror:2 row_mask:0xf bank_mask:0xf
v_add_f32_dpp v116, v116, v116 row_ror:1 row_mask:0xf bank_mask:0xf
v_add_f32_dpp v118, v118, v118 row_ror:1 row_mask:0xf bank_mask:0xf
v_add_f32_dpp v120, v120, v120 row_ror:1 row_mask:0xf bank_mask:0xf
v_add_f32_dpp v122, v122, v122 row_ror:1 row_mask:0xf bank_mask:0xf
v_mov_b32 v117, v116
v_mov_b32 v119, v118
v_mov_b32 v121, v120
v_mov_b32 v123, v122
s_nop 0
v_permlane16_swap_b32 v116, v117
v_permlane16_swap_b32 v118, v119
v_permlane16_swap_b32 v120, v121
v_permlane16_swap_b32 v122, v123
v_add_f32 v116, v116, v117
v_add_f32 v118, v118, v119
v_add_f32 v120, v120, v121
v_add_f32 v122, v122, v123
v_mov_b32 v117, v116
v_mov_b32 v119, v118
v_mov_b32 v121, v120
v_mov_b32 v123, v122
s_nop 0
v_permlane32_swap_b32 v116, v117
v_permlane32_swap_b32 v118, v119
v_permlane32_swap_b32 v120, v121
v_permlane32_swap_b32 v122, v123
v_add_f32 v116, v116, v117
v_add_f32 v118, v118, v119
v_add_f32 v120, v120, v121
v_add_f32 v122, v122, v123
v_mul_f32 v112, 0x3a800000, v116
v_mul_f32 v113, 0x3a800000, v118
v_fma_f32 v113, -v112, v112, v113
v_max_f32 v113, 0, v113
v_add_f32 v113, 0x3727c5ac, v113
v_rsq_f32 v113, v113
v_mul_f32 v114, 0x3a800000, v120
v_mul_f32 v115, 0x3a800000, v122
v_fma_f32 v115, -v114, v114, v115
v_max_f32 v115, 0, v115
v_add_f32 v115, 0x3727c5ac, v115
v_rsq_f32 v115, v115
s_nop 0
s_lshl_b32 s43, s47, 4
s_add_u32 s43, s43, 130176
v_mov_b32 v11, s43
ds_write_b128 v11, v[112:115]
s_waitcnt lgkmcnt(0)
s_barrier
v_lshlrev_b32 v5, 4, v1
v_and_b32 v5, 63, v5
v_add_u32 v6, 130176, v5
ds_read_b128 v[112:115], v6
s_lshl_b32 s43, s63, 3
v_add_u32 v5, s43, v5
s_waitcnt lgkmcnt(0)
s_mov_b64 exec, 15
buffer_store_dwordx4 v[112:115], v5, s[20:23], 0 offen sc1
s_mov_b64 exec, -1
s_load_dword s64, s[80:81], 0
s_load_dword s65, s[80:81], 64
s_load_dword s66, s[80:81], 128
s_load_dword s67, s[80:81], 192
s_load_dword s68, s[80:81], 7168
s_load_dword s69, s[80:81], 7232
s_load_dword s70, s[80:81], 7296
s_load_dword s71, s[80:81], 7360
s_add_u32 s80, s80, 14336
s_addc_u32 s81, s81, 0
s_barrier
v_mov_b32 v7, 0
v_mov_b32 v9, 1
buffer_load_dword v8, v7, s[56:59], 0 offen sc1
s_load_dword s64, s[80:81], 0
s_load_dword s65, s[80:81], 64
s_load_dword s66, s[80:81], 128
s_load_dword s67, s[80:81], 192
s_load_dword s68, s[80:81], 7168
s_load_dword s69, s[80:81], 7232
s_load_dword s70, s[80:81], 7296
s_load_dword s71, s[80:81], 7360
s_add_u32 s80, s80, 14336
s_addc_u32 s81, s81, 0
s_barrier
s_load_dword s64, s[80:81], 0
s_load_dword s65, s[80:81], 64
s_load_dword s66, s[80:81], 128
s_load_dword s67, s[80:81], 192
s_load_dword s68, s[80:81], 7168
s_load_dword s69, s[80:81], 7232
s_load_dword s70, s[80:81], 7296
s_load_dword s71, s[80:81], 7360
s_add_u32 s80, s80, 14336
s_addc_u32 s81, s81, 0
s_barrier
s_mov_b32 s41, 0x10000
Lpoll_34:
s_waitcnt vmcnt(0)
Lpf_36:
v_cmp_ne_u32 vcc, v9, v8
s_nop 4
s_cbranch_vccz Lpok_35
buffer_load_dword v8, v7, s[56:59], 0 offen sc1
s_sub_u32 s41, s41, 1
s_cmp_lg_u32 s41, 0
s_cbranch_scc1 Lpoll_34
s_waitcnt vmcnt(0)
Lpok_35:
s_add_u32 s56, s32, 28311552
s_addc_u32 s57, s33, 0
s_mov_b32 s58, 40960
s_mov_b32 s59, 0x20000
s_add_u32 s43, s34, 80
s_lshl_b32 s43, s43, 7
v_mov_b32 v5, s43
v_mov_b32 v6, 1
s_mov_b64 exec, 1
buffer_atomic_add v6, v5, s[56:59], 0 offen sc1
s_mov_b64 exec, -1
s_load_dword s64, s[80:81], 0
s_load_dword s65, s[80:81], 64
s_load_dword s66, s[80:81], 128
s_load_dword s67, s[80:81], 192
s_load_dword s68, s[80:81], 7168
s_load_dword s69, s[80:81], 7232
s_load_dword s70, s[80:81], 7296
s_load_dword s71, s[80:81], 7360
s_add_u32 s80, s80, 14336
s_addc_u32 s81, s81, 0
s_barrier
s_load_dword s64, s[80:81], 0
s_load_dword s65, s[80:81], 64
s_load_dword s66, s[80:81], 128
s_load_dword s67, s[80:81], 192
s_load_dword s68, s[80:81], 7168
s_load_dword s69, s[80:81], 7232
s_load_dword s70, s[80:81], 7296
s_load_dword s71, s[80:81], 7360
s_add_u32 s80, s80, 14336
s_addc_u32 s81, s81, 0
s_barrier
s_getpc_b64 s[88:89]
Lpc_37:
s_sub_u32 s88, s88, Lpc_37-sequential_preLN__sliding_local_dilated__glu_gated_geglu__prompt_kernel
s_subb_u32 s89, s89, 0
s_lshr_b32 s43, s2, 3
s_mul_i32 s43, s43, 3840
v_min_u32 v15, 29, v1
v_lshl_add_u32 v15, v15, 7, s43
v_min_u32 v15, Ldone_1-sequential_preLN__sliding_local_dilated__glu_gated_geglu__prompt_kernel, v15
global_load_dword v31, v15, s[88:89]
s_sub_u32 s44, s34, 1
s_max_i32 s44, s44, 0
v_mov_b32 v5, s44
v_mov_b32 v6, s34
v_cmp_eq_u32 vcc, 0, v1
s_nop 1
v_cndmask_b32 v5, v5, v6, vcc
v_add_u32 v5, 80, v5
v_lshlrev_b32 v5, 7, v5
buffer_load_dword v6, v5, s[56:59], 0 offen sc1
s_load_dword s64, s[80:81], 0
s_load_dword s65, s[80:81], 64
s_load_dword s66, s[80:81], 128
s_load_dword s67, s[80:81], 192
s_load_dword s68, s[80:81], 7168
s_load_dword s69, s[80:81], 7232
s_load_dword s70, s[80:81], 7296
s_load_dword s71, s[80:81], 7360
s_add_u32 s80, s80, 14336
s_addc_u32 s81, s81, 0
s_barrier
s_load_dword s64, s[80:81], 0
s_load_dword s65, s[80:81], 64
s_load_dword s66, s[80:81], 128
s_load_dword s67, s[80:81], 192
s_load_dword s68, s[80:81], 7168
s_load_dword s69, s[80:81], 7232
s_load_dword s70, s[80:81], 7296
s_load_dword s71, s[80:81], 7360
s_add_u32 s80, s80, 14336
s_addc_u32 s81, s81, 0
s_barrier
v_mov_b32 v7, 16
s_mov_b32 s41, 0x10000
Lpoll_38:
s_waitcnt vmcnt(0)
Lpf_40:
v_cmp_ne_u32 vcc, v7, v6
s_nop 4
s_cbranch_vccz Lpok_39
buffer_load_dword v6, v5, s[56:59], 0 offen sc1
s_sub_u32 s41, s41, 1
s_cmp_lg_u32 s41, 0
s_cbranch_scc1 Lpoll_38
s_waitcnt vmcnt(0)
Lpok_39:
v_add_u32 v5, 0, v1
v_min_u32 v5, 143, v5
v_lshlrev_b32 v20, 3, v5
v_add_u32 v5, s50, v5
v_max_i32 v5, 0, v5
v_lshlrev_b32 v5, 3, v5
buffer_load_dwordx2 v[32:33], v5, s[20:23], 0 offen sc1
v_add_u32 v5, 64, v1
v_min_u32 v5, 143, v5
v_lshlrev_b32 v21, 3, v5
v_add_u32 v5, s50, v5
v_max_i32 v5, 0, v5
v_lshlrev_b32 v5, 3, v5
buffer_load_dwordx2 v[34:35], v5, s[20:23], 0 offen sc1
v_add_u32 v5, 128, v1
v_min_u32 v5, 143, v5
v_lshlrev_b32 v22, 3, v5
v_add_u32 v5, s50, v5
v_max_i32 v5, 0, v5
v_lshlrev_b32 v5, 3, v5
buffer_load_dwordx2 v[36:37], v5, s[20:23], 0 offen sc1
s_load_dword s64, s[80:81], 0
s_load_dword s65, s[80:81], 64
s_load_dword s66, s[80:81], 128
s_load_dword s67, s[80:81], 192
s_load_dword s68, s[80:81], 7168
s_load_dword s69, s[80:81], 7232
s_load_dword s70, s[80:81], 7296
s_load_dword s71, s[80:81], 7360
s_add_u32 s80, s80, 14336
s_addc_u32 s81, s81, 0
s_barrier
s_load_dwordx2 s[88:89], s[0:1], 16
v_lshlrev_b32 v29, 7, v1
s_lshl_b32 s43, s2, 13
s_waitcnt lgkmcnt(0)
s_mov_b32 s84, s88
s_mov_b32 s85, s89
s_mov_b32 s86, 2097152
s_mov_b32 s87, 0x20000
buffer_load_dword v30, v29, s[84:87], s43 offen
v_and_b32 v29, 31, v1
v_lshlrev_b32 v29, 11, v29
s_and_b32 s43, s35, 8
s_or_b32 s43, s43, 3
s_lshl_b32 s43, s43, 7
s_lshr_b32 s44, s2, 3
s_lshl_b32 s44, s44, 16
s_add_u32 s43, s43, s44
buffer_load_dword v30, v29, s[84:87], s43 offen
s_barrier
s_waitcnt vmcnt(2)
v_add_u32 v20, 129024, v20
ds_write_b64 v20, v[32:33]
v_add_u32 v21, 129024, v21
ds_write_b64 v21, v[34:35]
v_add_u32 v22, 129024, v22
ds_write_b64 v22, v[36:37]
s_waitcnt lgkmcnt(0)
s_lshr_b32 s43, s2, 5
s_cmp_eq_u32 s43, 3
s_cbranch_scc1 Lnj_41
s_cmp_gt_u32 s43, 3
s_cselect_b32 s43, 32, 0
s_sub_u32 s43, s2, s43
s_lshr_b32 s43, s43, 1
s_and_b32 s44, s2, 1
s_lshl_b32 s45, s44, 3
s_add_u32 s45, s45, 32
s_load_dwordx2 s[88:89], s[0:1], s45
s_mul_i32 s45, s43, 2341
s_lshr_b32 s45, s45, 16
s_mul_i32 s46, s45, 28
s_sub_u32 s46, s43, s46
v_lshrrev_b32 v28, 4, v1
s_lshl_b32 s43, s45, 8
v_add_u32 v28, s43, v28
v_mul_u32_u24 v28, 7168, v28
v_and_b32 v29, 15, v1
v_lshl_add_u32 v28, v29, 4, v28
s_lshl_b32 s43, s46, 8
v_add_u32 v28, s43, v28
s_waitcnt lgkmcnt(0)
s_mov_b32 s84, s88
s_mov_b32 s85, s89
s_mov_b32 s86, 7340032
s_mov_b32 s87, 0x20000
s_mov_b32 s43, 0
buffer_load_dwordx4 v[128:131], v28, s[84:87], s43 offen
s_mov_b32 s43, 28672
buffer_load_dwordx4 v[132:135], v28, s[84:87], s43 offen
s_mov_b32 s43, 57344
buffer_load_dwordx4 v[136:139], v28, s[84:87], s43 offen
s_mov_b32 s43, 86016
buffer_load_dwordx4 v[140:143], v28, s[84:87], s43 offen
s_mov_b32 s43, 114688
buffer_load_dwordx4 v[144:147], v28, s[84:87], s43 offen
s_mov_b32 s43, 143360
buffer_load_dwordx4 v[148:151], v28, s[84:87], s43 offen
s_mov_b32 s43, 172032
buffer_load_dwordx4 v[152:155], v28, s[84:87], s43 offen
s_mov_b32 s43, 200704
buffer_load_dwordx4 v[156:159], v28, s[84:87], s43 offen
s_mov_b32 s43, 229376
buffer_load_dwordx4 v[160:163], v28, s[84:87], s43 offen
s_mov_b32 s43, 258048
buffer_load_dwordx4 v[164:167], v28, s[84:87], s43 offen
s_mov_b32 s43, 286720
buffer_load_dwordx4 v[168:171], v28, s[84:87], s43 offen
s_mov_b32 s43, 315392
buffer_load_dwordx4 v[172:175], v28, s[84:87], s43 offen
s_mov_b32 s43, 344064
buffer_load_dwordx4 v[176:179], v28, s[84:87], s43 offen
s_mov_b32 s43, 372736
buffer_load_dwordx4 v[180:183], v28, s[84:87], s43 offen
s_mov_b32 s43, 401408
buffer_load_dwordx4 v[184:187], v28, s[84:87], s43 offen
s_mov_b32 s43, 430080
buffer_load_dwordx4 v[188:191], v28, s[84:87], s43 offen
Lnj_41:
s_barrier
s_lshr_b32 s43, s2, 5
s_cmp_eq_u32 s43, 3
s_cbranch_scc1 Lnj_42
s_cmp_gt_u32 s43, 3
s_cselect_b32 s43, 32, 0
s_sub_u32 s43, s2, s43
s_lshr_b32 s43, s43, 1
s_and_b32 s44, s2, 1
s_lshl_b32 s45, s44, 3
s_add_u32 s45, s45, 32
s_load_dwordx2 s[88:89], s[0:1], s45
s_mul_i32 s45, s43, 2341
s_lshr_b32 s45, s45, 16
s_mul_i32 s46, s45, 28
s_sub_u32 s46, s43, s46
v_lshrrev_b32 v28, 4, v1
s_lshl_b32 s43, s45, 8
v_add_u32 v28, s43, v28
v_mul_u32_u24 v28, 7168, v28
v_and_b32 v29, 15, v1
v_lshl_add_u32 v28, v29, 4, v28
s_lshl_b32 s43, s46, 8
v_add_u32 v28, s43, v28
s_waitcnt lgkmcnt(0)
s_mov_b32 s84, s88
s_mov_b32 s85, s89
s_mov_b32 s86, 7340032
s_mov_b32 s87, 0x20000
s_mov_b32 s43, 458752
buffer_load_dwordx4 v[192:195], v28, s[84:87], s43 offen
s_mov_b32 s43, 487424
buffer_load_dwordx4 v[196:199], v28, s[84:87], s43 offen
s_mov_b32 s43, 516096
buffer_load_dwordx4 v[200:203], v28, s[84:87], s43 offen
s_mov_b32 s43, 544768
buffer_load_dwordx4 v[204:207], v28, s[84:87], s43 offen
s_mov_b32 s43, 573440
buffer_load_dwordx4 v[208:211], v28, s[84:87], s43 offen
s_mov_b32 s43, 602112
buffer_load_dwordx4 v[212:215], v28, s[84:87], s43 offen
s_mov_b32 s43, 630784
buffer_load_dwordx4 v[216:219], v28, s[84:87], s43 offen
s_mov_b32 s43, 659456
buffer_load_dwordx4 v[220:223], v28, s[84:87], s43 offen
s_mov_b32 s43, 688128
buffer_load_dwordx4 v[224:227], v28, s[84:87], s43 offen
s_mov_b32 s43, 716800
buffer_load_dwordx4 v[228:231], v28, s[84:87], s43 offen
s_mov_b32 s43, 745472
buffer_load_dwordx4 v[232:235], v28, s[84:87], s43 offen
s_mov_b32 s43, 774144
buffer_load_dwordx4 v[236:239], v28, s[84:87], s43 offen
s_mov_b32 s43, 802816
buffer_load_dwordx4 v[240:243], v28, s[84:87], s43 offen
s_mov_b32 s43, 831488
buffer_load_dwordx4 v[244:247], v28, s[84:87], s43 offen
s_mov_b32 s43, 860160
buffer_load_dwordx4 v[248:251], v28, s[84:87], s43 offen
s_mov_b32 s43, 888832
buffer_load_dwordx4 v[252:255], v28, s[84:87], s43 offen
Lnj_42:
s_barrier
s_branch Lw_43
Lr_44:
s_branch Lw_45
Lr_46:
s_branch Lw_47
Lr_48:
s_waitcnt lgkmcnt(0)
s_and_b32 s43, s36, 1
s_lshr_b32 s44, s36, 1
s_and_b32 s44, s44, 1
s_lshr_b32 s45, s36, 2
s_xor_b32 s45, s45, 1
v_lshlrev_b32 v14, 2, v13
v_sub_u32 v14, v12, v14
v_subrev_u32 v15, 0, v14
v_cmp_ge_u32 s[52:53], 7, v15
v_add_u32 v15, 16, v15
v_cmp_ge_u32 s[84:85], 7, v15
v_subrev_u32 v15, 1, v14
v_cmp_ge_u32 s[54:55], 7, v15
v_add_u32 v15, 16, v15
v_cmp_ge_u32 s[86:87], 7, v15
v_subrev_u32 v15, 2, v14
v_cmp_ge_u32 s[56:57], 7, v15
v_add_u32 v15, 16, v15
v_cmp_ge_u32 s[88:89], 7, v15
v_subrev_u32 v15, 3, v14
v_cmp_ge_u32 s[58:59], 7, v15
v_add_u32 v15, 16, v15
v_cmp_ge_u32 s[90:91], 7, v15
s_lshl_b32 s46, s45, 6
s_add_u32 s46, s46, s44
s_add_u32 s46, s46, 16
v_lshl_add_u32 v14, v12, 1, s46
s_lshl_b32 s47, s43, 6
v_lshl_add_u32 v15, v13, 4, s47
v_mul_u32_u24 v20, 400, v14
v_add_u32 v20, v20, v15
v_subrev_u32 v16, 32, v14
v_max_i32 v16, 0, v16
v_mul_u32_u24 v21, 400, v16
v_add_u32 v21, v21, v15
v_lshrrev_b32 v16, 2, v12
v_lshl_add_u32 v16, v13, 2, v16
v_lshl_add_u32 v16, v16, 1, s46
v_and_b32 v17, 3, v1
v_lshl_add_u32 v17, v17, 3, s47
v_mul_u32_u24 v22, 400, v16
v_add_u32 v22, v22, v17
v_subrev_u32 v16, 32, v16
v_max_i32 v16, 0, v16
v_mul_u32_u24 v23, 400, v16
v_add_u32 v23, v23, v17
s_lshl_b32 s60, s43, 13
s_lshl_b32 s61, s45, 10
s_add_u32 s60, s60, s61
s_lshl_b32 s61, s44, 8
s_add_u32 s60, s60, s61
v_lshlrev_b32 v27, 11, v13
v_lshl_add_u32 v27, v12, 4, v27
v_add_u32 v27, s60, v27
v_mov_b32 v28, 0xff800000
s_mov_b32 s61, 0x3e8293ee
s_nop 2
s_or_b32 s62, s34, s45
s_cmp_lg_u32 s62, 0
s_cselect_b64 s[64:65], s[84:85], 0
s_cselect_b64 s[66:67], s[86:87], 0
s_cselect_b64 s[68:69], s[88:89], 0
s_cselect_b64 s[70:71], s[90:91], 0
.p2align 3
Latt_5:
s_barrier
ds_read_b128 v[32:35], v20 offset:0
ds_read_b128 v[36:39], v20 offset:128
ds_read_b128 v[40:43], v21 offset:128
ds_read_b128 v[80:83], v20 offset:12800
ds_read_b128 v[84:87], v20 offset:12928
ds_read_b128 v[88:91], v20 offset:128
ds_read_b64_tr_b16 v[44:45], v23 offset:256
ds_read_b64_tr_b16 v[46:47], v22 offset:256
ds_read_b64_tr_b16 v[48:49], v23 offset:288
ds_read_b64_tr_b16 v[50:51], v22 offset:288
ds_read_b64_tr_b16 v[92:93], v22 offset:256
ds_read_b64_tr_b16 v[94:95], v22 offset:13056
ds_read_b64_tr_b16 v[96:97], v22 offset:288
ds_read_b64_tr_b16 v[98:99], v22 offset:13088
s_waitcnt lgkmcnt(11)
v_mfma_f32_16x16x32_bf16 v[52:55], v[40:43], v[32:35], 0
v_mfma_f32_16x16x32_bf16 v[56:59], v[36:39], v[32:35], 0
s_waitcnt lgkmcnt(8)
v_mfma_f32_16x16x32_bf16 v[100:103], v[88:91], v[80:83], 0
v_mfma_f32_16x16x32_bf16 v[104:107], v[84:87], v[80:83], 0
s_nop 7
v_cndmask_b32 v52, v28, v52, s[64:65]
v_cndmask_b32 v100, v28, v100, s[84:85]
v_cndmask_b32 v53, v28, v53, s[66:67]
v_cndmask_b32 v101, v28, v101, s[86:87]
v_cndmask_b32 v54, v28, v54, s[68:69]
v_cndmask_b32 v102, v28, v102, s[88:89]
v_cndmask_b32 v55, v28, v55, s[70:71]
v_cndmask_b32 v103, v28, v103, s[90:91]
v_cndmask_b32 v56, v28, v56, s[52:53]
v_cndmask_b32 v104, v28, v104, s[52:53]
v_cndmask_b32 v57, v28, v57, s[54:55]
v_cndmask_b32 v105, v28, v105, s[54:55]
v_cndmask_b32 v58, v28, v58, s[56:57]
v_cndmask_b32 v106, v28, v106, s[56:57]
v_cndmask_b32 v59, v28, v59, s[58:59]
v_cndmask_b32 v107, v28, v107, s[58:59]
v_max3_f32 v60, v52, v53, v54
v_max3_f32 v108, v100, v101, v102
v_max3_f32 v61, v55, v56, v57
v_max3_f32 v109, v103, v104, v105
v_max3_f32 v60, v60, v58, v59
v_max3_f32 v108, v108, v106, v107
v_max_f32 v60, v60, v61
v_max_f32 v108, v108, v109
v_mov_b32 v61, v60
v_mov_b32 v109, v108
s_nop 0
v_permlane32_swap_b32 v60, v61
v_permlane32_swap_b32 v108, v109
v_max_f32 v60, v60, v61
v_max_f32 v108, v108, v109
v_mov_b32 v61, v60
v_mov_b32 v109, v108
s_nop 0
v_permlane16_swap_b32 v60, v61
v_permlane16_swap_b32 v108, v109
v_max_f32 v60, v60, v61
v_max_f32 v108, v108, v109
v_mul_f32 v60, s61, v60
v_mul_f32 v108, s61, v108
v_fma_f32 v52, v52, s61, -v60
v_fma_f32 v100, v100, s61, -v108
v_fma_f32 v53, v53, s61, -v60
v_fma_f32 v101, v101, s61, -v108
v_fma_f32 v54, v54, s61, -v60
v_fma_f32 v102, v102, s61, -v108
v_fma_f32 v55, v55, s61, -v60
v_fma_f32 v103, v103, s61, -v108
v_fma_f32 v56, v56, s61, -v60
v_fma_f32 v104, v104, s61, -v108
v_fma_f32 v57, v57, s61, -v60
v_fma_f32 v105, v105, s61, -v108
v_fma_f32 v58, v58, s61, -v60
v_fma_f32 v106, v106, s61, -v108
v_fma_f32 v59, v59, s61, -v60
v_fma_f32 v107, v107, s61, -v108
v_exp_f32 v52, v52
v_exp_f32 v100, v100
s_barrier
v_exp_f32 v53, v53
v_exp_f32 v101, v101
v_exp_f32 v54, v54
v_exp_f32 v102, v102
v_exp_f32 v55, v55
v_exp_f32 v103, v103
v_exp_f32 v56, v56
v_exp_f32 v104, v104
v_exp_f32 v57, v57
v_exp_f32 v105, v105
v_exp_f32 v58, v58
v_exp_f32 v106, v106
v_exp_f32 v59, v59
v_exp_f32 v107, v107
v_cvt_pk_bf16_f32 v64, v52, v53
v_cvt_pk_bf16_f32 v112, v100, v101
v_cvt_pk_bf16_f32 v65, v54, v55
v_cvt_pk_bf16_f32 v113, v102, v103
v_cvt_pk_bf16_f32 v66, v56, v57
v_cvt_pk_bf16_f32 v114, v104, v105
v_cvt_pk_bf16_f32 v67, v58, v59
v_cvt_pk_bf16_f32 v115, v106, v107
s_waitcnt lgkmcnt(0)
v_mfma_f32_16x16x32_bf16 v[68:71], v[44:47], v[64:67], 0
v_mfma_f32_16x16x32_bf16 v[72:75], v[48:51], v[64:67], 0
v_mfma_f32_16x16x32_bf16 v[116:119], v[92:95], v[112:115], 0
v_mfma_f32_16x16x32_bf16 v[120:123], v[96:99], v[112:115], 0
s_load_dwordx4 s[4:7], s[0:1], 32
s_load_dwordx2 s[28:29], s[0:1], 16
s_load_dwordx4 s[60:63], s[0:1], 48
v_add_f32 v60, v52, v53
v_add_f32 v108, v100, v101
v_add_f32 v61, v54, v55
v_add_f32 v109, v102, v103
v_add_f32 v56, v56, v57
v_add_f32 v104, v104, v105
v_add_f32 v58, v58, v59
v_add_f32 v106, v106, v107
v_add_f32 v60, v60, v61
v_add_f32 v108, v108, v109
v_add_f32 v56, v56, v58
v_add_f32 v104, v104, v106
v_add_f32 v60, v60, v56
v_add_f32 v108, v108, v104
v_mov_b32 v61, v60
v_mov_b32 v109, v108
s_nop 0
v_permlane32_swap_b32 v60, v61
v_permlane32_swap_b32 v108, v109
v_add_f32 v60, v60, v61
v_add_f32 v108, v108, v109
v_mov_b32 v61, v60
v_mov_b32 v109, v108
s_nop 0
v_permlane16_swap_b32 v60, v61
v_permlane16_swap_b32 v108, v109
v_add_f32 v60, v60, v61
v_add_f32 v108, v108, v109
v_rcp_f32 v60, v60
v_rcp_f32 v108, v108
s_nop 0
v_pk_mul_f32 v[68:69], v[60:61], v[68:69] op_sel_hi:[0,1]
v_pk_mul_f32 v[70:71], v[60:61], v[70:71] op_sel_hi:[0,1]
v_pk_mul_f32 v[72:73], v[60:61], v[72:73] op_sel_hi:[0,1]
v_pk_mul_f32 v[74:75], v[60:61], v[74:75] op_sel_hi:[0,1]
v_cvt_pk_bf16_f32 v68, v68, v69
v_cvt_pk_bf16_f32 v69, v70, v71
v_cvt_pk_bf16_f32 v70, v72, v73
v_cvt_pk_bf16_f32 v71, v74, v75
buffer_store_dwordx4 v[68:71], v27, s[16:19], 0 offen offset:0 sc1
v_pk_mul_f32 v[116:117], v[108:109], v[116:117] op_sel_hi:[0,1]
v_pk_mul_f32 v[118:119], v[108:109], v[118:119] op_sel_hi:[0,1]
v_pk_mul_f32 v[120:121], v[108:109], v[120:121] op_sel_hi:[0,1]
v_pk_mul_f32 v[122:123], v[108:109], v[122:123] op_sel_hi:[0,1]
v_cvt_pk_bf16_f32 v116, v116, v117
v_cvt_pk_bf16_f32 v117, v118, v119
v_cvt_pk_bf16_f32 v118, v120, v121
v_cvt_pk_bf16_f32 v119, v122, v123
buffer_store_dwordx4 v[116:119], v27, s[16:19], 0 offen offset:512 sc1
s_branch Lk1e_49
.p2align 6
Lw_47:
s_branch Lr_48
s_nop 0
.p2align 3
Latt_4:
s_barrier
ds_read_b128 v[32:35], v20 offset:0
ds_read_b128 v[36:39], v20 offset:128
ds_read_b128 v[40:43], v21 offset:128
ds_read_b128 v[80:83], v20 offset:12800
ds_read_b128 v[84:87], v20 offset:12928
ds_read_b128 v[88:91], v20 offset:128
ds_read_b64_tr_b16 v[44:45], v23 offset:256
ds_read_b64_tr_b16 v[46:47], v22 offset:256
ds_read_b64_tr_b16 v[48:49], v23 offset:288
ds_read_b64_tr_b16 v[50:51], v22 offset:288
ds_read_b64_tr_b16 v[92:93], v22 offset:256
ds_read_b64_tr_b16 v[94:95], v22 offset:13056
ds_read_b64_tr_b16 v[96:97], v22 offset:288
ds_read_b64_tr_b16 v[98:99], v22 offset:13088
s_waitcnt lgkmcnt(11)
v_mfma_f32_16x16x32_bf16 v[52:55], v[40:43], v[32:35], 0
v_mfma_f32_16x16x32_bf16 v[56:59], v[36:39], v[32:35], 0
s_waitcnt lgkmcnt(8)
v_mfma_f32_16x16x32_bf16 v[100:103], v[88:91], v[80:83], 0
v_mfma_f32_16x16x32_bf16 v[104:107], v[84:87], v[80:83], 0
s_nop 7
v_cndmask_b32 v52, v28, v52, s[64:65]
v_cndmask_b32 v100, v28, v100, s[84:85]
v_cndmask_b32 v53, v28, v53, s[66:67]
v_cndmask_b32 v101, v28, v101, s[86:87]
v_cndmask_b32 v54, v28, v54, s[68:69]
v_cndmask_b32 v102, v28, v102, s[88:89]
v_cndmask_b32 v55, v28, v55, s[70:71]
v_cndmask_b32 v103, v28, v103, s[90:91]
v_cndmask_b32 v56, v28, v56, s[52:53]
v_cndmask_b32 v104, v28, v104, s[52:53]
v_cndmask_b32 v57, v28, v57, s[54:55]
v_cndmask_b32 v105, v28, v105, s[54:55]
v_cndmask_b32 v58, v28, v58, s[56:57]
v_cndmask_b32 v106, v28, v106, s[56:57]
v_cndmask_b32 v59, v28, v59, s[58:59]
v_cndmask_b32 v107, v28, v107, s[58:59]
v_max3_f32 v60, v52, v53, v54
v_max3_f32 v108, v100, v101, v102
v_max3_f32 v61, v55, v56, v57
v_max3_f32 v109, v103, v104, v105
v_max3_f32 v60, v60, v58, v59
v_max3_f32 v108, v108, v106, v107
v_max_f32 v60, v60, v61
v_max_f32 v108, v108, v109
v_mov_b32 v61, v60
v_mov_b32 v109, v108
s_nop 0
v_permlane32_swap_b32 v60, v61
v_permlane32_swap_b32 v108, v109
v_max_f32 v60, v60, v61
v_max_f32 v108, v108, v109
v_mov_b32 v61, v60
v_mov_b32 v109, v108
s_nop 0
v_permlane16_swap_b32 v60, v61
v_permlane16_swap_b32 v108, v109
v_max_f32 v60, v60, v61
v_max_f32 v108, v108, v109
v_mul_f32 v60, s61, v60
v_mul_f32 v108, s61, v108
v_fma_f32 v52, v52, s61, -v60
v_fma_f32 v100, v100, s61, -v108
v_fma_f32 v53, v53, s61, -v60
v_fma_f32 v101, v101, s61, -v108
v_fma_f32 v54, v54, s61, -v60
v_fma_f32 v102, v102, s61, -v108
v_fma_f32 v55, v55, s61, -v60
v_fma_f32 v103, v103, s61, -v108
v_fma_f32 v56, v56, s61, -v60
v_fma_f32 v104, v104, s61, -v108
v_fma_f32 v57, v57, s61, -v60
v_fma_f32 v105, v105, s61, -v108
v_fma_f32 v58, v58, s61, -v60
v_fma_f32 v106, v106, s61, -v108
v_fma_f32 v59, v59, s61, -v60
v_fma_f32 v107, v107, s61, -v108
v_exp_f32 v52, v52
v_exp_f32 v100, v100
v_exp_f32 v53, v53
v_exp_f32 v101, v101
v_exp_f32 v54, v54
v_exp_f32 v102, v102
v_exp_f32 v55, v55
v_exp_f32 v103, v103
v_exp_f32 v56, v56
v_exp_f32 v104, v104
v_exp_f32 v57, v57
v_exp_f32 v105, v105
v_exp_f32 v58, v58
v_exp_f32 v106, v106
v_exp_f32 v59, v59
v_exp_f32 v107, v107
v_cvt_pk_bf16_f32 v64, v52, v53
v_cvt_pk_bf16_f32 v112, v100, v101
v_cvt_pk_bf16_f32 v65, v54, v55
v_cvt_pk_bf16_f32 v113, v102, v103
v_cvt_pk_bf16_f32 v66, v56, v57
v_cvt_pk_bf16_f32 v114, v104, v105
v_cvt_pk_bf16_f32 v67, v58, v59
v_cvt_pk_bf16_f32 v115, v106, v107
s_waitcnt lgkmcnt(0)
v_mfma_f32_16x16x32_bf16 v[68:71], v[44:47], v[64:67], 0
v_mfma_f32_16x16x32_bf16 v[72:75], v[48:51], v[64:67], 0
v_mfma_f32_16x16x32_bf16 v[116:119], v[92:95], v[112:115], 0
v_mfma_f32_16x16x32_bf16 v[120:123], v[96:99], v[112:115], 0
s_load_dwordx4 s[4:7], s[0:1], 32
s_load_dwordx2 s[28:29], s[0:1], 16
s_load_dwordx4 s[60:63], s[0:1], 48
v_add_f32 v60, v52, v53
v_add_f32 v108, v100, v101
v_add_f32 v61, v54, v55
v_add_f32 v109, v102, v103
v_add_f32 v56, v56, v57
v_add_f32 v104, v104, v105
v_add_f32 v58, v58, v59
v_add_f32 v106, v106, v107
v_add_f32 v60, v60, v61
v_add_f32 v108, v108, v109
v_add_f32 v56, v56, v58
v_add_f32 v104, v104, v106
v_add_f32 v60, v60, v56
v_add_f32 v108, v108, v104
v_mov_b32 v61, v60
v_mov_b32 v109, v108
s_nop 0
v_permlane32_swap_b32 v60, v61
v_permlane32_swap_b32 v108, v109
v_add_f32 v60, v60, v61
v_add_f32 v108, v108, v109
v_mov_b32 v61, v60
v_mov_b32 v109, v108
s_nop 0
v_permlane16_swap_b32 v60, v61
v_permlane16_swap_b32 v108, v109
v_add_f32 v60, v60, v61
v_add_f32 v108, v108, v109
v_rcp_f32 v60, v60
v_rcp_f32 v108, v108
s_nop 0
v_pk_mul_f32 v[68:69], v[60:61], v[68:69] op_sel_hi:[0,1]
v_pk_mul_f32 v[70:71], v[60:61], v[70:71] op_sel_hi:[0,1]
v_pk_mul_f32 v[72:73], v[60:61], v[72:73] op_sel_hi:[0,1]
v_pk_mul_f32 v[74:75], v[60:61], v[74:75] op_sel_hi:[0,1]
v_cvt_pk_bf16_f32 v68, v68, v69
v_cvt_pk_bf16_f32 v69, v70, v71
v_cvt_pk_bf16_f32 v70, v72, v73
v_cvt_pk_bf16_f32 v71, v74, v75
buffer_store_dwordx4 v[68:71], v27, s[16:19], 0 offen offset:0 sc1
v_pk_mul_f32 v[116:117], v[108:109], v[116:117] op_sel_hi:[0,1]
v_pk_mul_f32 v[118:119], v[108:109], v[118:119] op_sel_hi:[0,1]
v_pk_mul_f32 v[120:121], v[108:109], v[120:121] op_sel_hi:[0,1]
v_pk_mul_f32 v[122:123], v[108:109], v[122:123] op_sel_hi:[0,1]
v_cvt_pk_bf16_f32 v116, v116, v117
v_cvt_pk_bf16_f32 v117, v118, v119
v_cvt_pk_bf16_f32 v118, v120, v121
v_cvt_pk_bf16_f32 v119, v122, v123
buffer_store_dwordx4 v[116:119], v27, s[16:19], 0 offen offset:512 sc1
Lk1e_49:
s_add_u32 s56, s32, 28311552
s_addc_u32 s57, s33, 0
s_mov_b32 s58, 40960
s_mov_b32 s59, 0x20000
v_and_b32 v17, 15, v1
v_lshrrev_b32 v18, 4, v1
s_lshr_b32 s46, s36, 1
s_and_b32 s46, s46, 1
s_and_b32 s47, s36, 1
s_and_b32 s51, s36, 3
s_bfe_u32 s49, s35, 0x20001
s_sub_u32 s43, 0, s49
s_and_b32 s43, s43, 3
s_cmp_ge_u32 s35, 8
s_cselect_b32 s49, s43, s49
s_lshl_b32 s49, s49, 2
s_lshr_b32 s43, s35, 3
s_lshl_b32 s43, s43, 1
s_add_u32 s49, s49, s43
s_and_b32 s43, s35, 1
s_add_u32 s49, s49, s43
s_waitcnt lgkmcnt(0)
s_cmp_ge_u32 s36, 4
s_cbranch_scc1 LG1_50
v_lshlrev_b32 v19, 11, v18
v_lshl_add_u32 v19, v17, 4, v19
s_lshl_b32 s43, s36, 9
v_add_u32 v2, s43, v19
v_add_u32 v4, 98304, v2
v_lshrrev_b32 v19, 2, v17
v_lshl_add_u32 v20, v18, 2, v19
v_bfe_u32 v21, v20, 1, 2
v_lshlrev_b32 v20, 7, v20
v_lshl_add_u32 v20, v21, 5, v20
v_and_b32 v19, 3, v1
v_lshl_add_u32 v20, v19, 3, v20
v_add_u32 v5, 0x10000, v20
v_xor_b32 v6, 32, v5
v_xor_b32 v7, 64, v5
v_xor_b32 v8, 96, v5
v_add_u32 v9, 0x10000, v5
v_add_u32 v10, 0x10000, v6
v_add_u32 v11, 0x10000, v7
v_add_u32 v12, 0x10000, v8
s_lshl_b32 s43, s34, 18
s_lshl_b32 s44, s35, 14
s_add_u32 s43, s43, s44
s_add_u32 s20, s32, s43
s_addc_u32 s21, s33, 0
s_add_u32 s20, s20, 4194304
s_addc_u32 s21, s21, 0
s_mov_b32 s22, 16384
s_mov_b32 s23, 0x20000
s_lshl_b32 s43, s34, 14
s_lshl_b32 s44, s35, 10
s_add_u32 s43, s43, s44
s_add_u32 s24, s32, s43
s_addc_u32 s25, s33, 0
s_add_u32 s24, s24, 25165824
s_addc_u32 s25, s25, 0
s_mov_b32 s26, 1024
s_mov_b32 s27, 0x20000
s_movk_i32 s50, 0x2000
v_lshrrev_b32 v19, 1, v18
v_lshl_add_u32 v19, v19, 4, v17
s_lshl_b32 s43, s36, 5
v_add_u32 v19, s43, v19
v_and_b32 v20, 1, v18
v_lshlrev_b32 v20, 2, v20
v_lshl_add_u32 v22, v19, 3, v20
s_lshl_b32 s43, s34, 18
s_add_u32 s12, s32, s43
s_addc_u32 s13, s33, 0
s_mov_b32 s14, 262144
s_mov_b32 s15, 0x20000
v_lshlrev_b32 v21, 4, v1
s_lshl_b32 s54, s36, 11
s_xor_b32 s43, s35, 1
s_and_b32 s43, s43, 15
s_lshl_b32 s43, s43, 14
s_add_u32 s30, s43, s54
s_xor_b32 s43, s35, 2
s_and_b32 s43, s43, 15
s_lshl_b32 s43, s43, 14
s_add_u32 s31, s43, s54
s_waitcnt vmcnt(0)
s_barrier
ds_write_b128 v27, v[68:71] offset:0
ds_write_b128 v27, v[116:119] offset:512
v_permlane16_swap_b32 v240, v242
v_permlane16_swap_b32 v241, v243
v_permlane16_swap_b32 v244, v246
v_permlane16_swap_b32 v245, v247
v_permlane16_swap_b32 v248, v250
v_permlane16_swap_b32 v249, v251
v_permlane16_swap_b32 v252, v254
v_permlane16_swap_b32 v253, v255
v_lshlrev_b32 v128, 16, v240
v_and_b32 v129, 0xffff0000, v240
v_lshlrev_b32 v130, 16, v241
v_and_b32 v131, 0xffff0000, v241
v_lshlrev_b32 v132, 16, v242
v_and_b32 v133, 0xffff0000, v242
v_lshlrev_b32 v134, 16, v243
v_and_b32 v135, 0xffff0000, v243
v_lshlrev_b32 v136, 16, v244
v_and_b32 v137, 0xffff0000, v244
v_lshlrev_b32 v138, 16, v245
v_and_b32 v139, 0xffff0000, v245
v_lshlrev_b32 v140, 16, v246
v_and_b32 v141, 0xffff0000, v246
v_lshlrev_b32 v142, 16, v247
v_and_b32 v143, 0xffff0000, v247
v_lshlrev_b32 v144, 16, v248
v_and_b32 v145, 0xffff0000, v248
v_lshlrev_b32 v146, 16, v249
v_and_b32 v147, 0xffff0000, v249
v_lshlrev_b32 v148, 16, v250
v_and_b32 v149, 0xffff0000, v250
v_lshlrev_b32 v150, 16, v251
v_and_b32 v151, 0xffff0000, v251
v_lshlrev_b32 v152, 16, v252
v_and_b32 v153, 0xffff0000, v252
v_lshlrev_b32 v154, 16, v253
v_and_b32 v155, 0xffff0000, v253
v_lshlrev_b32 v156, 16, v254
v_and_b32 v157, 0xffff0000, v254
v_lshlrev_b32 v158, 16, v255
v_and_b32 v159, 0xffff0000, v255
s_waitcnt lgkmcnt(0)
s_barrier
s_add_u32 m0, s54, 16384
s_add_u32 s43, s30, 0
buffer_load_dwordx4 v21, s[12:15], s43 offen sc1 lds
s_add_u32 m0, s54, 17408
s_add_u32 s43, s30, 1024
buffer_load_dwordx4 v21, s[12:15], s43 offen sc1 lds
s_add_u32 m0, s54, 32768
s_add_u32 s43, s31, 0
buffer_load_dwordx4 v21, s[12:15], s43 offen sc1 lds
s_add_u32 m0, s54, 33792
s_add_u32 s43, s31, 1024
buffer_load_dwordx4 v21, s[12:15], s43 offen sc1 lds
ds_read_b128 v[32:35], v2 offset:0
ds_read_b64_tr_b16 v[48:49], v5 offset:0
ds_read_b64_tr_b16 v[50:51], v5 offset:2048
ds_read_b64_tr_b16 v[52:53], v6 offset:0
ds_read_b64_tr_b16 v[54:55], v6 offset:2048
ds_read_b128 v[36:39], v2 offset:256
ds_read_b64_tr_b16 v[56:57], v7 offset:0
ds_read_b64_tr_b16 v[58:59], v7 offset:2048
ds_read_b64_tr_b16 v[60:61], v8 offset:0
ds_read_b64_tr_b16 v[62:63], v8 offset:2048
ds_read_b128 v[40:43], v2 offset:8192
ds_read_b64_tr_b16 v[64:65], v5 offset:4096
ds_read_b64_tr_b16 v[66:67], v5 offset:6144
ds_read_b64_tr_b16 v[68:69], v6 offset:4096
ds_read_b64_tr_b16 v[70:71], v6 offset:6144
ds_read_b128 v[44:47], v2 offset:8448
ds_read_b64_tr_b16 v[72:73], v7 offset:4096
ds_read_b64_tr_b16 v[74:75], v7 offset:6144
ds_read_b64_tr_b16 v[76:77], v8 offset:4096
ds_read_b64_tr_b16 v[78:79], v8 offset:6144
s_waitcnt lgkmcnt(0)
v_mfma_f32_16x16x32_bf16 v[128:131], v[48:51], v[32:35], v[128:131]
v_mfma_f32_16x16x32_bf16 v[132:135], v[52:55], v[32:35], v[132:135]
v_mfma_f32_16x16x32_bf16 v[136:139], v[56:59], v[32:35], v[136:139]
v_mfma_f32_16x16x32_bf16 v[140:143], v[60:63], v[32:35], v[140:143]
v_mfma_f32_16x16x32_bf16 v[144:147], v[48:51], v[36:39], v[144:147]
v_mfma_f32_16x16x32_bf16 v[148:151], v[52:55], v[36:39], v[148:151]
v_mfma_f32_16x16x32_bf16 v[152:155], v[56:59], v[36:39], v[152:155]
v_mfma_f32_16x16x32_bf16 v[156:159], v[60:63], v[36:39], v[156:159]
v_mfma_f32_16x16x32_bf16 v[128:131], v[64:67], v[40:43], v[128:131]
v_mfma_f32_16x16x32_bf16 v[132:135], v[68:71], v[40:43], v[132:135]
v_mfma_f32_16x16x32_bf16 v[136:139], v[72:75], v[40:43], v[136:139]
v_mfma_f32_16x16x32_bf16 v[140:143], v[76:79], v[40:43], v[140:143]
v_mfma_f32_16x16x32_bf16 v[144:147], v[64:67], v[44:47], v[144:147]
v_mfma_f32_16x16x32_bf16 v[148:151], v[68:71], v[44:47], v[148:151]
v_mfma_f32_16x16x32_bf16 v[152:155], v[72:75], v[44:47], v[152:155]
v_mfma_f32_16x16x32_bf16 v[156:159], v[76:79], v[44:47], v[156:159]
s_waitcnt vmcnt(2)
s_barrier
ds_read_b128 v[80:83], v2 offset:16384
ds_read_b64_tr_b16 v[96:97], v5 offset:8192
ds_read_b64_tr_b16 v[98:99], v5 offset:10240
ds_read_b64_tr_b16 v[100:101], v6 offset:8192
ds_read_b64_tr_b16 v[102:103], v6 offset:10240
ds_read_b128 v[84:87], v2 offset:16640
ds_read_b64_tr_b16 v[104:105], v7 offset:8192
ds_read_b64_tr_b16 v[106:107], v7 offset:10240
ds_read_b64_tr_b16 v[108:109], v8 offset:8192
ds_read_b64_tr_b16 v[110:111], v8 offset:10240
ds_read_b128 v[88:91], v2 offset:24576
ds_read_b64_tr_b16 v[112:113], v5 offset:12288
ds_read_b64_tr_b16 v[114:115], v5 offset:14336
ds_read_b64_tr_b16 v[116:117], v6 offset:12288
ds_read_b64_tr_b16 v[118:119], v6 offset:14336
ds_read_b128 v[92:95], v2 offset:24832
ds_read_b64_tr_b16 v[120:121], v7 offset:12288
ds_read_b64_tr_b16 v[122:123], v7 offset:14336
ds_read_b64_tr_b16 v[124:125], v8 offset:12288
ds_read_b64_tr_b16 v[126:127], v8 offset:14336
s_waitcnt vmcnt(0) lgkmcnt(0)
v_max3_u32 v19, v80, v81, v82
v_max3_u32 v19, v19, v83, v84
v_max3_u32 v19, v19, v85, v86
v_max3_u32 v19, v19, v87, v88
v_max3_u32 v19, v19, v89, v90
v_max3_u32 v19, v19, v91, v92
v_max3_u32 v19, v19, v93, v94
v_max_u32 v19, v19, v95
v_cmp_eq_u32 vcc, -1, v19
s_nop 4
s_cbranch_vccnz Lfx_53
Lok_51:
s_barrier
v_mfma_f32_16x16x32_bf16 v[128:131], v[96:99], v[80:83], v[128:131]
ds_read_b128 v[32:35], v2 offset:32768
ds_read_b64_tr_b16 v[48:49], v5 offset:16384
v_mfma_f32_16x16x32_bf16 v[132:135], v[100:103], v[80:83], v[132:135]
ds_read_b64_tr_b16 v[50:51], v5 offset:18432
v_mfma_f32_16x16x32_bf16 v[136:139], v[104:107], v[80:83], v[136:139]
ds_read_b64_tr_b16 v[52:53], v6 offset:16384
v_mfma_f32_16x16x32_bf16 v[140:143], v[108:111], v[80:83], v[140:143]
ds_read_b64_tr_b16 v[54:55], v6 offset:18432
v_mfma_f32_16x16x32_bf16 v[144:147], v[96:99], v[84:87], v[144:147]
ds_read_b128 v[36:39], v2 offset:33024
ds_read_b64_tr_b16 v[56:57], v7 offset:16384
v_mfma_f32_16x16x32_bf16 v[148:151], v[100:103], v[84:87], v[148:151]
ds_read_b64_tr_b16 v[58:59], v7 offset:18432
v_mfma_f32_16x16x32_bf16 v[152:155], v[104:107], v[84:87], v[152:155]
ds_read_b64_tr_b16 v[60:61], v8 offset:16384
v_mfma_f32_16x16x32_bf16 v[156:159], v[108:111], v[84:87], v[156:159]
ds_read_b64_tr_b16 v[62:63], v8 offset:18432
v_mfma_f32_16x16x32_bf16 v[128:131], v[112:115], v[88:91], v[128:131]
ds_read_b128 v[40:43], v2 offset:40960
ds_read_b64_tr_b16 v[64:65], v5 offset:20480
v_mfma_f32_16x16x32_bf16 v[132:135], v[116:119], v[88:91], v[132:135]
ds_read_b64_tr_b16 v[66:67], v5 offset:22528
v_mfma_f32_16x16x32_bf16 v[136:139], v[120:123], v[88:91], v[136:139]
ds_read_b64_tr_b16 v[68:69], v6 offset:20480
v_mfma_f32_16x16x32_bf16 v[140:143], v[124:127], v[88:91], v[140:143]
ds_read_b64_tr_b16 v[70:71], v6 offset:22528
v_mfma_f32_16x16x32_bf16 v[144:147], v[112:115], v[92:95], v[144:147]
ds_read_b128 v[44:47], v2 offset:41216
ds_read_b64_tr_b16 v[72:73], v7 offset:20480
v_mfma_f32_16x16x32_bf16 v[148:151], v[116:119], v[92:95], v[148:151]
ds_read_b64_tr_b16 v[74:75], v7 offset:22528
v_mfma_f32_16x16x32_bf16 v[152:155], v[120:123], v[92:95], v[152:155]
ds_read_b64_tr_b16 v[76:77], v8 offset:20480
v_mfma_f32_16x16x32_bf16 v[156:159], v[124:127], v[92:95], v[156:159]
ds_read_b64_tr_b16 v[78:79], v8 offset:22528
s_waitcnt lgkmcnt(0)
v_max3_u32 v19, v32, v33, v34
v_max3_u32 v19, v19, v35, v36
v_max3_u32 v19, v19, v37, v38
v_max3_u32 v19, v19, v39, v40
v_max3_u32 v19, v19, v41, v42
v_max3_u32 v19, v19, v43, v44
v_max3_u32 v19, v19, v45, v46
v_max_u32 v19, v19, v47
v_cmp_eq_u32 vcc, -1, v19
s_nop 4
s_cbranch_vccnz Lfx_56
Lok_54:
s_barrier
v_mfma_f32_16x16x32_bf16 v[128:131], v[48:51], v[32:35], v[128:131]
ds_read_b128 v[80:83], v2 offset:49152
ds_read_b64_tr_b16 v[96:97], v5 offset:24576
v_mfma_f32_16x16x32_bf16 v[132:135], v[52:55], v[32:35], v[132:135]
ds_read_b64_tr_b16 v[98:99], v5 offset:26624
v_mfma_f32_16x16x32_bf16 v[136:139], v[56:59], v[32:35], v[136:139]
ds_read_b64_tr_b16 v[100:101], v6 offset:24576
v_mfma_f32_16x16x32_bf16 v[140:143], v[60:63], v[32:35], v[140:143]
ds_read_b64_tr_b16 v[102:103], v6 offset:26624
v_mfma_f32_16x16x32_bf16 v[144:147], v[48:51], v[36:39], v[144:147]
ds_read_b128 v[84:87], v2 offset:49408
ds_read_b64_tr_b16 v[104:105], v7 offset:24576
v_mfma_f32_16x16x32_bf16 v[148:151], v[52:55], v[36:39], v[148:151]
ds_read_b64_tr_b16 v[106:107], v7 offset:26624
v_mfma_f32_16x16x32_bf16 v[152:155], v[56:59], v[36:39], v[152:155]
ds_read_b64_tr_b16 v[108:109], v8 offset:24576
v_mfma_f32_16x16x32_bf16 v[156:159], v[60:63], v[36:39], v[156:159]
ds_read_b64_tr_b16 v[110:111], v8 offset:26624
v_mfma_f32_16x16x32_bf16 v[128:131], v[64:67], v[40:43], v[128:131]
ds_read_b128 v[88:91], v2 offset:57344
ds_read_b64_tr_b16 v[112:113], v5 offset:28672
v_mfma_f32_16x16x32_bf16 v[132:135], v[68:71], v[40:43], v[132:135]
ds_read_b64_tr_b16 v[114:115], v5 offset:30720
v_mfma_f32_16x16x32_bf16 v[136:139], v[72:75], v[40:43], v[136:139]
ds_read_b64_tr_b16 v[116:117], v6 offset:28672
v_mfma_f32_16x16x32_bf16 v[140:143], v[76:79], v[40:43], v[140:143]
ds_read_b64_tr_b16 v[118:119], v6 offset:30720
v_mfma_f32_16x16x32_bf16 v[144:147], v[64:67], v[44:47], v[144:147]
ds_read_b128 v[92:95], v2 offset:57600
ds_read_b64_tr_b16 v[120:121], v7 offset:28672
v_mfma_f32_16x16x32_bf16 v[148:151], v[68:71], v[44:47], v[148:151]
ds_read_b64_tr_b16 v[122:123], v7 offset:30720
v_mfma_f32_16x16x32_bf16 v[152:155], v[72:75], v[44:47], v[152:155]
ds_read_b64_tr_b16 v[124:125], v8 offset:28672
v_mfma_f32_16x16x32_bf16 v[156:159], v[76:79], v[44:47], v[156:159]
ds_read_b64_tr_b16 v[126:127], v8 offset:30720
s_waitcnt lgkmcnt(0)
v_max3_u32 v19, v80, v81, v82
v_max3_u32 v19, v19, v83, v84
v_max3_u32 v19, v19, v85, v86
v_max3_u32 v19, v19, v87, v88
v_max3_u32 v19, v19, v89, v90
v_max3_u32 v19, v19, v91, v92
v_max3_u32 v19, v19, v93, v94
v_max_u32 v19, v19, v95
v_cmp_eq_u32 vcc, -1, v19
s_nop 4
s_cbranch_vccnz Lfx_59
Lok_57:
s_barrier
v_mfma_f32_16x16x32_bf16 v[128:131], v[96:99], v[80:83], v[128:131]
ds_read_b128 v[32:35], v2 offset:0
ds_read_b64_tr_b16 v[48:49], v5 offset:32768
v_mfma_f32_16x16x32_bf16 v[132:135], v[100:103], v[80:83], v[132:135]
ds_read_b64_tr_b16 v[50:51], v5 offset:34816
v_mfma_f32_16x16x32_bf16 v[136:139], v[104:107], v[80:83], v[136:139]
ds_read_b64_tr_b16 v[52:53], v6 offset:32768
v_mfma_f32_16x16x32_bf16 v[140:143], v[108:111], v[80:83], v[140:143]
ds_read_b64_tr_b16 v[54:55], v6 offset:34816
v_mfma_f32_16x16x32_bf16 v[144:147], v[96:99], v[84:87], v[144:147]
ds_read_b128 v[36:39], v2 offset:256
ds_read_b64_tr_b16 v[56:57], v7 offset:32768
v_mfma_f32_16x16x32_bf16 v[148:151], v[100:103], v[84:87], v[148:151]
ds_read_b64_tr_b16 v[58:59], v7 offset:34816
v_mfma_f32_16x16x32_bf16 v[152:155], v[104:107], v[84:87], v[152:155]
ds_read_b64_tr_b16 v[60:61], v8 offset:32768
v_mfma_f32_16x16x32_bf16 v[156:159], v[108:111], v[84:87], v[156:159]
ds_read_b64_tr_b16 v[62:63], v8 offset:34816
v_mfma_f32_16x16x32_bf16 v[128:131], v[112:115], v[88:91], v[128:131]
ds_read_b128 v[40:43], v2 offset:8192
ds_read_b64_tr_b16 v[64:65], v5 offset:36864
v_mfma_f32_16x16x32_bf16 v[132:135], v[116:119], v[88:91], v[132:135]
ds_read_b64_tr_b16 v[66:67], v5 offset:38912
v_mfma_f32_16x16x32_bf16 v[136:139], v[120:123], v[88:91], v[136:139]
ds_read_b64_tr_b16 v[68:69], v6 offset:36864
v_mfma_f32_16x16x32_bf16 v[140:143], v[124:127], v[88:91], v[140:143]
ds_read_b64_tr_b16 v[70:71], v6 offset:38912
v_mfma_f32_16x16x32_bf16 v[144:147], v[112:115], v[92:95], v[144:147]
ds_read_b128 v[44:47], v2 offset:8448
ds_read_b64_tr_b16 v[72:73], v7 offset:36864
v_mfma_f32_16x16x32_bf16 v[148:151], v[116:119], v[92:95], v[148:151]
ds_read_b64_tr_b16 v[74:75], v7 offset:38912
v_mfma_f32_16x16x32_bf16 v[152:155], v[120:123], v[92:95], v[152:155]
ds_read_b64_tr_b16 v[76:77], v8 offset:36864
v_mfma_f32_16x16x32_bf16 v[156:159], v[124:127], v[92:95], v[156:159]
ds_read_b64_tr_b16 v[78:79], v8 offset:38912
s_waitcnt lgkmcnt(0)
v_max3_u32 v19, v32, v33, v34
v_max3_u32 v19, v19, v35, v36
v_max3_u32 v19, v19, v37, v38
v_max3_u32 v19, v19, v39, v40
v_max3_u32 v19, v19, v41, v42
v_max3_u32 v19, v19, v43, v44
v_max3_u32 v19, v19, v45, v46
v_max_u32 v19, v19, v47
v_cmp_eq_u32 vcc, -1, v19
s_nop 4
s_cbranch_vccnz Lfx_62
Lok_60:
s_barrier
v_mfma_f32_16x16x32_bf16 v[128:131], v[48:51], v[32:35], v[128:131]
ds_read_b128 v[80:83], v2 offset:16384
ds_read_b64_tr_b16 v[96:97], v5 offset:40960
v_mfma_f32_16x16x32_bf16 v[132:135], v[52:55], v[32:35], v[132:135]
ds_read_b64_tr_b16 v[98:99], v5 offset:43008
v_mfma_f32_16x16x32_bf16 v[136:139], v[56:59], v[32:35], v[136:139]
ds_read_b64_tr_b16 v[100:101], v6 offset:40960
v_mfma_f32_16x16x32_bf16 v[140:143], v[60:63], v[32:35], v[140:143]
ds_read_b64_tr_b16 v[102:103], v6 offset:43008
v_mfma_f32_16x16x32_bf16 v[144:147], v[48:51], v[36:39], v[144:147]
ds_read_b128 v[84:87], v2 offset:16640
ds_read_b64_tr_b16 v[104:105], v7 offset:40960
v_mfma_f32_16x16x32_bf16 v[148:151], v[52:55], v[36:39], v[148:151]
ds_read_b64_tr_b16 v[106:107], v7 offset:43008
v_mfma_f32_16x16x32_bf16 v[152:155], v[56:59], v[36:39], v[152:155]
ds_read_b64_tr_b16 v[108:109], v8 offset:40960
v_mfma_f32_16x16x32_bf16 v[156:159], v[60:63], v[36:39], v[156:159]
ds_read_b64_tr_b16 v[110:111], v8 offset:43008
v_mfma_f32_16x16x32_bf16 v[128:131], v[64:67], v[40:43], v[128:131]
ds_read_b128 v[88:91], v2 offset:24576
ds_read_b64_tr_b16 v[112:113], v5 offset:45056
v_mfma_f32_16x16x32_bf16 v[132:135], v[68:71], v[40:43], v[132:135]
ds_read_b64_tr_b16 v[114:115], v5 offset:47104
v_mfma_f32_16x16x32_bf16 v[136:139], v[72:75], v[40:43], v[136:139]
ds_read_b64_tr_b16 v[116:117], v6 offset:45056
v_mfma_f32_16x16x32_bf16 v[140:143], v[76:79], v[40:43], v[140:143]
ds_read_b64_tr_b16 v[118:119], v6 offset:47104
v_mfma_f32_16x16x32_bf16 v[144:147], v[64:67], v[44:47], v[144:147]
ds_read_b128 v[92:95], v2 offset:24832
ds_read_b64_tr_b16 v[120:121], v7 offset:45056
v_mfma_f32_16x16x32_bf16 v[148:151], v[68:71], v[44:47], v[148:151]
ds_read_b64_tr_b16 v[122:123], v7 offset:47104
v_mfma_f32_16x16x32_bf16 v[152:155], v[72:75], v[44:47], v[152:155]
ds_read_b64_tr_b16 v[124:125], v8 offset:45056
v_mfma_f32_16x16x32_bf16 v[156:159], v[76:79], v[44:47], v[156:159]
ds_read_b64_tr_b16 v[126:127], v8 offset:47104
s_waitcnt lgkmcnt(0)
v_max3_u32 v19, v80, v81, v82
v_max3_u32 v19, v19, v83, v84
v_max3_u32 v19, v19, v85, v86
v_max3_u32 v19, v19, v87, v88
v_max3_u32 v19, v19, v89, v90
v_max3_u32 v19, v19, v91, v92
v_max3_u32 v19, v19, v93, v94
v_max_u32 v19, v19, v95
v_cmp_eq_u32 vcc, -1, v19
s_nop 4
s_cbranch_vccnz Lfx_65
Lok_63:
s_barrier
v_mfma_f32_16x16x32_bf16 v[128:131], v[96:99], v[80:83], v[128:131]
ds_read_b128 v[32:35], v2 offset:32768
ds_read_b64_tr_b16 v[48:49], v5 offset:49152
v_mfma_f32_16x16x32_bf16 v[132:135], v[100:103], v[80:83], v[132:135]
ds_read_b64_tr_b16 v[50:51], v5 offset:51200
v_mfma_f32_16x16x32_bf16 v[136:139], v[104:107], v[80:83], v[136:139]
ds_read_b64_tr_b16 v[52:53], v6 offset:49152
v_mfma_f32_16x16x32_bf16 v[140:143], v[108:111], v[80:83], v[140:143]
ds_read_b64_tr_b16 v[54:55], v6 offset:51200
v_mfma_f32_16x16x32_bf16 v[144:147], v[96:99], v[84:87], v[144:147]
ds_read_b128 v[36:39], v2 offset:33024
ds_read_b64_tr_b16 v[56:57], v7 offset:49152
v_mfma_f32_16x16x32_bf16 v[148:151], v[100:103], v[84:87], v[148:151]
ds_read_b64_tr_b16 v[58:59], v7 offset:51200
v_mfma_f32_16x16x32_bf16 v[152:155], v[104:107], v[84:87], v[152:155]
ds_read_b64_tr_b16 v[60:61], v8 offset:49152
v_mfma_f32_16x16x32_bf16 v[156:159], v[108:111], v[84:87], v[156:159]
ds_read_b64_tr_b16 v[62:63], v8 offset:51200
v_mfma_f32_16x16x32_bf16 v[128:131], v[112:115], v[88:91], v[128:131]
ds_read_b128 v[40:43], v2 offset:40960
ds_read_b64_tr_b16 v[64:65], v5 offset:53248
v_mfma_f32_16x16x32_bf16 v[132:135], v[116:119], v[88:91], v[132:135]
ds_read_b64_tr_b16 v[66:67], v5 offset:55296
v_mfma_f32_16x16x32_bf16 v[136:139], v[120:123], v[88:91], v[136:139]
ds_read_b64_tr_b16 v[68:69], v6 offset:53248
v_mfma_f32_16x16x32_bf16 v[140:143], v[124:127], v[88:91], v[140:143]
ds_read_b64_tr_b16 v[70:71], v6 offset:55296
v_mfma_f32_16x16x32_bf16 v[144:147], v[112:115], v[92:95], v[144:147]
ds_read_b128 v[44:47], v2 offset:41216
ds_read_b64_tr_b16 v[72:73], v7 offset:53248
v_mfma_f32_16x16x32_bf16 v[148:151], v[116:119], v[92:95], v[148:151]
ds_read_b64_tr_b16 v[74:75], v7 offset:55296
v_mfma_f32_16x16x32_bf16 v[152:155], v[120:123], v[92:95], v[152:155]
ds_read_b64_tr_b16 v[76:77], v8 offset:53248
v_mfma_f32_16x16x32_bf16 v[156:159], v[124:127], v[92:95], v[156:159]
ds_read_b64_tr_b16 v[78:79], v8 offset:55296
s_waitcnt lgkmcnt(0)
v_max3_u32 v19, v32, v33, v34
v_max3_u32 v19, v19, v35, v36
v_max3_u32 v19, v19, v37, v38
v_max3_u32 v19, v19, v39, v40
v_max3_u32 v19, v19, v41, v42
v_max3_u32 v19, v19, v43, v44
v_max3_u32 v19, v19, v45, v46
v_max_u32 v19, v19, v47
v_cmp_eq_u32 vcc, -1, v19
s_nop 4
s_cbranch_vccnz Lfx_68
Lok_66:
s_barrier
v_mfma_f32_16x16x32_bf16 v[128:131], v[48:51], v[32:35], v[128:131]
ds_read_b128 v[80:83], v2 offset:49152
ds_read_b64_tr_b16 v[96:97], v5 offset:57344
v_mfma_f32_16x16x32_bf16 v[132:135], v[52:55], v[32:35], v[132:135]
ds_read_b64_tr_b16 v[98:99], v5 offset:59392
v_mfma_f32_16x16x32_bf16 v[136:139], v[56:59], v[32:35], v[136:139]
ds_read_b64_tr_b16 v[100:101], v6 offset:57344
v_mfma_f32_16x16x32_bf16 v[140:143], v[60:63], v[32:35], v[140:143]
ds_read_b64_tr_b16 v[102:103], v6 offset:59392
v_mfma_f32_16x16x32_bf16 v[144:147], v[48:51], v[36:39], v[144:147]
ds_read_b128 v[84:87], v2 offset:49408
ds_read_b64_tr_b16 v[104:105], v7 offset:57344
v_mfma_f32_16x16x32_bf16 v[148:151], v[52:55], v[36:39], v[148:151]
ds_read_b64_tr_b16 v[106:107], v7 offset:59392
v_mfma_f32_16x16x32_bf16 v[152:155], v[56:59], v[36:39], v[152:155]
ds_read_b64_tr_b16 v[108:109], v8 offset:57344
v_mfma_f32_16x16x32_bf16 v[156:159], v[60:63], v[36:39], v[156:159]
ds_read_b64_tr_b16 v[110:111], v8 offset:59392
v_mfma_f32_16x16x32_bf16 v[128:131], v[64:67], v[40:43], v[128:131]
ds_read_b128 v[88:91], v2 offset:57344
ds_read_b64_tr_b16 v[112:113], v5 offset:61440
v_mfma_f32_16x16x32_bf16 v[132:135], v[68:71], v[40:43], v[132:135]
ds_read_b64_tr_b16 v[114:115], v5 offset:63488
v_mfma_f32_16x16x32_bf16 v[136:139], v[72:75], v[40:43], v[136:139]
ds_read_b64_tr_b16 v[116:117], v6 offset:61440
v_mfma_f32_16x16x32_bf16 v[140:143], v[76:79], v[40:43], v[140:143]
ds_read_b64_tr_b16 v[118:119], v6 offset:63488
v_mfma_f32_16x16x32_bf16 v[144:147], v[64:67], v[44:47], v[144:147]
ds_read_b128 v[92:95], v2 offset:57600
ds_read_b64_tr_b16 v[120:121], v7 offset:61440
v_mfma_f32_16x16x32_bf16 v[148:151], v[68:71], v[44:47], v[148:151]
ds_read_b64_tr_b16 v[122:123], v7 offset:63488
v_mfma_f32_16x16x32_bf16 v[152:155], v[72:75], v[44:47], v[152:155]
ds_read_b64_tr_b16 v[124:125], v8 offset:61440
v_mfma_f32_16x16x32_bf16 v[156:159], v[76:79], v[44:47], v[156:159]
ds_read_b64_tr_b16 v[126:127], v8 offset:63488
s_waitcnt lgkmcnt(0)
v_max3_u32 v19, v80, v81, v82
v_max3_u32 v19, v19, v83, v84
v_max3_u32 v19, v19, v85, v86
v_max3_u32 v19, v19, v87, v88
v_max3_u32 v19, v19, v89, v90
v_max3_u32 v19, v19, v91, v92
v_max3_u32 v19, v19, v93, v94
v_max_u32 v19, v19, v95
v_cmp_eq_u32 vcc, -1, v19
s_nop 4
s_cbranch_vccnz Lfx_71
Lok_69:
s_barrier
v_mfma_f32_16x16x32_bf16 v[128:131], v[96:99], v[80:83], v[128:131]
ds_read_b128 v[32:35], v2 offset:0
ds_read_b64_tr_b16 v[48:49], v9 offset:0
v_mfma_f32_16x16x32_bf16 v[132:135], v[100:103], v[80:83], v[132:135]
ds_read_b64_tr_b16 v[50:51], v9 offset:2048
v_mfma_f32_16x16x32_bf16 v[136:139], v[104:107], v[80:83], v[136:139]
ds_read_b64_tr_b16 v[52:53], v10 offset:0
v_mfma_f32_16x16x32_bf16 v[140:143], v[108:111], v[80:83], v[140:143]
ds_read_b64_tr_b16 v[54:55], v10 offset:2048
v_mfma_f32_16x16x32_bf16 v[144:147], v[96:99], v[84:87], v[144:147]
ds_read_b128 v[36:39], v2 offset:256
ds_read_b64_tr_b16 v[56:57], v11 offset:0
v_mfma_f32_16x16x32_bf16 v[148:151], v[100:103], v[84:87], v[148:151]
ds_read_b64_tr_b16 v[58:59], v11 offset:2048
v_mfma_f32_16x16x32_bf16 v[152:155], v[104:107], v[84:87], v[152:155]
ds_read_b64_tr_b16 v[60:61], v12 offset:0
v_mfma_f32_16x16x32_bf16 v[156:159], v[108:111], v[84:87], v[156:159]
ds_read_b64_tr_b16 v[62:63], v12 offset:2048
v_mfma_f32_16x16x32_bf16 v[128:131], v[112:115], v[88:91], v[128:131]
ds_read_b128 v[40:43], v2 offset:8192
ds_read_b64_tr_b16 v[64:65], v9 offset:4096
v_mfma_f32_16x16x32_bf16 v[132:135], v[116:119], v[88:91], v[132:135]
ds_read_b64_tr_b16 v[66:67], v9 offset:6144
v_mfma_f32_16x16x32_bf16 v[136:139], v[120:123], v[88:91], v[136:139]
ds_read_b64_tr_b16 v[68:69], v10 offset:4096
v_mfma_f32_16x16x32_bf16 v[140:143], v[124:127], v[88:91], v[140:143]
ds_read_b64_tr_b16 v[70:71], v10 offset:6144
v_mfma_f32_16x16x32_bf16 v[144:147], v[112:115], v[92:95], v[144:147]
ds_read_b128 v[44:47], v2 offset:8448
ds_read_b64_tr_b16 v[72:73], v11 offset:4096
v_mfma_f32_16x16x32_bf16 v[148:151], v[116:119], v[92:95], v[148:151]
ds_read_b64_tr_b16 v[74:75], v11 offset:6144
v_mfma_f32_16x16x32_bf16 v[152:155], v[120:123], v[92:95], v[152:155]
ds_read_b64_tr_b16 v[76:77], v12 offset:4096
v_mfma_f32_16x16x32_bf16 v[156:159], v[124:127], v[92:95], v[156:159]
ds_read_b64_tr_b16 v[78:79], v12 offset:6144
s_waitcnt lgkmcnt(0)
v_max3_u32 v19, v32, v33, v34
v_max3_u32 v19, v19, v35, v36
v_max3_u32 v19, v19, v37, v38
v_max3_u32 v19, v19, v39, v40
v_max3_u32 v19, v19, v41, v42
v_max3_u32 v19, v19, v43, v44
v_max3_u32 v19, v19, v45, v46
v_max_u32 v19, v19, v47
v_cmp_eq_u32 vcc, -1, v19
s_nop 4
s_cbranch_vccnz Lfx_74
Lok_72:
s_barrier
v_mfma_f32_16x16x32_bf16 v[128:131], v[48:51], v[32:35], v[128:131]
ds_read_b128 v[80:83], v2 offset:16384
ds_read_b64_tr_b16 v[96:97], v9 offset:8192
v_mfma_f32_16x16x32_bf16 v[132:135], v[52:55], v[32:35], v[132:135]
ds_read_b64_tr_b16 v[98:99], v9 offset:10240
v_mfma_f32_16x16x32_bf16 v[136:139], v[56:59], v[32:35], v[136:139]
ds_read_b64_tr_b16 v[100:101], v10 offset:8192
v_mfma_f32_16x16x32_bf16 v[140:143], v[60:63], v[32:35], v[140:143]
ds_read_b64_tr_b16 v[102:103], v10 offset:10240
v_mfma_f32_16x16x32_bf16 v[144:147], v[48:51], v[36:39], v[144:147]
ds_read_b128 v[84:87], v2 offset:16640
ds_read_b64_tr_b16 v[104:105], v11 offset:8192
v_mfma_f32_16x16x32_bf16 v[148:151], v[52:55], v[36:39], v[148:151]
ds_read_b64_tr_b16 v[106:107], v11 offset:10240
v_mfma_f32_16x16x32_bf16 v[152:155], v[56:59], v[36:39], v[152:155]
ds_read_b64_tr_b16 v[108:109], v12 offset:8192
v_mfma_f32_16x16x32_bf16 v[156:159], v[60:63], v[36:39], v[156:159]
ds_read_b64_tr_b16 v[110:111], v12 offset:10240
v_mfma_f32_16x16x32_bf16 v[128:131], v[64:67], v[40:43], v[128:131]
ds_read_b128 v[88:91], v2 offset:24576
ds_read_b64_tr_b16 v[112:113], v9 offset:12288
v_mfma_f32_16x16x32_bf16 v[132:135], v[68:71], v[40:43], v[132:135]
ds_read_b64_tr_b16 v[114:115], v9 offset:14336
v_mfma_f32_16x16x32_bf16 v[136:139], v[72:75], v[40:43], v[136:139]
ds_read_b64_tr_b16 v[116:117], v10 offset:12288
v_mfma_f32_16x16x32_bf16 v[140:143], v[76:79], v[40:43], v[140:143]
ds_read_b64_tr_b16 v[118:119], v10 offset:14336
v_mfma_f32_16x16x32_bf16 v[144:147], v[64:67], v[44:47], v[144:147]
ds_read_b128 v[92:95], v2 offset:24832
ds_read_b64_tr_b16 v[120:121], v11 offset:12288
v_mfma_f32_16x16x32_bf16 v[148:151], v[68:71], v[44:47], v[148:151]
ds_read_b64_tr_b16 v[122:123], v11 offset:14336
v_mfma_f32_16x16x32_bf16 v[152:155], v[72:75], v[44:47], v[152:155]
ds_read_b64_tr_b16 v[124:125], v12 offset:12288
v_mfma_f32_16x16x32_bf16 v[156:159], v[76:79], v[44:47], v[156:159]
ds_read_b64_tr_b16 v[126:127], v12 offset:14336
s_waitcnt lgkmcnt(0)
v_max3_u32 v19, v80, v81, v82
v_max3_u32 v19, v19, v83, v84
v_max3_u32 v19, v19, v85, v86
v_max3_u32 v19, v19, v87, v88
v_max3_u32 v19, v19, v89, v90
v_max3_u32 v19, v19, v91, v92
v_max3_u32 v19, v19, v93, v94
v_max_u32 v19, v19, v95
v_cmp_eq_u32 vcc, -1, v19
s_nop 4
s_cbranch_vccnz Lfx_77
Lok_75:
s_barrier
v_mfma_f32_16x16x32_bf16 v[128:131], v[96:99], v[80:83], v[128:131]
ds_read_b128 v[32:35], v2 offset:32768
ds_read_b64_tr_b16 v[48:49], v5 offset:0
v_mfma_f32_16x16x32_bf16 v[132:135], v[100:103], v[80:83], v[132:135]
ds_read_b64_tr_b16 v[50:51], v5 offset:2048
v_mfma_f32_16x16x32_bf16 v[136:139], v[104:107], v[80:83], v[136:139]
ds_read_b64_tr_b16 v[52:53], v6 offset:0
v_mfma_f32_16x16x32_bf16 v[140:143], v[108:111], v[80:83], v[140:143]
ds_read_b64_tr_b16 v[54:55], v6 offset:2048
v_mfma_f32_16x16x32_bf16 v[144:147], v[96:99], v[84:87], v[144:147]
ds_read_b128 v[36:39], v2 offset:33024
ds_read_b64_tr_b16 v[56:57], v7 offset:0
v_mfma_f32_16x16x32_bf16 v[148:151], v[100:103], v[84:87], v[148:151]
ds_read_b64_tr_b16 v[58:59], v7 offset:2048
v_mfma_f32_16x16x32_bf16 v[152:155], v[104:107], v[84:87], v[152:155]
ds_read_b64_tr_b16 v[60:61], v8 offset:0
v_mfma_f32_16x16x32_bf16 v[156:159], v[108:111], v[84:87], v[156:159]
ds_read_b64_tr_b16 v[62:63], v8 offset:2048
v_mfma_f32_16x16x32_bf16 v[128:131], v[112:115], v[88:91], v[128:131]
ds_read_b128 v[40:43], v2 offset:40960
ds_read_b64_tr_b16 v[64:65], v5 offset:4096
v_mfma_f32_16x16x32_bf16 v[132:135], v[116:119], v[88:91], v[132:135]
ds_read_b64_tr_b16 v[66:67], v5 offset:6144
v_mfma_f32_16x16x32_bf16 v[136:139], v[120:123], v[88:91], v[136:139]
ds_read_b64_tr_b16 v[68:69], v6 offset:4096
v_mfma_f32_16x16x32_bf16 v[140:143], v[124:127], v[88:91], v[140:143]
ds_read_b64_tr_b16 v[70:71], v6 offset:6144
v_mfma_f32_16x16x32_bf16 v[144:147], v[112:115], v[92:95], v[144:147]
ds_read_b128 v[44:47], v2 offset:41216
ds_read_b64_tr_b16 v[72:73], v7 offset:4096
v_mfma_f32_16x16x32_bf16 v[148:151], v[116:119], v[92:95], v[148:151]
ds_read_b64_tr_b16 v[74:75], v7 offset:6144
v_mfma_f32_16x16x32_bf16 v[152:155], v[120:123], v[92:95], v[152:155]
ds_read_b64_tr_b16 v[76:77], v8 offset:4096
v_mfma_f32_16x16x32_bf16 v[156:159], v[124:127], v[92:95], v[156:159]
ds_read_b64_tr_b16 v[78:79], v8 offset:6144
s_waitcnt lgkmcnt(0)
v_max3_u32 v19, v32, v33, v34
v_max3_u32 v19, v19, v35, v36
v_max3_u32 v19, v19, v37, v38
v_max3_u32 v19, v19, v39, v40
v_max3_u32 v19, v19, v41, v42
v_max3_u32 v19, v19, v43, v44
v_max3_u32 v19, v19, v45, v46
v_max_u32 v19, v19, v47
v_cmp_eq_u32 vcc, -1, v19
s_nop 4
s_cbranch_vccnz Lfx_80
Lok_78:
s_barrier
v_mfma_f32_16x16x32_bf16 v[128:131], v[48:51], v[32:35], v[128:131]
ds_read_b128 v[80:83], v2 offset:49152
ds_read_b64_tr_b16 v[96:97], v5 offset:8192
v_mfma_f32_16x16x32_bf16 v[132:135], v[52:55], v[32:35], v[132:135]
ds_read_b64_tr_b16 v[98:99], v5 offset:10240
v_mfma_f32_16x16x32_bf16 v[136:139], v[56:59], v[32:35], v[136:139]
ds_read_b64_tr_b16 v[100:101], v6 offset:8192
v_mfma_f32_16x16x32_bf16 v[140:143], v[60:63], v[32:35], v[140:143]
ds_read_b64_tr_b16 v[102:103], v6 offset:10240
v_mfma_f32_16x16x32_bf16 v[144:147], v[48:51], v[36:39], v[144:147]
ds_read_b128 v[84:87], v2 offset:49408
ds_read_b64_tr_b16 v[104:105], v7 offset:8192
v_mfma_f32_16x16x32_bf16 v[148:151], v[52:55], v[36:39], v[148:151]
ds_read_b64_tr_b16 v[106:107], v7 offset:10240
v_mfma_f32_16x16x32_bf16 v[152:155], v[56:59], v[36:39], v[152:155]
ds_read_b64_tr_b16 v[108:109], v8 offset:8192
v_mfma_f32_16x16x32_bf16 v[156:159], v[60:63], v[36:39], v[156:159]
ds_read_b64_tr_b16 v[110:111], v8 offset:10240
v_mfma_f32_16x16x32_bf16 v[128:131], v[64:67], v[40:43], v[128:131]
ds_read_b128 v[88:91], v2 offset:57344
ds_read_b64_tr_b16 v[112:113], v5 offset:12288
v_mfma_f32_16x16x32_bf16 v[132:135], v[68:71], v[40:43], v[132:135]
ds_read_b64_tr_b16 v[114:115], v5 offset:14336
v_mfma_f32_16x16x32_bf16 v[136:139], v[72:75], v[40:43], v[136:139]
ds_read_b64_tr_b16 v[116:117], v6 offset:12288
v_mfma_f32_16x16x32_bf16 v[140:143], v[76:79], v[40:43], v[140:143]
ds_read_b64_tr_b16 v[118:119], v6 offset:14336
v_mfma_f32_16x16x32_bf16 v[144:147], v[64:67], v[44:47], v[144:147]
ds_read_b128 v[92:95], v2 offset:57600
ds_read_b64_tr_b16 v[120:121], v7 offset:12288
v_mfma_f32_16x16x32_bf16 v[148:151], v[68:71], v[44:47], v[148:151]
ds_read_b64_tr_b16 v[122:123], v7 offset:14336
v_mfma_f32_16x16x32_bf16 v[152:155], v[72:75], v[44:47], v[152:155]
ds_read_b64_tr_b16 v[124:125], v8 offset:12288
v_mfma_f32_16x16x32_bf16 v[156:159], v[76:79], v[44:47], v[156:159]
ds_read_b64_tr_b16 v[126:127], v8 offset:14336
s_waitcnt lgkmcnt(0)
s_barrier
v_mfma_f32_16x16x32_bf16 v[128:131], v[96:99], v[80:83], v[128:131]
ds_read_b128 v[32:35], v2 offset:0
ds_read_b64_tr_b16 v[48:49], v5 offset:16384
v_mfma_f32_16x16x32_bf16 v[132:135], v[100:103], v[80:83], v[132:135]
ds_read_b64_tr_b16 v[50:51], v5 offset:18432
v_mfma_f32_16x16x32_bf16 v[136:139], v[104:107], v[80:83], v[136:139]
ds_read_b64_tr_b16 v[52:53], v6 offset:16384
v_mfma_f32_16x16x32_bf16 v[140:143], v[108:111], v[80:83], v[140:143]
ds_read_b64_tr_b16 v[54:55], v6 offset:18432
v_mfma_f32_16x16x32_bf16 v[144:147], v[96:99], v[84:87], v[144:147]
ds_read_b128 v[36:39], v2 offset:256
ds_read_b64_tr_b16 v[56:57], v7 offset:16384
v_mfma_f32_16x16x32_bf16 v[148:151], v[100:103], v[84:87], v[148:151]
ds_read_b64_tr_b16 v[58:59], v7 offset:18432
v_mfma_f32_16x16x32_bf16 v[152:155], v[104:107], v[84:87], v[152:155]
ds_read_b64_tr_b16 v[60:61], v8 offset:16384
v_mfma_f32_16x16x32_bf16 v[156:159], v[108:111], v[84:87], v[156:159]
ds_read_b64_tr_b16 v[62:63], v8 offset:18432
v_mfma_f32_16x16x32_bf16 v[128:131], v[112:115], v[88:91], v[128:131]
ds_read_b128 v[40:43], v2 offset:8192
ds_read_b64_tr_b16 v[64:65], v5 offset:20480
v_mfma_f32_16x16x32_bf16 v[132:135], v[116:119], v[88:91], v[132:135]
ds_read_b64_tr_b16 v[66:67], v5 offset:22528
v_mfma_f32_16x16x32_bf16 v[136:139], v[120:123], v[88:91], v[136:139]
ds_read_b64_tr_b16 v[68:69], v6 offset:20480
v_mfma_f32_16x16x32_bf16 v[140:143], v[124:127], v[88:91], v[140:143]
ds_read_b64_tr_b16 v[70:71], v6 offset:22528
v_mfma_f32_16x16x32_bf16 v[144:147], v[112:115], v[92:95], v[144:147]
ds_read_b128 v[44:47], v2 offset:8448
ds_read_b64_tr_b16 v[72:73], v7 offset:20480
v_mfma_f32_16x16x32_bf16 v[148:151], v[116:119], v[92:95], v[148:151]
ds_read_b64_tr_b16 v[74:75], v7 offset:22528
v_mfma_f32_16x16x32_bf16 v[152:155], v[120:123], v[92:95], v[152:155]
ds_read_b64_tr_b16 v[76:77], v8 offset:20480
v_mfma_f32_16x16x32_bf16 v[156:159], v[124:127], v[92:95], v[156:159]
ds_read_b64_tr_b16 v[78:79], v8 offset:22528
s_waitcnt lgkmcnt(0)
s_barrier
v_mfma_f32_16x16x32_bf16 v[128:131], v[48:51], v[32:35], v[128:131]
ds_read_b128 v[80:83], v2 offset:16384
ds_read_b64_tr_b16 v[96:97], v5 offset:24576
v_mfma_f32_16x16x32_bf16 v[132:135], v[52:55], v[32:35], v[132:135]
ds_read_b64_tr_b16 v[98:99], v5 offset:26624
v_mfma_f32_16x16x32_bf16 v[136:139], v[56:59], v[32:35], v[136:139]
ds_read_b64_tr_b16 v[100:101], v6 offset:24576
v_mfma_f32_16x16x32_bf16 v[140:143], v[60:63], v[32:35], v[140:143]
ds_read_b64_tr_b16 v[102:103], v6 offset:26624
v_mfma_f32_16x16x32_bf16 v[144:147], v[48:51], v[36:39], v[144:147]
ds_read_b128 v[84:87], v2 offset:16640
ds_read_b64_tr_b16 v[104:105], v7 offset:24576
v_mfma_f32_16x16x32_bf16 v[148:151], v[52:55], v[36:39], v[148:151]
ds_read_b64_tr_b16 v[106:107], v7 offset:26624
v_mfma_f32_16x16x32_bf16 v[152:155], v[56:59], v[36:39], v[152:155]
ds_read_b64_tr_b16 v[108:109], v8 offset:24576
v_mfma_f32_16x16x32_bf16 v[156:159], v[60:63], v[36:39], v[156:159]
ds_read_b64_tr_b16 v[110:111], v8 offset:26624
v_mfma_f32_16x16x32_bf16 v[128:131], v[64:67], v[40:43], v[128:131]
ds_read_b128 v[88:91], v2 offset:24576
ds_read_b64_tr_b16 v[112:113], v5 offset:28672
v_mfma_f32_16x16x32_bf16 v[132:135], v[68:71], v[40:43], v[132:135]
ds_read_b64_tr_b16 v[114:115], v5 offset:30720
v_mfma_f32_16x16x32_bf16 v[136:139], v[72:75], v[40:43], v[136:139]
ds_read_b64_tr_b16 v[116:117], v6 offset:28672
v_mfma_f32_16x16x32_bf16 v[140:143], v[76:79], v[40:43], v[140:143]
ds_read_b64_tr_b16 v[118:119], v6 offset:30720
v_mfma_f32_16x16x32_bf16 v[144:147], v[64:67], v[44:47], v[144:147]
ds_read_b128 v[92:95], v2 offset:24832
ds_read_b64_tr_b16 v[120:121], v7 offset:28672
v_mfma_f32_16x16x32_bf16 v[148:151], v[68:71], v[44:47], v[148:151]
ds_read_b64_tr_b16 v[122:123], v7 offset:30720
v_mfma_f32_16x16x32_bf16 v[152:155], v[72:75], v[44:47], v[152:155]
ds_read_b64_tr_b16 v[124:125], v8 offset:28672
v_mfma_f32_16x16x32_bf16 v[156:159], v[76:79], v[44:47], v[156:159]
ds_read_b64_tr_b16 v[126:127], v8 offset:30720
s_waitcnt lgkmcnt(0)
s_barrier
v_mfma_f32_16x16x32_bf16 v[128:131], v[96:99], v[80:83], v[128:131]
ds_read_b128 v[32:35], v2 offset:32768
ds_read_b64_tr_b16 v[48:49], v5 offset:32768
v_mfma_f32_16x16x32_bf16 v[132:135], v[100:103], v[80:83], v[132:135]
ds_read_b64_tr_b16 v[50:51], v5 offset:34816
v_mfma_f32_16x16x32_bf16 v[136:139], v[104:107], v[80:83], v[136:139]
ds_read_b64_tr_b16 v[52:53], v6 offset:32768
v_mfma_f32_16x16x32_bf16 v[140:143], v[108:111], v[80:83], v[140:143]
ds_read_b64_tr_b16 v[54:55], v6 offset:34816
v_mfma_f32_16x16x32_bf16 v[144:147], v[96:99], v[84:87], v[144:147]
ds_read_b128 v[36:39], v2 offset:33024
ds_read_b64_tr_b16 v[56:57], v7 offset:32768
v_mfma_f32_16x16x32_bf16 v[148:151], v[100:103], v[84:87], v[148:151]
ds_read_b64_tr_b16 v[58:59], v7 offset:34816
v_mfma_f32_16x16x32_bf16 v[152:155], v[104:107], v[84:87], v[152:155]
ds_read_b64_tr_b16 v[60:61], v8 offset:32768
v_mfma_f32_16x16x32_bf16 v[156:159], v[108:111], v[84:87], v[156:159]
ds_read_b64_tr_b16 v[62:63], v8 offset:34816
v_mfma_f32_16x16x32_bf16 v[128:131], v[112:115], v[88:91], v[128:131]
ds_read_b128 v[40:43], v2 offset:40960
ds_read_b64_tr_b16 v[64:65], v5 offset:36864
v_mfma_f32_16x16x32_bf16 v[132:135], v[116:119], v[88:91], v[132:135]
ds_read_b64_tr_b16 v[66:67], v5 offset:38912
v_mfma_f32_16x16x32_bf16 v[136:139], v[120:123], v[88:91], v[136:139]
ds_read_b64_tr_b16 v[68:69], v6 offset:36864
v_mfma_f32_16x16x32_bf16 v[140:143], v[124:127], v[88:91], v[140:143]
ds_read_b64_tr_b16 v[70:71], v6 offset:38912
v_mfma_f32_16x16x32_bf16 v[144:147], v[112:115], v[92:95], v[144:147]
ds_read_b128 v[44:47], v2 offset:41216
ds_read_b64_tr_b16 v[72:73], v7 offset:36864
v_mfma_f32_16x16x32_bf16 v[148:151], v[116:119], v[92:95], v[148:151]
ds_read_b64_tr_b16 v[74:75], v7 offset:38912
v_mfma_f32_16x16x32_bf16 v[152:155], v[120:123], v[92:95], v[152:155]
ds_read_b64_tr_b16 v[76:77], v8 offset:36864
v_mfma_f32_16x16x32_bf16 v[156:159], v[124:127], v[92:95], v[156:159]
ds_read_b64_tr_b16 v[78:79], v8 offset:38912
s_waitcnt lgkmcnt(0)
s_barrier
v_mfma_f32_16x16x32_bf16 v[128:131], v[48:51], v[32:35], v[128:131]
ds_read_b128 v[80:83], v2 offset:49152
ds_read_b64_tr_b16 v[96:97], v5 offset:40960
v_mfma_f32_16x16x32_bf16 v[132:135], v[52:55], v[32:35], v[132:135]
ds_read_b64_tr_b16 v[98:99], v5 offset:43008
v_mfma_f32_16x16x32_bf16 v[136:139], v[56:59], v[32:35], v[136:139]
ds_read_b64_tr_b16 v[100:101], v6 offset:40960
v_mfma_f32_16x16x32_bf16 v[140:143], v[60:63], v[32:35], v[140:143]
ds_read_b64_tr_b16 v[102:103], v6 offset:43008
v_mfma_f32_16x16x32_bf16 v[144:147], v[48:51], v[36:39], v[144:147]
ds_read_b128 v[84:87], v2 offset:49408
ds_read_b64_tr_b16 v[104:105], v7 offset:40960
v_mfma_f32_16x16x32_bf16 v[148:151], v[52:55], v[36:39], v[148:151]
ds_read_b64_tr_b16 v[106:107], v7 offset:43008
v_mfma_f32_16x16x32_bf16 v[152:155], v[56:59], v[36:39], v[152:155]
ds_read_b64_tr_b16 v[108:109], v8 offset:40960
v_mfma_f32_16x16x32_bf16 v[156:159], v[60:63], v[36:39], v[156:159]
ds_read_b64_tr_b16 v[110:111], v8 offset:43008
v_mfma_f32_16x16x32_bf16 v[128:131], v[64:67], v[40:43], v[128:131]
ds_read_b128 v[88:91], v2 offset:57344
ds_read_b64_tr_b16 v[112:113], v5 offset:45056
v_mfma_f32_16x16x32_bf16 v[132:135], v[68:71], v[40:43], v[132:135]
ds_read_b64_tr_b16 v[114:115], v5 offset:47104
v_mfma_f32_16x16x32_bf16 v[136:139], v[72:75], v[40:43], v[136:139]
ds_read_b64_tr_b16 v[116:117], v6 offset:45056
v_mfma_f32_16x16x32_bf16 v[140:143], v[76:79], v[40:43], v[140:143]
ds_read_b64_tr_b16 v[118:119], v6 offset:47104
v_mfma_f32_16x16x32_bf16 v[144:147], v[64:67], v[44:47], v[144:147]
ds_read_b128 v[92:95], v2 offset:57600
ds_read_b64_tr_b16 v[120:121], v7 offset:45056
v_mfma_f32_16x16x32_bf16 v[148:151], v[68:71], v[44:47], v[148:151]
ds_read_b64_tr_b16 v[122:123], v7 offset:47104
v_mfma_f32_16x16x32_bf16 v[152:155], v[72:75], v[44:47], v[152:155]
ds_read_b64_tr_b16 v[124:125], v8 offset:45056
v_mfma_f32_16x16x32_bf16 v[156:159], v[76:79], v[44:47], v[156:159]
ds_read_b64_tr_b16 v[126:127], v8 offset:47104
s_waitcnt lgkmcnt(0)
s_barrier
v_mfma_f32_16x16x32_bf16 v[128:131], v[96:99], v[80:83], v[128:131]
v_mfma_f32_16x16x32_bf16 v[132:135], v[100:103], v[80:83], v[132:135]
v_mfma_f32_16x16x32_bf16 v[136:139], v[104:107], v[80:83], v[136:139]
v_mfma_f32_16x16x32_bf16 v[140:143], v[108:111], v[80:83], v[140:143]
v_mfma_f32_16x16x32_bf16 v[144:147], v[96:99], v[84:87], v[144:147]
v_mfma_f32_16x16x32_bf16 v[148:151], v[100:103], v[84:87], v[148:151]
v_mfma_f32_16x16x32_bf16 v[152:155], v[104:107], v[84:87], v[152:155]
v_mfma_f32_16x16x32_bf16 v[156:159], v[108:111], v[84:87], v[156:159]
v_mfma_f32_16x16x32_bf16 v[128:131], v[112:115], v[88:91], v[128:131]
v_mfma_f32_16x16x32_bf16 v[132:135], v[116:119], v[88:91], v[132:135]
v_mfma_f32_16x16x32_bf16 v[136:139], v[120:123], v[88:91], v[136:139]
v_mfma_f32_16x16x32_bf16 v[140:143], v[124:127], v[88:91], v[140:143]
v_mfma_f32_16x16x32_bf16 v[144:147], v[112:115], v[92:95], v[144:147]
v_mfma_f32_16x16x32_bf16 v[148:151], v[116:119], v[92:95], v[148:151]
v_mfma_f32_16x16x32_bf16 v[152:155], v[120:123], v[92:95], v[152:155]
v_mfma_f32_16x16x32_bf16 v[156:159], v[124:127], v[92:95], v[156:159]
s_nop 4
v_cvt_pk_bf16_f32 v96, v128, v129
v_cvt_pk_bf16_f32 v97, v130, v131
v_cvt_pk_bf16_f32 v98, v132, v133
v_cvt_pk_bf16_f32 v99, v134, v135
buffer_store_dwordx4 v[96:99], v2, s[20:23], 0 offen offset:0 sc1
ds_write_b128 v4, v[96:99] offset:0
v_cvt_pk_bf16_f32 v100, v136, v137
v_cvt_pk_bf16_f32 v101, v138, v139
v_cvt_pk_bf16_f32 v102, v140, v141
v_cvt_pk_bf16_f32 v103, v142, v143
buffer_store_dwordx4 v[100:103], v2, s[20:23], s50 offen offset:0 sc1
ds_write_b128 v4, v[100:103] offset:8192
v_cvt_pk_bf16_f32 v104, v144, v145
v_cvt_pk_bf16_f32 v105, v146, v147
v_cvt_pk_bf16_f32 v106, v148, v149
v_cvt_pk_bf16_f32 v107, v150, v151
buffer_store_dwordx4 v[104:107], v2, s[20:23], 0 offen offset:256 sc1
ds_write_b128 v4, v[104:107] offset:256
v_cvt_pk_bf16_f32 v108, v152, v153
v_cvt_pk_bf16_f32 v109, v154, v155
v_cvt_pk_bf16_f32 v110, v156, v157
v_cvt_pk_bf16_f32 v111, v158, v159
buffer_store_dwordx4 v[108:111], v2, s[20:23], s50 offen offset:256 sc1
ds_write_b128 v4, v[108:111] offset:8448
v_pk_mul_f32 v[118:119], v[128:129], v[128:129]
v_pk_mul_f32 v[122:123], v[144:145], v[144:145]
v_pk_fma_f32 v[118:119], v[130:131], v[130:131], v[118:119]
v_pk_add_f32 v[116:117], v[130:131], v[128:129]
v_pk_fma_f32 v[122:123], v[146:147], v[146:147], v[122:123]
v_pk_add_f32 v[120:121], v[146:147], v[144:145]
v_pk_fma_f32 v[118:119], v[132:133], v[132:133], v[118:119]
v_pk_add_f32 v[116:117], v[132:133], v[116:117]
v_pk_fma_f32 v[122:123], v[148:149], v[148:149], v[122:123]
v_pk_add_f32 v[120:121], v[148:149], v[120:121]
v_pk_fma_f32 v[118:119], v[134:135], v[134:135], v[118:119]
v_pk_add_f32 v[116:117], v[134:135], v[116:117]
v_pk_fma_f32 v[122:123], v[150:151], v[150:151], v[122:123]
v_pk_add_f32 v[120:121], v[150:151], v[120:121]
v_pk_fma_f32 v[118:119], v[136:137], v[136:137], v[118:119]
v_pk_add_f32 v[116:117], v[136:137], v[116:117]
v_pk_fma_f32 v[122:123], v[152:153], v[152:153], v[122:123]
v_pk_add_f32 v[120:121], v[152:153], v[120:121]
v_pk_fma_f32 v[118:119], v[138:139], v[138:139], v[118:119]
v_pk_add_f32 v[116:117], v[138:139], v[116:117]
v_pk_fma_f32 v[122:123], v[154:155], v[154:155], v[122:123]
v_pk_add_f32 v[120:121], v[154:155], v[120:121]
v_pk_fma_f32 v[118:119], v[140:141], v[140:141], v[118:119]
v_pk_add_f32 v[116:117], v[140:141], v[116:117]
v_pk_fma_f32 v[122:123], v[156:157], v[156:157], v[122:123]
v_pk_add_f32 v[120:121], v[156:157], v[120:121]
v_pk_fma_f32 v[118:119], v[142:143], v[142:143], v[118:119]
v_pk_add_f32 v[116:117], v[142:143], v[116:117]
v_pk_fma_f32 v[122:123], v[158:159], v[158:159], v[122:123]
v_pk_add_f32 v[120:121], v[158:159], v[120:121]
v_add_f32 v112, v116, v117
v_add_f32 v113, v118, v119
v_add_f32 v114, v120, v121
v_add_f32 v115, v122, v123
s_nop 1
v_permlane32_swap_b32 v112, v114
v_permlane32_swap_b32 v113, v115
v_add_f32 v112, v112, v114
v_add_f32 v113, v113, v115
s_nop 1
v_permlane16_swap_b32 v112, v113
v_add_f32 v112, v112, v113
buffer_store_dword v112, v22, s[24:27], 0 offen sc1
s_waitcnt lgkmcnt(0)
s_barrier
s_lshl_b32 s53, s47, 2
v_lshlrev_b32 v19, 11, v18
v_lshl_add_u32 v19, v17, 4, v19
s_lshl_b32 s43, s46, 10
v_add_u32 v2, s43, v19
v_add_u32 v3, 49152, v2
v_add_u32 v4, 98304, v2
v_lshrrev_b32 v19, 2, v17
v_lshl_add_u32 v20, v18, 2, v19
v_and_b32 v21, 7, v20
v_lshlrev_b32 v20, 8, v20
v_and_b32 v19, 3, v1
v_lshl_add_u32 v20, v19, 3, v20
s_add_u32 s43, s53, 0
v_xor_b32 v19, s43, v21
v_lshl_add_u32 v5, v19, 5, v20
s_add_u32 s43, s53, 1
v_xor_b32 v19, s43, v21
v_lshl_add_u32 v6, v19, 5, v20
s_add_u32 s43, s53, 2
v_xor_b32 v19, s43, v21
v_lshl_add_u32 v7, v19, 5, v20
s_add_u32 s43, s53, 3
v_xor_b32 v19, s43, v21
v_lshl_add_u32 v8, v19, 5, v20
v_add_u32 v9, 49152, v5
v_add_u32 v10, 49152, v6
v_add_u32 v11, 49152, v7
v_add_u32 v12, 49152, v8
v_add_u32 v13, 98304, v5
v_add_u32 v14, 98304, v6
v_add_u32 v15, 98304, v7
v_add_u32 v16, 98304, v8
ds_read_b128 v[32:35], v4 offset:0
ds_read_b64_tr_b16 v[48:49], v13 offset:16384
ds_read_b64_tr_b16 v[50:51], v13 offset:20480
ds_read_b128 v[36:39], v4 offset:256
ds_read_b128 v[40:43], v4 offset:512
ds_read_b128 v[44:47], v4 offset:768
ds_read_b64_tr_b16 v[64:65], v13 offset:32768
ds_read_b64_tr_b16 v[66:67], v13 offset:36864
ds_read_b64_tr_b16 v[52:53], v14 offset:16384
ds_read_b64_tr_b16 v[54:55], v14 offset:20480
ds_read_b64_tr_b16 v[68:69], v14 offset:32768
ds_read_b64_tr_b16 v[70:71], v14 offset:36864
ds_read_b64_tr_b16 v[56:57], v15 offset:16384
ds_read_b64_tr_b16 v[58:59], v15 offset:20480
ds_read_b64_tr_b16 v[72:73], v15 offset:32768
ds_read_b64_tr_b16 v[74:75], v15 offset:36864
ds_read_b64_tr_b16 v[60:61], v16 offset:16384
ds_read_b64_tr_b16 v[62:63], v16 offset:20480
ds_read_b64_tr_b16 v[76:77], v16 offset:32768
ds_read_b64_tr_b16 v[78:79], v16 offset:36864
s_waitcnt lgkmcnt(0)
v_mfma_f32_16x16x32_bf16 v[128:131], v[48:51], v[32:35], 0
ds_read_b128 v[80:83], v4 offset:8192
v_mfma_f32_16x16x32_bf16 v[132:135], v[48:51], v[36:39], 0
ds_read_b64_tr_b16 v[96:97], v13 offset:24576
v_mfma_f32_16x16x32_bf16 v[136:139], v[48:51], v[40:43], 0
ds_read_b64_tr_b16 v[98:99], v13 offset:28672
v_mfma_f32_16x16x32_bf16 v[140:143], v[48:51], v[44:47], 0
ds_read_b128 v[84:87], v4 offset:8448
v_mfma_f32_16x16x32_bf16 v[204:207], v[64:67], v[44:47], 0
ds_read_b128 v[88:91], v4 offset:8704
v_mfma_f32_16x16x32_bf16 v[200:203], v[64:67], v[40:43], 0
ds_read_b128 v[92:95], v4 offset:8960
v_mfma_f32_16x16x32_bf16 v[196:199], v[64:67], v[36:39], 0
ds_read_b64_tr_b16 v[112:113], v13 offset:40960
v_mfma_f32_16x16x32_bf16 v[192:195], v[64:67], v[32:35], 0
ds_read_b64_tr_b16 v[114:115], v13 offset:45056
v_mfma_f32_16x16x32_bf16 v[144:147], v[52:55], v[32:35], 0
ds_read_b64_tr_b16 v[100:101], v14 offset:24576
v_mfma_f32_16x16x32_bf16 v[148:151], v[52:55], v[36:39], 0
ds_read_b64_tr_b16 v[102:103], v14 offset:28672
v_mfma_f32_16x16x32_bf16 v[152:155], v[52:55], v[40:43], 0
ds_read_b64_tr_b16 v[116:117], v14 offset:40960
v_mfma_f32_16x16x32_bf16 v[156:159], v[52:55], v[44:47], 0
ds_read_b64_tr_b16 v[118:119], v14 offset:45056
v_mfma_f32_16x16x32_bf16 v[220:223], v[68:71], v[44:47], 0
ds_read_b64_tr_b16 v[104:105], v15 offset:24576
v_mfma_f32_16x16x32_bf16 v[216:219], v[68:71], v[40:43], 0
ds_read_b64_tr_b16 v[106:107], v15 offset:28672
v_mfma_f32_16x16x32_bf16 v[212:215], v[68:71], v[36:39], 0
ds_read_b64_tr_b16 v[120:121], v15 offset:40960
v_mfma_f32_16x16x32_bf16 v[208:211], v[68:71], v[32:35], 0
ds_read_b64_tr_b16 v[122:123], v15 offset:45056
v_mfma_f32_16x16x32_bf16 v[160:163], v[56:59], v[32:35], 0
ds_read_b64_tr_b16 v[108:109], v16 offset:24576
v_mfma_f32_16x16x32_bf16 v[164:167], v[56:59], v[36:39], 0
ds_read_b64_tr_b16 v[110:111], v16 offset:28672
v_mfma_f32_16x16x32_bf16 v[168:171], v[56:59], v[40:43], 0
ds_read_b64_tr_b16 v[124:125], v16 offset:40960
v_mfma_f32_16x16x32_bf16 v[172:175], v[56:59], v[44:47], 0
ds_read_b64_tr_b16 v[126:127], v16 offset:45056
v_mfma_f32_16x16x32_bf16 v[236:239], v[72:75], v[44:47], 0
v_mfma_f32_16x16x32_bf16 v[232:235], v[72:75], v[40:43], 0
v_mfma_f32_16x16x32_bf16 v[228:231], v[72:75], v[36:39], 0
v_mfma_f32_16x16x32_bf16 v[224:227], v[72:75], v[32:35], 0
v_mfma_f32_16x16x32_bf16 v[176:179], v[60:63], v[32:35], 0
v_mfma_f32_16x16x32_bf16 v[180:183], v[60:63], v[36:39], 0
v_mfma_f32_16x16x32_bf16 v[184:187], v[60:63], v[40:43], 0
v_mfma_f32_16x16x32_bf16 v[188:191], v[60:63], v[44:47], 0
v_mfma_f32_16x16x32_bf16 v[252:255], v[76:79], v[44:47], 0
v_mfma_f32_16x16x32_bf16 v[248:251], v[76:79], v[40:43], 0
v_mfma_f32_16x16x32_bf16 v[244:247], v[76:79], v[36:39], 0
v_mfma_f32_16x16x32_bf16 v[240:243], v[76:79], v[32:35], 0
s_waitcnt lgkmcnt(0)
v_mfma_f32_16x16x32_bf16 v[128:131], v[96:99], v[80:83], v[128:131]
v_mfma_f32_16x16x32_bf16 v[132:135], v[96:99], v[84:87], v[132:135]
v_mfma_f32_16x16x32_bf16 v[136:139], v[96:99], v[88:91], v[136:139]
v_mfma_f32_16x16x32_bf16 v[140:143], v[96:99], v[92:95], v[140:143]
v_mfma_f32_16x16x32_bf16 v[204:207], v[112:115], v[92:95], v[204:207]
v_mfma_f32_16x16x32_bf16 v[200:203], v[112:115], v[88:91], v[200:203]
v_mfma_f32_16x16x32_bf16 v[196:199], v[112:115], v[84:87], v[196:199]
v_mfma_f32_16x16x32_bf16 v[192:195], v[112:115], v[80:83], v[192:195]
v_mfma_f32_16x16x32_bf16 v[144:147], v[100:103], v[80:83], v[144:147]
v_mfma_f32_16x16x32_bf16 v[148:151], v[100:103], v[84:87], v[148:151]
v_mfma_f32_16x16x32_bf16 v[152:155], v[100:103], v[88:91], v[152:155]
v_mfma_f32_16x16x32_bf16 v[156:159], v[100:103], v[92:95], v[156:159]
v_mfma_f32_16x16x32_bf16 v[220:223], v[116:119], v[92:95], v[220:223]
v_mfma_f32_16x16x32_bf16 v[216:219], v[116:119], v[88:91], v[216:219]
v_mfma_f32_16x16x32_bf16 v[212:215], v[116:119], v[84:87], v[212:215]
v_mfma_f32_16x16x32_bf16 v[208:211], v[116:119], v[80:83], v[208:211]
v_mfma_f32_16x16x32_bf16 v[160:163], v[104:107], v[80:83], v[160:163]
v_mfma_f32_16x16x32_bf16 v[164:167], v[104:107], v[84:87], v[164:167]
v_mfma_f32_16x16x32_bf16 v[168:171], v[104:107], v[88:91], v[168:171]
v_mfma_f32_16x16x32_bf16 v[172:175], v[104:107], v[92:95], v[172:175]
v_mfma_f32_16x16x32_bf16 v[236:239], v[120:123], v[92:95], v[236:239]
v_mfma_f32_16x16x32_bf16 v[232:235], v[120:123], v[88:91], v[232:235]
v_mfma_f32_16x16x32_bf16 v[228:231], v[120:123], v[84:87], v[228:231]
v_mfma_f32_16x16x32_bf16 v[224:227], v[120:123], v[80:83], v[224:227]
v_mfma_f32_16x16x32_bf16 v[176:179], v[108:111], v[80:83], v[176:179]
v_mfma_f32_16x16x32_bf16 v[180:183], v[108:111], v[84:87], v[180:183]
v_mfma_f32_16x16x32_bf16 v[184:187], v[108:111], v[88:91], v[184:187]
v_mfma_f32_16x16x32_bf16 v[188:191], v[108:111], v[92:95], v[188:191]
v_mfma_f32_16x16x32_bf16 v[252:255], v[124:127], v[92:95], v[252:255]
v_mfma_f32_16x16x32_bf16 v[248:251], v[124:127], v[88:91], v[248:251]
v_mfma_f32_16x16x32_bf16 v[244:247], v[124:127], v[84:87], v[244:247]
v_mfma_f32_16x16x32_bf16 v[240:243], v[124:127], v[80:83], v[240:243]
s_mul_i32 s43, s49, 192
s_and_b32 s43, s43, 0xffffff80
s_add_u32 s43, s43, 4096
s_cmp_eq_u32 s51, 1
s_cselect_b32 s8, s4, s6
s_cselect_b32 s9, s5, s7
s_sub_u32 s10, 7340032, s43
s_lshl_b32 s44, s34, 18
s_add_u32 s44, s44, 4194304
s_movk_i32 s38, 28672
s_cmp_eq_u32 s51, 0
s_cselect_b32 s8, s32, s8
s_cselect_b32 s9, s33, s9
s_cselect_b32 s10, 262144, s10
s_cselect_b32 s43, s44, s43
s_cselect_b32 s38, 1024, s38
s_cselect_b32 s45, 0, -1
s_add_u32 s8, s8, s43
s_addc_u32 s9, s9, 0
s_mov_b32 s11, 0x20000
s_lshl_b32 s40, s38, 4
s_mov_b32 s42, 1
s_lshl_b32 s39, s51, 14
v_lshrrev_b32 v19, 4, v1
v_lshlrev_b32 v20, 5, v19
v_mul_u32_u24 v19, 6912, v19
v_and_b32 v19, s45, v19
v_and_b32 v20, s45, v20
v_lshlrev_b32 v21, 4, v1
v_xor_b32 v21, v21, v20
v_add_u32 v22, v21, v19
s_and_b32 s45, s45, 128
v_xor_b32 v23, s45, v22
s_mul_i32 s43, s34, 917504
s_mul_i32 s44, s35, 16384
s_add_u32 s43, s43, s44
s_add_u32 s43, s43, 8388608
s_add_u32 s24, s32, s43
s_addc_u32 s25, s33, 0
s_mov_b32 s26, 278528
s_mov_b32 s27, 0x20000
s_mov_b32 s53, 262144
s_lshl_b32 s43, s47, 13
s_lshl_b32 s44, s46, 10
s_add_u32 s43, s43, s44
v_lshlrev_b32 v19, 11, v18
v_lshl_add_u32 v19, v17, 4, v19
v_add_u32 v27, s43, v19
s_lshl_b32 s43, s34, 18
s_lshl_b32 s44, s35, 7
s_add_u32 s43, s43, s44
s_add_u32 s16, s62, s43
s_addc_u32 s17, s63, 0
s_mov_b32 s18, 260224
s_mov_b32 s19, 0x20000
s_lshl_b32 s43, s46, 6
v_lshl_add_u32 v19, v17, 1, s43
v_lshlrev_b32 v19, 11, v19
v_and_b32 v20, 1, v18
v_lshl_add_u32 v19, v20, 5, v19
v_lshrrev_b32 v20, 1, v18
v_lshl_add_u32 v19, v20, 4, v19
s_lshl_b32 s43, s47, 6
v_add_u32 v28, s43, v19
s_lshl_b32 s43, s34, 4
s_add_u32 s43, s43, s35
s_xor_b32 s43, s43, 0
s_lshl_b32 s43, s43, 15
s_add_u32 s43, s43, 33554432
s_add_u32 s64, s32, s43
s_addc_u32 s65, s33, 0
s_mov_b32 s66, 32768
s_mov_b32 s67, 0x20000
s_lshl_b32 s43, s34, 4
s_add_u32 s43, s43, s35
s_xor_b32 s43, s43, 1
s_lshl_b32 s43, s43, 15
s_add_u32 s43, s43, 33554432
s_add_u32 s68, s32, s43
s_addc_u32 s69, s33, 0
s_mov_b32 s70, 32768
s_mov_b32 s71, 0x20000
s_lshl_b32 s43, s34, 18
s_add_u32 s12, s32, s43
s_addc_u32 s13, s33, 0
s_add_u32 s12, s12, 4194304
s_addc_u32 s13, s13, 0
s_mov_b32 s14, 262144
s_mov_b32 s15, 0x20000
v_lshlrev_b32 v21, 4, v1
s_lshl_b32 s54, s36, 11
s_xor_b32 s43, s35, 1
s_and_b32 s43, s43, 15
s_lshl_b32 s43, s43, 14
s_add_u32 s30, s43, s54
s_xor_b32 s43, s35, 2
s_and_b32 s43, s43, 15
s_lshl_b32 s43, s43, 14
s_add_u32 s31, s43, s54
s_waitcnt vmcnt(0)
s_barrier
s_setprio 1
ds_read_b128 v[32:35], v2 offset:0
ds_read_b64_tr_b16 v[48:49], v5 offset:16384
ds_read_b64_tr_b16 v[50:51], v5 offset:20480
ds_read_b128 v[36:39], v2 offset:256
ds_read_b128 v[40:43], v2 offset:512
ds_read_b128 v[44:47], v2 offset:768
ds_read_b64_tr_b16 v[64:65], v5 offset:32768
ds_read_b64_tr_b16 v[66:67], v5 offset:36864
ds_read_b64_tr_b16 v[52:53], v6 offset:16384
ds_read_b64_tr_b16 v[54:55], v6 offset:20480
ds_read_b64_tr_b16 v[68:69], v6 offset:32768
ds_read_b64_tr_b16 v[70:71], v6 offset:36864
ds_read_b64_tr_b16 v[56:57], v7 offset:16384
ds_read_b64_tr_b16 v[58:59], v7 offset:20480
ds_read_b64_tr_b16 v[72:73], v7 offset:32768
ds_read_b64_tr_b16 v[74:75], v7 offset:36864
ds_read_b64_tr_b16 v[60:61], v8 offset:16384
ds_read_b64_tr_b16 v[62:63], v8 offset:20480
ds_read_b64_tr_b16 v[76:77], v8 offset:32768
ds_read_b64_tr_b16 v[78:79], v8 offset:36864
s_waitcnt lgkmcnt(14)
v_max3_u32 v19, v32, v33, v34
v_max3_u32 v19, v19, v35, v36
v_max3_u32 v19, v19, v37, v38
v_max3_u32 v19, v19, v39, v40
v_max3_u32 v19, v19, v41, v42
v_max3_u32 v19, v19, v43, v44
v_max3_u32 v19, v19, v45, v46
v_max_u32 v19, v19, v47
v_cmp_eq_u32 vcc, -1, v19
s_nop 4
s_cbranch_vccnz Lfx_83
Lok_81:
s_waitcnt lgkmcnt(0)
v_mfma_f32_16x16x32_bf16 v[128:131], v[48:51], v[32:35], v[128:131]
ds_read_b128 v[80:83], v2 offset:8192
v_mfma_f32_16x16x32_bf16 v[132:135], v[48:51], v[36:39], v[132:135]
ds_read_b64_tr_b16 v[96:97], v5 offset:24576
v_mfma_f32_16x16x32_bf16 v[136:139], v[48:51], v[40:43], v[136:139]
ds_read_b64_tr_b16 v[98:99], v5 offset:28672
v_mfma_f32_16x16x32_bf16 v[140:143], v[48:51], v[44:47], v[140:143]
ds_read_b128 v[84:87], v2 offset:8448
v_mfma_f32_16x16x32_bf16 v[204:207], v[64:67], v[44:47], v[204:207]
ds_read_b128 v[88:91], v2 offset:8704
v_mfma_f32_16x16x32_bf16 v[200:203], v[64:67], v[40:43], v[200:203]
ds_read_b128 v[92:95], v2 offset:8960
v_mfma_f32_16x16x32_bf16 v[196:199], v[64:67], v[36:39], v[196:199]
ds_read_b64_tr_b16 v[112:113], v5 offset:40960
v_mfma_f32_16x16x32_bf16 v[192:195], v[64:67], v[32:35], v[192:195]
ds_read_b64_tr_b16 v[114:115], v5 offset:45056
v_mfma_f32_16x16x32_bf16 v[144:147], v[52:55], v[32:35], v[144:147]
ds_read_b64_tr_b16 v[100:101], v6 offset:24576
v_mfma_f32_16x16x32_bf16 v[148:151], v[52:55], v[36:39], v[148:151]
ds_read_b64_tr_b16 v[102:103], v6 offset:28672
v_mfma_f32_16x16x32_bf16 v[152:155], v[52:55], v[40:43], v[152:155]
ds_read_b64_tr_b16 v[116:117], v6 offset:40960
v_mfma_f32_16x16x32_bf16 v[156:159], v[52:55], v[44:47], v[156:159]
ds_read_b64_tr_b16 v[118:119], v6 offset:45056
v_mfma_f32_16x16x32_bf16 v[220:223], v[68:71], v[44:47], v[220:223]
ds_read_b64_tr_b16 v[104:105], v7 offset:24576
v_mfma_f32_16x16x32_bf16 v[216:219], v[68:71], v[40:43], v[216:219]
ds_read_b64_tr_b16 v[106:107], v7 offset:28672
v_mfma_f32_16x16x32_bf16 v[212:215], v[68:71], v[36:39], v[212:215]
ds_read_b64_tr_b16 v[120:121], v7 offset:40960
v_mfma_f32_16x16x32_bf16 v[208:211], v[68:71], v[32:35], v[208:211]
ds_read_b64_tr_b16 v[122:123], v7 offset:45056
v_mfma_f32_16x16x32_bf16 v[160:163], v[56:59], v[32:35], v[160:163]
ds_read_b64_tr_b16 v[108:109], v8 offset:24576
v_mfma_f32_16x16x32_bf16 v[164:167], v[56:59], v[36:39], v[164:167]
ds_read_b64_tr_b16 v[110:111], v8 offset:28672
v_mfma_f32_16x16x32_bf16 v[168:171], v[56:59], v[40:43], v[168:171]
ds_read_b64_tr_b16 v[124:125], v8 offset:40960
v_mfma_f32_16x16x32_bf16 v[172:175], v[56:59], v[44:47], v[172:175]
ds_read_b64_tr_b16 v[126:127], v8 offset:45056
s_waitcnt lgkmcnt(14)
v_mfma_f32_16x16x32_bf16 v[236:239], v[72:75], v[44:47], v[236:239]
v_max3_u32 v19, v80, v81, v82
v_mfma_f32_16x16x32_bf16 v[232:235], v[72:75], v[40:43], v[232:235]
v_max3_u32 v19, v19, v83, v84
v_mfma_f32_16x16x32_bf16 v[228:231], v[72:75], v[36:39], v[228:231]
v_max3_u32 v19, v19, v85, v86
v_mfma_f32_16x16x32_bf16 v[224:227], v[72:75], v[32:35], v[224:227]
v_max3_u32 v19, v19, v87, v88
v_mfma_f32_16x16x32_bf16 v[176:179], v[60:63], v[32:35], v[176:179]
v_max3_u32 v19, v19, v89, v90
v_mfma_f32_16x16x32_bf16 v[180:183], v[60:63], v[36:39], v[180:183]
v_max3_u32 v19, v19, v91, v92
v_mfma_f32_16x16x32_bf16 v[184:187], v[60:63], v[40:43], v[184:187]
v_max3_u32 v19, v19, v93, v94
v_mfma_f32_16x16x32_bf16 v[188:191], v[60:63], v[44:47], v[188:191]
v_max_u32 v19, v19, v95
v_mfma_f32_16x16x32_bf16 v[252:255], v[76:79], v[44:47], v[252:255]
v_cmp_eq_u32 vcc, -1, v19
v_mfma_f32_16x16x32_bf16 v[248:251], v[76:79], v[40:43], v[248:251]
v_mfma_f32_16x16x32_bf16 v[244:247], v[76:79], v[36:39], v[244:247]
v_mfma_f32_16x16x32_bf16 v[240:243], v[76:79], v[32:35], v[240:243]
s_nop 1
s_cbranch_vccnz Lfx_86
Lok_84:
s_waitcnt lgkmcnt(0)
s_barrier
v_mfma_f32_16x16x32_bf16 v[128:131], v[96:99], v[80:83], v[128:131]
ds_read_b128 v[32:35], v3 offset:0
v_mfma_f32_16x16x32_bf16 v[132:135], v[96:99], v[84:87], v[132:135]
ds_read_b64_tr_b16 v[48:49], v9 offset:16384
v_mfma_f32_16x16x32_bf16 v[136:139], v[96:99], v[88:91], v[136:139]
ds_read_b64_tr_b16 v[50:51], v9 offset:20480
v_mfma_f32_16x16x32_bf16 v[140:143], v[96:99], v[92:95], v[140:143]
ds_read_b128 v[36:39], v3 offset:256
v_mfma_f32_16x16x32_bf16 v[204:207], v[112:115], v[92:95], v[204:207]
ds_read_b128 v[40:43], v3 offset:512
v_mfma_f32_16x16x32_bf16 v[200:203], v[112:115], v[88:91], v[200:203]
ds_read_b128 v[44:47], v3 offset:768
v_mfma_f32_16x16x32_bf16 v[196:199], v[112:115], v[84:87], v[196:199]
ds_read_b64_tr_b16 v[64:65], v9 offset:32768
v_mfma_f32_16x16x32_bf16 v[192:195], v[112:115], v[80:83], v[192:195]
ds_read_b64_tr_b16 v[66:67], v9 offset:36864
v_mfma_f32_16x16x32_bf16 v[144:147], v[100:103], v[80:83], v[144:147]
ds_read_b64_tr_b16 v[52:53], v10 offset:16384
v_mfma_f32_16x16x32_bf16 v[148:151], v[100:103], v[84:87], v[148:151]
ds_read_b64_tr_b16 v[54:55], v10 offset:20480
v_mfma_f32_16x16x32_bf16 v[152:155], v[100:103], v[88:91], v[152:155]
ds_read_b64_tr_b16 v[68:69], v10 offset:32768
v_mfma_f32_16x16x32_bf16 v[156:159], v[100:103], v[92:95], v[156:159]
ds_read_b64_tr_b16 v[70:71], v10 offset:36864
v_mfma_f32_16x16x32_bf16 v[220:223], v[116:119], v[92:95], v[220:223]
ds_read_b64_tr_b16 v[56:57], v11 offset:16384
v_mfma_f32_16x16x32_bf16 v[216:219], v[116:119], v[88:91], v[216:219]
ds_read_b64_tr_b16 v[58:59], v11 offset:20480
v_mfma_f32_16x16x32_bf16 v[212:215], v[116:119], v[84:87], v[212:215]
ds_read_b64_tr_b16 v[72:73], v11 offset:32768
v_mfma_f32_16x16x32_bf16 v[208:211], v[116:119], v[80:83], v[208:211]
ds_read_b64_tr_b16 v[74:75], v11 offset:36864
v_mfma_f32_16x16x32_bf16 v[160:163], v[104:107], v[80:83], v[160:163]
ds_read_b64_tr_b16 v[60:61], v12 offset:16384
v_mfma_f32_16x16x32_bf16 v[164:167], v[104:107], v[84:87], v[164:167]
ds_read_b64_tr_b16 v[62:63], v12 offset:20480
v_mfma_f32_16x16x32_bf16 v[168:171], v[104:107], v[88:91], v[168:171]
ds_read_b64_tr_b16 v[76:77], v12 offset:32768
v_mfma_f32_16x16x32_bf16 v[172:175], v[104:107], v[92:95], v[172:175]
ds_read_b64_tr_b16 v[78:79], v12 offset:36864
s_waitcnt lgkmcnt(14)
v_mfma_f32_16x16x32_bf16 v[236:239], v[120:123], v[92:95], v[236:239]
v_max3_u32 v19, v32, v33, v34
v_mfma_f32_16x16x32_bf16 v[232:235], v[120:123], v[88:91], v[232:235]
v_max3_u32 v19, v19, v35, v36
v_mfma_f32_16x16x32_bf16 v[228:231], v[120:123], v[84:87], v[228:231]
v_max3_u32 v19, v19, v37, v38
v_mfma_f32_16x16x32_bf16 v[224:227], v[120:123], v[80:83], v[224:227]
v_max3_u32 v19, v19, v39, v40
v_mfma_f32_16x16x32_bf16 v[176:179], v[108:111], v[80:83], v[176:179]
v_max3_u32 v19, v19, v41, v42
v_mfma_f32_16x16x32_bf16 v[180:183], v[108:111], v[84:87], v[180:183]
v_max3_u32 v19, v19, v43, v44
v_mfma_f32_16x16x32_bf16 v[184:187], v[108:111], v[88:91], v[184:187]
v_max3_u32 v19, v19, v45, v46
v_mfma_f32_16x16x32_bf16 v[188:191], v[108:111], v[92:95], v[188:191]
v_max_u32 v19, v19, v47
v_mfma_f32_16x16x32_bf16 v[252:255], v[124:127], v[92:95], v[252:255]
v_cmp_eq_u32 vcc, -1, v19
v_mfma_f32_16x16x32_bf16 v[248:251], v[124:127], v[88:91], v[248:251]
v_mfma_f32_16x16x32_bf16 v[244:247], v[124:127], v[84:87], v[244:247]
v_mfma_f32_16x16x32_bf16 v[240:243], v[124:127], v[80:83], v[240:243]
s_nop 1
s_cbranch_vccnz Lfx_89
Lok_87:
s_waitcnt lgkmcnt(0)
v_mfma_f32_16x16x32_bf16 v[128:131], v[48:51], v[32:35], v[128:131]
ds_read_b128 v[80:83], v3 offset:8192
v_mfma_f32_16x16x32_bf16 v[132:135], v[48:51], v[36:39], v[132:135]
ds_read_b64_tr_b16 v[96:97], v9 offset:24576
v_mfma_f32_16x16x32_bf16 v[136:139], v[48:51], v[40:43], v[136:139]
ds_read_b64_tr_b16 v[98:99], v9 offset:28672
v_mfma_f32_16x16x32_bf16 v[140:143], v[48:51], v[44:47], v[140:143]
ds_read_b128 v[84:87], v3 offset:8448
v_mfma_f32_16x16x32_bf16 v[204:207], v[64:67], v[44:47], v[204:207]
ds_read_b128 v[88:91], v3 offset:8704
v_mfma_f32_16x16x32_bf16 v[200:203], v[64:67], v[40:43], v[200:203]
ds_read_b128 v[92:95], v3 offset:8960
v_mfma_f32_16x16x32_bf16 v[196:199], v[64:67], v[36:39], v[196:199]
ds_read_b64_tr_b16 v[112:113], v9 offset:40960
v_mfma_f32_16x16x32_bf16 v[192:195], v[64:67], v[32:35], v[192:195]
ds_read_b64_tr_b16 v[114:115], v9 offset:45056
v_mfma_f32_16x16x32_bf16 v[144:147], v[52:55], v[32:35], v[144:147]
ds_read_b64_tr_b16 v[100:101], v10 offset:24576
v_mfma_f32_16x16x32_bf16 v[148:151], v[52:55], v[36:39], v[148:151]
ds_read_b64_tr_b16 v[102:103], v10 offset:28672
v_mfma_f32_16x16x32_bf16 v[152:155], v[52:55], v[40:43], v[152:155]
ds_read_b64_tr_b16 v[116:117], v10 offset:40960
v_mfma_f32_16x16x32_bf16 v[156:159], v[52:55], v[44:47], v[156:159]
ds_read_b64_tr_b16 v[118:119], v10 offset:45056
v_mfma_f32_16x16x32_bf16 v[220:223], v[68:71], v[44:47], v[220:223]
ds_read_b64_tr_b16 v[104:105], v11 offset:24576
v_mfma_f32_16x16x32_bf16 v[216:219], v[68:71], v[40:43], v[216:219]
ds_read_b64_tr_b16 v[106:107], v11 offset:28672
v_mfma_f32_16x16x32_bf16 v[212:215], v[68:71], v[36:39], v[212:215]
ds_read_b64_tr_b16 v[120:121], v11 offset:40960
v_mfma_f32_16x16x32_bf16 v[208:211], v[68:71], v[32:35], v[208:211]
ds_read_b64_tr_b16 v[122:123], v11 offset:45056
v_mfma_f32_16x16x32_bf16 v[160:163], v[56:59], v[32:35], v[160:163]
ds_read_b64_tr_b16 v[108:109], v12 offset:24576
v_mfma_f32_16x16x32_bf16 v[164:167], v[56:59], v[36:39], v[164:167]
ds_read_b64_tr_b16 v[110:111], v12 offset:28672
v_mfma_f32_16x16x32_bf16 v[168:171], v[56:59], v[40:43], v[168:171]
ds_read_b64_tr_b16 v[124:125], v12 offset:40960
v_mfma_f32_16x16x32_bf16 v[172:175], v[56:59], v[44:47], v[172:175]
ds_read_b64_tr_b16 v[126:127], v12 offset:45056
s_waitcnt lgkmcnt(14)
v_mfma_f32_16x16x32_bf16 v[236:239], v[72:75], v[44:47], v[236:239]
v_max3_u32 v19, v80, v81, v82
v_mfma_f32_16x16x32_bf16 v[232:235], v[72:75], v[40:43], v[232:235]
v_max3_u32 v19, v19, v83, v84
v_mfma_f32_16x16x32_bf16 v[228:231], v[72:75], v[36:39], v[228:231]
v_max3_u32 v19, v19, v85, v86
v_mfma_f32_16x16x32_bf16 v[224:227], v[72:75], v[32:35], v[224:227]
v_max3_u32 v19, v19, v87, v88
v_mfma_f32_16x16x32_bf16 v[176:179], v[60:63], v[32:35], v[176:179]
v_max3_u32 v19, v19, v89, v90
v_mfma_f32_16x16x32_bf16 v[180:183], v[60:63], v[36:39], v[180:183]
v_max3_u32 v19, v19, v91, v92
v_mfma_f32_16x16x32_bf16 v[184:187], v[60:63], v[40:43], v[184:187]
v_max3_u32 v19, v19, v93, v94
v_mfma_f32_16x16x32_bf16 v[188:191], v[60:63], v[44:47], v[188:191]
v_max_u32 v19, v19, v95
v_mfma_f32_16x16x32_bf16 v[252:255], v[76:79], v[44:47], v[252:255]
v_cmp_eq_u32 vcc, -1, v19
v_mfma_f32_16x16x32_bf16 v[248:251], v[76:79], v[40:43], v[248:251]
v_mfma_f32_16x16x32_bf16 v[244:247], v[76:79], v[36:39], v[244:247]
v_mfma_f32_16x16x32_bf16 v[240:243], v[76:79], v[32:35], v[240:243]
s_nop 1
s_cbranch_vccnz Lfx_92
Lok_90:
s_waitcnt lgkmcnt(0)
s_barrier
v_mfma_f32_16x16x32_bf16 v[128:131], v[96:99], v[80:83], v[128:131]
ds_read_b128 v[32:35], v4 offset:0
v_mfma_f32_16x16x32_bf16 v[132:135], v[96:99], v[84:87], v[132:135]
ds_read_b64_tr_b16 v[48:49], v13 offset:16384
v_mfma_f32_16x16x32_bf16 v[136:139], v[96:99], v[88:91], v[136:139]
ds_read_b64_tr_b16 v[50:51], v13 offset:20480
v_mfma_f32_16x16x32_bf16 v[140:143], v[96:99], v[92:95], v[140:143]
ds_read_b128 v[36:39], v4 offset:256
v_mfma_f32_16x16x32_bf16 v[204:207], v[112:115], v[92:95], v[204:207]
ds_read_b128 v[40:43], v4 offset:512
v_mfma_f32_16x16x32_bf16 v[200:203], v[112:115], v[88:91], v[200:203]
ds_read_b128 v[44:47], v4 offset:768
v_mfma_f32_16x16x32_bf16 v[196:199], v[112:115], v[84:87], v[196:199]
ds_read_b64_tr_b16 v[64:65], v13 offset:32768
v_mfma_f32_16x16x32_bf16 v[192:195], v[112:115], v[80:83], v[192:195]
ds_read_b64_tr_b16 v[66:67], v13 offset:36864
v_mfma_f32_16x16x32_bf16 v[144:147], v[100:103], v[80:83], v[144:147]
ds_read_b64_tr_b16 v[52:53], v14 offset:16384
v_mfma_f32_16x16x32_bf16 v[148:151], v[100:103], v[84:87], v[148:151]
ds_read_b64_tr_b16 v[54:55], v14 offset:20480
v_mfma_f32_16x16x32_bf16 v[152:155], v[100:103], v[88:91], v[152:155]
ds_read_b64_tr_b16 v[68:69], v14 offset:32768
v_mfma_f32_16x16x32_bf16 v[156:159], v[100:103], v[92:95], v[156:159]
ds_read_b64_tr_b16 v[70:71], v14 offset:36864
v_mfma_f32_16x16x32_bf16 v[220:223], v[116:119], v[92:95], v[220:223]
ds_read_b64_tr_b16 v[56:57], v15 offset:16384
v_mfma_f32_16x16x32_bf16 v[216:219], v[116:119], v[88:91], v[216:219]
ds_read_b64_tr_b16 v[58:59], v15 offset:20480
v_mfma_f32_16x16x32_bf16 v[212:215], v[116:119], v[84:87], v[212:215]
ds_read_b64_tr_b16 v[72:73], v15 offset:32768
v_mfma_f32_16x16x32_bf16 v[208:211], v[116:119], v[80:83], v[208:211]
ds_read_b64_tr_b16 v[74:75], v15 offset:36864
v_mfma_f32_16x16x32_bf16 v[160:163], v[104:107], v[80:83], v[160:163]
ds_read_b64_tr_b16 v[60:61], v16 offset:16384
v_mfma_f32_16x16x32_bf16 v[164:167], v[104:107], v[84:87], v[164:167]
ds_read_b64_tr_b16 v[62:63], v16 offset:20480
v_mfma_f32_16x16x32_bf16 v[168:171], v[104:107], v[88:91], v[168:171]
ds_read_b64_tr_b16 v[76:77], v16 offset:32768
v_mfma_f32_16x16x32_bf16 v[172:175], v[104:107], v[92:95], v[172:175]
ds_read_b64_tr_b16 v[78:79], v16 offset:36864
s_waitcnt lgkmcnt(14)
v_mfma_f32_16x16x32_bf16 v[236:239], v[120:123], v[92:95], v[236:239]
v_max3_u32 v19, v32, v33, v34
v_mfma_f32_16x16x32_bf16 v[232:235], v[120:123], v[88:91], v[232:235]
v_max3_u32 v19, v19, v35, v36
v_mfma_f32_16x16x32_bf16 v[228:231], v[120:123], v[84:87], v[228:231]
v_max3_u32 v19, v19, v37, v38
v_mfma_f32_16x16x32_bf16 v[224:227], v[120:123], v[80:83], v[224:227]
v_max3_u32 v19, v19, v39, v40
v_mfma_f32_16x16x32_bf16 v[176:179], v[108:111], v[80:83], v[176:179]
v_max3_u32 v19, v19, v41, v42
v_mfma_f32_16x16x32_bf16 v[180:183], v[108:111], v[84:87], v[180:183]
v_max3_u32 v19, v19, v43, v44
v_mfma_f32_16x16x32_bf16 v[184:187], v[108:111], v[88:91], v[184:187]
v_max3_u32 v19, v19, v45, v46
v_mfma_f32_16x16x32_bf16 v[188:191], v[108:111], v[92:95], v[188:191]
v_max_u32 v19, v19, v47
v_mfma_f32_16x16x32_bf16 v[252:255], v[124:127], v[92:95], v[252:255]
v_cmp_eq_u32 vcc, -1, v19
v_mfma_f32_16x16x32_bf16 v[248:251], v[124:127], v[88:91], v[248:251]
v_mfma_f32_16x16x32_bf16 v[244:247], v[124:127], v[84:87], v[244:247]
v_mfma_f32_16x16x32_bf16 v[240:243], v[124:127], v[80:83], v[240:243]
s_nop 1
s_cbranch_vccnz Lfx_95
Lok_93:
s_waitcnt lgkmcnt(0)
v_mfma_f32_16x16x32_bf16 v[128:131], v[48:51], v[32:35], v[128:131]
ds_read_b128 v[80:83], v4 offset:8192
v_mfma_f32_16x16x32_bf16 v[132:135], v[48:51], v[36:39], v[132:135]
ds_read_b64_tr_b16 v[96:97], v13 offset:24576
v_mfma_f32_16x16x32_bf16 v[136:139], v[48:51], v[40:43], v[136:139]
ds_read_b64_tr_b16 v[98:99], v13 offset:28672
v_mfma_f32_16x16x32_bf16 v[140:143], v[48:51], v[44:47], v[140:143]
ds_read_b128 v[84:87], v4 offset:8448
v_mfma_f32_16x16x32_bf16 v[204:207], v[64:67], v[44:47], v[204:207]
ds_read_b128 v[88:91], v4 offset:8704
v_mfma_f32_16x16x32_bf16 v[200:203], v[64:67], v[40:43], v[200:203]
ds_read_b128 v[92:95], v4 offset:8960
v_mfma_f32_16x16x32_bf16 v[196:199], v[64:67], v[36:39], v[196:199]
ds_read_b64_tr_b16 v[112:113], v13 offset:40960
v_mfma_f32_16x16x32_bf16 v[192:195], v[64:67], v[32:35], v[192:195]
ds_read_b64_tr_b16 v[114:115], v13 offset:45056
v_mfma_f32_16x16x32_bf16 v[144:147], v[52:55], v[32:35], v[144:147]
ds_read_b64_tr_b16 v[100:101], v14 offset:24576
v_mfma_f32_16x16x32_bf16 v[148:151], v[52:55], v[36:39], v[148:151]
ds_read_b64_tr_b16 v[102:103], v14 offset:28672
v_mfma_f32_16x16x32_bf16 v[152:155], v[52:55], v[40:43], v[152:155]
ds_read_b64_tr_b16 v[116:117], v14 offset:40960
v_mfma_f32_16x16x32_bf16 v[156:159], v[52:55], v[44:47], v[156:159]
ds_read_b64_tr_b16 v[118:119], v14 offset:45056
v_mfma_f32_16x16x32_bf16 v[220:223], v[68:71], v[44:47], v[220:223]
ds_read_b64_tr_b16 v[104:105], v15 offset:24576
v_mfma_f32_16x16x32_bf16 v[216:219], v[68:71], v[40:43], v[216:219]
ds_read_b64_tr_b16 v[106:107], v15 offset:28672
v_mfma_f32_16x16x32_bf16 v[212:215], v[68:71], v[36:39], v[212:215]
ds_read_b64_tr_b16 v[120:121], v15 offset:40960
v_mfma_f32_16x16x32_bf16 v[208:211], v[68:71], v[32:35], v[208:211]
ds_read_b64_tr_b16 v[122:123], v15 offset:45056
v_mfma_f32_16x16x32_bf16 v[160:163], v[56:59], v[32:35], v[160:163]
ds_read_b64_tr_b16 v[108:109], v16 offset:24576
v_mfma_f32_16x16x32_bf16 v[164:167], v[56:59], v[36:39], v[164:167]
ds_read_b64_tr_b16 v[110:111], v16 offset:28672
v_mfma_f32_16x16x32_bf16 v[168:171], v[56:59], v[40:43], v[168:171]
ds_read_b64_tr_b16 v[124:125], v16 offset:40960
v_mfma_f32_16x16x32_bf16 v[172:175], v[56:59], v[44:47], v[172:175]
ds_read_b64_tr_b16 v[126:127], v16 offset:45056
s_waitcnt lgkmcnt(14)
v_mfma_f32_16x16x32_bf16 v[236:239], v[72:75], v[44:47], v[236:239]
v_max3_u32 v19, v80, v81, v82
v_mfma_f32_16x16x32_bf16 v[232:235], v[72:75], v[40:43], v[232:235]
v_max3_u32 v19, v19, v83, v84
v_mfma_f32_16x16x32_bf16 v[228:231], v[72:75], v[36:39], v[228:231]
v_max3_u32 v19, v19, v85, v86
v_mfma_f32_16x16x32_bf16 v[224:227], v[72:75], v[32:35], v[224:227]
v_max3_u32 v19, v19, v87, v88
v_mfma_f32_16x16x32_bf16 v[176:179], v[60:63], v[32:35], v[176:179]
v_max3_u32 v19, v19, v89, v90
v_mfma_f32_16x16x32_bf16 v[180:183], v[60:63], v[36:39], v[180:183]
v_max3_u32 v19, v19, v91, v92
v_mfma_f32_16x16x32_bf16 v[184:187], v[60:63], v[40:43], v[184:187]
v_max3_u32 v19, v19, v93, v94
v_mfma_f32_16x16x32_bf16 v[188:191], v[60:63], v[44:47], v[188:191]
v_max_u32 v19, v19, v95
v_mfma_f32_16x16x32_bf16 v[252:255], v[76:79], v[44:47], v[252:255]
v_cmp_eq_u32 vcc, -1, v19
v_mfma_f32_16x16x32_bf16 v[248:251], v[76:79], v[40:43], v[248:251]
v_mfma_f32_16x16x32_bf16 v[244:247], v[76:79], v[36:39], v[244:247]
v_mfma_f32_16x16x32_bf16 v[240:243], v[76:79], v[32:35], v[240:243]
s_nop 1
s_cbranch_vccnz Lfx_98
Lok_96:
s_waitcnt lgkmcnt(0)
s_barrier
v_mfma_f32_16x16x32_bf16 v[128:131], v[96:99], v[80:83], v[128:131]
ds_read_b128 v[32:35], v2 offset:0
v_mfma_f32_16x16x32_bf16 v[132:135], v[96:99], v[84:87], v[132:135]
ds_read_b64_tr_b16 v[48:49], v5 offset:16384
v_mfma_f32_16x16x32_bf16 v[136:139], v[96:99], v[88:91], v[136:139]
ds_read_b64_tr_b16 v[50:51], v5 offset:20480
v_mfma_f32_16x16x32_bf16 v[140:143], v[96:99], v[92:95], v[140:143]
ds_read_b128 v[36:39], v2 offset:256
v_mfma_f32_16x16x32_bf16 v[204:207], v[112:115], v[92:95], v[204:207]
ds_read_b128 v[40:43], v2 offset:512
v_mfma_f32_16x16x32_bf16 v[200:203], v[112:115], v[88:91], v[200:203]
ds_read_b128 v[44:47], v2 offset:768
v_mfma_f32_16x16x32_bf16 v[196:199], v[112:115], v[84:87], v[196:199]
ds_read_b64_tr_b16 v[64:65], v5 offset:32768
v_mfma_f32_16x16x32_bf16 v[192:195], v[112:115], v[80:83], v[192:195]
ds_read_b64_tr_b16 v[66:67], v5 offset:36864
v_mfma_f32_16x16x32_bf16 v[144:147], v[100:103], v[80:83], v[144:147]
ds_read_b64_tr_b16 v[52:53], v6 offset:16384
v_mfma_f32_16x16x32_bf16 v[148:151], v[100:103], v[84:87], v[148:151]
ds_read_b64_tr_b16 v[54:55], v6 offset:20480
v_mfma_f32_16x16x32_bf16 v[152:155], v[100:103], v[88:91], v[152:155]
ds_read_b64_tr_b16 v[68:69], v6 offset:32768
v_mfma_f32_16x16x32_bf16 v[156:159], v[100:103], v[92:95], v[156:159]
ds_read_b64_tr_b16 v[70:71], v6 offset:36864
v_mfma_f32_16x16x32_bf16 v[220:223], v[116:119], v[92:95], v[220:223]
ds_read_b64_tr_b16 v[56:57], v7 offset:16384
v_mfma_f32_16x16x32_bf16 v[216:219], v[116:119], v[88:91], v[216:219]
ds_read_b64_tr_b16 v[58:59], v7 offset:20480
v_mfma_f32_16x16x32_bf16 v[212:215], v[116:119], v[84:87], v[212:215]
ds_read_b64_tr_b16 v[72:73], v7 offset:32768
v_mfma_f32_16x16x32_bf16 v[208:211], v[116:119], v[80:83], v[208:211]
ds_read_b64_tr_b16 v[74:75], v7 offset:36864
v_mfma_f32_16x16x32_bf16 v[160:163], v[104:107], v[80:83], v[160:163]
ds_read_b64_tr_b16 v[60:61], v8 offset:16384
v_mfma_f32_16x16x32_bf16 v[164:167], v[104:107], v[84:87], v[164:167]
ds_read_b64_tr_b16 v[62:63], v8 offset:20480
v_mfma_f32_16x16x32_bf16 v[168:171], v[104:107], v[88:91], v[168:171]
ds_read_b64_tr_b16 v[76:77], v8 offset:32768
v_mfma_f32_16x16x32_bf16 v[172:175], v[104:107], v[92:95], v[172:175]
ds_read_b64_tr_b16 v[78:79], v8 offset:36864
s_waitcnt lgkmcnt(14)
v_mfma_f32_16x16x32_bf16 v[236:239], v[120:123], v[92:95], v[236:239]
v_max3_u32 v19, v32, v33, v34
v_mfma_f32_16x16x32_bf16 v[232:235], v[120:123], v[88:91], v[232:235]
v_max3_u32 v19, v19, v35, v36
v_mfma_f32_16x16x32_bf16 v[228:231], v[120:123], v[84:87], v[228:231]
v_max3_u32 v19, v19, v37, v38
v_mfma_f32_16x16x32_bf16 v[224:227], v[120:123], v[80:83], v[224:227]
v_max3_u32 v19, v19, v39, v40
v_mfma_f32_16x16x32_bf16 v[176:179], v[108:111], v[80:83], v[176:179]
v_max3_u32 v19, v19, v41, v42
v_mfma_f32_16x16x32_bf16 v[180:183], v[108:111], v[84:87], v[180:183]
v_max3_u32 v19, v19, v43, v44
v_mfma_f32_16x16x32_bf16 v[184:187], v[108:111], v[88:91], v[184:187]
v_max3_u32 v19, v19, v45, v46
v_mfma_f32_16x16x32_bf16 v[188:191], v[108:111], v[92:95], v[188:191]
v_max_u32 v19, v19, v47
v_mfma_f32_16x16x32_bf16 v[252:255], v[124:127], v[92:95], v[252:255]
v_cmp_eq_u32 vcc, -1, v19
v_mfma_f32_16x16x32_bf16 v[248:251], v[124:127], v[88:91], v[248:251]
v_mfma_f32_16x16x32_bf16 v[244:247], v[124:127], v[84:87], v[244:247]
v_mfma_f32_16x16x32_bf16 v[240:243], v[124:127], v[80:83], v[240:243]
s_nop 1
s_cbranch_vccnz Lfx_101
Lok_99:
s_waitcnt lgkmcnt(0)
v_mfma_f32_16x16x32_bf16 v[128:131], v[48:51], v[32:35], v[128:131]
ds_read_b128 v[80:83], v2 offset:8192
v_mfma_f32_16x16x32_bf16 v[132:135], v[48:51], v[36:39], v[132:135]
ds_read_b64_tr_b16 v[96:97], v5 offset:24576
v_mfma_f32_16x16x32_bf16 v[136:139], v[48:51], v[40:43], v[136:139]
ds_read_b64_tr_b16 v[98:99], v5 offset:28672
v_mfma_f32_16x16x32_bf16 v[140:143], v[48:51], v[44:47], v[140:143]
ds_read_b128 v[84:87], v2 offset:8448
v_mfma_f32_16x16x32_bf16 v[204:207], v[64:67], v[44:47], v[204:207]
ds_read_b128 v[88:91], v2 offset:8704
v_mfma_f32_16x16x32_bf16 v[200:203], v[64:67], v[40:43], v[200:203]
ds_read_b128 v[92:95], v2 offset:8960
v_mfma_f32_16x16x32_bf16 v[196:199], v[64:67], v[36:39], v[196:199]
ds_read_b64_tr_b16 v[112:113], v5 offset:40960
v_mfma_f32_16x16x32_bf16 v[192:195], v[64:67], v[32:35], v[192:195]
ds_read_b64_tr_b16 v[114:115], v5 offset:45056
v_mfma_f32_16x16x32_bf16 v[144:147], v[52:55], v[32:35], v[144:147]
ds_read_b64_tr_b16 v[100:101], v6 offset:24576
v_mfma_f32_16x16x32_bf16 v[148:151], v[52:55], v[36:39], v[148:151]
ds_read_b64_tr_b16 v[102:103], v6 offset:28672
v_mfma_f32_16x16x32_bf16 v[152:155], v[52:55], v[40:43], v[152:155]
ds_read_b64_tr_b16 v[116:117], v6 offset:40960
v_mfma_f32_16x16x32_bf16 v[156:159], v[52:55], v[44:47], v[156:159]
ds_read_b64_tr_b16 v[118:119], v6 offset:45056
v_mfma_f32_16x16x32_bf16 v[220:223], v[68:71], v[44:47], v[220:223]
ds_read_b64_tr_b16 v[104:105], v7 offset:24576
v_mfma_f32_16x16x32_bf16 v[216:219], v[68:71], v[40:43], v[216:219]
ds_read_b64_tr_b16 v[106:107], v7 offset:28672
v_mfma_f32_16x16x32_bf16 v[212:215], v[68:71], v[36:39], v[212:215]
ds_read_b64_tr_b16 v[120:121], v7 offset:40960
v_mfma_f32_16x16x32_bf16 v[208:211], v[68:71], v[32:35], v[208:211]
ds_read_b64_tr_b16 v[122:123], v7 offset:45056
v_mfma_f32_16x16x32_bf16 v[160:163], v[56:59], v[32:35], v[160:163]
ds_read_b64_tr_b16 v[108:109], v8 offset:24576
v_mfma_f32_16x16x32_bf16 v[164:167], v[56:59], v[36:39], v[164:167]
ds_read_b64_tr_b16 v[110:111], v8 offset:28672
v_mfma_f32_16x16x32_bf16 v[168:171], v[56:59], v[40:43], v[168:171]
ds_read_b64_tr_b16 v[124:125], v8 offset:40960
v_mfma_f32_16x16x32_bf16 v[172:175], v[56:59], v[44:47], v[172:175]
ds_read_b64_tr_b16 v[126:127], v8 offset:45056
s_waitcnt lgkmcnt(14)
v_mfma_f32_16x16x32_bf16 v[236:239], v[72:75], v[44:47], v[236:239]
v_max3_u32 v19, v80, v81, v82
v_mfma_f32_16x16x32_bf16 v[232:235], v[72:75], v[40:43], v[232:235]
v_max3_u32 v19, v19, v83, v84
v_mfma_f32_16x16x32_bf16 v[228:231], v[72:75], v[36:39], v[228:231]
v_max3_u32 v19, v19, v85, v86
v_mfma_f32_16x16x32_bf16 v[224:227], v[72:75], v[32:35], v[224:227]
v_max3_u32 v19, v19, v87, v88
v_mfma_f32_16x16x32_bf16 v[176:179], v[60:63], v[32:35], v[176:179]
v_max3_u32 v19, v19, v89, v90
v_mfma_f32_16x16x32_bf16 v[180:183], v[60:63], v[36:39], v[180:183]
v_max3_u32 v19, v19, v91, v92
v_mfma_f32_16x16x32_bf16 v[184:187], v[60:63], v[40:43], v[184:187]
v_max3_u32 v19, v19, v93, v94
v_mfma_f32_16x16x32_bf16 v[188:191], v[60:63], v[44:47], v[188:191]
v_max_u32 v19, v19, v95
v_mfma_f32_16x16x32_bf16 v[252:255], v[76:79], v[44:47], v[252:255]
v_cmp_eq_u32 vcc, -1, v19
v_mfma_f32_16x16x32_bf16 v[248:251], v[76:79], v[40:43], v[248:251]
v_mfma_f32_16x16x32_bf16 v[244:247], v[76:79], v[36:39], v[244:247]
v_mfma_f32_16x16x32_bf16 v[240:243], v[76:79], v[32:35], v[240:243]
s_nop 1
s_cbranch_vccnz Lfx_104
Lok_102:
s_waitcnt lgkmcnt(0)
s_barrier
v_mfma_f32_16x16x32_bf16 v[128:131], v[96:99], v[80:83], v[128:131]
ds_read_b128 v[32:35], v3 offset:0
v_mfma_f32_16x16x32_bf16 v[132:135], v[96:99], v[84:87], v[132:135]
ds_read_b64_tr_b16 v[48:49], v9 offset:16384
v_mfma_f32_16x16x32_bf16 v[136:139], v[96:99], v[88:91], v[136:139]
ds_read_b64_tr_b16 v[50:51], v9 offset:20480
v_mfma_f32_16x16x32_bf16 v[140:143], v[96:99], v[92:95], v[140:143]
ds_read_b128 v[36:39], v3 offset:256
v_mfma_f32_16x16x32_bf16 v[204:207], v[112:115], v[92:95], v[204:207]
ds_read_b128 v[40:43], v3 offset:512
v_mfma_f32_16x16x32_bf16 v[200:203], v[112:115], v[88:91], v[200:203]
ds_read_b128 v[44:47], v3 offset:768
v_mfma_f32_16x16x32_bf16 v[196:199], v[112:115], v[84:87], v[196:199]
ds_read_b64_tr_b16 v[64:65], v9 offset:32768
v_mfma_f32_16x16x32_bf16 v[192:195], v[112:115], v[80:83], v[192:195]
ds_read_b64_tr_b16 v[66:67], v9 offset:36864
v_mfma_f32_16x16x32_bf16 v[144:147], v[100:103], v[80:83], v[144:147]
ds_read_b64_tr_b16 v[52:53], v10 offset:16384
v_mfma_f32_16x16x32_bf16 v[148:151], v[100:103], v[84:87], v[148:151]
ds_read_b64_tr_b16 v[54:55], v10 offset:20480
v_mfma_f32_16x16x32_bf16 v[152:155], v[100:103], v[88:91], v[152:155]
ds_read_b64_tr_b16 v[68:69], v10 offset:32768
v_mfma_f32_16x16x32_bf16 v[156:159], v[100:103], v[92:95], v[156:159]
ds_read_b64_tr_b16 v[70:71], v10 offset:36864
v_mfma_f32_16x16x32_bf16 v[220:223], v[116:119], v[92:95], v[220:223]
ds_read_b64_tr_b16 v[56:57], v11 offset:16384
v_mfma_f32_16x16x32_bf16 v[216:219], v[116:119], v[88:91], v[216:219]
ds_read_b64_tr_b16 v[58:59], v11 offset:20480
v_mfma_f32_16x16x32_bf16 v[212:215], v[116:119], v[84:87], v[212:215]
ds_read_b64_tr_b16 v[72:73], v11 offset:32768
v_mfma_f32_16x16x32_bf16 v[208:211], v[116:119], v[80:83], v[208:211]
ds_read_b64_tr_b16 v[74:75], v11 offset:36864
v_mfma_f32_16x16x32_bf16 v[160:163], v[104:107], v[80:83], v[160:163]
ds_read_b64_tr_b16 v[60:61], v12 offset:16384
v_mfma_f32_16x16x32_bf16 v[164:167], v[104:107], v[84:87], v[164:167]
ds_read_b64_tr_b16 v[62:63], v12 offset:20480
v_mfma_f32_16x16x32_bf16 v[168:171], v[104:107], v[88:91], v[168:171]
ds_read_b64_tr_b16 v[76:77], v12 offset:32768
v_mfma_f32_16x16x32_bf16 v[172:175], v[104:107], v[92:95], v[172:175]
ds_read_b64_tr_b16 v[78:79], v12 offset:36864
s_waitcnt lgkmcnt(14)
v_mfma_f32_16x16x32_bf16 v[236:239], v[120:123], v[92:95], v[236:239]
v_max3_u32 v19, v32, v33, v34
v_mfma_f32_16x16x32_bf16 v[232:235], v[120:123], v[88:91], v[232:235]
v_max3_u32 v19, v19, v35, v36
v_mfma_f32_16x16x32_bf16 v[228:231], v[120:123], v[84:87], v[228:231]
v_max3_u32 v19, v19, v37, v38
v_mfma_f32_16x16x32_bf16 v[224:227], v[120:123], v[80:83], v[224:227]
v_max3_u32 v19, v19, v39, v40
v_mfma_f32_16x16x32_bf16 v[176:179], v[108:111], v[80:83], v[176:179]
v_max3_u32 v19, v19, v41, v42
v_mfma_f32_16x16x32_bf16 v[180:183], v[108:111], v[84:87], v[180:183]
v_max3_u32 v19, v19, v43, v44
v_mfma_f32_16x16x32_bf16 v[184:187], v[108:111], v[88:91], v[184:187]
v_max3_u32 v19, v19, v45, v46
v_mfma_f32_16x16x32_bf16 v[188:191], v[108:111], v[92:95], v[188:191]
v_max_u32 v19, v19, v47
v_mfma_f32_16x16x32_bf16 v[252:255], v[124:127], v[92:95], v[252:255]
v_cmp_eq_u32 vcc, -1, v19
v_mfma_f32_16x16x32_bf16 v[248:251], v[124:127], v[88:91], v[248:251]
v_mfma_f32_16x16x32_bf16 v[244:247], v[124:127], v[84:87], v[244:247]
v_mfma_f32_16x16x32_bf16 v[240:243], v[124:127], v[80:83], v[240:243]
s_nop 1
s_cbranch_vccnz Lfx_107
Lok_105:
s_waitcnt lgkmcnt(0)
v_mfma_f32_16x16x32_bf16 v[128:131], v[48:51], v[32:35], v[128:131]
ds_read_b128 v[80:83], v3 offset:8192
v_mfma_f32_16x16x32_bf16 v[132:135], v[48:51], v[36:39], v[132:135]
ds_read_b64_tr_b16 v[96:97], v9 offset:24576
v_mfma_f32_16x16x32_bf16 v[136:139], v[48:51], v[40:43], v[136:139]
ds_read_b64_tr_b16 v[98:99], v9 offset:28672
v_mfma_f32_16x16x32_bf16 v[140:143], v[48:51], v[44:47], v[140:143]
ds_read_b128 v[84:87], v3 offset:8448
v_mfma_f32_16x16x32_bf16 v[204:207], v[64:67], v[44:47], v[204:207]
ds_read_b128 v[88:91], v3 offset:8704
v_mfma_f32_16x16x32_bf16 v[200:203], v[64:67], v[40:43], v[200:203]
ds_read_b128 v[92:95], v3 offset:8960
v_mfma_f32_16x16x32_bf16 v[196:199], v[64:67], v[36:39], v[196:199]
ds_read_b64_tr_b16 v[112:113], v9 offset:40960
v_mfma_f32_16x16x32_bf16 v[192:195], v[64:67], v[32:35], v[192:195]
ds_read_b64_tr_b16 v[114:115], v9 offset:45056
v_mfma_f32_16x16x32_bf16 v[144:147], v[52:55], v[32:35], v[144:147]
ds_read_b64_tr_b16 v[100:101], v10 offset:24576
v_mfma_f32_16x16x32_bf16 v[148:151], v[52:55], v[36:39], v[148:151]
ds_read_b64_tr_b16 v[102:103], v10 offset:28672
v_mfma_f32_16x16x32_bf16 v[152:155], v[52:55], v[40:43], v[152:155]
ds_read_b64_tr_b16 v[116:117], v10 offset:40960
v_mfma_f32_16x16x32_bf16 v[156:159], v[52:55], v[44:47], v[156:159]
ds_read_b64_tr_b16 v[118:119], v10 offset:45056
v_mfma_f32_16x16x32_bf16 v[220:223], v[68:71], v[44:47], v[220:223]
ds_read_b64_tr_b16 v[104:105], v11 offset:24576
v_mfma_f32_16x16x32_bf16 v[216:219], v[68:71], v[40:43], v[216:219]
ds_read_b64_tr_b16 v[106:107], v11 offset:28672
v_mfma_f32_16x16x32_bf16 v[212:215], v[68:71], v[36:39], v[212:215]
ds_read_b64_tr_b16 v[120:121], v11 offset:40960
v_mfma_f32_16x16x32_bf16 v[208:211], v[68:71], v[32:35], v[208:211]
ds_read_b64_tr_b16 v[122:123], v11 offset:45056
v_mfma_f32_16x16x32_bf16 v[160:163], v[56:59], v[32:35], v[160:163]
ds_read_b64_tr_b16 v[108:109], v12 offset:24576
v_mfma_f32_16x16x32_bf16 v[164:167], v[56:59], v[36:39], v[164:167]
ds_read_b64_tr_b16 v[110:111], v12 offset:28672
v_mfma_f32_16x16x32_bf16 v[168:171], v[56:59], v[40:43], v[168:171]
ds_read_b64_tr_b16 v[124:125], v12 offset:40960
v_mfma_f32_16x16x32_bf16 v[172:175], v[56:59], v[44:47], v[172:175]
ds_read_b64_tr_b16 v[126:127], v12 offset:45056
s_waitcnt lgkmcnt(14)
v_mfma_f32_16x16x32_bf16 v[236:239], v[72:75], v[44:47], v[236:239]
v_max3_u32 v19, v80, v81, v82
v_mfma_f32_16x16x32_bf16 v[232:235], v[72:75], v[40:43], v[232:235]
v_max3_u32 v19, v19, v83, v84
v_mfma_f32_16x16x32_bf16 v[228:231], v[72:75], v[36:39], v[228:231]
v_max3_u32 v19, v19, v85, v86
v_mfma_f32_16x16x32_bf16 v[224:227], v[72:75], v[32:35], v[224:227]
v_max3_u32 v19, v19, v87, v88
v_mfma_f32_16x16x32_bf16 v[176:179], v[60:63], v[32:35], v[176:179]
v_max3_u32 v19, v19, v89, v90
v_mfma_f32_16x16x32_bf16 v[180:183], v[60:63], v[36:39], v[180:183]
v_max3_u32 v19, v19, v91, v92
v_mfma_f32_16x16x32_bf16 v[184:187], v[60:63], v[40:43], v[184:187]
v_max3_u32 v19, v19, v93, v94
v_mfma_f32_16x16x32_bf16 v[188:191], v[60:63], v[44:47], v[188:191]
v_max_u32 v19, v19, v95
v_mfma_f32_16x16x32_bf16 v[252:255], v[76:79], v[44:47], v[252:255]
v_cmp_eq_u32 vcc, -1, v19
v_mfma_f32_16x16x32_bf16 v[248:251], v[76:79], v[40:43], v[248:251]
v_mfma_f32_16x16x32_bf16 v[244:247], v[76:79], v[36:39], v[244:247]
v_mfma_f32_16x16x32_bf16 v[240:243], v[76:79], v[32:35], v[240:243]
s_nop 1
s_cbranch_vccnz Lfx_110
Lok_108:
s_waitcnt lgkmcnt(0)
s_barrier
v_mfma_f32_16x16x32_bf16 v[128:131], v[96:99], v[80:83], v[128:131]
ds_read_b128 v[32:35], v4 offset:0
v_mfma_f32_16x16x32_bf16 v[132:135], v[96:99], v[84:87], v[132:135]
ds_read_b64_tr_b16 v[48:49], v13 offset:16384
v_mfma_f32_16x16x32_bf16 v[136:139], v[96:99], v[88:91], v[136:139]
ds_read_b64_tr_b16 v[50:51], v13 offset:20480
v_mfma_f32_16x16x32_bf16 v[140:143], v[96:99], v[92:95], v[140:143]
ds_read_b128 v[36:39], v4 offset:256
v_mfma_f32_16x16x32_bf16 v[204:207], v[112:115], v[92:95], v[204:207]
ds_read_b128 v[40:43], v4 offset:512
v_mfma_f32_16x16x32_bf16 v[200:203], v[112:115], v[88:91], v[200:203]
ds_read_b128 v[44:47], v4 offset:768
v_mfma_f32_16x16x32_bf16 v[196:199], v[112:115], v[84:87], v[196:199]
ds_read_b64_tr_b16 v[64:65], v13 offset:32768
v_mfma_f32_16x16x32_bf16 v[192:195], v[112:115], v[80:83], v[192:195]
ds_read_b64_tr_b16 v[66:67], v13 offset:36864
v_mfma_f32_16x16x32_bf16 v[144:147], v[100:103], v[80:83], v[144:147]
ds_read_b64_tr_b16 v[52:53], v14 offset:16384
v_mfma_f32_16x16x32_bf16 v[148:151], v[100:103], v[84:87], v[148:151]
ds_read_b64_tr_b16 v[54:55], v14 offset:20480
v_mfma_f32_16x16x32_bf16 v[152:155], v[100:103], v[88:91], v[152:155]
ds_read_b64_tr_b16 v[68:69], v14 offset:32768
v_mfma_f32_16x16x32_bf16 v[156:159], v[100:103], v[92:95], v[156:159]
ds_read_b64_tr_b16 v[70:71], v14 offset:36864
v_mfma_f32_16x16x32_bf16 v[220:223], v[116:119], v[92:95], v[220:223]
ds_read_b64_tr_b16 v[56:57], v15 offset:16384
v_mfma_f32_16x16x32_bf16 v[216:219], v[116:119], v[88:91], v[216:219]
ds_read_b64_tr_b16 v[58:59], v15 offset:20480
v_mfma_f32_16x16x32_bf16 v[212:215], v[116:119], v[84:87], v[212:215]
ds_read_b64_tr_b16 v[72:73], v15 offset:32768
v_mfma_f32_16x16x32_bf16 v[208:211], v[116:119], v[80:83], v[208:211]
ds_read_b64_tr_b16 v[74:75], v15 offset:36864
v_mfma_f32_16x16x32_bf16 v[160:163], v[104:107], v[80:83], v[160:163]
ds_read_b64_tr_b16 v[60:61], v16 offset:16384
v_mfma_f32_16x16x32_bf16 v[164:167], v[104:107], v[84:87], v[164:167]
ds_read_b64_tr_b16 v[62:63], v16 offset:20480
v_mfma_f32_16x16x32_bf16 v[168:171], v[104:107], v[88:91], v[168:171]
ds_read_b64_tr_b16 v[76:77], v16 offset:32768
v_mfma_f32_16x16x32_bf16 v[172:175], v[104:107], v[92:95], v[172:175]
ds_read_b64_tr_b16 v[78:79], v16 offset:36864
s_waitcnt lgkmcnt(14)
v_mfma_f32_16x16x32_bf16 v[236:239], v[120:123], v[92:95], v[236:239]
v_max3_u32 v19, v32, v33, v34
v_mfma_f32_16x16x32_bf16 v[232:235], v[120:123], v[88:91], v[232:235]
v_max3_u32 v19, v19, v35, v36
v_mfma_f32_16x16x32_bf16 v[228:231], v[120:123], v[84:87], v[228:231]
v_max3_u32 v19, v19, v37, v38
v_mfma_f32_16x16x32_bf16 v[224:227], v[120:123], v[80:83], v[224:227]
v_max3_u32 v19, v19, v39, v40
v_mfma_f32_16x16x32_bf16 v[176:179], v[108:111], v[80:83], v[176:179]
v_max3_u32 v19, v19, v41, v42
v_mfma_f32_16x16x32_bf16 v[180:183], v[108:111], v[84:87], v[180:183]
v_max3_u32 v19, v19, v43, v44
v_mfma_f32_16x16x32_bf16 v[184:187], v[108:111], v[88:91], v[184:187]
v_max3_u32 v19, v19, v45, v46
v_mfma_f32_16x16x32_bf16 v[188:191], v[108:111], v[92:95], v[188:191]
v_max_u32 v19, v19, v47
v_mfma_f32_16x16x32_bf16 v[252:255], v[124:127], v[92:95], v[252:255]
v_cmp_eq_u32 vcc, -1, v19
v_mfma_f32_16x16x32_bf16 v[248:251], v[124:127], v[88:91], v[248:251]
v_mfma_f32_16x16x32_bf16 v[244:247], v[124:127], v[84:87], v[244:247]
v_mfma_f32_16x16x32_bf16 v[240:243], v[124:127], v[80:83], v[240:243]
s_nop 1
s_cbranch_vccnz Lfx_113
Lok_111:
s_waitcnt lgkmcnt(0)
v_mfma_f32_16x16x32_bf16 v[128:131], v[48:51], v[32:35], v[128:131]
ds_read_b128 v[80:83], v4 offset:8192
v_mfma_f32_16x16x32_bf16 v[132:135], v[48:51], v[36:39], v[132:135]
ds_read_b64_tr_b16 v[96:97], v13 offset:24576
v_mfma_f32_16x16x32_bf16 v[136:139], v[48:51], v[40:43], v[136:139]
ds_read_b64_tr_b16 v[98:99], v13 offset:28672
v_mfma_f32_16x16x32_bf16 v[140:143], v[48:51], v[44:47], v[140:143]
ds_read_b128 v[84:87], v4 offset:8448
v_mfma_f32_16x16x32_bf16 v[204:207], v[64:67], v[44:47], v[204:207]
ds_read_b128 v[88:91], v4 offset:8704
v_mfma_f32_16x16x32_bf16 v[200:203], v[64:67], v[40:43], v[200:203]
ds_read_b128 v[92:95], v4 offset:8960
v_mfma_f32_16x16x32_bf16 v[196:199], v[64:67], v[36:39], v[196:199]
ds_read_b64_tr_b16 v[112:113], v13 offset:40960
v_mfma_f32_16x16x32_bf16 v[192:195], v[64:67], v[32:35], v[192:195]
ds_read_b64_tr_b16 v[114:115], v13 offset:45056
v_mfma_f32_16x16x32_bf16 v[144:147], v[52:55], v[32:35], v[144:147]
ds_read_b64_tr_b16 v[100:101], v14 offset:24576
v_mfma_f32_16x16x32_bf16 v[148:151], v[52:55], v[36:39], v[148:151]
ds_read_b64_tr_b16 v[102:103], v14 offset:28672
v_mfma_f32_16x16x32_bf16 v[152:155], v[52:55], v[40:43], v[152:155]
ds_read_b64_tr_b16 v[116:117], v14 offset:40960
v_mfma_f32_16x16x32_bf16 v[156:159], v[52:55], v[44:47], v[156:159]
ds_read_b64_tr_b16 v[118:119], v14 offset:45056
v_mfma_f32_16x16x32_bf16 v[220:223], v[68:71], v[44:47], v[220:223]
ds_read_b64_tr_b16 v[104:105], v15 offset:24576
v_mfma_f32_16x16x32_bf16 v[216:219], v[68:71], v[40:43], v[216:219]
ds_read_b64_tr_b16 v[106:107], v15 offset:28672
v_mfma_f32_16x16x32_bf16 v[212:215], v[68:71], v[36:39], v[212:215]
ds_read_b64_tr_b16 v[120:121], v15 offset:40960
v_mfma_f32_16x16x32_bf16 v[208:211], v[68:71], v[32:35], v[208:211]
ds_read_b64_tr_b16 v[122:123], v15 offset:45056
v_mfma_f32_16x16x32_bf16 v[160:163], v[56:59], v[32:35], v[160:163]
ds_read_b64_tr_b16 v[108:109], v16 offset:24576
v_mfma_f32_16x16x32_bf16 v[164:167], v[56:59], v[36:39], v[164:167]
ds_read_b64_tr_b16 v[110:111], v16 offset:28672
v_mfma_f32_16x16x32_bf16 v[168:171], v[56:59], v[40:43], v[168:171]
ds_read_b64_tr_b16 v[124:125], v16 offset:40960
v_mfma_f32_16x16x32_bf16 v[172:175], v[56:59], v[44:47], v[172:175]
ds_read_b64_tr_b16 v[126:127], v16 offset:45056
s_waitcnt lgkmcnt(14)
v_mfma_f32_16x16x32_bf16 v[236:239], v[72:75], v[44:47], v[236:239]
v_max3_u32 v19, v80, v81, v82
v_mfma_f32_16x16x32_bf16 v[232:235], v[72:75], v[40:43], v[232:235]
v_max3_u32 v19, v19, v83, v84
v_mfma_f32_16x16x32_bf16 v[228:231], v[72:75], v[36:39], v[228:231]
v_max3_u32 v19, v19, v85, v86
v_mfma_f32_16x16x32_bf16 v[224:227], v[72:75], v[32:35], v[224:227]
v_max3_u32 v19, v19, v87, v88
v_mfma_f32_16x16x32_bf16 v[176:179], v[60:63], v[32:35], v[176:179]
v_max3_u32 v19, v19, v89, v90
v_mfma_f32_16x16x32_bf16 v[180:183], v[60:63], v[36:39], v[180:183]
v_max3_u32 v19, v19, v91, v92
v_mfma_f32_16x16x32_bf16 v[184:187], v[60:63], v[40:43], v[184:187]
v_max3_u32 v19, v19, v93, v94
v_mfma_f32_16x16x32_bf16 v[188:191], v[60:63], v[44:47], v[188:191]
v_max_u32 v19, v19, v95
v_mfma_f32_16x16x32_bf16 v[252:255], v[76:79], v[44:47], v[252:255]
v_cmp_eq_u32 vcc, -1, v19
v_mfma_f32_16x16x32_bf16 v[248:251], v[76:79], v[40:43], v[248:251]
v_mfma_f32_16x16x32_bf16 v[244:247], v[76:79], v[36:39], v[244:247]
v_mfma_f32_16x16x32_bf16 v[240:243], v[76:79], v[32:35], v[240:243]
s_nop 1
s_cbranch_vccnz Lfx_116
Lok_114:
s_waitcnt lgkmcnt(0)
s_barrier
v_mfma_f32_16x16x32_bf16 v[128:131], v[96:99], v[80:83], v[128:131]
ds_read_b128 v[32:35], v2 offset:0
v_mfma_f32_16x16x32_bf16 v[132:135], v[96:99], v[84:87], v[132:135]
ds_read_b64_tr_b16 v[48:49], v5 offset:16384
v_mfma_f32_16x16x32_bf16 v[136:139], v[96:99], v[88:91], v[136:139]
ds_read_b64_tr_b16 v[50:51], v5 offset:20480
v_mfma_f32_16x16x32_bf16 v[140:143], v[96:99], v[92:95], v[140:143]
ds_read_b128 v[36:39], v2 offset:256
v_mfma_f32_16x16x32_bf16 v[204:207], v[112:115], v[92:95], v[204:207]
ds_read_b128 v[40:43], v2 offset:512
v_mfma_f32_16x16x32_bf16 v[200:203], v[112:115], v[88:91], v[200:203]
ds_read_b128 v[44:47], v2 offset:768
v_mfma_f32_16x16x32_bf16 v[196:199], v[112:115], v[84:87], v[196:199]
ds_read_b64_tr_b16 v[64:65], v5 offset:32768
v_mfma_f32_16x16x32_bf16 v[192:195], v[112:115], v[80:83], v[192:195]
ds_read_b64_tr_b16 v[66:67], v5 offset:36864
v_mfma_f32_16x16x32_bf16 v[144:147], v[100:103], v[80:83], v[144:147]
ds_read_b64_tr_b16 v[52:53], v6 offset:16384
v_mfma_f32_16x16x32_bf16 v[148:151], v[100:103], v[84:87], v[148:151]
ds_read_b64_tr_b16 v[54:55], v6 offset:20480
v_mfma_f32_16x16x32_bf16 v[152:155], v[100:103], v[88:91], v[152:155]
ds_read_b64_tr_b16 v[68:69], v6 offset:32768
v_mfma_f32_16x16x32_bf16 v[156:159], v[100:103], v[92:95], v[156:159]
ds_read_b64_tr_b16 v[70:71], v6 offset:36864
v_mfma_f32_16x16x32_bf16 v[220:223], v[116:119], v[92:95], v[220:223]
ds_read_b64_tr_b16 v[56:57], v7 offset:16384
v_mfma_f32_16x16x32_bf16 v[216:219], v[116:119], v[88:91], v[216:219]
ds_read_b64_tr_b16 v[58:59], v7 offset:20480
v_mfma_f32_16x16x32_bf16 v[212:215], v[116:119], v[84:87], v[212:215]
ds_read_b64_tr_b16 v[72:73], v7 offset:32768
v_mfma_f32_16x16x32_bf16 v[208:211], v[116:119], v[80:83], v[208:211]
ds_read_b64_tr_b16 v[74:75], v7 offset:36864
v_mfma_f32_16x16x32_bf16 v[160:163], v[104:107], v[80:83], v[160:163]
ds_read_b64_tr_b16 v[60:61], v8 offset:16384
v_mfma_f32_16x16x32_bf16 v[164:167], v[104:107], v[84:87], v[164:167]
ds_read_b64_tr_b16 v[62:63], v8 offset:20480
v_mfma_f32_16x16x32_bf16 v[168:171], v[104:107], v[88:91], v[168:171]
ds_read_b64_tr_b16 v[76:77], v8 offset:32768
v_mfma_f32_16x16x32_bf16 v[172:175], v[104:107], v[92:95], v[172:175]
ds_read_b64_tr_b16 v[78:79], v8 offset:36864
s_waitcnt lgkmcnt(14)
v_mfma_f32_16x16x32_bf16 v[236:239], v[120:123], v[92:95], v[236:239]
v_max3_u32 v19, v32, v33, v34
v_mfma_f32_16x16x32_bf16 v[232:235], v[120:123], v[88:91], v[232:235]
v_max3_u32 v19, v19, v35, v36
v_mfma_f32_16x16x32_bf16 v[228:231], v[120:123], v[84:87], v[228:231]
v_max3_u32 v19, v19, v37, v38
v_mfma_f32_16x16x32_bf16 v[224:227], v[120:123], v[80:83], v[224:227]
v_max3_u32 v19, v19, v39, v40
v_mfma_f32_16x16x32_bf16 v[176:179], v[108:111], v[80:83], v[176:179]
v_max3_u32 v19, v19, v41, v42
v_mfma_f32_16x16x32_bf16 v[180:183], v[108:111], v[84:87], v[180:183]
v_max3_u32 v19, v19, v43, v44
v_mfma_f32_16x16x32_bf16 v[184:187], v[108:111], v[88:91], v[184:187]
v_max3_u32 v19, v19, v45, v46
v_mfma_f32_16x16x32_bf16 v[188:191], v[108:111], v[92:95], v[188:191]
v_max_u32 v19, v19, v47
v_mfma_f32_16x16x32_bf16 v[252:255], v[124:127], v[92:95], v[252:255]
v_cmp_eq_u32 vcc, -1, v19
v_mfma_f32_16x16x32_bf16 v[248:251], v[124:127], v[88:91], v[248:251]
v_mfma_f32_16x16x32_bf16 v[244:247], v[124:127], v[84:87], v[244:247]
v_mfma_f32_16x16x32_bf16 v[240:243], v[124:127], v[80:83], v[240:243]
s_nop 1
s_cbranch_vccnz Lfx_119
Lok_117:
s_waitcnt lgkmcnt(0)
v_mfma_f32_16x16x32_bf16 v[128:131], v[48:51], v[32:35], v[128:131]
ds_read_b128 v[80:83], v2 offset:8192
v_mfma_f32_16x16x32_bf16 v[132:135], v[48:51], v[36:39], v[132:135]
ds_read_b64_tr_b16 v[96:97], v5 offset:24576
v_mfma_f32_16x16x32_bf16 v[136:139], v[48:51], v[40:43], v[136:139]
ds_read_b64_tr_b16 v[98:99], v5 offset:28672
v_mfma_f32_16x16x32_bf16 v[140:143], v[48:51], v[44:47], v[140:143]
ds_read_b128 v[84:87], v2 offset:8448
v_mfma_f32_16x16x32_bf16 v[204:207], v[64:67], v[44:47], v[204:207]
ds_read_b128 v[88:91], v2 offset:8704
v_mfma_f32_16x16x32_bf16 v[200:203], v[64:67], v[40:43], v[200:203]
ds_read_b128 v[92:95], v2 offset:8960
v_mfma_f32_16x16x32_bf16 v[196:199], v[64:67], v[36:39], v[196:199]
ds_read_b64_tr_b16 v[112:113], v5 offset:40960
v_mfma_f32_16x16x32_bf16 v[192:195], v[64:67], v[32:35], v[192:195]
ds_read_b64_tr_b16 v[114:115], v5 offset:45056
v_mfma_f32_16x16x32_bf16 v[144:147], v[52:55], v[32:35], v[144:147]
ds_read_b64_tr_b16 v[100:101], v6 offset:24576
v_mfma_f32_16x16x32_bf16 v[148:151], v[52:55], v[36:39], v[148:151]
ds_read_b64_tr_b16 v[102:103], v6 offset:28672
v_mfma_f32_16x16x32_bf16 v[152:155], v[52:55], v[40:43], v[152:155]
ds_read_b64_tr_b16 v[116:117], v6 offset:40960
v_mfma_f32_16x16x32_bf16 v[156:159], v[52:55], v[44:47], v[156:159]
ds_read_b64_tr_b16 v[118:119], v6 offset:45056
v_mfma_f32_16x16x32_bf16 v[220:223], v[68:71], v[44:47], v[220:223]
ds_read_b64_tr_b16 v[104:105], v7 offset:24576
v_mfma_f32_16x16x32_bf16 v[216:219], v[68:71], v[40:43], v[216:219]
ds_read_b64_tr_b16 v[106:107], v7 offset:28672
v_mfma_f32_16x16x32_bf16 v[212:215], v[68:71], v[36:39], v[212:215]
ds_read_b64_tr_b16 v[120:121], v7 offset:40960
v_mfma_f32_16x16x32_bf16 v[208:211], v[68:71], v[32:35], v[208:211]
ds_read_b64_tr_b16 v[122:123], v7 offset:45056
v_mfma_f32_16x16x32_bf16 v[160:163], v[56:59], v[32:35], v[160:163]
ds_read_b64_tr_b16 v[108:109], v8 offset:24576
v_mfma_f32_16x16x32_bf16 v[164:167], v[56:59], v[36:39], v[164:167]
ds_read_b64_tr_b16 v[110:111], v8 offset:28672
v_mfma_f32_16x16x32_bf16 v[168:171], v[56:59], v[40:43], v[168:171]
ds_read_b64_tr_b16 v[124:125], v8 offset:40960
v_mfma_f32_16x16x32_bf16 v[172:175], v[56:59], v[44:47], v[172:175]
ds_read_b64_tr_b16 v[126:127], v8 offset:45056
s_waitcnt lgkmcnt(14)
v_mfma_f32_16x16x32_bf16 v[236:239], v[72:75], v[44:47], v[236:239]
v_max3_u32 v19, v80, v81, v82
v_mfma_f32_16x16x32_bf16 v[232:235], v[72:75], v[40:43], v[232:235]
v_max3_u32 v19, v19, v83, v84
v_mfma_f32_16x16x32_bf16 v[228:231], v[72:75], v[36:39], v[228:231]
v_max3_u32 v19, v19, v85, v86
v_mfma_f32_16x16x32_bf16 v[224:227], v[72:75], v[32:35], v[224:227]
v_max3_u32 v19, v19, v87, v88
v_mfma_f32_16x16x32_bf16 v[176:179], v[60:63], v[32:35], v[176:179]
v_max3_u32 v19, v19, v89, v90
v_mfma_f32_16x16x32_bf16 v[180:183], v[60:63], v[36:39], v[180:183]
v_max3_u32 v19, v19, v91, v92
v_mfma_f32_16x16x32_bf16 v[184:187], v[60:63], v[40:43], v[184:187]
v_max3_u32 v19, v19, v93, v94
v_mfma_f32_16x16x32_bf16 v[188:191], v[60:63], v[44:47], v[188:191]
v_max_u32 v19, v19, v95
v_mfma_f32_16x16x32_bf16 v[252:255], v[76:79], v[44:47], v[252:255]
v_cmp_eq_u32 vcc, -1, v19
v_mfma_f32_16x16x32_bf16 v[248:251], v[76:79], v[40:43], v[248:251]
v_mfma_f32_16x16x32_bf16 v[244:247], v[76:79], v[36:39], v[244:247]
v_mfma_f32_16x16x32_bf16 v[240:243], v[76:79], v[32:35], v[240:243]
s_nop 1
s_cbranch_vccnz Lfx_122
Lok_120:
s_waitcnt lgkmcnt(0)
s_barrier
v_mfma_f32_16x16x32_bf16 v[128:131], v[96:99], v[80:83], v[128:131]
ds_read_b128 v[32:35], v3 offset:0
v_mfma_f32_16x16x32_bf16 v[132:135], v[96:99], v[84:87], v[132:135]
ds_read_b64_tr_b16 v[48:49], v9 offset:16384
v_mfma_f32_16x16x32_bf16 v[136:139], v[96:99], v[88:91], v[136:139]
ds_read_b64_tr_b16 v[50:51], v9 offset:20480
v_mfma_f32_16x16x32_bf16 v[140:143], v[96:99], v[92:95], v[140:143]
ds_read_b128 v[36:39], v3 offset:256
v_mfma_f32_16x16x32_bf16 v[204:207], v[112:115], v[92:95], v[204:207]
ds_read_b128 v[40:43], v3 offset:512
v_mfma_f32_16x16x32_bf16 v[200:203], v[112:115], v[88:91], v[200:203]
ds_read_b128 v[44:47], v3 offset:768
v_mfma_f32_16x16x32_bf16 v[196:199], v[112:115], v[84:87], v[196:199]
ds_read_b64_tr_b16 v[64:65], v9 offset:32768
v_mfma_f32_16x16x32_bf16 v[192:195], v[112:115], v[80:83], v[192:195]
ds_read_b64_tr_b16 v[66:67], v9 offset:36864
v_mfma_f32_16x16x32_bf16 v[144:147], v[100:103], v[80:83], v[144:147]
ds_read_b64_tr_b16 v[52:53], v10 offset:16384
v_mfma_f32_16x16x32_bf16 v[148:151], v[100:103], v[84:87], v[148:151]
ds_read_b64_tr_b16 v[54:55], v10 offset:20480
v_mfma_f32_16x16x32_bf16 v[152:155], v[100:103], v[88:91], v[152:155]
ds_read_b64_tr_b16 v[68:69], v10 offset:32768
v_mfma_f32_16x16x32_bf16 v[156:159], v[100:103], v[92:95], v[156:159]
ds_read_b64_tr_b16 v[70:71], v10 offset:36864
v_mfma_f32_16x16x32_bf16 v[220:223], v[116:119], v[92:95], v[220:223]
ds_read_b64_tr_b16 v[56:57], v11 offset:16384
v_mfma_f32_16x16x32_bf16 v[216:219], v[116:119], v[88:91], v[216:219]
ds_read_b64_tr_b16 v[58:59], v11 offset:20480
v_mfma_f32_16x16x32_bf16 v[212:215], v[116:119], v[84:87], v[212:215]
ds_read_b64_tr_b16 v[72:73], v11 offset:32768
v_mfma_f32_16x16x32_bf16 v[208:211], v[116:119], v[80:83], v[208:211]
ds_read_b64_tr_b16 v[74:75], v11 offset:36864
v_mfma_f32_16x16x32_bf16 v[160:163], v[104:107], v[80:83], v[160:163]
ds_read_b64_tr_b16 v[60:61], v12 offset:16384
v_mfma_f32_16x16x32_bf16 v[164:167], v[104:107], v[84:87], v[164:167]
ds_read_b64_tr_b16 v[62:63], v12 offset:20480
v_mfma_f32_16x16x32_bf16 v[168:171], v[104:107], v[88:91], v[168:171]
ds_read_b64_tr_b16 v[76:77], v12 offset:32768
v_mfma_f32_16x16x32_bf16 v[172:175], v[104:107], v[92:95], v[172:175]
ds_read_b64_tr_b16 v[78:79], v12 offset:36864
v_mfma_f32_16x16x32_bf16 v[236:239], v[120:123], v[92:95], v[236:239]
v_mfma_f32_16x16x32_bf16 v[232:235], v[120:123], v[88:91], v[232:235]
v_mfma_f32_16x16x32_bf16 v[228:231], v[120:123], v[84:87], v[228:231]
v_mfma_f32_16x16x32_bf16 v[224:227], v[120:123], v[80:83], v[224:227]
v_mfma_f32_16x16x32_bf16 v[176:179], v[108:111], v[80:83], v[176:179]
v_mfma_f32_16x16x32_bf16 v[180:183], v[108:111], v[84:87], v[180:183]
v_mfma_f32_16x16x32_bf16 v[184:187], v[108:111], v[88:91], v[184:187]
v_mfma_f32_16x16x32_bf16 v[188:191], v[108:111], v[92:95], v[188:191]
v_mfma_f32_16x16x32_bf16 v[252:255], v[124:127], v[92:95], v[252:255]
v_mfma_f32_16x16x32_bf16 v[248:251], v[124:127], v[88:91], v[248:251]
v_mfma_f32_16x16x32_bf16 v[244:247], v[124:127], v[84:87], v[244:247]
v_mfma_f32_16x16x32_bf16 v[240:243], v[124:127], v[80:83], v[240:243]
s_mov_b32 s41, 2
.p2align 3
Lk3_123:
s_waitcnt lgkmcnt(0)
v_mfma_f32_16x16x32_bf16 v[128:131], v[48:51], v[32:35], v[128:131]
ds_read_b128 v[80:83], v3 offset:8192
v_mfma_f32_16x16x32_bf16 v[132:135], v[48:51], v[36:39], v[132:135]
ds_read_b64_tr_b16 v[96:97], v9 offset:24576
v_mfma_f32_16x16x32_bf16 v[136:139], v[48:51], v[40:43], v[136:139]
ds_read_b64_tr_b16 v[98:99], v9 offset:28672
v_mfma_f32_16x16x32_bf16 v[140:143], v[48:51], v[44:47], v[140:143]
ds_read_b128 v[84:87], v3 offset:8448
v_mfma_f32_16x16x32_bf16 v[204:207], v[64:67], v[44:47], v[204:207]
ds_read_b128 v[88:91], v3 offset:8704
v_mfma_f32_16x16x32_bf16 v[200:203], v[64:67], v[40:43], v[200:203]
ds_read_b128 v[92:95], v3 offset:8960
v_mfma_f32_16x16x32_bf16 v[196:199], v[64:67], v[36:39], v[196:199]
ds_read_b64_tr_b16 v[112:113], v9 offset:40960
v_mfma_f32_16x16x32_bf16 v[192:195], v[64:67], v[32:35], v[192:195]
ds_read_b64_tr_b16 v[114:115], v9 offset:45056
v_mfma_f32_16x16x32_bf16 v[144:147], v[52:55], v[32:35], v[144:147]
ds_read_b64_tr_b16 v[100:101], v10 offset:24576
v_mfma_f32_16x16x32_bf16 v[148:151], v[52:55], v[36:39], v[148:151]
ds_read_b64_tr_b16 v[102:103], v10 offset:28672
v_mfma_f32_16x16x32_bf16 v[152:155], v[52:55], v[40:43], v[152:155]
ds_read_b64_tr_b16 v[116:117], v10 offset:40960
v_mfma_f32_16x16x32_bf16 v[156:159], v[52:55], v[44:47], v[156:159]
ds_read_b64_tr_b16 v[118:119], v10 offset:45056
v_mfma_f32_16x16x32_bf16 v[220:223], v[68:71], v[44:47], v[220:223]
ds_read_b64_tr_b16 v[104:105], v11 offset:24576
v_mfma_f32_16x16x32_bf16 v[216:219], v[68:71], v[40:43], v[216:219]
ds_read_b64_tr_b16 v[106:107], v11 offset:28672
v_mfma_f32_16x16x32_bf16 v[212:215], v[68:71], v[36:39], v[212:215]
ds_read_b64_tr_b16 v[120:121], v11 offset:40960
v_mfma_f32_16x16x32_bf16 v[208:211], v[68:71], v[32:35], v[208:211]
ds_read_b64_tr_b16 v[122:123], v11 offset:45056
v_mfma_f32_16x16x32_bf16 v[160:163], v[56:59], v[32:35], v[160:163]
ds_read_b64_tr_b16 v[108:109], v12 offset:24576
v_mfma_f32_16x16x32_bf16 v[164:167], v[56:59], v[36:39], v[164:167]
ds_read_b64_tr_b16 v[110:111], v12 offset:28672
v_mfma_f32_16x16x32_bf16 v[168:171], v[56:59], v[40:43], v[168:171]
ds_read_b64_tr_b16 v[124:125], v12 offset:40960
v_mfma_f32_16x16x32_bf16 v[172:175], v[56:59], v[44:47], v[172:175]
ds_read_b64_tr_b16 v[126:127], v12 offset:45056
v_mfma_f32_16x16x32_bf16 v[236:239], v[72:75], v[44:47], v[236:239]
v_mfma_f32_16x16x32_bf16 v[232:235], v[72:75], v[40:43], v[232:235]
v_mfma_f32_16x16x32_bf16 v[228:231], v[72:75], v[36:39], v[228:231]
v_mfma_f32_16x16x32_bf16 v[224:227], v[72:75], v[32:35], v[224:227]
v_mfma_f32_16x16x32_bf16 v[176:179], v[60:63], v[32:35], v[176:179]
v_mfma_f32_16x16x32_bf16 v[180:183], v[60:63], v[36:39], v[180:183]
v_mfma_f32_16x16x32_bf16 v[184:187], v[60:63], v[40:43], v[184:187]
v_mfma_f32_16x16x32_bf16 v[188:191], v[60:63], v[44:47], v[188:191]
v_mfma_f32_16x16x32_bf16 v[252:255], v[76:79], v[44:47], v[252:255]
v_mfma_f32_16x16x32_bf16 v[248:251], v[76:79], v[40:43], v[248:251]
v_mfma_f32_16x16x32_bf16 v[244:247], v[76:79], v[36:39], v[244:247]
v_mfma_f32_16x16x32_bf16 v[240:243], v[76:79], v[32:35], v[240:243]
s_waitcnt lgkmcnt(0)
s_barrier
v_mfma_f32_16x16x32_bf16 v[128:131], v[96:99], v[80:83], v[128:131]
ds_read_b128 v[32:35], v4 offset:0
v_mfma_f32_16x16x32_bf16 v[132:135], v[96:99], v[84:87], v[132:135]
ds_read_b64_tr_b16 v[48:49], v13 offset:16384
v_mfma_f32_16x16x32_bf16 v[136:139], v[96:99], v[88:91], v[136:139]
ds_read_b64_tr_b16 v[50:51], v13 offset:20480
v_mfma_f32_16x16x32_bf16 v[140:143], v[96:99], v[92:95], v[140:143]
ds_read_b128 v[36:39], v4 offset:256
v_mfma_f32_16x16x32_bf16 v[204:207], v[112:115], v[92:95], v[204:207]
ds_read_b128 v[40:43], v4 offset:512
v_mfma_f32_16x16x32_bf16 v[200:203], v[112:115], v[88:91], v[200:203]
ds_read_b128 v[44:47], v4 offset:768
v_mfma_f32_16x16x32_bf16 v[196:199], v[112:115], v[84:87], v[196:199]
ds_read_b64_tr_b16 v[64:65], v13 offset:32768
v_mfma_f32_16x16x32_bf16 v[192:195], v[112:115], v[80:83], v[192:195]
ds_read_b64_tr_b16 v[66:67], v13 offset:36864
v_mfma_f32_16x16x32_bf16 v[144:147], v[100:103], v[80:83], v[144:147]
ds_read_b64_tr_b16 v[52:53], v14 offset:16384
v_mfma_f32_16x16x32_bf16 v[148:151], v[100:103], v[84:87], v[148:151]
ds_read_b64_tr_b16 v[54:55], v14 offset:20480
v_mfma_f32_16x16x32_bf16 v[152:155], v[100:103], v[88:91], v[152:155]
ds_read_b64_tr_b16 v[68:69], v14 offset:32768
v_mfma_f32_16x16x32_bf16 v[156:159], v[100:103], v[92:95], v[156:159]
ds_read_b64_tr_b16 v[70:71], v14 offset:36864
v_mfma_f32_16x16x32_bf16 v[220:223], v[116:119], v[92:95], v[220:223]
ds_read_b64_tr_b16 v[56:57], v15 offset:16384
v_mfma_f32_16x16x32_bf16 v[216:219], v[116:119], v[88:91], v[216:219]
ds_read_b64_tr_b16 v[58:59], v15 offset:20480
v_mfma_f32_16x16x32_bf16 v[212:215], v[116:119], v[84:87], v[212:215]
ds_read_b64_tr_b16 v[72:73], v15 offset:32768
v_mfma_f32_16x16x32_bf16 v[208:211], v[116:119], v[80:83], v[208:211]
ds_read_b64_tr_b16 v[74:75], v15 offset:36864
v_mfma_f32_16x16x32_bf16 v[160:163], v[104:107], v[80:83], v[160:163]
ds_read_b64_tr_b16 v[60:61], v16 offset:16384
v_mfma_f32_16x16x32_bf16 v[164:167], v[104:107], v[84:87], v[164:167]
ds_read_b64_tr_b16 v[62:63], v16 offset:20480
v_mfma_f32_16x16x32_bf16 v[168:171], v[104:107], v[88:91], v[168:171]
ds_read_b64_tr_b16 v[76:77], v16 offset:32768
v_mfma_f32_16x16x32_bf16 v[172:175], v[104:107], v[92:95], v[172:175]
ds_read_b64_tr_b16 v[78:79], v16 offset:36864
v_mfma_f32_16x16x32_bf16 v[236:239], v[120:123], v[92:95], v[236:239]
v_mfma_f32_16x16x32_bf16 v[232:235], v[120:123], v[88:91], v[232:235]
v_mfma_f32_16x16x32_bf16 v[228:231], v[120:123], v[84:87], v[228:231]
v_mfma_f32_16x16x32_bf16 v[224:227], v[120:123], v[80:83], v[224:227]
v_mfma_f32_16x16x32_bf16 v[176:179], v[108:111], v[80:83], v[176:179]
v_mfma_f32_16x16x32_bf16 v[180:183], v[108:111], v[84:87], v[180:183]
v_mfma_f32_16x16x32_bf16 v[184:187], v[108:111], v[88:91], v[184:187]
v_mfma_f32_16x16x32_bf16 v[188:191], v[108:111], v[92:95], v[188:191]
v_mfma_f32_16x16x32_bf16 v[252:255], v[124:127], v[92:95], v[252:255]
v_mfma_f32_16x16x32_bf16 v[248:251], v[124:127], v[88:91], v[248:251]
v_mfma_f32_16x16x32_bf16 v[244:247], v[124:127], v[84:87], v[244:247]
v_mfma_f32_16x16x32_bf16 v[240:243], v[124:127], v[80:83], v[240:243]
s_waitcnt lgkmcnt(0)
v_mfma_f32_16x16x32_bf16 v[128:131], v[48:51], v[32:35], v[128:131]
ds_read_b128 v[80:83], v4 offset:8192
v_mfma_f32_16x16x32_bf16 v[132:135], v[48:51], v[36:39], v[132:135]
ds_read_b64_tr_b16 v[96:97], v13 offset:24576
v_mfma_f32_16x16x32_bf16 v[136:139], v[48:51], v[40:43], v[136:139]
ds_read_b64_tr_b16 v[98:99], v13 offset:28672
v_mfma_f32_16x16x32_bf16 v[140:143], v[48:51], v[44:47], v[140:143]
ds_read_b128 v[84:87], v4 offset:8448
v_mfma_f32_16x16x32_bf16 v[204:207], v[64:67], v[44:47], v[204:207]
ds_read_b128 v[88:91], v4 offset:8704
v_mfma_f32_16x16x32_bf16 v[200:203], v[64:67], v[40:43], v[200:203]
ds_read_b128 v[92:95], v4 offset:8960
v_mfma_f32_16x16x32_bf16 v[196:199], v[64:67], v[36:39], v[196:199]
ds_read_b64_tr_b16 v[112:113], v13 offset:40960
v_mfma_f32_16x16x32_bf16 v[192:195], v[64:67], v[32:35], v[192:195]
ds_read_b64_tr_b16 v[114:115], v13 offset:45056
v_mfma_f32_16x16x32_bf16 v[144:147], v[52:55], v[32:35], v[144:147]
ds_read_b64_tr_b16 v[100:101], v14 offset:24576
v_mfma_f32_16x16x32_bf16 v[148:151], v[52:55], v[36:39], v[148:151]
ds_read_b64_tr_b16 v[102:103], v14 offset:28672
v_mfma_f32_16x16x32_bf16 v[152:155], v[52:55], v[40:43], v[152:155]
ds_read_b64_tr_b16 v[116:117], v14 offset:40960
v_mfma_f32_16x16x32_bf16 v[156:159], v[52:55], v[44:47], v[156:159]
ds_read_b64_tr_b16 v[118:119], v14 offset:45056
v_mfma_f32_16x16x32_bf16 v[220:223], v[68:71], v[44:47], v[220:223]
ds_read_b64_tr_b16 v[104:105], v15 offset:24576
v_mfma_f32_16x16x32_bf16 v[216:219], v[68:71], v[40:43], v[216:219]
ds_read_b64_tr_b16 v[106:107], v15 offset:28672
v_mfma_f32_16x16x32_bf16 v[212:215], v[68:71], v[36:39], v[212:215]
ds_read_b64_tr_b16 v[120:121], v15 offset:40960
v_mfma_f32_16x16x32_bf16 v[208:211], v[68:71], v[32:35], v[208:211]
ds_read_b64_tr_b16 v[122:123], v15 offset:45056
v_mfma_f32_16x16x32_bf16 v[160:163], v[56:59], v[32:35], v[160:163]
ds_read_b64_tr_b16 v[108:109], v16 offset:24576
v_mfma_f32_16x16x32_bf16 v[164:167], v[56:59], v[36:39], v[164:167]
ds_read_b64_tr_b16 v[110:111], v16 offset:28672
v_mfma_f32_16x16x32_bf16 v[168:171], v[56:59], v[40:43], v[168:171]
ds_read_b64_tr_b16 v[124:125], v16 offset:40960
v_mfma_f32_16x16x32_bf16 v[172:175], v[56:59], v[44:47], v[172:175]
ds_read_b64_tr_b16 v[126:127], v16 offset:45056
v_mfma_f32_16x16x32_bf16 v[236:239], v[72:75], v[44:47], v[236:239]
v_mfma_f32_16x16x32_bf16 v[232:235], v[72:75], v[40:43], v[232:235]
v_mfma_f32_16x16x32_bf16 v[228:231], v[72:75], v[36:39], v[228:231]
v_mfma_f32_16x16x32_bf16 v[224:227], v[72:75], v[32:35], v[224:227]
v_mfma_f32_16x16x32_bf16 v[176:179], v[60:63], v[32:35], v[176:179]
v_mfma_f32_16x16x32_bf16 v[180:183], v[60:63], v[36:39], v[180:183]
v_mfma_f32_16x16x32_bf16 v[184:187], v[60:63], v[40:43], v[184:187]
v_mfma_f32_16x16x32_bf16 v[188:191], v[60:63], v[44:47], v[188:191]
v_mfma_f32_16x16x32_bf16 v[252:255], v[76:79], v[44:47], v[252:255]
v_mfma_f32_16x16x32_bf16 v[248:251], v[76:79], v[40:43], v[248:251]
v_mfma_f32_16x16x32_bf16 v[244:247], v[76:79], v[36:39], v[244:247]
v_mfma_f32_16x16x32_bf16 v[240:243], v[76:79], v[32:35], v[240:243]
s_waitcnt lgkmcnt(0)
s_barrier
v_mfma_f32_16x16x32_bf16 v[128:131], v[96:99], v[80:83], v[128:131]
ds_read_b128 v[32:35], v2 offset:0
v_mfma_f32_16x16x32_bf16 v[132:135], v[96:99], v[84:87], v[132:135]
ds_read_b64_tr_b16 v[48:49], v5 offset:16384
v_mfma_f32_16x16x32_bf16 v[136:139], v[96:99], v[88:91], v[136:139]
ds_read_b64_tr_b16 v[50:51], v5 offset:20480
v_mfma_f32_16x16x32_bf16 v[140:143], v[96:99], v[92:95], v[140:143]
ds_read_b128 v[36:39], v2 offset:256
v_mfma_f32_16x16x32_bf16 v[204:207], v[112:115], v[92:95], v[204:207]
ds_read_b128 v[40:43], v2 offset:512
v_mfma_f32_16x16x32_bf16 v[200:203], v[112:115], v[88:91], v[200:203]
ds_read_b128 v[44:47], v2 offset:768
v_mfma_f32_16x16x32_bf16 v[196:199], v[112:115], v[84:87], v[196:199]
ds_read_b64_tr_b16 v[64:65], v5 offset:32768
v_mfma_f32_16x16x32_bf16 v[192:195], v[112:115], v[80:83], v[192:195]
ds_read_b64_tr_b16 v[66:67], v5 offset:36864
v_mfma_f32_16x16x32_bf16 v[144:147], v[100:103], v[80:83], v[144:147]
ds_read_b64_tr_b16 v[52:53], v6 offset:16384
v_mfma_f32_16x16x32_bf16 v[148:151], v[100:103], v[84:87], v[148:151]
ds_read_b64_tr_b16 v[54:55], v6 offset:20480
v_mfma_f32_16x16x32_bf16 v[152:155], v[100:103], v[88:91], v[152:155]
ds_read_b64_tr_b16 v[68:69], v6 offset:32768
v_mfma_f32_16x16x32_bf16 v[156:159], v[100:103], v[92:95], v[156:159]
ds_read_b64_tr_b16 v[70:71], v6 offset:36864
v_mfma_f32_16x16x32_bf16 v[220:223], v[116:119], v[92:95], v[220:223]
ds_read_b64_tr_b16 v[56:57], v7 offset:16384
v_mfma_f32_16x16x32_bf16 v[216:219], v[116:119], v[88:91], v[216:219]
ds_read_b64_tr_b16 v[58:59], v7 offset:20480
v_mfma_f32_16x16x32_bf16 v[212:215], v[116:119], v[84:87], v[212:215]
ds_read_b64_tr_b16 v[72:73], v7 offset:32768
v_mfma_f32_16x16x32_bf16 v[208:211], v[116:119], v[80:83], v[208:211]
ds_read_b64_tr_b16 v[74:75], v7 offset:36864
v_mfma_f32_16x16x32_bf16 v[160:163], v[104:107], v[80:83], v[160:163]
ds_read_b64_tr_b16 v[60:61], v8 offset:16384
v_mfma_f32_16x16x32_bf16 v[164:167], v[104:107], v[84:87], v[164:167]
ds_read_b64_tr_b16 v[62:63], v8 offset:20480
v_mfma_f32_16x16x32_bf16 v[168:171], v[104:107], v[88:91], v[168:171]
ds_read_b64_tr_b16 v[76:77], v8 offset:32768
v_mfma_f32_16x16x32_bf16 v[172:175], v[104:107], v[92:95], v[172:175]
ds_read_b64_tr_b16 v[78:79], v8 offset:36864
v_mfma_f32_16x16x32_bf16 v[236:239], v[120:123], v[92:95], v[236:239]
v_mfma_f32_16x16x32_bf16 v[232:235], v[120:123], v[88:91], v[232:235]
v_mfma_f32_16x16x32_bf16 v[228:231], v[120:123], v[84:87], v[228:231]
v_mfma_f32_16x16x32_bf16 v[224:227], v[120:123], v[80:83], v[224:227]
v_mfma_f32_16x16x32_bf16 v[176:179], v[108:111], v[80:83], v[176:179]
v_mfma_f32_16x16x32_bf16 v[180:183], v[108:111], v[84:87], v[180:183]
v_mfma_f32_16x16x32_bf16 v[184:187], v[108:111], v[88:91], v[184:187]
v_mfma_f32_16x16x32_bf16 v[188:191], v[108:111], v[92:95], v[188:191]
v_mfma_f32_16x16x32_bf16 v[252:255], v[124:127], v[92:95], v[252:255]
v_mfma_f32_16x16x32_bf16 v[248:251], v[124:127], v[88:91], v[248:251]
v_mfma_f32_16x16x32_bf16 v[244:247], v[124:127], v[84:87], v[244:247]
v_mfma_f32_16x16x32_bf16 v[240:243], v[124:127], v[80:83], v[240:243]
s_waitcnt lgkmcnt(0)
v_mfma_f32_16x16x32_bf16 v[128:131], v[48:51], v[32:35], v[128:131]
ds_read_b128 v[80:83], v2 offset:8192
v_mfma_f32_16x16x32_bf16 v[132:135], v[48:51], v[36:39], v[132:135]
ds_read_b64_tr_b16 v[96:97], v5 offset:24576
v_mfma_f32_16x16x32_bf16 v[136:139], v[48:51], v[40:43], v[136:139]
ds_read_b64_tr_b16 v[98:99], v5 offset:28672
v_mfma_f32_16x16x32_bf16 v[140:143], v[48:51], v[44:47], v[140:143]
ds_read_b128 v[84:87], v2 offset:8448
v_mfma_f32_16x16x32_bf16 v[204:207], v[64:67], v[44:47], v[204:207]
ds_read_b128 v[88:91], v2 offset:8704
v_mfma_f32_16x16x32_bf16 v[200:203], v[64:67], v[40:43], v[200:203]
ds_read_b128 v[92:95], v2 offset:8960
v_mfma_f32_16x16x32_bf16 v[196:199], v[64:67], v[36:39], v[196:199]
ds_read_b64_tr_b16 v[112:113], v5 offset:40960
v_mfma_f32_16x16x32_bf16 v[192:195], v[64:67], v[32:35], v[192:195]
ds_read_b64_tr_b16 v[114:115], v5 offset:45056
v_mfma_f32_16x16x32_bf16 v[144:147], v[52:55], v[32:35], v[144:147]
ds_read_b64_tr_b16 v[100:101], v6 offset:24576
v_mfma_f32_16x16x32_bf16 v[148:151], v[52:55], v[36:39], v[148:151]
ds_read_b64_tr_b16 v[102:103], v6 offset:28672
v_mfma_f32_16x16x32_bf16 v[152:155], v[52:55], v[40:43], v[152:155]
ds_read_b64_tr_b16 v[116:117], v6 offset:40960
v_mfma_f32_16x16x32_bf16 v[156:159], v[52:55], v[44:47], v[156:159]
ds_read_b64_tr_b16 v[118:119], v6 offset:45056
v_mfma_f32_16x16x32_bf16 v[220:223], v[68:71], v[44:47], v[220:223]
ds_read_b64_tr_b16 v[104:105], v7 offset:24576
v_mfma_f32_16x16x32_bf16 v[216:219], v[68:71], v[40:43], v[216:219]
ds_read_b64_tr_b16 v[106:107], v7 offset:28672
v_mfma_f32_16x16x32_bf16 v[212:215], v[68:71], v[36:39], v[212:215]
ds_read_b64_tr_b16 v[120:121], v7 offset:40960
v_mfma_f32_16x16x32_bf16 v[208:211], v[68:71], v[32:35], v[208:211]
ds_read_b64_tr_b16 v[122:123], v7 offset:45056
v_mfma_f32_16x16x32_bf16 v[160:163], v[56:59], v[32:35], v[160:163]
ds_read_b64_tr_b16 v[108:109], v8 offset:24576
v_mfma_f32_16x16x32_bf16 v[164:167], v[56:59], v[36:39], v[164:167]
ds_read_b64_tr_b16 v[110:111], v8 offset:28672
v_mfma_f32_16x16x32_bf16 v[168:171], v[56:59], v[40:43], v[168:171]
ds_read_b64_tr_b16 v[124:125], v8 offset:40960
v_mfma_f32_16x16x32_bf16 v[172:175], v[56:59], v[44:47], v[172:175]
ds_read_b64_tr_b16 v[126:127], v8 offset:45056
v_mfma_f32_16x16x32_bf16 v[236:239], v[72:75], v[44:47], v[236:239]
v_mfma_f32_16x16x32_bf16 v[232:235], v[72:75], v[40:43], v[232:235]
v_mfma_f32_16x16x32_bf16 v[228:231], v[72:75], v[36:39], v[228:231]
v_mfma_f32_16x16x32_bf16 v[224:227], v[72:75], v[32:35], v[224:227]
v_mfma_f32_16x16x32_bf16 v[176:179], v[60:63], v[32:35], v[176:179]
v_mfma_f32_16x16x32_bf16 v[180:183], v[60:63], v[36:39], v[180:183]
v_mfma_f32_16x16x32_bf16 v[184:187], v[60:63], v[40:43], v[184:187]
v_mfma_f32_16x16x32_bf16 v[188:191], v[60:63], v[44:47], v[188:191]
v_mfma_f32_16x16x32_bf16 v[252:255], v[76:79], v[44:47], v[252:255]
v_mfma_f32_16x16x32_bf16 v[248:251], v[76:79], v[40:43], v[248:251]
v_mfma_f32_16x16x32_bf16 v[244:247], v[76:79], v[36:39], v[244:247]
v_mfma_f32_16x16x32_bf16 v[240:243], v[76:79], v[32:35], v[240:243]
s_waitcnt lgkmcnt(0)
s_barrier
v_mfma_f32_16x16x32_bf16 v[128:131], v[96:99], v[80:83], v[128:131]
ds_read_b128 v[32:35], v3 offset:0
v_mfma_f32_16x16x32_bf16 v[132:135], v[96:99], v[84:87], v[132:135]
ds_read_b64_tr_b16 v[48:49], v9 offset:16384
v_mfma_f32_16x16x32_bf16 v[136:139], v[96:99], v[88:91], v[136:139]
ds_read_b64_tr_b16 v[50:51], v9 offset:20480
v_mfma_f32_16x16x32_bf16 v[140:143], v[96:99], v[92:95], v[140:143]
ds_read_b128 v[36:39], v3 offset:256
v_mfma_f32_16x16x32_bf16 v[204:207], v[112:115], v[92:95], v[204:207]
ds_read_b128 v[40:43], v3 offset:512
v_mfma_f32_16x16x32_bf16 v[200:203], v[112:115], v[88:91], v[200:203]
ds_read_b128 v[44:47], v3 offset:768
v_mfma_f32_16x16x32_bf16 v[196:199], v[112:115], v[84:87], v[196:199]
ds_read_b64_tr_b16 v[64:65], v9 offset:32768
v_mfma_f32_16x16x32_bf16 v[192:195], v[112:115], v[80:83], v[192:195]
ds_read_b64_tr_b16 v[66:67], v9 offset:36864
v_mfma_f32_16x16x32_bf16 v[144:147], v[100:103], v[80:83], v[144:147]
ds_read_b64_tr_b16 v[52:53], v10 offset:16384
v_mfma_f32_16x16x32_bf16 v[148:151], v[100:103], v[84:87], v[148:151]
ds_read_b64_tr_b16 v[54:55], v10 offset:20480
v_mfma_f32_16x16x32_bf16 v[152:155], v[100:103], v[88:91], v[152:155]
ds_read_b64_tr_b16 v[68:69], v10 offset:32768
v_mfma_f32_16x16x32_bf16 v[156:159], v[100:103], v[92:95], v[156:159]
ds_read_b64_tr_b16 v[70:71], v10 offset:36864
v_mfma_f32_16x16x32_bf16 v[220:223], v[116:119], v[92:95], v[220:223]
ds_read_b64_tr_b16 v[56:57], v11 offset:16384
v_mfma_f32_16x16x32_bf16 v[216:219], v[116:119], v[88:91], v[216:219]
ds_read_b64_tr_b16 v[58:59], v11 offset:20480
v_mfma_f32_16x16x32_bf16 v[212:215], v[116:119], v[84:87], v[212:215]
ds_read_b64_tr_b16 v[72:73], v11 offset:32768
v_mfma_f32_16x16x32_bf16 v[208:211], v[116:119], v[80:83], v[208:211]
ds_read_b64_tr_b16 v[74:75], v11 offset:36864
v_mfma_f32_16x16x32_bf16 v[160:163], v[104:107], v[80:83], v[160:163]
ds_read_b64_tr_b16 v[60:61], v12 offset:16384
v_mfma_f32_16x16x32_bf16 v[164:167], v[104:107], v[84:87], v[164:167]
ds_read_b64_tr_b16 v[62:63], v12 offset:20480
v_mfma_f32_16x16x32_bf16 v[168:171], v[104:107], v[88:91], v[168:171]
ds_read_b64_tr_b16 v[76:77], v12 offset:32768
v_mfma_f32_16x16x32_bf16 v[172:175], v[104:107], v[92:95], v[172:175]
ds_read_b64_tr_b16 v[78:79], v12 offset:36864
v_mfma_f32_16x16x32_bf16 v[236:239], v[120:123], v[92:95], v[236:239]
v_mfma_f32_16x16x32_bf16 v[232:235], v[120:123], v[88:91], v[232:235]
v_mfma_f32_16x16x32_bf16 v[228:231], v[120:123], v[84:87], v[228:231]
v_mfma_f32_16x16x32_bf16 v[224:227], v[120:123], v[80:83], v[224:227]
v_mfma_f32_16x16x32_bf16 v[176:179], v[108:111], v[80:83], v[176:179]
v_mfma_f32_16x16x32_bf16 v[180:183], v[108:111], v[84:87], v[180:183]
v_mfma_f32_16x16x32_bf16 v[184:187], v[108:111], v[88:91], v[184:187]
v_mfma_f32_16x16x32_bf16 v[188:191], v[108:111], v[92:95], v[188:191]
v_mfma_f32_16x16x32_bf16 v[252:255], v[124:127], v[92:95], v[252:255]
v_mfma_f32_16x16x32_bf16 v[248:251], v[124:127], v[88:91], v[248:251]
v_mfma_f32_16x16x32_bf16 v[244:247], v[124:127], v[84:87], v[244:247]
v_mfma_f32_16x16x32_bf16 v[240:243], v[124:127], v[80:83], v[240:243]
s_sub_u32 s41, s41, 1
s_cmp_lg_u32 s41, 0
s_cbranch_scc1 Lk3_123
s_waitcnt lgkmcnt(0)
v_mfma_f32_16x16x32_bf16 v[128:131], v[48:51], v[32:35], v[128:131]
ds_read_b128 v[80:83], v3 offset:8192
v_mfma_f32_16x16x32_bf16 v[132:135], v[48:51], v[36:39], v[132:135]
ds_read_b64_tr_b16 v[96:97], v9 offset:24576
v_mfma_f32_16x16x32_bf16 v[136:139], v[48:51], v[40:43], v[136:139]
ds_read_b64_tr_b16 v[98:99], v9 offset:28672
v_mfma_f32_16x16x32_bf16 v[140:143], v[48:51], v[44:47], v[140:143]
ds_read_b128 v[84:87], v3 offset:8448
v_mfma_f32_16x16x32_bf16 v[204:207], v[64:67], v[44:47], v[204:207]
ds_read_b128 v[88:91], v3 offset:8704
v_mfma_f32_16x16x32_bf16 v[200:203], v[64:67], v[40:43], v[200:203]
ds_read_b128 v[92:95], v3 offset:8960
v_mfma_f32_16x16x32_bf16 v[196:199], v[64:67], v[36:39], v[196:199]
ds_read_b64_tr_b16 v[112:113], v9 offset:40960
v_mfma_f32_16x16x32_bf16 v[192:195], v[64:67], v[32:35], v[192:195]
ds_read_b64_tr_b16 v[114:115], v9 offset:45056
v_mfma_f32_16x16x32_bf16 v[144:147], v[52:55], v[32:35], v[144:147]
ds_read_b64_tr_b16 v[100:101], v10 offset:24576
v_mfma_f32_16x16x32_bf16 v[148:151], v[52:55], v[36:39], v[148:151]
ds_read_b64_tr_b16 v[102:103], v10 offset:28672
v_mfma_f32_16x16x32_bf16 v[152:155], v[52:55], v[40:43], v[152:155]
ds_read_b64_tr_b16 v[116:117], v10 offset:40960
v_mfma_f32_16x16x32_bf16 v[156:159], v[52:55], v[44:47], v[156:159]
ds_read_b64_tr_b16 v[118:119], v10 offset:45056
v_mfma_f32_16x16x32_bf16 v[220:223], v[68:71], v[44:47], v[220:223]
ds_read_b64_tr_b16 v[104:105], v11 offset:24576
v_mfma_f32_16x16x32_bf16 v[216:219], v[68:71], v[40:43], v[216:219]
ds_read_b64_tr_b16 v[106:107], v11 offset:28672
v_mfma_f32_16x16x32_bf16 v[212:215], v[68:71], v[36:39], v[212:215]
ds_read_b64_tr_b16 v[120:121], v11 offset:40960
v_mfma_f32_16x16x32_bf16 v[208:211], v[68:71], v[32:35], v[208:211]
ds_read_b64_tr_b16 v[122:123], v11 offset:45056
v_mfma_f32_16x16x32_bf16 v[160:163], v[56:59], v[32:35], v[160:163]
ds_read_b64_tr_b16 v[108:109], v12 offset:24576
v_mfma_f32_16x16x32_bf16 v[164:167], v[56:59], v[36:39], v[164:167]
ds_read_b64_tr_b16 v[110:111], v12 offset:28672
v_mfma_f32_16x16x32_bf16 v[168:171], v[56:59], v[40:43], v[168:171]
ds_read_b64_tr_b16 v[124:125], v12 offset:40960
v_mfma_f32_16x16x32_bf16 v[172:175], v[56:59], v[44:47], v[172:175]
ds_read_b64_tr_b16 v[126:127], v12 offset:45056
v_mfma_f32_16x16x32_bf16 v[236:239], v[72:75], v[44:47], v[236:239]
v_mfma_f32_16x16x32_bf16 v[232:235], v[72:75], v[40:43], v[232:235]
v_mfma_f32_16x16x32_bf16 v[228:231], v[72:75], v[36:39], v[228:231]
v_mfma_f32_16x16x32_bf16 v[224:227], v[72:75], v[32:35], v[224:227]
v_mfma_f32_16x16x32_bf16 v[176:179], v[60:63], v[32:35], v[176:179]
v_mfma_f32_16x16x32_bf16 v[180:183], v[60:63], v[36:39], v[180:183]
v_mfma_f32_16x16x32_bf16 v[184:187], v[60:63], v[40:43], v[184:187]
v_mfma_f32_16x16x32_bf16 v[188:191], v[60:63], v[44:47], v[188:191]
v_mfma_f32_16x16x32_bf16 v[252:255], v[76:79], v[44:47], v[252:255]
v_mfma_f32_16x16x32_bf16 v[248:251], v[76:79], v[40:43], v[248:251]
v_mfma_f32_16x16x32_bf16 v[244:247], v[76:79], v[36:39], v[244:247]
v_mfma_f32_16x16x32_bf16 v[240:243], v[76:79], v[32:35], v[240:243]
s_waitcnt lgkmcnt(0)
s_barrier
v_mfma_f32_16x16x32_bf16 v[128:131], v[96:99], v[80:83], v[128:131]
ds_read_b128 v[32:35], v4 offset:0
v_mfma_f32_16x16x32_bf16 v[132:135], v[96:99], v[84:87], v[132:135]
ds_read_b64_tr_b16 v[48:49], v13 offset:16384
v_mfma_f32_16x16x32_bf16 v[136:139], v[96:99], v[88:91], v[136:139]
ds_read_b64_tr_b16 v[50:51], v13 offset:20480
v_mfma_f32_16x16x32_bf16 v[140:143], v[96:99], v[92:95], v[140:143]
ds_read_b128 v[36:39], v4 offset:256
v_mfma_f32_16x16x32_bf16 v[204:207], v[112:115], v[92:95], v[204:207]
ds_read_b128 v[40:43], v4 offset:512
v_mfma_f32_16x16x32_bf16 v[200:203], v[112:115], v[88:91], v[200:203]
ds_read_b128 v[44:47], v4 offset:768
v_mfma_f32_16x16x32_bf16 v[196:199], v[112:115], v[84:87], v[196:199]
ds_read_b64_tr_b16 v[64:65], v13 offset:32768
v_mfma_f32_16x16x32_bf16 v[192:195], v[112:115], v[80:83], v[192:195]
ds_read_b64_tr_b16 v[66:67], v13 offset:36864
v_mfma_f32_16x16x32_bf16 v[144:147], v[100:103], v[80:83], v[144:147]
ds_read_b64_tr_b16 v[52:53], v14 offset:16384
v_mfma_f32_16x16x32_bf16 v[148:151], v[100:103], v[84:87], v[148:151]
ds_read_b64_tr_b16 v[54:55], v14 offset:20480
v_mfma_f32_16x16x32_bf16 v[152:155], v[100:103], v[88:91], v[152:155]
ds_read_b64_tr_b16 v[68:69], v14 offset:32768
v_mfma_f32_16x16x32_bf16 v[156:159], v[100:103], v[92:95], v[156:159]
ds_read_b64_tr_b16 v[70:71], v14 offset:36864
v_mfma_f32_16x16x32_bf16 v[220:223], v[116:119], v[92:95], v[220:223]
ds_read_b64_tr_b16 v[56:57], v15 offset:16384
v_mfma_f32_16x16x32_bf16 v[216:219], v[116:119], v[88:91], v[216:219]
ds_read_b64_tr_b16 v[58:59], v15 offset:20480
v_mfma_f32_16x16x32_bf16 v[212:215], v[116:119], v[84:87], v[212:215]
ds_read_b64_tr_b16 v[72:73], v15 offset:32768
v_mfma_f32_16x16x32_bf16 v[208:211], v[116:119], v[80:83], v[208:211]
ds_read_b64_tr_b16 v[74:75], v15 offset:36864
v_mfma_f32_16x16x32_bf16 v[160:163], v[104:107], v[80:83], v[160:163]
ds_read_b64_tr_b16 v[60:61], v16 offset:16384
v_mfma_f32_16x16x32_bf16 v[164:167], v[104:107], v[84:87], v[164:167]
ds_read_b64_tr_b16 v[62:63], v16 offset:20480
v_mfma_f32_16x16x32_bf16 v[168:171], v[104:107], v[88:91], v[168:171]
ds_read_b64_tr_b16 v[76:77], v16 offset:32768
v_mfma_f32_16x16x32_bf16 v[172:175], v[104:107], v[92:95], v[172:175]
ds_read_b64_tr_b16 v[78:79], v16 offset:36864
v_mfma_f32_16x16x32_bf16 v[236:239], v[120:123], v[92:95], v[236:239]
v_mfma_f32_16x16x32_bf16 v[232:235], v[120:123], v[88:91], v[232:235]
v_mfma_f32_16x16x32_bf16 v[228:231], v[120:123], v[84:87], v[228:231]
v_mfma_f32_16x16x32_bf16 v[224:227], v[120:123], v[80:83], v[224:227]
v_mfma_f32_16x16x32_bf16 v[176:179], v[108:111], v[80:83], v[176:179]
v_mfma_f32_16x16x32_bf16 v[180:183], v[108:111], v[84:87], v[180:183]
v_mfma_f32_16x16x32_bf16 v[184:187], v[108:111], v[88:91], v[184:187]
v_mfma_f32_16x16x32_bf16 v[188:191], v[108:111], v[92:95], v[188:191]
v_mfma_f32_16x16x32_bf16 v[252:255], v[124:127], v[92:95], v[252:255]
v_mfma_f32_16x16x32_bf16 v[248:251], v[124:127], v[88:91], v[248:251]
v_mfma_f32_16x16x32_bf16 v[244:247], v[124:127], v[84:87], v[244:247]
v_mfma_f32_16x16x32_bf16 v[240:243], v[124:127], v[80:83], v[240:243]
s_waitcnt lgkmcnt(0)
v_mfma_f32_16x16x32_bf16 v[128:131], v[48:51], v[32:35], v[128:131]
ds_read_b128 v[80:83], v4 offset:8192
v_mfma_f32_16x16x32_bf16 v[132:135], v[48:51], v[36:39], v[132:135]
ds_read_b64_tr_b16 v[96:97], v13 offset:24576
v_mfma_f32_16x16x32_bf16 v[136:139], v[48:51], v[40:43], v[136:139]
ds_read_b64_tr_b16 v[98:99], v13 offset:28672
v_mfma_f32_16x16x32_bf16 v[140:143], v[48:51], v[44:47], v[140:143]
ds_read_b128 v[84:87], v4 offset:8448
v_mfma_f32_16x16x32_bf16 v[204:207], v[64:67], v[44:47], v[204:207]
ds_read_b128 v[88:91], v4 offset:8704
v_mfma_f32_16x16x32_bf16 v[200:203], v[64:67], v[40:43], v[200:203]
ds_read_b128 v[92:95], v4 offset:8960
v_mfma_f32_16x16x32_bf16 v[196:199], v[64:67], v[36:39], v[196:199]
ds_read_b64_tr_b16 v[112:113], v13 offset:40960
v_mfma_f32_16x16x32_bf16 v[192:195], v[64:67], v[32:35], v[192:195]
ds_read_b64_tr_b16 v[114:115], v13 offset:45056
v_mfma_f32_16x16x32_bf16 v[144:147], v[52:55], v[32:35], v[144:147]
ds_read_b64_tr_b16 v[100:101], v14 offset:24576
v_mfma_f32_16x16x32_bf16 v[148:151], v[52:55], v[36:39], v[148:151]
ds_read_b64_tr_b16 v[102:103], v14 offset:28672
v_mfma_f32_16x16x32_bf16 v[152:155], v[52:55], v[40:43], v[152:155]
ds_read_b64_tr_b16 v[116:117], v14 offset:40960
v_mfma_f32_16x16x32_bf16 v[156:159], v[52:55], v[44:47], v[156:159]
ds_read_b64_tr_b16 v[118:119], v14 offset:45056
v_mfma_f32_16x16x32_bf16 v[220:223], v[68:71], v[44:47], v[220:223]
ds_read_b64_tr_b16 v[104:105], v15 offset:24576
v_mfma_f32_16x16x32_bf16 v[216:219], v[68:71], v[40:43], v[216:219]
ds_read_b64_tr_b16 v[106:107], v15 offset:28672
v_mfma_f32_16x16x32_bf16 v[212:215], v[68:71], v[36:39], v[212:215]
ds_read_b64_tr_b16 v[120:121], v15 offset:40960
v_mfma_f32_16x16x32_bf16 v[208:211], v[68:71], v[32:35], v[208:211]
ds_read_b64_tr_b16 v[122:123], v15 offset:45056
v_mfma_f32_16x16x32_bf16 v[160:163], v[56:59], v[32:35], v[160:163]
ds_read_b64_tr_b16 v[108:109], v16 offset:24576
v_mfma_f32_16x16x32_bf16 v[164:167], v[56:59], v[36:39], v[164:167]
ds_read_b64_tr_b16 v[110:111], v16 offset:28672
v_mfma_f32_16x16x32_bf16 v[168:171], v[56:59], v[40:43], v[168:171]
ds_read_b64_tr_b16 v[124:125], v16 offset:40960
v_mfma_f32_16x16x32_bf16 v[172:175], v[56:59], v[44:47], v[172:175]
ds_read_b64_tr_b16 v[126:127], v16 offset:45056
v_mfma_f32_16x16x32_bf16 v[236:239], v[72:75], v[44:47], v[236:239]
v_mfma_f32_16x16x32_bf16 v[232:235], v[72:75], v[40:43], v[232:235]
v_mfma_f32_16x16x32_bf16 v[228:231], v[72:75], v[36:39], v[228:231]
v_mfma_f32_16x16x32_bf16 v[224:227], v[72:75], v[32:35], v[224:227]
v_mfma_f32_16x16x32_bf16 v[176:179], v[60:63], v[32:35], v[176:179]
v_mfma_f32_16x16x32_bf16 v[180:183], v[60:63], v[36:39], v[180:183]
v_mfma_f32_16x16x32_bf16 v[184:187], v[60:63], v[40:43], v[184:187]
v_mfma_f32_16x16x32_bf16 v[188:191], v[60:63], v[44:47], v[188:191]
v_mfma_f32_16x16x32_bf16 v[252:255], v[76:79], v[44:47], v[252:255]
v_mfma_f32_16x16x32_bf16 v[248:251], v[76:79], v[40:43], v[248:251]
v_mfma_f32_16x16x32_bf16 v[244:247], v[76:79], v[36:39], v[244:247]
v_mfma_f32_16x16x32_bf16 v[240:243], v[76:79], v[32:35], v[240:243]
s_waitcnt lgkmcnt(0)
s_barrier
s_cmp_eq_u32 s36, 3
s_cbranch_scc1 L3h_124
s_add_u32 s42, s42, 1
s_xor_b32 s37, s42, s35
s_add_u32 m0, s39, 98304
s_mul_i32 s37, s37, s40
buffer_load_dwordx4 v22, s[8:11], s37 offen sc1 lds
v_mfma_f32_16x16x32_bf16 v[128:131], v[96:99], v[80:83], v[128:131]
s_lshl_b32 s43, s46, 9
v_mfma_f32_16x16x32_bf16 v[132:135], v[96:99], v[84:87], v[132:135]
s_add_u32 s43, s43, 147456
s_add_u32 m0, s39, 99328
s_add_u32 s37, s37, s38
buffer_load_dwordx4 v23, s[8:11], s37 offen sc1 lds
v_mfma_f32_16x16x32_bf16 v[136:139], v[96:99], v[88:91], v[136:139]
v_lshl_add_u32 v19, v17, 3, s43
v_mfma_f32_16x16x32_bf16 v[140:143], v[96:99], v[92:95], v[140:143]
s_add_u32 m0, s39, 100352
s_add_u32 s37, s37, s38
buffer_load_dwordx4 v22, s[8:11], s37 offen sc1 lds
ds_read_b64 v[2:3], v19 offset:0
v_mfma_f32_16x16x32_bf16 v[204:207], v[112:115], v[92:95], v[204:207]
ds_read_b64 v[4:5], v19 offset:128
s_add_u32 m0, s39, 101376
s_add_u32 s37, s37, s38
buffer_load_dwordx4 v23, s[8:11], s37 offen sc1 lds
v_mfma_f32_16x16x32_bf16 v[200:203], v[112:115], v[88:91], v[200:203]
ds_read_b64 v[6:7], v19 offset:256
v_mfma_f32_16x16x32_bf16 v[196:199], v[112:115], v[84:87], v[196:199]
s_add_u32 m0, s39, 102400
s_add_u32 s37, s37, s38
buffer_load_dwordx4 v22, s[8:11], s37 offen sc1 lds
ds_read_b64 v[8:9], v19 offset:384
v_mfma_f32_16x16x32_bf16 v[192:195], v[112:115], v[80:83], v[192:195]
s_mul_i32 s43, s47, 256
s_add_u32 m0, s39, 103424
s_add_u32 s37, s37, s38
buffer_load_dwordx4 v23, s[8:11], s37 offen sc1 lds
v_mfma_f32_16x16x32_bf16 v[144:147], v[100:103], v[80:83], v[144:147]
s_add_u32 s43, s43, 148480
v_mfma_f32_16x16x32_bf16 v[148:151], v[100:103], v[84:87], v[148:151]
s_add_u32 m0, s39, 104448
s_add_u32 s37, s37, s38
buffer_load_dwordx4 v22, s[8:11], s37 offen sc1 lds
v_lshl_add_u32 v19, v18, 4, s43
v_mfma_f32_16x16x32_bf16 v[152:155], v[100:103], v[88:91], v[152:155]
ds_read_b128 v[48:51], v19 offset:0
s_add_u32 m0, s39, 105472
s_add_u32 s37, s37, s38
buffer_load_dwordx4 v23, s[8:11], s37 offen sc1 lds
v_mfma_f32_16x16x32_bf16 v[156:159], v[100:103], v[92:95], v[156:159]
ds_read_b128 v[52:55], v19 offset:64
v_mfma_f32_16x16x32_bf16 v[220:223], v[116:119], v[92:95], v[220:223]
s_add_u32 m0, s39, 106496
s_add_u32 s37, s37, s38
buffer_load_dwordx4 v22, s[8:11], s37 offen sc1 lds
ds_read_b128 v[56:59], v19 offset:128
v_mfma_f32_16x16x32_bf16 v[216:219], v[116:119], v[88:91], v[216:219]
ds_read_b128 v[60:63], v19 offset:192
v_mfma_f32_16x16x32_bf16 v[212:215], v[116:119], v[84:87], v[212:215]
s_add_u32 m0, s39, 107520
s_add_u32 s37, s37, s38
buffer_load_dwordx4 v23, s[8:11], s37 offen sc1 lds
ds_read_b128 v[64:67], v19 offset:896
v_mfma_f32_16x16x32_bf16 v[208:211], v[116:119], v[80:83], v[208:211]
ds_read_b128 v[68:71], v19 offset:960
s_add_u32 m0, s39, 108544
s_add_u32 s37, s37, s38
buffer_load_dwordx4 v22, s[8:11], s37 offen sc1 lds
v_mfma_f32_16x16x32_bf16 v[160:163], v[104:107], v[80:83], v[160:163]
ds_read_b128 v[72:75], v19 offset:1024
v_mfma_f32_16x16x32_bf16 v[164:167], v[104:107], v[84:87], v[164:167]
s_add_u32 m0, s39, 109568
s_add_u32 s37, s37, s38
buffer_load_dwordx4 v23, s[8:11], s37 offen sc1 lds
ds_read_b128 v[76:79], v19 offset:1088
v_mfma_f32_16x16x32_bf16 v[168:171], v[104:107], v[88:91], v[168:171]
v_mfma_f32_16x16x32_bf16 v[172:175], v[104:107], v[92:95], v[172:175]
s_add_u32 m0, s39, 110592
s_add_u32 s37, s37, s38
buffer_load_dwordx4 v22, s[8:11], s37 offen sc1 lds
v_mfma_f32_16x16x32_bf16 v[236:239], v[120:123], v[92:95], v[236:239]
v_mfma_f32_16x16x32_bf16 v[232:235], v[120:123], v[88:91], v[232:235]
v_mfma_f32_16x16x32_bf16 v[228:231], v[120:123], v[84:87], v[228:231]
s_add_u32 m0, s39, 111616
s_add_u32 s37, s37, s38
buffer_load_dwordx4 v23, s[8:11], s37 offen sc1 lds
v_mfma_f32_16x16x32_bf16 v[224:227], v[120:123], v[80:83], v[224:227]
v_mfma_f32_16x16x32_bf16 v[176:179], v[108:111], v[80:83], v[176:179]
v_mfma_f32_16x16x32_bf16 v[180:183], v[108:111], v[84:87], v[180:183]
s_add_u32 m0, s39, 112640
s_add_u32 s37, s37, s38
buffer_load_dwordx4 v22, s[8:11], s37 offen sc1 lds
v_mfma_f32_16x16x32_bf16 v[184:187], v[108:111], v[88:91], v[184:187]
v_mfma_f32_16x16x32_bf16 v[188:191], v[108:111], v[92:95], v[188:191]
v_mfma_f32_16x16x32_bf16 v[252:255], v[124:127], v[92:95], v[252:255]
s_add_u32 m0, s39, 113664
s_add_u32 s37, s37, s38
buffer_load_dwordx4 v23, s[8:11], s37 offen sc1 lds
v_mfma_f32_16x16x32_bf16 v[248:251], v[124:127], v[88:91], v[248:251]
v_mfma_f32_16x16x32_bf16 v[244:247], v[124:127], v[84:87], v[244:247]
v_mfma_f32_16x16x32_bf16 v[240:243], v[124:127], v[80:83], v[240:243]
s_setprio 0
s_waitcnt lgkmcnt(0)
v_mov_b32 v32, v2
v_mul_f32 v88, v3, v3
v_mul_f32 v36, 0xc0135761, v3
v_mul_f32 v89, 0xbdd2d3e8, v3
v_rcp_f32 v44, v88
v_mul_f32 v40, v89, v88
v_mov_b32 v33, v4
v_mul_f32 v88, v5, v5
v_mul_f32 v37, 0xc0135761, v5
v_mul_f32 v89, 0xbdd2d3e8, v5
v_rcp_f32 v45, v88
v_mul_f32 v41, v89, v88
v_mov_b32 v34, v6
v_mul_f32 v88, v7, v7
v_mul_f32 v38, 0xc0135761, v7
v_mul_f32 v89, 0xbdd2d3e8, v7
v_rcp_f32 v46, v88
v_mul_f32 v42, v89, v88
v_mov_b32 v35, v8
v_mul_f32 v88, v9, v9
v_mul_f32 v39, 0xc0135761, v9
v_mul_f32 v89, 0xbdd2d3e8, v9
v_rcp_f32 v47, v88
v_mul_f32 v43, v89, v88
s_barrier
s_add_u32 s42, s42, 1
s_xor_b32 s37, s42, s35
s_add_u32 m0, s39, 0
s_mul_i32 s37, s37, s40
buffer_load_dwordx4 v22, s[8:11], s37 offen sc1 lds
v_fma_f32 v128, -v32, v48, v128
v_fma_f32 v129, -v32, v49, v129
v_fma_f32 v130, -v32, v50, v130
v_fma_f32 v131, -v32, v51, v131
s_add_u32 m0, s39, 1024
s_add_u32 s37, s37, s38
buffer_load_dwordx4 v23, s[8:11], s37 offen sc1 lds
v_fma_f32 v192, -v32, v64, v192
v_fma_f32 v193, -v32, v65, v193
v_fma_f32 v194, -v32, v66, v194
s_add_u32 m0, s39, 2048
s_add_u32 s37, s37, s38
buffer_load_dwordx4 v22, s[8:11], s37 offen sc1 lds
v_fma_f32 v195, -v32, v67, v195
v_mul_f32 v80, v128, v128
v_mul_f32 v81, v129, v129
s_add_u32 m0, s39, 3072
s_add_u32 s37, s37, s38
buffer_load_dwordx4 v23, s[8:11], s37 offen sc1 lds
v_mul_f32 v82, v130, v130
v_mul_f32 v83, v131, v131
v_fma_f32 v80, v80, v40, v36
s_add_u32 m0, s39, 4096
s_add_u32 s37, s37, s38
buffer_load_dwordx4 v22, s[8:11], s37 offen sc1 lds
v_fma_f32 v81, v81, v40, v36
v_fma_f32 v82, v82, v40, v36
v_fma_f32 v83, v83, v40, v36
v_mul_f32 v80, v80, v128
s_add_u32 m0, s39, 5120
s_add_u32 s37, s37, s38
buffer_load_dwordx4 v23, s[8:11], s37 offen sc1 lds
v_mul_f32 v81, v81, v129
v_mul_f32 v82, v82, v130
v_mul_f32 v83, v83, v131
s_add_u32 m0, s39, 6144
s_add_u32 s37, s37, s38
buffer_load_dwordx4 v22, s[8:11], s37 offen sc1 lds
v_exp_f32 v80, v80
v_exp_f32 v81, v81
v_exp_f32 v82, v82
s_add_u32 m0, s39, 7168
s_add_u32 s37, s37, s38
buffer_load_dwordx4 v23, s[8:11], s37 offen sc1 lds
v_exp_f32 v83, v83
v_mul_f32 v192, v128, v192
v_mul_f32 v193, v129, v193
s_add_u32 m0, s39, 8192
s_add_u32 s37, s37, s38
buffer_load_dwordx4 v22, s[8:11], s37 offen sc1 lds
v_mul_f32 v194, v130, v194
v_mul_f32 v195, v131, v195
v_fma_f32 v80, v80, v44, v44
v_fma_f32 v81, v81, v44, v44
s_add_u32 m0, s39, 9216
s_add_u32 s37, s37, s38
buffer_load_dwordx4 v23, s[8:11], s37 offen sc1 lds
v_fma_f32 v82, v82, v44, v44
v_fma_f32 v83, v83, v44, v44
v_rcp_f32 v80, v80
s_add_u32 m0, s39, 10240
s_add_u32 s37, s37, s38
buffer_load_dwordx4 v22, s[8:11], s37 offen sc1 lds
v_rcp_f32 v81, v81
v_rcp_f32 v82, v82
v_rcp_f32 v83, v83
s_add_u32 m0, s39, 11264
s_add_u32 s37, s37, s38
buffer_load_dwordx4 v23, s[8:11], s37 offen sc1 lds
v_mul_f32 v192, v192, v80
v_mul_f32 v193, v193, v81
v_mul_f32 v194, v194, v82
s_add_u32 m0, s39, 12288
s_add_u32 s37, s37, s38
buffer_load_dwordx4 v22, s[8:11], s37 offen sc1 lds
v_mul_f32 v195, v195, v83
v_cvt_pk_bf16_f32 v96, v192, v193
v_cvt_pk_bf16_f32 v97, v194, v195
v_fma_f32 v144, -v32, v52, v144
s_add_u32 m0, s39, 13312
s_add_u32 s37, s37, s38
buffer_load_dwordx4 v23, s[8:11], s37 offen sc1 lds
v_fma_f32 v145, -v32, v53, v145
v_fma_f32 v146, -v32, v54, v146
v_fma_f32 v147, -v32, v55, v147
s_add_u32 m0, s39, 14336
s_add_u32 s37, s37, s38
buffer_load_dwordx4 v22, s[8:11], s37 offen sc1 lds
v_fma_f32 v208, -v32, v68, v208
v_fma_f32 v209, -v32, v69, v209
v_fma_f32 v210, -v32, v70, v210
s_add_u32 m0, s39, 15360
s_add_u32 s37, s37, s38
buffer_load_dwordx4 v23, s[8:11], s37 offen sc1 lds
v_fma_f32 v211, -v32, v71, v211
v_mul_f32 v84, v144, v144
v_mul_f32 v85, v145, v145
s_waitcnt vmcnt(16)
s_barrier
s_add_u32 s42, s42, 1
s_xor_b32 s37, s42, s35
s_add_u32 m0, s39, 49152
s_mul_i32 s37, s37, s40
buffer_load_dwordx4 v22, s[8:11], s37 offen sc1 lds
v_mul_f32 v86, v146, v146
v_mul_f32 v87, v147, v147
v_fma_f32 v84, v84, v40, v36
v_fma_f32 v85, v85, v40, v36
v_fma_f32 v86, v86, v40, v36
s_add_u32 m0, s39, 50176
s_add_u32 s37, s37, s38
buffer_load_dwordx4 v23, s[8:11], s37 offen sc1 lds
v_fma_f32 v87, v87, v40, v36
v_mul_f32 v84, v84, v144
v_mul_f32 v85, v85, v145
v_mul_f32 v86, v86, v146
v_mul_f32 v87, v87, v147
s_add_u32 m0, s39, 51200
s_add_u32 s37, s37, s38
buffer_load_dwordx4 v22, s[8:11], s37 offen sc1 lds
v_exp_f32 v84, v84
v_exp_f32 v85, v85
v_exp_f32 v86, v86
v_exp_f32 v87, v87
s_add_u32 m0, s39, 52224
s_add_u32 s37, s37, s38
buffer_load_dwordx4 v23, s[8:11], s37 offen sc1 lds
v_mul_f32 v208, v144, v208
v_mul_f32 v209, v145, v209
v_mul_f32 v210, v146, v210
v_mul_f32 v211, v147, v211
v_fma_f32 v84, v84, v44, v44
s_add_u32 m0, s39, 53248
s_add_u32 s37, s37, s38
buffer_load_dwordx4 v22, s[8:11], s37 offen sc1 lds
v_fma_f32 v85, v85, v44, v44
v_fma_f32 v86, v86, v44, v44
v_fma_f32 v87, v87, v44, v44
v_rcp_f32 v84, v84
v_rcp_f32 v85, v85
s_add_u32 m0, s39, 54272
s_add_u32 s37, s37, s38
buffer_load_dwordx4 v23, s[8:11], s37 offen sc1 lds
v_rcp_f32 v86, v86
v_rcp_f32 v87, v87
v_mul_f32 v208, v208, v84
v_mul_f32 v209, v209, v85
s_add_u32 m0, s39, 55296
s_add_u32 s37, s37, s38
buffer_load_dwordx4 v22, s[8:11], s37 offen sc1 lds
v_mul_f32 v210, v210, v86
v_mul_f32 v211, v211, v87
v_cvt_pk_bf16_f32 v98, v208, v209
v_cvt_pk_bf16_f32 v99, v210, v211
s_add_u32 m0, s39, 56320
s_add_u32 s37, s37, s38
buffer_load_dwordx4 v23, s[8:11], s37 offen sc1 lds
v_fma_f32 v132, -v33, v48, v132
v_fma_f32 v133, -v33, v49, v133
v_fma_f32 v134, -v33, v50, v134
v_fma_f32 v135, -v33, v51, v135
s_add_u32 m0, s39, 57344
s_add_u32 s37, s37, s38
buffer_load_dwordx4 v22, s[8:11], s37 offen sc1 lds
v_fma_f32 v196, -v33, v64, v196
v_fma_f32 v197, -v33, v65, v197
v_fma_f32 v198, -v33, v66, v198
v_fma_f32 v199, -v33, v67, v199
v_mul_f32 v80, v132, v132
s_add_u32 m0, s39, 58368
s_add_u32 s37, s37, s38
buffer_load_dwordx4 v23, s[8:11], s37 offen sc1 lds
v_mul_f32 v81, v133, v133
v_mul_f32 v82, v134, v134
v_mul_f32 v83, v135, v135
v_fma_f32 v80, v80, v41, v37
v_fma_f32 v81, v81, v41, v37
s_add_u32 m0, s39, 59392
s_add_u32 s37, s37, s38
buffer_load_dwordx4 v22, s[8:11], s37 offen sc1 lds
v_fma_f32 v82, v82, v41, v37
v_fma_f32 v83, v83, v41, v37
v_mul_f32 v80, v80, v132
v_mul_f32 v81, v81, v133
s_add_u32 m0, s39, 60416
s_add_u32 s37, s37, s38
buffer_load_dwordx4 v23, s[8:11], s37 offen sc1 lds
v_mul_f32 v82, v82, v134
v_lshlrev_b32 v19, 11, v18
v_lshl_add_u32 v19, v17, 4, v19
s_lshl_b32 s43, s46, 10
v_add_u32 v2, s43, v19
s_add_u32 m0, s39, 61440
s_add_u32 s37, s37, s38
buffer_load_dwordx4 v22, s[8:11], s37 offen sc1 lds
v_add_u32 v3, 0x10000, v2
v_lshrrev_b32 v19, 2, v17
v_lshl_add_u32 v20, v18, 2, v19
v_bfe_u32 v21, v20, 1, 2
s_lshl_b32 s43, s47, 1
s_add_u32 m0, s39, 62464
s_add_u32 s37, s37, s38
buffer_load_dwordx4 v23, s[8:11], s37 offen sc1 lds
v_xor_b32 v21, s43, v21
v_lshlrev_b32 v20, 7, v20
v_lshl_add_u32 v20, v21, 5, v20
v_and_b32 v19, 3, v1
s_add_u32 m0, s39, 63488
s_add_u32 s37, s37, s38
buffer_load_dwordx4 v22, s[8:11], s37 offen sc1 lds
v_lshl_add_u32 v20, v19, 3, v20
v_add_u32 v5, 16384, v20
v_xor_b32 v6, 32, v5
v_add_u32 v7, 0x10000, v5
v_add_u32 v8, 0x10000, v6
s_add_u32 m0, s39, 64512
s_add_u32 s37, s37, s38
buffer_load_dwordx4 v23, s[8:11], s37 offen sc1 lds
s_lshl_b32 s43, s36, 12
v_lshl_add_u32 v9, v1, 4, s43
s_mov_b32 s54, 0x10000
s_movk_i32 s52, 0x1000
buffer_store_dwordx4 v[96:99], v27, s[24:27], 0 offen offset:0 sc1
s_waitcnt vmcnt(17)
s_barrier
s_add_u32 s42, s42, 1
s_xor_b32 s37, s42, s35
s_add_u32 m0, s39, 98304
s_mul_i32 s37, s37, s40
buffer_load_dwordx4 v22, s[8:11], s37 offen sc1 lds
v_mul_f32 v83, v83, v135
v_exp_f32 v80, v80
v_exp_f32 v81, v81
v_exp_f32 v82, v82
s_add_u32 m0, s39, 99328
s_add_u32 s37, s37, s38
buffer_load_dwordx4 v23, s[8:11], s37 offen sc1 lds
v_exp_f32 v83, v83
v_mul_f32 v196, v132, v196
v_mul_f32 v197, v133, v197
s_add_u32 m0, s39, 100352
s_add_u32 s37, s37, s38
buffer_load_dwordx4 v22, s[8:11], s37 offen sc1 lds
v_mul_f32 v198, v134, v198
v_mul_f32 v199, v135, v199
v_fma_f32 v80, v80, v45, v45
s_add_u32 m0, s39, 101376
s_add_u32 s37, s37, s38
buffer_load_dwordx4 v23, s[8:11], s37 offen sc1 lds
v_fma_f32 v81, v81, v45, v45
v_fma_f32 v82, v82, v45, v45
v_fma_f32 v83, v83, v45, v45
s_add_u32 m0, s39, 102400
s_add_u32 s37, s37, s38
buffer_load_dwordx4 v22, s[8:11], s37 offen sc1 lds
v_rcp_f32 v80, v80
v_rcp_f32 v81, v81
v_rcp_f32 v82, v82
v_rcp_f32 v83, v83
s_add_u32 m0, s39, 103424
s_add_u32 s37, s37, s38
buffer_load_dwordx4 v23, s[8:11], s37 offen sc1 lds
v_mul_f32 v196, v196, v80
v_mul_f32 v197, v197, v81
v_mul_f32 v198, v198, v82
s_add_u32 m0, s39, 104448
s_add_u32 s37, s37, s38
buffer_load_dwordx4 v22, s[8:11], s37 offen sc1 lds
v_mul_f32 v199, v199, v83
v_cvt_pk_bf16_f32 v100, v196, v197
v_cvt_pk_bf16_f32 v101, v198, v199
s_add_u32 m0, s39, 105472
s_add_u32 s37, s37, s38
buffer_load_dwordx4 v23, s[8:11], s37 offen sc1 lds
v_fma_f32 v148, -v33, v52, v148
v_fma_f32 v149, -v33, v53, v149
v_fma_f32 v150, -v33, v54, v150
s_add_u32 m0, s39, 106496
s_add_u32 s37, s37, s38
buffer_load_dwordx4 v22, s[8:11], s37 offen sc1 lds
v_fma_f32 v151, -v33, v55, v151
v_fma_f32 v212, -v33, v68, v212
v_fma_f32 v213, -v33, v69, v213
v_fma_f32 v214, -v33, v70, v214
s_add_u32 m0, s39, 107520
s_add_u32 s37, s37, s38
buffer_load_dwordx4 v23, s[8:11], s37 offen sc1 lds
v_fma_f32 v215, -v33, v71, v215
v_mul_f32 v84, v148, v148
v_mul_f32 v85, v149, v149
s_add_u32 m0, s39, 108544
s_add_u32 s37, s37, s38
buffer_load_dwordx4 v22, s[8:11], s37 offen sc1 lds
v_mul_f32 v86, v150, v150
v_mul_f32 v87, v151, v151
v_fma_f32 v84, v84, v41, v37
s_add_u32 m0, s39, 109568
s_add_u32 s37, s37, s38
buffer_load_dwordx4 v23, s[8:11], s37 offen sc1 lds
v_fma_f32 v85, v85, v41, v37
v_fma_f32 v86, v86, v41, v37
v_fma_f32 v87, v87, v41, v37
s_add_u32 m0, s39, 110592
s_add_u32 s37, s37, s38
buffer_load_dwordx4 v22, s[8:11], s37 offen sc1 lds
v_mul_f32 v84, v84, v148
v_mul_f32 v85, v85, v149
v_mul_f32 v86, v86, v150
v_mul_f32 v87, v87, v151
s_add_u32 m0, s39, 111616
s_add_u32 s37, s37, s38
buffer_load_dwordx4 v23, s[8:11], s37 offen sc1 lds
v_exp_f32 v84, v84
v_exp_f32 v85, v85
v_exp_f32 v86, v86
s_add_u32 m0, s39, 112640
s_add_u32 s37, s37, s38
buffer_load_dwordx4 v22, s[8:11], s37 offen sc1 lds
v_exp_f32 v87, v87
v_mul_f32 v212, v148, v212
v_mul_f32 v213, v149, v213
s_add_u32 m0, s39, 113664
s_add_u32 s37, s37, s38
buffer_load_dwordx4 v23, s[8:11], s37 offen sc1 lds
v_mul_f32 v214, v150, v214
v_mul_f32 v215, v151, v215
v_fma_f32 v84, v84, v45, v45
s_waitcnt vmcnt(17)
s_barrier
s_add_u32 s42, s42, 1
s_xor_b32 s37, s42, s35
s_add_u32 m0, s39, 0
s_mul_i32 s37, s37, s40
buffer_load_dwordx4 v22, s[8:11], s37 offen sc1 lds
v_fma_f32 v85, v85, v45, v45
v_fma_f32 v86, v86, v45, v45
v_fma_f32 v87, v87, v45, v45
v_rcp_f32 v84, v84
s_add_u32 m0, s39, 1024
s_add_u32 s37, s37, s38
buffer_load_dwordx4 v23, s[8:11], s37 offen sc1 lds
v_rcp_f32 v85, v85
v_rcp_f32 v86, v86
v_rcp_f32 v87, v87
s_add_u32 m0, s39, 2048
s_add_u32 s37, s37, s38
buffer_load_dwordx4 v22, s[8:11], s37 offen sc1 lds
v_mul_f32 v212, v212, v84
v_mul_f32 v213, v213, v85
v_mul_f32 v214, v214, v86
s_add_u32 m0, s39, 3072
s_add_u32 s37, s37, s38
buffer_load_dwordx4 v23, s[8:11], s37 offen sc1 lds
v_mul_f32 v215, v215, v87
v_cvt_pk_bf16_f32 v102, v212, v213
v_cvt_pk_bf16_f32 v103, v214, v215
s_add_u32 m0, s39, 4096
s_add_u32 s37, s37, s38
buffer_load_dwordx4 v22, s[8:11], s37 offen sc1 lds
v_fma_f32 v136, -v34, v48, v136
v_fma_f32 v137, -v34, v49, v137
v_fma_f32 v138, -v34, v50, v138
s_add_u32 m0, s39, 5120
s_add_u32 s37, s37, s38
buffer_load_dwordx4 v23, s[8:11], s37 offen sc1 lds
v_fma_f32 v139, -v34, v51, v139
v_fma_f32 v200, -v34, v64, v200
v_fma_f32 v201, -v34, v65, v201
s_add_u32 m0, s39, 6144
s_add_u32 s37, s37, s38
buffer_load_dwordx4 v22, s[8:11], s37 offen sc1 lds
v_fma_f32 v202, -v34, v66, v202
v_fma_f32 v203, -v34, v67, v203
v_mul_f32 v80, v136, v136
v_mul_f32 v81, v137, v137
s_add_u32 m0, s39, 7168
s_add_u32 s37, s37, s38
buffer_load_dwordx4 v23, s[8:11], s37 offen sc1 lds
v_mul_f32 v82, v138, v138
v_mul_f32 v83, v139, v139
v_fma_f32 v80, v80, v42, v38
s_add_u32 m0, s39, 8192
s_add_u32 s37, s37, s38
buffer_load_dwordx4 v22, s[8:11], s37 offen sc1 lds
v_fma_f32 v81, v81, v42, v38
v_fma_f32 v82, v82, v42, v38
v_fma_f32 v83, v83, v42, v38
s_add_u32 m0, s39, 9216
s_add_u32 s37, s37, s38
buffer_load_dwordx4 v23, s[8:11], s37 offen sc1 lds
v_mul_f32 v80, v80, v136
v_mul_f32 v81, v81, v137
v_mul_f32 v82, v82, v138
v_mul_f32 v83, v83, v139
s_add_u32 m0, s39, 10240
s_add_u32 s37, s37, s38
buffer_load_dwordx4 v22, s[8:11], s37 offen sc1 lds
v_exp_f32 v80, v80
v_exp_f32 v81, v81
v_exp_f32 v82, v82
s_add_u32 m0, s39, 11264
s_add_u32 s37, s37, s38
buffer_load_dwordx4 v23, s[8:11], s37 offen sc1 lds
v_exp_f32 v83, v83
v_mul_f32 v200, v136, v200
v_mul_f32 v201, v137, v201
s_add_u32 m0, s39, 12288
s_add_u32 s37, s37, s38
buffer_load_dwordx4 v22, s[8:11], s37 offen sc1 lds
v_mul_f32 v202, v138, v202
v_mul_f32 v203, v139, v203
v_fma_f32 v80, v80, v46, v46
v_fma_f32 v81, v81, v46, v46
s_add_u32 m0, s39, 13312
s_add_u32 s37, s37, s38
buffer_load_dwordx4 v23, s[8:11], s37 offen sc1 lds
v_fma_f32 v82, v82, v46, v46
v_fma_f32 v83, v83, v46, v46
v_rcp_f32 v80, v80
s_add_u32 m0, s39, 14336
s_add_u32 s37, s37, s38
buffer_load_dwordx4 v22, s[8:11], s37 offen sc1 lds
v_rcp_f32 v81, v81
v_rcp_f32 v82, v82
v_rcp_f32 v83, v83
s_add_u32 m0, s39, 15360
s_add_u32 s37, s37, s38
buffer_load_dwordx4 v23, s[8:11], s37 offen sc1 lds
v_mul_f32 v200, v200, v80
v_mul_f32 v201, v201, v81
v_mul_f32 v202, v202, v82
buffer_store_dwordx4 v[100:103], v27, s[24:27], 0 offen offset:256 sc1
s_waitcnt vmcnt(17)
s_barrier
s_add_u32 s42, s42, 1
s_xor_b32 s37, s42, s35
s_add_u32 m0, s39, 49152
s_mul_i32 s37, s37, s40
buffer_load_dwordx4 v22, s[8:11], s37 offen sc1 lds
v_mul_f32 v203, v203, v83
v_cvt_pk_bf16_f32 v104, v200, v201
v_cvt_pk_bf16_f32 v105, v202, v203
v_fma_f32 v152, -v34, v52, v152
s_add_u32 m0, s39, 50176
s_add_u32 s37, s37, s38
buffer_load_dwordx4 v23, s[8:11], s37 offen sc1 lds
v_fma_f32 v153, -v34, v53, v153
v_fma_f32 v154, -v34, v54, v154
v_fma_f32 v155, -v34, v55, v155
s_add_u32 m0, s39, 51200
s_add_u32 s37, s37, s38
buffer_load_dwordx4 v22, s[8:11], s37 offen sc1 lds
v_fma_f32 v216, -v34, v68, v216
v_fma_f32 v217, -v34, v69, v217
v_fma_f32 v218, -v34, v70, v218
s_add_u32 m0, s39, 52224
s_add_u32 s37, s37, s38
buffer_load_dwordx4 v23, s[8:11], s37 offen sc1 lds
v_fma_f32 v219, -v34, v71, v219
v_mul_f32 v84, v152, v152
v_mul_f32 v85, v153, v153
s_add_u32 m0, s39, 53248
s_add_u32 s37, s37, s38
buffer_load_dwordx4 v22, s[8:11], s37 offen sc1 lds
v_mul_f32 v86, v154, v154
v_mul_f32 v87, v155, v155
v_fma_f32 v84, v84, v42, v38
v_fma_f32 v85, v85, v42, v38
s_add_u32 m0, s39, 54272
s_add_u32 s37, s37, s38
buffer_load_dwordx4 v23, s[8:11], s37 offen sc1 lds
v_fma_f32 v86, v86, v42, v38
v_fma_f32 v87, v87, v42, v38
v_mul_f32 v84, v84, v152
s_add_u32 m0, s39, 55296
s_add_u32 s37, s37, s38
buffer_load_dwordx4 v22, s[8:11], s37 offen sc1 lds
v_mul_f32 v85, v85, v153
v_mul_f32 v86, v86, v154
v_mul_f32 v87, v87, v155
s_add_u32 m0, s39, 56320
s_add_u32 s37, s37, s38
buffer_load_dwordx4 v23, s[8:11], s37 offen sc1 lds
v_exp_f32 v84, v84
v_exp_f32 v85, v85
v_exp_f32 v86, v86
s_add_u32 m0, s39, 57344
s_add_u32 s37, s37, s38
buffer_load_dwordx4 v22, s[8:11], s37 offen sc1 lds
v_exp_f32 v87, v87
v_mul_f32 v216, v152, v216
v_mul_f32 v217, v153, v217
v_mul_f32 v218, v154, v218
s_add_u32 m0, s39, 58368
s_add_u32 s37, s37, s38
buffer_load_dwordx4 v23, s[8:11], s37 offen sc1 lds
v_mul_f32 v219, v155, v219
v_fma_f32 v84, v84, v46, v46
v_fma_f32 v85, v85, v46, v46
s_add_u32 m0, s39, 59392
s_add_u32 s37, s37, s38
buffer_load_dwordx4 v22, s[8:11], s37 offen sc1 lds
v_fma_f32 v86, v86, v46, v46
v_fma_f32 v87, v87, v46, v46
v_rcp_f32 v84, v84
s_add_u32 m0, s39, 60416
s_add_u32 s37, s37, s38
buffer_load_dwordx4 v23, s[8:11], s37 offen sc1 lds
v_rcp_f32 v85, v85
v_rcp_f32 v86, v86
v_rcp_f32 v87, v87
s_add_u32 m0, s39, 61440
s_add_u32 s37, s37, s38
buffer_load_dwordx4 v22, s[8:11], s37 offen sc1 lds
v_mul_f32 v216, v216, v84
v_mul_f32 v217, v217, v85
v_mul_f32 v218, v218, v86
v_mul_f32 v219, v219, v87
s_add_u32 m0, s39, 62464
s_add_u32 s37, s37, s38
buffer_load_dwordx4 v23, s[8:11], s37 offen sc1 lds
v_cvt_pk_bf16_f32 v106, v216, v217
v_cvt_pk_bf16_f32 v107, v218, v219
s_add_u32 m0, s39, 63488
s_add_u32 s37, s37, s38
buffer_load_dwordx4 v22, s[8:11], s37 offen sc1 lds
v_fma_f32 v140, -v35, v48, v140
v_fma_f32 v141, -v35, v49, v141
v_fma_f32 v142, -v35, v50, v142
s_add_u32 m0, s39, 64512
s_add_u32 s37, s37, s38
buffer_load_dwordx4 v23, s[8:11], s37 offen sc1 lds
v_fma_f32 v143, -v35, v51, v143
v_fma_f32 v204, -v35, v64, v204
v_fma_f32 v205, -v35, v65, v205
buffer_store_dwordx4 v[104:107], v27, s[24:27], 0 offen offset:512 sc1
s_waitcnt vmcnt(18)
s_barrier
s_add_u32 s42, s42, 1
s_xor_b32 s37, s42, s35
s_add_u32 m0, s39, 98304
s_mul_i32 s37, s37, s40
buffer_load_dwordx4 v22, s[8:11], s37 offen sc1 lds
v_fma_f32 v206, -v35, v66, v206
v_fma_f32 v207, -v35, v67, v207
v_mul_f32 v80, v140, v140
v_mul_f32 v81, v141, v141
s_add_u32 m0, s39, 99328
s_add_u32 s37, s37, s38
buffer_load_dwordx4 v23, s[8:11], s37 offen sc1 lds
v_mul_f32 v82, v142, v142
v_mul_f32 v83, v143, v143
v_fma_f32 v80, v80, v43, v39
s_add_u32 m0, s39, 100352
s_add_u32 s37, s37, s38
buffer_load_dwordx4 v22, s[8:11], s37 offen sc1 lds
v_fma_f32 v81, v81, v43, v39
v_fma_f32 v82, v82, v43, v39
v_fma_f32 v83, v83, v43, v39
s_add_u32 m0, s39, 101376
s_add_u32 s37, s37, s38
buffer_load_dwordx4 v23, s[8:11], s37 offen sc1 lds
v_mul_f32 v80, v80, v140
v_mul_f32 v81, v81, v141
v_mul_f32 v82, v82, v142
s_add_u32 m0, s39, 102400
s_add_u32 s37, s37, s38
buffer_load_dwordx4 v22, s[8:11], s37 offen sc1 lds
v_mul_f32 v83, v83, v143
v_exp_f32 v80, v80
v_exp_f32 v81, v81
v_exp_f32 v82, v82
s_add_u32 m0, s39, 103424
s_add_u32 s37, s37, s38
buffer_load_dwordx4 v23, s[8:11], s37 offen sc1 lds
v_exp_f32 v83, v83
v_mul_f32 v204, v140, v204
v_mul_f32 v205, v141, v205
s_add_u32 m0, s39, 104448
s_add_u32 s37, s37, s38
buffer_load_dwordx4 v22, s[8:11], s37 offen sc1 lds
v_mul_f32 v206, v142, v206
v_mul_f32 v207, v143, v207
v_fma_f32 v80, v80, v47, v47
s_add_u32 m0, s39, 105472
s_add_u32 s37, s37, s38
buffer_load_dwordx4 v23, s[8:11], s37 offen sc1 lds
v_fma_f32 v81, v81, v47, v47
v_fma_f32 v82, v82, v47, v47
v_fma_f32 v83, v83, v47, v47
s_add_u32 m0, s39, 106496
s_add_u32 s37, s37, s38
buffer_load_dwordx4 v22, s[8:11], s37 offen sc1 lds
v_rcp_f32 v80, v80
v_rcp_f32 v81, v81
v_rcp_f32 v82, v82
v_rcp_f32 v83, v83
s_add_u32 m0, s39, 107520
s_add_u32 s37, s37, s38
buffer_load_dwordx4 v23, s[8:11], s37 offen sc1 lds
v_mul_f32 v204, v204, v80
v_mul_f32 v205, v205, v81
v_mul_f32 v206, v206, v82
s_add_u32 m0, s39, 108544
s_add_u32 s37, s37, s38
buffer_load_dwordx4 v22, s[8:11], s37 offen sc1 lds
v_mul_f32 v207, v207, v83
v_cvt_pk_bf16_f32 v108, v204, v205
v_cvt_pk_bf16_f32 v109, v206, v207
s_add_u32 m0, s39, 109568
s_add_u32 s37, s37, s38
buffer_load_dwordx4 v23, s[8:11], s37 offen sc1 lds
v_fma_f32 v156, -v35, v52, v156
v_fma_f32 v157, -v35, v53, v157
v_fma_f32 v158, -v35, v54, v158
s_add_u32 m0, s39, 110592
s_add_u32 s37, s37, s38
buffer_load_dwordx4 v22, s[8:11], s37 offen sc1 lds
v_fma_f32 v159, -v35, v55, v159
v_fma_f32 v220, -v35, v68, v220
v_fma_f32 v221, -v35, v69, v221
v_fma_f32 v222, -v35, v70, v222
s_add_u32 m0, s39, 111616
s_add_u32 s37, s37, s38
buffer_load_dwordx4 v23, s[8:11], s37 offen sc1 lds
v_fma_f32 v223, -v35, v71, v223
v_mul_f32 v84, v156, v156
v_mul_f32 v85, v157, v157
s_add_u32 m0, s39, 112640
s_add_u32 s37, s37, s38
buffer_load_dwordx4 v22, s[8:11], s37 offen sc1 lds
v_mul_f32 v86, v158, v158
v_mul_f32 v87, v159, v159
v_fma_f32 v84, v84, v43, v39
s_add_u32 m0, s39, 113664
s_add_u32 s37, s37, s38
buffer_load_dwordx4 v23, s[8:11], s37 offen sc1 lds
v_fma_f32 v85, v85, v43, v39
v_fma_f32 v86, v86, v43, v39
v_fma_f32 v87, v87, v43, v39
s_waitcnt vmcnt(17)
s_barrier
s_add_u32 s42, s42, 1
s_xor_b32 s37, s42, s35
s_add_u32 m0, s39, 0
s_mul_i32 s37, s37, s40
buffer_load_dwordx4 v22, s[8:11], s37 offen sc1 lds
v_mul_f32 v84, v84, v156
v_mul_f32 v85, v85, v157
v_mul_f32 v86, v86, v158
v_mul_f32 v87, v87, v159
s_add_u32 m0, s39, 1024
s_add_u32 s37, s37, s38
buffer_load_dwordx4 v23, s[8:11], s37 offen sc1 lds
v_exp_f32 v84, v84
v_exp_f32 v85, v85
v_exp_f32 v86, v86
s_add_u32 m0, s39, 2048
s_add_u32 s37, s37, s38
buffer_load_dwordx4 v22, s[8:11], s37 offen sc1 lds
v_exp_f32 v87, v87
v_mul_f32 v220, v156, v220
v_mul_f32 v221, v157, v221
s_add_u32 m0, s39, 3072
s_add_u32 s37, s37, s38
buffer_load_dwordx4 v23, s[8:11], s37 offen sc1 lds
v_mul_f32 v222, v158, v222
v_mul_f32 v223, v159, v223
v_fma_f32 v84, v84, v47, v47
v_fma_f32 v85, v85, v47, v47
s_add_u32 m0, s39, 4096
s_add_u32 s37, s37, s38
buffer_load_dwordx4 v22, s[8:11], s37 offen sc1 lds
v_fma_f32 v86, v86, v47, v47
v_fma_f32 v87, v87, v47, v47
v_rcp_f32 v84, v84
s_add_u32 m0, s39, 5120
s_add_u32 s37, s37, s38
buffer_load_dwordx4 v23, s[8:11], s37 offen sc1 lds
v_rcp_f32 v85, v85
v_rcp_f32 v86, v86
v_rcp_f32 v87, v87
s_add_u32 m0, s39, 6144
s_add_u32 s37, s37, s38
buffer_load_dwordx4 v22, s[8:11], s37 offen sc1 lds
v_mul_f32 v220, v220, v84
v_mul_f32 v221, v221, v85
v_mul_f32 v222, v222, v86
v_mul_f32 v223, v223, v87
s_add_u32 m0, s39, 7168
s_add_u32 s37, s37, s38
buffer_load_dwordx4 v23, s[8:11], s37 offen sc1 lds
v_cvt_pk_bf16_f32 v110, v220, v221
v_cvt_pk_bf16_f32 v111, v222, v223
s_add_u32 m0, s39, 8192
s_add_u32 s37, s37, s38
buffer_load_dwordx4 v22, s[8:11], s37 offen sc1 lds
v_fma_f32 v160, -v32, v56, v160
v_fma_f32 v161, -v32, v57, v161
v_fma_f32 v162, -v32, v58, v162
s_add_u32 m0, s39, 9216
s_add_u32 s37, s37, s38
buffer_load_dwordx4 v23, s[8:11], s37 offen sc1 lds
v_fma_f32 v163, -v32, v59, v163
v_fma_f32 v224, -v32, v72, v224
v_fma_f32 v225, -v32, v73, v225
v_fma_f32 v226, -v32, v74, v226
s_add_u32 m0, s39, 10240
s_add_u32 s37, s37, s38
buffer_load_dwordx4 v22, s[8:11], s37 offen sc1 lds
v_fma_f32 v227, -v32, v75, v227
v_mul_f32 v80, v160, v160
v_mul_f32 v81, v161, v161
s_add_u32 m0, s39, 11264
s_add_u32 s37, s37, s38
buffer_load_dwordx4 v23, s[8:11], s37 offen sc1 lds
v_mul_f32 v82, v162, v162
v_mul_f32 v83, v163, v163
v_fma_f32 v80, v80, v40, v36
s_add_u32 m0, s39, 12288
s_add_u32 s37, s37, s38
buffer_load_dwordx4 v22, s[8:11], s37 offen sc1 lds
v_fma_f32 v81, v81, v40, v36
v_fma_f32 v82, v82, v40, v36
v_fma_f32 v83, v83, v40, v36
v_mul_f32 v80, v80, v160
s_add_u32 m0, s39, 13312
s_add_u32 s37, s37, s38
buffer_load_dwordx4 v23, s[8:11], s37 offen sc1 lds
v_mul_f32 v81, v81, v161
v_mul_f32 v82, v82, v162
v_mul_f32 v83, v83, v163
s_add_u32 m0, s39, 14336
s_add_u32 s37, s37, s38
buffer_load_dwordx4 v22, s[8:11], s37 offen sc1 lds
v_exp_f32 v80, v80
v_exp_f32 v81, v81
v_exp_f32 v82, v82
s_add_u32 m0, s39, 15360
s_add_u32 s37, s37, s38
buffer_load_dwordx4 v23, s[8:11], s37 offen sc1 lds
v_exp_f32 v83, v83
v_mul_f32 v224, v160, v224
v_mul_f32 v225, v161, v225
buffer_store_dwordx4 v[108:111], v27, s[24:27], 0 offen offset:768 sc1
s_waitcnt vmcnt(17)
s_barrier
s_add_u32 s42, s42, 1
s_xor_b32 s37, s42, s35
s_add_u32 m0, s39, 49152
s_mul_i32 s37, s37, s40
buffer_load_dwordx4 v22, s[8:11], s37 offen sc1 lds
v_mul_f32 v226, v162, v226
v_mul_f32 v227, v163, v227
v_fma_f32 v80, v80, v44, v44
v_fma_f32 v81, v81, v44, v44
s_add_u32 m0, s39, 50176
s_add_u32 s37, s37, s38
buffer_load_dwordx4 v23, s[8:11], s37 offen sc1 lds
v_fma_f32 v82, v82, v44, v44
v_fma_f32 v83, v83, v44, v44
v_rcp_f32 v80, v80
v_rcp_f32 v81, v81
s_add_u32 m0, s39, 51200
s_add_u32 s37, s37, s38
buffer_load_dwordx4 v22, s[8:11], s37 offen sc1 lds
v_rcp_f32 v82, v82
v_rcp_f32 v83, v83
v_mul_f32 v224, v224, v80
v_mul_f32 v225, v225, v81
s_add_u32 m0, s39, 52224
s_add_u32 s37, s37, s38
buffer_load_dwordx4 v23, s[8:11], s37 offen sc1 lds
v_mul_f32 v226, v226, v82
v_mul_f32 v227, v227, v83
v_cvt_pk_bf16_f32 v96, v224, v225
v_cvt_pk_bf16_f32 v97, v226, v227
s_add_u32 m0, s39, 53248
s_add_u32 s37, s37, s38
buffer_load_dwordx4 v22, s[8:11], s37 offen sc1 lds
v_fma_f32 v176, -v32, v60, v176
v_fma_f32 v177, -v32, v61, v177
v_fma_f32 v178, -v32, v62, v178
v_fma_f32 v179, -v32, v63, v179
s_add_u32 m0, s39, 54272
s_add_u32 s37, s37, s38
buffer_load_dwordx4 v23, s[8:11], s37 offen sc1 lds
v_fma_f32 v240, -v32, v76, v240
v_fma_f32 v241, -v32, v77, v241
v_fma_f32 v242, -v32, v78, v242
v_fma_f32 v243, -v32, v79, v243
s_add_u32 m0, s39, 55296
s_add_u32 s37, s37, s38
buffer_load_dwordx4 v22, s[8:11], s37 offen sc1 lds
v_mul_f32 v84, v176, v176
v_mul_f32 v85, v177, v177
v_mul_f32 v86, v178, v178
v_mul_f32 v87, v179, v179
s_add_u32 m0, s39, 56320
s_add_u32 s37, s37, s38
buffer_load_dwordx4 v23, s[8:11], s37 offen sc1 lds
v_fma_f32 v84, v84, v40, v36
v_fma_f32 v85, v85, v40, v36
v_fma_f32 v86, v86, v40, v36
s_add_u32 m0, s39, 57344
s_add_u32 s37, s37, s38
buffer_load_dwordx4 v22, s[8:11], s37 offen sc1 lds
v_fma_f32 v87, v87, v40, v36
v_mul_f32 v84, v84, v176
v_mul_f32 v85, v85, v177
v_mul_f32 v86, v86, v178
s_add_u32 m0, s39, 58368
s_add_u32 s37, s37, s38
buffer_load_dwordx4 v23, s[8:11], s37 offen sc1 lds
v_mul_f32 v87, v87, v179
v_exp_f32 v84, v84
v_exp_f32 v85, v85
v_exp_f32 v86, v86
s_add_u32 m0, s39, 59392
s_add_u32 s37, s37, s38
buffer_load_dwordx4 v22, s[8:11], s37 offen sc1 lds
v_exp_f32 v87, v87
v_mul_f32 v240, v176, v240
v_mul_f32 v241, v177, v241
v_mul_f32 v242, v178, v242
s_add_u32 m0, s39, 60416
s_add_u32 s37, s37, s38
buffer_load_dwordx4 v23, s[8:11], s37 offen sc1 lds
v_mul_f32 v243, v179, v243
v_fma_f32 v84, v84, v44, v44
v_fma_f32 v85, v85, v44, v44
v_fma_f32 v86, v86, v44, v44
s_add_u32 m0, s39, 61440
s_add_u32 s37, s37, s38
buffer_load_dwordx4 v22, s[8:11], s37 offen sc1 lds
v_fma_f32 v87, v87, v44, v44
v_rcp_f32 v84, v84
v_rcp_f32 v85, v85
v_rcp_f32 v86, v86
s_add_u32 m0, s39, 62464
s_add_u32 s37, s37, s38
buffer_load_dwordx4 v23, s[8:11], s37 offen sc1 lds
v_rcp_f32 v87, v87
v_lshlrev_b32 v19, 11, v18
v_lshl_add_u32 v19, v17, 4, v19
s_lshl_b32 s43, s46, 10
s_add_u32 m0, s39, 63488
s_add_u32 s37, s37, s38
buffer_load_dwordx4 v22, s[8:11], s37 offen sc1 lds
s_lshl_b32 s44, s47, 13
v_add3_u32 v208, v19, s43, 0
v_add_u32 v208, s44, v208
buffer_load_dwordx4 v[192:195], v208, s[20:23], 0 offen offset:0 sc1
s_add_u32 m0, s39, 64512
s_add_u32 s37, s37, s38
buffer_load_dwordx4 v23, s[8:11], s37 offen sc1 lds
buffer_load_dwordx4 v[196:199], v208, s[20:23], 0 offen offset:256 sc1
buffer_load_dwordx4 v[200:203], v208, s[20:23], 0 offen offset:512 sc1
buffer_load_dwordx4 v[204:207], v208, s[20:23], 0 offen offset:768 sc1
s_waitcnt vmcnt(20)
s_barrier
s_add_u32 s42, s42, 1
s_xor_b32 s37, s42, s35
s_add_u32 m0, s39, 98304
s_mul_i32 s37, s37, s40
buffer_load_dwordx4 v22, s[8:11], s37 offen sc1 lds
v_mul_f32 v240, v240, v84
v_mul_f32 v241, v241, v85
v_mul_f32 v242, v242, v86
v_mul_f32 v243, v243, v87
s_add_u32 m0, s39, 99328
s_add_u32 s37, s37, s38
buffer_load_dwordx4 v23, s[8:11], s37 offen sc1 lds
v_cvt_pk_bf16_f32 v98, v240, v241
v_cvt_pk_bf16_f32 v99, v242, v243
s_add_u32 m0, s39, 100352
s_add_u32 s37, s37, s38
buffer_load_dwordx4 v22, s[8:11], s37 offen sc1 lds
v_fma_f32 v164, -v33, v56, v164
v_fma_f32 v165, -v33, v57, v165
v_fma_f32 v166, -v33, v58, v166
s_add_u32 m0, s39, 101376
s_add_u32 s37, s37, s38
buffer_load_dwordx4 v23, s[8:11], s37 offen sc1 lds
v_fma_f32 v167, -v33, v59, v167
v_fma_f32 v228, -v33, v72, v228
v_fma_f32 v229, -v33, v73, v229
s_add_u32 m0, s39, 102400
s_add_u32 s37, s37, s38
buffer_load_dwordx4 v22, s[8:11], s37 offen sc1 lds
v_fma_f32 v230, -v33, v74, v230
v_fma_f32 v231, -v33, v75, v231
v_mul_f32 v80, v164, v164
v_mul_f32 v81, v165, v165
s_add_u32 m0, s39, 103424
s_add_u32 s37, s37, s38
buffer_load_dwordx4 v23, s[8:11], s37 offen sc1 lds
v_mul_f32 v82, v166, v166
v_mul_f32 v83, v167, v167
v_fma_f32 v80, v80, v41, v37
s_add_u32 m0, s39, 104448
s_add_u32 s37, s37, s38
buffer_load_dwordx4 v22, s[8:11], s37 offen sc1 lds
v_fma_f32 v81, v81, v41, v37
v_fma_f32 v82, v82, v41, v37
v_fma_f32 v83, v83, v41, v37
s_add_u32 m0, s39, 105472
s_add_u32 s37, s37, s38
buffer_load_dwordx4 v23, s[8:11], s37 offen sc1 lds
v_mul_f32 v80, v80, v164
v_mul_f32 v81, v81, v165
v_mul_f32 v82, v82, v166
s_add_u32 m0, s39, 106496
s_add_u32 s37, s37, s38
buffer_load_dwordx4 v22, s[8:11], s37 offen sc1 lds
v_mul_f32 v83, v83, v167
v_exp_f32 v80, v80
v_exp_f32 v81, v81
v_exp_f32 v82, v82
s_add_u32 m0, s39, 107520
s_add_u32 s37, s37, s38
buffer_load_dwordx4 v23, s[8:11], s37 offen sc1 lds
v_exp_f32 v83, v83
v_mul_f32 v228, v164, v228
v_mul_f32 v229, v165, v229
s_add_u32 m0, s39, 108544
s_add_u32 s37, s37, s38
buffer_load_dwordx4 v22, s[8:11], s37 offen sc1 lds
v_mul_f32 v230, v166, v230
v_mul_f32 v231, v167, v231
v_fma_f32 v80, v80, v45, v45
s_add_u32 m0, s39, 109568
s_add_u32 s37, s37, s38
buffer_load_dwordx4 v23, s[8:11], s37 offen sc1 lds
v_fma_f32 v81, v81, v45, v45
v_fma_f32 v82, v82, v45, v45
v_fma_f32 v83, v83, v45, v45
s_add_u32 m0, s39, 110592
s_add_u32 s37, s37, s38
buffer_load_dwordx4 v22, s[8:11], s37 offen sc1 lds
v_rcp_f32 v80, v80
v_rcp_f32 v81, v81
v_rcp_f32 v82, v82
v_rcp_f32 v83, v83
s_add_u32 m0, s39, 111616
s_add_u32 s37, s37, s38
buffer_load_dwordx4 v23, s[8:11], s37 offen sc1 lds
v_mul_f32 v228, v228, v80
v_mul_f32 v229, v229, v81
v_mul_f32 v230, v230, v82
s_add_u32 m0, s39, 112640
s_add_u32 s37, s37, s38
buffer_load_dwordx4 v22, s[8:11], s37 offen sc1 lds
v_mul_f32 v231, v231, v83
v_cvt_pk_bf16_f32 v100, v228, v229
v_cvt_pk_bf16_f32 v101, v230, v231
s_add_u32 m0, s39, 113664
s_add_u32 s37, s37, s38
buffer_load_dwordx4 v23, s[8:11], s37 offen sc1 lds
v_fma_f32 v180, -v33, v60, v180
v_fma_f32 v181, -v33, v61, v181
v_fma_f32 v182, -v33, v62, v182
buffer_store_dwordx4 v[96:99], v27, s[24:27], s53 offen offset:0 sc1
s_waitcnt vmcnt(20)
s_barrier
s_add_u32 s42, s42, 1
s_xor_b32 s37, s42, s35
s_add_u32 m0, s39, 0
s_mul_i32 s37, s37, s40
buffer_load_dwordx4 v22, s[8:11], s37 offen sc1 lds
v_fma_f32 v183, -v33, v63, v183
v_fma_f32 v244, -v33, v76, v244
v_fma_f32 v245, -v33, v77, v245
v_fma_f32 v246, -v33, v78, v246
s_add_u32 m0, s39, 1024
s_add_u32 s37, s37, s38
buffer_load_dwordx4 v23, s[8:11], s37 offen sc1 lds
v_fma_f32 v247, -v33, v79, v247
v_mul_f32 v84, v180, v180
v_mul_f32 v85, v181, v181
s_add_u32 m0, s39, 2048
s_add_u32 s37, s37, s38
buffer_load_dwordx4 v22, s[8:11], s37 offen sc1 lds
v_mul_f32 v86, v182, v182
v_mul_f32 v87, v183, v183
v_fma_f32 v84, v84, v41, v37
s_add_u32 m0, s39, 3072
s_add_u32 s37, s37, s38
buffer_load_dwordx4 v23, s[8:11], s37 offen sc1 lds
v_fma_f32 v85, v85, v41, v37
v_fma_f32 v86, v86, v41, v37
v_fma_f32 v87, v87, v41, v37
v_mul_f32 v84, v84, v180
s_add_u32 m0, s39, 4096
s_add_u32 s37, s37, s38
buffer_load_dwordx4 v22, s[8:11], s37 offen sc1 lds
v_mul_f32 v85, v85, v181
v_mul_f32 v86, v86, v182
v_mul_f32 v87, v87, v183
s_add_u32 m0, s39, 5120
s_add_u32 s37, s37, s38
buffer_load_dwordx4 v23, s[8:11], s37 offen sc1 lds
v_exp_f32 v84, v84
v_exp_f32 v85, v85
v_exp_f32 v86, v86
s_add_u32 m0, s39, 6144
s_add_u32 s37, s37, s38
buffer_load_dwordx4 v22, s[8:11], s37 offen sc1 lds
v_exp_f32 v87, v87
v_mul_f32 v244, v180, v244
v_mul_f32 v245, v181, v245
v_mul_f32 v246, v182, v246
s_add_u32 m0, s39, 7168
s_add_u32 s37, s37, s38
buffer_load_dwordx4 v23, s[8:11], s37 offen sc1 lds
v_mul_f32 v247, v183, v247
v_fma_f32 v84, v84, v45, v45
v_fma_f32 v85, v85, v45, v45
s_add_u32 m0, s39, 8192
s_add_u32 s37, s37, s38
buffer_load_dwordx4 v22, s[8:11], s37 offen sc1 lds
v_fma_f32 v86, v86, v45, v45
v_fma_f32 v87, v87, v45, v45
v_rcp_f32 v84, v84
s_add_u32 m0, s39, 9216
s_add_u32 s37, s37, s38
buffer_load_dwordx4 v23, s[8:11], s37 offen sc1 lds
v_rcp_f32 v85, v85
v_rcp_f32 v86, v86
v_rcp_f32 v87, v87
v_mul_f32 v244, v244, v84
s_add_u32 m0, s39, 10240
s_add_u32 s37, s37, s38
buffer_load_dwordx4 v22, s[8:11], s37 offen sc1 lds
v_mul_f32 v245, v245, v85
v_mul_f32 v246, v246, v86
v_mul_f32 v247, v247, v87
s_add_u32 m0, s39, 11264
s_add_u32 s37, s37, s38
buffer_load_dwordx4 v23, s[8:11], s37 offen sc1 lds
v_cvt_pk_bf16_f32 v102, v244, v245
v_cvt_pk_bf16_f32 v103, v246, v247
s_add_u32 m0, s39, 12288
s_add_u32 s37, s37, s38
buffer_load_dwordx4 v22, s[8:11], s37 offen sc1 lds
v_fma_f32 v168, -v34, v56, v168
v_fma_f32 v169, -v34, v57, v169
v_fma_f32 v170, -v34, v58, v170
v_fma_f32 v171, -v34, v59, v171
s_add_u32 m0, s39, 13312
s_add_u32 s37, s37, s38
buffer_load_dwordx4 v23, s[8:11], s37 offen sc1 lds
v_fma_f32 v232, -v34, v72, v232
v_fma_f32 v233, -v34, v73, v233
v_fma_f32 v234, -v34, v74, v234
s_add_u32 m0, s39, 14336
s_add_u32 s37, s37, s38
buffer_load_dwordx4 v22, s[8:11], s37 offen sc1 lds
v_fma_f32 v235, -v34, v75, v235
v_mul_f32 v80, v168, v168
v_mul_f32 v81, v169, v169
s_add_u32 m0, s39, 15360
s_add_u32 s37, s37, s38
buffer_load_dwordx4 v23, s[8:11], s37 offen sc1 lds
v_mul_f32 v82, v170, v170
v_mul_f32 v83, v171, v171
v_fma_f32 v80, v80, v42, v38
buffer_store_dwordx4 v[100:103], v27, s[24:27], s53 offen offset:256 sc1
s_waitcnt vmcnt(18)
s_barrier
s_add_u32 s42, s42, 1
s_xor_b32 s37, s42, s35
s_add_u32 m0, s39, 49152
s_mul_i32 s37, s37, s40
buffer_load_dwordx4 v22, s[8:11], s37 offen sc1 lds
v_fma_f32 v81, v81, v42, v38
v_fma_f32 v82, v82, v42, v38
v_fma_f32 v83, v83, v42, v38
v_mul_f32 v80, v80, v168
s_add_u32 m0, s39, 50176
s_add_u32 s37, s37, s38
buffer_load_dwordx4 v23, s[8:11], s37 offen sc1 lds
v_mul_f32 v81, v81, v169
v_mul_f32 v82, v82, v170
v_mul_f32 v83, v83, v171
s_add_u32 m0, s39, 51200
s_add_u32 s37, s37, s38
buffer_load_dwordx4 v22, s[8:11], s37 offen sc1 lds
v_exp_f32 v80, v80
v_exp_f32 v81, v81
v_exp_f32 v82, v82
s_add_u32 m0, s39, 52224
s_add_u32 s37, s37, s38
buffer_load_dwordx4 v23, s[8:11], s37 offen sc1 lds
v_exp_f32 v83, v83
v_mul_f32 v232, v168, v232
v_mul_f32 v233, v169, v233
s_add_u32 m0, s39, 53248
s_add_u32 s37, s37, s38
buffer_load_dwordx4 v22, s[8:11], s37 offen sc1 lds
v_mul_f32 v234, v170, v234
v_mul_f32 v235, v171, v235
v_fma_f32 v80, v80, v46, v46
v_fma_f32 v81, v81, v46, v46
s_add_u32 m0, s39, 54272
s_add_u32 s37, s37, s38
buffer_load_dwordx4 v23, s[8:11], s37 offen sc1 lds
v_fma_f32 v82, v82, v46, v46
v_fma_f32 v83, v83, v46, v46
v_rcp_f32 v80, v80
s_add_u32 m0, s39, 55296
s_add_u32 s37, s37, s38
buffer_load_dwordx4 v22, s[8:11], s37 offen sc1 lds
v_rcp_f32 v81, v81
v_rcp_f32 v82, v82
v_rcp_f32 v83, v83
s_add_u32 m0, s39, 56320
s_add_u32 s37, s37, s38
buffer_load_dwordx4 v23, s[8:11], s37 offen sc1 lds
v_mul_f32 v232, v232, v80
v_mul_f32 v233, v233, v81
v_mul_f32 v234, v234, v82
s_add_u32 m0, s39, 57344
s_add_u32 s37, s37, s38
buffer_load_dwordx4 v22, s[8:11], s37 offen sc1 lds
v_mul_f32 v235, v235, v83
v_cvt_pk_bf16_f32 v104, v232, v233
v_cvt_pk_bf16_f32 v105, v234, v235
v_fma_f32 v184, -v34, v60, v184
s_add_u32 m0, s39, 58368
s_add_u32 s37, s37, s38
buffer_load_dwordx4 v23, s[8:11], s37 offen sc1 lds
v_fma_f32 v185, -v34, v61, v185
v_fma_f32 v186, -v34, v62, v186
v_fma_f32 v187, -v34, v63, v187
s_add_u32 m0, s39, 59392
s_add_u32 s37, s37, s38
buffer_load_dwordx4 v22, s[8:11], s37 offen sc1 lds
v_fma_f32 v248, -v34, v76, v248
v_fma_f32 v249, -v34, v77, v249
v_fma_f32 v250, -v34, v78, v250
s_add_u32 m0, s39, 60416
s_add_u32 s37, s37, s38
buffer_load_dwordx4 v23, s[8:11], s37 offen sc1 lds
v_fma_f32 v251, -v34, v79, v251
v_mul_f32 v84, v184, v184
v_mul_f32 v85, v185, v185
s_add_u32 m0, s39, 61440
s_add_u32 s37, s37, s38
buffer_load_dwordx4 v22, s[8:11], s37 offen sc1 lds
v_mul_f32 v86, v186, v186
v_mul_f32 v87, v187, v187
v_fma_f32 v84, v84, v42, v38
v_fma_f32 v85, v85, v42, v38
s_add_u32 m0, s39, 62464
s_add_u32 s37, s37, s38
buffer_load_dwordx4 v23, s[8:11], s37 offen sc1 lds
v_fma_f32 v86, v86, v42, v38
v_fma_f32 v87, v87, v42, v38
v_mul_f32 v84, v84, v184
s_add_u32 m0, s39, 63488
s_add_u32 s37, s37, s38
buffer_load_dwordx4 v22, s[8:11], s37 offen sc1 lds
v_mul_f32 v85, v85, v185
v_mul_f32 v86, v86, v186
v_mul_f32 v87, v87, v187
s_add_u32 m0, s39, 64512
s_add_u32 s37, s37, s38
buffer_load_dwordx4 v23, s[8:11], s37 offen sc1 lds
v_exp_f32 v84, v84
v_exp_f32 v85, v85
v_exp_f32 v86, v86
s_waitcnt vmcnt(17)
s_barrier
s_add_u32 s42, s42, 1
s_xor_b32 s37, s42, s35
s_add_u32 m0, s39, 98304
s_mul_i32 s37, s37, s40
buffer_load_dwordx4 v22, s[8:11], s37 offen sc1 lds
v_exp_f32 v87, v87
v_mul_f32 v248, v184, v248
v_mul_f32 v249, v185, v249
v_mul_f32 v250, v186, v250
s_add_u32 m0, s39, 99328
s_add_u32 s37, s37, s38
buffer_load_dwordx4 v23, s[8:11], s37 offen sc1 lds
v_mul_f32 v251, v187, v251
v_fma_f32 v84, v84, v46, v46
v_fma_f32 v85, v85, v46, v46
s_add_u32 m0, s39, 100352
s_add_u32 s37, s37, s38
buffer_load_dwordx4 v22, s[8:11], s37 offen sc1 lds
v_fma_f32 v86, v86, v46, v46
v_fma_f32 v87, v87, v46, v46
v_rcp_f32 v84, v84
s_add_u32 m0, s39, 101376
s_add_u32 s37, s37, s38
buffer_load_dwordx4 v23, s[8:11], s37 offen sc1 lds
v_rcp_f32 v85, v85
v_rcp_f32 v86, v86
v_rcp_f32 v87, v87
s_add_u32 m0, s39, 102400
s_add_u32 s37, s37, s38
buffer_load_dwordx4 v22, s[8:11], s37 offen sc1 lds
v_mul_f32 v248, v248, v84
v_mul_f32 v249, v249, v85
v_mul_f32 v250, v250, v86
v_mul_f32 v251, v251, v87
s_add_u32 m0, s39, 103424
s_add_u32 s37, s37, s38
buffer_load_dwordx4 v23, s[8:11], s37 offen sc1 lds
v_cvt_pk_bf16_f32 v106, v248, v249
v_cvt_pk_bf16_f32 v107, v250, v251
s_add_u32 m0, s39, 104448
s_add_u32 s37, s37, s38
buffer_load_dwordx4 v22, s[8:11], s37 offen sc1 lds
v_fma_f32 v172, -v35, v56, v172
v_fma_f32 v173, -v35, v57, v173
v_fma_f32 v174, -v35, v58, v174
s_add_u32 m0, s39, 105472
s_add_u32 s37, s37, s38
buffer_load_dwordx4 v23, s[8:11], s37 offen sc1 lds
v_fma_f32 v175, -v35, v59, v175
v_fma_f32 v236, -v35, v72, v236
v_fma_f32 v237, -v35, v73, v237
s_add_u32 m0, s39, 106496
s_add_u32 s37, s37, s38
buffer_load_dwordx4 v22, s[8:11], s37 offen sc1 lds
v_fma_f32 v238, -v35, v74, v238
v_fma_f32 v239, -v35, v75, v239
v_mul_f32 v80, v172, v172
v_mul_f32 v81, v173, v173
s_add_u32 m0, s39, 107520
s_add_u32 s37, s37, s38
buffer_load_dwordx4 v23, s[8:11], s37 offen sc1 lds
v_mul_f32 v82, v174, v174
v_mul_f32 v83, v175, v175
v_fma_f32 v80, v80, v43, v39
s_add_u32 m0, s39, 108544
s_add_u32 s37, s37, s38
buffer_load_dwordx4 v22, s[8:11], s37 offen sc1 lds
v_fma_f32 v81, v81, v43, v39
v_fma_f32 v82, v82, v43, v39
v_fma_f32 v83, v83, v43, v39
s_add_u32 m0, s39, 109568
s_add_u32 s37, s37, s38
buffer_load_dwordx4 v23, s[8:11], s37 offen sc1 lds
v_mul_f32 v80, v80, v172
v_mul_f32 v81, v81, v173
v_mul_f32 v82, v82, v174
s_add_u32 m0, s39, 110592
s_add_u32 s37, s37, s38
buffer_load_dwordx4 v22, s[8:11], s37 offen sc1 lds
v_mul_f32 v83, v83, v175
v_exp_f32 v80, v80
v_exp_f32 v81, v81
v_exp_f32 v82, v82
s_add_u32 m0, s39, 111616
s_add_u32 s37, s37, s38
buffer_load_dwordx4 v23, s[8:11], s37 offen sc1 lds
v_exp_f32 v83, v83
v_mul_f32 v236, v172, v236
v_mul_f32 v237, v173, v237
s_add_u32 m0, s39, 112640
s_add_u32 s37, s37, s38
buffer_load_dwordx4 v22, s[8:11], s37 offen sc1 lds
v_mul_f32 v238, v174, v238
v_mul_f32 v239, v175, v239
v_fma_f32 v80, v80, v47, v47
s_add_u32 m0, s39, 113664
s_add_u32 s37, s37, s38
buffer_load_dwordx4 v23, s[8:11], s37 offen sc1 lds
v_fma_f32 v81, v81, v47, v47
v_fma_f32 v82, v82, v47, v47
v_fma_f32 v83, v83, v47, v47
buffer_store_dwordx4 v[104:107], v27, s[24:27], s53 offen offset:512 sc1
s_waitcnt vmcnt(17)
s_barrier
s_add_u32 s42, s42, 1
s_xor_b32 s37, s42, s35
s_add_u32 m0, s39, 0
s_mul_i32 s37, s37, s40
buffer_load_dwordx4 v22, s[8:11], s37 offen sc1 lds
v_rcp_f32 v80, v80
v_rcp_f32 v81, v81
v_rcp_f32 v82, v82
v_rcp_f32 v83, v83
s_add_u32 m0, s39, 1024
s_add_u32 s37, s37, s38
buffer_load_dwordx4 v23, s[8:11], s37 offen sc1 lds
v_mul_f32 v236, v236, v80
v_mul_f32 v237, v237, v81
v_mul_f32 v238, v238, v82
s_add_u32 m0, s39, 2048
s_add_u32 s37, s37, s38
buffer_load_dwordx4 v22, s[8:11], s37 offen sc1 lds
v_mul_f32 v239, v239, v83
v_cvt_pk_bf16_f32 v108, v236, v237
v_cvt_pk_bf16_f32 v109, v238, v239
s_add_u32 m0, s39, 3072
s_add_u32 s37, s37, s38
buffer_load_dwordx4 v23, s[8:11], s37 offen sc1 lds
v_fma_f32 v188, -v35, v60, v188
v_fma_f32 v189, -v35, v61, v189
v_fma_f32 v190, -v35, v62, v190
v_fma_f32 v191, -v35, v63, v191
s_add_u32 m0, s39, 4096
s_add_u32 s37, s37, s38
buffer_load_dwordx4 v22, s[8:11], s37 offen sc1 lds
v_fma_f32 v252, -v35, v76, v252
v_fma_f32 v253, -v35, v77, v253
v_fma_f32 v254, -v35, v78, v254
s_add_u32 m0, s39, 5120
s_add_u32 s37, s37, s38
buffer_load_dwordx4 v23, s[8:11], s37 offen sc1 lds
v_fma_f32 v255, -v35, v79, v255
v_mul_f32 v84, v188, v188
v_mul_f32 v85, v189, v189
s_add_u32 m0, s39, 6144
s_add_u32 s37, s37, s38
buffer_load_dwordx4 v22, s[8:11], s37 offen sc1 lds
v_mul_f32 v86, v190, v190
v_mul_f32 v87, v191, v191
v_fma_f32 v84, v84, v43, v39
v_fma_f32 v85, v85, v43, v39
s_add_u32 m0, s39, 7168
s_add_u32 s37, s37, s38
buffer_load_dwordx4 v23, s[8:11], s37 offen sc1 lds
v_fma_f32 v86, v86, v43, v39
v_fma_f32 v87, v87, v43, v39
v_mul_f32 v84, v84, v188
s_add_u32 m0, s39, 8192
s_add_u32 s37, s37, s38
buffer_load_dwordx4 v22, s[8:11], s37 offen sc1 lds
v_mul_f32 v85, v85, v189
v_mul_f32 v86, v86, v190
v_mul_f32 v87, v87, v191
s_add_u32 m0, s39, 9216
s_add_u32 s37, s37, s38
buffer_load_dwordx4 v23, s[8:11], s37 offen sc1 lds
v_exp_f32 v84, v84
v_exp_f32 v85, v85
v_exp_f32 v86, v86
v_exp_f32 v87, v87
s_add_u32 m0, s39, 10240
s_add_u32 s37, s37, s38
buffer_load_dwordx4 v22, s[8:11], s37 offen sc1 lds
v_mul_f32 v252, v188, v252
v_mul_f32 v253, v189, v253
v_mul_f32 v254, v190, v254
s_add_u32 m0, s39, 11264
s_add_u32 s37, s37, s38
buffer_load_dwordx4 v23, s[8:11], s37 offen sc1 lds
v_mul_f32 v255, v191, v255
v_fma_f32 v84, v84, v47, v47
v_fma_f32 v85, v85, v47, v47
s_add_u32 m0, s39, 12288
s_add_u32 s37, s37, s38
buffer_load_dwordx4 v22, s[8:11], s37 offen sc1 lds
v_fma_f32 v86, v86, v47, v47
v_fma_f32 v87, v87, v47, v47
v_rcp_f32 v84, v84
v_rcp_f32 v85, v85
s_add_u32 m0, s39, 13312
s_add_u32 s37, s37, s38
buffer_load_dwordx4 v23, s[8:11], s37 offen sc1 lds
v_rcp_f32 v86, v86
v_rcp_f32 v87, v87
v_mul_f32 v252, v252, v84
s_add_u32 m0, s39, 14336
s_add_u32 s37, s37, s38
buffer_load_dwordx4 v22, s[8:11], s37 offen sc1 lds
v_mul_f32 v253, v253, v85
v_mul_f32 v254, v254, v86
v_mul_f32 v255, v255, v87
s_add_u32 m0, s39, 15360
s_add_u32 s37, s37, s38
buffer_load_dwordx4 v23, s[8:11], s37 offen sc1 lds
v_cvt_pk_bf16_f32 v110, v252, v253
v_cvt_pk_bf16_f32 v111, v254, v255
buffer_store_dwordx4 v[108:111], v27, s[24:27], s53 offen offset:768 sc1
s_waitcnt vmcnt(18)
s_barrier
s_mul_i32 s44, s34, 917504
s_lshl_b32 s39, s51, 13
s_add_u32 s44, s44, s39
s_add_u32 s44, s44, 8388608
s_and_b32 s43, s51, 1
s_xor_b32 s43, s43, s35
s_lshl_b32 s43, s43, 7
s_mov_b32 s10, 909312
s_movk_i32 s38, 1024
s_movk_i32 s40, 9216
s_movk_i32 s37, 0x4000
s_cmp_ge_u32 s51, 2
s_cselect_b32 s8, s60, s32
s_cselect_b32 s9, s61, s33
s_cselect_b32 s10, 7338112, s10
s_cselect_b32 s43, s43, s44
s_cselect_b32 s38, 16384, s38
s_cselect_b32 s40, 81920, s40
s_cselect_b32 s55, 81920, s38
s_cselect_b32 s37, 262144, s37
s_cselect_b32 s45, -1, 0
s_add_u32 s8, s8, s43
s_addc_u32 s9, s9, 0
s_mov_b32 s11, 0x20000
s_and_b32 s53, s35, 1
s_mul_i32 s54, s53, 6
s_mul_i32 s54, s54, s37
s_mul_i32 s29, s53, 2
s_add_u32 s29, s29, 6
s_mul_i32 s29, s29, s37
s_and_b32 s43, s45, 4290838528
s_add_u32 s29, s29, s43
s_mul_i32 s37, s37, 0
s_sub_u32 s37, s37, s40
v_lshrrev_b32 v19, 3, v1
v_mul_u32_u24 v19, 1920, v19
v_lshrrev_b32 v20, 4, v1
v_lshlrev_b32 v20, 5, v20
v_and_b32 v19, s45, v19
v_and_b32 v20, s45, v20
v_lshlrev_b32 v21, 4, v1
v_xor_b32 v21, v21, v20
v_add_u32 v21, v21, v19
s_mov_b64 s[72:73], -1
s_add_u32 m0, s39, 65536
s_add_u32 s37, s37, s40
buffer_load_dwordx4 v21, s[8:11], s37 offen sc1 lds
v_lshlrev_b32 v128, 16, v192
v_and_b32 v129, 0xffff0000, v192
v_lshlrev_b32 v130, 16, v193
v_and_b32 v131, 0xffff0000, v193
s_add_u32 m0, s39, 66560
s_add_u32 s37, s37, s38
buffer_load_dwordx4 v21, s[8:11], s37 offen sc1 lds
v_lshlrev_b32 v132, 16, v194
v_and_b32 v133, 0xffff0000, v194
v_lshlrev_b32 v134, 16, v195
v_and_b32 v135, 0xffff0000, v195
s_add_u32 m0, s39, 67584
s_add_u32 s37, s37, s38
buffer_load_dwordx4 v21, s[8:11], s37 offen sc1 lds
v_lshlrev_b32 v136, 16, v196
v_and_b32 v137, 0xffff0000, v196
v_lshlrev_b32 v138, 16, v197
v_and_b32 v139, 0xffff0000, v197
s_add_u32 m0, s39, 68608
s_add_u32 s37, s37, s38
buffer_load_dwordx4 v21, s[8:11], s37 offen sc1 lds
v_lshlrev_b32 v140, 16, v198
v_and_b32 v141, 0xffff0000, v198
v_lshlrev_b32 v142, 16, v199
v_and_b32 v143, 0xffff0000, v199
s_add_u32 m0, s39, 69632
s_add_u32 s37, s37, s55
buffer_load_dwordx4 v21, s[8:11], s37 offen sc1 lds
v_lshlrev_b32 v144, 16, v200
v_and_b32 v145, 0xffff0000, v200
v_lshlrev_b32 v146, 16, v201
v_and_b32 v147, 0xffff0000, v201
s_add_u32 m0, s39, 70656
s_add_u32 s37, s37, s38
buffer_load_dwordx4 v21, s[8:11], s37 offen sc1 lds
v_lshlrev_b32 v148, 16, v202
v_and_b32 v149, 0xffff0000, v202
v_lshlrev_b32 v150, 16, v203
v_and_b32 v151, 0xffff0000, v203
s_add_u32 m0, s39, 71680
s_add_u32 s37, s37, s38
buffer_load_dwordx4 v21, s[8:11], s37 offen sc1 lds
v_lshlrev_b32 v152, 16, v204
v_and_b32 v153, 0xffff0000, v204
v_lshlrev_b32 v154, 16, v205
v_and_b32 v155, 0xffff0000, v205
s_add_u32 m0, s39, 72704
s_add_u32 s37, s37, s38
buffer_load_dwordx4 v21, s[8:11], s37 offen sc1 lds
v_lshlrev_b32 v156, 16, v206
v_and_b32 v157, 0xffff0000, v206
v_lshlrev_b32 v158, 16, v207
v_and_b32 v159, 0xffff0000, v207
s_waitcnt vmcnt(8)
s_barrier
s_add_u32 m0, s39, 98304
s_add_u32 s37, s37, s40
buffer_load_dwordx4 v21, s[8:11], s37 offen sc1 lds
v_mov_b32 v192, 0
v_mov_b32 v193, 0
v_mov_b32 v194, 0
v_mov_b32 v195, 0
s_add_u32 m0, s39, 99328
s_add_u32 s37, s37, s38
buffer_load_dwordx4 v21, s[8:11], s37 offen sc1 lds
v_mov_b32 v196, 0
v_mov_b32 v197, 0
v_mov_b32 v198, 0
v_mov_b32 v199, 0
s_add_u32 m0, s39, 100352
s_add_u32 s37, s37, s38
buffer_load_dwordx4 v21, s[8:11], s37 offen sc1 lds
v_mov_b32 v200, 0
v_mov_b32 v201, 0
v_mov_b32 v202, 0
v_mov_b32 v203, 0
s_add_u32 m0, s39, 101376
s_add_u32 s37, s37, s38
buffer_load_dwordx4 v21, s[8:11], s37 offen sc1 lds
v_mov_b32 v204, 0
v_mov_b32 v205, 0
v_mov_b32 v206, 0
v_mov_b32 v207, 0
s_add_u32 m0, s39, 102400
s_add_u32 s37, s37, s55
buffer_load_dwordx4 v21, s[8:11], s37 offen sc1 lds
v_mov_b32 v208, 0
v_mov_b32 v209, 0
v_mov_b32 v210, 0
v_mov_b32 v211, 0
s_add_u32 m0, s39, 103424
s_add_u32 s37, s37, s38
buffer_load_dwordx4 v21, s[8:11], s37 offen sc1 lds
v_mov_b32 v212, 0
v_mov_b32 v213, 0
v_mov_b32 v214, 0
v_mov_b32 v215, 0
s_add_u32 m0, s39, 104448
s_add_u32 s37, s37, s38
buffer_load_dwordx4 v21, s[8:11], s37 offen sc1 lds
v_mov_b32 v216, 0
v_mov_b32 v217, 0
v_mov_b32 v218, 0
v_mov_b32 v219, 0
s_add_u32 m0, s39, 105472
s_add_u32 s37, s37, s38
buffer_load_dwordx4 v21, s[8:11], s37 offen sc1 lds
v_mov_b32 v220, 0
v_mov_b32 v221, 0
v_mov_b32 v222, 0
v_mov_b32 v223, 0
s_waitcnt vmcnt(8)
s_barrier
s_branch LK4_125
.p2align 6
Lw_155:
s_branch Lr_156
s_nop 0
.p2align 3
L3h_124:
v_mfma_f32_16x16x32_bf16 v[128:131], v[96:99], v[80:83], v[128:131]
s_lshl_b32 s43, s46, 9
v_mfma_f32_16x16x32_bf16 v[132:135], v[96:99], v[84:87], v[132:135]
s_add_u32 s43, s43, 147456
v_mfma_f32_16x16x32_bf16 v[136:139], v[96:99], v[88:91], v[136:139]
v_lshl_add_u32 v19, v17, 3, s43
v_mfma_f32_16x16x32_bf16 v[140:143], v[96:99], v[92:95], v[140:143]
ds_read_b64 v[2:3], v19 offset:0
v_mfma_f32_16x16x32_bf16 v[204:207], v[112:115], v[92:95], v[204:207]
ds_read_b64 v[4:5], v19 offset:128
v_mfma_f32_16x16x32_bf16 v[200:203], v[112:115], v[88:91], v[200:203]
ds_read_b64 v[6:7], v19 offset:256
v_mfma_f32_16x16x32_bf16 v[196:199], v[112:115], v[84:87], v[196:199]
ds_read_b64 v[8:9], v19 offset:384
v_mfma_f32_16x16x32_bf16 v[192:195], v[112:115], v[80:83], v[192:195]
s_mul_i32 s43, s47, 256
v_mfma_f32_16x16x32_bf16 v[144:147], v[100:103], v[80:83], v[144:147]
s_add_u32 s43, s43, 148480
v_mfma_f32_16x16x32_bf16 v[148:151], v[100:103], v[84:87], v[148:151]
v_lshl_add_u32 v19, v18, 4, s43
v_mfma_f32_16x16x32_bf16 v[152:155], v[100:103], v[88:91], v[152:155]
ds_read_b128 v[48:51], v19 offset:0
v_mfma_f32_16x16x32_bf16 v[156:159], v[100:103], v[92:95], v[156:159]
ds_read_b128 v[52:55], v19 offset:64
v_mfma_f32_16x16x32_bf16 v[220:223], v[116:119], v[92:95], v[220:223]
ds_read_b128 v[56:59], v19 offset:128
v_mfma_f32_16x16x32_bf16 v[216:219], v[116:119], v[88:91], v[216:219]
ds_read_b128 v[60:63], v19 offset:192
v_mfma_f32_16x16x32_bf16 v[212:215], v[116:119], v[84:87], v[212:215]
ds_read_b128 v[64:67], v19 offset:896
v_mfma_f32_16x16x32_bf16 v[208:211], v[116:119], v[80:83], v[208:211]
ds_read_b128 v[68:71], v19 offset:960
v_mfma_f32_16x16x32_bf16 v[160:163], v[104:107], v[80:83], v[160:163]
ds_read_b128 v[72:75], v19 offset:1024
v_mfma_f32_16x16x32_bf16 v[164:167], v[104:107], v[84:87], v[164:167]
ds_read_b128 v[76:79], v19 offset:1088
v_mfma_f32_16x16x32_bf16 v[168:171], v[104:107], v[88:91], v[168:171]
v_mfma_f32_16x16x32_bf16 v[172:175], v[104:107], v[92:95], v[172:175]
v_mfma_f32_16x16x32_bf16 v[236:239], v[120:123], v[92:95], v[236:239]
v_mfma_f32_16x16x32_bf16 v[232:235], v[120:123], v[88:91], v[232:235]
v_mfma_f32_16x16x32_bf16 v[228:231], v[120:123], v[84:87], v[228:231]
v_mfma_f32_16x16x32_bf16 v[224:227], v[120:123], v[80:83], v[224:227]
v_mfma_f32_16x16x32_bf16 v[176:179], v[108:111], v[80:83], v[176:179]
v_mfma_f32_16x16x32_bf16 v[180:183], v[108:111], v[84:87], v[180:183]
v_mfma_f32_16x16x32_bf16 v[184:187], v[108:111], v[88:91], v[184:187]
v_mfma_f32_16x16x32_bf16 v[188:191], v[108:111], v[92:95], v[188:191]
v_mfma_f32_16x16x32_bf16 v[252:255], v[124:127], v[92:95], v[252:255]
v_mfma_f32_16x16x32_bf16 v[248:251], v[124:127], v[88:91], v[248:251]
v_mfma_f32_16x16x32_bf16 v[244:247], v[124:127], v[84:87], v[244:247]
v_mfma_f32_16x16x32_bf16 v[240:243], v[124:127], v[80:83], v[240:243]
s_setprio 0
s_waitcnt lgkmcnt(0)
v_mov_b32 v32, v2
v_mul_f32 v88, v3, v3
v_mul_f32 v36, 0xc0135761, v3
v_mul_f32 v89, 0xbdd2d3e8, v3
v_rcp_f32 v44, v88
v_mul_f32 v40, v89, v88
v_mov_b32 v33, v4
v_mul_f32 v88, v5, v5
v_mul_f32 v37, 0xc0135761, v5
v_mul_f32 v89, 0xbdd2d3e8, v5
v_rcp_f32 v45, v88
v_mul_f32 v41, v89, v88
v_mov_b32 v34, v6
v_mul_f32 v88, v7, v7
v_mul_f32 v38, 0xc0135761, v7
v_mul_f32 v89, 0xbdd2d3e8, v7
v_rcp_f32 v46, v88
v_mul_f32 v42, v89, v88
v_mov_b32 v35, v8
v_mul_f32 v88, v9, v9
v_mul_f32 v39, 0xc0135761, v9
v_mul_f32 v89, 0xbdd2d3e8, v9
v_rcp_f32 v47, v88
v_mul_f32 v43, v89, v88
s_barrier
v_fma_f32 v128, -v32, v48, v128
v_fma_f32 v129, -v32, v49, v129
v_fma_f32 v130, -v32, v50, v130
v_fma_f32 v131, -v32, v51, v131
v_fma_f32 v192, -v32, v64, v192
v_fma_f32 v193, -v32, v65, v193
v_fma_f32 v194, -v32, v66, v194
v_fma_f32 v195, -v32, v67, v195
v_mul_f32 v80, v128, v128
v_mul_f32 v81, v129, v129
v_mul_f32 v82, v130, v130
v_mul_f32 v83, v131, v131
v_fma_f32 v80, v80, v40, v36
v_fma_f32 v81, v81, v40, v36
v_fma_f32 v82, v82, v40, v36
v_fma_f32 v83, v83, v40, v36
v_mul_f32 v80, v80, v128
v_mul_f32 v81, v81, v129
v_mul_f32 v82, v82, v130
v_mul_f32 v83, v83, v131
v_exp_f32 v80, v80
v_exp_f32 v81, v81
v_exp_f32 v82, v82
v_exp_f32 v83, v83
v_mul_f32 v192, v128, v192
v_mul_f32 v193, v129, v193
v_mul_f32 v194, v130, v194
v_mul_f32 v195, v131, v195
v_fma_f32 v80, v80, v44, v44
v_fma_f32 v81, v81, v44, v44
v_fma_f32 v82, v82, v44, v44
v_fma_f32 v83, v83, v44, v44
v_rcp_f32 v80, v80
v_rcp_f32 v81, v81
v_rcp_f32 v82, v82
v_rcp_f32 v83, v83
v_mul_f32 v192, v192, v80
v_mul_f32 v193, v193, v81
v_mul_f32 v194, v194, v82
v_mul_f32 v195, v195, v83
v_cvt_pk_bf16_f32 v96, v192, v193
v_cvt_pk_bf16_f32 v97, v194, v195
v_fma_f32 v144, -v32, v52, v144
v_fma_f32 v145, -v32, v53, v145
v_fma_f32 v146, -v32, v54, v146
v_fma_f32 v147, -v32, v55, v147
v_fma_f32 v208, -v32, v68, v208
v_fma_f32 v209, -v32, v69, v209
v_fma_f32 v210, -v32, v70, v210
v_fma_f32 v211, -v32, v71, v211
v_mul_f32 v84, v144, v144
v_mul_f32 v85, v145, v145
s_barrier
v_mul_f32 v86, v146, v146
v_mul_f32 v87, v147, v147
v_fma_f32 v84, v84, v40, v36
v_fma_f32 v85, v85, v40, v36
v_fma_f32 v86, v86, v40, v36
v_fma_f32 v87, v87, v40, v36
v_mul_f32 v84, v84, v144
v_mul_f32 v85, v85, v145
v_mul_f32 v86, v86, v146
v_mul_f32 v87, v87, v147
v_exp_f32 v84, v84
v_exp_f32 v85, v85
v_exp_f32 v86, v86
v_exp_f32 v87, v87
v_mul_f32 v208, v144, v208
v_mul_f32 v209, v145, v209
v_mul_f32 v210, v146, v210
v_mul_f32 v211, v147, v211
v_fma_f32 v84, v84, v44, v44
v_fma_f32 v85, v85, v44, v44
v_fma_f32 v86, v86, v44, v44
v_fma_f32 v87, v87, v44, v44
v_rcp_f32 v84, v84
v_rcp_f32 v85, v85
v_rcp_f32 v86, v86
v_rcp_f32 v87, v87
v_mul_f32 v208, v208, v84
v_mul_f32 v209, v209, v85
v_mul_f32 v210, v210, v86
v_mul_f32 v211, v211, v87
v_cvt_pk_bf16_f32 v98, v208, v209
v_cvt_pk_bf16_f32 v99, v210, v211
buffer_store_dwordx4 v[96:99], v27, s[24:27], 0 offen offset:0 sc1
v_fma_f32 v132, -v33, v48, v132
v_fma_f32 v133, -v33, v49, v133
v_fma_f32 v134, -v33, v50, v134
v_fma_f32 v135, -v33, v51, v135
v_fma_f32 v196, -v33, v64, v196
v_fma_f32 v197, -v33, v65, v197
v_fma_f32 v198, -v33, v66, v198
v_fma_f32 v199, -v33, v67, v199
v_mul_f32 v80, v132, v132
v_mul_f32 v81, v133, v133
v_mul_f32 v82, v134, v134
v_mul_f32 v83, v135, v135
v_fma_f32 v80, v80, v41, v37
v_fma_f32 v81, v81, v41, v37
v_fma_f32 v82, v82, v41, v37
v_fma_f32 v83, v83, v41, v37
v_mul_f32 v80, v80, v132
v_mul_f32 v81, v81, v133
v_mul_f32 v82, v82, v134
v_lshlrev_b32 v19, 11, v18
v_lshl_add_u32 v19, v17, 4, v19
s_lshl_b32 s43, s46, 10
v_add_u32 v2, s43, v19
v_add_u32 v3, 0x10000, v2
v_lshrrev_b32 v19, 2, v17
v_lshl_add_u32 v20, v18, 2, v19
v_bfe_u32 v21, v20, 1, 2
s_lshl_b32 s43, s47, 1
v_xor_b32 v21, s43, v21
v_lshlrev_b32 v20, 7, v20
v_lshl_add_u32 v20, v21, 5, v20
v_and_b32 v19, 3, v1
v_lshl_add_u32 v20, v19, 3, v20
v_add_u32 v5, 16384, v20
v_xor_b32 v6, 32, v5
v_add_u32 v7, 0x10000, v5
v_add_u32 v8, 0x10000, v6
s_lshl_b32 s43, s36, 12
v_lshl_add_u32 v9, v1, 4, s43
s_mov_b32 s54, 0x10000
s_movk_i32 s52, 0x1000
s_barrier
v_mul_f32 v83, v83, v135
v_exp_f32 v80, v80
v_exp_f32 v81, v81
v_exp_f32 v82, v82
v_exp_f32 v83, v83
v_mul_f32 v196, v132, v196
v_mul_f32 v197, v133, v197
v_mul_f32 v198, v134, v198
v_mul_f32 v199, v135, v199
v_fma_f32 v80, v80, v45, v45
v_fma_f32 v81, v81, v45, v45
v_fma_f32 v82, v82, v45, v45
v_fma_f32 v83, v83, v45, v45
v_rcp_f32 v80, v80
v_rcp_f32 v81, v81
v_rcp_f32 v82, v82
v_rcp_f32 v83, v83
v_mul_f32 v196, v196, v80
v_mul_f32 v197, v197, v81
v_mul_f32 v198, v198, v82
v_mul_f32 v199, v199, v83
v_cvt_pk_bf16_f32 v100, v196, v197
v_cvt_pk_bf16_f32 v101, v198, v199
v_fma_f32 v148, -v33, v52, v148
v_fma_f32 v149, -v33, v53, v149
v_fma_f32 v150, -v33, v54, v150
v_fma_f32 v151, -v33, v55, v151
v_fma_f32 v212, -v33, v68, v212
v_fma_f32 v213, -v33, v69, v213
v_fma_f32 v214, -v33, v70, v214
v_fma_f32 v215, -v33, v71, v215
v_mul_f32 v84, v148, v148
v_mul_f32 v85, v149, v149
v_mul_f32 v86, v150, v150
v_mul_f32 v87, v151, v151
v_fma_f32 v84, v84, v41, v37
v_fma_f32 v85, v85, v41, v37
v_fma_f32 v86, v86, v41, v37
v_fma_f32 v87, v87, v41, v37
v_mul_f32 v84, v84, v148
v_mul_f32 v85, v85, v149
v_mul_f32 v86, v86, v150
v_mul_f32 v87, v87, v151
v_exp_f32 v84, v84
v_exp_f32 v85, v85
v_exp_f32 v86, v86
v_exp_f32 v87, v87
v_mul_f32 v212, v148, v212
v_mul_f32 v213, v149, v213
v_mul_f32 v214, v150, v214
v_mul_f32 v215, v151, v215
v_fma_f32 v84, v84, v45, v45
s_barrier
v_fma_f32 v85, v85, v45, v45
v_fma_f32 v86, v86, v45, v45
v_fma_f32 v87, v87, v45, v45
v_rcp_f32 v84, v84
v_rcp_f32 v85, v85
v_rcp_f32 v86, v86
v_rcp_f32 v87, v87
v_mul_f32 v212, v212, v84
v_mul_f32 v213, v213, v85
v_mul_f32 v214, v214, v86
v_mul_f32 v215, v215, v87
v_cvt_pk_bf16_f32 v102, v212, v213
v_cvt_pk_bf16_f32 v103, v214, v215
buffer_store_dwordx4 v[100:103], v27, s[24:27], 0 offen offset:256 sc1
v_fma_f32 v136, -v34, v48, v136
v_fma_f32 v137, -v34, v49, v137
v_fma_f32 v138, -v34, v50, v138
v_fma_f32 v139, -v34, v51, v139
v_fma_f32 v200, -v34, v64, v200
v_fma_f32 v201, -v34, v65, v201
v_fma_f32 v202, -v34, v66, v202
v_fma_f32 v203, -v34, v67, v203
v_mul_f32 v80, v136, v136
v_mul_f32 v81, v137, v137
v_mul_f32 v82, v138, v138
v_mul_f32 v83, v139, v139
v_fma_f32 v80, v80, v42, v38
v_fma_f32 v81, v81, v42, v38
v_fma_f32 v82, v82, v42, v38
v_fma_f32 v83, v83, v42, v38
v_mul_f32 v80, v80, v136
v_mul_f32 v81, v81, v137
v_mul_f32 v82, v82, v138
v_mul_f32 v83, v83, v139
v_exp_f32 v80, v80
v_exp_f32 v81, v81
v_exp_f32 v82, v82
v_exp_f32 v83, v83
v_mul_f32 v200, v136, v200
v_mul_f32 v201, v137, v201
v_mul_f32 v202, v138, v202
v_mul_f32 v203, v139, v203
v_fma_f32 v80, v80, v46, v46
v_fma_f32 v81, v81, v46, v46
v_fma_f32 v82, v82, v46, v46
v_fma_f32 v83, v83, v46, v46
v_rcp_f32 v80, v80
v_rcp_f32 v81, v81
v_rcp_f32 v82, v82
v_rcp_f32 v83, v83
v_mul_f32 v200, v200, v80
v_mul_f32 v201, v201, v81
v_mul_f32 v202, v202, v82
s_barrier
v_mul_f32 v203, v203, v83
v_cvt_pk_bf16_f32 v104, v200, v201
v_cvt_pk_bf16_f32 v105, v202, v203
v_fma_f32 v152, -v34, v52, v152
v_fma_f32 v153, -v34, v53, v153
v_fma_f32 v154, -v34, v54, v154
v_fma_f32 v155, -v34, v55, v155
v_fma_f32 v216, -v34, v68, v216
v_fma_f32 v217, -v34, v69, v217
v_fma_f32 v218, -v34, v70, v218
v_fma_f32 v219, -v34, v71, v219
v_mul_f32 v84, v152, v152
v_mul_f32 v85, v153, v153
v_mul_f32 v86, v154, v154
v_mul_f32 v87, v155, v155
v_fma_f32 v84, v84, v42, v38
v_fma_f32 v85, v85, v42, v38
v_fma_f32 v86, v86, v42, v38
v_fma_f32 v87, v87, v42, v38
v_mul_f32 v84, v84, v152
v_mul_f32 v85, v85, v153
v_mul_f32 v86, v86, v154
v_mul_f32 v87, v87, v155
v_exp_f32 v84, v84
v_exp_f32 v85, v85
v_exp_f32 v86, v86
v_exp_f32 v87, v87
v_mul_f32 v216, v152, v216
v_mul_f32 v217, v153, v217
v_mul_f32 v218, v154, v218
v_mul_f32 v219, v155, v219
v_fma_f32 v84, v84, v46, v46
v_fma_f32 v85, v85, v46, v46
v_fma_f32 v86, v86, v46, v46
v_fma_f32 v87, v87, v46, v46
v_rcp_f32 v84, v84
v_rcp_f32 v85, v85
v_rcp_f32 v86, v86
v_rcp_f32 v87, v87
v_mul_f32 v216, v216, v84
v_mul_f32 v217, v217, v85
v_mul_f32 v218, v218, v86
v_mul_f32 v219, v219, v87
v_cvt_pk_bf16_f32 v106, v216, v217
v_cvt_pk_bf16_f32 v107, v218, v219
buffer_store_dwordx4 v[104:107], v27, s[24:27], 0 offen offset:512 sc1
v_fma_f32 v140, -v35, v48, v140
v_fma_f32 v141, -v35, v49, v141
v_fma_f32 v142, -v35, v50, v142
v_fma_f32 v143, -v35, v51, v143
v_fma_f32 v204, -v35, v64, v204
v_fma_f32 v205, -v35, v65, v205
s_barrier
v_fma_f32 v206, -v35, v66, v206
v_fma_f32 v207, -v35, v67, v207
v_mul_f32 v80, v140, v140
v_mul_f32 v81, v141, v141
v_mul_f32 v82, v142, v142
v_mul_f32 v83, v143, v143
v_fma_f32 v80, v80, v43, v39
v_fma_f32 v81, v81, v43, v39
v_fma_f32 v82, v82, v43, v39
v_fma_f32 v83, v83, v43, v39
v_mul_f32 v80, v80, v140
v_mul_f32 v81, v81, v141
v_mul_f32 v82, v82, v142
v_mul_f32 v83, v83, v143
v_exp_f32 v80, v80
v_exp_f32 v81, v81
v_exp_f32 v82, v82
v_exp_f32 v83, v83
v_mul_f32 v204, v140, v204
v_mul_f32 v205, v141, v205
v_mul_f32 v206, v142, v206
v_mul_f32 v207, v143, v207
v_fma_f32 v80, v80, v47, v47
v_fma_f32 v81, v81, v47, v47
v_fma_f32 v82, v82, v47, v47
v_fma_f32 v83, v83, v47, v47
v_rcp_f32 v80, v80
v_rcp_f32 v81, v81
v_rcp_f32 v82, v82
v_rcp_f32 v83, v83
v_mul_f32 v204, v204, v80
v_mul_f32 v205, v205, v81
v_mul_f32 v206, v206, v82
v_mul_f32 v207, v207, v83
v_cvt_pk_bf16_f32 v108, v204, v205
v_cvt_pk_bf16_f32 v109, v206, v207
v_fma_f32 v156, -v35, v52, v156
v_fma_f32 v157, -v35, v53, v157
v_fma_f32 v158, -v35, v54, v158
v_fma_f32 v159, -v35, v55, v159
v_fma_f32 v220, -v35, v68, v220
v_fma_f32 v221, -v35, v69, v221
v_fma_f32 v222, -v35, v70, v222
v_fma_f32 v223, -v35, v71, v223
v_mul_f32 v84, v156, v156
v_mul_f32 v85, v157, v157
v_mul_f32 v86, v158, v158
v_mul_f32 v87, v159, v159
v_fma_f32 v84, v84, v43, v39
v_fma_f32 v85, v85, v43, v39
v_fma_f32 v86, v86, v43, v39
v_fma_f32 v87, v87, v43, v39
s_barrier
s_getpc_b64 s[78:79]
Lpc_126:
s_sub_u32 s78, s78, Lpc_126-sequential_preLN__sliding_local_dilated__glu_gated_geglu__prompt_kernel
s_subb_u32 s79, s79, 0
s_lshr_b32 s43, s2, 3
s_mul_i32 s43, s43, 3840
v_min_u32 v19, 29, v1
v_lshl_add_u32 v19, v19, 7, s43
v_min_u32 v19, Ldone_1-sequential_preLN__sliding_local_dilated__glu_gated_geglu__prompt_kernel, v19
global_load_dword v30, v19, s[78:79]
v_mul_f32 v84, v84, v156
v_mul_f32 v85, v85, v157
v_mul_f32 v86, v86, v158
v_mul_f32 v87, v87, v159
v_exp_f32 v84, v84
v_exp_f32 v85, v85
v_exp_f32 v86, v86
v_exp_f32 v87, v87
v_mul_f32 v220, v156, v220
v_mul_f32 v221, v157, v221
v_mul_f32 v222, v158, v222
v_mul_f32 v223, v159, v223
v_fma_f32 v84, v84, v47, v47
v_fma_f32 v85, v85, v47, v47
v_fma_f32 v86, v86, v47, v47
v_fma_f32 v87, v87, v47, v47
v_rcp_f32 v84, v84
v_rcp_f32 v85, v85
v_rcp_f32 v86, v86
v_rcp_f32 v87, v87
v_mul_f32 v220, v220, v84
v_mul_f32 v221, v221, v85
v_mul_f32 v222, v222, v86
v_mul_f32 v223, v223, v87
v_cvt_pk_bf16_f32 v110, v220, v221
v_cvt_pk_bf16_f32 v111, v222, v223
buffer_store_dwordx4 v[108:111], v27, s[24:27], 0 offen offset:768 sc1
v_fma_f32 v160, -v32, v56, v160
v_fma_f32 v161, -v32, v57, v161
v_fma_f32 v162, -v32, v58, v162
v_fma_f32 v163, -v32, v59, v163
v_fma_f32 v224, -v32, v72, v224
v_fma_f32 v225, -v32, v73, v225
v_fma_f32 v226, -v32, v74, v226
v_fma_f32 v227, -v32, v75, v227
v_mul_f32 v80, v160, v160
v_mul_f32 v81, v161, v161
v_mul_f32 v82, v162, v162
v_mul_f32 v83, v163, v163
v_fma_f32 v80, v80, v40, v36
v_fma_f32 v81, v81, v40, v36
v_fma_f32 v82, v82, v40, v36
v_fma_f32 v83, v83, v40, v36
v_mul_f32 v80, v80, v160
v_mul_f32 v81, v81, v161
v_mul_f32 v82, v82, v162
v_mul_f32 v83, v83, v163
v_exp_f32 v80, v80
v_exp_f32 v81, v81
v_exp_f32 v82, v82
v_exp_f32 v83, v83
v_mul_f32 v224, v160, v224
v_mul_f32 v225, v161, v225
s_barrier
v_mul_f32 v226, v162, v226
v_mul_f32 v227, v163, v227
v_fma_f32 v80, v80, v44, v44
v_fma_f32 v81, v81, v44, v44
v_fma_f32 v82, v82, v44, v44
v_fma_f32 v83, v83, v44, v44
v_rcp_f32 v80, v80
v_rcp_f32 v81, v81
v_rcp_f32 v82, v82
v_rcp_f32 v83, v83
v_mul_f32 v224, v224, v80
v_mul_f32 v225, v225, v81
v_mul_f32 v226, v226, v82
v_mul_f32 v227, v227, v83
v_cvt_pk_bf16_f32 v96, v224, v225
v_cvt_pk_bf16_f32 v97, v226, v227
v_fma_f32 v176, -v32, v60, v176
v_fma_f32 v177, -v32, v61, v177
v_fma_f32 v178, -v32, v62, v178
v_fma_f32 v179, -v32, v63, v179
v_fma_f32 v240, -v32, v76, v240
v_fma_f32 v241, -v32, v77, v241
v_fma_f32 v242, -v32, v78, v242
v_fma_f32 v243, -v32, v79, v243
v_mul_f32 v84, v176, v176
v_mul_f32 v85, v177, v177
v_mul_f32 v86, v178, v178
v_mul_f32 v87, v179, v179
v_fma_f32 v84, v84, v40, v36
v_fma_f32 v85, v85, v40, v36
v_fma_f32 v86, v86, v40, v36
v_fma_f32 v87, v87, v40, v36
v_mul_f32 v84, v84, v176
v_mul_f32 v85, v85, v177
v_mul_f32 v86, v86, v178
v_mul_f32 v87, v87, v179
v_exp_f32 v84, v84
v_exp_f32 v85, v85
v_exp_f32 v86, v86
v_exp_f32 v87, v87
v_mul_f32 v240, v176, v240
v_mul_f32 v241, v177, v241
v_mul_f32 v242, v178, v242
v_mul_f32 v243, v179, v243
v_fma_f32 v84, v84, v44, v44
v_fma_f32 v85, v85, v44, v44
v_fma_f32 v86, v86, v44, v44
v_fma_f32 v87, v87, v44, v44
v_rcp_f32 v84, v84
v_rcp_f32 v85, v85
v_rcp_f32 v86, v86
v_rcp_f32 v87, v87
v_lshlrev_b32 v19, 11, v18
v_lshl_add_u32 v19, v17, 4, v19
s_lshl_b32 s43, s46, 10
s_lshl_b32 s44, s47, 13
v_add3_u32 v208, v19, s43, 0
v_add_u32 v208, s44, v208
buffer_load_dwordx4 v[192:195], v208, s[20:23], 0 offen offset:0 sc1
buffer_load_dwordx4 v[196:199], v208, s[20:23], 0 offen offset:256 sc1
buffer_load_dwordx4 v[200:203], v208, s[20:23], 0 offen offset:512 sc1
buffer_load_dwordx4 v[204:207], v208, s[20:23], 0 offen offset:768 sc1
s_waitcnt vmcnt(4)
s_barrier
s_add_u32 s43, s34, 32
s_lshl_b32 s43, s43, 7
v_mov_b32 v21, s43
v_mov_b32 v22, 1
s_mov_b64 exec, 1
buffer_atomic_add v22, v21, s[56:59], 0 offen sc1
s_mov_b64 exec, -1
v_mul_f32 v240, v240, v84
v_mul_f32 v241, v241, v85
v_mul_f32 v242, v242, v86
v_mul_f32 v243, v243, v87
v_cvt_pk_bf16_f32 v98, v240, v241
v_cvt_pk_bf16_f32 v99, v242, v243
buffer_store_dwordx4 v[96:99], v27, s[24:27], s53 offen offset:0 sc1
v_fma_f32 v164, -v33, v56, v164
v_fma_f32 v165, -v33, v57, v165
v_fma_f32 v166, -v33, v58, v166
v_fma_f32 v167, -v33, v59, v167
v_fma_f32 v228, -v33, v72, v228
v_fma_f32 v229, -v33, v73, v229
v_fma_f32 v230, -v33, v74, v230
v_fma_f32 v231, -v33, v75, v231
v_mul_f32 v80, v164, v164
v_mul_f32 v81, v165, v165
v_mul_f32 v82, v166, v166
v_mul_f32 v83, v167, v167
v_fma_f32 v80, v80, v41, v37
v_fma_f32 v81, v81, v41, v37
v_fma_f32 v82, v82, v41, v37
v_fma_f32 v83, v83, v41, v37
v_mul_f32 v80, v80, v164
v_mul_f32 v81, v81, v165
v_mul_f32 v82, v82, v166
v_mul_f32 v83, v83, v167
v_exp_f32 v80, v80
v_exp_f32 v81, v81
v_exp_f32 v82, v82
v_exp_f32 v83, v83
v_mul_f32 v228, v164, v228
v_mul_f32 v229, v165, v229
v_mul_f32 v230, v166, v230
v_mul_f32 v231, v167, v231
v_fma_f32 v80, v80, v45, v45
v_fma_f32 v81, v81, v45, v45
v_fma_f32 v82, v82, v45, v45
v_fma_f32 v83, v83, v45, v45
v_rcp_f32 v80, v80
v_rcp_f32 v81, v81
v_rcp_f32 v82, v82
v_rcp_f32 v83, v83
v_mul_f32 v228, v228, v80
v_mul_f32 v229, v229, v81
v_mul_f32 v230, v230, v82
v_mul_f32 v231, v231, v83
v_cvt_pk_bf16_f32 v100, v228, v229
v_cvt_pk_bf16_f32 v101, v230, v231
v_fma_f32 v180, -v33, v60, v180
v_fma_f32 v181, -v33, v61, v181
v_fma_f32 v182, -v33, v62, v182
s_barrier
s_mov_b32 s80, s60
s_mov_b32 s81, s61
s_mov_b32 s82, 7340032
s_mov_b32 s83, 0x20000
v_and_b32 v29, 31, v1
v_lshlrev_b32 v29, 11, v29
s_and_b32 s43, s35, 8
s_or_b32 s43, s43, 3
s_lshl_b32 s43, s43, 7
v_add_u32 v29, s43, v29
s_lshr_b32 s44, s2, 3
s_lshl_b32 s44, s44, 17
s_add_u32 s43, s44, 0
buffer_load_dword v30, v29, s[80:83], s43 offen
v_fma_f32 v183, -v33, v63, v183
v_fma_f32 v244, -v33, v76, v244
v_fma_f32 v245, -v33, v77, v245
v_fma_f32 v246, -v33, v78, v246
v_fma_f32 v247, -v33, v79, v247
v_mul_f32 v84, v180, v180
v_mul_f32 v85, v181, v181
v_mul_f32 v86, v182, v182
v_mul_f32 v87, v183, v183
v_fma_f32 v84, v84, v41, v37
v_fma_f32 v85, v85, v41, v37
v_fma_f32 v86, v86, v41, v37
v_fma_f32 v87, v87, v41, v37
v_mul_f32 v84, v84, v180
v_mul_f32 v85, v85, v181
v_mul_f32 v86, v86, v182
v_mul_f32 v87, v87, v183
v_exp_f32 v84, v84
v_exp_f32 v85, v85
v_exp_f32 v86, v86
v_exp_f32 v87, v87
v_mul_f32 v244, v180, v244
v_mul_f32 v245, v181, v245
v_mul_f32 v246, v182, v246
v_mul_f32 v247, v183, v247
v_fma_f32 v84, v84, v45, v45
v_fma_f32 v85, v85, v45, v45
v_fma_f32 v86, v86, v45, v45
v_fma_f32 v87, v87, v45, v45
v_rcp_f32 v84, v84
v_rcp_f32 v85, v85
v_rcp_f32 v86, v86
v_rcp_f32 v87, v87
v_mul_f32 v244, v244, v84
v_mul_f32 v245, v245, v85
v_mul_f32 v246, v246, v86
v_mul_f32 v247, v247, v87
v_cvt_pk_bf16_f32 v102, v244, v245
v_cvt_pk_bf16_f32 v103, v246, v247
buffer_store_dwordx4 v[100:103], v27, s[24:27], s53 offen offset:256 sc1
v_fma_f32 v168, -v34, v56, v168
v_fma_f32 v169, -v34, v57, v169
v_fma_f32 v170, -v34, v58, v170
v_fma_f32 v171, -v34, v59, v171
v_fma_f32 v232, -v34, v72, v232
v_fma_f32 v233, -v34, v73, v233
v_fma_f32 v234, -v34, v74, v234
v_fma_f32 v235, -v34, v75, v235
v_mul_f32 v80, v168, v168
v_mul_f32 v81, v169, v169
v_mul_f32 v82, v170, v170
v_mul_f32 v83, v171, v171
v_fma_f32 v80, v80, v42, v38
s_waitcnt vmcnt(2)
s_barrier
v_fma_f32 v81, v81, v42, v38
v_fma_f32 v82, v82, v42, v38
v_fma_f32 v83, v83, v42, v38
v_mul_f32 v80, v80, v168
v_mul_f32 v81, v81, v169
v_mul_f32 v82, v82, v170
v_mul_f32 v83, v83, v171
v_exp_f32 v80, v80
v_exp_f32 v81, v81
v_exp_f32 v82, v82
v_exp_f32 v83, v83
v_mul_f32 v232, v168, v232
v_mul_f32 v233, v169, v233
v_mul_f32 v234, v170, v234
v_mul_f32 v235, v171, v235
v_fma_f32 v80, v80, v46, v46
v_fma_f32 v81, v81, v46, v46
v_fma_f32 v82, v82, v46, v46
v_fma_f32 v83, v83, v46, v46
v_rcp_f32 v80, v80
v_rcp_f32 v81, v81
v_rcp_f32 v82, v82
v_rcp_f32 v83, v83
v_mul_f32 v232, v232, v80
v_mul_f32 v233, v233, v81
v_mul_f32 v234, v234, v82
v_mul_f32 v235, v235, v83
v_cvt_pk_bf16_f32 v104, v232, v233
v_cvt_pk_bf16_f32 v105, v234, v235
v_fma_f32 v184, -v34, v60, v184
v_fma_f32 v185, -v34, v61, v185
v_fma_f32 v186, -v34, v62, v186
v_fma_f32 v187, -v34, v63, v187
v_fma_f32 v248, -v34, v76, v248
v_fma_f32 v249, -v34, v77, v249
v_fma_f32 v250, -v34, v78, v250
v_fma_f32 v251, -v34, v79, v251
v_mul_f32 v84, v184, v184
v_mul_f32 v85, v185, v185
v_mul_f32 v86, v186, v186
v_mul_f32 v87, v187, v187
v_fma_f32 v84, v84, v42, v38
v_fma_f32 v85, v85, v42, v38
v_fma_f32 v86, v86, v42, v38
v_fma_f32 v87, v87, v42, v38
v_mul_f32 v84, v84, v184
v_mul_f32 v85, v85, v185
v_mul_f32 v86, v86, v186
v_mul_f32 v87, v87, v187
v_exp_f32 v84, v84
v_exp_f32 v85, v85
v_exp_f32 v86, v86
s_barrier
s_add_u32 s43, s34, 32
s_lshl_b32 s43, s43, 7
v_mov_b32 v21, s43
v_mov_b32 v23, 16
buffer_load_dword v22, v21, s[56:59], 0 offen sc1
v_exp_f32 v87, v87
v_mul_f32 v248, v184, v248
v_mul_f32 v249, v185, v249
v_mul_f32 v250, v186, v250
v_mul_f32 v251, v187, v251
v_fma_f32 v84, v84, v46, v46
v_fma_f32 v85, v85, v46, v46
v_fma_f32 v86, v86, v46, v46
v_fma_f32 v87, v87, v46, v46
v_rcp_f32 v84, v84
v_rcp_f32 v85, v85
v_rcp_f32 v86, v86
v_rcp_f32 v87, v87
v_mul_f32 v248, v248, v84
v_mul_f32 v249, v249, v85
v_mul_f32 v250, v250, v86
v_mul_f32 v251, v251, v87
v_cvt_pk_bf16_f32 v106, v248, v249
v_cvt_pk_bf16_f32 v107, v250, v251
buffer_store_dwordx4 v[104:107], v27, s[24:27], s53 offen offset:512 sc1
v_fma_f32 v172, -v35, v56, v172
v_fma_f32 v173, -v35, v57, v173
v_fma_f32 v174, -v35, v58, v174
v_fma_f32 v175, -v35, v59, v175
v_fma_f32 v236, -v35, v72, v236
v_fma_f32 v237, -v35, v73, v237
v_fma_f32 v238, -v35, v74, v238
v_fma_f32 v239, -v35, v75, v239
v_mul_f32 v80, v172, v172
v_mul_f32 v81, v173, v173
v_mul_f32 v82, v174, v174
v_mul_f32 v83, v175, v175
v_fma_f32 v80, v80, v43, v39
v_fma_f32 v81, v81, v43, v39
v_fma_f32 v82, v82, v43, v39
v_fma_f32 v83, v83, v43, v39
v_mul_f32 v80, v80, v172
v_mul_f32 v81, v81, v173
v_mul_f32 v82, v82, v174
v_mul_f32 v83, v83, v175
v_exp_f32 v80, v80
v_exp_f32 v81, v81
v_exp_f32 v82, v82
v_exp_f32 v83, v83
v_mul_f32 v236, v172, v236
v_mul_f32 v237, v173, v237
v_mul_f32 v238, v174, v238
v_mul_f32 v239, v175, v239
v_fma_f32 v80, v80, v47, v47
v_fma_f32 v81, v81, v47, v47
v_fma_f32 v82, v82, v47, v47
v_fma_f32 v83, v83, v47, v47
s_barrier
v_rcp_f32 v80, v80
v_rcp_f32 v81, v81
v_rcp_f32 v82, v82
v_rcp_f32 v83, v83
v_mul_f32 v236, v236, v80
v_mul_f32 v237, v237, v81
v_mul_f32 v238, v238, v82
v_mul_f32 v239, v239, v83
v_cvt_pk_bf16_f32 v108, v236, v237
v_cvt_pk_bf16_f32 v109, v238, v239
v_fma_f32 v188, -v35, v60, v188
v_fma_f32 v189, -v35, v61, v189
v_fma_f32 v190, -v35, v62, v190
v_fma_f32 v191, -v35, v63, v191
v_fma_f32 v252, -v35, v76, v252
v_fma_f32 v253, -v35, v77, v253
v_fma_f32 v254, -v35, v78, v254
v_fma_f32 v255, -v35, v79, v255
v_mul_f32 v84, v188, v188
v_mul_f32 v85, v189, v189
v_mul_f32 v86, v190, v190
v_mul_f32 v87, v191, v191
v_fma_f32 v84, v84, v43, v39
v_fma_f32 v85, v85, v43, v39
v_fma_f32 v86, v86, v43, v39
v_fma_f32 v87, v87, v43, v39
v_mul_f32 v84, v84, v188
v_mul_f32 v85, v85, v189
v_mul_f32 v86, v86, v190
v_mul_f32 v87, v87, v191
v_exp_f32 v84, v84
v_exp_f32 v85, v85
v_exp_f32 v86, v86
v_exp_f32 v87, v87
v_mul_f32 v252, v188, v252
v_mul_f32 v253, v189, v253
v_mul_f32 v254, v190, v254
v_mul_f32 v255, v191, v255
v_fma_f32 v84, v84, v47, v47
v_fma_f32 v85, v85, v47, v47
v_fma_f32 v86, v86, v47, v47
v_fma_f32 v87, v87, v47, v47
v_rcp_f32 v84, v84
v_rcp_f32 v85, v85
v_rcp_f32 v86, v86
v_rcp_f32 v87, v87
v_mul_f32 v252, v252, v84
v_mul_f32 v253, v253, v85
v_mul_f32 v254, v254, v86
v_mul_f32 v255, v255, v87
v_cvt_pk_bf16_f32 v110, v252, v253
v_cvt_pk_bf16_f32 v111, v254, v255
buffer_store_dwordx4 v[108:111], v27, s[24:27], s53 offen offset:768 sc1
s_mov_b32 s41, 0x10000
s_waitcnt vmcnt(2)
s_branch Lpf_129
Lpoll_127:
s_waitcnt vmcnt(0)
Lpf_129:
v_cmp_ne_u32 vcc, v23, v22
s_nop 4
s_cbranch_vccz Lpok_128
buffer_load_dword v22, v21, s[56:59], 0 offen sc1
s_sub_u32 s41, s41, 1
s_cmp_lg_u32 s41, 0
s_cbranch_scc1 Lpoll_127
s_waitcnt vmcnt(0)
Lpok_128:
s_barrier
v_lshlrev_b32 v128, 16, v192
v_and_b32 v129, 0xffff0000, v192
v_lshlrev_b32 v130, 16, v193
v_and_b32 v131, 0xffff0000, v193
v_lshlrev_b32 v132, 16, v194
v_and_b32 v133, 0xffff0000, v194
v_lshlrev_b32 v134, 16, v195
v_and_b32 v135, 0xffff0000, v195
v_lshlrev_b32 v136, 16, v196
v_and_b32 v137, 0xffff0000, v196
v_lshlrev_b32 v138, 16, v197
v_and_b32 v139, 0xffff0000, v197
v_lshlrev_b32 v140, 16, v198
v_and_b32 v141, 0xffff0000, v198
v_lshlrev_b32 v142, 16, v199
v_and_b32 v143, 0xffff0000, v199
v_lshlrev_b32 v144, 16, v200
v_and_b32 v145, 0xffff0000, v200
v_lshlrev_b32 v146, 16, v201
v_and_b32 v147, 0xffff0000, v201
v_lshlrev_b32 v148, 16, v202
v_and_b32 v149, 0xffff0000, v202
v_lshlrev_b32 v150, 16, v203
v_and_b32 v151, 0xffff0000, v203
v_lshlrev_b32 v152, 16, v204
v_and_b32 v153, 0xffff0000, v204
v_lshlrev_b32 v154, 16, v205
v_and_b32 v155, 0xffff0000, v205
v_lshlrev_b32 v156, 16, v206
v_and_b32 v157, 0xffff0000, v206
v_lshlrev_b32 v158, 16, v207
v_and_b32 v159, 0xffff0000, v207
s_waitcnt vmcnt(0)
s_barrier
s_add_u32 s43, s34, 48
s_lshl_b32 s43, s43, 7
v_mov_b32 v22, s43
v_mov_b32 v23, 1
s_mov_b64 exec, 1
buffer_atomic_add v23, v22, s[56:59], 0 offen sc1
s_mov_b64 exec, -1
s_branch Lw_130
Lr_131:
v_mov_b32 v192, 0
v_mov_b32 v193, 0
v_mov_b32 v194, 0
v_mov_b32 v195, 0
v_mov_b32 v196, 0
v_mov_b32 v197, 0
v_mov_b32 v198, 0
v_mov_b32 v199, 0
v_mov_b32 v200, 0
v_mov_b32 v201, 0
v_mov_b32 v202, 0
v_mov_b32 v203, 0
v_mov_b32 v204, 0
v_mov_b32 v205, 0
v_mov_b32 v206, 0
v_mov_b32 v207, 0
v_mov_b32 v208, 0
v_mov_b32 v209, 0
v_mov_b32 v210, 0
v_mov_b32 v211, 0
v_mov_b32 v212, 0
v_mov_b32 v213, 0
v_mov_b32 v214, 0
v_mov_b32 v215, 0
v_mov_b32 v216, 0
v_mov_b32 v217, 0
v_mov_b32 v218, 0
v_mov_b32 v219, 0
v_mov_b32 v220, 0
v_mov_b32 v221, 0
v_mov_b32 v222, 0
v_mov_b32 v223, 0
s_barrier
.p2align 3
LK4_125:
s_setprio 1
ds_read_b64_tr_b16 v[64:65], v7 offset:0
ds_read_b128 v[32:35], v3 offset:0
ds_read_b64_tr_b16 v[66:67], v7 offset:2048
ds_read_b128 v[36:39], v3 offset:256
ds_read_b64_tr_b16 v[68:69], v8 offset:0
ds_read_b128 v[40:43], v3 offset:512
ds_read_b64_tr_b16 v[70:71], v8 offset:2048
ds_read_b128 v[44:47], v3 offset:768
ds_read_b64_tr_b16 v[72:73], v7 offset:4096
ds_read_b128 v[48:51], v3 offset:8192
ds_read_b64_tr_b16 v[74:75], v7 offset:6144
ds_read_b128 v[52:55], v3 offset:8448
ds_read_b64_tr_b16 v[76:77], v8 offset:4096
ds_read_b128 v[56:59], v3 offset:8704
ds_read_b64_tr_b16 v[78:79], v8 offset:6144
ds_read_b128 v[60:63], v3 offset:8960
s_waitcnt vmcnt(0) lgkmcnt(0)
s_barrier
v_mfma_f32_16x16x32_bf16 v[128:131], v[64:67], v[32:35], v[128:131]
ds_read_b64_tr_b16 v[160:161], v7 offset:32768
v_mfma_f32_16x16x32_bf16 v[132:135], v[68:71], v[32:35], v[132:135]
ds_read_b128 v[96:99], v3 offset:32768
v_mfma_f32_16x16x32_bf16 v[136:139], v[64:67], v[36:39], v[136:139]
ds_read_b64_tr_b16 v[162:163], v7 offset:34816
v_mfma_f32_16x16x32_bf16 v[140:143], v[68:71], v[36:39], v[140:143]
ds_read_b128 v[100:103], v3 offset:33024
v_mfma_f32_16x16x32_bf16 v[144:147], v[64:67], v[40:43], v[144:147]
ds_read_b64_tr_b16 v[164:165], v8 offset:32768
v_mfma_f32_16x16x32_bf16 v[148:151], v[68:71], v[40:43], v[148:151]
ds_read_b128 v[104:107], v3 offset:33280
v_mfma_f32_16x16x32_bf16 v[152:155], v[64:67], v[44:47], v[152:155]
ds_read_b64_tr_b16 v[166:167], v8 offset:34816
v_mfma_f32_16x16x32_bf16 v[156:159], v[68:71], v[44:47], v[156:159]
ds_read_b128 v[108:111], v3 offset:33536
v_mfma_f32_16x16x32_bf16 v[128:131], v[72:75], v[48:51], v[128:131]
ds_read_b64_tr_b16 v[168:169], v7 offset:36864
v_mfma_f32_16x16x32_bf16 v[132:135], v[76:79], v[48:51], v[132:135]
ds_read_b128 v[112:115], v3 offset:40960
v_mfma_f32_16x16x32_bf16 v[136:139], v[72:75], v[52:55], v[136:139]
ds_read_b64_tr_b16 v[170:171], v7 offset:38912
v_mfma_f32_16x16x32_bf16 v[140:143], v[76:79], v[52:55], v[140:143]
ds_read_b128 v[116:119], v3 offset:41216
v_mfma_f32_16x16x32_bf16 v[144:147], v[72:75], v[56:59], v[144:147]
ds_read_b64_tr_b16 v[172:173], v8 offset:36864
v_mfma_f32_16x16x32_bf16 v[148:151], v[76:79], v[56:59], v[148:151]
ds_read_b128 v[120:123], v3 offset:41472
v_mfma_f32_16x16x32_bf16 v[152:155], v[72:75], v[60:63], v[152:155]
ds_read_b64_tr_b16 v[174:175], v8 offset:38912
v_mfma_f32_16x16x32_bf16 v[156:159], v[76:79], v[60:63], v[156:159]
ds_read_b128 v[124:127], v3 offset:41728
s_waitcnt lgkmcnt(0)
s_barrier
v_mfma_f32_16x16x32_bf16 v[128:131], v[160:163], v[96:99], v[128:131]
ds_read_b64_tr_b16 v[64:65], v5 offset:0
v_mfma_f32_16x16x32_bf16 v[132:135], v[164:167], v[96:99], v[132:135]
ds_read_b128 v[32:35], v2 offset:0
v_mfma_f32_16x16x32_bf16 v[136:139], v[160:163], v[100:103], v[136:139]
ds_read_b64_tr_b16 v[66:67], v5 offset:2048
v_mfma_f32_16x16x32_bf16 v[140:143], v[164:167], v[100:103], v[140:143]
ds_read_b128 v[36:39], v2 offset:256
v_mfma_f32_16x16x32_bf16 v[144:147], v[160:163], v[104:107], v[144:147]
ds_read_b64_tr_b16 v[68:69], v6 offset:0
v_mfma_f32_16x16x32_bf16 v[148:151], v[164:167], v[104:107], v[148:151]
ds_read_b128 v[40:43], v2 offset:512
v_mfma_f32_16x16x32_bf16 v[152:155], v[160:163], v[108:111], v[152:155]
ds_read_b64_tr_b16 v[70:71], v6 offset:2048
v_mfma_f32_16x16x32_bf16 v[156:159], v[164:167], v[108:111], v[156:159]
ds_read_b128 v[44:47], v2 offset:768
v_mfma_f32_16x16x32_bf16 v[128:131], v[168:171], v[112:115], v[128:131]
ds_read_b64_tr_b16 v[72:73], v5 offset:4096
v_mfma_f32_16x16x32_bf16 v[132:135], v[172:175], v[112:115], v[132:135]
ds_read_b128 v[48:51], v2 offset:8192
v_mfma_f32_16x16x32_bf16 v[136:139], v[168:171], v[116:119], v[136:139]
ds_read_b64_tr_b16 v[74:75], v5 offset:6144
v_mfma_f32_16x16x32_bf16 v[140:143], v[172:175], v[116:119], v[140:143]
ds_read_b128 v[52:55], v2 offset:8448
v_mfma_f32_16x16x32_bf16 v[144:147], v[168:171], v[120:123], v[144:147]
ds_read_b64_tr_b16 v[76:77], v6 offset:4096
v_mfma_f32_16x16x32_bf16 v[148:151], v[172:175], v[120:123], v[148:151]
ds_read_b128 v[56:59], v2 offset:8704
v_mfma_f32_16x16x32_bf16 v[152:155], v[168:171], v[124:127], v[152:155]
ds_read_b64_tr_b16 v[78:79], v6 offset:6144
v_mfma_f32_16x16x32_bf16 v[156:159], v[172:175], v[124:127], v[156:159]
ds_read_b128 v[60:63], v2 offset:8960
s_waitcnt lgkmcnt(0)
s_barrier
v_mfma_f32_16x16x32_bf16 v[128:131], v[64:67], v[32:35], v[128:131]
ds_read_b64_tr_b16 v[160:161], v5 offset:32768
v_mfma_f32_16x16x32_bf16 v[132:135], v[68:71], v[32:35], v[132:135]
ds_read_b128 v[96:99], v2 offset:32768
v_mfma_f32_16x16x32_bf16 v[136:139], v[64:67], v[36:39], v[136:139]
ds_read_b64_tr_b16 v[162:163], v5 offset:34816
v_mfma_f32_16x16x32_bf16 v[140:143], v[68:71], v[36:39], v[140:143]
ds_read_b128 v[100:103], v2 offset:33024
v_mfma_f32_16x16x32_bf16 v[144:147], v[64:67], v[40:43], v[144:147]
ds_read_b64_tr_b16 v[164:165], v6 offset:32768
v_mfma_f32_16x16x32_bf16 v[148:151], v[68:71], v[40:43], v[148:151]
ds_read_b128 v[104:107], v2 offset:33280
v_mfma_f32_16x16x32_bf16 v[152:155], v[64:67], v[44:47], v[152:155]
ds_read_b64_tr_b16 v[166:167], v6 offset:34816
v_mfma_f32_16x16x32_bf16 v[156:159], v[68:71], v[44:47], v[156:159]
ds_read_b128 v[108:111], v2 offset:33536
v_mfma_f32_16x16x32_bf16 v[128:131], v[72:75], v[48:51], v[128:131]
ds_read_b64_tr_b16 v[168:169], v5 offset:36864
v_mfma_f32_16x16x32_bf16 v[132:135], v[76:79], v[48:51], v[132:135]
ds_read_b128 v[112:115], v2 offset:40960
v_mfma_f32_16x16x32_bf16 v[136:139], v[72:75], v[52:55], v[136:139]
ds_read_b64_tr_b16 v[170:171], v5 offset:38912
v_mfma_f32_16x16x32_bf16 v[140:143], v[76:79], v[52:55], v[140:143]
ds_read_b128 v[116:119], v2 offset:41216
v_mfma_f32_16x16x32_bf16 v[144:147], v[72:75], v[56:59], v[144:147]
ds_read_b64_tr_b16 v[172:173], v6 offset:36864
v_mfma_f32_16x16x32_bf16 v[148:151], v[76:79], v[56:59], v[148:151]
ds_read_b128 v[120:123], v2 offset:41472
v_mfma_f32_16x16x32_bf16 v[152:155], v[72:75], v[60:63], v[152:155]
ds_read_b64_tr_b16 v[174:175], v6 offset:38912
v_mfma_f32_16x16x32_bf16 v[156:159], v[76:79], v[60:63], v[156:159]
ds_read_b128 v[124:127], v2 offset:41728
s_waitcnt lgkmcnt(0)
s_barrier
v_mfma_f32_16x16x32_bf16 v[128:131], v[160:163], v[96:99], v[128:131]
ds_read_b64_tr_b16 v[64:65], v7 offset:0
v_mfma_f32_16x16x32_bf16 v[132:135], v[164:167], v[96:99], v[132:135]
ds_read_b128 v[32:35], v3 offset:0
v_mfma_f32_16x16x32_bf16 v[136:139], v[160:163], v[100:103], v[136:139]
ds_read_b64_tr_b16 v[66:67], v7 offset:2048
v_mfma_f32_16x16x32_bf16 v[140:143], v[164:167], v[100:103], v[140:143]
ds_read_b128 v[36:39], v3 offset:256
v_mfma_f32_16x16x32_bf16 v[144:147], v[160:163], v[104:107], v[144:147]
ds_read_b64_tr_b16 v[68:69], v8 offset:0
v_mfma_f32_16x16x32_bf16 v[148:151], v[164:167], v[104:107], v[148:151]
ds_read_b128 v[40:43], v3 offset:512
v_mfma_f32_16x16x32_bf16 v[152:155], v[160:163], v[108:111], v[152:155]
ds_read_b64_tr_b16 v[70:71], v8 offset:2048
v_mfma_f32_16x16x32_bf16 v[156:159], v[164:167], v[108:111], v[156:159]
ds_read_b128 v[44:47], v3 offset:768
v_mfma_f32_16x16x32_bf16 v[128:131], v[168:171], v[112:115], v[128:131]
ds_read_b64_tr_b16 v[80:81], v7 offset:8192
v_mfma_f32_16x16x32_bf16 v[132:135], v[172:175], v[112:115], v[132:135]
ds_read_b64_tr_b16 v[82:83], v7 offset:10240
v_mfma_f32_16x16x32_bf16 v[136:139], v[168:171], v[116:119], v[136:139]
ds_read_b64_tr_b16 v[84:85], v8 offset:8192
v_mfma_f32_16x16x32_bf16 v[140:143], v[172:175], v[116:119], v[140:143]
ds_read_b64_tr_b16 v[86:87], v8 offset:10240
v_mfma_f32_16x16x32_bf16 v[144:147], v[168:171], v[120:123], v[144:147]
ds_read_b64_tr_b16 v[72:73], v7 offset:4096
v_mfma_f32_16x16x32_bf16 v[148:151], v[172:175], v[120:123], v[148:151]
ds_read_b128 v[48:51], v3 offset:8192
v_mfma_f32_16x16x32_bf16 v[152:155], v[168:171], v[124:127], v[152:155]
ds_read_b64_tr_b16 v[74:75], v7 offset:6144
v_mfma_f32_16x16x32_bf16 v[156:159], v[172:175], v[124:127], v[156:159]
ds_read_b128 v[52:55], v3 offset:8448
ds_read_b64_tr_b16 v[76:77], v8 offset:4096
ds_read_b128 v[56:59], v3 offset:8704
ds_read_b64_tr_b16 v[78:79], v8 offset:6144
ds_read_b128 v[60:63], v3 offset:8960
ds_read_b64_tr_b16 v[88:89], v7 offset:12288
ds_read_b64_tr_b16 v[90:91], v7 offset:14336
ds_read_b64_tr_b16 v[92:93], v8 offset:12288
ds_read_b64_tr_b16 v[94:95], v8 offset:14336
s_mov_b32 s41, 4
.p2align 3
Lk4_132:
s_waitcnt lgkmcnt(0)
s_barrier
v_mfma_f32_16x16x32_bf16 v[128:131], v[64:67], v[32:35], v[128:131]
ds_read_b64_tr_b16 v[160:161], v7 offset:32768
v_mfma_f32_16x16x32_bf16 v[132:135], v[68:71], v[32:35], v[132:135]
ds_read_b128 v[96:99], v3 offset:32768
v_mfma_f32_16x16x32_bf16 v[192:195], v[80:83], v[32:35], v[192:195]
ds_read_b64_tr_b16 v[162:163], v7 offset:34816
v_mfma_f32_16x16x32_bf16 v[196:199], v[84:87], v[32:35], v[196:199]
ds_read_b128 v[100:103], v3 offset:33024
v_mfma_f32_16x16x32_bf16 v[136:139], v[64:67], v[36:39], v[136:139]
ds_read_b64_tr_b16 v[164:165], v8 offset:32768
v_mfma_f32_16x16x32_bf16 v[140:143], v[68:71], v[36:39], v[140:143]
ds_read_b128 v[104:107], v3 offset:33280
v_mfma_f32_16x16x32_bf16 v[200:203], v[80:83], v[36:39], v[200:203]
ds_read_b64_tr_b16 v[166:167], v8 offset:34816
v_mfma_f32_16x16x32_bf16 v[204:207], v[84:87], v[36:39], v[204:207]
ds_read_b128 v[108:111], v3 offset:33536
v_mfma_f32_16x16x32_bf16 v[144:147], v[64:67], v[40:43], v[144:147]
ds_read_b64_tr_b16 v[176:177], v7 offset:40960
v_mfma_f32_16x16x32_bf16 v[148:151], v[68:71], v[40:43], v[148:151]
ds_read_b64_tr_b16 v[178:179], v7 offset:43008
v_mfma_f32_16x16x32_bf16 v[208:211], v[80:83], v[40:43], v[208:211]
ds_read_b64_tr_b16 v[180:181], v8 offset:40960
v_mfma_f32_16x16x32_bf16 v[212:215], v[84:87], v[40:43], v[212:215]
ds_read_b64_tr_b16 v[182:183], v8 offset:43008
v_mfma_f32_16x16x32_bf16 v[152:155], v[64:67], v[44:47], v[152:155]
ds_read_b64_tr_b16 v[168:169], v7 offset:36864
v_mfma_f32_16x16x32_bf16 v[156:159], v[68:71], v[44:47], v[156:159]
ds_read_b128 v[112:115], v3 offset:40960
v_mfma_f32_16x16x32_bf16 v[216:219], v[80:83], v[44:47], v[216:219]
ds_read_b64_tr_b16 v[170:171], v7 offset:38912
v_mfma_f32_16x16x32_bf16 v[220:223], v[84:87], v[44:47], v[220:223]
ds_read_b128 v[116:119], v3 offset:41216
v_mfma_f32_16x16x32_bf16 v[128:131], v[72:75], v[48:51], v[128:131]
ds_read_b64_tr_b16 v[172:173], v8 offset:36864
v_mfma_f32_16x16x32_bf16 v[132:135], v[76:79], v[48:51], v[132:135]
ds_read_b128 v[120:123], v3 offset:41472
v_mfma_f32_16x16x32_bf16 v[192:195], v[88:91], v[48:51], v[192:195]
ds_read_b64_tr_b16 v[174:175], v8 offset:38912
v_mfma_f32_16x16x32_bf16 v[196:199], v[92:95], v[48:51], v[196:199]
ds_read_b128 v[124:127], v3 offset:41728
v_mfma_f32_16x16x32_bf16 v[136:139], v[72:75], v[52:55], v[136:139]
ds_read_b64_tr_b16 v[184:185], v7 offset:45056
v_mfma_f32_16x16x32_bf16 v[140:143], v[76:79], v[52:55], v[140:143]
ds_read_b64_tr_b16 v[186:187], v7 offset:47104
v_mfma_f32_16x16x32_bf16 v[200:203], v[88:91], v[52:55], v[200:203]
ds_read_b64_tr_b16 v[188:189], v8 offset:45056
v_mfma_f32_16x16x32_bf16 v[204:207], v[92:95], v[52:55], v[204:207]
ds_read_b64_tr_b16 v[190:191], v8 offset:47104
v_mfma_f32_16x16x32_bf16 v[144:147], v[72:75], v[56:59], v[144:147]
v_mfma_f32_16x16x32_bf16 v[148:151], v[76:79], v[56:59], v[148:151]
v_mfma_f32_16x16x32_bf16 v[208:211], v[88:91], v[56:59], v[208:211]
v_mfma_f32_16x16x32_bf16 v[212:215], v[92:95], v[56:59], v[212:215]
v_mfma_f32_16x16x32_bf16 v[152:155], v[72:75], v[60:63], v[152:155]
v_mfma_f32_16x16x32_bf16 v[156:159], v[76:79], v[60:63], v[156:159]
v_mfma_f32_16x16x32_bf16 v[216:219], v[88:91], v[60:63], v[216:219]
v_mfma_f32_16x16x32_bf16 v[220:223], v[92:95], v[60:63], v[220:223]
s_waitcnt lgkmcnt(0)
s_barrier
v_mfma_f32_16x16x32_bf16 v[128:131], v[160:163], v[96:99], v[128:131]
ds_read_b64_tr_b16 v[64:65], v5 offset:0
v_mfma_f32_16x16x32_bf16 v[132:135], v[164:167], v[96:99], v[132:135]
ds_read_b128 v[32:35], v2 offset:0
v_mfma_f32_16x16x32_bf16 v[192:195], v[176:179], v[96:99], v[192:195]
ds_read_b64_tr_b16 v[66:67], v5 offset:2048
v_mfma_f32_16x16x32_bf16 v[196:199], v[180:183], v[96:99], v[196:199]
ds_read_b128 v[36:39], v2 offset:256
v_mfma_f32_16x16x32_bf16 v[136:139], v[160:163], v[100:103], v[136:139]
ds_read_b64_tr_b16 v[68:69], v6 offset:0
v_mfma_f32_16x16x32_bf16 v[140:143], v[164:167], v[100:103], v[140:143]
ds_read_b128 v[40:43], v2 offset:512
v_mfma_f32_16x16x32_bf16 v[200:203], v[176:179], v[100:103], v[200:203]
ds_read_b64_tr_b16 v[70:71], v6 offset:2048
v_mfma_f32_16x16x32_bf16 v[204:207], v[180:183], v[100:103], v[204:207]
ds_read_b128 v[44:47], v2 offset:768
v_mfma_f32_16x16x32_bf16 v[144:147], v[160:163], v[104:107], v[144:147]
ds_read_b64_tr_b16 v[80:81], v5 offset:8192
v_mfma_f32_16x16x32_bf16 v[148:151], v[164:167], v[104:107], v[148:151]
ds_read_b64_tr_b16 v[82:83], v5 offset:10240
v_mfma_f32_16x16x32_bf16 v[208:211], v[176:179], v[104:107], v[208:211]
ds_read_b64_tr_b16 v[84:85], v6 offset:8192
v_mfma_f32_16x16x32_bf16 v[212:215], v[180:183], v[104:107], v[212:215]
ds_read_b64_tr_b16 v[86:87], v6 offset:10240
v_mfma_f32_16x16x32_bf16 v[152:155], v[160:163], v[108:111], v[152:155]
ds_read_b64_tr_b16 v[72:73], v5 offset:4096
v_mfma_f32_16x16x32_bf16 v[156:159], v[164:167], v[108:111], v[156:159]
ds_read_b128 v[48:51], v2 offset:8192
v_mfma_f32_16x16x32_bf16 v[216:219], v[176:179], v[108:111], v[216:219]
ds_read_b64_tr_b16 v[74:75], v5 offset:6144
v_mfma_f32_16x16x32_bf16 v[220:223], v[180:183], v[108:111], v[220:223]
ds_read_b128 v[52:55], v2 offset:8448
v_mfma_f32_16x16x32_bf16 v[128:131], v[168:171], v[112:115], v[128:131]
ds_read_b64_tr_b16 v[76:77], v6 offset:4096
v_mfma_f32_16x16x32_bf16 v[132:135], v[172:175], v[112:115], v[132:135]
ds_read_b128 v[56:59], v2 offset:8704
v_mfma_f32_16x16x32_bf16 v[192:195], v[184:187], v[112:115], v[192:195]
ds_read_b64_tr_b16 v[78:79], v6 offset:6144
v_mfma_f32_16x16x32_bf16 v[196:199], v[188:191], v[112:115], v[196:199]
ds_read_b128 v[60:63], v2 offset:8960
v_mfma_f32_16x16x32_bf16 v[136:139], v[168:171], v[116:119], v[136:139]
ds_read_b64_tr_b16 v[88:89], v5 offset:12288
v_mfma_f32_16x16x32_bf16 v[140:143], v[172:175], v[116:119], v[140:143]
ds_read_b64_tr_b16 v[90:91], v5 offset:14336
v_mfma_f32_16x16x32_bf16 v[200:203], v[184:187], v[116:119], v[200:203]
ds_read_b64_tr_b16 v[92:93], v6 offset:12288
v_mfma_f32_16x16x32_bf16 v[204:207], v[188:191], v[116:119], v[204:207]
ds_read_b64_tr_b16 v[94:95], v6 offset:14336
v_mfma_f32_16x16x32_bf16 v[144:147], v[168:171], v[120:123], v[144:147]
v_mfma_f32_16x16x32_bf16 v[148:151], v[172:175], v[120:123], v[148:151]
v_mfma_f32_16x16x32_bf16 v[208:211], v[184:187], v[120:123], v[208:211]
v_mfma_f32_16x16x32_bf16 v[212:215], v[188:191], v[120:123], v[212:215]
v_mfma_f32_16x16x32_bf16 v[152:155], v[168:171], v[124:127], v[152:155]
v_mfma_f32_16x16x32_bf16 v[156:159], v[172:175], v[124:127], v[156:159]
v_mfma_f32_16x16x32_bf16 v[216:219], v[184:187], v[124:127], v[216:219]
v_mfma_f32_16x16x32_bf16 v[220:223], v[188:191], v[124:127], v[220:223]
s_waitcnt lgkmcnt(0)
s_barrier
v_mfma_f32_16x16x32_bf16 v[128:131], v[64:67], v[32:35], v[128:131]
ds_read_b64_tr_b16 v[160:161], v5 offset:32768
v_mfma_f32_16x16x32_bf16 v[132:135], v[68:71], v[32:35], v[132:135]
ds_read_b128 v[96:99], v2 offset:32768
v_mfma_f32_16x16x32_bf16 v[192:195], v[80:83], v[32:35], v[192:195]
ds_read_b64_tr_b16 v[162:163], v5 offset:34816
v_mfma_f32_16x16x32_bf16 v[196:199], v[84:87], v[32:35], v[196:199]
ds_read_b128 v[100:103], v2 offset:33024
v_mfma_f32_16x16x32_bf16 v[136:139], v[64:67], v[36:39], v[136:139]
ds_read_b64_tr_b16 v[164:165], v6 offset:32768
v_mfma_f32_16x16x32_bf16 v[140:143], v[68:71], v[36:39], v[140:143]
ds_read_b128 v[104:107], v2 offset:33280
v_mfma_f32_16x16x32_bf16 v[200:203], v[80:83], v[36:39], v[200:203]
ds_read_b64_tr_b16 v[166:167], v6 offset:34816
v_mfma_f32_16x16x32_bf16 v[204:207], v[84:87], v[36:39], v[204:207]
ds_read_b128 v[108:111], v2 offset:33536
v_mfma_f32_16x16x32_bf16 v[144:147], v[64:67], v[40:43], v[144:147]
ds_read_b64_tr_b16 v[176:177], v5 offset:40960
v_mfma_f32_16x16x32_bf16 v[148:151], v[68:71], v[40:43], v[148:151]
ds_read_b64_tr_b16 v[178:179], v5 offset:43008
v_mfma_f32_16x16x32_bf16 v[208:211], v[80:83], v[40:43], v[208:211]
ds_read_b64_tr_b16 v[180:181], v6 offset:40960
v_mfma_f32_16x16x32_bf16 v[212:215], v[84:87], v[40:43], v[212:215]
ds_read_b64_tr_b16 v[182:183], v6 offset:43008
v_mfma_f32_16x16x32_bf16 v[152:155], v[64:67], v[44:47], v[152:155]
ds_read_b64_tr_b16 v[168:169], v5 offset:36864
v_mfma_f32_16x16x32_bf16 v[156:159], v[68:71], v[44:47], v[156:159]
ds_read_b128 v[112:115], v2 offset:40960
v_mfma_f32_16x16x32_bf16 v[216:219], v[80:83], v[44:47], v[216:219]
ds_read_b64_tr_b16 v[170:171], v5 offset:38912
v_mfma_f32_16x16x32_bf16 v[220:223], v[84:87], v[44:47], v[220:223]
ds_read_b128 v[116:119], v2 offset:41216
v_mfma_f32_16x16x32_bf16 v[128:131], v[72:75], v[48:51], v[128:131]
ds_read_b64_tr_b16 v[172:173], v6 offset:36864
v_mfma_f32_16x16x32_bf16 v[132:135], v[76:79], v[48:51], v[132:135]
ds_read_b128 v[120:123], v2 offset:41472
v_mfma_f32_16x16x32_bf16 v[192:195], v[88:91], v[48:51], v[192:195]
ds_read_b64_tr_b16 v[174:175], v6 offset:38912
v_mfma_f32_16x16x32_bf16 v[196:199], v[92:95], v[48:51], v[196:199]
ds_read_b128 v[124:127], v2 offset:41728
v_mfma_f32_16x16x32_bf16 v[136:139], v[72:75], v[52:55], v[136:139]
ds_read_b64_tr_b16 v[184:185], v5 offset:45056
v_mfma_f32_16x16x32_bf16 v[140:143], v[76:79], v[52:55], v[140:143]
ds_read_b64_tr_b16 v[186:187], v5 offset:47104
v_mfma_f32_16x16x32_bf16 v[200:203], v[88:91], v[52:55], v[200:203]
ds_read_b64_tr_b16 v[188:189], v6 offset:45056
v_mfma_f32_16x16x32_bf16 v[204:207], v[92:95], v[52:55], v[204:207]
ds_read_b64_tr_b16 v[190:191], v6 offset:47104
v_mfma_f32_16x16x32_bf16 v[144:147], v[72:75], v[56:59], v[144:147]
v_mfma_f32_16x16x32_bf16 v[148:151], v[76:79], v[56:59], v[148:151]
v_mfma_f32_16x16x32_bf16 v[208:211], v[88:91], v[56:59], v[208:211]
v_mfma_f32_16x16x32_bf16 v[212:215], v[92:95], v[56:59], v[212:215]
v_mfma_f32_16x16x32_bf16 v[152:155], v[72:75], v[60:63], v[152:155]
v_mfma_f32_16x16x32_bf16 v[156:159], v[76:79], v[60:63], v[156:159]
v_mfma_f32_16x16x32_bf16 v[216:219], v[88:91], v[60:63], v[216:219]
v_mfma_f32_16x16x32_bf16 v[220:223], v[92:95], v[60:63], v[220:223]
s_waitcnt lgkmcnt(0)
s_barrier
v_mfma_f32_16x16x32_bf16 v[128:131], v[160:163], v[96:99], v[128:131]
ds_read_b64_tr_b16 v[64:65], v7 offset:0
v_mfma_f32_16x16x32_bf16 v[132:135], v[164:167], v[96:99], v[132:135]
ds_read_b128 v[32:35], v3 offset:0
v_mfma_f32_16x16x32_bf16 v[192:195], v[176:179], v[96:99], v[192:195]
ds_read_b64_tr_b16 v[66:67], v7 offset:2048
v_mfma_f32_16x16x32_bf16 v[196:199], v[180:183], v[96:99], v[196:199]
ds_read_b128 v[36:39], v3 offset:256
v_mfma_f32_16x16x32_bf16 v[136:139], v[160:163], v[100:103], v[136:139]
ds_read_b64_tr_b16 v[68:69], v8 offset:0
v_mfma_f32_16x16x32_bf16 v[140:143], v[164:167], v[100:103], v[140:143]
ds_read_b128 v[40:43], v3 offset:512
v_mfma_f32_16x16x32_bf16 v[200:203], v[176:179], v[100:103], v[200:203]
ds_read_b64_tr_b16 v[70:71], v8 offset:2048
v_mfma_f32_16x16x32_bf16 v[204:207], v[180:183], v[100:103], v[204:207]
ds_read_b128 v[44:47], v3 offset:768
v_mfma_f32_16x16x32_bf16 v[144:147], v[160:163], v[104:107], v[144:147]
ds_read_b64_tr_b16 v[80:81], v7 offset:8192
v_mfma_f32_16x16x32_bf16 v[148:151], v[164:167], v[104:107], v[148:151]
ds_read_b64_tr_b16 v[82:83], v7 offset:10240
v_mfma_f32_16x16x32_bf16 v[208:211], v[176:179], v[104:107], v[208:211]
ds_read_b64_tr_b16 v[84:85], v8 offset:8192
v_mfma_f32_16x16x32_bf16 v[212:215], v[180:183], v[104:107], v[212:215]
ds_read_b64_tr_b16 v[86:87], v8 offset:10240
v_mfma_f32_16x16x32_bf16 v[152:155], v[160:163], v[108:111], v[152:155]
ds_read_b64_tr_b16 v[72:73], v7 offset:4096
v_mfma_f32_16x16x32_bf16 v[156:159], v[164:167], v[108:111], v[156:159]
ds_read_b128 v[48:51], v3 offset:8192
v_mfma_f32_16x16x32_bf16 v[216:219], v[176:179], v[108:111], v[216:219]
ds_read_b64_tr_b16 v[74:75], v7 offset:6144
v_mfma_f32_16x16x32_bf16 v[220:223], v[180:183], v[108:111], v[220:223]
ds_read_b128 v[52:55], v3 offset:8448
v_mfma_f32_16x16x32_bf16 v[128:131], v[168:171], v[112:115], v[128:131]
ds_read_b64_tr_b16 v[76:77], v8 offset:4096
v_mfma_f32_16x16x32_bf16 v[132:135], v[172:175], v[112:115], v[132:135]
ds_read_b128 v[56:59], v3 offset:8704
v_mfma_f32_16x16x32_bf16 v[192:195], v[184:187], v[112:115], v[192:195]
ds_read_b64_tr_b16 v[78:79], v8 offset:6144
v_mfma_f32_16x16x32_bf16 v[196:199], v[188:191], v[112:115], v[196:199]
ds_read_b128 v[60:63], v3 offset:8960
v_mfma_f32_16x16x32_bf16 v[136:139], v[168:171], v[116:119], v[136:139]
ds_read_b64_tr_b16 v[88:89], v7 offset:12288
v_mfma_f32_16x16x32_bf16 v[140:143], v[172:175], v[116:119], v[140:143]
ds_read_b64_tr_b16 v[90:91], v7 offset:14336
v_mfma_f32_16x16x32_bf16 v[200:203], v[184:187], v[116:119], v[200:203]
ds_read_b64_tr_b16 v[92:93], v8 offset:12288
v_mfma_f32_16x16x32_bf16 v[204:207], v[188:191], v[116:119], v[204:207]
ds_read_b64_tr_b16 v[94:95], v8 offset:14336
v_mfma_f32_16x16x32_bf16 v[144:147], v[168:171], v[120:123], v[144:147]
v_mfma_f32_16x16x32_bf16 v[148:151], v[172:175], v[120:123], v[148:151]
v_mfma_f32_16x16x32_bf16 v[208:211], v[184:187], v[120:123], v[208:211]
v_mfma_f32_16x16x32_bf16 v[212:215], v[188:191], v[120:123], v[212:215]
v_mfma_f32_16x16x32_bf16 v[152:155], v[168:171], v[124:127], v[152:155]
v_mfma_f32_16x16x32_bf16 v[156:159], v[172:175], v[124:127], v[156:159]
v_mfma_f32_16x16x32_bf16 v[216:219], v[184:187], v[124:127], v[216:219]
v_mfma_f32_16x16x32_bf16 v[220:223], v[188:191], v[124:127], v[220:223]
s_sub_u32 s41, s41, 1
s_cmp_lg_u32 s41, 0
s_cbranch_scc1 Lk4_132
s_waitcnt lgkmcnt(0)
s_barrier
v_mfma_f32_16x16x32_bf16 v[128:131], v[64:67], v[32:35], v[128:131]
ds_read_b64_tr_b16 v[160:161], v7 offset:32768
v_mfma_f32_16x16x32_bf16 v[132:135], v[68:71], v[32:35], v[132:135]
ds_read_b128 v[96:99], v3 offset:32768
v_mfma_f32_16x16x32_bf16 v[192:195], v[80:83], v[32:35], v[192:195]
ds_read_b64_tr_b16 v[162:163], v7 offset:34816
v_mfma_f32_16x16x32_bf16 v[196:199], v[84:87], v[32:35], v[196:199]
ds_read_b128 v[100:103], v3 offset:33024
v_mfma_f32_16x16x32_bf16 v[136:139], v[64:67], v[36:39], v[136:139]
ds_read_b64_tr_b16 v[164:165], v8 offset:32768
v_mfma_f32_16x16x32_bf16 v[140:143], v[68:71], v[36:39], v[140:143]
ds_read_b128 v[104:107], v3 offset:33280
v_mfma_f32_16x16x32_bf16 v[200:203], v[80:83], v[36:39], v[200:203]
ds_read_b64_tr_b16 v[166:167], v8 offset:34816
v_mfma_f32_16x16x32_bf16 v[204:207], v[84:87], v[36:39], v[204:207]
ds_read_b128 v[108:111], v3 offset:33536
v_mfma_f32_16x16x32_bf16 v[144:147], v[64:67], v[40:43], v[144:147]
ds_read_b64_tr_b16 v[176:177], v7 offset:40960
v_mfma_f32_16x16x32_bf16 v[148:151], v[68:71], v[40:43], v[148:151]
ds_read_b64_tr_b16 v[178:179], v7 offset:43008
v_mfma_f32_16x16x32_bf16 v[208:211], v[80:83], v[40:43], v[208:211]
ds_read_b64_tr_b16 v[180:181], v8 offset:40960
v_mfma_f32_16x16x32_bf16 v[212:215], v[84:87], v[40:43], v[212:215]
ds_read_b64_tr_b16 v[182:183], v8 offset:43008
v_mfma_f32_16x16x32_bf16 v[152:155], v[64:67], v[44:47], v[152:155]
ds_read_b64_tr_b16 v[168:169], v7 offset:36864
v_mfma_f32_16x16x32_bf16 v[156:159], v[68:71], v[44:47], v[156:159]
ds_read_b128 v[112:115], v3 offset:40960
v_mfma_f32_16x16x32_bf16 v[216:219], v[80:83], v[44:47], v[216:219]
ds_read_b64_tr_b16 v[170:171], v7 offset:38912
v_mfma_f32_16x16x32_bf16 v[220:223], v[84:87], v[44:47], v[220:223]
ds_read_b128 v[116:119], v3 offset:41216
v_mfma_f32_16x16x32_bf16 v[128:131], v[72:75], v[48:51], v[128:131]
ds_read_b64_tr_b16 v[172:173], v8 offset:36864
v_mfma_f32_16x16x32_bf16 v[132:135], v[76:79], v[48:51], v[132:135]
ds_read_b128 v[120:123], v3 offset:41472
v_mfma_f32_16x16x32_bf16 v[192:195], v[88:91], v[48:51], v[192:195]
ds_read_b64_tr_b16 v[174:175], v8 offset:38912
v_mfma_f32_16x16x32_bf16 v[196:199], v[92:95], v[48:51], v[196:199]
ds_read_b128 v[124:127], v3 offset:41728
v_mfma_f32_16x16x32_bf16 v[136:139], v[72:75], v[52:55], v[136:139]
ds_read_b64_tr_b16 v[184:185], v7 offset:45056
v_mfma_f32_16x16x32_bf16 v[140:143], v[76:79], v[52:55], v[140:143]
ds_read_b64_tr_b16 v[186:187], v7 offset:47104
v_mfma_f32_16x16x32_bf16 v[200:203], v[88:91], v[52:55], v[200:203]
ds_read_b64_tr_b16 v[188:189], v8 offset:45056
v_mfma_f32_16x16x32_bf16 v[204:207], v[92:95], v[52:55], v[204:207]
ds_read_b64_tr_b16 v[190:191], v8 offset:47104
v_mfma_f32_16x16x32_bf16 v[144:147], v[72:75], v[56:59], v[144:147]
v_mfma_f32_16x16x32_bf16 v[148:151], v[76:79], v[56:59], v[148:151]
v_mfma_f32_16x16x32_bf16 v[208:211], v[88:91], v[56:59], v[208:211]
v_mfma_f32_16x16x32_bf16 v[212:215], v[92:95], v[56:59], v[212:215]
v_mfma_f32_16x16x32_bf16 v[152:155], v[72:75], v[60:63], v[152:155]
v_mfma_f32_16x16x32_bf16 v[156:159], v[76:79], v[60:63], v[156:159]
v_mfma_f32_16x16x32_bf16 v[216:219], v[88:91], v[60:63], v[216:219]
v_mfma_f32_16x16x32_bf16 v[220:223], v[92:95], v[60:63], v[220:223]
s_waitcnt lgkmcnt(0)
s_barrier
v_mfma_f32_16x16x32_bf16 v[128:131], v[160:163], v[96:99], v[128:131]
ds_read_b64_tr_b16 v[64:65], v5 offset:0
v_mfma_f32_16x16x32_bf16 v[132:135], v[164:167], v[96:99], v[132:135]
ds_read_b128 v[32:35], v2 offset:0
v_mfma_f32_16x16x32_bf16 v[192:195], v[176:179], v[96:99], v[192:195]
ds_read_b64_tr_b16 v[66:67], v5 offset:2048
v_mfma_f32_16x16x32_bf16 v[196:199], v[180:183], v[96:99], v[196:199]
ds_read_b128 v[36:39], v2 offset:256
v_mfma_f32_16x16x32_bf16 v[136:139], v[160:163], v[100:103], v[136:139]
ds_read_b64_tr_b16 v[68:69], v6 offset:0
v_mfma_f32_16x16x32_bf16 v[140:143], v[164:167], v[100:103], v[140:143]
ds_read_b128 v[40:43], v2 offset:512
v_mfma_f32_16x16x32_bf16 v[200:203], v[176:179], v[100:103], v[200:203]
ds_read_b64_tr_b16 v[70:71], v6 offset:2048
v_mfma_f32_16x16x32_bf16 v[204:207], v[180:183], v[100:103], v[204:207]
ds_read_b128 v[44:47], v2 offset:768
v_mfma_f32_16x16x32_bf16 v[144:147], v[160:163], v[104:107], v[144:147]
ds_read_b64_tr_b16 v[80:81], v5 offset:8192
v_mfma_f32_16x16x32_bf16 v[148:151], v[164:167], v[104:107], v[148:151]
ds_read_b64_tr_b16 v[82:83], v5 offset:10240
v_mfma_f32_16x16x32_bf16 v[208:211], v[176:179], v[104:107], v[208:211]
ds_read_b64_tr_b16 v[84:85], v6 offset:8192
v_mfma_f32_16x16x32_bf16 v[212:215], v[180:183], v[104:107], v[212:215]
ds_read_b64_tr_b16 v[86:87], v6 offset:10240
v_mfma_f32_16x16x32_bf16 v[152:155], v[160:163], v[108:111], v[152:155]
ds_read_b64_tr_b16 v[72:73], v5 offset:4096
v_mfma_f32_16x16x32_bf16 v[156:159], v[164:167], v[108:111], v[156:159]
ds_read_b128 v[48:51], v2 offset:8192
v_mfma_f32_16x16x32_bf16 v[216:219], v[176:179], v[108:111], v[216:219]
ds_read_b64_tr_b16 v[74:75], v5 offset:6144
v_mfma_f32_16x16x32_bf16 v[220:223], v[180:183], v[108:111], v[220:223]
ds_read_b128 v[52:55], v2 offset:8448
v_mfma_f32_16x16x32_bf16 v[128:131], v[168:171], v[112:115], v[128:131]
ds_read_b64_tr_b16 v[76:77], v6 offset:4096
v_mfma_f32_16x16x32_bf16 v[132:135], v[172:175], v[112:115], v[132:135]
ds_read_b128 v[56:59], v2 offset:8704
v_mfma_f32_16x16x32_bf16 v[192:195], v[184:187], v[112:115], v[192:195]
ds_read_b64_tr_b16 v[78:79], v6 offset:6144
v_mfma_f32_16x16x32_bf16 v[196:199], v[188:191], v[112:115], v[196:199]
ds_read_b128 v[60:63], v2 offset:8960
v_mfma_f32_16x16x32_bf16 v[136:139], v[168:171], v[116:119], v[136:139]
ds_read_b64_tr_b16 v[88:89], v5 offset:12288
v_mfma_f32_16x16x32_bf16 v[140:143], v[172:175], v[116:119], v[140:143]
ds_read_b64_tr_b16 v[90:91], v5 offset:14336
v_mfma_f32_16x16x32_bf16 v[200:203], v[184:187], v[116:119], v[200:203]
ds_read_b64_tr_b16 v[92:93], v6 offset:12288
v_mfma_f32_16x16x32_bf16 v[204:207], v[188:191], v[116:119], v[204:207]
ds_read_b64_tr_b16 v[94:95], v6 offset:14336
v_mfma_f32_16x16x32_bf16 v[144:147], v[168:171], v[120:123], v[144:147]
v_mfma_f32_16x16x32_bf16 v[148:151], v[172:175], v[120:123], v[148:151]
v_mfma_f32_16x16x32_bf16 v[208:211], v[184:187], v[120:123], v[208:211]
v_mfma_f32_16x16x32_bf16 v[212:215], v[188:191], v[120:123], v[212:215]
v_mfma_f32_16x16x32_bf16 v[152:155], v[168:171], v[124:127], v[152:155]
v_mfma_f32_16x16x32_bf16 v[156:159], v[172:175], v[124:127], v[156:159]
v_mfma_f32_16x16x32_bf16 v[216:219], v[184:187], v[124:127], v[216:219]
v_mfma_f32_16x16x32_bf16 v[220:223], v[188:191], v[124:127], v[220:223]
s_waitcnt lgkmcnt(0)
s_barrier
v_mfma_f32_16x16x32_bf16 v[128:131], v[64:67], v[32:35], v[128:131]
ds_read_b64_tr_b16 v[160:161], v5 offset:32768
v_mfma_f32_16x16x32_bf16 v[132:135], v[68:71], v[32:35], v[132:135]
ds_read_b128 v[96:99], v2 offset:32768
v_mfma_f32_16x16x32_bf16 v[192:195], v[80:83], v[32:35], v[192:195]
ds_read_b64_tr_b16 v[162:163], v5 offset:34816
v_mfma_f32_16x16x32_bf16 v[196:199], v[84:87], v[32:35], v[196:199]
ds_read_b128 v[100:103], v2 offset:33024
v_mfma_f32_16x16x32_bf16 v[136:139], v[64:67], v[36:39], v[136:139]
ds_read_b64_tr_b16 v[164:165], v6 offset:32768
v_mfma_f32_16x16x32_bf16 v[140:143], v[68:71], v[36:39], v[140:143]
ds_read_b128 v[104:107], v2 offset:33280
v_mfma_f32_16x16x32_bf16 v[200:203], v[80:83], v[36:39], v[200:203]
ds_read_b64_tr_b16 v[166:167], v6 offset:34816
v_mfma_f32_16x16x32_bf16 v[204:207], v[84:87], v[36:39], v[204:207]
ds_read_b128 v[108:111], v2 offset:33536
v_mfma_f32_16x16x32_bf16 v[144:147], v[64:67], v[40:43], v[144:147]
ds_read_b64_tr_b16 v[176:177], v5 offset:40960
v_mfma_f32_16x16x32_bf16 v[148:151], v[68:71], v[40:43], v[148:151]
ds_read_b64_tr_b16 v[178:179], v5 offset:43008
v_mfma_f32_16x16x32_bf16 v[208:211], v[80:83], v[40:43], v[208:211]
ds_read_b64_tr_b16 v[180:181], v6 offset:40960
v_mfma_f32_16x16x32_bf16 v[212:215], v[84:87], v[40:43], v[212:215]
ds_read_b64_tr_b16 v[182:183], v6 offset:43008
v_mfma_f32_16x16x32_bf16 v[152:155], v[64:67], v[44:47], v[152:155]
ds_read_b64_tr_b16 v[168:169], v5 offset:36864
v_mfma_f32_16x16x32_bf16 v[156:159], v[68:71], v[44:47], v[156:159]
ds_read_b128 v[112:115], v2 offset:40960
v_mfma_f32_16x16x32_bf16 v[216:219], v[80:83], v[44:47], v[216:219]
ds_read_b64_tr_b16 v[170:171], v5 offset:38912
v_mfma_f32_16x16x32_bf16 v[220:223], v[84:87], v[44:47], v[220:223]
ds_read_b128 v[116:119], v2 offset:41216
v_mfma_f32_16x16x32_bf16 v[128:131], v[72:75], v[48:51], v[128:131]
ds_read_b64_tr_b16 v[172:173], v6 offset:36864
v_mfma_f32_16x16x32_bf16 v[132:135], v[76:79], v[48:51], v[132:135]
ds_read_b128 v[120:123], v2 offset:41472
v_mfma_f32_16x16x32_bf16 v[192:195], v[88:91], v[48:51], v[192:195]
ds_read_b64_tr_b16 v[174:175], v6 offset:38912
v_mfma_f32_16x16x32_bf16 v[196:199], v[92:95], v[48:51], v[196:199]
ds_read_b128 v[124:127], v2 offset:41728
v_mfma_f32_16x16x32_bf16 v[136:139], v[72:75], v[52:55], v[136:139]
ds_read_b64_tr_b16 v[184:185], v5 offset:45056
v_mfma_f32_16x16x32_bf16 v[140:143], v[76:79], v[52:55], v[140:143]
ds_read_b64_tr_b16 v[186:187], v5 offset:47104
v_mfma_f32_16x16x32_bf16 v[200:203], v[88:91], v[52:55], v[200:203]
ds_read_b64_tr_b16 v[188:189], v6 offset:45056
v_mfma_f32_16x16x32_bf16 v[204:207], v[92:95], v[52:55], v[204:207]
ds_read_b64_tr_b16 v[190:191], v6 offset:47104
v_mfma_f32_16x16x32_bf16 v[144:147], v[72:75], v[56:59], v[144:147]
v_mfma_f32_16x16x32_bf16 v[148:151], v[76:79], v[56:59], v[148:151]
v_mfma_f32_16x16x32_bf16 v[208:211], v[88:91], v[56:59], v[208:211]
v_mfma_f32_16x16x32_bf16 v[212:215], v[92:95], v[56:59], v[212:215]
v_mfma_f32_16x16x32_bf16 v[152:155], v[72:75], v[60:63], v[152:155]
v_mfma_f32_16x16x32_bf16 v[156:159], v[76:79], v[60:63], v[156:159]
v_mfma_f32_16x16x32_bf16 v[216:219], v[88:91], v[60:63], v[216:219]
v_mfma_f32_16x16x32_bf16 v[220:223], v[92:95], v[60:63], v[220:223]
s_waitcnt lgkmcnt(0)
s_barrier
v_mfma_f32_16x16x32_bf16 v[128:131], v[160:163], v[96:99], v[128:131]
ds_read_b64_tr_b16 v[64:65], v7 offset:0
v_mfma_f32_16x16x32_bf16 v[132:135], v[164:167], v[96:99], v[132:135]
ds_read_b128 v[32:35], v3 offset:0
v_mfma_f32_16x16x32_bf16 v[192:195], v[176:179], v[96:99], v[192:195]
ds_read_b64_tr_b16 v[66:67], v7 offset:2048
v_mfma_f32_16x16x32_bf16 v[196:199], v[180:183], v[96:99], v[196:199]
ds_read_b128 v[36:39], v3 offset:256
v_mfma_f32_16x16x32_bf16 v[136:139], v[160:163], v[100:103], v[136:139]
ds_read_b64_tr_b16 v[68:69], v8 offset:0
v_mfma_f32_16x16x32_bf16 v[140:143], v[164:167], v[100:103], v[140:143]
ds_read_b128 v[40:43], v3 offset:512
v_mfma_f32_16x16x32_bf16 v[200:203], v[176:179], v[100:103], v[200:203]
ds_read_b64_tr_b16 v[70:71], v8 offset:2048
v_mfma_f32_16x16x32_bf16 v[204:207], v[180:183], v[100:103], v[204:207]
ds_read_b128 v[44:47], v3 offset:768
v_mfma_f32_16x16x32_bf16 v[144:147], v[160:163], v[104:107], v[144:147]
ds_read_b64_tr_b16 v[72:73], v7 offset:4096
v_mfma_f32_16x16x32_bf16 v[148:151], v[164:167], v[104:107], v[148:151]
ds_read_b128 v[48:51], v3 offset:8192
v_mfma_f32_16x16x32_bf16 v[208:211], v[176:179], v[104:107], v[208:211]
ds_read_b64_tr_b16 v[74:75], v7 offset:6144
v_mfma_f32_16x16x32_bf16 v[212:215], v[180:183], v[104:107], v[212:215]
ds_read_b128 v[52:55], v3 offset:8448
v_mfma_f32_16x16x32_bf16 v[152:155], v[160:163], v[108:111], v[152:155]
ds_read_b64_tr_b16 v[76:77], v8 offset:4096
v_mfma_f32_16x16x32_bf16 v[156:159], v[164:167], v[108:111], v[156:159]
ds_read_b128 v[56:59], v3 offset:8704
v_mfma_f32_16x16x32_bf16 v[216:219], v[176:179], v[108:111], v[216:219]
ds_read_b64_tr_b16 v[78:79], v8 offset:6144
v_mfma_f32_16x16x32_bf16 v[220:223], v[180:183], v[108:111], v[220:223]
ds_read_b128 v[60:63], v3 offset:8960
v_mfma_f32_16x16x32_bf16 v[128:131], v[168:171], v[112:115], v[128:131]
v_mfma_f32_16x16x32_bf16 v[132:135], v[172:175], v[112:115], v[132:135]
v_mfma_f32_16x16x32_bf16 v[192:195], v[184:187], v[112:115], v[192:195]
v_mfma_f32_16x16x32_bf16 v[196:199], v[188:191], v[112:115], v[196:199]
v_mfma_f32_16x16x32_bf16 v[136:139], v[168:171], v[116:119], v[136:139]
v_mfma_f32_16x16x32_bf16 v[140:143], v[172:175], v[116:119], v[140:143]
v_mfma_f32_16x16x32_bf16 v[200:203], v[184:187], v[116:119], v[200:203]
v_mfma_f32_16x16x32_bf16 v[204:207], v[188:191], v[116:119], v[204:207]
v_mfma_f32_16x16x32_bf16 v[144:147], v[168:171], v[120:123], v[144:147]
v_mfma_f32_16x16x32_bf16 v[148:151], v[172:175], v[120:123], v[148:151]
v_mfma_f32_16x16x32_bf16 v[208:211], v[184:187], v[120:123], v[208:211]
v_mfma_f32_16x16x32_bf16 v[212:215], v[188:191], v[120:123], v[212:215]
v_mfma_f32_16x16x32_bf16 v[152:155], v[168:171], v[124:127], v[152:155]
v_mfma_f32_16x16x32_bf16 v[156:159], v[172:175], v[124:127], v[156:159]
v_mfma_f32_16x16x32_bf16 v[216:219], v[184:187], v[124:127], v[216:219]
v_mfma_f32_16x16x32_bf16 v[220:223], v[188:191], v[124:127], v[220:223]
s_mov_b32 s54, 0x10000
s_waitcnt lgkmcnt(0)
s_barrier
v_mfma_f32_16x16x32_bf16 v[128:131], v[64:67], v[32:35], v[128:131]
ds_read_b64_tr_b16 v[160:161], v7 offset:32768
v_mfma_f32_16x16x32_bf16 v[132:135], v[68:71], v[32:35], v[132:135]
ds_read_b128 v[96:99], v3 offset:32768
v_mfma_f32_16x16x32_bf16 v[136:139], v[64:67], v[36:39], v[136:139]
ds_read_b64_tr_b16 v[162:163], v7 offset:34816
v_mfma_f32_16x16x32_bf16 v[140:143], v[68:71], v[36:39], v[140:143]
ds_read_b128 v[100:103], v3 offset:33024
v_cvt_pk_bf16_f32 v224, v192, v193
v_mfma_f32_16x16x32_bf16 v[144:147], v[64:67], v[40:43], v[144:147]
ds_read_b64_tr_b16 v[164:165], v8 offset:32768
v_cvt_pk_bf16_f32 v225, v194, v195
v_mfma_f32_16x16x32_bf16 v[148:151], v[68:71], v[40:43], v[148:151]
v_cvt_pk_bf16_f32 v226, v196, v197
ds_read_b128 v[104:107], v3 offset:33280
v_cvt_pk_bf16_f32 v227, v198, v199
v_mfma_f32_16x16x32_bf16 v[152:155], v[64:67], v[44:47], v[152:155]
buffer_store_dwordx4 v[224:227], v9, s[64:67], 0 offen offset:0 sc1
ds_read_b64_tr_b16 v[166:167], v8 offset:34816
v_cvt_pk_bf16_f32 v228, v200, v201
v_mfma_f32_16x16x32_bf16 v[156:159], v[68:71], v[44:47], v[156:159]
ds_read_b128 v[108:111], v3 offset:33536
v_cvt_pk_bf16_f32 v229, v202, v203
v_mfma_f32_16x16x32_bf16 v[128:131], v[72:75], v[48:51], v[128:131]
v_cvt_pk_bf16_f32 v230, v204, v205
ds_read_b64_tr_b16 v[168:169], v7 offset:36864
v_cvt_pk_bf16_f32 v231, v206, v207
v_mfma_f32_16x16x32_bf16 v[132:135], v[76:79], v[48:51], v[132:135]
buffer_store_dwordx4 v[228:231], v9, s[64:67], 0 offen offset:1024 sc1
ds_read_b128 v[112:115], v3 offset:40960
v_cvt_pk_bf16_f32 v232, v208, v209
v_mfma_f32_16x16x32_bf16 v[136:139], v[72:75], v[52:55], v[136:139]
ds_read_b64_tr_b16 v[170:171], v7 offset:38912
v_cvt_pk_bf16_f32 v233, v210, v211
v_mfma_f32_16x16x32_bf16 v[140:143], v[76:79], v[52:55], v[140:143]
v_cvt_pk_bf16_f32 v234, v212, v213
ds_read_b128 v[116:119], v3 offset:41216
v_cvt_pk_bf16_f32 v235, v214, v215
v_mfma_f32_16x16x32_bf16 v[144:147], v[72:75], v[56:59], v[144:147]
buffer_store_dwordx4 v[232:235], v9, s[64:67], 0 offen offset:2048 sc1
ds_read_b64_tr_b16 v[172:173], v8 offset:36864
v_cvt_pk_bf16_f32 v236, v216, v217
v_mfma_f32_16x16x32_bf16 v[148:151], v[76:79], v[56:59], v[148:151]
ds_read_b128 v[120:123], v3 offset:41472
v_cvt_pk_bf16_f32 v237, v218, v219
v_mfma_f32_16x16x32_bf16 v[152:155], v[72:75], v[60:63], v[152:155]
v_cvt_pk_bf16_f32 v238, v220, v221
ds_read_b64_tr_b16 v[174:175], v8 offset:38912
v_cvt_pk_bf16_f32 v239, v222, v223
v_mfma_f32_16x16x32_bf16 v[156:159], v[76:79], v[60:63], v[156:159]
buffer_store_dwordx4 v[236:239], v9, s[64:67], 0 offen offset:3072 sc1
ds_read_b128 v[124:127], v3 offset:41728
s_waitcnt lgkmcnt(0)
s_barrier
v_mfma_f32_16x16x32_bf16 v[128:131], v[160:163], v[96:99], v[128:131]
ds_read_b64_tr_b16 v[64:65], v5 offset:0
v_mfma_f32_16x16x32_bf16 v[132:135], v[164:167], v[96:99], v[132:135]
ds_read_b128 v[32:35], v2 offset:0
v_mfma_f32_16x16x32_bf16 v[136:139], v[160:163], v[100:103], v[136:139]
ds_read_b64_tr_b16 v[66:67], v5 offset:2048
v_mfma_f32_16x16x32_bf16 v[140:143], v[164:167], v[100:103], v[140:143]
ds_read_b128 v[36:39], v2 offset:256
v_mfma_f32_16x16x32_bf16 v[144:147], v[160:163], v[104:107], v[144:147]
ds_read_b64_tr_b16 v[68:69], v6 offset:0
v_mfma_f32_16x16x32_bf16 v[148:151], v[164:167], v[104:107], v[148:151]
ds_read_b128 v[40:43], v2 offset:512
v_mfma_f32_16x16x32_bf16 v[152:155], v[160:163], v[108:111], v[152:155]
ds_read_b64_tr_b16 v[70:71], v6 offset:2048
v_mfma_f32_16x16x32_bf16 v[156:159], v[164:167], v[108:111], v[156:159]
ds_read_b128 v[44:47], v2 offset:768
v_mfma_f32_16x16x32_bf16 v[128:131], v[168:171], v[112:115], v[128:131]
ds_read_b64_tr_b16 v[72:73], v5 offset:4096
v_mfma_f32_16x16x32_bf16 v[132:135], v[172:175], v[112:115], v[132:135]
ds_read_b128 v[48:51], v2 offset:8192
v_mfma_f32_16x16x32_bf16 v[136:139], v[168:171], v[116:119], v[136:139]
ds_read_b64_tr_b16 v[74:75], v5 offset:6144
v_mfma_f32_16x16x32_bf16 v[140:143], v[172:175], v[116:119], v[140:143]
ds_read_b128 v[52:55], v2 offset:8448
v_mfma_f32_16x16x32_bf16 v[144:147], v[168:171], v[120:123], v[144:147]
ds_read_b64_tr_b16 v[76:77], v6 offset:4096
v_mfma_f32_16x16x32_bf16 v[148:151], v[172:175], v[120:123], v[148:151]
ds_read_b128 v[56:59], v2 offset:8704
v_mfma_f32_16x16x32_bf16 v[152:155], v[168:171], v[124:127], v[152:155]
ds_read_b64_tr_b16 v[78:79], v6 offset:6144
v_mfma_f32_16x16x32_bf16 v[156:159], v[172:175], v[124:127], v[156:159]
ds_read_b128 v[60:63], v2 offset:8960
s_waitcnt lgkmcnt(0)
s_barrier
v_mfma_f32_16x16x32_bf16 v[128:131], v[64:67], v[32:35], v[128:131]
ds_read_b64_tr_b16 v[160:161], v5 offset:32768
v_mfma_f32_16x16x32_bf16 v[132:135], v[68:71], v[32:35], v[132:135]
ds_read_b128 v[96:99], v2 offset:32768
v_mfma_f32_16x16x32_bf16 v[136:139], v[64:67], v[36:39], v[136:139]
ds_read_b64_tr_b16 v[162:163], v5 offset:34816
v_mfma_f32_16x16x32_bf16 v[140:143], v[68:71], v[36:39], v[140:143]
ds_read_b128 v[100:103], v2 offset:33024
v_mfma_f32_16x16x32_bf16 v[144:147], v[64:67], v[40:43], v[144:147]
ds_read_b64_tr_b16 v[164:165], v6 offset:32768
v_mfma_f32_16x16x32_bf16 v[148:151], v[68:71], v[40:43], v[148:151]
ds_read_b128 v[104:107], v2 offset:33280
v_mfma_f32_16x16x32_bf16 v[152:155], v[64:67], v[44:47], v[152:155]
ds_read_b64_tr_b16 v[166:167], v6 offset:34816
v_mfma_f32_16x16x32_bf16 v[156:159], v[68:71], v[44:47], v[156:159]
ds_read_b128 v[108:111], v2 offset:33536
v_mfma_f32_16x16x32_bf16 v[128:131], v[72:75], v[48:51], v[128:131]
ds_read_b64_tr_b16 v[168:169], v5 offset:36864
v_mfma_f32_16x16x32_bf16 v[132:135], v[76:79], v[48:51], v[132:135]
ds_read_b128 v[112:115], v2 offset:40960
v_mfma_f32_16x16x32_bf16 v[136:139], v[72:75], v[52:55], v[136:139]
ds_read_b64_tr_b16 v[170:171], v5 offset:38912
v_mfma_f32_16x16x32_bf16 v[140:143], v[76:79], v[52:55], v[140:143]
ds_read_b128 v[116:119], v2 offset:41216
v_mfma_f32_16x16x32_bf16 v[144:147], v[72:75], v[56:59], v[144:147]
ds_read_b64_tr_b16 v[172:173], v6 offset:36864
v_mfma_f32_16x16x32_bf16 v[148:151], v[76:79], v[56:59], v[148:151]
ds_read_b128 v[120:123], v2 offset:41472
v_mfma_f32_16x16x32_bf16 v[152:155], v[72:75], v[60:63], v[152:155]
ds_read_b64_tr_b16 v[174:175], v6 offset:38912
v_mfma_f32_16x16x32_bf16 v[156:159], v[76:79], v[60:63], v[156:159]
ds_read_b128 v[124:127], v2 offset:41728
s_waitcnt vmcnt(0) lgkmcnt(0)
s_barrier
v_mfma_f32_16x16x32_bf16 v[128:131], v[160:163], v[96:99], v[128:131]
ds_read_b64_tr_b16 v[64:65], v7 offset:0
v_mfma_f32_16x16x32_bf16 v[132:135], v[164:167], v[96:99], v[132:135]
ds_read_b128 v[32:35], v3 offset:0
v_mfma_f32_16x16x32_bf16 v[136:139], v[160:163], v[100:103], v[136:139]
ds_read_b64_tr_b16 v[66:67], v7 offset:2048
v_mfma_f32_16x16x32_bf16 v[140:143], v[164:167], v[100:103], v[140:143]
ds_read_b128 v[36:39], v3 offset:256
v_mfma_f32_16x16x32_bf16 v[144:147], v[160:163], v[104:107], v[144:147]
ds_read_b64_tr_b16 v[68:69], v8 offset:0
v_mfma_f32_16x16x32_bf16 v[148:151], v[164:167], v[104:107], v[148:151]
ds_read_b128 v[40:43], v3 offset:512
v_mfma_f32_16x16x32_bf16 v[152:155], v[160:163], v[108:111], v[152:155]
ds_read_b64_tr_b16 v[70:71], v8 offset:2048
v_mfma_f32_16x16x32_bf16 v[156:159], v[164:167], v[108:111], v[156:159]
ds_read_b128 v[44:47], v3 offset:768
v_mfma_f32_16x16x32_bf16 v[128:131], v[168:171], v[112:115], v[128:131]
ds_read_b64_tr_b16 v[72:73], v7 offset:4096
v_mfma_f32_16x16x32_bf16 v[132:135], v[172:175], v[112:115], v[132:135]
ds_read_b128 v[48:51], v3 offset:8192
v_mfma_f32_16x16x32_bf16 v[136:139], v[168:171], v[116:119], v[136:139]
ds_read_b64_tr_b16 v[74:75], v7 offset:6144
v_mfma_f32_16x16x32_bf16 v[140:143], v[172:175], v[116:119], v[140:143]
ds_read_b128 v[52:55], v3 offset:8448
v_mfma_f32_16x16x32_bf16 v[144:147], v[168:171], v[120:123], v[144:147]
ds_read_b64_tr_b16 v[76:77], v8 offset:4096
v_mfma_f32_16x16x32_bf16 v[148:151], v[172:175], v[120:123], v[148:151]
ds_read_b128 v[56:59], v3 offset:8704
v_mfma_f32_16x16x32_bf16 v[152:155], v[168:171], v[124:127], v[152:155]
ds_read_b64_tr_b16 v[78:79], v8 offset:6144
v_mfma_f32_16x16x32_bf16 v[156:159], v[172:175], v[124:127], v[156:159]
ds_read_b128 v[60:63], v3 offset:8960
s_waitcnt lgkmcnt(0)
s_barrier
v_mfma_f32_16x16x32_bf16 v[128:131], v[64:67], v[32:35], v[128:131]
ds_read_b64_tr_b16 v[160:161], v7 offset:32768
v_mfma_f32_16x16x32_bf16 v[132:135], v[68:71], v[32:35], v[132:135]
ds_read_b128 v[96:99], v3 offset:32768
v_mfma_f32_16x16x32_bf16 v[136:139], v[64:67], v[36:39], v[136:139]
ds_read_b64_tr_b16 v[162:163], v7 offset:34816
v_mfma_f32_16x16x32_bf16 v[140:143], v[68:71], v[36:39], v[140:143]
ds_read_b128 v[100:103], v3 offset:33024
v_mfma_f32_16x16x32_bf16 v[144:147], v[64:67], v[40:43], v[144:147]
ds_read_b64_tr_b16 v[164:165], v8 offset:32768
v_mfma_f32_16x16x32_bf16 v[148:151], v[68:71], v[40:43], v[148:151]
ds_read_b128 v[104:107], v3 offset:33280
v_mfma_f32_16x16x32_bf16 v[152:155], v[64:67], v[44:47], v[152:155]
ds_read_b64_tr_b16 v[166:167], v8 offset:34816
v_mfma_f32_16x16x32_bf16 v[156:159], v[68:71], v[44:47], v[156:159]
ds_read_b128 v[108:111], v3 offset:33536
v_mfma_f32_16x16x32_bf16 v[128:131], v[72:75], v[48:51], v[128:131]
ds_read_b64_tr_b16 v[168:169], v7 offset:36864
v_mfma_f32_16x16x32_bf16 v[132:135], v[76:79], v[48:51], v[132:135]
ds_read_b128 v[112:115], v3 offset:40960
v_mfma_f32_16x16x32_bf16 v[136:139], v[72:75], v[52:55], v[136:139]
ds_read_b64_tr_b16 v[170:171], v7 offset:38912
v_mfma_f32_16x16x32_bf16 v[140:143], v[76:79], v[52:55], v[140:143]
ds_read_b128 v[116:119], v3 offset:41216
v_mfma_f32_16x16x32_bf16 v[144:147], v[72:75], v[56:59], v[144:147]
ds_read_b64_tr_b16 v[172:173], v8 offset:36864
v_mfma_f32_16x16x32_bf16 v[148:151], v[76:79], v[56:59], v[148:151]
ds_read_b128 v[120:123], v3 offset:41472
v_mfma_f32_16x16x32_bf16 v[152:155], v[72:75], v[60:63], v[152:155]
ds_read_b64_tr_b16 v[174:175], v8 offset:38912
v_mfma_f32_16x16x32_bf16 v[156:159], v[76:79], v[60:63], v[156:159]
ds_read_b128 v[124:127], v3 offset:41728
s_waitcnt lgkmcnt(0)
s_barrier
v_mfma_f32_16x16x32_bf16 v[128:131], v[160:163], v[96:99], v[128:131]
ds_read_b64_tr_b16 v[64:65], v5 offset:0
v_mfma_f32_16x16x32_bf16 v[132:135], v[164:167], v[96:99], v[132:135]
ds_read_b128 v[32:35], v2 offset:0
v_mfma_f32_16x16x32_bf16 v[136:139], v[160:163], v[100:103], v[136:139]
ds_read_b64_tr_b16 v[66:67], v5 offset:2048
v_mfma_f32_16x16x32_bf16 v[140:143], v[164:167], v[100:103], v[140:143]
ds_read_b128 v[36:39], v2 offset:256
v_mfma_f32_16x16x32_bf16 v[144:147], v[160:163], v[104:107], v[144:147]
ds_read_b64_tr_b16 v[68:69], v6 offset:0
v_mfma_f32_16x16x32_bf16 v[148:151], v[164:167], v[104:107], v[148:151]
ds_read_b128 v[40:43], v2 offset:512
v_mfma_f32_16x16x32_bf16 v[152:155], v[160:163], v[108:111], v[152:155]
ds_read_b64_tr_b16 v[70:71], v6 offset:2048
v_mfma_f32_16x16x32_bf16 v[156:159], v[164:167], v[108:111], v[156:159]
ds_read_b128 v[44:47], v2 offset:768
v_mfma_f32_16x16x32_bf16 v[128:131], v[168:171], v[112:115], v[128:131]
ds_read_b64_tr_b16 v[72:73], v5 offset:4096
v_mfma_f32_16x16x32_bf16 v[132:135], v[172:175], v[112:115], v[132:135]
ds_read_b128 v[48:51], v2 offset:8192
v_mfma_f32_16x16x32_bf16 v[136:139], v[168:171], v[116:119], v[136:139]
ds_read_b64_tr_b16 v[74:75], v5 offset:6144
v_mfma_f32_16x16x32_bf16 v[140:143], v[172:175], v[116:119], v[140:143]
ds_read_b128 v[52:55], v2 offset:8448
v_mfma_f32_16x16x32_bf16 v[144:147], v[168:171], v[120:123], v[144:147]
ds_read_b64_tr_b16 v[76:77], v6 offset:4096
v_mfma_f32_16x16x32_bf16 v[148:151], v[172:175], v[120:123], v[148:151]
ds_read_b128 v[56:59], v2 offset:8704
v_mfma_f32_16x16x32_bf16 v[152:155], v[168:171], v[124:127], v[152:155]
ds_read_b64_tr_b16 v[78:79], v6 offset:6144
v_mfma_f32_16x16x32_bf16 v[156:159], v[172:175], v[124:127], v[156:159]
ds_read_b128 v[60:63], v2 offset:8960
s_waitcnt lgkmcnt(0)
s_barrier
v_mfma_f32_16x16x32_bf16 v[128:131], v[64:67], v[32:35], v[128:131]
ds_read_b64_tr_b16 v[160:161], v5 offset:32768
v_mfma_f32_16x16x32_bf16 v[132:135], v[68:71], v[32:35], v[132:135]
ds_read_b128 v[96:99], v2 offset:32768
v_mfma_f32_16x16x32_bf16 v[136:139], v[64:67], v[36:39], v[136:139]
ds_read_b64_tr_b16 v[162:163], v5 offset:34816
v_mfma_f32_16x16x32_bf16 v[140:143], v[68:71], v[36:39], v[140:143]
ds_read_b128 v[100:103], v2 offset:33024
v_mfma_f32_16x16x32_bf16 v[144:147], v[64:67], v[40:43], v[144:147]
ds_read_b64_tr_b16 v[164:165], v6 offset:32768
v_mfma_f32_16x16x32_bf16 v[148:151], v[68:71], v[40:43], v[148:151]
ds_read_b128 v[104:107], v2 offset:33280
v_mfma_f32_16x16x32_bf16 v[152:155], v[64:67], v[44:47], v[152:155]
ds_read_b64_tr_b16 v[166:167], v6 offset:34816
v_mfma_f32_16x16x32_bf16 v[156:159], v[68:71], v[44:47], v[156:159]
ds_read_b128 v[108:111], v2 offset:33536
v_mfma_f32_16x16x32_bf16 v[128:131], v[72:75], v[48:51], v[128:131]
ds_read_b64_tr_b16 v[168:169], v5 offset:36864
v_mfma_f32_16x16x32_bf16 v[132:135], v[76:79], v[48:51], v[132:135]
ds_read_b128 v[112:115], v2 offset:40960
v_mfma_f32_16x16x32_bf16 v[136:139], v[72:75], v[52:55], v[136:139]
ds_read_b64_tr_b16 v[170:171], v5 offset:38912
v_mfma_f32_16x16x32_bf16 v[140:143], v[76:79], v[52:55], v[140:143]
ds_read_b128 v[116:119], v2 offset:41216
v_mfma_f32_16x16x32_bf16 v[144:147], v[72:75], v[56:59], v[144:147]
ds_read_b64_tr_b16 v[172:173], v6 offset:36864
v_mfma_f32_16x16x32_bf16 v[148:151], v[76:79], v[56:59], v[148:151]
ds_read_b128 v[120:123], v2 offset:41472
v_mfma_f32_16x16x32_bf16 v[152:155], v[72:75], v[60:63], v[152:155]
ds_read_b64_tr_b16 v[174:175], v6 offset:38912
v_mfma_f32_16x16x32_bf16 v[156:159], v[76:79], v[60:63], v[156:159]
ds_read_b128 v[124:127], v2 offset:41728
s_waitcnt lgkmcnt(0)
s_barrier
v_mfma_f32_16x16x32_bf16 v[128:131], v[160:163], v[96:99], v[128:131]
ds_read_b64_tr_b16 v[64:65], v7 offset:0
v_mfma_f32_16x16x32_bf16 v[132:135], v[164:167], v[96:99], v[132:135]
ds_read_b128 v[32:35], v3 offset:0
v_mfma_f32_16x16x32_bf16 v[136:139], v[160:163], v[100:103], v[136:139]
ds_read_b64_tr_b16 v[66:67], v7 offset:2048
v_mfma_f32_16x16x32_bf16 v[140:143], v[164:167], v[100:103], v[140:143]
ds_read_b128 v[36:39], v3 offset:256
v_mfma_f32_16x16x32_bf16 v[144:147], v[160:163], v[104:107], v[144:147]
ds_read_b64_tr_b16 v[68:69], v8 offset:0
v_mfma_f32_16x16x32_bf16 v[148:151], v[164:167], v[104:107], v[148:151]
ds_read_b128 v[40:43], v3 offset:512
v_mfma_f32_16x16x32_bf16 v[152:155], v[160:163], v[108:111], v[152:155]
ds_read_b64_tr_b16 v[70:71], v8 offset:2048
v_mfma_f32_16x16x32_bf16 v[156:159], v[164:167], v[108:111], v[156:159]
ds_read_b128 v[44:47], v3 offset:768
v_mfma_f32_16x16x32_bf16 v[128:131], v[168:171], v[112:115], v[128:131]
ds_read_b64_tr_b16 v[72:73], v7 offset:4096
v_mfma_f32_16x16x32_bf16 v[132:135], v[172:175], v[112:115], v[132:135]
ds_read_b128 v[48:51], v3 offset:8192
v_mfma_f32_16x16x32_bf16 v[136:139], v[168:171], v[116:119], v[136:139]
ds_read_b64_tr_b16 v[74:75], v7 offset:6144
v_mfma_f32_16x16x32_bf16 v[140:143], v[172:175], v[116:119], v[140:143]
ds_read_b128 v[52:55], v3 offset:8448
v_mfma_f32_16x16x32_bf16 v[144:147], v[168:171], v[120:123], v[144:147]
ds_read_b64_tr_b16 v[76:77], v8 offset:4096
v_mfma_f32_16x16x32_bf16 v[148:151], v[172:175], v[120:123], v[148:151]
ds_read_b128 v[56:59], v3 offset:8704
v_mfma_f32_16x16x32_bf16 v[152:155], v[168:171], v[124:127], v[152:155]
ds_read_b64_tr_b16 v[78:79], v8 offset:6144
v_mfma_f32_16x16x32_bf16 v[156:159], v[172:175], v[124:127], v[156:159]
ds_read_b128 v[60:63], v3 offset:8960
s_waitcnt lgkmcnt(0)
s_barrier
v_mfma_f32_16x16x32_bf16 v[128:131], v[64:67], v[32:35], v[128:131]
ds_read_b64_tr_b16 v[160:161], v7 offset:32768
v_mfma_f32_16x16x32_bf16 v[132:135], v[68:71], v[32:35], v[132:135]
ds_read_b128 v[96:99], v3 offset:32768
v_mfma_f32_16x16x32_bf16 v[136:139], v[64:67], v[36:39], v[136:139]
ds_read_b64_tr_b16 v[162:163], v7 offset:34816
v_mfma_f32_16x16x32_bf16 v[140:143], v[68:71], v[36:39], v[140:143]
ds_read_b128 v[100:103], v3 offset:33024
v_mfma_f32_16x16x32_bf16 v[144:147], v[64:67], v[40:43], v[144:147]
ds_read_b64_tr_b16 v[164:165], v8 offset:32768
v_mfma_f32_16x16x32_bf16 v[148:151], v[68:71], v[40:43], v[148:151]
ds_read_b128 v[104:107], v3 offset:33280
v_mfma_f32_16x16x32_bf16 v[152:155], v[64:67], v[44:47], v[152:155]
ds_read_b64_tr_b16 v[166:167], v8 offset:34816
v_mfma_f32_16x16x32_bf16 v[156:159], v[68:71], v[44:47], v[156:159]
ds_read_b128 v[108:111], v3 offset:33536
v_mfma_f32_16x16x32_bf16 v[128:131], v[72:75], v[48:51], v[128:131]
ds_read_b64_tr_b16 v[168:169], v7 offset:36864
v_mfma_f32_16x16x32_bf16 v[132:135], v[76:79], v[48:51], v[132:135]
ds_read_b128 v[112:115], v3 offset:40960
v_mfma_f32_16x16x32_bf16 v[136:139], v[72:75], v[52:55], v[136:139]
ds_read_b64_tr_b16 v[170:171], v7 offset:38912
v_mfma_f32_16x16x32_bf16 v[140:143], v[76:79], v[52:55], v[140:143]
ds_read_b128 v[116:119], v3 offset:41216
v_mfma_f32_16x16x32_bf16 v[144:147], v[72:75], v[56:59], v[144:147]
ds_read_b64_tr_b16 v[172:173], v8 offset:36864
v_mfma_f32_16x16x32_bf16 v[148:151], v[76:79], v[56:59], v[148:151]
ds_read_b128 v[120:123], v3 offset:41472
v_mfma_f32_16x16x32_bf16 v[152:155], v[72:75], v[60:63], v[152:155]
ds_read_b64_tr_b16 v[174:175], v8 offset:38912
v_mfma_f32_16x16x32_bf16 v[156:159], v[76:79], v[60:63], v[156:159]
ds_read_b128 v[124:127], v3 offset:41728
s_waitcnt lgkmcnt(0)
s_barrier
v_mfma_f32_16x16x32_bf16 v[128:131], v[160:163], v[96:99], v[128:131]
ds_read_b64_tr_b16 v[64:65], v5 offset:0
v_mfma_f32_16x16x32_bf16 v[132:135], v[164:167], v[96:99], v[132:135]
ds_read_b128 v[32:35], v2 offset:0
v_mfma_f32_16x16x32_bf16 v[136:139], v[160:163], v[100:103], v[136:139]
ds_read_b64_tr_b16 v[66:67], v5 offset:2048
v_mfma_f32_16x16x32_bf16 v[140:143], v[164:167], v[100:103], v[140:143]
ds_read_b128 v[36:39], v2 offset:256
buffer_load_dwordx4 v[192:195], v9, s[68:71], 0 offen offset:0 sc1
v_mfma_f32_16x16x32_bf16 v[144:147], v[160:163], v[104:107], v[144:147]
ds_read_b64_tr_b16 v[68:69], v6 offset:0
v_mfma_f32_16x16x32_bf16 v[148:151], v[164:167], v[104:107], v[148:151]
ds_read_b128 v[40:43], v2 offset:512
v_mfma_f32_16x16x32_bf16 v[152:155], v[160:163], v[108:111], v[152:155]
ds_read_b64_tr_b16 v[70:71], v6 offset:2048
buffer_load_dwordx4 v[196:199], v9, s[68:71], 0 offen offset:1024 sc1
v_mfma_f32_16x16x32_bf16 v[156:159], v[164:167], v[108:111], v[156:159]
ds_read_b128 v[44:47], v2 offset:768
v_mfma_f32_16x16x32_bf16 v[128:131], v[168:171], v[112:115], v[128:131]
ds_read_b64_tr_b16 v[72:73], v5 offset:4096
v_mfma_f32_16x16x32_bf16 v[132:135], v[172:175], v[112:115], v[132:135]
ds_read_b128 v[48:51], v2 offset:8192
buffer_load_dwordx4 v[200:203], v9, s[68:71], 0 offen offset:2048 sc1
v_mfma_f32_16x16x32_bf16 v[136:139], v[168:171], v[116:119], v[136:139]
ds_read_b64_tr_b16 v[74:75], v5 offset:6144
v_mfma_f32_16x16x32_bf16 v[140:143], v[172:175], v[116:119], v[140:143]
ds_read_b128 v[52:55], v2 offset:8448
v_mfma_f32_16x16x32_bf16 v[144:147], v[168:171], v[120:123], v[144:147]
ds_read_b64_tr_b16 v[76:77], v6 offset:4096
buffer_load_dwordx4 v[204:207], v9, s[68:71], 0 offen offset:3072 sc1
v_mfma_f32_16x16x32_bf16 v[148:151], v[172:175], v[120:123], v[148:151]
ds_read_b128 v[56:59], v2 offset:8704
v_mfma_f32_16x16x32_bf16 v[152:155], v[168:171], v[124:127], v[152:155]
ds_read_b64_tr_b16 v[78:79], v6 offset:6144
v_mfma_f32_16x16x32_bf16 v[156:159], v[172:175], v[124:127], v[156:159]
ds_read_b128 v[60:63], v2 offset:8960
s_waitcnt lgkmcnt(0)
s_barrier
v_mfma_f32_16x16x32_bf16 v[128:131], v[64:67], v[32:35], v[128:131]
ds_read_b64_tr_b16 v[160:161], v5 offset:32768
v_mfma_f32_16x16x32_bf16 v[132:135], v[68:71], v[32:35], v[132:135]
ds_read_b128 v[96:99], v2 offset:32768
v_mfma_f32_16x16x32_bf16 v[136:139], v[64:67], v[36:39], v[136:139]
ds_read_b64_tr_b16 v[162:163], v5 offset:34816
v_mfma_f32_16x16x32_bf16 v[140:143], v[68:71], v[36:39], v[140:143]
ds_read_b128 v[100:103], v2 offset:33024
v_mfma_f32_16x16x32_bf16 v[144:147], v[64:67], v[40:43], v[144:147]
ds_read_b64_tr_b16 v[164:165], v6 offset:32768
v_mfma_f32_16x16x32_bf16 v[148:151], v[68:71], v[40:43], v[148:151]
ds_read_b128 v[104:107], v2 offset:33280
v_mfma_f32_16x16x32_bf16 v[152:155], v[64:67], v[44:47], v[152:155]
ds_read_b64_tr_b16 v[166:167], v6 offset:34816
v_mfma_f32_16x16x32_bf16 v[156:159], v[68:71], v[44:47], v[156:159]
ds_read_b128 v[108:111], v2 offset:33536
v_mfma_f32_16x16x32_bf16 v[128:131], v[72:75], v[48:51], v[128:131]
ds_read_b64_tr_b16 v[168:169], v5 offset:36864
v_mfma_f32_16x16x32_bf16 v[132:135], v[76:79], v[48:51], v[132:135]
ds_read_b128 v[112:115], v2 offset:40960
v_mfma_f32_16x16x32_bf16 v[136:139], v[72:75], v[52:55], v[136:139]
ds_read_b64_tr_b16 v[170:171], v5 offset:38912
v_mfma_f32_16x16x32_bf16 v[140:143], v[76:79], v[52:55], v[140:143]
ds_read_b128 v[116:119], v2 offset:41216
v_mfma_f32_16x16x32_bf16 v[144:147], v[72:75], v[56:59], v[144:147]
ds_read_b64_tr_b16 v[172:173], v6 offset:36864
v_mfma_f32_16x16x32_bf16 v[148:151], v[76:79], v[56:59], v[148:151]
ds_read_b128 v[120:123], v2 offset:41472
v_mfma_f32_16x16x32_bf16 v[152:155], v[72:75], v[60:63], v[152:155]
ds_read_b64_tr_b16 v[174:175], v6 offset:38912
v_mfma_f32_16x16x32_bf16 v[156:159], v[76:79], v[60:63], v[156:159]
ds_read_b128 v[124:127], v2 offset:41728
s_waitcnt lgkmcnt(0)
s_barrier
v_mfma_f32_16x16x32_bf16 v[128:131], v[160:163], v[96:99], v[128:131]
v_mfma_f32_16x16x32_bf16 v[132:135], v[164:167], v[96:99], v[132:135]
v_mfma_f32_16x16x32_bf16 v[136:139], v[160:163], v[100:103], v[136:139]
v_mfma_f32_16x16x32_bf16 v[140:143], v[164:167], v[100:103], v[140:143]
v_mfma_f32_16x16x32_bf16 v[144:147], v[160:163], v[104:107], v[144:147]
v_mfma_f32_16x16x32_bf16 v[148:151], v[164:167], v[104:107], v[148:151]
v_mfma_f32_16x16x32_bf16 v[152:155], v[160:163], v[108:111], v[152:155]
v_mfma_f32_16x16x32_bf16 v[156:159], v[164:167], v[108:111], v[156:159]
s_waitcnt vmcnt(0)
v_mfma_f32_16x16x32_bf16 v[128:131], v[168:171], v[112:115], v[128:131]
v_lshlrev_b32 v224, 16, v192
v_and_b32 v225, 0xffff0000, v192
v_lshlrev_b32 v226, 16, v193
v_and_b32 v227, 0xffff0000, v193
v_mfma_f32_16x16x32_bf16 v[132:135], v[172:175], v[112:115], v[132:135]
v_lshlrev_b32 v228, 16, v194
v_and_b32 v229, 0xffff0000, v194
v_lshlrev_b32 v230, 16, v195
v_and_b32 v231, 0xffff0000, v195
v_mfma_f32_16x16x32_bf16 v[136:139], v[168:171], v[116:119], v[136:139]
v_lshlrev_b32 v232, 16, v196
v_and_b32 v233, 0xffff0000, v196
v_lshlrev_b32 v234, 16, v197
v_and_b32 v235, 0xffff0000, v197
v_mfma_f32_16x16x32_bf16 v[140:143], v[172:175], v[116:119], v[140:143]
v_lshlrev_b32 v236, 16, v198
v_and_b32 v237, 0xffff0000, v198
v_lshlrev_b32 v238, 16, v199
v_and_b32 v239, 0xffff0000, v199
v_mfma_f32_16x16x32_bf16 v[144:147], v[168:171], v[120:123], v[144:147]
v_lshlrev_b32 v240, 16, v200
v_and_b32 v241, 0xffff0000, v200
v_lshlrev_b32 v242, 16, v201
v_and_b32 v243, 0xffff0000, v201
v_mfma_f32_16x16x32_bf16 v[148:151], v[172:175], v[120:123], v[148:151]
v_lshlrev_b32 v244, 16, v202
v_and_b32 v245, 0xffff0000, v202
v_lshlrev_b32 v246, 16, v203
v_and_b32 v247, 0xffff0000, v203
v_mfma_f32_16x16x32_bf16 v[152:155], v[168:171], v[124:127], v[152:155]
v_lshlrev_b32 v248, 16, v204
v_and_b32 v249, 0xffff0000, v204
v_lshlrev_b32 v250, 16, v205
v_and_b32 v251, 0xffff0000, v205
v_mfma_f32_16x16x32_bf16 v[156:159], v[172:175], v[124:127], v[156:159]
v_lshlrev_b32 v252, 16, v206
v_and_b32 v253, 0xffff0000, v206
v_lshlrev_b32 v254, 16, v207
v_and_b32 v255, 0xffff0000, v207
s_waitcnt vmcnt(0)
s_nop 4
v_pk_add_f32 v[128:129], v[128:129], v[224:225]
v_pk_add_f32 v[130:131], v[130:131], v[226:227]
v_pk_add_f32 v[132:133], v[132:133], v[228:229]
v_pk_add_f32 v[134:135], v[134:135], v[230:231]
v_cvt_pk_bf16_f32 v32, v128, v129
v_cvt_pk_bf16_f32 v33, v130, v131
v_cvt_pk_bf16_f32 v34, v132, v133
v_cvt_pk_bf16_f32 v35, v134, v135
v_pk_add_f32 v[136:137], v[136:137], v[232:233]
v_pk_add_f32 v[138:139], v[138:139], v[234:235]
v_pk_add_f32 v[140:141], v[140:141], v[236:237]
v_pk_add_f32 v[142:143], v[142:143], v[238:239]
v_cvt_pk_bf16_f32 v36, v136, v137
v_cvt_pk_bf16_f32 v37, v138, v139
v_cvt_pk_bf16_f32 v38, v140, v141
v_cvt_pk_bf16_f32 v39, v142, v143
v_pk_add_f32 v[144:145], v[144:145], v[240:241]
v_pk_add_f32 v[146:147], v[146:147], v[242:243]
v_pk_add_f32 v[148:149], v[148:149], v[244:245]
v_pk_add_f32 v[150:151], v[150:151], v[246:247]
v_cvt_pk_bf16_f32 v40, v144, v145
v_cvt_pk_bf16_f32 v41, v146, v147
v_cvt_pk_bf16_f32 v42, v148, v149
v_cvt_pk_bf16_f32 v43, v150, v151
v_pk_add_f32 v[152:153], v[152:153], v[248:249]
v_pk_add_f32 v[154:155], v[154:155], v[250:251]
v_pk_add_f32 v[156:157], v[156:157], v[252:253]
v_pk_add_f32 v[158:159], v[158:159], v[254:255]
v_cvt_pk_bf16_f32 v44, v152, v153
v_cvt_pk_bf16_f32 v45, v154, v155
v_cvt_pk_bf16_f32 v46, v156, v157
v_cvt_pk_bf16_f32 v47, v158, v159
v_permlane16_swap_b32 v32, v34
v_permlane16_swap_b32 v33, v35
buffer_store_dwordx4 v[32:35], v28, s[16:19], 0 offen offset:0
v_permlane16_swap_b32 v36, v38
v_permlane16_swap_b32 v37, v39
buffer_store_dwordx4 v[36:39], v28, s[16:19], 0 offen offset:2048
v_permlane16_swap_b32 v40, v42
v_permlane16_swap_b32 v41, v43
buffer_store_dwordx4 v[40:43], v28, s[16:19], s54 offen offset:0
v_permlane16_swap_b32 v44, v46
v_permlane16_swap_b32 v45, v47
buffer_store_dwordx4 v[44:47], v28, s[16:19], s54 offen offset:2048
s_branch Ldone_1
.p2align 6
Lw_24:
s_branch Lr_25
s_nop 0
.p2align 3
LG1_50:
s_cmp_eq_u32 s36, 7
s_cbranch_scc1 L7_133
s_mul_i32 s44, s34, 262144
s_lshl_b32 s39, s51, 13
s_add_u32 s44, s44, s39
s_add_u32 s44, s44, 0
s_lshl_b32 s43, s35, 7
s_mov_b32 s10, 253952
s_movk_i32 s38, 1024
s_movk_i32 s40, 9216
s_cmp_eq_u32 s51, 2
s_cselect_b32 s8, s28, s32
s_cselect_b32 s9, s29, s33
s_cselect_b32 s10, 2095232, s10
s_cselect_b32 s43, s43, s44
s_cselect_b32 s38, 16384, s38
s_cselect_b32 s40, 16384, s40
s_cselect_b32 s55, 16384, s38
s_cselect_b32 s45, -1, 0
s_add_u32 s8, s8, s43
s_addc_u32 s9, s9, 0
s_mov_b32 s11, 0x20000
s_sub_u32 s37, 0, s40
v_lshrrev_b32 v19, 3, v1
v_mul_u32_u24 v19, 1920, v19
v_lshrrev_b32 v20, 4, v1
v_lshlrev_b32 v20, 5, v20
v_and_b32 v19, s45, v19
v_and_b32 v20, s45, v20
v_lshlrev_b32 v23, 4, v1
v_xor_b32 v23, v23, v20
v_add_u32 v23, v23, v19
s_lshl_b32 s43, s34, 18
s_add_u32 s12, s32, s43
s_addc_u32 s13, s33, 0
s_mov_b32 s14, 262144
s_mov_b32 s15, 0x20000
v_lshlrev_b32 v21, 4, v1
s_lshl_b32 s54, s36, 11
s_xor_b32 s43, s35, 1
s_and_b32 s43, s43, 15
s_lshl_b32 s43, s43, 14
s_add_u32 s30, s43, s54
s_xor_b32 s43, s35, 2
s_and_b32 s43, s43, 15
s_lshl_b32 s43, s43, 14
s_add_u32 s31, s43, s54
s_cmp_eq_u32 s51, 1
s_cbranch_scc1 Lp_137
s_cmp_eq_u32 s51, 2
s_cbranch_scc1 Lp_138
.p2align 3
Lp_136:
s_mov_b32 s42, 2
s_waitcnt vmcnt(0)
s_barrier
ds_write_b128 v27, v[68:71] offset:0
ds_write_b128 v27, v[116:119] offset:512
s_waitcnt lgkmcnt(0)
s_barrier
s_add_u32 m0, s54, 16384
s_add_u32 s43, s30, 0
buffer_load_dwordx4 v21, s[12:15], s43 offen sc1 lds
s_add_u32 m0, s54, 17408
s_add_u32 s43, s30, 1024
buffer_load_dwordx4 v21, s[12:15], s43 offen sc1 lds
s_add_u32 m0, s54, 32768
s_add_u32 s43, s31, 0
buffer_load_dwordx4 v21, s[12:15], s43 offen sc1 lds
s_add_u32 m0, s54, 33792
s_add_u32 s43, s31, 1024
buffer_load_dwordx4 v21, s[12:15], s43 offen sc1 lds
s_add_u32 s42, s42, 1
s_xor_b32 s37, s42, s35
s_add_u32 m0, s39, 49152
s_lshl_b32 s37, s37, 14
buffer_load_dwordx4 v23, s[8:11], s37 offen sc1 lds
s_add_u32 m0, s39, 50176
s_add_u32 s37, s37, s38
buffer_load_dwordx4 v23, s[8:11], s37 offen sc1 lds
s_add_u32 m0, s39, 51200
s_add_u32 s37, s37, s38
buffer_load_dwordx4 v23, s[8:11], s37 offen sc1 lds
s_add_u32 m0, s39, 52224
s_add_u32 s37, s37, s38
buffer_load_dwordx4 v23, s[8:11], s37 offen sc1 lds
s_add_u32 m0, s39, 53248
s_add_u32 s37, s37, s38
buffer_load_dwordx4 v23, s[8:11], s37 offen sc1 lds
s_add_u32 m0, s39, 54272
s_add_u32 s37, s37, s38
buffer_load_dwordx4 v23, s[8:11], s37 offen sc1 lds
s_add_u32 m0, s39, 55296
s_add_u32 s37, s37, s38
buffer_load_dwordx4 v23, s[8:11], s37 offen sc1 lds
s_add_u32 m0, s39, 56320
s_add_u32 s37, s37, s38
buffer_load_dwordx4 v23, s[8:11], s37 offen sc1 lds
s_waitcnt vmcnt(10)
s_barrier
s_add_u32 s42, s42, 1
s_xor_b32 s37, s42, s35
s_add_u32 m0, s39, 0
s_lshl_b32 s37, s37, 14
buffer_load_dwordx4 v23, s[8:11], s37 offen sc1 lds
s_add_u32 m0, s39, 1024
s_add_u32 s37, s37, s38
buffer_load_dwordx4 v23, s[8:11], s37 offen sc1 lds
s_add_u32 m0, s39, 2048
s_add_u32 s37, s37, s38
buffer_load_dwordx4 v23, s[8:11], s37 offen sc1 lds
s_add_u32 m0, s39, 3072
s_add_u32 s37, s37, s38
buffer_load_dwordx4 v23, s[8:11], s37 offen sc1 lds
s_add_u32 m0, s39, 4096
s_add_u32 s37, s37, s38
buffer_load_dwordx4 v23, s[8:11], s37 offen sc1 lds
s_add_u32 m0, s39, 5120
s_add_u32 s37, s37, s38
buffer_load_dwordx4 v23, s[8:11], s37 offen sc1 lds
s_add_u32 m0, s39, 6144
s_add_u32 s37, s37, s38
buffer_load_dwordx4 v23, s[8:11], s37 offen sc1 lds
s_add_u32 m0, s39, 7168
s_add_u32 s37, s37, s38
buffer_load_dwordx4 v23, s[8:11], s37 offen sc1 lds
s_waitcnt vmcnt(16)
s_barrier
s_add_u32 s42, s42, 1
s_xor_b32 s37, s42, s35
s_add_u32 m0, s39, 16384
s_lshl_b32 s37, s37, 14
buffer_load_dwordx4 v23, s[8:11], s37 offen sc1 lds
s_add_u32 m0, s39, 17408
s_add_u32 s37, s37, s38
buffer_load_dwordx4 v23, s[8:11], s37 offen sc1 lds
s_add_u32 m0, s39, 18432
s_add_u32 s37, s37, s38
buffer_load_dwordx4 v23, s[8:11], s37 offen sc1 lds
s_add_u32 m0, s39, 19456
s_add_u32 s37, s37, s38
buffer_load_dwordx4 v23, s[8:11], s37 offen sc1 lds
s_add_u32 m0, s39, 20480
s_add_u32 s37, s37, s38
buffer_load_dwordx4 v23, s[8:11], s37 offen sc1 lds
s_add_u32 m0, s39, 21504
s_add_u32 s37, s37, s38
buffer_load_dwordx4 v23, s[8:11], s37 offen sc1 lds
s_add_u32 m0, s39, 22528
s_add_u32 s37, s37, s38
buffer_load_dwordx4 v23, s[8:11], s37 offen sc1 lds
s_add_u32 m0, s39, 23552
s_add_u32 s37, s37, s38
buffer_load_dwordx4 v23, s[8:11], s37 offen sc1 lds
s_waitcnt vmcnt(16)
s_barrier
s_add_u32 s42, s42, 1
s_xor_b32 s37, s42, s35
s_add_u32 m0, s39, 32768
s_lshl_b32 s37, s37, 14
buffer_load_dwordx4 v23, s[8:11], s37 offen sc1 lds
s_add_u32 m0, s39, 33792
s_add_u32 s37, s37, s38
buffer_load_dwordx4 v23, s[8:11], s37 offen sc1 lds
s_add_u32 m0, s39, 34816
s_add_u32 s37, s37, s38
buffer_load_dwordx4 v23, s[8:11], s37 offen sc1 lds
s_add_u32 m0, s39, 35840
s_add_u32 s37, s37, s38
buffer_load_dwordx4 v23, s[8:11], s37 offen sc1 lds
s_add_u32 m0, s39, 36864
s_add_u32 s37, s37, s38
buffer_load_dwordx4 v23, s[8:11], s37 offen sc1 lds
s_add_u32 m0, s39, 37888
s_add_u32 s37, s37, s38
buffer_load_dwordx4 v23, s[8:11], s37 offen sc1 lds
s_add_u32 m0, s39, 38912
s_add_u32 s37, s37, s38
buffer_load_dwordx4 v23, s[8:11], s37 offen sc1 lds
s_add_u32 m0, s39, 39936
s_add_u32 s37, s37, s38
buffer_load_dwordx4 v23, s[8:11], s37 offen sc1 lds
s_waitcnt vmcnt(16)
s_barrier
s_add_u32 s42, s42, 1
s_xor_b32 s37, s42, s35
s_add_u32 m0, s39, 49152
s_lshl_b32 s37, s37, 14
buffer_load_dwordx4 v23, s[8:11], s37 offen sc1 lds
s_add_u32 m0, s39, 50176
s_add_u32 s37, s37, s38
buffer_load_dwordx4 v23, s[8:11], s37 offen sc1 lds
s_add_u32 m0, s39, 51200
s_add_u32 s37, s37, s38
buffer_load_dwordx4 v23, s[8:11], s37 offen sc1 lds
s_add_u32 m0, s39, 52224
s_add_u32 s37, s37, s38
buffer_load_dwordx4 v23, s[8:11], s37 offen sc1 lds
s_add_u32 m0, s39, 53248
s_add_u32 s37, s37, s38
buffer_load_dwordx4 v23, s[8:11], s37 offen sc1 lds
s_add_u32 m0, s39, 54272
s_add_u32 s37, s37, s38
buffer_load_dwordx4 v23, s[8:11], s37 offen sc1 lds
s_add_u32 m0, s39, 55296
s_add_u32 s37, s37, s38
buffer_load_dwordx4 v23, s[8:11], s37 offen sc1 lds
s_add_u32 m0, s39, 56320
s_add_u32 s37, s37, s38
buffer_load_dwordx4 v23, s[8:11], s37 offen sc1 lds
s_waitcnt vmcnt(16)
s_barrier
s_add_u32 s42, s42, 1
s_xor_b32 s37, s42, s35
s_add_u32 m0, s39, 0
s_lshl_b32 s37, s37, 14
buffer_load_dwordx4 v23, s[8:11], s37 offen sc1 lds
s_add_u32 m0, s39, 1024
s_add_u32 s37, s37, s38
buffer_load_dwordx4 v23, s[8:11], s37 offen sc1 lds
s_add_u32 m0, s39, 2048
s_add_u32 s37, s37, s38
buffer_load_dwordx4 v23, s[8:11], s37 offen sc1 lds
s_add_u32 m0, s39, 3072
s_add_u32 s37, s37, s38
buffer_load_dwordx4 v23, s[8:11], s37 offen sc1 lds
s_add_u32 m0, s39, 4096
s_add_u32 s37, s37, s38
buffer_load_dwordx4 v23, s[8:11], s37 offen sc1 lds
s_add_u32 m0, s39, 5120
s_add_u32 s37, s37, s38
buffer_load_dwordx4 v23, s[8:11], s37 offen sc1 lds
s_add_u32 m0, s39, 6144
s_add_u32 s37, s37, s38
buffer_load_dwordx4 v23, s[8:11], s37 offen sc1 lds
s_add_u32 m0, s39, 7168
s_add_u32 s37, s37, s38
buffer_load_dwordx4 v23, s[8:11], s37 offen sc1 lds
s_waitcnt vmcnt(16)
s_barrier
s_add_u32 s42, s42, 1
s_xor_b32 s37, s42, s35
s_add_u32 m0, s39, 16384
s_lshl_b32 s37, s37, 14
buffer_load_dwordx4 v23, s[8:11], s37 offen sc1 lds
s_add_u32 m0, s39, 17408
s_add_u32 s37, s37, s38
buffer_load_dwordx4 v23, s[8:11], s37 offen sc1 lds
s_add_u32 m0, s39, 18432
s_add_u32 s37, s37, s38
buffer_load_dwordx4 v23, s[8:11], s37 offen sc1 lds
s_add_u32 m0, s39, 19456
s_add_u32 s37, s37, s38
buffer_load_dwordx4 v23, s[8:11], s37 offen sc1 lds
s_add_u32 m0, s39, 20480
s_add_u32 s37, s37, s38
buffer_load_dwordx4 v23, s[8:11], s37 offen sc1 lds
s_add_u32 m0, s39, 21504
s_add_u32 s37, s37, s38
buffer_load_dwordx4 v23, s[8:11], s37 offen sc1 lds
s_add_u32 m0, s39, 22528
s_add_u32 s37, s37, s38
buffer_load_dwordx4 v23, s[8:11], s37 offen sc1 lds
s_add_u32 m0, s39, 23552
s_add_u32 s37, s37, s38
buffer_load_dwordx4 v23, s[8:11], s37 offen sc1 lds
s_waitcnt vmcnt(16)
s_barrier
s_add_u32 s42, s42, 1
s_xor_b32 s37, s42, s35
s_add_u32 m0, s39, 32768
s_lshl_b32 s37, s37, 14
buffer_load_dwordx4 v23, s[8:11], s37 offen sc1 lds
s_add_u32 m0, s39, 33792
s_add_u32 s37, s37, s38
buffer_load_dwordx4 v23, s[8:11], s37 offen sc1 lds
s_add_u32 m0, s39, 34816
s_add_u32 s37, s37, s38
buffer_load_dwordx4 v23, s[8:11], s37 offen sc1 lds
s_add_u32 m0, s39, 35840
s_add_u32 s37, s37, s38
buffer_load_dwordx4 v23, s[8:11], s37 offen sc1 lds
s_add_u32 m0, s39, 36864
s_add_u32 s37, s37, s38
buffer_load_dwordx4 v23, s[8:11], s37 offen sc1 lds
s_add_u32 m0, s39, 37888
s_add_u32 s37, s37, s38
buffer_load_dwordx4 v23, s[8:11], s37 offen sc1 lds
s_add_u32 m0, s39, 38912
s_add_u32 s37, s37, s38
buffer_load_dwordx4 v23, s[8:11], s37 offen sc1 lds
s_add_u32 m0, s39, 39936
s_add_u32 s37, s37, s38
buffer_load_dwordx4 v23, s[8:11], s37 offen sc1 lds
s_waitcnt vmcnt(16)
s_barrier
s_add_u32 s42, s42, 1
s_xor_b32 s37, s42, s35
s_add_u32 m0, s39, 49152
s_lshl_b32 s37, s37, 14
buffer_load_dwordx4 v23, s[8:11], s37 offen sc1 lds
s_add_u32 m0, s39, 50176
s_add_u32 s37, s37, s38
buffer_load_dwordx4 v23, s[8:11], s37 offen sc1 lds
s_add_u32 m0, s39, 51200
s_add_u32 s37, s37, s38
buffer_load_dwordx4 v23, s[8:11], s37 offen sc1 lds
s_add_u32 m0, s39, 52224
s_add_u32 s37, s37, s38
buffer_load_dwordx4 v23, s[8:11], s37 offen sc1 lds
s_add_u32 m0, s39, 53248
s_add_u32 s37, s37, s38
buffer_load_dwordx4 v23, s[8:11], s37 offen sc1 lds
s_add_u32 m0, s39, 54272
s_add_u32 s37, s37, s38
buffer_load_dwordx4 v23, s[8:11], s37 offen sc1 lds
s_add_u32 m0, s39, 55296
s_add_u32 s37, s37, s38
buffer_load_dwordx4 v23, s[8:11], s37 offen sc1 lds
s_add_u32 m0, s39, 56320
s_add_u32 s37, s37, s38
buffer_load_dwordx4 v23, s[8:11], s37 offen sc1 lds
s_waitcnt vmcnt(16)
s_barrier
s_add_u32 s42, s42, 1
s_xor_b32 s37, s42, s35
s_add_u32 m0, s39, 0
s_lshl_b32 s37, s37, 14
buffer_load_dwordx4 v23, s[8:11], s37 offen sc1 lds
s_add_u32 m0, s39, 1024
s_add_u32 s37, s37, s38
buffer_load_dwordx4 v23, s[8:11], s37 offen sc1 lds
s_add_u32 m0, s39, 2048
s_add_u32 s37, s37, s38
buffer_load_dwordx4 v23, s[8:11], s37 offen sc1 lds
s_add_u32 m0, s39, 3072
s_add_u32 s37, s37, s38
buffer_load_dwordx4 v23, s[8:11], s37 offen sc1 lds
s_add_u32 m0, s39, 4096
s_add_u32 s37, s37, s38
buffer_load_dwordx4 v23, s[8:11], s37 offen sc1 lds
s_add_u32 m0, s39, 5120
s_add_u32 s37, s37, s38
buffer_load_dwordx4 v23, s[8:11], s37 offen sc1 lds
s_add_u32 m0, s39, 6144
s_add_u32 s37, s37, s38
buffer_load_dwordx4 v23, s[8:11], s37 offen sc1 lds
s_add_u32 m0, s39, 7168
s_add_u32 s37, s37, s38
buffer_load_dwordx4 v23, s[8:11], s37 offen sc1 lds
s_waitcnt vmcnt(16)
s_barrier
s_add_u32 s42, s42, 1
s_xor_b32 s37, s42, s35
s_add_u32 m0, s39, 16384
s_lshl_b32 s37, s37, 14
buffer_load_dwordx4 v23, s[8:11], s37 offen sc1 lds
s_add_u32 m0, s39, 17408
s_add_u32 s37, s37, s38
buffer_load_dwordx4 v23, s[8:11], s37 offen sc1 lds
s_add_u32 m0, s39, 18432
s_add_u32 s37, s37, s38
buffer_load_dwordx4 v23, s[8:11], s37 offen sc1 lds
s_add_u32 m0, s39, 19456
s_add_u32 s37, s37, s38
buffer_load_dwordx4 v23, s[8:11], s37 offen sc1 lds
s_add_u32 m0, s39, 20480
s_add_u32 s37, s37, s38
buffer_load_dwordx4 v23, s[8:11], s37 offen sc1 lds
s_add_u32 m0, s39, 21504
s_add_u32 s37, s37, s38
buffer_load_dwordx4 v23, s[8:11], s37 offen sc1 lds
s_add_u32 m0, s39, 22528
s_add_u32 s37, s37, s38
buffer_load_dwordx4 v23, s[8:11], s37 offen sc1 lds
s_add_u32 m0, s39, 23552
s_add_u32 s37, s37, s38
buffer_load_dwordx4 v23, s[8:11], s37 offen sc1 lds
s_waitcnt vmcnt(16)
s_barrier
s_add_u32 s42, s42, 1
s_xor_b32 s37, s42, s35
s_add_u32 m0, s39, 32768
s_lshl_b32 s37, s37, 14
buffer_load_dwordx4 v23, s[8:11], s37 offen sc1 lds
s_add_u32 m0, s39, 33792
s_add_u32 s37, s37, s38
buffer_load_dwordx4 v23, s[8:11], s37 offen sc1 lds
s_add_u32 m0, s39, 34816
s_add_u32 s37, s37, s38
buffer_load_dwordx4 v23, s[8:11], s37 offen sc1 lds
s_add_u32 m0, s39, 35840
s_add_u32 s37, s37, s38
buffer_load_dwordx4 v23, s[8:11], s37 offen sc1 lds
s_add_u32 m0, s39, 36864
s_add_u32 s37, s37, s38
buffer_load_dwordx4 v23, s[8:11], s37 offen sc1 lds
s_add_u32 m0, s39, 37888
s_add_u32 s37, s37, s38
buffer_load_dwordx4 v23, s[8:11], s37 offen sc1 lds
s_add_u32 m0, s39, 38912
s_add_u32 s37, s37, s38
buffer_load_dwordx4 v23, s[8:11], s37 offen sc1 lds
s_add_u32 m0, s39, 39936
s_add_u32 s37, s37, s38
buffer_load_dwordx4 v23, s[8:11], s37 offen sc1 lds
s_waitcnt vmcnt(16)
s_barrier
s_add_u32 s42, s42, 1
s_xor_b32 s37, s42, s35
s_add_u32 m0, s39, 49152
s_lshl_b32 s37, s37, 14
buffer_load_dwordx4 v23, s[8:11], s37 offen sc1 lds
s_add_u32 m0, s39, 50176
s_add_u32 s37, s37, s38
buffer_load_dwordx4 v23, s[8:11], s37 offen sc1 lds
s_add_u32 m0, s39, 51200
s_add_u32 s37, s37, s38
buffer_load_dwordx4 v23, s[8:11], s37 offen sc1 lds
s_add_u32 m0, s39, 52224
s_add_u32 s37, s37, s38
buffer_load_dwordx4 v23, s[8:11], s37 offen sc1 lds
s_add_u32 m0, s39, 53248
s_add_u32 s37, s37, s38
buffer_load_dwordx4 v23, s[8:11], s37 offen sc1 lds
s_add_u32 m0, s39, 54272
s_add_u32 s37, s37, s38
buffer_load_dwordx4 v23, s[8:11], s37 offen sc1 lds
s_add_u32 m0, s39, 55296
s_add_u32 s37, s37, s38
buffer_load_dwordx4 v23, s[8:11], s37 offen sc1 lds
s_add_u32 m0, s39, 56320
s_add_u32 s37, s37, s38
buffer_load_dwordx4 v23, s[8:11], s37 offen sc1 lds
s_lshl_b32 s43, s35, 8
s_cmp_eq_u32 s51, 1
s_cselect_b32 s8, s4, s6
s_cselect_b32 s9, s5, s7
s_sub_u32 s10, 7340032, s43
s_lshl_b32 s44, s34, 18
s_add_u32 s44, s44, 4194304
s_movk_i32 s38, 28672
s_cmp_eq_u32 s51, 0
s_cselect_b32 s8, s32, s8
s_cselect_b32 s9, s33, s9
s_cselect_b32 s10, 262144, s10
s_cselect_b32 s43, s44, s43
s_cselect_b32 s38, 1024, s38
s_cselect_b32 s45, 0, -1
s_add_u32 s8, s8, s43
s_addc_u32 s9, s9, 0
s_mov_b32 s11, 0x20000
s_lshl_b32 s40, s38, 4
s_mov_b32 s42, -1
s_lshl_b32 s39, s51, 14
v_lshrrev_b32 v19, 4, v1
v_lshlrev_b32 v20, 5, v19
v_mul_u32_u24 v19, 6912, v19
v_and_b32 v19, s45, v19
v_and_b32 v20, s45, v20
v_lshlrev_b32 v21, 4, v1
v_xor_b32 v21, v21, v20
v_add_u32 v22, v21, v19
s_and_b32 s45, s45, 128
v_xor_b32 v23, s45, v22
s_waitcnt vmcnt(16)
s_barrier
s_waitcnt vmcnt(8)
s_barrier
s_waitcnt vmcnt(0)
s_barrier
s_barrier
s_barrier
s_add_u32 s43, s34, 16
s_lshl_b32 s43, s43, 7
v_mov_b32 v8, s43
v_mov_b32 v10, 16
buffer_load_dword v9, v8, s[56:59], 0 offen sc1
s_waitcnt vmcnt(0)
s_add_u32 s43, s34, 16
s_lshl_b32 s43, s43, 7
v_mov_b32 v8, s43
v_mov_b32 v10, 16
buffer_load_dword v9, v8, s[56:59], 0 offen sc1
s_waitcnt vmcnt(0)
s_add_u32 s42, s42, 1
s_add_u32 s42, s42, 1
s_xor_b32 s37, s42, s35
s_add_u32 m0, s39, 0
s_mul_i32 s37, s37, s40
buffer_load_dwordx4 v22, s[8:11], s37 offen sc1 lds
s_add_u32 m0, s39, 1024
s_add_u32 s37, s37, s38
buffer_load_dwordx4 v23, s[8:11], s37 offen sc1 lds
s_add_u32 m0, s39, 2048
s_add_u32 s37, s37, s38
buffer_load_dwordx4 v22, s[8:11], s37 offen sc1 lds
s_add_u32 m0, s39, 3072
s_add_u32 s37, s37, s38
buffer_load_dwordx4 v23, s[8:11], s37 offen sc1 lds
s_add_u32 m0, s39, 4096
s_add_u32 s37, s37, s38
buffer_load_dwordx4 v22, s[8:11], s37 offen sc1 lds
s_add_u32 m0, s39, 5120
s_add_u32 s37, s37, s38
buffer_load_dwordx4 v23, s[8:11], s37 offen sc1 lds
s_add_u32 m0, s39, 6144
s_add_u32 s37, s37, s38
buffer_load_dwordx4 v22, s[8:11], s37 offen sc1 lds
s_add_u32 m0, s39, 7168
s_add_u32 s37, s37, s38
buffer_load_dwordx4 v23, s[8:11], s37 offen sc1 lds
s_add_u32 m0, s39, 8192
s_add_u32 s37, s37, s38
buffer_load_dwordx4 v22, s[8:11], s37 offen sc1 lds
s_add_u32 m0, s39, 9216
s_add_u32 s37, s37, s38
buffer_load_dwordx4 v23, s[8:11], s37 offen sc1 lds
s_add_u32 m0, s39, 10240
s_add_u32 s37, s37, s38
buffer_load_dwordx4 v22, s[8:11], s37 offen sc1 lds
s_add_u32 m0, s39, 11264
s_add_u32 s37, s37, s38
buffer_load_dwordx4 v23, s[8:11], s37 offen sc1 lds
s_add_u32 m0, s39, 12288
s_add_u32 s37, s37, s38
buffer_load_dwordx4 v22, s[8:11], s37 offen sc1 lds
s_add_u32 m0, s39, 13312
s_add_u32 s37, s37, s38
buffer_load_dwordx4 v23, s[8:11], s37 offen sc1 lds
s_add_u32 m0, s39, 14336
s_add_u32 s37, s37, s38
buffer_load_dwordx4 v22, s[8:11], s37 offen sc1 lds
s_add_u32 m0, s39, 15360
s_add_u32 s37, s37, s38
buffer_load_dwordx4 v23, s[8:11], s37 offen sc1 lds
s_add_u32 s42, s42, 1
s_xor_b32 s37, s42, s35
s_add_u32 m0, s39, 49152
s_mul_i32 s37, s37, s40
buffer_load_dwordx4 v22, s[8:11], s37 offen sc1 lds
s_add_u32 m0, s39, 50176
s_add_u32 s37, s37, s38
buffer_load_dwordx4 v23, s[8:11], s37 offen sc1 lds
s_add_u32 m0, s39, 51200
s_add_u32 s37, s37, s38
buffer_load_dwordx4 v22, s[8:11], s37 offen sc1 lds
s_add_u32 m0, s39, 52224
s_add_u32 s37, s37, s38
buffer_load_dwordx4 v23, s[8:11], s37 offen sc1 lds
s_add_u32 m0, s39, 53248
s_add_u32 s37, s37, s38
buffer_load_dwordx4 v22, s[8:11], s37 offen sc1 lds
s_add_u32 m0, s39, 54272
s_add_u32 s37, s37, s38
buffer_load_dwordx4 v23, s[8:11], s37 offen sc1 lds
s_add_u32 m0, s39, 55296
s_add_u32 s37, s37, s38
buffer_load_dwordx4 v22, s[8:11], s37 offen sc1 lds
s_add_u32 m0, s39, 56320
s_add_u32 s37, s37, s38
buffer_load_dwordx4 v23, s[8:11], s37 offen sc1 lds
s_add_u32 m0, s39, 57344
s_add_u32 s37, s37, s38
buffer_load_dwordx4 v22, s[8:11], s37 offen sc1 lds
s_add_u32 m0, s39, 58368
s_add_u32 s37, s37, s38
buffer_load_dwordx4 v23, s[8:11], s37 offen sc1 lds
s_add_u32 m0, s39, 59392
s_add_u32 s37, s37, s38
buffer_load_dwordx4 v22, s[8:11], s37 offen sc1 lds
s_add_u32 m0, s39, 60416
s_add_u32 s37, s37, s38
buffer_load_dwordx4 v23, s[8:11], s37 offen sc1 lds
s_add_u32 m0, s39, 61440
s_add_u32 s37, s37, s38
buffer_load_dwordx4 v22, s[8:11], s37 offen sc1 lds
s_add_u32 m0, s39, 62464
s_add_u32 s37, s37, s38
buffer_load_dwordx4 v23, s[8:11], s37 offen sc1 lds
s_add_u32 m0, s39, 63488
s_add_u32 s37, s37, s38
buffer_load_dwordx4 v22, s[8:11], s37 offen sc1 lds
s_add_u32 m0, s39, 64512
s_add_u32 s37, s37, s38
buffer_load_dwordx4 v23, s[8:11], s37 offen sc1 lds
s_branch LP3_135
.p2align 6
Lw_22:
s_branch Lr_23
s_nop 0
.p2align 3
Lp_137:
s_mov_b32 s42, 2
s_waitcnt vmcnt(0)
s_barrier
s_add_u32 s43, s34, 0
s_lshl_b32 s43, s43, 7
v_mov_b32 v13, s43
v_mov_b32 v14, 1
s_mov_b64 exec, 1
buffer_atomic_add v14, v13, s[56:59], 0 offen sc1
s_mov_b64 exec, -1
ds_write_b128 v27, v[68:71] offset:0
ds_write_b128 v27, v[116:119] offset:512
s_waitcnt lgkmcnt(0)
s_barrier
s_add_u32 m0, s54, 16384
s_add_u32 s43, s30, 0
buffer_load_dwordx4 v21, s[12:15], s43 offen sc1 lds
s_add_u32 m0, s54, 17408
s_add_u32 s43, s30, 1024
buffer_load_dwordx4 v21, s[12:15], s43 offen sc1 lds
s_add_u32 m0, s54, 32768
s_add_u32 s43, s31, 0
buffer_load_dwordx4 v21, s[12:15], s43 offen sc1 lds
s_add_u32 m0, s54, 33792
s_add_u32 s43, s31, 1024
buffer_load_dwordx4 v21, s[12:15], s43 offen sc1 lds
s_add_u32 s42, s42, 1
s_xor_b32 s37, s42, s35
s_add_u32 m0, s39, 49152
s_lshl_b32 s37, s37, 14
buffer_load_dwordx4 v23, s[8:11], s37 offen sc1 lds
s_add_u32 m0, s39, 50176
s_add_u32 s37, s37, s38
buffer_load_dwordx4 v23, s[8:11], s37 offen sc1 lds
s_add_u32 m0, s39, 51200
s_add_u32 s37, s37, s38
buffer_load_dwordx4 v23, s[8:11], s37 offen sc1 lds
s_add_u32 m0, s39, 52224
s_add_u32 s37, s37, s38
buffer_load_dwordx4 v23, s[8:11], s37 offen sc1 lds
s_add_u32 m0, s39, 53248
s_add_u32 s37, s37, s38
buffer_load_dwordx4 v23, s[8:11], s37 offen sc1 lds
s_add_u32 m0, s39, 54272
s_add_u32 s37, s37, s38
buffer_load_dwordx4 v23, s[8:11], s37 offen sc1 lds
s_add_u32 m0, s39, 55296
s_add_u32 s37, s37, s38
buffer_load_dwordx4 v23, s[8:11], s37 offen sc1 lds
s_add_u32 m0, s39, 56320
s_add_u32 s37, s37, s38
buffer_load_dwordx4 v23, s[8:11], s37 offen sc1 lds
s_waitcnt vmcnt(10)
s_barrier
s_add_u32 s42, s42, 1
s_xor_b32 s37, s42, s35
s_add_u32 m0, s39, 0
s_lshl_b32 s37, s37, 14
buffer_load_dwordx4 v23, s[8:11], s37 offen sc1 lds
s_add_u32 m0, s39, 1024
s_add_u32 s37, s37, s38
buffer_load_dwordx4 v23, s[8:11], s37 offen sc1 lds
s_add_u32 m0, s39, 2048
s_add_u32 s37, s37, s38
buffer_load_dwordx4 v23, s[8:11], s37 offen sc1 lds
s_add_u32 m0, s39, 3072
s_add_u32 s37, s37, s38
buffer_load_dwordx4 v23, s[8:11], s37 offen sc1 lds
s_add_u32 m0, s39, 4096
s_add_u32 s37, s37, s38
buffer_load_dwordx4 v23, s[8:11], s37 offen sc1 lds
s_add_u32 m0, s39, 5120
s_add_u32 s37, s37, s38
buffer_load_dwordx4 v23, s[8:11], s37 offen sc1 lds
s_add_u32 m0, s39, 6144
s_add_u32 s37, s37, s38
buffer_load_dwordx4 v23, s[8:11], s37 offen sc1 lds
s_add_u32 m0, s39, 7168
s_add_u32 s37, s37, s38
buffer_load_dwordx4 v23, s[8:11], s37 offen sc1 lds
s_waitcnt vmcnt(16)
s_barrier
s_add_u32 s42, s42, 1
s_xor_b32 s37, s42, s35
s_add_u32 m0, s39, 16384
s_lshl_b32 s37, s37, 14
buffer_load_dwordx4 v23, s[8:11], s37 offen sc1 lds
s_add_u32 m0, s39, 17408
s_add_u32 s37, s37, s38
buffer_load_dwordx4 v23, s[8:11], s37 offen sc1 lds
s_add_u32 m0, s39, 18432
s_add_u32 s37, s37, s38
buffer_load_dwordx4 v23, s[8:11], s37 offen sc1 lds
s_add_u32 m0, s39, 19456
s_add_u32 s37, s37, s38
buffer_load_dwordx4 v23, s[8:11], s37 offen sc1 lds
s_add_u32 m0, s39, 20480
s_add_u32 s37, s37, s38
buffer_load_dwordx4 v23, s[8:11], s37 offen sc1 lds
s_add_u32 m0, s39, 21504
s_add_u32 s37, s37, s38
buffer_load_dwordx4 v23, s[8:11], s37 offen sc1 lds
s_add_u32 m0, s39, 22528
s_add_u32 s37, s37, s38
buffer_load_dwordx4 v23, s[8:11], s37 offen sc1 lds
s_add_u32 m0, s39, 23552
s_add_u32 s37, s37, s38
buffer_load_dwordx4 v23, s[8:11], s37 offen sc1 lds
s_waitcnt vmcnt(16)
s_barrier
s_add_u32 s42, s42, 1
s_xor_b32 s37, s42, s35
s_add_u32 m0, s39, 32768
s_lshl_b32 s37, s37, 14
buffer_load_dwordx4 v23, s[8:11], s37 offen sc1 lds
s_add_u32 m0, s39, 33792
s_add_u32 s37, s37, s38
buffer_load_dwordx4 v23, s[8:11], s37 offen sc1 lds
s_add_u32 m0, s39, 34816
s_add_u32 s37, s37, s38
buffer_load_dwordx4 v23, s[8:11], s37 offen sc1 lds
s_add_u32 m0, s39, 35840
s_add_u32 s37, s37, s38
buffer_load_dwordx4 v23, s[8:11], s37 offen sc1 lds
s_add_u32 m0, s39, 36864
s_add_u32 s37, s37, s38
buffer_load_dwordx4 v23, s[8:11], s37 offen sc1 lds
s_add_u32 m0, s39, 37888
s_add_u32 s37, s37, s38
buffer_load_dwordx4 v23, s[8:11], s37 offen sc1 lds
s_add_u32 m0, s39, 38912
s_add_u32 s37, s37, s38
buffer_load_dwordx4 v23, s[8:11], s37 offen sc1 lds
s_add_u32 m0, s39, 39936
s_add_u32 s37, s37, s38
buffer_load_dwordx4 v23, s[8:11], s37 offen sc1 lds
s_waitcnt vmcnt(16)
s_barrier
s_add_u32 s42, s42, 1
s_xor_b32 s37, s42, s35
s_add_u32 m0, s39, 49152
s_lshl_b32 s37, s37, 14
buffer_load_dwordx4 v23, s[8:11], s37 offen sc1 lds
s_add_u32 m0, s39, 50176
s_add_u32 s37, s37, s38
buffer_load_dwordx4 v23, s[8:11], s37 offen sc1 lds
s_add_u32 m0, s39, 51200
s_add_u32 s37, s37, s38
buffer_load_dwordx4 v23, s[8:11], s37 offen sc1 lds
s_add_u32 m0, s39, 52224
s_add_u32 s37, s37, s38
buffer_load_dwordx4 v23, s[8:11], s37 offen sc1 lds
s_add_u32 m0, s39, 53248
s_add_u32 s37, s37, s38
buffer_load_dwordx4 v23, s[8:11], s37 offen sc1 lds
s_add_u32 m0, s39, 54272
s_add_u32 s37, s37, s38
buffer_load_dwordx4 v23, s[8:11], s37 offen sc1 lds
s_add_u32 m0, s39, 55296
s_add_u32 s37, s37, s38
buffer_load_dwordx4 v23, s[8:11], s37 offen sc1 lds
s_add_u32 m0, s39, 56320
s_add_u32 s37, s37, s38
buffer_load_dwordx4 v23, s[8:11], s37 offen sc1 lds
s_waitcnt vmcnt(16)
s_barrier
s_add_u32 s42, s42, 1
s_xor_b32 s37, s42, s35
s_add_u32 m0, s39, 0
s_lshl_b32 s37, s37, 14
buffer_load_dwordx4 v23, s[8:11], s37 offen sc1 lds
s_add_u32 m0, s39, 1024
s_add_u32 s37, s37, s38
buffer_load_dwordx4 v23, s[8:11], s37 offen sc1 lds
s_add_u32 m0, s39, 2048
s_add_u32 s37, s37, s38
buffer_load_dwordx4 v23, s[8:11], s37 offen sc1 lds
s_add_u32 m0, s39, 3072
s_add_u32 s37, s37, s38
buffer_load_dwordx4 v23, s[8:11], s37 offen sc1 lds
s_add_u32 m0, s39, 4096
s_add_u32 s37, s37, s38
buffer_load_dwordx4 v23, s[8:11], s37 offen sc1 lds
s_add_u32 m0, s39, 5120
s_add_u32 s37, s37, s38
buffer_load_dwordx4 v23, s[8:11], s37 offen sc1 lds
s_add_u32 m0, s39, 6144
s_add_u32 s37, s37, s38
buffer_load_dwordx4 v23, s[8:11], s37 offen sc1 lds
s_add_u32 m0, s39, 7168
s_add_u32 s37, s37, s38
buffer_load_dwordx4 v23, s[8:11], s37 offen sc1 lds
s_waitcnt vmcnt(16)
s_barrier
s_add_u32 s42, s42, 1
s_xor_b32 s37, s42, s35
s_add_u32 m0, s39, 16384
s_lshl_b32 s37, s37, 14
buffer_load_dwordx4 v23, s[8:11], s37 offen sc1 lds
s_add_u32 m0, s39, 17408
s_add_u32 s37, s37, s38
buffer_load_dwordx4 v23, s[8:11], s37 offen sc1 lds
s_add_u32 m0, s39, 18432
s_add_u32 s37, s37, s38
buffer_load_dwordx4 v23, s[8:11], s37 offen sc1 lds
s_add_u32 m0, s39, 19456
s_add_u32 s37, s37, s38
buffer_load_dwordx4 v23, s[8:11], s37 offen sc1 lds
s_add_u32 m0, s39, 20480
s_add_u32 s37, s37, s38
buffer_load_dwordx4 v23, s[8:11], s37 offen sc1 lds
s_add_u32 m0, s39, 21504
s_add_u32 s37, s37, s38
buffer_load_dwordx4 v23, s[8:11], s37 offen sc1 lds
s_add_u32 m0, s39, 22528
s_add_u32 s37, s37, s38
buffer_load_dwordx4 v23, s[8:11], s37 offen sc1 lds
s_add_u32 m0, s39, 23552
s_add_u32 s37, s37, s38
buffer_load_dwordx4 v23, s[8:11], s37 offen sc1 lds
s_waitcnt vmcnt(16)
s_barrier
s_add_u32 s42, s42, 1
s_xor_b32 s37, s42, s35
s_add_u32 m0, s39, 32768
s_lshl_b32 s37, s37, 14
buffer_load_dwordx4 v23, s[8:11], s37 offen sc1 lds
s_add_u32 m0, s39, 33792
s_add_u32 s37, s37, s38
buffer_load_dwordx4 v23, s[8:11], s37 offen sc1 lds
s_add_u32 m0, s39, 34816
s_add_u32 s37, s37, s38
buffer_load_dwordx4 v23, s[8:11], s37 offen sc1 lds
s_add_u32 m0, s39, 35840
s_add_u32 s37, s37, s38
buffer_load_dwordx4 v23, s[8:11], s37 offen sc1 lds
s_add_u32 m0, s39, 36864
s_add_u32 s37, s37, s38
buffer_load_dwordx4 v23, s[8:11], s37 offen sc1 lds
s_add_u32 m0, s39, 37888
s_add_u32 s37, s37, s38
buffer_load_dwordx4 v23, s[8:11], s37 offen sc1 lds
s_add_u32 m0, s39, 38912
s_add_u32 s37, s37, s38
buffer_load_dwordx4 v23, s[8:11], s37 offen sc1 lds
s_add_u32 m0, s39, 39936
s_add_u32 s37, s37, s38
buffer_load_dwordx4 v23, s[8:11], s37 offen sc1 lds
s_waitcnt vmcnt(16)
s_barrier
s_add_u32 s42, s42, 1
s_xor_b32 s37, s42, s35
s_add_u32 m0, s39, 49152
s_lshl_b32 s37, s37, 14
buffer_load_dwordx4 v23, s[8:11], s37 offen sc1 lds
s_add_u32 m0, s39, 50176
s_add_u32 s37, s37, s38
buffer_load_dwordx4 v23, s[8:11], s37 offen sc1 lds
s_add_u32 m0, s39, 51200
s_add_u32 s37, s37, s38
buffer_load_dwordx4 v23, s[8:11], s37 offen sc1 lds
s_add_u32 m0, s39, 52224
s_add_u32 s37, s37, s38
buffer_load_dwordx4 v23, s[8:11], s37 offen sc1 lds
s_add_u32 m0, s39, 53248
s_add_u32 s37, s37, s38
buffer_load_dwordx4 v23, s[8:11], s37 offen sc1 lds
s_add_u32 m0, s39, 54272
s_add_u32 s37, s37, s38
buffer_load_dwordx4 v23, s[8:11], s37 offen sc1 lds
s_add_u32 m0, s39, 55296
s_add_u32 s37, s37, s38
buffer_load_dwordx4 v23, s[8:11], s37 offen sc1 lds
s_add_u32 m0, s39, 56320
s_add_u32 s37, s37, s38
buffer_load_dwordx4 v23, s[8:11], s37 offen sc1 lds
s_waitcnt vmcnt(16)
s_barrier
s_add_u32 s42, s42, 1
s_xor_b32 s37, s42, s35
s_add_u32 m0, s39, 0
s_lshl_b32 s37, s37, 14
buffer_load_dwordx4 v23, s[8:11], s37 offen sc1 lds
s_add_u32 m0, s39, 1024
s_add_u32 s37, s37, s38
buffer_load_dwordx4 v23, s[8:11], s37 offen sc1 lds
s_add_u32 m0, s39, 2048
s_add_u32 s37, s37, s38
buffer_load_dwordx4 v23, s[8:11], s37 offen sc1 lds
s_add_u32 m0, s39, 3072
s_add_u32 s37, s37, s38
buffer_load_dwordx4 v23, s[8:11], s37 offen sc1 lds
s_add_u32 m0, s39, 4096
s_add_u32 s37, s37, s38
buffer_load_dwordx4 v23, s[8:11], s37 offen sc1 lds
s_add_u32 m0, s39, 5120
s_add_u32 s37, s37, s38
buffer_load_dwordx4 v23, s[8:11], s37 offen sc1 lds
s_add_u32 m0, s39, 6144
s_add_u32 s37, s37, s38
buffer_load_dwordx4 v23, s[8:11], s37 offen sc1 lds
s_add_u32 m0, s39, 7168
s_add_u32 s37, s37, s38
buffer_load_dwordx4 v23, s[8:11], s37 offen sc1 lds
s_waitcnt vmcnt(16)
s_barrier
s_add_u32 s42, s42, 1
s_xor_b32 s37, s42, s35
s_add_u32 m0, s39, 16384
s_lshl_b32 s37, s37, 14
buffer_load_dwordx4 v23, s[8:11], s37 offen sc1 lds
s_add_u32 m0, s39, 17408
s_add_u32 s37, s37, s38
buffer_load_dwordx4 v23, s[8:11], s37 offen sc1 lds
s_add_u32 m0, s39, 18432
s_add_u32 s37, s37, s38
buffer_load_dwordx4 v23, s[8:11], s37 offen sc1 lds
s_add_u32 m0, s39, 19456
s_add_u32 s37, s37, s38
buffer_load_dwordx4 v23, s[8:11], s37 offen sc1 lds
s_add_u32 m0, s39, 20480
s_add_u32 s37, s37, s38
buffer_load_dwordx4 v23, s[8:11], s37 offen sc1 lds
s_add_u32 m0, s39, 21504
s_add_u32 s37, s37, s38
buffer_load_dwordx4 v23, s[8:11], s37 offen sc1 lds
s_add_u32 m0, s39, 22528
s_add_u32 s37, s37, s38
buffer_load_dwordx4 v23, s[8:11], s37 offen sc1 lds
s_add_u32 m0, s39, 23552
s_add_u32 s37, s37, s38
buffer_load_dwordx4 v23, s[8:11], s37 offen sc1 lds
s_waitcnt vmcnt(16)
s_barrier
s_add_u32 s42, s42, 1
s_xor_b32 s37, s42, s35
s_add_u32 m0, s39, 32768
s_lshl_b32 s37, s37, 14
buffer_load_dwordx4 v23, s[8:11], s37 offen sc1 lds
s_add_u32 m0, s39, 33792
s_add_u32 s37, s37, s38
buffer_load_dwordx4 v23, s[8:11], s37 offen sc1 lds
s_add_u32 m0, s39, 34816
s_add_u32 s37, s37, s38
buffer_load_dwordx4 v23, s[8:11], s37 offen sc1 lds
s_add_u32 m0, s39, 35840
s_add_u32 s37, s37, s38
buffer_load_dwordx4 v23, s[8:11], s37 offen sc1 lds
s_add_u32 m0, s39, 36864
s_add_u32 s37, s37, s38
buffer_load_dwordx4 v23, s[8:11], s37 offen sc1 lds
s_add_u32 m0, s39, 37888
s_add_u32 s37, s37, s38
buffer_load_dwordx4 v23, s[8:11], s37 offen sc1 lds
s_add_u32 m0, s39, 38912
s_add_u32 s37, s37, s38
buffer_load_dwordx4 v23, s[8:11], s37 offen sc1 lds
s_add_u32 m0, s39, 39936
s_add_u32 s37, s37, s38
buffer_load_dwordx4 v23, s[8:11], s37 offen sc1 lds
s_waitcnt vmcnt(16)
s_barrier
s_add_u32 s42, s42, 1
s_xor_b32 s37, s42, s35
s_add_u32 m0, s39, 49152
s_lshl_b32 s37, s37, 14
buffer_load_dwordx4 v23, s[8:11], s37 offen sc1 lds
s_add_u32 m0, s39, 50176
s_add_u32 s37, s37, s38
buffer_load_dwordx4 v23, s[8:11], s37 offen sc1 lds
s_add_u32 m0, s39, 51200
s_add_u32 s37, s37, s38
buffer_load_dwordx4 v23, s[8:11], s37 offen sc1 lds
s_add_u32 m0, s39, 52224
s_add_u32 s37, s37, s38
buffer_load_dwordx4 v23, s[8:11], s37 offen sc1 lds
s_add_u32 m0, s39, 53248
s_add_u32 s37, s37, s38
buffer_load_dwordx4 v23, s[8:11], s37 offen sc1 lds
s_add_u32 m0, s39, 54272
s_add_u32 s37, s37, s38
buffer_load_dwordx4 v23, s[8:11], s37 offen sc1 lds
s_add_u32 m0, s39, 55296
s_add_u32 s37, s37, s38
buffer_load_dwordx4 v23, s[8:11], s37 offen sc1 lds
s_add_u32 m0, s39, 56320
s_add_u32 s37, s37, s38
buffer_load_dwordx4 v23, s[8:11], s37 offen sc1 lds
s_lshl_b32 s43, s35, 8
s_cmp_eq_u32 s51, 1
s_cselect_b32 s8, s4, s6
s_cselect_b32 s9, s5, s7
s_sub_u32 s10, 7340032, s43
s_lshl_b32 s44, s34, 18
s_add_u32 s44, s44, 4194304
s_movk_i32 s38, 28672
s_cmp_eq_u32 s51, 0
s_cselect_b32 s8, s32, s8
s_cselect_b32 s9, s33, s9
s_cselect_b32 s10, 262144, s10
s_cselect_b32 s43, s44, s43
s_cselect_b32 s38, 1024, s38
s_cselect_b32 s45, 0, -1
s_add_u32 s8, s8, s43
s_addc_u32 s9, s9, 0
s_mov_b32 s11, 0x20000
s_lshl_b32 s40, s38, 4
s_mov_b32 s42, -1
s_lshl_b32 s39, s51, 14
v_lshrrev_b32 v19, 4, v1
v_lshlrev_b32 v20, 5, v19
v_mul_u32_u24 v19, 6912, v19
v_and_b32 v19, s45, v19
v_and_b32 v20, s45, v20
v_lshlrev_b32 v21, 4, v1
v_xor_b32 v21, v21, v20
v_add_u32 v22, v21, v19
s_and_b32 s45, s45, 128
v_xor_b32 v23, s45, v22
s_waitcnt vmcnt(16)
s_barrier
s_add_u32 s42, s42, 1
s_xor_b32 s37, s42, s35
s_add_u32 m0, s39, 98304
s_mul_i32 s37, s37, s40
buffer_load_dwordx4 v22, s[8:11], s37 offen sc1 lds
s_add_u32 m0, s39, 99328
s_add_u32 s37, s37, s38
buffer_load_dwordx4 v23, s[8:11], s37 offen sc1 lds
s_add_u32 m0, s39, 100352
s_add_u32 s37, s37, s38
buffer_load_dwordx4 v22, s[8:11], s37 offen sc1 lds
s_add_u32 m0, s39, 101376
s_add_u32 s37, s37, s38
buffer_load_dwordx4 v23, s[8:11], s37 offen sc1 lds
s_add_u32 m0, s39, 102400
s_add_u32 s37, s37, s38
buffer_load_dwordx4 v22, s[8:11], s37 offen sc1 lds
s_add_u32 m0, s39, 103424
s_add_u32 s37, s37, s38
buffer_load_dwordx4 v23, s[8:11], s37 offen sc1 lds
s_add_u32 m0, s39, 104448
s_add_u32 s37, s37, s38
buffer_load_dwordx4 v22, s[8:11], s37 offen sc1 lds
s_add_u32 m0, s39, 105472
s_add_u32 s37, s37, s38
buffer_load_dwordx4 v23, s[8:11], s37 offen sc1 lds
s_add_u32 m0, s39, 106496
s_add_u32 s37, s37, s38
buffer_load_dwordx4 v22, s[8:11], s37 offen sc1 lds
s_add_u32 m0, s39, 107520
s_add_u32 s37, s37, s38
buffer_load_dwordx4 v23, s[8:11], s37 offen sc1 lds
s_add_u32 m0, s39, 108544
s_add_u32 s37, s37, s38
buffer_load_dwordx4 v22, s[8:11], s37 offen sc1 lds
s_add_u32 m0, s39, 109568
s_add_u32 s37, s37, s38
buffer_load_dwordx4 v23, s[8:11], s37 offen sc1 lds
s_add_u32 m0, s39, 110592
s_add_u32 s37, s37, s38
buffer_load_dwordx4 v22, s[8:11], s37 offen sc1 lds
s_add_u32 m0, s39, 111616
s_add_u32 s37, s37, s38
buffer_load_dwordx4 v23, s[8:11], s37 offen sc1 lds
s_add_u32 m0, s39, 112640
s_add_u32 s37, s37, s38
buffer_load_dwordx4 v22, s[8:11], s37 offen sc1 lds
s_add_u32 m0, s39, 113664
s_add_u32 s37, s37, s38
buffer_load_dwordx4 v23, s[8:11], s37 offen sc1 lds
s_waitcnt vmcnt(24)
s_barrier
s_waitcnt vmcnt(16)
s_barrier
s_add_u32 s42, s42, 1
s_xor_b32 s37, s42, s35
s_add_u32 m0, s39, 0
s_mul_i32 s37, s37, s40
buffer_load_dwordx4 v22, s[8:11], s37 offen sc1 lds
s_add_u32 m0, s39, 1024
s_add_u32 s37, s37, s38
buffer_load_dwordx4 v23, s[8:11], s37 offen sc1 lds
s_add_u32 m0, s39, 2048
s_add_u32 s37, s37, s38
buffer_load_dwordx4 v22, s[8:11], s37 offen sc1 lds
s_add_u32 m0, s39, 3072
s_add_u32 s37, s37, s38
buffer_load_dwordx4 v23, s[8:11], s37 offen sc1 lds
s_add_u32 m0, s39, 4096
s_add_u32 s37, s37, s38
buffer_load_dwordx4 v22, s[8:11], s37 offen sc1 lds
s_add_u32 m0, s39, 5120
s_add_u32 s37, s37, s38
buffer_load_dwordx4 v23, s[8:11], s37 offen sc1 lds
s_add_u32 m0, s39, 6144
s_add_u32 s37, s37, s38
buffer_load_dwordx4 v22, s[8:11], s37 offen sc1 lds
s_add_u32 m0, s39, 7168
s_add_u32 s37, s37, s38
buffer_load_dwordx4 v23, s[8:11], s37 offen sc1 lds
s_add_u32 m0, s39, 8192
s_add_u32 s37, s37, s38
buffer_load_dwordx4 v22, s[8:11], s37 offen sc1 lds
s_add_u32 m0, s39, 9216
s_add_u32 s37, s37, s38
buffer_load_dwordx4 v23, s[8:11], s37 offen sc1 lds
s_add_u32 m0, s39, 10240
s_add_u32 s37, s37, s38
buffer_load_dwordx4 v22, s[8:11], s37 offen sc1 lds
s_add_u32 m0, s39, 11264
s_add_u32 s37, s37, s38
buffer_load_dwordx4 v23, s[8:11], s37 offen sc1 lds
s_add_u32 m0, s39, 12288
s_add_u32 s37, s37, s38
buffer_load_dwordx4 v22, s[8:11], s37 offen sc1 lds
s_add_u32 m0, s39, 13312
s_add_u32 s37, s37, s38
buffer_load_dwordx4 v23, s[8:11], s37 offen sc1 lds
s_add_u32 m0, s39, 14336
s_add_u32 s37, s37, s38
buffer_load_dwordx4 v22, s[8:11], s37 offen sc1 lds
s_add_u32 m0, s39, 15360
s_add_u32 s37, s37, s38
buffer_load_dwordx4 v23, s[8:11], s37 offen sc1 lds
s_barrier
s_waitcnt vmcnt(16)
s_barrier
s_add_u32 s42, s42, 1
s_xor_b32 s37, s42, s35
s_add_u32 m0, s39, 49152
s_mul_i32 s37, s37, s40
buffer_load_dwordx4 v22, s[8:11], s37 offen sc1 lds
s_add_u32 m0, s39, 50176
s_add_u32 s37, s37, s38
buffer_load_dwordx4 v23, s[8:11], s37 offen sc1 lds
s_add_u32 m0, s39, 51200
s_add_u32 s37, s37, s38
buffer_load_dwordx4 v22, s[8:11], s37 offen sc1 lds
s_add_u32 m0, s39, 52224
s_add_u32 s37, s37, s38
buffer_load_dwordx4 v23, s[8:11], s37 offen sc1 lds
s_add_u32 m0, s39, 53248
s_add_u32 s37, s37, s38
buffer_load_dwordx4 v22, s[8:11], s37 offen sc1 lds
s_add_u32 m0, s39, 54272
s_add_u32 s37, s37, s38
buffer_load_dwordx4 v23, s[8:11], s37 offen sc1 lds
s_add_u32 m0, s39, 55296
s_add_u32 s37, s37, s38
buffer_load_dwordx4 v22, s[8:11], s37 offen sc1 lds
s_add_u32 m0, s39, 56320
s_add_u32 s37, s37, s38
buffer_load_dwordx4 v23, s[8:11], s37 offen sc1 lds
s_add_u32 m0, s39, 57344
s_add_u32 s37, s37, s38
buffer_load_dwordx4 v22, s[8:11], s37 offen sc1 lds
s_add_u32 m0, s39, 58368
s_add_u32 s37, s37, s38
buffer_load_dwordx4 v23, s[8:11], s37 offen sc1 lds
s_add_u32 m0, s39, 59392
s_add_u32 s37, s37, s38
buffer_load_dwordx4 v22, s[8:11], s37 offen sc1 lds
s_add_u32 m0, s39, 60416
s_add_u32 s37, s37, s38
buffer_load_dwordx4 v23, s[8:11], s37 offen sc1 lds
s_add_u32 m0, s39, 61440
s_add_u32 s37, s37, s38
buffer_load_dwordx4 v22, s[8:11], s37 offen sc1 lds
s_add_u32 m0, s39, 62464
s_add_u32 s37, s37, s38
buffer_load_dwordx4 v23, s[8:11], s37 offen sc1 lds
s_add_u32 m0, s39, 63488
s_add_u32 s37, s37, s38
buffer_load_dwordx4 v22, s[8:11], s37 offen sc1 lds
s_add_u32 m0, s39, 64512
s_add_u32 s37, s37, s38
buffer_load_dwordx4 v23, s[8:11], s37 offen sc1 lds
s_branch LP3_135
.p2align 6
Lw_20:
s_branch Lr_21
s_nop 0
.p2align 3
Lp_138:
s_mov_b32 s42, -1
s_waitcnt vmcnt(0)
s_barrier
ds_write_b128 v27, v[68:71] offset:0
ds_write_b128 v27, v[116:119] offset:512
s_add_u32 s42, s42, 1
s_xor_b32 s37, s42, s35
s_add_u32 m0, s39, 49152
s_lshl_b32 s37, s37, 17
buffer_load_dwordx4 v23, s[8:11], s37 offen sc1 lds
s_add_u32 m0, s39, 50176
s_add_u32 s37, s37, s38
buffer_load_dwordx4 v23, s[8:11], s37 offen sc1 lds
s_add_u32 m0, s39, 51200
s_add_u32 s37, s37, s38
buffer_load_dwordx4 v23, s[8:11], s37 offen sc1 lds
s_add_u32 m0, s39, 52224
s_add_u32 s37, s37, s38
buffer_load_dwordx4 v23, s[8:11], s37 offen sc1 lds
s_add_u32 m0, s39, 53248
s_add_u32 s37, s37, s38
buffer_load_dwordx4 v23, s[8:11], s37 offen sc1 lds
s_add_u32 m0, s39, 54272
s_add_u32 s37, s37, s38
buffer_load_dwordx4 v23, s[8:11], s37 offen sc1 lds
s_add_u32 m0, s39, 55296
s_add_u32 s37, s37, s38
buffer_load_dwordx4 v23, s[8:11], s37 offen sc1 lds
s_add_u32 m0, s39, 56320
s_add_u32 s37, s37, s38
buffer_load_dwordx4 v23, s[8:11], s37 offen sc1 lds
s_add_u32 s42, s42, 1
s_xor_b32 s37, s42, s35
s_add_u32 m0, s39, 57344
s_lshl_b32 s37, s37, 17
buffer_load_dwordx4 v23, s[8:11], s37 offen sc1 lds
s_add_u32 m0, s39, 58368
s_add_u32 s37, s37, s38
buffer_load_dwordx4 v23, s[8:11], s37 offen sc1 lds
s_add_u32 m0, s39, 59392
s_add_u32 s37, s37, s38
buffer_load_dwordx4 v23, s[8:11], s37 offen sc1 lds
s_add_u32 m0, s39, 60416
s_add_u32 s37, s37, s38
buffer_load_dwordx4 v23, s[8:11], s37 offen sc1 lds
s_add_u32 m0, s39, 61440
s_add_u32 s37, s37, s38
buffer_load_dwordx4 v23, s[8:11], s37 offen sc1 lds
s_add_u32 m0, s39, 62464
s_add_u32 s37, s37, s38
buffer_load_dwordx4 v23, s[8:11], s37 offen sc1 lds
s_add_u32 m0, s39, 63488
s_add_u32 s37, s37, s38
buffer_load_dwordx4 v23, s[8:11], s37 offen sc1 lds
s_add_u32 m0, s39, 64512
s_add_u32 s37, s37, s38
buffer_load_dwordx4 v23, s[8:11], s37 offen sc1 lds
s_waitcnt vmcnt(8)
s_waitcnt lgkmcnt(0)
s_barrier
s_add_u32 m0, s54, 16384
s_add_u32 s43, s30, 0
buffer_load_dwordx4 v21, s[12:15], s43 offen sc1 lds
s_add_u32 m0, s54, 17408
s_add_u32 s43, s30, 1024
buffer_load_dwordx4 v21, s[12:15], s43 offen sc1 lds
s_add_u32 m0, s54, 32768
s_add_u32 s43, s31, 0
buffer_load_dwordx4 v21, s[12:15], s43 offen sc1 lds
s_add_u32 m0, s54, 33792
s_add_u32 s43, s31, 1024
buffer_load_dwordx4 v21, s[12:15], s43 offen sc1 lds
s_add_u32 s42, s42, 1
s_xor_b32 s37, s42, s35
s_add_u32 m0, s39, 65536
s_lshl_b32 s37, s37, 17
buffer_load_dwordx4 v23, s[8:11], s37 offen sc1 lds
s_add_u32 m0, s39, 66560
s_add_u32 s37, s37, s38
buffer_load_dwordx4 v23, s[8:11], s37 offen sc1 lds
s_add_u32 m0, s39, 67584
s_add_u32 s37, s37, s38
buffer_load_dwordx4 v23, s[8:11], s37 offen sc1 lds
s_add_u32 m0, s39, 68608
s_add_u32 s37, s37, s38
buffer_load_dwordx4 v23, s[8:11], s37 offen sc1 lds
s_add_u32 m0, s39, 69632
s_add_u32 s37, s37, s38
buffer_load_dwordx4 v23, s[8:11], s37 offen sc1 lds
s_add_u32 m0, s39, 70656
s_add_u32 s37, s37, s38
buffer_load_dwordx4 v23, s[8:11], s37 offen sc1 lds
s_add_u32 m0, s39, 71680
s_add_u32 s37, s37, s38
buffer_load_dwordx4 v23, s[8:11], s37 offen sc1 lds
s_add_u32 m0, s39, 72704
s_add_u32 s37, s37, s38
buffer_load_dwordx4 v23, s[8:11], s37 offen sc1 lds
s_waitcnt vmcnt(10)
s_barrier
s_add_u32 s42, s42, 1
s_xor_b32 s37, s42, s35
s_add_u32 m0, s39, 73728
s_lshl_b32 s37, s37, 17
buffer_load_dwordx4 v23, s[8:11], s37 offen sc1 lds
s_add_u32 m0, s39, 74752
s_add_u32 s37, s37, s38
buffer_load_dwordx4 v23, s[8:11], s37 offen sc1 lds
s_add_u32 m0, s39, 75776
s_add_u32 s37, s37, s38
buffer_load_dwordx4 v23, s[8:11], s37 offen sc1 lds
s_add_u32 m0, s39, 76800
s_add_u32 s37, s37, s38
buffer_load_dwordx4 v23, s[8:11], s37 offen sc1 lds
s_add_u32 m0, s39, 77824
s_add_u32 s37, s37, s38
buffer_load_dwordx4 v23, s[8:11], s37 offen sc1 lds
s_add_u32 m0, s39, 78848
s_add_u32 s37, s37, s38
buffer_load_dwordx4 v23, s[8:11], s37 offen sc1 lds
s_add_u32 m0, s39, 79872
s_add_u32 s37, s37, s38
buffer_load_dwordx4 v23, s[8:11], s37 offen sc1 lds
s_add_u32 m0, s39, 80896
s_add_u32 s37, s37, s38
buffer_load_dwordx4 v23, s[8:11], s37 offen sc1 lds
s_waitcnt vmcnt(8)
s_barrier
s_add_u32 s42, s42, 1
s_xor_b32 s37, s42, s35
s_add_u32 m0, s39, 81920
s_lshl_b32 s37, s37, 17
buffer_load_dwordx4 v23, s[8:11], s37 offen sc1 lds
s_add_u32 m0, s39, 82944
s_add_u32 s37, s37, s38
buffer_load_dwordx4 v23, s[8:11], s37 offen sc1 lds
s_add_u32 m0, s39, 83968
s_add_u32 s37, s37, s38
buffer_load_dwordx4 v23, s[8:11], s37 offen sc1 lds
s_add_u32 m0, s39, 84992
s_add_u32 s37, s37, s38
buffer_load_dwordx4 v23, s[8:11], s37 offen sc1 lds
s_add_u32 m0, s39, 86016
s_add_u32 s37, s37, s38
buffer_load_dwordx4 v23, s[8:11], s37 offen sc1 lds
s_add_u32 m0, s39, 87040
s_add_u32 s37, s37, s38
buffer_load_dwordx4 v23, s[8:11], s37 offen sc1 lds
s_add_u32 m0, s39, 88064
s_add_u32 s37, s37, s38
buffer_load_dwordx4 v23, s[8:11], s37 offen sc1 lds
s_add_u32 m0, s39, 89088
s_add_u32 s37, s37, s38
buffer_load_dwordx4 v23, s[8:11], s37 offen sc1 lds
s_add_u32 s42, s42, 1
s_xor_b32 s37, s42, s35
s_add_u32 m0, s39, 90112
s_lshl_b32 s37, s37, 17
buffer_load_dwordx4 v23, s[8:11], s37 offen sc1 lds
s_add_u32 m0, s39, 91136
s_add_u32 s37, s37, s38
buffer_load_dwordx4 v23, s[8:11], s37 offen sc1 lds
s_add_u32 m0, s39, 92160
s_add_u32 s37, s37, s38
buffer_load_dwordx4 v23, s[8:11], s37 offen sc1 lds
s_add_u32 m0, s39, 93184
s_add_u32 s37, s37, s38
buffer_load_dwordx4 v23, s[8:11], s37 offen sc1 lds
s_add_u32 m0, s39, 94208
s_add_u32 s37, s37, s38
buffer_load_dwordx4 v23, s[8:11], s37 offen sc1 lds
s_add_u32 m0, s39, 95232
s_add_u32 s37, s37, s38
buffer_load_dwordx4 v23, s[8:11], s37 offen sc1 lds
s_add_u32 m0, s39, 96256
s_add_u32 s37, s37, s38
buffer_load_dwordx4 v23, s[8:11], s37 offen sc1 lds
s_add_u32 m0, s39, 97280
s_add_u32 s37, s37, s38
buffer_load_dwordx4 v23, s[8:11], s37 offen sc1 lds
s_waitcnt vmcnt(16)
s_barrier
s_add_u32 s42, s42, 1
s_xor_b32 s37, s42, s35
s_add_u32 m0, s39, 98304
s_lshl_b32 s37, s37, 17
buffer_load_dwordx4 v23, s[8:11], s37 offen sc1 lds
s_add_u32 m0, s39, 99328
s_add_u32 s37, s37, s38
buffer_load_dwordx4 v23, s[8:11], s37 offen sc1 lds
s_add_u32 m0, s39, 100352
s_add_u32 s37, s37, s38
buffer_load_dwordx4 v23, s[8:11], s37 offen sc1 lds
s_add_u32 m0, s39, 101376
s_add_u32 s37, s37, s38
buffer_load_dwordx4 v23, s[8:11], s37 offen sc1 lds
s_add_u32 m0, s39, 102400
s_add_u32 s37, s37, s38
buffer_load_dwordx4 v23, s[8:11], s37 offen sc1 lds
s_add_u32 m0, s39, 103424
s_add_u32 s37, s37, s38
buffer_load_dwordx4 v23, s[8:11], s37 offen sc1 lds
s_add_u32 m0, s39, 104448
s_add_u32 s37, s37, s38
buffer_load_dwordx4 v23, s[8:11], s37 offen sc1 lds
s_add_u32 m0, s39, 105472
s_add_u32 s37, s37, s38
buffer_load_dwordx4 v23, s[8:11], s37 offen sc1 lds
s_add_u32 s42, s42, 1
s_xor_b32 s37, s42, s35
s_add_u32 m0, s39, 106496
s_lshl_b32 s37, s37, 17
buffer_load_dwordx4 v23, s[8:11], s37 offen sc1 lds
s_add_u32 m0, s39, 107520
s_add_u32 s37, s37, s38
buffer_load_dwordx4 v23, s[8:11], s37 offen sc1 lds
s_add_u32 m0, s39, 108544
s_add_u32 s37, s37, s38
buffer_load_dwordx4 v23, s[8:11], s37 offen sc1 lds
s_add_u32 m0, s39, 109568
s_add_u32 s37, s37, s38
buffer_load_dwordx4 v23, s[8:11], s37 offen sc1 lds
s_add_u32 m0, s39, 110592
s_add_u32 s37, s37, s38
buffer_load_dwordx4 v23, s[8:11], s37 offen sc1 lds
s_add_u32 m0, s39, 111616
s_add_u32 s37, s37, s38
buffer_load_dwordx4 v23, s[8:11], s37 offen sc1 lds
s_add_u32 m0, s39, 112640
s_add_u32 s37, s37, s38
buffer_load_dwordx4 v23, s[8:11], s37 offen sc1 lds
s_add_u32 m0, s39, 113664
s_add_u32 s37, s37, s38
buffer_load_dwordx4 v23, s[8:11], s37 offen sc1 lds
s_waitcnt vmcnt(24)
s_barrier
s_add_u32 s42, s42, 1
s_xor_b32 s37, s42, s35
s_add_u32 m0, s39, 114688
s_lshl_b32 s37, s37, 17
buffer_load_dwordx4 v23, s[8:11], s37 offen sc1 lds
s_add_u32 m0, s39, 115712
s_add_u32 s37, s37, s38
buffer_load_dwordx4 v23, s[8:11], s37 offen sc1 lds
s_add_u32 m0, s39, 116736
s_add_u32 s37, s37, s38
buffer_load_dwordx4 v23, s[8:11], s37 offen sc1 lds
s_add_u32 m0, s39, 117760
s_add_u32 s37, s37, s38
buffer_load_dwordx4 v23, s[8:11], s37 offen sc1 lds
s_add_u32 m0, s39, 118784
s_add_u32 s37, s37, s38
buffer_load_dwordx4 v23, s[8:11], s37 offen sc1 lds
s_add_u32 m0, s39, 119808
s_add_u32 s37, s37, s38
buffer_load_dwordx4 v23, s[8:11], s37 offen sc1 lds
s_add_u32 m0, s39, 120832
s_add_u32 s37, s37, s38
buffer_load_dwordx4 v23, s[8:11], s37 offen sc1 lds
s_add_u32 m0, s39, 121856
s_add_u32 s37, s37, s38
buffer_load_dwordx4 v23, s[8:11], s37 offen sc1 lds
s_add_u32 s42, s42, 1
s_xor_b32 s37, s42, s35
s_add_u32 m0, s39, 122880
s_lshl_b32 s37, s37, 17
buffer_load_dwordx4 v23, s[8:11], s37 offen sc1 lds
s_add_u32 m0, s39, 123904
s_add_u32 s37, s37, s38
buffer_load_dwordx4 v23, s[8:11], s37 offen sc1 lds
s_add_u32 m0, s39, 124928
s_add_u32 s37, s37, s38
buffer_load_dwordx4 v23, s[8:11], s37 offen sc1 lds
s_add_u32 m0, s39, 125952
s_add_u32 s37, s37, s38
buffer_load_dwordx4 v23, s[8:11], s37 offen sc1 lds
s_add_u32 m0, s39, 126976
s_add_u32 s37, s37, s38
buffer_load_dwordx4 v23, s[8:11], s37 offen sc1 lds
s_add_u32 m0, s39, 128000
s_add_u32 s37, s37, s38
buffer_load_dwordx4 v23, s[8:11], s37 offen sc1 lds
s_add_u32 m0, s39, 129024
s_add_u32 s37, s37, s38
buffer_load_dwordx4 v23, s[8:11], s37 offen sc1 lds
s_add_u32 m0, s39, 130048
s_add_u32 s37, s37, s38
buffer_load_dwordx4 v23, s[8:11], s37 offen sc1 lds
s_waitcnt vmcnt(32)
s_barrier
s_add_u32 s42, s42, 1
s_xor_b32 s37, s42, s35
s_add_u32 m0, s39, 49152
s_lshl_b32 s37, s37, 17
buffer_load_dwordx4 v23, s[8:11], s37 offen sc1 lds
s_add_u32 m0, s39, 50176
s_add_u32 s37, s37, s38
buffer_load_dwordx4 v23, s[8:11], s37 offen sc1 lds
s_add_u32 m0, s39, 51200
s_add_u32 s37, s37, s38
buffer_load_dwordx4 v23, s[8:11], s37 offen sc1 lds
s_add_u32 m0, s39, 52224
s_add_u32 s37, s37, s38
buffer_load_dwordx4 v23, s[8:11], s37 offen sc1 lds
s_add_u32 m0, s39, 53248
s_add_u32 s37, s37, s38
buffer_load_dwordx4 v23, s[8:11], s37 offen sc1 lds
s_add_u32 m0, s39, 54272
s_add_u32 s37, s37, s38
buffer_load_dwordx4 v23, s[8:11], s37 offen sc1 lds
s_add_u32 m0, s39, 55296
s_add_u32 s37, s37, s38
buffer_load_dwordx4 v23, s[8:11], s37 offen sc1 lds
s_add_u32 m0, s39, 56320
s_add_u32 s37, s37, s38
buffer_load_dwordx4 v23, s[8:11], s37 offen sc1 lds
s_add_u32 s42, s42, 1
s_xor_b32 s37, s42, s35
s_add_u32 m0, s39, 57344
s_lshl_b32 s37, s37, 17
buffer_load_dwordx4 v23, s[8:11], s37 offen sc1 lds
s_add_u32 m0, s39, 58368
s_add_u32 s37, s37, s38
buffer_load_dwordx4 v23, s[8:11], s37 offen sc1 lds
s_add_u32 m0, s39, 59392
s_add_u32 s37, s37, s38
buffer_load_dwordx4 v23, s[8:11], s37 offen sc1 lds
s_add_u32 m0, s39, 60416
s_add_u32 s37, s37, s38
buffer_load_dwordx4 v23, s[8:11], s37 offen sc1 lds
s_add_u32 m0, s39, 61440
s_add_u32 s37, s37, s38
buffer_load_dwordx4 v23, s[8:11], s37 offen sc1 lds
s_add_u32 m0, s39, 62464
s_add_u32 s37, s37, s38
buffer_load_dwordx4 v23, s[8:11], s37 offen sc1 lds
s_add_u32 m0, s39, 63488
s_add_u32 s37, s37, s38
buffer_load_dwordx4 v23, s[8:11], s37 offen sc1 lds
s_add_u32 m0, s39, 64512
s_add_u32 s37, s37, s38
buffer_load_dwordx4 v23, s[8:11], s37 offen sc1 lds
s_waitcnt vmcnt(40)
s_barrier
s_add_u32 s42, s42, 1
s_xor_b32 s37, s42, s35
s_add_u32 m0, s39, 65536
s_lshl_b32 s37, s37, 17
buffer_load_dwordx4 v23, s[8:11], s37 offen sc1 lds
s_add_u32 m0, s39, 66560
s_add_u32 s37, s37, s38
buffer_load_dwordx4 v23, s[8:11], s37 offen sc1 lds
s_add_u32 m0, s39, 67584
s_add_u32 s37, s37, s38
buffer_load_dwordx4 v23, s[8:11], s37 offen sc1 lds
s_add_u32 m0, s39, 68608
s_add_u32 s37, s37, s38
buffer_load_dwordx4 v23, s[8:11], s37 offen sc1 lds
s_add_u32 m0, s39, 69632
s_add_u32 s37, s37, s38
buffer_load_dwordx4 v23, s[8:11], s37 offen sc1 lds
s_add_u32 m0, s39, 70656
s_add_u32 s37, s37, s38
buffer_load_dwordx4 v23, s[8:11], s37 offen sc1 lds
s_add_u32 m0, s39, 71680
s_add_u32 s37, s37, s38
buffer_load_dwordx4 v23, s[8:11], s37 offen sc1 lds
s_add_u32 m0, s39, 72704
s_add_u32 s37, s37, s38
buffer_load_dwordx4 v23, s[8:11], s37 offen sc1 lds
s_add_u32 s42, s42, 1
s_xor_b32 s37, s42, s35
s_add_u32 m0, s39, 73728
s_lshl_b32 s37, s37, 17
buffer_load_dwordx4 v23, s[8:11], s37 offen sc1 lds
s_add_u32 m0, s39, 74752
s_add_u32 s37, s37, s38
buffer_load_dwordx4 v23, s[8:11], s37 offen sc1 lds
s_add_u32 m0, s39, 75776
s_add_u32 s37, s37, s38
buffer_load_dwordx4 v23, s[8:11], s37 offen sc1 lds
s_add_u32 m0, s39, 76800
s_add_u32 s37, s37, s38
buffer_load_dwordx4 v23, s[8:11], s37 offen sc1 lds
s_add_u32 m0, s39, 77824
s_add_u32 s37, s37, s38
buffer_load_dwordx4 v23, s[8:11], s37 offen sc1 lds
s_add_u32 m0, s39, 78848
s_add_u32 s37, s37, s38
buffer_load_dwordx4 v23, s[8:11], s37 offen sc1 lds
s_add_u32 m0, s39, 79872
s_add_u32 s37, s37, s38
buffer_load_dwordx4 v23, s[8:11], s37 offen sc1 lds
s_add_u32 m0, s39, 80896
s_add_u32 s37, s37, s38
buffer_load_dwordx4 v23, s[8:11], s37 offen sc1 lds
s_waitcnt vmcnt(48)
s_barrier
s_add_u32 s42, s42, 1
s_xor_b32 s37, s42, s35
s_add_u32 m0, s39, 81920
s_lshl_b32 s37, s37, 17
buffer_load_dwordx4 v23, s[8:11], s37 offen sc1 lds
s_add_u32 m0, s39, 82944
s_add_u32 s37, s37, s38
buffer_load_dwordx4 v23, s[8:11], s37 offen sc1 lds
s_add_u32 m0, s39, 83968
s_add_u32 s37, s37, s38
buffer_load_dwordx4 v23, s[8:11], s37 offen sc1 lds
s_add_u32 m0, s39, 84992
s_add_u32 s37, s37, s38
buffer_load_dwordx4 v23, s[8:11], s37 offen sc1 lds
s_add_u32 m0, s39, 86016
s_add_u32 s37, s37, s38
buffer_load_dwordx4 v23, s[8:11], s37 offen sc1 lds
s_add_u32 m0, s39, 87040
s_add_u32 s37, s37, s38
buffer_load_dwordx4 v23, s[8:11], s37 offen sc1 lds
s_add_u32 m0, s39, 88064
s_add_u32 s37, s37, s38
buffer_load_dwordx4 v23, s[8:11], s37 offen sc1 lds
s_add_u32 m0, s39, 89088
s_add_u32 s37, s37, s38
buffer_load_dwordx4 v23, s[8:11], s37 offen sc1 lds
s_add_u32 s42, s42, 1
s_xor_b32 s37, s42, s35
s_add_u32 m0, s39, 90112
s_lshl_b32 s37, s37, 17
buffer_load_dwordx4 v23, s[8:11], s37 offen sc1 lds
s_add_u32 m0, s39, 91136
s_add_u32 s37, s37, s38
buffer_load_dwordx4 v23, s[8:11], s37 offen sc1 lds
s_add_u32 m0, s39, 92160
s_add_u32 s37, s37, s38
buffer_load_dwordx4 v23, s[8:11], s37 offen sc1 lds
s_add_u32 m0, s39, 93184
s_add_u32 s37, s37, s38
buffer_load_dwordx4 v23, s[8:11], s37 offen sc1 lds
s_add_u32 m0, s39, 94208
s_add_u32 s37, s37, s38
buffer_load_dwordx4 v23, s[8:11], s37 offen sc1 lds
s_add_u32 m0, s39, 95232
s_add_u32 s37, s37, s38
buffer_load_dwordx4 v23, s[8:11], s37 offen sc1 lds
s_add_u32 m0, s39, 96256
s_add_u32 s37, s37, s38
buffer_load_dwordx4 v23, s[8:11], s37 offen sc1 lds
s_add_u32 m0, s39, 97280
s_add_u32 s37, s37, s38
buffer_load_dwordx4 v23, s[8:11], s37 offen sc1 lds
s_waitcnt vmcnt(56)
s_barrier
s_waitcnt vmcnt(48)
s_barrier
s_waitcnt vmcnt(40)
s_barrier
s_waitcnt vmcnt(32)
s_barrier
s_waitcnt vmcnt(24)
s_barrier
s_lshl_b32 s43, s35, 8
s_cmp_eq_u32 s51, 1
s_cselect_b32 s8, s4, s6
s_cselect_b32 s9, s5, s7
s_sub_u32 s10, 7340032, s43
s_lshl_b32 s44, s34, 18
s_add_u32 s44, s44, 4194304
s_movk_i32 s38, 28672
s_cmp_eq_u32 s51, 0
s_cselect_b32 s8, s32, s8
s_cselect_b32 s9, s33, s9
s_cselect_b32 s10, 262144, s10
s_cselect_b32 s43, s44, s43
s_cselect_b32 s38, 1024, s38
s_cselect_b32 s45, 0, -1
s_add_u32 s8, s8, s43
s_addc_u32 s9, s9, 0
s_mov_b32 s11, 0x20000
s_lshl_b32 s40, s38, 4
s_mov_b32 s42, -1
s_lshl_b32 s39, s51, 14
v_lshrrev_b32 v19, 4, v1
v_lshlrev_b32 v20, 5, v19
v_mul_u32_u24 v19, 6912, v19
v_and_b32 v19, s45, v19
v_and_b32 v20, s45, v20
v_lshlrev_b32 v21, 4, v1
v_xor_b32 v21, v21, v20
v_add_u32 v22, v21, v19
s_and_b32 s45, s45, 128
v_xor_b32 v23, s45, v22
s_waitcnt vmcnt(16)
s_barrier
s_add_u32 s42, s42, 1
s_xor_b32 s37, s42, s35
s_add_u32 m0, s39, 98304
s_mul_i32 s37, s37, s40
buffer_load_dwordx4 v22, s[8:11], s37 offen sc1 lds
s_add_u32 m0, s39, 99328
s_add_u32 s37, s37, s38
buffer_load_dwordx4 v23, s[8:11], s37 offen sc1 lds
s_add_u32 m0, s39, 100352
s_add_u32 s37, s37, s38
buffer_load_dwordx4 v22, s[8:11], s37 offen sc1 lds
s_add_u32 m0, s39, 101376
s_add_u32 s37, s37, s38
buffer_load_dwordx4 v23, s[8:11], s37 offen sc1 lds
s_add_u32 m0, s39, 102400
s_add_u32 s37, s37, s38
buffer_load_dwordx4 v22, s[8:11], s37 offen sc1 lds
s_add_u32 m0, s39, 103424
s_add_u32 s37, s37, s38
buffer_load_dwordx4 v23, s[8:11], s37 offen sc1 lds
s_add_u32 m0, s39, 104448
s_add_u32 s37, s37, s38
buffer_load_dwordx4 v22, s[8:11], s37 offen sc1 lds
s_add_u32 m0, s39, 105472
s_add_u32 s37, s37, s38
buffer_load_dwordx4 v23, s[8:11], s37 offen sc1 lds
s_add_u32 m0, s39, 106496
s_add_u32 s37, s37, s38
buffer_load_dwordx4 v22, s[8:11], s37 offen sc1 lds
s_add_u32 m0, s39, 107520
s_add_u32 s37, s37, s38
buffer_load_dwordx4 v23, s[8:11], s37 offen sc1 lds
s_add_u32 m0, s39, 108544
s_add_u32 s37, s37, s38
buffer_load_dwordx4 v22, s[8:11], s37 offen sc1 lds
s_add_u32 m0, s39, 109568
s_add_u32 s37, s37, s38
buffer_load_dwordx4 v23, s[8:11], s37 offen sc1 lds
s_add_u32 m0, s39, 110592
s_add_u32 s37, s37, s38
buffer_load_dwordx4 v22, s[8:11], s37 offen sc1 lds
s_add_u32 m0, s39, 111616
s_add_u32 s37, s37, s38
buffer_load_dwordx4 v23, s[8:11], s37 offen sc1 lds
s_add_u32 m0, s39, 112640
s_add_u32 s37, s37, s38
buffer_load_dwordx4 v22, s[8:11], s37 offen sc1 lds
s_add_u32 m0, s39, 113664
s_add_u32 s37, s37, s38
buffer_load_dwordx4 v23, s[8:11], s37 offen sc1 lds
s_waitcnt vmcnt(24)
s_barrier
s_waitcnt vmcnt(16)
s_barrier
s_add_u32 s42, s42, 1
s_xor_b32 s37, s42, s35
s_add_u32 m0, s39, 0
s_mul_i32 s37, s37, s40
buffer_load_dwordx4 v22, s[8:11], s37 offen sc1 lds
s_add_u32 m0, s39, 1024
s_add_u32 s37, s37, s38
buffer_load_dwordx4 v23, s[8:11], s37 offen sc1 lds
s_add_u32 m0, s39, 2048
s_add_u32 s37, s37, s38
buffer_load_dwordx4 v22, s[8:11], s37 offen sc1 lds
s_add_u32 m0, s39, 3072
s_add_u32 s37, s37, s38
buffer_load_dwordx4 v23, s[8:11], s37 offen sc1 lds
s_add_u32 m0, s39, 4096
s_add_u32 s37, s37, s38
buffer_load_dwordx4 v22, s[8:11], s37 offen sc1 lds
s_add_u32 m0, s39, 5120
s_add_u32 s37, s37, s38
buffer_load_dwordx4 v23, s[8:11], s37 offen sc1 lds
s_add_u32 m0, s39, 6144
s_add_u32 s37, s37, s38
buffer_load_dwordx4 v22, s[8:11], s37 offen sc1 lds
s_add_u32 m0, s39, 7168
s_add_u32 s37, s37, s38
buffer_load_dwordx4 v23, s[8:11], s37 offen sc1 lds
s_add_u32 m0, s39, 8192
s_add_u32 s37, s37, s38
buffer_load_dwordx4 v22, s[8:11], s37 offen sc1 lds
s_add_u32 m0, s39, 9216
s_add_u32 s37, s37, s38
buffer_load_dwordx4 v23, s[8:11], s37 offen sc1 lds
s_add_u32 m0, s39, 10240
s_add_u32 s37, s37, s38
buffer_load_dwordx4 v22, s[8:11], s37 offen sc1 lds
s_add_u32 m0, s39, 11264
s_add_u32 s37, s37, s38
buffer_load_dwordx4 v23, s[8:11], s37 offen sc1 lds
s_add_u32 m0, s39, 12288
s_add_u32 s37, s37, s38
buffer_load_dwordx4 v22, s[8:11], s37 offen sc1 lds
s_add_u32 m0, s39, 13312
s_add_u32 s37, s37, s38
buffer_load_dwordx4 v23, s[8:11], s37 offen sc1 lds
s_add_u32 m0, s39, 14336
s_add_u32 s37, s37, s38
buffer_load_dwordx4 v22, s[8:11], s37 offen sc1 lds
s_add_u32 m0, s39, 15360
s_add_u32 s37, s37, s38
buffer_load_dwordx4 v23, s[8:11], s37 offen sc1 lds
s_barrier
s_waitcnt vmcnt(16)
s_barrier
s_add_u32 s42, s42, 1
s_xor_b32 s37, s42, s35
s_add_u32 m0, s39, 49152
s_mul_i32 s37, s37, s40
buffer_load_dwordx4 v22, s[8:11], s37 offen sc1 lds
s_add_u32 m0, s39, 50176
s_add_u32 s37, s37, s38
buffer_load_dwordx4 v23, s[8:11], s37 offen sc1 lds
s_add_u32 m0, s39, 51200
s_add_u32 s37, s37, s38
buffer_load_dwordx4 v22, s[8:11], s37 offen sc1 lds
s_add_u32 m0, s39, 52224
s_add_u32 s37, s37, s38
buffer_load_dwordx4 v23, s[8:11], s37 offen sc1 lds
s_add_u32 m0, s39, 53248
s_add_u32 s37, s37, s38
buffer_load_dwordx4 v22, s[8:11], s37 offen sc1 lds
s_add_u32 m0, s39, 54272
s_add_u32 s37, s37, s38
buffer_load_dwordx4 v23, s[8:11], s37 offen sc1 lds
s_add_u32 m0, s39, 55296
s_add_u32 s37, s37, s38
buffer_load_dwordx4 v22, s[8:11], s37 offen sc1 lds
s_add_u32 m0, s39, 56320
s_add_u32 s37, s37, s38
buffer_load_dwordx4 v23, s[8:11], s37 offen sc1 lds
s_add_u32 m0, s39, 57344
s_add_u32 s37, s37, s38
buffer_load_dwordx4 v22, s[8:11], s37 offen sc1 lds
s_add_u32 m0, s39, 58368
s_add_u32 s37, s37, s38
buffer_load_dwordx4 v23, s[8:11], s37 offen sc1 lds
s_add_u32 m0, s39, 59392
s_add_u32 s37, s37, s38
buffer_load_dwordx4 v22, s[8:11], s37 offen sc1 lds
s_add_u32 m0, s39, 60416
s_add_u32 s37, s37, s38
buffer_load_dwordx4 v23, s[8:11], s37 offen sc1 lds
s_add_u32 m0, s39, 61440
s_add_u32 s37, s37, s38
buffer_load_dwordx4 v22, s[8:11], s37 offen sc1 lds
s_add_u32 m0, s39, 62464
s_add_u32 s37, s37, s38
buffer_load_dwordx4 v23, s[8:11], s37 offen sc1 lds
s_add_u32 m0, s39, 63488
s_add_u32 s37, s37, s38
buffer_load_dwordx4 v22, s[8:11], s37 offen sc1 lds
s_add_u32 m0, s39, 64512
s_add_u32 s37, s37, s38
buffer_load_dwordx4 v23, s[8:11], s37 offen sc1 lds
.p2align 3
LP3_135:
s_mul_i32 s43, s2, 28672
s_mul_i32 s44, s51, 7168
s_add_u32 s43, s43, s44
s_add_u32 s80, s60, s43
s_addc_u32 s81, s61, 0
s_waitcnt vmcnt(16)
s_barrier
s_add_u32 s42, s42, 1
s_xor_b32 s37, s42, s35
s_add_u32 m0, s39, 98304
s_mul_i32 s37, s37, s40
buffer_load_dwordx4 v22, s[8:11], s37 offen sc1 lds
s_add_u32 m0, s39, 99328
s_add_u32 s37, s37, s38
buffer_load_dwordx4 v23, s[8:11], s37 offen sc1 lds
s_add_u32 m0, s39, 100352
s_add_u32 s37, s37, s38
buffer_load_dwordx4 v22, s[8:11], s37 offen sc1 lds
s_add_u32 m0, s39, 101376
s_add_u32 s37, s37, s38
buffer_load_dwordx4 v23, s[8:11], s37 offen sc1 lds
s_add_u32 m0, s39, 102400
s_add_u32 s37, s37, s38
buffer_load_dwordx4 v22, s[8:11], s37 offen sc1 lds
s_add_u32 m0, s39, 103424
s_add_u32 s37, s37, s38
buffer_load_dwordx4 v23, s[8:11], s37 offen sc1 lds
s_add_u32 m0, s39, 104448
s_add_u32 s37, s37, s38
buffer_load_dwordx4 v22, s[8:11], s37 offen sc1 lds
s_add_u32 m0, s39, 105472
s_add_u32 s37, s37, s38
buffer_load_dwordx4 v23, s[8:11], s37 offen sc1 lds
s_add_u32 m0, s39, 106496
s_add_u32 s37, s37, s38
buffer_load_dwordx4 v22, s[8:11], s37 offen sc1 lds
s_add_u32 m0, s39, 107520
s_add_u32 s37, s37, s38
buffer_load_dwordx4 v23, s[8:11], s37 offen sc1 lds
s_add_u32 m0, s39, 108544
s_add_u32 s37, s37, s38
buffer_load_dwordx4 v22, s[8:11], s37 offen sc1 lds
s_add_u32 m0, s39, 109568
s_add_u32 s37, s37, s38
buffer_load_dwordx4 v23, s[8:11], s37 offen sc1 lds
s_add_u32 m0, s39, 110592
s_add_u32 s37, s37, s38
buffer_load_dwordx4 v22, s[8:11], s37 offen sc1 lds
s_add_u32 m0, s39, 111616
s_add_u32 s37, s37, s38
buffer_load_dwordx4 v23, s[8:11], s37 offen sc1 lds
s_add_u32 m0, s39, 112640
s_add_u32 s37, s37, s38
buffer_load_dwordx4 v22, s[8:11], s37 offen sc1 lds
s_add_u32 m0, s39, 113664
s_add_u32 s37, s37, s38
buffer_load_dwordx4 v23, s[8:11], s37 offen sc1 lds
s_load_dword s64, s[80:81], 0
s_load_dword s65, s[80:81], 64
s_load_dword s66, s[80:81], 128
s_load_dword s67, s[80:81], 192
s_load_dword s68, s[80:81], 256
s_load_dword s69, s[80:81], 320
s_load_dword s70, s[80:81], 384
s_load_dword s71, s[80:81], 448
s_load_dword s72, s[80:81], 512
s_add_u32 s80, s80, 576
s_addc_u32 s81, s81, 0
s_waitcnt vmcnt(16)
s_barrier
s_mov_b32 s41, 2
.p2align 3
Lp3_139:
s_add_u32 s42, s42, 1
s_xor_b32 s37, s42, s35
s_add_u32 m0, s39, 0
s_mul_i32 s37, s37, s40
buffer_load_dwordx4 v22, s[8:11], s37 offen sc1 lds
s_add_u32 m0, s39, 1024
s_add_u32 s37, s37, s38
buffer_load_dwordx4 v23, s[8:11], s37 offen sc1 lds
s_add_u32 m0, s39, 2048
s_add_u32 s37, s37, s38
buffer_load_dwordx4 v22, s[8:11], s37 offen sc1 lds
s_add_u32 m0, s39, 3072
s_add_u32 s37, s37, s38
buffer_load_dwordx4 v23, s[8:11], s37 offen sc1 lds
s_add_u32 m0, s39, 4096
s_add_u32 s37, s37, s38
buffer_load_dwordx4 v22, s[8:11], s37 offen sc1 lds
s_add_u32 m0, s39, 5120
s_add_u32 s37, s37, s38
buffer_load_dwordx4 v23, s[8:11], s37 offen sc1 lds
s_add_u32 m0, s39, 6144
s_add_u32 s37, s37, s38
buffer_load_dwordx4 v22, s[8:11], s37 offen sc1 lds
s_add_u32 m0, s39, 7168
s_add_u32 s37, s37, s38
buffer_load_dwordx4 v23, s[8:11], s37 offen sc1 lds
s_add_u32 m0, s39, 8192
s_add_u32 s37, s37, s38
buffer_load_dwordx4 v22, s[8:11], s37 offen sc1 lds
s_add_u32 m0, s39, 9216
s_add_u32 s37, s37, s38
buffer_load_dwordx4 v23, s[8:11], s37 offen sc1 lds
s_add_u32 m0, s39, 10240
s_add_u32 s37, s37, s38
buffer_load_dwordx4 v22, s[8:11], s37 offen sc1 lds
s_add_u32 m0, s39, 11264
s_add_u32 s37, s37, s38
buffer_load_dwordx4 v23, s[8:11], s37 offen sc1 lds
s_add_u32 m0, s39, 12288
s_add_u32 s37, s37, s38
buffer_load_dwordx4 v22, s[8:11], s37 offen sc1 lds
s_add_u32 m0, s39, 13312
s_add_u32 s37, s37, s38
buffer_load_dwordx4 v23, s[8:11], s37 offen sc1 lds
s_add_u32 m0, s39, 14336
s_add_u32 s37, s37, s38
buffer_load_dwordx4 v22, s[8:11], s37 offen sc1 lds
s_add_u32 m0, s39, 15360
s_add_u32 s37, s37, s38
buffer_load_dwordx4 v23, s[8:11], s37 offen sc1 lds
s_load_dword s64, s[80:81], 0
s_load_dword s65, s[80:81], 64
s_load_dword s66, s[80:81], 128
s_load_dword s67, s[80:81], 192
s_load_dword s68, s[80:81], 256
s_load_dword s69, s[80:81], 320
s_load_dword s70, s[80:81], 384
s_load_dword s71, s[80:81], 448
s_load_dword s72, s[80:81], 512
s_add_u32 s80, s80, 576
s_addc_u32 s81, s81, 0
s_waitcnt vmcnt(16)
s_barrier
s_add_u32 s42, s42, 1
s_xor_b32 s37, s42, s35
s_add_u32 m0, s39, 49152
s_mul_i32 s37, s37, s40
buffer_load_dwordx4 v22, s[8:11], s37 offen sc1 lds
s_add_u32 m0, s39, 50176
s_add_u32 s37, s37, s38
buffer_load_dwordx4 v23, s[8:11], s37 offen sc1 lds
s_add_u32 m0, s39, 51200
s_add_u32 s37, s37, s38
buffer_load_dwordx4 v22, s[8:11], s37 offen sc1 lds
s_add_u32 m0, s39, 52224
s_add_u32 s37, s37, s38
buffer_load_dwordx4 v23, s[8:11], s37 offen sc1 lds
s_add_u32 m0, s39, 53248
s_add_u32 s37, s37, s38
buffer_load_dwordx4 v22, s[8:11], s37 offen sc1 lds
s_add_u32 m0, s39, 54272
s_add_u32 s37, s37, s38
buffer_load_dwordx4 v23, s[8:11], s37 offen sc1 lds
s_add_u32 m0, s39, 55296
s_add_u32 s37, s37, s38
buffer_load_dwordx4 v22, s[8:11], s37 offen sc1 lds
s_add_u32 m0, s39, 56320
s_add_u32 s37, s37, s38
buffer_load_dwordx4 v23, s[8:11], s37 offen sc1 lds
s_add_u32 m0, s39, 57344
s_add_u32 s37, s37, s38
buffer_load_dwordx4 v22, s[8:11], s37 offen sc1 lds
s_add_u32 m0, s39, 58368
s_add_u32 s37, s37, s38
buffer_load_dwordx4 v23, s[8:11], s37 offen sc1 lds
s_add_u32 m0, s39, 59392
s_add_u32 s37, s37, s38
buffer_load_dwordx4 v22, s[8:11], s37 offen sc1 lds
s_add_u32 m0, s39, 60416
s_add_u32 s37, s37, s38
buffer_load_dwordx4 v23, s[8:11], s37 offen sc1 lds
s_add_u32 m0, s39, 61440
s_add_u32 s37, s37, s38
buffer_load_dwordx4 v22, s[8:11], s37 offen sc1 lds
s_add_u32 m0, s39, 62464
s_add_u32 s37, s37, s38
buffer_load_dwordx4 v23, s[8:11], s37 offen sc1 lds
s_add_u32 m0, s39, 63488
s_add_u32 s37, s37, s38
buffer_load_dwordx4 v22, s[8:11], s37 offen sc1 lds
s_add_u32 m0, s39, 64512
s_add_u32 s37, s37, s38
buffer_load_dwordx4 v23, s[8:11], s37 offen sc1 lds
s_load_dword s64, s[80:81], 0
s_load_dword s65, s[80:81], 64
s_load_dword s66, s[80:81], 128
s_load_dword s67, s[80:81], 192
s_load_dword s68, s[80:81], 256
s_load_dword s69, s[80:81], 320
s_load_dword s70, s[80:81], 384
s_load_dword s71, s[80:81], 448
s_load_dword s72, s[80:81], 512
s_add_u32 s80, s80, 576
s_addc_u32 s81, s81, 0
s_waitcnt vmcnt(16)
s_barrier
s_add_u32 s42, s42, 1
s_xor_b32 s37, s42, s35
s_add_u32 m0, s39, 98304
s_mul_i32 s37, s37, s40
buffer_load_dwordx4 v22, s[8:11], s37 offen sc1 lds
s_add_u32 m0, s39, 99328
s_add_u32 s37, s37, s38
buffer_load_dwordx4 v23, s[8:11], s37 offen sc1 lds
s_add_u32 m0, s39, 100352
s_add_u32 s37, s37, s38
buffer_load_dwordx4 v22, s[8:11], s37 offen sc1 lds
s_add_u32 m0, s39, 101376
s_add_u32 s37, s37, s38
buffer_load_dwordx4 v23, s[8:11], s37 offen sc1 lds
s_add_u32 m0, s39, 102400
s_add_u32 s37, s37, s38
buffer_load_dwordx4 v22, s[8:11], s37 offen sc1 lds
s_add_u32 m0, s39, 103424
s_add_u32 s37, s37, s38
buffer_load_dwordx4 v23, s[8:11], s37 offen sc1 lds
s_add_u32 m0, s39, 104448
s_add_u32 s37, s37, s38
buffer_load_dwordx4 v22, s[8:11], s37 offen sc1 lds
s_add_u32 m0, s39, 105472
s_add_u32 s37, s37, s38
buffer_load_dwordx4 v23, s[8:11], s37 offen sc1 lds
s_add_u32 m0, s39, 106496
s_add_u32 s37, s37, s38
buffer_load_dwordx4 v22, s[8:11], s37 offen sc1 lds
s_add_u32 m0, s39, 107520
s_add_u32 s37, s37, s38
buffer_load_dwordx4 v23, s[8:11], s37 offen sc1 lds
s_add_u32 m0, s39, 108544
s_add_u32 s37, s37, s38
buffer_load_dwordx4 v22, s[8:11], s37 offen sc1 lds
s_add_u32 m0, s39, 109568
s_add_u32 s37, s37, s38
buffer_load_dwordx4 v23, s[8:11], s37 offen sc1 lds
s_add_u32 m0, s39, 110592
s_add_u32 s37, s37, s38
buffer_load_dwordx4 v22, s[8:11], s37 offen sc1 lds
s_add_u32 m0, s39, 111616
s_add_u32 s37, s37, s38
buffer_load_dwordx4 v23, s[8:11], s37 offen sc1 lds
s_add_u32 m0, s39, 112640
s_add_u32 s37, s37, s38
buffer_load_dwordx4 v22, s[8:11], s37 offen sc1 lds
s_add_u32 m0, s39, 113664
s_add_u32 s37, s37, s38
buffer_load_dwordx4 v23, s[8:11], s37 offen sc1 lds
s_load_dword s64, s[80:81], 0
s_load_dword s65, s[80:81], 64
s_load_dword s66, s[80:81], 128
s_load_dword s67, s[80:81], 192
s_load_dword s68, s[80:81], 256
s_load_dword s69, s[80:81], 320
s_load_dword s70, s[80:81], 384
s_load_dword s71, s[80:81], 448
s_load_dword s72, s[80:81], 512
s_add_u32 s80, s80, 576
s_addc_u32 s81, s81, 0
s_waitcnt vmcnt(16)
s_barrier
s_sub_u32 s41, s41, 1
s_cmp_lg_u32 s41, 0
s_cbranch_scc1 Lp3_139
s_add_u32 s42, s42, 1
s_xor_b32 s37, s42, s35
s_add_u32 m0, s39, 0
s_mul_i32 s37, s37, s40
buffer_load_dwordx4 v22, s[8:11], s37 offen sc1 lds
s_add_u32 m0, s39, 1024
s_add_u32 s37, s37, s38
buffer_load_dwordx4 v23, s[8:11], s37 offen sc1 lds
s_add_u32 m0, s39, 2048
s_add_u32 s37, s37, s38
buffer_load_dwordx4 v22, s[8:11], s37 offen sc1 lds
s_add_u32 m0, s39, 3072
s_add_u32 s37, s37, s38
buffer_load_dwordx4 v23, s[8:11], s37 offen sc1 lds
s_add_u32 m0, s39, 4096
s_add_u32 s37, s37, s38
buffer_load_dwordx4 v22, s[8:11], s37 offen sc1 lds
s_add_u32 m0, s39, 5120
s_add_u32 s37, s37, s38
buffer_load_dwordx4 v23, s[8:11], s37 offen sc1 lds
s_add_u32 m0, s39, 6144
s_add_u32 s37, s37, s38
buffer_load_dwordx4 v22, s[8:11], s37 offen sc1 lds
s_add_u32 m0, s39, 7168
s_add_u32 s37, s37, s38
buffer_load_dwordx4 v23, s[8:11], s37 offen sc1 lds
s_add_u32 m0, s39, 8192
s_add_u32 s37, s37, s38
buffer_load_dwordx4 v22, s[8:11], s37 offen sc1 lds
s_add_u32 m0, s39, 9216
s_add_u32 s37, s37, s38
buffer_load_dwordx4 v23, s[8:11], s37 offen sc1 lds
s_add_u32 m0, s39, 10240
s_add_u32 s37, s37, s38
buffer_load_dwordx4 v22, s[8:11], s37 offen sc1 lds
s_add_u32 m0, s39, 11264
s_add_u32 s37, s37, s38
buffer_load_dwordx4 v23, s[8:11], s37 offen sc1 lds
s_add_u32 m0, s39, 12288
s_add_u32 s37, s37, s38
buffer_load_dwordx4 v22, s[8:11], s37 offen sc1 lds
s_add_u32 m0, s39, 13312
s_add_u32 s37, s37, s38
buffer_load_dwordx4 v23, s[8:11], s37 offen sc1 lds
s_add_u32 m0, s39, 14336
s_add_u32 s37, s37, s38
buffer_load_dwordx4 v22, s[8:11], s37 offen sc1 lds
s_add_u32 m0, s39, 15360
s_add_u32 s37, s37, s38
buffer_load_dwordx4 v23, s[8:11], s37 offen sc1 lds
s_load_dword s64, s[80:81], 0
s_load_dword s65, s[80:81], 64
s_load_dword s66, s[80:81], 128
s_load_dword s67, s[80:81], 192
s_load_dword s68, s[80:81], 256
s_load_dword s69, s[80:81], 320
s_load_dword s70, s[80:81], 384
s_load_dword s71, s[80:81], 448
s_load_dword s72, s[80:81], 512
s_add_u32 s80, s80, 576
s_addc_u32 s81, s81, 0
s_waitcnt vmcnt(16)
s_barrier
s_add_u32 s42, s42, 1
s_xor_b32 s37, s42, s35
s_add_u32 m0, s39, 49152
s_mul_i32 s37, s37, s40
buffer_load_dwordx4 v22, s[8:11], s37 offen sc1 lds
s_add_u32 m0, s39, 50176
s_add_u32 s37, s37, s38
buffer_load_dwordx4 v23, s[8:11], s37 offen sc1 lds
s_add_u32 m0, s39, 51200
s_add_u32 s37, s37, s38
buffer_load_dwordx4 v22, s[8:11], s37 offen sc1 lds
s_add_u32 m0, s39, 52224
s_add_u32 s37, s37, s38
buffer_load_dwordx4 v23, s[8:11], s37 offen sc1 lds
s_add_u32 m0, s39, 53248
s_add_u32 s37, s37, s38
buffer_load_dwordx4 v22, s[8:11], s37 offen sc1 lds
s_add_u32 m0, s39, 54272
s_add_u32 s37, s37, s38
buffer_load_dwordx4 v23, s[8:11], s37 offen sc1 lds
s_add_u32 m0, s39, 55296
s_add_u32 s37, s37, s38
buffer_load_dwordx4 v22, s[8:11], s37 offen sc1 lds
s_add_u32 m0, s39, 56320
s_add_u32 s37, s37, s38
buffer_load_dwordx4 v23, s[8:11], s37 offen sc1 lds
s_add_u32 m0, s39, 57344
s_add_u32 s37, s37, s38
buffer_load_dwordx4 v22, s[8:11], s37 offen sc1 lds
s_add_u32 m0, s39, 58368
s_add_u32 s37, s37, s38
buffer_load_dwordx4 v23, s[8:11], s37 offen sc1 lds
s_add_u32 m0, s39, 59392
s_add_u32 s37, s37, s38
buffer_load_dwordx4 v22, s[8:11], s37 offen sc1 lds
s_add_u32 m0, s39, 60416
s_add_u32 s37, s37, s38
buffer_load_dwordx4 v23, s[8:11], s37 offen sc1 lds
s_add_u32 m0, s39, 61440
s_add_u32 s37, s37, s38
buffer_load_dwordx4 v22, s[8:11], s37 offen sc1 lds
s_add_u32 m0, s39, 62464
s_add_u32 s37, s37, s38
buffer_load_dwordx4 v23, s[8:11], s37 offen sc1 lds
s_add_u32 m0, s39, 63488
s_add_u32 s37, s37, s38
buffer_load_dwordx4 v22, s[8:11], s37 offen sc1 lds
s_add_u32 m0, s39, 64512
s_add_u32 s37, s37, s38
buffer_load_dwordx4 v23, s[8:11], s37 offen sc1 lds
s_load_dword s64, s[80:81], 0
s_load_dword s65, s[80:81], 64
s_load_dword s66, s[80:81], 128
s_load_dword s67, s[80:81], 192
s_load_dword s68, s[80:81], 256
s_load_dword s69, s[80:81], 320
s_load_dword s70, s[80:81], 384
s_load_dword s71, s[80:81], 448
s_load_dword s72, s[80:81], 512
s_add_u32 s80, s80, 576
s_addc_u32 s81, s81, 0
s_waitcnt vmcnt(16)
s_barrier
s_add_u32 s42, s42, 1
s_xor_b32 s37, s42, s35
s_add_u32 m0, s39, 98304
s_mul_i32 s37, s37, s40
buffer_load_dwordx4 v22, s[8:11], s37 offen sc1 lds
s_and_b32 s53, s35, 1
s_lshl_b32 s53, s53, 1
s_mul_i32 s43, s47, 3
s_add_u32 m0, s39, 99328
s_add_u32 s37, s37, s38
buffer_load_dwordx4 v23, s[8:11], s37 offen sc1 lds
s_add_u32 s53, s53, s43
v_lshlrev_b32 v19, 11, v18
v_lshl_add_u32 v19, v17, 4, v19
s_add_u32 m0, s39, 100352
s_add_u32 s37, s37, s38
buffer_load_dwordx4 v22, s[8:11], s37 offen sc1 lds
s_lshl_b32 s43, s46, 10
v_add_u32 v2, s43, v19
v_add_u32 v3, 49152, v2
s_add_u32 m0, s39, 101376
s_add_u32 s37, s37, s38
buffer_load_dwordx4 v23, s[8:11], s37 offen sc1 lds
v_add_u32 v4, 98304, v2
v_lshrrev_b32 v19, 2, v17
v_lshl_add_u32 v20, v18, 2, v19
s_add_u32 m0, s39, 102400
s_add_u32 s37, s37, s38
buffer_load_dwordx4 v22, s[8:11], s37 offen sc1 lds
v_and_b32 v21, 7, v20
v_lshlrev_b32 v20, 8, v20
v_and_b32 v19, 3, v1
s_add_u32 m0, s39, 103424
s_add_u32 s37, s37, s38
buffer_load_dwordx4 v23, s[8:11], s37 offen sc1 lds
v_lshl_add_u32 v20, v19, 3, v20
s_add_u32 s43, s53, 0
v_xor_b32 v19, s43, v21
s_add_u32 m0, s39, 104448
s_add_u32 s37, s37, s38
buffer_load_dwordx4 v22, s[8:11], s37 offen sc1 lds
v_lshl_add_u32 v5, v19, 5, v20
s_add_u32 s43, s53, 1
v_xor_b32 v19, s43, v21
s_add_u32 m0, s39, 105472
s_add_u32 s37, s37, s38
buffer_load_dwordx4 v23, s[8:11], s37 offen sc1 lds
v_lshl_add_u32 v6, v19, 5, v20
s_add_u32 s43, s53, 2
v_xor_b32 v19, s43, v21
s_add_u32 m0, s39, 106496
s_add_u32 s37, s37, s38
buffer_load_dwordx4 v22, s[8:11], s37 offen sc1 lds
v_lshl_add_u32 v7, v19, 5, v20
v_add_u32 v9, 49152, v5
v_add_u32 v10, 49152, v6
s_add_u32 m0, s39, 107520
s_add_u32 s37, s37, s38
buffer_load_dwordx4 v23, s[8:11], s37 offen sc1 lds
v_add_u32 v11, 49152, v7
v_add_u32 v13, 98304, v5
v_add_u32 v14, 98304, v6
s_add_u32 m0, s39, 108544
s_add_u32 s37, s37, s38
buffer_load_dwordx4 v22, s[8:11], s37 offen sc1 lds
v_add_u32 v15, 98304, v7
s_lshl_b32 s43, s46, 9
s_add_u32 s43, s43, 147456
s_add_u32 m0, s39, 109568
s_add_u32 s37, s37, s38
buffer_load_dwordx4 v23, s[8:11], s37 offen sc1 lds
v_lshl_add_u32 v19, v17, 3, s43
ds_read_b64 v[80:81], v19 offset:0
ds_read_b64 v[82:83], v19 offset:128
s_add_u32 m0, s39, 110592
s_add_u32 s37, s37, s38
buffer_load_dwordx4 v22, s[8:11], s37 offen sc1 lds
ds_read_b64 v[84:85], v19 offset:256
ds_read_b64 v[86:87], v19 offset:384
s_mul_i32 s43, s47, 192
s_add_u32 m0, s39, 111616
s_add_u32 s37, s37, s38
buffer_load_dwordx4 v23, s[8:11], s37 offen sc1 lds
s_add_u32 s43, s43, 148992
v_lshl_add_u32 v19, v18, 4, s43
ds_read_b128 v[48:51], v19 offset:0
s_add_u32 m0, s39, 112640
s_add_u32 s37, s37, s38
buffer_load_dwordx4 v22, s[8:11], s37 offen sc1 lds
ds_read_b128 v[52:55], v19 offset:64
ds_read_b128 v[56:59], v19 offset:128
ds_read_b128 v[60:63], v19 offset:896
s_add_u32 m0, s39, 113664
s_add_u32 s37, s37, s38
buffer_load_dwordx4 v23, s[8:11], s37 offen sc1 lds
ds_read_b128 v[64:67], v19 offset:960
ds_read_b128 v[68:71], v19 offset:1024
s_waitcnt vmcnt(16)
s_barrier
s_add_u32 s42, s42, 1
s_xor_b32 s37, s42, s35
s_add_u32 m0, s39, 0
s_mul_i32 s37, s37, s40
buffer_load_dwordx4 v22, s[8:11], s37 offen sc1 lds
s_waitcnt lgkmcnt(0)
v_mul_f32 v88, v81, v81
s_add_u32 m0, s39, 1024
s_add_u32 s37, s37, s38
buffer_load_dwordx4 v23, s[8:11], s37 offen sc1 lds
v_mul_f32 v228, 0xc0135761, v81
s_add_u32 m0, s39, 2048
s_add_u32 s37, s37, s38
buffer_load_dwordx4 v22, s[8:11], s37 offen sc1 lds
v_mul_f32 v89, 0xbdd2d3e8, v81
s_add_u32 m0, s39, 3072
s_add_u32 s37, s37, s38
buffer_load_dwordx4 v23, s[8:11], s37 offen sc1 lds
v_rcp_f32 v236, v88
v_mul_f32 v232, v89, v88
s_add_u32 m0, s39, 4096
s_add_u32 s37, s37, s38
buffer_load_dwordx4 v22, s[8:11], s37 offen sc1 lds
v_mul_f32 v88, v83, v83
s_add_u32 m0, s39, 5120
s_add_u32 s37, s37, s38
buffer_load_dwordx4 v23, s[8:11], s37 offen sc1 lds
v_mul_f32 v229, 0xc0135761, v83
s_add_u32 m0, s39, 6144
s_add_u32 s37, s37, s38
buffer_load_dwordx4 v22, s[8:11], s37 offen sc1 lds
v_mul_f32 v89, 0xbdd2d3e8, v83
v_rcp_f32 v237, v88
s_add_u32 m0, s39, 7168
s_add_u32 s37, s37, s38
buffer_load_dwordx4 v23, s[8:11], s37 offen sc1 lds
v_mul_f32 v233, v89, v88
s_add_u32 m0, s39, 8192
s_add_u32 s37, s37, s38
buffer_load_dwordx4 v22, s[8:11], s37 offen sc1 lds
v_mul_f32 v88, v85, v85
s_add_u32 m0, s39, 9216
s_add_u32 s37, s37, s38
buffer_load_dwordx4 v23, s[8:11], s37 offen sc1 lds
v_mul_f32 v230, 0xc0135761, v85
v_mul_f32 v89, 0xbdd2d3e8, v85
s_add_u32 m0, s39, 10240
s_add_u32 s37, s37, s38
buffer_load_dwordx4 v22, s[8:11], s37 offen sc1 lds
v_rcp_f32 v238, v88
s_add_u32 m0, s39, 11264
s_add_u32 s37, s37, s38
buffer_load_dwordx4 v23, s[8:11], s37 offen sc1 lds
v_mul_f32 v234, v89, v88
s_add_u32 m0, s39, 12288
s_add_u32 s37, s37, s38
buffer_load_dwordx4 v22, s[8:11], s37 offen sc1 lds
v_mul_f32 v88, v87, v87
v_mul_f32 v231, 0xc0135761, v87
s_add_u32 m0, s39, 13312
s_add_u32 s37, s37, s38
buffer_load_dwordx4 v23, s[8:11], s37 offen sc1 lds
v_mul_f32 v89, 0xbdd2d3e8, v87
s_add_u32 m0, s39, 14336
s_add_u32 s37, s37, s38
buffer_load_dwordx4 v22, s[8:11], s37 offen sc1 lds
v_rcp_f32 v239, v88
s_add_u32 m0, s39, 15360
s_add_u32 s37, s37, s38
buffer_load_dwordx4 v23, s[8:11], s37 offen sc1 lds
v_mul_f32 v235, v89, v88
s_mul_i32 s43, s34, 917504
s_mov_b32 s44, 3577949200
s_mov_b32 s45, 3137247350
s_lshl_b32 s50, s49, 2
s_lshr_b64 s[44:45], s[44:45], s50
s_and_b32 s50, s44, 15
s_mul_i32 s44, s50, 24576
s_add_u32 s43, s43, s44
s_add_u32 s43, s43, 8912896
s_add_u32 s24, s32, s43
s_addc_u32 s25, s33, 0
s_mov_b32 s26, 24576
s_mov_b32 s27, 0x20000
s_mov_b32 s53, 262144
s_lshl_b32 s43, s47, 13
s_lshl_b32 s44, s46, 10
s_add_u32 s43, s43, s44
v_lshlrev_b32 v19, 11, v18
v_lshl_add_u32 v19, v17, 4, v19
v_add_u32 v27, s43, v19
s_lshl_b32 s43, s47, 12
s_add_u32 s43, s43, s44
s_add_u32 s43, s43, 16384
v_and_b32 v19, 1, v18
v_lshlrev_b32 v19, 11, v19
v_lshrrev_b32 v20, 1, v18
v_lshl_add_u32 v19, v20, 8, v19
v_lshl_add_u32 v19, v17, 4, v19
v_add_u32 v28, s43, v19
s_load_dword s64, s[80:81], 0
s_load_dword s65, s[80:81], 64
s_load_dword s66, s[80:81], 128
s_load_dword s67, s[80:81], 192
s_load_dword s68, s[80:81], 256
s_load_dword s69, s[80:81], 320
s_load_dword s70, s[80:81], 384
s_load_dword s71, s[80:81], 448
s_add_u32 s80, s80, 512
s_addc_u32 s81, s81, 0
s_waitcnt vmcnt(16)
s_barrier
s_add_u32 s42, s42, 1
s_xor_b32 s37, s42, s35
s_add_u32 m0, s39, 49152
s_mul_i32 s37, s37, s40
buffer_load_dwordx4 v22, s[8:11], s37 offen sc1 lds
v_mul_f32 v128, -v80, v48
v_mul_f32 v129, -v80, v49
s_add_u32 m0, s39, 50176
s_add_u32 s37, s37, s38
buffer_load_dwordx4 v23, s[8:11], s37 offen sc1 lds
v_mul_f32 v130, -v80, v50
v_mul_f32 v131, -v80, v51
s_add_u32 m0, s39, 51200
s_add_u32 s37, s37, s38
buffer_load_dwordx4 v22, s[8:11], s37 offen sc1 lds
v_mul_f32 v132, -v82, v48
v_mul_f32 v133, -v82, v49
s_add_u32 m0, s39, 52224
s_add_u32 s37, s37, s38
buffer_load_dwordx4 v23, s[8:11], s37 offen sc1 lds
v_mul_f32 v134, -v82, v50
v_mul_f32 v135, -v82, v51
s_add_u32 m0, s39, 53248
s_add_u32 s37, s37, s38
buffer_load_dwordx4 v22, s[8:11], s37 offen sc1 lds
v_mul_f32 v136, -v84, v48
v_mul_f32 v137, -v84, v49
s_add_u32 m0, s39, 54272
s_add_u32 s37, s37, s38
buffer_load_dwordx4 v23, s[8:11], s37 offen sc1 lds
v_mul_f32 v138, -v84, v50
v_mul_f32 v139, -v84, v51
s_add_u32 m0, s39, 55296
s_add_u32 s37, s37, s38
buffer_load_dwordx4 v22, s[8:11], s37 offen sc1 lds
v_mul_f32 v140, -v86, v48
v_mul_f32 v141, -v86, v49
s_add_u32 m0, s39, 56320
s_add_u32 s37, s37, s38
buffer_load_dwordx4 v23, s[8:11], s37 offen sc1 lds
v_mul_f32 v142, -v86, v50
v_mul_f32 v143, -v86, v51
s_add_u32 m0, s39, 57344
s_add_u32 s37, s37, s38
buffer_load_dwordx4 v22, s[8:11], s37 offen sc1 lds
v_mul_f32 v144, -v80, v52
v_mul_f32 v145, -v80, v53
s_add_u32 m0, s39, 58368
s_add_u32 s37, s37, s38
buffer_load_dwordx4 v23, s[8:11], s37 offen sc1 lds
v_mul_f32 v146, -v80, v54
v_mul_f32 v147, -v80, v55
s_add_u32 m0, s39, 59392
s_add_u32 s37, s37, s38
buffer_load_dwordx4 v22, s[8:11], s37 offen sc1 lds
v_mul_f32 v148, -v82, v52
v_mul_f32 v149, -v82, v53
s_add_u32 m0, s39, 60416
s_add_u32 s37, s37, s38
buffer_load_dwordx4 v23, s[8:11], s37 offen sc1 lds
v_mul_f32 v150, -v82, v54
v_mul_f32 v151, -v82, v55
s_add_u32 m0, s39, 61440
s_add_u32 s37, s37, s38
buffer_load_dwordx4 v22, s[8:11], s37 offen sc1 lds
v_mul_f32 v152, -v84, v52
v_mul_f32 v153, -v84, v53
s_add_u32 m0, s39, 62464
s_add_u32 s37, s37, s38
buffer_load_dwordx4 v23, s[8:11], s37 offen sc1 lds
v_mul_f32 v154, -v84, v54
v_mul_f32 v155, -v84, v55
s_add_u32 m0, s39, 63488
s_add_u32 s37, s37, s38
buffer_load_dwordx4 v22, s[8:11], s37 offen sc1 lds
v_mul_f32 v156, -v86, v52
v_mul_f32 v157, -v86, v53
s_add_u32 m0, s39, 64512
s_add_u32 s37, s37, s38
buffer_load_dwordx4 v23, s[8:11], s37 offen sc1 lds
v_mul_f32 v158, -v86, v54
v_mul_f32 v159, -v86, v55
s_load_dword s64, s[80:81], 0
s_load_dword s65, s[80:81], 64
s_load_dword s66, s[80:81], 128
s_load_dword s67, s[80:81], 192
s_load_dword s68, s[80:81], 256
s_load_dword s69, s[80:81], 320
s_load_dword s70, s[80:81], 384
s_load_dword s71, s[80:81], 448
s_add_u32 s80, s80, 512
s_addc_u32 s81, s81, 0
s_waitcnt vmcnt(16)
s_barrier
s_add_u32 s42, s42, 1
s_xor_b32 s37, s42, s35
s_add_u32 m0, s39, 98304
s_mul_i32 s37, s37, s40
buffer_load_dwordx4 v22, s[8:11], s37 offen sc1 lds
v_mul_f32 v160, -v80, v56
v_mul_f32 v161, -v80, v57
s_add_u32 m0, s39, 99328
s_add_u32 s37, s37, s38
buffer_load_dwordx4 v23, s[8:11], s37 offen sc1 lds
v_mul_f32 v162, -v80, v58
v_mul_f32 v163, -v80, v59
s_add_u32 m0, s39, 100352
s_add_u32 s37, s37, s38
buffer_load_dwordx4 v22, s[8:11], s37 offen sc1 lds
v_mul_f32 v164, -v82, v56
v_mul_f32 v165, -v82, v57
s_add_u32 m0, s39, 101376
s_add_u32 s37, s37, s38
buffer_load_dwordx4 v23, s[8:11], s37 offen sc1 lds
v_mul_f32 v166, -v82, v58
v_mul_f32 v167, -v82, v59
s_add_u32 m0, s39, 102400
s_add_u32 s37, s37, s38
buffer_load_dwordx4 v22, s[8:11], s37 offen sc1 lds
v_mul_f32 v168, -v84, v56
v_mul_f32 v169, -v84, v57
s_add_u32 m0, s39, 103424
s_add_u32 s37, s37, s38
buffer_load_dwordx4 v23, s[8:11], s37 offen sc1 lds
v_mul_f32 v170, -v84, v58
v_mul_f32 v171, -v84, v59
s_add_u32 m0, s39, 104448
s_add_u32 s37, s37, s38
buffer_load_dwordx4 v22, s[8:11], s37 offen sc1 lds
v_mul_f32 v172, -v86, v56
v_mul_f32 v173, -v86, v57
s_add_u32 m0, s39, 105472
s_add_u32 s37, s37, s38
buffer_load_dwordx4 v23, s[8:11], s37 offen sc1 lds
v_mul_f32 v174, -v86, v58
v_mul_f32 v175, -v86, v59
s_add_u32 m0, s39, 106496
s_add_u32 s37, s37, s38
buffer_load_dwordx4 v22, s[8:11], s37 offen sc1 lds
v_mul_f32 v176, -v80, v60
v_mul_f32 v177, -v80, v61
s_add_u32 m0, s39, 107520
s_add_u32 s37, s37, s38
buffer_load_dwordx4 v23, s[8:11], s37 offen sc1 lds
v_mul_f32 v178, -v80, v62
v_mul_f32 v179, -v80, v63
s_add_u32 m0, s39, 108544
s_add_u32 s37, s37, s38
buffer_load_dwordx4 v22, s[8:11], s37 offen sc1 lds
v_mul_f32 v180, -v82, v60
v_mul_f32 v181, -v82, v61
s_add_u32 m0, s39, 109568
s_add_u32 s37, s37, s38
buffer_load_dwordx4 v23, s[8:11], s37 offen sc1 lds
v_mul_f32 v182, -v82, v62
v_mul_f32 v183, -v82, v63
s_add_u32 m0, s39, 110592
s_add_u32 s37, s37, s38
buffer_load_dwordx4 v22, s[8:11], s37 offen sc1 lds
v_mul_f32 v184, -v84, v60
v_mul_f32 v185, -v84, v61
s_add_u32 m0, s39, 111616
s_add_u32 s37, s37, s38
buffer_load_dwordx4 v23, s[8:11], s37 offen sc1 lds
v_mul_f32 v186, -v84, v62
v_mul_f32 v187, -v84, v63
s_add_u32 m0, s39, 112640
s_add_u32 s37, s37, s38
buffer_load_dwordx4 v22, s[8:11], s37 offen sc1 lds
v_mul_f32 v188, -v86, v60
v_mul_f32 v189, -v86, v61
s_add_u32 m0, s39, 113664
s_add_u32 s37, s37, s38
buffer_load_dwordx4 v23, s[8:11], s37 offen sc1 lds
v_mul_f32 v190, -v86, v62
v_mul_f32 v191, -v86, v63
s_load_dword s64, s[80:81], 0
s_load_dword s65, s[80:81], 64
s_load_dword s66, s[80:81], 128
s_load_dword s67, s[80:81], 192
s_load_dword s68, s[80:81], 256
s_load_dword s69, s[80:81], 320
s_load_dword s70, s[80:81], 384
s_load_dword s71, s[80:81], 448
s_add_u32 s80, s80, 512
s_addc_u32 s81, s81, 0
s_waitcnt vmcnt(16)
s_barrier
s_mul_i32 s43, s49, 192
s_and_b32 s43, s43, 0xffffff80
s_add_u32 s43, s43, 4096
s_cmp_eq_u32 s51, 1
s_cselect_b32 s8, s4, s6
s_cselect_b32 s9, s5, s7
s_sub_u32 s10, 7340032, s43
s_lshl_b32 s44, s34, 18
s_add_u32 s44, s44, 4194304
s_movk_i32 s38, 28672
s_cmp_eq_u32 s51, 0
s_cselect_b32 s8, s32, s8
s_cselect_b32 s9, s33, s9
s_cselect_b32 s10, 262144, s10
s_cselect_b32 s43, s44, s43
s_cselect_b32 s38, 1024, s38
s_cselect_b32 s45, 0, -1
s_add_u32 s8, s8, s43
s_addc_u32 s9, s9, 0
s_mov_b32 s11, 0x20000
s_lshl_b32 s40, s38, 4
s_mov_b32 s42, -1
s_lshl_b32 s39, s51, 14
v_lshrrev_b32 v19, 4, v1
v_lshlrev_b32 v20, 5, v19
v_mul_u32_u24 v19, 6912, v19
v_and_b32 v19, s45, v19
v_and_b32 v20, s45, v20
v_lshlrev_b32 v21, 4, v1
v_xor_b32 v21, v21, v20
v_add_u32 v22, v21, v19
s_and_b32 s45, s45, 128
v_xor_b32 v23, s45, v22
s_add_u32 s42, s42, 1
s_xor_b32 s37, s42, s35
s_add_u32 m0, s39, 0
s_mul_i32 s37, s37, s40
buffer_load_dwordx4 v22, s[8:11], s37 offen sc1 lds
v_mul_f32 v192, -v80, v64
v_mul_f32 v193, -v80, v65
s_add_u32 m0, s39, 1024
s_add_u32 s37, s37, s38
buffer_load_dwordx4 v23, s[8:11], s37 offen sc1 lds
v_mul_f32 v194, -v80, v66
v_mul_f32 v195, -v80, v67
s_add_u32 m0, s39, 2048
s_add_u32 s37, s37, s38
buffer_load_dwordx4 v22, s[8:11], s37 offen sc1 lds
v_mul_f32 v196, -v82, v64
v_mul_f32 v197, -v82, v65
s_add_u32 m0, s39, 3072
s_add_u32 s37, s37, s38
buffer_load_dwordx4 v23, s[8:11], s37 offen sc1 lds
v_mul_f32 v198, -v82, v66
v_mul_f32 v199, -v82, v67
s_add_u32 m0, s39, 4096
s_add_u32 s37, s37, s38
buffer_load_dwordx4 v22, s[8:11], s37 offen sc1 lds
v_mul_f32 v200, -v84, v64
v_mul_f32 v201, -v84, v65
s_add_u32 m0, s39, 5120
s_add_u32 s37, s37, s38
buffer_load_dwordx4 v23, s[8:11], s37 offen sc1 lds
v_mul_f32 v202, -v84, v66
v_mul_f32 v203, -v84, v67
s_add_u32 m0, s39, 6144
s_add_u32 s37, s37, s38
buffer_load_dwordx4 v22, s[8:11], s37 offen sc1 lds
v_mul_f32 v204, -v86, v64
v_mul_f32 v205, -v86, v65
s_add_u32 m0, s39, 7168
s_add_u32 s37, s37, s38
buffer_load_dwordx4 v23, s[8:11], s37 offen sc1 lds
v_mul_f32 v206, -v86, v66
v_mul_f32 v207, -v86, v67
s_add_u32 m0, s39, 8192
s_add_u32 s37, s37, s38
buffer_load_dwordx4 v22, s[8:11], s37 offen sc1 lds
v_mul_f32 v208, -v80, v68
v_mul_f32 v209, -v80, v69
s_add_u32 m0, s39, 9216
s_add_u32 s37, s37, s38
buffer_load_dwordx4 v23, s[8:11], s37 offen sc1 lds
v_mul_f32 v210, -v80, v70
v_mul_f32 v211, -v80, v71
s_add_u32 m0, s39, 10240
s_add_u32 s37, s37, s38
buffer_load_dwordx4 v22, s[8:11], s37 offen sc1 lds
v_mul_f32 v212, -v82, v68
v_mul_f32 v213, -v82, v69
s_add_u32 m0, s39, 11264
s_add_u32 s37, s37, s38
buffer_load_dwordx4 v23, s[8:11], s37 offen sc1 lds
v_mul_f32 v214, -v82, v70
v_mul_f32 v215, -v82, v71
s_add_u32 m0, s39, 12288
s_add_u32 s37, s37, s38
buffer_load_dwordx4 v22, s[8:11], s37 offen sc1 lds
v_mul_f32 v216, -v84, v68
v_mul_f32 v217, -v84, v69
s_add_u32 m0, s39, 13312
s_add_u32 s37, s37, s38
buffer_load_dwordx4 v23, s[8:11], s37 offen sc1 lds
v_mul_f32 v218, -v84, v70
v_mul_f32 v219, -v84, v71
s_add_u32 m0, s39, 14336
s_add_u32 s37, s37, s38
buffer_load_dwordx4 v22, s[8:11], s37 offen sc1 lds
v_mul_f32 v220, -v86, v68
v_mul_f32 v221, -v86, v69
s_add_u32 m0, s39, 15360
s_add_u32 s37, s37, s38
buffer_load_dwordx4 v23, s[8:11], s37 offen sc1 lds
v_mul_f32 v222, -v86, v70
v_mul_f32 v223, -v86, v71
s_load_dword s64, s[80:81], 0
s_load_dword s65, s[80:81], 64
s_load_dword s66, s[80:81], 128
s_load_dword s67, s[80:81], 192
s_load_dword s68, s[80:81], 256
s_load_dword s69, s[80:81], 320
s_load_dword s70, s[80:81], 384
s_add_u32 s80, s80, 448
s_addc_u32 s81, s81, 0
s_waitcnt vmcnt(16)
s_barrier
s_add_u32 s42, s42, 1
s_xor_b32 s37, s42, s35
s_add_u32 m0, s39, 49152
s_mul_i32 s37, s37, s40
buffer_load_dwordx4 v22, s[8:11], s37 offen sc1 lds
s_add_u32 m0, s39, 50176
s_add_u32 s37, s37, s38
buffer_load_dwordx4 v23, s[8:11], s37 offen sc1 lds
s_add_u32 m0, s39, 51200
s_add_u32 s37, s37, s38
buffer_load_dwordx4 v22, s[8:11], s37 offen sc1 lds
s_add_u32 m0, s39, 52224
s_add_u32 s37, s37, s38
buffer_load_dwordx4 v23, s[8:11], s37 offen sc1 lds
s_add_u32 m0, s39, 53248
s_add_u32 s37, s37, s38
buffer_load_dwordx4 v22, s[8:11], s37 offen sc1 lds
s_add_u32 m0, s39, 54272
s_add_u32 s37, s37, s38
buffer_load_dwordx4 v23, s[8:11], s37 offen sc1 lds
s_add_u32 m0, s39, 55296
s_add_u32 s37, s37, s38
buffer_load_dwordx4 v22, s[8:11], s37 offen sc1 lds
s_add_u32 m0, s39, 56320
s_add_u32 s37, s37, s38
buffer_load_dwordx4 v23, s[8:11], s37 offen sc1 lds
s_add_u32 m0, s39, 57344
s_add_u32 s37, s37, s38
buffer_load_dwordx4 v22, s[8:11], s37 offen sc1 lds
s_add_u32 m0, s39, 58368
s_add_u32 s37, s37, s38
buffer_load_dwordx4 v23, s[8:11], s37 offen sc1 lds
s_add_u32 m0, s39, 59392
s_add_u32 s37, s37, s38
buffer_load_dwordx4 v22, s[8:11], s37 offen sc1 lds
s_add_u32 m0, s39, 60416
s_add_u32 s37, s37, s38
buffer_load_dwordx4 v23, s[8:11], s37 offen sc1 lds
s_add_u32 m0, s39, 61440
s_add_u32 s37, s37, s38
buffer_load_dwordx4 v22, s[8:11], s37 offen sc1 lds
s_add_u32 m0, s39, 62464
s_add_u32 s37, s37, s38
buffer_load_dwordx4 v23, s[8:11], s37 offen sc1 lds
s_add_u32 m0, s39, 63488
s_add_u32 s37, s37, s38
buffer_load_dwordx4 v22, s[8:11], s37 offen sc1 lds
s_add_u32 m0, s39, 64512
s_add_u32 s37, s37, s38
buffer_load_dwordx4 v23, s[8:11], s37 offen sc1 lds
s_mul_i32 s44, s34, 917504
s_lshl_b32 s39, s51, 13
s_add_u32 s44, s44, s39
s_add_u32 s44, s44, 8388608
s_and_b32 s43, s51, 1
s_xor_b32 s43, s43, s35
s_lshl_b32 s43, s43, 7
s_mov_b32 s10, 909312
s_movk_i32 s38, 1024
s_movk_i32 s40, 9216
s_movk_i32 s37, 0x4000
s_cmp_ge_u32 s51, 2
s_cselect_b32 s8, s60, s32
s_cselect_b32 s9, s61, s33
s_cselect_b32 s10, 7338112, s10
s_cselect_b32 s43, s43, s44
s_cselect_b32 s38, 16384, s38
s_cselect_b32 s40, 81920, s40
s_cselect_b32 s55, 81920, s38
s_cselect_b32 s37, 262144, s37
s_cselect_b32 s45, -1, 0
s_add_u32 s8, s8, s43
s_addc_u32 s9, s9, 0
s_mov_b32 s11, 0x20000
s_and_b32 s53, s35, 1
s_mul_i32 s54, s53, 6
s_mul_i32 s54, s54, s37
s_mul_i32 s29, s53, 2
s_add_u32 s29, s29, 6
s_mul_i32 s29, s29, s37
s_and_b32 s43, s45, 4290838528
s_add_u32 s29, s29, s43
s_mul_i32 s37, s37, 2
s_sub_u32 s37, s37, s40
v_lshrrev_b32 v19, 3, v1
v_mul_u32_u24 v19, 1920, v19
v_lshrrev_b32 v20, 4, v1
v_lshlrev_b32 v20, 5, v20
v_and_b32 v19, s45, v19
v_and_b32 v20, s45, v20
v_lshlrev_b32 v21, 4, v1
v_xor_b32 v21, v21, v20
v_add_u32 v21, v21, v19
s_waitcnt vmcnt(16)
s_barrier
s_branch LK3b_134
.p2align 6
Lw_43:
s_branch Lr_44
s_nop 0
.p2align 3
L7_133:
s_lshr_b32 s43, s2, 5
s_cmp_eq_u32 s43, 3
s_cbranch_scc1 Lnojob_140
s_cmp_gt_u32 s43, 3
s_cselect_b32 s43, 32, 0
s_sub_u32 s43, s2, s43
s_lshr_b32 s43, s43, 1
s_and_b32 s44, s2, 1
s_cmp_eq_u32 s44, 0
s_cselect_b32 s68, s4, s6
s_cselect_b32 s69, s5, s7
s_mul_i32 s45, s43, 2341
s_lshr_b32 s45, s45, 16
s_mul_i32 s46, s45, 28
s_sub_u32 s46, s43, s46
v_lshrrev_b32 v4, 4, v1
s_lshl_b32 s43, s45, 8
v_add_u32 v4, s43, v4
v_mul_u32_u24 v4, 7168, v4
v_and_b32 v5, 15, v1
v_lshl_add_u32 v4, v5, 4, v4
s_lshl_b32 s43, s46, 8
v_add_u32 v4, s43, v4
s_mov_b32 s64, s68
s_mov_b32 s65, s69
s_mov_b32 s66, 7340032
s_mov_b32 s67, 0x20000
s_lshl_b32 s55, s45, 1
s_add_u32 s55, s55, s44
s_mul_i32 s55, s55, 14336
s_lshl_b32 s45, s46, 9
s_mov_b32 s50, s46
s_add_u32 s55, s55, s45
v_lshl_add_u32 v5, v5, 5, s55
s_add_u32 s72, s32, 27262976
s_addc_u32 s73, s33, 0
s_mov_b32 s74, 114688
s_mov_b32 s75, 0x20000
v_mov_b32 v32, 0
v_mov_b32 v33, 0
v_mov_b32 v34, 0
v_mov_b32 v35, 0
v_mov_b32 v36, 0
v_mov_b32 v37, 0
v_mov_b32 v38, 0
v_mov_b32 v39, 0
s_lshl_b32 s43, s34, 18
s_add_u32 s12, s32, s43
s_addc_u32 s13, s33, 0
s_mov_b32 s14, 262144
s_mov_b32 s15, 0x20000
v_lshlrev_b32 v21, 4, v1
s_lshl_b32 s54, s36, 11
s_xor_b32 s43, s35, 1
s_and_b32 s43, s43, 15
s_lshl_b32 s43, s43, 14
s_add_u32 s30, s43, s54
s_xor_b32 s43, s35, 2
s_and_b32 s43, s43, 15
s_lshl_b32 s43, s43, 14
s_add_u32 s31, s43, s54
s_waitcnt vmcnt(0)
s_barrier
ds_write_b128 v27, v[68:71] offset:0
ds_write_b128 v27, v[116:119] offset:512
s_mov_b32 s43, 917504
buffer_load_dwordx4 v[56:59], v4, s[64:67], s43 offen
s_mov_b32 s43, 946176
buffer_load_dwordx4 v[60:63], v4, s[64:67], s43 offen
s_mov_b32 s43, 974848
buffer_load_dwordx4 v[64:67], v4, s[64:67], s43 offen
s_mov_b32 s43, 1003520
buffer_load_dwordx4 v[72:75], v4, s[64:67], s43 offen
s_mov_b32 s43, 1032192
buffer_load_dwordx4 v[76:79], v4, s[64:67], s43 offen
s_mov_b32 s43, 1060864
buffer_load_dwordx4 v[80:83], v4, s[64:67], s43 offen
s_mov_b32 s43, 1089536
buffer_load_dwordx4 v[84:87], v4, s[64:67], s43 offen
s_mov_b32 s43, 1118208
buffer_load_dwordx4 v[88:91], v4, s[64:67], s43 offen
s_mov_b32 s43, 1146880
buffer_load_dwordx4 v[92:95], v4, s[64:67], s43 offen
s_mov_b32 s43, 1175552
buffer_load_dwordx4 v[96:99], v4, s[64:67], s43 offen
s_mov_b32 s43, 1204224
buffer_load_dwordx4 v[100:103], v4, s[64:67], s43 offen
s_mov_b32 s43, 1232896
buffer_load_dwordx4 v[104:107], v4, s[64:67], s43 offen
s_mov_b32 s43, 1261568
buffer_load_dwordx4 v[108:111], v4, s[64:67], s43 offen
s_mov_b32 s43, 1290240
buffer_load_dwordx4 v[112:115], v4, s[64:67], s43 offen
s_mov_b32 s43, 1318912
buffer_load_dwordx4 v[120:123], v4, s[64:67], s43 offen
s_mov_b32 s43, 1347584
buffer_load_dwordx4 v[124:127], v4, s[64:67], s43 offen
v_lshlrev_b32 v40, 16, v128
v_and_b32 v41, 0xffff0000, v128
v_lshlrev_b32 v42, 16, v129
v_and_b32 v43, 0xffff0000, v129
v_lshlrev_b32 v44, 16, v130
v_and_b32 v45, 0xffff0000, v130
v_lshlrev_b32 v46, 16, v131
v_and_b32 v47, 0xffff0000, v131
v_pk_add_f32 v[32:33], v[32:33], v[40:41]
v_pk_add_f32 v[34:35], v[34:35], v[42:43]
v_pk_add_f32 v[36:37], v[36:37], v[44:45]
v_pk_add_f32 v[38:39], v[38:39], v[46:47]
v_lshlrev_b32 v48, 16, v132
v_and_b32 v49, 0xffff0000, v132
v_lshlrev_b32 v50, 16, v133
v_and_b32 v51, 0xffff0000, v133
v_lshlrev_b32 v52, 16, v134
v_and_b32 v53, 0xffff0000, v134
v_lshlrev_b32 v54, 16, v135
v_and_b32 v55, 0xffff0000, v135
v_pk_add_f32 v[32:33], v[32:33], v[48:49]
v_pk_add_f32 v[34:35], v[34:35], v[50:51]
v_pk_add_f32 v[36:37], v[36:37], v[52:53]
v_pk_add_f32 v[38:39], v[38:39], v[54:55]
v_lshlrev_b32 v40, 16, v136
v_and_b32 v41, 0xffff0000, v136
v_lshlrev_b32 v42, 16, v137
v_and_b32 v43, 0xffff0000, v137
v_lshlrev_b32 v44, 16, v138
v_and_b32 v45, 0xffff0000, v138
v_lshlrev_b32 v46, 16, v139
v_and_b32 v47, 0xffff0000, v139
v_pk_add_f32 v[32:33], v[32:33], v[40:41]
v_pk_add_f32 v[34:35], v[34:35], v[42:43]
v_pk_add_f32 v[36:37], v[36:37], v[44:45]
v_pk_add_f32 v[38:39], v[38:39], v[46:47]
v_lshlrev_b32 v48, 16, v140
v_and_b32 v49, 0xffff0000, v140
v_lshlrev_b32 v50, 16, v141
v_and_b32 v51, 0xffff0000, v141
v_lshlrev_b32 v52, 16, v142
v_and_b32 v53, 0xffff0000, v142
v_lshlrev_b32 v54, 16, v143
v_and_b32 v55, 0xffff0000, v143
v_pk_add_f32 v[32:33], v[32:33], v[48:49]
v_pk_add_f32 v[34:35], v[34:35], v[50:51]
v_pk_add_f32 v[36:37], v[36:37], v[52:53]
v_pk_add_f32 v[38:39], v[38:39], v[54:55]
v_lshlrev_b32 v40, 16, v144
v_and_b32 v41, 0xffff0000, v144
v_lshlrev_b32 v42, 16, v145
v_and_b32 v43, 0xffff0000, v145
v_lshlrev_b32 v44, 16, v146
v_and_b32 v45, 0xffff0000, v146
v_lshlrev_b32 v46, 16, v147
v_and_b32 v47, 0xffff0000, v147
v_pk_add_f32 v[32:33], v[32:33], v[40:41]
v_pk_add_f32 v[34:35], v[34:35], v[42:43]
v_pk_add_f32 v[36:37], v[36:37], v[44:45]
v_pk_add_f32 v[38:39], v[38:39], v[46:47]
v_lshlrev_b32 v48, 16, v148
v_and_b32 v49, 0xffff0000, v148
v_lshlrev_b32 v50, 16, v149
v_and_b32 v51, 0xffff0000, v149
v_lshlrev_b32 v52, 16, v150
v_and_b32 v53, 0xffff0000, v150
v_lshlrev_b32 v54, 16, v151
v_and_b32 v55, 0xffff0000, v151
v_pk_add_f32 v[32:33], v[32:33], v[48:49]
v_pk_add_f32 v[34:35], v[34:35], v[50:51]
v_pk_add_f32 v[36:37], v[36:37], v[52:53]
v_pk_add_f32 v[38:39], v[38:39], v[54:55]
v_lshlrev_b32 v40, 16, v152
v_and_b32 v41, 0xffff0000, v152
v_lshlrev_b32 v42, 16, v153
v_and_b32 v43, 0xffff0000, v153
v_lshlrev_b32 v44, 16, v154
v_and_b32 v45, 0xffff0000, v154
v_lshlrev_b32 v46, 16, v155
v_and_b32 v47, 0xffff0000, v155
v_pk_add_f32 v[32:33], v[32:33], v[40:41]
v_pk_add_f32 v[34:35], v[34:35], v[42:43]
v_pk_add_f32 v[36:37], v[36:37], v[44:45]
v_pk_add_f32 v[38:39], v[38:39], v[46:47]
v_lshlrev_b32 v48, 16, v156
v_and_b32 v49, 0xffff0000, v156
v_lshlrev_b32 v50, 16, v157
v_and_b32 v51, 0xffff0000, v157
v_lshlrev_b32 v52, 16, v158
v_and_b32 v53, 0xffff0000, v158
v_lshlrev_b32 v54, 16, v159
v_and_b32 v55, 0xffff0000, v159
v_pk_add_f32 v[32:33], v[32:33], v[48:49]
v_pk_add_f32 v[34:35], v[34:35], v[50:51]
v_pk_add_f32 v[36:37], v[36:37], v[52:53]
v_pk_add_f32 v[38:39], v[38:39], v[54:55]
s_waitcnt lgkmcnt(0)
s_barrier
s_add_u32 m0, s54, 16384
s_add_u32 s43, s30, 0
buffer_load_dwordx4 v21, s[12:15], s43 offen sc1 lds
s_add_u32 m0, s54, 17408
s_add_u32 s43, s30, 1024
buffer_load_dwordx4 v21, s[12:15], s43 offen sc1 lds
s_add_u32 m0, s54, 32768
s_add_u32 s43, s31, 0
buffer_load_dwordx4 v21, s[12:15], s43 offen sc1 lds
s_add_u32 m0, s54, 33792
s_add_u32 s43, s31, 1024
buffer_load_dwordx4 v21, s[12:15], s43 offen sc1 lds
s_waitcnt vmcnt(2)
s_barrier
s_waitcnt vmcnt(0)
s_barrier
v_lshlrev_b32 v40, 16, v160
v_and_b32 v41, 0xffff0000, v160
v_lshlrev_b32 v42, 16, v161
v_and_b32 v43, 0xffff0000, v161
v_lshlrev_b32 v44, 16, v162
v_and_b32 v45, 0xffff0000, v162
v_lshlrev_b32 v46, 16, v163
v_and_b32 v47, 0xffff0000, v163
v_pk_add_f32 v[32:33], v[32:33], v[40:41]
v_pk_add_f32 v[34:35], v[34:35], v[42:43]
v_pk_add_f32 v[36:37], v[36:37], v[44:45]
v_pk_add_f32 v[38:39], v[38:39], v[46:47]
v_lshlrev_b32 v48, 16, v164
v_and_b32 v49, 0xffff0000, v164
v_lshlrev_b32 v50, 16, v165
v_and_b32 v51, 0xffff0000, v165
v_lshlrev_b32 v52, 16, v166
v_and_b32 v53, 0xffff0000, v166
v_lshlrev_b32 v54, 16, v167
v_and_b32 v55, 0xffff0000, v167
v_pk_add_f32 v[32:33], v[32:33], v[48:49]
v_pk_add_f32 v[34:35], v[34:35], v[50:51]
v_pk_add_f32 v[36:37], v[36:37], v[52:53]
v_pk_add_f32 v[38:39], v[38:39], v[54:55]
v_lshlrev_b32 v40, 16, v168
v_and_b32 v41, 0xffff0000, v168
v_lshlrev_b32 v42, 16, v169
v_and_b32 v43, 0xffff0000, v169
v_lshlrev_b32 v44, 16, v170
v_and_b32 v45, 0xffff0000, v170
v_lshlrev_b32 v46, 16, v171
v_and_b32 v47, 0xffff0000, v171
v_pk_add_f32 v[32:33], v[32:33], v[40:41]
v_pk_add_f32 v[34:35], v[34:35], v[42:43]
v_pk_add_f32 v[36:37], v[36:37], v[44:45]
v_pk_add_f32 v[38:39], v[38:39], v[46:47]
v_lshlrev_b32 v48, 16, v172
v_and_b32 v49, 0xffff0000, v172
v_lshlrev_b32 v50, 16, v173
v_and_b32 v51, 0xffff0000, v173
v_lshlrev_b32 v52, 16, v174
v_and_b32 v53, 0xffff0000, v174
v_lshlrev_b32 v54, 16, v175
v_and_b32 v55, 0xffff0000, v175
v_pk_add_f32 v[32:33], v[32:33], v[48:49]
v_pk_add_f32 v[34:35], v[34:35], v[50:51]
v_pk_add_f32 v[36:37], v[36:37], v[52:53]
v_pk_add_f32 v[38:39], v[38:39], v[54:55]
s_barrier
v_lshlrev_b32 v40, 16, v176
v_and_b32 v41, 0xffff0000, v176
v_lshlrev_b32 v42, 16, v177
v_and_b32 v43, 0xffff0000, v177
v_lshlrev_b32 v44, 16, v178
v_and_b32 v45, 0xffff0000, v178
v_lshlrev_b32 v46, 16, v179
v_and_b32 v47, 0xffff0000, v179
v_pk_add_f32 v[32:33], v[32:33], v[40:41]
v_pk_add_f32 v[34:35], v[34:35], v[42:43]
v_pk_add_f32 v[36:37], v[36:37], v[44:45]
v_pk_add_f32 v[38:39], v[38:39], v[46:47]
v_lshlrev_b32 v48, 16, v180
v_and_b32 v49, 0xffff0000, v180
v_lshlrev_b32 v50, 16, v181
v_and_b32 v51, 0xffff0000, v181
v_lshlrev_b32 v52, 16, v182
v_and_b32 v53, 0xffff0000, v182
v_lshlrev_b32 v54, 16, v183
v_and_b32 v55, 0xffff0000, v183
v_pk_add_f32 v[32:33], v[32:33], v[48:49]
v_pk_add_f32 v[34:35], v[34:35], v[50:51]
v_pk_add_f32 v[36:37], v[36:37], v[52:53]
v_pk_add_f32 v[38:39], v[38:39], v[54:55]
v_lshlrev_b32 v40, 16, v184
v_and_b32 v41, 0xffff0000, v184
v_lshlrev_b32 v42, 16, v185
v_and_b32 v43, 0xffff0000, v185
v_lshlrev_b32 v44, 16, v186
v_and_b32 v45, 0xffff0000, v186
v_lshlrev_b32 v46, 16, v187
v_and_b32 v47, 0xffff0000, v187
v_pk_add_f32 v[32:33], v[32:33], v[40:41]
v_pk_add_f32 v[34:35], v[34:35], v[42:43]
v_pk_add_f32 v[36:37], v[36:37], v[44:45]
v_pk_add_f32 v[38:39], v[38:39], v[46:47]
v_lshlrev_b32 v48, 16, v188
v_and_b32 v49, 0xffff0000, v188
v_lshlrev_b32 v50, 16, v189
v_and_b32 v51, 0xffff0000, v189
v_lshlrev_b32 v52, 16, v190
v_and_b32 v53, 0xffff0000, v190
v_lshlrev_b32 v54, 16, v191
v_and_b32 v55, 0xffff0000, v191
v_pk_add_f32 v[32:33], v[32:33], v[48:49]
v_pk_add_f32 v[34:35], v[34:35], v[50:51]
v_pk_add_f32 v[36:37], v[36:37], v[52:53]
v_pk_add_f32 v[38:39], v[38:39], v[54:55]
s_barrier
s_add_u32 s43, s34, 0
s_lshl_b32 s43, s43, 7
v_mov_b32 v8, s43
v_mov_b32 v10, 16
buffer_load_dword v9, v8, s[56:59], 0 offen sc1
v_lshlrev_b32 v40, 16, v192
v_and_b32 v41, 0xffff0000, v192
v_lshlrev_b32 v42, 16, v193
v_and_b32 v43, 0xffff0000, v193
v_lshlrev_b32 v44, 16, v194
v_and_b32 v45, 0xffff0000, v194
v_lshlrev_b32 v46, 16, v195
v_and_b32 v47, 0xffff0000, v195
v_pk_add_f32 v[32:33], v[32:33], v[40:41]
v_pk_add_f32 v[34:35], v[34:35], v[42:43]
v_pk_add_f32 v[36:37], v[36:37], v[44:45]
v_pk_add_f32 v[38:39], v[38:39], v[46:47]
v_lshlrev_b32 v48, 16, v196
v_and_b32 v49, 0xffff0000, v196
v_lshlrev_b32 v50, 16, v197
v_and_b32 v51, 0xffff0000, v197
v_lshlrev_b32 v52, 16, v198
v_and_b32 v53, 0xffff0000, v198
v_lshlrev_b32 v54, 16, v199
v_and_b32 v55, 0xffff0000, v199
v_pk_add_f32 v[32:33], v[32:33], v[48:49]
v_pk_add_f32 v[34:35], v[34:35], v[50:51]
v_pk_add_f32 v[36:37], v[36:37], v[52:53]
v_pk_add_f32 v[38:39], v[38:39], v[54:55]
v_lshlrev_b32 v40, 16, v200
v_and_b32 v41, 0xffff0000, v200
v_lshlrev_b32 v42, 16, v201
v_and_b32 v43, 0xffff0000, v201
v_lshlrev_b32 v44, 16, v202
v_and_b32 v45, 0xffff0000, v202
v_lshlrev_b32 v46, 16, v203
v_and_b32 v47, 0xffff0000, v203
v_pk_add_f32 v[32:33], v[32:33], v[40:41]
v_pk_add_f32 v[34:35], v[34:35], v[42:43]
v_pk_add_f32 v[36:37], v[36:37], v[44:45]
v_pk_add_f32 v[38:39], v[38:39], v[46:47]
v_lshlrev_b32 v48, 16, v204
v_and_b32 v49, 0xffff0000, v204
v_lshlrev_b32 v50, 16, v205
v_and_b32 v51, 0xffff0000, v205
v_lshlrev_b32 v52, 16, v206
v_and_b32 v53, 0xffff0000, v206
v_lshlrev_b32 v54, 16, v207
v_and_b32 v55, 0xffff0000, v207
v_pk_add_f32 v[32:33], v[32:33], v[48:49]
v_pk_add_f32 v[34:35], v[34:35], v[50:51]
v_pk_add_f32 v[36:37], v[36:37], v[52:53]
v_pk_add_f32 v[38:39], v[38:39], v[54:55]
s_barrier
v_lshlrev_b32 v40, 16, v208
v_and_b32 v41, 0xffff0000, v208
v_lshlrev_b32 v42, 16, v209
v_and_b32 v43, 0xffff0000, v209
v_lshlrev_b32 v44, 16, v210
v_and_b32 v45, 0xffff0000, v210
v_lshlrev_b32 v46, 16, v211
v_and_b32 v47, 0xffff0000, v211
v_pk_add_f32 v[32:33], v[32:33], v[40:41]
v_pk_add_f32 v[34:35], v[34:35], v[42:43]
v_pk_add_f32 v[36:37], v[36:37], v[44:45]
v_pk_add_f32 v[38:39], v[38:39], v[46:47]
v_lshlrev_b32 v48, 16, v212
v_and_b32 v49, 0xffff0000, v212
v_lshlrev_b32 v50, 16, v213
v_and_b32 v51, 0xffff0000, v213
v_lshlrev_b32 v52, 16, v214
v_and_b32 v53, 0xffff0000, v214
v_lshlrev_b32 v54, 16, v215
v_and_b32 v55, 0xffff0000, v215
v_pk_add_f32 v[32:33], v[32:33], v[48:49]
v_pk_add_f32 v[34:35], v[34:35], v[50:51]
v_pk_add_f32 v[36:37], v[36:37], v[52:53]
v_pk_add_f32 v[38:39], v[38:39], v[54:55]
v_lshlrev_b32 v40, 16, v216
v_and_b32 v41, 0xffff0000, v216
v_lshlrev_b32 v42, 16, v217
v_and_b32 v43, 0xffff0000, v217
v_lshlrev_b32 v44, 16, v218
v_and_b32 v45, 0xffff0000, v218
v_lshlrev_b32 v46, 16, v219
v_and_b32 v47, 0xffff0000, v219
v_pk_add_f32 v[32:33], v[32:33], v[40:41]
v_pk_add_f32 v[34:35], v[34:35], v[42:43]
v_pk_add_f32 v[36:37], v[36:37], v[44:45]
v_pk_add_f32 v[38:39], v[38:39], v[46:47]
v_lshlrev_b32 v48, 16, v220
v_and_b32 v49, 0xffff0000, v220
v_lshlrev_b32 v50, 16, v221
v_and_b32 v51, 0xffff0000, v221
v_lshlrev_b32 v52, 16, v222
v_and_b32 v53, 0xffff0000, v222
v_lshlrev_b32 v54, 16, v223
v_and_b32 v55, 0xffff0000, v223
v_pk_add_f32 v[32:33], v[32:33], v[48:49]
v_pk_add_f32 v[34:35], v[34:35], v[50:51]
v_pk_add_f32 v[36:37], v[36:37], v[52:53]
v_pk_add_f32 v[38:39], v[38:39], v[54:55]
s_barrier
v_lshlrev_b32 v40, 16, v224
v_and_b32 v41, 0xffff0000, v224
v_lshlrev_b32 v42, 16, v225
v_and_b32 v43, 0xffff0000, v225
v_lshlrev_b32 v44, 16, v226
v_and_b32 v45, 0xffff0000, v226
v_lshlrev_b32 v46, 16, v227
v_and_b32 v47, 0xffff0000, v227
v_pk_add_f32 v[32:33], v[32:33], v[40:41]
v_pk_add_f32 v[34:35], v[34:35], v[42:43]
v_pk_add_f32 v[36:37], v[36:37], v[44:45]
v_pk_add_f32 v[38:39], v[38:39], v[46:47]
v_lshlrev_b32 v48, 16, v228
v_and_b32 v49, 0xffff0000, v228
v_lshlrev_b32 v50, 16, v229
v_and_b32 v51, 0xffff0000, v229
v_lshlrev_b32 v52, 16, v230
v_and_b32 v53, 0xffff0000, v230
v_lshlrev_b32 v54, 16, v231
v_and_b32 v55, 0xffff0000, v231
v_pk_add_f32 v[32:33], v[32:33], v[48:49]
v_pk_add_f32 v[34:35], v[34:35], v[50:51]
v_pk_add_f32 v[36:37], v[36:37], v[52:53]
v_pk_add_f32 v[38:39], v[38:39], v[54:55]
v_lshlrev_b32 v40, 16, v232
v_and_b32 v41, 0xffff0000, v232
v_lshlrev_b32 v42, 16, v233
v_and_b32 v43, 0xffff0000, v233
v_lshlrev_b32 v44, 16, v234
v_and_b32 v45, 0xffff0000, v234
v_lshlrev_b32 v46, 16, v235
v_and_b32 v47, 0xffff0000, v235
v_pk_add_f32 v[32:33], v[32:33], v[40:41]
v_pk_add_f32 v[34:35], v[34:35], v[42:43]
v_pk_add_f32 v[36:37], v[36:37], v[44:45]
v_pk_add_f32 v[38:39], v[38:39], v[46:47]
v_lshlrev_b32 v48, 16, v236
v_and_b32 v49, 0xffff0000, v236
v_lshlrev_b32 v50, 16, v237
v_and_b32 v51, 0xffff0000, v237
v_lshlrev_b32 v52, 16, v238
v_and_b32 v53, 0xffff0000, v238
v_lshlrev_b32 v54, 16, v239
v_and_b32 v55, 0xffff0000, v239
v_pk_add_f32 v[32:33], v[32:33], v[48:49]
v_pk_add_f32 v[34:35], v[34:35], v[50:51]
v_pk_add_f32 v[36:37], v[36:37], v[52:53]
v_pk_add_f32 v[38:39], v[38:39], v[54:55]
s_barrier
s_mov_b32 s41, 0x10000
Lpoll_142:
s_waitcnt vmcnt(0)
Lpf_144:
v_cmp_ne_u32 vcc, v10, v9
s_nop 4
s_cbranch_vccz Lpok_143
buffer_load_dword v9, v8, s[56:59], 0 offen sc1
s_sub_u32 s41, s41, 1
s_cmp_lg_u32 s41, 0
s_cbranch_scc1 Lpoll_142
s_waitcnt vmcnt(0)
Lpok_143:
v_lshlrev_b32 v40, 16, v240
v_and_b32 v41, 0xffff0000, v240
v_lshlrev_b32 v42, 16, v241
v_and_b32 v43, 0xffff0000, v241
v_lshlrev_b32 v44, 16, v242
v_and_b32 v45, 0xffff0000, v242
v_lshlrev_b32 v46, 16, v243
v_and_b32 v47, 0xffff0000, v243
v_pk_add_f32 v[32:33], v[32:33], v[40:41]
v_pk_add_f32 v[34:35], v[34:35], v[42:43]
v_pk_add_f32 v[36:37], v[36:37], v[44:45]
v_pk_add_f32 v[38:39], v[38:39], v[46:47]
v_lshlrev_b32 v48, 16, v244
v_and_b32 v49, 0xffff0000, v244
v_lshlrev_b32 v50, 16, v245
v_and_b32 v51, 0xffff0000, v245
v_lshlrev_b32 v52, 16, v246
v_and_b32 v53, 0xffff0000, v246
v_lshlrev_b32 v54, 16, v247
v_and_b32 v55, 0xffff0000, v247
v_pk_add_f32 v[32:33], v[32:33], v[48:49]
v_pk_add_f32 v[34:35], v[34:35], v[50:51]
v_pk_add_f32 v[36:37], v[36:37], v[52:53]
v_pk_add_f32 v[38:39], v[38:39], v[54:55]
v_lshlrev_b32 v40, 16, v248
v_and_b32 v41, 0xffff0000, v248
v_lshlrev_b32 v42, 16, v249
v_and_b32 v43, 0xffff0000, v249
v_lshlrev_b32 v44, 16, v250
v_and_b32 v45, 0xffff0000, v250
v_lshlrev_b32 v46, 16, v251
v_and_b32 v47, 0xffff0000, v251
v_pk_add_f32 v[32:33], v[32:33], v[40:41]
v_pk_add_f32 v[34:35], v[34:35], v[42:43]
v_pk_add_f32 v[36:37], v[36:37], v[44:45]
v_pk_add_f32 v[38:39], v[38:39], v[46:47]
v_lshlrev_b32 v48, 16, v252
v_and_b32 v49, 0xffff0000, v252
v_lshlrev_b32 v50, 16, v253
v_and_b32 v51, 0xffff0000, v253
v_lshlrev_b32 v52, 16, v254
v_and_b32 v53, 0xffff0000, v254
v_lshlrev_b32 v54, 16, v255
v_and_b32 v55, 0xffff0000, v255
v_pk_add_f32 v[32:33], v[32:33], v[48:49]
v_pk_add_f32 v[34:35], v[34:35], v[50:51]
v_pk_add_f32 v[36:37], v[36:37], v[52:53]
v_pk_add_f32 v[38:39], v[38:39], v[54:55]
s_barrier
s_mov_b32 s43, 1376256
buffer_load_dwordx4 v[128:131], v4, s[64:67], s43 offen
s_mov_b32 s43, 1404928
buffer_load_dwordx4 v[132:135], v4, s[64:67], s43 offen
s_mov_b32 s43, 1433600
buffer_load_dwordx4 v[136:139], v4, s[64:67], s43 offen
s_mov_b32 s43, 1462272
buffer_load_dwordx4 v[140:143], v4, s[64:67], s43 offen
s_mov_b32 s43, 1490944
buffer_load_dwordx4 v[144:147], v4, s[64:67], s43 offen
s_mov_b32 s43, 1519616
buffer_load_dwordx4 v[148:151], v4, s[64:67], s43 offen
s_mov_b32 s43, 1548288
buffer_load_dwordx4 v[152:155], v4, s[64:67], s43 offen
s_mov_b32 s43, 1576960
buffer_load_dwordx4 v[156:159], v4, s[64:67], s43 offen
s_mov_b32 s43, 1605632
buffer_load_dwordx4 v[160:163], v4, s[64:67], s43 offen
s_mov_b32 s43, 1634304
buffer_load_dwordx4 v[164:167], v4, s[64:67], s43 offen
s_mov_b32 s43, 1662976
buffer_load_dwordx4 v[168:171], v4, s[64:67], s43 offen
s_mov_b32 s43, 1691648
buffer_load_dwordx4 v[172:175], v4, s[64:67], s43 offen
s_mov_b32 s43, 1720320
buffer_load_dwordx4 v[176:179], v4, s[64:67], s43 offen
s_mov_b32 s43, 1748992
buffer_load_dwordx4 v[180:183], v4, s[64:67], s43 offen
s_mov_b32 s43, 1777664
buffer_load_dwordx4 v[184:187], v4, s[64:67], s43 offen
s_mov_b32 s43, 1806336
buffer_load_dwordx4 v[188:191], v4, s[64:67], s43 offen
s_barrier
v_lshlrev_b32 v40, 16, v56
v_and_b32 v41, 0xffff0000, v56
v_lshlrev_b32 v42, 16, v57
v_and_b32 v43, 0xffff0000, v57
v_lshlrev_b32 v44, 16, v58
v_and_b32 v45, 0xffff0000, v58
v_lshlrev_b32 v46, 16, v59
v_and_b32 v47, 0xffff0000, v59
v_pk_add_f32 v[32:33], v[32:33], v[40:41]
v_pk_add_f32 v[34:35], v[34:35], v[42:43]
v_pk_add_f32 v[36:37], v[36:37], v[44:45]
v_pk_add_f32 v[38:39], v[38:39], v[46:47]
v_lshlrev_b32 v48, 16, v60
v_and_b32 v49, 0xffff0000, v60
v_lshlrev_b32 v50, 16, v61
v_and_b32 v51, 0xffff0000, v61
v_lshlrev_b32 v52, 16, v62
v_and_b32 v53, 0xffff0000, v62
v_lshlrev_b32 v54, 16, v63
v_and_b32 v55, 0xffff0000, v63
v_pk_add_f32 v[32:33], v[32:33], v[48:49]
v_pk_add_f32 v[34:35], v[34:35], v[50:51]
v_pk_add_f32 v[36:37], v[36:37], v[52:53]
v_pk_add_f32 v[38:39], v[38:39], v[54:55]
v_lshlrev_b32 v40, 16, v64
v_and_b32 v41, 0xffff0000, v64
v_lshlrev_b32 v42, 16, v65
v_and_b32 v43, 0xffff0000, v65
v_lshlrev_b32 v44, 16, v66
v_and_b32 v45, 0xffff0000, v66
v_lshlrev_b32 v46, 16, v67
v_and_b32 v47, 0xffff0000, v67
v_pk_add_f32 v[32:33], v[32:33], v[40:41]
v_pk_add_f32 v[34:35], v[34:35], v[42:43]
v_pk_add_f32 v[36:37], v[36:37], v[44:45]
v_pk_add_f32 v[38:39], v[38:39], v[46:47]
v_lshlrev_b32 v48, 16, v72
v_and_b32 v49, 0xffff0000, v72
v_lshlrev_b32 v50, 16, v73
v_and_b32 v51, 0xffff0000, v73
v_lshlrev_b32 v52, 16, v74
v_and_b32 v53, 0xffff0000, v74
v_lshlrev_b32 v54, 16, v75
v_and_b32 v55, 0xffff0000, v75
v_pk_add_f32 v[32:33], v[32:33], v[48:49]
v_pk_add_f32 v[34:35], v[34:35], v[50:51]
v_pk_add_f32 v[36:37], v[36:37], v[52:53]
v_pk_add_f32 v[38:39], v[38:39], v[54:55]
s_barrier
v_lshlrev_b32 v40, 16, v76
v_and_b32 v41, 0xffff0000, v76
v_lshlrev_b32 v42, 16, v77
v_and_b32 v43, 0xffff0000, v77
v_lshlrev_b32 v44, 16, v78
v_and_b32 v45, 0xffff0000, v78
v_lshlrev_b32 v46, 16, v79
v_and_b32 v47, 0xffff0000, v79
v_pk_add_f32 v[32:33], v[32:33], v[40:41]
v_pk_add_f32 v[34:35], v[34:35], v[42:43]
v_pk_add_f32 v[36:37], v[36:37], v[44:45]
v_pk_add_f32 v[38:39], v[38:39], v[46:47]
v_lshlrev_b32 v48, 16, v80
v_and_b32 v49, 0xffff0000, v80
v_lshlrev_b32 v50, 16, v81
v_and_b32 v51, 0xffff0000, v81
v_lshlrev_b32 v52, 16, v82
v_and_b32 v53, 0xffff0000, v82
v_lshlrev_b32 v54, 16, v83
v_and_b32 v55, 0xffff0000, v83
v_pk_add_f32 v[32:33], v[32:33], v[48:49]
v_pk_add_f32 v[34:35], v[34:35], v[50:51]
v_pk_add_f32 v[36:37], v[36:37], v[52:53]
v_pk_add_f32 v[38:39], v[38:39], v[54:55]
v_lshlrev_b32 v40, 16, v84
v_and_b32 v41, 0xffff0000, v84
v_lshlrev_b32 v42, 16, v85
v_and_b32 v43, 0xffff0000, v85
v_lshlrev_b32 v44, 16, v86
v_and_b32 v45, 0xffff0000, v86
v_lshlrev_b32 v46, 16, v87
v_and_b32 v47, 0xffff0000, v87
v_pk_add_f32 v[32:33], v[32:33], v[40:41]
v_pk_add_f32 v[34:35], v[34:35], v[42:43]
v_pk_add_f32 v[36:37], v[36:37], v[44:45]
v_pk_add_f32 v[38:39], v[38:39], v[46:47]
v_lshlrev_b32 v48, 16, v88
v_and_b32 v49, 0xffff0000, v88
v_lshlrev_b32 v50, 16, v89
v_and_b32 v51, 0xffff0000, v89
v_lshlrev_b32 v52, 16, v90
v_and_b32 v53, 0xffff0000, v90
v_lshlrev_b32 v54, 16, v91
v_and_b32 v55, 0xffff0000, v91
v_pk_add_f32 v[32:33], v[32:33], v[48:49]
v_pk_add_f32 v[34:35], v[34:35], v[50:51]
v_pk_add_f32 v[36:37], v[36:37], v[52:53]
v_pk_add_f32 v[38:39], v[38:39], v[54:55]
s_barrier
v_lshlrev_b32 v40, 16, v92
v_and_b32 v41, 0xffff0000, v92
v_lshlrev_b32 v42, 16, v93
v_and_b32 v43, 0xffff0000, v93
v_lshlrev_b32 v44, 16, v94
v_and_b32 v45, 0xffff0000, v94
v_lshlrev_b32 v46, 16, v95
v_and_b32 v47, 0xffff0000, v95
v_pk_add_f32 v[32:33], v[32:33], v[40:41]
v_pk_add_f32 v[34:35], v[34:35], v[42:43]
v_pk_add_f32 v[36:37], v[36:37], v[44:45]
v_pk_add_f32 v[38:39], v[38:39], v[46:47]
v_lshlrev_b32 v48, 16, v96
v_and_b32 v49, 0xffff0000, v96
v_lshlrev_b32 v50, 16, v97
v_and_b32 v51, 0xffff0000, v97
v_lshlrev_b32 v52, 16, v98
v_and_b32 v53, 0xffff0000, v98
v_lshlrev_b32 v54, 16, v99
v_and_b32 v55, 0xffff0000, v99
v_pk_add_f32 v[32:33], v[32:33], v[48:49]
v_pk_add_f32 v[34:35], v[34:35], v[50:51]
v_pk_add_f32 v[36:37], v[36:37], v[52:53]
v_pk_add_f32 v[38:39], v[38:39], v[54:55]
v_lshlrev_b32 v40, 16, v100
v_and_b32 v41, 0xffff0000, v100
v_lshlrev_b32 v42, 16, v101
v_and_b32 v43, 0xffff0000, v101
v_lshlrev_b32 v44, 16, v102
v_and_b32 v45, 0xffff0000, v102
v_lshlrev_b32 v46, 16, v103
v_and_b32 v47, 0xffff0000, v103
v_pk_add_f32 v[32:33], v[32:33], v[40:41]
v_pk_add_f32 v[34:35], v[34:35], v[42:43]
v_pk_add_f32 v[36:37], v[36:37], v[44:45]
v_pk_add_f32 v[38:39], v[38:39], v[46:47]
v_lshlrev_b32 v48, 16, v104
v_and_b32 v49, 0xffff0000, v104
v_lshlrev_b32 v50, 16, v105
v_and_b32 v51, 0xffff0000, v105
v_lshlrev_b32 v52, 16, v106
v_and_b32 v53, 0xffff0000, v106
v_lshlrev_b32 v54, 16, v107
v_and_b32 v55, 0xffff0000, v107
v_pk_add_f32 v[32:33], v[32:33], v[48:49]
v_pk_add_f32 v[34:35], v[34:35], v[50:51]
v_pk_add_f32 v[36:37], v[36:37], v[52:53]
v_pk_add_f32 v[38:39], v[38:39], v[54:55]
s_barrier
v_lshlrev_b32 v40, 16, v108
v_and_b32 v41, 0xffff0000, v108
v_lshlrev_b32 v42, 16, v109
v_and_b32 v43, 0xffff0000, v109
v_lshlrev_b32 v44, 16, v110
v_and_b32 v45, 0xffff0000, v110
v_lshlrev_b32 v46, 16, v111
v_and_b32 v47, 0xffff0000, v111
v_pk_add_f32 v[32:33], v[32:33], v[40:41]
v_pk_add_f32 v[34:35], v[34:35], v[42:43]
v_pk_add_f32 v[36:37], v[36:37], v[44:45]
v_pk_add_f32 v[38:39], v[38:39], v[46:47]
v_lshlrev_b32 v48, 16, v112
v_and_b32 v49, 0xffff0000, v112
v_lshlrev_b32 v50, 16, v113
v_and_b32 v51, 0xffff0000, v113
v_lshlrev_b32 v52, 16, v114
v_and_b32 v53, 0xffff0000, v114
v_lshlrev_b32 v54, 16, v115
v_and_b32 v55, 0xffff0000, v115
v_pk_add_f32 v[32:33], v[32:33], v[48:49]
v_pk_add_f32 v[34:35], v[34:35], v[50:51]
v_pk_add_f32 v[36:37], v[36:37], v[52:53]
v_pk_add_f32 v[38:39], v[38:39], v[54:55]
v_lshlrev_b32 v40, 16, v120
v_and_b32 v41, 0xffff0000, v120
v_lshlrev_b32 v42, 16, v121
v_and_b32 v43, 0xffff0000, v121
v_lshlrev_b32 v44, 16, v122
v_and_b32 v45, 0xffff0000, v122
v_lshlrev_b32 v46, 16, v123
v_and_b32 v47, 0xffff0000, v123
v_pk_add_f32 v[32:33], v[32:33], v[40:41]
v_pk_add_f32 v[34:35], v[34:35], v[42:43]
v_pk_add_f32 v[36:37], v[36:37], v[44:45]
v_pk_add_f32 v[38:39], v[38:39], v[46:47]
v_lshlrev_b32 v48, 16, v124
v_and_b32 v49, 0xffff0000, v124
v_lshlrev_b32 v50, 16, v125
v_and_b32 v51, 0xffff0000, v125
v_lshlrev_b32 v52, 16, v126
v_and_b32 v53, 0xffff0000, v126
v_lshlrev_b32 v54, 16, v127
v_and_b32 v55, 0xffff0000, v127
v_pk_add_f32 v[32:33], v[32:33], v[48:49]
v_pk_add_f32 v[34:35], v[34:35], v[50:51]
v_pk_add_f32 v[36:37], v[36:37], v[52:53]
v_pk_add_f32 v[38:39], v[38:39], v[54:55]
s_barrier
s_waitcnt vmcnt(0)
v_lshlrev_b32 v40, 16, v128
v_and_b32 v41, 0xffff0000, v128
v_lshlrev_b32 v42, 16, v129
v_and_b32 v43, 0xffff0000, v129
v_lshlrev_b32 v44, 16, v130
v_and_b32 v45, 0xffff0000, v130
v_lshlrev_b32 v46, 16, v131
v_and_b32 v47, 0xffff0000, v131
v_pk_add_f32 v[32:33], v[32:33], v[40:41]
v_pk_add_f32 v[34:35], v[34:35], v[42:43]
v_pk_add_f32 v[36:37], v[36:37], v[44:45]
v_pk_add_f32 v[38:39], v[38:39], v[46:47]
v_lshlrev_b32 v48, 16, v132
v_and_b32 v49, 0xffff0000, v132
v_lshlrev_b32 v50, 16, v133
v_and_b32 v51, 0xffff0000, v133
v_lshlrev_b32 v52, 16, v134
v_and_b32 v53, 0xffff0000, v134
v_lshlrev_b32 v54, 16, v135
v_and_b32 v55, 0xffff0000, v135
v_pk_add_f32 v[32:33], v[32:33], v[48:49]
v_pk_add_f32 v[34:35], v[34:35], v[50:51]
v_pk_add_f32 v[36:37], v[36:37], v[52:53]
v_pk_add_f32 v[38:39], v[38:39], v[54:55]
v_lshlrev_b32 v40, 16, v136
v_and_b32 v41, 0xffff0000, v136
v_lshlrev_b32 v42, 16, v137
v_and_b32 v43, 0xffff0000, v137
v_lshlrev_b32 v44, 16, v138
v_and_b32 v45, 0xffff0000, v138
v_lshlrev_b32 v46, 16, v139
v_and_b32 v47, 0xffff0000, v139
v_pk_add_f32 v[32:33], v[32:33], v[40:41]
v_pk_add_f32 v[34:35], v[34:35], v[42:43]
v_pk_add_f32 v[36:37], v[36:37], v[44:45]
v_pk_add_f32 v[38:39], v[38:39], v[46:47]
v_lshlrev_b32 v48, 16, v140
v_and_b32 v49, 0xffff0000, v140
v_lshlrev_b32 v50, 16, v141
v_and_b32 v51, 0xffff0000, v141
v_lshlrev_b32 v52, 16, v142
v_and_b32 v53, 0xffff0000, v142
v_lshlrev_b32 v54, 16, v143
v_and_b32 v55, 0xffff0000, v143
v_pk_add_f32 v[32:33], v[32:33], v[48:49]
v_pk_add_f32 v[34:35], v[34:35], v[50:51]
v_pk_add_f32 v[36:37], v[36:37], v[52:53]
v_pk_add_f32 v[38:39], v[38:39], v[54:55]
s_barrier
v_lshlrev_b32 v40, 16, v144
v_and_b32 v41, 0xffff0000, v144
v_lshlrev_b32 v42, 16, v145
v_and_b32 v43, 0xffff0000, v145
v_lshlrev_b32 v44, 16, v146
v_and_b32 v45, 0xffff0000, v146
v_lshlrev_b32 v46, 16, v147
v_and_b32 v47, 0xffff0000, v147
v_pk_add_f32 v[32:33], v[32:33], v[40:41]
v_pk_add_f32 v[34:35], v[34:35], v[42:43]
v_pk_add_f32 v[36:37], v[36:37], v[44:45]
v_pk_add_f32 v[38:39], v[38:39], v[46:47]
v_lshlrev_b32 v48, 16, v148
v_and_b32 v49, 0xffff0000, v148
v_lshlrev_b32 v50, 16, v149
v_and_b32 v51, 0xffff0000, v149
v_lshlrev_b32 v52, 16, v150
v_and_b32 v53, 0xffff0000, v150
v_lshlrev_b32 v54, 16, v151
v_and_b32 v55, 0xffff0000, v151
v_pk_add_f32 v[32:33], v[32:33], v[48:49]
v_pk_add_f32 v[34:35], v[34:35], v[50:51]
v_pk_add_f32 v[36:37], v[36:37], v[52:53]
v_pk_add_f32 v[38:39], v[38:39], v[54:55]
v_lshlrev_b32 v40, 16, v152
v_and_b32 v41, 0xffff0000, v152
v_lshlrev_b32 v42, 16, v153
v_and_b32 v43, 0xffff0000, v153
v_lshlrev_b32 v44, 16, v154
v_and_b32 v45, 0xffff0000, v154
v_lshlrev_b32 v46, 16, v155
v_and_b32 v47, 0xffff0000, v155
v_pk_add_f32 v[32:33], v[32:33], v[40:41]
v_pk_add_f32 v[34:35], v[34:35], v[42:43]
v_pk_add_f32 v[36:37], v[36:37], v[44:45]
v_pk_add_f32 v[38:39], v[38:39], v[46:47]
v_lshlrev_b32 v48, 16, v156
v_and_b32 v49, 0xffff0000, v156
v_lshlrev_b32 v50, 16, v157
v_and_b32 v51, 0xffff0000, v157
v_lshlrev_b32 v52, 16, v158
v_and_b32 v53, 0xffff0000, v158
v_lshlrev_b32 v54, 16, v159
v_and_b32 v55, 0xffff0000, v159
v_pk_add_f32 v[32:33], v[32:33], v[48:49]
v_pk_add_f32 v[34:35], v[34:35], v[50:51]
v_pk_add_f32 v[36:37], v[36:37], v[52:53]
v_pk_add_f32 v[38:39], v[38:39], v[54:55]
s_barrier
v_lshlrev_b32 v40, 16, v160
v_and_b32 v41, 0xffff0000, v160
v_lshlrev_b32 v42, 16, v161
v_and_b32 v43, 0xffff0000, v161
v_lshlrev_b32 v44, 16, v162
v_and_b32 v45, 0xffff0000, v162
v_lshlrev_b32 v46, 16, v163
v_and_b32 v47, 0xffff0000, v163
v_pk_add_f32 v[32:33], v[32:33], v[40:41]
v_pk_add_f32 v[34:35], v[34:35], v[42:43]
v_pk_add_f32 v[36:37], v[36:37], v[44:45]
v_pk_add_f32 v[38:39], v[38:39], v[46:47]
v_lshlrev_b32 v48, 16, v164
v_and_b32 v49, 0xffff0000, v164
v_lshlrev_b32 v50, 16, v165
v_and_b32 v51, 0xffff0000, v165
v_lshlrev_b32 v52, 16, v166
v_and_b32 v53, 0xffff0000, v166
v_lshlrev_b32 v54, 16, v167
v_and_b32 v55, 0xffff0000, v167
v_pk_add_f32 v[32:33], v[32:33], v[48:49]
v_pk_add_f32 v[34:35], v[34:35], v[50:51]
v_pk_add_f32 v[36:37], v[36:37], v[52:53]
v_pk_add_f32 v[38:39], v[38:39], v[54:55]
v_lshlrev_b32 v40, 16, v168
v_and_b32 v41, 0xffff0000, v168
v_lshlrev_b32 v42, 16, v169
v_and_b32 v43, 0xffff0000, v169
v_lshlrev_b32 v44, 16, v170
v_and_b32 v45, 0xffff0000, v170
v_lshlrev_b32 v46, 16, v171
v_and_b32 v47, 0xffff0000, v171
v_pk_add_f32 v[32:33], v[32:33], v[40:41]
v_pk_add_f32 v[34:35], v[34:35], v[42:43]
v_pk_add_f32 v[36:37], v[36:37], v[44:45]
v_pk_add_f32 v[38:39], v[38:39], v[46:47]
v_lshlrev_b32 v48, 16, v172
v_and_b32 v49, 0xffff0000, v172
v_lshlrev_b32 v50, 16, v173
v_and_b32 v51, 0xffff0000, v173
v_lshlrev_b32 v52, 16, v174
v_and_b32 v53, 0xffff0000, v174
v_lshlrev_b32 v54, 16, v175
v_and_b32 v55, 0xffff0000, v175
v_pk_add_f32 v[32:33], v[32:33], v[48:49]
v_pk_add_f32 v[34:35], v[34:35], v[50:51]
v_pk_add_f32 v[36:37], v[36:37], v[52:53]
v_pk_add_f32 v[38:39], v[38:39], v[54:55]
s_barrier
v_lshlrev_b32 v40, 16, v176
v_and_b32 v41, 0xffff0000, v176
v_lshlrev_b32 v42, 16, v177
v_and_b32 v43, 0xffff0000, v177
v_lshlrev_b32 v44, 16, v178
v_and_b32 v45, 0xffff0000, v178
v_lshlrev_b32 v46, 16, v179
v_and_b32 v47, 0xffff0000, v179
v_pk_add_f32 v[32:33], v[32:33], v[40:41]
v_pk_add_f32 v[34:35], v[34:35], v[42:43]
v_pk_add_f32 v[36:37], v[36:37], v[44:45]
v_pk_add_f32 v[38:39], v[38:39], v[46:47]
v_lshlrev_b32 v48, 16, v180
v_and_b32 v49, 0xffff0000, v180
v_lshlrev_b32 v50, 16, v181
v_and_b32 v51, 0xffff0000, v181
v_lshlrev_b32 v52, 16, v182
v_and_b32 v53, 0xffff0000, v182
v_lshlrev_b32 v54, 16, v183
v_and_b32 v55, 0xffff0000, v183
v_pk_add_f32 v[32:33], v[32:33], v[48:49]
v_pk_add_f32 v[34:35], v[34:35], v[50:51]
v_pk_add_f32 v[36:37], v[36:37], v[52:53]
v_pk_add_f32 v[38:39], v[38:39], v[54:55]
v_lshlrev_b32 v40, 16, v184
v_and_b32 v41, 0xffff0000, v184
v_lshlrev_b32 v42, 16, v185
v_and_b32 v43, 0xffff0000, v185
v_lshlrev_b32 v44, 16, v186
v_and_b32 v45, 0xffff0000, v186
v_lshlrev_b32 v46, 16, v187
v_and_b32 v47, 0xffff0000, v187
v_pk_add_f32 v[32:33], v[32:33], v[40:41]
v_pk_add_f32 v[34:35], v[34:35], v[42:43]
v_pk_add_f32 v[36:37], v[36:37], v[44:45]
v_pk_add_f32 v[38:39], v[38:39], v[46:47]
v_lshlrev_b32 v48, 16, v188
v_and_b32 v49, 0xffff0000, v188
v_lshlrev_b32 v50, 16, v189
v_and_b32 v51, 0xffff0000, v189
v_lshlrev_b32 v52, 16, v190
v_and_b32 v53, 0xffff0000, v190
v_lshlrev_b32 v54, 16, v191
v_and_b32 v55, 0xffff0000, v191
v_pk_add_f32 v[32:33], v[32:33], v[48:49]
v_pk_add_f32 v[34:35], v[34:35], v[50:51]
v_pk_add_f32 v[36:37], v[36:37], v[52:53]
v_pk_add_f32 v[38:39], v[38:39], v[54:55]
s_barrier
s_nop 2
v_mov_b32 v40, v32
v_mov_b32 v41, v33
v_mov_b32 v42, v34
v_mov_b32 v43, v35
v_mov_b32 v44, v36
v_mov_b32 v45, v37
v_mov_b32 v46, v38
v_mov_b32 v47, v39
s_nop 0
v_permlane16_swap_b32 v32, v40
v_permlane16_swap_b32 v33, v41
v_permlane16_swap_b32 v34, v42
v_permlane16_swap_b32 v35, v43
v_permlane16_swap_b32 v36, v44
v_permlane16_swap_b32 v37, v45
v_permlane16_swap_b32 v38, v46
v_permlane16_swap_b32 v39, v47
v_add_f32 v32, v32, v40
v_add_f32 v33, v33, v41
v_add_f32 v34, v34, v42
v_add_f32 v35, v35, v43
v_add_f32 v36, v36, v44
v_add_f32 v37, v37, v45
v_add_f32 v38, v38, v46
v_add_f32 v39, v39, v47
v_mov_b32 v40, v32
v_mov_b32 v41, v33
v_mov_b32 v42, v34
v_mov_b32 v43, v35
v_mov_b32 v44, v36
v_mov_b32 v45, v37
v_mov_b32 v46, v38
v_mov_b32 v47, v39
s_nop 0
v_permlane32_swap_b32 v32, v40
v_permlane32_swap_b32 v33, v41
v_permlane32_swap_b32 v34, v42
v_permlane32_swap_b32 v35, v43
v_permlane32_swap_b32 v36, v44
v_permlane32_swap_b32 v37, v45
v_permlane32_swap_b32 v38, v46
v_permlane32_swap_b32 v39, v47
v_add_f32 v32, v32, v40
v_add_f32 v33, v33, v41
v_add_f32 v34, v34, v42
v_add_f32 v35, v35, v43
v_add_f32 v36, v36, v44
v_add_f32 v37, v37, v45
v_add_f32 v38, v38, v46
v_add_f32 v39, v39, v47
s_mov_b64 exec, 0xffff
buffer_store_dwordx4 v[32:35], v5, s[72:75], 0 offen sc1
buffer_store_dwordx4 v[36:39], v5, s[72:75], 0 offen offset:16 sc1
s_mov_b64 exec, -1
s_waitcnt vmcnt(0)
s_add_u32 s43, s50, 96
s_lshl_b32 s43, s43, 7
v_mov_b32 v12, s43
v_mov_b32 v13, 1
s_mov_b64 exec, 1
buffer_atomic_add v13, v12, s[56:59], 0 offen sc1
s_mov_b64 exec, -1
s_branch Lcsd_141
.p2align 6
Lw_45:
s_branch Lr_46
s_nop 0
Lnojob_140:
s_lshl_b32 s43, s34, 18
s_add_u32 s12, s32, s43
s_addc_u32 s13, s33, 0
s_mov_b32 s14, 262144
s_mov_b32 s15, 0x20000
v_lshlrev_b32 v21, 4, v1
s_lshl_b32 s54, s36, 11
s_xor_b32 s43, s35, 1
s_and_b32 s43, s43, 15
s_lshl_b32 s43, s43, 14
s_add_u32 s30, s43, s54
s_xor_b32 s43, s35, 2
s_and_b32 s43, s43, 15
s_lshl_b32 s43, s43, 14
s_add_u32 s31, s43, s54
s_waitcnt vmcnt(0)
s_barrier
ds_write_b128 v27, v[68:71] offset:0
ds_write_b128 v27, v[116:119] offset:512
s_waitcnt lgkmcnt(0)
s_barrier
s_add_u32 m0, s54, 16384
s_add_u32 s43, s30, 0
buffer_load_dwordx4 v21, s[12:15], s43 offen sc1 lds
s_add_u32 m0, s54, 17408
s_add_u32 s43, s30, 1024
buffer_load_dwordx4 v21, s[12:15], s43 offen sc1 lds
s_add_u32 m0, s54, 32768
s_add_u32 s43, s31, 0
buffer_load_dwordx4 v21, s[12:15], s43 offen sc1 lds
s_add_u32 m0, s54, 33792
s_add_u32 s43, s31, 1024
buffer_load_dwordx4 v21, s[12:15], s43 offen sc1 lds
s_waitcnt vmcnt(2)
s_barrier
s_waitcnt vmcnt(0)
s_barrier
s_barrier
s_barrier
s_add_u32 s43, s34, 0
s_lshl_b32 s43, s43, 7
v_mov_b32 v8, s43
v_mov_b32 v10, 16
buffer_load_dword v9, v8, s[56:59], 0 offen sc1
s_barrier
s_barrier
s_barrier
s_mov_b32 s41, 0x10000
Lpoll_145:
s_waitcnt vmcnt(0)
Lpf_147:
v_cmp_ne_u32 vcc, v10, v9
s_nop 4
s_cbranch_vccz Lpok_146
buffer_load_dword v9, v8, s[56:59], 0 offen sc1
s_sub_u32 s41, s41, 1
s_cmp_lg_u32 s41, 0
s_cbranch_scc1 Lpoll_145
s_waitcnt vmcnt(0)
Lpok_146:
s_barrier
s_barrier
s_barrier
s_barrier
s_barrier
s_barrier
s_barrier
s_barrier
s_barrier
s_barrier
s_mov_b32 s55, 0
.p2align 3
Lcsd_141:
s_mov_b32 s46, 1
s_lshl_b32 s43, s34, 18
s_add_u32 s12, s32, s43
s_addc_u32 s13, s33, 0
s_add_u32 s12, s12, 4194304
s_addc_u32 s13, s13, 0
s_mov_b32 s14, 262144
s_mov_b32 s15, 0x20000
v_lshlrev_b32 v21, 4, v1
s_lshl_b32 s54, s36, 11
s_xor_b32 s43, s35, 1
s_and_b32 s43, s43, 15
s_lshl_b32 s43, s43, 14
s_add_u32 s30, s43, s54
s_xor_b32 s43, s35, 2
s_and_b32 s43, s43, 15
s_lshl_b32 s43, s43, 14
s_add_u32 s31, s43, s54
s_lshl_b32 s43, s34, 14
s_add_u32 s64, s32, s43
s_addc_u32 s65, s33, 0
s_add_u32 s64, s64, 25165824
s_addc_u32 s65, s65, 0
s_mov_b32 s66, 16384
s_mov_b32 s67, 0x20000
s_add_u32 s72, s32, 27262976
s_addc_u32 s73, s33, 0
s_mov_b32 s74, 114688
s_mov_b32 s75, 0x20000
s_barrier
s_add_u32 s43, s34, 16
s_lshl_b32 s43, s43, 7
v_mov_b32 v8, s43
v_mov_b32 v9, 1
s_mov_b64 exec, 1
buffer_atomic_add v9, v8, s[56:59], 0 offen sc1
s_mov_b64 exec, -1
s_waitcnt vmcnt(0)
s_mul_i32 s43, s2, 28672
s_mul_i32 s44, s51, 7168
s_add_u32 s43, s43, s44
s_add_u32 s80, s60, s43
s_addc_u32 s81, s61, 0
s_load_dword s82, s[80:81], 0
s_load_dword s83, s[80:81], 64
s_load_dword s84, s[80:81], 128
s_load_dword s85, s[80:81], 192
s_load_dword s86, s[80:81], 256
s_load_dword s87, s[80:81], 320
s_load_dword s82, s[80:81], 384
s_load_dword s83, s[80:81], 448
s_load_dword s84, s[80:81], 512
s_load_dword s85, s[80:81], 576
s_load_dword s86, s[80:81], 640
s_add_u32 s80, s80, 704
s_addc_u32 s81, s81, 0
s_barrier
s_load_dword s82, s[80:81], 0
s_load_dword s83, s[80:81], 64
s_load_dword s84, s[80:81], 128
s_load_dword s85, s[80:81], 192
s_load_dword s86, s[80:81], 256
s_load_dword s87, s[80:81], 320
s_load_dword s82, s[80:81], 384
s_load_dword s83, s[80:81], 448
s_load_dword s84, s[80:81], 512
s_load_dword s85, s[80:81], 576
s_load_dword s86, s[80:81], 640
s_add_u32 s80, s80, 704
s_addc_u32 s81, s81, 0
s_barrier
s_getpc_b64 s[78:79]
Lpc_148:
s_sub_u32 s78, s78, Lpc_148-sequential_preLN__sliding_local_dilated__glu_gated_geglu__prompt_kernel
s_subb_u32 s79, s79, 0
s_lshr_b32 s43, s2, 3
s_mul_i32 s43, s43, 3840
v_min_u32 v19, 29, v1
v_lshl_add_u32 v19, v19, 7, s43
v_min_u32 v19, Ldone_1-sequential_preLN__sliding_local_dilated__glu_gated_geglu__prompt_kernel, v19
global_load_dword v30, v19, s[78:79]
s_mul_i32 s43, s49, 96
s_add_u32 s44, s43, 95
s_lshr_b32 s43, s43, 7
s_lshr_b32 s44, s44, 7
s_add_u32 s43, s43, 16
s_add_u32 s44, s44, 16
v_mov_b32 v12, s44
v_writelane_b32 v12, s35, 0
v_writelane_b32 v12, s43, 1
v_add_u32 v12, 96, v12
v_lshlrev_b32 v12, 7, v12
v_mov_b32 v14, 8
buffer_load_dword v13, v12, s[56:59], 0 offen sc1
s_load_dword s82, s[80:81], 0
s_load_dword s83, s[80:81], 64
s_load_dword s84, s[80:81], 128
s_load_dword s85, s[80:81], 192
s_load_dword s86, s[80:81], 256
s_load_dword s87, s[80:81], 320
s_load_dword s82, s[80:81], 384
s_load_dword s83, s[80:81], 448
s_load_dword s84, s[80:81], 512
s_load_dword s85, s[80:81], 576
s_load_dword s86, s[80:81], 640
s_add_u32 s80, s80, 704
s_addc_u32 s81, s81, 0
s_barrier
s_add_u32 s43, s34, 16
s_lshl_b32 s43, s43, 7
v_mov_b32 v8, s43
v_mov_b32 v10, 16
buffer_load_dword v9, v8, s[56:59], 0 offen sc1
s_load_dword s82, s[80:81], 0
s_load_dword s83, s[80:81], 64
s_load_dword s84, s[80:81], 128
s_load_dword s85, s[80:81], 192
s_load_dword s86, s[80:81], 256
s_load_dword s87, s[80:81], 320
s_load_dword s82, s[80:81], 384
s_load_dword s83, s[80:81], 448
s_load_dword s84, s[80:81], 512
s_load_dword s85, s[80:81], 576
s_load_dword s86, s[80:81], 640
s_add_u32 s80, s80, 704
s_addc_u32 s81, s81, 0
s_barrier
s_mov_b32 s41, 0x10000
Lpoll_149:
s_waitcnt vmcnt(0)
Lpf_151:
v_cmp_ne_u32 vcc, v10, v9
s_nop 4
s_cbranch_vccz Lpok_150
buffer_load_dword v9, v8, s[56:59], 0 offen sc1
s_sub_u32 s41, s41, 1
s_cmp_lg_u32 s41, 0
s_cbranch_scc1 Lpoll_149
s_waitcnt vmcnt(0)
Lpok_150:
s_mov_b32 s41, 0x10000
Lpoll_152:
s_waitcnt vmcnt(0)
Lpf_154:
v_cmp_ne_u32 vcc, v14, v13
s_nop 4
s_cbranch_vccz Lpok_153
buffer_load_dword v13, v12, s[56:59], 0 offen sc1
s_sub_u32 s41, s41, 1
s_cmp_lg_u32 s41, 0
s_cbranch_scc1 Lpoll_152
s_waitcnt vmcnt(0)
Lpok_153:
v_min_u32 v12, 55, v1
v_lshlrev_b32 v13, 4, v12
s_lshl_b32 s43, s35, 9
s_mul_i32 s44, s49, 384
s_add_u32 s44, s44, 7680
v_mov_b32 v14, s44
v_mov_b32 v15, s43
v_cmp_gt_u32 vcc, 32, v12
s_nop 1
v_cndmask_b32 v14, v14, v15, vcc
v_add_u32 v14, v14, v13
v_add_u32 v13, 148480, v13
s_mov_b32 s43, 0
buffer_load_dwordx4 v[192:195], v14, s[72:75], s43 offen sc1
s_mov_b32 s43, 28672
buffer_load_dwordx4 v[196:199], v14, s[72:75], s43 offen sc1
s_mov_b32 s43, 57344
buffer_load_dwordx4 v[200:203], v14, s[72:75], s43 offen sc1
s_mov_b32 s43, 86016
buffer_load_dwordx4 v[204:207], v14, s[72:75], s43 offen sc1
s_mov_b32 s43, 14336
buffer_load_dwordx4 v[208:211], v14, s[72:75], s43 offen sc1
s_mov_b32 s43, 43008
buffer_load_dwordx4 v[212:215], v14, s[72:75], s43 offen sc1
s_mov_b32 s43, 71680
buffer_load_dwordx4 v[216:219], v14, s[72:75], s43 offen sc1
s_mov_b32 s43, 100352
buffer_load_dwordx4 v[220:223], v14, s[72:75], s43 offen sc1
s_load_dword s82, s[80:81], 0
s_load_dword s83, s[80:81], 64
s_load_dword s84, s[80:81], 128
s_load_dword s85, s[80:81], 192
s_load_dword s86, s[80:81], 256
s_load_dword s87, s[80:81], 320
s_load_dword s82, s[80:81], 384
s_load_dword s83, s[80:81], 448
s_load_dword s84, s[80:81], 512
s_load_dword s85, s[80:81], 576
s_load_dword s86, s[80:81], 640
s_add_u32 s80, s80, 704
s_addc_u32 s81, s81, 0
s_barrier
s_mov_b32 s43, 0
buffer_load_dwordx4 v[128:131], v21, s[64:67], s43 offen sc1
s_mov_b32 s43, 1024
buffer_load_dwordx4 v[132:135], v21, s[64:67], s43 offen sc1
s_mov_b32 s43, 2048
buffer_load_dwordx4 v[136:139], v21, s[64:67], s43 offen sc1
s_mov_b32 s43, 3072
buffer_load_dwordx4 v[140:143], v21, s[64:67], s43 offen sc1
s_mov_b32 s43, 4096
buffer_load_dwordx4 v[144:147], v21, s[64:67], s43 offen sc1
s_mov_b32 s43, 5120
buffer_load_dwordx4 v[148:151], v21, s[64:67], s43 offen sc1
s_mov_b32 s43, 6144
buffer_load_dwordx4 v[152:155], v21, s[64:67], s43 offen sc1
s_mov_b32 s43, 7168
buffer_load_dwordx4 v[156:159], v21, s[64:67], s43 offen sc1
s_load_dword s82, s[80:81], 0
s_load_dword s83, s[80:81], 64
s_load_dword s84, s[80:81], 128
s_load_dword s85, s[80:81], 192
s_load_dword s86, s[80:81], 256
s_load_dword s87, s[80:81], 320
s_load_dword s82, s[80:81], 384
s_load_dword s83, s[80:81], 448
s_load_dword s84, s[80:81], 512
s_load_dword s85, s[80:81], 576
s_load_dword s86, s[80:81], 640
s_add_u32 s80, s80, 704
s_addc_u32 s81, s81, 0
s_barrier
s_mov_b32 s43, 8192
buffer_load_dwordx4 v[160:163], v21, s[64:67], s43 offen sc1
s_mov_b32 s43, 9216
buffer_load_dwordx4 v[164:167], v21, s[64:67], s43 offen sc1
s_mov_b32 s43, 10240
buffer_load_dwordx4 v[168:171], v21, s[64:67], s43 offen sc1
s_mov_b32 s43, 11264
buffer_load_dwordx4 v[172:175], v21, s[64:67], s43 offen sc1
s_mov_b32 s43, 12288
buffer_load_dwordx4 v[176:179], v21, s[64:67], s43 offen sc1
s_mov_b32 s43, 13312
buffer_load_dwordx4 v[180:183], v21, s[64:67], s43 offen sc1
s_mov_b32 s43, 14336
buffer_load_dwordx4 v[184:187], v21, s[64:67], s43 offen sc1
s_mov_b32 s43, 15360
buffer_load_dwordx4 v[188:191], v21, s[64:67], s43 offen sc1
s_load_dword s82, s[80:81], 0
s_load_dword s83, s[80:81], 64
s_load_dword s84, s[80:81], 128
s_load_dword s85, s[80:81], 192
s_load_dword s86, s[80:81], 256
s_load_dword s87, s[80:81], 320
s_load_dword s82, s[80:81], 384
s_load_dword s83, s[80:81], 448
s_load_dword s84, s[80:81], 512
s_load_dword s85, s[80:81], 576
s_load_dword s86, s[80:81], 640
s_add_u32 s80, s80, 704
s_addc_u32 s81, s81, 0
s_barrier
s_waitcnt vmcnt(16)
v_add_f32 v192, v192, v196
v_add_f32 v200, v200, v204
v_add_f32 v193, v193, v197
v_add_f32 v201, v201, v205
v_add_f32 v194, v194, v198
v_add_f32 v202, v202, v206
v_add_f32 v195, v195, v199
v_add_f32 v203, v203, v207
v_add_f32 v192, v192, v200
v_add_f32 v193, v193, v201
v_add_f32 v194, v194, v202
v_add_f32 v195, v195, v203
ds_write_b128 v13, v[192:195] offset:0
v_add_f32 v208, v208, v212
v_add_f32 v216, v216, v220
v_add_f32 v209, v209, v213
v_add_f32 v217, v217, v221
v_add_f32 v210, v210, v214
v_add_f32 v218, v218, v222
v_add_f32 v211, v211, v215
v_add_f32 v219, v219, v223
v_add_f32 v208, v208, v216
v_add_f32 v209, v209, v217
v_add_f32 v210, v210, v218
v_add_f32 v211, v211, v219
ds_write_b128 v13, v[208:211] offset:896
s_barrier
s_waitcnt vmcnt(0)
v_add_f32 v128, v128, v132
v_add_f32 v129, v129, v133
v_add_f32 v130, v130, v134
v_add_f32 v131, v131, v135
v_add_f32 v128, v128, v136
v_add_f32 v129, v129, v137
v_add_f32 v130, v130, v138
v_add_f32 v131, v131, v139
v_add_f32 v128, v128, v140
v_add_f32 v129, v129, v141
v_add_f32 v130, v130, v142
v_add_f32 v131, v131, v143
v_add_f32 v128, v128, v144
v_add_f32 v129, v129, v145
v_add_f32 v130, v130, v146
v_add_f32 v131, v131, v147
v_add_f32 v128, v128, v148
v_add_f32 v129, v129, v149
v_add_f32 v130, v130, v150
v_add_f32 v131, v131, v151
v_add_f32 v128, v128, v152
v_add_f32 v129, v129, v153
v_add_f32 v130, v130, v154
v_add_f32 v131, v131, v155
v_add_f32 v128, v128, v156
v_add_f32 v129, v129, v157
v_add_f32 v130, v130, v158
v_add_f32 v131, v131, v159
v_add_f32 v128, v128, v160
v_add_f32 v129, v129, v161
v_add_f32 v130, v130, v162
v_add_f32 v131, v131, v163
v_add_f32 v128, v128, v164
v_add_f32 v129, v129, v165
v_add_f32 v130, v130, v166
v_add_f32 v131, v131, v167
v_add_f32 v128, v128, v168
v_add_f32 v129, v129, v169
v_add_f32 v130, v130, v170
v_add_f32 v131, v131, v171
v_add_f32 v128, v128, v172
v_add_f32 v129, v129, v173
v_add_f32 v130, v130, v174
v_add_f32 v131, v131, v175
v_add_f32 v128, v128, v176
v_add_f32 v129, v129, v177
v_add_f32 v130, v130, v178
v_add_f32 v131, v131, v179
v_add_f32 v128, v128, v180
v_add_f32 v129, v129, v181
v_add_f32 v130, v130, v182
v_add_f32 v131, v131, v183
v_add_f32 v128, v128, v184
v_add_f32 v129, v129, v185
v_add_f32 v130, v130, v186
v_add_f32 v131, v131, v187
v_add_f32 v128, v128, v188
v_add_f32 v129, v129, v189
v_add_f32 v130, v130, v190
v_add_f32 v131, v131, v191
v_mul_f32 v128, 0x3a800000, v128
v_mul_f32 v129, 0x3a800000, v129
v_fma_f32 v129, -v128, v128, v129
v_max_f32 v129, 0, v129
v_add_f32 v129, 0x3727c5ac, v129
v_rsq_f32 v129, v129
v_mul_f32 v130, 0x3a800000, v130
v_mul_f32 v131, 0x3a800000, v131
v_fma_f32 v131, -v130, v130, v131
v_max_f32 v131, 0, v131
v_add_f32 v131, 0x3727c5ac, v131
v_rsq_f32 v131, v131
v_add_u32 v19, 147456, v21
ds_write_b128 v19, v[128:131]
s_waitcnt lgkmcnt(0)
s_load_dword s82, s[80:81], 0
s_load_dword s83, s[80:81], 64
s_load_dword s84, s[80:81], 128
s_load_dword s85, s[80:81], 192
s_load_dword s86, s[80:81], 256
s_load_dword s87, s[80:81], 320
s_load_dword s82, s[80:81], 384
s_load_dword s83, s[80:81], 448
s_load_dword s84, s[80:81], 512
s_load_dword s85, s[80:81], 576
s_load_dword s86, s[80:81], 640
s_add_u32 s80, s80, 704
s_addc_u32 s81, s81, 0
s_barrier
s_and_b32 s53, s35, 1
s_lshl_b32 s53, s53, 1
s_mul_i32 s43, s47, 3
s_add_u32 s53, s53, s43
v_lshlrev_b32 v19, 11, v18
v_lshl_add_u32 v19, v17, 4, v19
s_lshl_b32 s43, s46, 10
v_add_u32 v2, s43, v19
v_add_u32 v3, 49152, v2
v_add_u32 v4, 98304, v2
v_lshrrev_b32 v19, 2, v17
v_lshl_add_u32 v20, v18, 2, v19
v_and_b32 v21, 7, v20
v_lshlrev_b32 v20, 8, v20
v_and_b32 v19, 3, v1
v_lshl_add_u32 v20, v19, 3, v20
s_add_u32 s43, s53, 0
v_xor_b32 v19, s43, v21
v_lshl_add_u32 v5, v19, 5, v20
s_add_u32 s43, s53, 1
v_xor_b32 v19, s43, v21
v_lshl_add_u32 v6, v19, 5, v20
s_add_u32 s43, s53, 2
v_xor_b32 v19, s43, v21
v_lshl_add_u32 v7, v19, 5, v20
v_add_u32 v9, 49152, v5
v_add_u32 v10, 49152, v6
v_add_u32 v11, 49152, v7
v_add_u32 v13, 98304, v5
v_add_u32 v14, 98304, v6
v_add_u32 v15, 98304, v7
s_lshl_b32 s43, s46, 9
s_add_u32 s43, s43, 147456
v_lshl_add_u32 v19, v17, 3, s43
ds_read_b64 v[80:81], v19 offset:0
ds_read_b64 v[82:83], v19 offset:128
ds_read_b64 v[84:85], v19 offset:256
ds_read_b64 v[86:87], v19 offset:384
s_mul_i32 s43, s47, 192
s_add_u32 s43, s43, 148992
v_lshl_add_u32 v19, v18, 4, s43
ds_read_b128 v[48:51], v19 offset:0
ds_read_b128 v[52:55], v19 offset:64
ds_read_b128 v[56:59], v19 offset:128
ds_read_b128 v[60:63], v19 offset:896
ds_read_b128 v[64:67], v19 offset:960
ds_read_b128 v[68:71], v19 offset:1024
s_barrier
s_waitcnt lgkmcnt(0)
v_mul_f32 v88, v81, v81
v_mul_f32 v228, 0xc0135761, v81
v_mul_f32 v89, 0xbdd2d3e8, v81
v_rcp_f32 v236, v88
v_mul_f32 v232, v89, v88
v_mul_f32 v88, v83, v83
v_mul_f32 v229, 0xc0135761, v83
v_mul_f32 v89, 0xbdd2d3e8, v83
v_rcp_f32 v237, v88
v_mul_f32 v233, v89, v88
v_mul_f32 v88, v85, v85
v_mul_f32 v230, 0xc0135761, v85
v_mul_f32 v89, 0xbdd2d3e8, v85
v_rcp_f32 v238, v88
v_mul_f32 v234, v89, v88
v_mul_f32 v88, v87, v87
v_mul_f32 v231, 0xc0135761, v87
v_mul_f32 v89, 0xbdd2d3e8, v87
v_rcp_f32 v239, v88
v_mul_f32 v235, v89, v88
s_load_dword s82, s[80:81], 0
s_load_dword s83, s[80:81], 64
s_load_dword s84, s[80:81], 128
s_load_dword s85, s[80:81], 192
s_load_dword s86, s[80:81], 256
s_load_dword s87, s[80:81], 320
s_load_dword s82, s[80:81], 384
s_load_dword s83, s[80:81], 448
s_add_u32 s80, s80, 512
s_addc_u32 s81, s81, 0
s_barrier
v_mul_f32 v128, -v80, v48
v_mul_f32 v129, -v80, v49
v_mul_f32 v130, -v80, v50
v_mul_f32 v131, -v80, v51
v_mul_f32 v132, -v82, v48
v_mul_f32 v133, -v82, v49
v_mul_f32 v134, -v82, v50
v_mul_f32 v135, -v82, v51
v_mul_f32 v136, -v84, v48
v_mul_f32 v137, -v84, v49
v_mul_f32 v138, -v84, v50
v_mul_f32 v139, -v84, v51
v_mul_f32 v140, -v86, v48
v_mul_f32 v141, -v86, v49
v_mul_f32 v142, -v86, v50
v_mul_f32 v143, -v86, v51
v_mul_f32 v144, -v80, v52
v_mul_f32 v145, -v80, v53
v_mul_f32 v146, -v80, v54
v_mul_f32 v147, -v80, v55
v_mul_f32 v148, -v82, v52
v_mul_f32 v149, -v82, v53
v_mul_f32 v150, -v82, v54
v_mul_f32 v151, -v82, v55
v_mul_f32 v152, -v84, v52
v_mul_f32 v153, -v84, v53
v_mul_f32 v154, -v84, v54
v_mul_f32 v155, -v84, v55
v_mul_f32 v156, -v86, v52
v_mul_f32 v157, -v86, v53
v_mul_f32 v158, -v86, v54
v_mul_f32 v159, -v86, v55
s_load_dword s82, s[80:81], 0
s_load_dword s83, s[80:81], 64
s_load_dword s84, s[80:81], 128
s_load_dword s85, s[80:81], 192
s_load_dword s86, s[80:81], 256
s_load_dword s87, s[80:81], 320
s_load_dword s82, s[80:81], 384
s_load_dword s83, s[80:81], 448
s_add_u32 s80, s80, 512
s_addc_u32 s81, s81, 0
s_barrier
v_mul_f32 v160, -v80, v56
v_mul_f32 v161, -v80, v57
v_mul_f32 v162, -v80, v58
v_mul_f32 v163, -v80, v59
v_mul_f32 v164, -v82, v56
v_mul_f32 v165, -v82, v57
v_mul_f32 v166, -v82, v58
v_mul_f32 v167, -v82, v59
v_mul_f32 v168, -v84, v56
v_mul_f32 v169, -v84, v57
v_mul_f32 v170, -v84, v58
v_mul_f32 v171, -v84, v59
v_mul_f32 v172, -v86, v56
v_mul_f32 v173, -v86, v57
v_mul_f32 v174, -v86, v58
v_mul_f32 v175, -v86, v59
v_mul_f32 v176, -v80, v60
v_mul_f32 v177, -v80, v61
v_mul_f32 v178, -v80, v62
v_mul_f32 v179, -v80, v63
v_mul_f32 v180, -v82, v60
v_mul_f32 v181, -v82, v61
v_mul_f32 v182, -v82, v62
v_mul_f32 v183, -v82, v63
v_mul_f32 v184, -v84, v60
v_mul_f32 v185, -v84, v61
v_mul_f32 v186, -v84, v62
v_mul_f32 v187, -v84, v63
v_mul_f32 v188, -v86, v60
v_mul_f32 v189, -v86, v61
v_mul_f32 v190, -v86, v62
v_mul_f32 v191, -v86, v63
s_load_dword s82, s[80:81], 0
s_load_dword s83, s[80:81], 64
s_load_dword s84, s[80:81], 128
s_load_dword s85, s[80:81], 192
s_load_dword s86, s[80:81], 256
s_load_dword s87, s[80:81], 320
s_load_dword s82, s[80:81], 384
s_load_dword s83, s[80:81], 448
s_add_u32 s80, s80, 512
s_addc_u32 s81, s81, 0
s_barrier
v_mul_f32 v192, -v80, v64
v_mul_f32 v193, -v80, v65
v_mul_f32 v194, -v80, v66
v_mul_f32 v195, -v80, v67
v_mul_f32 v196, -v82, v64
v_mul_f32 v197, -v82, v65
v_mul_f32 v198, -v82, v66
v_mul_f32 v199, -v82, v67
v_mul_f32 v200, -v84, v64
v_mul_f32 v201, -v84, v65
v_mul_f32 v202, -v84, v66
v_mul_f32 v203, -v84, v67
v_mul_f32 v204, -v86, v64
v_mul_f32 v205, -v86, v65
v_mul_f32 v206, -v86, v66
v_mul_f32 v207, -v86, v67
v_mul_f32 v208, -v80, v68
v_mul_f32 v209, -v80, v69
v_mul_f32 v210, -v80, v70
v_mul_f32 v211, -v80, v71
v_mul_f32 v212, -v82, v68
v_mul_f32 v213, -v82, v69
v_mul_f32 v214, -v82, v70
v_mul_f32 v215, -v82, v71
v_mul_f32 v216, -v84, v68
v_mul_f32 v217, -v84, v69
v_mul_f32 v218, -v84, v70
v_mul_f32 v219, -v84, v71
v_mul_f32 v220, -v86, v68
v_mul_f32 v221, -v86, v69
v_mul_f32 v222, -v86, v70
v_mul_f32 v223, -v86, v71
s_mul_i32 s43, s34, 917504
s_mov_b32 s44, 3577949200
s_mov_b32 s45, 3137247350
s_lshl_b32 s50, s49, 2
s_lshr_b64 s[44:45], s[44:45], s50
s_and_b32 s50, s44, 15
s_mul_i32 s44, s50, 24576
s_add_u32 s43, s43, s44
s_add_u32 s43, s43, 8912896
s_add_u32 s24, s32, s43
s_addc_u32 s25, s33, 0
s_mov_b32 s26, 24576
s_mov_b32 s27, 0x20000
s_mov_b32 s53, 262144
s_lshl_b32 s43, s47, 13
s_lshl_b32 s44, s46, 10
s_add_u32 s43, s43, s44
v_lshlrev_b32 v19, 11, v18
v_lshl_add_u32 v19, v17, 4, v19
v_add_u32 v27, s43, v19
s_lshl_b32 s43, s47, 12
s_add_u32 s43, s43, s44
s_add_u32 s43, s43, 16384
v_and_b32 v19, 1, v18
v_lshlrev_b32 v19, 11, v19
v_lshrrev_b32 v20, 1, v18
v_lshl_add_u32 v19, v20, 8, v19
v_lshl_add_u32 v19, v17, 4, v19
v_add_u32 v28, s43, v19
s_barrier
s_branch Lw_155
Lr_156:
s_mul_i32 s44, s34, 917504
s_lshl_b32 s39, s51, 13
s_add_u32 s44, s44, s39
s_add_u32 s44, s44, 8388608
s_and_b32 s43, s51, 1
s_xor_b32 s43, s43, s35
s_lshl_b32 s43, s43, 7
s_mov_b32 s10, 909312
s_movk_i32 s38, 1024
s_movk_i32 s40, 9216
s_movk_i32 s37, 0x4000
s_cmp_ge_u32 s51, 2
s_cselect_b32 s8, s60, s32
s_cselect_b32 s9, s61, s33
s_cselect_b32 s10, 7338112, s10
s_cselect_b32 s43, s43, s44
s_cselect_b32 s38, 16384, s38
s_cselect_b32 s40, 81920, s40
s_cselect_b32 s55, 81920, s38
s_cselect_b32 s37, 262144, s37
s_cselect_b32 s45, -1, 0
s_add_u32 s8, s8, s43
s_addc_u32 s9, s9, 0
s_mov_b32 s11, 0x20000
s_and_b32 s53, s35, 1
s_mul_i32 s54, s53, 6
s_mul_i32 s54, s54, s37
s_mul_i32 s29, s53, 2
s_add_u32 s29, s29, 6
s_mul_i32 s29, s29, s37
s_and_b32 s43, s45, 4290838528
s_add_u32 s29, s29, s43
s_mul_i32 s37, s37, 2
s_sub_u32 s37, s37, s40
v_lshrrev_b32 v19, 3, v1
v_mul_u32_u24 v19, 1920, v19
v_lshrrev_b32 v20, 4, v1
v_lshlrev_b32 v20, 5, v20
v_and_b32 v19, s45, v19
v_and_b32 v20, s45, v20
v_lshlrev_b32 v21, 4, v1
v_xor_b32 v21, v21, v20
v_add_u32 v21, v21, v19
s_barrier
.p2align 3
LK3b_134:
s_setprio 1
ds_read_b128 v[32:35], v2 offset:0
ds_read_b64_tr_b16 v[48:49], v5 offset:16384
ds_read_b64_tr_b16 v[50:51], v5 offset:20480
ds_read_b128 v[36:39], v2 offset:256
ds_read_b128 v[40:43], v2 offset:512
ds_read_b128 v[44:47], v2 offset:768
ds_read_b64_tr_b16 v[60:61], v5 offset:32768
ds_read_b64_tr_b16 v[62:63], v5 offset:36864
ds_read_b64_tr_b16 v[52:53], v6 offset:16384
ds_read_b64_tr_b16 v[54:55], v6 offset:20480
ds_read_b64_tr_b16 v[64:65], v6 offset:32768
ds_read_b64_tr_b16 v[66:67], v6 offset:36864
ds_read_b64_tr_b16 v[56:57], v7 offset:16384
ds_read_b64_tr_b16 v[58:59], v7 offset:20480
ds_read_b64_tr_b16 v[68:69], v7 offset:32768
ds_read_b64_tr_b16 v[70:71], v7 offset:36864
s_mov_b32 s41, 5
.p2align 3
Lk3_157:
s_waitcnt lgkmcnt(0)
v_mfma_f32_16x16x32_bf16 v[128:131], v[48:51], v[32:35], v[128:131]
ds_read_b128 v[80:83], v2 offset:8192
v_mfma_f32_16x16x32_bf16 v[132:135], v[48:51], v[36:39], v[132:135]
ds_read_b64_tr_b16 v[96:97], v5 offset:24576
v_mfma_f32_16x16x32_bf16 v[136:139], v[48:51], v[40:43], v[136:139]
ds_read_b64_tr_b16 v[98:99], v5 offset:28672
v_mfma_f32_16x16x32_bf16 v[140:143], v[48:51], v[44:47], v[140:143]
ds_read_b128 v[84:87], v2 offset:8448
v_mfma_f32_16x16x32_bf16 v[188:191], v[60:63], v[44:47], v[188:191]
ds_read_b128 v[88:91], v2 offset:8704
v_mfma_f32_16x16x32_bf16 v[184:187], v[60:63], v[40:43], v[184:187]
ds_read_b128 v[92:95], v2 offset:8960
v_mfma_f32_16x16x32_bf16 v[180:183], v[60:63], v[36:39], v[180:183]
ds_read_b64_tr_b16 v[108:109], v5 offset:40960
v_mfma_f32_16x16x32_bf16 v[176:179], v[60:63], v[32:35], v[176:179]
ds_read_b64_tr_b16 v[110:111], v5 offset:45056
v_mfma_f32_16x16x32_bf16 v[144:147], v[52:55], v[32:35], v[144:147]
ds_read_b64_tr_b16 v[100:101], v6 offset:24576
v_mfma_f32_16x16x32_bf16 v[148:151], v[52:55], v[36:39], v[148:151]
ds_read_b64_tr_b16 v[102:103], v6 offset:28672
v_mfma_f32_16x16x32_bf16 v[152:155], v[52:55], v[40:43], v[152:155]
ds_read_b64_tr_b16 v[112:113], v6 offset:40960
v_mfma_f32_16x16x32_bf16 v[156:159], v[52:55], v[44:47], v[156:159]
ds_read_b64_tr_b16 v[114:115], v6 offset:45056
v_mfma_f32_16x16x32_bf16 v[204:207], v[64:67], v[44:47], v[204:207]
ds_read_b64_tr_b16 v[104:105], v7 offset:24576
v_mfma_f32_16x16x32_bf16 v[200:203], v[64:67], v[40:43], v[200:203]
ds_read_b64_tr_b16 v[106:107], v7 offset:28672
v_mfma_f32_16x16x32_bf16 v[196:199], v[64:67], v[36:39], v[196:199]
ds_read_b64_tr_b16 v[116:117], v7 offset:40960
v_mfma_f32_16x16x32_bf16 v[192:195], v[64:67], v[32:35], v[192:195]
ds_read_b64_tr_b16 v[118:119], v7 offset:45056
v_mfma_f32_16x16x32_bf16 v[160:163], v[56:59], v[32:35], v[160:163]
v_mfma_f32_16x16x32_bf16 v[164:167], v[56:59], v[36:39], v[164:167]
v_mfma_f32_16x16x32_bf16 v[168:171], v[56:59], v[40:43], v[168:171]
v_mfma_f32_16x16x32_bf16 v[172:175], v[56:59], v[44:47], v[172:175]
v_mfma_f32_16x16x32_bf16 v[220:223], v[68:71], v[44:47], v[220:223]
v_mfma_f32_16x16x32_bf16 v[216:219], v[68:71], v[40:43], v[216:219]
v_mfma_f32_16x16x32_bf16 v[212:215], v[68:71], v[36:39], v[212:215]
v_mfma_f32_16x16x32_bf16 v[208:211], v[68:71], v[32:35], v[208:211]
s_waitcnt vmcnt(0) lgkmcnt(0)
s_barrier
v_mfma_f32_16x16x32_bf16 v[128:131], v[96:99], v[80:83], v[128:131]
ds_read_b128 v[32:35], v3 offset:0
v_mfma_f32_16x16x32_bf16 v[132:135], v[96:99], v[84:87], v[132:135]
ds_read_b64_tr_b16 v[48:49], v9 offset:16384
v_mfma_f32_16x16x32_bf16 v[136:139], v[96:99], v[88:91], v[136:139]
ds_read_b64_tr_b16 v[50:51], v9 offset:20480
v_mfma_f32_16x16x32_bf16 v[140:143], v[96:99], v[92:95], v[140:143]
ds_read_b128 v[36:39], v3 offset:256
v_mfma_f32_16x16x32_bf16 v[188:191], v[108:111], v[92:95], v[188:191]
ds_read_b128 v[40:43], v3 offset:512
v_mfma_f32_16x16x32_bf16 v[184:187], v[108:111], v[88:91], v[184:187]
ds_read_b128 v[44:47], v3 offset:768
v_mfma_f32_16x16x32_bf16 v[180:183], v[108:111], v[84:87], v[180:183]
ds_read_b64_tr_b16 v[60:61], v9 offset:32768
v_mfma_f32_16x16x32_bf16 v[176:179], v[108:111], v[80:83], v[176:179]
ds_read_b64_tr_b16 v[62:63], v9 offset:36864
v_mfma_f32_16x16x32_bf16 v[144:147], v[100:103], v[80:83], v[144:147]
ds_read_b64_tr_b16 v[52:53], v10 offset:16384
v_mfma_f32_16x16x32_bf16 v[148:151], v[100:103], v[84:87], v[148:151]
ds_read_b64_tr_b16 v[54:55], v10 offset:20480
v_mfma_f32_16x16x32_bf16 v[152:155], v[100:103], v[88:91], v[152:155]
ds_read_b64_tr_b16 v[64:65], v10 offset:32768
v_mfma_f32_16x16x32_bf16 v[156:159], v[100:103], v[92:95], v[156:159]
ds_read_b64_tr_b16 v[66:67], v10 offset:36864
v_mfma_f32_16x16x32_bf16 v[204:207], v[112:115], v[92:95], v[204:207]
ds_read_b64_tr_b16 v[56:57], v11 offset:16384
v_mfma_f32_16x16x32_bf16 v[200:203], v[112:115], v[88:91], v[200:203]
ds_read_b64_tr_b16 v[58:59], v11 offset:20480
v_mfma_f32_16x16x32_bf16 v[196:199], v[112:115], v[84:87], v[196:199]
ds_read_b64_tr_b16 v[68:69], v11 offset:32768
v_mfma_f32_16x16x32_bf16 v[192:195], v[112:115], v[80:83], v[192:195]
ds_read_b64_tr_b16 v[70:71], v11 offset:36864
v_mfma_f32_16x16x32_bf16 v[160:163], v[104:107], v[80:83], v[160:163]
v_mfma_f32_16x16x32_bf16 v[164:167], v[104:107], v[84:87], v[164:167]
v_mfma_f32_16x16x32_bf16 v[168:171], v[104:107], v[88:91], v[168:171]
v_mfma_f32_16x16x32_bf16 v[172:175], v[104:107], v[92:95], v[172:175]
v_mfma_f32_16x16x32_bf16 v[220:223], v[116:119], v[92:95], v[220:223]
v_mfma_f32_16x16x32_bf16 v[216:219], v[116:119], v[88:91], v[216:219]
v_mfma_f32_16x16x32_bf16 v[212:215], v[116:119], v[84:87], v[212:215]
v_mfma_f32_16x16x32_bf16 v[208:211], v[116:119], v[80:83], v[208:211]
s_waitcnt lgkmcnt(0)
v_mfma_f32_16x16x32_bf16 v[128:131], v[48:51], v[32:35], v[128:131]
ds_read_b128 v[80:83], v3 offset:8192
v_mfma_f32_16x16x32_bf16 v[132:135], v[48:51], v[36:39], v[132:135]
ds_read_b64_tr_b16 v[96:97], v9 offset:24576
v_mfma_f32_16x16x32_bf16 v[136:139], v[48:51], v[40:43], v[136:139]
ds_read_b64_tr_b16 v[98:99], v9 offset:28672
v_mfma_f32_16x16x32_bf16 v[140:143], v[48:51], v[44:47], v[140:143]
ds_read_b128 v[84:87], v3 offset:8448
v_mfma_f32_16x16x32_bf16 v[188:191], v[60:63], v[44:47], v[188:191]
ds_read_b128 v[88:91], v3 offset:8704
v_mfma_f32_16x16x32_bf16 v[184:187], v[60:63], v[40:43], v[184:187]
ds_read_b128 v[92:95], v3 offset:8960
v_mfma_f32_16x16x32_bf16 v[180:183], v[60:63], v[36:39], v[180:183]
ds_read_b64_tr_b16 v[108:109], v9 offset:40960
v_mfma_f32_16x16x32_bf16 v[176:179], v[60:63], v[32:35], v[176:179]
ds_read_b64_tr_b16 v[110:111], v9 offset:45056
v_mfma_f32_16x16x32_bf16 v[144:147], v[52:55], v[32:35], v[144:147]
ds_read_b64_tr_b16 v[100:101], v10 offset:24576
v_mfma_f32_16x16x32_bf16 v[148:151], v[52:55], v[36:39], v[148:151]
ds_read_b64_tr_b16 v[102:103], v10 offset:28672
v_mfma_f32_16x16x32_bf16 v[152:155], v[52:55], v[40:43], v[152:155]
ds_read_b64_tr_b16 v[112:113], v10 offset:40960
v_mfma_f32_16x16x32_bf16 v[156:159], v[52:55], v[44:47], v[156:159]
ds_read_b64_tr_b16 v[114:115], v10 offset:45056
v_mfma_f32_16x16x32_bf16 v[204:207], v[64:67], v[44:47], v[204:207]
ds_read_b64_tr_b16 v[104:105], v11 offset:24576
v_mfma_f32_16x16x32_bf16 v[200:203], v[64:67], v[40:43], v[200:203]
ds_read_b64_tr_b16 v[106:107], v11 offset:28672
v_mfma_f32_16x16x32_bf16 v[196:199], v[64:67], v[36:39], v[196:199]
ds_read_b64_tr_b16 v[116:117], v11 offset:40960
v_mfma_f32_16x16x32_bf16 v[192:195], v[64:67], v[32:35], v[192:195]
ds_read_b64_tr_b16 v[118:119], v11 offset:45056
v_mfma_f32_16x16x32_bf16 v[160:163], v[56:59], v[32:35], v[160:163]
v_mfma_f32_16x16x32_bf16 v[164:167], v[56:59], v[36:39], v[164:167]
v_mfma_f32_16x16x32_bf16 v[168:171], v[56:59], v[40:43], v[168:171]
v_mfma_f32_16x16x32_bf16 v[172:175], v[56:59], v[44:47], v[172:175]
v_mfma_f32_16x16x32_bf16 v[220:223], v[68:71], v[44:47], v[220:223]
v_mfma_f32_16x16x32_bf16 v[216:219], v[68:71], v[40:43], v[216:219]
v_mfma_f32_16x16x32_bf16 v[212:215], v[68:71], v[36:39], v[212:215]
v_mfma_f32_16x16x32_bf16 v[208:211], v[68:71], v[32:35], v[208:211]
s_waitcnt lgkmcnt(0)
s_barrier
v_mfma_f32_16x16x32_bf16 v[128:131], v[96:99], v[80:83], v[128:131]
ds_read_b128 v[32:35], v4 offset:0
v_mfma_f32_16x16x32_bf16 v[132:135], v[96:99], v[84:87], v[132:135]
ds_read_b64_tr_b16 v[48:49], v13 offset:16384
v_mfma_f32_16x16x32_bf16 v[136:139], v[96:99], v[88:91], v[136:139]
ds_read_b64_tr_b16 v[50:51], v13 offset:20480
v_mfma_f32_16x16x32_bf16 v[140:143], v[96:99], v[92:95], v[140:143]
ds_read_b128 v[36:39], v4 offset:256
v_mfma_f32_16x16x32_bf16 v[188:191], v[108:111], v[92:95], v[188:191]
ds_read_b128 v[40:43], v4 offset:512
v_mfma_f32_16x16x32_bf16 v[184:187], v[108:111], v[88:91], v[184:187]
ds_read_b128 v[44:47], v4 offset:768
v_mfma_f32_16x16x32_bf16 v[180:183], v[108:111], v[84:87], v[180:183]
ds_read_b64_tr_b16 v[60:61], v13 offset:32768
v_mfma_f32_16x16x32_bf16 v[176:179], v[108:111], v[80:83], v[176:179]
ds_read_b64_tr_b16 v[62:63], v13 offset:36864
v_mfma_f32_16x16x32_bf16 v[144:147], v[100:103], v[80:83], v[144:147]
ds_read_b64_tr_b16 v[52:53], v14 offset:16384
v_mfma_f32_16x16x32_bf16 v[148:151], v[100:103], v[84:87], v[148:151]
ds_read_b64_tr_b16 v[54:55], v14 offset:20480
v_mfma_f32_16x16x32_bf16 v[152:155], v[100:103], v[88:91], v[152:155]
ds_read_b64_tr_b16 v[64:65], v14 offset:32768
v_mfma_f32_16x16x32_bf16 v[156:159], v[100:103], v[92:95], v[156:159]
ds_read_b64_tr_b16 v[66:67], v14 offset:36864
v_mfma_f32_16x16x32_bf16 v[204:207], v[112:115], v[92:95], v[204:207]
ds_read_b64_tr_b16 v[56:57], v15 offset:16384
v_mfma_f32_16x16x32_bf16 v[200:203], v[112:115], v[88:91], v[200:203]
ds_read_b64_tr_b16 v[58:59], v15 offset:20480
v_mfma_f32_16x16x32_bf16 v[196:199], v[112:115], v[84:87], v[196:199]
ds_read_b64_tr_b16 v[68:69], v15 offset:32768
v_mfma_f32_16x16x32_bf16 v[192:195], v[112:115], v[80:83], v[192:195]
ds_read_b64_tr_b16 v[70:71], v15 offset:36864
v_mfma_f32_16x16x32_bf16 v[160:163], v[104:107], v[80:83], v[160:163]
v_mfma_f32_16x16x32_bf16 v[164:167], v[104:107], v[84:87], v[164:167]
v_mfma_f32_16x16x32_bf16 v[168:171], v[104:107], v[88:91], v[168:171]
v_mfma_f32_16x16x32_bf16 v[172:175], v[104:107], v[92:95], v[172:175]
v_mfma_f32_16x16x32_bf16 v[220:223], v[116:119], v[92:95], v[220:223]
v_mfma_f32_16x16x32_bf16 v[216:219], v[116:119], v[88:91], v[216:219]
v_mfma_f32_16x16x32_bf16 v[212:215], v[116:119], v[84:87], v[212:215]
v_mfma_f32_16x16x32_bf16 v[208:211], v[116:119], v[80:83], v[208:211]
s_waitcnt lgkmcnt(0)
v_mfma_f32_16x16x32_bf16 v[128:131], v[48:51], v[32:35], v[128:131]
ds_read_b128 v[80:83], v4 offset:8192
v_mfma_f32_16x16x32_bf16 v[132:135], v[48:51], v[36:39], v[132:135]
ds_read_b64_tr_b16 v[96:97], v13 offset:24576
v_mfma_f32_16x16x32_bf16 v[136:139], v[48:51], v[40:43], v[136:139]
ds_read_b64_tr_b16 v[98:99], v13 offset:28672
v_mfma_f32_16x16x32_bf16 v[140:143], v[48:51], v[44:47], v[140:143]
ds_read_b128 v[84:87], v4 offset:8448
v_mfma_f32_16x16x32_bf16 v[188:191], v[60:63], v[44:47], v[188:191]
ds_read_b128 v[88:91], v4 offset:8704
v_mfma_f32_16x16x32_bf16 v[184:187], v[60:63], v[40:43], v[184:187]
ds_read_b128 v[92:95], v4 offset:8960
v_mfma_f32_16x16x32_bf16 v[180:183], v[60:63], v[36:39], v[180:183]
ds_read_b64_tr_b16 v[108:109], v13 offset:40960
v_mfma_f32_16x16x32_bf16 v[176:179], v[60:63], v[32:35], v[176:179]
ds_read_b64_tr_b16 v[110:111], v13 offset:45056
v_mfma_f32_16x16x32_bf16 v[144:147], v[52:55], v[32:35], v[144:147]
ds_read_b64_tr_b16 v[100:101], v14 offset:24576
v_mfma_f32_16x16x32_bf16 v[148:151], v[52:55], v[36:39], v[148:151]
ds_read_b64_tr_b16 v[102:103], v14 offset:28672
v_mfma_f32_16x16x32_bf16 v[152:155], v[52:55], v[40:43], v[152:155]
ds_read_b64_tr_b16 v[112:113], v14 offset:40960
v_mfma_f32_16x16x32_bf16 v[156:159], v[52:55], v[44:47], v[156:159]
ds_read_b64_tr_b16 v[114:115], v14 offset:45056
v_mfma_f32_16x16x32_bf16 v[204:207], v[64:67], v[44:47], v[204:207]
ds_read_b64_tr_b16 v[104:105], v15 offset:24576
v_mfma_f32_16x16x32_bf16 v[200:203], v[64:67], v[40:43], v[200:203]
ds_read_b64_tr_b16 v[106:107], v15 offset:28672
v_mfma_f32_16x16x32_bf16 v[196:199], v[64:67], v[36:39], v[196:199]
ds_read_b64_tr_b16 v[116:117], v15 offset:40960
v_mfma_f32_16x16x32_bf16 v[192:195], v[64:67], v[32:35], v[192:195]
ds_read_b64_tr_b16 v[118:119], v15 offset:45056
v_mfma_f32_16x16x32_bf16 v[160:163], v[56:59], v[32:35], v[160:163]
v_mfma_f32_16x16x32_bf16 v[164:167], v[56:59], v[36:39], v[164:167]
v_mfma_f32_16x16x32_bf16 v[168:171], v[56:59], v[40:43], v[168:171]
v_mfma_f32_16x16x32_bf16 v[172:175], v[56:59], v[44:47], v[172:175]
v_mfma_f32_16x16x32_bf16 v[220:223], v[68:71], v[44:47], v[220:223]
v_mfma_f32_16x16x32_bf16 v[216:219], v[68:71], v[40:43], v[216:219]
v_mfma_f32_16x16x32_bf16 v[212:215], v[68:71], v[36:39], v[212:215]
v_mfma_f32_16x16x32_bf16 v[208:211], v[68:71], v[32:35], v[208:211]
s_waitcnt lgkmcnt(0)
s_barrier
v_mfma_f32_16x16x32_bf16 v[128:131], v[96:99], v[80:83], v[128:131]
ds_read_b128 v[32:35], v2 offset:0
v_mfma_f32_16x16x32_bf16 v[132:135], v[96:99], v[84:87], v[132:135]
ds_read_b64_tr_b16 v[48:49], v5 offset:16384
v_mfma_f32_16x16x32_bf16 v[136:139], v[96:99], v[88:91], v[136:139]
ds_read_b64_tr_b16 v[50:51], v5 offset:20480
v_mfma_f32_16x16x32_bf16 v[140:143], v[96:99], v[92:95], v[140:143]
ds_read_b128 v[36:39], v2 offset:256
v_mfma_f32_16x16x32_bf16 v[188:191], v[108:111], v[92:95], v[188:191]
ds_read_b128 v[40:43], v2 offset:512
v_mfma_f32_16x16x32_bf16 v[184:187], v[108:111], v[88:91], v[184:187]
ds_read_b128 v[44:47], v2 offset:768
v_mfma_f32_16x16x32_bf16 v[180:183], v[108:111], v[84:87], v[180:183]
ds_read_b64_tr_b16 v[60:61], v5 offset:32768
v_mfma_f32_16x16x32_bf16 v[176:179], v[108:111], v[80:83], v[176:179]
ds_read_b64_tr_b16 v[62:63], v5 offset:36864
v_mfma_f32_16x16x32_bf16 v[144:147], v[100:103], v[80:83], v[144:147]
ds_read_b64_tr_b16 v[52:53], v6 offset:16384
v_mfma_f32_16x16x32_bf16 v[148:151], v[100:103], v[84:87], v[148:151]
ds_read_b64_tr_b16 v[54:55], v6 offset:20480
v_mfma_f32_16x16x32_bf16 v[152:155], v[100:103], v[88:91], v[152:155]
ds_read_b64_tr_b16 v[64:65], v6 offset:32768
v_mfma_f32_16x16x32_bf16 v[156:159], v[100:103], v[92:95], v[156:159]
ds_read_b64_tr_b16 v[66:67], v6 offset:36864
v_mfma_f32_16x16x32_bf16 v[204:207], v[112:115], v[92:95], v[204:207]
ds_read_b64_tr_b16 v[56:57], v7 offset:16384
v_mfma_f32_16x16x32_bf16 v[200:203], v[112:115], v[88:91], v[200:203]
ds_read_b64_tr_b16 v[58:59], v7 offset:20480
v_mfma_f32_16x16x32_bf16 v[196:199], v[112:115], v[84:87], v[196:199]
ds_read_b64_tr_b16 v[68:69], v7 offset:32768
v_mfma_f32_16x16x32_bf16 v[192:195], v[112:115], v[80:83], v[192:195]
ds_read_b64_tr_b16 v[70:71], v7 offset:36864
v_mfma_f32_16x16x32_bf16 v[160:163], v[104:107], v[80:83], v[160:163]
v_mfma_f32_16x16x32_bf16 v[164:167], v[104:107], v[84:87], v[164:167]
v_mfma_f32_16x16x32_bf16 v[168:171], v[104:107], v[88:91], v[168:171]
v_mfma_f32_16x16x32_bf16 v[172:175], v[104:107], v[92:95], v[172:175]
v_mfma_f32_16x16x32_bf16 v[220:223], v[116:119], v[92:95], v[220:223]
v_mfma_f32_16x16x32_bf16 v[216:219], v[116:119], v[88:91], v[216:219]
v_mfma_f32_16x16x32_bf16 v[212:215], v[116:119], v[84:87], v[212:215]
v_mfma_f32_16x16x32_bf16 v[208:211], v[116:119], v[80:83], v[208:211]
s_sub_u32 s41, s41, 1
s_cmp_lg_u32 s41, 0
s_cbranch_scc1 Lk3_157
s_waitcnt lgkmcnt(0)
v_mfma_f32_16x16x32_bf16 v[128:131], v[48:51], v[32:35], v[128:131]
ds_read_b128 v[80:83], v2 offset:8192
v_mfma_f32_16x16x32_bf16 v[132:135], v[48:51], v[36:39], v[132:135]
ds_read_b64_tr_b16 v[96:97], v5 offset:24576
v_mfma_f32_16x16x32_bf16 v[136:139], v[48:51], v[40:43], v[136:139]
ds_read_b64_tr_b16 v[98:99], v5 offset:28672
v_mfma_f32_16x16x32_bf16 v[140:143], v[48:51], v[44:47], v[140:143]
ds_read_b128 v[84:87], v2 offset:8448
v_mfma_f32_16x16x32_bf16 v[188:191], v[60:63], v[44:47], v[188:191]
ds_read_b128 v[88:91], v2 offset:8704
v_mfma_f32_16x16x32_bf16 v[184:187], v[60:63], v[40:43], v[184:187]
ds_read_b128 v[92:95], v2 offset:8960
v_mfma_f32_16x16x32_bf16 v[180:183], v[60:63], v[36:39], v[180:183]
ds_read_b64_tr_b16 v[108:109], v5 offset:40960
v_mfma_f32_16x16x32_bf16 v[176:179], v[60:63], v[32:35], v[176:179]
ds_read_b64_tr_b16 v[110:111], v5 offset:45056
v_mfma_f32_16x16x32_bf16 v[144:147], v[52:55], v[32:35], v[144:147]
ds_read_b64_tr_b16 v[100:101], v6 offset:24576
v_mfma_f32_16x16x32_bf16 v[148:151], v[52:55], v[36:39], v[148:151]
ds_read_b64_tr_b16 v[102:103], v6 offset:28672
v_mfma_f32_16x16x32_bf16 v[152:155], v[52:55], v[40:43], v[152:155]
ds_read_b64_tr_b16 v[112:113], v6 offset:40960
v_mfma_f32_16x16x32_bf16 v[156:159], v[52:55], v[44:47], v[156:159]
ds_read_b64_tr_b16 v[114:115], v6 offset:45056
v_mfma_f32_16x16x32_bf16 v[204:207], v[64:67], v[44:47], v[204:207]
ds_read_b64_tr_b16 v[104:105], v7 offset:24576
v_mfma_f32_16x16x32_bf16 v[200:203], v[64:67], v[40:43], v[200:203]
ds_read_b64_tr_b16 v[106:107], v7 offset:28672
v_mfma_f32_16x16x32_bf16 v[196:199], v[64:67], v[36:39], v[196:199]
ds_read_b64_tr_b16 v[116:117], v7 offset:40960
v_mfma_f32_16x16x32_bf16 v[192:195], v[64:67], v[32:35], v[192:195]
ds_read_b64_tr_b16 v[118:119], v7 offset:45056
v_mfma_f32_16x16x32_bf16 v[160:163], v[56:59], v[32:35], v[160:163]
v_mfma_f32_16x16x32_bf16 v[164:167], v[56:59], v[36:39], v[164:167]
v_mfma_f32_16x16x32_bf16 v[168:171], v[56:59], v[40:43], v[168:171]
v_mfma_f32_16x16x32_bf16 v[172:175], v[56:59], v[44:47], v[172:175]
v_mfma_f32_16x16x32_bf16 v[220:223], v[68:71], v[44:47], v[220:223]
v_mfma_f32_16x16x32_bf16 v[216:219], v[68:71], v[40:43], v[216:219]
v_mfma_f32_16x16x32_bf16 v[212:215], v[68:71], v[36:39], v[212:215]
v_mfma_f32_16x16x32_bf16 v[208:211], v[68:71], v[32:35], v[208:211]
s_waitcnt lgkmcnt(0)
s_barrier
s_cmp_eq_u32 s36, 7
s_cbranch_scc1 L7b_158
s_add_u32 m0, s39, 0
s_add_u32 s37, s37, s40
buffer_load_dwordx4 v21, s[8:11], s37 offen sc1 lds
v_mfma_f32_16x16x32_bf16 v[128:131], v[96:99], v[80:83], v[128:131]
v_mfma_f32_16x16x32_bf16 v[132:135], v[96:99], v[84:87], v[132:135]
s_add_u32 m0, s39, 1024
s_add_u32 s37, s37, s38
buffer_load_dwordx4 v21, s[8:11], s37 offen sc1 lds
v_mfma_f32_16x16x32_bf16 v[136:139], v[96:99], v[88:91], v[136:139]
s_add_u32 m0, s39, 2048
s_add_u32 s37, s37, s38
buffer_load_dwordx4 v21, s[8:11], s37 offen sc1 lds
v_mfma_f32_16x16x32_bf16 v[140:143], v[96:99], v[92:95], v[140:143]
v_mfma_f32_16x16x32_bf16 v[188:191], v[108:111], v[92:95], v[188:191]
s_add_u32 m0, s39, 3072
s_add_u32 s37, s37, s38
buffer_load_dwordx4 v21, s[8:11], s37 offen sc1 lds
v_mfma_f32_16x16x32_bf16 v[184:187], v[108:111], v[88:91], v[184:187]
s_add_u32 m0, s39, 4096
s_add_u32 s37, s37, s55
buffer_load_dwordx4 v21, s[8:11], s37 offen sc1 lds
v_mfma_f32_16x16x32_bf16 v[180:183], v[108:111], v[84:87], v[180:183]
v_mfma_f32_16x16x32_bf16 v[176:179], v[108:111], v[80:83], v[176:179]
s_add_u32 m0, s39, 5120
s_add_u32 s37, s37, s38
buffer_load_dwordx4 v21, s[8:11], s37 offen sc1 lds
v_mfma_f32_16x16x32_bf16 v[144:147], v[100:103], v[80:83], v[144:147]
s_add_u32 m0, s39, 6144
s_add_u32 s37, s37, s38
buffer_load_dwordx4 v21, s[8:11], s37 offen sc1 lds
v_mfma_f32_16x16x32_bf16 v[148:151], v[100:103], v[84:87], v[148:151]
v_mfma_f32_16x16x32_bf16 v[152:155], v[100:103], v[88:91], v[152:155]
s_add_u32 m0, s39, 7168
s_add_u32 s37, s37, s38
buffer_load_dwordx4 v21, s[8:11], s37 offen sc1 lds
v_mfma_f32_16x16x32_bf16 v[156:159], v[100:103], v[92:95], v[156:159]
s_add_u32 m0, s39, 32768
s_add_u32 s37, s37, s40
buffer_load_dwordx4 v21, s[8:11], s37 offen sc1 lds
v_mfma_f32_16x16x32_bf16 v[204:207], v[112:115], v[92:95], v[204:207]
v_mfma_f32_16x16x32_bf16 v[200:203], v[112:115], v[88:91], v[200:203]
s_add_u32 m0, s39, 33792
s_add_u32 s37, s37, s38
buffer_load_dwordx4 v21, s[8:11], s37 offen sc1 lds
v_mfma_f32_16x16x32_bf16 v[196:199], v[112:115], v[84:87], v[196:199]
s_add_u32 m0, s39, 34816
s_add_u32 s37, s37, s38
buffer_load_dwordx4 v21, s[8:11], s37 offen sc1 lds
v_mfma_f32_16x16x32_bf16 v[192:195], v[112:115], v[80:83], v[192:195]
v_mfma_f32_16x16x32_bf16 v[160:163], v[104:107], v[80:83], v[160:163]
s_add_u32 m0, s39, 35840
s_add_u32 s37, s37, s38
buffer_load_dwordx4 v21, s[8:11], s37 offen sc1 lds
v_mfma_f32_16x16x32_bf16 v[164:167], v[104:107], v[84:87], v[164:167]
s_add_u32 m0, s39, 36864
s_add_u32 s37, s37, s55
buffer_load_dwordx4 v21, s[8:11], s37 offen sc1 lds
v_mfma_f32_16x16x32_bf16 v[168:171], v[104:107], v[88:91], v[168:171]
v_mfma_f32_16x16x32_bf16 v[172:175], v[104:107], v[92:95], v[172:175]
s_add_u32 m0, s39, 37888
s_add_u32 s37, s37, s38
buffer_load_dwordx4 v21, s[8:11], s37 offen sc1 lds
v_mfma_f32_16x16x32_bf16 v[220:223], v[116:119], v[92:95], v[220:223]
s_add_u32 m0, s39, 38912
s_add_u32 s37, s37, s38
buffer_load_dwordx4 v21, s[8:11], s37 offen sc1 lds
v_mfma_f32_16x16x32_bf16 v[216:219], v[116:119], v[88:91], v[216:219]
v_mfma_f32_16x16x32_bf16 v[212:215], v[116:119], v[84:87], v[212:215]
s_add_u32 m0, s39, 39936
s_add_u32 s37, s37, s38
buffer_load_dwordx4 v21, s[8:11], s37 offen sc1 lds
v_mfma_f32_16x16x32_bf16 v[208:211], v[116:119], v[80:83], v[208:211]
s_setprio 0
s_barrier
s_add_u32 s37, s37, s54
s_add_u32 m0, s39, 65536
s_add_u32 s37, s37, s40
buffer_load_dwordx4 v21, s[8:11], s37 offen sc1 lds
v_mul_f32 v80, v128, v128
v_mul_f32 v81, v129, v129
v_mul_f32 v82, v130, v130
v_mul_f32 v83, v131, v131
v_fma_f32 v80, v80, v232, v228
v_fma_f32 v81, v81, v232, v228
v_fma_f32 v82, v82, v232, v228
s_add_u32 m0, s39, 66560
s_add_u32 s37, s37, s38
buffer_load_dwordx4 v21, s[8:11], s37 offen sc1 lds
v_fma_f32 v83, v83, v232, v228
v_mul_f32 v80, v80, v128
v_mul_f32 v81, v81, v129
v_mul_f32 v82, v82, v130
v_mul_f32 v83, v83, v131
v_exp_f32 v80, v80
s_add_u32 m0, s39, 67584
s_add_u32 s37, s37, s38
buffer_load_dwordx4 v21, s[8:11], s37 offen sc1 lds
v_exp_f32 v81, v81
v_exp_f32 v82, v82
v_exp_f32 v83, v83
v_mul_f32 v176, v128, v176
v_mul_f32 v177, v129, v177
v_mul_f32 v178, v130, v178
v_mul_f32 v179, v131, v179
s_add_u32 m0, s39, 68608
s_add_u32 s37, s37, s38
buffer_load_dwordx4 v21, s[8:11], s37 offen sc1 lds
v_fma_f32 v80, v80, v236, v236
v_fma_f32 v81, v81, v236, v236
v_fma_f32 v82, v82, v236, v236
v_fma_f32 v83, v83, v236, v236
v_rcp_f32 v80, v80
v_rcp_f32 v81, v81
s_add_u32 m0, s39, 69632
s_add_u32 s37, s37, s55
buffer_load_dwordx4 v21, s[8:11], s37 offen sc1 lds
v_rcp_f32 v82, v82
v_rcp_f32 v83, v83
v_mul_f32 v176, v176, v80
v_mul_f32 v177, v177, v81
v_mul_f32 v178, v178, v82
v_mul_f32 v179, v179, v83
v_cvt_pk_bf16_f32 v96, v176, v177
s_add_u32 m0, s39, 70656
s_add_u32 s37, s37, s38
buffer_load_dwordx4 v21, s[8:11], s37 offen sc1 lds
v_cvt_pk_bf16_f32 v97, v178, v179
v_mul_f32 v84, v144, v144
v_mul_f32 v85, v145, v145
v_mul_f32 v86, v146, v146
v_mul_f32 v87, v147, v147
v_fma_f32 v84, v84, v232, v228
s_add_u32 m0, s39, 71680
s_add_u32 s37, s37, s38
buffer_load_dwordx4 v21, s[8:11], s37 offen sc1 lds
v_fma_f32 v85, v85, v232, v228
v_fma_f32 v86, v86, v232, v228
v_fma_f32 v87, v87, v232, v228
v_mul_f32 v84, v84, v144
v_mul_f32 v85, v85, v145
v_mul_f32 v86, v86, v146
v_mul_f32 v87, v87, v147
s_add_u32 m0, s39, 72704
s_add_u32 s37, s37, s38
buffer_load_dwordx4 v21, s[8:11], s37 offen sc1 lds
v_exp_f32 v84, v84
v_exp_f32 v85, v85
v_exp_f32 v86, v86
v_exp_f32 v87, v87
v_mul_f32 v192, v144, v192
v_mul_f32 v193, v145, v193
s_waitcnt vmcnt(16)
s_barrier
s_add_u32 m0, s39, 98304
s_add_u32 s37, s37, s40
buffer_load_dwordx4 v21, s[8:11], s37 offen sc1 lds
v_mul_f32 v194, v146, v194
v_mul_f32 v195, v147, v195
v_fma_f32 v84, v84, v236, v236
v_fma_f32 v85, v85, v236, v236
v_fma_f32 v86, v86, v236, v236
v_fma_f32 v87, v87, v236, v236
v_rcp_f32 v84, v84
s_add_u32 m0, s39, 99328
s_add_u32 s37, s37, s38
buffer_load_dwordx4 v21, s[8:11], s37 offen sc1 lds
v_rcp_f32 v85, v85
v_rcp_f32 v86, v86
v_rcp_f32 v87, v87
v_mul_f32 v192, v192, v84
v_mul_f32 v193, v193, v85
v_mul_f32 v194, v194, v86
v_mul_f32 v195, v195, v87
s_add_u32 m0, s39, 100352
s_add_u32 s37, s37, s38
buffer_load_dwordx4 v21, s[8:11], s37 offen sc1 lds
v_cvt_pk_bf16_f32 v98, v192, v193
v_cvt_pk_bf16_f32 v99, v194, v195
v_mul_f32 v80, v160, v160
v_mul_f32 v81, v161, v161
v_mul_f32 v82, v162, v162
s_add_u32 m0, s39, 101376
s_add_u32 s37, s37, s38
buffer_load_dwordx4 v21, s[8:11], s37 offen sc1 lds
v_mul_f32 v83, v163, v163
v_fma_f32 v80, v80, v232, v228
v_fma_f32 v81, v81, v232, v228
v_fma_f32 v82, v82, v232, v228
v_fma_f32 v83, v83, v232, v228
v_mul_f32 v80, v80, v160
v_mul_f32 v81, v81, v161
s_add_u32 m0, s39, 102400
s_add_u32 s37, s37, s55
buffer_load_dwordx4 v21, s[8:11], s37 offen sc1 lds
v_mul_f32 v82, v82, v162
v_mul_f32 v83, v83, v163
v_exp_f32 v80, v80
v_exp_f32 v81, v81
v_exp_f32 v82, v82
v_exp_f32 v83, v83
v_mul_f32 v208, v160, v208
s_add_u32 m0, s39, 103424
s_add_u32 s37, s37, s38
buffer_load_dwordx4 v21, s[8:11], s37 offen sc1 lds
v_mul_f32 v209, v161, v209
v_mul_f32 v210, v162, v210
v_mul_f32 v211, v163, v211
v_fma_f32 v80, v80, v236, v236
v_fma_f32 v81, v81, v236, v236
v_fma_f32 v82, v82, v236, v236
s_add_u32 m0, s39, 104448
s_add_u32 s37, s37, s38
buffer_load_dwordx4 v21, s[8:11], s37 offen sc1 lds
v_fma_f32 v83, v83, v236, v236
v_rcp_f32 v80, v80
v_rcp_f32 v81, v81
v_rcp_f32 v82, v82
v_rcp_f32 v83, v83
v_mul_f32 v208, v208, v80
v_mul_f32 v209, v209, v81
s_add_u32 m0, s39, 105472
s_add_u32 s37, s37, s38
buffer_load_dwordx4 v21, s[8:11], s37 offen sc1 lds
v_mul_f32 v210, v210, v82
v_mul_f32 v211, v211, v83
v_cvt_pk_bf16_f32 v112, v208, v209
v_cvt_pk_bf16_f32 v113, v210, v211
v_mul_f32 v80, v132, v132
v_mul_f32 v81, v133, v133
buffer_store_dwordx4 v[96:99], v27, s[24:27], 0 offen offset:0 sc1
s_waitcnt vmcnt(17)
s_barrier
s_add_u32 m0, s39, 0
s_add_u32 s37, s37, s40
buffer_load_dwordx4 v21, s[8:11], s37 offen sc1 lds
v_mul_f32 v82, v134, v134
v_mul_f32 v83, v135, v135
v_fma_f32 v80, v80, v233, v229
v_fma_f32 v81, v81, v233, v229
v_fma_f32 v82, v82, v233, v229
v_fma_f32 v83, v83, v233, v229
v_mul_f32 v80, v80, v132
s_add_u32 m0, s39, 1024
s_add_u32 s37, s37, s38
buffer_load_dwordx4 v21, s[8:11], s37 offen sc1 lds
v_mul_f32 v81, v81, v133
v_mul_f32 v82, v82, v134
v_mul_f32 v83, v83, v135
v_exp_f32 v80, v80
v_exp_f32 v81, v81
v_exp_f32 v82, v82
s_add_u32 m0, s39, 2048
s_add_u32 s37, s37, s38
buffer_load_dwordx4 v21, s[8:11], s37 offen sc1 lds
v_exp_f32 v83, v83
v_mul_f32 v180, v132, v180
v_mul_f32 v181, v133, v181
v_mul_f32 v182, v134, v182
v_mul_f32 v183, v135, v183
v_fma_f32 v80, v80, v237, v237
v_fma_f32 v81, v81, v237, v237
s_add_u32 m0, s39, 3072
s_add_u32 s37, s37, s38
buffer_load_dwordx4 v21, s[8:11], s37 offen sc1 lds
v_fma_f32 v82, v82, v237, v237
v_fma_f32 v83, v83, v237, v237
v_rcp_f32 v80, v80
v_rcp_f32 v81, v81
v_rcp_f32 v82, v82
v_rcp_f32 v83, v83
s_add_u32 m0, s39, 4096
s_add_u32 s37, s37, s55
buffer_load_dwordx4 v21, s[8:11], s37 offen sc1 lds
v_mul_f32 v180, v180, v80
v_mul_f32 v181, v181, v81
v_mul_f32 v182, v182, v82
v_mul_f32 v183, v183, v83
v_cvt_pk_bf16_f32 v100, v180, v181
v_cvt_pk_bf16_f32 v101, v182, v183
v_mul_f32 v84, v148, v148
s_add_u32 m0, s39, 5120
s_add_u32 s37, s37, s38
buffer_load_dwordx4 v21, s[8:11], s37 offen sc1 lds
v_mul_f32 v85, v149, v149
v_mul_f32 v86, v150, v150
v_mul_f32 v87, v151, v151
v_fma_f32 v84, v84, v233, v229
v_fma_f32 v85, v85, v233, v229
v_fma_f32 v86, v86, v233, v229
s_add_u32 m0, s39, 6144
s_add_u32 s37, s37, s38
buffer_load_dwordx4 v21, s[8:11], s37 offen sc1 lds
v_fma_f32 v87, v87, v233, v229
v_mul_f32 v84, v84, v148
v_mul_f32 v85, v85, v149
v_mul_f32 v86, v86, v150
v_mul_f32 v87, v87, v151
v_exp_f32 v84, v84
v_exp_f32 v85, v85
s_add_u32 m0, s39, 7168
s_add_u32 s37, s37, s38
buffer_load_dwordx4 v21, s[8:11], s37 offen sc1 lds
v_exp_f32 v86, v86
v_exp_f32 v87, v87
v_mul_f32 v196, v148, v196
v_mul_f32 v197, v149, v197
v_mul_f32 v198, v150, v198
v_mul_f32 v199, v151, v199
s_waitcnt vmcnt(17)
s_barrier
s_add_u32 m0, s39, 32768
s_add_u32 s37, s37, s40
buffer_load_dwordx4 v21, s[8:11], s37 offen sc1 lds
v_fma_f32 v84, v84, v237, v237
v_fma_f32 v85, v85, v237, v237
v_fma_f32 v86, v86, v237, v237
v_fma_f32 v87, v87, v237, v237
v_rcp_f32 v84, v84
v_rcp_f32 v85, v85
v_rcp_f32 v86, v86
s_add_u32 m0, s39, 33792
s_add_u32 s37, s37, s38
buffer_load_dwordx4 v21, s[8:11], s37 offen sc1 lds
v_rcp_f32 v87, v87
v_mul_f32 v196, v196, v84
v_mul_f32 v197, v197, v85
v_mul_f32 v198, v198, v86
v_mul_f32 v199, v199, v87
v_cvt_pk_bf16_f32 v102, v196, v197
v_cvt_pk_bf16_f32 v103, v198, v199
s_add_u32 m0, s39, 34816
s_add_u32 s37, s37, s38
buffer_load_dwordx4 v21, s[8:11], s37 offen sc1 lds
v_mul_f32 v80, v164, v164
v_mul_f32 v81, v165, v165
v_mul_f32 v82, v166, v166
v_mul_f32 v83, v167, v167
v_fma_f32 v80, v80, v233, v229
s_add_u32 m0, s39, 35840
s_add_u32 s37, s37, s38
buffer_load_dwordx4 v21, s[8:11], s37 offen sc1 lds
v_fma_f32 v81, v81, v233, v229
v_fma_f32 v82, v82, v233, v229
v_fma_f32 v83, v83, v233, v229
v_mul_f32 v80, v80, v164
v_mul_f32 v81, v81, v165
v_mul_f32 v82, v82, v166
v_mul_f32 v83, v83, v167
s_add_u32 m0, s39, 36864
s_add_u32 s37, s37, s55
buffer_load_dwordx4 v21, s[8:11], s37 offen sc1 lds
v_exp_f32 v80, v80
v_exp_f32 v81, v81
v_exp_f32 v82, v82
v_exp_f32 v83, v83
v_mul_f32 v212, v164, v212
v_mul_f32 v213, v165, v213
v_mul_f32 v214, v166, v214
s_add_u32 m0, s39, 37888
s_add_u32 s37, s37, s38
buffer_load_dwordx4 v21, s[8:11], s37 offen sc1 lds
v_mul_f32 v215, v167, v215
v_fma_f32 v80, v80, v237, v237
v_fma_f32 v81, v81, v237, v237
v_fma_f32 v82, v82, v237, v237
v_fma_f32 v83, v83, v237, v237
v_rcp_f32 v80, v80
s_add_u32 m0, s39, 38912
s_add_u32 s37, s37, s38
buffer_load_dwordx4 v21, s[8:11], s37 offen sc1 lds
v_rcp_f32 v81, v81
v_rcp_f32 v82, v82
v_rcp_f32 v83, v83
v_mul_f32 v212, v212, v80
v_mul_f32 v213, v213, v81
v_mul_f32 v214, v214, v82
v_mul_f32 v215, v215, v83
s_add_u32 m0, s39, 39936
s_add_u32 s37, s37, s38
buffer_load_dwordx4 v21, s[8:11], s37 offen sc1 lds
v_cvt_pk_bf16_f32 v114, v212, v213
v_cvt_pk_bf16_f32 v115, v214, v215
s_nop 1
v_permlane32_swap_b32 v112, v114
v_permlane32_swap_b32 v113, v115
buffer_store_dwordx4 v[100:103], v27, s[24:27], 0 offen offset:256 sc1
buffer_store_dwordx4 v[112:115], v28, s[24:27], 0 offen offset:0 sc1
s_waitcnt vmcnt(19)
s_barrier
s_add_u32 m0, s39, 65536
s_add_u32 s37, s37, s40
buffer_load_dwordx4 v21, s[8:11], s37 offen sc1 lds
v_mul_f32 v80, v136, v136
v_mul_f32 v81, v137, v137
v_mul_f32 v82, v138, v138
v_mul_f32 v83, v139, v139
v_fma_f32 v80, v80, v234, v230
v_fma_f32 v81, v81, v234, v230
v_fma_f32 v82, v82, v234, v230
s_add_u32 m0, s39, 66560
s_add_u32 s37, s37, s38
buffer_load_dwordx4 v21, s[8:11], s37 offen sc1 lds
v_fma_f32 v83, v83, v234, v230
v_mul_f32 v80, v80, v136
v_mul_f32 v81, v81, v137
v_mul_f32 v82, v82, v138
v_mul_f32 v83, v83, v139
v_exp_f32 v80, v80
s_add_u32 m0, s39, 67584
s_add_u32 s37, s37, s38
buffer_load_dwordx4 v21, s[8:11], s37 offen sc1 lds
v_exp_f32 v81, v81
v_exp_f32 v82, v82
v_exp_f32 v83, v83
v_mul_f32 v184, v136, v184
v_mul_f32 v185, v137, v185
v_mul_f32 v186, v138, v186
v_mul_f32 v187, v139, v187
s_add_u32 m0, s39, 68608
s_add_u32 s37, s37, s38
buffer_load_dwordx4 v21, s[8:11], s37 offen sc1 lds
v_fma_f32 v80, v80, v238, v238
v_fma_f32 v81, v81, v238, v238
v_fma_f32 v82, v82, v238, v238
v_fma_f32 v83, v83, v238, v238
v_rcp_f32 v80, v80
v_rcp_f32 v81, v81
s_add_u32 m0, s39, 69632
s_add_u32 s37, s37, s55
buffer_load_dwordx4 v21, s[8:11], s37 offen sc1 lds
v_rcp_f32 v82, v82
v_rcp_f32 v83, v83
v_mul_f32 v184, v184, v80
v_mul_f32 v185, v185, v81
v_mul_f32 v186, v186, v82
v_mul_f32 v187, v187, v83
v_cvt_pk_bf16_f32 v104, v184, v185
s_add_u32 m0, s39, 70656
s_add_u32 s37, s37, s38
buffer_load_dwordx4 v21, s[8:11], s37 offen sc1 lds
v_cvt_pk_bf16_f32 v105, v186, v187
v_mul_f32 v84, v152, v152
v_mul_f32 v85, v153, v153
v_mul_f32 v86, v154, v154
v_mul_f32 v87, v155, v155
v_fma_f32 v84, v84, v234, v230
s_add_u32 m0, s39, 71680
s_add_u32 s37, s37, s38
buffer_load_dwordx4 v21, s[8:11], s37 offen sc1 lds
v_fma_f32 v85, v85, v234, v230
v_fma_f32 v86, v86, v234, v230
v_fma_f32 v87, v87, v234, v230
v_mul_f32 v84, v84, v152
v_mul_f32 v85, v85, v153
v_mul_f32 v86, v86, v154
v_mul_f32 v87, v87, v155
s_add_u32 m0, s39, 72704
s_add_u32 s37, s37, s38
buffer_load_dwordx4 v21, s[8:11], s37 offen sc1 lds
v_exp_f32 v84, v84
v_exp_f32 v85, v85
v_exp_f32 v86, v86
v_exp_f32 v87, v87
v_mul_f32 v200, v152, v200
v_mul_f32 v201, v153, v201
s_waitcnt vmcnt(18)
s_barrier
s_add_u32 m0, s39, 98304
s_add_u32 s37, s37, s40
buffer_load_dwordx4 v21, s[8:11], s37 offen sc1 lds
v_mul_f32 v202, v154, v202
v_mul_f32 v203, v155, v203
v_fma_f32 v84, v84, v238, v238
v_fma_f32 v85, v85, v238, v238
v_fma_f32 v86, v86, v238, v238
v_fma_f32 v87, v87, v238, v238
v_rcp_f32 v84, v84
s_add_u32 m0, s39, 99328
s_add_u32 s37, s37, s38
buffer_load_dwordx4 v21, s[8:11], s37 offen sc1 lds
v_rcp_f32 v85, v85
v_rcp_f32 v86, v86
v_rcp_f32 v87, v87
v_mul_f32 v200, v200, v84
v_mul_f32 v201, v201, v85
v_mul_f32 v202, v202, v86
v_mul_f32 v203, v203, v87
s_add_u32 m0, s39, 100352
s_add_u32 s37, s37, s38
buffer_load_dwordx4 v21, s[8:11], s37 offen sc1 lds
v_cvt_pk_bf16_f32 v106, v200, v201
v_cvt_pk_bf16_f32 v107, v202, v203
v_mul_f32 v80, v168, v168
v_mul_f32 v81, v169, v169
v_mul_f32 v82, v170, v170
s_add_u32 m0, s39, 101376
s_add_u32 s37, s37, s38
buffer_load_dwordx4 v21, s[8:11], s37 offen sc1 lds
v_mul_f32 v83, v171, v171
v_fma_f32 v80, v80, v234, v230
v_fma_f32 v81, v81, v234, v230
v_fma_f32 v82, v82, v234, v230
v_fma_f32 v83, v83, v234, v230
v_mul_f32 v80, v80, v168
v_mul_f32 v81, v81, v169
s_add_u32 m0, s39, 102400
s_add_u32 s37, s37, s55
buffer_load_dwordx4 v21, s[8:11], s37 offen sc1 lds
v_mul_f32 v82, v82, v170
v_mul_f32 v83, v83, v171
v_exp_f32 v80, v80
v_exp_f32 v81, v81
v_exp_f32 v82, v82
v_exp_f32 v83, v83
v_mul_f32 v216, v168, v216
s_add_u32 m0, s39, 103424
s_add_u32 s37, s37, s38
buffer_load_dwordx4 v21, s[8:11], s37 offen sc1 lds
v_mul_f32 v217, v169, v217
v_mul_f32 v218, v170, v218
v_mul_f32 v219, v171, v219
v_fma_f32 v80, v80, v238, v238
v_fma_f32 v81, v81, v238, v238
v_fma_f32 v82, v82, v238, v238
s_add_u32 m0, s39, 104448
s_add_u32 s37, s37, s38
buffer_load_dwordx4 v21, s[8:11], s37 offen sc1 lds
v_fma_f32 v83, v83, v238, v238
v_rcp_f32 v80, v80
v_rcp_f32 v81, v81
v_rcp_f32 v82, v82
v_rcp_f32 v83, v83
v_mul_f32 v216, v216, v80
v_mul_f32 v217, v217, v81
s_add_u32 m0, s39, 105472
s_add_u32 s37, s37, s38
buffer_load_dwordx4 v21, s[8:11], s37 offen sc1 lds
v_mul_f32 v218, v218, v82
v_mul_f32 v219, v219, v83
v_cvt_pk_bf16_f32 v116, v216, v217
v_cvt_pk_bf16_f32 v117, v218, v219
v_mul_f32 v80, v140, v140
v_mul_f32 v81, v141, v141
buffer_store_dwordx4 v[104:107], v27, s[24:27], 0 offen offset:512 sc1
s_waitcnt vmcnt(19)
s_barrier
s_add_u32 s37, s37, s29
s_add_u32 m0, s39, 0
s_add_u32 s37, s37, s40
buffer_load_dwordx4 v21, s[8:11], s37 offen sc1 lds
v_mul_f32 v82, v142, v142
v_mul_f32 v83, v143, v143
v_fma_f32 v80, v80, v235, v231
v_fma_f32 v81, v81, v235, v231
v_fma_f32 v82, v82, v235, v231
v_fma_f32 v83, v83, v235, v231
v_mul_f32 v80, v80, v140
s_add_u32 m0, s39, 1024
s_add_u32 s37, s37, s38
buffer_load_dwordx4 v21, s[8:11], s37 offen sc1 lds
v_mul_f32 v81, v81, v141
v_mul_f32 v82, v82, v142
v_mul_f32 v83, v83, v143
v_exp_f32 v80, v80
v_exp_f32 v81, v81
v_exp_f32 v82, v82
s_add_u32 m0, s39, 2048
s_add_u32 s37, s37, s38
buffer_load_dwordx4 v21, s[8:11], s37 offen sc1 lds
v_exp_f32 v83, v83
v_mul_f32 v188, v140, v188
v_mul_f32 v189, v141, v189
v_mul_f32 v190, v142, v190
v_mul_f32 v191, v143, v191
v_fma_f32 v80, v80, v239, v239
v_fma_f32 v81, v81, v239, v239
s_add_u32 m0, s39, 3072
s_add_u32 s37, s37, s38
buffer_load_dwordx4 v21, s[8:11], s37 offen sc1 lds
v_fma_f32 v82, v82, v239, v239
v_fma_f32 v83, v83, v239, v239
v_rcp_f32 v80, v80
v_rcp_f32 v81, v81
v_rcp_f32 v82, v82
v_rcp_f32 v83, v83
s_add_u32 m0, s39, 4096
s_add_u32 s37, s37, s55
buffer_load_dwordx4 v21, s[8:11], s37 offen sc1 lds
v_mul_f32 v188, v188, v80
v_mul_f32 v189, v189, v81
v_mul_f32 v190, v190, v82
v_mul_f32 v191, v191, v83
v_cvt_pk_bf16_f32 v108, v188, v189
v_cvt_pk_bf16_f32 v109, v190, v191
v_mul_f32 v84, v156, v156
s_add_u32 m0, s39, 5120
s_add_u32 s37, s37, s38
buffer_load_dwordx4 v21, s[8:11], s37 offen sc1 lds
v_mul_f32 v85, v157, v157
v_mul_f32 v86, v158, v158
v_mul_f32 v87, v159, v159
v_fma_f32 v84, v84, v235, v231
v_fma_f32 v85, v85, v235, v231
v_fma_f32 v86, v86, v235, v231
s_add_u32 m0, s39, 6144
s_add_u32 s37, s37, s38
buffer_load_dwordx4 v21, s[8:11], s37 offen sc1 lds
v_fma_f32 v87, v87, v235, v231
v_mul_f32 v84, v84, v156
v_mul_f32 v85, v85, v157
v_mul_f32 v86, v86, v158
v_mul_f32 v87, v87, v159
v_exp_f32 v84, v84
v_exp_f32 v85, v85
s_add_u32 m0, s39, 7168
s_add_u32 s37, s37, s38
buffer_load_dwordx4 v21, s[8:11], s37 offen sc1 lds
v_exp_f32 v86, v86
v_exp_f32 v87, v87
v_mul_f32 v204, v156, v204
v_mul_f32 v205, v157, v205
v_mul_f32 v206, v158, v206
v_mul_f32 v207, v159, v207
s_waitcnt vmcnt(17)
s_barrier
s_add_u32 m0, s39, 32768
s_add_u32 s37, s37, s40
buffer_load_dwordx4 v21, s[8:11], s37 offen sc1 lds
v_fma_f32 v84, v84, v239, v239
v_fma_f32 v85, v85, v239, v239
v_fma_f32 v86, v86, v239, v239
v_fma_f32 v87, v87, v239, v239
v_rcp_f32 v84, v84
v_rcp_f32 v85, v85
v_rcp_f32 v86, v86
s_add_u32 m0, s39, 33792
s_add_u32 s37, s37, s38
buffer_load_dwordx4 v21, s[8:11], s37 offen sc1 lds
v_rcp_f32 v87, v87
v_mul_f32 v204, v204, v84
v_mul_f32 v205, v205, v85
v_mul_f32 v206, v206, v86
v_mul_f32 v207, v207, v87
v_cvt_pk_bf16_f32 v110, v204, v205
v_cvt_pk_bf16_f32 v111, v206, v207
s_add_u32 m0, s39, 34816
s_add_u32 s37, s37, s38
buffer_load_dwordx4 v21, s[8:11], s37 offen sc1 lds
v_mul_f32 v80, v172, v172
v_mul_f32 v81, v173, v173
v_mul_f32 v82, v174, v174
v_mul_f32 v83, v175, v175
v_fma_f32 v80, v80, v235, v231
s_add_u32 m0, s39, 35840
s_add_u32 s37, s37, s38
buffer_load_dwordx4 v21, s[8:11], s37 offen sc1 lds
v_fma_f32 v81, v81, v235, v231
v_fma_f32 v82, v82, v235, v231
v_fma_f32 v83, v83, v235, v231
v_mul_f32 v80, v80, v172
v_mul_f32 v81, v81, v173
v_mul_f32 v82, v82, v174
v_mul_f32 v83, v83, v175
s_add_u32 m0, s39, 36864
s_add_u32 s37, s37, s55
buffer_load_dwordx4 v21, s[8:11], s37 offen sc1 lds
v_exp_f32 v80, v80
v_exp_f32 v81, v81
v_exp_f32 v82, v82
v_exp_f32 v83, v83
v_mul_f32 v220, v172, v220
v_mul_f32 v221, v173, v221
v_mul_f32 v222, v174, v222
s_add_u32 m0, s39, 37888
s_add_u32 s37, s37, s38
buffer_load_dwordx4 v21, s[8:11], s37 offen sc1 lds
v_mul_f32 v223, v175, v223
v_fma_f32 v80, v80, v239, v239
v_fma_f32 v81, v81, v239, v239
v_fma_f32 v82, v82, v239, v239
v_fma_f32 v83, v83, v239, v239
v_rcp_f32 v80, v80
s_add_u32 m0, s39, 38912
s_add_u32 s37, s37, s38
buffer_load_dwordx4 v21, s[8:11], s37 offen sc1 lds
v_rcp_f32 v81, v81
v_rcp_f32 v82, v82
v_rcp_f32 v83, v83
v_mul_f32 v220, v220, v80
v_mul_f32 v221, v221, v81
v_mul_f32 v222, v222, v82
v_mul_f32 v223, v223, v83
s_add_u32 m0, s39, 39936
s_add_u32 s37, s37, s38
buffer_load_dwordx4 v21, s[8:11], s37 offen sc1 lds
v_cvt_pk_bf16_f32 v118, v220, v221
v_cvt_pk_bf16_f32 v119, v222, v223
s_nop 1
v_permlane32_swap_b32 v116, v118
v_permlane32_swap_b32 v117, v119
buffer_store_dwordx4 v[108:111], v27, s[24:27], 0 offen offset:768 sc1
buffer_store_dwordx4 v[116:119], v28, s[24:27], 0 offen offset:512 sc1
s_waitcnt vmcnt(19)
s_barrier
s_add_u32 m0, s39, 65536
s_add_u32 s37, s37, s40
buffer_load_dwordx4 v21, s[8:11], s37 offen sc1 lds
s_add_u32 m0, s39, 66560
s_add_u32 s37, s37, s38
buffer_load_dwordx4 v21, s[8:11], s37 offen sc1 lds
s_add_u32 m0, s39, 67584
s_add_u32 s37, s37, s38
buffer_load_dwordx4 v21, s[8:11], s37 offen sc1 lds
s_add_u32 m0, s39, 68608
s_add_u32 s37, s37, s38
buffer_load_dwordx4 v21, s[8:11], s37 offen sc1 lds
s_add_u32 m0, s39, 69632
s_add_u32 s37, s37, s55
buffer_load_dwordx4 v21, s[8:11], s37 offen sc1 lds
s_add_u32 m0, s39, 70656
s_add_u32 s37, s37, s38
buffer_load_dwordx4 v21, s[8:11], s37 offen sc1 lds
s_add_u32 m0, s39, 71680
s_add_u32 s37, s37, s38
buffer_load_dwordx4 v21, s[8:11], s37 offen sc1 lds
s_add_u32 m0, s39, 72704
s_add_u32 s37, s37, s38
buffer_load_dwordx4 v21, s[8:11], s37 offen sc1 lds
s_waitcnt vmcnt(8)
s_barrier
s_add_u32 m0, s39, 98304
s_add_u32 s37, s37, s40
buffer_load_dwordx4 v21, s[8:11], s37 offen sc1 lds
s_add_u32 m0, s39, 99328
s_add_u32 s37, s37, s38
buffer_load_dwordx4 v21, s[8:11], s37 offen sc1 lds
s_add_u32 m0, s39, 100352
s_add_u32 s37, s37, s38
buffer_load_dwordx4 v21, s[8:11], s37 offen sc1 lds
s_add_u32 m0, s39, 101376
s_add_u32 s37, s37, s38
buffer_load_dwordx4 v21, s[8:11], s37 offen sc1 lds
s_add_u32 m0, s39, 102400
s_add_u32 s37, s37, s55
buffer_load_dwordx4 v21, s[8:11], s37 offen sc1 lds
s_add_u32 m0, s39, 103424
s_add_u32 s37, s37, s38
buffer_load_dwordx4 v21, s[8:11], s37 offen sc1 lds
s_add_u32 m0, s39, 104448
s_add_u32 s37, s37, s38
buffer_load_dwordx4 v21, s[8:11], s37 offen sc1 lds
s_add_u32 m0, s39, 105472
s_add_u32 s37, s37, s38
buffer_load_dwordx4 v21, s[8:11], s37 offen sc1 lds
s_waitcnt vmcnt(18)
s_barrier
s_add_u32 m0, s39, 0
s_add_u32 s37, s37, s40
buffer_load_dwordx4 v21, s[8:11], s37 offen sc1 lds
s_add_u32 m0, s39, 1024
s_add_u32 s37, s37, s38
buffer_load_dwordx4 v21, s[8:11], s37 offen sc1 lds
s_add_u32 m0, s39, 2048
s_add_u32 s37, s37, s38
buffer_load_dwordx4 v21, s[8:11], s37 offen sc1 lds
s_add_u32 m0, s39, 3072
s_add_u32 s37, s37, s38
buffer_load_dwordx4 v21, s[8:11], s37 offen sc1 lds
s_add_u32 m0, s39, 4096
s_add_u32 s37, s37, s55
buffer_load_dwordx4 v21, s[8:11], s37 offen sc1 lds
s_add_u32 m0, s39, 5120
s_add_u32 s37, s37, s38
buffer_load_dwordx4 v21, s[8:11], s37 offen sc1 lds
s_add_u32 m0, s39, 6144
s_add_u32 s37, s37, s38
buffer_load_dwordx4 v21, s[8:11], s37 offen sc1 lds
s_add_u32 m0, s39, 7168
s_add_u32 s37, s37, s38
buffer_load_dwordx4 v21, s[8:11], s37 offen sc1 lds
s_waitcnt vmcnt(16)
s_barrier
s_add_u32 m0, s39, 32768
s_add_u32 s37, s37, s40
buffer_load_dwordx4 v21, s[8:11], s37 offen sc1 lds
s_add_u32 m0, s39, 33792
s_add_u32 s37, s37, s38
buffer_load_dwordx4 v21, s[8:11], s37 offen sc1 lds
s_add_u32 m0, s39, 34816
s_add_u32 s37, s37, s38
buffer_load_dwordx4 v21, s[8:11], s37 offen sc1 lds
s_add_u32 m0, s39, 35840
s_add_u32 s37, s37, s38
buffer_load_dwordx4 v21, s[8:11], s37 offen sc1 lds
s_add_u32 m0, s39, 36864
s_add_u32 s37, s37, s55
buffer_load_dwordx4 v21, s[8:11], s37 offen sc1 lds
s_add_u32 m0, s39, 37888
s_add_u32 s37, s37, s38
buffer_load_dwordx4 v21, s[8:11], s37 offen sc1 lds
s_add_u32 m0, s39, 38912
s_add_u32 s37, s37, s38
buffer_load_dwordx4 v21, s[8:11], s37 offen sc1 lds
s_add_u32 m0, s39, 39936
s_add_u32 s37, s37, s38
buffer_load_dwordx4 v21, s[8:11], s37 offen sc1 lds
s_waitcnt vmcnt(16)
s_barrier
s_add_u32 m0, s39, 65536
s_add_u32 s37, s37, s40
buffer_load_dwordx4 v21, s[8:11], s37 offen sc1 lds
s_add_u32 m0, s39, 66560
s_add_u32 s37, s37, s38
buffer_load_dwordx4 v21, s[8:11], s37 offen sc1 lds
s_add_u32 m0, s39, 67584
s_add_u32 s37, s37, s38
buffer_load_dwordx4 v21, s[8:11], s37 offen sc1 lds
s_add_u32 m0, s39, 68608
s_add_u32 s37, s37, s38
buffer_load_dwordx4 v21, s[8:11], s37 offen sc1 lds
s_add_u32 m0, s39, 69632
s_add_u32 s37, s37, s55
buffer_load_dwordx4 v21, s[8:11], s37 offen sc1 lds
s_add_u32 m0, s39, 70656
s_add_u32 s37, s37, s38
buffer_load_dwordx4 v21, s[8:11], s37 offen sc1 lds
s_add_u32 m0, s39, 71680
s_add_u32 s37, s37, s38
buffer_load_dwordx4 v21, s[8:11], s37 offen sc1 lds
s_add_u32 m0, s39, 72704
s_add_u32 s37, s37, s38
buffer_load_dwordx4 v21, s[8:11], s37 offen sc1 lds
s_waitcnt vmcnt(16)
s_barrier
s_add_u32 m0, s39, 98304
s_add_u32 s37, s37, s40
buffer_load_dwordx4 v21, s[8:11], s37 offen sc1 lds
s_add_u32 m0, s39, 99328
s_add_u32 s37, s37, s38
buffer_load_dwordx4 v21, s[8:11], s37 offen sc1 lds
s_add_u32 m0, s39, 100352
s_add_u32 s37, s37, s38
buffer_load_dwordx4 v21, s[8:11], s37 offen sc1 lds
s_add_u32 m0, s39, 101376
s_add_u32 s37, s37, s38
buffer_load_dwordx4 v21, s[8:11], s37 offen sc1 lds
s_add_u32 m0, s39, 102400
s_add_u32 s37, s37, s55
buffer_load_dwordx4 v21, s[8:11], s37 offen sc1 lds
s_add_u32 m0, s39, 103424
s_add_u32 s37, s37, s38
buffer_load_dwordx4 v21, s[8:11], s37 offen sc1 lds
s_add_u32 m0, s39, 104448
s_add_u32 s37, s37, s38
buffer_load_dwordx4 v21, s[8:11], s37 offen sc1 lds
s_add_u32 m0, s39, 105472
s_add_u32 s37, s37, s38
buffer_load_dwordx4 v21, s[8:11], s37 offen sc1 lds
s_waitcnt vmcnt(16)
s_barrier
s_cmp_eq_u32 s51, 2
s_cbranch_scc1 LW4_159
s_mul_i32 s40, s53, 98304
s_add_u32 m0, s39, 0
s_add_u32 s37, s40, 524288
buffer_load_dwordx4 v21, s[8:11], s37 offen sc1 lds
s_add_u32 m0, s39, 1024
s_add_u32 s37, s40, 525312
buffer_load_dwordx4 v21, s[8:11], s37 offen sc1 lds
s_add_u32 m0, s39, 2048
s_add_u32 s37, s40, 526336
buffer_load_dwordx4 v21, s[8:11], s37 offen sc1 lds
s_add_u32 m0, s39, 3072
s_add_u32 s37, s40, 527360
buffer_load_dwordx4 v21, s[8:11], s37 offen sc1 lds
s_add_u32 m0, s39, 4096
s_add_u32 s37, s40, 528384
buffer_load_dwordx4 v21, s[8:11], s37 offen sc1 lds
s_add_u32 m0, s39, 5120
s_add_u32 s37, s40, 529408
buffer_load_dwordx4 v21, s[8:11], s37 offen sc1 lds
s_add_u32 m0, s39, 6144
s_add_u32 s37, s40, 530432
buffer_load_dwordx4 v21, s[8:11], s37 offen sc1 lds
s_add_u32 m0, s39, 7168
s_add_u32 s37, s40, 531456
buffer_load_dwordx4 v21, s[8:11], s37 offen sc1 lds
s_waitcnt vmcnt(16)
s_barrier
s_add_u32 m0, s39, 32768
s_add_u32 s37, s40, 540672
buffer_load_dwordx4 v21, s[8:11], s37 offen sc1 lds
s_add_u32 m0, s39, 33792
s_add_u32 s37, s40, 541696
buffer_load_dwordx4 v21, s[8:11], s37 offen sc1 lds
s_add_u32 m0, s39, 34816
s_add_u32 s37, s40, 542720
buffer_load_dwordx4 v21, s[8:11], s37 offen sc1 lds
s_add_u32 m0, s39, 35840
s_add_u32 s37, s40, 543744
buffer_load_dwordx4 v21, s[8:11], s37 offen sc1 lds
s_add_u32 m0, s39, 36864
s_add_u32 s37, s40, 544768
buffer_load_dwordx4 v21, s[8:11], s37 offen sc1 lds
s_add_u32 m0, s39, 37888
s_add_u32 s37, s40, 545792
buffer_load_dwordx4 v21, s[8:11], s37 offen sc1 lds
s_add_u32 m0, s39, 38912
s_add_u32 s37, s40, 546816
buffer_load_dwordx4 v21, s[8:11], s37 offen sc1 lds
s_add_u32 m0, s39, 39936
s_add_u32 s37, s40, 547840
buffer_load_dwordx4 v21, s[8:11], s37 offen sc1 lds
s_waitcnt vmcnt(16)
s_barrier
s_add_u32 m0, s39, 65536
s_add_u32 s37, s40, 557056
buffer_load_dwordx4 v21, s[8:11], s37 offen sc1 lds
s_add_u32 m0, s39, 66560
s_add_u32 s37, s40, 558080
buffer_load_dwordx4 v21, s[8:11], s37 offen sc1 lds
s_add_u32 m0, s39, 67584
s_add_u32 s37, s40, 559104
buffer_load_dwordx4 v21, s[8:11], s37 offen sc1 lds
s_add_u32 m0, s39, 68608
s_add_u32 s37, s40, 560128
buffer_load_dwordx4 v21, s[8:11], s37 offen sc1 lds
s_add_u32 m0, s39, 69632
s_add_u32 s37, s40, 561152
buffer_load_dwordx4 v21, s[8:11], s37 offen sc1 lds
s_add_u32 m0, s39, 70656
s_add_u32 s37, s40, 562176
buffer_load_dwordx4 v21, s[8:11], s37 offen sc1 lds
s_add_u32 m0, s39, 71680
s_add_u32 s37, s40, 563200
buffer_load_dwordx4 v21, s[8:11], s37 offen sc1 lds
s_add_u32 m0, s39, 72704
s_add_u32 s37, s40, 564224
buffer_load_dwordx4 v21, s[8:11], s37 offen sc1 lds
s_waitcnt vmcnt(16)
s_barrier
s_add_u32 m0, s39, 98304
s_add_u32 s37, s40, 573440
buffer_load_dwordx4 v21, s[8:11], s37 offen sc1 lds
s_add_u32 m0, s39, 99328
s_add_u32 s37, s40, 574464
buffer_load_dwordx4 v21, s[8:11], s37 offen sc1 lds
s_add_u32 m0, s39, 100352
s_add_u32 s37, s40, 575488
buffer_load_dwordx4 v21, s[8:11], s37 offen sc1 lds
s_add_u32 m0, s39, 101376
s_add_u32 s37, s40, 576512
buffer_load_dwordx4 v21, s[8:11], s37 offen sc1 lds
s_add_u32 m0, s39, 102400
s_add_u32 s37, s40, 577536
buffer_load_dwordx4 v21, s[8:11], s37 offen sc1 lds
s_add_u32 m0, s39, 103424
s_add_u32 s37, s40, 578560
buffer_load_dwordx4 v21, s[8:11], s37 offen sc1 lds
s_add_u32 m0, s39, 104448
s_add_u32 s37, s40, 579584
buffer_load_dwordx4 v21, s[8:11], s37 offen sc1 lds
s_add_u32 m0, s39, 105472
s_add_u32 s37, s40, 580608
buffer_load_dwordx4 v21, s[8:11], s37 offen sc1 lds
s_waitcnt vmcnt(16)
s_barrier
s_add_u32 m0, s39, 0
s_add_u32 s37, s40, 589824
buffer_load_dwordx4 v21, s[8:11], s37 offen sc1 lds
s_add_u32 m0, s39, 1024
s_add_u32 s37, s40, 590848
buffer_load_dwordx4 v21, s[8:11], s37 offen sc1 lds
s_add_u32 m0, s39, 2048
s_add_u32 s37, s40, 591872
buffer_load_dwordx4 v21, s[8:11], s37 offen sc1 lds
s_add_u32 m0, s39, 3072
s_add_u32 s37, s40, 592896
buffer_load_dwordx4 v21, s[8:11], s37 offen sc1 lds
s_add_u32 m0, s39, 4096
s_add_u32 s37, s40, 593920
buffer_load_dwordx4 v21, s[8:11], s37 offen sc1 lds
s_add_u32 m0, s39, 5120
s_add_u32 s37, s40, 594944
buffer_load_dwordx4 v21, s[8:11], s37 offen sc1 lds
s_add_u32 m0, s39, 6144
s_add_u32 s37, s40, 595968
buffer_load_dwordx4 v21, s[8:11], s37 offen sc1 lds
s_add_u32 m0, s39, 7168
s_add_u32 s37, s40, 596992
buffer_load_dwordx4 v21, s[8:11], s37 offen sc1 lds
s_waitcnt vmcnt(16)
s_barrier
s_add_u32 m0, s39, 32768
s_add_u32 s37, s40, 606208
buffer_load_dwordx4 v21, s[8:11], s37 offen sc1 lds
s_add_u32 m0, s39, 33792
s_add_u32 s37, s40, 607232
buffer_load_dwordx4 v21, s[8:11], s37 offen sc1 lds
s_add_u32 m0, s39, 34816
s_add_u32 s37, s40, 608256
buffer_load_dwordx4 v21, s[8:11], s37 offen sc1 lds
s_add_u32 m0, s39, 35840
s_add_u32 s37, s40, 609280
buffer_load_dwordx4 v21, s[8:11], s37 offen sc1 lds
s_add_u32 m0, s39, 36864
s_add_u32 s37, s40, 610304
buffer_load_dwordx4 v21, s[8:11], s37 offen sc1 lds
s_add_u32 m0, s39, 37888
s_add_u32 s37, s40, 611328
buffer_load_dwordx4 v21, s[8:11], s37 offen sc1 lds
s_add_u32 m0, s39, 38912
s_add_u32 s37, s40, 612352
buffer_load_dwordx4 v21, s[8:11], s37 offen sc1 lds
s_add_u32 m0, s39, 39936
s_add_u32 s37, s40, 613376
buffer_load_dwordx4 v21, s[8:11], s37 offen sc1 lds
s_waitcnt vmcnt(16)
s_barrier
s_add_u32 m0, s39, 65536
s_mov_b32 s37, 720896
buffer_load_dwordx4 v21, s[8:11], s37 offen sc1 lds
s_add_u32 m0, s39, 66560
s_mov_b32 s37, 721920
buffer_load_dwordx4 v21, s[8:11], s37 offen sc1 lds
s_add_u32 m0, s39, 67584
s_mov_b32 s37, 722944
buffer_load_dwordx4 v21, s[8:11], s37 offen sc1 lds
s_add_u32 m0, s39, 68608
s_mov_b32 s37, 723968
buffer_load_dwordx4 v21, s[8:11], s37 offen sc1 lds
s_add_u32 m0, s39, 69632
s_mov_b32 s37, 724992
buffer_load_dwordx4 v21, s[8:11], s37 offen sc1 lds
s_add_u32 m0, s39, 70656
s_mov_b32 s37, 726016
buffer_load_dwordx4 v21, s[8:11], s37 offen sc1 lds
s_add_u32 m0, s39, 71680
s_mov_b32 s37, 727040
buffer_load_dwordx4 v21, s[8:11], s37 offen sc1 lds
s_add_u32 m0, s39, 72704
s_mov_b32 s37, 728064
buffer_load_dwordx4 v21, s[8:11], s37 offen sc1 lds
s_waitcnt vmcnt(16)
s_barrier
s_add_u32 m0, s39, 98304
s_mov_b32 s37, 737280
buffer_load_dwordx4 v21, s[8:11], s37 offen sc1 lds
s_add_u32 m0, s39, 99328
s_mov_b32 s37, 738304
buffer_load_dwordx4 v21, s[8:11], s37 offen sc1 lds
s_add_u32 m0, s39, 100352
s_mov_b32 s37, 739328
buffer_load_dwordx4 v21, s[8:11], s37 offen sc1 lds
s_add_u32 m0, s39, 101376
s_mov_b32 s37, 740352
buffer_load_dwordx4 v21, s[8:11], s37 offen sc1 lds
s_add_u32 m0, s39, 102400
s_mov_b32 s37, 741376
buffer_load_dwordx4 v21, s[8:11], s37 offen sc1 lds
s_add_u32 m0, s39, 103424
s_mov_b32 s37, 742400
buffer_load_dwordx4 v21, s[8:11], s37 offen sc1 lds
s_add_u32 m0, s39, 104448
s_mov_b32 s37, 743424
buffer_load_dwordx4 v21, s[8:11], s37 offen sc1 lds
s_add_u32 m0, s39, 105472
s_mov_b32 s37, 744448
buffer_load_dwordx4 v21, s[8:11], s37 offen sc1 lds
s_waitcnt vmcnt(16)
s_barrier
s_add_u32 m0, s39, 0
s_mov_b32 s37, 753664
buffer_load_dwordx4 v21, s[8:11], s37 offen sc1 lds
s_add_u32 m0, s39, 1024
s_mov_b32 s37, 754688
buffer_load_dwordx4 v21, s[8:11], s37 offen sc1 lds
s_add_u32 m0, s39, 2048
s_mov_b32 s37, 755712
buffer_load_dwordx4 v21, s[8:11], s37 offen sc1 lds
s_add_u32 m0, s39, 3072
s_mov_b32 s37, 756736
buffer_load_dwordx4 v21, s[8:11], s37 offen sc1 lds
s_add_u32 m0, s39, 4096
s_mov_b32 s37, 757760
buffer_load_dwordx4 v21, s[8:11], s37 offen sc1 lds
s_add_u32 m0, s39, 5120
s_mov_b32 s37, 758784
buffer_load_dwordx4 v21, s[8:11], s37 offen sc1 lds
s_add_u32 m0, s39, 6144
s_mov_b32 s37, 759808
buffer_load_dwordx4 v21, s[8:11], s37 offen sc1 lds
s_add_u32 m0, s39, 7168
s_mov_b32 s37, 760832
buffer_load_dwordx4 v21, s[8:11], s37 offen sc1 lds
s_waitcnt vmcnt(16)
s_barrier
s_add_u32 m0, s39, 32768
s_mov_b32 s37, 770048
buffer_load_dwordx4 v21, s[8:11], s37 offen sc1 lds
s_add_u32 m0, s39, 33792
s_mov_b32 s37, 771072
buffer_load_dwordx4 v21, s[8:11], s37 offen sc1 lds
s_add_u32 m0, s39, 34816
s_mov_b32 s37, 772096
buffer_load_dwordx4 v21, s[8:11], s37 offen sc1 lds
s_add_u32 m0, s39, 35840
s_mov_b32 s37, 773120
buffer_load_dwordx4 v21, s[8:11], s37 offen sc1 lds
s_add_u32 m0, s39, 36864
s_mov_b32 s37, 774144
buffer_load_dwordx4 v21, s[8:11], s37 offen sc1 lds
s_add_u32 m0, s39, 37888
s_mov_b32 s37, 775168
buffer_load_dwordx4 v21, s[8:11], s37 offen sc1 lds
s_add_u32 m0, s39, 38912
s_mov_b32 s37, 776192
buffer_load_dwordx4 v21, s[8:11], s37 offen sc1 lds
s_add_u32 m0, s39, 39936
s_mov_b32 s37, 777216
buffer_load_dwordx4 v21, s[8:11], s37 offen sc1 lds
s_waitcnt vmcnt(16)
s_barrier
s_add_u32 m0, s39, 65536
s_mov_b32 s37, 786432
buffer_load_dwordx4 v21, s[8:11], s37 offen sc1 lds
s_add_u32 m0, s39, 66560
s_mov_b32 s37, 787456
buffer_load_dwordx4 v21, s[8:11], s37 offen sc1 lds
s_add_u32 m0, s39, 67584
s_mov_b32 s37, 788480
buffer_load_dwordx4 v21, s[8:11], s37 offen sc1 lds
s_add_u32 m0, s39, 68608
s_mov_b32 s37, 789504
buffer_load_dwordx4 v21, s[8:11], s37 offen sc1 lds
s_add_u32 m0, s39, 69632
s_mov_b32 s37, 790528
buffer_load_dwordx4 v21, s[8:11], s37 offen sc1 lds
s_add_u32 m0, s39, 70656
s_mov_b32 s37, 791552
buffer_load_dwordx4 v21, s[8:11], s37 offen sc1 lds
s_add_u32 m0, s39, 71680
s_mov_b32 s37, 792576
buffer_load_dwordx4 v21, s[8:11], s37 offen sc1 lds
s_add_u32 m0, s39, 72704
s_mov_b32 s37, 793600
buffer_load_dwordx4 v21, s[8:11], s37 offen sc1 lds
s_waitcnt vmcnt(16)
s_barrier
s_add_u32 m0, s39, 98304
s_mov_b32 s37, 802816
buffer_load_dwordx4 v21, s[8:11], s37 offen sc1 lds
s_add_u32 m0, s39, 99328
s_mov_b32 s37, 803840
buffer_load_dwordx4 v21, s[8:11], s37 offen sc1 lds
s_add_u32 m0, s39, 100352
s_mov_b32 s37, 804864
buffer_load_dwordx4 v21, s[8:11], s37 offen sc1 lds
s_add_u32 m0, s39, 101376
s_mov_b32 s37, 805888
buffer_load_dwordx4 v21, s[8:11], s37 offen sc1 lds
s_add_u32 m0, s39, 102400
s_mov_b32 s37, 806912
buffer_load_dwordx4 v21, s[8:11], s37 offen sc1 lds
s_add_u32 m0, s39, 103424
s_mov_b32 s37, 807936
buffer_load_dwordx4 v21, s[8:11], s37 offen sc1 lds
s_add_u32 m0, s39, 104448
s_mov_b32 s37, 808960
buffer_load_dwordx4 v21, s[8:11], s37 offen sc1 lds
s_add_u32 m0, s39, 105472
s_mov_b32 s37, 809984
buffer_load_dwordx4 v21, s[8:11], s37 offen sc1 lds
s_waitcnt vmcnt(16)
s_barrier
s_add_u32 m0, s39, 0
s_mov_b32 s37, 819200
buffer_load_dwordx4 v21, s[8:11], s37 offen sc1 lds
s_add_u32 m0, s39, 1024
s_mov_b32 s37, 820224
buffer_load_dwordx4 v21, s[8:11], s37 offen sc1 lds
s_add_u32 m0, s39, 2048
s_mov_b32 s37, 821248
buffer_load_dwordx4 v21, s[8:11], s37 offen sc1 lds
s_add_u32 m0, s39, 3072
s_mov_b32 s37, 822272
buffer_load_dwordx4 v21, s[8:11], s37 offen sc1 lds
s_add_u32 m0, s39, 4096
s_mov_b32 s37, 823296
buffer_load_dwordx4 v21, s[8:11], s37 offen sc1 lds
s_add_u32 m0, s39, 5120
s_mov_b32 s37, 824320
buffer_load_dwordx4 v21, s[8:11], s37 offen sc1 lds
s_add_u32 m0, s39, 6144
s_mov_b32 s37, 825344
buffer_load_dwordx4 v21, s[8:11], s37 offen sc1 lds
s_add_u32 m0, s39, 7168
s_mov_b32 s37, 826368
buffer_load_dwordx4 v21, s[8:11], s37 offen sc1 lds
s_waitcnt vmcnt(16)
s_barrier
s_add_u32 m0, s39, 32768
s_mov_b32 s37, 835584
buffer_load_dwordx4 v21, s[8:11], s37 offen sc1 lds
s_add_u32 m0, s39, 33792
s_mov_b32 s37, 836608
buffer_load_dwordx4 v21, s[8:11], s37 offen sc1 lds
s_add_u32 m0, s39, 34816
s_mov_b32 s37, 837632
buffer_load_dwordx4 v21, s[8:11], s37 offen sc1 lds
s_add_u32 m0, s39, 35840
s_mov_b32 s37, 838656
buffer_load_dwordx4 v21, s[8:11], s37 offen sc1 lds
s_add_u32 m0, s39, 36864
s_mov_b32 s37, 839680
buffer_load_dwordx4 v21, s[8:11], s37 offen sc1 lds
s_add_u32 m0, s39, 37888
s_mov_b32 s37, 840704
buffer_load_dwordx4 v21, s[8:11], s37 offen sc1 lds
s_add_u32 m0, s39, 38912
s_mov_b32 s37, 841728
buffer_load_dwordx4 v21, s[8:11], s37 offen sc1 lds
s_add_u32 m0, s39, 39936
s_mov_b32 s37, 842752
buffer_load_dwordx4 v21, s[8:11], s37 offen sc1 lds
s_waitcnt vmcnt(16)
s_barrier
s_add_u32 m0, s39, 65536
s_mov_b32 s37, 851968
buffer_load_dwordx4 v21, s[8:11], s37 offen sc1 lds
s_add_u32 m0, s39, 66560
s_mov_b32 s37, 852992
buffer_load_dwordx4 v21, s[8:11], s37 offen sc1 lds
s_add_u32 m0, s39, 67584
s_mov_b32 s37, 854016
buffer_load_dwordx4 v21, s[8:11], s37 offen sc1 lds
s_add_u32 m0, s39, 68608
s_mov_b32 s37, 855040
buffer_load_dwordx4 v21, s[8:11], s37 offen sc1 lds
s_add_u32 m0, s39, 69632
s_mov_b32 s37, 856064
buffer_load_dwordx4 v21, s[8:11], s37 offen sc1 lds
s_add_u32 m0, s39, 70656
s_mov_b32 s37, 857088
buffer_load_dwordx4 v21, s[8:11], s37 offen sc1 lds
s_add_u32 m0, s39, 71680
s_mov_b32 s37, 858112
buffer_load_dwordx4 v21, s[8:11], s37 offen sc1 lds
s_add_u32 m0, s39, 72704
s_mov_b32 s37, 859136
buffer_load_dwordx4 v21, s[8:11], s37 offen sc1 lds
s_waitcnt vmcnt(16)
s_barrier
s_add_u32 m0, s39, 98304
s_mov_b32 s37, 868352
buffer_load_dwordx4 v21, s[8:11], s37 offen sc1 lds
s_add_u32 m0, s39, 99328
s_mov_b32 s37, 869376
buffer_load_dwordx4 v21, s[8:11], s37 offen sc1 lds
s_add_u32 m0, s39, 100352
s_mov_b32 s37, 870400
buffer_load_dwordx4 v21, s[8:11], s37 offen sc1 lds
s_add_u32 m0, s39, 101376
s_mov_b32 s37, 871424
buffer_load_dwordx4 v21, s[8:11], s37 offen sc1 lds
s_add_u32 m0, s39, 102400
s_mov_b32 s37, 872448
buffer_load_dwordx4 v21, s[8:11], s37 offen sc1 lds
s_add_u32 m0, s39, 103424
s_mov_b32 s37, 873472
buffer_load_dwordx4 v21, s[8:11], s37 offen sc1 lds
s_add_u32 m0, s39, 104448
s_mov_b32 s37, 874496
buffer_load_dwordx4 v21, s[8:11], s37 offen sc1 lds
s_add_u32 m0, s39, 105472
s_mov_b32 s37, 875520
buffer_load_dwordx4 v21, s[8:11], s37 offen sc1 lds
s_waitcnt vmcnt(16)
s_barrier
s_add_u32 m0, s39, 0
s_mov_b32 s37, 884736
buffer_load_dwordx4 v21, s[8:11], s37 offen sc1 lds
s_add_u32 m0, s39, 1024
s_mov_b32 s37, 885760
buffer_load_dwordx4 v21, s[8:11], s37 offen sc1 lds
s_add_u32 m0, s39, 2048
s_mov_b32 s37, 886784
buffer_load_dwordx4 v21, s[8:11], s37 offen sc1 lds
s_add_u32 m0, s39, 3072
s_mov_b32 s37, 887808
buffer_load_dwordx4 v21, s[8:11], s37 offen sc1 lds
s_add_u32 m0, s39, 4096
s_mov_b32 s37, 888832
buffer_load_dwordx4 v21, s[8:11], s37 offen sc1 lds
s_add_u32 m0, s39, 5120
s_mov_b32 s37, 889856
buffer_load_dwordx4 v21, s[8:11], s37 offen sc1 lds
s_add_u32 m0, s39, 6144
s_mov_b32 s37, 890880
buffer_load_dwordx4 v21, s[8:11], s37 offen sc1 lds
s_add_u32 m0, s39, 7168
s_mov_b32 s37, 891904
buffer_load_dwordx4 v21, s[8:11], s37 offen sc1 lds
s_waitcnt vmcnt(16)
s_barrier
s_add_u32 m0, s39, 32768
s_mov_b32 s37, 901120
buffer_load_dwordx4 v21, s[8:11], s37 offen sc1 lds
s_add_u32 m0, s39, 33792
s_mov_b32 s37, 902144
buffer_load_dwordx4 v21, s[8:11], s37 offen sc1 lds
s_add_u32 m0, s39, 34816
s_mov_b32 s37, 903168
buffer_load_dwordx4 v21, s[8:11], s37 offen sc1 lds
s_add_u32 m0, s39, 35840
s_mov_b32 s37, 904192
buffer_load_dwordx4 v21, s[8:11], s37 offen sc1 lds
s_add_u32 m0, s39, 36864
s_mov_b32 s37, 905216
buffer_load_dwordx4 v21, s[8:11], s37 offen sc1 lds
s_add_u32 m0, s39, 37888
s_mov_b32 s37, 906240
buffer_load_dwordx4 v21, s[8:11], s37 offen sc1 lds
s_add_u32 m0, s39, 38912
s_mov_b32 s37, 907264
buffer_load_dwordx4 v21, s[8:11], s37 offen sc1 lds
s_add_u32 m0, s39, 39936
s_mov_b32 s37, 908288
buffer_load_dwordx4 v21, s[8:11], s37 offen sc1 lds
s_waitcnt vmcnt(16)
s_barrier
s_waitcnt vmcnt(8)
s_barrier
s_waitcnt vmcnt(0)
s_barrier
s_branch Ldone_1
.p2align 6
Lw_163:
s_branch Lr_164
s_nop 0
.p2align 3
LW4_159:
s_mul_i32 s40, s53, 983040
s_add_u32 m0, s39, 0
s_add_u32 s37, s40, 4194304
buffer_load_dwordx4 v21, s[8:11], s37 offen sc1 lds
s_add_u32 m0, s39, 1024
s_add_u32 s37, s40, 4210688
buffer_load_dwordx4 v21, s[8:11], s37 offen sc1 lds
s_add_u32 m0, s39, 2048
s_add_u32 s37, s40, 4227072
buffer_load_dwordx4 v21, s[8:11], s37 offen sc1 lds
s_add_u32 m0, s39, 3072
s_add_u32 s37, s40, 4243456
buffer_load_dwordx4 v21, s[8:11], s37 offen sc1 lds
s_add_u32 m0, s39, 4096
s_add_u32 s37, s40, 4292608
buffer_load_dwordx4 v21, s[8:11], s37 offen sc1 lds
s_add_u32 m0, s39, 5120
s_add_u32 s37, s40, 4308992
buffer_load_dwordx4 v21, s[8:11], s37 offen sc1 lds
s_add_u32 m0, s39, 6144
s_add_u32 s37, s40, 4325376
buffer_load_dwordx4 v21, s[8:11], s37 offen sc1 lds
s_add_u32 m0, s39, 7168
s_add_u32 s37, s40, 4341760
buffer_load_dwordx4 v21, s[8:11], s37 offen sc1 lds
s_waitcnt vmcnt(16)
s_barrier
s_add_u32 m0, s39, 32768
s_add_u32 s37, s40, 4259840
buffer_load_dwordx4 v21, s[8:11], s37 offen sc1 lds
s_add_u32 m0, s39, 33792
s_add_u32 s37, s40, 4358144
buffer_load_dwordx4 v21, s[8:11], s37 offen sc1 lds
s_add_u32 m0, s39, 34816
s_add_u32 s37, s40, 4276224
buffer_load_dwordx4 v21, s[8:11], s37 offen sc1 lds
s_add_u32 m0, s39, 35840
s_add_u32 s37, s40, 4374528
buffer_load_dwordx4 v21, s[8:11], s37 offen sc1 lds
s_add_u32 m0, s39, 36864
s_add_u32 s37, s40, 4390912
buffer_load_dwordx4 v21, s[8:11], s37 offen sc1 lds
s_add_u32 m0, s39, 37888
s_add_u32 s37, s40, 4407296
buffer_load_dwordx4 v21, s[8:11], s37 offen sc1 lds
s_add_u32 m0, s39, 38912
s_add_u32 s37, s40, 4423680
buffer_load_dwordx4 v21, s[8:11], s37 offen sc1 lds
s_add_u32 m0, s39, 39936
s_add_u32 s37, s40, 4440064
buffer_load_dwordx4 v21, s[8:11], s37 offen sc1 lds
s_waitcnt vmcnt(16)
s_barrier
s_add_u32 m0, s39, 65536
s_add_u32 s37, s40, 4489216
buffer_load_dwordx4 v21, s[8:11], s37 offen sc1 lds
s_add_u32 m0, s39, 66560
s_add_u32 s37, s40, 4505600
buffer_load_dwordx4 v21, s[8:11], s37 offen sc1 lds
s_add_u32 m0, s39, 67584
s_add_u32 s37, s40, 4521984
buffer_load_dwordx4 v21, s[8:11], s37 offen sc1 lds
s_add_u32 m0, s39, 68608
s_add_u32 s37, s40, 4538368
buffer_load_dwordx4 v21, s[8:11], s37 offen sc1 lds
s_add_u32 m0, s39, 69632
s_add_u32 s37, s40, 4456448
buffer_load_dwordx4 v21, s[8:11], s37 offen sc1 lds
s_add_u32 m0, s39, 70656
s_add_u32 s37, s40, 4554752
buffer_load_dwordx4 v21, s[8:11], s37 offen sc1 lds
s_add_u32 m0, s39, 71680
s_add_u32 s37, s40, 4472832
buffer_load_dwordx4 v21, s[8:11], s37 offen sc1 lds
s_add_u32 m0, s39, 72704
s_add_u32 s37, s40, 4571136
buffer_load_dwordx4 v21, s[8:11], s37 offen sc1 lds
s_waitcnt vmcnt(16)
s_barrier
s_add_u32 m0, s39, 98304
s_add_u32 s37, s40, 4784128
buffer_load_dwordx4 v21, s[8:11], s37 offen sc1 lds
s_add_u32 m0, s39, 99328
s_add_u32 s37, s40, 4800512
buffer_load_dwordx4 v21, s[8:11], s37 offen sc1 lds
s_add_u32 m0, s39, 100352
s_add_u32 s37, s40, 4816896
buffer_load_dwordx4 v21, s[8:11], s37 offen sc1 lds
s_add_u32 m0, s39, 101376
s_add_u32 s37, s40, 4833280
buffer_load_dwordx4 v21, s[8:11], s37 offen sc1 lds
s_add_u32 m0, s39, 102400
s_add_u32 s37, s40, 4882432
buffer_load_dwordx4 v21, s[8:11], s37 offen sc1 lds
s_add_u32 m0, s39, 103424
s_add_u32 s37, s40, 4898816
buffer_load_dwordx4 v21, s[8:11], s37 offen sc1 lds
s_add_u32 m0, s39, 104448
s_add_u32 s37, s40, 4915200
buffer_load_dwordx4 v21, s[8:11], s37 offen sc1 lds
s_add_u32 m0, s39, 105472
s_add_u32 s37, s40, 4931584
buffer_load_dwordx4 v21, s[8:11], s37 offen sc1 lds
s_waitcnt vmcnt(16)
s_barrier
s_add_u32 m0, s39, 0
s_add_u32 s37, s40, 4849664
buffer_load_dwordx4 v21, s[8:11], s37 offen sc1 lds
s_add_u32 m0, s39, 1024
s_add_u32 s37, s40, 4947968
buffer_load_dwordx4 v21, s[8:11], s37 offen sc1 lds
s_add_u32 m0, s39, 2048
s_add_u32 s37, s40, 4866048
buffer_load_dwordx4 v21, s[8:11], s37 offen sc1 lds
s_add_u32 m0, s39, 3072
s_add_u32 s37, s40, 4964352
buffer_load_dwordx4 v21, s[8:11], s37 offen sc1 lds
s_add_u32 m0, s39, 4096
s_add_u32 s37, s40, 4980736
buffer_load_dwordx4 v21, s[8:11], s37 offen sc1 lds
s_add_u32 m0, s39, 5120
s_add_u32 s37, s40, 4997120
buffer_load_dwordx4 v21, s[8:11], s37 offen sc1 lds
s_add_u32 m0, s39, 6144
s_add_u32 s37, s40, 5013504
buffer_load_dwordx4 v21, s[8:11], s37 offen sc1 lds
s_add_u32 m0, s39, 7168
s_add_u32 s37, s40, 5029888
buffer_load_dwordx4 v21, s[8:11], s37 offen sc1 lds
s_waitcnt vmcnt(16)
s_barrier
s_add_u32 m0, s39, 32768
s_add_u32 s37, s40, 5079040
buffer_load_dwordx4 v21, s[8:11], s37 offen sc1 lds
s_add_u32 m0, s39, 33792
s_add_u32 s37, s40, 5095424
buffer_load_dwordx4 v21, s[8:11], s37 offen sc1 lds
s_add_u32 m0, s39, 34816
s_add_u32 s37, s40, 5111808
buffer_load_dwordx4 v21, s[8:11], s37 offen sc1 lds
s_add_u32 m0, s39, 35840
s_add_u32 s37, s40, 5128192
buffer_load_dwordx4 v21, s[8:11], s37 offen sc1 lds
s_add_u32 m0, s39, 36864
s_add_u32 s37, s40, 5046272
buffer_load_dwordx4 v21, s[8:11], s37 offen sc1 lds
s_add_u32 m0, s39, 37888
s_add_u32 s37, s40, 5144576
buffer_load_dwordx4 v21, s[8:11], s37 offen sc1 lds
s_add_u32 m0, s39, 38912
s_add_u32 s37, s40, 5062656
buffer_load_dwordx4 v21, s[8:11], s37 offen sc1 lds
s_add_u32 m0, s39, 39936
s_add_u32 s37, s40, 5160960
buffer_load_dwordx4 v21, s[8:11], s37 offen sc1 lds
s_waitcnt vmcnt(16)
s_barrier
s_add_u32 m0, s39, 65536
s_mov_b32 s37, 6160384
buffer_load_dwordx4 v21, s[8:11], s37 offen sc1 lds
s_add_u32 m0, s39, 66560
s_mov_b32 s37, 6176768
buffer_load_dwordx4 v21, s[8:11], s37 offen sc1 lds
s_add_u32 m0, s39, 67584
s_mov_b32 s37, 6193152
buffer_load_dwordx4 v21, s[8:11], s37 offen sc1 lds
s_add_u32 m0, s39, 68608
s_mov_b32 s37, 6209536
buffer_load_dwordx4 v21, s[8:11], s37 offen sc1 lds
s_add_u32 m0, s39, 69632
s_mov_b32 s37, 6258688
buffer_load_dwordx4 v21, s[8:11], s37 offen sc1 lds
s_add_u32 m0, s39, 70656
s_mov_b32 s37, 6275072
buffer_load_dwordx4 v21, s[8:11], s37 offen sc1 lds
s_add_u32 m0, s39, 71680
s_mov_b32 s37, 6291456
buffer_load_dwordx4 v21, s[8:11], s37 offen sc1 lds
s_add_u32 m0, s39, 72704
s_mov_b32 s37, 6307840
buffer_load_dwordx4 v21, s[8:11], s37 offen sc1 lds
s_waitcnt vmcnt(16)
s_barrier
s_add_u32 m0, s39, 98304
s_mov_b32 s37, 6225920
buffer_load_dwordx4 v21, s[8:11], s37 offen sc1 lds
s_add_u32 m0, s39, 99328
s_mov_b32 s37, 6324224
buffer_load_dwordx4 v21, s[8:11], s37 offen sc1 lds
s_add_u32 m0, s39, 100352
s_mov_b32 s37, 6242304
buffer_load_dwordx4 v21, s[8:11], s37 offen sc1 lds
s_add_u32 m0, s39, 101376
s_mov_b32 s37, 6340608
buffer_load_dwordx4 v21, s[8:11], s37 offen sc1 lds
s_add_u32 m0, s39, 102400
s_mov_b32 s37, 6356992
buffer_load_dwordx4 v21, s[8:11], s37 offen sc1 lds
s_add_u32 m0, s39, 103424
s_mov_b32 s37, 6373376
buffer_load_dwordx4 v21, s[8:11], s37 offen sc1 lds
s_add_u32 m0, s39, 104448
s_mov_b32 s37, 6389760
buffer_load_dwordx4 v21, s[8:11], s37 offen sc1 lds
s_add_u32 m0, s39, 105472
s_mov_b32 s37, 6406144
buffer_load_dwordx4 v21, s[8:11], s37 offen sc1 lds
s_waitcnt vmcnt(16)
s_barrier
s_add_u32 m0, s39, 0
s_mov_b32 s37, 6455296
buffer_load_dwordx4 v21, s[8:11], s37 offen sc1 lds
s_add_u32 m0, s39, 1024
s_mov_b32 s37, 6471680
buffer_load_dwordx4 v21, s[8:11], s37 offen sc1 lds
s_add_u32 m0, s39, 2048
s_mov_b32 s37, 6488064
buffer_load_dwordx4 v21, s[8:11], s37 offen sc1 lds
s_add_u32 m0, s39, 3072
s_mov_b32 s37, 6504448
buffer_load_dwordx4 v21, s[8:11], s37 offen sc1 lds
s_add_u32 m0, s39, 4096
s_mov_b32 s37, 6422528
buffer_load_dwordx4 v21, s[8:11], s37 offen sc1 lds
s_add_u32 m0, s39, 5120
s_mov_b32 s37, 6520832
buffer_load_dwordx4 v21, s[8:11], s37 offen sc1 lds
s_add_u32 m0, s39, 6144
s_mov_b32 s37, 6438912
buffer_load_dwordx4 v21, s[8:11], s37 offen sc1 lds
s_add_u32 m0, s39, 7168
s_mov_b32 s37, 6537216
buffer_load_dwordx4 v21, s[8:11], s37 offen sc1 lds
s_waitcnt vmcnt(16)
s_barrier
s_add_u32 m0, s39, 32768
s_mov_b32 s37, 6946816
buffer_load_dwordx4 v21, s[8:11], s37 offen sc1 lds
s_add_u32 m0, s39, 33792
s_mov_b32 s37, 6963200
buffer_load_dwordx4 v21, s[8:11], s37 offen sc1 lds
s_add_u32 m0, s39, 34816
s_mov_b32 s37, 6979584
buffer_load_dwordx4 v21, s[8:11], s37 offen sc1 lds
s_add_u32 m0, s39, 35840
s_mov_b32 s37, 6995968
buffer_load_dwordx4 v21, s[8:11], s37 offen sc1 lds
s_add_u32 m0, s39, 36864
s_mov_b32 s37, 7045120
buffer_load_dwordx4 v21, s[8:11], s37 offen sc1 lds
s_add_u32 m0, s39, 37888
s_mov_b32 s37, 7061504
buffer_load_dwordx4 v21, s[8:11], s37 offen sc1 lds
s_add_u32 m0, s39, 38912
s_mov_b32 s37, 7077888
buffer_load_dwordx4 v21, s[8:11], s37 offen sc1 lds
s_add_u32 m0, s39, 39936
s_mov_b32 s37, 7094272
buffer_load_dwordx4 v21, s[8:11], s37 offen sc1 lds
s_waitcnt vmcnt(16)
s_barrier
s_add_u32 m0, s39, 65536
s_mov_b32 s37, 7012352
buffer_load_dwordx4 v21, s[8:11], s37 offen sc1 lds
s_add_u32 m0, s39, 66560
s_mov_b32 s37, 7110656
buffer_load_dwordx4 v21, s[8:11], s37 offen sc1 lds
s_add_u32 m0, s39, 67584
s_mov_b32 s37, 7028736
buffer_load_dwordx4 v21, s[8:11], s37 offen sc1 lds
s_add_u32 m0, s39, 68608
s_mov_b32 s37, 7127040
buffer_load_dwordx4 v21, s[8:11], s37 offen sc1 lds
s_add_u32 m0, s39, 69632
s_mov_b32 s37, 7143424
buffer_load_dwordx4 v21, s[8:11], s37 offen sc1 lds
s_add_u32 m0, s39, 70656
s_mov_b32 s37, 7159808
buffer_load_dwordx4 v21, s[8:11], s37 offen sc1 lds
s_add_u32 m0, s39, 71680
s_mov_b32 s37, 7176192
buffer_load_dwordx4 v21, s[8:11], s37 offen sc1 lds
s_add_u32 m0, s39, 72704
s_mov_b32 s37, 7192576
buffer_load_dwordx4 v21, s[8:11], s37 offen sc1 lds
s_waitcnt vmcnt(16)
s_barrier
s_add_u32 m0, s39, 98304
s_mov_b32 s37, 7241728
buffer_load_dwordx4 v21, s[8:11], s37 offen sc1 lds
s_add_u32 m0, s39, 99328
s_mov_b32 s37, 7258112
buffer_load_dwordx4 v21, s[8:11], s37 offen sc1 lds
s_add_u32 m0, s39, 100352
s_mov_b32 s37, 7274496
buffer_load_dwordx4 v21, s[8:11], s37 offen sc1 lds
s_add_u32 m0, s39, 101376
s_mov_b32 s37, 7290880
buffer_load_dwordx4 v21, s[8:11], s37 offen sc1 lds
s_add_u32 m0, s39, 102400
s_mov_b32 s37, 7208960
buffer_load_dwordx4 v21, s[8:11], s37 offen sc1 lds
s_add_u32 m0, s39, 103424
s_mov_b32 s37, 7307264
buffer_load_dwordx4 v21, s[8:11], s37 offen sc1 lds
s_add_u32 m0, s39, 104448
s_mov_b32 s37, 7225344
buffer_load_dwordx4 v21, s[8:11], s37 offen sc1 lds
s_add_u32 m0, s39, 105472
s_mov_b32 s37, 7323648
buffer_load_dwordx4 v21, s[8:11], s37 offen sc1 lds
s_waitcnt vmcnt(16)
s_barrier
s_add_u32 m0, s39, 0
s_mov_b32 s37, 4587520
buffer_load_dwordx4 v21, s[8:11], s37 offen sc1 lds
s_add_u32 m0, s39, 1024
s_mov_b32 s37, 4603904
buffer_load_dwordx4 v21, s[8:11], s37 offen sc1 lds
s_add_u32 m0, s39, 2048
s_mov_b32 s37, 4620288
buffer_load_dwordx4 v21, s[8:11], s37 offen sc1 lds
s_add_u32 m0, s39, 3072
s_mov_b32 s37, 4636672
buffer_load_dwordx4 v21, s[8:11], s37 offen sc1 lds
s_add_u32 m0, s39, 4096
s_mov_b32 s37, 4685824
buffer_load_dwordx4 v21, s[8:11], s37 offen sc1 lds
s_add_u32 m0, s39, 5120
s_mov_b32 s37, 4702208
buffer_load_dwordx4 v21, s[8:11], s37 offen sc1 lds
s_add_u32 m0, s39, 6144
s_mov_b32 s37, 4718592
buffer_load_dwordx4 v21, s[8:11], s37 offen sc1 lds
s_add_u32 m0, s39, 7168
s_mov_b32 s37, 4734976
buffer_load_dwordx4 v21, s[8:11], s37 offen sc1 lds
s_waitcnt vmcnt(16)
s_barrier
s_add_u32 m0, s39, 32768
s_mov_b32 s37, 4653056
buffer_load_dwordx4 v21, s[8:11], s37 offen sc1 lds
s_add_u32 m0, s39, 33792
s_mov_b32 s37, 4751360
buffer_load_dwordx4 v21, s[8:11], s37 offen sc1 lds
s_add_u32 m0, s39, 34816
s_mov_b32 s37, 4669440
buffer_load_dwordx4 v21, s[8:11], s37 offen sc1 lds
s_add_u32 m0, s39, 35840
s_mov_b32 s37, 4767744
buffer_load_dwordx4 v21, s[8:11], s37 offen sc1 lds
s_add_u32 m0, s39, 36864
s_mov_b32 s37, 5570560
buffer_load_dwordx4 v21, s[8:11], s37 offen sc1 lds
s_add_u32 m0, s39, 37888
s_mov_b32 s37, 5586944
buffer_load_dwordx4 v21, s[8:11], s37 offen sc1 lds
s_add_u32 m0, s39, 38912
s_mov_b32 s37, 5603328
buffer_load_dwordx4 v21, s[8:11], s37 offen sc1 lds
s_add_u32 m0, s39, 39936
s_mov_b32 s37, 5619712
buffer_load_dwordx4 v21, s[8:11], s37 offen sc1 lds
s_waitcnt vmcnt(16)
s_barrier
s_add_u32 m0, s39, 65536
s_mov_b32 s37, 5668864
buffer_load_dwordx4 v21, s[8:11], s37 offen sc1 lds
s_add_u32 m0, s39, 66560
s_mov_b32 s37, 5685248
buffer_load_dwordx4 v21, s[8:11], s37 offen sc1 lds
s_add_u32 m0, s39, 67584
s_mov_b32 s37, 5701632
buffer_load_dwordx4 v21, s[8:11], s37 offen sc1 lds
s_add_u32 m0, s39, 68608
s_mov_b32 s37, 5718016
buffer_load_dwordx4 v21, s[8:11], s37 offen sc1 lds
s_add_u32 m0, s39, 69632
s_mov_b32 s37, 5636096
buffer_load_dwordx4 v21, s[8:11], s37 offen sc1 lds
s_add_u32 m0, s39, 70656
s_mov_b32 s37, 5734400
buffer_load_dwordx4 v21, s[8:11], s37 offen sc1 lds
s_add_u32 m0, s39, 71680
s_mov_b32 s37, 5652480
buffer_load_dwordx4 v21, s[8:11], s37 offen sc1 lds
s_add_u32 m0, s39, 72704
s_mov_b32 s37, 5750784
buffer_load_dwordx4 v21, s[8:11], s37 offen sc1 lds
s_waitcnt vmcnt(16)
s_barrier
s_add_u32 m0, s39, 98304
s_mov_b32 s37, 6553600
buffer_load_dwordx4 v21, s[8:11], s37 offen sc1 lds
s_add_u32 m0, s39, 99328
s_mov_b32 s37, 6569984
buffer_load_dwordx4 v21, s[8:11], s37 offen sc1 lds
s_add_u32 m0, s39, 100352
s_mov_b32 s37, 6586368
buffer_load_dwordx4 v21, s[8:11], s37 offen sc1 lds
s_add_u32 m0, s39, 101376
s_mov_b32 s37, 6602752
buffer_load_dwordx4 v21, s[8:11], s37 offen sc1 lds
s_add_u32 m0, s39, 102400
s_mov_b32 s37, 6651904
buffer_load_dwordx4 v21, s[8:11], s37 offen sc1 lds
s_add_u32 m0, s39, 103424
s_mov_b32 s37, 6668288
buffer_load_dwordx4 v21, s[8:11], s37 offen sc1 lds
s_add_u32 m0, s39, 104448
s_mov_b32 s37, 6684672
buffer_load_dwordx4 v21, s[8:11], s37 offen sc1 lds
s_add_u32 m0, s39, 105472
s_mov_b32 s37, 6701056
buffer_load_dwordx4 v21, s[8:11], s37 offen sc1 lds
s_waitcnt vmcnt(16)
s_barrier
s_add_u32 m0, s39, 0
s_mov_b32 s37, 6619136
buffer_load_dwordx4 v21, s[8:11], s37 offen sc1 lds
s_add_u32 m0, s39, 1024
s_mov_b32 s37, 6717440
buffer_load_dwordx4 v21, s[8:11], s37 offen sc1 lds
s_add_u32 m0, s39, 2048
s_mov_b32 s37, 6635520
buffer_load_dwordx4 v21, s[8:11], s37 offen sc1 lds
s_add_u32 m0, s39, 3072
s_mov_b32 s37, 6733824
buffer_load_dwordx4 v21, s[8:11], s37 offen sc1 lds
s_add_u32 m0, s39, 4096
s_mov_b32 s37, 6750208
buffer_load_dwordx4 v21, s[8:11], s37 offen sc1 lds
s_add_u32 m0, s39, 5120
s_mov_b32 s37, 6766592
buffer_load_dwordx4 v21, s[8:11], s37 offen sc1 lds
s_add_u32 m0, s39, 6144
s_mov_b32 s37, 6782976
buffer_load_dwordx4 v21, s[8:11], s37 offen sc1 lds
s_add_u32 m0, s39, 7168
s_mov_b32 s37, 6799360
buffer_load_dwordx4 v21, s[8:11], s37 offen sc1 lds
s_waitcnt vmcnt(16)
s_barrier
s_add_u32 m0, s39, 32768
s_mov_b32 s37, 6848512
buffer_load_dwordx4 v21, s[8:11], s37 offen sc1 lds
s_add_u32 m0, s39, 33792
s_mov_b32 s37, 6864896
buffer_load_dwordx4 v21, s[8:11], s37 offen sc1 lds
s_add_u32 m0, s39, 34816
s_mov_b32 s37, 6881280
buffer_load_dwordx4 v21, s[8:11], s37 offen sc1 lds
s_add_u32 m0, s39, 35840
s_mov_b32 s37, 6897664
buffer_load_dwordx4 v21, s[8:11], s37 offen sc1 lds
s_add_u32 m0, s39, 36864
s_mov_b32 s37, 6815744
buffer_load_dwordx4 v21, s[8:11], s37 offen sc1 lds
s_add_u32 m0, s39, 37888
s_mov_b32 s37, 6914048
buffer_load_dwordx4 v21, s[8:11], s37 offen sc1 lds
s_add_u32 m0, s39, 38912
s_mov_b32 s37, 6832128
buffer_load_dwordx4 v21, s[8:11], s37 offen sc1 lds
s_add_u32 m0, s39, 39936
s_mov_b32 s37, 6930432
buffer_load_dwordx4 v21, s[8:11], s37 offen sc1 lds
s_waitcnt vmcnt(16)
s_barrier
s_waitcnt vmcnt(8)
s_barrier
s_waitcnt vmcnt(0)
s_barrier
s_branch Ldone_1
.p2align 6
Lw_130:
s_branch Lr_131
s_nop 0
.p2align 3
L7b_158:
v_mfma_f32_16x16x32_bf16 v[128:131], v[96:99], v[80:83], v[128:131]
v_mfma_f32_16x16x32_bf16 v[132:135], v[96:99], v[84:87], v[132:135]
v_mfma_f32_16x16x32_bf16 v[136:139], v[96:99], v[88:91], v[136:139]
v_mfma_f32_16x16x32_bf16 v[140:143], v[96:99], v[92:95], v[140:143]
v_mfma_f32_16x16x32_bf16 v[188:191], v[108:111], v[92:95], v[188:191]
v_mfma_f32_16x16x32_bf16 v[184:187], v[108:111], v[88:91], v[184:187]
v_mfma_f32_16x16x32_bf16 v[180:183], v[108:111], v[84:87], v[180:183]
v_mfma_f32_16x16x32_bf16 v[176:179], v[108:111], v[80:83], v[176:179]
v_mfma_f32_16x16x32_bf16 v[144:147], v[100:103], v[80:83], v[144:147]
v_mfma_f32_16x16x32_bf16 v[148:151], v[100:103], v[84:87], v[148:151]
v_mfma_f32_16x16x32_bf16 v[152:155], v[100:103], v[88:91], v[152:155]
v_mfma_f32_16x16x32_bf16 v[156:159], v[100:103], v[92:95], v[156:159]
v_mfma_f32_16x16x32_bf16 v[204:207], v[112:115], v[92:95], v[204:207]
v_mfma_f32_16x16x32_bf16 v[200:203], v[112:115], v[88:91], v[200:203]
v_mfma_f32_16x16x32_bf16 v[196:199], v[112:115], v[84:87], v[196:199]
v_mfma_f32_16x16x32_bf16 v[192:195], v[112:115], v[80:83], v[192:195]
v_mfma_f32_16x16x32_bf16 v[160:163], v[104:107], v[80:83], v[160:163]
v_mfma_f32_16x16x32_bf16 v[164:167], v[104:107], v[84:87], v[164:167]
v_mfma_f32_16x16x32_bf16 v[168:171], v[104:107], v[88:91], v[168:171]
v_mfma_f32_16x16x32_bf16 v[172:175], v[104:107], v[92:95], v[172:175]
v_mfma_f32_16x16x32_bf16 v[220:223], v[116:119], v[92:95], v[220:223]
v_mfma_f32_16x16x32_bf16 v[216:219], v[116:119], v[88:91], v[216:219]
v_mfma_f32_16x16x32_bf16 v[212:215], v[116:119], v[84:87], v[212:215]
v_mfma_f32_16x16x32_bf16 v[208:211], v[116:119], v[80:83], v[208:211]
s_mul_i32 s43, s38, 32
s_add_u32 s37, s37, s43
s_setprio 0
s_barrier
s_mov_b32 s80, s60
s_mov_b32 s81, s61
s_mov_b32 s82, 7340032
s_mov_b32 s83, 0x20000
v_and_b32 v29, 31, v1
v_lshlrev_b32 v29, 11, v29
s_and_b32 s43, s35, 8
s_or_b32 s43, s43, 3
s_lshl_b32 s43, s43, 7
v_add_u32 v29, s43, v29
s_add_u32 s37, s37, s54
s_add_u32 m0, s39, 65536
s_add_u32 s37, s37, s40
buffer_load_dwordx4 v21, s[8:11], s37 offen sc1 lds
v_mul_f32 v80, v128, v128
v_mul_f32 v81, v129, v129
v_mul_f32 v82, v130, v130
v_mul_f32 v83, v131, v131
v_fma_f32 v80, v80, v232, v228
v_fma_f32 v81, v81, v232, v228
v_fma_f32 v82, v82, v232, v228
s_add_u32 m0, s39, 66560
s_add_u32 s37, s37, s38
buffer_load_dwordx4 v21, s[8:11], s37 offen sc1 lds
v_fma_f32 v83, v83, v232, v228
v_mul_f32 v80, v80, v128
v_mul_f32 v81, v81, v129
v_mul_f32 v82, v82, v130
v_mul_f32 v83, v83, v131
v_exp_f32 v80, v80
s_add_u32 m0, s39, 67584
s_add_u32 s37, s37, s38
buffer_load_dwordx4 v21, s[8:11], s37 offen sc1 lds
v_exp_f32 v81, v81
v_exp_f32 v82, v82
v_exp_f32 v83, v83
v_mul_f32 v176, v128, v176
v_mul_f32 v177, v129, v177
v_mul_f32 v178, v130, v178
v_mul_f32 v179, v131, v179
s_add_u32 m0, s39, 68608
s_add_u32 s37, s37, s38
buffer_load_dwordx4 v21, s[8:11], s37 offen sc1 lds
v_fma_f32 v80, v80, v236, v236
v_fma_f32 v81, v81, v236, v236
v_fma_f32 v82, v82, v236, v236
v_fma_f32 v83, v83, v236, v236
v_rcp_f32 v80, v80
v_rcp_f32 v81, v81
s_add_u32 m0, s39, 69632
s_add_u32 s37, s37, s55
buffer_load_dwordx4 v21, s[8:11], s37 offen sc1 lds
v_rcp_f32 v82, v82
v_rcp_f32 v83, v83
v_mul_f32 v176, v176, v80
v_mul_f32 v177, v177, v81
v_mul_f32 v178, v178, v82
v_mul_f32 v179, v179, v83
v_cvt_pk_bf16_f32 v96, v176, v177
s_add_u32 m0, s39, 70656
s_add_u32 s37, s37, s38
buffer_load_dwordx4 v21, s[8:11], s37 offen sc1 lds
v_cvt_pk_bf16_f32 v97, v178, v179
v_mul_f32 v84, v144, v144
v_mul_f32 v85, v145, v145
v_mul_f32 v86, v146, v146
v_mul_f32 v87, v147, v147
v_fma_f32 v84, v84, v232, v228
s_add_u32 m0, s39, 71680
s_add_u32 s37, s37, s38
buffer_load_dwordx4 v21, s[8:11], s37 offen sc1 lds
v_fma_f32 v85, v85, v232, v228
v_fma_f32 v86, v86, v232, v228
v_fma_f32 v87, v87, v232, v228
v_mul_f32 v84, v84, v144
v_mul_f32 v85, v85, v145
v_mul_f32 v86, v86, v146
v_mul_f32 v87, v87, v147
s_add_u32 m0, s39, 72704
s_add_u32 s37, s37, s38
buffer_load_dwordx4 v21, s[8:11], s37 offen sc1 lds
v_exp_f32 v84, v84
v_exp_f32 v85, v85
v_exp_f32 v86, v86
v_exp_f32 v87, v87
v_mul_f32 v192, v144, v192
v_mul_f32 v193, v145, v193
s_barrier
s_lshr_b32 s44, s2, 3
s_lshl_b32 s44, s44, 17
s_add_u32 s43, s44, 65536
buffer_load_dword v30, v29, s[80:83], s43 offen
s_add_u32 m0, s39, 98304
s_add_u32 s37, s37, s40
buffer_load_dwordx4 v21, s[8:11], s37 offen sc1 lds
v_mul_f32 v194, v146, v194
v_mul_f32 v195, v147, v195
v_fma_f32 v84, v84, v236, v236
v_fma_f32 v85, v85, v236, v236
v_fma_f32 v86, v86, v236, v236
v_fma_f32 v87, v87, v236, v236
v_rcp_f32 v84, v84
s_add_u32 m0, s39, 99328
s_add_u32 s37, s37, s38
buffer_load_dwordx4 v21, s[8:11], s37 offen sc1 lds
v_rcp_f32 v85, v85
v_rcp_f32 v86, v86
v_rcp_f32 v87, v87
v_mul_f32 v192, v192, v84
v_mul_f32 v193, v193, v85
v_mul_f32 v194, v194, v86
v_mul_f32 v195, v195, v87
s_add_u32 m0, s39, 100352
s_add_u32 s37, s37, s38
buffer_load_dwordx4 v21, s[8:11], s37 offen sc1 lds
v_cvt_pk_bf16_f32 v98, v192, v193
v_cvt_pk_bf16_f32 v99, v194, v195
v_mul_f32 v80, v160, v160
v_mul_f32 v81, v161, v161
v_mul_f32 v82, v162, v162
s_add_u32 m0, s39, 101376
s_add_u32 s37, s37, s38
buffer_load_dwordx4 v21, s[8:11], s37 offen sc1 lds
v_mul_f32 v83, v163, v163
v_fma_f32 v80, v80, v232, v228
v_fma_f32 v81, v81, v232, v228
v_fma_f32 v82, v82, v232, v228
v_fma_f32 v83, v83, v232, v228
v_mul_f32 v80, v80, v160
v_mul_f32 v81, v81, v161
s_add_u32 m0, s39, 102400
s_add_u32 s37, s37, s55
buffer_load_dwordx4 v21, s[8:11], s37 offen sc1 lds
v_mul_f32 v82, v82, v162
v_mul_f32 v83, v83, v163
v_exp_f32 v80, v80
v_exp_f32 v81, v81
v_exp_f32 v82, v82
v_exp_f32 v83, v83
v_mul_f32 v208, v160, v208
s_add_u32 m0, s39, 103424
s_add_u32 s37, s37, s38
buffer_load_dwordx4 v21, s[8:11], s37 offen sc1 lds
v_mul_f32 v209, v161, v209
v_mul_f32 v210, v162, v210
v_mul_f32 v211, v163, v211
v_fma_f32 v80, v80, v236, v236
v_fma_f32 v81, v81, v236, v236
v_fma_f32 v82, v82, v236, v236
s_add_u32 m0, s39, 104448
s_add_u32 s37, s37, s38
buffer_load_dwordx4 v21, s[8:11], s37 offen sc1 lds
v_fma_f32 v83, v83, v236, v236
v_rcp_f32 v80, v80
v_rcp_f32 v81, v81
v_rcp_f32 v82, v82
v_rcp_f32 v83, v83
v_mul_f32 v208, v208, v80
v_mul_f32 v209, v209, v81
s_add_u32 m0, s39, 105472
s_add_u32 s37, s37, s38
buffer_load_dwordx4 v21, s[8:11], s37 offen sc1 lds
v_mul_f32 v210, v210, v82
v_mul_f32 v211, v211, v83
v_cvt_pk_bf16_f32 v112, v208, v209
v_cvt_pk_bf16_f32 v113, v210, v211
v_mul_f32 v80, v132, v132
v_mul_f32 v81, v133, v133
buffer_store_dwordx4 v[96:99], v27, s[24:27], 0 offen offset:0 sc1
s_barrier
s_add_u32 m0, s39, 0
s_add_u32 s37, s37, s40
buffer_load_dwordx4 v21, s[8:11], s37 offen sc1 lds
v_mul_f32 v82, v134, v134
v_mul_f32 v83, v135, v135
v_fma_f32 v80, v80, v233, v229
v_fma_f32 v81, v81, v233, v229
v_fma_f32 v82, v82, v233, v229
v_fma_f32 v83, v83, v233, v229
v_mul_f32 v80, v80, v132
s_add_u32 m0, s39, 1024
s_add_u32 s37, s37, s38
buffer_load_dwordx4 v21, s[8:11], s37 offen sc1 lds
v_mul_f32 v81, v81, v133
v_mul_f32 v82, v82, v134
v_mul_f32 v83, v83, v135
v_exp_f32 v80, v80
v_exp_f32 v81, v81
v_exp_f32 v82, v82
s_add_u32 m0, s39, 2048
s_add_u32 s37, s37, s38
buffer_load_dwordx4 v21, s[8:11], s37 offen sc1 lds
v_exp_f32 v83, v83
v_mul_f32 v180, v132, v180
v_mul_f32 v181, v133, v181
v_mul_f32 v182, v134, v182
v_mul_f32 v183, v135, v183
v_fma_f32 v80, v80, v237, v237
v_fma_f32 v81, v81, v237, v237
s_add_u32 m0, s39, 3072
s_add_u32 s37, s37, s38
buffer_load_dwordx4 v21, s[8:11], s37 offen sc1 lds
v_fma_f32 v82, v82, v237, v237
v_fma_f32 v83, v83, v237, v237
v_rcp_f32 v80, v80
v_rcp_f32 v81, v81
v_rcp_f32 v82, v82
v_rcp_f32 v83, v83
s_add_u32 m0, s39, 4096
s_add_u32 s37, s37, s55
buffer_load_dwordx4 v21, s[8:11], s37 offen sc1 lds
v_mul_f32 v180, v180, v80
v_mul_f32 v181, v181, v81
v_mul_f32 v182, v182, v82
v_mul_f32 v183, v183, v83
v_cvt_pk_bf16_f32 v100, v180, v181
v_cvt_pk_bf16_f32 v101, v182, v183
v_mul_f32 v84, v148, v148
s_add_u32 m0, s39, 5120
s_add_u32 s37, s37, s38
buffer_load_dwordx4 v21, s[8:11], s37 offen sc1 lds
v_mul_f32 v85, v149, v149
v_mul_f32 v86, v150, v150
v_mul_f32 v87, v151, v151
v_fma_f32 v84, v84, v233, v229
v_fma_f32 v85, v85, v233, v229
v_fma_f32 v86, v86, v233, v229
s_add_u32 m0, s39, 6144
s_add_u32 s37, s37, s38
buffer_load_dwordx4 v21, s[8:11], s37 offen sc1 lds
v_fma_f32 v87, v87, v233, v229
v_mul_f32 v84, v84, v148
v_mul_f32 v85, v85, v149
v_mul_f32 v86, v86, v150
v_mul_f32 v87, v87, v151
v_exp_f32 v84, v84
v_exp_f32 v85, v85
s_add_u32 m0, s39, 7168
s_add_u32 s37, s37, s38
buffer_load_dwordx4 v21, s[8:11], s37 offen sc1 lds
v_exp_f32 v86, v86
v_exp_f32 v87, v87
v_mul_f32 v196, v148, v196
v_mul_f32 v197, v149, v197
v_mul_f32 v198, v150, v198
v_mul_f32 v199, v151, v199
s_waitcnt vmcnt(18)
s_barrier
s_add_u32 s43, s34, 48
s_lshl_b32 s43, s43, 7
v_mov_b32 v10, s43
v_mov_b32 v12, 16
buffer_load_dword v11, v10, s[56:59], 0 offen sc1
s_add_u32 m0, s39, 32768
s_add_u32 s37, s37, s40
buffer_load_dwordx4 v21, s[8:11], s37 offen sc1 lds
v_fma_f32 v84, v84, v237, v237
v_fma_f32 v85, v85, v237, v237
v_fma_f32 v86, v86, v237, v237
v_fma_f32 v87, v87, v237, v237
v_rcp_f32 v84, v84
v_rcp_f32 v85, v85
v_rcp_f32 v86, v86
s_add_u32 m0, s39, 33792
s_add_u32 s37, s37, s38
buffer_load_dwordx4 v21, s[8:11], s37 offen sc1 lds
v_rcp_f32 v87, v87
v_mul_f32 v196, v196, v84
v_mul_f32 v197, v197, v85
v_mul_f32 v198, v198, v86
v_mul_f32 v199, v199, v87
v_cvt_pk_bf16_f32 v102, v196, v197
v_cvt_pk_bf16_f32 v103, v198, v199
s_add_u32 m0, s39, 34816
s_add_u32 s37, s37, s38
buffer_load_dwordx4 v21, s[8:11], s37 offen sc1 lds
v_mul_f32 v80, v164, v164
v_mul_f32 v81, v165, v165
v_mul_f32 v82, v166, v166
v_mul_f32 v83, v167, v167
v_fma_f32 v80, v80, v233, v229
s_add_u32 m0, s39, 35840
s_add_u32 s37, s37, s38
buffer_load_dwordx4 v21, s[8:11], s37 offen sc1 lds
v_fma_f32 v81, v81, v233, v229
v_fma_f32 v82, v82, v233, v229
v_fma_f32 v83, v83, v233, v229
v_mul_f32 v80, v80, v164
v_mul_f32 v81, v81, v165
v_mul_f32 v82, v82, v166
v_mul_f32 v83, v83, v167
s_add_u32 m0, s39, 36864
s_add_u32 s37, s37, s55
buffer_load_dwordx4 v21, s[8:11], s37 offen sc1 lds
v_exp_f32 v80, v80
v_exp_f32 v81, v81
v_exp_f32 v82, v82
v_exp_f32 v83, v83
v_mul_f32 v212, v164, v212
v_mul_f32 v213, v165, v213
v_mul_f32 v214, v166, v214
s_add_u32 m0, s39, 37888
s_add_u32 s37, s37, s38
buffer_load_dwordx4 v21, s[8:11], s37 offen sc1 lds
v_mul_f32 v215, v167, v215
v_fma_f32 v80, v80, v237, v237
v_fma_f32 v81, v81, v237, v237
v_fma_f32 v82, v82, v237, v237
v_fma_f32 v83, v83, v237, v237
v_rcp_f32 v80, v80
s_add_u32 m0, s39, 38912
s_add_u32 s37, s37, s38
buffer_load_dwordx4 v21, s[8:11], s37 offen sc1 lds
v_rcp_f32 v81, v81
v_rcp_f32 v82, v82
v_rcp_f32 v83, v83
v_mul_f32 v212, v212, v80
v_mul_f32 v213, v213, v81
v_mul_f32 v214, v214, v82
v_mul_f32 v215, v215, v83
s_add_u32 m0, s39, 39936
s_add_u32 s37, s37, s38
buffer_load_dwordx4 v21, s[8:11], s37 offen sc1 lds
v_cvt_pk_bf16_f32 v114, v212, v213
v_cvt_pk_bf16_f32 v115, v214, v215
s_nop 1
v_permlane32_swap_b32 v112, v114
v_permlane32_swap_b32 v113, v115
buffer_store_dwordx4 v[100:103], v27, s[24:27], 0 offen offset:256 sc1
buffer_store_dwordx4 v[112:115], v28, s[24:27], 0 offen offset:0 sc1
s_waitcnt vmcnt(20)
s_barrier
s_add_u32 m0, s39, 65536
s_add_u32 s37, s37, s40
buffer_load_dwordx4 v21, s[8:11], s37 offen sc1 lds
v_mul_f32 v80, v136, v136
v_mul_f32 v81, v137, v137
v_mul_f32 v82, v138, v138
v_mul_f32 v83, v139, v139
v_fma_f32 v80, v80, v234, v230
v_fma_f32 v81, v81, v234, v230
v_fma_f32 v82, v82, v234, v230
s_add_u32 m0, s39, 66560
s_add_u32 s37, s37, s38
buffer_load_dwordx4 v21, s[8:11], s37 offen sc1 lds
v_fma_f32 v83, v83, v234, v230
v_mul_f32 v80, v80, v136
v_mul_f32 v81, v81, v137
v_mul_f32 v82, v82, v138
v_mul_f32 v83, v83, v139
v_exp_f32 v80, v80
s_add_u32 m0, s39, 67584
s_add_u32 s37, s37, s38
buffer_load_dwordx4 v21, s[8:11], s37 offen sc1 lds
v_exp_f32 v81, v81
v_exp_f32 v82, v82
v_exp_f32 v83, v83
v_mul_f32 v184, v136, v184
v_mul_f32 v185, v137, v185
v_mul_f32 v186, v138, v186
v_mul_f32 v187, v139, v187
s_add_u32 m0, s39, 68608
s_add_u32 s37, s37, s38
buffer_load_dwordx4 v21, s[8:11], s37 offen sc1 lds
v_fma_f32 v80, v80, v238, v238
v_fma_f32 v81, v81, v238, v238
v_fma_f32 v82, v82, v238, v238
v_fma_f32 v83, v83, v238, v238
v_rcp_f32 v80, v80
v_rcp_f32 v81, v81
s_add_u32 m0, s39, 69632
s_add_u32 s37, s37, s55
buffer_load_dwordx4 v21, s[8:11], s37 offen sc1 lds
v_rcp_f32 v82, v82
v_rcp_f32 v83, v83
v_mul_f32 v184, v184, v80
v_mul_f32 v185, v185, v81
v_mul_f32 v186, v186, v82
v_mul_f32 v187, v187, v83
v_cvt_pk_bf16_f32 v104, v184, v185
s_add_u32 m0, s39, 70656
s_add_u32 s37, s37, s38
buffer_load_dwordx4 v21, s[8:11], s37 offen sc1 lds
v_cvt_pk_bf16_f32 v105, v186, v187
v_mul_f32 v84, v152, v152
v_mul_f32 v85, v153, v153
v_mul_f32 v86, v154, v154
v_mul_f32 v87, v155, v155
v_fma_f32 v84, v84, v234, v230
s_add_u32 m0, s39, 71680
s_add_u32 s37, s37, s38
buffer_load_dwordx4 v21, s[8:11], s37 offen sc1 lds
v_fma_f32 v85, v85, v234, v230
v_fma_f32 v86, v86, v234, v230
v_fma_f32 v87, v87, v234, v230
v_mul_f32 v84, v84, v152
v_mul_f32 v85, v85, v153
v_mul_f32 v86, v86, v154
v_mul_f32 v87, v87, v155
s_add_u32 m0, s39, 72704
s_add_u32 s37, s37, s38
buffer_load_dwordx4 v21, s[8:11], s37 offen sc1 lds
v_exp_f32 v84, v84
v_exp_f32 v85, v85
v_exp_f32 v86, v86
v_exp_f32 v87, v87
v_mul_f32 v200, v152, v200
v_mul_f32 v201, v153, v201
s_waitcnt vmcnt(19)
s_barrier
s_add_u32 m0, s39, 98304
s_add_u32 s37, s37, s40
buffer_load_dwordx4 v21, s[8:11], s37 offen sc1 lds
v_mul_f32 v202, v154, v202
v_mul_f32 v203, v155, v203
v_fma_f32 v84, v84, v238, v238
v_fma_f32 v85, v85, v238, v238
v_fma_f32 v86, v86, v238, v238
v_fma_f32 v87, v87, v238, v238
v_rcp_f32 v84, v84
s_add_u32 m0, s39, 99328
s_add_u32 s37, s37, s38
buffer_load_dwordx4 v21, s[8:11], s37 offen sc1 lds
v_rcp_f32 v85, v85
v_rcp_f32 v86, v86
v_rcp_f32 v87, v87
v_mul_f32 v200, v200, v84
v_mul_f32 v201, v201, v85
v_mul_f32 v202, v202, v86
v_mul_f32 v203, v203, v87
s_add_u32 m0, s39, 100352
s_add_u32 s37, s37, s38
buffer_load_dwordx4 v21, s[8:11], s37 offen sc1 lds
v_cvt_pk_bf16_f32 v106, v200, v201
v_cvt_pk_bf16_f32 v107, v202, v203
v_mul_f32 v80, v168, v168
v_mul_f32 v81, v169, v169
v_mul_f32 v82, v170, v170
s_add_u32 m0, s39, 101376
s_add_u32 s37, s37, s38
buffer_load_dwordx4 v21, s[8:11], s37 offen sc1 lds
v_mul_f32 v83, v171, v171
v_fma_f32 v80, v80, v234, v230
v_fma_f32 v81, v81, v234, v230
v_fma_f32 v82, v82, v234, v230
v_fma_f32 v83, v83, v234, v230
v_mul_f32 v80, v80, v168
v_mul_f32 v81, v81, v169
s_add_u32 m0, s39, 102400
s_add_u32 s37, s37, s55
buffer_load_dwordx4 v21, s[8:11], s37 offen sc1 lds
v_mul_f32 v82, v82, v170
v_mul_f32 v83, v83, v171
v_exp_f32 v80, v80
v_exp_f32 v81, v81
v_exp_f32 v82, v82
v_exp_f32 v83, v83
v_mul_f32 v216, v168, v216
s_add_u32 m0, s39, 103424
s_add_u32 s37, s37, s38
buffer_load_dwordx4 v21, s[8:11], s37 offen sc1 lds
v_mul_f32 v217, v169, v217
v_mul_f32 v218, v170, v218
v_mul_f32 v219, v171, v219
v_fma_f32 v80, v80, v238, v238
v_fma_f32 v81, v81, v238, v238
v_fma_f32 v82, v82, v238, v238
s_add_u32 m0, s39, 104448
s_add_u32 s37, s37, s38
buffer_load_dwordx4 v21, s[8:11], s37 offen sc1 lds
v_fma_f32 v83, v83, v238, v238
v_rcp_f32 v80, v80
v_rcp_f32 v81, v81
v_rcp_f32 v82, v82
v_rcp_f32 v83, v83
v_mul_f32 v216, v216, v80
v_mul_f32 v217, v217, v81
s_add_u32 m0, s39, 105472
s_add_u32 s37, s37, s38
buffer_load_dwordx4 v21, s[8:11], s37 offen sc1 lds
v_mul_f32 v218, v218, v82
v_mul_f32 v219, v219, v83
v_cvt_pk_bf16_f32 v116, v216, v217
v_cvt_pk_bf16_f32 v117, v218, v219
v_mul_f32 v80, v140, v140
v_mul_f32 v81, v141, v141
buffer_store_dwordx4 v[104:107], v27, s[24:27], 0 offen offset:512 sc1
s_waitcnt vmcnt(19)
s_mov_b32 s41, 0x10000
s_waitcnt vmcnt(27)
s_branch Lpf_162
Lpoll_160:
s_waitcnt vmcnt(0)
Lpf_162:
v_cmp_ne_u32 vcc, v12, v11
s_nop 4
s_cbranch_vccz Lpok_161
buffer_load_dword v11, v10, s[56:59], 0 offen sc1
s_sub_u32 s41, s41, 1
s_cmp_lg_u32 s41, 0
s_cbranch_scc1 Lpoll_160
s_waitcnt vmcnt(0)
Lpok_161:
s_barrier
s_add_u32 s37, s37, s29
s_add_u32 m0, s39, 0
s_add_u32 s37, s37, s40
buffer_load_dwordx4 v21, s[8:11], s37 offen sc1 lds
v_mul_f32 v82, v142, v142
v_mul_f32 v83, v143, v143
v_fma_f32 v80, v80, v235, v231
v_fma_f32 v81, v81, v235, v231
v_fma_f32 v82, v82, v235, v231
v_fma_f32 v83, v83, v235, v231
v_mul_f32 v80, v80, v140
s_add_u32 m0, s39, 1024
s_add_u32 s37, s37, s38
buffer_load_dwordx4 v21, s[8:11], s37 offen sc1 lds
v_mul_f32 v81, v81, v141
v_mul_f32 v82, v82, v142
v_mul_f32 v83, v83, v143
v_exp_f32 v80, v80
v_exp_f32 v81, v81
v_exp_f32 v82, v82
s_add_u32 m0, s39, 2048
s_add_u32 s37, s37, s38
buffer_load_dwordx4 v21, s[8:11], s37 offen sc1 lds
v_exp_f32 v83, v83
v_mul_f32 v188, v140, v188
v_mul_f32 v189, v141, v189
v_mul_f32 v190, v142, v190
v_mul_f32 v191, v143, v191
v_fma_f32 v80, v80, v239, v239
v_fma_f32 v81, v81, v239, v239
s_add_u32 m0, s39, 3072
s_add_u32 s37, s37, s38
buffer_load_dwordx4 v21, s[8:11], s37 offen sc1 lds
v_fma_f32 v82, v82, v239, v239
v_fma_f32 v83, v83, v239, v239
v_rcp_f32 v80, v80
v_rcp_f32 v81, v81
v_rcp_f32 v82, v82
v_rcp_f32 v83, v83
s_add_u32 m0, s39, 4096
s_add_u32 s37, s37, s55
buffer_load_dwordx4 v21, s[8:11], s37 offen sc1 lds
v_mul_f32 v188, v188, v80
v_mul_f32 v189, v189, v81
v_mul_f32 v190, v190, v82
v_mul_f32 v191, v191, v83
v_cvt_pk_bf16_f32 v108, v188, v189
v_cvt_pk_bf16_f32 v109, v190, v191
v_mul_f32 v84, v156, v156
s_add_u32 m0, s39, 5120
s_add_u32 s37, s37, s38
buffer_load_dwordx4 v21, s[8:11], s37 offen sc1 lds
v_mul_f32 v85, v157, v157
v_mul_f32 v86, v158, v158
v_mul_f32 v87, v159, v159
v_fma_f32 v84, v84, v235, v231
v_fma_f32 v85, v85, v235, v231
v_fma_f32 v86, v86, v235, v231
s_add_u32 m0, s39, 6144
s_add_u32 s37, s37, s38
buffer_load_dwordx4 v21, s[8:11], s37 offen sc1 lds
v_fma_f32 v87, v87, v235, v231
v_mul_f32 v84, v84, v156
v_mul_f32 v85, v85, v157
v_mul_f32 v86, v86, v158
v_mul_f32 v87, v87, v159
v_exp_f32 v84, v84
v_exp_f32 v85, v85
s_add_u32 m0, s39, 7168
s_add_u32 s37, s37, s38
buffer_load_dwordx4 v21, s[8:11], s37 offen sc1 lds
v_exp_f32 v86, v86
v_exp_f32 v87, v87
v_mul_f32 v204, v156, v204
v_mul_f32 v205, v157, v205
v_mul_f32 v206, v158, v206
v_mul_f32 v207, v159, v207
s_waitcnt vmcnt(17)
s_barrier
s_add_u32 m0, s39, 32768
s_add_u32 s37, s37, s40
buffer_load_dwordx4 v21, s[8:11], s37 offen sc1 lds
v_fma_f32 v84, v84, v239, v239
v_fma_f32 v85, v85, v239, v239
v_fma_f32 v86, v86, v239, v239
v_fma_f32 v87, v87, v239, v239
v_rcp_f32 v84, v84
v_rcp_f32 v85, v85
v_rcp_f32 v86, v86
s_add_u32 m0, s39, 33792
s_add_u32 s37, s37, s38
buffer_load_dwordx4 v21, s[8:11], s37 offen sc1 lds
v_rcp_f32 v87, v87
v_mul_f32 v204, v204, v84
v_mul_f32 v205, v205, v85
v_mul_f32 v206, v206, v86
v_mul_f32 v207, v207, v87
v_cvt_pk_bf16_f32 v110, v204, v205
v_cvt_pk_bf16_f32 v111, v206, v207
s_add_u32 m0, s39, 34816
s_add_u32 s37, s37, s38
buffer_load_dwordx4 v21, s[8:11], s37 offen sc1 lds
v_mul_f32 v80, v172, v172
v_mul_f32 v81, v173, v173
v_mul_f32 v82, v174, v174
v_mul_f32 v83, v175, v175
v_fma_f32 v80, v80, v235, v231
s_add_u32 m0, s39, 35840
s_add_u32 s37, s37, s38
buffer_load_dwordx4 v21, s[8:11], s37 offen sc1 lds
v_fma_f32 v81, v81, v235, v231
v_fma_f32 v82, v82, v235, v231
v_fma_f32 v83, v83, v235, v231
v_mul_f32 v80, v80, v172
v_mul_f32 v81, v81, v173
v_mul_f32 v82, v82, v174
v_mul_f32 v83, v83, v175
s_add_u32 m0, s39, 36864
s_add_u32 s37, s37, s55
buffer_load_dwordx4 v21, s[8:11], s37 offen sc1 lds
v_exp_f32 v80, v80
v_exp_f32 v81, v81
v_exp_f32 v82, v82
v_exp_f32 v83, v83
v_mul_f32 v220, v172, v220
v_mul_f32 v221, v173, v221
v_mul_f32 v222, v174, v222
s_add_u32 m0, s39, 37888
s_add_u32 s37, s37, s38
buffer_load_dwordx4 v21, s[8:11], s37 offen sc1 lds
v_mul_f32 v223, v175, v223
v_fma_f32 v80, v80, v239, v239
v_fma_f32 v81, v81, v239, v239
v_fma_f32 v82, v82, v239, v239
v_fma_f32 v83, v83, v239, v239
v_rcp_f32 v80, v80
s_add_u32 m0, s39, 38912
s_add_u32 s37, s37, s38
buffer_load_dwordx4 v21, s[8:11], s37 offen sc1 lds
v_rcp_f32 v81, v81
v_rcp_f32 v82, v82
v_rcp_f32 v83, v83
v_mul_f32 v220, v220, v80
v_mul_f32 v221, v221, v81
v_mul_f32 v222, v222, v82
v_mul_f32 v223, v223, v83
s_add_u32 m0, s39, 39936
s_add_u32 s37, s37, s38
buffer_load_dwordx4 v21, s[8:11], s37 offen sc1 lds
v_cvt_pk_bf16_f32 v118, v220, v221
v_cvt_pk_bf16_f32 v119, v222, v223
s_nop 1
v_permlane32_swap_b32 v116, v118
v_permlane32_swap_b32 v117, v119
buffer_store_dwordx4 v[108:111], v27, s[24:27], 0 offen offset:768 sc1
buffer_store_dwordx4 v[116:119], v28, s[24:27], 0 offen offset:512 sc1
s_waitcnt vmcnt(19)
s_barrier
s_add_u32 m0, s39, 65536
s_add_u32 s37, s37, s40
buffer_load_dwordx4 v21, s[8:11], s37 offen sc1 lds
s_add_u32 m0, s39, 66560
s_add_u32 s37, s37, s38
buffer_load_dwordx4 v21, s[8:11], s37 offen sc1 lds
s_add_u32 m0, s39, 67584
s_add_u32 s37, s37, s38
buffer_load_dwordx4 v21, s[8:11], s37 offen sc1 lds
s_add_u32 m0, s39, 68608
s_add_u32 s37, s37, s38
buffer_load_dwordx4 v21, s[8:11], s37 offen sc1 lds
s_add_u32 m0, s39, 69632
s_add_u32 s37, s37, s55
buffer_load_dwordx4 v21, s[8:11], s37 offen sc1 lds
s_add_u32 m0, s39, 70656
s_add_u32 s37, s37, s38
buffer_load_dwordx4 v21, s[8:11], s37 offen sc1 lds
s_add_u32 m0, s39, 71680
s_add_u32 s37, s37, s38
buffer_load_dwordx4 v21, s[8:11], s37 offen sc1 lds
s_add_u32 m0, s39, 72704
s_add_u32 s37, s37, s38
buffer_load_dwordx4 v21, s[8:11], s37 offen sc1 lds
s_waitcnt vmcnt(8)
s_barrier
s_cmp_ge_u32 s50, 12
s_cselect_b32 s44, 64, 0
s_add_u32 s44, s44, s34
s_add_u32 s43, s44, 64
s_lshl_b32 s43, s43, 7
v_mov_b32 v10, s43
v_mov_b32 v11, 1
s_mov_b64 exec, 1
buffer_atomic_add v11, v10, s[56:59], 0 offen sc1
s_mov_b64 exec, -1
s_add_u32 m0, s39, 98304
s_add_u32 s37, s37, s40
buffer_load_dwordx4 v21, s[8:11], s37 offen sc1 lds
s_add_u32 m0, s39, 99328
s_add_u32 s37, s37, s38
buffer_load_dwordx4 v21, s[8:11], s37 offen sc1 lds
s_add_u32 m0, s39, 100352
s_add_u32 s37, s37, s38
buffer_load_dwordx4 v21, s[8:11], s37 offen sc1 lds
s_add_u32 m0, s39, 101376
s_add_u32 s37, s37, s38
buffer_load_dwordx4 v21, s[8:11], s37 offen sc1 lds
s_add_u32 m0, s39, 102400
s_add_u32 s37, s37, s55
buffer_load_dwordx4 v21, s[8:11], s37 offen sc1 lds
s_add_u32 m0, s39, 103424
s_add_u32 s37, s37, s38
buffer_load_dwordx4 v21, s[8:11], s37 offen sc1 lds
s_add_u32 m0, s39, 104448
s_add_u32 s37, s37, s38
buffer_load_dwordx4 v21, s[8:11], s37 offen sc1 lds
s_add_u32 m0, s39, 105472
s_add_u32 s37, s37, s38
buffer_load_dwordx4 v21, s[8:11], s37 offen sc1 lds
s_waitcnt vmcnt(19)
s_barrier
s_lshr_b32 s44, s2, 3
s_lshl_b32 s44, s44, 16
s_add_u32 s43, s44, 4194304
buffer_load_dword v30, v29, s[80:83], s43 offen
s_add_u32 m0, s39, 0
s_add_u32 s37, s37, s40
buffer_load_dwordx4 v21, s[8:11], s37 offen sc1 lds
s_add_u32 m0, s39, 1024
s_add_u32 s37, s37, s38
buffer_load_dwordx4 v21, s[8:11], s37 offen sc1 lds
s_add_u32 m0, s39, 2048
s_add_u32 s37, s37, s38
buffer_load_dwordx4 v21, s[8:11], s37 offen sc1 lds
s_add_u32 m0, s39, 3072
s_add_u32 s37, s37, s38
buffer_load_dwordx4 v21, s[8:11], s37 offen sc1 lds
s_add_u32 m0, s39, 4096
s_add_u32 s37, s37, s55
buffer_load_dwordx4 v21, s[8:11], s37 offen sc1 lds
s_add_u32 m0, s39, 5120
s_add_u32 s37, s37, s38
buffer_load_dwordx4 v21, s[8:11], s37 offen sc1 lds
s_add_u32 m0, s39, 6144
s_add_u32 s37, s37, s38
buffer_load_dwordx4 v21, s[8:11], s37 offen sc1 lds
s_add_u32 m0, s39, 7168
s_add_u32 s37, s37, s38
buffer_load_dwordx4 v21, s[8:11], s37 offen sc1 lds
s_waitcnt vmcnt(18)
s_barrier
s_add_u32 s43, s34, 64
s_lshl_b32 s43, s43, 7
v_mov_b32 v10, s43
v_mov_b32 v12, 12
buffer_load_dword v11, v10, s[56:59], 0 offen sc1
s_add_u32 m0, s39, 32768
s_add_u32 s37, s37, s40
buffer_load_dwordx4 v21, s[8:11], s37 offen sc1 lds
s_add_u32 m0, s39, 33792
s_add_u32 s37, s37, s38
buffer_load_dwordx4 v21, s[8:11], s37 offen sc1 lds
s_add_u32 m0, s39, 34816
s_add_u32 s37, s37, s38
buffer_load_dwordx4 v21, s[8:11], s37 offen sc1 lds
s_add_u32 m0, s39, 35840
s_add_u32 s37, s37, s38
buffer_load_dwordx4 v21, s[8:11], s37 offen sc1 lds
s_add_u32 m0, s39, 36864
s_add_u32 s37, s37, s55
buffer_load_dwordx4 v21, s[8:11], s37 offen sc1 lds
s_add_u32 m0, s39, 37888
s_add_u32 s37, s37, s38
buffer_load_dwordx4 v21, s[8:11], s37 offen sc1 lds
s_add_u32 m0, s39, 38912
s_add_u32 s37, s37, s38
buffer_load_dwordx4 v21, s[8:11], s37 offen sc1 lds
s_add_u32 m0, s39, 39936
s_add_u32 s37, s37, s38
buffer_load_dwordx4 v21, s[8:11], s37 offen sc1 lds
s_waitcnt vmcnt(18)
s_barrier
s_add_u32 m0, s39, 65536
s_add_u32 s37, s37, s40
buffer_load_dwordx4 v21, s[8:11], s37 offen sc1 lds
s_add_u32 m0, s39, 66560
s_add_u32 s37, s37, s38
buffer_load_dwordx4 v21, s[8:11], s37 offen sc1 lds
s_add_u32 m0, s39, 67584
s_add_u32 s37, s37, s38
buffer_load_dwordx4 v21, s[8:11], s37 offen sc1 lds
s_add_u32 m0, s39, 68608
s_add_u32 s37, s37, s38
buffer_load_dwordx4 v21, s[8:11], s37 offen sc1 lds
s_add_u32 m0, s39, 69632
s_add_u32 s37, s37, s55
buffer_load_dwordx4 v21, s[8:11], s37 offen sc1 lds
s_add_u32 m0, s39, 70656
s_add_u32 s37, s37, s38
buffer_load_dwordx4 v21, s[8:11], s37 offen sc1 lds
s_add_u32 m0, s39, 71680
s_add_u32 s37, s37, s38
buffer_load_dwordx4 v21, s[8:11], s37 offen sc1 lds
s_add_u32 m0, s39, 72704
s_add_u32 s37, s37, s38
buffer_load_dwordx4 v21, s[8:11], s37 offen sc1 lds
s_waitcnt vmcnt(17)
s_barrier
s_branch Lw_163
Lr_164:
s_add_u32 m0, s39, 98304
s_add_u32 s37, s37, s40
buffer_load_dwordx4 v21, s[8:11], s37 offen sc1 lds
s_add_u32 m0, s39, 99328
s_add_u32 s37, s37, s38
buffer_load_dwordx4 v21, s[8:11], s37 offen sc1 lds
s_add_u32 m0, s39, 100352
s_add_u32 s37, s37, s38
buffer_load_dwordx4 v21, s[8:11], s37 offen sc1 lds
s_add_u32 m0, s39, 101376
s_add_u32 s37, s37, s38
buffer_load_dwordx4 v21, s[8:11], s37 offen sc1 lds
s_add_u32 m0, s39, 102400
s_add_u32 s37, s37, s55
buffer_load_dwordx4 v21, s[8:11], s37 offen sc1 lds
s_add_u32 m0, s39, 103424
s_add_u32 s37, s37, s38
buffer_load_dwordx4 v21, s[8:11], s37 offen sc1 lds
s_add_u32 m0, s39, 104448
s_add_u32 s37, s37, s38
buffer_load_dwordx4 v21, s[8:11], s37 offen sc1 lds
s_add_u32 m0, s39, 105472
s_add_u32 s37, s37, s38
buffer_load_dwordx4 v21, s[8:11], s37 offen sc1 lds
s_waitcnt vmcnt(16)
s_mov_b32 s41, 0x10000
s_waitcnt vmcnt(24)
s_branch Lpf_167
Lpoll_165:
s_waitcnt vmcnt(0)
Lpf_167:
v_cmp_ne_u32 vcc, v12, v11
s_nop 4
s_cbranch_vccz Lpok_166
buffer_load_dword v11, v10, s[56:59], 0 offen sc1
s_sub_u32 s41, s41, 1
s_cmp_lg_u32 s41, 0
s_cbranch_scc1 Lpoll_165
s_waitcnt vmcnt(0)
Lpok_166:
s_barrier
s_mul_i32 s40, s53, 983040
s_add_u32 m0, s39, 0
s_add_u32 s37, s40, 4194304
buffer_load_dwordx4 v21, s[8:11], s37 offen sc1 lds
s_add_u32 m0, s39, 1024
s_add_u32 s37, s40, 4210688
buffer_load_dwordx4 v21, s[8:11], s37 offen sc1 lds
s_add_u32 m0, s39, 2048
s_add_u32 s37, s40, 4227072
buffer_load_dwordx4 v21, s[8:11], s37 offen sc1 lds
s_add_u32 m0, s39, 3072
s_add_u32 s37, s40, 4243456
buffer_load_dwordx4 v21, s[8:11], s37 offen sc1 lds
s_add_u32 m0, s39, 4096
s_add_u32 s37, s40, 4292608
buffer_load_dwordx4 v21, s[8:11], s37 offen sc1 lds
s_add_u32 m0, s39, 5120
s_add_u32 s37, s40, 4308992
buffer_load_dwordx4 v21, s[8:11], s37 offen sc1 lds
s_add_u32 m0, s39, 6144
s_add_u32 s37, s40, 4325376
buffer_load_dwordx4 v21, s[8:11], s37 offen sc1 lds
s_add_u32 m0, s39, 7168
s_add_u32 s37, s40, 4341760
buffer_load_dwordx4 v21, s[8:11], s37 offen sc1 lds
s_waitcnt vmcnt(16)
s_barrier
s_add_u32 m0, s39, 32768
s_add_u32 s37, s40, 4259840
buffer_load_dwordx4 v21, s[8:11], s37 offen sc1 lds
s_add_u32 m0, s39, 33792
s_add_u32 s37, s40, 4358144
buffer_load_dwordx4 v21, s[8:11], s37 offen sc1 lds
s_add_u32 m0, s39, 34816
s_add_u32 s37, s40, 4276224
buffer_load_dwordx4 v21, s[8:11], s37 offen sc1 lds
s_add_u32 m0, s39, 35840
s_add_u32 s37, s40, 4374528
buffer_load_dwordx4 v21, s[8:11], s37 offen sc1 lds
s_add_u32 m0, s39, 36864
s_add_u32 s37, s40, 4390912
buffer_load_dwordx4 v21, s[8:11], s37 offen sc1 lds
s_add_u32 m0, s39, 37888
s_add_u32 s37, s40, 4407296
buffer_load_dwordx4 v21, s[8:11], s37 offen sc1 lds
s_add_u32 m0, s39, 38912
s_add_u32 s37, s40, 4423680
buffer_load_dwordx4 v21, s[8:11], s37 offen sc1 lds
s_add_u32 m0, s39, 39936
s_add_u32 s37, s40, 4440064
buffer_load_dwordx4 v21, s[8:11], s37 offen sc1 lds
s_waitcnt vmcnt(16)
s_barrier
s_add_u32 m0, s39, 65536
s_add_u32 s37, s40, 4489216
buffer_load_dwordx4 v21, s[8:11], s37 offen sc1 lds
s_add_u32 m0, s39, 66560
s_add_u32 s37, s40, 4505600
buffer_load_dwordx4 v21, s[8:11], s37 offen sc1 lds
s_add_u32 m0, s39, 67584
s_add_u32 s37, s40, 4521984
buffer_load_dwordx4 v21, s[8:11], s37 offen sc1 lds
s_add_u32 m0, s39, 68608
s_add_u32 s37, s40, 4538368
buffer_load_dwordx4 v21, s[8:11], s37 offen sc1 lds
s_add_u32 m0, s39, 69632
s_add_u32 s37, s40, 4456448
buffer_load_dwordx4 v21, s[8:11], s37 offen sc1 lds
s_add_u32 m0, s39, 70656
s_add_u32 s37, s40, 4554752
buffer_load_dwordx4 v21, s[8:11], s37 offen sc1 lds
s_add_u32 m0, s39, 71680
s_add_u32 s37, s40, 4472832
buffer_load_dwordx4 v21, s[8:11], s37 offen sc1 lds
s_add_u32 m0, s39, 72704
s_add_u32 s37, s40, 4571136
buffer_load_dwordx4 v21, s[8:11], s37 offen sc1 lds
s_waitcnt vmcnt(16)
s_barrier
s_add_u32 m0, s39, 98304
s_add_u32 s37, s40, 4784128
buffer_load_dwordx4 v21, s[8:11], s37 offen sc1 lds
s_add_u32 m0, s39, 99328
s_add_u32 s37, s40, 4800512
buffer_load_dwordx4 v21, s[8:11], s37 offen sc1 lds
s_add_u32 m0, s39, 100352
s_add_u32 s37, s40, 4816896
buffer_load_dwordx4 v21, s[8:11], s37 offen sc1 lds
s_add_u32 m0, s39, 101376
s_add_u32 s37, s40, 4833280
buffer_load_dwordx4 v21, s[8:11], s37 offen sc1 lds
s_add_u32 m0, s39, 102400
s_add_u32 s37, s40, 4882432
buffer_load_dwordx4 v21, s[8:11], s37 offen sc1 lds
s_add_u32 m0, s39, 103424
s_add_u32 s37, s40, 4898816
buffer_load_dwordx4 v21, s[8:11], s37 offen sc1 lds
s_add_u32 m0, s39, 104448
s_add_u32 s37, s40, 4915200
buffer_load_dwordx4 v21, s[8:11], s37 offen sc1 lds
s_add_u32 m0, s39, 105472
s_add_u32 s37, s40, 4931584
buffer_load_dwordx4 v21, s[8:11], s37 offen sc1 lds
s_waitcnt vmcnt(16)
s_barrier
s_lshr_b32 s44, s2, 3
s_and_b32 s44, s44, 15
s_lshl_b32 s44, s44, 16
s_add_u32 s43, s44, 6291456
buffer_load_dword v30, v29, s[80:83], s43 offen
s_add_u32 m0, s39, 0
s_add_u32 s37, s40, 4849664
buffer_load_dwordx4 v21, s[8:11], s37 offen sc1 lds
s_add_u32 m0, s39, 1024
s_add_u32 s37, s40, 4947968
buffer_load_dwordx4 v21, s[8:11], s37 offen sc1 lds
s_add_u32 m0, s39, 2048
s_add_u32 s37, s40, 4866048
buffer_load_dwordx4 v21, s[8:11], s37 offen sc1 lds
s_add_u32 m0, s39, 3072
s_add_u32 s37, s40, 4964352
buffer_load_dwordx4 v21, s[8:11], s37 offen sc1 lds
s_add_u32 m0, s39, 4096
s_add_u32 s37, s40, 4980736
buffer_load_dwordx4 v21, s[8:11], s37 offen sc1 lds
s_add_u32 m0, s39, 5120
s_add_u32 s37, s40, 4997120
buffer_load_dwordx4 v21, s[8:11], s37 offen sc1 lds
s_add_u32 m0, s39, 6144
s_add_u32 s37, s40, 5013504
buffer_load_dwordx4 v21, s[8:11], s37 offen sc1 lds
s_add_u32 m0, s39, 7168
s_add_u32 s37, s40, 5029888
buffer_load_dwordx4 v21, s[8:11], s37 offen sc1 lds
s_waitcnt vmcnt(17)
s_barrier
s_add_u32 m0, s39, 32768
s_add_u32 s37, s40, 5079040
buffer_load_dwordx4 v21, s[8:11], s37 offen sc1 lds
s_add_u32 m0, s39, 33792
s_add_u32 s37, s40, 5095424
buffer_load_dwordx4 v21, s[8:11], s37 offen sc1 lds
s_add_u32 m0, s39, 34816
s_add_u32 s37, s40, 5111808
buffer_load_dwordx4 v21, s[8:11], s37 offen sc1 lds
s_add_u32 m0, s39, 35840
s_add_u32 s37, s40, 5128192
buffer_load_dwordx4 v21, s[8:11], s37 offen sc1 lds
s_add_u32 m0, s39, 36864
s_add_u32 s37, s40, 5046272
buffer_load_dwordx4 v21, s[8:11], s37 offen sc1 lds
s_add_u32 m0, s39, 37888
s_add_u32 s37, s40, 5144576
buffer_load_dwordx4 v21, s[8:11], s37 offen sc1 lds
s_add_u32 m0, s39, 38912
s_add_u32 s37, s40, 5062656
buffer_load_dwordx4 v21, s[8:11], s37 offen sc1 lds
s_add_u32 m0, s39, 39936
s_add_u32 s37, s40, 5160960
buffer_load_dwordx4 v21, s[8:11], s37 offen sc1 lds
s_waitcnt vmcnt(17)
s_barrier
s_waitcnt vmcnt(8)
s_barrier
s_waitcnt vmcnt(0)
s_barrier
s_barrier
s_add_u32 s43, s34, 128
s_lshl_b32 s43, s43, 7
v_mov_b32 v13, s43
v_mov_b32 v15, 4
buffer_load_dword v14, v13, s[56:59], 0 offen sc1
s_barrier
s_barrier
s_mov_b32 s41, 0x10000
Lpoll_168:
s_waitcnt vmcnt(0)
Lpf_170:
v_cmp_ne_u32 vcc, v15, v14
s_nop 4
s_cbranch_vccz Lpok_169
buffer_load_dword v14, v13, s[56:59], 0 offen sc1
s_sub_u32 s41, s41, 1
s_cmp_lg_u32 s41, 0
s_cbranch_scc1 Lpoll_168
s_waitcnt vmcnt(0)
Lpok_169:
s_barrier
s_barrier
s_lshl_b32 s43, s34, 4
s_add_u32 s43, s43, s35
s_and_b32 s44, s43, 1
s_lshl_b32 s44, s44, 2
s_lshr_b32 s43, s43, 1
s_add_u32 s43, s43, 144
s_lshl_b32 s43, s43, 7
s_add_u32 s43, s43, s44
v_mov_b32 v10, s43
v_mov_b32 v11, 1
s_mov_b64 exec, 1
buffer_store_dword v11, v10, s[56:59], 0 offen sc1
s_mov_b64 exec, -1
s_barrier
s_barrier
s_barrier
s_lshl_b32 s43, s34, 4
s_add_u32 s43, s43, s35
s_xor_b32 s43, s43, 1
s_and_b32 s44, s43, 1
s_lshl_b32 s44, s44, 2
s_lshr_b32 s43, s43, 1
s_add_u32 s43, s43, 144
s_lshl_b32 s43, s43, 7
s_add_u32 s43, s43, s44
v_mov_b32 v10, s43
v_mov_b32 v12, 1
buffer_load_dword v11, v10, s[56:59], 0 offen sc1
s_barrier
s_barrier
s_mov_b32 s41, 0x10000
Lpoll_171:
s_waitcnt vmcnt(0)
Lpf_173:
v_cmp_ne_u32 vcc, v12, v11
s_nop 4
s_cbranch_vccz Lpok_172
buffer_load_dword v11, v10, s[56:59], 0 offen sc1
s_sub_u32 s41, s41, 1
s_cmp_lg_u32 s41, 0
s_cbranch_scc1 Lpoll_171
s_waitcnt vmcnt(0)
Lpok_172:
s_barrier
s_branch Ldone_1
Lxr_8:
v_add_u32 v15, 0, v10
v_xor_b32 v16, 64, v15
ds_read_b128 v[240:243], v15 offset:0
ds_read_b128 v[244:247], v16 offset:0
ds_read_b128 v[248:251], v15 offset:128
ds_read_b128 v[252:255], v16 offset:128
s_branch Lxb_9
Lxr_10:
v_add_u32 v15, 43008, v10
v_xor_b32 v16, 64, v15
ds_read_b128 v[240:243], v15 offset:0
ds_read_b128 v[244:247], v16 offset:0
ds_read_b128 v[248:251], v15 offset:128
ds_read_b128 v[252:255], v16 offset:128
s_branch Lxb_11
Lxr_12:
v_add_u32 v15, 86016, v10
v_xor_b32 v16, 64, v15
ds_read_b128 v[240:243], v15 offset:0
ds_read_b128 v[244:247], v16 offset:0
ds_read_b128 v[248:251], v15 offset:128
ds_read_b128 v[252:255], v16 offset:128
s_branch Lxb_13
Lxr_14:
v_add_u32 v15, 0, v10
v_xor_b32 v16, 64, v15
ds_read_b128 v[240:243], v15 offset:0
ds_read_b128 v[244:247], v16 offset:0
ds_read_b128 v[248:251], v15 offset:128
ds_read_b128 v[252:255], v16 offset:128
s_branch Lxb_15
Lfx_53:
s_xor_b32 s44, s35, 1
s_and_b32 s44, s44, 15
s_lshl_b32 s44, s44, 14
s_add_u32 s43, s44, 0x2000
s_mov_b32 s45, 0x20000
Lre_52:
buffer_load_dwordx4 v[80:83], v2, s[12:15], s44 offen offset:0 sc1
buffer_load_dwordx4 v[84:87], v2, s[12:15], s44 offen offset:256 sc1
buffer_load_dwordx4 v[88:91], v2, s[12:15], s43 offen offset:0 sc1
buffer_load_dwordx4 v[92:95], v2, s[12:15], s43 offen offset:256 sc1
s_waitcnt vmcnt(0)
v_max3_u32 v19, v80, v81, v82
v_max3_u32 v19, v19, v83, v84
v_max3_u32 v19, v19, v85, v86
v_max3_u32 v19, v19, v87, v88
v_max3_u32 v19, v19, v89, v90
v_max3_u32 v19, v19, v91, v92
v_max3_u32 v19, v19, v93, v94
v_max_u32 v19, v19, v95
v_cmp_eq_u32 vcc, -1, v19
s_sub_u32 s45, s45, 1
s_cmp_eq_u32 s45, 0
s_cbranch_scc1 Lok_51
s_nop 2
s_cbranch_vccnz Lre_52
s_branch Lok_51
Lfx_56:
s_xor_b32 s44, s35, 2
s_and_b32 s44, s44, 15
s_lshl_b32 s44, s44, 14
s_add_u32 s43, s44, 0x2000
s_mov_b32 s45, 0x20000
Lre_55:
buffer_load_dwordx4 v[32:35], v2, s[12:15], s44 offen offset:0 sc1
buffer_load_dwordx4 v[36:39], v2, s[12:15], s44 offen offset:256 sc1
buffer_load_dwordx4 v[40:43], v2, s[12:15], s43 offen offset:0 sc1
buffer_load_dwordx4 v[44:47], v2, s[12:15], s43 offen offset:256 sc1
s_waitcnt vmcnt(0)
v_max3_u32 v19, v32, v33, v34
v_max3_u32 v19, v19, v35, v36
v_max3_u32 v19, v19, v37, v38
v_max3_u32 v19, v19, v39, v40
v_max3_u32 v19, v19, v41, v42
v_max3_u32 v19, v19, v43, v44
v_max3_u32 v19, v19, v45, v46
v_max_u32 v19, v19, v47
v_cmp_eq_u32 vcc, -1, v19
s_sub_u32 s45, s45, 1
s_cmp_eq_u32 s45, 0
s_cbranch_scc1 Lok_54
s_nop 2
s_cbranch_vccnz Lre_55
s_branch Lok_54
Lfx_59:
s_xor_b32 s44, s35, 3
s_and_b32 s44, s44, 15
s_lshl_b32 s44, s44, 14
s_add_u32 s43, s44, 0x2000
s_mov_b32 s45, 0x20000
Lre_58:
buffer_load_dwordx4 v[80:83], v2, s[12:15], s44 offen offset:0 sc1
buffer_load_dwordx4 v[84:87], v2, s[12:15], s44 offen offset:256 sc1
buffer_load_dwordx4 v[88:91], v2, s[12:15], s43 offen offset:0 sc1
buffer_load_dwordx4 v[92:95], v2, s[12:15], s43 offen offset:256 sc1
s_waitcnt vmcnt(0)
v_max3_u32 v19, v80, v81, v82
v_max3_u32 v19, v19, v83, v84
v_max3_u32 v19, v19, v85, v86
v_max3_u32 v19, v19, v87, v88
v_max3_u32 v19, v19, v89, v90
v_max3_u32 v19, v19, v91, v92
v_max3_u32 v19, v19, v93, v94
v_max_u32 v19, v19, v95
v_cmp_eq_u32 vcc, -1, v19
s_sub_u32 s45, s45, 1
s_cmp_eq_u32 s45, 0
s_cbranch_scc1 Lok_57
s_nop 2
s_cbranch_vccnz Lre_58
s_branch Lok_57
Lfx_62:
s_xor_b32 s44, s35, 4
s_and_b32 s44, s44, 15
s_lshl_b32 s44, s44, 14
s_add_u32 s43, s44, 0x2000
s_mov_b32 s45, 0x20000
Lre_61:
buffer_load_dwordx4 v[32:35], v2, s[12:15], s44 offen offset:0 sc1
buffer_load_dwordx4 v[36:39], v2, s[12:15], s44 offen offset:256 sc1
buffer_load_dwordx4 v[40:43], v2, s[12:15], s43 offen offset:0 sc1
buffer_load_dwordx4 v[44:47], v2, s[12:15], s43 offen offset:256 sc1
s_waitcnt vmcnt(0)
v_max3_u32 v19, v32, v33, v34
v_max3_u32 v19, v19, v35, v36
v_max3_u32 v19, v19, v37, v38
v_max3_u32 v19, v19, v39, v40
v_max3_u32 v19, v19, v41, v42
v_max3_u32 v19, v19, v43, v44
v_max3_u32 v19, v19, v45, v46
v_max_u32 v19, v19, v47
v_cmp_eq_u32 vcc, -1, v19
s_sub_u32 s45, s45, 1
s_cmp_eq_u32 s45, 0
s_cbranch_scc1 Lok_60
s_nop 2
s_cbranch_vccnz Lre_61
s_branch Lok_60
Lfx_65:
s_xor_b32 s44, s35, 5
s_and_b32 s44, s44, 15
s_lshl_b32 s44, s44, 14
s_add_u32 s43, s44, 0x2000
s_mov_b32 s45, 0x20000
Lre_64:
buffer_load_dwordx4 v[80:83], v2, s[12:15], s44 offen offset:0 sc1
buffer_load_dwordx4 v[84:87], v2, s[12:15], s44 offen offset:256 sc1
buffer_load_dwordx4 v[88:91], v2, s[12:15], s43 offen offset:0 sc1
buffer_load_dwordx4 v[92:95], v2, s[12:15], s43 offen offset:256 sc1
s_waitcnt vmcnt(0)
v_max3_u32 v19, v80, v81, v82
v_max3_u32 v19, v19, v83, v84
v_max3_u32 v19, v19, v85, v86
v_max3_u32 v19, v19, v87, v88
v_max3_u32 v19, v19, v89, v90
v_max3_u32 v19, v19, v91, v92
v_max3_u32 v19, v19, v93, v94
v_max_u32 v19, v19, v95
v_cmp_eq_u32 vcc, -1, v19
s_sub_u32 s45, s45, 1
s_cmp_eq_u32 s45, 0
s_cbranch_scc1 Lok_63
s_nop 2
s_cbranch_vccnz Lre_64
s_branch Lok_63
Lfx_68:
s_xor_b32 s44, s35, 6
s_and_b32 s44, s44, 15
s_lshl_b32 s44, s44, 14
s_add_u32 s43, s44, 0x2000
s_mov_b32 s45, 0x20000
Lre_67:
buffer_load_dwordx4 v[32:35], v2, s[12:15], s44 offen offset:0 sc1
buffer_load_dwordx4 v[36:39], v2, s[12:15], s44 offen offset:256 sc1
buffer_load_dwordx4 v[40:43], v2, s[12:15], s43 offen offset:0 sc1
buffer_load_dwordx4 v[44:47], v2, s[12:15], s43 offen offset:256 sc1
s_waitcnt vmcnt(0)
v_max3_u32 v19, v32, v33, v34
v_max3_u32 v19, v19, v35, v36
v_max3_u32 v19, v19, v37, v38
v_max3_u32 v19, v19, v39, v40
v_max3_u32 v19, v19, v41, v42
v_max3_u32 v19, v19, v43, v44
v_max3_u32 v19, v19, v45, v46
v_max_u32 v19, v19, v47
v_cmp_eq_u32 vcc, -1, v19
s_sub_u32 s45, s45, 1
s_cmp_eq_u32 s45, 0
s_cbranch_scc1 Lok_66
s_nop 2
s_cbranch_vccnz Lre_67
s_branch Lok_66
Lfx_71:
s_xor_b32 s44, s35, 7
s_and_b32 s44, s44, 15
s_lshl_b32 s44, s44, 14
s_add_u32 s43, s44, 0x2000
s_mov_b32 s45, 0x20000
Lre_70:
buffer_load_dwordx4 v[80:83], v2, s[12:15], s44 offen offset:0 sc1
buffer_load_dwordx4 v[84:87], v2, s[12:15], s44 offen offset:256 sc1
buffer_load_dwordx4 v[88:91], v2, s[12:15], s43 offen offset:0 sc1
buffer_load_dwordx4 v[92:95], v2, s[12:15], s43 offen offset:256 sc1
s_waitcnt vmcnt(0)
v_max3_u32 v19, v80, v81, v82
v_max3_u32 v19, v19, v83, v84
v_max3_u32 v19, v19, v85, v86
v_max3_u32 v19, v19, v87, v88
v_max3_u32 v19, v19, v89, v90
v_max3_u32 v19, v19, v91, v92
v_max3_u32 v19, v19, v93, v94
v_max_u32 v19, v19, v95
v_cmp_eq_u32 vcc, -1, v19
s_sub_u32 s45, s45, 1
s_cmp_eq_u32 s45, 0
s_cbranch_scc1 Lok_69
s_nop 2
s_cbranch_vccnz Lre_70
s_branch Lok_69
Lfx_74:
s_xor_b32 s44, s35, 8
s_and_b32 s44, s44, 15
s_lshl_b32 s44, s44, 14
s_add_u32 s43, s44, 0x2000
s_mov_b32 s45, 0x20000
Lre_73:
buffer_load_dwordx4 v[32:35], v2, s[12:15], s44 offen offset:0 sc1
buffer_load_dwordx4 v[36:39], v2, s[12:15], s44 offen offset:256 sc1
buffer_load_dwordx4 v[40:43], v2, s[12:15], s43 offen offset:0 sc1
buffer_load_dwordx4 v[44:47], v2, s[12:15], s43 offen offset:256 sc1
s_waitcnt vmcnt(0)
v_max3_u32 v19, v32, v33, v34
v_max3_u32 v19, v19, v35, v36
v_max3_u32 v19, v19, v37, v38
v_max3_u32 v19, v19, v39, v40
v_max3_u32 v19, v19, v41, v42
v_max3_u32 v19, v19, v43, v44
v_max3_u32 v19, v19, v45, v46
v_max_u32 v19, v19, v47
v_cmp_eq_u32 vcc, -1, v19
s_sub_u32 s45, s45, 1
s_cmp_eq_u32 s45, 0
s_cbranch_scc1 Lok_72
s_nop 2
s_cbranch_vccnz Lre_73
s_branch Lok_72
Lfx_77:
s_xor_b32 s44, s35, 9
s_and_b32 s44, s44, 15
s_lshl_b32 s44, s44, 14
s_add_u32 s43, s44, 0x2000
s_mov_b32 s45, 0x20000
Lre_76:
buffer_load_dwordx4 v[80:83], v2, s[12:15], s44 offen offset:0 sc1
buffer_load_dwordx4 v[84:87], v2, s[12:15], s44 offen offset:256 sc1
buffer_load_dwordx4 v[88:91], v2, s[12:15], s43 offen offset:0 sc1
buffer_load_dwordx4 v[92:95], v2, s[12:15], s43 offen offset:256 sc1
s_waitcnt vmcnt(0)
v_max3_u32 v19, v80, v81, v82
v_max3_u32 v19, v19, v83, v84
v_max3_u32 v19, v19, v85, v86
v_max3_u32 v19, v19, v87, v88
v_max3_u32 v19, v19, v89, v90
v_max3_u32 v19, v19, v91, v92
v_max3_u32 v19, v19, v93, v94
v_max_u32 v19, v19, v95
v_cmp_eq_u32 vcc, -1, v19
s_sub_u32 s45, s45, 1
s_cmp_eq_u32 s45, 0
s_cbranch_scc1 Lok_75
s_nop 2
s_cbranch_vccnz Lre_76
s_branch Lok_75
Lfx_80:
s_xor_b32 s44, s35, 10
s_and_b32 s44, s44, 15
s_lshl_b32 s44, s44, 14
s_add_u32 s43, s44, 0x2000
s_mov_b32 s45, 0x20000
Lre_79:
buffer_load_dwordx4 v[32:35], v2, s[12:15], s44 offen offset:0 sc1
buffer_load_dwordx4 v[36:39], v2, s[12:15], s44 offen offset:256 sc1
buffer_load_dwordx4 v[40:43], v2, s[12:15], s43 offen offset:0 sc1
buffer_load_dwordx4 v[44:47], v2, s[12:15], s43 offen offset:256 sc1
s_waitcnt vmcnt(0)
v_max3_u32 v19, v32, v33, v34
v_max3_u32 v19, v19, v35, v36
v_max3_u32 v19, v19, v37, v38
v_max3_u32 v19, v19, v39, v40
v_max3_u32 v19, v19, v41, v42
v_max3_u32 v19, v19, v43, v44
v_max3_u32 v19, v19, v45, v46
v_max_u32 v19, v19, v47
v_cmp_eq_u32 vcc, -1, v19
s_sub_u32 s45, s45, 1
s_cmp_eq_u32 s45, 0
s_cbranch_scc1 Lok_78
s_nop 2
s_cbranch_vccnz Lre_79
s_branch Lok_78
Lfx_83:
s_xor_b32 s44, s35, 1
s_and_b32 s44, s44, 15
s_lshl_b32 s44, s44, 14
s_add_u32 s44, s44, 0
s_mov_b32 s45, 0x20000
Lre_82:
buffer_load_dwordx4 v[32:35], v2, s[12:15], s44 offen offset:0 sc1
buffer_load_dwordx4 v[36:39], v2, s[12:15], s44 offen offset:256 sc1
buffer_load_dwordx4 v[40:43], v2, s[12:15], s44 offen offset:512 sc1
buffer_load_dwordx4 v[44:47], v2, s[12:15], s44 offen offset:768 sc1
s_waitcnt vmcnt(0)
v_max3_u32 v19, v32, v33, v34
v_max3_u32 v19, v19, v35, v36
v_max3_u32 v19, v19, v37, v38
v_max3_u32 v19, v19, v39, v40
v_max3_u32 v19, v19, v41, v42
v_max3_u32 v19, v19, v43, v44
v_max3_u32 v19, v19, v45, v46
v_max_u32 v19, v19, v47
v_cmp_eq_u32 vcc, -1, v19
s_sub_u32 s45, s45, 1
s_cmp_eq_u32 s45, 0
s_cbranch_scc1 Lok_81
s_nop 2
s_cbranch_vccnz Lre_82
s_branch Lok_81
Lfx_86:
s_xor_b32 s44, s35, 1
s_and_b32 s44, s44, 15
s_lshl_b32 s44, s44, 14
s_add_u32 s44, s44, 8192
s_mov_b32 s45, 0x20000
Lre_85:
buffer_load_dwordx4 v[80:83], v2, s[12:15], s44 offen offset:0 sc1
buffer_load_dwordx4 v[84:87], v2, s[12:15], s44 offen offset:256 sc1
buffer_load_dwordx4 v[88:91], v2, s[12:15], s44 offen offset:512 sc1
buffer_load_dwordx4 v[92:95], v2, s[12:15], s44 offen offset:768 sc1
s_waitcnt vmcnt(0)
v_max3_u32 v19, v80, v81, v82
v_max3_u32 v19, v19, v83, v84
v_max3_u32 v19, v19, v85, v86
v_max3_u32 v19, v19, v87, v88
v_max3_u32 v19, v19, v89, v90
v_max3_u32 v19, v19, v91, v92
v_max3_u32 v19, v19, v93, v94
v_max_u32 v19, v19, v95
v_cmp_eq_u32 vcc, -1, v19
s_sub_u32 s45, s45, 1
s_cmp_eq_u32 s45, 0
s_cbranch_scc1 Lok_84
s_nop 2
s_cbranch_vccnz Lre_85
s_branch Lok_84
Lfx_89:
s_xor_b32 s44, s35, 2
s_and_b32 s44, s44, 15
s_lshl_b32 s44, s44, 14
s_add_u32 s44, s44, 0
s_mov_b32 s45, 0x20000
Lre_88:
buffer_load_dwordx4 v[32:35], v2, s[12:15], s44 offen offset:0 sc1
buffer_load_dwordx4 v[36:39], v2, s[12:15], s44 offen offset:256 sc1
buffer_load_dwordx4 v[40:43], v2, s[12:15], s44 offen offset:512 sc1
buffer_load_dwordx4 v[44:47], v2, s[12:15], s44 offen offset:768 sc1
s_waitcnt vmcnt(0)
v_max3_u32 v19, v32, v33, v34
v_max3_u32 v19, v19, v35, v36
v_max3_u32 v19, v19, v37, v38
v_max3_u32 v19, v19, v39, v40
v_max3_u32 v19, v19, v41, v42
v_max3_u32 v19, v19, v43, v44
v_max3_u32 v19, v19, v45, v46
v_max_u32 v19, v19, v47
v_cmp_eq_u32 vcc, -1, v19
s_sub_u32 s45, s45, 1
s_cmp_eq_u32 s45, 0
s_cbranch_scc1 Lok_87
s_nop 2
s_cbranch_vccnz Lre_88
s_branch Lok_87
Lfx_92:
s_xor_b32 s44, s35, 2
s_and_b32 s44, s44, 15
s_lshl_b32 s44, s44, 14
s_add_u32 s44, s44, 8192
s_mov_b32 s45, 0x20000
Lre_91:
buffer_load_dwordx4 v[80:83], v2, s[12:15], s44 offen offset:0 sc1
buffer_load_dwordx4 v[84:87], v2, s[12:15], s44 offen offset:256 sc1
buffer_load_dwordx4 v[88:91], v2, s[12:15], s44 offen offset:512 sc1
buffer_load_dwordx4 v[92:95], v2, s[12:15], s44 offen offset:768 sc1
s_waitcnt vmcnt(0)
v_max3_u32 v19, v80, v81, v82
v_max3_u32 v19, v19, v83, v84
v_max3_u32 v19, v19, v85, v86
v_max3_u32 v19, v19, v87, v88
v_max3_u32 v19, v19, v89, v90
v_max3_u32 v19, v19, v91, v92
v_max3_u32 v19, v19, v93, v94
v_max_u32 v19, v19, v95
v_cmp_eq_u32 vcc, -1, v19
s_sub_u32 s45, s45, 1
s_cmp_eq_u32 s45, 0
s_cbranch_scc1 Lok_90
s_nop 2
s_cbranch_vccnz Lre_91
s_branch Lok_90
Lfx_95:
s_xor_b32 s44, s35, 3
s_and_b32 s44, s44, 15
s_lshl_b32 s44, s44, 14
s_add_u32 s44, s44, 0
s_mov_b32 s45, 0x20000
Lre_94:
buffer_load_dwordx4 v[32:35], v2, s[12:15], s44 offen offset:0 sc1
buffer_load_dwordx4 v[36:39], v2, s[12:15], s44 offen offset:256 sc1
buffer_load_dwordx4 v[40:43], v2, s[12:15], s44 offen offset:512 sc1
buffer_load_dwordx4 v[44:47], v2, s[12:15], s44 offen offset:768 sc1
s_waitcnt vmcnt(0)
v_max3_u32 v19, v32, v33, v34
v_max3_u32 v19, v19, v35, v36
v_max3_u32 v19, v19, v37, v38
v_max3_u32 v19, v19, v39, v40
v_max3_u32 v19, v19, v41, v42
v_max3_u32 v19, v19, v43, v44
v_max3_u32 v19, v19, v45, v46
v_max_u32 v19, v19, v47
v_cmp_eq_u32 vcc, -1, v19
s_sub_u32 s45, s45, 1
s_cmp_eq_u32 s45, 0
s_cbranch_scc1 Lok_93
s_nop 2
s_cbranch_vccnz Lre_94
s_branch Lok_93
Lfx_98:
s_xor_b32 s44, s35, 3
s_and_b32 s44, s44, 15
s_lshl_b32 s44, s44, 14
s_add_u32 s44, s44, 8192
s_mov_b32 s45, 0x20000
Lre_97:
buffer_load_dwordx4 v[80:83], v2, s[12:15], s44 offen offset:0 sc1
buffer_load_dwordx4 v[84:87], v2, s[12:15], s44 offen offset:256 sc1
buffer_load_dwordx4 v[88:91], v2, s[12:15], s44 offen offset:512 sc1
buffer_load_dwordx4 v[92:95], v2, s[12:15], s44 offen offset:768 sc1
s_waitcnt vmcnt(0)
v_max3_u32 v19, v80, v81, v82
v_max3_u32 v19, v19, v83, v84
v_max3_u32 v19, v19, v85, v86
v_max3_u32 v19, v19, v87, v88
v_max3_u32 v19, v19, v89, v90
v_max3_u32 v19, v19, v91, v92
v_max3_u32 v19, v19, v93, v94
v_max_u32 v19, v19, v95
v_cmp_eq_u32 vcc, -1, v19
s_sub_u32 s45, s45, 1
s_cmp_eq_u32 s45, 0
s_cbranch_scc1 Lok_96
s_nop 2
s_cbranch_vccnz Lre_97
s_branch Lok_96
Lfx_101:
s_xor_b32 s44, s35, 4
s_and_b32 s44, s44, 15
s_lshl_b32 s44, s44, 14
s_add_u32 s44, s44, 0
s_mov_b32 s45, 0x20000
Lre_100:
buffer_load_dwordx4 v[32:35], v2, s[12:15], s44 offen offset:0 sc1
buffer_load_dwordx4 v[36:39], v2, s[12:15], s44 offen offset:256 sc1
buffer_load_dwordx4 v[40:43], v2, s[12:15], s44 offen offset:512 sc1
buffer_load_dwordx4 v[44:47], v2, s[12:15], s44 offen offset:768 sc1
s_waitcnt vmcnt(0)
v_max3_u32 v19, v32, v33, v34
v_max3_u32 v19, v19, v35, v36
v_max3_u32 v19, v19, v37, v38
v_max3_u32 v19, v19, v39, v40
v_max3_u32 v19, v19, v41, v42
v_max3_u32 v19, v19, v43, v44
v_max3_u32 v19, v19, v45, v46
v_max_u32 v19, v19, v47
v_cmp_eq_u32 vcc, -1, v19
s_sub_u32 s45, s45, 1
s_cmp_eq_u32 s45, 0
s_cbranch_scc1 Lok_99
s_nop 2
s_cbranch_vccnz Lre_100
s_branch Lok_99
Lfx_104:
s_xor_b32 s44, s35, 4
s_and_b32 s44, s44, 15
s_lshl_b32 s44, s44, 14
s_add_u32 s44, s44, 8192
s_mov_b32 s45, 0x20000
Lre_103:
buffer_load_dwordx4 v[80:83], v2, s[12:15], s44 offen offset:0 sc1
buffer_load_dwordx4 v[84:87], v2, s[12:15], s44 offen offset:256 sc1
buffer_load_dwordx4 v[88:91], v2, s[12:15], s44 offen offset:512 sc1
buffer_load_dwordx4 v[92:95], v2, s[12:15], s44 offen offset:768 sc1
s_waitcnt vmcnt(0)
v_max3_u32 v19, v80, v81, v82
v_max3_u32 v19, v19, v83, v84
v_max3_u32 v19, v19, v85, v86
v_max3_u32 v19, v19, v87, v88
v_max3_u32 v19, v19, v89, v90
v_max3_u32 v19, v19, v91, v92
v_max3_u32 v19, v19, v93, v94
v_max_u32 v19, v19, v95
v_cmp_eq_u32 vcc, -1, v19
s_sub_u32 s45, s45, 1
s_cmp_eq_u32 s45, 0
s_cbranch_scc1 Lok_102
s_nop 2
s_cbranch_vccnz Lre_103
s_branch Lok_102
Lfx_107:
s_xor_b32 s44, s35, 5
s_and_b32 s44, s44, 15
s_lshl_b32 s44, s44, 14
s_add_u32 s44, s44, 0
s_mov_b32 s45, 0x20000
Lre_106:
buffer_load_dwordx4 v[32:35], v2, s[12:15], s44 offen offset:0 sc1
buffer_load_dwordx4 v[36:39], v2, s[12:15], s44 offen offset:256 sc1
buffer_load_dwordx4 v[40:43], v2, s[12:15], s44 offen offset:512 sc1
buffer_load_dwordx4 v[44:47], v2, s[12:15], s44 offen offset:768 sc1
s_waitcnt vmcnt(0)
v_max3_u32 v19, v32, v33, v34
v_max3_u32 v19, v19, v35, v36
v_max3_u32 v19, v19, v37, v38
v_max3_u32 v19, v19, v39, v40
v_max3_u32 v19, v19, v41, v42
v_max3_u32 v19, v19, v43, v44
v_max3_u32 v19, v19, v45, v46
v_max_u32 v19, v19, v47
v_cmp_eq_u32 vcc, -1, v19
s_sub_u32 s45, s45, 1
s_cmp_eq_u32 s45, 0
s_cbranch_scc1 Lok_105
s_nop 2
s_cbranch_vccnz Lre_106
s_branch Lok_105
Lfx_110:
s_xor_b32 s44, s35, 5
s_and_b32 s44, s44, 15
s_lshl_b32 s44, s44, 14
s_add_u32 s44, s44, 8192
s_mov_b32 s45, 0x20000
Lre_109:
buffer_load_dwordx4 v[80:83], v2, s[12:15], s44 offen offset:0 sc1
buffer_load_dwordx4 v[84:87], v2, s[12:15], s44 offen offset:256 sc1
buffer_load_dwordx4 v[88:91], v2, s[12:15], s44 offen offset:512 sc1
buffer_load_dwordx4 v[92:95], v2, s[12:15], s44 offen offset:768 sc1
s_waitcnt vmcnt(0)
v_max3_u32 v19, v80, v81, v82
v_max3_u32 v19, v19, v83, v84
v_max3_u32 v19, v19, v85, v86
v_max3_u32 v19, v19, v87, v88
v_max3_u32 v19, v19, v89, v90
v_max3_u32 v19, v19, v91, v92
v_max3_u32 v19, v19, v93, v94
v_max_u32 v19, v19, v95
v_cmp_eq_u32 vcc, -1, v19
s_sub_u32 s45, s45, 1
s_cmp_eq_u32 s45, 0
s_cbranch_scc1 Lok_108
s_nop 2
s_cbranch_vccnz Lre_109
s_branch Lok_108
Lfx_113:
s_xor_b32 s44, s35, 6
s_and_b32 s44, s44, 15
s_lshl_b32 s44, s44, 14
s_add_u32 s44, s44, 0
s_mov_b32 s45, 0x20000
Lre_112:
buffer_load_dwordx4 v[32:35], v2, s[12:15], s44 offen offset:0 sc1
buffer_load_dwordx4 v[36:39], v2, s[12:15], s44 offen offset:256 sc1
buffer_load_dwordx4 v[40:43], v2, s[12:15], s44 offen offset:512 sc1
buffer_load_dwordx4 v[44:47], v2, s[12:15], s44 offen offset:768 sc1
s_waitcnt vmcnt(0)
v_max3_u32 v19, v32, v33, v34
v_max3_u32 v19, v19, v35, v36
v_max3_u32 v19, v19, v37, v38
v_max3_u32 v19, v19, v39, v40
v_max3_u32 v19, v19, v41, v42
v_max3_u32 v19, v19, v43, v44
v_max3_u32 v19, v19, v45, v46
v_max_u32 v19, v19, v47
v_cmp_eq_u32 vcc, -1, v19
s_sub_u32 s45, s45, 1
s_cmp_eq_u32 s45, 0
s_cbranch_scc1 Lok_111
s_nop 2
s_cbranch_vccnz Lre_112
s_branch Lok_111
Lfx_116:
s_xor_b32 s44, s35, 6
s_and_b32 s44, s44, 15
s_lshl_b32 s44, s44, 14
s_add_u32 s44, s44, 8192
s_mov_b32 s45, 0x20000
Lre_115:
buffer_load_dwordx4 v[80:83], v2, s[12:15], s44 offen offset:0 sc1
buffer_load_dwordx4 v[84:87], v2, s[12:15], s44 offen offset:256 sc1
buffer_load_dwordx4 v[88:91], v2, s[12:15], s44 offen offset:512 sc1
buffer_load_dwordx4 v[92:95], v2, s[12:15], s44 offen offset:768 sc1
s_waitcnt vmcnt(0)
v_max3_u32 v19, v80, v81, v82
v_max3_u32 v19, v19, v83, v84
v_max3_u32 v19, v19, v85, v86
v_max3_u32 v19, v19, v87, v88
v_max3_u32 v19, v19, v89, v90
v_max3_u32 v19, v19, v91, v92
v_max3_u32 v19, v19, v93, v94
v_max_u32 v19, v19, v95
v_cmp_eq_u32 vcc, -1, v19
s_sub_u32 s45, s45, 1
s_cmp_eq_u32 s45, 0
s_cbranch_scc1 Lok_114
s_nop 2
s_cbranch_vccnz Lre_115
s_branch Lok_114
Lfx_119:
s_xor_b32 s44, s35, 7
s_and_b32 s44, s44, 15
s_lshl_b32 s44, s44, 14
s_add_u32 s44, s44, 0
s_mov_b32 s45, 0x20000
Lre_118:
buffer_load_dwordx4 v[32:35], v2, s[12:15], s44 offen offset:0 sc1
buffer_load_dwordx4 v[36:39], v2, s[12:15], s44 offen offset:256 sc1
buffer_load_dwordx4 v[40:43], v2, s[12:15], s44 offen offset:512 sc1
buffer_load_dwordx4 v[44:47], v2, s[12:15], s44 offen offset:768 sc1
s_waitcnt vmcnt(0)
v_max3_u32 v19, v32, v33, v34
v_max3_u32 v19, v19, v35, v36
v_max3_u32 v19, v19, v37, v38
v_max3_u32 v19, v19, v39, v40
v_max3_u32 v19, v19, v41, v42
v_max3_u32 v19, v19, v43, v44
v_max3_u32 v19, v19, v45, v46
v_max_u32 v19, v19, v47
v_cmp_eq_u32 vcc, -1, v19
s_sub_u32 s45, s45, 1
s_cmp_eq_u32 s45, 0
s_cbranch_scc1 Lok_117
s_nop 2
s_cbranch_vccnz Lre_118
s_branch Lok_117
Lfx_122:
s_xor_b32 s44, s35, 7
s_and_b32 s44, s44, 15
s_lshl_b32 s44, s44, 14
s_add_u32 s44, s44, 8192
s_mov_b32 s45, 0x20000
Lre_121:
buffer_load_dwordx4 v[80:83], v2, s[12:15], s44 offen offset:0 sc1
buffer_load_dwordx4 v[84:87], v2, s[12:15], s44 offen offset:256 sc1
buffer_load_dwordx4 v[88:91], v2, s[12:15], s44 offen offset:512 sc1
buffer_load_dwordx4 v[92:95], v2, s[12:15], s44 offen offset:768 sc1
s_waitcnt vmcnt(0)
v_max3_u32 v19, v80, v81, v82
v_max3_u32 v19, v19, v83, v84
v_max3_u32 v19, v19, v85, v86
v_max3_u32 v19, v19, v87, v88
v_max3_u32 v19, v19, v89, v90
v_max3_u32 v19, v19, v91, v92
v_max3_u32 v19, v19, v93, v94
v_max_u32 v19, v19, v95
v_cmp_eq_u32 vcc, -1, v19
s_sub_u32 s45, s45, 1
s_cmp_eq_u32 s45, 0
s_cbranch_scc1 Lok_120
s_nop 2
s_cbranch_vccnz Lre_121
s_branch Lok_120
Ldone_1:
s_endpgm
.section .rodata,"a"
.p2align 6
.amdhsa_kernel sequential_preLN__sliding_local_dilated__glu_gated_geglu__prompt_kernel
  .amdhsa_next_free_vgpr 256
  .amdhsa_next_free_sgpr 100
  .amdhsa_accum_offset 256
  .amdhsa_group_segment_fixed_size 0
  .amdhsa_kernarg_size 80
  .amdhsa_user_sgpr_count 2
  .amdhsa_user_sgpr_kernarg_segment_ptr 1
  .amdhsa_system_sgpr_workgroup_id_x 1
  .amdhsa_float_denorm_mode_32 3
  .amdhsa_float_denorm_mode_16_64 3
.end_amdhsa_kernel
```
